```python
import torch

def _softmax(x, axis=-1):
    return torch.softmax(x, dim=axis)

def _gelu(x):
    return torch.nn.functional.gelu(x, approximate='tanh')

def _silu(x):
    return torch.nn.functional.silu(x)

def _sigmoid(x):
    return torch.sigmoid(x)

def _layernorm(x, axis=-1, eps=1e-05):
    m = x.mean(dim=axis, keepdim=True)
    v = x.var(dim=axis, keepdim=True, unbiased=False)
    return (x - m) / torch.sqrt(v + eps)

def _scatter_add(tgt, idx, src, axis=0):
    return tgt.clone().index_add_(axis, idx, src)

def _segment_sum(src, seg, n):
    out = torch.zeros((n,) + src.shape[1:], dtype=src.dtype)
    return out.index_add_(0, seg, src)

def _pad(x, pw):
    flat = tuple((v for pair in reversed(pw) for v in pair))
    return torch.nn.functional.pad(x, flat)
kernel_name = 'interleave_layers__linear_attn_block__memory_aug_recurrent_mem_tr__prompt'

def setup_inputs():

    _w = lambda a: (lambda t: t.to(torch.bfloat16) if t.is_floating_point() else t)(torch.as_tensor(a))

    def _A_setup():
        B, S, D = (1, 2048, 640)
        return {'x': _w((lambda *s: torch.randn(*s, dtype=torch.bfloat16) * 0.05)(B, S, D)), 'wqkv': _w((lambda *s: torch.randn(*s, dtype=torch.bfloat16) * 0.05)(D, 3 * D)), 'wo': _w((lambda *s: torch.randn(*s, dtype=torch.bfloat16) * 0.05)(D, D))}
    _A_in = _A_setup()

    def _B_setup():
        B, S, Dm = (1, 2048, 640)
        H, Dh = (32, 192)
        M, seg = (8, 32)
        seg = min(seg, S)
        S = S // seg * seg
        return {'x': _w((lambda *s: torch.randn(*s, dtype=torch.bfloat16) * 0.05)(B, S, Dm)), 'mem0': _w((lambda *s: torch.randn(*s, dtype=torch.bfloat16) * 0.8)(B, M, Dm)), 'Wq': _w((lambda *s: torch.randn(*s, dtype=torch.bfloat16) * 1.6)(Dm, H, Dh) * Dm ** (-0.5)), 'Wk': _w((lambda *s: torch.randn(*s, dtype=torch.bfloat16) * 1.6)(Dm, H, Dh) * Dm ** (-0.5)), 'Wv': _w((lambda *s: torch.randn(*s, dtype=torch.bfloat16) * 0.8)(Dm, H, Dh) * Dm ** (-0.5)), 'Wo': _w((lambda *s: torch.randn(*s, dtype=torch.bfloat16) * 0.8)(H, Dh, Dm) * (H * Dh) ** (-0.5)), 'seg_len': seg}
    _B_in = _B_setup()
    return {'A_x': _A_in['x'], 'A_wqkv': _A_in['wqkv'], 'A_wo': _A_in['wo'], 'B_x': _B_in['x'], 'B_mem0': _B_in['mem0'], 'B_Wq': _B_in['Wq'], 'B_Wk': _B_in['Wk'], 'B_Wv': _B_in['Wv'], 'B_Wo': _B_in['Wo'], 'B_seg_len': _B_in['seg_len']}

def reference(A_x, A_wqkv, A_wo, B_x, B_mem0, B_Wq, B_Wk, B_Wv, B_Wo, B_seg_len):

    def _A_ref(x, wqkv, wo):
        B, S, D = x.shape
        H = 32
        Dh = D // H
        qkv = (lambda x, *d: x.permute(*d))((x @ wqkv).reshape(B, S, 3, H, Dh), 2, 0, 3, 1, 4)
        q, k, v = (qkv[0], qkv[1], qkv[2])
        phi = lambda t: torch.where(t > 0, t + 1, torch.exp(t)) + 1e-06
        pq, pk = (phi(q), phi(k))
        kv = torch.einsum('bhsd,bhse->bhde', pk, v)
        z = torch.einsum('bhsd->bhd', pk)
        num = torch.einsum('bhqd,bhde->bhqe', pq, kv)
        den = torch.einsum('bhqd,bhd->bhq', pq, z)[..., None] + 1e-06
        o = num / den
        return (lambda x, *d: x.permute(*d))(o, 0, 2, 1, 3).reshape(B, S, D) @ wo

    def _B_ref(x, mem0, Wq, Wk, Wv, Wo, seg_len):
        B, S, Dm = x.shape
        H, Dh = (Wq.shape[1], Wq.shape[2])
        M = mem0.shape[1]
        scale = Dh ** (-0.5)
        n_seg = S // seg_len
        L = M + seg_len
        idx = torch.arange(L)
        mask = (idx[:, None] < M) | (idx[:, None] >= idx[None, :])
        mem = mem0
        outs = []
        for s in range(n_seg):
            xs = x[:, s * seg_len:(s + 1) * seg_len, :].clone()
            h = torch.concatenate([mem, xs], axis=1)
            q = torch.einsum('btd,dhe->bhte', h, Wq)
            k = torch.einsum('btd,dhe->bhte', h, Wk)
            v = torch.einsum('btd,dhe->bhte', h, Wv)
            scores = torch.einsum('bhqe,bhke->bhqk', q, k) * scale
            scores = torch.where(mask[None, None], scores, -1000000000.0)
            p = _softmax(scores, axis=-1)
            o = torch.einsum('bhqk,bhke->bhqe', p, v)
            o = torch.einsum('bhte,hed->btd', o, Wo)
            mem = o[:, :M, :].clone()
            outs.append(o[:, M:, :])
        return torch.concatenate(outs, axis=1)
    x = A_x
    x = x + _A_ref(_layernorm(x, axis=-1), A_wqkv, A_wo)
    x = x + _B_ref(_layernorm(x, axis=-1), B_mem0, B_Wq, B_Wk, B_Wv, B_Wo, B_seg_len)
    x = x + _A_ref(_layernorm(x, axis=-1), A_wqkv, A_wo)
    x = x + _B_ref(_layernorm(x, axis=-1), B_mem0, B_Wq, B_Wk, B_Wv, B_Wo, B_seg_len)
    return x
```

```asm
; @launch kernel=pack_kernel grid=(864,1,1) block=(256,1,1) lds=0
; @launch kernel=prep_kernel grid=(465,1,1) block=(256,1,1) lds=0
; @launch kernel=ln_a1_kernel grid=(512,1,1) block=(256,1,1) lds=0
; @launch kernel=qkv_a_kernel grid=(192,1,1) block=(256,1,1) lds=0
; @launch kernel=kvz_a1_kernel grid=(128,1,1) block=(256,1,1) lds=0
; @launch kernel=attn_a1_kernel grid=(256,1,1) block=(256,1,1) lds=86016
; @launch kernel=wo_a1_kernel grid=(128,1,1) block=(256,1,1) lds=0
; @launch kernel=ln_b1_kernel grid=(513,1,1) block=(256,1,1) lds=0
; @launch kernel=gemmb_kernel grid=(256,1,1) block=(256,1,1) lds=122880
; @launch kernel=chain1_kernel grid=(256,1,1) block=(256,1,1) lds=143616
; @launch kernel=w3a_kernel grid=(512,1,1) block=(256,1,1) lds=0
; @launch kernel=w3b1_kernel grid=(320,1,1) block=(256,1,1) lds=0
; @launch kernel=ln_a2_kernel grid=(512,1,1) block=(256,1,1) lds=0
; @launch kernel=qkv_a_kernel grid=(192,1,1) block=(256,1,1) lds=0
; @launch kernel=kvz_a2_kernel grid=(128,1,1) block=(256,1,1) lds=0
; @launch kernel=attn_a2_kernel grid=(256,1,1) block=(256,1,1) lds=86016
; @launch kernel=wo_a2_kernel grid=(128,1,1) block=(256,1,1) lds=0
; @launch kernel=ln_b2_kernel grid=(513,1,1) block=(256,1,1) lds=0
; @launch kernel=gemmb_kernel grid=(256,1,1) block=(256,1,1) lds=122880
; @launch kernel=chain2_kernel grid=(256,1,1) block=(256,1,1) lds=143616
; @launch kernel=w3a_kernel grid=(512,1,1) block=(256,1,1) lds=0
; @launch kernel=w3b2_kernel grid=(320,1,1) block=(256,1,1) lds=0
.amdgcn_target "amdgcn-amd-amdhsa--gfx950"
.text
.globl pack_kernel
.p2align 8
.type pack_kernel,@function
pack_kernel:
    v_lshrrev_b32 v1, 6, v0
    v_and_b32 v2, 63, v0
    s_nop 0
    v_readfirstlane_b32 s3, v1
    s_lshl_b32 s4, s2, 2
    s_add_u32 s4, s4, s3
    s_load_dwordx2 s[6:7], s[0:1], 96
    s_waitcnt lgkmcnt(0)
    s_mov_b32 s8, s6
    s_mov_b32 s9, s7
    s_mov_b32 s10, 268435456
    s_mov_b32 s11, 0x00020000
    s_cmp_lt_u32 s4, 3200
    s_cbranch_scc1 pack_kernel_pk
    s_cmp_ge_u32 s4, 3456
    s_cbranch_scc1 pack_kernel_end
    s_sub_u32 s4, s4, 3200
    s_lshl_b32 s5, s4, 10
    v_lshlrev_b32 v3, 4, v2
    v_add_u32 v3, s5, v3
    v_add_u32 v4, 242221056, v3
    s_cmp_lt_u32 s5, 0
    s_cbranch_scc1 pack_kernel_clr
    v_add_u32 v4, 242221056, v3
pack_kernel_clr:
    v_mov_b32 v8, 0
    v_mov_b32 v9, 0
    v_mov_b32 v10, 0
    v_mov_b32 v11, 0
    buffer_store_dwordx4 v[8:11], v4, s[8:11], 0 offen
    s_branch pack_kernel_end
pack_kernel_pk:
    s_cmp_lt_u32 s4, 2400
    s_cbranch_scc0 pack_kernel_nx0
    s_sub_u32 s4, s4, 0
    s_load_dwordx2 s[12:13], s[0:1], 8
    s_mov_b32 s20, 1920
    s_mov_b32 s21, 20
    s_mov_b32 s22, 243269632
    s_mov_b32 s23, 2457600
    s_mul_i32 s24, s4, 1639
    s_lshr_b32 s24, s24, 15
    s_branch pack_kernel_go
pack_kernel_nx0:
    s_cmp_lt_u32 s4, 3200
    s_cbranch_scc0 pack_kernel_nx1
    s_sub_u32 s4, s4, 2400
    s_load_dwordx2 s[12:13], s[0:1], 16
    s_mov_b32 s20, 640
    s_mov_b32 s21, 20
    s_mov_b32 s22, 246415360
    s_mov_b32 s23, 819200
    s_mul_i32 s24, s4, 205
    s_lshr_b32 s24, s24, 12
    s_branch pack_kernel_go
pack_kernel_nx1:
    s_branch pack_kernel_end
pack_kernel_go:
    s_waitcnt lgkmcnt(0)
    s_mov_b32 s16, s12
    s_mov_b32 s17, s13
    s_mov_b32 s18, s23
    s_mov_b32 s19, 0x00020000
    s_mul_i32 s25, s24, s21
    s_sub_u32 s25, s4, s25
    v_lshrrev_b32 v3, 4, v2
    v_lshlrev_b32 v3, 3, v3
    s_lshl_b32 s26, s25, 5
    v_add_u32 v3, s26, v3
    v_mul_lo_u32 v3, v3, s20
    v_and_b32 v4, 15, v2
    s_lshl_b32 s27, s24, 4
    v_add3_u32 v3, v3, v4, s27
    v_lshlrev_b32 v3, 1, v3
    s_lshl_b32 s28, s20, 1
    s_mov_b32 s29, 0
    buffer_load_ushort v12, v3, s[16:19], s29 offen
    s_add_u32 s29, s29, s28
    buffer_load_ushort v13, v3, s[16:19], s29 offen
    s_add_u32 s29, s29, s28
    buffer_load_ushort v14, v3, s[16:19], s29 offen
    s_add_u32 s29, s29, s28
    buffer_load_ushort v15, v3, s[16:19], s29 offen
    s_add_u32 s29, s29, s28
    buffer_load_ushort v16, v3, s[16:19], s29 offen
    s_add_u32 s29, s29, s28
    buffer_load_ushort v17, v3, s[16:19], s29 offen
    s_add_u32 s29, s29, s28
    buffer_load_ushort v18, v3, s[16:19], s29 offen
    s_add_u32 s29, s29, s28
    buffer_load_ushort v19, v3, s[16:19], s29 offen
    s_lshl_b32 s5, s4, 10
    s_add_u32 s5, s5, s22
    v_lshlrev_b32 v5, 4, v2
    v_add_u32 v5, s5, v5
    s_waitcnt vmcnt(0)
    v_lshl_or_b32 v8, v13, 16, v12
    v_lshl_or_b32 v9, v15, 16, v14
    v_lshl_or_b32 v10, v17, 16, v16
    v_lshl_or_b32 v11, v19, 16, v18
    buffer_store_dwordx4 v[8:11], v5, s[8:11], 0 offen
pack_kernel_end:
    s_endpgm
.section .rodata,"a"
.p2align 6
.amdhsa_kernel pack_kernel
  .amdhsa_next_free_vgpr 24
  .amdhsa_next_free_sgpr 40
  .amdhsa_accum_offset 24
  .amdhsa_group_segment_fixed_size 0
  .amdhsa_kernarg_size 104
  .amdhsa_user_sgpr_count 2
  .amdhsa_user_sgpr_kernarg_segment_ptr 1
  .amdhsa_system_sgpr_workgroup_id_x 1
.end_amdhsa_kernel
.text
.globl prep_kernel
.p2align 8
.type prep_kernel,@function
prep_kernel:
    s_cmp_ge_u32 s2, 465
    s_cbranch_scc1 prep_kernel_end
    s_load_dwordx2 s[4:5], s[0:1], 96
    v_lshrrev_b32 v1, 6, v0
    v_and_b32 v0, 63, v0
    s_nop 0
    v_readfirstlane_b32 s13, v1
    s_waitcnt lgkmcnt(0)
    s_mov_b32 s8, s4
    s_mov_b32 s9, s5
    s_mov_b32 s10, 268435456
    s_mov_b32 s11, 0x00020000
    s_cmp_eq_u32 s2, 0
    s_cbranch_scc1 prep_kernel_r_ctl
    s_sub_u32 s20, s2, 1
    s_cmp_lt_u32 s20, 160
    s_cbranch_scc1 prep_kernel_r_wvo
    s_sub_u32 s20, s20, 160
    s_cmp_lt_u32 s20, 240
    s_cbranch_scc1 prep_kernel_r_pwp
    s_sub_u32 s20, s20, 240
    s_sub_u32 s21, 0, s4
    s_and_b32 s21, s21, 0x1fffff
    s_mul_i32 s22, s20, 131072
    s_add_u32 s21, s21, s22
    s_lshl_b32 s22, s13, 10
    s_add_u32 s21, s21, s22
    v_lshlrev_b32 v1, 4, v0
    v_mov_b32 v4, -1
    v_mov_b32 v5, -1
    v_mov_b32 v6, -1
    v_mov_b32 v7, -1
    s_mov_b32 s22, 32
prep_kernel_clr_loop:
    buffer_store_dwordx4 v[4:7], v1, s[8:11], s21 offen
    s_add_u32 s21, s21, 4096
    s_sub_u32 s22, s22, 1
    s_cmp_lg_u32 s22, 0
    s_cbranch_scc1 prep_kernel_clr_loop
    s_branch prep_kernel_end
prep_kernel_r_ctl:
    s_cmp_lg_u32 s13, 0
    s_cbranch_scc1 prep_kernel_end
    v_lshlrev_b32 v1, 4, v0
    v_mov_b32 v4, 0
    v_mov_b32 v5, 0
    v_mov_b32 v6, 0
    v_mov_b32 v7, 0
    s_mov_b32 s21, 10485760
    buffer_store_dwordx4 v[4:7], v1, s[8:11], s21 offen
    s_mov_b32 s21, 10486784
    buffer_store_dwordx4 v[4:7], v1, s[8:11], s21 offen
    s_mov_b32 s21, 10487808
    buffer_store_dwordx4 v[4:7], v1, s[8:11], s21 offen
    s_mov_b32 s21, 10488832
    buffer_store_dwordx4 v[4:7], v1, s[8:11], s21 offen
    s_sub_u32 s22, 0, s4
    s_and_b32 s22, s22, 0x1fffff
    s_getreg_b32 s23, hwreg(HW_REG_XCC_ID)
    s_bfe_u32 s23, s23, 0x10002
    s_mov_b64 exec, 1
    v_mov_b32 v1, 0
    s_add_u32 s24, s22, 2086912
    s_mov_b32 s30, -1
    s_mov_b32 s25, 12
prep_kernel_cal00:
    s_memrealtime s[26:27]
    s_waitcnt lgkmcnt(0)
    buffer_store_dword v1, v1, s[8:11], s24 offen sc1
    s_waitcnt vmcnt(0)
    buffer_load_dword v2, v1, s[8:11], s24 offen sc1
    s_waitcnt vmcnt(0)
    buffer_store_dword v2, v1, s[8:11], s24 offen offset:64 sc1
    s_waitcnt vmcnt(0)
    buffer_load_dword v2, v1, s[8:11], s24 offen offset:64 sc1
    s_waitcnt vmcnt(0)
    s_memrealtime s[28:29]
    s_waitcnt lgkmcnt(0)
    s_sub_u32 s26, s28, s26
    s_min_u32 s30, s30, s26
    s_sub_u32 s25, s25, 1
    s_cmp_lg_u32 s25, 0
    s_cbranch_scc1 prep_kernel_cal00
    s_add_u32 s24, s22, 2095104
    s_mov_b32 s31, -1
    s_mov_b32 s25, 12
prep_kernel_cal01:
    s_memrealtime s[26:27]
    s_waitcnt lgkmcnt(0)
    buffer_store_dword v1, v1, s[8:11], s24 offen sc1
    s_waitcnt vmcnt(0)
    buffer_load_dword v2, v1, s[8:11], s24 offen sc1
    s_waitcnt vmcnt(0)
    buffer_store_dword v2, v1, s[8:11], s24 offen offset:64 sc1
    s_waitcnt vmcnt(0)
    buffer_load_dword v2, v1, s[8:11], s24 offen offset:64 sc1
    s_waitcnt vmcnt(0)
    s_memrealtime s[28:29]
    s_waitcnt lgkmcnt(0)
    s_sub_u32 s26, s28, s26
    s_min_u32 s31, s31, s26
    s_sub_u32 s25, s25, 1
    s_cmp_lg_u32 s25, 0
    s_cbranch_scc1 prep_kernel_cal01
    s_cmp_lt_u32 s31, s30
    s_cselect_b32 s24, 1, 0
    s_xor_b32 s24, s24, s23
    s_lshl_b32 s24, s24, 13
    v_mov_b32 v3, s24
    s_mov_b32 s25, 10551296
    buffer_store_dword v3, v1, s[8:11], s25 offen
    s_lshl_b32 s26, s30, 16
    s_or_b32 s26, s26, s31
    v_mov_b32 v3, s26
    buffer_store_dword v3, v1, s[8:11], s25 offen offset:64
    s_add_u32 s24, s22, 4184064
    s_mov_b32 s30, -1
    s_mov_b32 s25, 12
prep_kernel_cal10:
    s_memrealtime s[26:27]
    s_waitcnt lgkmcnt(0)
    buffer_store_dword v1, v1, s[8:11], s24 offen sc1
    s_waitcnt vmcnt(0)
    buffer_load_dword v2, v1, s[8:11], s24 offen sc1
    s_waitcnt vmcnt(0)
    buffer_store_dword v2, v1, s[8:11], s24 offen offset:64 sc1
    s_waitcnt vmcnt(0)
    buffer_load_dword v2, v1, s[8:11], s24 offen offset:64 sc1
    s_waitcnt vmcnt(0)
    s_memrealtime s[28:29]
    s_waitcnt lgkmcnt(0)
    s_sub_u32 s26, s28, s26
    s_min_u32 s30, s30, s26
    s_sub_u32 s25, s25, 1
    s_cmp_lg_u32 s25, 0
    s_cbranch_scc1 prep_kernel_cal10
    s_add_u32 s24, s22, 4192256
    s_mov_b32 s31, -1
    s_mov_b32 s25, 12
prep_kernel_cal11:
    s_memrealtime s[26:27]
    s_waitcnt lgkmcnt(0)
    buffer_store_dword v1, v1, s[8:11], s24 offen sc1
    s_waitcnt vmcnt(0)
    buffer_load_dword v2, v1, s[8:11], s24 offen sc1
    s_waitcnt vmcnt(0)
    buffer_store_dword v2, v1, s[8:11], s24 offen offset:64 sc1
    s_waitcnt vmcnt(0)
    buffer_load_dword v2, v1, s[8:11], s24 offen offset:64 sc1
    s_waitcnt vmcnt(0)
    s_memrealtime s[28:29]
    s_waitcnt lgkmcnt(0)
    s_sub_u32 s26, s28, s26
    s_min_u32 s31, s31, s26
    s_sub_u32 s25, s25, 1
    s_cmp_lg_u32 s25, 0
    s_cbranch_scc1 prep_kernel_cal11
    s_cmp_lt_u32 s31, s30
    s_cselect_b32 s24, 1, 0
    s_xor_b32 s24, s24, s23
    s_lshl_b32 s24, s24, 13
    v_mov_b32 v3, s24
    s_mov_b32 s25, 10551300
    buffer_store_dword v3, v1, s[8:11], s25 offen
    s_lshl_b32 s26, s30, 16
    s_or_b32 s26, s26, s31
    v_mov_b32 v3, s26
    buffer_store_dword v3, v1, s[8:11], s25 offen offset:64
    s_add_u32 s24, s22, 6281216
    s_mov_b32 s30, -1
    s_mov_b32 s25, 12
prep_kernel_cal20:
    s_memrealtime s[26:27]
    s_waitcnt lgkmcnt(0)
    buffer_store_dword v1, v1, s[8:11], s24 offen sc1
    s_waitcnt vmcnt(0)
    buffer_load_dword v2, v1, s[8:11], s24 offen sc1
    s_waitcnt vmcnt(0)
    buffer_store_dword v2, v1, s[8:11], s24 offen offset:64 sc1
    s_waitcnt vmcnt(0)
    buffer_load_dword v2, v1, s[8:11], s24 offen offset:64 sc1
    s_waitcnt vmcnt(0)
    s_memrealtime s[28:29]
    s_waitcnt lgkmcnt(0)
    s_sub_u32 s26, s28, s26
    s_min_u32 s30, s30, s26
    s_sub_u32 s25, s25, 1
    s_cmp_lg_u32 s25, 0
    s_cbranch_scc1 prep_kernel_cal20
    s_add_u32 s24, s22, 6289408
    s_mov_b32 s31, -1
    s_mov_b32 s25, 12
prep_kernel_cal21:
    s_memrealtime s[26:27]
    s_waitcnt lgkmcnt(0)
    buffer_store_dword v1, v1, s[8:11], s24 offen sc1
    s_waitcnt vmcnt(0)
    buffer_load_dword v2, v1, s[8:11], s24 offen sc1
    s_waitcnt vmcnt(0)
    buffer_store_dword v2, v1, s[8:11], s24 offen offset:64 sc1
    s_waitcnt vmcnt(0)
    buffer_load_dword v2, v1, s[8:11], s24 offen offset:64 sc1
    s_waitcnt vmcnt(0)
    s_memrealtime s[28:29]
    s_waitcnt lgkmcnt(0)
    s_sub_u32 s26, s28, s26
    s_min_u32 s31, s31, s26
    s_sub_u32 s25, s25, 1
    s_cmp_lg_u32 s25, 0
    s_cbranch_scc1 prep_kernel_cal21
    s_cmp_lt_u32 s31, s30
    s_cselect_b32 s24, 1, 0
    s_xor_b32 s24, s24, s23
    s_lshl_b32 s24, s24, 13
    v_mov_b32 v3, s24
    s_mov_b32 s25, 10551304
    buffer_store_dword v3, v1, s[8:11], s25 offen
    s_lshl_b32 s26, s30, 16
    s_or_b32 s26, s26, s31
    v_mov_b32 v3, s26
    buffer_store_dword v3, v1, s[8:11], s25 offen offset:64
    s_add_u32 s24, s22, 8378368
    s_mov_b32 s30, -1
    s_mov_b32 s25, 12
prep_kernel_cal30:
    s_memrealtime s[26:27]
    s_waitcnt lgkmcnt(0)
    buffer_store_dword v1, v1, s[8:11], s24 offen sc1
    s_waitcnt vmcnt(0)
    buffer_load_dword v2, v1, s[8:11], s24 offen sc1
    s_waitcnt vmcnt(0)
    buffer_store_dword v2, v1, s[8:11], s24 offen offset:64 sc1
    s_waitcnt vmcnt(0)
    buffer_load_dword v2, v1, s[8:11], s24 offen offset:64 sc1
    s_waitcnt vmcnt(0)
    s_memrealtime s[28:29]
    s_waitcnt lgkmcnt(0)
    s_sub_u32 s26, s28, s26
    s_min_u32 s30, s30, s26
    s_sub_u32 s25, s25, 1
    s_cmp_lg_u32 s25, 0
    s_cbranch_scc1 prep_kernel_cal30
    s_add_u32 s24, s22, 8386560
    s_mov_b32 s31, -1
    s_mov_b32 s25, 12
prep_kernel_cal31:
    s_memrealtime s[26:27]
    s_waitcnt lgkmcnt(0)
    buffer_store_dword v1, v1, s[8:11], s24 offen sc1
    s_waitcnt vmcnt(0)
    buffer_load_dword v2, v1, s[8:11], s24 offen sc1
    s_waitcnt vmcnt(0)
    buffer_store_dword v2, v1, s[8:11], s24 offen offset:64 sc1
    s_waitcnt vmcnt(0)
    buffer_load_dword v2, v1, s[8:11], s24 offen offset:64 sc1
    s_waitcnt vmcnt(0)
    s_memrealtime s[28:29]
    s_waitcnt lgkmcnt(0)
    s_sub_u32 s26, s28, s26
    s_min_u32 s31, s31, s26
    s_sub_u32 s25, s25, 1
    s_cmp_lg_u32 s25, 0
    s_cbranch_scc1 prep_kernel_cal31
    s_cmp_lt_u32 s31, s30
    s_cselect_b32 s24, 1, 0
    s_xor_b32 s24, s24, s23
    s_lshl_b32 s24, s24, 13
    v_mov_b32 v3, s24
    s_mov_b32 s25, 10551308
    buffer_store_dword v3, v1, s[8:11], s25 offen
    s_lshl_b32 s26, s30, 16
    s_or_b32 s26, s26, s31
    v_mov_b32 v3, s26
    buffer_store_dword v3, v1, s[8:11], s25 offen offset:64
    s_branch prep_kernel_end
prep_kernel_r_wvo:
    s_lshl_b32 s20, s20, 2
    s_add_u32 s20, s20, s13
    s_load_dwordx2 s[24:25], s[0:1], 56
    s_load_dwordx2 s[26:27], s[0:1], 64
    s_and_b32 s21, s20, 1
    s_lshr_b32 s22, s20, 1
    s_mul_i32 s23, s22, 205
    s_lshr_b32 s23, s23, 11
    s_mul_i32 s28, s23, 10
    s_sub_u32 s22, s22, s28
    s_waitcnt lgkmcnt(0)
    s_mov_b32 s32, s24
    s_mov_b32 s33, s25
    s_mov_b32 s34, 7864320
    s_mov_b32 s35, 0x00020000
    s_mov_b32 s36, s26
    s_mov_b32 s37, s27
    s_mov_b32 s38, 7864320
    s_mov_b32 s39, 0x00020000
    v_and_b32 v1, 31, v0
    v_lshrrev_b32 v2, 5, v0
    v_mul_u32_u24 v3, 10240, v2
    v_lshl_add_u32 v3, v1, 2, v3
    s_mul_i32 s28, s23, 245760
    s_lshl_b32 s29, s22, 7
    s_add_u32 s28, s28, s29
    s_add_u32 s29, s28, 0
    buffer_load_dword v112, v3, s[36:39], s29 offen
    s_add_u32 s29, s28, 1280
    buffer_load_dword v113, v3, s[36:39], s29 offen
    s_add_u32 s29, s28, 2560
    buffer_load_dword v114, v3, s[36:39], s29 offen
    s_add_u32 s29, s28, 3840
    buffer_load_dword v115, v3, s[36:39], s29 offen
    s_add_u32 s29, s28, 5120
    buffer_load_dword v116, v3, s[36:39], s29 offen
    s_add_u32 s29, s28, 6400
    buffer_load_dword v117, v3, s[36:39], s29 offen
    s_add_u32 s29, s28, 7680
    buffer_load_dword v118, v3, s[36:39], s29 offen
    s_add_u32 s29, s28, 8960
    buffer_load_dword v119, v3, s[36:39], s29 offen
    s_add_u32 s29, s28, 20480
    buffer_load_dword v120, v3, s[36:39], s29 offen
    s_add_u32 s29, s28, 21760
    buffer_load_dword v121, v3, s[36:39], s29 offen
    s_add_u32 s29, s28, 23040
    buffer_load_dword v122, v3, s[36:39], s29 offen
    s_add_u32 s29, s28, 24320
    buffer_load_dword v123, v3, s[36:39], s29 offen
    s_add_u32 s29, s28, 25600
    buffer_load_dword v124, v3, s[36:39], s29 offen
    s_add_u32 s29, s28, 26880
    buffer_load_dword v125, v3, s[36:39], s29 offen
    s_add_u32 s29, s28, 28160
    buffer_load_dword v126, v3, s[36:39], s29 offen
    s_add_u32 s29, s28, 29440
    buffer_load_dword v127, v3, s[36:39], s29 offen
    s_add_u32 s29, s28, 40960
    buffer_load_dword v128, v3, s[36:39], s29 offen
    s_add_u32 s29, s28, 42240
    buffer_load_dword v129, v3, s[36:39], s29 offen
    s_add_u32 s29, s28, 43520
    buffer_load_dword v130, v3, s[36:39], s29 offen
    s_add_u32 s29, s28, 44800
    buffer_load_dword v131, v3, s[36:39], s29 offen
    s_add_u32 s29, s28, 46080
    buffer_load_dword v132, v3, s[36:39], s29 offen
    s_add_u32 s29, s28, 47360
    buffer_load_dword v133, v3, s[36:39], s29 offen
    s_add_u32 s29, s28, 48640
    buffer_load_dword v134, v3, s[36:39], s29 offen
    s_add_u32 s29, s28, 49920
    buffer_load_dword v135, v3, s[36:39], s29 offen
    s_add_u32 s29, s28, 61440
    buffer_load_dword v136, v3, s[36:39], s29 offen
    s_add_u32 s29, s28, 62720
    buffer_load_dword v137, v3, s[36:39], s29 offen
    s_add_u32 s29, s28, 64000
    buffer_load_dword v138, v3, s[36:39], s29 offen
    s_add_u32 s29, s28, 65280
    buffer_load_dword v139, v3, s[36:39], s29 offen
    s_add_u32 s29, s28, 66560
    buffer_load_dword v140, v3, s[36:39], s29 offen
    s_add_u32 s29, s28, 67840
    buffer_load_dword v141, v3, s[36:39], s29 offen
    s_add_u32 s29, s28, 69120
    buffer_load_dword v142, v3, s[36:39], s29 offen
    s_add_u32 s29, s28, 70400
    buffer_load_dword v143, v3, s[36:39], s29 offen
    s_add_u32 s29, s28, 81920
    buffer_load_dword v144, v3, s[36:39], s29 offen
    s_add_u32 s29, s28, 83200
    buffer_load_dword v145, v3, s[36:39], s29 offen
    s_add_u32 s29, s28, 84480
    buffer_load_dword v146, v3, s[36:39], s29 offen
    s_add_u32 s29, s28, 85760
    buffer_load_dword v147, v3, s[36:39], s29 offen
    s_add_u32 s29, s28, 87040
    buffer_load_dword v148, v3, s[36:39], s29 offen
    s_add_u32 s29, s28, 88320
    buffer_load_dword v149, v3, s[36:39], s29 offen
    s_add_u32 s29, s28, 89600
    buffer_load_dword v150, v3, s[36:39], s29 offen
    s_add_u32 s29, s28, 90880
    buffer_load_dword v151, v3, s[36:39], s29 offen
    s_add_u32 s29, s28, 102400
    buffer_load_dword v152, v3, s[36:39], s29 offen
    s_add_u32 s29, s28, 103680
    buffer_load_dword v153, v3, s[36:39], s29 offen
    s_add_u32 s29, s28, 104960
    buffer_load_dword v154, v3, s[36:39], s29 offen
    s_add_u32 s29, s28, 106240
    buffer_load_dword v155, v3, s[36:39], s29 offen
    s_add_u32 s29, s28, 107520
    buffer_load_dword v156, v3, s[36:39], s29 offen
    s_add_u32 s29, s28, 108800
    buffer_load_dword v157, v3, s[36:39], s29 offen
    s_add_u32 s29, s28, 110080
    buffer_load_dword v158, v3, s[36:39], s29 offen
    s_add_u32 s29, s28, 111360
    buffer_load_dword v159, v3, s[36:39], s29 offen
    v_mov_b32 v4, 0x05040100
    v_mov_b32 v5, 0x07060302
    s_waitcnt vmcnt(0)
    v_perm_b32 v16, v113, v112, v4
    v_perm_b32 v64, v113, v112, v5
    v_perm_b32 v17, v115, v114, v4
    v_perm_b32 v65, v115, v114, v5
    v_perm_b32 v18, v117, v116, v4
    v_perm_b32 v66, v117, v116, v5
    v_perm_b32 v19, v119, v118, v4
    v_perm_b32 v67, v119, v118, v5
    v_perm_b32 v20, v121, v120, v4
    v_perm_b32 v68, v121, v120, v5
    v_perm_b32 v21, v123, v122, v4
    v_perm_b32 v69, v123, v122, v5
    v_perm_b32 v22, v125, v124, v4
    v_perm_b32 v70, v125, v124, v5
    v_perm_b32 v23, v127, v126, v4
    v_perm_b32 v71, v127, v126, v5
    v_perm_b32 v24, v129, v128, v4
    v_perm_b32 v72, v129, v128, v5
    v_perm_b32 v25, v131, v130, v4
    v_perm_b32 v73, v131, v130, v5
    v_perm_b32 v26, v133, v132, v4
    v_perm_b32 v74, v133, v132, v5
    v_perm_b32 v27, v135, v134, v4
    v_perm_b32 v75, v135, v134, v5
    v_perm_b32 v28, v137, v136, v4
    v_perm_b32 v76, v137, v136, v5
    v_perm_b32 v29, v139, v138, v4
    v_perm_b32 v77, v139, v138, v5
    v_perm_b32 v30, v141, v140, v4
    v_perm_b32 v78, v141, v140, v5
    v_perm_b32 v31, v143, v142, v4
    v_perm_b32 v79, v143, v142, v5
    v_perm_b32 v32, v145, v144, v4
    v_perm_b32 v80, v145, v144, v5
    v_perm_b32 v33, v147, v146, v4
    v_perm_b32 v81, v147, v146, v5
    v_perm_b32 v34, v149, v148, v4
    v_perm_b32 v82, v149, v148, v5
    v_perm_b32 v35, v151, v150, v4
    v_perm_b32 v83, v151, v150, v5
    v_perm_b32 v36, v153, v152, v4
    v_perm_b32 v84, v153, v152, v5
    v_perm_b32 v37, v155, v154, v4
    v_perm_b32 v85, v155, v154, v5
    v_perm_b32 v38, v157, v156, v4
    v_perm_b32 v86, v157, v156, v5
    v_perm_b32 v39, v159, v158, v4
    v_perm_b32 v87, v159, v158, v5
    s_add_u32 s29, s28, 122880
    buffer_load_dword v112, v3, s[36:39], s29 offen
    s_add_u32 s29, s28, 124160
    buffer_load_dword v113, v3, s[36:39], s29 offen
    s_add_u32 s29, s28, 125440
    buffer_load_dword v114, v3, s[36:39], s29 offen
    s_add_u32 s29, s28, 126720
    buffer_load_dword v115, v3, s[36:39], s29 offen
    s_add_u32 s29, s28, 128000
    buffer_load_dword v116, v3, s[36:39], s29 offen
    s_add_u32 s29, s28, 129280
    buffer_load_dword v117, v3, s[36:39], s29 offen
    s_add_u32 s29, s28, 130560
    buffer_load_dword v118, v3, s[36:39], s29 offen
    s_add_u32 s29, s28, 131840
    buffer_load_dword v119, v3, s[36:39], s29 offen
    s_add_u32 s29, s28, 143360
    buffer_load_dword v120, v3, s[36:39], s29 offen
    s_add_u32 s29, s28, 144640
    buffer_load_dword v121, v3, s[36:39], s29 offen
    s_add_u32 s29, s28, 145920
    buffer_load_dword v122, v3, s[36:39], s29 offen
    s_add_u32 s29, s28, 147200
    buffer_load_dword v123, v3, s[36:39], s29 offen
    s_add_u32 s29, s28, 148480
    buffer_load_dword v124, v3, s[36:39], s29 offen
    s_add_u32 s29, s28, 149760
    buffer_load_dword v125, v3, s[36:39], s29 offen
    s_add_u32 s29, s28, 151040
    buffer_load_dword v126, v3, s[36:39], s29 offen
    s_add_u32 s29, s28, 152320
    buffer_load_dword v127, v3, s[36:39], s29 offen
    s_add_u32 s29, s28, 163840
    buffer_load_dword v128, v3, s[36:39], s29 offen
    s_add_u32 s29, s28, 165120
    buffer_load_dword v129, v3, s[36:39], s29 offen
    s_add_u32 s29, s28, 166400
    buffer_load_dword v130, v3, s[36:39], s29 offen
    s_add_u32 s29, s28, 167680
    buffer_load_dword v131, v3, s[36:39], s29 offen
    s_add_u32 s29, s28, 168960
    buffer_load_dword v132, v3, s[36:39], s29 offen
    s_add_u32 s29, s28, 170240
    buffer_load_dword v133, v3, s[36:39], s29 offen
    s_add_u32 s29, s28, 171520
    buffer_load_dword v134, v3, s[36:39], s29 offen
    s_add_u32 s29, s28, 172800
    buffer_load_dword v135, v3, s[36:39], s29 offen
    s_add_u32 s29, s28, 184320
    buffer_load_dword v136, v3, s[36:39], s29 offen
    s_add_u32 s29, s28, 185600
    buffer_load_dword v137, v3, s[36:39], s29 offen
    s_add_u32 s29, s28, 186880
    buffer_load_dword v138, v3, s[36:39], s29 offen
    s_add_u32 s29, s28, 188160
    buffer_load_dword v139, v3, s[36:39], s29 offen
    s_add_u32 s29, s28, 189440
    buffer_load_dword v140, v3, s[36:39], s29 offen
    s_add_u32 s29, s28, 190720
    buffer_load_dword v141, v3, s[36:39], s29 offen
    s_add_u32 s29, s28, 192000
    buffer_load_dword v142, v3, s[36:39], s29 offen
    s_add_u32 s29, s28, 193280
    buffer_load_dword v143, v3, s[36:39], s29 offen
    s_add_u32 s29, s28, 204800
    buffer_load_dword v144, v3, s[36:39], s29 offen
    s_add_u32 s29, s28, 206080
    buffer_load_dword v145, v3, s[36:39], s29 offen
    s_add_u32 s29, s28, 207360
    buffer_load_dword v146, v3, s[36:39], s29 offen
    s_add_u32 s29, s28, 208640
    buffer_load_dword v147, v3, s[36:39], s29 offen
    s_add_u32 s29, s28, 209920
    buffer_load_dword v148, v3, s[36:39], s29 offen
    s_add_u32 s29, s28, 211200
    buffer_load_dword v149, v3, s[36:39], s29 offen
    s_add_u32 s29, s28, 212480
    buffer_load_dword v150, v3, s[36:39], s29 offen
    s_add_u32 s29, s28, 213760
    buffer_load_dword v151, v3, s[36:39], s29 offen
    s_add_u32 s29, s28, 225280
    buffer_load_dword v152, v3, s[36:39], s29 offen
    s_add_u32 s29, s28, 226560
    buffer_load_dword v153, v3, s[36:39], s29 offen
    s_add_u32 s29, s28, 227840
    buffer_load_dword v154, v3, s[36:39], s29 offen
    s_add_u32 s29, s28, 229120
    buffer_load_dword v155, v3, s[36:39], s29 offen
    s_add_u32 s29, s28, 230400
    buffer_load_dword v156, v3, s[36:39], s29 offen
    s_add_u32 s29, s28, 231680
    buffer_load_dword v157, v3, s[36:39], s29 offen
    s_add_u32 s29, s28, 232960
    buffer_load_dword v158, v3, s[36:39], s29 offen
    s_add_u32 s29, s28, 234240
    buffer_load_dword v159, v3, s[36:39], s29 offen
    v_mov_b32 v4, 0x05040100
    v_mov_b32 v5, 0x07060302
    s_waitcnt vmcnt(0)
    v_perm_b32 v40, v113, v112, v4
    v_perm_b32 v88, v113, v112, v5
    v_perm_b32 v41, v115, v114, v4
    v_perm_b32 v89, v115, v114, v5
    v_perm_b32 v42, v117, v116, v4
    v_perm_b32 v90, v117, v116, v5
    v_perm_b32 v43, v119, v118, v4
    v_perm_b32 v91, v119, v118, v5
    v_perm_b32 v44, v121, v120, v4
    v_perm_b32 v92, v121, v120, v5
    v_perm_b32 v45, v123, v122, v4
    v_perm_b32 v93, v123, v122, v5
    v_perm_b32 v46, v125, v124, v4
    v_perm_b32 v94, v125, v124, v5
    v_perm_b32 v47, v127, v126, v4
    v_perm_b32 v95, v127, v126, v5
    v_perm_b32 v48, v129, v128, v4
    v_perm_b32 v96, v129, v128, v5
    v_perm_b32 v49, v131, v130, v4
    v_perm_b32 v97, v131, v130, v5
    v_perm_b32 v50, v133, v132, v4
    v_perm_b32 v98, v133, v132, v5
    v_perm_b32 v51, v135, v134, v4
    v_perm_b32 v99, v135, v134, v5
    v_perm_b32 v52, v137, v136, v4
    v_perm_b32 v100, v137, v136, v5
    v_perm_b32 v53, v139, v138, v4
    v_perm_b32 v101, v139, v138, v5
    v_perm_b32 v54, v141, v140, v4
    v_perm_b32 v102, v141, v140, v5
    v_perm_b32 v55, v143, v142, v4
    v_perm_b32 v103, v143, v142, v5
    v_perm_b32 v56, v145, v144, v4
    v_perm_b32 v104, v145, v144, v5
    v_perm_b32 v57, v147, v146, v4
    v_perm_b32 v105, v147, v146, v5
    v_perm_b32 v58, v149, v148, v4
    v_perm_b32 v106, v149, v148, v5
    v_perm_b32 v59, v151, v150, v4
    v_perm_b32 v107, v151, v150, v5
    v_perm_b32 v60, v153, v152, v4
    v_perm_b32 v108, v153, v152, v5
    v_perm_b32 v61, v155, v154, v4
    v_perm_b32 v109, v155, v154, v5
    v_perm_b32 v62, v157, v156, v4
    v_perm_b32 v110, v157, v156, v5
    v_perm_b32 v63, v159, v158, v4
    v_perm_b32 v111, v159, v158, v5
    v_lshrrev_b32 v6, 3, v1
    v_lshrrev_b32 v7, 2, v6
    v_lshlrev_b32 v7, 5, v7
    v_and_b32 v8, 2, v6
    v_lshl_add_u32 v7, v8, 3, v7
    v_and_b32 v8, 1, v6
    v_lshl_add_u32 v7, v8, 2, v7
    v_and_b32 v8, 7, v1
    v_and_b32 v9, 1, v8
    v_add_u32 v7, v7, v9
    v_and_b32 v9, 2, v8
    v_lshl_add_u32 v7, v9, 2, v7
    v_lshrrev_b32 v9, 2, v8
    v_lshl_add_u32 v7, v9, 1, v7
    v_mul_u32_u24 v7, 12288, v7
    v_lshl_add_u32 v7, v2, 4, v7
    s_mul_i32 s28, s23, 384
    s_mul_i32 s29, s21, 3932160
    s_add_u32 s28, s28, s29
    v_lshrrev_b32 v10, 2, v1
    v_mul_u32_u24 v10, 20480, v10
    v_lshlrev_b32 v10, 4, v10
    v_and_b32 v11, 3, v1
    v_lshl_add_u32 v10, v11, 5, v10
    v_lshl_add_u32 v10, v2, 8, v10
    s_mul_i32 s30, s22, 2621440
    s_lshr_b32 s31, s23, 3
    s_mul_i32 s31, s31, 81920
    s_add_u32 s30, s30, s31
    s_and_b32 s31, s23, 3
    s_mul_i32 s31, s31, 20480
    s_add_u32 s30, s30, s31
    s_bfe_u32 s31, s23, 0x10002
    s_lshl_b32 s31, s31, 7
    s_add_u32 s30, s30, s31
    s_mul_i32 s31, s21, 10240
    s_add_u32 s30, s30, s31
    s_add_u32 s30, s30, 27262976
    buffer_load_dwordx4 v[112:115], v7, s[32:35], s28 offen offset:0
    buffer_load_dwordx4 v[116:119], v7, s[32:35], s28 offen offset:32
    buffer_load_dwordx4 v[120:123], v7, s[32:35], s28 offen offset:64
    buffer_load_dwordx4 v[124:127], v7, s[32:35], s28 offen offset:96
    buffer_load_dwordx4 v[128:131], v7, s[32:35], s28 offen offset:128
    buffer_load_dwordx4 v[132:135], v7, s[32:35], s28 offen offset:160
    buffer_load_dwordx4 v[136:139], v7, s[32:35], s28 offen offset:192
    buffer_load_dwordx4 v[140:143], v7, s[32:35], s28 offen offset:224
    buffer_load_dwordx4 v[144:147], v7, s[32:35], s28 offen offset:256
    buffer_load_dwordx4 v[148:151], v7, s[32:35], s28 offen offset:288
    buffer_load_dwordx4 v[152:155], v7, s[32:35], s28 offen offset:320
    buffer_load_dwordx4 v[156:159], v7, s[32:35], s28 offen offset:352
    s_add_u32 s28, s28, 393216
    s_mov_b32 s31, 5
prep_kernel_wvo_loop:
    buffer_load_dwordx4 v[160:163], v7, s[32:35], s28 offen offset:0
    buffer_load_dwordx4 v[164:167], v7, s[32:35], s28 offen offset:32
    buffer_load_dwordx4 v[168:171], v7, s[32:35], s28 offen offset:64
    buffer_load_dwordx4 v[172:175], v7, s[32:35], s28 offen offset:96
    buffer_load_dwordx4 v[176:179], v7, s[32:35], s28 offen offset:128
    buffer_load_dwordx4 v[180:183], v7, s[32:35], s28 offen offset:160
    buffer_load_dwordx4 v[184:187], v7, s[32:35], s28 offen offset:192
    buffer_load_dwordx4 v[188:191], v7, s[32:35], s28 offen offset:224
    buffer_load_dwordx4 v[192:195], v7, s[32:35], s28 offen offset:256
    buffer_load_dwordx4 v[196:199], v7, s[32:35], s28 offen offset:288
    buffer_load_dwordx4 v[200:203], v7, s[32:35], s28 offen offset:320
    buffer_load_dwordx4 v[204:207], v7, s[32:35], s28 offen offset:352
    s_add_u32 s28, s28, 393216
    s_waitcnt vmcnt(12)
    v_mfma_f32_32x32x16_bf16 v[208:223], v[112:115], v[16:19], 0
    v_mfma_f32_32x32x16_bf16 v[224:239], v[112:115], v[64:67], 0
    v_mfma_f32_32x32x16_bf16 v[208:223], v[116:119], v[20:23], v[208:223]
    v_mfma_f32_32x32x16_bf16 v[224:239], v[116:119], v[68:71], v[224:239]
    v_mfma_f32_32x32x16_bf16 v[208:223], v[120:123], v[24:27], v[208:223]
    v_mfma_f32_32x32x16_bf16 v[224:239], v[120:123], v[72:75], v[224:239]
    v_mfma_f32_32x32x16_bf16 v[208:223], v[124:127], v[28:31], v[208:223]
    v_mfma_f32_32x32x16_bf16 v[224:239], v[124:127], v[76:79], v[224:239]
    v_mfma_f32_32x32x16_bf16 v[208:223], v[128:131], v[32:35], v[208:223]
    v_mfma_f32_32x32x16_bf16 v[224:239], v[128:131], v[80:83], v[224:239]
    v_mfma_f32_32x32x16_bf16 v[208:223], v[132:135], v[36:39], v[208:223]
    v_mfma_f32_32x32x16_bf16 v[224:239], v[132:135], v[84:87], v[224:239]
    v_mfma_f32_32x32x16_bf16 v[208:223], v[136:139], v[40:43], v[208:223]
    v_mfma_f32_32x32x16_bf16 v[224:239], v[136:139], v[88:91], v[224:239]
    v_mfma_f32_32x32x16_bf16 v[208:223], v[140:143], v[44:47], v[208:223]
    v_mfma_f32_32x32x16_bf16 v[224:239], v[140:143], v[92:95], v[224:239]
    v_mfma_f32_32x32x16_bf16 v[208:223], v[144:147], v[48:51], v[208:223]
    v_mfma_f32_32x32x16_bf16 v[224:239], v[144:147], v[96:99], v[224:239]
    v_mfma_f32_32x32x16_bf16 v[208:223], v[148:151], v[52:55], v[208:223]
    v_mfma_f32_32x32x16_bf16 v[224:239], v[148:151], v[100:103], v[224:239]
    v_mfma_f32_32x32x16_bf16 v[208:223], v[152:155], v[56:59], v[208:223]
    v_mfma_f32_32x32x16_bf16 v[224:239], v[152:155], v[104:107], v[224:239]
    v_mfma_f32_32x32x16_bf16 v[208:223], v[156:159], v[60:63], v[208:223]
    v_mfma_f32_32x32x16_bf16 v[224:239], v[156:159], v[108:111], v[224:239]
    s_nop 7
    s_nop 7
    v_cvt_pk_bf16_f32 v240, v208, v209
    v_cvt_pk_bf16_f32 v241, v210, v211
    v_cvt_pk_bf16_f32 v242, v212, v213
    v_cvt_pk_bf16_f32 v243, v214, v215
    s_nop 1
    v_permlane32_swap_b32 v240, v242
    v_permlane32_swap_b32 v241, v243
    buffer_store_dwordx4 v[240:243], v10, s[8:11], s30 offen offset:0
    v_cvt_pk_bf16_f32 v244, v216, v217
    v_cvt_pk_bf16_f32 v245, v218, v219
    v_cvt_pk_bf16_f32 v246, v220, v221
    v_cvt_pk_bf16_f32 v247, v222, v223
    s_nop 1
    v_permlane32_swap_b32 v244, v246
    v_permlane32_swap_b32 v245, v247
    buffer_store_dwordx4 v[244:247], v10, s[8:11], s30 offen offset:512
    s_nop 1
    v_cvt_pk_bf16_f32 v240, v224, v225
    v_cvt_pk_bf16_f32 v241, v226, v227
    v_cvt_pk_bf16_f32 v242, v228, v229
    v_cvt_pk_bf16_f32 v243, v230, v231
    s_nop 1
    v_permlane32_swap_b32 v240, v242
    v_permlane32_swap_b32 v241, v243
    buffer_store_dwordx4 v[240:243], v10, s[8:11], s30 offen offset:16
    v_cvt_pk_bf16_f32 v244, v232, v233
    v_cvt_pk_bf16_f32 v245, v234, v235
    v_cvt_pk_bf16_f32 v246, v236, v237
    v_cvt_pk_bf16_f32 v247, v238, v239
    s_nop 1
    v_permlane32_swap_b32 v244, v246
    v_permlane32_swap_b32 v245, v247
    buffer_store_dwordx4 v[244:247], v10, s[8:11], s30 offen offset:528
    s_nop 1
    s_add_u32 s30, s30, 1024
    s_cmp_eq_u32 s31, 1
    s_cbranch_scc1 prep_kernel_wvo_last
    buffer_load_dwordx4 v[112:115], v7, s[32:35], s28 offen offset:0
    buffer_load_dwordx4 v[116:119], v7, s[32:35], s28 offen offset:32
    buffer_load_dwordx4 v[120:123], v7, s[32:35], s28 offen offset:64
    buffer_load_dwordx4 v[124:127], v7, s[32:35], s28 offen offset:96
    buffer_load_dwordx4 v[128:131], v7, s[32:35], s28 offen offset:128
    buffer_load_dwordx4 v[132:135], v7, s[32:35], s28 offen offset:160
    buffer_load_dwordx4 v[136:139], v7, s[32:35], s28 offen offset:192
    buffer_load_dwordx4 v[140:143], v7, s[32:35], s28 offen offset:224
    buffer_load_dwordx4 v[144:147], v7, s[32:35], s28 offen offset:256
    buffer_load_dwordx4 v[148:151], v7, s[32:35], s28 offen offset:288
    buffer_load_dwordx4 v[152:155], v7, s[32:35], s28 offen offset:320
    buffer_load_dwordx4 v[156:159], v7, s[32:35], s28 offen offset:352
    s_add_u32 s28, s28, 393216
    s_waitcnt vmcnt(12)
    v_mfma_f32_32x32x16_bf16 v[208:223], v[160:163], v[16:19], 0
    v_mfma_f32_32x32x16_bf16 v[224:239], v[160:163], v[64:67], 0
    v_mfma_f32_32x32x16_bf16 v[208:223], v[164:167], v[20:23], v[208:223]
    v_mfma_f32_32x32x16_bf16 v[224:239], v[164:167], v[68:71], v[224:239]
    v_mfma_f32_32x32x16_bf16 v[208:223], v[168:171], v[24:27], v[208:223]
    v_mfma_f32_32x32x16_bf16 v[224:239], v[168:171], v[72:75], v[224:239]
    v_mfma_f32_32x32x16_bf16 v[208:223], v[172:175], v[28:31], v[208:223]
    v_mfma_f32_32x32x16_bf16 v[224:239], v[172:175], v[76:79], v[224:239]
    v_mfma_f32_32x32x16_bf16 v[208:223], v[176:179], v[32:35], v[208:223]
    v_mfma_f32_32x32x16_bf16 v[224:239], v[176:179], v[80:83], v[224:239]
    v_mfma_f32_32x32x16_bf16 v[208:223], v[180:183], v[36:39], v[208:223]
    v_mfma_f32_32x32x16_bf16 v[224:239], v[180:183], v[84:87], v[224:239]
    v_mfma_f32_32x32x16_bf16 v[208:223], v[184:187], v[40:43], v[208:223]
    v_mfma_f32_32x32x16_bf16 v[224:239], v[184:187], v[88:91], v[224:239]
    v_mfma_f32_32x32x16_bf16 v[208:223], v[188:191], v[44:47], v[208:223]
    v_mfma_f32_32x32x16_bf16 v[224:239], v[188:191], v[92:95], v[224:239]
    v_mfma_f32_32x32x16_bf16 v[208:223], v[192:195], v[48:51], v[208:223]
    v_mfma_f32_32x32x16_bf16 v[224:239], v[192:195], v[96:99], v[224:239]
    v_mfma_f32_32x32x16_bf16 v[208:223], v[196:199], v[52:55], v[208:223]
    v_mfma_f32_32x32x16_bf16 v[224:239], v[196:199], v[100:103], v[224:239]
    v_mfma_f32_32x32x16_bf16 v[208:223], v[200:203], v[56:59], v[208:223]
    v_mfma_f32_32x32x16_bf16 v[224:239], v[200:203], v[104:107], v[224:239]
    v_mfma_f32_32x32x16_bf16 v[208:223], v[204:207], v[60:63], v[208:223]
    v_mfma_f32_32x32x16_bf16 v[224:239], v[204:207], v[108:111], v[224:239]
    s_nop 7
    s_nop 7
    v_cvt_pk_bf16_f32 v240, v208, v209
    v_cvt_pk_bf16_f32 v241, v210, v211
    v_cvt_pk_bf16_f32 v242, v212, v213
    v_cvt_pk_bf16_f32 v243, v214, v215
    s_nop 1
    v_permlane32_swap_b32 v240, v242
    v_permlane32_swap_b32 v241, v243
    buffer_store_dwordx4 v[240:243], v10, s[8:11], s30 offen offset:0
    v_cvt_pk_bf16_f32 v244, v216, v217
    v_cvt_pk_bf16_f32 v245, v218, v219
    v_cvt_pk_bf16_f32 v246, v220, v221
    v_cvt_pk_bf16_f32 v247, v222, v223
    s_nop 1
    v_permlane32_swap_b32 v244, v246
    v_permlane32_swap_b32 v245, v247
    buffer_store_dwordx4 v[244:247], v10, s[8:11], s30 offen offset:512
    s_nop 1
    v_cvt_pk_bf16_f32 v240, v224, v225
    v_cvt_pk_bf16_f32 v241, v226, v227
    v_cvt_pk_bf16_f32 v242, v228, v229
    v_cvt_pk_bf16_f32 v243, v230, v231
    s_nop 1
    v_permlane32_swap_b32 v240, v242
    v_permlane32_swap_b32 v241, v243
    buffer_store_dwordx4 v[240:243], v10, s[8:11], s30 offen offset:16
    v_cvt_pk_bf16_f32 v244, v232, v233
    v_cvt_pk_bf16_f32 v245, v234, v235
    v_cvt_pk_bf16_f32 v246, v236, v237
    v_cvt_pk_bf16_f32 v247, v238, v239
    s_nop 1
    v_permlane32_swap_b32 v244, v246
    v_permlane32_swap_b32 v245, v247
    buffer_store_dwordx4 v[244:247], v10, s[8:11], s30 offen offset:528
    s_nop 1
    s_add_u32 s30, s30, 1024
    s_sub_u32 s31, s31, 1
    s_branch prep_kernel_wvo_loop
prep_kernel_wvo_last:
    s_waitcnt vmcnt(0)
    v_mfma_f32_32x32x16_bf16 v[208:223], v[160:163], v[16:19], 0
    v_mfma_f32_32x32x16_bf16 v[224:239], v[160:163], v[64:67], 0
    v_mfma_f32_32x32x16_bf16 v[208:223], v[164:167], v[20:23], v[208:223]
    v_mfma_f32_32x32x16_bf16 v[224:239], v[164:167], v[68:71], v[224:239]
    v_mfma_f32_32x32x16_bf16 v[208:223], v[168:171], v[24:27], v[208:223]
    v_mfma_f32_32x32x16_bf16 v[224:239], v[168:171], v[72:75], v[224:239]
    v_mfma_f32_32x32x16_bf16 v[208:223], v[172:175], v[28:31], v[208:223]
    v_mfma_f32_32x32x16_bf16 v[224:239], v[172:175], v[76:79], v[224:239]
    v_mfma_f32_32x32x16_bf16 v[208:223], v[176:179], v[32:35], v[208:223]
    v_mfma_f32_32x32x16_bf16 v[224:239], v[176:179], v[80:83], v[224:239]
    v_mfma_f32_32x32x16_bf16 v[208:223], v[180:183], v[36:39], v[208:223]
    v_mfma_f32_32x32x16_bf16 v[224:239], v[180:183], v[84:87], v[224:239]
    v_mfma_f32_32x32x16_bf16 v[208:223], v[184:187], v[40:43], v[208:223]
    v_mfma_f32_32x32x16_bf16 v[224:239], v[184:187], v[88:91], v[224:239]
    v_mfma_f32_32x32x16_bf16 v[208:223], v[188:191], v[44:47], v[208:223]
    v_mfma_f32_32x32x16_bf16 v[224:239], v[188:191], v[92:95], v[224:239]
    v_mfma_f32_32x32x16_bf16 v[208:223], v[192:195], v[48:51], v[208:223]
    v_mfma_f32_32x32x16_bf16 v[224:239], v[192:195], v[96:99], v[224:239]
    v_mfma_f32_32x32x16_bf16 v[208:223], v[196:199], v[52:55], v[208:223]
    v_mfma_f32_32x32x16_bf16 v[224:239], v[196:199], v[100:103], v[224:239]
    v_mfma_f32_32x32x16_bf16 v[208:223], v[200:203], v[56:59], v[208:223]
    v_mfma_f32_32x32x16_bf16 v[224:239], v[200:203], v[104:107], v[224:239]
    v_mfma_f32_32x32x16_bf16 v[208:223], v[204:207], v[60:63], v[208:223]
    v_mfma_f32_32x32x16_bf16 v[224:239], v[204:207], v[108:111], v[224:239]
    s_nop 7
    s_nop 7
    v_cvt_pk_bf16_f32 v240, v208, v209
    v_cvt_pk_bf16_f32 v241, v210, v211
    v_cvt_pk_bf16_f32 v242, v212, v213
    v_cvt_pk_bf16_f32 v243, v214, v215
    s_nop 1
    v_permlane32_swap_b32 v240, v242
    v_permlane32_swap_b32 v241, v243
    buffer_store_dwordx4 v[240:243], v10, s[8:11], s30 offen offset:0
    v_cvt_pk_bf16_f32 v244, v216, v217
    v_cvt_pk_bf16_f32 v245, v218, v219
    v_cvt_pk_bf16_f32 v246, v220, v221
    v_cvt_pk_bf16_f32 v247, v222, v223
    s_nop 1
    v_permlane32_swap_b32 v244, v246
    v_permlane32_swap_b32 v245, v247
    buffer_store_dwordx4 v[244:247], v10, s[8:11], s30 offen offset:512
    s_nop 1
    v_cvt_pk_bf16_f32 v240, v224, v225
    v_cvt_pk_bf16_f32 v241, v226, v227
    v_cvt_pk_bf16_f32 v242, v228, v229
    v_cvt_pk_bf16_f32 v243, v230, v231
    s_nop 1
    v_permlane32_swap_b32 v240, v242
    v_permlane32_swap_b32 v241, v243
    buffer_store_dwordx4 v[240:243], v10, s[8:11], s30 offen offset:16
    v_cvt_pk_bf16_f32 v244, v232, v233
    v_cvt_pk_bf16_f32 v245, v234, v235
    v_cvt_pk_bf16_f32 v246, v236, v237
    v_cvt_pk_bf16_f32 v247, v238, v239
    s_nop 1
    v_permlane32_swap_b32 v244, v246
    v_permlane32_swap_b32 v245, v247
    buffer_store_dwordx4 v[244:247], v10, s[8:11], s30 offen offset:528
    s_nop 1
    s_add_u32 s30, s30, 1024
    s_branch prep_kernel_end
prep_kernel_r_pwp:
    s_lshl_b32 s20, s20, 2
    s_add_u32 s20, s20, s13
    s_mul_i32 s21, s20, 13108
    s_lshr_b32 s21, s21, 16
    s_mul_i32 s22, s21, 5
    s_sub_u32 s22, s20, s22
    s_mul_i32 s23, s21, 21846
    s_lshr_b32 s23, s23, 16
    s_mul_i32 s28, s23, 3
    s_sub_u32 s21, s21, s28
    s_lshr_b32 s29, s23, 5
    s_and_b32 s23, s23, 31
    s_cmp_eq_u32 s29, 0
    s_cbranch_scc0 prep_kernel_pwp_k
    s_load_dwordx2 s[24:25], s[0:1], 40
    s_branch prep_kernel_pwp_go
prep_kernel_pwp_k:
    s_load_dwordx2 s[24:25], s[0:1], 48
prep_kernel_pwp_go:
    v_and_b32 v1, 31, v0
    v_lshrrev_b32 v2, 5, v0
    s_lshl_b32 s28, s21, 6
    v_lshlrev_b32 v3, 1, v1
    v_add_u32 v3, s28, v3
    v_and_b32 v4, 0xc1, v3
    v_and_b32 v5, 8, v3
    v_lshl_or_b32 v4, v5, 2, v4
    v_and_b32 v5, 32, v3
    v_lshrrev_b32 v5, 1, v5
    v_or_b32 v4, v4, v5
    v_and_b32 v5, 2, v3
    v_lshl_or_b32 v4, v5, 2, v4
    v_and_b32 v5, 16, v3
    v_lshrrev_b32 v5, 2, v5
    v_or_b32 v4, v4, v5
    v_and_b32 v5, 4, v3
    v_lshrrev_b32 v5, 1, v5
    v_or_b32 v4, v4, v5
    s_cmp_eq_u32 s29, 0
    s_cselect_b64 vcc, -1, 0
    s_nop 1
    v_cndmask_b32 v4, v4, v3, vcc
    v_lshrrev_b32 v5, 4, v3
    v_mul_u32_u24 v6, 11, v5
    v_lshrrev_b32 v6, 5, v6
    v_mul_u32_u24 v6, 3, v6
    v_add_u32 v5, v5, v6
    v_mul_u32_u24 v5, 20480, v5
    v_and_b32 v6, 15, v3
    v_lshl_add_u32 v7, v6, 4, v5
    s_mul_i32 s30, s29, 61440
    s_mul_i32 s31, s23, 491520
    s_add_u32 s30, s30, s31
    s_add_u32 s30, s30, 11534336
    s_lshl_b32 s31, s22, 4
    v_add_u32 v8, s31, v2
    s_waitcnt lgkmcnt(0)
    s_mov_b32 s32, s24
    s_mov_b32 s33, s25
    s_mov_b32 s34, 7864320
    s_mov_b32 s35, 0x00020000
    s_mul_i32 s28, s23, 384
    v_add_u32 v9, 0, v8
    v_lshrrev_b32 v10, 2, v9
    v_lshlrev_b32 v10, 5, v10
    v_and_b32 v11, 2, v9
    v_lshl_add_u32 v10, v11, 3, v10
    v_and_b32 v11, 1, v9
    v_lshl_add_u32 v10, v11, 2, v10
    v_mul_u32_u24 v10, 12288, v10
    v_lshl_add_u32 v10, v4, 1, v10
    s_add_u32 s31, s28, 0
    buffer_load_dword v16, v10, s[32:35], s31 offen
    s_add_u32 s31, s28, 12288
    buffer_load_dword v17, v10, s[32:35], s31 offen
    s_add_u32 s31, s28, 98304
    buffer_load_dword v18, v10, s[32:35], s31 offen
    s_add_u32 s31, s28, 110592
    buffer_load_dword v19, v10, s[32:35], s31 offen
    s_add_u32 s31, s28, 24576
    buffer_load_dword v20, v10, s[32:35], s31 offen
    s_add_u32 s31, s28, 36864
    buffer_load_dword v21, v10, s[32:35], s31 offen
    s_add_u32 s31, s28, 122880
    buffer_load_dword v22, v10, s[32:35], s31 offen
    s_add_u32 s31, s28, 135168
    buffer_load_dword v23, v10, s[32:35], s31 offen
    v_add_u32 v9, 2, v8
    v_lshrrev_b32 v10, 2, v9
    v_lshlrev_b32 v10, 5, v10
    v_and_b32 v11, 2, v9
    v_lshl_add_u32 v10, v11, 3, v10
    v_and_b32 v11, 1, v9
    v_lshl_add_u32 v10, v11, 2, v10
    v_mul_u32_u24 v10, 12288, v10
    v_lshl_add_u32 v10, v4, 1, v10
    s_add_u32 s31, s28, 0
    buffer_load_dword v24, v10, s[32:35], s31 offen
    s_add_u32 s31, s28, 12288
    buffer_load_dword v25, v10, s[32:35], s31 offen
    s_add_u32 s31, s28, 98304
    buffer_load_dword v26, v10, s[32:35], s31 offen
    s_add_u32 s31, s28, 110592
    buffer_load_dword v27, v10, s[32:35], s31 offen
    s_add_u32 s31, s28, 24576
    buffer_load_dword v28, v10, s[32:35], s31 offen
    s_add_u32 s31, s28, 36864
    buffer_load_dword v29, v10, s[32:35], s31 offen
    s_add_u32 s31, s28, 122880
    buffer_load_dword v30, v10, s[32:35], s31 offen
    s_add_u32 s31, s28, 135168
    buffer_load_dword v31, v10, s[32:35], s31 offen
    v_add_u32 v9, 4, v8
    v_lshrrev_b32 v10, 2, v9
    v_lshlrev_b32 v10, 5, v10
    v_and_b32 v11, 2, v9
    v_lshl_add_u32 v10, v11, 3, v10
    v_and_b32 v11, 1, v9
    v_lshl_add_u32 v10, v11, 2, v10
    v_mul_u32_u24 v10, 12288, v10
    v_lshl_add_u32 v10, v4, 1, v10
    s_add_u32 s31, s28, 0
    buffer_load_dword v32, v10, s[32:35], s31 offen
    s_add_u32 s31, s28, 12288
    buffer_load_dword v33, v10, s[32:35], s31 offen
    s_add_u32 s31, s28, 98304
    buffer_load_dword v34, v10, s[32:35], s31 offen
    s_add_u32 s31, s28, 110592
    buffer_load_dword v35, v10, s[32:35], s31 offen
    s_add_u32 s31, s28, 24576
    buffer_load_dword v36, v10, s[32:35], s31 offen
    s_add_u32 s31, s28, 36864
    buffer_load_dword v37, v10, s[32:35], s31 offen
    s_add_u32 s31, s28, 122880
    buffer_load_dword v38, v10, s[32:35], s31 offen
    s_add_u32 s31, s28, 135168
    buffer_load_dword v39, v10, s[32:35], s31 offen
    v_add_u32 v9, 6, v8
    v_lshrrev_b32 v10, 2, v9
    v_lshlrev_b32 v10, 5, v10
    v_and_b32 v11, 2, v9
    v_lshl_add_u32 v10, v11, 3, v10
    v_and_b32 v11, 1, v9
    v_lshl_add_u32 v10, v11, 2, v10
    v_mul_u32_u24 v10, 12288, v10
    v_lshl_add_u32 v10, v4, 1, v10
    s_add_u32 s31, s28, 0
    buffer_load_dword v40, v10, s[32:35], s31 offen
    s_add_u32 s31, s28, 12288
    buffer_load_dword v41, v10, s[32:35], s31 offen
    s_add_u32 s31, s28, 98304
    buffer_load_dword v42, v10, s[32:35], s31 offen
    s_add_u32 s31, s28, 110592
    buffer_load_dword v43, v10, s[32:35], s31 offen
    s_add_u32 s31, s28, 24576
    buffer_load_dword v44, v10, s[32:35], s31 offen
    s_add_u32 s31, s28, 36864
    buffer_load_dword v45, v10, s[32:35], s31 offen
    s_add_u32 s31, s28, 122880
    buffer_load_dword v46, v10, s[32:35], s31 offen
    s_add_u32 s31, s28, 135168
    buffer_load_dword v47, v10, s[32:35], s31 offen
    v_add_u32 v9, 8, v8
    v_lshrrev_b32 v10, 2, v9
    v_lshlrev_b32 v10, 5, v10
    v_and_b32 v11, 2, v9
    v_lshl_add_u32 v10, v11, 3, v10
    v_and_b32 v11, 1, v9
    v_lshl_add_u32 v10, v11, 2, v10
    v_mul_u32_u24 v10, 12288, v10
    v_lshl_add_u32 v10, v4, 1, v10
    s_add_u32 s31, s28, 0
    buffer_load_dword v48, v10, s[32:35], s31 offen
    s_add_u32 s31, s28, 12288
    buffer_load_dword v49, v10, s[32:35], s31 offen
    s_add_u32 s31, s28, 98304
    buffer_load_dword v50, v10, s[32:35], s31 offen
    s_add_u32 s31, s28, 110592
    buffer_load_dword v51, v10, s[32:35], s31 offen
    s_add_u32 s31, s28, 24576
    buffer_load_dword v52, v10, s[32:35], s31 offen
    s_add_u32 s31, s28, 36864
    buffer_load_dword v53, v10, s[32:35], s31 offen
    s_add_u32 s31, s28, 122880
    buffer_load_dword v54, v10, s[32:35], s31 offen
    s_add_u32 s31, s28, 135168
    buffer_load_dword v55, v10, s[32:35], s31 offen
    v_add_u32 v9, 10, v8
    v_lshrrev_b32 v10, 2, v9
    v_lshlrev_b32 v10, 5, v10
    v_and_b32 v11, 2, v9
    v_lshl_add_u32 v10, v11, 3, v10
    v_and_b32 v11, 1, v9
    v_lshl_add_u32 v10, v11, 2, v10
    v_mul_u32_u24 v10, 12288, v10
    v_lshl_add_u32 v10, v4, 1, v10
    s_add_u32 s31, s28, 0
    buffer_load_dword v56, v10, s[32:35], s31 offen
    s_add_u32 s31, s28, 12288
    buffer_load_dword v57, v10, s[32:35], s31 offen
    s_add_u32 s31, s28, 98304
    buffer_load_dword v58, v10, s[32:35], s31 offen
    s_add_u32 s31, s28, 110592
    buffer_load_dword v59, v10, s[32:35], s31 offen
    s_add_u32 s31, s28, 24576
    buffer_load_dword v60, v10, s[32:35], s31 offen
    s_add_u32 s31, s28, 36864
    buffer_load_dword v61, v10, s[32:35], s31 offen
    s_add_u32 s31, s28, 122880
    buffer_load_dword v62, v10, s[32:35], s31 offen
    s_add_u32 s31, s28, 135168
    buffer_load_dword v63, v10, s[32:35], s31 offen
    v_add_u32 v9, 12, v8
    v_lshrrev_b32 v10, 2, v9
    v_lshlrev_b32 v10, 5, v10
    v_and_b32 v11, 2, v9
    v_lshl_add_u32 v10, v11, 3, v10
    v_and_b32 v11, 1, v9
    v_lshl_add_u32 v10, v11, 2, v10
    v_mul_u32_u24 v10, 12288, v10
    v_lshl_add_u32 v10, v4, 1, v10
    s_add_u32 s31, s28, 0
    buffer_load_dword v64, v10, s[32:35], s31 offen
    s_add_u32 s31, s28, 12288
    buffer_load_dword v65, v10, s[32:35], s31 offen
    s_add_u32 s31, s28, 98304
    buffer_load_dword v66, v10, s[32:35], s31 offen
    s_add_u32 s31, s28, 110592
    buffer_load_dword v67, v10, s[32:35], s31 offen
    s_add_u32 s31, s28, 24576
    buffer_load_dword v68, v10, s[32:35], s31 offen
    s_add_u32 s31, s28, 36864
    buffer_load_dword v69, v10, s[32:35], s31 offen
    s_add_u32 s31, s28, 122880
    buffer_load_dword v70, v10, s[32:35], s31 offen
    s_add_u32 s31, s28, 135168
    buffer_load_dword v71, v10, s[32:35], s31 offen
    v_add_u32 v9, 14, v8
    v_lshrrev_b32 v10, 2, v9
    v_lshlrev_b32 v10, 5, v10
    v_and_b32 v11, 2, v9
    v_lshl_add_u32 v10, v11, 3, v10
    v_and_b32 v11, 1, v9
    v_lshl_add_u32 v10, v11, 2, v10
    v_mul_u32_u24 v10, 12288, v10
    v_lshl_add_u32 v10, v4, 1, v10
    s_add_u32 s31, s28, 0
    buffer_load_dword v72, v10, s[32:35], s31 offen
    s_add_u32 s31, s28, 12288
    buffer_load_dword v73, v10, s[32:35], s31 offen
    s_add_u32 s31, s28, 98304
    buffer_load_dword v74, v10, s[32:35], s31 offen
    s_add_u32 s31, s28, 110592
    buffer_load_dword v75, v10, s[32:35], s31 offen
    s_add_u32 s31, s28, 24576
    buffer_load_dword v76, v10, s[32:35], s31 offen
    s_add_u32 s31, s28, 36864
    buffer_load_dword v77, v10, s[32:35], s31 offen
    s_add_u32 s31, s28, 122880
    buffer_load_dword v78, v10, s[32:35], s31 offen
    s_add_u32 s31, s28, 135168
    buffer_load_dword v79, v10, s[32:35], s31 offen
    v_lshl_add_u32 v7, v8, 8, v7
    v_mov_b32 v4, 0x05040100
    v_mov_b32 v5, 0x07060302
    s_waitcnt vmcnt(56)
    v_perm_b32 v80, v17, v16, v4
    v_perm_b32 v84, v17, v16, v5
    v_perm_b32 v81, v19, v18, v4
    v_perm_b32 v85, v19, v18, v5
    v_perm_b32 v82, v21, v20, v4
    v_perm_b32 v86, v21, v20, v5
    v_perm_b32 v83, v23, v22, v4
    v_perm_b32 v87, v23, v22, v5
    buffer_store_dwordx4 v[80:83], v7, s[8:11], s30 offen offset:0
    buffer_store_dwordx4 v[84:87], v7, s[8:11], s30 offen offset:16
    s_waitcnt vmcnt(48)
    v_perm_b32 v88, v25, v24, v4
    v_perm_b32 v92, v25, v24, v5
    v_perm_b32 v89, v27, v26, v4
    v_perm_b32 v93, v27, v26, v5
    v_perm_b32 v90, v29, v28, v4
    v_perm_b32 v94, v29, v28, v5
    v_perm_b32 v91, v31, v30, v4
    v_perm_b32 v95, v31, v30, v5
    buffer_store_dwordx4 v[88:91], v7, s[8:11], s30 offen offset:512
    buffer_store_dwordx4 v[92:95], v7, s[8:11], s30 offen offset:528
    s_nop 0
    s_waitcnt vmcnt(40)
    v_perm_b32 v80, v33, v32, v4
    v_perm_b32 v84, v33, v32, v5
    v_perm_b32 v81, v35, v34, v4
    v_perm_b32 v85, v35, v34, v5
    v_perm_b32 v82, v37, v36, v4
    v_perm_b32 v86, v37, v36, v5
    v_perm_b32 v83, v39, v38, v4
    v_perm_b32 v87, v39, v38, v5
    buffer_store_dwordx4 v[80:83], v7, s[8:11], s30 offen offset:1024
    buffer_store_dwordx4 v[84:87], v7, s[8:11], s30 offen offset:1040
    s_nop 0
    s_waitcnt vmcnt(32)
    v_perm_b32 v88, v41, v40, v4
    v_perm_b32 v92, v41, v40, v5
    v_perm_b32 v89, v43, v42, v4
    v_perm_b32 v93, v43, v42, v5
    v_perm_b32 v90, v45, v44, v4
    v_perm_b32 v94, v45, v44, v5
    v_perm_b32 v91, v47, v46, v4
    v_perm_b32 v95, v47, v46, v5
    buffer_store_dwordx4 v[88:91], v7, s[8:11], s30 offen offset:1536
    buffer_store_dwordx4 v[92:95], v7, s[8:11], s30 offen offset:1552
    s_nop 0
    s_waitcnt vmcnt(24)
    v_perm_b32 v80, v49, v48, v4
    v_perm_b32 v84, v49, v48, v5
    v_perm_b32 v81, v51, v50, v4
    v_perm_b32 v85, v51, v50, v5
    v_perm_b32 v82, v53, v52, v4
    v_perm_b32 v86, v53, v52, v5
    v_perm_b32 v83, v55, v54, v4
    v_perm_b32 v87, v55, v54, v5
    buffer_store_dwordx4 v[80:83], v7, s[8:11], s30 offen offset:2048
    buffer_store_dwordx4 v[84:87], v7, s[8:11], s30 offen offset:2064
    s_nop 0
    s_waitcnt vmcnt(16)
    v_perm_b32 v88, v57, v56, v4
    v_perm_b32 v92, v57, v56, v5
    v_perm_b32 v89, v59, v58, v4
    v_perm_b32 v93, v59, v58, v5
    v_perm_b32 v90, v61, v60, v4
    v_perm_b32 v94, v61, v60, v5
    v_perm_b32 v91, v63, v62, v4
    v_perm_b32 v95, v63, v62, v5
    buffer_store_dwordx4 v[88:91], v7, s[8:11], s30 offen offset:2560
    buffer_store_dwordx4 v[92:95], v7, s[8:11], s30 offen offset:2576
    s_nop 0
    s_waitcnt vmcnt(8)
    v_perm_b32 v80, v65, v64, v4
    v_perm_b32 v84, v65, v64, v5
    v_perm_b32 v81, v67, v66, v4
    v_perm_b32 v85, v67, v66, v5
    v_perm_b32 v82, v69, v68, v4
    v_perm_b32 v86, v69, v68, v5
    v_perm_b32 v83, v71, v70, v4
    v_perm_b32 v87, v71, v70, v5
    buffer_store_dwordx4 v[80:83], v7, s[8:11], s30 offen offset:3072
    buffer_store_dwordx4 v[84:87], v7, s[8:11], s30 offen offset:3088
    s_nop 0
    s_waitcnt vmcnt(0)
    v_perm_b32 v88, v73, v72, v4
    v_perm_b32 v92, v73, v72, v5
    v_perm_b32 v89, v75, v74, v4
    v_perm_b32 v93, v75, v74, v5
    v_perm_b32 v90, v77, v76, v4
    v_perm_b32 v94, v77, v76, v5
    v_perm_b32 v91, v79, v78, v4
    v_perm_b32 v95, v79, v78, v5
    buffer_store_dwordx4 v[88:91], v7, s[8:11], s30 offen offset:3584
    buffer_store_dwordx4 v[92:95], v7, s[8:11], s30 offen offset:3600
    s_nop 0
    s_branch prep_kernel_end
prep_kernel_end:
    s_endpgm
.section .rodata,"a"
.p2align 6
.amdhsa_kernel prep_kernel
  .amdhsa_next_free_vgpr 248
  .amdhsa_next_free_sgpr 64
  .amdhsa_accum_offset 248
  .amdhsa_group_segment_fixed_size 0
  .amdhsa_kernarg_size 104
  .amdhsa_user_sgpr_count 2
  .amdhsa_user_sgpr_kernarg_segment_ptr 1
  .amdhsa_system_sgpr_workgroup_id_x 1
.end_amdhsa_kernel
.text
.globl ln_a1_kernel
.p2align 8
.type ln_a1_kernel,@function
ln_a1_kernel:
    v_lshrrev_b32 v1, 6, v0
    v_and_b32 v2, 63, v0
    s_nop 0
    v_readfirstlane_b32 s3, v1
    s_lshl_b32 s4, s2, 2
    s_add_u32 s4, s4, s3
    s_cmp_ge_u32 s4, 2048
    s_cbranch_scc1 ln_a1_kernel_end
    s_load_dwordx2 s[6:7], s[0:1], 0
    s_load_dwordx2 s[12:13], s[0:1], 96
    s_waitcnt lgkmcnt(0)
    s_mov_b32 s8, s6
    s_mov_b32 s9, s7
    s_mov_b32 s10, 2621440
    s_mov_b32 s11, 0x00020000
    s_add_u32 s16, s12, 223346688
    s_addc_u32 s17, s13, 0
    s_mov_b32 s18, 2621440
    s_mov_b32 s19, 0x00020000
    s_mul_i32 s5, s4, 1280
    v_lshlrev_b32 v3, 2, v2
    v_add_u32 v3, s5, v3
    buffer_load_dword v4, v3, s[8:11], 0 offen offset:0
    buffer_load_dword v5, v3, s[8:11], 0 offen offset:256
    buffer_load_dword v6, v3, s[8:11], 0 offen offset:512
    buffer_load_dword v7, v3, s[8:11], 0 offen offset:768
    buffer_load_dword v8, v3, s[8:11], 0 offen offset:1024
    s_waitcnt vmcnt(0)
    v_lshlrev_b32 v10, 16, v4
    v_and_b32 v11, 0xffff0000, v4
    v_lshlrev_b32 v12, 16, v5
    v_and_b32 v13, 0xffff0000, v5
    v_lshlrev_b32 v14, 16, v6
    v_and_b32 v15, 0xffff0000, v6
    v_lshlrev_b32 v16, 16, v7
    v_and_b32 v17, 0xffff0000, v7
    v_lshlrev_b32 v18, 16, v8
    v_and_b32 v19, 0xffff0000, v8
    v_add_f32 v20, v10, v11
    v_add_f32 v20, v20, v12
    v_add_f32 v20, v20, v13
    v_add_f32 v20, v20, v14
    v_add_f32 v20, v20, v15
    v_add_f32 v20, v20, v16
    v_add_f32 v20, v20, v17
    v_add_f32 v20, v20, v18
    v_add_f32 v20, v20, v19
    s_nop 1
    v_add_f32 v21, v20, v20 quad_perm:[1,0,3,2] row_mask:0xf bank_mask:0xf
    s_nop 1
    v_add_f32 v21, v21, v21 quad_perm:[2,3,0,1] row_mask:0xf bank_mask:0xf
    s_nop 1
    v_add_f32 v21, v21, v21 row_half_mirror row_mask:0xf bank_mask:0xf
    s_nop 1
    v_add_f32 v21, v21, v21 row_mirror row_mask:0xf bank_mask:0xf
    s_nop 1
    v_readlane_b32 s24, v21, 0
    v_readlane_b32 s25, v21, 16
    v_readlane_b32 s26, v21, 32
    v_readlane_b32 s27, v21, 48
    s_nop 1
    v_mov_b32 v20, s24
    v_add_f32 v20, s25, v20
    v_add_f32 v20, s26, v20
    v_add_f32 v20, s27, v20
    v_mul_f32 v20, 0.0015625, v20
    v_sub_f32 v10, v10, v20
    v_sub_f32 v11, v11, v20
    v_sub_f32 v12, v12, v20
    v_sub_f32 v13, v13, v20
    v_sub_f32 v14, v14, v20
    v_sub_f32 v15, v15, v20
    v_sub_f32 v16, v16, v20
    v_sub_f32 v17, v17, v20
    v_sub_f32 v18, v18, v20
    v_sub_f32 v19, v19, v20
    v_mul_f32 v21, v10, v10
    v_fmac_f32 v21, v11, v11
    v_fmac_f32 v21, v12, v12
    v_fmac_f32 v21, v13, v13
    v_fmac_f32 v21, v14, v14
    v_fmac_f32 v21, v15, v15
    v_fmac_f32 v21, v16, v16
    v_fmac_f32 v21, v17, v17
    v_fmac_f32 v21, v18, v18
    v_fmac_f32 v21, v19, v19
    s_nop 1
    v_add_f32 v22, v21, v21 quad_perm:[1,0,3,2] row_mask:0xf bank_mask:0xf
    s_nop 1
    v_add_f32 v22, v22, v22 quad_perm:[2,3,0,1] row_mask:0xf bank_mask:0xf
    s_nop 1
    v_add_f32 v22, v22, v22 row_half_mirror row_mask:0xf bank_mask:0xf
    s_nop 1
    v_add_f32 v22, v22, v22 row_mirror row_mask:0xf bank_mask:0xf
    s_nop 1
    v_readlane_b32 s24, v22, 0
    v_readlane_b32 s25, v22, 16
    v_readlane_b32 s26, v22, 32
    v_readlane_b32 s27, v22, 48
    s_nop 1
    v_mov_b32 v21, s24
    v_add_f32 v21, s25, v21
    v_add_f32 v21, s26, v21
    v_add_f32 v21, s27, v21
    v_mov_b32 v22, 0x3727c5ac
    v_fmac_f32 v22, 0.0015625, v21
    v_rsq_f32 v22, v22
    s_nop 0
    v_mul_f32 v10, v10, v22
    v_mul_f32 v11, v11, v22
    v_mul_f32 v12, v12, v22
    v_mul_f32 v13, v13, v22
    v_mul_f32 v14, v14, v22
    v_mul_f32 v15, v15, v22
    v_mul_f32 v16, v16, v22
    v_mul_f32 v17, v17, v22
    v_mul_f32 v18, v18, v22
    v_mul_f32 v19, v19, v22
    v_cvt_pk_bf16_f32 v4, v10, v11
    v_cvt_pk_bf16_f32 v5, v12, v13
    v_cvt_pk_bf16_f32 v6, v14, v15
    v_cvt_pk_bf16_f32 v7, v16, v17
    v_cvt_pk_bf16_f32 v8, v18, v19
    buffer_store_dword v4, v3, s[16:19], 0 offen offset:0
    buffer_store_dword v5, v3, s[16:19], 0 offen offset:256
    buffer_store_dword v6, v3, s[16:19], 0 offen offset:512
    buffer_store_dword v7, v3, s[16:19], 0 offen offset:768
    buffer_store_dword v8, v3, s[16:19], 0 offen offset:1024
ln_a1_kernel_end:
    s_endpgm
.section .rodata,"a"
.p2align 6
.amdhsa_kernel ln_a1_kernel
  .amdhsa_next_free_vgpr 32
  .amdhsa_next_free_sgpr 40
  .amdhsa_accum_offset 32
  .amdhsa_group_segment_fixed_size 0
  .amdhsa_kernarg_size 104
  .amdhsa_user_sgpr_count 2
  .amdhsa_user_sgpr_kernarg_segment_ptr 1
  .amdhsa_system_sgpr_workgroup_id_x 1
.end_amdhsa_kernel
.text
.globl qkv_a_kernel
.p2align 8
.type qkv_a_kernel,@function
qkv_a_kernel:
    v_lshrrev_b32 v1, 6, v0
    v_and_b32 v2, 63, v0
    s_nop 0
    v_readfirstlane_b32 s3, v1
    s_cmp_ge_u32 s2, 192
    s_cbranch_scc1 qkv_a_kernel_end
    s_load_dwordx2 s[4:5], s[0:1], 96
    s_load_dwordx2 s[6:7], s[0:1], 80
    s_mul_i32 s20, s2, 171
    s_lshr_b32 s20, s20, 12
    s_mul_i32 s21, s20, 24
    s_sub_u32 s21, s2, s21
    s_lshl_b32 s20, s20, 2
    s_add_u32 s20, s20, s3
    s_mul_i32 s22, s20, 64
    s_mul_i32 s23, s21, 80
    s_waitcnt lgkmcnt(0)
    s_mov_b32 s8, s4
    s_mov_b32 s9, s5
    s_mov_b32 s10, 268435456
    s_mov_b32 s11, 0x00020000
    v_and_b32 v3, 15, v2
    v_lshrrev_b32 v4, 4, v2
    s_mov_b32 s24, 1280
    v_add_u32 v5, s22, v3
    v_mul_lo_u32 v5, v5, s24
    v_lshlrev_b32 v6, 4, v4
    v_add_u32 v5, v5, v6
    v_add_u32 v5, 223346688, v5
    v_mov_b32 v8, v5
    v_add_u32 v9, 20480, v5
    v_add_u32 v10, 40960, v5
    v_add_u32 v11, 61440, v5
    v_lshlrev_b32 v7, 4, v2
    s_mov_b32 s25, 0
    s_mov_b32 s26, 0
    s_mul_i32 s27, s21, 102400
    s_add_u32 s27, s27, s26
    s_add_u32 s27, s27, 243269632
    s_add_u32 s32, s27, 0
    s_add_u32 s33, s27, 20480
    s_add_u32 s34, s27, 40960
    s_add_u32 s35, s27, 61440
    s_add_u32 s36, s27, 81920
    v_accvgpr_write_b32 a0, 0
    v_accvgpr_write_b32 a1, 0
    v_accvgpr_write_b32 a2, 0
    v_accvgpr_write_b32 a3, 0
    v_accvgpr_write_b32 a4, 0
    v_accvgpr_write_b32 a5, 0
    v_accvgpr_write_b32 a6, 0
    v_accvgpr_write_b32 a7, 0
    v_accvgpr_write_b32 a8, 0
    v_accvgpr_write_b32 a9, 0
    v_accvgpr_write_b32 a10, 0
    v_accvgpr_write_b32 a11, 0
    v_accvgpr_write_b32 a12, 0
    v_accvgpr_write_b32 a13, 0
    v_accvgpr_write_b32 a14, 0
    v_accvgpr_write_b32 a15, 0
    v_accvgpr_write_b32 a16, 0
    v_accvgpr_write_b32 a17, 0
    v_accvgpr_write_b32 a18, 0
    v_accvgpr_write_b32 a19, 0
    v_accvgpr_write_b32 a20, 0
    v_accvgpr_write_b32 a21, 0
    v_accvgpr_write_b32 a22, 0
    v_accvgpr_write_b32 a23, 0
    v_accvgpr_write_b32 a24, 0
    v_accvgpr_write_b32 a25, 0
    v_accvgpr_write_b32 a26, 0
    v_accvgpr_write_b32 a27, 0
    v_accvgpr_write_b32 a28, 0
    v_accvgpr_write_b32 a29, 0
    v_accvgpr_write_b32 a30, 0
    v_accvgpr_write_b32 a31, 0
    v_accvgpr_write_b32 a32, 0
    v_accvgpr_write_b32 a33, 0
    v_accvgpr_write_b32 a34, 0
    v_accvgpr_write_b32 a35, 0
    v_accvgpr_write_b32 a36, 0
    v_accvgpr_write_b32 a37, 0
    v_accvgpr_write_b32 a38, 0
    v_accvgpr_write_b32 a39, 0
    v_accvgpr_write_b32 a40, 0
    v_accvgpr_write_b32 a41, 0
    v_accvgpr_write_b32 a42, 0
    v_accvgpr_write_b32 a43, 0
    v_accvgpr_write_b32 a44, 0
    v_accvgpr_write_b32 a45, 0
    v_accvgpr_write_b32 a46, 0
    v_accvgpr_write_b32 a47, 0
    v_accvgpr_write_b32 a48, 0
    v_accvgpr_write_b32 a49, 0
    v_accvgpr_write_b32 a50, 0
    v_accvgpr_write_b32 a51, 0
    v_accvgpr_write_b32 a52, 0
    v_accvgpr_write_b32 a53, 0
    v_accvgpr_write_b32 a54, 0
    v_accvgpr_write_b32 a55, 0
    v_accvgpr_write_b32 a56, 0
    v_accvgpr_write_b32 a57, 0
    v_accvgpr_write_b32 a58, 0
    v_accvgpr_write_b32 a59, 0
    v_accvgpr_write_b32 a60, 0
    v_accvgpr_write_b32 a61, 0
    v_accvgpr_write_b32 a62, 0
    v_accvgpr_write_b32 a63, 0
    v_accvgpr_write_b32 a64, 0
    v_accvgpr_write_b32 a65, 0
    v_accvgpr_write_b32 a66, 0
    v_accvgpr_write_b32 a67, 0
    v_accvgpr_write_b32 a68, 0
    v_accvgpr_write_b32 a69, 0
    v_accvgpr_write_b32 a70, 0
    v_accvgpr_write_b32 a71, 0
    v_accvgpr_write_b32 a72, 0
    v_accvgpr_write_b32 a73, 0
    v_accvgpr_write_b32 a74, 0
    v_accvgpr_write_b32 a75, 0
    v_accvgpr_write_b32 a76, 0
    v_accvgpr_write_b32 a77, 0
    v_accvgpr_write_b32 a78, 0
    v_accvgpr_write_b32 a79, 0
    s_cmp_ge_u32 s23, 640
    s_cbranch_scc1 qkv_a_kernel_nrm
    buffer_load_dwordx4 v[16:19], v8, s[8:11], s25 offen
    buffer_load_dwordx4 v[20:23], v9, s[8:11], s25 offen
    buffer_load_dwordx4 v[24:27], v10, s[8:11], s25 offen
    buffer_load_dwordx4 v[28:31], v11, s[8:11], s25 offen
    buffer_load_dwordx4 v[32:35], v7, s[8:11], s32 offen
    buffer_load_dwordx4 v[36:39], v7, s[8:11], s33 offen
    buffer_load_dwordx4 v[40:43], v7, s[8:11], s34 offen
    buffer_load_dwordx4 v[44:47], v7, s[8:11], s35 offen
    buffer_load_dwordx4 v[48:51], v7, s[8:11], s36 offen
    s_mov_b32 s28, 10
qkv_a_kernel_loop0:
    s_add_u32 s25, s25, 64
    s_add_u32 s32, s32, 1024
    s_add_u32 s33, s33, 1024
    s_add_u32 s34, s34, 1024
    s_add_u32 s35, s35, 1024
    s_add_u32 s36, s36, 1024
    buffer_load_dwordx4 v[52:55], v8, s[8:11], s25 offen
    buffer_load_dwordx4 v[56:59], v9, s[8:11], s25 offen
    buffer_load_dwordx4 v[60:63], v10, s[8:11], s25 offen
    buffer_load_dwordx4 v[64:67], v11, s[8:11], s25 offen
    buffer_load_dwordx4 v[68:71], v7, s[8:11], s32 offen
    buffer_load_dwordx4 v[72:75], v7, s[8:11], s33 offen
    buffer_load_dwordx4 v[76:79], v7, s[8:11], s34 offen
    buffer_load_dwordx4 v[80:83], v7, s[8:11], s35 offen
    buffer_load_dwordx4 v[84:87], v7, s[8:11], s36 offen
    s_waitcnt vmcnt(9)
    v_mfma_f32_16x16x32_bf16 a[0:3], v[32:35], v[16:19], a[0:3]
    v_mfma_f32_16x16x32_bf16 a[20:23], v[32:35], v[20:23], a[20:23]
    v_mfma_f32_16x16x32_bf16 a[40:43], v[32:35], v[24:27], a[40:43]
    v_mfma_f32_16x16x32_bf16 a[60:63], v[32:35], v[28:31], a[60:63]
    v_mfma_f32_16x16x32_bf16 a[4:7], v[36:39], v[16:19], a[4:7]
    v_mfma_f32_16x16x32_bf16 a[24:27], v[36:39], v[20:23], a[24:27]
    v_mfma_f32_16x16x32_bf16 a[44:47], v[36:39], v[24:27], a[44:47]
    v_mfma_f32_16x16x32_bf16 a[64:67], v[36:39], v[28:31], a[64:67]
    v_mfma_f32_16x16x32_bf16 a[8:11], v[40:43], v[16:19], a[8:11]
    v_mfma_f32_16x16x32_bf16 a[28:31], v[40:43], v[20:23], a[28:31]
    v_mfma_f32_16x16x32_bf16 a[48:51], v[40:43], v[24:27], a[48:51]
    v_mfma_f32_16x16x32_bf16 a[68:71], v[40:43], v[28:31], a[68:71]
    v_mfma_f32_16x16x32_bf16 a[12:15], v[44:47], v[16:19], a[12:15]
    v_mfma_f32_16x16x32_bf16 a[32:35], v[44:47], v[20:23], a[32:35]
    v_mfma_f32_16x16x32_bf16 a[52:55], v[44:47], v[24:27], a[52:55]
    v_mfma_f32_16x16x32_bf16 a[72:75], v[44:47], v[28:31], a[72:75]
    v_mfma_f32_16x16x32_bf16 a[16:19], v[48:51], v[16:19], a[16:19]
    v_mfma_f32_16x16x32_bf16 a[36:39], v[48:51], v[20:23], a[36:39]
    v_mfma_f32_16x16x32_bf16 a[56:59], v[48:51], v[24:27], a[56:59]
    v_mfma_f32_16x16x32_bf16 a[76:79], v[48:51], v[28:31], a[76:79]
    s_sub_u32 s28, s28, 1
    s_cmp_eq_u32 s28, 0
    s_cbranch_scc1 qkv_a_kernel_loop0_last
    s_add_u32 s25, s25, 64
    s_add_u32 s32, s32, 1024
    s_add_u32 s33, s33, 1024
    s_add_u32 s34, s34, 1024
    s_add_u32 s35, s35, 1024
    s_add_u32 s36, s36, 1024
    buffer_load_dwordx4 v[16:19], v8, s[8:11], s25 offen
    buffer_load_dwordx4 v[20:23], v9, s[8:11], s25 offen
    buffer_load_dwordx4 v[24:27], v10, s[8:11], s25 offen
    buffer_load_dwordx4 v[28:31], v11, s[8:11], s25 offen
    buffer_load_dwordx4 v[32:35], v7, s[8:11], s32 offen
    buffer_load_dwordx4 v[36:39], v7, s[8:11], s33 offen
    buffer_load_dwordx4 v[40:43], v7, s[8:11], s34 offen
    buffer_load_dwordx4 v[44:47], v7, s[8:11], s35 offen
    buffer_load_dwordx4 v[48:51], v7, s[8:11], s36 offen
    s_waitcnt vmcnt(9)
    v_mfma_f32_16x16x32_bf16 a[0:3], v[68:71], v[52:55], a[0:3]
    v_mfma_f32_16x16x32_bf16 a[20:23], v[68:71], v[56:59], a[20:23]
    v_mfma_f32_16x16x32_bf16 a[40:43], v[68:71], v[60:63], a[40:43]
    v_mfma_f32_16x16x32_bf16 a[60:63], v[68:71], v[64:67], a[60:63]
    v_mfma_f32_16x16x32_bf16 a[4:7], v[72:75], v[52:55], a[4:7]
    v_mfma_f32_16x16x32_bf16 a[24:27], v[72:75], v[56:59], a[24:27]
    v_mfma_f32_16x16x32_bf16 a[44:47], v[72:75], v[60:63], a[44:47]
    v_mfma_f32_16x16x32_bf16 a[64:67], v[72:75], v[64:67], a[64:67]
    v_mfma_f32_16x16x32_bf16 a[8:11], v[76:79], v[52:55], a[8:11]
    v_mfma_f32_16x16x32_bf16 a[28:31], v[76:79], v[56:59], a[28:31]
    v_mfma_f32_16x16x32_bf16 a[48:51], v[76:79], v[60:63], a[48:51]
    v_mfma_f32_16x16x32_bf16 a[68:71], v[76:79], v[64:67], a[68:71]
    v_mfma_f32_16x16x32_bf16 a[12:15], v[80:83], v[52:55], a[12:15]
    v_mfma_f32_16x16x32_bf16 a[32:35], v[80:83], v[56:59], a[32:35]
    v_mfma_f32_16x16x32_bf16 a[52:55], v[80:83], v[60:63], a[52:55]
    v_mfma_f32_16x16x32_bf16 a[72:75], v[80:83], v[64:67], a[72:75]
    v_mfma_f32_16x16x32_bf16 a[16:19], v[84:87], v[52:55], a[16:19]
    v_mfma_f32_16x16x32_bf16 a[36:39], v[84:87], v[56:59], a[36:39]
    v_mfma_f32_16x16x32_bf16 a[56:59], v[84:87], v[60:63], a[56:59]
    v_mfma_f32_16x16x32_bf16 a[76:79], v[84:87], v[64:67], a[76:79]
    s_branch qkv_a_kernel_loop0
qkv_a_kernel_loop0_last:
    s_waitcnt vmcnt(0)
    v_mfma_f32_16x16x32_bf16 a[0:3], v[68:71], v[52:55], a[0:3]
    v_mfma_f32_16x16x32_bf16 a[20:23], v[68:71], v[56:59], a[20:23]
    v_mfma_f32_16x16x32_bf16 a[40:43], v[68:71], v[60:63], a[40:43]
    v_mfma_f32_16x16x32_bf16 a[60:63], v[68:71], v[64:67], a[60:63]
    v_mfma_f32_16x16x32_bf16 a[4:7], v[72:75], v[52:55], a[4:7]
    v_mfma_f32_16x16x32_bf16 a[24:27], v[72:75], v[56:59], a[24:27]
    v_mfma_f32_16x16x32_bf16 a[44:47], v[72:75], v[60:63], a[44:47]
    v_mfma_f32_16x16x32_bf16 a[64:67], v[72:75], v[64:67], a[64:67]
    v_mfma_f32_16x16x32_bf16 a[8:11], v[76:79], v[52:55], a[8:11]
    v_mfma_f32_16x16x32_bf16 a[28:31], v[76:79], v[56:59], a[28:31]
    v_mfma_f32_16x16x32_bf16 a[48:51], v[76:79], v[60:63], a[48:51]
    v_mfma_f32_16x16x32_bf16 a[68:71], v[76:79], v[64:67], a[68:71]
    v_mfma_f32_16x16x32_bf16 a[12:15], v[80:83], v[52:55], a[12:15]
    v_mfma_f32_16x16x32_bf16 a[32:35], v[80:83], v[56:59], a[32:35]
    v_mfma_f32_16x16x32_bf16 a[52:55], v[80:83], v[60:63], a[52:55]
    v_mfma_f32_16x16x32_bf16 a[72:75], v[80:83], v[64:67], a[72:75]
    v_mfma_f32_16x16x32_bf16 a[16:19], v[84:87], v[52:55], a[16:19]
    v_mfma_f32_16x16x32_bf16 a[36:39], v[84:87], v[56:59], a[36:39]
    v_mfma_f32_16x16x32_bf16 a[56:59], v[84:87], v[60:63], a[56:59]
    v_mfma_f32_16x16x32_bf16 a[76:79], v[84:87], v[64:67], a[76:79]
    s_nop 7
    s_nop 7
    s_mov_b32 s24, 1280
    s_lshl_b32 s29, s23, 1
    s_add_u32 s29, s29, 229638144
    v_add_u32 v5, s22, v3
    v_mul_lo_u32 v5, v5, s24
    v_lshlrev_b32 v6, 3, v4
    v_add3_u32 v5, v5, v6, s29
    v_accvgpr_read_b32 v92, a0
    v_accvgpr_read_b32 v93, a1
    v_accvgpr_read_b32 v94, a2
    v_accvgpr_read_b32 v95, a3
    v_cvt_pk_bf16_f32 v96, v92, v93
    v_cvt_pk_bf16_f32 v97, v94, v95
    v_add_u32 v6, 0, v5
    buffer_store_dwordx2 v[96:97], v6, s[8:11], 0 offen
    v_accvgpr_read_b32 v92, a4
    v_accvgpr_read_b32 v93, a5
    v_accvgpr_read_b32 v94, a6
    v_accvgpr_read_b32 v95, a7
    v_cvt_pk_bf16_f32 v96, v92, v93
    v_cvt_pk_bf16_f32 v97, v94, v95
    v_add_u32 v6, 32, v5
    buffer_store_dwordx2 v[96:97], v6, s[8:11], 0 offen
    v_accvgpr_read_b32 v92, a8
    v_accvgpr_read_b32 v93, a9
    v_accvgpr_read_b32 v94, a10
    v_accvgpr_read_b32 v95, a11
    v_cvt_pk_bf16_f32 v96, v92, v93
    v_cvt_pk_bf16_f32 v97, v94, v95
    v_add_u32 v6, 64, v5
    buffer_store_dwordx2 v[96:97], v6, s[8:11], 0 offen
    v_accvgpr_read_b32 v92, a12
    v_accvgpr_read_b32 v93, a13
    v_accvgpr_read_b32 v94, a14
    v_accvgpr_read_b32 v95, a15
    v_cvt_pk_bf16_f32 v96, v92, v93
    v_cvt_pk_bf16_f32 v97, v94, v95
    v_add_u32 v6, 96, v5
    buffer_store_dwordx2 v[96:97], v6, s[8:11], 0 offen
    v_accvgpr_read_b32 v92, a16
    v_accvgpr_read_b32 v93, a17
    v_accvgpr_read_b32 v94, a18
    v_accvgpr_read_b32 v95, a19
    v_cvt_pk_bf16_f32 v96, v92, v93
    v_cvt_pk_bf16_f32 v97, v94, v95
    v_add_u32 v6, 128, v5
    buffer_store_dwordx2 v[96:97], v6, s[8:11], 0 offen
    v_accvgpr_read_b32 v92, a20
    v_accvgpr_read_b32 v93, a21
    v_accvgpr_read_b32 v94, a22
    v_accvgpr_read_b32 v95, a23
    v_cvt_pk_bf16_f32 v96, v92, v93
    v_cvt_pk_bf16_f32 v97, v94, v95
    v_add_u32 v6, 20480, v5
    buffer_store_dwordx2 v[96:97], v6, s[8:11], 0 offen
    v_accvgpr_read_b32 v92, a24
    v_accvgpr_read_b32 v93, a25
    v_accvgpr_read_b32 v94, a26
    v_accvgpr_read_b32 v95, a27
    v_cvt_pk_bf16_f32 v96, v92, v93
    v_cvt_pk_bf16_f32 v97, v94, v95
    v_add_u32 v6, 20512, v5
    buffer_store_dwordx2 v[96:97], v6, s[8:11], 0 offen
    v_accvgpr_read_b32 v92, a28
    v_accvgpr_read_b32 v93, a29
    v_accvgpr_read_b32 v94, a30
    v_accvgpr_read_b32 v95, a31
    v_cvt_pk_bf16_f32 v96, v92, v93
    v_cvt_pk_bf16_f32 v97, v94, v95
    v_add_u32 v6, 20544, v5
    buffer_store_dwordx2 v[96:97], v6, s[8:11], 0 offen
    v_accvgpr_read_b32 v92, a32
    v_accvgpr_read_b32 v93, a33
    v_accvgpr_read_b32 v94, a34
    v_accvgpr_read_b32 v95, a35
    v_cvt_pk_bf16_f32 v96, v92, v93
    v_cvt_pk_bf16_f32 v97, v94, v95
    v_add_u32 v6, 20576, v5
    buffer_store_dwordx2 v[96:97], v6, s[8:11], 0 offen
    v_accvgpr_read_b32 v92, a36
    v_accvgpr_read_b32 v93, a37
    v_accvgpr_read_b32 v94, a38
    v_accvgpr_read_b32 v95, a39
    v_cvt_pk_bf16_f32 v96, v92, v93
    v_cvt_pk_bf16_f32 v97, v94, v95
    v_add_u32 v6, 20608, v5
    buffer_store_dwordx2 v[96:97], v6, s[8:11], 0 offen
    v_accvgpr_read_b32 v92, a40
    v_accvgpr_read_b32 v93, a41
    v_accvgpr_read_b32 v94, a42
    v_accvgpr_read_b32 v95, a43
    v_cvt_pk_bf16_f32 v96, v92, v93
    v_cvt_pk_bf16_f32 v97, v94, v95
    v_add_u32 v6, 40960, v5
    buffer_store_dwordx2 v[96:97], v6, s[8:11], 0 offen
    v_accvgpr_read_b32 v92, a44
    v_accvgpr_read_b32 v93, a45
    v_accvgpr_read_b32 v94, a46
    v_accvgpr_read_b32 v95, a47
    v_cvt_pk_bf16_f32 v96, v92, v93
    v_cvt_pk_bf16_f32 v97, v94, v95
    v_add_u32 v6, 40992, v5
    buffer_store_dwordx2 v[96:97], v6, s[8:11], 0 offen
    v_accvgpr_read_b32 v92, a48
    v_accvgpr_read_b32 v93, a49
    v_accvgpr_read_b32 v94, a50
    v_accvgpr_read_b32 v95, a51
    v_cvt_pk_bf16_f32 v96, v92, v93
    v_cvt_pk_bf16_f32 v97, v94, v95
    v_add_u32 v6, 41024, v5
    buffer_store_dwordx2 v[96:97], v6, s[8:11], 0 offen
    v_accvgpr_read_b32 v92, a52
    v_accvgpr_read_b32 v93, a53
    v_accvgpr_read_b32 v94, a54
    v_accvgpr_read_b32 v95, a55
    v_cvt_pk_bf16_f32 v96, v92, v93
    v_cvt_pk_bf16_f32 v97, v94, v95
    v_add_u32 v6, 41056, v5
    buffer_store_dwordx2 v[96:97], v6, s[8:11], 0 offen
    v_accvgpr_read_b32 v92, a56
    v_accvgpr_read_b32 v93, a57
    v_accvgpr_read_b32 v94, a58
    v_accvgpr_read_b32 v95, a59
    v_cvt_pk_bf16_f32 v96, v92, v93
    v_cvt_pk_bf16_f32 v97, v94, v95
    v_add_u32 v6, 41088, v5
    buffer_store_dwordx2 v[96:97], v6, s[8:11], 0 offen
    v_accvgpr_read_b32 v92, a60
    v_accvgpr_read_b32 v93, a61
    v_accvgpr_read_b32 v94, a62
    v_accvgpr_read_b32 v95, a63
    v_cvt_pk_bf16_f32 v96, v92, v93
    v_cvt_pk_bf16_f32 v97, v94, v95
    v_add_u32 v6, 61440, v5
    buffer_store_dwordx2 v[96:97], v6, s[8:11], 0 offen
    v_accvgpr_read_b32 v92, a64
    v_accvgpr_read_b32 v93, a65
    v_accvgpr_read_b32 v94, a66
    v_accvgpr_read_b32 v95, a67
    v_cvt_pk_bf16_f32 v96, v92, v93
    v_cvt_pk_bf16_f32 v97, v94, v95
    v_add_u32 v6, 61472, v5
    buffer_store_dwordx2 v[96:97], v6, s[8:11], 0 offen
    v_accvgpr_read_b32 v92, a68
    v_accvgpr_read_b32 v93, a69
    v_accvgpr_read_b32 v94, a70
    v_accvgpr_read_b32 v95, a71
    v_cvt_pk_bf16_f32 v96, v92, v93
    v_cvt_pk_bf16_f32 v97, v94, v95
    v_add_u32 v6, 61504, v5
    buffer_store_dwordx2 v[96:97], v6, s[8:11], 0 offen
    v_accvgpr_read_b32 v92, a72
    v_accvgpr_read_b32 v93, a73
    v_accvgpr_read_b32 v94, a74
    v_accvgpr_read_b32 v95, a75
    v_cvt_pk_bf16_f32 v96, v92, v93
    v_cvt_pk_bf16_f32 v97, v94, v95
    v_add_u32 v6, 61536, v5
    buffer_store_dwordx2 v[96:97], v6, s[8:11], 0 offen
    v_accvgpr_read_b32 v92, a76
    v_accvgpr_read_b32 v93, a77
    v_accvgpr_read_b32 v94, a78
    v_accvgpr_read_b32 v95, a79
    v_cvt_pk_bf16_f32 v96, v92, v93
    v_cvt_pk_bf16_f32 v97, v94, v95
    v_add_u32 v6, 61568, v5
    buffer_store_dwordx2 v[96:97], v6, s[8:11], 0 offen
    s_branch qkv_a_kernel_end
qkv_a_kernel_nrm:
    buffer_load_dwordx4 v[16:19], v8, s[8:11], s25 offen
    buffer_load_dwordx4 v[20:23], v9, s[8:11], s25 offen
    buffer_load_dwordx4 v[24:27], v10, s[8:11], s25 offen
    buffer_load_dwordx4 v[28:31], v11, s[8:11], s25 offen
    buffer_load_dwordx4 v[32:35], v7, s[8:11], s32 offen
    buffer_load_dwordx4 v[36:39], v7, s[8:11], s33 offen
    buffer_load_dwordx4 v[40:43], v7, s[8:11], s34 offen
    buffer_load_dwordx4 v[44:47], v7, s[8:11], s35 offen
    buffer_load_dwordx4 v[48:51], v7, s[8:11], s36 offen
    s_mov_b32 s28, 10
qkv_a_kernel_loop1:
    s_add_u32 s25, s25, 64
    s_add_u32 s32, s32, 1024
    s_add_u32 s33, s33, 1024
    s_add_u32 s34, s34, 1024
    s_add_u32 s35, s35, 1024
    s_add_u32 s36, s36, 1024
    buffer_load_dwordx4 v[52:55], v8, s[8:11], s25 offen
    buffer_load_dwordx4 v[56:59], v9, s[8:11], s25 offen
    buffer_load_dwordx4 v[60:63], v10, s[8:11], s25 offen
    buffer_load_dwordx4 v[64:67], v11, s[8:11], s25 offen
    buffer_load_dwordx4 v[68:71], v7, s[8:11], s32 offen
    buffer_load_dwordx4 v[72:75], v7, s[8:11], s33 offen
    buffer_load_dwordx4 v[76:79], v7, s[8:11], s34 offen
    buffer_load_dwordx4 v[80:83], v7, s[8:11], s35 offen
    buffer_load_dwordx4 v[84:87], v7, s[8:11], s36 offen
    s_waitcnt vmcnt(9)
    v_mfma_f32_16x16x32_bf16 a[0:3], v[16:19], v[32:35], a[0:3]
    v_mfma_f32_16x16x32_bf16 a[20:23], v[20:23], v[32:35], a[20:23]
    v_mfma_f32_16x16x32_bf16 a[40:43], v[24:27], v[32:35], a[40:43]
    v_mfma_f32_16x16x32_bf16 a[60:63], v[28:31], v[32:35], a[60:63]
    v_mfma_f32_16x16x32_bf16 a[4:7], v[16:19], v[36:39], a[4:7]
    v_mfma_f32_16x16x32_bf16 a[24:27], v[20:23], v[36:39], a[24:27]
    v_mfma_f32_16x16x32_bf16 a[44:47], v[24:27], v[36:39], a[44:47]
    v_mfma_f32_16x16x32_bf16 a[64:67], v[28:31], v[36:39], a[64:67]
    v_mfma_f32_16x16x32_bf16 a[8:11], v[16:19], v[40:43], a[8:11]
    v_mfma_f32_16x16x32_bf16 a[28:31], v[20:23], v[40:43], a[28:31]
    v_mfma_f32_16x16x32_bf16 a[48:51], v[24:27], v[40:43], a[48:51]
    v_mfma_f32_16x16x32_bf16 a[68:71], v[28:31], v[40:43], a[68:71]
    v_mfma_f32_16x16x32_bf16 a[12:15], v[16:19], v[44:47], a[12:15]
    v_mfma_f32_16x16x32_bf16 a[32:35], v[20:23], v[44:47], a[32:35]
    v_mfma_f32_16x16x32_bf16 a[52:55], v[24:27], v[44:47], a[52:55]
    v_mfma_f32_16x16x32_bf16 a[72:75], v[28:31], v[44:47], a[72:75]
    v_mfma_f32_16x16x32_bf16 a[16:19], v[16:19], v[48:51], a[16:19]
    v_mfma_f32_16x16x32_bf16 a[36:39], v[20:23], v[48:51], a[36:39]
    v_mfma_f32_16x16x32_bf16 a[56:59], v[24:27], v[48:51], a[56:59]
    v_mfma_f32_16x16x32_bf16 a[76:79], v[28:31], v[48:51], a[76:79]
    s_sub_u32 s28, s28, 1
    s_cmp_eq_u32 s28, 0
    s_cbranch_scc1 qkv_a_kernel_loop1_last
    s_add_u32 s25, s25, 64
    s_add_u32 s32, s32, 1024
    s_add_u32 s33, s33, 1024
    s_add_u32 s34, s34, 1024
    s_add_u32 s35, s35, 1024
    s_add_u32 s36, s36, 1024
    buffer_load_dwordx4 v[16:19], v8, s[8:11], s25 offen
    buffer_load_dwordx4 v[20:23], v9, s[8:11], s25 offen
    buffer_load_dwordx4 v[24:27], v10, s[8:11], s25 offen
    buffer_load_dwordx4 v[28:31], v11, s[8:11], s25 offen
    buffer_load_dwordx4 v[32:35], v7, s[8:11], s32 offen
    buffer_load_dwordx4 v[36:39], v7, s[8:11], s33 offen
    buffer_load_dwordx4 v[40:43], v7, s[8:11], s34 offen
    buffer_load_dwordx4 v[44:47], v7, s[8:11], s35 offen
    buffer_load_dwordx4 v[48:51], v7, s[8:11], s36 offen
    s_waitcnt vmcnt(9)
    v_mfma_f32_16x16x32_bf16 a[0:3], v[52:55], v[68:71], a[0:3]
    v_mfma_f32_16x16x32_bf16 a[20:23], v[56:59], v[68:71], a[20:23]
    v_mfma_f32_16x16x32_bf16 a[40:43], v[60:63], v[68:71], a[40:43]
    v_mfma_f32_16x16x32_bf16 a[60:63], v[64:67], v[68:71], a[60:63]
    v_mfma_f32_16x16x32_bf16 a[4:7], v[52:55], v[72:75], a[4:7]
    v_mfma_f32_16x16x32_bf16 a[24:27], v[56:59], v[72:75], a[24:27]
    v_mfma_f32_16x16x32_bf16 a[44:47], v[60:63], v[72:75], a[44:47]
    v_mfma_f32_16x16x32_bf16 a[64:67], v[64:67], v[72:75], a[64:67]
    v_mfma_f32_16x16x32_bf16 a[8:11], v[52:55], v[76:79], a[8:11]
    v_mfma_f32_16x16x32_bf16 a[28:31], v[56:59], v[76:79], a[28:31]
    v_mfma_f32_16x16x32_bf16 a[48:51], v[60:63], v[76:79], a[48:51]
    v_mfma_f32_16x16x32_bf16 a[68:71], v[64:67], v[76:79], a[68:71]
    v_mfma_f32_16x16x32_bf16 a[12:15], v[52:55], v[80:83], a[12:15]
    v_mfma_f32_16x16x32_bf16 a[32:35], v[56:59], v[80:83], a[32:35]
    v_mfma_f32_16x16x32_bf16 a[52:55], v[60:63], v[80:83], a[52:55]
    v_mfma_f32_16x16x32_bf16 a[72:75], v[64:67], v[80:83], a[72:75]
    v_mfma_f32_16x16x32_bf16 a[16:19], v[52:55], v[84:87], a[16:19]
    v_mfma_f32_16x16x32_bf16 a[36:39], v[56:59], v[84:87], a[36:39]
    v_mfma_f32_16x16x32_bf16 a[56:59], v[60:63], v[84:87], a[56:59]
    v_mfma_f32_16x16x32_bf16 a[76:79], v[64:67], v[84:87], a[76:79]
    s_branch qkv_a_kernel_loop1
qkv_a_kernel_loop1_last:
    s_waitcnt vmcnt(0)
    v_mfma_f32_16x16x32_bf16 a[0:3], v[52:55], v[68:71], a[0:3]
    v_mfma_f32_16x16x32_bf16 a[20:23], v[56:59], v[68:71], a[20:23]
    v_mfma_f32_16x16x32_bf16 a[40:43], v[60:63], v[68:71], a[40:43]
    v_mfma_f32_16x16x32_bf16 a[60:63], v[64:67], v[68:71], a[60:63]
    v_mfma_f32_16x16x32_bf16 a[4:7], v[52:55], v[72:75], a[4:7]
    v_mfma_f32_16x16x32_bf16 a[24:27], v[56:59], v[72:75], a[24:27]
    v_mfma_f32_16x16x32_bf16 a[44:47], v[60:63], v[72:75], a[44:47]
    v_mfma_f32_16x16x32_bf16 a[64:67], v[64:67], v[72:75], a[64:67]
    v_mfma_f32_16x16x32_bf16 a[8:11], v[52:55], v[76:79], a[8:11]
    v_mfma_f32_16x16x32_bf16 a[28:31], v[56:59], v[76:79], a[28:31]
    v_mfma_f32_16x16x32_bf16 a[48:51], v[60:63], v[76:79], a[48:51]
    v_mfma_f32_16x16x32_bf16 a[68:71], v[64:67], v[76:79], a[68:71]
    v_mfma_f32_16x16x32_bf16 a[12:15], v[52:55], v[80:83], a[12:15]
    v_mfma_f32_16x16x32_bf16 a[32:35], v[56:59], v[80:83], a[32:35]
    v_mfma_f32_16x16x32_bf16 a[52:55], v[60:63], v[80:83], a[52:55]
    v_mfma_f32_16x16x32_bf16 a[72:75], v[64:67], v[80:83], a[72:75]
    v_mfma_f32_16x16x32_bf16 a[16:19], v[52:55], v[84:87], a[16:19]
    v_mfma_f32_16x16x32_bf16 a[36:39], v[56:59], v[84:87], a[36:39]
    v_mfma_f32_16x16x32_bf16 a[56:59], v[60:63], v[84:87], a[56:59]
    v_mfma_f32_16x16x32_bf16 a[76:79], v[64:67], v[84:87], a[76:79]
    s_nop 7
    s_nop 7
    s_sub_u32 s29, s23, 640
    v_add_u32 v5, s29, v3
    v_lshlrev_b32 v5, 11, v5
    v_lshlrev_b32 v6, 2, v4
    v_add3_u32 v5, v5, v6, s22
    v_lshlrev_b32 v5, 1, v5
    v_add_u32 v5, 232783872, v5
    v_accvgpr_read_b32 v92, a0
    v_accvgpr_read_b32 v93, a1
    v_accvgpr_read_b32 v94, a2
    v_accvgpr_read_b32 v95, a3
    v_cvt_pk_bf16_f32 v96, v92, v93
    v_cvt_pk_bf16_f32 v97, v94, v95
    v_add_u32 v6, 0, v5
    buffer_store_dwordx2 v[96:97], v6, s[8:11], 0 offen
    v_accvgpr_read_b32 v92, a4
    v_accvgpr_read_b32 v93, a5
    v_accvgpr_read_b32 v94, a6
    v_accvgpr_read_b32 v95, a7
    v_cvt_pk_bf16_f32 v96, v92, v93
    v_cvt_pk_bf16_f32 v97, v94, v95
    v_add_u32 v6, 65536, v5
    buffer_store_dwordx2 v[96:97], v6, s[8:11], 0 offen
    v_accvgpr_read_b32 v92, a8
    v_accvgpr_read_b32 v93, a9
    v_accvgpr_read_b32 v94, a10
    v_accvgpr_read_b32 v95, a11
    v_cvt_pk_bf16_f32 v96, v92, v93
    v_cvt_pk_bf16_f32 v97, v94, v95
    v_add_u32 v6, 131072, v5
    buffer_store_dwordx2 v[96:97], v6, s[8:11], 0 offen
    v_accvgpr_read_b32 v92, a12
    v_accvgpr_read_b32 v93, a13
    v_accvgpr_read_b32 v94, a14
    v_accvgpr_read_b32 v95, a15
    v_cvt_pk_bf16_f32 v96, v92, v93
    v_cvt_pk_bf16_f32 v97, v94, v95
    v_add_u32 v6, 196608, v5
    buffer_store_dwordx2 v[96:97], v6, s[8:11], 0 offen
    v_accvgpr_read_b32 v92, a16
    v_accvgpr_read_b32 v93, a17
    v_accvgpr_read_b32 v94, a18
    v_accvgpr_read_b32 v95, a19
    v_cvt_pk_bf16_f32 v96, v92, v93
    v_cvt_pk_bf16_f32 v97, v94, v95
    v_add_u32 v6, 262144, v5
    buffer_store_dwordx2 v[96:97], v6, s[8:11], 0 offen
    v_accvgpr_read_b32 v92, a20
    v_accvgpr_read_b32 v93, a21
    v_accvgpr_read_b32 v94, a22
    v_accvgpr_read_b32 v95, a23
    v_cvt_pk_bf16_f32 v96, v92, v93
    v_cvt_pk_bf16_f32 v97, v94, v95
    v_add_u32 v6, 32, v5
    buffer_store_dwordx2 v[96:97], v6, s[8:11], 0 offen
    v_accvgpr_read_b32 v92, a24
    v_accvgpr_read_b32 v93, a25
    v_accvgpr_read_b32 v94, a26
    v_accvgpr_read_b32 v95, a27
    v_cvt_pk_bf16_f32 v96, v92, v93
    v_cvt_pk_bf16_f32 v97, v94, v95
    v_add_u32 v6, 65568, v5
    buffer_store_dwordx2 v[96:97], v6, s[8:11], 0 offen
    v_accvgpr_read_b32 v92, a28
    v_accvgpr_read_b32 v93, a29
    v_accvgpr_read_b32 v94, a30
    v_accvgpr_read_b32 v95, a31
    v_cvt_pk_bf16_f32 v96, v92, v93
    v_cvt_pk_bf16_f32 v97, v94, v95
    v_add_u32 v6, 131104, v5
    buffer_store_dwordx2 v[96:97], v6, s[8:11], 0 offen
    v_accvgpr_read_b32 v92, a32
    v_accvgpr_read_b32 v93, a33
    v_accvgpr_read_b32 v94, a34
    v_accvgpr_read_b32 v95, a35
    v_cvt_pk_bf16_f32 v96, v92, v93
    v_cvt_pk_bf16_f32 v97, v94, v95
    v_add_u32 v6, 196640, v5
    buffer_store_dwordx2 v[96:97], v6, s[8:11], 0 offen
    v_accvgpr_read_b32 v92, a36
    v_accvgpr_read_b32 v93, a37
    v_accvgpr_read_b32 v94, a38
    v_accvgpr_read_b32 v95, a39
    v_cvt_pk_bf16_f32 v96, v92, v93
    v_cvt_pk_bf16_f32 v97, v94, v95
    v_add_u32 v6, 262176, v5
    buffer_store_dwordx2 v[96:97], v6, s[8:11], 0 offen
    v_accvgpr_read_b32 v92, a40
    v_accvgpr_read_b32 v93, a41
    v_accvgpr_read_b32 v94, a42
    v_accvgpr_read_b32 v95, a43
    v_cvt_pk_bf16_f32 v96, v92, v93
    v_cvt_pk_bf16_f32 v97, v94, v95
    v_add_u32 v6, 64, v5
    buffer_store_dwordx2 v[96:97], v6, s[8:11], 0 offen
    v_accvgpr_read_b32 v92, a44
    v_accvgpr_read_b32 v93, a45
    v_accvgpr_read_b32 v94, a46
    v_accvgpr_read_b32 v95, a47
    v_cvt_pk_bf16_f32 v96, v92, v93
    v_cvt_pk_bf16_f32 v97, v94, v95
    v_add_u32 v6, 65600, v5
    buffer_store_dwordx2 v[96:97], v6, s[8:11], 0 offen
    v_accvgpr_read_b32 v92, a48
    v_accvgpr_read_b32 v93, a49
    v_accvgpr_read_b32 v94, a50
    v_accvgpr_read_b32 v95, a51
    v_cvt_pk_bf16_f32 v96, v92, v93
    v_cvt_pk_bf16_f32 v97, v94, v95
    v_add_u32 v6, 131136, v5
    buffer_store_dwordx2 v[96:97], v6, s[8:11], 0 offen
    v_accvgpr_read_b32 v92, a52
    v_accvgpr_read_b32 v93, a53
    v_accvgpr_read_b32 v94, a54
    v_accvgpr_read_b32 v95, a55
    v_cvt_pk_bf16_f32 v96, v92, v93
    v_cvt_pk_bf16_f32 v97, v94, v95
    v_add_u32 v6, 196672, v5
    buffer_store_dwordx2 v[96:97], v6, s[8:11], 0 offen
    v_accvgpr_read_b32 v92, a56
    v_accvgpr_read_b32 v93, a57
    v_accvgpr_read_b32 v94, a58
    v_accvgpr_read_b32 v95, a59
    v_cvt_pk_bf16_f32 v96, v92, v93
    v_cvt_pk_bf16_f32 v97, v94, v95
    v_add_u32 v6, 262208, v5
    buffer_store_dwordx2 v[96:97], v6, s[8:11], 0 offen
    v_accvgpr_read_b32 v92, a60
    v_accvgpr_read_b32 v93, a61
    v_accvgpr_read_b32 v94, a62
    v_accvgpr_read_b32 v95, a63
    v_cvt_pk_bf16_f32 v96, v92, v93
    v_cvt_pk_bf16_f32 v97, v94, v95
    v_add_u32 v6, 96, v5
    buffer_store_dwordx2 v[96:97], v6, s[8:11], 0 offen
    v_accvgpr_read_b32 v92, a64
    v_accvgpr_read_b32 v93, a65
    v_accvgpr_read_b32 v94, a66
    v_accvgpr_read_b32 v95, a67
    v_cvt_pk_bf16_f32 v96, v92, v93
    v_cvt_pk_bf16_f32 v97, v94, v95
    v_add_u32 v6, 65632, v5
    buffer_store_dwordx2 v[96:97], v6, s[8:11], 0 offen
    v_accvgpr_read_b32 v92, a68
    v_accvgpr_read_b32 v93, a69
    v_accvgpr_read_b32 v94, a70
    v_accvgpr_read_b32 v95, a71
    v_cvt_pk_bf16_f32 v96, v92, v93
    v_cvt_pk_bf16_f32 v97, v94, v95
    v_add_u32 v6, 131168, v5
    buffer_store_dwordx2 v[96:97], v6, s[8:11], 0 offen
    v_accvgpr_read_b32 v92, a72
    v_accvgpr_read_b32 v93, a73
    v_accvgpr_read_b32 v94, a74
    v_accvgpr_read_b32 v95, a75
    v_cvt_pk_bf16_f32 v96, v92, v93
    v_cvt_pk_bf16_f32 v97, v94, v95
    v_add_u32 v6, 196704, v5
    buffer_store_dwordx2 v[96:97], v6, s[8:11], 0 offen
    v_accvgpr_read_b32 v92, a76
    v_accvgpr_read_b32 v93, a77
    v_accvgpr_read_b32 v94, a78
    v_accvgpr_read_b32 v95, a79
    v_cvt_pk_bf16_f32 v96, v92, v93
    v_cvt_pk_bf16_f32 v97, v94, v95
    v_add_u32 v6, 262240, v5
    buffer_store_dwordx2 v[96:97], v6, s[8:11], 0 offen
qkv_a_kernel_end:
    s_endpgm
.section .rodata,"a"
.p2align 6
.amdhsa_kernel qkv_a_kernel
  .amdhsa_next_free_vgpr 192
  .amdhsa_next_free_sgpr 64
  .amdhsa_accum_offset 112
  .amdhsa_group_segment_fixed_size 0
  .amdhsa_kernarg_size 104
  .amdhsa_user_sgpr_count 2
  .amdhsa_user_sgpr_kernarg_segment_ptr 1
  .amdhsa_system_sgpr_workgroup_id_x 1
.end_amdhsa_kernel
.text
.globl kvz_a1_kernel
.p2align 8
.type kvz_a1_kernel,@function
kvz_a1_kernel:
    v_lshrrev_b32 v1, 6, v0
    v_and_b32 v2, 63, v0
    s_nop 0
    v_readfirstlane_b32 s3, v1
    s_lshl_b32 s4, s2, 2
    s_add_u32 s4, s4, s3
    s_cmp_ge_u32 s4, 512
    s_cbranch_scc1 kvz_a1_kernel_end
    s_load_dwordx2 s[6:7], s[0:1], 96
    s_waitcnt lgkmcnt(0)
    s_mov_b32 s8, s6
    s_mov_b32 s9, s7
    s_mov_b32 s10, 268435456
    s_mov_b32 s11, 0x00020000
    s_lshr_b32 s5, s4, 4
    s_and_b32 s12, s4, 15
    s_mul_i32 s13, s5, 20
    v_and_b32 v3, 15, v2
    v_lshrrev_b32 v4, 4, v2
    s_lshl_b32 s14, s12, 7
    v_lshlrev_b32 v5, 3, v4
    v_add_u32 v5, s14, v5
    v_add_u32 v6, 0, v3
    v_min_u32 v8, 19, v6
    v_add_u32 v8, s13, v8
    v_lshlrev_b32 v8, 11, v8
    v_add_u32 v8, v8, v5
    v_lshlrev_b32 v8, 1, v8
    v_add_u32 v8, 232783872, v8
    v_add_u32 v10, 2621440, v8
    v_add_u32 v7, 16, v3
    v_min_u32 v9, 19, v7
    v_add_u32 v9, s13, v9
    v_lshlrev_b32 v9, 11, v9
    v_add_u32 v9, v9, v5
    v_lshlrev_b32 v9, 1, v9
    v_add_u32 v9, 232783872, v9
    v_add_u32 v11, 2621440, v9
    v_accvgpr_write_b32 a0, 0
    v_accvgpr_write_b32 a1, 0
    v_accvgpr_write_b32 a2, 0
    v_accvgpr_write_b32 a3, 0
    v_accvgpr_write_b32 a4, 0
    v_accvgpr_write_b32 a5, 0
    v_accvgpr_write_b32 a6, 0
    v_accvgpr_write_b32 a7, 0
    v_accvgpr_write_b32 a8, 0
    v_accvgpr_write_b32 a9, 0
    v_accvgpr_write_b32 a10, 0
    v_accvgpr_write_b32 a11, 0
    v_accvgpr_write_b32 a12, 0
    v_accvgpr_write_b32 a13, 0
    v_accvgpr_write_b32 a14, 0
    v_accvgpr_write_b32 a15, 0
    v_cmp_gt_u32 s[16:17], 20, v7
    v_cmp_eq_u32 s[18:19], 20, v7
    buffer_load_dwordx4 v[16:19], v8, s[8:11], 0 offen offset:0
    buffer_load_dwordx4 v[24:27], v10, s[8:11], 0 offen offset:0
    buffer_load_dwordx4 v[20:23], v9, s[8:11], 0 offen offset:0
    buffer_load_dwordx4 v[28:31], v11, s[8:11], 0 offen offset:0
    s_waitcnt vmcnt(0)
    v_lshlrev_b32 v32, 16, v16
    v_and_b32 v33, 0xffff0000, v16
    v_mul_f32 v36, 1.4426950408889634, v32
    v_exp_f32 v36, v36
    v_add_f32 v34, 1.0, v32
    v_cmp_lt_f32 vcc, 0, v32
    s_nop 1
    v_cndmask_b32 v34, v36, v34, vcc
    v_add_f32 v34, 0x358637bd, v34
    v_mul_f32 v36, 1.4426950408889634, v33
    v_exp_f32 v36, v36
    v_add_f32 v35, 1.0, v33
    v_cmp_lt_f32 vcc, 0, v33
    s_nop 1
    v_cndmask_b32 v35, v36, v35, vcc
    v_add_f32 v35, 0x358637bd, v35
    v_cvt_pk_bf16_f32 v16, v34, v35
    v_lshlrev_b32 v32, 16, v17
    v_and_b32 v33, 0xffff0000, v17
    v_mul_f32 v36, 1.4426950408889634, v32
    v_exp_f32 v36, v36
    v_add_f32 v34, 1.0, v32
    v_cmp_lt_f32 vcc, 0, v32
    s_nop 1
    v_cndmask_b32 v34, v36, v34, vcc
    v_add_f32 v34, 0x358637bd, v34
    v_mul_f32 v36, 1.4426950408889634, v33
    v_exp_f32 v36, v36
    v_add_f32 v35, 1.0, v33
    v_cmp_lt_f32 vcc, 0, v33
    s_nop 1
    v_cndmask_b32 v35, v36, v35, vcc
    v_add_f32 v35, 0x358637bd, v35
    v_cvt_pk_bf16_f32 v17, v34, v35
    v_lshlrev_b32 v32, 16, v18
    v_and_b32 v33, 0xffff0000, v18
    v_mul_f32 v36, 1.4426950408889634, v32
    v_exp_f32 v36, v36
    v_add_f32 v34, 1.0, v32
    v_cmp_lt_f32 vcc, 0, v32
    s_nop 1
    v_cndmask_b32 v34, v36, v34, vcc
    v_add_f32 v34, 0x358637bd, v34
    v_mul_f32 v36, 1.4426950408889634, v33
    v_exp_f32 v36, v36
    v_add_f32 v35, 1.0, v33
    v_cmp_lt_f32 vcc, 0, v33
    s_nop 1
    v_cndmask_b32 v35, v36, v35, vcc
    v_add_f32 v35, 0x358637bd, v35
    v_cvt_pk_bf16_f32 v18, v34, v35
    v_lshlrev_b32 v32, 16, v19
    v_and_b32 v33, 0xffff0000, v19
    v_mul_f32 v36, 1.4426950408889634, v32
    v_exp_f32 v36, v36
    v_add_f32 v34, 1.0, v32
    v_cmp_lt_f32 vcc, 0, v32
    s_nop 1
    v_cndmask_b32 v34, v36, v34, vcc
    v_add_f32 v34, 0x358637bd, v34
    v_mul_f32 v36, 1.4426950408889634, v33
    v_exp_f32 v36, v36
    v_add_f32 v35, 1.0, v33
    v_cmp_lt_f32 vcc, 0, v33
    s_nop 1
    v_cndmask_b32 v35, v36, v35, vcc
    v_add_f32 v35, 0x358637bd, v35
    v_cvt_pk_bf16_f32 v19, v34, v35
    v_lshlrev_b32 v32, 16, v20
    v_and_b32 v33, 0xffff0000, v20
    v_mul_f32 v36, 1.4426950408889634, v32
    v_exp_f32 v36, v36
    v_add_f32 v34, 1.0, v32
    v_cmp_lt_f32 vcc, 0, v32
    s_nop 1
    v_cndmask_b32 v34, v36, v34, vcc
    v_add_f32 v34, 0x358637bd, v34
    v_mul_f32 v36, 1.4426950408889634, v33
    v_exp_f32 v36, v36
    v_add_f32 v35, 1.0, v33
    v_cmp_lt_f32 vcc, 0, v33
    s_nop 1
    v_cndmask_b32 v35, v36, v35, vcc
    v_add_f32 v35, 0x358637bd, v35
    v_cvt_pk_bf16_f32 v20, v34, v35
    v_lshlrev_b32 v32, 16, v21
    v_and_b32 v33, 0xffff0000, v21
    v_mul_f32 v36, 1.4426950408889634, v32
    v_exp_f32 v36, v36
    v_add_f32 v34, 1.0, v32
    v_cmp_lt_f32 vcc, 0, v32
    s_nop 1
    v_cndmask_b32 v34, v36, v34, vcc
    v_add_f32 v34, 0x358637bd, v34
    v_mul_f32 v36, 1.4426950408889634, v33
    v_exp_f32 v36, v36
    v_add_f32 v35, 1.0, v33
    v_cmp_lt_f32 vcc, 0, v33
    s_nop 1
    v_cndmask_b32 v35, v36, v35, vcc
    v_add_f32 v35, 0x358637bd, v35
    v_cvt_pk_bf16_f32 v21, v34, v35
    v_lshlrev_b32 v32, 16, v22
    v_and_b32 v33, 0xffff0000, v22
    v_mul_f32 v36, 1.4426950408889634, v32
    v_exp_f32 v36, v36
    v_add_f32 v34, 1.0, v32
    v_cmp_lt_f32 vcc, 0, v32
    s_nop 1
    v_cndmask_b32 v34, v36, v34, vcc
    v_add_f32 v34, 0x358637bd, v34
    v_mul_f32 v36, 1.4426950408889634, v33
    v_exp_f32 v36, v36
    v_add_f32 v35, 1.0, v33
    v_cmp_lt_f32 vcc, 0, v33
    s_nop 1
    v_cndmask_b32 v35, v36, v35, vcc
    v_add_f32 v35, 0x358637bd, v35
    v_cvt_pk_bf16_f32 v22, v34, v35
    v_lshlrev_b32 v32, 16, v23
    v_and_b32 v33, 0xffff0000, v23
    v_mul_f32 v36, 1.4426950408889634, v32
    v_exp_f32 v36, v36
    v_add_f32 v34, 1.0, v32
    v_cmp_lt_f32 vcc, 0, v32
    s_nop 1
    v_cndmask_b32 v34, v36, v34, vcc
    v_add_f32 v34, 0x358637bd, v34
    v_mul_f32 v36, 1.4426950408889634, v33
    v_exp_f32 v36, v36
    v_add_f32 v35, 1.0, v33
    v_cmp_lt_f32 vcc, 0, v33
    s_nop 1
    v_cndmask_b32 v35, v36, v35, vcc
    v_add_f32 v35, 0x358637bd, v35
    v_cvt_pk_bf16_f32 v23, v34, v35
    v_mov_b32 v37, 0x3f803f80
    v_cndmask_b32 v20, 0, v20, s[16:17]
    v_cndmask_b32 v28, 0, v28, s[16:17]
    v_cndmask_b32 v28, v28, v37, s[18:19]
    v_cndmask_b32 v21, 0, v21, s[16:17]
    v_cndmask_b32 v29, 0, v29, s[16:17]
    v_cndmask_b32 v29, v29, v37, s[18:19]
    v_cndmask_b32 v22, 0, v22, s[16:17]
    v_cndmask_b32 v30, 0, v30, s[16:17]
    v_cndmask_b32 v30, v30, v37, s[18:19]
    v_cndmask_b32 v23, 0, v23, s[16:17]
    v_cndmask_b32 v31, 0, v31, s[16:17]
    v_cndmask_b32 v31, v31, v37, s[18:19]
    s_nop 1
    v_mfma_f32_16x16x32_bf16 a[0:3], v[24:27], v[16:19], a[0:3]
    v_mfma_f32_16x16x32_bf16 a[4:7], v[24:27], v[20:23], a[4:7]
    v_mfma_f32_16x16x32_bf16 a[8:11], v[28:31], v[16:19], a[8:11]
    v_mfma_f32_16x16x32_bf16 a[12:15], v[28:31], v[20:23], a[12:15]
    buffer_load_dwordx4 v[16:19], v8, s[8:11], 0 offen offset:64
    buffer_load_dwordx4 v[24:27], v10, s[8:11], 0 offen offset:64
    buffer_load_dwordx4 v[20:23], v9, s[8:11], 0 offen offset:64
    buffer_load_dwordx4 v[28:31], v11, s[8:11], 0 offen offset:64
    s_waitcnt vmcnt(0)
    v_lshlrev_b32 v32, 16, v16
    v_and_b32 v33, 0xffff0000, v16
    v_mul_f32 v36, 1.4426950408889634, v32
    v_exp_f32 v36, v36
    v_add_f32 v34, 1.0, v32
    v_cmp_lt_f32 vcc, 0, v32
    s_nop 1
    v_cndmask_b32 v34, v36, v34, vcc
    v_add_f32 v34, 0x358637bd, v34
    v_mul_f32 v36, 1.4426950408889634, v33
    v_exp_f32 v36, v36
    v_add_f32 v35, 1.0, v33
    v_cmp_lt_f32 vcc, 0, v33
    s_nop 1
    v_cndmask_b32 v35, v36, v35, vcc
    v_add_f32 v35, 0x358637bd, v35
    v_cvt_pk_bf16_f32 v16, v34, v35
    v_lshlrev_b32 v32, 16, v17
    v_and_b32 v33, 0xffff0000, v17
    v_mul_f32 v36, 1.4426950408889634, v32
    v_exp_f32 v36, v36
    v_add_f32 v34, 1.0, v32
    v_cmp_lt_f32 vcc, 0, v32
    s_nop 1
    v_cndmask_b32 v34, v36, v34, vcc
    v_add_f32 v34, 0x358637bd, v34
    v_mul_f32 v36, 1.4426950408889634, v33
    v_exp_f32 v36, v36
    v_add_f32 v35, 1.0, v33
    v_cmp_lt_f32 vcc, 0, v33
    s_nop 1
    v_cndmask_b32 v35, v36, v35, vcc
    v_add_f32 v35, 0x358637bd, v35
    v_cvt_pk_bf16_f32 v17, v34, v35
    v_lshlrev_b32 v32, 16, v18
    v_and_b32 v33, 0xffff0000, v18
    v_mul_f32 v36, 1.4426950408889634, v32
    v_exp_f32 v36, v36
    v_add_f32 v34, 1.0, v32
    v_cmp_lt_f32 vcc, 0, v32
    s_nop 1
    v_cndmask_b32 v34, v36, v34, vcc
    v_add_f32 v34, 0x358637bd, v34
    v_mul_f32 v36, 1.4426950408889634, v33
    v_exp_f32 v36, v36
    v_add_f32 v35, 1.0, v33
    v_cmp_lt_f32 vcc, 0, v33
    s_nop 1
    v_cndmask_b32 v35, v36, v35, vcc
    v_add_f32 v35, 0x358637bd, v35
    v_cvt_pk_bf16_f32 v18, v34, v35
    v_lshlrev_b32 v32, 16, v19
    v_and_b32 v33, 0xffff0000, v19
    v_mul_f32 v36, 1.4426950408889634, v32
    v_exp_f32 v36, v36
    v_add_f32 v34, 1.0, v32
    v_cmp_lt_f32 vcc, 0, v32
    s_nop 1
    v_cndmask_b32 v34, v36, v34, vcc
    v_add_f32 v34, 0x358637bd, v34
    v_mul_f32 v36, 1.4426950408889634, v33
    v_exp_f32 v36, v36
    v_add_f32 v35, 1.0, v33
    v_cmp_lt_f32 vcc, 0, v33
    s_nop 1
    v_cndmask_b32 v35, v36, v35, vcc
    v_add_f32 v35, 0x358637bd, v35
    v_cvt_pk_bf16_f32 v19, v34, v35
    v_lshlrev_b32 v32, 16, v20
    v_and_b32 v33, 0xffff0000, v20
    v_mul_f32 v36, 1.4426950408889634, v32
    v_exp_f32 v36, v36
    v_add_f32 v34, 1.0, v32
    v_cmp_lt_f32 vcc, 0, v32
    s_nop 1
    v_cndmask_b32 v34, v36, v34, vcc
    v_add_f32 v34, 0x358637bd, v34
    v_mul_f32 v36, 1.4426950408889634, v33
    v_exp_f32 v36, v36
    v_add_f32 v35, 1.0, v33
    v_cmp_lt_f32 vcc, 0, v33
    s_nop 1
    v_cndmask_b32 v35, v36, v35, vcc
    v_add_f32 v35, 0x358637bd, v35
    v_cvt_pk_bf16_f32 v20, v34, v35
    v_lshlrev_b32 v32, 16, v21
    v_and_b32 v33, 0xffff0000, v21
    v_mul_f32 v36, 1.4426950408889634, v32
    v_exp_f32 v36, v36
    v_add_f32 v34, 1.0, v32
    v_cmp_lt_f32 vcc, 0, v32
    s_nop 1
    v_cndmask_b32 v34, v36, v34, vcc
    v_add_f32 v34, 0x358637bd, v34
    v_mul_f32 v36, 1.4426950408889634, v33
    v_exp_f32 v36, v36
    v_add_f32 v35, 1.0, v33
    v_cmp_lt_f32 vcc, 0, v33
    s_nop 1
    v_cndmask_b32 v35, v36, v35, vcc
    v_add_f32 v35, 0x358637bd, v35
    v_cvt_pk_bf16_f32 v21, v34, v35
    v_lshlrev_b32 v32, 16, v22
    v_and_b32 v33, 0xffff0000, v22
    v_mul_f32 v36, 1.4426950408889634, v32
    v_exp_f32 v36, v36
    v_add_f32 v34, 1.0, v32
    v_cmp_lt_f32 vcc, 0, v32
    s_nop 1
    v_cndmask_b32 v34, v36, v34, vcc
    v_add_f32 v34, 0x358637bd, v34
    v_mul_f32 v36, 1.4426950408889634, v33
    v_exp_f32 v36, v36
    v_add_f32 v35, 1.0, v33
    v_cmp_lt_f32 vcc, 0, v33
    s_nop 1
    v_cndmask_b32 v35, v36, v35, vcc
    v_add_f32 v35, 0x358637bd, v35
    v_cvt_pk_bf16_f32 v22, v34, v35
    v_lshlrev_b32 v32, 16, v23
    v_and_b32 v33, 0xffff0000, v23
    v_mul_f32 v36, 1.4426950408889634, v32
    v_exp_f32 v36, v36
    v_add_f32 v34, 1.0, v32
    v_cmp_lt_f32 vcc, 0, v32
    s_nop 1
    v_cndmask_b32 v34, v36, v34, vcc
    v_add_f32 v34, 0x358637bd, v34
    v_mul_f32 v36, 1.4426950408889634, v33
    v_exp_f32 v36, v36
    v_add_f32 v35, 1.0, v33
    v_cmp_lt_f32 vcc, 0, v33
    s_nop 1
    v_cndmask_b32 v35, v36, v35, vcc
    v_add_f32 v35, 0x358637bd, v35
    v_cvt_pk_bf16_f32 v23, v34, v35
    v_mov_b32 v37, 0x3f803f80
    v_cndmask_b32 v20, 0, v20, s[16:17]
    v_cndmask_b32 v28, 0, v28, s[16:17]
    v_cndmask_b32 v28, v28, v37, s[18:19]
    v_cndmask_b32 v21, 0, v21, s[16:17]
    v_cndmask_b32 v29, 0, v29, s[16:17]
    v_cndmask_b32 v29, v29, v37, s[18:19]
    v_cndmask_b32 v22, 0, v22, s[16:17]
    v_cndmask_b32 v30, 0, v30, s[16:17]
    v_cndmask_b32 v30, v30, v37, s[18:19]
    v_cndmask_b32 v23, 0, v23, s[16:17]
    v_cndmask_b32 v31, 0, v31, s[16:17]
    v_cndmask_b32 v31, v31, v37, s[18:19]
    s_nop 1
    v_mfma_f32_16x16x32_bf16 a[0:3], v[24:27], v[16:19], a[0:3]
    v_mfma_f32_16x16x32_bf16 a[4:7], v[24:27], v[20:23], a[4:7]
    v_mfma_f32_16x16x32_bf16 a[8:11], v[28:31], v[16:19], a[8:11]
    v_mfma_f32_16x16x32_bf16 a[12:15], v[28:31], v[20:23], a[12:15]
    buffer_load_dwordx4 v[16:19], v8, s[8:11], 0 offen offset:128
    buffer_load_dwordx4 v[24:27], v10, s[8:11], 0 offen offset:128
    buffer_load_dwordx4 v[20:23], v9, s[8:11], 0 offen offset:128
    buffer_load_dwordx4 v[28:31], v11, s[8:11], 0 offen offset:128
    s_waitcnt vmcnt(0)
    v_lshlrev_b32 v32, 16, v16
    v_and_b32 v33, 0xffff0000, v16
    v_mul_f32 v36, 1.4426950408889634, v32
    v_exp_f32 v36, v36
    v_add_f32 v34, 1.0, v32
    v_cmp_lt_f32 vcc, 0, v32
    s_nop 1
    v_cndmask_b32 v34, v36, v34, vcc
    v_add_f32 v34, 0x358637bd, v34
    v_mul_f32 v36, 1.4426950408889634, v33
    v_exp_f32 v36, v36
    v_add_f32 v35, 1.0, v33
    v_cmp_lt_f32 vcc, 0, v33
    s_nop 1
    v_cndmask_b32 v35, v36, v35, vcc
    v_add_f32 v35, 0x358637bd, v35
    v_cvt_pk_bf16_f32 v16, v34, v35
    v_lshlrev_b32 v32, 16, v17
    v_and_b32 v33, 0xffff0000, v17
    v_mul_f32 v36, 1.4426950408889634, v32
    v_exp_f32 v36, v36
    v_add_f32 v34, 1.0, v32
    v_cmp_lt_f32 vcc, 0, v32
    s_nop 1
    v_cndmask_b32 v34, v36, v34, vcc
    v_add_f32 v34, 0x358637bd, v34
    v_mul_f32 v36, 1.4426950408889634, v33
    v_exp_f32 v36, v36
    v_add_f32 v35, 1.0, v33
    v_cmp_lt_f32 vcc, 0, v33
    s_nop 1
    v_cndmask_b32 v35, v36, v35, vcc
    v_add_f32 v35, 0x358637bd, v35
    v_cvt_pk_bf16_f32 v17, v34, v35
    v_lshlrev_b32 v32, 16, v18
    v_and_b32 v33, 0xffff0000, v18
    v_mul_f32 v36, 1.4426950408889634, v32
    v_exp_f32 v36, v36
    v_add_f32 v34, 1.0, v32
    v_cmp_lt_f32 vcc, 0, v32
    s_nop 1
    v_cndmask_b32 v34, v36, v34, vcc
    v_add_f32 v34, 0x358637bd, v34
    v_mul_f32 v36, 1.4426950408889634, v33
    v_exp_f32 v36, v36
    v_add_f32 v35, 1.0, v33
    v_cmp_lt_f32 vcc, 0, v33
    s_nop 1
    v_cndmask_b32 v35, v36, v35, vcc
    v_add_f32 v35, 0x358637bd, v35
    v_cvt_pk_bf16_f32 v18, v34, v35
    v_lshlrev_b32 v32, 16, v19
    v_and_b32 v33, 0xffff0000, v19
    v_mul_f32 v36, 1.4426950408889634, v32
    v_exp_f32 v36, v36
    v_add_f32 v34, 1.0, v32
    v_cmp_lt_f32 vcc, 0, v32
    s_nop 1
    v_cndmask_b32 v34, v36, v34, vcc
    v_add_f32 v34, 0x358637bd, v34
    v_mul_f32 v36, 1.4426950408889634, v33
    v_exp_f32 v36, v36
    v_add_f32 v35, 1.0, v33
    v_cmp_lt_f32 vcc, 0, v33
    s_nop 1
    v_cndmask_b32 v35, v36, v35, vcc
    v_add_f32 v35, 0x358637bd, v35
    v_cvt_pk_bf16_f32 v19, v34, v35
    v_lshlrev_b32 v32, 16, v20
    v_and_b32 v33, 0xffff0000, v20
    v_mul_f32 v36, 1.4426950408889634, v32
    v_exp_f32 v36, v36
    v_add_f32 v34, 1.0, v32
    v_cmp_lt_f32 vcc, 0, v32
    s_nop 1
    v_cndmask_b32 v34, v36, v34, vcc
    v_add_f32 v34, 0x358637bd, v34
    v_mul_f32 v36, 1.4426950408889634, v33
    v_exp_f32 v36, v36
    v_add_f32 v35, 1.0, v33
    v_cmp_lt_f32 vcc, 0, v33
    s_nop 1
    v_cndmask_b32 v35, v36, v35, vcc
    v_add_f32 v35, 0x358637bd, v35
    v_cvt_pk_bf16_f32 v20, v34, v35
    v_lshlrev_b32 v32, 16, v21
    v_and_b32 v33, 0xffff0000, v21
    v_mul_f32 v36, 1.4426950408889634, v32
    v_exp_f32 v36, v36
    v_add_f32 v34, 1.0, v32
    v_cmp_lt_f32 vcc, 0, v32
    s_nop 1
    v_cndmask_b32 v34, v36, v34, vcc
    v_add_f32 v34, 0x358637bd, v34
    v_mul_f32 v36, 1.4426950408889634, v33
    v_exp_f32 v36, v36
    v_add_f32 v35, 1.0, v33
    v_cmp_lt_f32 vcc, 0, v33
    s_nop 1
    v_cndmask_b32 v35, v36, v35, vcc
    v_add_f32 v35, 0x358637bd, v35
    v_cvt_pk_bf16_f32 v21, v34, v35
    v_lshlrev_b32 v32, 16, v22
    v_and_b32 v33, 0xffff0000, v22
    v_mul_f32 v36, 1.4426950408889634, v32
    v_exp_f32 v36, v36
    v_add_f32 v34, 1.0, v32
    v_cmp_lt_f32 vcc, 0, v32
    s_nop 1
    v_cndmask_b32 v34, v36, v34, vcc
    v_add_f32 v34, 0x358637bd, v34
    v_mul_f32 v36, 1.4426950408889634, v33
    v_exp_f32 v36, v36
    v_add_f32 v35, 1.0, v33
    v_cmp_lt_f32 vcc, 0, v33
    s_nop 1
    v_cndmask_b32 v35, v36, v35, vcc
    v_add_f32 v35, 0x358637bd, v35
    v_cvt_pk_bf16_f32 v22, v34, v35
    v_lshlrev_b32 v32, 16, v23
    v_and_b32 v33, 0xffff0000, v23
    v_mul_f32 v36, 1.4426950408889634, v32
    v_exp_f32 v36, v36
    v_add_f32 v34, 1.0, v32
    v_cmp_lt_f32 vcc, 0, v32
    s_nop 1
    v_cndmask_b32 v34, v36, v34, vcc
    v_add_f32 v34, 0x358637bd, v34
    v_mul_f32 v36, 1.4426950408889634, v33
    v_exp_f32 v36, v36
    v_add_f32 v35, 1.0, v33
    v_cmp_lt_f32 vcc, 0, v33
    s_nop 1
    v_cndmask_b32 v35, v36, v35, vcc
    v_add_f32 v35, 0x358637bd, v35
    v_cvt_pk_bf16_f32 v23, v34, v35
    v_mov_b32 v37, 0x3f803f80
    v_cndmask_b32 v20, 0, v20, s[16:17]
    v_cndmask_b32 v28, 0, v28, s[16:17]
    v_cndmask_b32 v28, v28, v37, s[18:19]
    v_cndmask_b32 v21, 0, v21, s[16:17]
    v_cndmask_b32 v29, 0, v29, s[16:17]
    v_cndmask_b32 v29, v29, v37, s[18:19]
    v_cndmask_b32 v22, 0, v22, s[16:17]
    v_cndmask_b32 v30, 0, v30, s[16:17]
    v_cndmask_b32 v30, v30, v37, s[18:19]
    v_cndmask_b32 v23, 0, v23, s[16:17]
    v_cndmask_b32 v31, 0, v31, s[16:17]
    v_cndmask_b32 v31, v31, v37, s[18:19]
    s_nop 1
    v_mfma_f32_16x16x32_bf16 a[0:3], v[24:27], v[16:19], a[0:3]
    v_mfma_f32_16x16x32_bf16 a[4:7], v[24:27], v[20:23], a[4:7]
    v_mfma_f32_16x16x32_bf16 a[8:11], v[28:31], v[16:19], a[8:11]
    v_mfma_f32_16x16x32_bf16 a[12:15], v[28:31], v[20:23], a[12:15]
    buffer_load_dwordx4 v[16:19], v8, s[8:11], 0 offen offset:192
    buffer_load_dwordx4 v[24:27], v10, s[8:11], 0 offen offset:192
    buffer_load_dwordx4 v[20:23], v9, s[8:11], 0 offen offset:192
    buffer_load_dwordx4 v[28:31], v11, s[8:11], 0 offen offset:192
    s_waitcnt vmcnt(0)
    v_lshlrev_b32 v32, 16, v16
    v_and_b32 v33, 0xffff0000, v16
    v_mul_f32 v36, 1.4426950408889634, v32
    v_exp_f32 v36, v36
    v_add_f32 v34, 1.0, v32
    v_cmp_lt_f32 vcc, 0, v32
    s_nop 1
    v_cndmask_b32 v34, v36, v34, vcc
    v_add_f32 v34, 0x358637bd, v34
    v_mul_f32 v36, 1.4426950408889634, v33
    v_exp_f32 v36, v36
    v_add_f32 v35, 1.0, v33
    v_cmp_lt_f32 vcc, 0, v33
    s_nop 1
    v_cndmask_b32 v35, v36, v35, vcc
    v_add_f32 v35, 0x358637bd, v35
    v_cvt_pk_bf16_f32 v16, v34, v35
    v_lshlrev_b32 v32, 16, v17
    v_and_b32 v33, 0xffff0000, v17
    v_mul_f32 v36, 1.4426950408889634, v32
    v_exp_f32 v36, v36
    v_add_f32 v34, 1.0, v32
    v_cmp_lt_f32 vcc, 0, v32
    s_nop 1
    v_cndmask_b32 v34, v36, v34, vcc
    v_add_f32 v34, 0x358637bd, v34
    v_mul_f32 v36, 1.4426950408889634, v33
    v_exp_f32 v36, v36
    v_add_f32 v35, 1.0, v33
    v_cmp_lt_f32 vcc, 0, v33
    s_nop 1
    v_cndmask_b32 v35, v36, v35, vcc
    v_add_f32 v35, 0x358637bd, v35
    v_cvt_pk_bf16_f32 v17, v34, v35
    v_lshlrev_b32 v32, 16, v18
    v_and_b32 v33, 0xffff0000, v18
    v_mul_f32 v36, 1.4426950408889634, v32
    v_exp_f32 v36, v36
    v_add_f32 v34, 1.0, v32
    v_cmp_lt_f32 vcc, 0, v32
    s_nop 1
    v_cndmask_b32 v34, v36, v34, vcc
    v_add_f32 v34, 0x358637bd, v34
    v_mul_f32 v36, 1.4426950408889634, v33
    v_exp_f32 v36, v36
    v_add_f32 v35, 1.0, v33
    v_cmp_lt_f32 vcc, 0, v33
    s_nop 1
    v_cndmask_b32 v35, v36, v35, vcc
    v_add_f32 v35, 0x358637bd, v35
    v_cvt_pk_bf16_f32 v18, v34, v35
    v_lshlrev_b32 v32, 16, v19
    v_and_b32 v33, 0xffff0000, v19
    v_mul_f32 v36, 1.4426950408889634, v32
    v_exp_f32 v36, v36
    v_add_f32 v34, 1.0, v32
    v_cmp_lt_f32 vcc, 0, v32
    s_nop 1
    v_cndmask_b32 v34, v36, v34, vcc
    v_add_f32 v34, 0x358637bd, v34
    v_mul_f32 v36, 1.4426950408889634, v33
    v_exp_f32 v36, v36
    v_add_f32 v35, 1.0, v33
    v_cmp_lt_f32 vcc, 0, v33
    s_nop 1
    v_cndmask_b32 v35, v36, v35, vcc
    v_add_f32 v35, 0x358637bd, v35
    v_cvt_pk_bf16_f32 v19, v34, v35
    v_lshlrev_b32 v32, 16, v20
    v_and_b32 v33, 0xffff0000, v20
    v_mul_f32 v36, 1.4426950408889634, v32
    v_exp_f32 v36, v36
    v_add_f32 v34, 1.0, v32
    v_cmp_lt_f32 vcc, 0, v32
    s_nop 1
    v_cndmask_b32 v34, v36, v34, vcc
    v_add_f32 v34, 0x358637bd, v34
    v_mul_f32 v36, 1.4426950408889634, v33
    v_exp_f32 v36, v36
    v_add_f32 v35, 1.0, v33
    v_cmp_lt_f32 vcc, 0, v33
    s_nop 1
    v_cndmask_b32 v35, v36, v35, vcc
    v_add_f32 v35, 0x358637bd, v35
    v_cvt_pk_bf16_f32 v20, v34, v35
    v_lshlrev_b32 v32, 16, v21
    v_and_b32 v33, 0xffff0000, v21
    v_mul_f32 v36, 1.4426950408889634, v32
    v_exp_f32 v36, v36
    v_add_f32 v34, 1.0, v32
    v_cmp_lt_f32 vcc, 0, v32
    s_nop 1
    v_cndmask_b32 v34, v36, v34, vcc
    v_add_f32 v34, 0x358637bd, v34
    v_mul_f32 v36, 1.4426950408889634, v33
    v_exp_f32 v36, v36
    v_add_f32 v35, 1.0, v33
    v_cmp_lt_f32 vcc, 0, v33
    s_nop 1
    v_cndmask_b32 v35, v36, v35, vcc
    v_add_f32 v35, 0x358637bd, v35
    v_cvt_pk_bf16_f32 v21, v34, v35
    v_lshlrev_b32 v32, 16, v22
    v_and_b32 v33, 0xffff0000, v22
    v_mul_f32 v36, 1.4426950408889634, v32
    v_exp_f32 v36, v36
    v_add_f32 v34, 1.0, v32
    v_cmp_lt_f32 vcc, 0, v32
    s_nop 1
    v_cndmask_b32 v34, v36, v34, vcc
    v_add_f32 v34, 0x358637bd, v34
    v_mul_f32 v36, 1.4426950408889634, v33
    v_exp_f32 v36, v36
    v_add_f32 v35, 1.0, v33
    v_cmp_lt_f32 vcc, 0, v33
    s_nop 1
    v_cndmask_b32 v35, v36, v35, vcc
    v_add_f32 v35, 0x358637bd, v35
    v_cvt_pk_bf16_f32 v22, v34, v35
    v_lshlrev_b32 v32, 16, v23
    v_and_b32 v33, 0xffff0000, v23
    v_mul_f32 v36, 1.4426950408889634, v32
    v_exp_f32 v36, v36
    v_add_f32 v34, 1.0, v32
    v_cmp_lt_f32 vcc, 0, v32
    s_nop 1
    v_cndmask_b32 v34, v36, v34, vcc
    v_add_f32 v34, 0x358637bd, v34
    v_mul_f32 v36, 1.4426950408889634, v33
    v_exp_f32 v36, v36
    v_add_f32 v35, 1.0, v33
    v_cmp_lt_f32 vcc, 0, v33
    s_nop 1
    v_cndmask_b32 v35, v36, v35, vcc
    v_add_f32 v35, 0x358637bd, v35
    v_cvt_pk_bf16_f32 v23, v34, v35
    v_mov_b32 v37, 0x3f803f80
    v_cndmask_b32 v20, 0, v20, s[16:17]
    v_cndmask_b32 v28, 0, v28, s[16:17]
    v_cndmask_b32 v28, v28, v37, s[18:19]
    v_cndmask_b32 v21, 0, v21, s[16:17]
    v_cndmask_b32 v29, 0, v29, s[16:17]
    v_cndmask_b32 v29, v29, v37, s[18:19]
    v_cndmask_b32 v22, 0, v22, s[16:17]
    v_cndmask_b32 v30, 0, v30, s[16:17]
    v_cndmask_b32 v30, v30, v37, s[18:19]
    v_cndmask_b32 v23, 0, v23, s[16:17]
    v_cndmask_b32 v31, 0, v31, s[16:17]
    v_cndmask_b32 v31, v31, v37, s[18:19]
    s_nop 1
    v_mfma_f32_16x16x32_bf16 a[0:3], v[24:27], v[16:19], a[0:3]
    v_mfma_f32_16x16x32_bf16 a[4:7], v[24:27], v[20:23], a[4:7]
    v_mfma_f32_16x16x32_bf16 a[8:11], v[28:31], v[16:19], a[8:11]
    v_mfma_f32_16x16x32_bf16 a[12:15], v[28:31], v[20:23], a[12:15]
    s_nop 7
    s_nop 7
    v_lshlrev_b32 v5, 2, v4
    v_lshlrev_b32 v5, 5, v5
    v_add_u32 v5, v5, v3
    v_lshlrev_b32 v5, 2, v5
    s_lshl_b32 s14, s5, 12
    s_add_u32 s14, s14, 242221056
    v_add_u32 v5, s14, v5
    v_accvgpr_read_b32 v40, a0
    v_accvgpr_read_b32 v41, a1
    v_accvgpr_read_b32 v42, a2
    v_accvgpr_read_b32 v43, a3
    buffer_atomic_add_f32 v40, v5, s[8:11], 0 offen offset:0
    buffer_atomic_add_f32 v41, v5, s[8:11], 0 offen offset:128
    buffer_atomic_add_f32 v42, v5, s[8:11], 0 offen offset:256
    buffer_atomic_add_f32 v43, v5, s[8:11], 0 offen offset:384
    v_accvgpr_read_b32 v40, a4
    v_accvgpr_read_b32 v41, a5
    v_accvgpr_read_b32 v42, a6
    v_accvgpr_read_b32 v43, a7
    buffer_atomic_add_f32 v40, v5, s[8:11], 0 offen offset:64
    buffer_atomic_add_f32 v41, v5, s[8:11], 0 offen offset:192
    buffer_atomic_add_f32 v42, v5, s[8:11], 0 offen offset:320
    buffer_atomic_add_f32 v43, v5, s[8:11], 0 offen offset:448
    v_accvgpr_read_b32 v40, a8
    v_accvgpr_read_b32 v41, a9
    v_accvgpr_read_b32 v42, a10
    v_accvgpr_read_b32 v43, a11
    buffer_atomic_add_f32 v40, v5, s[8:11], 0 offen offset:2048
    buffer_atomic_add_f32 v41, v5, s[8:11], 0 offen offset:2176
    buffer_atomic_add_f32 v42, v5, s[8:11], 0 offen offset:2304
    buffer_atomic_add_f32 v43, v5, s[8:11], 0 offen offset:2432
    v_accvgpr_read_b32 v40, a12
    v_accvgpr_read_b32 v41, a13
    v_accvgpr_read_b32 v42, a14
    v_accvgpr_read_b32 v43, a15
    buffer_atomic_add_f32 v40, v5, s[8:11], 0 offen offset:2112
    buffer_atomic_add_f32 v41, v5, s[8:11], 0 offen offset:2240
    buffer_atomic_add_f32 v42, v5, s[8:11], 0 offen offset:2368
    buffer_atomic_add_f32 v43, v5, s[8:11], 0 offen offset:2496
kvz_a1_kernel_end:
    s_endpgm
.section .rodata,"a"
.p2align 6
.amdhsa_kernel kvz_a1_kernel
  .amdhsa_next_free_vgpr 80
  .amdhsa_next_free_sgpr 40
  .amdhsa_accum_offset 64
  .amdhsa_group_segment_fixed_size 0
  .amdhsa_kernarg_size 104
  .amdhsa_user_sgpr_count 2
  .amdhsa_user_sgpr_kernarg_segment_ptr 1
  .amdhsa_system_sgpr_workgroup_id_x 1
.end_amdhsa_kernel
.text
.globl attn_a1_kernel
.p2align 8
.type attn_a1_kernel,@function
attn_a1_kernel:
    s_cmp_ge_u32 s2, 256
    s_cbranch_scc1 attn_a1_kernel_end
    s_load_dwordx2 s[6:7], s[0:1], 96
    s_waitcnt lgkmcnt(0)
    s_mov_b32 s8, s6
    s_mov_b32 s9, s7
    s_mov_b32 s10, 268435456
    s_mov_b32 s11, 0x00020000
    v_mov_b32 v1, v0
    v_add_u32 v2, 0, v1
    s_mov_b32 s12, 3121
    v_mul_lo_u32 v3, v2, s12
    v_lshrrev_b32 v3, 19, v3
    v_mul_u32_u24 v4, 168, v3
    v_sub_u32 v4, v2, v4
    v_lshlrev_b32 v5, 12, v3
    v_lshlrev_b32 v6, 4, v4
    v_add_u32 v5, v5, v6
    v_add_u32 v5, 242221056, v5
    buffer_load_dwordx4 v[8:11], v5, s[8:11], 0 offen
    v_mul_u32_u24 v7, 2688, v3
    v_add_u32 v7, v7, v6
    s_waitcnt vmcnt(0)
    ds_write_b128 v7, v[8:11]
    v_add_u32 v2, 256, v1
    s_mov_b32 s12, 3121
    v_mul_lo_u32 v3, v2, s12
    v_lshrrev_b32 v3, 19, v3
    v_mul_u32_u24 v4, 168, v3
    v_sub_u32 v4, v2, v4
    v_lshlrev_b32 v5, 12, v3
    v_lshlrev_b32 v6, 4, v4
    v_add_u32 v5, v5, v6
    v_add_u32 v5, 242221056, v5
    buffer_load_dwordx4 v[8:11], v5, s[8:11], 0 offen
    v_mul_u32_u24 v7, 2688, v3
    v_add_u32 v7, v7, v6
    s_waitcnt vmcnt(0)
    ds_write_b128 v7, v[8:11]
    v_add_u32 v2, 512, v1
    s_mov_b32 s12, 3121
    v_mul_lo_u32 v3, v2, s12
    v_lshrrev_b32 v3, 19, v3
    v_mul_u32_u24 v4, 168, v3
    v_sub_u32 v4, v2, v4
    v_lshlrev_b32 v5, 12, v3
    v_lshlrev_b32 v6, 4, v4
    v_add_u32 v5, v5, v6
    v_add_u32 v5, 242221056, v5
    buffer_load_dwordx4 v[8:11], v5, s[8:11], 0 offen
    v_mul_u32_u24 v7, 2688, v3
    v_add_u32 v7, v7, v6
    s_waitcnt vmcnt(0)
    ds_write_b128 v7, v[8:11]
    v_add_u32 v2, 768, v1
    s_mov_b32 s12, 3121
    v_mul_lo_u32 v3, v2, s12
    v_lshrrev_b32 v3, 19, v3
    v_mul_u32_u24 v4, 168, v3
    v_sub_u32 v4, v2, v4
    v_lshlrev_b32 v5, 12, v3
    v_lshlrev_b32 v6, 4, v4
    v_add_u32 v5, v5, v6
    v_add_u32 v5, 242221056, v5
    buffer_load_dwordx4 v[8:11], v5, s[8:11], 0 offen
    v_mul_u32_u24 v7, 2688, v3
    v_add_u32 v7, v7, v6
    s_waitcnt vmcnt(0)
    ds_write_b128 v7, v[8:11]
    v_add_u32 v2, 1024, v1
    s_mov_b32 s12, 3121
    v_mul_lo_u32 v3, v2, s12
    v_lshrrev_b32 v3, 19, v3
    v_mul_u32_u24 v4, 168, v3
    v_sub_u32 v4, v2, v4
    v_lshlrev_b32 v5, 12, v3
    v_lshlrev_b32 v6, 4, v4
    v_add_u32 v5, v5, v6
    v_add_u32 v5, 242221056, v5
    buffer_load_dwordx4 v[8:11], v5, s[8:11], 0 offen
    v_mul_u32_u24 v7, 2688, v3
    v_add_u32 v7, v7, v6
    s_waitcnt vmcnt(0)
    ds_write_b128 v7, v[8:11]
    v_add_u32 v2, 1280, v1
    s_mov_b32 s12, 3121
    v_mul_lo_u32 v3, v2, s12
    v_lshrrev_b32 v3, 19, v3
    v_mul_u32_u24 v4, 168, v3
    v_sub_u32 v4, v2, v4
    v_lshlrev_b32 v5, 12, v3
    v_lshlrev_b32 v6, 4, v4
    v_add_u32 v5, v5, v6
    v_add_u32 v5, 242221056, v5
    buffer_load_dwordx4 v[8:11], v5, s[8:11], 0 offen
    v_mul_u32_u24 v7, 2688, v3
    v_add_u32 v7, v7, v6
    s_waitcnt vmcnt(0)
    ds_write_b128 v7, v[8:11]
    v_add_u32 v2, 1536, v1
    s_mov_b32 s12, 3121
    v_mul_lo_u32 v3, v2, s12
    v_lshrrev_b32 v3, 19, v3
    v_mul_u32_u24 v4, 168, v3
    v_sub_u32 v4, v2, v4
    v_lshlrev_b32 v5, 12, v3
    v_lshlrev_b32 v6, 4, v4
    v_add_u32 v5, v5, v6
    v_add_u32 v5, 242221056, v5
    buffer_load_dwordx4 v[8:11], v5, s[8:11], 0 offen
    v_mul_u32_u24 v7, 2688, v3
    v_add_u32 v7, v7, v6
    s_waitcnt vmcnt(0)
    ds_write_b128 v7, v[8:11]
    v_add_u32 v2, 1792, v1
    s_mov_b32 s12, 3121
    v_mul_lo_u32 v3, v2, s12
    v_lshrrev_b32 v3, 19, v3
    v_mul_u32_u24 v4, 168, v3
    v_sub_u32 v4, v2, v4
    v_lshlrev_b32 v5, 12, v3
    v_lshlrev_b32 v6, 4, v4
    v_add_u32 v5, v5, v6
    v_add_u32 v5, 242221056, v5
    buffer_load_dwordx4 v[8:11], v5, s[8:11], 0 offen
    v_mul_u32_u24 v7, 2688, v3
    v_add_u32 v7, v7, v6
    s_waitcnt vmcnt(0)
    ds_write_b128 v7, v[8:11]
    v_add_u32 v2, 2048, v1
    s_mov_b32 s12, 3121
    v_mul_lo_u32 v3, v2, s12
    v_lshrrev_b32 v3, 19, v3
    v_mul_u32_u24 v4, 168, v3
    v_sub_u32 v4, v2, v4
    v_lshlrev_b32 v5, 12, v3
    v_lshlrev_b32 v6, 4, v4
    v_add_u32 v5, v5, v6
    v_add_u32 v5, 242221056, v5
    buffer_load_dwordx4 v[8:11], v5, s[8:11], 0 offen
    v_mul_u32_u24 v7, 2688, v3
    v_add_u32 v7, v7, v6
    s_waitcnt vmcnt(0)
    ds_write_b128 v7, v[8:11]
    v_add_u32 v2, 2304, v1
    s_mov_b32 s12, 3121
    v_mul_lo_u32 v3, v2, s12
    v_lshrrev_b32 v3, 19, v3
    v_mul_u32_u24 v4, 168, v3
    v_sub_u32 v4, v2, v4
    v_lshlrev_b32 v5, 12, v3
    v_lshlrev_b32 v6, 4, v4
    v_add_u32 v5, v5, v6
    v_add_u32 v5, 242221056, v5
    buffer_load_dwordx4 v[8:11], v5, s[8:11], 0 offen
    v_mul_u32_u24 v7, 2688, v3
    v_add_u32 v7, v7, v6
    s_waitcnt vmcnt(0)
    ds_write_b128 v7, v[8:11]
    v_add_u32 v2, 2560, v1
    s_mov_b32 s12, 3121
    v_mul_lo_u32 v3, v2, s12
    v_lshrrev_b32 v3, 19, v3
    v_mul_u32_u24 v4, 168, v3
    v_sub_u32 v4, v2, v4
    v_lshlrev_b32 v5, 12, v3
    v_lshlrev_b32 v6, 4, v4
    v_add_u32 v5, v5, v6
    v_add_u32 v5, 242221056, v5
    buffer_load_dwordx4 v[8:11], v5, s[8:11], 0 offen
    v_mul_u32_u24 v7, 2688, v3
    v_add_u32 v7, v7, v6
    s_waitcnt vmcnt(0)
    ds_write_b128 v7, v[8:11]
    v_add_u32 v2, 2816, v1
    s_mov_b32 s12, 3121
    v_mul_lo_u32 v3, v2, s12
    v_lshrrev_b32 v3, 19, v3
    v_mul_u32_u24 v4, 168, v3
    v_sub_u32 v4, v2, v4
    v_lshlrev_b32 v5, 12, v3
    v_lshlrev_b32 v6, 4, v4
    v_add_u32 v5, v5, v6
    v_add_u32 v5, 242221056, v5
    buffer_load_dwordx4 v[8:11], v5, s[8:11], 0 offen
    v_mul_u32_u24 v7, 2688, v3
    v_add_u32 v7, v7, v6
    s_waitcnt vmcnt(0)
    ds_write_b128 v7, v[8:11]
    v_add_u32 v2, 3072, v1
    s_mov_b32 s12, 3121
    v_mul_lo_u32 v3, v2, s12
    v_lshrrev_b32 v3, 19, v3
    v_mul_u32_u24 v4, 168, v3
    v_sub_u32 v4, v2, v4
    v_lshlrev_b32 v5, 12, v3
    v_lshlrev_b32 v6, 4, v4
    v_add_u32 v5, v5, v6
    v_add_u32 v5, 242221056, v5
    buffer_load_dwordx4 v[8:11], v5, s[8:11], 0 offen
    v_mul_u32_u24 v7, 2688, v3
    v_add_u32 v7, v7, v6
    s_waitcnt vmcnt(0)
    ds_write_b128 v7, v[8:11]
    v_add_u32 v2, 3328, v1
    s_mov_b32 s12, 3121
    v_mul_lo_u32 v3, v2, s12
    v_lshrrev_b32 v3, 19, v3
    v_mul_u32_u24 v4, 168, v3
    v_sub_u32 v4, v2, v4
    v_lshlrev_b32 v5, 12, v3
    v_lshlrev_b32 v6, 4, v4
    v_add_u32 v5, v5, v6
    v_add_u32 v5, 242221056, v5
    buffer_load_dwordx4 v[8:11], v5, s[8:11], 0 offen
    v_mul_u32_u24 v7, 2688, v3
    v_add_u32 v7, v7, v6
    s_waitcnt vmcnt(0)
    ds_write_b128 v7, v[8:11]
    v_add_u32 v2, 3584, v1
    s_mov_b32 s12, 3121
    v_mul_lo_u32 v3, v2, s12
    v_lshrrev_b32 v3, 19, v3
    v_mul_u32_u24 v4, 168, v3
    v_sub_u32 v4, v2, v4
    v_lshlrev_b32 v5, 12, v3
    v_lshlrev_b32 v6, 4, v4
    v_add_u32 v5, v5, v6
    v_add_u32 v5, 242221056, v5
    buffer_load_dwordx4 v[8:11], v5, s[8:11], 0 offen
    v_mul_u32_u24 v7, 2688, v3
    v_add_u32 v7, v7, v6
    s_waitcnt vmcnt(0)
    ds_write_b128 v7, v[8:11]
    v_add_u32 v2, 3840, v1
    s_mov_b32 s12, 3121
    v_mul_lo_u32 v3, v2, s12
    v_lshrrev_b32 v3, 19, v3
    v_mul_u32_u24 v4, 168, v3
    v_sub_u32 v4, v2, v4
    v_lshlrev_b32 v5, 12, v3
    v_lshlrev_b32 v6, 4, v4
    v_add_u32 v5, v5, v6
    v_add_u32 v5, 242221056, v5
    buffer_load_dwordx4 v[8:11], v5, s[8:11], 0 offen
    v_mul_u32_u24 v7, 2688, v3
    v_add_u32 v7, v7, v6
    s_waitcnt vmcnt(0)
    ds_write_b128 v7, v[8:11]
    v_add_u32 v2, 4096, v1
    s_mov_b32 s12, 3121
    v_mul_lo_u32 v3, v2, s12
    v_lshrrev_b32 v3, 19, v3
    v_mul_u32_u24 v4, 168, v3
    v_sub_u32 v4, v2, v4
    v_lshlrev_b32 v5, 12, v3
    v_lshlrev_b32 v6, 4, v4
    v_add_u32 v5, v5, v6
    v_add_u32 v5, 242221056, v5
    buffer_load_dwordx4 v[8:11], v5, s[8:11], 0 offen
    v_mul_u32_u24 v7, 2688, v3
    v_add_u32 v7, v7, v6
    s_waitcnt vmcnt(0)
    ds_write_b128 v7, v[8:11]
    v_add_u32 v2, 4352, v1
    s_mov_b32 s12, 3121
    v_mul_lo_u32 v3, v2, s12
    v_lshrrev_b32 v3, 19, v3
    v_mul_u32_u24 v4, 168, v3
    v_sub_u32 v4, v2, v4
    v_lshlrev_b32 v5, 12, v3
    v_lshlrev_b32 v6, 4, v4
    v_add_u32 v5, v5, v6
    v_add_u32 v5, 242221056, v5
    buffer_load_dwordx4 v[8:11], v5, s[8:11], 0 offen
    v_mul_u32_u24 v7, 2688, v3
    v_add_u32 v7, v7, v6
    s_waitcnt vmcnt(0)
    ds_write_b128 v7, v[8:11]
    v_add_u32 v2, 4608, v1
    s_mov_b32 s12, 3121
    v_mul_lo_u32 v3, v2, s12
    v_lshrrev_b32 v3, 19, v3
    v_mul_u32_u24 v4, 168, v3
    v_sub_u32 v4, v2, v4
    v_lshlrev_b32 v5, 12, v3
    v_lshlrev_b32 v6, 4, v4
    v_add_u32 v5, v5, v6
    v_add_u32 v5, 242221056, v5
    buffer_load_dwordx4 v[8:11], v5, s[8:11], 0 offen
    v_mul_u32_u24 v7, 2688, v3
    v_add_u32 v7, v7, v6
    s_waitcnt vmcnt(0)
    ds_write_b128 v7, v[8:11]
    v_add_u32 v2, 4864, v1
    s_mov_b32 s12, 3121
    v_mul_lo_u32 v3, v2, s12
    v_lshrrev_b32 v3, 19, v3
    v_mul_u32_u24 v4, 168, v3
    v_sub_u32 v4, v2, v4
    v_lshlrev_b32 v5, 12, v3
    v_lshlrev_b32 v6, 4, v4
    v_add_u32 v5, v5, v6
    v_add_u32 v5, 242221056, v5
    buffer_load_dwordx4 v[8:11], v5, s[8:11], 0 offen
    v_mul_u32_u24 v7, 2688, v3
    v_add_u32 v7, v7, v6
    s_waitcnt vmcnt(0)
    ds_write_b128 v7, v[8:11]
    v_add_u32 v2, 5120, v1
    s_mov_b32 s12, 3121
    v_mul_lo_u32 v3, v2, s12
    v_lshrrev_b32 v3, 19, v3
    v_mul_u32_u24 v4, 168, v3
    v_sub_u32 v4, v2, v4
    v_lshlrev_b32 v5, 12, v3
    v_lshlrev_b32 v6, 4, v4
    v_add_u32 v5, v5, v6
    v_add_u32 v5, 242221056, v5
    buffer_load_dwordx4 v[8:11], v5, s[8:11], 0 offen
    v_mul_u32_u24 v7, 2688, v3
    v_add_u32 v7, v7, v6
    s_waitcnt vmcnt(0)
    ds_write_b128 v7, v[8:11]
    s_waitcnt lgkmcnt(0)
    s_barrier
    v_and_b32 v2, 31, v0
    v_lshrrev_b32 v3, 5, v0
    s_lshl_b32 s12, s2, 3
    v_add_u32 v3, s12, v3
    v_mul_u32_u24 v4, 1280, v3
    v_mul_u32_u24 v5, 40, v2
    v_add_u32 v4, v4, v5
    v_add_u32 v6, 229638144, v4
    buffer_load_dwordx2 v[8:9], v6, s[8:11], 0 offen offset:0
    buffer_load_dwordx2 v[10:11], v6, s[8:11], 0 offen offset:8
    buffer_load_dwordx2 v[12:13], v6, s[8:11], 0 offen offset:16
    buffer_load_dwordx2 v[14:15], v6, s[8:11], 0 offen offset:24
    buffer_load_dwordx2 v[16:17], v6, s[8:11], 0 offen offset:32
    s_waitcnt vmcnt(0)
    v_lshlrev_b32 v40, 16, v8
    v_and_b32 v41, 0xffff0000, v8
    v_mul_f32 v44, 1.4426950408889634, v40
    v_exp_f32 v44, v44
    v_add_f32 v42, 1.0, v40
    v_cmp_lt_f32 vcc, 0, v40
    s_nop 1
    v_cndmask_b32 v42, v44, v42, vcc
    v_add_f32 v42, 0x358637bd, v42
    v_mul_f32 v44, 1.4426950408889634, v41
    v_exp_f32 v44, v44
    v_add_f32 v43, 1.0, v41
    v_cmp_lt_f32 vcc, 0, v41
    s_nop 1
    v_cndmask_b32 v43, v44, v43, vcc
    v_add_f32 v43, 0x358637bd, v43
    v_cvt_pk_bf16_f32 v45, v42, v43
    v_lshlrev_b32 v20, 16, v45
    v_and_b32 v21, 0xffff0000, v45
    v_lshlrev_b32 v40, 16, v9
    v_and_b32 v41, 0xffff0000, v9
    v_mul_f32 v44, 1.4426950408889634, v40
    v_exp_f32 v44, v44
    v_add_f32 v42, 1.0, v40
    v_cmp_lt_f32 vcc, 0, v40
    s_nop 1
    v_cndmask_b32 v42, v44, v42, vcc
    v_add_f32 v42, 0x358637bd, v42
    v_mul_f32 v44, 1.4426950408889634, v41
    v_exp_f32 v44, v44
    v_add_f32 v43, 1.0, v41
    v_cmp_lt_f32 vcc, 0, v41
    s_nop 1
    v_cndmask_b32 v43, v44, v43, vcc
    v_add_f32 v43, 0x358637bd, v43
    v_cvt_pk_bf16_f32 v45, v42, v43
    v_lshlrev_b32 v22, 16, v45
    v_and_b32 v23, 0xffff0000, v45
    v_lshlrev_b32 v40, 16, v10
    v_and_b32 v41, 0xffff0000, v10
    v_mul_f32 v44, 1.4426950408889634, v40
    v_exp_f32 v44, v44
    v_add_f32 v42, 1.0, v40
    v_cmp_lt_f32 vcc, 0, v40
    s_nop 1
    v_cndmask_b32 v42, v44, v42, vcc
    v_add_f32 v42, 0x358637bd, v42
    v_mul_f32 v44, 1.4426950408889634, v41
    v_exp_f32 v44, v44
    v_add_f32 v43, 1.0, v41
    v_cmp_lt_f32 vcc, 0, v41
    s_nop 1
    v_cndmask_b32 v43, v44, v43, vcc
    v_add_f32 v43, 0x358637bd, v43
    v_cvt_pk_bf16_f32 v45, v42, v43
    v_lshlrev_b32 v24, 16, v45
    v_and_b32 v25, 0xffff0000, v45
    v_lshlrev_b32 v40, 16, v11
    v_and_b32 v41, 0xffff0000, v11
    v_mul_f32 v44, 1.4426950408889634, v40
    v_exp_f32 v44, v44
    v_add_f32 v42, 1.0, v40
    v_cmp_lt_f32 vcc, 0, v40
    s_nop 1
    v_cndmask_b32 v42, v44, v42, vcc
    v_add_f32 v42, 0x358637bd, v42
    v_mul_f32 v44, 1.4426950408889634, v41
    v_exp_f32 v44, v44
    v_add_f32 v43, 1.0, v41
    v_cmp_lt_f32 vcc, 0, v41
    s_nop 1
    v_cndmask_b32 v43, v44, v43, vcc
    v_add_f32 v43, 0x358637bd, v43
    v_cvt_pk_bf16_f32 v45, v42, v43
    v_lshlrev_b32 v26, 16, v45
    v_and_b32 v27, 0xffff0000, v45
    v_lshlrev_b32 v40, 16, v12
    v_and_b32 v41, 0xffff0000, v12
    v_mul_f32 v44, 1.4426950408889634, v40
    v_exp_f32 v44, v44
    v_add_f32 v42, 1.0, v40
    v_cmp_lt_f32 vcc, 0, v40
    s_nop 1
    v_cndmask_b32 v42, v44, v42, vcc
    v_add_f32 v42, 0x358637bd, v42
    v_mul_f32 v44, 1.4426950408889634, v41
    v_exp_f32 v44, v44
    v_add_f32 v43, 1.0, v41
    v_cmp_lt_f32 vcc, 0, v41
    s_nop 1
    v_cndmask_b32 v43, v44, v43, vcc
    v_add_f32 v43, 0x358637bd, v43
    v_cvt_pk_bf16_f32 v45, v42, v43
    v_lshlrev_b32 v28, 16, v45
    v_and_b32 v29, 0xffff0000, v45
    v_lshlrev_b32 v40, 16, v13
    v_and_b32 v41, 0xffff0000, v13
    v_mul_f32 v44, 1.4426950408889634, v40
    v_exp_f32 v44, v44
    v_add_f32 v42, 1.0, v40
    v_cmp_lt_f32 vcc, 0, v40
    s_nop 1
    v_cndmask_b32 v42, v44, v42, vcc
    v_add_f32 v42, 0x358637bd, v42
    v_mul_f32 v44, 1.4426950408889634, v41
    v_exp_f32 v44, v44
    v_add_f32 v43, 1.0, v41
    v_cmp_lt_f32 vcc, 0, v41
    s_nop 1
    v_cndmask_b32 v43, v44, v43, vcc
    v_add_f32 v43, 0x358637bd, v43
    v_cvt_pk_bf16_f32 v45, v42, v43
    v_lshlrev_b32 v30, 16, v45
    v_and_b32 v31, 0xffff0000, v45
    v_lshlrev_b32 v40, 16, v14
    v_and_b32 v41, 0xffff0000, v14
    v_mul_f32 v44, 1.4426950408889634, v40
    v_exp_f32 v44, v44
    v_add_f32 v42, 1.0, v40
    v_cmp_lt_f32 vcc, 0, v40
    s_nop 1
    v_cndmask_b32 v42, v44, v42, vcc
    v_add_f32 v42, 0x358637bd, v42
    v_mul_f32 v44, 1.4426950408889634, v41
    v_exp_f32 v44, v44
    v_add_f32 v43, 1.0, v41
    v_cmp_lt_f32 vcc, 0, v41
    s_nop 1
    v_cndmask_b32 v43, v44, v43, vcc
    v_add_f32 v43, 0x358637bd, v43
    v_cvt_pk_bf16_f32 v45, v42, v43
    v_lshlrev_b32 v32, 16, v45
    v_and_b32 v33, 0xffff0000, v45
    v_lshlrev_b32 v40, 16, v15
    v_and_b32 v41, 0xffff0000, v15
    v_mul_f32 v44, 1.4426950408889634, v40
    v_exp_f32 v44, v44
    v_add_f32 v42, 1.0, v40
    v_cmp_lt_f32 vcc, 0, v40
    s_nop 1
    v_cndmask_b32 v42, v44, v42, vcc
    v_add_f32 v42, 0x358637bd, v42
    v_mul_f32 v44, 1.4426950408889634, v41
    v_exp_f32 v44, v44
    v_add_f32 v43, 1.0, v41
    v_cmp_lt_f32 vcc, 0, v41
    s_nop 1
    v_cndmask_b32 v43, v44, v43, vcc
    v_add_f32 v43, 0x358637bd, v43
    v_cvt_pk_bf16_f32 v45, v42, v43
    v_lshlrev_b32 v34, 16, v45
    v_and_b32 v35, 0xffff0000, v45
    v_lshlrev_b32 v40, 16, v16
    v_and_b32 v41, 0xffff0000, v16
    v_mul_f32 v44, 1.4426950408889634, v40
    v_exp_f32 v44, v44
    v_add_f32 v42, 1.0, v40
    v_cmp_lt_f32 vcc, 0, v40
    s_nop 1
    v_cndmask_b32 v42, v44, v42, vcc
    v_add_f32 v42, 0x358637bd, v42
    v_mul_f32 v44, 1.4426950408889634, v41
    v_exp_f32 v44, v44
    v_add_f32 v43, 1.0, v41
    v_cmp_lt_f32 vcc, 0, v41
    s_nop 1
    v_cndmask_b32 v43, v44, v43, vcc
    v_add_f32 v43, 0x358637bd, v43
    v_cvt_pk_bf16_f32 v45, v42, v43
    v_lshlrev_b32 v36, 16, v45
    v_and_b32 v37, 0xffff0000, v45
    v_lshlrev_b32 v40, 16, v17
    v_and_b32 v41, 0xffff0000, v17
    v_mul_f32 v44, 1.4426950408889634, v40
    v_exp_f32 v44, v44
    v_add_f32 v42, 1.0, v40
    v_cmp_lt_f32 vcc, 0, v40
    s_nop 1
    v_cndmask_b32 v42, v44, v42, vcc
    v_add_f32 v42, 0x358637bd, v42
    v_mul_f32 v44, 1.4426950408889634, v41
    v_exp_f32 v44, v44
    v_add_f32 v43, 1.0, v41
    v_cmp_lt_f32 vcc, 0, v41
    s_nop 1
    v_cndmask_b32 v43, v44, v43, vcc
    v_add_f32 v43, 0x358637bd, v43
    v_cvt_pk_bf16_f32 v45, v42, v43
    v_lshlrev_b32 v38, 16, v45
    v_and_b32 v39, 0xffff0000, v45
    v_mul_u32_u24 v7, 2688, v2
    ds_read_b128 v[72:75], v7 offset:0
    ds_read_b128 v[76:79], v7 offset:16
    ds_read_b128 v[80:83], v7 offset:32
    ds_read_b128 v[84:87], v7 offset:48
    ds_read_b128 v[88:91], v7 offset:64
    s_waitcnt lgkmcnt(0)
    v_mul_f32 v50, v20, v72
    v_fmac_f32 v50, v21, v73
    v_fmac_f32 v50, v22, v74
    v_fmac_f32 v50, v23, v75
    v_fmac_f32 v50, v24, v76
    v_fmac_f32 v50, v25, v77
    v_fmac_f32 v50, v26, v78
    v_fmac_f32 v50, v27, v79
    v_fmac_f32 v50, v28, v80
    v_fmac_f32 v50, v29, v81
    v_fmac_f32 v50, v30, v82
    v_fmac_f32 v50, v31, v83
    v_fmac_f32 v50, v32, v84
    v_fmac_f32 v50, v33, v85
    v_fmac_f32 v50, v34, v86
    v_fmac_f32 v50, v35, v87
    v_fmac_f32 v50, v36, v88
    v_fmac_f32 v50, v37, v89
    v_fmac_f32 v50, v38, v90
    v_fmac_f32 v50, v39, v91
    ds_read_b128 v[72:75], v7 offset:128
    ds_read_b128 v[76:79], v7 offset:144
    ds_read_b128 v[80:83], v7 offset:160
    ds_read_b128 v[84:87], v7 offset:176
    ds_read_b128 v[88:91], v7 offset:192
    s_waitcnt lgkmcnt(0)
    v_mul_f32 v51, v20, v72
    v_fmac_f32 v51, v21, v73
    v_fmac_f32 v51, v22, v74
    v_fmac_f32 v51, v23, v75
    v_fmac_f32 v51, v24, v76
    v_fmac_f32 v51, v25, v77
    v_fmac_f32 v51, v26, v78
    v_fmac_f32 v51, v27, v79
    v_fmac_f32 v51, v28, v80
    v_fmac_f32 v51, v29, v81
    v_fmac_f32 v51, v30, v82
    v_fmac_f32 v51, v31, v83
    v_fmac_f32 v51, v32, v84
    v_fmac_f32 v51, v33, v85
    v_fmac_f32 v51, v34, v86
    v_fmac_f32 v51, v35, v87
    v_fmac_f32 v51, v36, v88
    v_fmac_f32 v51, v37, v89
    v_fmac_f32 v51, v38, v90
    v_fmac_f32 v51, v39, v91
    ds_read_b128 v[72:75], v7 offset:256
    ds_read_b128 v[76:79], v7 offset:272
    ds_read_b128 v[80:83], v7 offset:288
    ds_read_b128 v[84:87], v7 offset:304
    ds_read_b128 v[88:91], v7 offset:320
    s_waitcnt lgkmcnt(0)
    v_mul_f32 v52, v20, v72
    v_fmac_f32 v52, v21, v73
    v_fmac_f32 v52, v22, v74
    v_fmac_f32 v52, v23, v75
    v_fmac_f32 v52, v24, v76
    v_fmac_f32 v52, v25, v77
    v_fmac_f32 v52, v26, v78
    v_fmac_f32 v52, v27, v79
    v_fmac_f32 v52, v28, v80
    v_fmac_f32 v52, v29, v81
    v_fmac_f32 v52, v30, v82
    v_fmac_f32 v52, v31, v83
    v_fmac_f32 v52, v32, v84
    v_fmac_f32 v52, v33, v85
    v_fmac_f32 v52, v34, v86
    v_fmac_f32 v52, v35, v87
    v_fmac_f32 v52, v36, v88
    v_fmac_f32 v52, v37, v89
    v_fmac_f32 v52, v38, v90
    v_fmac_f32 v52, v39, v91
    ds_read_b128 v[72:75], v7 offset:384
    ds_read_b128 v[76:79], v7 offset:400
    ds_read_b128 v[80:83], v7 offset:416
    ds_read_b128 v[84:87], v7 offset:432
    ds_read_b128 v[88:91], v7 offset:448
    s_waitcnt lgkmcnt(0)
    v_mul_f32 v53, v20, v72
    v_fmac_f32 v53, v21, v73
    v_fmac_f32 v53, v22, v74
    v_fmac_f32 v53, v23, v75
    v_fmac_f32 v53, v24, v76
    v_fmac_f32 v53, v25, v77
    v_fmac_f32 v53, v26, v78
    v_fmac_f32 v53, v27, v79
    v_fmac_f32 v53, v28, v80
    v_fmac_f32 v53, v29, v81
    v_fmac_f32 v53, v30, v82
    v_fmac_f32 v53, v31, v83
    v_fmac_f32 v53, v32, v84
    v_fmac_f32 v53, v33, v85
    v_fmac_f32 v53, v34, v86
    v_fmac_f32 v53, v35, v87
    v_fmac_f32 v53, v36, v88
    v_fmac_f32 v53, v37, v89
    v_fmac_f32 v53, v38, v90
    v_fmac_f32 v53, v39, v91
    ds_read_b128 v[72:75], v7 offset:512
    ds_read_b128 v[76:79], v7 offset:528
    ds_read_b128 v[80:83], v7 offset:544
    ds_read_b128 v[84:87], v7 offset:560
    ds_read_b128 v[88:91], v7 offset:576
    s_waitcnt lgkmcnt(0)
    v_mul_f32 v54, v20, v72
    v_fmac_f32 v54, v21, v73
    v_fmac_f32 v54, v22, v74
    v_fmac_f32 v54, v23, v75
    v_fmac_f32 v54, v24, v76
    v_fmac_f32 v54, v25, v77
    v_fmac_f32 v54, v26, v78
    v_fmac_f32 v54, v27, v79
    v_fmac_f32 v54, v28, v80
    v_fmac_f32 v54, v29, v81
    v_fmac_f32 v54, v30, v82
    v_fmac_f32 v54, v31, v83
    v_fmac_f32 v54, v32, v84
    v_fmac_f32 v54, v33, v85
    v_fmac_f32 v54, v34, v86
    v_fmac_f32 v54, v35, v87
    v_fmac_f32 v54, v36, v88
    v_fmac_f32 v54, v37, v89
    v_fmac_f32 v54, v38, v90
    v_fmac_f32 v54, v39, v91
    ds_read_b128 v[72:75], v7 offset:640
    ds_read_b128 v[76:79], v7 offset:656
    ds_read_b128 v[80:83], v7 offset:672
    ds_read_b128 v[84:87], v7 offset:688
    ds_read_b128 v[88:91], v7 offset:704
    s_waitcnt lgkmcnt(0)
    v_mul_f32 v55, v20, v72
    v_fmac_f32 v55, v21, v73
    v_fmac_f32 v55, v22, v74
    v_fmac_f32 v55, v23, v75
    v_fmac_f32 v55, v24, v76
    v_fmac_f32 v55, v25, v77
    v_fmac_f32 v55, v26, v78
    v_fmac_f32 v55, v27, v79
    v_fmac_f32 v55, v28, v80
    v_fmac_f32 v55, v29, v81
    v_fmac_f32 v55, v30, v82
    v_fmac_f32 v55, v31, v83
    v_fmac_f32 v55, v32, v84
    v_fmac_f32 v55, v33, v85
    v_fmac_f32 v55, v34, v86
    v_fmac_f32 v55, v35, v87
    v_fmac_f32 v55, v36, v88
    v_fmac_f32 v55, v37, v89
    v_fmac_f32 v55, v38, v90
    v_fmac_f32 v55, v39, v91
    ds_read_b128 v[72:75], v7 offset:768
    ds_read_b128 v[76:79], v7 offset:784
    ds_read_b128 v[80:83], v7 offset:800
    ds_read_b128 v[84:87], v7 offset:816
    ds_read_b128 v[88:91], v7 offset:832
    s_waitcnt lgkmcnt(0)
    v_mul_f32 v56, v20, v72
    v_fmac_f32 v56, v21, v73
    v_fmac_f32 v56, v22, v74
    v_fmac_f32 v56, v23, v75
    v_fmac_f32 v56, v24, v76
    v_fmac_f32 v56, v25, v77
    v_fmac_f32 v56, v26, v78
    v_fmac_f32 v56, v27, v79
    v_fmac_f32 v56, v28, v80
    v_fmac_f32 v56, v29, v81
    v_fmac_f32 v56, v30, v82
    v_fmac_f32 v56, v31, v83
    v_fmac_f32 v56, v32, v84
    v_fmac_f32 v56, v33, v85
    v_fmac_f32 v56, v34, v86
    v_fmac_f32 v56, v35, v87
    v_fmac_f32 v56, v36, v88
    v_fmac_f32 v56, v37, v89
    v_fmac_f32 v56, v38, v90
    v_fmac_f32 v56, v39, v91
    ds_read_b128 v[72:75], v7 offset:896
    ds_read_b128 v[76:79], v7 offset:912
    ds_read_b128 v[80:83], v7 offset:928
    ds_read_b128 v[84:87], v7 offset:944
    ds_read_b128 v[88:91], v7 offset:960
    s_waitcnt lgkmcnt(0)
    v_mul_f32 v57, v20, v72
    v_fmac_f32 v57, v21, v73
    v_fmac_f32 v57, v22, v74
    v_fmac_f32 v57, v23, v75
    v_fmac_f32 v57, v24, v76
    v_fmac_f32 v57, v25, v77
    v_fmac_f32 v57, v26, v78
    v_fmac_f32 v57, v27, v79
    v_fmac_f32 v57, v28, v80
    v_fmac_f32 v57, v29, v81
    v_fmac_f32 v57, v30, v82
    v_fmac_f32 v57, v31, v83
    v_fmac_f32 v57, v32, v84
    v_fmac_f32 v57, v33, v85
    v_fmac_f32 v57, v34, v86
    v_fmac_f32 v57, v35, v87
    v_fmac_f32 v57, v36, v88
    v_fmac_f32 v57, v37, v89
    v_fmac_f32 v57, v38, v90
    v_fmac_f32 v57, v39, v91
    ds_read_b128 v[72:75], v7 offset:1024
    ds_read_b128 v[76:79], v7 offset:1040
    ds_read_b128 v[80:83], v7 offset:1056
    ds_read_b128 v[84:87], v7 offset:1072
    ds_read_b128 v[88:91], v7 offset:1088
    s_waitcnt lgkmcnt(0)
    v_mul_f32 v58, v20, v72
    v_fmac_f32 v58, v21, v73
    v_fmac_f32 v58, v22, v74
    v_fmac_f32 v58, v23, v75
    v_fmac_f32 v58, v24, v76
    v_fmac_f32 v58, v25, v77
    v_fmac_f32 v58, v26, v78
    v_fmac_f32 v58, v27, v79
    v_fmac_f32 v58, v28, v80
    v_fmac_f32 v58, v29, v81
    v_fmac_f32 v58, v30, v82
    v_fmac_f32 v58, v31, v83
    v_fmac_f32 v58, v32, v84
    v_fmac_f32 v58, v33, v85
    v_fmac_f32 v58, v34, v86
    v_fmac_f32 v58, v35, v87
    v_fmac_f32 v58, v36, v88
    v_fmac_f32 v58, v37, v89
    v_fmac_f32 v58, v38, v90
    v_fmac_f32 v58, v39, v91
    ds_read_b128 v[72:75], v7 offset:1152
    ds_read_b128 v[76:79], v7 offset:1168
    ds_read_b128 v[80:83], v7 offset:1184
    ds_read_b128 v[84:87], v7 offset:1200
    ds_read_b128 v[88:91], v7 offset:1216
    s_waitcnt lgkmcnt(0)
    v_mul_f32 v59, v20, v72
    v_fmac_f32 v59, v21, v73
    v_fmac_f32 v59, v22, v74
    v_fmac_f32 v59, v23, v75
    v_fmac_f32 v59, v24, v76
    v_fmac_f32 v59, v25, v77
    v_fmac_f32 v59, v26, v78
    v_fmac_f32 v59, v27, v79
    v_fmac_f32 v59, v28, v80
    v_fmac_f32 v59, v29, v81
    v_fmac_f32 v59, v30, v82
    v_fmac_f32 v59, v31, v83
    v_fmac_f32 v59, v32, v84
    v_fmac_f32 v59, v33, v85
    v_fmac_f32 v59, v34, v86
    v_fmac_f32 v59, v35, v87
    v_fmac_f32 v59, v36, v88
    v_fmac_f32 v59, v37, v89
    v_fmac_f32 v59, v38, v90
    v_fmac_f32 v59, v39, v91
    ds_read_b128 v[72:75], v7 offset:1280
    ds_read_b128 v[76:79], v7 offset:1296
    ds_read_b128 v[80:83], v7 offset:1312
    ds_read_b128 v[84:87], v7 offset:1328
    ds_read_b128 v[88:91], v7 offset:1344
    s_waitcnt lgkmcnt(0)
    v_mul_f32 v60, v20, v72
    v_fmac_f32 v60, v21, v73
    v_fmac_f32 v60, v22, v74
    v_fmac_f32 v60, v23, v75
    v_fmac_f32 v60, v24, v76
    v_fmac_f32 v60, v25, v77
    v_fmac_f32 v60, v26, v78
    v_fmac_f32 v60, v27, v79
    v_fmac_f32 v60, v28, v80
    v_fmac_f32 v60, v29, v81
    v_fmac_f32 v60, v30, v82
    v_fmac_f32 v60, v31, v83
    v_fmac_f32 v60, v32, v84
    v_fmac_f32 v60, v33, v85
    v_fmac_f32 v60, v34, v86
    v_fmac_f32 v60, v35, v87
    v_fmac_f32 v60, v36, v88
    v_fmac_f32 v60, v37, v89
    v_fmac_f32 v60, v38, v90
    v_fmac_f32 v60, v39, v91
    ds_read_b128 v[72:75], v7 offset:1408
    ds_read_b128 v[76:79], v7 offset:1424
    ds_read_b128 v[80:83], v7 offset:1440
    ds_read_b128 v[84:87], v7 offset:1456
    ds_read_b128 v[88:91], v7 offset:1472
    s_waitcnt lgkmcnt(0)
    v_mul_f32 v61, v20, v72
    v_fmac_f32 v61, v21, v73
    v_fmac_f32 v61, v22, v74
    v_fmac_f32 v61, v23, v75
    v_fmac_f32 v61, v24, v76
    v_fmac_f32 v61, v25, v77
    v_fmac_f32 v61, v26, v78
    v_fmac_f32 v61, v27, v79
    v_fmac_f32 v61, v28, v80
    v_fmac_f32 v61, v29, v81
    v_fmac_f32 v61, v30, v82
    v_fmac_f32 v61, v31, v83
    v_fmac_f32 v61, v32, v84
    v_fmac_f32 v61, v33, v85
    v_fmac_f32 v61, v34, v86
    v_fmac_f32 v61, v35, v87
    v_fmac_f32 v61, v36, v88
    v_fmac_f32 v61, v37, v89
    v_fmac_f32 v61, v38, v90
    v_fmac_f32 v61, v39, v91
    ds_read_b128 v[72:75], v7 offset:1536
    ds_read_b128 v[76:79], v7 offset:1552
    ds_read_b128 v[80:83], v7 offset:1568
    ds_read_b128 v[84:87], v7 offset:1584
    ds_read_b128 v[88:91], v7 offset:1600
    s_waitcnt lgkmcnt(0)
    v_mul_f32 v62, v20, v72
    v_fmac_f32 v62, v21, v73
    v_fmac_f32 v62, v22, v74
    v_fmac_f32 v62, v23, v75
    v_fmac_f32 v62, v24, v76
    v_fmac_f32 v62, v25, v77
    v_fmac_f32 v62, v26, v78
    v_fmac_f32 v62, v27, v79
    v_fmac_f32 v62, v28, v80
    v_fmac_f32 v62, v29, v81
    v_fmac_f32 v62, v30, v82
    v_fmac_f32 v62, v31, v83
    v_fmac_f32 v62, v32, v84
    v_fmac_f32 v62, v33, v85
    v_fmac_f32 v62, v34, v86
    v_fmac_f32 v62, v35, v87
    v_fmac_f32 v62, v36, v88
    v_fmac_f32 v62, v37, v89
    v_fmac_f32 v62, v38, v90
    v_fmac_f32 v62, v39, v91
    ds_read_b128 v[72:75], v7 offset:1664
    ds_read_b128 v[76:79], v7 offset:1680
    ds_read_b128 v[80:83], v7 offset:1696
    ds_read_b128 v[84:87], v7 offset:1712
    ds_read_b128 v[88:91], v7 offset:1728
    s_waitcnt lgkmcnt(0)
    v_mul_f32 v63, v20, v72
    v_fmac_f32 v63, v21, v73
    v_fmac_f32 v63, v22, v74
    v_fmac_f32 v63, v23, v75
    v_fmac_f32 v63, v24, v76
    v_fmac_f32 v63, v25, v77
    v_fmac_f32 v63, v26, v78
    v_fmac_f32 v63, v27, v79
    v_fmac_f32 v63, v28, v80
    v_fmac_f32 v63, v29, v81
    v_fmac_f32 v63, v30, v82
    v_fmac_f32 v63, v31, v83
    v_fmac_f32 v63, v32, v84
    v_fmac_f32 v63, v33, v85
    v_fmac_f32 v63, v34, v86
    v_fmac_f32 v63, v35, v87
    v_fmac_f32 v63, v36, v88
    v_fmac_f32 v63, v37, v89
    v_fmac_f32 v63, v38, v90
    v_fmac_f32 v63, v39, v91
    ds_read_b128 v[72:75], v7 offset:1792
    ds_read_b128 v[76:79], v7 offset:1808
    ds_read_b128 v[80:83], v7 offset:1824
    ds_read_b128 v[84:87], v7 offset:1840
    ds_read_b128 v[88:91], v7 offset:1856
    s_waitcnt lgkmcnt(0)
    v_mul_f32 v64, v20, v72
    v_fmac_f32 v64, v21, v73
    v_fmac_f32 v64, v22, v74
    v_fmac_f32 v64, v23, v75
    v_fmac_f32 v64, v24, v76
    v_fmac_f32 v64, v25, v77
    v_fmac_f32 v64, v26, v78
    v_fmac_f32 v64, v27, v79
    v_fmac_f32 v64, v28, v80
    v_fmac_f32 v64, v29, v81
    v_fmac_f32 v64, v30, v82
    v_fmac_f32 v64, v31, v83
    v_fmac_f32 v64, v32, v84
    v_fmac_f32 v64, v33, v85
    v_fmac_f32 v64, v34, v86
    v_fmac_f32 v64, v35, v87
    v_fmac_f32 v64, v36, v88
    v_fmac_f32 v64, v37, v89
    v_fmac_f32 v64, v38, v90
    v_fmac_f32 v64, v39, v91
    ds_read_b128 v[72:75], v7 offset:1920
    ds_read_b128 v[76:79], v7 offset:1936
    ds_read_b128 v[80:83], v7 offset:1952
    ds_read_b128 v[84:87], v7 offset:1968
    ds_read_b128 v[88:91], v7 offset:1984
    s_waitcnt lgkmcnt(0)
    v_mul_f32 v65, v20, v72
    v_fmac_f32 v65, v21, v73
    v_fmac_f32 v65, v22, v74
    v_fmac_f32 v65, v23, v75
    v_fmac_f32 v65, v24, v76
    v_fmac_f32 v65, v25, v77
    v_fmac_f32 v65, v26, v78
    v_fmac_f32 v65, v27, v79
    v_fmac_f32 v65, v28, v80
    v_fmac_f32 v65, v29, v81
    v_fmac_f32 v65, v30, v82
    v_fmac_f32 v65, v31, v83
    v_fmac_f32 v65, v32, v84
    v_fmac_f32 v65, v33, v85
    v_fmac_f32 v65, v34, v86
    v_fmac_f32 v65, v35, v87
    v_fmac_f32 v65, v36, v88
    v_fmac_f32 v65, v37, v89
    v_fmac_f32 v65, v38, v90
    v_fmac_f32 v65, v39, v91
    ds_read_b128 v[72:75], v7 offset:2048
    ds_read_b128 v[76:79], v7 offset:2064
    ds_read_b128 v[80:83], v7 offset:2080
    ds_read_b128 v[84:87], v7 offset:2096
    ds_read_b128 v[88:91], v7 offset:2112
    s_waitcnt lgkmcnt(0)
    v_mul_f32 v66, v20, v72
    v_fmac_f32 v66, v21, v73
    v_fmac_f32 v66, v22, v74
    v_fmac_f32 v66, v23, v75
    v_fmac_f32 v66, v24, v76
    v_fmac_f32 v66, v25, v77
    v_fmac_f32 v66, v26, v78
    v_fmac_f32 v66, v27, v79
    v_fmac_f32 v66, v28, v80
    v_fmac_f32 v66, v29, v81
    v_fmac_f32 v66, v30, v82
    v_fmac_f32 v66, v31, v83
    v_fmac_f32 v66, v32, v84
    v_fmac_f32 v66, v33, v85
    v_fmac_f32 v66, v34, v86
    v_fmac_f32 v66, v35, v87
    v_fmac_f32 v66, v36, v88
    v_fmac_f32 v66, v37, v89
    v_fmac_f32 v66, v38, v90
    v_fmac_f32 v66, v39, v91
    ds_read_b128 v[72:75], v7 offset:2176
    ds_read_b128 v[76:79], v7 offset:2192
    ds_read_b128 v[80:83], v7 offset:2208
    ds_read_b128 v[84:87], v7 offset:2224
    ds_read_b128 v[88:91], v7 offset:2240
    s_waitcnt lgkmcnt(0)
    v_mul_f32 v67, v20, v72
    v_fmac_f32 v67, v21, v73
    v_fmac_f32 v67, v22, v74
    v_fmac_f32 v67, v23, v75
    v_fmac_f32 v67, v24, v76
    v_fmac_f32 v67, v25, v77
    v_fmac_f32 v67, v26, v78
    v_fmac_f32 v67, v27, v79
    v_fmac_f32 v67, v28, v80
    v_fmac_f32 v67, v29, v81
    v_fmac_f32 v67, v30, v82
    v_fmac_f32 v67, v31, v83
    v_fmac_f32 v67, v32, v84
    v_fmac_f32 v67, v33, v85
    v_fmac_f32 v67, v34, v86
    v_fmac_f32 v67, v35, v87
    v_fmac_f32 v67, v36, v88
    v_fmac_f32 v67, v37, v89
    v_fmac_f32 v67, v38, v90
    v_fmac_f32 v67, v39, v91
    ds_read_b128 v[72:75], v7 offset:2304
    ds_read_b128 v[76:79], v7 offset:2320
    ds_read_b128 v[80:83], v7 offset:2336
    ds_read_b128 v[84:87], v7 offset:2352
    ds_read_b128 v[88:91], v7 offset:2368
    s_waitcnt lgkmcnt(0)
    v_mul_f32 v68, v20, v72
    v_fmac_f32 v68, v21, v73
    v_fmac_f32 v68, v22, v74
    v_fmac_f32 v68, v23, v75
    v_fmac_f32 v68, v24, v76
    v_fmac_f32 v68, v25, v77
    v_fmac_f32 v68, v26, v78
    v_fmac_f32 v68, v27, v79
    v_fmac_f32 v68, v28, v80
    v_fmac_f32 v68, v29, v81
    v_fmac_f32 v68, v30, v82
    v_fmac_f32 v68, v31, v83
    v_fmac_f32 v68, v32, v84
    v_fmac_f32 v68, v33, v85
    v_fmac_f32 v68, v34, v86
    v_fmac_f32 v68, v35, v87
    v_fmac_f32 v68, v36, v88
    v_fmac_f32 v68, v37, v89
    v_fmac_f32 v68, v38, v90
    v_fmac_f32 v68, v39, v91
    ds_read_b128 v[72:75], v7 offset:2432
    ds_read_b128 v[76:79], v7 offset:2448
    ds_read_b128 v[80:83], v7 offset:2464
    ds_read_b128 v[84:87], v7 offset:2480
    ds_read_b128 v[88:91], v7 offset:2496
    s_waitcnt lgkmcnt(0)
    v_mul_f32 v69, v20, v72
    v_fmac_f32 v69, v21, v73
    v_fmac_f32 v69, v22, v74
    v_fmac_f32 v69, v23, v75
    v_fmac_f32 v69, v24, v76
    v_fmac_f32 v69, v25, v77
    v_fmac_f32 v69, v26, v78
    v_fmac_f32 v69, v27, v79
    v_fmac_f32 v69, v28, v80
    v_fmac_f32 v69, v29, v81
    v_fmac_f32 v69, v30, v82
    v_fmac_f32 v69, v31, v83
    v_fmac_f32 v69, v32, v84
    v_fmac_f32 v69, v33, v85
    v_fmac_f32 v69, v34, v86
    v_fmac_f32 v69, v35, v87
    v_fmac_f32 v69, v36, v88
    v_fmac_f32 v69, v37, v89
    v_fmac_f32 v69, v38, v90
    v_fmac_f32 v69, v39, v91
    ds_read_b128 v[72:75], v7 offset:2560
    ds_read_b128 v[76:79], v7 offset:2576
    ds_read_b128 v[80:83], v7 offset:2592
    ds_read_b128 v[84:87], v7 offset:2608
    ds_read_b128 v[88:91], v7 offset:2624
    s_waitcnt lgkmcnt(0)
    v_mul_f32 v70, v20, v72
    v_fmac_f32 v70, v21, v73
    v_fmac_f32 v70, v22, v74
    v_fmac_f32 v70, v23, v75
    v_fmac_f32 v70, v24, v76
    v_fmac_f32 v70, v25, v77
    v_fmac_f32 v70, v26, v78
    v_fmac_f32 v70, v27, v79
    v_fmac_f32 v70, v28, v80
    v_fmac_f32 v70, v29, v81
    v_fmac_f32 v70, v30, v82
    v_fmac_f32 v70, v31, v83
    v_fmac_f32 v70, v32, v84
    v_fmac_f32 v70, v33, v85
    v_fmac_f32 v70, v34, v86
    v_fmac_f32 v70, v35, v87
    v_fmac_f32 v70, v36, v88
    v_fmac_f32 v70, v37, v89
    v_fmac_f32 v70, v38, v90
    v_fmac_f32 v70, v39, v91
    v_add_f32 v70, 0x358637bd, v70
    v_rcp_f32 v70, v70
    s_nop 0
    v_mul_f32 v50, v50, v70
    v_mul_f32 v51, v51, v70
    v_mul_f32 v52, v52, v70
    v_mul_f32 v53, v53, v70
    v_mul_f32 v54, v54, v70
    v_mul_f32 v55, v55, v70
    v_mul_f32 v56, v56, v70
    v_mul_f32 v57, v57, v70
    v_mul_f32 v58, v58, v70
    v_mul_f32 v59, v59, v70
    v_mul_f32 v60, v60, v70
    v_mul_f32 v61, v61, v70
    v_mul_f32 v62, v62, v70
    v_mul_f32 v63, v63, v70
    v_mul_f32 v64, v64, v70
    v_mul_f32 v65, v65, v70
    v_mul_f32 v66, v66, v70
    v_mul_f32 v67, v67, v70
    v_mul_f32 v68, v68, v70
    v_mul_f32 v69, v69, v70
    v_cvt_pk_bf16_f32 v8, v50, v51
    v_cvt_pk_bf16_f32 v9, v52, v53
    v_cvt_pk_bf16_f32 v10, v54, v55
    v_cvt_pk_bf16_f32 v11, v56, v57
    v_cvt_pk_bf16_f32 v12, v58, v59
    v_cvt_pk_bf16_f32 v13, v60, v61
    v_cvt_pk_bf16_f32 v14, v62, v63
    v_cvt_pk_bf16_f32 v15, v64, v65
    v_cvt_pk_bf16_f32 v16, v66, v67
    v_cvt_pk_bf16_f32 v17, v68, v69
    v_add_u32 v6, 239075328, v4
    buffer_store_dwordx2 v[8:9], v6, s[8:11], 0 offen offset:0
    buffer_store_dwordx2 v[10:11], v6, s[8:11], 0 offen offset:8
    buffer_store_dwordx2 v[12:13], v6, s[8:11], 0 offen offset:16
    buffer_store_dwordx2 v[14:15], v6, s[8:11], 0 offen offset:24
    buffer_store_dwordx2 v[16:17], v6, s[8:11], 0 offen offset:32
attn_a1_kernel_end:
    s_endpgm
.section .rodata,"a"
.p2align 6
.amdhsa_kernel attn_a1_kernel
  .amdhsa_next_free_vgpr 96
  .amdhsa_next_free_sgpr 40
  .amdhsa_accum_offset 96
  .amdhsa_group_segment_fixed_size 0
  .amdhsa_kernarg_size 104
  .amdhsa_user_sgpr_count 2
  .amdhsa_user_sgpr_kernarg_segment_ptr 1
  .amdhsa_system_sgpr_workgroup_id_x 1
.end_amdhsa_kernel
.text
.globl wo_a1_kernel
.p2align 8
.type wo_a1_kernel,@function
wo_a1_kernel:
    v_lshrrev_b32 v1, 6, v0
    v_and_b32 v2, 63, v0
    s_nop 0
    v_readfirstlane_b32 s3, v1
    s_cmp_ge_u32 s2, 128
    s_cbranch_scc1 wo_a1_kernel_end
    s_load_dwordx2 s[4:5], s[0:1], 96
    s_load_dwordx2 s[6:7], s[0:1], 80
    s_load_dwordx2 s[42:43], s[0:1], 0
    s_mul_i32 s20, s2, 1
    s_lshr_b32 s20, s20, 3
    s_mul_i32 s21, s20, 8
    s_sub_u32 s21, s2, s21
    s_lshl_b32 s20, s20, 2
    s_add_u32 s20, s20, s3
    s_mul_i32 s22, s20, 32
    s_mul_i32 s23, s21, 80
    s_waitcnt lgkmcnt(0)
    s_mov_b32 s8, s4
    s_mov_b32 s9, s5
    s_mov_b32 s10, 268435456
    s_mov_b32 s11, 0x00020000
    v_and_b32 v3, 15, v2
    v_lshrrev_b32 v4, 4, v2
    s_mov_b32 s24, 1280
    v_add_u32 v5, s22, v3
    v_mul_lo_u32 v5, v5, s24
    v_lshlrev_b32 v6, 4, v4
    v_add_u32 v5, v5, v6
    v_add_u32 v5, 239075328, v5
    v_mov_b32 v8, v5
    v_add_u32 v9, 20480, v5
    v_lshlrev_b32 v7, 4, v2
    s_mov_b32 s25, 0
    s_mov_b32 s26, 0
    s_mul_i32 s27, s21, 102400
    s_add_u32 s27, s27, s26
    s_add_u32 s27, s27, 246415360
    s_add_u32 s32, s27, 0
    s_add_u32 s33, s27, 20480
    s_add_u32 s34, s27, 40960
    s_add_u32 s35, s27, 61440
    s_add_u32 s36, s27, 81920
    v_accvgpr_write_b32 a0, 0
    v_accvgpr_write_b32 a1, 0
    v_accvgpr_write_b32 a2, 0
    v_accvgpr_write_b32 a3, 0
    v_accvgpr_write_b32 a4, 0
    v_accvgpr_write_b32 a5, 0
    v_accvgpr_write_b32 a6, 0
    v_accvgpr_write_b32 a7, 0
    v_accvgpr_write_b32 a8, 0
    v_accvgpr_write_b32 a9, 0
    v_accvgpr_write_b32 a10, 0
    v_accvgpr_write_b32 a11, 0
    v_accvgpr_write_b32 a12, 0
    v_accvgpr_write_b32 a13, 0
    v_accvgpr_write_b32 a14, 0
    v_accvgpr_write_b32 a15, 0
    v_accvgpr_write_b32 a16, 0
    v_accvgpr_write_b32 a17, 0
    v_accvgpr_write_b32 a18, 0
    v_accvgpr_write_b32 a19, 0
    v_accvgpr_write_b32 a20, 0
    v_accvgpr_write_b32 a21, 0
    v_accvgpr_write_b32 a22, 0
    v_accvgpr_write_b32 a23, 0
    v_accvgpr_write_b32 a24, 0
    v_accvgpr_write_b32 a25, 0
    v_accvgpr_write_b32 a26, 0
    v_accvgpr_write_b32 a27, 0
    v_accvgpr_write_b32 a28, 0
    v_accvgpr_write_b32 a29, 0
    v_accvgpr_write_b32 a30, 0
    v_accvgpr_write_b32 a31, 0
    v_accvgpr_write_b32 a32, 0
    v_accvgpr_write_b32 a33, 0
    v_accvgpr_write_b32 a34, 0
    v_accvgpr_write_b32 a35, 0
    v_accvgpr_write_b32 a36, 0
    v_accvgpr_write_b32 a37, 0
    v_accvgpr_write_b32 a38, 0
    v_accvgpr_write_b32 a39, 0
    buffer_load_dwordx4 v[16:19], v8, s[8:11], s25 offen
    buffer_load_dwordx4 v[20:23], v9, s[8:11], s25 offen
    buffer_load_dwordx4 v[24:27], v7, s[8:11], s32 offen
    buffer_load_dwordx4 v[28:31], v7, s[8:11], s33 offen
    buffer_load_dwordx4 v[32:35], v7, s[8:11], s34 offen
    buffer_load_dwordx4 v[36:39], v7, s[8:11], s35 offen
    buffer_load_dwordx4 v[40:43], v7, s[8:11], s36 offen
    s_mov_b32 s28, 10
wo_a1_kernel_loop0:
    s_add_u32 s25, s25, 64
    s_add_u32 s32, s32, 1024
    s_add_u32 s33, s33, 1024
    s_add_u32 s34, s34, 1024
    s_add_u32 s35, s35, 1024
    s_add_u32 s36, s36, 1024
    buffer_load_dwordx4 v[44:47], v8, s[8:11], s25 offen
    buffer_load_dwordx4 v[48:51], v9, s[8:11], s25 offen
    buffer_load_dwordx4 v[52:55], v7, s[8:11], s32 offen
    buffer_load_dwordx4 v[56:59], v7, s[8:11], s33 offen
    buffer_load_dwordx4 v[60:63], v7, s[8:11], s34 offen
    buffer_load_dwordx4 v[64:67], v7, s[8:11], s35 offen
    buffer_load_dwordx4 v[68:71], v7, s[8:11], s36 offen
    s_waitcnt vmcnt(7)
    v_mfma_f32_16x16x32_bf16 a[0:3], v[24:27], v[16:19], a[0:3]
    v_mfma_f32_16x16x32_bf16 a[20:23], v[24:27], v[20:23], a[20:23]
    v_mfma_f32_16x16x32_bf16 a[4:7], v[28:31], v[16:19], a[4:7]
    v_mfma_f32_16x16x32_bf16 a[24:27], v[28:31], v[20:23], a[24:27]
    v_mfma_f32_16x16x32_bf16 a[8:11], v[32:35], v[16:19], a[8:11]
    v_mfma_f32_16x16x32_bf16 a[28:31], v[32:35], v[20:23], a[28:31]
    v_mfma_f32_16x16x32_bf16 a[12:15], v[36:39], v[16:19], a[12:15]
    v_mfma_f32_16x16x32_bf16 a[32:35], v[36:39], v[20:23], a[32:35]
    v_mfma_f32_16x16x32_bf16 a[16:19], v[40:43], v[16:19], a[16:19]
    v_mfma_f32_16x16x32_bf16 a[36:39], v[40:43], v[20:23], a[36:39]
    s_sub_u32 s28, s28, 1
    s_cmp_eq_u32 s28, 0
    s_cbranch_scc1 wo_a1_kernel_loop0_last
    s_add_u32 s25, s25, 64
    s_add_u32 s32, s32, 1024
    s_add_u32 s33, s33, 1024
    s_add_u32 s34, s34, 1024
    s_add_u32 s35, s35, 1024
    s_add_u32 s36, s36, 1024
    buffer_load_dwordx4 v[16:19], v8, s[8:11], s25 offen
    buffer_load_dwordx4 v[20:23], v9, s[8:11], s25 offen
    buffer_load_dwordx4 v[24:27], v7, s[8:11], s32 offen
    buffer_load_dwordx4 v[28:31], v7, s[8:11], s33 offen
    buffer_load_dwordx4 v[32:35], v7, s[8:11], s34 offen
    buffer_load_dwordx4 v[36:39], v7, s[8:11], s35 offen
    buffer_load_dwordx4 v[40:43], v7, s[8:11], s36 offen
    s_waitcnt vmcnt(7)
    v_mfma_f32_16x16x32_bf16 a[0:3], v[52:55], v[44:47], a[0:3]
    v_mfma_f32_16x16x32_bf16 a[20:23], v[52:55], v[48:51], a[20:23]
    v_mfma_f32_16x16x32_bf16 a[4:7], v[56:59], v[44:47], a[4:7]
    v_mfma_f32_16x16x32_bf16 a[24:27], v[56:59], v[48:51], a[24:27]
    v_mfma_f32_16x16x32_bf16 a[8:11], v[60:63], v[44:47], a[8:11]
    v_mfma_f32_16x16x32_bf16 a[28:31], v[60:63], v[48:51], a[28:31]
    v_mfma_f32_16x16x32_bf16 a[12:15], v[64:67], v[44:47], a[12:15]
    v_mfma_f32_16x16x32_bf16 a[32:35], v[64:67], v[48:51], a[32:35]
    v_mfma_f32_16x16x32_bf16 a[16:19], v[68:71], v[44:47], a[16:19]
    v_mfma_f32_16x16x32_bf16 a[36:39], v[68:71], v[48:51], a[36:39]
    s_branch wo_a1_kernel_loop0
wo_a1_kernel_loop0_last:
    s_waitcnt vmcnt(0)
    v_mfma_f32_16x16x32_bf16 a[0:3], v[52:55], v[44:47], a[0:3]
    v_mfma_f32_16x16x32_bf16 a[20:23], v[52:55], v[48:51], a[20:23]
    v_mfma_f32_16x16x32_bf16 a[4:7], v[56:59], v[44:47], a[4:7]
    v_mfma_f32_16x16x32_bf16 a[24:27], v[56:59], v[48:51], a[24:27]
    v_mfma_f32_16x16x32_bf16 a[8:11], v[60:63], v[44:47], a[8:11]
    v_mfma_f32_16x16x32_bf16 a[28:31], v[60:63], v[48:51], a[28:31]
    v_mfma_f32_16x16x32_bf16 a[12:15], v[64:67], v[44:47], a[12:15]
    v_mfma_f32_16x16x32_bf16 a[32:35], v[64:67], v[48:51], a[32:35]
    v_mfma_f32_16x16x32_bf16 a[16:19], v[68:71], v[44:47], a[16:19]
    v_mfma_f32_16x16x32_bf16 a[36:39], v[68:71], v[48:51], a[36:39]
    s_nop 7
    s_nop 7
    s_mov_b32 s44, s42
    s_mov_b32 s45, s43
    s_mov_b32 s46, 2621440
    s_mov_b32 s47, 0x00020000
    s_mov_b32 s24, 1280
    v_add_u32 v5, s22, v3
    v_mul_lo_u32 v5, v5, s24
    v_lshlrev_b32 v6, 3, v4
    s_lshl_b32 s29, s23, 1
    v_add3_u32 v5, v5, v6, s29
    v_add_u32 v6, 0, v5
    buffer_load_dwordx2 v[72:73], v6, s[44:47], 0 offen
    v_accvgpr_read_b32 v76, a0
    v_accvgpr_read_b32 v77, a1
    v_accvgpr_read_b32 v78, a2
    v_accvgpr_read_b32 v79, a3
    v_cvt_pk_bf16_f32 v80, v76, v77
    v_cvt_pk_bf16_f32 v81, v78, v79
    s_waitcnt vmcnt(0)
    v_lshlrev_b32 v76, 16, v80
    v_and_b32 v77, 0xffff0000, v80
    v_lshlrev_b32 v82, 16, v72
    v_and_b32 v83, 0xffff0000, v72
    v_add_f32 v76, v76, v82
    v_add_f32 v77, v77, v83
    v_lshlrev_b32 v78, 16, v81
    v_and_b32 v79, 0xffff0000, v81
    v_lshlrev_b32 v82, 16, v73
    v_and_b32 v83, 0xffff0000, v73
    v_add_f32 v78, v78, v82
    v_add_f32 v79, v79, v83
    v_cvt_pk_bf16_f32 v80, v76, v77
    v_cvt_pk_bf16_f32 v81, v78, v79
    v_add_u32 v6, 226492416, v5
    buffer_store_dwordx2 v[80:81], v6, s[8:11], 0 offen
    v_add_u32 v6, 32, v5
    buffer_load_dwordx2 v[72:73], v6, s[44:47], 0 offen
    v_accvgpr_read_b32 v76, a4
    v_accvgpr_read_b32 v77, a5
    v_accvgpr_read_b32 v78, a6
    v_accvgpr_read_b32 v79, a7
    v_cvt_pk_bf16_f32 v80, v76, v77
    v_cvt_pk_bf16_f32 v81, v78, v79
    s_waitcnt vmcnt(0)
    v_lshlrev_b32 v76, 16, v80
    v_and_b32 v77, 0xffff0000, v80
    v_lshlrev_b32 v82, 16, v72
    v_and_b32 v83, 0xffff0000, v72
    v_add_f32 v76, v76, v82
    v_add_f32 v77, v77, v83
    v_lshlrev_b32 v78, 16, v81
    v_and_b32 v79, 0xffff0000, v81
    v_lshlrev_b32 v82, 16, v73
    v_and_b32 v83, 0xffff0000, v73
    v_add_f32 v78, v78, v82
    v_add_f32 v79, v79, v83
    v_cvt_pk_bf16_f32 v80, v76, v77
    v_cvt_pk_bf16_f32 v81, v78, v79
    v_add_u32 v6, 226492448, v5
    buffer_store_dwordx2 v[80:81], v6, s[8:11], 0 offen
    v_add_u32 v6, 64, v5
    buffer_load_dwordx2 v[72:73], v6, s[44:47], 0 offen
    v_accvgpr_read_b32 v76, a8
    v_accvgpr_read_b32 v77, a9
    v_accvgpr_read_b32 v78, a10
    v_accvgpr_read_b32 v79, a11
    v_cvt_pk_bf16_f32 v80, v76, v77
    v_cvt_pk_bf16_f32 v81, v78, v79
    s_waitcnt vmcnt(0)
    v_lshlrev_b32 v76, 16, v80
    v_and_b32 v77, 0xffff0000, v80
    v_lshlrev_b32 v82, 16, v72
    v_and_b32 v83, 0xffff0000, v72
    v_add_f32 v76, v76, v82
    v_add_f32 v77, v77, v83
    v_lshlrev_b32 v78, 16, v81
    v_and_b32 v79, 0xffff0000, v81
    v_lshlrev_b32 v82, 16, v73
    v_and_b32 v83, 0xffff0000, v73
    v_add_f32 v78, v78, v82
    v_add_f32 v79, v79, v83
    v_cvt_pk_bf16_f32 v80, v76, v77
    v_cvt_pk_bf16_f32 v81, v78, v79
    v_add_u32 v6, 226492480, v5
    buffer_store_dwordx2 v[80:81], v6, s[8:11], 0 offen
    v_add_u32 v6, 96, v5
    buffer_load_dwordx2 v[72:73], v6, s[44:47], 0 offen
    v_accvgpr_read_b32 v76, a12
    v_accvgpr_read_b32 v77, a13
    v_accvgpr_read_b32 v78, a14
    v_accvgpr_read_b32 v79, a15
    v_cvt_pk_bf16_f32 v80, v76, v77
    v_cvt_pk_bf16_f32 v81, v78, v79
    s_waitcnt vmcnt(0)
    v_lshlrev_b32 v76, 16, v80
    v_and_b32 v77, 0xffff0000, v80
    v_lshlrev_b32 v82, 16, v72
    v_and_b32 v83, 0xffff0000, v72
    v_add_f32 v76, v76, v82
    v_add_f32 v77, v77, v83
    v_lshlrev_b32 v78, 16, v81
    v_and_b32 v79, 0xffff0000, v81
    v_lshlrev_b32 v82, 16, v73
    v_and_b32 v83, 0xffff0000, v73
    v_add_f32 v78, v78, v82
    v_add_f32 v79, v79, v83
    v_cvt_pk_bf16_f32 v80, v76, v77
    v_cvt_pk_bf16_f32 v81, v78, v79
    v_add_u32 v6, 226492512, v5
    buffer_store_dwordx2 v[80:81], v6, s[8:11], 0 offen
    v_add_u32 v6, 128, v5
    buffer_load_dwordx2 v[72:73], v6, s[44:47], 0 offen
    v_accvgpr_read_b32 v76, a16
    v_accvgpr_read_b32 v77, a17
    v_accvgpr_read_b32 v78, a18
    v_accvgpr_read_b32 v79, a19
    v_cvt_pk_bf16_f32 v80, v76, v77
    v_cvt_pk_bf16_f32 v81, v78, v79
    s_waitcnt vmcnt(0)
    v_lshlrev_b32 v76, 16, v80
    v_and_b32 v77, 0xffff0000, v80
    v_lshlrev_b32 v82, 16, v72
    v_and_b32 v83, 0xffff0000, v72
    v_add_f32 v76, v76, v82
    v_add_f32 v77, v77, v83
    v_lshlrev_b32 v78, 16, v81
    v_and_b32 v79, 0xffff0000, v81
    v_lshlrev_b32 v82, 16, v73
    v_and_b32 v83, 0xffff0000, v73
    v_add_f32 v78, v78, v82
    v_add_f32 v79, v79, v83
    v_cvt_pk_bf16_f32 v80, v76, v77
    v_cvt_pk_bf16_f32 v81, v78, v79
    v_add_u32 v6, 226492544, v5
    buffer_store_dwordx2 v[80:81], v6, s[8:11], 0 offen
    v_add_u32 v6, 20480, v5
    buffer_load_dwordx2 v[72:73], v6, s[44:47], 0 offen
    v_accvgpr_read_b32 v76, a20
    v_accvgpr_read_b32 v77, a21
    v_accvgpr_read_b32 v78, a22
    v_accvgpr_read_b32 v79, a23
    v_cvt_pk_bf16_f32 v80, v76, v77
    v_cvt_pk_bf16_f32 v81, v78, v79
    s_waitcnt vmcnt(0)
    v_lshlrev_b32 v76, 16, v80
    v_and_b32 v77, 0xffff0000, v80
    v_lshlrev_b32 v82, 16, v72
    v_and_b32 v83, 0xffff0000, v72
    v_add_f32 v76, v76, v82
    v_add_f32 v77, v77, v83
    v_lshlrev_b32 v78, 16, v81
    v_and_b32 v79, 0xffff0000, v81
    v_lshlrev_b32 v82, 16, v73
    v_and_b32 v83, 0xffff0000, v73
    v_add_f32 v78, v78, v82
    v_add_f32 v79, v79, v83
    v_cvt_pk_bf16_f32 v80, v76, v77
    v_cvt_pk_bf16_f32 v81, v78, v79
    v_add_u32 v6, 226512896, v5
    buffer_store_dwordx2 v[80:81], v6, s[8:11], 0 offen
    v_add_u32 v6, 20512, v5
    buffer_load_dwordx2 v[72:73], v6, s[44:47], 0 offen
    v_accvgpr_read_b32 v76, a24
    v_accvgpr_read_b32 v77, a25
    v_accvgpr_read_b32 v78, a26
    v_accvgpr_read_b32 v79, a27
    v_cvt_pk_bf16_f32 v80, v76, v77
    v_cvt_pk_bf16_f32 v81, v78, v79
    s_waitcnt vmcnt(0)
    v_lshlrev_b32 v76, 16, v80
    v_and_b32 v77, 0xffff0000, v80
    v_lshlrev_b32 v82, 16, v72
    v_and_b32 v83, 0xffff0000, v72
    v_add_f32 v76, v76, v82
    v_add_f32 v77, v77, v83
    v_lshlrev_b32 v78, 16, v81
    v_and_b32 v79, 0xffff0000, v81
    v_lshlrev_b32 v82, 16, v73
    v_and_b32 v83, 0xffff0000, v73
    v_add_f32 v78, v78, v82
    v_add_f32 v79, v79, v83
    v_cvt_pk_bf16_f32 v80, v76, v77
    v_cvt_pk_bf16_f32 v81, v78, v79
    v_add_u32 v6, 226512928, v5
    buffer_store_dwordx2 v[80:81], v6, s[8:11], 0 offen
    v_add_u32 v6, 20544, v5
    buffer_load_dwordx2 v[72:73], v6, s[44:47], 0 offen
    v_accvgpr_read_b32 v76, a28
    v_accvgpr_read_b32 v77, a29
    v_accvgpr_read_b32 v78, a30
    v_accvgpr_read_b32 v79, a31
    v_cvt_pk_bf16_f32 v80, v76, v77
    v_cvt_pk_bf16_f32 v81, v78, v79
    s_waitcnt vmcnt(0)
    v_lshlrev_b32 v76, 16, v80
    v_and_b32 v77, 0xffff0000, v80
    v_lshlrev_b32 v82, 16, v72
    v_and_b32 v83, 0xffff0000, v72
    v_add_f32 v76, v76, v82
    v_add_f32 v77, v77, v83
    v_lshlrev_b32 v78, 16, v81
    v_and_b32 v79, 0xffff0000, v81
    v_lshlrev_b32 v82, 16, v73
    v_and_b32 v83, 0xffff0000, v73
    v_add_f32 v78, v78, v82
    v_add_f32 v79, v79, v83
    v_cvt_pk_bf16_f32 v80, v76, v77
    v_cvt_pk_bf16_f32 v81, v78, v79
    v_add_u32 v6, 226512960, v5
    buffer_store_dwordx2 v[80:81], v6, s[8:11], 0 offen
    v_add_u32 v6, 20576, v5
    buffer_load_dwordx2 v[72:73], v6, s[44:47], 0 offen
    v_accvgpr_read_b32 v76, a32
    v_accvgpr_read_b32 v77, a33
    v_accvgpr_read_b32 v78, a34
    v_accvgpr_read_b32 v79, a35
    v_cvt_pk_bf16_f32 v80, v76, v77
    v_cvt_pk_bf16_f32 v81, v78, v79
    s_waitcnt vmcnt(0)
    v_lshlrev_b32 v76, 16, v80
    v_and_b32 v77, 0xffff0000, v80
    v_lshlrev_b32 v82, 16, v72
    v_and_b32 v83, 0xffff0000, v72
    v_add_f32 v76, v76, v82
    v_add_f32 v77, v77, v83
    v_lshlrev_b32 v78, 16, v81
    v_and_b32 v79, 0xffff0000, v81
    v_lshlrev_b32 v82, 16, v73
    v_and_b32 v83, 0xffff0000, v73
    v_add_f32 v78, v78, v82
    v_add_f32 v79, v79, v83
    v_cvt_pk_bf16_f32 v80, v76, v77
    v_cvt_pk_bf16_f32 v81, v78, v79
    v_add_u32 v6, 226512992, v5
    buffer_store_dwordx2 v[80:81], v6, s[8:11], 0 offen
    v_add_u32 v6, 20608, v5
    buffer_load_dwordx2 v[72:73], v6, s[44:47], 0 offen
    v_accvgpr_read_b32 v76, a36
    v_accvgpr_read_b32 v77, a37
    v_accvgpr_read_b32 v78, a38
    v_accvgpr_read_b32 v79, a39
    v_cvt_pk_bf16_f32 v80, v76, v77
    v_cvt_pk_bf16_f32 v81, v78, v79
    s_waitcnt vmcnt(0)
    v_lshlrev_b32 v76, 16, v80
    v_and_b32 v77, 0xffff0000, v80
    v_lshlrev_b32 v82, 16, v72
    v_and_b32 v83, 0xffff0000, v72
    v_add_f32 v76, v76, v82
    v_add_f32 v77, v77, v83
    v_lshlrev_b32 v78, 16, v81
    v_and_b32 v79, 0xffff0000, v81
    v_lshlrev_b32 v82, 16, v73
    v_and_b32 v83, 0xffff0000, v73
    v_add_f32 v78, v78, v82
    v_add_f32 v79, v79, v83
    v_cvt_pk_bf16_f32 v80, v76, v77
    v_cvt_pk_bf16_f32 v81, v78, v79
    v_add_u32 v6, 226513024, v5
    buffer_store_dwordx2 v[80:81], v6, s[8:11], 0 offen
wo_a1_kernel_end:
    s_endpgm
.section .rodata,"a"
.p2align 6
.amdhsa_kernel wo_a1_kernel
  .amdhsa_next_free_vgpr 136
  .amdhsa_next_free_sgpr 64
  .amdhsa_accum_offset 96
  .amdhsa_group_segment_fixed_size 0
  .amdhsa_kernarg_size 104
  .amdhsa_user_sgpr_count 2
  .amdhsa_user_sgpr_kernarg_segment_ptr 1
  .amdhsa_system_sgpr_workgroup_id_x 1
.end_amdhsa_kernel
.text
.globl ln_b1_kernel
.p2align 8
.type ln_b1_kernel,@function
ln_b1_kernel:
    s_cmp_gt_u32 s2, 512
    s_cbranch_scc1 ln_b1_kernel_end
    s_load_dwordx2 s[4:5], s[0:1], 96
    s_load_dwordx2 s[6:7], s[0:1], 32
    v_lshrrev_b32 v1, 6, v0
    v_and_b32 v0, 63, v0
    s_nop 0
    v_readfirstlane_b32 s13, v1
    s_waitcnt lgkmcnt(0)
    s_mov_b32 s8, s4
    s_mov_b32 s9, s5
    s_mov_b32 s10, 268435456
    s_mov_b32 s11, 0x00020000
    s_cmp_eq_u32 s2, 512
    s_cbranch_scc1 ln_b1_kernel_mem0
    s_lshl_b32 s20, s2, 2
    s_add_u32 s20, s20, s13
    s_mul_i32 s21, s20, 1280
    s_add_u32 s21, s21, 226492416
    v_lshlrev_b32 v3, 2, v0
    buffer_load_dword v4, v3, s[8:11], s21 offen offset:0
    buffer_load_dword v5, v3, s[8:11], s21 offen offset:256
    buffer_load_dword v6, v3, s[8:11], s21 offen offset:512
    buffer_load_dword v7, v3, s[8:11], s21 offen offset:768
    buffer_load_dword v8, v3, s[8:11], s21 offen offset:1024
    v_lshrrev_b32 v20, 4, v0
    v_lshlrev_b32 v20, 2, v20
    v_bfe_u32 v21, v0, 3, 1
    v_lshl_add_u32 v20, v21, 1, v20
    v_bfe_u32 v21, v0, 1, 1
    v_add_u32 v20, v20, v21
    v_lshlrev_b32 v20, 9, v20
    v_and_b32 v21, 1, v0
    v_lshl_add_u32 v20, v21, 3, v20
    v_bfe_u32 v21, v0, 2, 1
    v_lshl_add_u32 v23, v21, 2, v20
    s_lshr_b32 s22, s20, 5
    s_mul_i32 s22, s22, 40960
    s_and_b32 s23, s20, 31
    s_lshl_b32 s23, s23, 4
    s_add_u32 s22, s22, s23
    s_add_u32 s22, s22, 220200960
    s_waitcnt vmcnt(0)
    v_lshlrev_b32 v10, 16, v4
    v_and_b32 v11, 0xffff0000, v4
    v_lshlrev_b32 v12, 16, v5
    v_and_b32 v13, 0xffff0000, v5
    v_lshlrev_b32 v14, 16, v6
    v_and_b32 v15, 0xffff0000, v6
    v_lshlrev_b32 v16, 16, v7
    v_and_b32 v17, 0xffff0000, v7
    v_lshlrev_b32 v18, 16, v8
    v_and_b32 v19, 0xffff0000, v8
    v_add_f32 v20, v10, v11
    v_add_f32 v20, v20, v12
    v_add_f32 v20, v20, v13
    v_add_f32 v20, v20, v14
    v_add_f32 v20, v20, v15
    v_add_f32 v20, v20, v16
    v_add_f32 v20, v20, v17
    v_add_f32 v20, v20, v18
    v_add_f32 v20, v20, v19
    s_nop 1
    v_add_f32 v21, v20, v20 quad_perm:[1,0,3,2] row_mask:0xf bank_mask:0xf
    s_nop 1
    v_add_f32 v21, v21, v21 quad_perm:[2,3,0,1] row_mask:0xf bank_mask:0xf
    s_nop 1
    v_add_f32 v21, v21, v21 row_half_mirror row_mask:0xf bank_mask:0xf
    s_nop 1
    v_add_f32 v21, v21, v21 row_mirror row_mask:0xf bank_mask:0xf
    s_nop 1
    v_readlane_b32 s24, v21, 0
    v_readlane_b32 s25, v21, 16
    v_readlane_b32 s26, v21, 32
    v_readlane_b32 s27, v21, 48
    s_nop 1
    v_mov_b32 v20, s24
    v_add_f32 v20, s25, v20
    v_add_f32 v20, s26, v20
    v_add_f32 v20, s27, v20
    v_mul_f32 v20, 0x3acccccd, v20
    v_sub_f32 v10, v10, v20
    v_sub_f32 v11, v11, v20
    v_sub_f32 v12, v12, v20
    v_sub_f32 v13, v13, v20
    v_sub_f32 v14, v14, v20
    v_sub_f32 v15, v15, v20
    v_sub_f32 v16, v16, v20
    v_sub_f32 v17, v17, v20
    v_sub_f32 v18, v18, v20
    v_sub_f32 v19, v19, v20
    v_mul_f32 v21, v10, v10
    v_fmac_f32 v21, v11, v11
    v_fmac_f32 v21, v12, v12
    v_fmac_f32 v21, v13, v13
    v_fmac_f32 v21, v14, v14
    v_fmac_f32 v21, v15, v15
    v_fmac_f32 v21, v16, v16
    v_fmac_f32 v21, v17, v17
    v_fmac_f32 v21, v18, v18
    v_fmac_f32 v21, v19, v19
    s_nop 1
    v_add_f32 v22, v21, v21 quad_perm:[1,0,3,2] row_mask:0xf bank_mask:0xf
    s_nop 1
    v_add_f32 v22, v22, v22 quad_perm:[2,3,0,1] row_mask:0xf bank_mask:0xf
    s_nop 1
    v_add_f32 v22, v22, v22 row_half_mirror row_mask:0xf bank_mask:0xf
    s_nop 1
    v_add_f32 v22, v22, v22 row_mirror row_mask:0xf bank_mask:0xf
    s_nop 1
    v_readlane_b32 s24, v22, 0
    v_readlane_b32 s25, v22, 16
    v_readlane_b32 s26, v22, 32
    v_readlane_b32 s27, v22, 48
    s_nop 1
    v_mov_b32 v21, s24
    v_add_f32 v21, s25, v21
    v_add_f32 v21, s26, v21
    v_add_f32 v21, s27, v21
    v_mov_b32 v22, 0x3727c5ac
    v_fmac_f32 v22, 0x3acccccd, v21
    v_rsq_f32 v22, v22
    s_nop 0
    v_mul_f32 v10, v10, v22
    v_mul_f32 v11, v11, v22
    v_mul_f32 v12, v12, v22
    v_mul_f32 v13, v13, v22
    v_mul_f32 v14, v14, v22
    v_mul_f32 v15, v15, v22
    v_mul_f32 v16, v16, v22
    v_mul_f32 v17, v17, v22
    v_mul_f32 v18, v18, v22
    v_mul_f32 v19, v19, v22
    v_cvt_pk_bf16_f32 v4, v10, v11
    v_cvt_pk_bf16_f32 v5, v12, v13
    v_cvt_pk_bf16_f32 v6, v14, v15
    v_cvt_pk_bf16_f32 v7, v16, v17
    v_cvt_pk_bf16_f32 v8, v18, v19
    s_add_u32 s23, s22, 0
    buffer_store_dword v4, v23, s[8:11], s23 offen
    s_add_u32 s23, s22, 8192
    buffer_store_dword v5, v23, s[8:11], s23 offen
    s_add_u32 s23, s22, 16384
    buffer_store_dword v6, v23, s[8:11], s23 offen
    s_add_u32 s23, s22, 24576
    buffer_store_dword v7, v23, s[8:11], s23 offen
    s_add_u32 s23, s22, 32768
    buffer_store_dword v8, v23, s[8:11], s23 offen
    s_branch ln_b1_kernel_end
ln_b1_kernel_mem0:
    s_mov_b32 s16, s6
    s_mov_b32 s17, s7
    s_mov_b32 s18, 10240
    s_mov_b32 s19, 0x00020000
    s_sub_u32 s22, 0, s4
    s_and_b32 s22, s22, 0x1fffff
    s_mov_b32 s23, 10551296
    s_buffer_load_dword s24, s[8:11], s23
    s_waitcnt lgkmcnt(0)
    s_and_b32 s24, s24, 8192
    s_add_u32 s22, s22, s24
    s_add_u32 s22, s22, 0
    s_lshl_b32 s25, s13, 6
    v_add_u32 v1, s25, v0
    v_add_u32 v2, 0, v1
    v_and_b32 v3, 7, v2
    v_mul_u32_u24 v3, 1280, v3
    v_lshrrev_b32 v4, 3, v2
    v_lshl_add_u32 v3, v4, 4, v3
    v_lshlrev_b32 v5, 4, v2
    v_add_u32 v5, 20480, v5
    v_lshrrev_b32 v6, 13, v5
    v_lshlrev_b32 v6, 14, v6
    v_and_b32 v5, 8191, v5
    v_add_u32 v5, v5, v6
    v_cmp_gt_u32 vcc, 640, v2
    s_and_saveexec_b64 s[30:31], vcc
    s_cbranch_execz ln_b1_kernel_m0s0
    buffer_load_dwordx4 v[8:11], v3, s[16:19], 0 offen
    s_waitcnt vmcnt(0)
    buffer_store_dwordx4 v[8:11], v5, s[8:11], s22 offen
ln_b1_kernel_m0s0:
    s_mov_b64 exec, s[30:31]
    v_add_u32 v2, 256, v1
    v_and_b32 v3, 7, v2
    v_mul_u32_u24 v3, 1280, v3
    v_lshrrev_b32 v4, 3, v2
    v_lshl_add_u32 v3, v4, 4, v3
    v_lshlrev_b32 v5, 4, v2
    v_add_u32 v5, 20480, v5
    v_lshrrev_b32 v6, 13, v5
    v_lshlrev_b32 v6, 14, v6
    v_and_b32 v5, 8191, v5
    v_add_u32 v5, v5, v6
    v_cmp_gt_u32 vcc, 640, v2
    s_and_saveexec_b64 s[30:31], vcc
    s_cbranch_execz ln_b1_kernel_m0s1
    buffer_load_dwordx4 v[8:11], v3, s[16:19], 0 offen
    s_waitcnt vmcnt(0)
    buffer_store_dwordx4 v[8:11], v5, s[8:11], s22 offen
ln_b1_kernel_m0s1:
    s_mov_b64 exec, s[30:31]
    v_add_u32 v2, 512, v1
    v_and_b32 v3, 7, v2
    v_mul_u32_u24 v3, 1280, v3
    v_lshrrev_b32 v4, 3, v2
    v_lshl_add_u32 v3, v4, 4, v3
    v_lshlrev_b32 v5, 4, v2
    v_add_u32 v5, 20480, v5
    v_lshrrev_b32 v6, 13, v5
    v_lshlrev_b32 v6, 14, v6
    v_and_b32 v5, 8191, v5
    v_add_u32 v5, v5, v6
    v_cmp_gt_u32 vcc, 640, v2
    s_and_saveexec_b64 s[30:31], vcc
    s_cbranch_execz ln_b1_kernel_m0s2
    buffer_load_dwordx4 v[8:11], v3, s[16:19], 0 offen
    s_waitcnt vmcnt(0)
    buffer_store_dwordx4 v[8:11], v5, s[8:11], s22 offen
ln_b1_kernel_m0s2:
    s_mov_b64 exec, s[30:31]
ln_b1_kernel_end:
    s_endpgm
.section .rodata,"a"
.p2align 6
.amdhsa_kernel ln_b1_kernel
  .amdhsa_next_free_vgpr 32
  .amdhsa_next_free_sgpr 48
  .amdhsa_accum_offset 32
  .amdhsa_group_segment_fixed_size 0
  .amdhsa_kernarg_size 104
  .amdhsa_user_sgpr_count 2
  .amdhsa_user_sgpr_kernarg_segment_ptr 1
  .amdhsa_system_sgpr_workgroup_id_x 1
.end_amdhsa_kernel
.text
.globl gemmb_kernel
.p2align 8
.type gemmb_kernel,@function
gemmb_kernel:
    s_cmp_ge_u32 s2, 256
    s_cbranch_scc1 gemmb_kernel_end
    s_load_dwordx2 s[4:5], s[0:1], 96
    v_lshrrev_b32 v1, 6, v0
    v_and_b32 v0, 63, v0
    s_nop 0
    v_readfirstlane_b32 s13, v1
    s_waitcnt lgkmcnt(0)
    s_mov_b32 s8, s4
    s_mov_b32 s9, s5
    s_mov_b32 s10, 268435456
    s_mov_b32 s11, 0x00020000
    s_and_b32 s36, s2, 127
    s_lshr_b32 s37, s2, 7
    s_mul_i32 s14, s37, 32
    s_add_u32 s15, s14, 32
    v_lshlrev_b32 v1, 4, v0
    v_and_b32 v8, 31, v0
    v_lshrrev_b32 v9, 5, v0
    s_cmp_ge_u32 s36, 80
    s_cbranch_scc1 gemmb_kernel_g_qk
    v_lshrrev_b32 v10, 3, v8
    v_and_b32 v11, 7, v8
    v_mul_u32_u24 v12, 20480, v10
    v_lshl_add_u32 v12, v11, 4, v12
    v_lshl_add_u32 v4, v9, 8, v12
    s_mul_i32 s24, s36, 327680
    s_mul_i32 s25, s13, 81920
    s_add_u32 s24, s24, s25
    s_add_u32 s24, s24, 27262976
    buffer_load_dwordx4 a[0:3], v4, s[8:11], s24 offen offset:0
    buffer_load_dwordx4 a[4:7], v4, s[8:11], s24 offen offset:128
    buffer_load_dwordx4 a[8:11], v4, s[8:11], s24 offen offset:512
    buffer_load_dwordx4 a[12:15], v4, s[8:11], s24 offen offset:640
    buffer_load_dwordx4 a[16:19], v4, s[8:11], s24 offen offset:1024
    buffer_load_dwordx4 a[20:23], v4, s[8:11], s24 offen offset:1152
    buffer_load_dwordx4 a[24:27], v4, s[8:11], s24 offen offset:1536
    buffer_load_dwordx4 a[28:31], v4, s[8:11], s24 offen offset:1664
    buffer_load_dwordx4 a[32:35], v4, s[8:11], s24 offen offset:2048
    buffer_load_dwordx4 a[36:39], v4, s[8:11], s24 offen offset:2176
    buffer_load_dwordx4 a[40:43], v4, s[8:11], s24 offen offset:2560
    buffer_load_dwordx4 a[44:47], v4, s[8:11], s24 offen offset:2688
    buffer_load_dwordx4 a[48:51], v4, s[8:11], s24 offen offset:3072
    buffer_load_dwordx4 a[52:55], v4, s[8:11], s24 offen offset:3200
    s_add_u32 s24, s24, 3584
    buffer_load_dwordx4 a[56:59], v4, s[8:11], s24 offen offset:0
    buffer_load_dwordx4 a[60:63], v4, s[8:11], s24 offen offset:128
    buffer_load_dwordx4 a[64:67], v4, s[8:11], s24 offen offset:512
    buffer_load_dwordx4 a[68:71], v4, s[8:11], s24 offen offset:640
    buffer_load_dwordx4 a[72:75], v4, s[8:11], s24 offen offset:1024
    buffer_load_dwordx4 a[76:79], v4, s[8:11], s24 offen offset:1152
    buffer_load_dwordx4 a[80:83], v4, s[8:11], s24 offen offset:1536
    buffer_load_dwordx4 a[84:87], v4, s[8:11], s24 offen offset:1664
    buffer_load_dwordx4 a[88:91], v4, s[8:11], s24 offen offset:2048
    buffer_load_dwordx4 a[92:95], v4, s[8:11], s24 offen offset:2176
    buffer_load_dwordx4 a[96:99], v4, s[8:11], s24 offen offset:2560
    buffer_load_dwordx4 a[100:103], v4, s[8:11], s24 offen offset:2688
    buffer_load_dwordx4 a[104:107], v4, s[8:11], s24 offen offset:3072
    buffer_load_dwordx4 a[108:111], v4, s[8:11], s24 offen offset:3200
    s_add_u32 s24, s24, 3584
    buffer_load_dwordx4 a[112:115], v4, s[8:11], s24 offen offset:0
    buffer_load_dwordx4 a[116:119], v4, s[8:11], s24 offen offset:128
    buffer_load_dwordx4 a[120:123], v4, s[8:11], s24 offen offset:512
    buffer_load_dwordx4 a[124:127], v4, s[8:11], s24 offen offset:640
    buffer_load_dwordx4 a[128:131], v4, s[8:11], s24 offen offset:1024
    buffer_load_dwordx4 a[132:135], v4, s[8:11], s24 offen offset:1152
    buffer_load_dwordx4 a[136:139], v4, s[8:11], s24 offen offset:1536
    buffer_load_dwordx4 a[140:143], v4, s[8:11], s24 offen offset:1664
    buffer_load_dwordx4 a[144:147], v4, s[8:11], s24 offen offset:2048
    buffer_load_dwordx4 a[148:151], v4, s[8:11], s24 offen offset:2176
    buffer_load_dwordx4 a[152:155], v4, s[8:11], s24 offen offset:2560
    buffer_load_dwordx4 a[156:159], v4, s[8:11], s24 offen offset:2688
    buffer_load_dwordx4 a[160:163], v4, s[8:11], s24 offen offset:3072
    buffer_load_dwordx4 a[164:167], v4, s[8:11], s24 offen offset:3200
    s_add_u32 s24, s24, 3584
    buffer_load_dwordx4 a[168:171], v4, s[8:11], s24 offen offset:0
    buffer_load_dwordx4 a[172:175], v4, s[8:11], s24 offen offset:128
    buffer_load_dwordx4 a[176:179], v4, s[8:11], s24 offen offset:512
    buffer_load_dwordx4 a[180:183], v4, s[8:11], s24 offen offset:640
    buffer_load_dwordx4 a[184:187], v4, s[8:11], s24 offen offset:1024
    buffer_load_dwordx4 a[188:191], v4, s[8:11], s24 offen offset:1152
    buffer_load_dwordx4 a[192:195], v4, s[8:11], s24 offen offset:1536
    buffer_load_dwordx4 a[196:199], v4, s[8:11], s24 offen offset:1664
    buffer_load_dwordx4 a[200:203], v4, s[8:11], s24 offen offset:2048
    buffer_load_dwordx4 a[204:207], v4, s[8:11], s24 offen offset:2176
    buffer_load_dwordx4 a[208:211], v4, s[8:11], s24 offen offset:2560
    buffer_load_dwordx4 a[212:215], v4, s[8:11], s24 offen offset:2688
    buffer_load_dwordx4 a[216:219], v4, s[8:11], s24 offen offset:3072
    buffer_load_dwordx4 a[220:223], v4, s[8:11], s24 offen offset:3200
    s_add_u32 s24, s24, 3584
    buffer_load_dwordx4 a[224:227], v4, s[8:11], s24 offen offset:0
    buffer_load_dwordx4 a[228:231], v4, s[8:11], s24 offen offset:128
    buffer_load_dwordx4 a[232:235], v4, s[8:11], s24 offen offset:512
    buffer_load_dwordx4 a[236:239], v4, s[8:11], s24 offen offset:640
    buffer_load_dwordx4 a[240:243], v4, s[8:11], s24 offen offset:1024
    buffer_load_dwordx4 a[244:247], v4, s[8:11], s24 offen offset:1152
    buffer_load_dwordx4 a[248:251], v4, s[8:11], s24 offen offset:1536
    buffer_load_dwordx4 a[252:255], v4, s[8:11], s24 offen offset:1664
    buffer_load_dwordx4 v[192:195], v4, s[8:11], s24 offen offset:2048
    buffer_load_dwordx4 v[196:199], v4, s[8:11], s24 offen offset:2176
    buffer_load_dwordx4 v[200:203], v4, s[8:11], s24 offen offset:2560
    buffer_load_dwordx4 v[204:207], v4, s[8:11], s24 offen offset:2688
    buffer_load_dwordx4 v[208:211], v4, s[8:11], s24 offen offset:3072
    buffer_load_dwordx4 v[212:215], v4, s[8:11], s24 offen offset:3200
    s_add_u32 s24, s24, 3584
    buffer_load_dwordx4 v[216:219], v4, s[8:11], s24 offen offset:0
    buffer_load_dwordx4 v[220:223], v4, s[8:11], s24 offen offset:128
    buffer_load_dwordx4 v[224:227], v4, s[8:11], s24 offen offset:512
    buffer_load_dwordx4 v[228:231], v4, s[8:11], s24 offen offset:640
    buffer_load_dwordx4 v[232:235], v4, s[8:11], s24 offen offset:1024
    buffer_load_dwordx4 v[236:239], v4, s[8:11], s24 offen offset:1152
    buffer_load_dwordx4 v[240:243], v4, s[8:11], s24 offen offset:1536
    buffer_load_dwordx4 v[244:247], v4, s[8:11], s24 offen offset:1664
    buffer_load_dwordx4 v[248:251], v4, s[8:11], s24 offen offset:2048
    buffer_load_dwordx4 v[252:255], v4, s[8:11], s24 offen offset:2176
    s_lshl_b32 s25, s13, 3
    v_add_u32 v10, s25, v10
    v_mul_u32_u24 v10, 640, v10
    v_lshl_add_u32 v10, v9, 7, v10
    v_lshl_add_u32 v10, v11, 4, v10
    v_add_u32 v3, 128, v10
    s_mul_i32 s17, s36, 20480
    s_mul_i32 s25, s14, 1638400
    s_add_u32 s17, s17, s25
    s_add_u32 s17, s17, 103809024
    s_mov_b32 s20, 1638400
    s_mul_i32 s19, s13, 10240
    s_add_u32 s19, s19, 220200960
    s_mov_b32 s22, 0
    s_min_u32 s24, s14, 63
    s_mul_i32 s24, s24, 40960
    s_add_u32 s24, s24, s19
    s_mul_i32 s25, s13, 10240
    s_add_u32 s25, s25, s22
    s_mov_b32 m0, s25
    s_nop 0
    buffer_load_dwordx4 v1, s[8:11], s24 offen offset:0 lds
    buffer_load_dwordx4 v1, s[8:11], s24 offen offset:1024 lds
    buffer_load_dwordx4 v1, s[8:11], s24 offen offset:2048 lds
    buffer_load_dwordx4 v1, s[8:11], s24 offen offset:3072 lds
    s_add_u32 s24, s24, 4096
    s_add_u32 s25, s25, 4096
    s_mov_b32 m0, s25
    s_nop 0
    buffer_load_dwordx4 v1, s[8:11], s24 offen offset:0 lds
    buffer_load_dwordx4 v1, s[8:11], s24 offen offset:1024 lds
    buffer_load_dwordx4 v1, s[8:11], s24 offen offset:2048 lds
    buffer_load_dwordx4 v1, s[8:11], s24 offen offset:3072 lds
    s_add_u32 s24, s24, 4096
    s_add_u32 s25, s25, 4096
    s_mov_b32 m0, s25
    s_nop 0
    buffer_load_dwordx4 v1, s[8:11], s24 offen offset:0 lds
    buffer_load_dwordx4 v1, s[8:11], s24 offen offset:1024 lds
    s_mov_b32 s22, 40960
    s_add_u32 s23, s14, 1
    s_min_u32 s24, s23, 63
    s_mul_i32 s24, s24, 40960
    s_add_u32 s24, s24, s19
    s_mul_i32 s25, s13, 10240
    s_add_u32 s25, s25, s22
    s_mov_b32 m0, s25
    s_nop 0
    buffer_load_dwordx4 v1, s[8:11], s24 offen offset:0 lds
    buffer_load_dwordx4 v1, s[8:11], s24 offen offset:1024 lds
    buffer_load_dwordx4 v1, s[8:11], s24 offen offset:2048 lds
    buffer_load_dwordx4 v1, s[8:11], s24 offen offset:3072 lds
    s_add_u32 s24, s24, 4096
    s_add_u32 s25, s25, 4096
    s_mov_b32 m0, s25
    s_nop 0
    buffer_load_dwordx4 v1, s[8:11], s24 offen offset:0 lds
    buffer_load_dwordx4 v1, s[8:11], s24 offen offset:1024 lds
    buffer_load_dwordx4 v1, s[8:11], s24 offen offset:2048 lds
    buffer_load_dwordx4 v1, s[8:11], s24 offen offset:3072 lds
    s_add_u32 s24, s24, 4096
    s_add_u32 s25, s25, 4096
    s_mov_b32 m0, s25
    s_nop 0
    buffer_load_dwordx4 v1, s[8:11], s24 offen offset:0 lds
    buffer_load_dwordx4 v1, s[8:11], s24 offen offset:1024 lds
    s_mov_b32 s22, 81920
    s_mov_b32 s16, 0
    s_waitcnt vmcnt(10)
    s_barrier
    v_mov_b32 v2, v1
    ds_read_b128 v[8:11], v2 offset:0
    ds_read_b128 v[12:15], v2 offset:1024
    ds_read_b128 v[16:19], v2 offset:2048
    ds_read_b128 v[20:23], v2 offset:3072
    ds_read_b128 v[24:27], v2 offset:4096
    ds_read_b128 v[28:31], v2 offset:5120
    ds_read_b128 v[32:35], v2 offset:6144
    s_waitcnt lgkmcnt(6)
    v_mfma_f32_32x32x16_bf16 v[40:55], v[8:11], a[0:3], 0
    v_mfma_f32_32x32x16_bf16 v[56:71], v[8:11], a[4:7], 0
    ds_read_b128 v[36:39], v2 offset:7168
    s_waitcnt lgkmcnt(6)
    v_mfma_f32_32x32x16_bf16 v[40:55], v[12:15], a[8:11], v[40:55]
    v_mfma_f32_32x32x16_bf16 v[56:71], v[12:15], a[12:15], v[56:71]
    ds_read_b128 v[8:11], v2 offset:8192
    s_waitcnt lgkmcnt(6)
    v_mfma_f32_32x32x16_bf16 v[40:55], v[16:19], a[16:19], v[40:55]
    v_mfma_f32_32x32x16_bf16 v[56:71], v[16:19], a[20:23], v[56:71]
    ds_read_b128 v[12:15], v2 offset:9216
    s_waitcnt lgkmcnt(6)
    v_mfma_f32_32x32x16_bf16 v[40:55], v[20:23], a[24:27], v[40:55]
    v_mfma_f32_32x32x16_bf16 v[56:71], v[20:23], a[28:31], v[56:71]
    ds_read_b128 v[16:19], v2 offset:10240
    s_waitcnt lgkmcnt(6)
    v_mfma_f32_32x32x16_bf16 v[40:55], v[24:27], a[32:35], v[40:55]
    v_mfma_f32_32x32x16_bf16 v[56:71], v[24:27], a[36:39], v[56:71]
    ds_read_b128 v[20:23], v2 offset:11264
    s_waitcnt lgkmcnt(6)
    v_mfma_f32_32x32x16_bf16 v[40:55], v[28:31], a[40:43], v[40:55]
    v_mfma_f32_32x32x16_bf16 v[56:71], v[28:31], a[44:47], v[56:71]
    ds_read_b128 v[24:27], v2 offset:12288
    s_waitcnt lgkmcnt(6)
    v_mfma_f32_32x32x16_bf16 v[40:55], v[32:35], a[48:51], v[40:55]
    v_mfma_f32_32x32x16_bf16 v[56:71], v[32:35], a[52:55], v[56:71]
    ds_read_b128 v[28:31], v2 offset:13312
    s_waitcnt lgkmcnt(6)
    v_mfma_f32_32x32x16_bf16 v[40:55], v[36:39], a[56:59], v[40:55]
    v_mfma_f32_32x32x16_bf16 v[56:71], v[36:39], a[60:63], v[56:71]
    ds_read_b128 v[32:35], v2 offset:14336
    s_waitcnt lgkmcnt(6)
    v_mfma_f32_32x32x16_bf16 v[40:55], v[8:11], a[64:67], v[40:55]
    v_mfma_f32_32x32x16_bf16 v[56:71], v[8:11], a[68:71], v[56:71]
    ds_read_b128 v[36:39], v2 offset:15360
    s_waitcnt lgkmcnt(6)
    v_mfma_f32_32x32x16_bf16 v[40:55], v[12:15], a[72:75], v[40:55]
    v_mfma_f32_32x32x16_bf16 v[56:71], v[12:15], a[76:79], v[56:71]
    ds_read_b128 v[8:11], v2 offset:16384
    s_waitcnt lgkmcnt(6)
    v_mfma_f32_32x32x16_bf16 v[40:55], v[16:19], a[80:83], v[40:55]
    v_mfma_f32_32x32x16_bf16 v[56:71], v[16:19], a[84:87], v[56:71]
    ds_read_b128 v[12:15], v2 offset:17408
    s_waitcnt lgkmcnt(6)
    v_mfma_f32_32x32x16_bf16 v[40:55], v[20:23], a[88:91], v[40:55]
    v_mfma_f32_32x32x16_bf16 v[56:71], v[20:23], a[92:95], v[56:71]
    ds_read_b128 v[16:19], v2 offset:18432
    s_waitcnt lgkmcnt(6)
    v_mfma_f32_32x32x16_bf16 v[40:55], v[24:27], a[96:99], v[40:55]
    v_mfma_f32_32x32x16_bf16 v[56:71], v[24:27], a[100:103], v[56:71]
    ds_read_b128 v[20:23], v2 offset:19456
    s_waitcnt lgkmcnt(6)
    v_mfma_f32_32x32x16_bf16 v[40:55], v[28:31], a[104:107], v[40:55]
    v_mfma_f32_32x32x16_bf16 v[56:71], v[28:31], a[108:111], v[56:71]
    ds_read_b128 v[24:27], v2 offset:20480
    s_waitcnt lgkmcnt(6)
    v_mfma_f32_32x32x16_bf16 v[40:55], v[32:35], a[112:115], v[40:55]
    v_mfma_f32_32x32x16_bf16 v[56:71], v[32:35], a[116:119], v[56:71]
    ds_read_b128 v[28:31], v2 offset:21504
    s_waitcnt lgkmcnt(6)
    v_mfma_f32_32x32x16_bf16 v[40:55], v[36:39], a[120:123], v[40:55]
    v_mfma_f32_32x32x16_bf16 v[56:71], v[36:39], a[124:127], v[56:71]
    ds_read_b128 v[32:35], v2 offset:22528
    s_waitcnt lgkmcnt(6)
    v_mfma_f32_32x32x16_bf16 v[40:55], v[8:11], a[128:131], v[40:55]
    v_mfma_f32_32x32x16_bf16 v[56:71], v[8:11], a[132:135], v[56:71]
    ds_read_b128 v[36:39], v2 offset:23552
    s_waitcnt lgkmcnt(6)
    v_mfma_f32_32x32x16_bf16 v[40:55], v[12:15], a[136:139], v[40:55]
    v_mfma_f32_32x32x16_bf16 v[56:71], v[12:15], a[140:143], v[56:71]
    ds_read_b128 v[8:11], v2 offset:24576
    s_waitcnt lgkmcnt(6)
    v_mfma_f32_32x32x16_bf16 v[40:55], v[16:19], a[144:147], v[40:55]
    v_mfma_f32_32x32x16_bf16 v[56:71], v[16:19], a[148:151], v[56:71]
    ds_read_b128 v[12:15], v2 offset:25600
    s_waitcnt lgkmcnt(6)
    v_mfma_f32_32x32x16_bf16 v[40:55], v[20:23], a[152:155], v[40:55]
    v_mfma_f32_32x32x16_bf16 v[56:71], v[20:23], a[156:159], v[56:71]
    ds_read_b128 v[16:19], v2 offset:26624
    s_waitcnt lgkmcnt(6)
    v_mfma_f32_32x32x16_bf16 v[40:55], v[24:27], a[160:163], v[40:55]
    v_mfma_f32_32x32x16_bf16 v[56:71], v[24:27], a[164:167], v[56:71]
    ds_read_b128 v[20:23], v2 offset:27648
    s_waitcnt lgkmcnt(6)
    v_mfma_f32_32x32x16_bf16 v[40:55], v[28:31], a[168:171], v[40:55]
    v_mfma_f32_32x32x16_bf16 v[56:71], v[28:31], a[172:175], v[56:71]
    ds_read_b128 v[24:27], v2 offset:28672
    s_waitcnt lgkmcnt(6)
    v_mfma_f32_32x32x16_bf16 v[40:55], v[32:35], a[176:179], v[40:55]
    v_mfma_f32_32x32x16_bf16 v[56:71], v[32:35], a[180:183], v[56:71]
    ds_read_b128 v[28:31], v2 offset:29696
    s_waitcnt lgkmcnt(6)
    v_mfma_f32_32x32x16_bf16 v[40:55], v[36:39], a[184:187], v[40:55]
    v_mfma_f32_32x32x16_bf16 v[56:71], v[36:39], a[188:191], v[56:71]
    ds_read_b128 v[32:35], v2 offset:30720
    s_waitcnt lgkmcnt(6)
    v_mfma_f32_32x32x16_bf16 v[40:55], v[8:11], a[192:195], v[40:55]
    v_mfma_f32_32x32x16_bf16 v[56:71], v[8:11], a[196:199], v[56:71]
    ds_read_b128 v[36:39], v2 offset:31744
    s_waitcnt lgkmcnt(6)
    v_mfma_f32_32x32x16_bf16 v[40:55], v[12:15], a[200:203], v[40:55]
    v_mfma_f32_32x32x16_bf16 v[56:71], v[12:15], a[204:207], v[56:71]
    ds_read_b128 v[8:11], v2 offset:32768
    s_waitcnt lgkmcnt(6)
    v_mfma_f32_32x32x16_bf16 v[40:55], v[16:19], a[208:211], v[40:55]
    v_mfma_f32_32x32x16_bf16 v[56:71], v[16:19], a[212:215], v[56:71]
    ds_read_b128 v[12:15], v2 offset:33792
    s_waitcnt lgkmcnt(6)
    v_mfma_f32_32x32x16_bf16 v[40:55], v[20:23], a[216:219], v[40:55]
    v_mfma_f32_32x32x16_bf16 v[56:71], v[20:23], a[220:223], v[56:71]
    ds_read_b128 v[16:19], v2 offset:34816
    s_waitcnt lgkmcnt(6)
    v_mfma_f32_32x32x16_bf16 v[40:55], v[24:27], a[224:227], v[40:55]
    v_mfma_f32_32x32x16_bf16 v[56:71], v[24:27], a[228:231], v[56:71]
    s_waitcnt vmcnt(0)
    s_barrier
    s_add_u32 s21, s16, 40960
    s_cmp_eq_u32 s21, 122880
    s_cselect_b32 s21, 0, s21
    s_add_u32 s23, s14, 2
    s_min_u32 s24, s23, 63
    s_mul_i32 s24, s24, 40960
    s_add_u32 s24, s24, s19
    s_mul_i32 s25, s13, 10240
    s_add_u32 s25, s25, s22
    s_mov_b32 m0, s25
    s_nop 0
    buffer_load_dwordx4 v1, s[8:11], s24 offen offset:0 lds
    buffer_load_dwordx4 v1, s[8:11], s24 offen offset:1024 lds
    buffer_load_dwordx4 v1, s[8:11], s24 offen offset:2048 lds
    buffer_load_dwordx4 v1, s[8:11], s24 offen offset:3072 lds
    s_add_u32 s24, s24, 4096
    s_add_u32 s25, s25, 4096
    s_mov_b32 m0, s25
    s_nop 0
    buffer_load_dwordx4 v1, s[8:11], s24 offen offset:0 lds
    buffer_load_dwordx4 v1, s[8:11], s24 offen offset:1024 lds
    buffer_load_dwordx4 v1, s[8:11], s24 offen offset:2048 lds
    buffer_load_dwordx4 v1, s[8:11], s24 offen offset:3072 lds
    s_add_u32 s24, s24, 4096
    s_add_u32 s25, s25, 4096
    s_mov_b32 m0, s25
    s_nop 0
    buffer_load_dwordx4 v1, s[8:11], s24 offen offset:0 lds
    buffer_load_dwordx4 v1, s[8:11], s24 offen offset:1024 lds
    s_add_u32 s22, s22, 40960
    s_cmp_eq_u32 s22, 122880
    s_cselect_b32 s22, 0, s22
    ds_read_b128 v[20:23], v2 offset:35840
    s_waitcnt lgkmcnt(6)
    v_mfma_f32_32x32x16_bf16 v[40:55], v[28:31], a[232:235], v[40:55]
    v_mfma_f32_32x32x16_bf16 v[56:71], v[28:31], a[236:239], v[56:71]
    ds_read_b128 v[24:27], v2 offset:36864
    s_waitcnt lgkmcnt(6)
    v_mfma_f32_32x32x16_bf16 v[40:55], v[32:35], a[240:243], v[40:55]
    v_mfma_f32_32x32x16_bf16 v[56:71], v[32:35], a[244:247], v[56:71]
    ds_read_b128 v[28:31], v2 offset:37888
    s_waitcnt lgkmcnt(6)
    v_mfma_f32_32x32x16_bf16 v[40:55], v[36:39], a[248:251], v[40:55]
    v_mfma_f32_32x32x16_bf16 v[56:71], v[36:39], a[252:255], v[56:71]
    ds_read_b128 v[32:35], v2 offset:38912
    s_waitcnt lgkmcnt(6)
    v_mfma_f32_32x32x16_bf16 v[40:55], v[8:11], v[192:195], v[40:55]
    v_mfma_f32_32x32x16_bf16 v[56:71], v[8:11], v[196:199], v[56:71]
    ds_read_b128 v[36:39], v2 offset:39936
    s_waitcnt lgkmcnt(6)
    v_mfma_f32_32x32x16_bf16 v[40:55], v[12:15], v[200:203], v[40:55]
    v_mfma_f32_32x32x16_bf16 v[56:71], v[12:15], v[204:207], v[56:71]
    v_add_u32 v6, s21, v1
    ds_read_b128 v[8:11], v6 offset:0
    s_waitcnt lgkmcnt(6)
    v_mfma_f32_32x32x16_bf16 v[40:55], v[16:19], v[208:211], v[40:55]
    v_mfma_f32_32x32x16_bf16 v[56:71], v[16:19], v[212:215], v[56:71]
    ds_read_b128 v[12:15], v6 offset:1024
    s_waitcnt lgkmcnt(6)
    v_mfma_f32_32x32x16_bf16 v[40:55], v[20:23], v[216:219], v[40:55]
    v_mfma_f32_32x32x16_bf16 v[56:71], v[20:23], v[220:223], v[56:71]
    ds_read_b128 v[16:19], v6 offset:2048
    s_waitcnt lgkmcnt(6)
    v_mfma_f32_32x32x16_bf16 v[40:55], v[24:27], v[224:227], v[40:55]
    v_mfma_f32_32x32x16_bf16 v[56:71], v[24:27], v[228:231], v[56:71]
    ds_read_b128 v[20:23], v6 offset:3072
    s_waitcnt lgkmcnt(6)
    v_mfma_f32_32x32x16_bf16 v[40:55], v[28:31], v[232:235], v[40:55]
    v_mfma_f32_32x32x16_bf16 v[56:71], v[28:31], v[236:239], v[56:71]
    ds_read_b128 v[24:27], v6 offset:4096
    s_waitcnt lgkmcnt(6)
    v_mfma_f32_32x32x16_bf16 v[40:55], v[32:35], v[240:243], v[40:55]
    v_mfma_f32_32x32x16_bf16 v[56:71], v[32:35], v[244:247], v[56:71]
    ds_read_b128 v[28:31], v6 offset:5120
    s_waitcnt lgkmcnt(6)
    v_mfma_f32_32x32x16_bf16 v[40:55], v[36:39], v[248:251], v[40:55]
    v_mfma_f32_32x32x16_bf16 v[56:71], v[36:39], v[252:255], v[56:71]
    v_mov_b32 v2, v6
    s_mov_b32 s16, s21
    s_add_u32 s14, s14, 1
    s_cmp_ge_u32 s14, s15
    s_cbranch_scc1 gemmb_kernel_gu_fin0
gemmb_kernel_gu_loop:
    ds_read_b128 v[32:35], v2 offset:6144
    s_waitcnt lgkmcnt(6)
    v_mfma_f32_32x32x16_bf16 v[72:87], v[8:11], a[0:3], 0
    v_mfma_f32_32x32x16_bf16 v[88:103], v[8:11], a[4:7], 0
    ds_read_b128 v[36:39], v2 offset:7168
    s_waitcnt lgkmcnt(6)
    v_mfma_f32_32x32x16_bf16 v[72:87], v[12:15], a[8:11], v[72:87]
    v_mfma_f32_32x32x16_bf16 v[88:103], v[12:15], a[12:15], v[88:103]
    ds_read_b128 v[8:11], v2 offset:8192
    s_waitcnt lgkmcnt(6)
    v_mfma_f32_32x32x16_bf16 v[72:87], v[16:19], a[16:19], v[72:87]
    v_cvt_pk_bf16_f32 v104, v40, v41
    v_mfma_f32_32x32x16_bf16 v[88:103], v[16:19], a[20:23], v[88:103]
    v_cvt_pk_bf16_f32 v105, v42, v43
    ds_read_b128 v[12:15], v2 offset:9216
    s_waitcnt lgkmcnt(6)
    v_mfma_f32_32x32x16_bf16 v[72:87], v[20:23], a[24:27], v[72:87]
    v_cvt_pk_bf16_f32 v106, v44, v45
    v_mfma_f32_32x32x16_bf16 v[88:103], v[20:23], a[28:31], v[88:103]
    v_cvt_pk_bf16_f32 v107, v46, v47
    ds_read_b128 v[16:19], v2 offset:10240
    s_waitcnt lgkmcnt(6)
    v_mfma_f32_32x32x16_bf16 v[72:87], v[24:27], a[32:35], v[72:87]
    s_nop 1
    v_mfma_f32_32x32x16_bf16 v[88:103], v[24:27], a[36:39], v[88:103]
    v_permlane32_swap_b32 v104, v106
    ds_read_b128 v[20:23], v2 offset:11264
    s_waitcnt lgkmcnt(6)
    v_mfma_f32_32x32x16_bf16 v[72:87], v[28:31], a[40:43], v[72:87]
    v_permlane32_swap_b32 v105, v107
    v_mfma_f32_32x32x16_bf16 v[88:103], v[28:31], a[44:47], v[88:103]
    buffer_store_dwordx4 v[104:107], v3, s[8:11], s17 offen offset:0
    ds_read_b128 v[24:27], v2 offset:12288
    s_waitcnt lgkmcnt(6)
    v_mfma_f32_32x32x16_bf16 v[72:87], v[32:35], a[48:51], v[72:87]
    v_cvt_pk_bf16_f32 v108, v48, v49
    v_mfma_f32_32x32x16_bf16 v[88:103], v[32:35], a[52:55], v[88:103]
    v_cvt_pk_bf16_f32 v109, v50, v51
    ds_read_b128 v[28:31], v2 offset:13312
    s_waitcnt lgkmcnt(6)
    v_mfma_f32_32x32x16_bf16 v[72:87], v[36:39], a[56:59], v[72:87]
    v_cvt_pk_bf16_f32 v110, v52, v53
    v_mfma_f32_32x32x16_bf16 v[88:103], v[36:39], a[60:63], v[88:103]
    v_cvt_pk_bf16_f32 v111, v54, v55
    ds_read_b128 v[32:35], v2 offset:14336
    s_waitcnt lgkmcnt(6)
    v_mfma_f32_32x32x16_bf16 v[72:87], v[8:11], a[64:67], v[72:87]
    s_nop 1
    v_mfma_f32_32x32x16_bf16 v[88:103], v[8:11], a[68:71], v[88:103]
    v_permlane32_swap_b32 v108, v110
    ds_read_b128 v[36:39], v2 offset:15360
    s_waitcnt lgkmcnt(6)
    v_mfma_f32_32x32x16_bf16 v[72:87], v[12:15], a[72:75], v[72:87]
    v_permlane32_swap_b32 v109, v111
    v_mfma_f32_32x32x16_bf16 v[88:103], v[12:15], a[76:79], v[88:103]
    buffer_store_dwordx4 v[108:111], v3, s[8:11], s17 offen offset:256
    ds_read_b128 v[8:11], v2 offset:16384
    s_waitcnt lgkmcnt(6)
    v_mfma_f32_32x32x16_bf16 v[72:87], v[16:19], a[80:83], v[72:87]
    v_cvt_pk_bf16_f32 v112, v56, v57
    v_mfma_f32_32x32x16_bf16 v[88:103], v[16:19], a[84:87], v[88:103]
    v_cvt_pk_bf16_f32 v113, v58, v59
    ds_read_b128 v[12:15], v2 offset:17408
    s_waitcnt lgkmcnt(6)
    v_mfma_f32_32x32x16_bf16 v[72:87], v[20:23], a[88:91], v[72:87]
    v_cvt_pk_bf16_f32 v114, v60, v61
    v_mfma_f32_32x32x16_bf16 v[88:103], v[20:23], a[92:95], v[88:103]
    v_cvt_pk_bf16_f32 v115, v62, v63
    ds_read_b128 v[16:19], v2 offset:18432
    s_waitcnt lgkmcnt(6)
    v_mfma_f32_32x32x16_bf16 v[72:87], v[24:27], a[96:99], v[72:87]
    s_nop 1
    v_mfma_f32_32x32x16_bf16 v[88:103], v[24:27], a[100:103], v[88:103]
    v_permlane32_swap_b32 v112, v114
    ds_read_b128 v[20:23], v2 offset:19456
    s_waitcnt lgkmcnt(6)
    v_mfma_f32_32x32x16_bf16 v[72:87], v[28:31], a[104:107], v[72:87]
    v_permlane32_swap_b32 v113, v115
    v_mfma_f32_32x32x16_bf16 v[88:103], v[28:31], a[108:111], v[88:103]
    buffer_store_dwordx4 v[112:115], v3, s[8:11], s17 offen offset:2560
    ds_read_b128 v[24:27], v2 offset:20480
    s_waitcnt lgkmcnt(6)
    v_mfma_f32_32x32x16_bf16 v[72:87], v[32:35], a[112:115], v[72:87]
    v_cvt_pk_bf16_f32 v116, v64, v65
    v_mfma_f32_32x32x16_bf16 v[88:103], v[32:35], a[116:119], v[88:103]
    v_cvt_pk_bf16_f32 v117, v66, v67
    ds_read_b128 v[28:31], v2 offset:21504
    s_waitcnt lgkmcnt(6)
    v_mfma_f32_32x32x16_bf16 v[72:87], v[36:39], a[120:123], v[72:87]
    v_cvt_pk_bf16_f32 v118, v68, v69
    v_mfma_f32_32x32x16_bf16 v[88:103], v[36:39], a[124:127], v[88:103]
    v_cvt_pk_bf16_f32 v119, v70, v71
    ds_read_b128 v[32:35], v2 offset:22528
    s_waitcnt lgkmcnt(6)
    v_mfma_f32_32x32x16_bf16 v[72:87], v[8:11], a[128:131], v[72:87]
    s_nop 1
    v_mfma_f32_32x32x16_bf16 v[88:103], v[8:11], a[132:135], v[88:103]
    v_permlane32_swap_b32 v116, v118
    ds_read_b128 v[36:39], v2 offset:23552
    s_waitcnt lgkmcnt(6)
    v_mfma_f32_32x32x16_bf16 v[72:87], v[12:15], a[136:139], v[72:87]
    v_permlane32_swap_b32 v117, v119
    v_mfma_f32_32x32x16_bf16 v[88:103], v[12:15], a[140:143], v[88:103]
    buffer_store_dwordx4 v[116:119], v3, s[8:11], s17 offen offset:2816
    ds_read_b128 v[8:11], v2 offset:24576
    s_waitcnt lgkmcnt(6)
    v_mfma_f32_32x32x16_bf16 v[72:87], v[16:19], a[144:147], v[72:87]
    s_add_u32 s17, s17, s20
    v_mfma_f32_32x32x16_bf16 v[88:103], v[16:19], a[148:151], v[88:103]
    s_add_u32 s18, s18, s20
    ds_read_b128 v[12:15], v2 offset:25600
    s_waitcnt lgkmcnt(6)
    v_mfma_f32_32x32x16_bf16 v[72:87], v[20:23], a[152:155], v[72:87]
    v_mfma_f32_32x32x16_bf16 v[88:103], v[20:23], a[156:159], v[88:103]
    ds_read_b128 v[16:19], v2 offset:26624
    s_waitcnt lgkmcnt(6)
    v_mfma_f32_32x32x16_bf16 v[72:87], v[24:27], a[160:163], v[72:87]
    v_mfma_f32_32x32x16_bf16 v[88:103], v[24:27], a[164:167], v[88:103]
    ds_read_b128 v[20:23], v2 offset:27648
    s_waitcnt lgkmcnt(6)
    v_mfma_f32_32x32x16_bf16 v[72:87], v[28:31], a[168:171], v[72:87]
    v_mfma_f32_32x32x16_bf16 v[88:103], v[28:31], a[172:175], v[88:103]
    ds_read_b128 v[24:27], v2 offset:28672
    s_waitcnt lgkmcnt(6)
    v_mfma_f32_32x32x16_bf16 v[72:87], v[32:35], a[176:179], v[72:87]
    v_mfma_f32_32x32x16_bf16 v[88:103], v[32:35], a[180:183], v[88:103]
    ds_read_b128 v[28:31], v2 offset:29696
    s_waitcnt lgkmcnt(6)
    v_mfma_f32_32x32x16_bf16 v[72:87], v[36:39], a[184:187], v[72:87]
    v_mfma_f32_32x32x16_bf16 v[88:103], v[36:39], a[188:191], v[88:103]
    ds_read_b128 v[32:35], v2 offset:30720
    s_waitcnt lgkmcnt(6)
    v_mfma_f32_32x32x16_bf16 v[72:87], v[8:11], a[192:195], v[72:87]
    v_mfma_f32_32x32x16_bf16 v[88:103], v[8:11], a[196:199], v[88:103]
    ds_read_b128 v[36:39], v2 offset:31744
    s_waitcnt lgkmcnt(6)
    v_mfma_f32_32x32x16_bf16 v[72:87], v[12:15], a[200:203], v[72:87]
    v_mfma_f32_32x32x16_bf16 v[88:103], v[12:15], a[204:207], v[88:103]
    ds_read_b128 v[8:11], v2 offset:32768
    s_waitcnt lgkmcnt(6)
    v_mfma_f32_32x32x16_bf16 v[72:87], v[16:19], a[208:211], v[72:87]
    v_mfma_f32_32x32x16_bf16 v[88:103], v[16:19], a[212:215], v[88:103]
    ds_read_b128 v[12:15], v2 offset:33792
    s_waitcnt lgkmcnt(6)
    v_mfma_f32_32x32x16_bf16 v[72:87], v[20:23], a[216:219], v[72:87]
    v_mfma_f32_32x32x16_bf16 v[88:103], v[20:23], a[220:223], v[88:103]
    ds_read_b128 v[16:19], v2 offset:34816
    s_waitcnt lgkmcnt(6)
    v_mfma_f32_32x32x16_bf16 v[72:87], v[24:27], a[224:227], v[72:87]
    v_mfma_f32_32x32x16_bf16 v[88:103], v[24:27], a[228:231], v[88:103]
    s_waitcnt vmcnt(0)
    s_barrier
    s_add_u32 s21, s16, 40960
    s_cmp_eq_u32 s21, 122880
    s_cselect_b32 s21, 0, s21
    s_add_u32 s23, s14, 2
    s_min_u32 s24, s23, 63
    s_mul_i32 s24, s24, 40960
    s_add_u32 s24, s24, s19
    s_mul_i32 s25, s13, 10240
    s_add_u32 s25, s25, s22
    s_mov_b32 m0, s25
    s_nop 0
    buffer_load_dwordx4 v1, s[8:11], s24 offen offset:0 lds
    buffer_load_dwordx4 v1, s[8:11], s24 offen offset:1024 lds
    buffer_load_dwordx4 v1, s[8:11], s24 offen offset:2048 lds
    buffer_load_dwordx4 v1, s[8:11], s24 offen offset:3072 lds
    s_add_u32 s24, s24, 4096
    s_add_u32 s25, s25, 4096
    s_mov_b32 m0, s25
    s_nop 0
    buffer_load_dwordx4 v1, s[8:11], s24 offen offset:0 lds
    buffer_load_dwordx4 v1, s[8:11], s24 offen offset:1024 lds
    buffer_load_dwordx4 v1, s[8:11], s24 offen offset:2048 lds
    buffer_load_dwordx4 v1, s[8:11], s24 offen offset:3072 lds
    s_add_u32 s24, s24, 4096
    s_add_u32 s25, s25, 4096
    s_mov_b32 m0, s25
    s_nop 0
    buffer_load_dwordx4 v1, s[8:11], s24 offen offset:0 lds
    buffer_load_dwordx4 v1, s[8:11], s24 offen offset:1024 lds
    s_add_u32 s22, s22, 40960
    s_cmp_eq_u32 s22, 122880
    s_cselect_b32 s22, 0, s22
    ds_read_b128 v[20:23], v2 offset:35840
    s_waitcnt lgkmcnt(6)
    v_mfma_f32_32x32x16_bf16 v[72:87], v[28:31], a[232:235], v[72:87]
    v_mfma_f32_32x32x16_bf16 v[88:103], v[28:31], a[236:239], v[88:103]
    ds_read_b128 v[24:27], v2 offset:36864
    s_waitcnt lgkmcnt(6)
    v_mfma_f32_32x32x16_bf16 v[72:87], v[32:35], a[240:243], v[72:87]
    v_mfma_f32_32x32x16_bf16 v[88:103], v[32:35], a[244:247], v[88:103]
    ds_read_b128 v[28:31], v2 offset:37888
    s_waitcnt lgkmcnt(6)
    v_mfma_f32_32x32x16_bf16 v[72:87], v[36:39], a[248:251], v[72:87]
    v_mfma_f32_32x32x16_bf16 v[88:103], v[36:39], a[252:255], v[88:103]
    ds_read_b128 v[32:35], v2 offset:38912
    s_waitcnt lgkmcnt(6)
    v_mfma_f32_32x32x16_bf16 v[72:87], v[8:11], v[192:195], v[72:87]
    v_mfma_f32_32x32x16_bf16 v[88:103], v[8:11], v[196:199], v[88:103]
    ds_read_b128 v[36:39], v2 offset:39936
    s_waitcnt lgkmcnt(6)
    v_mfma_f32_32x32x16_bf16 v[72:87], v[12:15], v[200:203], v[72:87]
    v_mfma_f32_32x32x16_bf16 v[88:103], v[12:15], v[204:207], v[88:103]
    v_add_u32 v6, s21, v1
    ds_read_b128 v[8:11], v6 offset:0
    s_waitcnt lgkmcnt(6)
    v_mfma_f32_32x32x16_bf16 v[72:87], v[16:19], v[208:211], v[72:87]
    v_mfma_f32_32x32x16_bf16 v[88:103], v[16:19], v[212:215], v[88:103]
    ds_read_b128 v[12:15], v6 offset:1024
    s_waitcnt lgkmcnt(6)
    v_mfma_f32_32x32x16_bf16 v[72:87], v[20:23], v[216:219], v[72:87]
    v_mfma_f32_32x32x16_bf16 v[88:103], v[20:23], v[220:223], v[88:103]
    ds_read_b128 v[16:19], v6 offset:2048
    s_waitcnt lgkmcnt(6)
    v_mfma_f32_32x32x16_bf16 v[72:87], v[24:27], v[224:227], v[72:87]
    v_mfma_f32_32x32x16_bf16 v[88:103], v[24:27], v[228:231], v[88:103]
    ds_read_b128 v[20:23], v6 offset:3072
    s_waitcnt lgkmcnt(6)
    v_mfma_f32_32x32x16_bf16 v[72:87], v[28:31], v[232:235], v[72:87]
    v_mfma_f32_32x32x16_bf16 v[88:103], v[28:31], v[236:239], v[88:103]
    ds_read_b128 v[24:27], v6 offset:4096
    s_waitcnt lgkmcnt(6)
    v_mfma_f32_32x32x16_bf16 v[72:87], v[32:35], v[240:243], v[72:87]
    v_mfma_f32_32x32x16_bf16 v[88:103], v[32:35], v[244:247], v[88:103]
    ds_read_b128 v[28:31], v6 offset:5120
    s_waitcnt lgkmcnt(6)
    v_mfma_f32_32x32x16_bf16 v[72:87], v[36:39], v[248:251], v[72:87]
    v_mfma_f32_32x32x16_bf16 v[88:103], v[36:39], v[252:255], v[88:103]
    v_mov_b32 v2, v6
    s_mov_b32 s16, s21
    s_add_u32 s14, s14, 1
    s_cmp_ge_u32 s14, s15
    s_cbranch_scc1 gemmb_kernel_gu_fin1
    ds_read_b128 v[32:35], v2 offset:6144
    s_waitcnt lgkmcnt(6)
    v_mfma_f32_32x32x16_bf16 v[40:55], v[8:11], a[0:3], 0
    v_mfma_f32_32x32x16_bf16 v[56:71], v[8:11], a[4:7], 0
    ds_read_b128 v[36:39], v2 offset:7168
    s_waitcnt lgkmcnt(6)
    v_mfma_f32_32x32x16_bf16 v[40:55], v[12:15], a[8:11], v[40:55]
    v_mfma_f32_32x32x16_bf16 v[56:71], v[12:15], a[12:15], v[56:71]
    ds_read_b128 v[8:11], v2 offset:8192
    s_waitcnt lgkmcnt(6)
    v_mfma_f32_32x32x16_bf16 v[40:55], v[16:19], a[16:19], v[40:55]
    v_cvt_pk_bf16_f32 v104, v72, v73
    v_mfma_f32_32x32x16_bf16 v[56:71], v[16:19], a[20:23], v[56:71]
    v_cvt_pk_bf16_f32 v105, v74, v75
    ds_read_b128 v[12:15], v2 offset:9216
    s_waitcnt lgkmcnt(6)
    v_mfma_f32_32x32x16_bf16 v[40:55], v[20:23], a[24:27], v[40:55]
    v_cvt_pk_bf16_f32 v106, v76, v77
    v_mfma_f32_32x32x16_bf16 v[56:71], v[20:23], a[28:31], v[56:71]
    v_cvt_pk_bf16_f32 v107, v78, v79
    ds_read_b128 v[16:19], v2 offset:10240
    s_waitcnt lgkmcnt(6)
    v_mfma_f32_32x32x16_bf16 v[40:55], v[24:27], a[32:35], v[40:55]
    s_nop 1
    v_mfma_f32_32x32x16_bf16 v[56:71], v[24:27], a[36:39], v[56:71]
    v_permlane32_swap_b32 v104, v106
    ds_read_b128 v[20:23], v2 offset:11264
    s_waitcnt lgkmcnt(6)
    v_mfma_f32_32x32x16_bf16 v[40:55], v[28:31], a[40:43], v[40:55]
    v_permlane32_swap_b32 v105, v107
    v_mfma_f32_32x32x16_bf16 v[56:71], v[28:31], a[44:47], v[56:71]
    buffer_store_dwordx4 v[104:107], v3, s[8:11], s17 offen offset:0
    ds_read_b128 v[24:27], v2 offset:12288
    s_waitcnt lgkmcnt(6)
    v_mfma_f32_32x32x16_bf16 v[40:55], v[32:35], a[48:51], v[40:55]
    v_cvt_pk_bf16_f32 v108, v80, v81
    v_mfma_f32_32x32x16_bf16 v[56:71], v[32:35], a[52:55], v[56:71]
    v_cvt_pk_bf16_f32 v109, v82, v83
    ds_read_b128 v[28:31], v2 offset:13312
    s_waitcnt lgkmcnt(6)
    v_mfma_f32_32x32x16_bf16 v[40:55], v[36:39], a[56:59], v[40:55]
    v_cvt_pk_bf16_f32 v110, v84, v85
    v_mfma_f32_32x32x16_bf16 v[56:71], v[36:39], a[60:63], v[56:71]
    v_cvt_pk_bf16_f32 v111, v86, v87
    ds_read_b128 v[32:35], v2 offset:14336
    s_waitcnt lgkmcnt(6)
    v_mfma_f32_32x32x16_bf16 v[40:55], v[8:11], a[64:67], v[40:55]
    s_nop 1
    v_mfma_f32_32x32x16_bf16 v[56:71], v[8:11], a[68:71], v[56:71]
    v_permlane32_swap_b32 v108, v110
    ds_read_b128 v[36:39], v2 offset:15360
    s_waitcnt lgkmcnt(6)
    v_mfma_f32_32x32x16_bf16 v[40:55], v[12:15], a[72:75], v[40:55]
    v_permlane32_swap_b32 v109, v111
    v_mfma_f32_32x32x16_bf16 v[56:71], v[12:15], a[76:79], v[56:71]
    buffer_store_dwordx4 v[108:111], v3, s[8:11], s17 offen offset:256
    ds_read_b128 v[8:11], v2 offset:16384
    s_waitcnt lgkmcnt(6)
    v_mfma_f32_32x32x16_bf16 v[40:55], v[16:19], a[80:83], v[40:55]
    v_cvt_pk_bf16_f32 v112, v88, v89
    v_mfma_f32_32x32x16_bf16 v[56:71], v[16:19], a[84:87], v[56:71]
    v_cvt_pk_bf16_f32 v113, v90, v91
    ds_read_b128 v[12:15], v2 offset:17408
    s_waitcnt lgkmcnt(6)
    v_mfma_f32_32x32x16_bf16 v[40:55], v[20:23], a[88:91], v[40:55]
    v_cvt_pk_bf16_f32 v114, v92, v93
    v_mfma_f32_32x32x16_bf16 v[56:71], v[20:23], a[92:95], v[56:71]
    v_cvt_pk_bf16_f32 v115, v94, v95
    ds_read_b128 v[16:19], v2 offset:18432
    s_waitcnt lgkmcnt(6)
    v_mfma_f32_32x32x16_bf16 v[40:55], v[24:27], a[96:99], v[40:55]
    s_nop 1
    v_mfma_f32_32x32x16_bf16 v[56:71], v[24:27], a[100:103], v[56:71]
    v_permlane32_swap_b32 v112, v114
    ds_read_b128 v[20:23], v2 offset:19456
    s_waitcnt lgkmcnt(6)
    v_mfma_f32_32x32x16_bf16 v[40:55], v[28:31], a[104:107], v[40:55]
    v_permlane32_swap_b32 v113, v115
    v_mfma_f32_32x32x16_bf16 v[56:71], v[28:31], a[108:111], v[56:71]
    buffer_store_dwordx4 v[112:115], v3, s[8:11], s17 offen offset:2560
    ds_read_b128 v[24:27], v2 offset:20480
    s_waitcnt lgkmcnt(6)
    v_mfma_f32_32x32x16_bf16 v[40:55], v[32:35], a[112:115], v[40:55]
    v_cvt_pk_bf16_f32 v116, v96, v97
    v_mfma_f32_32x32x16_bf16 v[56:71], v[32:35], a[116:119], v[56:71]
    v_cvt_pk_bf16_f32 v117, v98, v99
    ds_read_b128 v[28:31], v2 offset:21504
    s_waitcnt lgkmcnt(6)
    v_mfma_f32_32x32x16_bf16 v[40:55], v[36:39], a[120:123], v[40:55]
    v_cvt_pk_bf16_f32 v118, v100, v101
    v_mfma_f32_32x32x16_bf16 v[56:71], v[36:39], a[124:127], v[56:71]
    v_cvt_pk_bf16_f32 v119, v102, v103
    ds_read_b128 v[32:35], v2 offset:22528
    s_waitcnt lgkmcnt(6)
    v_mfma_f32_32x32x16_bf16 v[40:55], v[8:11], a[128:131], v[40:55]
    s_nop 1
    v_mfma_f32_32x32x16_bf16 v[56:71], v[8:11], a[132:135], v[56:71]
    v_permlane32_swap_b32 v116, v118
    ds_read_b128 v[36:39], v2 offset:23552
    s_waitcnt lgkmcnt(6)
    v_mfma_f32_32x32x16_bf16 v[40:55], v[12:15], a[136:139], v[40:55]
    v_permlane32_swap_b32 v117, v119
    v_mfma_f32_32x32x16_bf16 v[56:71], v[12:15], a[140:143], v[56:71]
    buffer_store_dwordx4 v[116:119], v3, s[8:11], s17 offen offset:2816
    ds_read_b128 v[8:11], v2 offset:24576
    s_waitcnt lgkmcnt(6)
    v_mfma_f32_32x32x16_bf16 v[40:55], v[16:19], a[144:147], v[40:55]
    s_add_u32 s17, s17, s20
    v_mfma_f32_32x32x16_bf16 v[56:71], v[16:19], a[148:151], v[56:71]
    s_add_u32 s18, s18, s20
    ds_read_b128 v[12:15], v2 offset:25600
    s_waitcnt lgkmcnt(6)
    v_mfma_f32_32x32x16_bf16 v[40:55], v[20:23], a[152:155], v[40:55]
    v_mfma_f32_32x32x16_bf16 v[56:71], v[20:23], a[156:159], v[56:71]
    ds_read_b128 v[16:19], v2 offset:26624
    s_waitcnt lgkmcnt(6)
    v_mfma_f32_32x32x16_bf16 v[40:55], v[24:27], a[160:163], v[40:55]
    v_mfma_f32_32x32x16_bf16 v[56:71], v[24:27], a[164:167], v[56:71]
    ds_read_b128 v[20:23], v2 offset:27648
    s_waitcnt lgkmcnt(6)
    v_mfma_f32_32x32x16_bf16 v[40:55], v[28:31], a[168:171], v[40:55]
    v_mfma_f32_32x32x16_bf16 v[56:71], v[28:31], a[172:175], v[56:71]
    ds_read_b128 v[24:27], v2 offset:28672
    s_waitcnt lgkmcnt(6)
    v_mfma_f32_32x32x16_bf16 v[40:55], v[32:35], a[176:179], v[40:55]
    v_mfma_f32_32x32x16_bf16 v[56:71], v[32:35], a[180:183], v[56:71]
    ds_read_b128 v[28:31], v2 offset:29696
    s_waitcnt lgkmcnt(6)
    v_mfma_f32_32x32x16_bf16 v[40:55], v[36:39], a[184:187], v[40:55]
    v_mfma_f32_32x32x16_bf16 v[56:71], v[36:39], a[188:191], v[56:71]
    ds_read_b128 v[32:35], v2 offset:30720
    s_waitcnt lgkmcnt(6)
    v_mfma_f32_32x32x16_bf16 v[40:55], v[8:11], a[192:195], v[40:55]
    v_mfma_f32_32x32x16_bf16 v[56:71], v[8:11], a[196:199], v[56:71]
    ds_read_b128 v[36:39], v2 offset:31744
    s_waitcnt lgkmcnt(6)
    v_mfma_f32_32x32x16_bf16 v[40:55], v[12:15], a[200:203], v[40:55]
    v_mfma_f32_32x32x16_bf16 v[56:71], v[12:15], a[204:207], v[56:71]
    ds_read_b128 v[8:11], v2 offset:32768
    s_waitcnt lgkmcnt(6)
    v_mfma_f32_32x32x16_bf16 v[40:55], v[16:19], a[208:211], v[40:55]
    v_mfma_f32_32x32x16_bf16 v[56:71], v[16:19], a[212:215], v[56:71]
    ds_read_b128 v[12:15], v2 offset:33792
    s_waitcnt lgkmcnt(6)
    v_mfma_f32_32x32x16_bf16 v[40:55], v[20:23], a[216:219], v[40:55]
    v_mfma_f32_32x32x16_bf16 v[56:71], v[20:23], a[220:223], v[56:71]
    ds_read_b128 v[16:19], v2 offset:34816
    s_waitcnt lgkmcnt(6)
    v_mfma_f32_32x32x16_bf16 v[40:55], v[24:27], a[224:227], v[40:55]
    v_mfma_f32_32x32x16_bf16 v[56:71], v[24:27], a[228:231], v[56:71]
    s_waitcnt vmcnt(0)
    s_barrier
    s_add_u32 s21, s16, 40960
    s_cmp_eq_u32 s21, 122880
    s_cselect_b32 s21, 0, s21
    s_add_u32 s23, s14, 2
    s_min_u32 s24, s23, 63
    s_mul_i32 s24, s24, 40960
    s_add_u32 s24, s24, s19
    s_mul_i32 s25, s13, 10240
    s_add_u32 s25, s25, s22
    s_mov_b32 m0, s25
    s_nop 0
    buffer_load_dwordx4 v1, s[8:11], s24 offen offset:0 lds
    buffer_load_dwordx4 v1, s[8:11], s24 offen offset:1024 lds
    buffer_load_dwordx4 v1, s[8:11], s24 offen offset:2048 lds
    buffer_load_dwordx4 v1, s[8:11], s24 offen offset:3072 lds
    s_add_u32 s24, s24, 4096
    s_add_u32 s25, s25, 4096
    s_mov_b32 m0, s25
    s_nop 0
    buffer_load_dwordx4 v1, s[8:11], s24 offen offset:0 lds
    buffer_load_dwordx4 v1, s[8:11], s24 offen offset:1024 lds
    buffer_load_dwordx4 v1, s[8:11], s24 offen offset:2048 lds
    buffer_load_dwordx4 v1, s[8:11], s24 offen offset:3072 lds
    s_add_u32 s24, s24, 4096
    s_add_u32 s25, s25, 4096
    s_mov_b32 m0, s25
    s_nop 0
    buffer_load_dwordx4 v1, s[8:11], s24 offen offset:0 lds
    buffer_load_dwordx4 v1, s[8:11], s24 offen offset:1024 lds
    s_add_u32 s22, s22, 40960
    s_cmp_eq_u32 s22, 122880
    s_cselect_b32 s22, 0, s22
    ds_read_b128 v[20:23], v2 offset:35840
    s_waitcnt lgkmcnt(6)
    v_mfma_f32_32x32x16_bf16 v[40:55], v[28:31], a[232:235], v[40:55]
    v_mfma_f32_32x32x16_bf16 v[56:71], v[28:31], a[236:239], v[56:71]
    ds_read_b128 v[24:27], v2 offset:36864
    s_waitcnt lgkmcnt(6)
    v_mfma_f32_32x32x16_bf16 v[40:55], v[32:35], a[240:243], v[40:55]
    v_mfma_f32_32x32x16_bf16 v[56:71], v[32:35], a[244:247], v[56:71]
    ds_read_b128 v[28:31], v2 offset:37888
    s_waitcnt lgkmcnt(6)
    v_mfma_f32_32x32x16_bf16 v[40:55], v[36:39], a[248:251], v[40:55]
    v_mfma_f32_32x32x16_bf16 v[56:71], v[36:39], a[252:255], v[56:71]
    ds_read_b128 v[32:35], v2 offset:38912
    s_waitcnt lgkmcnt(6)
    v_mfma_f32_32x32x16_bf16 v[40:55], v[8:11], v[192:195], v[40:55]
    v_mfma_f32_32x32x16_bf16 v[56:71], v[8:11], v[196:199], v[56:71]
    ds_read_b128 v[36:39], v2 offset:39936
    s_waitcnt lgkmcnt(6)
    v_mfma_f32_32x32x16_bf16 v[40:55], v[12:15], v[200:203], v[40:55]
    v_mfma_f32_32x32x16_bf16 v[56:71], v[12:15], v[204:207], v[56:71]
    v_add_u32 v6, s21, v1
    ds_read_b128 v[8:11], v6 offset:0
    s_waitcnt lgkmcnt(6)
    v_mfma_f32_32x32x16_bf16 v[40:55], v[16:19], v[208:211], v[40:55]
    v_mfma_f32_32x32x16_bf16 v[56:71], v[16:19], v[212:215], v[56:71]
    ds_read_b128 v[12:15], v6 offset:1024
    s_waitcnt lgkmcnt(6)
    v_mfma_f32_32x32x16_bf16 v[40:55], v[20:23], v[216:219], v[40:55]
    v_mfma_f32_32x32x16_bf16 v[56:71], v[20:23], v[220:223], v[56:71]
    ds_read_b128 v[16:19], v6 offset:2048
    s_waitcnt lgkmcnt(6)
    v_mfma_f32_32x32x16_bf16 v[40:55], v[24:27], v[224:227], v[40:55]
    v_mfma_f32_32x32x16_bf16 v[56:71], v[24:27], v[228:231], v[56:71]
    ds_read_b128 v[20:23], v6 offset:3072
    s_waitcnt lgkmcnt(6)
    v_mfma_f32_32x32x16_bf16 v[40:55], v[28:31], v[232:235], v[40:55]
    v_mfma_f32_32x32x16_bf16 v[56:71], v[28:31], v[236:239], v[56:71]
    ds_read_b128 v[24:27], v6 offset:4096
    s_waitcnt lgkmcnt(6)
    v_mfma_f32_32x32x16_bf16 v[40:55], v[32:35], v[240:243], v[40:55]
    v_mfma_f32_32x32x16_bf16 v[56:71], v[32:35], v[244:247], v[56:71]
    ds_read_b128 v[28:31], v6 offset:5120
    s_waitcnt lgkmcnt(6)
    v_mfma_f32_32x32x16_bf16 v[40:55], v[36:39], v[248:251], v[40:55]
    v_mfma_f32_32x32x16_bf16 v[56:71], v[36:39], v[252:255], v[56:71]
    v_mov_b32 v2, v6
    s_mov_b32 s16, s21
    s_add_u32 s14, s14, 1
    s_cmp_lt_u32 s14, s15
    s_cbranch_scc1 gemmb_kernel_gu_loop
gemmb_kernel_gu_fin0:
    s_nop 7
    s_nop 7
    v_cvt_pk_bf16_f32 v104, v40, v41
    v_cvt_pk_bf16_f32 v105, v42, v43
    v_cvt_pk_bf16_f32 v106, v44, v45
    v_cvt_pk_bf16_f32 v107, v46, v47
    s_nop 1
    v_permlane32_swap_b32 v104, v106
    v_permlane32_swap_b32 v105, v107
    buffer_store_dwordx4 v[104:107], v3, s[8:11], s17 offen offset:0
    v_cvt_pk_bf16_f32 v108, v48, v49
    v_cvt_pk_bf16_f32 v109, v50, v51
    v_cvt_pk_bf16_f32 v110, v52, v53
    v_cvt_pk_bf16_f32 v111, v54, v55
    s_nop 1
    v_permlane32_swap_b32 v108, v110
    v_permlane32_swap_b32 v109, v111
    buffer_store_dwordx4 v[108:111], v3, s[8:11], s17 offen offset:256
    v_cvt_pk_bf16_f32 v112, v56, v57
    v_cvt_pk_bf16_f32 v113, v58, v59
    v_cvt_pk_bf16_f32 v114, v60, v61
    v_cvt_pk_bf16_f32 v115, v62, v63
    s_nop 1
    v_permlane32_swap_b32 v112, v114
    v_permlane32_swap_b32 v113, v115
    buffer_store_dwordx4 v[112:115], v3, s[8:11], s17 offen offset:2560
    v_cvt_pk_bf16_f32 v116, v64, v65
    v_cvt_pk_bf16_f32 v117, v66, v67
    v_cvt_pk_bf16_f32 v118, v68, v69
    v_cvt_pk_bf16_f32 v119, v70, v71
    s_nop 1
    v_permlane32_swap_b32 v116, v118
    v_permlane32_swap_b32 v117, v119
    buffer_store_dwordx4 v[116:119], v3, s[8:11], s17 offen offset:2816
    s_add_u32 s17, s17, s20
    s_add_u32 s18, s18, s20
    s_branch gemmb_kernel_gu_done
gemmb_kernel_gu_fin1:
    s_nop 7
    s_nop 7
    v_cvt_pk_bf16_f32 v104, v72, v73
    v_cvt_pk_bf16_f32 v105, v74, v75
    v_cvt_pk_bf16_f32 v106, v76, v77
    v_cvt_pk_bf16_f32 v107, v78, v79
    s_nop 1
    v_permlane32_swap_b32 v104, v106
    v_permlane32_swap_b32 v105, v107
    buffer_store_dwordx4 v[104:107], v3, s[8:11], s17 offen offset:0
    v_cvt_pk_bf16_f32 v108, v80, v81
    v_cvt_pk_bf16_f32 v109, v82, v83
    v_cvt_pk_bf16_f32 v110, v84, v85
    v_cvt_pk_bf16_f32 v111, v86, v87
    s_nop 1
    v_permlane32_swap_b32 v108, v110
    v_permlane32_swap_b32 v109, v111
    buffer_store_dwordx4 v[108:111], v3, s[8:11], s17 offen offset:256
    v_cvt_pk_bf16_f32 v112, v88, v89
    v_cvt_pk_bf16_f32 v113, v90, v91
    v_cvt_pk_bf16_f32 v114, v92, v93
    v_cvt_pk_bf16_f32 v115, v94, v95
    s_nop 1
    v_permlane32_swap_b32 v112, v114
    v_permlane32_swap_b32 v113, v115
    buffer_store_dwordx4 v[112:115], v3, s[8:11], s17 offen offset:2560
    v_cvt_pk_bf16_f32 v116, v96, v97
    v_cvt_pk_bf16_f32 v117, v98, v99
    v_cvt_pk_bf16_f32 v118, v100, v101
    v_cvt_pk_bf16_f32 v119, v102, v103
    s_nop 1
    v_permlane32_swap_b32 v116, v118
    v_permlane32_swap_b32 v117, v119
    buffer_store_dwordx4 v[116:119], v3, s[8:11], s17 offen offset:2816
    s_add_u32 s17, s17, s20
    s_add_u32 s18, s18, s20
gemmb_kernel_gu_done:
    s_waitcnt vmcnt(0) lgkmcnt(0)
    s_branch gemmb_kernel_g_done
gemmb_kernel_g_qk:
    s_sub_u32 s26, s36, 80
    s_cmp_ge_u32 s26, 24
    s_cselect_b32 s27, 1, 0
    s_cselect_b32 s28, 24, 0
    s_sub_u32 s26, s26, s28
    s_lshl_b32 s26, s26, 3
    s_lshl_b32 s28, s13, 1
    s_add_u32 s26, s26, s28
    s_add_u32 s28, s26, 0
    s_mul_i32 s29, s28, 171
    s_lshr_b32 s29, s29, 10
    s_mul_i32 s30, s29, 6
    s_sub_u32 s30, s28, s30
    s_mul_i32 s31, s29, 12288
    s_lshl_b32 s32, s30, 11
    s_add_u32 s31, s31, s32
    s_mul_i32 s32, s14, 393216
    s_add_u32 s31, s31, s32
    s_mul_i32 s32, s27, 25165824
    s_add_u32 s31, s31, s32
    s_add_u32 s17, s31, 53477376
    s_lshl_b32 s30, s30, 5
    v_add_u32 v10, s30, v8
    v_and_b32 v11, 0xc1, v10
    v_and_b32 v12, 8, v10
    v_lshl_or_b32 v11, v12, 2, v11
    v_and_b32 v12, 32, v10
    v_lshrrev_b32 v12, 1, v12
    v_or_b32 v11, v11, v12
    v_and_b32 v12, 2, v10
    v_lshl_or_b32 v11, v12, 2, v11
    v_and_b32 v12, 16, v10
    v_lshrrev_b32 v12, 2, v12
    v_or_b32 v11, v11, v12
    v_and_b32 v12, 4, v10
    v_lshrrev_b32 v12, 1, v12
    v_or_b32 v11, v11, v12
    s_cmp_eq_u32 s27, 1
    s_cselect_b64 vcc, -1, 0
    s_nop 1
    v_cndmask_b32 v10, v10, v11, vcc
    v_lshrrev_b32 v12, 4, v10
    v_mul_u32_u24 v13, 11, v12
    v_lshrrev_b32 v13, 5, v13
    v_mul_u32_u24 v13, 3, v13
    v_add_u32 v12, v12, v13
    v_mul_u32_u24 v12, 20480, v12
    v_and_b32 v13, 15, v10
    v_lshl_add_u32 v11, v13, 4, v12
    v_lshl_add_u32 v4, v9, 8, v11
    s_xor_b32 s30, s27, 1
    s_mul_i32 s30, s30, 61440
    s_mul_i32 s31, s29, 491520
    s_add_u32 s30, s30, s31
    s_add_u32 s34, s30, 11534336
    s_add_u32 s28, s26, 1
    s_mul_i32 s29, s28, 171
    s_lshr_b32 s29, s29, 10
    s_mul_i32 s30, s29, 6
    s_sub_u32 s30, s28, s30
    s_mul_i32 s31, s29, 12288
    s_lshl_b32 s32, s30, 11
    s_add_u32 s31, s31, s32
    s_mul_i32 s32, s14, 393216
    s_add_u32 s31, s31, s32
    s_mul_i32 s32, s27, 25165824
    s_add_u32 s31, s31, s32
    s_add_u32 s18, s31, 53477376
    s_lshl_b32 s30, s30, 5
    v_add_u32 v10, s30, v8
    v_and_b32 v11, 0xc1, v10
    v_and_b32 v12, 8, v10
    v_lshl_or_b32 v11, v12, 2, v11
    v_and_b32 v12, 32, v10
    v_lshrrev_b32 v12, 1, v12
    v_or_b32 v11, v11, v12
    v_and_b32 v12, 2, v10
    v_lshl_or_b32 v11, v12, 2, v11
    v_and_b32 v12, 16, v10
    v_lshrrev_b32 v12, 2, v12
    v_or_b32 v11, v11, v12
    v_and_b32 v12, 4, v10
    v_lshrrev_b32 v12, 1, v12
    v_or_b32 v11, v11, v12
    s_cmp_eq_u32 s27, 1
    s_cselect_b64 vcc, -1, 0
    s_nop 1
    v_cndmask_b32 v10, v10, v11, vcc
    v_lshrrev_b32 v12, 4, v10
    v_mul_u32_u24 v13, 11, v12
    v_lshrrev_b32 v13, 5, v13
    v_mul_u32_u24 v13, 3, v13
    v_add_u32 v12, v12, v13
    v_mul_u32_u24 v12, 20480, v12
    v_and_b32 v13, 15, v10
    v_lshl_add_u32 v11, v13, 4, v12
    v_lshl_add_u32 v5, v9, 8, v11
    s_xor_b32 s30, s27, 1
    s_mul_i32 s30, s30, 61440
    s_mul_i32 s31, s29, 491520
    s_add_u32 s30, s30, s31
    s_add_u32 s35, s30, 11534336
    buffer_load_dwordx4 a[0:3], v4, s[8:11], s34 offen offset:0
    buffer_load_dwordx4 a[4:7], v5, s[8:11], s35 offen offset:0
    buffer_load_dwordx4 a[8:11], v4, s[8:11], s34 offen offset:512
    buffer_load_dwordx4 a[12:15], v5, s[8:11], s35 offen offset:512
    buffer_load_dwordx4 a[16:19], v4, s[8:11], s34 offen offset:1024
    buffer_load_dwordx4 a[20:23], v5, s[8:11], s35 offen offset:1024
    buffer_load_dwordx4 a[24:27], v4, s[8:11], s34 offen offset:1536
    buffer_load_dwordx4 a[28:31], v5, s[8:11], s35 offen offset:1536
    buffer_load_dwordx4 a[32:35], v4, s[8:11], s34 offen offset:2048
    buffer_load_dwordx4 a[36:39], v5, s[8:11], s35 offen offset:2048
    buffer_load_dwordx4 a[40:43], v4, s[8:11], s34 offen offset:2560
    buffer_load_dwordx4 a[44:47], v5, s[8:11], s35 offen offset:2560
    buffer_load_dwordx4 a[48:51], v4, s[8:11], s34 offen offset:3072
    buffer_load_dwordx4 a[52:55], v5, s[8:11], s35 offen offset:3072
    buffer_load_dwordx4 a[56:59], v4, s[8:11], s34 offen offset:3584
    buffer_load_dwordx4 a[60:63], v5, s[8:11], s35 offen offset:3584
    s_add_u32 s34, s34, 4096
    s_add_u32 s35, s35, 4096
    buffer_load_dwordx4 a[64:67], v4, s[8:11], s34 offen offset:0
    buffer_load_dwordx4 a[68:71], v5, s[8:11], s35 offen offset:0
    buffer_load_dwordx4 a[72:75], v4, s[8:11], s34 offen offset:512
    buffer_load_dwordx4 a[76:79], v5, s[8:11], s35 offen offset:512
    buffer_load_dwordx4 a[80:83], v4, s[8:11], s34 offen offset:1024
    buffer_load_dwordx4 a[84:87], v5, s[8:11], s35 offen offset:1024
    buffer_load_dwordx4 a[88:91], v4, s[8:11], s34 offen offset:1536
    buffer_load_dwordx4 a[92:95], v5, s[8:11], s35 offen offset:1536
    buffer_load_dwordx4 a[96:99], v4, s[8:11], s34 offen offset:2048
    buffer_load_dwordx4 a[100:103], v5, s[8:11], s35 offen offset:2048
    buffer_load_dwordx4 a[104:107], v4, s[8:11], s34 offen offset:2560
    buffer_load_dwordx4 a[108:111], v5, s[8:11], s35 offen offset:2560
    buffer_load_dwordx4 a[112:115], v4, s[8:11], s34 offen offset:3072
    buffer_load_dwordx4 a[116:119], v5, s[8:11], s35 offen offset:3072
    buffer_load_dwordx4 a[120:123], v4, s[8:11], s34 offen offset:3584
    buffer_load_dwordx4 a[124:127], v5, s[8:11], s35 offen offset:3584
    s_add_u32 s34, s34, 4096
    s_add_u32 s35, s35, 4096
    buffer_load_dwordx4 a[128:131], v4, s[8:11], s34 offen offset:0
    buffer_load_dwordx4 a[132:135], v5, s[8:11], s35 offen offset:0
    buffer_load_dwordx4 a[136:139], v4, s[8:11], s34 offen offset:512
    buffer_load_dwordx4 a[140:143], v5, s[8:11], s35 offen offset:512
    buffer_load_dwordx4 a[144:147], v4, s[8:11], s34 offen offset:1024
    buffer_load_dwordx4 a[148:151], v5, s[8:11], s35 offen offset:1024
    buffer_load_dwordx4 a[152:155], v4, s[8:11], s34 offen offset:1536
    buffer_load_dwordx4 a[156:159], v5, s[8:11], s35 offen offset:1536
    buffer_load_dwordx4 a[160:163], v4, s[8:11], s34 offen offset:2048
    buffer_load_dwordx4 a[164:167], v5, s[8:11], s35 offen offset:2048
    buffer_load_dwordx4 a[168:171], v4, s[8:11], s34 offen offset:2560
    buffer_load_dwordx4 a[172:175], v5, s[8:11], s35 offen offset:2560
    buffer_load_dwordx4 a[176:179], v4, s[8:11], s34 offen offset:3072
    buffer_load_dwordx4 a[180:183], v5, s[8:11], s35 offen offset:3072
    buffer_load_dwordx4 a[184:187], v4, s[8:11], s34 offen offset:3584
    buffer_load_dwordx4 a[188:191], v5, s[8:11], s35 offen offset:3584
    s_add_u32 s34, s34, 4096
    s_add_u32 s35, s35, 4096
    buffer_load_dwordx4 a[192:195], v4, s[8:11], s34 offen offset:0
    buffer_load_dwordx4 a[196:199], v5, s[8:11], s35 offen offset:0
    buffer_load_dwordx4 a[200:203], v4, s[8:11], s34 offen offset:512
    buffer_load_dwordx4 a[204:207], v5, s[8:11], s35 offen offset:512
    buffer_load_dwordx4 a[208:211], v4, s[8:11], s34 offen offset:1024
    buffer_load_dwordx4 a[212:215], v5, s[8:11], s35 offen offset:1024
    buffer_load_dwordx4 a[216:219], v4, s[8:11], s34 offen offset:1536
    buffer_load_dwordx4 a[220:223], v5, s[8:11], s35 offen offset:1536
    buffer_load_dwordx4 a[224:227], v4, s[8:11], s34 offen offset:2048
    buffer_load_dwordx4 a[228:231], v5, s[8:11], s35 offen offset:2048
    buffer_load_dwordx4 a[232:235], v4, s[8:11], s34 offen offset:2560
    buffer_load_dwordx4 a[236:239], v5, s[8:11], s35 offen offset:2560
    buffer_load_dwordx4 a[240:243], v4, s[8:11], s34 offen offset:3072
    buffer_load_dwordx4 a[244:247], v5, s[8:11], s35 offen offset:3072
    buffer_load_dwordx4 a[248:251], v4, s[8:11], s34 offen offset:3584
    buffer_load_dwordx4 a[252:255], v5, s[8:11], s35 offen offset:3584
    s_add_u32 s34, s34, 4096
    s_add_u32 s35, s35, 4096
    buffer_load_dwordx4 v[192:195], v4, s[8:11], s34 offen offset:0
    buffer_load_dwordx4 v[196:199], v5, s[8:11], s35 offen offset:0
    buffer_load_dwordx4 v[200:203], v4, s[8:11], s34 offen offset:512
    buffer_load_dwordx4 v[204:207], v5, s[8:11], s35 offen offset:512
    buffer_load_dwordx4 v[208:211], v4, s[8:11], s34 offen offset:1024
    buffer_load_dwordx4 v[212:215], v5, s[8:11], s35 offen offset:1024
    buffer_load_dwordx4 v[216:219], v4, s[8:11], s34 offen offset:1536
    buffer_load_dwordx4 v[220:223], v5, s[8:11], s35 offen offset:1536
    buffer_load_dwordx4 v[224:227], v4, s[8:11], s34 offen offset:2048
    buffer_load_dwordx4 v[228:231], v5, s[8:11], s35 offen offset:2048
    buffer_load_dwordx4 v[232:235], v4, s[8:11], s34 offen offset:2560
    buffer_load_dwordx4 v[236:239], v5, s[8:11], s35 offen offset:2560
    buffer_load_dwordx4 v[240:243], v4, s[8:11], s34 offen offset:3072
    buffer_load_dwordx4 v[244:247], v5, s[8:11], s35 offen offset:3072
    buffer_load_dwordx4 v[248:251], v4, s[8:11], s34 offen offset:3584
    buffer_load_dwordx4 v[252:255], v5, s[8:11], s35 offen offset:3584
    v_mov_b32 v3, v1
    s_mov_b32 s20, 393216
    s_mul_i32 s19, s13, 10240
    s_add_u32 s19, s19, 220200960
    s_mov_b32 s22, 0
    s_min_u32 s24, s14, 63
    s_mul_i32 s24, s24, 40960
    s_add_u32 s24, s24, s19
    s_mul_i32 s25, s13, 10240
    s_add_u32 s25, s25, s22
    s_mov_b32 m0, s25
    s_nop 0
    buffer_load_dwordx4 v1, s[8:11], s24 offen offset:0 lds
    buffer_load_dwordx4 v1, s[8:11], s24 offen offset:1024 lds
    buffer_load_dwordx4 v1, s[8:11], s24 offen offset:2048 lds
    buffer_load_dwordx4 v1, s[8:11], s24 offen offset:3072 lds
    s_add_u32 s24, s24, 4096
    s_add_u32 s25, s25, 4096
    s_mov_b32 m0, s25
    s_nop 0
    buffer_load_dwordx4 v1, s[8:11], s24 offen offset:0 lds
    buffer_load_dwordx4 v1, s[8:11], s24 offen offset:1024 lds
    buffer_load_dwordx4 v1, s[8:11], s24 offen offset:2048 lds
    buffer_load_dwordx4 v1, s[8:11], s24 offen offset:3072 lds
    s_add_u32 s24, s24, 4096
    s_add_u32 s25, s25, 4096
    s_mov_b32 m0, s25
    s_nop 0
    buffer_load_dwordx4 v1, s[8:11], s24 offen offset:0 lds
    buffer_load_dwordx4 v1, s[8:11], s24 offen offset:1024 lds
    s_mov_b32 s22, 40960
    s_add_u32 s23, s14, 1
    s_min_u32 s24, s23, 63
    s_mul_i32 s24, s24, 40960
    s_add_u32 s24, s24, s19
    s_mul_i32 s25, s13, 10240
    s_add_u32 s25, s25, s22
    s_mov_b32 m0, s25
    s_nop 0
    buffer_load_dwordx4 v1, s[8:11], s24 offen offset:0 lds
    buffer_load_dwordx4 v1, s[8:11], s24 offen offset:1024 lds
    buffer_load_dwordx4 v1, s[8:11], s24 offen offset:2048 lds
    buffer_load_dwordx4 v1, s[8:11], s24 offen offset:3072 lds
    s_add_u32 s24, s24, 4096
    s_add_u32 s25, s25, 4096
    s_mov_b32 m0, s25
    s_nop 0
    buffer_load_dwordx4 v1, s[8:11], s24 offen offset:0 lds
    buffer_load_dwordx4 v1, s[8:11], s24 offen offset:1024 lds
    buffer_load_dwordx4 v1, s[8:11], s24 offen offset:2048 lds
    buffer_load_dwordx4 v1, s[8:11], s24 offen offset:3072 lds
    s_add_u32 s24, s24, 4096
    s_add_u32 s25, s25, 4096
    s_mov_b32 m0, s25
    s_nop 0
    buffer_load_dwordx4 v1, s[8:11], s24 offen offset:0 lds
    buffer_load_dwordx4 v1, s[8:11], s24 offen offset:1024 lds
    s_mov_b32 s22, 81920
    s_mov_b32 s16, 0
    s_waitcnt vmcnt(10)
    s_barrier
    v_mov_b32 v2, v1
    ds_read_b128 v[8:11], v2 offset:0
    ds_read_b128 v[12:15], v2 offset:1024
    ds_read_b128 v[16:19], v2 offset:2048
    ds_read_b128 v[20:23], v2 offset:3072
    ds_read_b128 v[24:27], v2 offset:4096
    ds_read_b128 v[28:31], v2 offset:5120
    ds_read_b128 v[32:35], v2 offset:6144
    s_waitcnt lgkmcnt(6)
    v_mfma_f32_32x32x16_bf16 v[40:55], a[0:3], v[8:11], 0
    v_mfma_f32_32x32x16_bf16 v[56:71], a[4:7], v[8:11], 0
    ds_read_b128 v[36:39], v2 offset:7168
    s_waitcnt lgkmcnt(6)
    v_mfma_f32_32x32x16_bf16 v[40:55], a[8:11], v[12:15], v[40:55]
    v_mfma_f32_32x32x16_bf16 v[56:71], a[12:15], v[12:15], v[56:71]
    ds_read_b128 v[8:11], v2 offset:8192
    s_waitcnt lgkmcnt(6)
    v_mfma_f32_32x32x16_bf16 v[40:55], a[16:19], v[16:19], v[40:55]
    v_mfma_f32_32x32x16_bf16 v[56:71], a[20:23], v[16:19], v[56:71]
    ds_read_b128 v[12:15], v2 offset:9216
    s_waitcnt lgkmcnt(6)
    v_mfma_f32_32x32x16_bf16 v[40:55], a[24:27], v[20:23], v[40:55]
    v_mfma_f32_32x32x16_bf16 v[56:71], a[28:31], v[20:23], v[56:71]
    ds_read_b128 v[16:19], v2 offset:10240
    s_waitcnt lgkmcnt(6)
    v_mfma_f32_32x32x16_bf16 v[40:55], a[32:35], v[24:27], v[40:55]
    v_mfma_f32_32x32x16_bf16 v[56:71], a[36:39], v[24:27], v[56:71]
    ds_read_b128 v[20:23], v2 offset:11264
    s_waitcnt lgkmcnt(6)
    v_mfma_f32_32x32x16_bf16 v[40:55], a[40:43], v[28:31], v[40:55]
    v_mfma_f32_32x32x16_bf16 v[56:71], a[44:47], v[28:31], v[56:71]
    ds_read_b128 v[24:27], v2 offset:12288
    s_waitcnt lgkmcnt(6)
    v_mfma_f32_32x32x16_bf16 v[40:55], a[48:51], v[32:35], v[40:55]
    v_mfma_f32_32x32x16_bf16 v[56:71], a[52:55], v[32:35], v[56:71]
    ds_read_b128 v[28:31], v2 offset:13312
    s_waitcnt lgkmcnt(6)
    v_mfma_f32_32x32x16_bf16 v[40:55], a[56:59], v[36:39], v[40:55]
    v_mfma_f32_32x32x16_bf16 v[56:71], a[60:63], v[36:39], v[56:71]
    ds_read_b128 v[32:35], v2 offset:14336
    s_waitcnt lgkmcnt(6)
    v_mfma_f32_32x32x16_bf16 v[40:55], a[64:67], v[8:11], v[40:55]
    v_mfma_f32_32x32x16_bf16 v[56:71], a[68:71], v[8:11], v[56:71]
    ds_read_b128 v[36:39], v2 offset:15360
    s_waitcnt lgkmcnt(6)
    v_mfma_f32_32x32x16_bf16 v[40:55], a[72:75], v[12:15], v[40:55]
    v_mfma_f32_32x32x16_bf16 v[56:71], a[76:79], v[12:15], v[56:71]
    ds_read_b128 v[8:11], v2 offset:16384
    s_waitcnt lgkmcnt(6)
    v_mfma_f32_32x32x16_bf16 v[40:55], a[80:83], v[16:19], v[40:55]
    v_mfma_f32_32x32x16_bf16 v[56:71], a[84:87], v[16:19], v[56:71]
    ds_read_b128 v[12:15], v2 offset:17408
    s_waitcnt lgkmcnt(6)
    v_mfma_f32_32x32x16_bf16 v[40:55], a[88:91], v[20:23], v[40:55]
    v_mfma_f32_32x32x16_bf16 v[56:71], a[92:95], v[20:23], v[56:71]
    ds_read_b128 v[16:19], v2 offset:18432
    s_waitcnt lgkmcnt(6)
    v_mfma_f32_32x32x16_bf16 v[40:55], a[96:99], v[24:27], v[40:55]
    v_mfma_f32_32x32x16_bf16 v[56:71], a[100:103], v[24:27], v[56:71]
    ds_read_b128 v[20:23], v2 offset:19456
    s_waitcnt lgkmcnt(6)
    v_mfma_f32_32x32x16_bf16 v[40:55], a[104:107], v[28:31], v[40:55]
    v_mfma_f32_32x32x16_bf16 v[56:71], a[108:111], v[28:31], v[56:71]
    ds_read_b128 v[24:27], v2 offset:20480
    s_waitcnt lgkmcnt(6)
    v_mfma_f32_32x32x16_bf16 v[40:55], a[112:115], v[32:35], v[40:55]
    v_mfma_f32_32x32x16_bf16 v[56:71], a[116:119], v[32:35], v[56:71]
    ds_read_b128 v[28:31], v2 offset:21504
    s_waitcnt lgkmcnt(6)
    v_mfma_f32_32x32x16_bf16 v[40:55], a[120:123], v[36:39], v[40:55]
    v_mfma_f32_32x32x16_bf16 v[56:71], a[124:127], v[36:39], v[56:71]
    ds_read_b128 v[32:35], v2 offset:22528
    s_waitcnt lgkmcnt(6)
    v_mfma_f32_32x32x16_bf16 v[40:55], a[128:131], v[8:11], v[40:55]
    v_mfma_f32_32x32x16_bf16 v[56:71], a[132:135], v[8:11], v[56:71]
    ds_read_b128 v[36:39], v2 offset:23552
    s_waitcnt lgkmcnt(6)
    v_mfma_f32_32x32x16_bf16 v[40:55], a[136:139], v[12:15], v[40:55]
    v_mfma_f32_32x32x16_bf16 v[56:71], a[140:143], v[12:15], v[56:71]
    ds_read_b128 v[8:11], v2 offset:24576
    s_waitcnt lgkmcnt(6)
    v_mfma_f32_32x32x16_bf16 v[40:55], a[144:147], v[16:19], v[40:55]
    v_mfma_f32_32x32x16_bf16 v[56:71], a[148:151], v[16:19], v[56:71]
    ds_read_b128 v[12:15], v2 offset:25600
    s_waitcnt lgkmcnt(6)
    v_mfma_f32_32x32x16_bf16 v[40:55], a[152:155], v[20:23], v[40:55]
    v_mfma_f32_32x32x16_bf16 v[56:71], a[156:159], v[20:23], v[56:71]
    ds_read_b128 v[16:19], v2 offset:26624
    s_waitcnt lgkmcnt(6)
    v_mfma_f32_32x32x16_bf16 v[40:55], a[160:163], v[24:27], v[40:55]
    v_mfma_f32_32x32x16_bf16 v[56:71], a[164:167], v[24:27], v[56:71]
    ds_read_b128 v[20:23], v2 offset:27648
    s_waitcnt lgkmcnt(6)
    v_mfma_f32_32x32x16_bf16 v[40:55], a[168:171], v[28:31], v[40:55]
    v_mfma_f32_32x32x16_bf16 v[56:71], a[172:175], v[28:31], v[56:71]
    ds_read_b128 v[24:27], v2 offset:28672
    s_waitcnt lgkmcnt(6)
    v_mfma_f32_32x32x16_bf16 v[40:55], a[176:179], v[32:35], v[40:55]
    v_mfma_f32_32x32x16_bf16 v[56:71], a[180:183], v[32:35], v[56:71]
    ds_read_b128 v[28:31], v2 offset:29696
    s_waitcnt lgkmcnt(6)
    v_mfma_f32_32x32x16_bf16 v[40:55], a[184:187], v[36:39], v[40:55]
    v_mfma_f32_32x32x16_bf16 v[56:71], a[188:191], v[36:39], v[56:71]
    ds_read_b128 v[32:35], v2 offset:30720
    s_waitcnt lgkmcnt(6)
    v_mfma_f32_32x32x16_bf16 v[40:55], a[192:195], v[8:11], v[40:55]
    v_mfma_f32_32x32x16_bf16 v[56:71], a[196:199], v[8:11], v[56:71]
    ds_read_b128 v[36:39], v2 offset:31744
    s_waitcnt lgkmcnt(6)
    v_mfma_f32_32x32x16_bf16 v[40:55], a[200:203], v[12:15], v[40:55]
    v_mfma_f32_32x32x16_bf16 v[56:71], a[204:207], v[12:15], v[56:71]
    ds_read_b128 v[8:11], v2 offset:32768
    s_waitcnt lgkmcnt(6)
    v_mfma_f32_32x32x16_bf16 v[40:55], a[208:211], v[16:19], v[40:55]
    v_mfma_f32_32x32x16_bf16 v[56:71], a[212:215], v[16:19], v[56:71]
    ds_read_b128 v[12:15], v2 offset:33792
    s_waitcnt lgkmcnt(6)
    v_mfma_f32_32x32x16_bf16 v[40:55], a[216:219], v[20:23], v[40:55]
    v_mfma_f32_32x32x16_bf16 v[56:71], a[220:223], v[20:23], v[56:71]
    ds_read_b128 v[16:19], v2 offset:34816
    s_waitcnt lgkmcnt(6)
    v_mfma_f32_32x32x16_bf16 v[40:55], a[224:227], v[24:27], v[40:55]
    v_mfma_f32_32x32x16_bf16 v[56:71], a[228:231], v[24:27], v[56:71]
    s_waitcnt vmcnt(0)
    s_barrier
    s_add_u32 s21, s16, 40960
    s_cmp_eq_u32 s21, 122880
    s_cselect_b32 s21, 0, s21
    s_add_u32 s23, s14, 2
    s_min_u32 s24, s23, 63
    s_mul_i32 s24, s24, 40960
    s_add_u32 s24, s24, s19
    s_mul_i32 s25, s13, 10240
    s_add_u32 s25, s25, s22
    s_mov_b32 m0, s25
    s_nop 0
    buffer_load_dwordx4 v1, s[8:11], s24 offen offset:0 lds
    buffer_load_dwordx4 v1, s[8:11], s24 offen offset:1024 lds
    buffer_load_dwordx4 v1, s[8:11], s24 offen offset:2048 lds
    buffer_load_dwordx4 v1, s[8:11], s24 offen offset:3072 lds
    s_add_u32 s24, s24, 4096
    s_add_u32 s25, s25, 4096
    s_mov_b32 m0, s25
    s_nop 0
    buffer_load_dwordx4 v1, s[8:11], s24 offen offset:0 lds
    buffer_load_dwordx4 v1, s[8:11], s24 offen offset:1024 lds
    buffer_load_dwordx4 v1, s[8:11], s24 offen offset:2048 lds
    buffer_load_dwordx4 v1, s[8:11], s24 offen offset:3072 lds
    s_add_u32 s24, s24, 4096
    s_add_u32 s25, s25, 4096
    s_mov_b32 m0, s25
    s_nop 0
    buffer_load_dwordx4 v1, s[8:11], s24 offen offset:0 lds
    buffer_load_dwordx4 v1, s[8:11], s24 offen offset:1024 lds
    s_add_u32 s22, s22, 40960
    s_cmp_eq_u32 s22, 122880
    s_cselect_b32 s22, 0, s22
    ds_read_b128 v[20:23], v2 offset:35840
    s_waitcnt lgkmcnt(6)
    v_mfma_f32_32x32x16_bf16 v[40:55], a[232:235], v[28:31], v[40:55]
    v_mfma_f32_32x32x16_bf16 v[56:71], a[236:239], v[28:31], v[56:71]
    ds_read_b128 v[24:27], v2 offset:36864
    s_waitcnt lgkmcnt(6)
    v_mfma_f32_32x32x16_bf16 v[40:55], a[240:243], v[32:35], v[40:55]
    v_mfma_f32_32x32x16_bf16 v[56:71], a[244:247], v[32:35], v[56:71]
    ds_read_b128 v[28:31], v2 offset:37888
    s_waitcnt lgkmcnt(6)
    v_mfma_f32_32x32x16_bf16 v[40:55], a[248:251], v[36:39], v[40:55]
    v_mfma_f32_32x32x16_bf16 v[56:71], a[252:255], v[36:39], v[56:71]
    ds_read_b128 v[32:35], v2 offset:38912
    s_waitcnt lgkmcnt(6)
    v_mfma_f32_32x32x16_bf16 v[40:55], v[192:195], v[8:11], v[40:55]
    v_mfma_f32_32x32x16_bf16 v[56:71], v[196:199], v[8:11], v[56:71]
    ds_read_b128 v[36:39], v2 offset:39936
    s_waitcnt lgkmcnt(6)
    v_mfma_f32_32x32x16_bf16 v[40:55], v[200:203], v[12:15], v[40:55]
    v_mfma_f32_32x32x16_bf16 v[56:71], v[204:207], v[12:15], v[56:71]
    v_add_u32 v6, s21, v1
    ds_read_b128 v[8:11], v6 offset:0
    s_waitcnt lgkmcnt(6)
    v_mfma_f32_32x32x16_bf16 v[40:55], v[208:211], v[16:19], v[40:55]
    v_mfma_f32_32x32x16_bf16 v[56:71], v[212:215], v[16:19], v[56:71]
    ds_read_b128 v[12:15], v6 offset:1024
    s_waitcnt lgkmcnt(6)
    v_mfma_f32_32x32x16_bf16 v[40:55], v[216:219], v[20:23], v[40:55]
    v_mfma_f32_32x32x16_bf16 v[56:71], v[220:223], v[20:23], v[56:71]
    ds_read_b128 v[16:19], v6 offset:2048
    s_waitcnt lgkmcnt(6)
    v_mfma_f32_32x32x16_bf16 v[40:55], v[224:227], v[24:27], v[40:55]
    v_mfma_f32_32x32x16_bf16 v[56:71], v[228:231], v[24:27], v[56:71]
    ds_read_b128 v[20:23], v6 offset:3072
    s_waitcnt lgkmcnt(6)
    v_mfma_f32_32x32x16_bf16 v[40:55], v[232:235], v[28:31], v[40:55]
    v_mfma_f32_32x32x16_bf16 v[56:71], v[236:239], v[28:31], v[56:71]
    ds_read_b128 v[24:27], v6 offset:4096
    s_waitcnt lgkmcnt(6)
    v_mfma_f32_32x32x16_bf16 v[40:55], v[240:243], v[32:35], v[40:55]
    v_mfma_f32_32x32x16_bf16 v[56:71], v[244:247], v[32:35], v[56:71]
    ds_read_b128 v[28:31], v6 offset:5120
    s_waitcnt lgkmcnt(6)
    v_mfma_f32_32x32x16_bf16 v[40:55], v[248:251], v[36:39], v[40:55]
    v_mfma_f32_32x32x16_bf16 v[56:71], v[252:255], v[36:39], v[56:71]
    v_mov_b32 v2, v6
    s_mov_b32 s16, s21
    s_add_u32 s14, s14, 1
    s_cmp_ge_u32 s14, s15
    s_cbranch_scc1 gemmb_kernel_gk_fin0
gemmb_kernel_gk_loop:
    ds_read_b128 v[32:35], v2 offset:6144
    s_waitcnt lgkmcnt(6)
    v_mfma_f32_32x32x16_bf16 v[72:87], a[0:3], v[8:11], 0
    v_mfma_f32_32x32x16_bf16 v[88:103], a[4:7], v[8:11], 0
    ds_read_b128 v[36:39], v2 offset:7168
    s_waitcnt lgkmcnt(6)
    v_mfma_f32_32x32x16_bf16 v[72:87], a[8:11], v[12:15], v[72:87]
    v_mfma_f32_32x32x16_bf16 v[88:103], a[12:15], v[12:15], v[88:103]
    ds_read_b128 v[8:11], v2 offset:8192
    s_waitcnt lgkmcnt(6)
    v_mfma_f32_32x32x16_bf16 v[72:87], a[16:19], v[16:19], v[72:87]
    v_cvt_pk_bf16_f32 v104, v40, v41
    v_mfma_f32_32x32x16_bf16 v[88:103], a[20:23], v[16:19], v[88:103]
    v_cvt_pk_bf16_f32 v105, v42, v43
    ds_read_b128 v[12:15], v2 offset:9216
    s_waitcnt lgkmcnt(6)
    v_mfma_f32_32x32x16_bf16 v[72:87], a[24:27], v[20:23], v[72:87]
    v_cvt_pk_bf16_f32 v106, v44, v45
    v_mfma_f32_32x32x16_bf16 v[88:103], a[28:31], v[20:23], v[88:103]
    v_cvt_pk_bf16_f32 v107, v46, v47
    ds_read_b128 v[16:19], v2 offset:10240
    s_waitcnt lgkmcnt(6)
    v_mfma_f32_32x32x16_bf16 v[72:87], a[32:35], v[24:27], v[72:87]
    s_nop 1
    v_mfma_f32_32x32x16_bf16 v[88:103], a[36:39], v[24:27], v[88:103]
    v_permlane32_swap_b32 v104, v106
    ds_read_b128 v[20:23], v2 offset:11264
    s_waitcnt lgkmcnt(6)
    v_mfma_f32_32x32x16_bf16 v[72:87], a[40:43], v[28:31], v[72:87]
    v_permlane32_swap_b32 v105, v107
    v_mfma_f32_32x32x16_bf16 v[88:103], a[44:47], v[28:31], v[88:103]
    buffer_store_dwordx4 v[104:107], v3, s[8:11], s17 offen offset:0
    ds_read_b128 v[24:27], v2 offset:12288
    s_waitcnt lgkmcnt(6)
    v_mfma_f32_32x32x16_bf16 v[72:87], a[48:51], v[32:35], v[72:87]
    v_cvt_pk_bf16_f32 v108, v48, v49
    v_mfma_f32_32x32x16_bf16 v[88:103], a[52:55], v[32:35], v[88:103]
    v_cvt_pk_bf16_f32 v109, v50, v51
    ds_read_b128 v[28:31], v2 offset:13312
    s_waitcnt lgkmcnt(6)
    v_mfma_f32_32x32x16_bf16 v[72:87], a[56:59], v[36:39], v[72:87]
    v_cvt_pk_bf16_f32 v110, v52, v53
    v_mfma_f32_32x32x16_bf16 v[88:103], a[60:63], v[36:39], v[88:103]
    v_cvt_pk_bf16_f32 v111, v54, v55
    ds_read_b128 v[32:35], v2 offset:14336
    s_waitcnt lgkmcnt(6)
    v_mfma_f32_32x32x16_bf16 v[72:87], a[64:67], v[8:11], v[72:87]
    s_nop 1
    v_mfma_f32_32x32x16_bf16 v[88:103], a[68:71], v[8:11], v[88:103]
    v_permlane32_swap_b32 v108, v110
    ds_read_b128 v[36:39], v2 offset:15360
    s_waitcnt lgkmcnt(6)
    v_mfma_f32_32x32x16_bf16 v[72:87], a[72:75], v[12:15], v[72:87]
    v_permlane32_swap_b32 v109, v111
    v_mfma_f32_32x32x16_bf16 v[88:103], a[76:79], v[12:15], v[88:103]
    buffer_store_dwordx4 v[108:111], v3, s[8:11], s17 offen offset:1024
    ds_read_b128 v[8:11], v2 offset:16384
    s_waitcnt lgkmcnt(6)
    v_mfma_f32_32x32x16_bf16 v[72:87], a[80:83], v[16:19], v[72:87]
    v_cvt_pk_bf16_f32 v112, v56, v57
    v_mfma_f32_32x32x16_bf16 v[88:103], a[84:87], v[16:19], v[88:103]
    v_cvt_pk_bf16_f32 v113, v58, v59
    ds_read_b128 v[12:15], v2 offset:17408
    s_waitcnt lgkmcnt(6)
    v_mfma_f32_32x32x16_bf16 v[72:87], a[88:91], v[20:23], v[72:87]
    v_cvt_pk_bf16_f32 v114, v60, v61
    v_mfma_f32_32x32x16_bf16 v[88:103], a[92:95], v[20:23], v[88:103]
    v_cvt_pk_bf16_f32 v115, v62, v63
    ds_read_b128 v[16:19], v2 offset:18432
    s_waitcnt lgkmcnt(6)
    v_mfma_f32_32x32x16_bf16 v[72:87], a[96:99], v[24:27], v[72:87]
    s_nop 1
    v_mfma_f32_32x32x16_bf16 v[88:103], a[100:103], v[24:27], v[88:103]
    v_permlane32_swap_b32 v112, v114
    ds_read_b128 v[20:23], v2 offset:19456
    s_waitcnt lgkmcnt(6)
    v_mfma_f32_32x32x16_bf16 v[72:87], a[104:107], v[28:31], v[72:87]
    v_permlane32_swap_b32 v113, v115
    v_mfma_f32_32x32x16_bf16 v[88:103], a[108:111], v[28:31], v[88:103]
    buffer_store_dwordx4 v[112:115], v3, s[8:11], s18 offen offset:0
    ds_read_b128 v[24:27], v2 offset:20480
    s_waitcnt lgkmcnt(6)
    v_mfma_f32_32x32x16_bf16 v[72:87], a[112:115], v[32:35], v[72:87]
    v_cvt_pk_bf16_f32 v116, v64, v65
    v_mfma_f32_32x32x16_bf16 v[88:103], a[116:119], v[32:35], v[88:103]
    v_cvt_pk_bf16_f32 v117, v66, v67
    ds_read_b128 v[28:31], v2 offset:21504
    s_waitcnt lgkmcnt(6)
    v_mfma_f32_32x32x16_bf16 v[72:87], a[120:123], v[36:39], v[72:87]
    v_cvt_pk_bf16_f32 v118, v68, v69
    v_mfma_f32_32x32x16_bf16 v[88:103], a[124:127], v[36:39], v[88:103]
    v_cvt_pk_bf16_f32 v119, v70, v71
    ds_read_b128 v[32:35], v2 offset:22528
    s_waitcnt lgkmcnt(6)
    v_mfma_f32_32x32x16_bf16 v[72:87], a[128:131], v[8:11], v[72:87]
    s_nop 1
    v_mfma_f32_32x32x16_bf16 v[88:103], a[132:135], v[8:11], v[88:103]
    v_permlane32_swap_b32 v116, v118
    ds_read_b128 v[36:39], v2 offset:23552
    s_waitcnt lgkmcnt(6)
    v_mfma_f32_32x32x16_bf16 v[72:87], a[136:139], v[12:15], v[72:87]
    v_permlane32_swap_b32 v117, v119
    v_mfma_f32_32x32x16_bf16 v[88:103], a[140:143], v[12:15], v[88:103]
    buffer_store_dwordx4 v[116:119], v3, s[8:11], s18 offen offset:1024
    ds_read_b128 v[8:11], v2 offset:24576
    s_waitcnt lgkmcnt(6)
    v_mfma_f32_32x32x16_bf16 v[72:87], a[144:147], v[16:19], v[72:87]
    s_add_u32 s17, s17, s20
    v_mfma_f32_32x32x16_bf16 v[88:103], a[148:151], v[16:19], v[88:103]
    s_add_u32 s18, s18, s20
    ds_read_b128 v[12:15], v2 offset:25600
    s_waitcnt lgkmcnt(6)
    v_mfma_f32_32x32x16_bf16 v[72:87], a[152:155], v[20:23], v[72:87]
    v_mfma_f32_32x32x16_bf16 v[88:103], a[156:159], v[20:23], v[88:103]
    ds_read_b128 v[16:19], v2 offset:26624
    s_waitcnt lgkmcnt(6)
    v_mfma_f32_32x32x16_bf16 v[72:87], a[160:163], v[24:27], v[72:87]
    v_mfma_f32_32x32x16_bf16 v[88:103], a[164:167], v[24:27], v[88:103]
    ds_read_b128 v[20:23], v2 offset:27648
    s_waitcnt lgkmcnt(6)
    v_mfma_f32_32x32x16_bf16 v[72:87], a[168:171], v[28:31], v[72:87]
    v_mfma_f32_32x32x16_bf16 v[88:103], a[172:175], v[28:31], v[88:103]
    ds_read_b128 v[24:27], v2 offset:28672
    s_waitcnt lgkmcnt(6)
    v_mfma_f32_32x32x16_bf16 v[72:87], a[176:179], v[32:35], v[72:87]
    v_mfma_f32_32x32x16_bf16 v[88:103], a[180:183], v[32:35], v[88:103]
    ds_read_b128 v[28:31], v2 offset:29696
    s_waitcnt lgkmcnt(6)
    v_mfma_f32_32x32x16_bf16 v[72:87], a[184:187], v[36:39], v[72:87]
    v_mfma_f32_32x32x16_bf16 v[88:103], a[188:191], v[36:39], v[88:103]
    ds_read_b128 v[32:35], v2 offset:30720
    s_waitcnt lgkmcnt(6)
    v_mfma_f32_32x32x16_bf16 v[72:87], a[192:195], v[8:11], v[72:87]
    v_mfma_f32_32x32x16_bf16 v[88:103], a[196:199], v[8:11], v[88:103]
    ds_read_b128 v[36:39], v2 offset:31744
    s_waitcnt lgkmcnt(6)
    v_mfma_f32_32x32x16_bf16 v[72:87], a[200:203], v[12:15], v[72:87]
    v_mfma_f32_32x32x16_bf16 v[88:103], a[204:207], v[12:15], v[88:103]
    ds_read_b128 v[8:11], v2 offset:32768
    s_waitcnt lgkmcnt(6)
    v_mfma_f32_32x32x16_bf16 v[72:87], a[208:211], v[16:19], v[72:87]
    v_mfma_f32_32x32x16_bf16 v[88:103], a[212:215], v[16:19], v[88:103]
    ds_read_b128 v[12:15], v2 offset:33792
    s_waitcnt lgkmcnt(6)
    v_mfma_f32_32x32x16_bf16 v[72:87], a[216:219], v[20:23], v[72:87]
    v_mfma_f32_32x32x16_bf16 v[88:103], a[220:223], v[20:23], v[88:103]
    ds_read_b128 v[16:19], v2 offset:34816
    s_waitcnt lgkmcnt(6)
    v_mfma_f32_32x32x16_bf16 v[72:87], a[224:227], v[24:27], v[72:87]
    v_mfma_f32_32x32x16_bf16 v[88:103], a[228:231], v[24:27], v[88:103]
    s_waitcnt vmcnt(0)
    s_barrier
    s_add_u32 s21, s16, 40960
    s_cmp_eq_u32 s21, 122880
    s_cselect_b32 s21, 0, s21
    s_add_u32 s23, s14, 2
    s_min_u32 s24, s23, 63
    s_mul_i32 s24, s24, 40960
    s_add_u32 s24, s24, s19
    s_mul_i32 s25, s13, 10240
    s_add_u32 s25, s25, s22
    s_mov_b32 m0, s25
    s_nop 0
    buffer_load_dwordx4 v1, s[8:11], s24 offen offset:0 lds
    buffer_load_dwordx4 v1, s[8:11], s24 offen offset:1024 lds
    buffer_load_dwordx4 v1, s[8:11], s24 offen offset:2048 lds
    buffer_load_dwordx4 v1, s[8:11], s24 offen offset:3072 lds
    s_add_u32 s24, s24, 4096
    s_add_u32 s25, s25, 4096
    s_mov_b32 m0, s25
    s_nop 0
    buffer_load_dwordx4 v1, s[8:11], s24 offen offset:0 lds
    buffer_load_dwordx4 v1, s[8:11], s24 offen offset:1024 lds
    buffer_load_dwordx4 v1, s[8:11], s24 offen offset:2048 lds
    buffer_load_dwordx4 v1, s[8:11], s24 offen offset:3072 lds
    s_add_u32 s24, s24, 4096
    s_add_u32 s25, s25, 4096
    s_mov_b32 m0, s25
    s_nop 0
    buffer_load_dwordx4 v1, s[8:11], s24 offen offset:0 lds
    buffer_load_dwordx4 v1, s[8:11], s24 offen offset:1024 lds
    s_add_u32 s22, s22, 40960
    s_cmp_eq_u32 s22, 122880
    s_cselect_b32 s22, 0, s22
    ds_read_b128 v[20:23], v2 offset:35840
    s_waitcnt lgkmcnt(6)
    v_mfma_f32_32x32x16_bf16 v[72:87], a[232:235], v[28:31], v[72:87]
    v_mfma_f32_32x32x16_bf16 v[88:103], a[236:239], v[28:31], v[88:103]
    ds_read_b128 v[24:27], v2 offset:36864
    s_waitcnt lgkmcnt(6)
    v_mfma_f32_32x32x16_bf16 v[72:87], a[240:243], v[32:35], v[72:87]
    v_mfma_f32_32x32x16_bf16 v[88:103], a[244:247], v[32:35], v[88:103]
    ds_read_b128 v[28:31], v2 offset:37888
    s_waitcnt lgkmcnt(6)
    v_mfma_f32_32x32x16_bf16 v[72:87], a[248:251], v[36:39], v[72:87]
    v_mfma_f32_32x32x16_bf16 v[88:103], a[252:255], v[36:39], v[88:103]
    ds_read_b128 v[32:35], v2 offset:38912
    s_waitcnt lgkmcnt(6)
    v_mfma_f32_32x32x16_bf16 v[72:87], v[192:195], v[8:11], v[72:87]
    v_mfma_f32_32x32x16_bf16 v[88:103], v[196:199], v[8:11], v[88:103]
    ds_read_b128 v[36:39], v2 offset:39936
    s_waitcnt lgkmcnt(6)
    v_mfma_f32_32x32x16_bf16 v[72:87], v[200:203], v[12:15], v[72:87]
    v_mfma_f32_32x32x16_bf16 v[88:103], v[204:207], v[12:15], v[88:103]
    v_add_u32 v6, s21, v1
    ds_read_b128 v[8:11], v6 offset:0
    s_waitcnt lgkmcnt(6)
    v_mfma_f32_32x32x16_bf16 v[72:87], v[208:211], v[16:19], v[72:87]
    v_mfma_f32_32x32x16_bf16 v[88:103], v[212:215], v[16:19], v[88:103]
    ds_read_b128 v[12:15], v6 offset:1024
    s_waitcnt lgkmcnt(6)
    v_mfma_f32_32x32x16_bf16 v[72:87], v[216:219], v[20:23], v[72:87]
    v_mfma_f32_32x32x16_bf16 v[88:103], v[220:223], v[20:23], v[88:103]
    ds_read_b128 v[16:19], v6 offset:2048
    s_waitcnt lgkmcnt(6)
    v_mfma_f32_32x32x16_bf16 v[72:87], v[224:227], v[24:27], v[72:87]
    v_mfma_f32_32x32x16_bf16 v[88:103], v[228:231], v[24:27], v[88:103]
    ds_read_b128 v[20:23], v6 offset:3072
    s_waitcnt lgkmcnt(6)
    v_mfma_f32_32x32x16_bf16 v[72:87], v[232:235], v[28:31], v[72:87]
    v_mfma_f32_32x32x16_bf16 v[88:103], v[236:239], v[28:31], v[88:103]
    ds_read_b128 v[24:27], v6 offset:4096
    s_waitcnt lgkmcnt(6)
    v_mfma_f32_32x32x16_bf16 v[72:87], v[240:243], v[32:35], v[72:87]
    v_mfma_f32_32x32x16_bf16 v[88:103], v[244:247], v[32:35], v[88:103]
    ds_read_b128 v[28:31], v6 offset:5120
    s_waitcnt lgkmcnt(6)
    v_mfma_f32_32x32x16_bf16 v[72:87], v[248:251], v[36:39], v[72:87]
    v_mfma_f32_32x32x16_bf16 v[88:103], v[252:255], v[36:39], v[88:103]
    v_mov_b32 v2, v6
    s_mov_b32 s16, s21
    s_add_u32 s14, s14, 1
    s_cmp_ge_u32 s14, s15
    s_cbranch_scc1 gemmb_kernel_gk_fin1
    ds_read_b128 v[32:35], v2 offset:6144
    s_waitcnt lgkmcnt(6)
    v_mfma_f32_32x32x16_bf16 v[40:55], a[0:3], v[8:11], 0
    v_mfma_f32_32x32x16_bf16 v[56:71], a[4:7], v[8:11], 0
    ds_read_b128 v[36:39], v2 offset:7168
    s_waitcnt lgkmcnt(6)
    v_mfma_f32_32x32x16_bf16 v[40:55], a[8:11], v[12:15], v[40:55]
    v_mfma_f32_32x32x16_bf16 v[56:71], a[12:15], v[12:15], v[56:71]
    ds_read_b128 v[8:11], v2 offset:8192
    s_waitcnt lgkmcnt(6)
    v_mfma_f32_32x32x16_bf16 v[40:55], a[16:19], v[16:19], v[40:55]
    v_cvt_pk_bf16_f32 v104, v72, v73
    v_mfma_f32_32x32x16_bf16 v[56:71], a[20:23], v[16:19], v[56:71]
    v_cvt_pk_bf16_f32 v105, v74, v75
    ds_read_b128 v[12:15], v2 offset:9216
    s_waitcnt lgkmcnt(6)
    v_mfma_f32_32x32x16_bf16 v[40:55], a[24:27], v[20:23], v[40:55]
    v_cvt_pk_bf16_f32 v106, v76, v77
    v_mfma_f32_32x32x16_bf16 v[56:71], a[28:31], v[20:23], v[56:71]
    v_cvt_pk_bf16_f32 v107, v78, v79
    ds_read_b128 v[16:19], v2 offset:10240
    s_waitcnt lgkmcnt(6)
    v_mfma_f32_32x32x16_bf16 v[40:55], a[32:35], v[24:27], v[40:55]
    s_nop 1
    v_mfma_f32_32x32x16_bf16 v[56:71], a[36:39], v[24:27], v[56:71]
    v_permlane32_swap_b32 v104, v106
    ds_read_b128 v[20:23], v2 offset:11264
    s_waitcnt lgkmcnt(6)
    v_mfma_f32_32x32x16_bf16 v[40:55], a[40:43], v[28:31], v[40:55]
    v_permlane32_swap_b32 v105, v107
    v_mfma_f32_32x32x16_bf16 v[56:71], a[44:47], v[28:31], v[56:71]
    buffer_store_dwordx4 v[104:107], v3, s[8:11], s17 offen offset:0
    ds_read_b128 v[24:27], v2 offset:12288
    s_waitcnt lgkmcnt(6)
    v_mfma_f32_32x32x16_bf16 v[40:55], a[48:51], v[32:35], v[40:55]
    v_cvt_pk_bf16_f32 v108, v80, v81
    v_mfma_f32_32x32x16_bf16 v[56:71], a[52:55], v[32:35], v[56:71]
    v_cvt_pk_bf16_f32 v109, v82, v83
    ds_read_b128 v[28:31], v2 offset:13312
    s_waitcnt lgkmcnt(6)
    v_mfma_f32_32x32x16_bf16 v[40:55], a[56:59], v[36:39], v[40:55]
    v_cvt_pk_bf16_f32 v110, v84, v85
    v_mfma_f32_32x32x16_bf16 v[56:71], a[60:63], v[36:39], v[56:71]
    v_cvt_pk_bf16_f32 v111, v86, v87
    ds_read_b128 v[32:35], v2 offset:14336
    s_waitcnt lgkmcnt(6)
    v_mfma_f32_32x32x16_bf16 v[40:55], a[64:67], v[8:11], v[40:55]
    s_nop 1
    v_mfma_f32_32x32x16_bf16 v[56:71], a[68:71], v[8:11], v[56:71]
    v_permlane32_swap_b32 v108, v110
    ds_read_b128 v[36:39], v2 offset:15360
    s_waitcnt lgkmcnt(6)
    v_mfma_f32_32x32x16_bf16 v[40:55], a[72:75], v[12:15], v[40:55]
    v_permlane32_swap_b32 v109, v111
    v_mfma_f32_32x32x16_bf16 v[56:71], a[76:79], v[12:15], v[56:71]
    buffer_store_dwordx4 v[108:111], v3, s[8:11], s17 offen offset:1024
    ds_read_b128 v[8:11], v2 offset:16384
    s_waitcnt lgkmcnt(6)
    v_mfma_f32_32x32x16_bf16 v[40:55], a[80:83], v[16:19], v[40:55]
    v_cvt_pk_bf16_f32 v112, v88, v89
    v_mfma_f32_32x32x16_bf16 v[56:71], a[84:87], v[16:19], v[56:71]
    v_cvt_pk_bf16_f32 v113, v90, v91
    ds_read_b128 v[12:15], v2 offset:17408
    s_waitcnt lgkmcnt(6)
    v_mfma_f32_32x32x16_bf16 v[40:55], a[88:91], v[20:23], v[40:55]
    v_cvt_pk_bf16_f32 v114, v92, v93
    v_mfma_f32_32x32x16_bf16 v[56:71], a[92:95], v[20:23], v[56:71]
    v_cvt_pk_bf16_f32 v115, v94, v95
    ds_read_b128 v[16:19], v2 offset:18432
    s_waitcnt lgkmcnt(6)
    v_mfma_f32_32x32x16_bf16 v[40:55], a[96:99], v[24:27], v[40:55]
    s_nop 1
    v_mfma_f32_32x32x16_bf16 v[56:71], a[100:103], v[24:27], v[56:71]
    v_permlane32_swap_b32 v112, v114
    ds_read_b128 v[20:23], v2 offset:19456
    s_waitcnt lgkmcnt(6)
    v_mfma_f32_32x32x16_bf16 v[40:55], a[104:107], v[28:31], v[40:55]
    v_permlane32_swap_b32 v113, v115
    v_mfma_f32_32x32x16_bf16 v[56:71], a[108:111], v[28:31], v[56:71]
    buffer_store_dwordx4 v[112:115], v3, s[8:11], s18 offen offset:0
    ds_read_b128 v[24:27], v2 offset:20480
    s_waitcnt lgkmcnt(6)
    v_mfma_f32_32x32x16_bf16 v[40:55], a[112:115], v[32:35], v[40:55]
    v_cvt_pk_bf16_f32 v116, v96, v97
    v_mfma_f32_32x32x16_bf16 v[56:71], a[116:119], v[32:35], v[56:71]
    v_cvt_pk_bf16_f32 v117, v98, v99
    ds_read_b128 v[28:31], v2 offset:21504
    s_waitcnt lgkmcnt(6)
    v_mfma_f32_32x32x16_bf16 v[40:55], a[120:123], v[36:39], v[40:55]
    v_cvt_pk_bf16_f32 v118, v100, v101
    v_mfma_f32_32x32x16_bf16 v[56:71], a[124:127], v[36:39], v[56:71]
    v_cvt_pk_bf16_f32 v119, v102, v103
    ds_read_b128 v[32:35], v2 offset:22528
    s_waitcnt lgkmcnt(6)
    v_mfma_f32_32x32x16_bf16 v[40:55], a[128:131], v[8:11], v[40:55]
    s_nop 1
    v_mfma_f32_32x32x16_bf16 v[56:71], a[132:135], v[8:11], v[56:71]
    v_permlane32_swap_b32 v116, v118
    ds_read_b128 v[36:39], v2 offset:23552
    s_waitcnt lgkmcnt(6)
    v_mfma_f32_32x32x16_bf16 v[40:55], a[136:139], v[12:15], v[40:55]
    v_permlane32_swap_b32 v117, v119
    v_mfma_f32_32x32x16_bf16 v[56:71], a[140:143], v[12:15], v[56:71]
    buffer_store_dwordx4 v[116:119], v3, s[8:11], s18 offen offset:1024
    ds_read_b128 v[8:11], v2 offset:24576
    s_waitcnt lgkmcnt(6)
    v_mfma_f32_32x32x16_bf16 v[40:55], a[144:147], v[16:19], v[40:55]
    s_add_u32 s17, s17, s20
    v_mfma_f32_32x32x16_bf16 v[56:71], a[148:151], v[16:19], v[56:71]
    s_add_u32 s18, s18, s20
    ds_read_b128 v[12:15], v2 offset:25600
    s_waitcnt lgkmcnt(6)
    v_mfma_f32_32x32x16_bf16 v[40:55], a[152:155], v[20:23], v[40:55]
    v_mfma_f32_32x32x16_bf16 v[56:71], a[156:159], v[20:23], v[56:71]
    ds_read_b128 v[16:19], v2 offset:26624
    s_waitcnt lgkmcnt(6)
    v_mfma_f32_32x32x16_bf16 v[40:55], a[160:163], v[24:27], v[40:55]
    v_mfma_f32_32x32x16_bf16 v[56:71], a[164:167], v[24:27], v[56:71]
    ds_read_b128 v[20:23], v2 offset:27648
    s_waitcnt lgkmcnt(6)
    v_mfma_f32_32x32x16_bf16 v[40:55], a[168:171], v[28:31], v[40:55]
    v_mfma_f32_32x32x16_bf16 v[56:71], a[172:175], v[28:31], v[56:71]
    ds_read_b128 v[24:27], v2 offset:28672
    s_waitcnt lgkmcnt(6)
    v_mfma_f32_32x32x16_bf16 v[40:55], a[176:179], v[32:35], v[40:55]
    v_mfma_f32_32x32x16_bf16 v[56:71], a[180:183], v[32:35], v[56:71]
    ds_read_b128 v[28:31], v2 offset:29696
    s_waitcnt lgkmcnt(6)
    v_mfma_f32_32x32x16_bf16 v[40:55], a[184:187], v[36:39], v[40:55]
    v_mfma_f32_32x32x16_bf16 v[56:71], a[188:191], v[36:39], v[56:71]
    ds_read_b128 v[32:35], v2 offset:30720
    s_waitcnt lgkmcnt(6)
    v_mfma_f32_32x32x16_bf16 v[40:55], a[192:195], v[8:11], v[40:55]
    v_mfma_f32_32x32x16_bf16 v[56:71], a[196:199], v[8:11], v[56:71]
    ds_read_b128 v[36:39], v2 offset:31744
    s_waitcnt lgkmcnt(6)
    v_mfma_f32_32x32x16_bf16 v[40:55], a[200:203], v[12:15], v[40:55]
    v_mfma_f32_32x32x16_bf16 v[56:71], a[204:207], v[12:15], v[56:71]
    ds_read_b128 v[8:11], v2 offset:32768
    s_waitcnt lgkmcnt(6)
    v_mfma_f32_32x32x16_bf16 v[40:55], a[208:211], v[16:19], v[40:55]
    v_mfma_f32_32x32x16_bf16 v[56:71], a[212:215], v[16:19], v[56:71]
    ds_read_b128 v[12:15], v2 offset:33792
    s_waitcnt lgkmcnt(6)
    v_mfma_f32_32x32x16_bf16 v[40:55], a[216:219], v[20:23], v[40:55]
    v_mfma_f32_32x32x16_bf16 v[56:71], a[220:223], v[20:23], v[56:71]
    ds_read_b128 v[16:19], v2 offset:34816
    s_waitcnt lgkmcnt(6)
    v_mfma_f32_32x32x16_bf16 v[40:55], a[224:227], v[24:27], v[40:55]
    v_mfma_f32_32x32x16_bf16 v[56:71], a[228:231], v[24:27], v[56:71]
    s_waitcnt vmcnt(0)
    s_barrier
    s_add_u32 s21, s16, 40960
    s_cmp_eq_u32 s21, 122880
    s_cselect_b32 s21, 0, s21
    s_add_u32 s23, s14, 2
    s_min_u32 s24, s23, 63
    s_mul_i32 s24, s24, 40960
    s_add_u32 s24, s24, s19
    s_mul_i32 s25, s13, 10240
    s_add_u32 s25, s25, s22
    s_mov_b32 m0, s25
    s_nop 0
    buffer_load_dwordx4 v1, s[8:11], s24 offen offset:0 lds
    buffer_load_dwordx4 v1, s[8:11], s24 offen offset:1024 lds
    buffer_load_dwordx4 v1, s[8:11], s24 offen offset:2048 lds
    buffer_load_dwordx4 v1, s[8:11], s24 offen offset:3072 lds
    s_add_u32 s24, s24, 4096
    s_add_u32 s25, s25, 4096
    s_mov_b32 m0, s25
    s_nop 0
    buffer_load_dwordx4 v1, s[8:11], s24 offen offset:0 lds
    buffer_load_dwordx4 v1, s[8:11], s24 offen offset:1024 lds
    buffer_load_dwordx4 v1, s[8:11], s24 offen offset:2048 lds
    buffer_load_dwordx4 v1, s[8:11], s24 offen offset:3072 lds
    s_add_u32 s24, s24, 4096
    s_add_u32 s25, s25, 4096
    s_mov_b32 m0, s25
    s_nop 0
    buffer_load_dwordx4 v1, s[8:11], s24 offen offset:0 lds
    buffer_load_dwordx4 v1, s[8:11], s24 offen offset:1024 lds
    s_add_u32 s22, s22, 40960
    s_cmp_eq_u32 s22, 122880
    s_cselect_b32 s22, 0, s22
    ds_read_b128 v[20:23], v2 offset:35840
    s_waitcnt lgkmcnt(6)
    v_mfma_f32_32x32x16_bf16 v[40:55], a[232:235], v[28:31], v[40:55]
    v_mfma_f32_32x32x16_bf16 v[56:71], a[236:239], v[28:31], v[56:71]
    ds_read_b128 v[24:27], v2 offset:36864
    s_waitcnt lgkmcnt(6)
    v_mfma_f32_32x32x16_bf16 v[40:55], a[240:243], v[32:35], v[40:55]
    v_mfma_f32_32x32x16_bf16 v[56:71], a[244:247], v[32:35], v[56:71]
    ds_read_b128 v[28:31], v2 offset:37888
    s_waitcnt lgkmcnt(6)
    v_mfma_f32_32x32x16_bf16 v[40:55], a[248:251], v[36:39], v[40:55]
    v_mfma_f32_32x32x16_bf16 v[56:71], a[252:255], v[36:39], v[56:71]
    ds_read_b128 v[32:35], v2 offset:38912
    s_waitcnt lgkmcnt(6)
    v_mfma_f32_32x32x16_bf16 v[40:55], v[192:195], v[8:11], v[40:55]
    v_mfma_f32_32x32x16_bf16 v[56:71], v[196:199], v[8:11], v[56:71]
    ds_read_b128 v[36:39], v2 offset:39936
    s_waitcnt lgkmcnt(6)
    v_mfma_f32_32x32x16_bf16 v[40:55], v[200:203], v[12:15], v[40:55]
    v_mfma_f32_32x32x16_bf16 v[56:71], v[204:207], v[12:15], v[56:71]
    v_add_u32 v6, s21, v1
    ds_read_b128 v[8:11], v6 offset:0
    s_waitcnt lgkmcnt(6)
    v_mfma_f32_32x32x16_bf16 v[40:55], v[208:211], v[16:19], v[40:55]
    v_mfma_f32_32x32x16_bf16 v[56:71], v[212:215], v[16:19], v[56:71]
    ds_read_b128 v[12:15], v6 offset:1024
    s_waitcnt lgkmcnt(6)
    v_mfma_f32_32x32x16_bf16 v[40:55], v[216:219], v[20:23], v[40:55]
    v_mfma_f32_32x32x16_bf16 v[56:71], v[220:223], v[20:23], v[56:71]
    ds_read_b128 v[16:19], v6 offset:2048
    s_waitcnt lgkmcnt(6)
    v_mfma_f32_32x32x16_bf16 v[40:55], v[224:227], v[24:27], v[40:55]
    v_mfma_f32_32x32x16_bf16 v[56:71], v[228:231], v[24:27], v[56:71]
    ds_read_b128 v[20:23], v6 offset:3072
    s_waitcnt lgkmcnt(6)
    v_mfma_f32_32x32x16_bf16 v[40:55], v[232:235], v[28:31], v[40:55]
    v_mfma_f32_32x32x16_bf16 v[56:71], v[236:239], v[28:31], v[56:71]
    ds_read_b128 v[24:27], v6 offset:4096
    s_waitcnt lgkmcnt(6)
    v_mfma_f32_32x32x16_bf16 v[40:55], v[240:243], v[32:35], v[40:55]
    v_mfma_f32_32x32x16_bf16 v[56:71], v[244:247], v[32:35], v[56:71]
    ds_read_b128 v[28:31], v6 offset:5120
    s_waitcnt lgkmcnt(6)
    v_mfma_f32_32x32x16_bf16 v[40:55], v[248:251], v[36:39], v[40:55]
    v_mfma_f32_32x32x16_bf16 v[56:71], v[252:255], v[36:39], v[56:71]
    v_mov_b32 v2, v6
    s_mov_b32 s16, s21
    s_add_u32 s14, s14, 1
    s_cmp_lt_u32 s14, s15
    s_cbranch_scc1 gemmb_kernel_gk_loop
gemmb_kernel_gk_fin0:
    s_nop 7
    s_nop 7
    v_cvt_pk_bf16_f32 v104, v40, v41
    v_cvt_pk_bf16_f32 v105, v42, v43
    v_cvt_pk_bf16_f32 v106, v44, v45
    v_cvt_pk_bf16_f32 v107, v46, v47
    s_nop 1
    v_permlane32_swap_b32 v104, v106
    v_permlane32_swap_b32 v105, v107
    buffer_store_dwordx4 v[104:107], v3, s[8:11], s17 offen offset:0
    v_cvt_pk_bf16_f32 v108, v48, v49
    v_cvt_pk_bf16_f32 v109, v50, v51
    v_cvt_pk_bf16_f32 v110, v52, v53
    v_cvt_pk_bf16_f32 v111, v54, v55
    s_nop 1
    v_permlane32_swap_b32 v108, v110
    v_permlane32_swap_b32 v109, v111
    buffer_store_dwordx4 v[108:111], v3, s[8:11], s17 offen offset:1024
    v_cvt_pk_bf16_f32 v112, v56, v57
    v_cvt_pk_bf16_f32 v113, v58, v59
    v_cvt_pk_bf16_f32 v114, v60, v61
    v_cvt_pk_bf16_f32 v115, v62, v63
    s_nop 1
    v_permlane32_swap_b32 v112, v114
    v_permlane32_swap_b32 v113, v115
    buffer_store_dwordx4 v[112:115], v3, s[8:11], s18 offen offset:0
    v_cvt_pk_bf16_f32 v116, v64, v65
    v_cvt_pk_bf16_f32 v117, v66, v67
    v_cvt_pk_bf16_f32 v118, v68, v69
    v_cvt_pk_bf16_f32 v119, v70, v71
    s_nop 1
    v_permlane32_swap_b32 v116, v118
    v_permlane32_swap_b32 v117, v119
    buffer_store_dwordx4 v[116:119], v3, s[8:11], s18 offen offset:1024
    s_add_u32 s17, s17, s20
    s_add_u32 s18, s18, s20
    s_branch gemmb_kernel_gk_done
gemmb_kernel_gk_fin1:
    s_nop 7
    s_nop 7
    v_cvt_pk_bf16_f32 v104, v72, v73
    v_cvt_pk_bf16_f32 v105, v74, v75
    v_cvt_pk_bf16_f32 v106, v76, v77
    v_cvt_pk_bf16_f32 v107, v78, v79
    s_nop 1
    v_permlane32_swap_b32 v104, v106
    v_permlane32_swap_b32 v105, v107
    buffer_store_dwordx4 v[104:107], v3, s[8:11], s17 offen offset:0
    v_cvt_pk_bf16_f32 v108, v80, v81
    v_cvt_pk_bf16_f32 v109, v82, v83
    v_cvt_pk_bf16_f32 v110, v84, v85
    v_cvt_pk_bf16_f32 v111, v86, v87
    s_nop 1
    v_permlane32_swap_b32 v108, v110
    v_permlane32_swap_b32 v109, v111
    buffer_store_dwordx4 v[108:111], v3, s[8:11], s17 offen offset:1024
    v_cvt_pk_bf16_f32 v112, v88, v89
    v_cvt_pk_bf16_f32 v113, v90, v91
    v_cvt_pk_bf16_f32 v114, v92, v93
    v_cvt_pk_bf16_f32 v115, v94, v95
    s_nop 1
    v_permlane32_swap_b32 v112, v114
    v_permlane32_swap_b32 v113, v115
    buffer_store_dwordx4 v[112:115], v3, s[8:11], s18 offen offset:0
    v_cvt_pk_bf16_f32 v116, v96, v97
    v_cvt_pk_bf16_f32 v117, v98, v99
    v_cvt_pk_bf16_f32 v118, v100, v101
    v_cvt_pk_bf16_f32 v119, v102, v103
    s_nop 1
    v_permlane32_swap_b32 v116, v118
    v_permlane32_swap_b32 v117, v119
    buffer_store_dwordx4 v[116:119], v3, s[8:11], s18 offen offset:1024
    s_add_u32 s17, s17, s20
    s_add_u32 s18, s18, s20
gemmb_kernel_gk_done:
    s_waitcnt vmcnt(0) lgkmcnt(0)
gemmb_kernel_g_done:
gemmb_kernel_end:
    s_endpgm
.section .rodata,"a"
.p2align 6
.amdhsa_kernel gemmb_kernel
  .amdhsa_next_free_vgpr 512
  .amdhsa_next_free_sgpr 64
  .amdhsa_accum_offset 256
  .amdhsa_group_segment_fixed_size 0
  .amdhsa_kernarg_size 104
  .amdhsa_user_sgpr_count 2
  .amdhsa_user_sgpr_kernarg_segment_ptr 1
  .amdhsa_system_sgpr_workgroup_id_x 1
.end_amdhsa_kernel
.text
.globl chain1_kernel
.p2align 8
.type chain1_kernel,@function
chain1_kernel:
    s_cmp_ge_u32 s2, 256
    s_cbranch_scc1 chain1_kernel_end
    s_load_dwordx2 s[4:5], s[0:1], 96
    v_lshrrev_b32 v1, 6, v0
    v_and_b32 v0, 63, v0
    s_nop 0
    v_readfirstlane_b32 s13, v1
    s_mov_b32 s15, 400000
    s_waitcnt lgkmcnt(0)
    s_mov_b32 s8, s4
    s_mov_b32 s9, s5
    s_mov_b32 s10, 268435456
    s_mov_b32 s11, 0x00020000
    s_getreg_b32 s20, hwreg(HW_REG_XCC_ID)
    s_and_b32 s20, s20, 7
    s_cmp_lg_u32 s13, 0
    s_cbranch_scc1 chain1_kernel_tk_wait
    s_lshl_b32 s22, s20, 8
    s_add_u32 s22, s22, 10485760
    s_mov_b64 exec, 1
    v_mov_b32 v2, 0
    v_mov_b32 v3, 1
    buffer_atomic_add v3, v2, s[8:11], s22 offen sc0 sc1
    s_waitcnt vmcnt(0)
    s_mov_b64 exec, -1
    s_nop 0
    v_readfirstlane_b32 s21, v3
    s_cmp_lt_u32 s21, 32
    s_cbranch_scc1 chain1_kernel_tk_pub
    v_lshlrev_b32 v2, 8, v0
    v_and_b32 v2, 0x7ff, v2
    s_mov_b32 s22, 10485760
chain1_kernel_tk_poll:
    buffer_load_dword v3, v2, s[8:11], s22 offen sc1
    s_waitcnt vmcnt(0)
    s_mov_b32 s23, 0
    v_readlane_b32 s24, v3, 0
    s_nop 0
    s_add_u32 s23, s23, s24
    v_readlane_b32 s25, v3, 1
    s_nop 0
    s_add_u32 s23, s23, s25
    v_readlane_b32 s26, v3, 2
    s_nop 0
    s_add_u32 s23, s23, s26
    v_readlane_b32 s27, v3, 3
    s_nop 0
    s_add_u32 s23, s23, s27
    v_readlane_b32 s28, v3, 4
    s_nop 0
    s_add_u32 s23, s23, s28
    v_readlane_b32 s29, v3, 5
    s_nop 0
    s_add_u32 s23, s23, s29
    v_readlane_b32 s30, v3, 6
    s_nop 0
    s_add_u32 s23, s23, s30
    v_readlane_b32 s31, v3, 7
    s_nop 0
    s_add_u32 s23, s23, s31
    s_sub_u32 s15, s15, 1
    s_cbranch_scc1 chain1_kernel_bail
    s_cmp_lt_u32 s23, 256
    s_cbranch_scc1 chain1_kernel_tk_poll
    s_sub_u32 s21, s21, 32
    s_max_u32 s23, s24, 32
    s_sub_u32 s23, s23, 32
    s_cmp_gt_u32 s20, 0
    s_cselect_b32 s23, s23, 0
    s_add_u32 s21, s21, s23
    s_max_u32 s23, s25, 32
    s_sub_u32 s23, s23, 32
    s_cmp_gt_u32 s20, 1
    s_cselect_b32 s23, s23, 0
    s_add_u32 s21, s21, s23
    s_max_u32 s23, s26, 32
    s_sub_u32 s23, s23, 32
    s_cmp_gt_u32 s20, 2
    s_cselect_b32 s23, s23, 0
    s_add_u32 s21, s21, s23
    s_max_u32 s23, s27, 32
    s_sub_u32 s23, s23, 32
    s_cmp_gt_u32 s20, 3
    s_cselect_b32 s23, s23, 0
    s_add_u32 s21, s21, s23
    s_max_u32 s23, s28, 32
    s_sub_u32 s23, s23, 32
    s_cmp_gt_u32 s20, 4
    s_cselect_b32 s23, s23, 0
    s_add_u32 s21, s21, s23
    s_max_u32 s23, s29, 32
    s_sub_u32 s23, s23, 32
    s_cmp_gt_u32 s20, 5
    s_cselect_b32 s23, s23, 0
    s_add_u32 s21, s21, s23
    s_max_u32 s23, s30, 32
    s_sub_u32 s23, s23, 32
    s_cmp_gt_u32 s20, 6
    s_cselect_b32 s23, s23, 0
    s_add_u32 s21, s21, s23
    s_min_u32 s23, s24, 32
    s_sub_u32 s22, 32, s23
    s_cmp_lt_u32 s21, s22
    s_cbranch_scc0 chain1_kernel_tk_n0
    s_mov_b32 s20, 0
    s_add_u32 s21, s21, s23
    s_branch chain1_kernel_tk_pub
chain1_kernel_tk_n0:
    s_sub_u32 s21, s21, s22
    s_min_u32 s23, s25, 32
    s_sub_u32 s22, 32, s23
    s_cmp_lt_u32 s21, s22
    s_cbranch_scc0 chain1_kernel_tk_n1
    s_mov_b32 s20, 1
    s_add_u32 s21, s21, s23
    s_branch chain1_kernel_tk_pub
chain1_kernel_tk_n1:
    s_sub_u32 s21, s21, s22
    s_min_u32 s23, s26, 32
    s_sub_u32 s22, 32, s23
    s_cmp_lt_u32 s21, s22
    s_cbranch_scc0 chain1_kernel_tk_n2
    s_mov_b32 s20, 2
    s_add_u32 s21, s21, s23
    s_branch chain1_kernel_tk_pub
chain1_kernel_tk_n2:
    s_sub_u32 s21, s21, s22
    s_min_u32 s23, s27, 32
    s_sub_u32 s22, 32, s23
    s_cmp_lt_u32 s21, s22
    s_cbranch_scc0 chain1_kernel_tk_n3
    s_mov_b32 s20, 3
    s_add_u32 s21, s21, s23
    s_branch chain1_kernel_tk_pub
chain1_kernel_tk_n3:
    s_sub_u32 s21, s21, s22
    s_min_u32 s23, s28, 32
    s_sub_u32 s22, 32, s23
    s_cmp_lt_u32 s21, s22
    s_cbranch_scc0 chain1_kernel_tk_n4
    s_mov_b32 s20, 4
    s_add_u32 s21, s21, s23
    s_branch chain1_kernel_tk_pub
chain1_kernel_tk_n4:
    s_sub_u32 s21, s21, s22
    s_min_u32 s23, s29, 32
    s_sub_u32 s22, 32, s23
    s_cmp_lt_u32 s21, s22
    s_cbranch_scc0 chain1_kernel_tk_n5
    s_mov_b32 s20, 5
    s_add_u32 s21, s21, s23
    s_branch chain1_kernel_tk_pub
chain1_kernel_tk_n5:
    s_sub_u32 s21, s21, s22
    s_min_u32 s23, s30, 32
    s_sub_u32 s22, 32, s23
    s_cmp_lt_u32 s21, s22
    s_cbranch_scc0 chain1_kernel_tk_n6
    s_mov_b32 s20, 6
    s_add_u32 s21, s21, s23
    s_branch chain1_kernel_tk_pub
chain1_kernel_tk_n6:
    s_sub_u32 s21, s21, s22
    s_min_u32 s23, s31, 32
    s_sub_u32 s22, 32, s23
    s_cmp_lt_u32 s21, s22
    s_cbranch_scc0 chain1_kernel_tk_n7
    s_mov_b32 s20, 7
    s_add_u32 s21, s21, s23
    s_branch chain1_kernel_tk_pub
chain1_kernel_tk_n7:
    s_sub_u32 s21, s21, s22
    s_branch chain1_kernel_bail
chain1_kernel_tk_pub:
    s_lshl_b32 s22, s20, 8
    s_or_b32 s22, s22, s21
    v_mov_b32 v2, 0
    v_mov_b32 v3, s22
    ds_write_b32 v2, v3
    s_waitcnt lgkmcnt(0)
chain1_kernel_tk_wait:
    s_barrier
    v_mov_b32 v2, 0
    ds_read_b32 v3, v2
    s_waitcnt lgkmcnt(0)
    v_readfirstlane_b32 s22, v3
    s_barrier
    s_lshr_b32 s20, s22, 8
    s_and_b32 s21, s22, 255
    s_sub_u32 s22, 0, s4
    s_and_b32 s22, s22, 0x1fffff
    s_mov_b32 s23, 10551296
    s_buffer_load_dwordx2 s[24:25], s[8:11], s23
    s_waitcnt lgkmcnt(0)
    s_and_b32 s24, s24, 8192
    s_and_b32 s25, s25, 8192
    s_add_u32 s22, s22, 0
    s_add_u32 s16, s22, s24
    s_add_u32 s17, s22, s25
    s_add_u32 s17, s17, 2097152
    s_mov_b32 s40, 0x01010101
    s_mov_b32 s41, 0x01010101
    s_mov_b32 s42, 0x00010001
    s_mov_b32 s43, 0
    v_lshlrev_b32 v1, 4, v0
    v_and_b32 v16, 8, v0
    v_cmp_eq_u32 vcc, 0, v16
    v_mov_b32 v17, 0xeeeeeeee
    v_mov_b32 v18, 0x44444444
    v_cndmask_b32 v2, v17, v18, vcc
    s_cmp_eq_u32 s20, 0
    s_cbranch_scc0 chain1_kernel_notp
    s_mov_b32 s12, s21
    s_cmp_eq_u32 s13, 0
    s_cbranch_scc1 chain1_kernel_p0_start
    s_cmp_eq_u32 s13, 1
    s_cbranch_scc1 chain1_kernel_p1_start
    s_cmp_eq_u32 s13, 2
    s_cbranch_scc1 chain1_kernel_p2_start
    s_cmp_eq_u32 s13, 3
    s_cbranch_scc1 chain1_kernel_p3_start
chain1_kernel_notp:
    s_cmp_ge_u32 s20, 4
    s_cbranch_scc1 chain1_kernel_end
    s_cmp_ge_u32 s21, 27
    s_cbranch_scc1 chain1_kernel_end
    s_sub_u32 s22, s20, 1
    s_mul_i32 s22, s22, 27
    s_add_u32 s12, s22, s21
    s_cmp_ge_u32 s12, 80
    s_cbranch_scc1 chain1_kernel_end
    s_cmp_eq_u32 s13, 0
    s_cbranch_scc1 chain1_kernel_y0_start
    s_cmp_eq_u32 s13, 1
    s_cbranch_scc1 chain1_kernel_y1_start
    s_cmp_eq_u32 s13, 2
    s_cbranch_scc1 chain1_kernel_y2_start
    s_cmp_eq_u32 s13, 3
    s_cbranch_scc1 chain1_kernel_y3_start
    s_branch chain1_kernel_end
chain1_kernel_p0_start:
    v_lshrrev_b32 v16, 4, v0
    v_and_b32 v17, 15, v0
    v_and_b32 v18, 1, v16
    v_lshlrev_b32 v18, 2, v18
    v_lshrrev_b32 v19, 1, v16
    v_lshl_add_u32 v18, v19, 1, v18
    v_mul_u32_u24 v18, 400, v18
    v_lshl_add_u32 v18, v17, 1, v18
    v_add_u32 v3, 133120, v18
    v_and_b32 v18, 7, v0
    v_mul_u32_u24 v18, 400, v18
    v_lshrrev_b32 v19, 3, v0
    v_lshl_add_u32 v18, v19, 4, v18
    v_add_u32 v4, 133120, v18
    v_and_b32 v18, 7, v0
    v_mul_u32_u24 v18, 400, v18
    v_lshl_add_u32 v18, v16, 5, v18
    v_add_u32 v5, 136320, v18
    v_lshrrev_b32 v18, 1, v16
    v_lshlrev_b32 v18, 10, v18
    v_and_b32 v19, 31, v0
    v_lshl_add_u32 v18, v19, 4, v18
    v_add_u32 v6, 139520, v18
    v_add_u32 v15, 139520, v1
    v_lshrrev_b32 v18, 1, v16
    v_lshlrev_b32 v18, 1, v18
    v_lshrrev_b32 v19, 3, v17
    v_add3_u32 v18, v18, v19, 1
    v_lshrrev_b32 v19, 1, v18
    v_lshlrev_b32 v19, 14, v19
    v_and_b32 v18, 1, v18
    v_lshl_add_u32 v18, v18, 12, v19
    v_and_b32 v19, 1, v16
    v_lshlrev_b32 v19, 4, v19
    v_add_u32 v19, 0, v19
    s_lshl_b32 s20, s12, 7
    v_add_u32 v8, s20, v19
    v_add_u32 v7, v8, v18
    v_lshlrev_b32 v18, 4, v17
    v_lshl_add_u32 v18, v16, 10, v18
    v_add_u32 v9, 0, v18
    v_add_u32 v18, 0, v0
    v_mul_u32_u24 v19, 2731, v18
    v_lshrrev_b32 v19, 16, v19
    v_mul_u32_u24 v20, 24, v19
    v_sub_u32 v20, v18, v20
    v_mul_u32_u24 v21, 400, v19
    v_lshl_add_u32 v21, v20, 4, v21
    v_add_u32 v10, 136320, v21
    v_lshlrev_b32 v21, 4, v19
    v_lshl_add_u32 v11, v20, 7, v21
    v_and_b32 v18, 0x28, v0
    v_cmp_eq_u32 vcc, 0, v18
    v_mov_b32 v18, 1.0
    v_mov_b32 v19, 0
    v_cndmask_b32 v12, v19, v18, vcc
    v_add_u32 v13, 0, v1
    v_add_u32 v14, 122880, v1
    s_mul_i32 s44, s12, 12288
    s_add_u32 s44, s44, 53477376
    s_mul_i32 s45, s12, 3072
    s_add_u32 s45, s45, 208666624
    s_mul_i32 s20, s12, 491520
    s_add_u32 s20, s20, 11534336
    s_add_u32 s21, s20, 6144
    buffer_load_dwordx4 v[16:19], v1, s[8:11], s21 offen offset:0
    buffer_load_dwordx4 v[20:23], v1, s[8:11], s21 offen offset:1024
    s_add_u32 s21, s20, 47104
    buffer_load_dwordx4 v[24:27], v1, s[8:11], s21 offen offset:0
    buffer_load_dwordx4 v[28:31], v1, s[8:11], s21 offen offset:1024
    s_add_u32 s21, s20, 28672
    buffer_load_dwordx4 v[32:35], v1, s[8:11], s21 offen offset:0
    buffer_load_dwordx4 v[36:39], v1, s[8:11], s21 offen offset:1024
    s_add_u32 s21, s20, 10240
    buffer_load_dwordx4 v[40:43], v1, s[8:11], s21 offen offset:0
    buffer_load_dwordx4 v[44:47], v1, s[8:11], s21 offen offset:1024
    s_add_u32 s21, s20, 51200
    buffer_load_dwordx4 v[48:51], v1, s[8:11], s21 offen offset:0
    buffer_load_dwordx4 v[52:55], v1, s[8:11], s21 offen offset:1024
    s_add_u32 s21, s20, 32768
    buffer_load_dwordx4 v[56:59], v1, s[8:11], s21 offen offset:0
    buffer_load_dwordx4 v[60:63], v1, s[8:11], s21 offen offset:1024
    s_add_u32 s21, s20, 14336
    buffer_load_dwordx4 v[64:67], v1, s[8:11], s21 offen offset:0
    buffer_load_dwordx4 v[68:71], v1, s[8:11], s21 offen offset:1024
    s_add_u32 s21, s20, 55296
    buffer_load_dwordx4 v[72:75], v1, s[8:11], s21 offen offset:0
    buffer_load_dwordx4 v[76:79], v1, s[8:11], s21 offen offset:1024
    s_add_u32 s21, s20, 36864
    buffer_load_dwordx4 v[80:83], v1, s[8:11], s21 offen offset:0
    buffer_load_dwordx4 v[84:87], v1, s[8:11], s21 offen offset:1024
    s_add_u32 s21, s20, 18432
    buffer_load_dwordx4 v[88:91], v1, s[8:11], s21 offen offset:0
    buffer_load_dwordx4 v[92:95], v1, s[8:11], s21 offen offset:1024
    s_add_u32 s21, s20, 59392
    buffer_load_dwordx4 v[96:99], v1, s[8:11], s21 offen offset:0
    buffer_load_dwordx4 v[100:103], v1, s[8:11], s21 offen offset:1024
    s_add_u32 s21, s20, 90112
    buffer_load_dwordx4 v[104:107], v1, s[8:11], s21 offen offset:0
    buffer_load_dwordx4 v[108:111], v1, s[8:11], s21 offen offset:1024
    s_add_u32 s21, s20, 98304
    buffer_load_dwordx4 v[112:115], v1, s[8:11], s21 offen offset:0
    buffer_load_dwordx4 v[116:119], v1, s[8:11], s21 offen offset:1024
    s_add_u32 s21, s20, 106496
    buffer_load_dwordx4 v[120:123], v1, s[8:11], s21 offen offset:0
    buffer_load_dwordx4 v[124:127], v1, s[8:11], s21 offen offset:1024
    s_add_u32 s21, s20, 114688
    buffer_load_dwordx4 v[128:131], v1, s[8:11], s21 offen offset:0
    buffer_load_dwordx4 v[132:135], v1, s[8:11], s21 offen offset:1024
    s_add_u32 s21, s20, 0
    buffer_load_dwordx4 a[0:3], v1, s[8:11], s21 offen offset:0
    buffer_load_dwordx4 a[4:7], v1, s[8:11], s21 offen offset:1024
    s_add_u32 s21, s20, 20480
    buffer_load_dwordx4 a[8:11], v1, s[8:11], s21 offen offset:0
    buffer_load_dwordx4 a[12:15], v1, s[8:11], s21 offen offset:1024
    s_add_u32 s21, s20, 40960
    buffer_load_dwordx4 a[16:19], v1, s[8:11], s21 offen offset:0
    buffer_load_dwordx4 a[20:23], v1, s[8:11], s21 offen offset:1024
    s_add_u32 s21, s20, 2048
    buffer_load_dwordx4 a[24:27], v1, s[8:11], s21 offen offset:0
    buffer_load_dwordx4 a[28:31], v1, s[8:11], s21 offen offset:1024
    s_add_u32 s21, s20, 22528
    buffer_load_dwordx4 a[32:35], v1, s[8:11], s21 offen offset:0
    buffer_load_dwordx4 a[36:39], v1, s[8:11], s21 offen offset:1024
    s_add_u32 s21, s20, 43008
    buffer_load_dwordx4 a[40:43], v1, s[8:11], s21 offen offset:0
    buffer_load_dwordx4 a[44:47], v1, s[8:11], s21 offen offset:1024
    s_add_u32 s21, s20, 4096
    buffer_load_dwordx4 a[48:51], v1, s[8:11], s21 offen offset:0
    buffer_load_dwordx4 a[52:55], v1, s[8:11], s21 offen offset:1024
    s_add_u32 s21, s20, 24576
    buffer_load_dwordx4 a[56:59], v1, s[8:11], s21 offen offset:0
    buffer_load_dwordx4 a[60:63], v1, s[8:11], s21 offen offset:1024
    s_add_u32 s21, s20, 45056
    buffer_load_dwordx4 a[64:67], v1, s[8:11], s21 offen offset:0
    buffer_load_dwordx4 a[68:71], v1, s[8:11], s21 offen offset:1024
    s_add_u32 s21, s20, 26624
    buffer_load_dwordx4 a[72:75], v1, s[8:11], s21 offen offset:0
    buffer_load_dwordx4 a[76:79], v1, s[8:11], s21 offen offset:1024
    s_add_u32 s21, s20, 8192
    buffer_load_dwordx4 a[80:83], v1, s[8:11], s21 offen offset:0
    buffer_load_dwordx4 a[84:87], v1, s[8:11], s21 offen offset:1024
    s_add_u32 s21, s20, 49152
    buffer_load_dwordx4 a[88:91], v1, s[8:11], s21 offen offset:0
    buffer_load_dwordx4 a[92:95], v1, s[8:11], s21 offen offset:1024
    s_add_u32 s21, s20, 30720
    buffer_load_dwordx4 a[96:99], v1, s[8:11], s21 offen offset:0
    buffer_load_dwordx4 a[100:103], v1, s[8:11], s21 offen offset:1024
    s_add_u32 s21, s20, 12288
    buffer_load_dwordx4 a[104:107], v1, s[8:11], s21 offen offset:0
    buffer_load_dwordx4 a[108:111], v1, s[8:11], s21 offen offset:1024
    s_add_u32 s21, s20, 53248
    buffer_load_dwordx4 a[112:115], v1, s[8:11], s21 offen offset:0
    buffer_load_dwordx4 a[116:119], v1, s[8:11], s21 offen offset:1024
    s_add_u32 s21, s20, 34816
    buffer_load_dwordx4 a[120:123], v1, s[8:11], s21 offen offset:0
    buffer_load_dwordx4 a[124:127], v1, s[8:11], s21 offen offset:1024
    s_waitcnt vmcnt(32)
    ds_write_b128 v13, v[16:19] offset:0
    ds_write_b128 v13, v[20:23] offset:1024
    ds_write_b128 v13, v[24:27] offset:2048
    ds_write_b128 v13, v[28:31] offset:3072
    ds_write_b128 v13, v[32:35] offset:4096
    ds_write_b128 v13, v[36:39] offset:5120
    ds_write_b128 v13, v[40:43] offset:6144
    ds_write_b128 v13, v[44:47] offset:7168
    ds_write_b128 v13, v[48:51] offset:8192
    ds_write_b128 v13, v[52:55] offset:9216
    ds_write_b128 v13, v[56:59] offset:10240
    ds_write_b128 v13, v[60:63] offset:11264
    ds_write_b128 v13, v[64:67] offset:12288
    ds_write_b128 v13, v[68:71] offset:13312
    ds_write_b128 v13, v[72:75] offset:14336
    ds_write_b128 v13, v[76:79] offset:15360
    ds_write_b128 v13, v[80:83] offset:16384
    ds_write_b128 v13, v[84:87] offset:17408
    ds_write_b128 v13, v[88:91] offset:18432
    ds_write_b128 v13, v[92:95] offset:19456
    ds_write_b128 v13, v[96:99] offset:20480
    ds_write_b128 v13, v[100:103] offset:21504
    ds_write_b128 v13, v[104:107] offset:22528
    ds_write_b128 v13, v[108:111] offset:23552
    ds_write_b128 v13, v[112:115] offset:24576
    ds_write_b128 v13, v[116:119] offset:25600
    ds_write_b128 v13, v[120:123] offset:26624
    ds_write_b128 v13, v[124:127] offset:27648
    ds_write_b128 v13, v[128:131] offset:28672
    ds_write_b128 v13, v[132:135] offset:29696
    s_add_u32 s21, s20, 16384
    buffer_load_dwordx4 a[128:131], v1, s[8:11], s21 offen offset:0
    buffer_load_dwordx4 a[132:135], v1, s[8:11], s21 offen offset:1024
    s_add_u32 s21, s20, 57344
    buffer_load_dwordx4 a[136:139], v1, s[8:11], s21 offen offset:0
    buffer_load_dwordx4 a[140:143], v1, s[8:11], s21 offen offset:1024
    s_add_u32 s21, s20, 38912
    buffer_load_dwordx4 a[144:147], v1, s[8:11], s21 offen offset:0
    buffer_load_dwordx4 a[148:151], v1, s[8:11], s21 offen offset:1024
    s_add_u32 s21, s20, 61440
    buffer_load_dwordx4 a[152:155], v1, s[8:11], s21 offen offset:0
    buffer_load_dwordx4 a[156:159], v1, s[8:11], s21 offen offset:1024
    s_add_u32 s21, s20, 63488
    buffer_load_dwordx4 a[160:163], v1, s[8:11], s21 offen offset:0
    buffer_load_dwordx4 a[164:167], v1, s[8:11], s21 offen offset:1024
    s_add_u32 s21, s20, 65536
    buffer_load_dwordx4 a[168:171], v1, s[8:11], s21 offen offset:0
    buffer_load_dwordx4 a[172:175], v1, s[8:11], s21 offen offset:1024
    s_add_u32 s21, s20, 67584
    buffer_load_dwordx4 a[176:179], v1, s[8:11], s21 offen offset:0
    buffer_load_dwordx4 a[180:183], v1, s[8:11], s21 offen offset:1024
    s_add_u32 s21, s20, 69632
    buffer_load_dwordx4 a[184:187], v1, s[8:11], s21 offen offset:0
    buffer_load_dwordx4 a[188:191], v1, s[8:11], s21 offen offset:1024
    s_add_u32 s21, s20, 71680
    buffer_load_dwordx4 a[192:195], v1, s[8:11], s21 offen offset:0
    buffer_load_dwordx4 a[196:199], v1, s[8:11], s21 offen offset:1024
    s_add_u32 s21, s20, 73728
    buffer_load_dwordx4 a[200:203], v1, s[8:11], s21 offen offset:0
    buffer_load_dwordx4 a[204:207], v1, s[8:11], s21 offen offset:1024
    s_add_u32 s21, s20, 75776
    buffer_load_dwordx4 a[208:211], v1, s[8:11], s21 offen offset:0
    buffer_load_dwordx4 a[212:215], v1, s[8:11], s21 offen offset:1024
    s_add_u32 s21, s20, 77824
    buffer_load_dwordx4 a[216:219], v1, s[8:11], s21 offen offset:0
    buffer_load_dwordx4 a[220:223], v1, s[8:11], s21 offen offset:1024
    s_add_u32 s21, s20, 79872
    buffer_load_dwordx4 a[224:227], v1, s[8:11], s21 offen offset:0
    buffer_load_dwordx4 a[228:231], v1, s[8:11], s21 offen offset:1024
    s_add_u32 s21, s20, 81920
    buffer_load_dwordx4 a[232:235], v1, s[8:11], s21 offen offset:0
    buffer_load_dwordx4 a[236:239], v1, s[8:11], s21 offen offset:1024
    s_add_u32 s21, s20, 83968
    buffer_load_dwordx4 a[240:243], v1, s[8:11], s21 offen offset:0
    buffer_load_dwordx4 a[244:247], v1, s[8:11], s21 offen offset:1024
    s_add_u32 s21, s20, 86016
    buffer_load_dwordx4 a[248:251], v1, s[8:11], s21 offen offset:0
    buffer_load_dwordx4 a[252:255], v1, s[8:11], s21 offen offset:1024
    s_add_u32 s21, s20, 88064
    buffer_load_dwordx4 v[148:151], v1, s[8:11], s21 offen offset:0
    buffer_load_dwordx4 v[152:155], v1, s[8:11], s21 offen offset:1024
    s_add_u32 s21, s20, 92160
    buffer_load_dwordx4 v[156:159], v1, s[8:11], s21 offen offset:0
    buffer_load_dwordx4 v[160:163], v1, s[8:11], s21 offen offset:1024
    s_add_u32 s21, s20, 94208
    buffer_load_dwordx4 v[164:167], v1, s[8:11], s21 offen offset:0
    buffer_load_dwordx4 v[168:171], v1, s[8:11], s21 offen offset:1024
    s_add_u32 s21, s20, 96256
    buffer_load_dwordx4 v[172:175], v1, s[8:11], s21 offen offset:0
    buffer_load_dwordx4 v[176:179], v1, s[8:11], s21 offen offset:1024
    s_add_u32 s21, s20, 100352
    buffer_load_dwordx4 v[180:183], v1, s[8:11], s21 offen offset:0
    buffer_load_dwordx4 v[184:187], v1, s[8:11], s21 offen offset:1024
    s_add_u32 s21, s20, 102400
    buffer_load_dwordx4 v[188:191], v1, s[8:11], s21 offen offset:0
    buffer_load_dwordx4 v[192:195], v1, s[8:11], s21 offen offset:1024
    s_add_u32 s21, s20, 104448
    buffer_load_dwordx4 v[196:199], v1, s[8:11], s21 offen offset:0
    buffer_load_dwordx4 v[200:203], v1, s[8:11], s21 offen offset:1024
    s_add_u32 s21, s20, 108544
    buffer_load_dwordx4 v[204:207], v1, s[8:11], s21 offen offset:0
    buffer_load_dwordx4 v[208:211], v1, s[8:11], s21 offen offset:1024
    s_add_u32 s21, s20, 110592
    buffer_load_dwordx4 v[212:215], v1, s[8:11], s21 offen offset:0
    buffer_load_dwordx4 v[216:219], v1, s[8:11], s21 offen offset:1024
    s_add_u32 s21, s20, 112640
    buffer_load_dwordx4 v[220:223], v1, s[8:11], s21 offen offset:0
    buffer_load_dwordx4 v[224:227], v1, s[8:11], s21 offen offset:1024
    s_add_u32 s21, s20, 116736
    buffer_load_dwordx4 v[228:231], v1, s[8:11], s21 offen offset:0
    buffer_load_dwordx4 v[232:235], v1, s[8:11], s21 offen offset:1024
    s_add_u32 s21, s20, 118784
    buffer_load_dwordx4 v[236:239], v1, s[8:11], s21 offen offset:0
    buffer_load_dwordx4 v[240:243], v1, s[8:11], s21 offen offset:1024
    s_add_u32 s21, s20, 120832
    buffer_load_dwordx4 v[244:247], v1, s[8:11], s21 offen offset:0
    buffer_load_dwordx4 v[248:251], v1, s[8:11], s21 offen offset:1024
    s_waitcnt lgkmcnt(0)
    s_mov_b32 s14, 0
    s_mul_i32 s20, s14, 393216
    s_add_u32 s20, s20, s44
    s_add_u32 s21, s20, 0
    buffer_load_dwordx4 v[100:103], v9, s[8:11], s21 offen offset:0
    buffer_load_dwordx4 v[104:107], v9, s[8:11], s21 offen offset:512
    s_add_u32 s21, s20, 4096
    buffer_load_dwordx4 v[108:111], v9, s[8:11], s21 offen offset:0
    buffer_load_dwordx4 v[112:115], v9, s[8:11], s21 offen offset:512
    v_mov_b32 v56, 0
    v_mov_b32 v57, 0
    v_mov_b32 v58, 0
    v_mov_b32 v59, 0
    v_mov_b32 v60, 0
    v_mov_b32 v61, 0
    v_mov_b32 v62, 0
    v_mov_b32 v63, 0
    v_mov_b32 v64, 0
    v_mov_b32 v65, 0
    v_mov_b32 v66, 0
    v_mov_b32 v67, 0
    v_mov_b32 v68, 0
    v_mov_b32 v69, 0
    v_mov_b32 v70, 0
    v_mov_b32 v71, 0
    v_mov_b32 v72, 0
    v_mov_b32 v73, 0
    v_mov_b32 v74, 0
    v_mov_b32 v75, 0
    v_mov_b32 v76, 0
    v_mov_b32 v77, 0
    v_mov_b32 v78, 0
    v_mov_b32 v79, 0
    v_mov_b32 v80, 0
    v_mov_b32 v81, 0
    v_mov_b32 v82, 0
    v_mov_b32 v83, 0
    v_mov_b32 v84, 0
    v_mov_b32 v85, 0
    v_mov_b32 v86, 0
    v_mov_b32 v87, 0
    ds_read_b128 v[116:119], v13 offset:0
    ds_read_b128 v[120:123], v13 offset:1024
    ds_read_b128 v[124:127], v13 offset:2048
    ds_read_b128 v[128:131], v13 offset:3072
    ds_read_b128 v[132:135], v13 offset:4096
    ds_read_b128 v[136:139], v13 offset:5120
    ds_read_b128 v[140:143], v13 offset:6144
    ds_read_b128 v[144:147], v13 offset:7168
    s_waitcnt lgkmcnt(0)
chain1_kernel_p0_step:
    s_cmp_lt_u32 s14, 32
    s_cselect_b32 s18, s16, s17
    s_and_b32 s20, s14, 31
    s_lshl_b32 s20, s20, 16
    s_add_u32 s18, s18, s20
    s_add_u32 s22, s18, 36864
    s_add_u32 s23, s18, 37888
    s_add_u32 s24, s18, 38912
chain1_kernel_p0_poll:
    buffer_load_dwordx4 v[16:19], v1, s[8:11], s22 offen sc1
    buffer_load_dwordx4 v[20:23], v1, s[8:11], s23 offen sc1
    buffer_load_dwordx4 v[24:27], v1, s[8:11], s24 offen sc1
    s_waitcnt vmcnt(0)
    ds_write_b128 v14, v[16:19] offset:0
    ds_write_b128 v14, v[20:23] offset:1024
    ds_write_b128 v14, v[24:27] offset:2048
    v_max3_u32 v88, v16, v17, v18
    v_max3_u32 v88, v88, v19, v20
    v_max3_u32 v88, v88, v21, v22
    v_max3_u32 v88, v88, v23, v24
    v_max3_u32 v88, v88, v25, v26
    v_max_u32 v88, v88, v27
    v_cmp_eq_u32 vcc, -1, v88
    s_sub_u32 s15, s15, 1
    s_cbranch_scc1 chain1_kernel_bail
    s_cbranch_vccnz chain1_kernel_p0_poll
    s_waitcnt lgkmcnt(0)
    s_barrier
    ds_read_b128 v[28:31], v14 offset:3072
    ds_read_b128 v[32:35], v14 offset:4096
    ds_read_b128 v[36:39], v14 offset:5120
    ds_read_b128 v[40:43], v14 offset:6144
    ds_read_b128 v[44:47], v14 offset:7168
    ds_read_b128 v[48:51], v14 offset:8192
    ds_read_b128 v[52:55], v14 offset:9216
    v_smfmac_f32_16x16x64_bf16 v[56:59], v[16:19], a[0:7], v2
    v_smfmac_f32_16x16x64_bf16 v[60:63], v[16:19], a[8:15], v2
    v_smfmac_f32_16x16x64_bf16 v[64:67], v[16:19], a[16:23], v2
    v_smfmac_f32_16x16x64_bf16 v[56:59], v[20:23], a[24:31], v2
    v_smfmac_f32_16x16x64_bf16 v[60:63], v[20:23], a[32:39], v2
    v_smfmac_f32_16x16x64_bf16 v[64:67], v[20:23], a[40:47], v2
    v_smfmac_f32_16x16x64_bf16 v[56:59], v[24:27], a[48:55], v2
    v_smfmac_f32_16x16x64_bf16 v[60:63], v[24:27], a[56:63], v2
    v_smfmac_f32_16x16x64_bf16 v[64:67], v[24:27], a[64:71], v2
    s_waitcnt lgkmcnt(6)
    v_smfmac_f32_16x16x64_bf16 v[56:59], v[28:31], v[116:123], v2
    ds_read_b128 v[116:119], v13 offset:8192
    ds_read_b128 v[120:123], v13 offset:9216
    v_smfmac_f32_16x16x64_bf16 v[60:63], v[28:31], a[72:79], v2
    v_smfmac_f32_16x16x64_bf16 v[64:67], v[28:31], v[124:131], v2
    ds_read_b128 v[124:127], v13 offset:10240
    ds_read_b128 v[128:131], v13 offset:11264
    s_waitcnt lgkmcnt(9)
    v_smfmac_f32_16x16x64_bf16 v[56:59], v[32:35], a[80:87], v2
    v_smfmac_f32_16x16x64_bf16 v[60:63], v[32:35], v[132:139], v2
    ds_read_b128 v[132:135], v13 offset:12288
    ds_read_b128 v[136:139], v13 offset:13312
    v_smfmac_f32_16x16x64_bf16 v[64:67], v[32:35], a[88:95], v2
    s_waitcnt lgkmcnt(10)
    v_smfmac_f32_16x16x64_bf16 v[56:59], v[36:39], v[140:147], v2
    ds_read_b128 v[140:143], v13 offset:14336
    ds_read_b128 v[144:147], v13 offset:15360
    v_smfmac_f32_16x16x64_bf16 v[60:63], v[36:39], a[96:103], v2
    s_waitcnt lgkmcnt(6)
    v_smfmac_f32_16x16x64_bf16 v[64:67], v[36:39], v[116:123], v2
    ds_read_b128 v[116:119], v13 offset:16384
    ds_read_b128 v[120:123], v13 offset:17408
    v_smfmac_f32_16x16x64_bf16 v[56:59], v[40:43], a[104:111], v2
    s_waitcnt lgkmcnt(6)
    v_smfmac_f32_16x16x64_bf16 v[60:63], v[40:43], v[124:131], v2
    ds_read_b128 v[124:127], v13 offset:18432
    ds_read_b128 v[128:131], v13 offset:19456
    v_smfmac_f32_16x16x64_bf16 v[64:67], v[40:43], a[112:119], v2
    s_waitcnt lgkmcnt(6)
    v_smfmac_f32_16x16x64_bf16 v[56:59], v[44:47], v[132:139], v2
    ds_read_b128 v[132:135], v13 offset:20480
    ds_read_b128 v[136:139], v13 offset:21504
    v_smfmac_f32_16x16x64_bf16 v[60:63], v[44:47], a[120:127], v2
    s_waitcnt lgkmcnt(6)
    v_smfmac_f32_16x16x64_bf16 v[64:67], v[44:47], v[140:147], v2
    ds_read_b128 v[140:143], v13 offset:22528
    ds_read_b128 v[144:147], v13 offset:23552
    v_smfmac_f32_16x16x64_bf16 v[56:59], v[48:51], a[128:135], v2
    s_waitcnt lgkmcnt(6)
    v_smfmac_f32_16x16x64_bf16 v[60:63], v[48:51], v[116:123], v2
    ds_read_b128 v[116:119], v13 offset:24576
    ds_read_b128 v[120:123], v13 offset:25600
    v_smfmac_f32_16x16x64_bf16 v[64:67], v[48:51], a[136:143], v2
    s_waitcnt lgkmcnt(6)
    v_smfmac_f32_16x16x64_bf16 v[56:59], v[52:55], v[124:131], v2
    ds_read_b128 v[124:127], v13 offset:26624
    ds_read_b128 v[128:131], v13 offset:27648
    v_smfmac_f32_16x16x64_bf16 v[60:63], v[52:55], a[144:151], v2
    s_waitcnt lgkmcnt(6)
    v_smfmac_f32_16x16x64_bf16 v[64:67], v[52:55], v[132:139], v2
    ds_read_b128 v[132:135], v13 offset:28672
    ds_read_b128 v[136:139], v13 offset:29696
    v_smfmac_f32_16x16x64_bf16 v[68:71], v[16:19], a[152:159], v2
    v_smfmac_f32_16x16x64_bf16 v[68:71], v[20:23], a[160:167], v2
    v_permlane32_swap_b32 v56, v58
    v_permlane32_swap_b32 v57, v59
    v_smfmac_f32_16x16x64_bf16 v[68:71], v[24:27], a[168:175], v2
    v_add_f32 v56, v56, v58
    v_add_f32 v57, v57, v59
    v_smfmac_f32_16x16x64_bf16 v[68:71], v[28:31], a[176:183], v2
    v_cvt_pk_bf16_f32 v56, v56, v57
    ds_write_b16 v3, v56 offset:0
    v_smfmac_f32_16x16x64_bf16 v[68:71], v[32:35], a[184:191], v2
    ds_write_b16_d16_hi v3, v56 offset:400
    v_permlane32_swap_b32 v60, v62
    v_smfmac_f32_16x16x64_bf16 v[68:71], v[36:39], a[192:199], v2
    v_permlane32_swap_b32 v61, v63
    v_add_f32 v60, v60, v62
    v_smfmac_f32_16x16x64_bf16 v[68:71], v[40:43], a[200:207], v2
    v_add_f32 v61, v61, v63
    v_cvt_pk_bf16_f32 v60, v60, v61
    v_smfmac_f32_16x16x64_bf16 v[68:71], v[44:47], a[208:215], v2
    ds_write_b16 v3, v60 offset:32
    ds_write_b16_d16_hi v3, v60 offset:432
    v_smfmac_f32_16x16x64_bf16 v[68:71], v[48:51], a[216:223], v2
    v_permlane32_swap_b32 v64, v66
    v_permlane32_swap_b32 v65, v67
    v_smfmac_f32_16x16x64_bf16 v[68:71], v[52:55], a[224:231], v2
    v_add_f32 v64, v64, v66
    v_add_f32 v65, v65, v67
    v_smfmac_f32_16x16x64_bf16 v[72:75], v[16:19], a[232:239], v2
    v_cvt_pk_bf16_f32 v64, v64, v65
    ds_write_b16 v3, v64 offset:64
    v_smfmac_f32_16x16x64_bf16 v[72:75], v[20:23], a[240:247], v2
    ds_write_b16_d16_hi v3, v64 offset:464
    v_smfmac_f32_16x16x64_bf16 v[72:75], v[24:27], a[248:255], v2
    v_smfmac_f32_16x16x64_bf16 v[72:75], v[28:31], v[148:155], v2
    s_waitcnt lgkmcnt(0)
    s_barrier
    ds_read_b128 v[88:91], v4 offset:0
    v_smfmac_f32_16x16x64_bf16 v[72:75], v[32:35], v[140:147], v2
    ds_read_b128 v[92:95], v4 offset:128
    ds_read_b128 v[96:99], v4 offset:256
    v_smfmac_f32_16x16x64_bf16 v[72:75], v[36:39], v[156:163], v2
    v_permlane32_swap_b32 v68, v70
    v_permlane32_swap_b32 v69, v71
    v_smfmac_f32_16x16x64_bf16 v[72:75], v[40:43], v[164:171], v2
    v_add_f32 v68, v68, v70
    v_add_f32 v69, v69, v71
    v_smfmac_f32_16x16x64_bf16 v[72:75], v[44:47], v[172:179], v2
    v_cvt_pk_bf16_f32 v68, v68, v69
    ds_write_b16 v3, v68 offset:3200
    v_smfmac_f32_16x16x64_bf16 v[72:75], v[48:51], v[116:123], v2
    ds_write_b16_d16_hi v3, v68 offset:3600
    v_smfmac_f32_16x16x64_bf16 v[72:75], v[52:55], v[180:187], v2
    s_waitcnt lgkmcnt(2)
    v_smfmac_f32_16x16x64_bf16 v[80:83], v[88:91], v[100:107], v2
    v_smfmac_f32_16x16x64_bf16 v[80:83], v[92:95], v[108:115], v2
    v_smfmac_f32_16x16x64_bf16 v[76:79], v[16:19], v[188:195], v2
    v_smfmac_f32_16x16x64_bf16 v[76:79], v[20:23], v[196:203], v2
    v_smfmac_f32_16x16x64_bf16 v[76:79], v[24:27], v[124:131], v2
    v_permlane32_swap_b32 v72, v74
    v_permlane32_swap_b32 v73, v75
    v_smfmac_f32_16x16x64_bf16 v[76:79], v[28:31], v[204:211], v2
    v_add_f32 v72, v72, v74
    v_add_f32 v73, v73, v75
    ds_write_b128 v15, v[80:83]
    v_smfmac_f32_16x16x64_bf16 v[76:79], v[32:35], v[212:219], v2
    v_cvt_pk_bf16_f32 v72, v72, v73
    ds_write_b16 v3, v72 offset:3232
    v_smfmac_f32_16x16x64_bf16 v[76:79], v[36:39], v[220:227], v2
    ds_write_b16_d16_hi v3, v72 offset:3632
    v_smfmac_f32_16x16x64_bf16 v[76:79], v[40:43], v[132:139], v2
    v_smfmac_f32_16x16x64_bf16 v[76:79], v[44:47], v[228:235], v2
    v_smfmac_f32_16x16x64_bf16 v[76:79], v[48:51], v[236:243], v2
    v_smfmac_f32_16x16x64_bf16 v[76:79], v[52:55], v[244:251], v2
    s_nop 7
    v_permlane32_swap_b32 v76, v78
    v_permlane32_swap_b32 v77, v79
    v_add_f32 v76, v76, v78
    v_add_f32 v77, v77, v79
    v_cvt_pk_bf16_f32 v76, v76, v77
    ds_write_b16 v3, v76 offset:3264
    ds_write_b16_d16_hi v3, v76 offset:3664
    s_waitcnt lgkmcnt(0)
    s_barrier
    ds_read2st64_b32 v[40:41], v6 offset0:0 offset1:2
    ds_read2st64_b32 v[42:43], v6 offset0:8 offset1:10
    ds_read_b128 v[16:19], v5 offset:0
    ds_read_b128 v[20:23], v5 offset:16
    ds_read_b128 v[24:27], v5 offset:128
    ds_read_b128 v[28:31], v5 offset:144
    ds_read_b128 v[32:35], v5 offset:256
    ds_read_b128 v[36:39], v5 offset:272
    s_waitcnt lgkmcnt(6)
    v_add_f32 v40, v40, v41
    v_add_f32 v42, v42, v43
    v_add_f32 v44, v40, v42
    v_mul_f32 v44, 0x3dd53b95, v44
    s_waitcnt lgkmcnt(4)
    v_smfmac_f32_16x16x64_bf16 v[84:87], v[88:91], v[16:23], v2
    s_waitcnt lgkmcnt(2)
    v_smfmac_f32_16x16x64_bf16 v[84:87], v[92:95], v[24:31], v2
    s_waitcnt lgkmcnt(0)
    v_smfmac_f32_16x16x64_bf16 v[84:87], v[96:99], v[32:39], v2
    v_max_f32_dpp v45, v44, v44 row_ror:8 row_mask:0xf bank_mask:0xf
    s_nop 1
    v_max_f32_dpp v45, v45, v45 row_ror:4 row_mask:0xf bank_mask:0xf
    s_nop 1
    v_max_f32_dpp v45, v45, v45 row_ror:2 row_mask:0xf bank_mask:0xf
    s_nop 1
    v_max_f32_dpp v45, v45, v45 row_ror:1 row_mask:0xf bank_mask:0xf
    v_mov_b32 v47, v45
    s_nop 1
    v_permlane32_swap_b32 v45, v47
    v_max_f32 v45, v45, v47
    v_mov_b32 v47, v84
    s_nop 1
    v_permlane32_swap_b32 v84, v47
    v_add_f32 v48, v84, v47
    v_mul_f32 v48, 0x3dd53b95, v48
    s_nop 1
    v_max_f32_dpp v46, v48, v48 row_ror:4 row_mask:0xf bank_mask:0xf
    s_nop 1
    v_max_f32_dpp v46, v46, v46 row_ror:2 row_mask:0xf bank_mask:0xf
    s_nop 1
    v_max_f32_dpp v46, v46, v46 row_ror:1 row_mask:0xf bank_mask:0xf
    v_max_f32 v45, v45, v46
    v_sub_f32 v49, v44, v45
    v_sub_f32 v50, v48, v45
    v_exp_f32 v49, v49
    v_exp_f32 v50, v50
    s_nop 0
    v_fma_f32 v51, v50, v12, v49
    s_nop 1
    v_add_f32_dpp v51, v51, v51 row_ror:8 row_mask:0xf bank_mask:0xf
    s_nop 1
    v_add_f32_dpp v51, v51, v51 row_ror:4 row_mask:0xf bank_mask:0xf
    s_nop 1
    v_add_f32_dpp v51, v51, v51 row_ror:2 row_mask:0xf bank_mask:0xf
    s_nop 1
    v_add_f32_dpp v51, v51, v51 row_ror:1 row_mask:0xf bank_mask:0xf
    v_mov_b32 v47, v51
    s_nop 1
    v_permlane32_swap_b32 v51, v47
    v_add_f32 v51, v51, v47
    v_rcp_f32 v51, v51
    s_nop 0
    v_mul_f32 v49, v49, v51
    v_mul_f32 v50, v50, v51
    s_nop 0
    v_mov_b32_dpp v46, v49 quad_perm:[1,0,3,2] row_mask:0xf bank_mask:0xf
    v_mov_b32_dpp v47, v50 quad_perm:[1,0,3,2] row_mask:0xf bank_mask:0xf
    v_cvt_pk_bf16_f32 v16, v49, v46
    v_cvt_pk_bf16_f32 v20, v50, v47
    s_nop 0
    v_mov_b32_dpp v17, v16 row_shl:2 row_mask:0xf bank_mask:0xf
    v_mov_b32_dpp v18, v16 row_shl:4 row_mask:0xf bank_mask:0xf
    v_mov_b32_dpp v19, v16 row_shl:6 row_mask:0xf bank_mask:0xf
    v_mov_b32_dpp v21, v20 row_shl:2 row_mask:0xf bank_mask:0xf
    v_mov_b32_dpp v22, v20 row_shl:4 row_mask:0xf bank_mask:0xf
    v_mov_b32_dpp v23, v20 row_shl:6 row_mask:0xf bank_mask:0xf
    s_mov_b64 exec, s[40:41]
    buffer_store_dwordx4 v[16:19], v7, s[8:11], s18 offen sc1
    s_mov_b64 exec, s[42:43]
    buffer_store_dwordx4 v[20:23], v8, s[8:11], s18 offen sc1
    s_mov_b64 exec, -1
    ds_read_b128 v[40:43], v10
    s_add_u32 s28, s14, 1
    s_min_u32 s28, s28, 63
    s_mul_i32 s20, s28, 393216
    s_add_u32 s20, s20, s44
    s_add_u32 s21, s20, 0
    buffer_load_dwordx4 v[100:103], v9, s[8:11], s21 offen offset:0
    buffer_load_dwordx4 v[104:107], v9, s[8:11], s21 offen offset:512
    s_add_u32 s21, s20, 4096
    buffer_load_dwordx4 v[108:111], v9, s[8:11], s21 offen offset:0
    buffer_load_dwordx4 v[112:115], v9, s[8:11], s21 offen offset:512
    v_mov_b32 v56, 0
    v_mov_b32 v57, 0
    v_mov_b32 v58, 0
    v_mov_b32 v59, 0
    v_mov_b32 v60, 0
    v_mov_b32 v61, 0
    v_mov_b32 v62, 0
    v_mov_b32 v63, 0
    v_mov_b32 v64, 0
    v_mov_b32 v65, 0
    v_mov_b32 v66, 0
    v_mov_b32 v67, 0
    v_mov_b32 v68, 0
    v_mov_b32 v69, 0
    v_mov_b32 v70, 0
    v_mov_b32 v71, 0
    v_mov_b32 v72, 0
    v_mov_b32 v73, 0
    v_mov_b32 v74, 0
    v_mov_b32 v75, 0
    v_mov_b32 v76, 0
    v_mov_b32 v77, 0
    v_mov_b32 v78, 0
    v_mov_b32 v79, 0
    v_mov_b32 v80, 0
    v_mov_b32 v81, 0
    v_mov_b32 v82, 0
    v_mov_b32 v83, 0
    v_mov_b32 v84, 0
    v_mov_b32 v85, 0
    v_mov_b32 v86, 0
    v_mov_b32 v87, 0
    s_waitcnt lgkmcnt(0)
    s_mul_i32 s20, s14, 98304
    s_add_u32 s20, s20, s45
    buffer_store_dwordx4 v[40:43], v11, s[8:11], s20 offen
    ds_read_b128 v[116:119], v13 offset:0
    ds_read_b128 v[120:123], v13 offset:1024
    ds_read_b128 v[124:127], v13 offset:2048
    ds_read_b128 v[128:131], v13 offset:3072
    ds_read_b128 v[132:135], v13 offset:4096
    ds_read_b128 v[136:139], v13 offset:5120
    ds_read_b128 v[140:143], v13 offset:6144
    ds_read_b128 v[144:147], v13 offset:7168
    s_waitcnt lgkmcnt(0)
    s_add_u32 s14, s14, 1
    s_cmp_lt_u32 s14, 64
    s_cbranch_scc1 chain1_kernel_p0_step
    s_branch chain1_kernel_end
chain1_kernel_p1_start:
    v_lshrrev_b32 v16, 4, v0
    v_and_b32 v17, 15, v0
    v_and_b32 v18, 1, v16
    v_lshlrev_b32 v18, 2, v18
    v_lshrrev_b32 v19, 1, v16
    v_lshl_add_u32 v18, v19, 1, v18
    v_mul_u32_u24 v18, 400, v18
    v_lshl_add_u32 v18, v17, 1, v18
    v_add_u32 v3, 133216, v18
    v_and_b32 v18, 7, v0
    v_mul_u32_u24 v18, 400, v18
    v_lshrrev_b32 v19, 3, v0
    v_lshl_add_u32 v18, v19, 4, v18
    v_add_u32 v4, 133120, v18
    v_and_b32 v18, 7, v0
    v_mul_u32_u24 v18, 400, v18
    v_lshl_add_u32 v18, v16, 5, v18
    v_add_u32 v5, 136320, v18
    v_lshrrev_b32 v18, 1, v16
    v_lshlrev_b32 v18, 10, v18
    v_and_b32 v19, 31, v0
    v_lshl_add_u32 v18, v19, 4, v18
    v_add_u32 v6, 139524, v18
    v_add_u32 v15, 140544, v1
    v_lshrrev_b32 v18, 1, v16
    v_lshlrev_b32 v18, 1, v18
    v_lshrrev_b32 v19, 3, v17
    v_add3_u32 v18, v18, v19, 1
    v_lshrrev_b32 v19, 1, v18
    v_lshlrev_b32 v19, 14, v19
    v_and_b32 v18, 1, v18
    v_lshl_add_u32 v18, v18, 12, v19
    v_and_b32 v19, 1, v16
    v_lshlrev_b32 v19, 4, v19
    v_add_u32 v19, 32, v19
    s_lshl_b32 s20, s12, 7
    v_add_u32 v8, s20, v19
    v_add_u32 v7, v8, v18
    v_lshlrev_b32 v18, 4, v17
    v_lshl_add_u32 v18, v16, 10, v18
    v_add_u32 v9, 256, v18
    v_add_u32 v18, 64, v0
    v_mul_u32_u24 v19, 2731, v18
    v_lshrrev_b32 v19, 16, v19
    v_mul_u32_u24 v20, 24, v19
    v_sub_u32 v20, v18, v20
    v_mul_u32_u24 v21, 400, v19
    v_lshl_add_u32 v21, v20, 4, v21
    v_add_u32 v10, 136320, v21
    v_lshlrev_b32 v21, 4, v19
    v_lshl_add_u32 v11, v20, 7, v21
    v_and_b32 v18, 0x28, v0
    v_cmp_eq_u32 vcc, 0, v18
    v_mov_b32 v18, 1.0
    v_mov_b32 v19, 0
    v_cndmask_b32 v12, v19, v18, vcc
    v_add_u32 v13, 30720, v1
    v_add_u32 v14, 122880, v1
    s_mul_i32 s44, s12, 12288
    s_add_u32 s44, s44, 53477376
    s_mul_i32 s45, s12, 3072
    s_add_u32 s45, s45, 208666624
    s_mul_i32 s20, s12, 491520
    s_add_u32 s20, s20, 11657216
    s_add_u32 s21, s20, 0
    buffer_load_dwordx4 v[16:19], v1, s[8:11], s21 offen offset:0
    buffer_load_dwordx4 v[20:23], v1, s[8:11], s21 offen offset:1024
    s_add_u32 s21, s20, 40960
    buffer_load_dwordx4 v[24:27], v1, s[8:11], s21 offen offset:0
    buffer_load_dwordx4 v[28:31], v1, s[8:11], s21 offen offset:1024
    s_add_u32 s21, s20, 22528
    buffer_load_dwordx4 v[32:35], v1, s[8:11], s21 offen offset:0
    buffer_load_dwordx4 v[36:39], v1, s[8:11], s21 offen offset:1024
    s_add_u32 s21, s20, 4096
    buffer_load_dwordx4 v[40:43], v1, s[8:11], s21 offen offset:0
    buffer_load_dwordx4 v[44:47], v1, s[8:11], s21 offen offset:1024
    s_add_u32 s21, s20, 45056
    buffer_load_dwordx4 v[48:51], v1, s[8:11], s21 offen offset:0
    buffer_load_dwordx4 v[52:55], v1, s[8:11], s21 offen offset:1024
    s_add_u32 s21, s20, 32768
    buffer_load_dwordx4 v[56:59], v1, s[8:11], s21 offen offset:0
    buffer_load_dwordx4 v[60:63], v1, s[8:11], s21 offen offset:1024
    s_add_u32 s21, s20, 14336
    buffer_load_dwordx4 v[64:67], v1, s[8:11], s21 offen offset:0
    buffer_load_dwordx4 v[68:71], v1, s[8:11], s21 offen offset:1024
    s_add_u32 s21, s20, 55296
    buffer_load_dwordx4 v[72:75], v1, s[8:11], s21 offen offset:0
    buffer_load_dwordx4 v[76:79], v1, s[8:11], s21 offen offset:1024
    s_add_u32 s21, s20, 36864
    buffer_load_dwordx4 v[80:83], v1, s[8:11], s21 offen offset:0
    buffer_load_dwordx4 v[84:87], v1, s[8:11], s21 offen offset:1024
    s_add_u32 s21, s20, 18432
    buffer_load_dwordx4 v[88:91], v1, s[8:11], s21 offen offset:0
    buffer_load_dwordx4 v[92:95], v1, s[8:11], s21 offen offset:1024
    s_add_u32 s21, s20, 59392
    buffer_load_dwordx4 v[96:99], v1, s[8:11], s21 offen offset:0
    buffer_load_dwordx4 v[100:103], v1, s[8:11], s21 offen offset:1024
    s_add_u32 s21, s20, 90112
    buffer_load_dwordx4 v[104:107], v1, s[8:11], s21 offen offset:0
    buffer_load_dwordx4 v[108:111], v1, s[8:11], s21 offen offset:1024
    s_add_u32 s21, s20, 98304
    buffer_load_dwordx4 v[112:115], v1, s[8:11], s21 offen offset:0
    buffer_load_dwordx4 v[116:119], v1, s[8:11], s21 offen offset:1024
    s_add_u32 s21, s20, 106496
    buffer_load_dwordx4 v[120:123], v1, s[8:11], s21 offen offset:0
    buffer_load_dwordx4 v[124:127], v1, s[8:11], s21 offen offset:1024
    s_add_u32 s21, s20, 114688
    buffer_load_dwordx4 v[128:131], v1, s[8:11], s21 offen offset:0
    buffer_load_dwordx4 v[132:135], v1, s[8:11], s21 offen offset:1024
    s_add_u32 s21, s20, 6144
    buffer_load_dwordx4 a[0:3], v1, s[8:11], s21 offen offset:0
    buffer_load_dwordx4 a[4:7], v1, s[8:11], s21 offen offset:1024
    s_add_u32 s21, s20, 26624
    buffer_load_dwordx4 a[8:11], v1, s[8:11], s21 offen offset:0
    buffer_load_dwordx4 a[12:15], v1, s[8:11], s21 offen offset:1024
    s_add_u32 s21, s20, 47104
    buffer_load_dwordx4 a[16:19], v1, s[8:11], s21 offen offset:0
    buffer_load_dwordx4 a[20:23], v1, s[8:11], s21 offen offset:1024
    s_add_u32 s21, s20, 8192
    buffer_load_dwordx4 a[24:27], v1, s[8:11], s21 offen offset:0
    buffer_load_dwordx4 a[28:31], v1, s[8:11], s21 offen offset:1024
    s_add_u32 s21, s20, 28672
    buffer_load_dwordx4 a[32:35], v1, s[8:11], s21 offen offset:0
    buffer_load_dwordx4 a[36:39], v1, s[8:11], s21 offen offset:1024
    s_add_u32 s21, s20, 49152
    buffer_load_dwordx4 a[40:43], v1, s[8:11], s21 offen offset:0
    buffer_load_dwordx4 a[44:47], v1, s[8:11], s21 offen offset:1024
    s_add_u32 s21, s20, 10240
    buffer_load_dwordx4 a[48:51], v1, s[8:11], s21 offen offset:0
    buffer_load_dwordx4 a[52:55], v1, s[8:11], s21 offen offset:1024
    s_add_u32 s21, s20, 30720
    buffer_load_dwordx4 a[56:59], v1, s[8:11], s21 offen offset:0
    buffer_load_dwordx4 a[60:63], v1, s[8:11], s21 offen offset:1024
    s_add_u32 s21, s20, 51200
    buffer_load_dwordx4 a[64:67], v1, s[8:11], s21 offen offset:0
    buffer_load_dwordx4 a[68:71], v1, s[8:11], s21 offen offset:1024
    s_add_u32 s21, s20, 20480
    buffer_load_dwordx4 a[72:75], v1, s[8:11], s21 offen offset:0
    buffer_load_dwordx4 a[76:79], v1, s[8:11], s21 offen offset:1024
    s_add_u32 s21, s20, 2048
    buffer_load_dwordx4 a[80:83], v1, s[8:11], s21 offen offset:0
    buffer_load_dwordx4 a[84:87], v1, s[8:11], s21 offen offset:1024
    s_add_u32 s21, s20, 43008
    buffer_load_dwordx4 a[88:91], v1, s[8:11], s21 offen offset:0
    buffer_load_dwordx4 a[92:95], v1, s[8:11], s21 offen offset:1024
    s_add_u32 s21, s20, 24576
    buffer_load_dwordx4 a[96:99], v1, s[8:11], s21 offen offset:0
    buffer_load_dwordx4 a[100:103], v1, s[8:11], s21 offen offset:1024
    s_add_u32 s21, s20, 12288
    buffer_load_dwordx4 a[104:107], v1, s[8:11], s21 offen offset:0
    buffer_load_dwordx4 a[108:111], v1, s[8:11], s21 offen offset:1024
    s_add_u32 s21, s20, 53248
    buffer_load_dwordx4 a[112:115], v1, s[8:11], s21 offen offset:0
    buffer_load_dwordx4 a[116:119], v1, s[8:11], s21 offen offset:1024
    s_add_u32 s21, s20, 34816
    buffer_load_dwordx4 a[120:123], v1, s[8:11], s21 offen offset:0
    buffer_load_dwordx4 a[124:127], v1, s[8:11], s21 offen offset:1024
    s_waitcnt vmcnt(32)
    ds_write_b128 v13, v[16:19] offset:0
    ds_write_b128 v13, v[20:23] offset:1024
    ds_write_b128 v13, v[24:27] offset:2048
    ds_write_b128 v13, v[28:31] offset:3072
    ds_write_b128 v13, v[32:35] offset:4096
    ds_write_b128 v13, v[36:39] offset:5120
    ds_write_b128 v13, v[40:43] offset:6144
    ds_write_b128 v13, v[44:47] offset:7168
    ds_write_b128 v13, v[48:51] offset:8192
    ds_write_b128 v13, v[52:55] offset:9216
    ds_write_b128 v13, v[56:59] offset:10240
    ds_write_b128 v13, v[60:63] offset:11264
    ds_write_b128 v13, v[64:67] offset:12288
    ds_write_b128 v13, v[68:71] offset:13312
    ds_write_b128 v13, v[72:75] offset:14336
    ds_write_b128 v13, v[76:79] offset:15360
    ds_write_b128 v13, v[80:83] offset:16384
    ds_write_b128 v13, v[84:87] offset:17408
    ds_write_b128 v13, v[88:91] offset:18432
    ds_write_b128 v13, v[92:95] offset:19456
    ds_write_b128 v13, v[96:99] offset:20480
    ds_write_b128 v13, v[100:103] offset:21504
    ds_write_b128 v13, v[104:107] offset:22528
    ds_write_b128 v13, v[108:111] offset:23552
    ds_write_b128 v13, v[112:115] offset:24576
    ds_write_b128 v13, v[116:119] offset:25600
    ds_write_b128 v13, v[120:123] offset:26624
    ds_write_b128 v13, v[124:127] offset:27648
    ds_write_b128 v13, v[128:131] offset:28672
    ds_write_b128 v13, v[132:135] offset:29696
    s_add_u32 s21, s20, 16384
    buffer_load_dwordx4 a[128:131], v1, s[8:11], s21 offen offset:0
    buffer_load_dwordx4 a[132:135], v1, s[8:11], s21 offen offset:1024
    s_add_u32 s21, s20, 57344
    buffer_load_dwordx4 a[136:139], v1, s[8:11], s21 offen offset:0
    buffer_load_dwordx4 a[140:143], v1, s[8:11], s21 offen offset:1024
    s_add_u32 s21, s20, 38912
    buffer_load_dwordx4 a[144:147], v1, s[8:11], s21 offen offset:0
    buffer_load_dwordx4 a[148:151], v1, s[8:11], s21 offen offset:1024
    s_add_u32 s21, s20, 61440
    buffer_load_dwordx4 a[152:155], v1, s[8:11], s21 offen offset:0
    buffer_load_dwordx4 a[156:159], v1, s[8:11], s21 offen offset:1024
    s_add_u32 s21, s20, 63488
    buffer_load_dwordx4 a[160:163], v1, s[8:11], s21 offen offset:0
    buffer_load_dwordx4 a[164:167], v1, s[8:11], s21 offen offset:1024
    s_add_u32 s21, s20, 65536
    buffer_load_dwordx4 a[168:171], v1, s[8:11], s21 offen offset:0
    buffer_load_dwordx4 a[172:175], v1, s[8:11], s21 offen offset:1024
    s_add_u32 s21, s20, 67584
    buffer_load_dwordx4 a[176:179], v1, s[8:11], s21 offen offset:0
    buffer_load_dwordx4 a[180:183], v1, s[8:11], s21 offen offset:1024
    s_add_u32 s21, s20, 69632
    buffer_load_dwordx4 a[184:187], v1, s[8:11], s21 offen offset:0
    buffer_load_dwordx4 a[188:191], v1, s[8:11], s21 offen offset:1024
    s_add_u32 s21, s20, 71680
    buffer_load_dwordx4 a[192:195], v1, s[8:11], s21 offen offset:0
    buffer_load_dwordx4 a[196:199], v1, s[8:11], s21 offen offset:1024
    s_add_u32 s21, s20, 73728
    buffer_load_dwordx4 a[200:203], v1, s[8:11], s21 offen offset:0
    buffer_load_dwordx4 a[204:207], v1, s[8:11], s21 offen offset:1024
    s_add_u32 s21, s20, 75776
    buffer_load_dwordx4 a[208:211], v1, s[8:11], s21 offen offset:0
    buffer_load_dwordx4 a[212:215], v1, s[8:11], s21 offen offset:1024
    s_add_u32 s21, s20, 77824
    buffer_load_dwordx4 a[216:219], v1, s[8:11], s21 offen offset:0
    buffer_load_dwordx4 a[220:223], v1, s[8:11], s21 offen offset:1024
    s_add_u32 s21, s20, 79872
    buffer_load_dwordx4 a[224:227], v1, s[8:11], s21 offen offset:0
    buffer_load_dwordx4 a[228:231], v1, s[8:11], s21 offen offset:1024
    s_add_u32 s21, s20, 81920
    buffer_load_dwordx4 a[232:235], v1, s[8:11], s21 offen offset:0
    buffer_load_dwordx4 a[236:239], v1, s[8:11], s21 offen offset:1024
    s_add_u32 s21, s20, 83968
    buffer_load_dwordx4 a[240:243], v1, s[8:11], s21 offen offset:0
    buffer_load_dwordx4 a[244:247], v1, s[8:11], s21 offen offset:1024
    s_add_u32 s21, s20, 86016
    buffer_load_dwordx4 a[248:251], v1, s[8:11], s21 offen offset:0
    buffer_load_dwordx4 a[252:255], v1, s[8:11], s21 offen offset:1024
    s_add_u32 s21, s20, 88064
    buffer_load_dwordx4 v[148:151], v1, s[8:11], s21 offen offset:0
    buffer_load_dwordx4 v[152:155], v1, s[8:11], s21 offen offset:1024
    s_add_u32 s21, s20, 92160
    buffer_load_dwordx4 v[156:159], v1, s[8:11], s21 offen offset:0
    buffer_load_dwordx4 v[160:163], v1, s[8:11], s21 offen offset:1024
    s_add_u32 s21, s20, 94208
    buffer_load_dwordx4 v[164:167], v1, s[8:11], s21 offen offset:0
    buffer_load_dwordx4 v[168:171], v1, s[8:11], s21 offen offset:1024
    s_add_u32 s21, s20, 96256
    buffer_load_dwordx4 v[172:175], v1, s[8:11], s21 offen offset:0
    buffer_load_dwordx4 v[176:179], v1, s[8:11], s21 offen offset:1024
    s_add_u32 s21, s20, 100352
    buffer_load_dwordx4 v[180:183], v1, s[8:11], s21 offen offset:0
    buffer_load_dwordx4 v[184:187], v1, s[8:11], s21 offen offset:1024
    s_add_u32 s21, s20, 102400
    buffer_load_dwordx4 v[188:191], v1, s[8:11], s21 offen offset:0
    buffer_load_dwordx4 v[192:195], v1, s[8:11], s21 offen offset:1024
    s_add_u32 s21, s20, 104448
    buffer_load_dwordx4 v[196:199], v1, s[8:11], s21 offen offset:0
    buffer_load_dwordx4 v[200:203], v1, s[8:11], s21 offen offset:1024
    s_add_u32 s21, s20, 108544
    buffer_load_dwordx4 v[204:207], v1, s[8:11], s21 offen offset:0
    buffer_load_dwordx4 v[208:211], v1, s[8:11], s21 offen offset:1024
    s_add_u32 s21, s20, 110592
    buffer_load_dwordx4 v[212:215], v1, s[8:11], s21 offen offset:0
    buffer_load_dwordx4 v[216:219], v1, s[8:11], s21 offen offset:1024
    s_add_u32 s21, s20, 112640
    buffer_load_dwordx4 v[220:223], v1, s[8:11], s21 offen offset:0
    buffer_load_dwordx4 v[224:227], v1, s[8:11], s21 offen offset:1024
    s_add_u32 s21, s20, 116736
    buffer_load_dwordx4 v[228:231], v1, s[8:11], s21 offen offset:0
    buffer_load_dwordx4 v[232:235], v1, s[8:11], s21 offen offset:1024
    s_add_u32 s21, s20, 118784
    buffer_load_dwordx4 v[236:239], v1, s[8:11], s21 offen offset:0
    buffer_load_dwordx4 v[240:243], v1, s[8:11], s21 offen offset:1024
    s_add_u32 s21, s20, 120832
    buffer_load_dwordx4 v[244:247], v1, s[8:11], s21 offen offset:0
    buffer_load_dwordx4 v[248:251], v1, s[8:11], s21 offen offset:1024
    s_waitcnt lgkmcnt(0)
    s_mov_b32 s14, 0
    s_mul_i32 s20, s14, 393216
    s_add_u32 s20, s20, s44
    s_add_u32 s21, s20, 0
    buffer_load_dwordx4 v[100:103], v9, s[8:11], s21 offen offset:0
    buffer_load_dwordx4 v[104:107], v9, s[8:11], s21 offen offset:512
    s_add_u32 s21, s20, 4096
    buffer_load_dwordx4 v[108:111], v9, s[8:11], s21 offen offset:0
    buffer_load_dwordx4 v[112:115], v9, s[8:11], s21 offen offset:512
    v_mov_b32 v56, 0
    v_mov_b32 v57, 0
    v_mov_b32 v58, 0
    v_mov_b32 v59, 0
    v_mov_b32 v60, 0
    v_mov_b32 v61, 0
    v_mov_b32 v62, 0
    v_mov_b32 v63, 0
    v_mov_b32 v64, 0
    v_mov_b32 v65, 0
    v_mov_b32 v66, 0
    v_mov_b32 v67, 0
    v_mov_b32 v68, 0
    v_mov_b32 v69, 0
    v_mov_b32 v70, 0
    v_mov_b32 v71, 0
    v_mov_b32 v72, 0
    v_mov_b32 v73, 0
    v_mov_b32 v74, 0
    v_mov_b32 v75, 0
    v_mov_b32 v76, 0
    v_mov_b32 v77, 0
    v_mov_b32 v78, 0
    v_mov_b32 v79, 0
    v_mov_b32 v80, 0
    v_mov_b32 v81, 0
    v_mov_b32 v82, 0
    v_mov_b32 v83, 0
    v_mov_b32 v84, 0
    v_mov_b32 v85, 0
    v_mov_b32 v86, 0
    v_mov_b32 v87, 0
    ds_read_b128 v[116:119], v13 offset:0
    ds_read_b128 v[120:123], v13 offset:1024
    ds_read_b128 v[124:127], v13 offset:2048
    ds_read_b128 v[128:131], v13 offset:3072
    ds_read_b128 v[132:135], v13 offset:4096
    ds_read_b128 v[136:139], v13 offset:5120
    ds_read_b128 v[140:143], v13 offset:6144
    ds_read_b128 v[144:147], v13 offset:7168
    s_waitcnt lgkmcnt(0)
chain1_kernel_p1_step:
    s_cmp_lt_u32 s14, 32
    s_cselect_b32 s18, s16, s17
    s_and_b32 s20, s14, 31
    s_lshl_b32 s20, s20, 16
    s_add_u32 s18, s18, s20
    s_add_u32 s22, s18, 39936
    s_add_u32 s23, s18, 49152
    s_add_u32 s24, s18, 50176
chain1_kernel_p1_poll:
    buffer_load_dwordx4 v[28:31], v1, s[8:11], s22 offen sc1
    buffer_load_dwordx4 v[32:35], v1, s[8:11], s23 offen sc1
    buffer_load_dwordx4 v[36:39], v1, s[8:11], s24 offen sc1
    s_waitcnt vmcnt(0)
    ds_write_b128 v14, v[28:31] offset:3072
    ds_write_b128 v14, v[32:35] offset:4096
    ds_write_b128 v14, v[36:39] offset:5120
    v_max3_u32 v88, v28, v29, v30
    v_max3_u32 v88, v88, v31, v32
    v_max3_u32 v88, v88, v33, v34
    v_max3_u32 v88, v88, v35, v36
    v_max3_u32 v88, v88, v37, v38
    v_max_u32 v88, v88, v39
    v_cmp_eq_u32 vcc, -1, v88
    s_sub_u32 s15, s15, 1
    s_cbranch_scc1 chain1_kernel_bail
    s_cbranch_vccnz chain1_kernel_p1_poll
    s_waitcnt lgkmcnt(0)
    s_barrier
    ds_read_b128 v[16:19], v14 offset:0
    ds_read_b128 v[20:23], v14 offset:1024
    ds_read_b128 v[24:27], v14 offset:2048
    ds_read_b128 v[40:43], v14 offset:6144
    ds_read_b128 v[44:47], v14 offset:7168
    ds_read_b128 v[48:51], v14 offset:8192
    ds_read_b128 v[52:55], v14 offset:9216
    v_smfmac_f32_16x16x64_bf16 v[56:59], v[28:31], a[0:7], v2
    v_smfmac_f32_16x16x64_bf16 v[60:63], v[28:31], a[8:15], v2
    v_smfmac_f32_16x16x64_bf16 v[64:67], v[28:31], a[16:23], v2
    v_smfmac_f32_16x16x64_bf16 v[56:59], v[32:35], a[24:31], v2
    v_smfmac_f32_16x16x64_bf16 v[60:63], v[32:35], a[32:39], v2
    v_smfmac_f32_16x16x64_bf16 v[64:67], v[32:35], a[40:47], v2
    v_smfmac_f32_16x16x64_bf16 v[56:59], v[36:39], a[48:55], v2
    v_smfmac_f32_16x16x64_bf16 v[60:63], v[36:39], a[56:63], v2
    v_smfmac_f32_16x16x64_bf16 v[64:67], v[36:39], a[64:71], v2
    s_waitcnt lgkmcnt(6)
    v_smfmac_f32_16x16x64_bf16 v[56:59], v[16:19], v[116:123], v2
    ds_read_b128 v[116:119], v13 offset:8192
    ds_read_b128 v[120:123], v13 offset:9216
    v_smfmac_f32_16x16x64_bf16 v[60:63], v[16:19], a[72:79], v2
    v_smfmac_f32_16x16x64_bf16 v[64:67], v[16:19], v[124:131], v2
    ds_read_b128 v[124:127], v13 offset:10240
    ds_read_b128 v[128:131], v13 offset:11264
    s_waitcnt lgkmcnt(9)
    v_smfmac_f32_16x16x64_bf16 v[56:59], v[20:23], a[80:87], v2
    v_smfmac_f32_16x16x64_bf16 v[60:63], v[20:23], v[132:139], v2
    ds_read_b128 v[132:135], v13 offset:12288
    ds_read_b128 v[136:139], v13 offset:13312
    v_smfmac_f32_16x16x64_bf16 v[64:67], v[20:23], a[88:95], v2
    s_waitcnt lgkmcnt(10)
    v_smfmac_f32_16x16x64_bf16 v[56:59], v[24:27], v[140:147], v2
    ds_read_b128 v[140:143], v13 offset:14336
    ds_read_b128 v[144:147], v13 offset:15360
    v_smfmac_f32_16x16x64_bf16 v[60:63], v[24:27], a[96:103], v2
    s_waitcnt lgkmcnt(6)
    v_smfmac_f32_16x16x64_bf16 v[64:67], v[24:27], v[116:123], v2
    ds_read_b128 v[116:119], v13 offset:16384
    ds_read_b128 v[120:123], v13 offset:17408
    v_smfmac_f32_16x16x64_bf16 v[56:59], v[40:43], a[104:111], v2
    s_waitcnt lgkmcnt(6)
    v_smfmac_f32_16x16x64_bf16 v[60:63], v[40:43], v[124:131], v2
    ds_read_b128 v[124:127], v13 offset:18432
    ds_read_b128 v[128:131], v13 offset:19456
    v_smfmac_f32_16x16x64_bf16 v[64:67], v[40:43], a[112:119], v2
    s_waitcnt lgkmcnt(6)
    v_smfmac_f32_16x16x64_bf16 v[56:59], v[44:47], v[132:139], v2
    ds_read_b128 v[132:135], v13 offset:20480
    ds_read_b128 v[136:139], v13 offset:21504
    v_smfmac_f32_16x16x64_bf16 v[60:63], v[44:47], a[120:127], v2
    s_waitcnt lgkmcnt(6)
    v_smfmac_f32_16x16x64_bf16 v[64:67], v[44:47], v[140:147], v2
    ds_read_b128 v[140:143], v13 offset:22528
    ds_read_b128 v[144:147], v13 offset:23552
    v_smfmac_f32_16x16x64_bf16 v[56:59], v[48:51], a[128:135], v2
    s_waitcnt lgkmcnt(6)
    v_smfmac_f32_16x16x64_bf16 v[60:63], v[48:51], v[116:123], v2
    ds_read_b128 v[116:119], v13 offset:24576
    ds_read_b128 v[120:123], v13 offset:25600
    v_smfmac_f32_16x16x64_bf16 v[64:67], v[48:51], a[136:143], v2
    s_waitcnt lgkmcnt(6)
    v_smfmac_f32_16x16x64_bf16 v[56:59], v[52:55], v[124:131], v2
    ds_read_b128 v[124:127], v13 offset:26624
    ds_read_b128 v[128:131], v13 offset:27648
    v_smfmac_f32_16x16x64_bf16 v[60:63], v[52:55], a[144:151], v2
    s_waitcnt lgkmcnt(6)
    v_smfmac_f32_16x16x64_bf16 v[64:67], v[52:55], v[132:139], v2
    ds_read_b128 v[132:135], v13 offset:28672
    ds_read_b128 v[136:139], v13 offset:29696
    v_smfmac_f32_16x16x64_bf16 v[68:71], v[16:19], a[152:159], v2
    v_smfmac_f32_16x16x64_bf16 v[68:71], v[20:23], a[160:167], v2
    v_permlane32_swap_b32 v56, v58
    v_permlane32_swap_b32 v57, v59
    v_smfmac_f32_16x16x64_bf16 v[68:71], v[24:27], a[168:175], v2
    v_add_f32 v56, v56, v58
    v_add_f32 v57, v57, v59
    v_smfmac_f32_16x16x64_bf16 v[68:71], v[28:31], a[176:183], v2
    v_cvt_pk_bf16_f32 v56, v56, v57
    ds_write_b16 v3, v56 offset:0
    v_smfmac_f32_16x16x64_bf16 v[68:71], v[32:35], a[184:191], v2
    ds_write_b16_d16_hi v3, v56 offset:400
    v_permlane32_swap_b32 v60, v62
    v_smfmac_f32_16x16x64_bf16 v[68:71], v[36:39], a[192:199], v2
    v_permlane32_swap_b32 v61, v63
    v_add_f32 v60, v60, v62
    v_smfmac_f32_16x16x64_bf16 v[68:71], v[40:43], a[200:207], v2
    v_add_f32 v61, v61, v63
    v_cvt_pk_bf16_f32 v60, v60, v61
    v_smfmac_f32_16x16x64_bf16 v[68:71], v[44:47], a[208:215], v2
    ds_write_b16 v3, v60 offset:32
    ds_write_b16_d16_hi v3, v60 offset:432
    v_smfmac_f32_16x16x64_bf16 v[68:71], v[48:51], a[216:223], v2
    v_permlane32_swap_b32 v64, v66
    v_permlane32_swap_b32 v65, v67
    v_smfmac_f32_16x16x64_bf16 v[68:71], v[52:55], a[224:231], v2
    v_add_f32 v64, v64, v66
    v_add_f32 v65, v65, v67
    v_smfmac_f32_16x16x64_bf16 v[72:75], v[16:19], a[232:239], v2
    v_cvt_pk_bf16_f32 v64, v64, v65
    ds_write_b16 v3, v64 offset:64
    v_smfmac_f32_16x16x64_bf16 v[72:75], v[20:23], a[240:247], v2
    ds_write_b16_d16_hi v3, v64 offset:464
    v_smfmac_f32_16x16x64_bf16 v[72:75], v[24:27], a[248:255], v2
    v_smfmac_f32_16x16x64_bf16 v[72:75], v[28:31], v[148:155], v2
    s_waitcnt lgkmcnt(0)
    s_barrier
    ds_read_b128 v[88:91], v4 offset:0
    v_smfmac_f32_16x16x64_bf16 v[72:75], v[32:35], v[140:147], v2
    ds_read_b128 v[92:95], v4 offset:128
    ds_read_b128 v[96:99], v4 offset:256
    v_smfmac_f32_16x16x64_bf16 v[72:75], v[36:39], v[156:163], v2
    v_permlane32_swap_b32 v68, v70
    v_permlane32_swap_b32 v69, v71
    v_smfmac_f32_16x16x64_bf16 v[72:75], v[40:43], v[164:171], v2
    v_add_f32 v68, v68, v70
    v_add_f32 v69, v69, v71
    v_smfmac_f32_16x16x64_bf16 v[72:75], v[44:47], v[172:179], v2
    v_cvt_pk_bf16_f32 v68, v68, v69
    ds_write_b16 v3, v68 offset:3200
    v_smfmac_f32_16x16x64_bf16 v[72:75], v[48:51], v[116:123], v2
    ds_write_b16_d16_hi v3, v68 offset:3600
    v_smfmac_f32_16x16x64_bf16 v[72:75], v[52:55], v[180:187], v2
    s_waitcnt lgkmcnt(2)
    v_smfmac_f32_16x16x64_bf16 v[80:83], v[88:91], v[100:107], v2
    v_smfmac_f32_16x16x64_bf16 v[80:83], v[92:95], v[108:115], v2
    v_smfmac_f32_16x16x64_bf16 v[76:79], v[16:19], v[188:195], v2
    v_smfmac_f32_16x16x64_bf16 v[76:79], v[20:23], v[196:203], v2
    v_smfmac_f32_16x16x64_bf16 v[76:79], v[24:27], v[124:131], v2
    v_permlane32_swap_b32 v72, v74
    v_permlane32_swap_b32 v73, v75
    v_smfmac_f32_16x16x64_bf16 v[76:79], v[28:31], v[204:211], v2
    v_add_f32 v72, v72, v74
    v_add_f32 v73, v73, v75
    ds_write_b128 v15, v[80:83]
    v_smfmac_f32_16x16x64_bf16 v[76:79], v[32:35], v[212:219], v2
    v_cvt_pk_bf16_f32 v72, v72, v73
    ds_write_b16 v3, v72 offset:3232
    v_smfmac_f32_16x16x64_bf16 v[76:79], v[36:39], v[220:227], v2
    ds_write_b16_d16_hi v3, v72 offset:3632
    v_smfmac_f32_16x16x64_bf16 v[76:79], v[40:43], v[132:139], v2
    v_smfmac_f32_16x16x64_bf16 v[76:79], v[44:47], v[228:235], v2
    v_smfmac_f32_16x16x64_bf16 v[76:79], v[48:51], v[236:243], v2
    v_smfmac_f32_16x16x64_bf16 v[76:79], v[52:55], v[244:251], v2
    s_nop 7
    v_permlane32_swap_b32 v76, v78
    v_permlane32_swap_b32 v77, v79
    v_add_f32 v76, v76, v78
    v_add_f32 v77, v77, v79
    v_cvt_pk_bf16_f32 v76, v76, v77
    ds_write_b16 v3, v76 offset:3264
    ds_write_b16_d16_hi v3, v76 offset:3664
    s_waitcnt lgkmcnt(0)
    s_barrier
    ds_read2st64_b32 v[40:41], v6 offset0:0 offset1:2
    ds_read2st64_b32 v[42:43], v6 offset0:8 offset1:10
    ds_read_b128 v[16:19], v5 offset:0
    ds_read_b128 v[20:23], v5 offset:16
    ds_read_b128 v[24:27], v5 offset:128
    ds_read_b128 v[28:31], v5 offset:144
    ds_read_b128 v[32:35], v5 offset:256
    ds_read_b128 v[36:39], v5 offset:272
    s_waitcnt lgkmcnt(6)
    v_add_f32 v40, v40, v41
    v_add_f32 v42, v42, v43
    v_add_f32 v44, v40, v42
    v_mul_f32 v44, 0x3dd53b95, v44
    s_waitcnt lgkmcnt(4)
    v_smfmac_f32_16x16x64_bf16 v[84:87], v[88:91], v[16:23], v2
    s_waitcnt lgkmcnt(2)
    v_smfmac_f32_16x16x64_bf16 v[84:87], v[92:95], v[24:31], v2
    s_waitcnt lgkmcnt(0)
    v_smfmac_f32_16x16x64_bf16 v[84:87], v[96:99], v[32:39], v2
    v_max_f32_dpp v45, v44, v44 row_ror:8 row_mask:0xf bank_mask:0xf
    s_nop 1
    v_max_f32_dpp v45, v45, v45 row_ror:4 row_mask:0xf bank_mask:0xf
    s_nop 1
    v_max_f32_dpp v45, v45, v45 row_ror:2 row_mask:0xf bank_mask:0xf
    s_nop 1
    v_max_f32_dpp v45, v45, v45 row_ror:1 row_mask:0xf bank_mask:0xf
    v_mov_b32 v47, v45
    s_nop 1
    v_permlane32_swap_b32 v45, v47
    v_max_f32 v45, v45, v47
    v_mov_b32 v47, v85
    s_nop 1
    v_permlane32_swap_b32 v85, v47
    v_add_f32 v48, v85, v47
    v_mul_f32 v48, 0x3dd53b95, v48
    s_nop 1
    v_max_f32_dpp v46, v48, v48 row_ror:4 row_mask:0xf bank_mask:0xf
    s_nop 1
    v_max_f32_dpp v46, v46, v46 row_ror:2 row_mask:0xf bank_mask:0xf
    s_nop 1
    v_max_f32_dpp v46, v46, v46 row_ror:1 row_mask:0xf bank_mask:0xf
    v_max_f32 v45, v45, v46
    v_sub_f32 v49, v44, v45
    v_sub_f32 v50, v48, v45
    v_exp_f32 v49, v49
    v_exp_f32 v50, v50
    s_nop 0
    v_fma_f32 v51, v50, v12, v49
    s_nop 1
    v_add_f32_dpp v51, v51, v51 row_ror:8 row_mask:0xf bank_mask:0xf
    s_nop 1
    v_add_f32_dpp v51, v51, v51 row_ror:4 row_mask:0xf bank_mask:0xf
    s_nop 1
    v_add_f32_dpp v51, v51, v51 row_ror:2 row_mask:0xf bank_mask:0xf
    s_nop 1
    v_add_f32_dpp v51, v51, v51 row_ror:1 row_mask:0xf bank_mask:0xf
    v_mov_b32 v47, v51
    s_nop 1
    v_permlane32_swap_b32 v51, v47
    v_add_f32 v51, v51, v47
    v_rcp_f32 v51, v51
    s_nop 0
    v_mul_f32 v49, v49, v51
    v_mul_f32 v50, v50, v51
    s_nop 0
    v_mov_b32_dpp v46, v49 quad_perm:[1,0,3,2] row_mask:0xf bank_mask:0xf
    v_mov_b32_dpp v47, v50 quad_perm:[1,0,3,2] row_mask:0xf bank_mask:0xf
    v_cvt_pk_bf16_f32 v16, v49, v46
    v_cvt_pk_bf16_f32 v20, v50, v47
    s_nop 0
    v_mov_b32_dpp v17, v16 row_shl:2 row_mask:0xf bank_mask:0xf
    v_mov_b32_dpp v18, v16 row_shl:4 row_mask:0xf bank_mask:0xf
    v_mov_b32_dpp v19, v16 row_shl:6 row_mask:0xf bank_mask:0xf
    v_mov_b32_dpp v21, v20 row_shl:2 row_mask:0xf bank_mask:0xf
    v_mov_b32_dpp v22, v20 row_shl:4 row_mask:0xf bank_mask:0xf
    v_mov_b32_dpp v23, v20 row_shl:6 row_mask:0xf bank_mask:0xf
    s_mov_b64 exec, s[40:41]
    buffer_store_dwordx4 v[16:19], v7, s[8:11], s18 offen sc1
    s_mov_b64 exec, s[42:43]
    buffer_store_dwordx4 v[20:23], v8, s[8:11], s18 offen sc1
    s_mov_b64 exec, -1
    ds_read_b128 v[40:43], v10
    s_add_u32 s28, s14, 1
    s_min_u32 s28, s28, 63
    s_mul_i32 s20, s28, 393216
    s_add_u32 s20, s20, s44
    s_add_u32 s21, s20, 0
    buffer_load_dwordx4 v[100:103], v9, s[8:11], s21 offen offset:0
    buffer_load_dwordx4 v[104:107], v9, s[8:11], s21 offen offset:512
    s_add_u32 s21, s20, 4096
    buffer_load_dwordx4 v[108:111], v9, s[8:11], s21 offen offset:0
    buffer_load_dwordx4 v[112:115], v9, s[8:11], s21 offen offset:512
    v_mov_b32 v56, 0
    v_mov_b32 v57, 0
    v_mov_b32 v58, 0
    v_mov_b32 v59, 0
    v_mov_b32 v60, 0
    v_mov_b32 v61, 0
    v_mov_b32 v62, 0
    v_mov_b32 v63, 0
    v_mov_b32 v64, 0
    v_mov_b32 v65, 0
    v_mov_b32 v66, 0
    v_mov_b32 v67, 0
    v_mov_b32 v68, 0
    v_mov_b32 v69, 0
    v_mov_b32 v70, 0
    v_mov_b32 v71, 0
    v_mov_b32 v72, 0
    v_mov_b32 v73, 0
    v_mov_b32 v74, 0
    v_mov_b32 v75, 0
    v_mov_b32 v76, 0
    v_mov_b32 v77, 0
    v_mov_b32 v78, 0
    v_mov_b32 v79, 0
    v_mov_b32 v80, 0
    v_mov_b32 v81, 0
    v_mov_b32 v82, 0
    v_mov_b32 v83, 0
    v_mov_b32 v84, 0
    v_mov_b32 v85, 0
    v_mov_b32 v86, 0
    v_mov_b32 v87, 0
    s_waitcnt lgkmcnt(0)
    s_mul_i32 s20, s14, 98304
    s_add_u32 s20, s20, s45
    buffer_store_dwordx4 v[40:43], v11, s[8:11], s20 offen
    ds_read_b128 v[116:119], v13 offset:0
    ds_read_b128 v[120:123], v13 offset:1024
    ds_read_b128 v[124:127], v13 offset:2048
    ds_read_b128 v[128:131], v13 offset:3072
    ds_read_b128 v[132:135], v13 offset:4096
    ds_read_b128 v[136:139], v13 offset:5120
    ds_read_b128 v[140:143], v13 offset:6144
    ds_read_b128 v[144:147], v13 offset:7168
    s_waitcnt lgkmcnt(0)
    s_add_u32 s14, s14, 1
    s_cmp_lt_u32 s14, 64
    s_cbranch_scc1 chain1_kernel_p1_step
    s_branch chain1_kernel_end
chain1_kernel_p2_start:
    v_lshrrev_b32 v16, 4, v0
    v_and_b32 v17, 15, v0
    v_and_b32 v18, 1, v16
    v_lshlrev_b32 v18, 2, v18
    v_lshrrev_b32 v19, 1, v16
    v_lshl_add_u32 v18, v19, 1, v18
    v_mul_u32_u24 v18, 400, v18
    v_lshl_add_u32 v18, v17, 1, v18
    v_add_u32 v3, 133312, v18
    v_and_b32 v18, 7, v0
    v_mul_u32_u24 v18, 400, v18
    v_lshrrev_b32 v19, 3, v0
    v_lshl_add_u32 v18, v19, 4, v18
    v_add_u32 v4, 133120, v18
    v_and_b32 v18, 7, v0
    v_mul_u32_u24 v18, 400, v18
    v_lshl_add_u32 v18, v16, 5, v18
    v_add_u32 v5, 136320, v18
    v_lshrrev_b32 v18, 1, v16
    v_lshlrev_b32 v18, 10, v18
    v_and_b32 v19, 31, v0
    v_lshl_add_u32 v18, v19, 4, v18
    v_add_u32 v6, 139528, v18
    v_add_u32 v15, 141568, v1
    v_lshrrev_b32 v18, 1, v16
    v_lshlrev_b32 v18, 1, v18
    v_lshrrev_b32 v19, 3, v17
    v_add3_u32 v18, v18, v19, 1
    v_lshrrev_b32 v19, 1, v18
    v_lshlrev_b32 v19, 14, v19
    v_and_b32 v18, 1, v18
    v_lshl_add_u32 v18, v18, 12, v19
    v_and_b32 v19, 1, v16
    v_lshlrev_b32 v19, 4, v19
    v_add_u32 v19, 64, v19
    s_lshl_b32 s20, s12, 7
    v_add_u32 v8, s20, v19
    v_add_u32 v7, v8, v18
    v_lshlrev_b32 v18, 4, v17
    v_lshl_add_u32 v18, v16, 10, v18
    v_add_u32 v9, 0, v18
    v_add_u32 v18, 128, v0
    v_mul_u32_u24 v19, 2731, v18
    v_lshrrev_b32 v19, 16, v19
    v_mul_u32_u24 v20, 24, v19
    v_sub_u32 v20, v18, v20
    v_mul_u32_u24 v21, 400, v19
    v_lshl_add_u32 v21, v20, 4, v21
    v_add_u32 v10, 136320, v21
    v_lshlrev_b32 v21, 4, v19
    v_lshl_add_u32 v11, v20, 7, v21
    v_and_b32 v18, 0x28, v0
    v_cmp_eq_u32 vcc, 0, v18
    v_mov_b32 v18, 1.0
    v_mov_b32 v19, 0
    v_cndmask_b32 v12, v19, v18, vcc
    v_add_u32 v13, 61440, v1
    v_add_u32 v14, 122880, v1
    s_mul_i32 s44, s12, 12288
    s_add_u32 s44, s44, 53477376
    s_mul_i32 s45, s12, 3072
    s_add_u32 s45, s45, 208666624
    s_mul_i32 s20, s12, 491520
    s_add_u32 s20, s20, 11780096
    s_add_u32 s21, s20, 2048
    buffer_load_dwordx4 v[16:19], v1, s[8:11], s21 offen offset:0
    buffer_load_dwordx4 v[20:23], v1, s[8:11], s21 offen offset:1024
    s_add_u32 s21, s20, 43008
    buffer_load_dwordx4 v[24:27], v1, s[8:11], s21 offen offset:0
    buffer_load_dwordx4 v[28:31], v1, s[8:11], s21 offen offset:1024
    s_add_u32 s21, s20, 24576
    buffer_load_dwordx4 v[32:35], v1, s[8:11], s21 offen offset:0
    buffer_load_dwordx4 v[36:39], v1, s[8:11], s21 offen offset:1024
    s_add_u32 s21, s20, 6144
    buffer_load_dwordx4 v[40:43], v1, s[8:11], s21 offen offset:0
    buffer_load_dwordx4 v[44:47], v1, s[8:11], s21 offen offset:1024
    s_add_u32 s21, s20, 47104
    buffer_load_dwordx4 v[48:51], v1, s[8:11], s21 offen offset:0
    buffer_load_dwordx4 v[52:55], v1, s[8:11], s21 offen offset:1024
    s_add_u32 s21, s20, 28672
    buffer_load_dwordx4 v[56:59], v1, s[8:11], s21 offen offset:0
    buffer_load_dwordx4 v[60:63], v1, s[8:11], s21 offen offset:1024
    s_add_u32 s21, s20, 10240
    buffer_load_dwordx4 v[64:67], v1, s[8:11], s21 offen offset:0
    buffer_load_dwordx4 v[68:71], v1, s[8:11], s21 offen offset:1024
    s_add_u32 s21, s20, 51200
    buffer_load_dwordx4 v[72:75], v1, s[8:11], s21 offen offset:0
    buffer_load_dwordx4 v[76:79], v1, s[8:11], s21 offen offset:1024
    s_add_u32 s21, s20, 36864
    buffer_load_dwordx4 v[80:83], v1, s[8:11], s21 offen offset:0
    buffer_load_dwordx4 v[84:87], v1, s[8:11], s21 offen offset:1024
    s_add_u32 s21, s20, 18432
    buffer_load_dwordx4 v[88:91], v1, s[8:11], s21 offen offset:0
    buffer_load_dwordx4 v[92:95], v1, s[8:11], s21 offen offset:1024
    s_add_u32 s21, s20, 59392
    buffer_load_dwordx4 v[96:99], v1, s[8:11], s21 offen offset:0
    buffer_load_dwordx4 v[100:103], v1, s[8:11], s21 offen offset:1024
    s_add_u32 s21, s20, 90112
    buffer_load_dwordx4 v[104:107], v1, s[8:11], s21 offen offset:0
    buffer_load_dwordx4 v[108:111], v1, s[8:11], s21 offen offset:1024
    s_add_u32 s21, s20, 98304
    buffer_load_dwordx4 v[112:115], v1, s[8:11], s21 offen offset:0
    buffer_load_dwordx4 v[116:119], v1, s[8:11], s21 offen offset:1024
    s_add_u32 s21, s20, 106496
    buffer_load_dwordx4 v[120:123], v1, s[8:11], s21 offen offset:0
    buffer_load_dwordx4 v[124:127], v1, s[8:11], s21 offen offset:1024
    s_add_u32 s21, s20, 114688
    buffer_load_dwordx4 v[128:131], v1, s[8:11], s21 offen offset:0
    buffer_load_dwordx4 v[132:135], v1, s[8:11], s21 offen offset:1024
    s_add_u32 s21, s20, 12288
    buffer_load_dwordx4 a[0:3], v1, s[8:11], s21 offen offset:0
    buffer_load_dwordx4 a[4:7], v1, s[8:11], s21 offen offset:1024
    s_add_u32 s21, s20, 32768
    buffer_load_dwordx4 a[8:11], v1, s[8:11], s21 offen offset:0
    buffer_load_dwordx4 a[12:15], v1, s[8:11], s21 offen offset:1024
    s_add_u32 s21, s20, 53248
    buffer_load_dwordx4 a[16:19], v1, s[8:11], s21 offen offset:0
    buffer_load_dwordx4 a[20:23], v1, s[8:11], s21 offen offset:1024
    s_add_u32 s21, s20, 14336
    buffer_load_dwordx4 a[24:27], v1, s[8:11], s21 offen offset:0
    buffer_load_dwordx4 a[28:31], v1, s[8:11], s21 offen offset:1024
    s_add_u32 s21, s20, 34816
    buffer_load_dwordx4 a[32:35], v1, s[8:11], s21 offen offset:0
    buffer_load_dwordx4 a[36:39], v1, s[8:11], s21 offen offset:1024
    s_add_u32 s21, s20, 55296
    buffer_load_dwordx4 a[40:43], v1, s[8:11], s21 offen offset:0
    buffer_load_dwordx4 a[44:47], v1, s[8:11], s21 offen offset:1024
    s_add_u32 s21, s20, 0
    buffer_load_dwordx4 a[48:51], v1, s[8:11], s21 offen offset:0
    buffer_load_dwordx4 a[52:55], v1, s[8:11], s21 offen offset:1024
    s_add_u32 s21, s20, 20480
    buffer_load_dwordx4 a[56:59], v1, s[8:11], s21 offen offset:0
    buffer_load_dwordx4 a[60:63], v1, s[8:11], s21 offen offset:1024
    s_add_u32 s21, s20, 40960
    buffer_load_dwordx4 a[64:67], v1, s[8:11], s21 offen offset:0
    buffer_load_dwordx4 a[68:71], v1, s[8:11], s21 offen offset:1024
    s_add_u32 s21, s20, 22528
    buffer_load_dwordx4 a[72:75], v1, s[8:11], s21 offen offset:0
    buffer_load_dwordx4 a[76:79], v1, s[8:11], s21 offen offset:1024
    s_add_u32 s21, s20, 4096
    buffer_load_dwordx4 a[80:83], v1, s[8:11], s21 offen offset:0
    buffer_load_dwordx4 a[84:87], v1, s[8:11], s21 offen offset:1024
    s_add_u32 s21, s20, 45056
    buffer_load_dwordx4 a[88:91], v1, s[8:11], s21 offen offset:0
    buffer_load_dwordx4 a[92:95], v1, s[8:11], s21 offen offset:1024
    s_add_u32 s21, s20, 26624
    buffer_load_dwordx4 a[96:99], v1, s[8:11], s21 offen offset:0
    buffer_load_dwordx4 a[100:103], v1, s[8:11], s21 offen offset:1024
    s_add_u32 s21, s20, 8192
    buffer_load_dwordx4 a[104:107], v1, s[8:11], s21 offen offset:0
    buffer_load_dwordx4 a[108:111], v1, s[8:11], s21 offen offset:1024
    s_add_u32 s21, s20, 49152
    buffer_load_dwordx4 a[112:115], v1, s[8:11], s21 offen offset:0
    buffer_load_dwordx4 a[116:119], v1, s[8:11], s21 offen offset:1024
    s_add_u32 s21, s20, 30720
    buffer_load_dwordx4 a[120:123], v1, s[8:11], s21 offen offset:0
    buffer_load_dwordx4 a[124:127], v1, s[8:11], s21 offen offset:1024
    s_waitcnt vmcnt(32)
    ds_write_b128 v13, v[16:19] offset:0
    ds_write_b128 v13, v[20:23] offset:1024
    ds_write_b128 v13, v[24:27] offset:2048
    ds_write_b128 v13, v[28:31] offset:3072
    ds_write_b128 v13, v[32:35] offset:4096
    ds_write_b128 v13, v[36:39] offset:5120
    ds_write_b128 v13, v[40:43] offset:6144
    ds_write_b128 v13, v[44:47] offset:7168
    ds_write_b128 v13, v[48:51] offset:8192
    ds_write_b128 v13, v[52:55] offset:9216
    ds_write_b128 v13, v[56:59] offset:10240
    ds_write_b128 v13, v[60:63] offset:11264
    ds_write_b128 v13, v[64:67] offset:12288
    ds_write_b128 v13, v[68:71] offset:13312
    ds_write_b128 v13, v[72:75] offset:14336
    ds_write_b128 v13, v[76:79] offset:15360
    ds_write_b128 v13, v[80:83] offset:16384
    ds_write_b128 v13, v[84:87] offset:17408
    ds_write_b128 v13, v[88:91] offset:18432
    ds_write_b128 v13, v[92:95] offset:19456
    ds_write_b128 v13, v[96:99] offset:20480
    ds_write_b128 v13, v[100:103] offset:21504
    ds_write_b128 v13, v[104:107] offset:22528
    ds_write_b128 v13, v[108:111] offset:23552
    ds_write_b128 v13, v[112:115] offset:24576
    ds_write_b128 v13, v[116:119] offset:25600
    ds_write_b128 v13, v[120:123] offset:26624
    ds_write_b128 v13, v[124:127] offset:27648
    ds_write_b128 v13, v[128:131] offset:28672
    ds_write_b128 v13, v[132:135] offset:29696
    s_add_u32 s21, s20, 16384
    buffer_load_dwordx4 a[128:131], v1, s[8:11], s21 offen offset:0
    buffer_load_dwordx4 a[132:135], v1, s[8:11], s21 offen offset:1024
    s_add_u32 s21, s20, 57344
    buffer_load_dwordx4 a[136:139], v1, s[8:11], s21 offen offset:0
    buffer_load_dwordx4 a[140:143], v1, s[8:11], s21 offen offset:1024
    s_add_u32 s21, s20, 38912
    buffer_load_dwordx4 a[144:147], v1, s[8:11], s21 offen offset:0
    buffer_load_dwordx4 a[148:151], v1, s[8:11], s21 offen offset:1024
    s_add_u32 s21, s20, 61440
    buffer_load_dwordx4 a[152:155], v1, s[8:11], s21 offen offset:0
    buffer_load_dwordx4 a[156:159], v1, s[8:11], s21 offen offset:1024
    s_add_u32 s21, s20, 63488
    buffer_load_dwordx4 a[160:163], v1, s[8:11], s21 offen offset:0
    buffer_load_dwordx4 a[164:167], v1, s[8:11], s21 offen offset:1024
    s_add_u32 s21, s20, 65536
    buffer_load_dwordx4 a[168:171], v1, s[8:11], s21 offen offset:0
    buffer_load_dwordx4 a[172:175], v1, s[8:11], s21 offen offset:1024
    s_add_u32 s21, s20, 67584
    buffer_load_dwordx4 a[176:179], v1, s[8:11], s21 offen offset:0
    buffer_load_dwordx4 a[180:183], v1, s[8:11], s21 offen offset:1024
    s_add_u32 s21, s20, 69632
    buffer_load_dwordx4 a[184:187], v1, s[8:11], s21 offen offset:0
    buffer_load_dwordx4 a[188:191], v1, s[8:11], s21 offen offset:1024
    s_add_u32 s21, s20, 71680
    buffer_load_dwordx4 a[192:195], v1, s[8:11], s21 offen offset:0
    buffer_load_dwordx4 a[196:199], v1, s[8:11], s21 offen offset:1024
    s_add_u32 s21, s20, 73728
    buffer_load_dwordx4 a[200:203], v1, s[8:11], s21 offen offset:0
    buffer_load_dwordx4 a[204:207], v1, s[8:11], s21 offen offset:1024
    s_add_u32 s21, s20, 75776
    buffer_load_dwordx4 a[208:211], v1, s[8:11], s21 offen offset:0
    buffer_load_dwordx4 a[212:215], v1, s[8:11], s21 offen offset:1024
    s_add_u32 s21, s20, 77824
    buffer_load_dwordx4 a[216:219], v1, s[8:11], s21 offen offset:0
    buffer_load_dwordx4 a[220:223], v1, s[8:11], s21 offen offset:1024
    s_add_u32 s21, s20, 79872
    buffer_load_dwordx4 a[224:227], v1, s[8:11], s21 offen offset:0
    buffer_load_dwordx4 a[228:231], v1, s[8:11], s21 offen offset:1024
    s_add_u32 s21, s20, 81920
    buffer_load_dwordx4 a[232:235], v1, s[8:11], s21 offen offset:0
    buffer_load_dwordx4 a[236:239], v1, s[8:11], s21 offen offset:1024
    s_add_u32 s21, s20, 83968
    buffer_load_dwordx4 a[240:243], v1, s[8:11], s21 offen offset:0
    buffer_load_dwordx4 a[244:247], v1, s[8:11], s21 offen offset:1024
    s_add_u32 s21, s20, 86016
    buffer_load_dwordx4 a[248:251], v1, s[8:11], s21 offen offset:0
    buffer_load_dwordx4 a[252:255], v1, s[8:11], s21 offen offset:1024
    s_add_u32 s21, s20, 88064
    buffer_load_dwordx4 v[148:151], v1, s[8:11], s21 offen offset:0
    buffer_load_dwordx4 v[152:155], v1, s[8:11], s21 offen offset:1024
    s_add_u32 s21, s20, 92160
    buffer_load_dwordx4 v[156:159], v1, s[8:11], s21 offen offset:0
    buffer_load_dwordx4 v[160:163], v1, s[8:11], s21 offen offset:1024
    s_add_u32 s21, s20, 94208
    buffer_load_dwordx4 v[164:167], v1, s[8:11], s21 offen offset:0
    buffer_load_dwordx4 v[168:171], v1, s[8:11], s21 offen offset:1024
    s_add_u32 s21, s20, 96256
    buffer_load_dwordx4 v[172:175], v1, s[8:11], s21 offen offset:0
    buffer_load_dwordx4 v[176:179], v1, s[8:11], s21 offen offset:1024
    s_add_u32 s21, s20, 100352
    buffer_load_dwordx4 v[180:183], v1, s[8:11], s21 offen offset:0
    buffer_load_dwordx4 v[184:187], v1, s[8:11], s21 offen offset:1024
    s_add_u32 s21, s20, 102400
    buffer_load_dwordx4 v[188:191], v1, s[8:11], s21 offen offset:0
    buffer_load_dwordx4 v[192:195], v1, s[8:11], s21 offen offset:1024
    s_add_u32 s21, s20, 104448
    buffer_load_dwordx4 v[196:199], v1, s[8:11], s21 offen offset:0
    buffer_load_dwordx4 v[200:203], v1, s[8:11], s21 offen offset:1024
    s_add_u32 s21, s20, 108544
    buffer_load_dwordx4 v[204:207], v1, s[8:11], s21 offen offset:0
    buffer_load_dwordx4 v[208:211], v1, s[8:11], s21 offen offset:1024
    s_add_u32 s21, s20, 110592
    buffer_load_dwordx4 v[212:215], v1, s[8:11], s21 offen offset:0
    buffer_load_dwordx4 v[216:219], v1, s[8:11], s21 offen offset:1024
    s_add_u32 s21, s20, 112640
    buffer_load_dwordx4 v[220:223], v1, s[8:11], s21 offen offset:0
    buffer_load_dwordx4 v[224:227], v1, s[8:11], s21 offen offset:1024
    s_add_u32 s21, s20, 116736
    buffer_load_dwordx4 v[228:231], v1, s[8:11], s21 offen offset:0
    buffer_load_dwordx4 v[232:235], v1, s[8:11], s21 offen offset:1024
    s_add_u32 s21, s20, 118784
    buffer_load_dwordx4 v[236:239], v1, s[8:11], s21 offen offset:0
    buffer_load_dwordx4 v[240:243], v1, s[8:11], s21 offen offset:1024
    s_add_u32 s21, s20, 120832
    buffer_load_dwordx4 v[244:247], v1, s[8:11], s21 offen offset:0
    buffer_load_dwordx4 v[248:251], v1, s[8:11], s21 offen offset:1024
    s_waitcnt lgkmcnt(0)
    s_mov_b32 s14, 0
    s_mul_i32 s20, s14, 393216
    s_add_u32 s20, s20, s44
    s_add_u32 s21, s20, 8192
    buffer_load_dwordx4 v[100:103], v9, s[8:11], s21 offen offset:0
    buffer_load_dwordx4 v[104:107], v9, s[8:11], s21 offen offset:512
    v_mov_b32 v56, 0
    v_mov_b32 v57, 0
    v_mov_b32 v58, 0
    v_mov_b32 v59, 0
    v_mov_b32 v60, 0
    v_mov_b32 v61, 0
    v_mov_b32 v62, 0
    v_mov_b32 v63, 0
    v_mov_b32 v64, 0
    v_mov_b32 v65, 0
    v_mov_b32 v66, 0
    v_mov_b32 v67, 0
    v_mov_b32 v68, 0
    v_mov_b32 v69, 0
    v_mov_b32 v70, 0
    v_mov_b32 v71, 0
    v_mov_b32 v72, 0
    v_mov_b32 v73, 0
    v_mov_b32 v74, 0
    v_mov_b32 v75, 0
    v_mov_b32 v76, 0
    v_mov_b32 v77, 0
    v_mov_b32 v78, 0
    v_mov_b32 v79, 0
    v_mov_b32 v80, 0
    v_mov_b32 v81, 0
    v_mov_b32 v82, 0
    v_mov_b32 v83, 0
    v_mov_b32 v84, 0
    v_mov_b32 v85, 0
    v_mov_b32 v86, 0
    v_mov_b32 v87, 0
    ds_read_b128 v[116:119], v13 offset:0
    ds_read_b128 v[120:123], v13 offset:1024
    ds_read_b128 v[124:127], v13 offset:2048
    ds_read_b128 v[128:131], v13 offset:3072
    ds_read_b128 v[132:135], v13 offset:4096
    ds_read_b128 v[136:139], v13 offset:5120
    ds_read_b128 v[140:143], v13 offset:6144
    ds_read_b128 v[144:147], v13 offset:7168
    s_waitcnt lgkmcnt(0)
chain1_kernel_p2_step:
    s_cmp_lt_u32 s14, 32
    s_cselect_b32 s18, s16, s17
    s_and_b32 s20, s14, 31
    s_lshl_b32 s20, s20, 16
    s_add_u32 s18, s18, s20
    s_add_u32 s22, s18, 51200
    s_add_u32 s23, s18, 52224
chain1_kernel_p2_poll:
    buffer_load_dwordx4 v[40:43], v1, s[8:11], s22 offen sc1
    buffer_load_dwordx4 v[44:47], v1, s[8:11], s23 offen sc1
    s_waitcnt vmcnt(0)
    ds_write_b128 v14, v[40:43] offset:6144
    ds_write_b128 v14, v[44:47] offset:7168
    v_max3_u32 v88, v40, v41, v42
    v_max3_u32 v88, v88, v43, v44
    v_max3_u32 v88, v88, v45, v46
    v_max_u32 v88, v88, v47
    v_cmp_eq_u32 vcc, -1, v88
    s_sub_u32 s15, s15, 1
    s_cbranch_scc1 chain1_kernel_bail
    s_cbranch_vccnz chain1_kernel_p2_poll
    s_waitcnt lgkmcnt(0)
    s_barrier
    ds_read_b128 v[16:19], v14 offset:0
    ds_read_b128 v[20:23], v14 offset:1024
    ds_read_b128 v[24:27], v14 offset:2048
    ds_read_b128 v[28:31], v14 offset:3072
    ds_read_b128 v[32:35], v14 offset:4096
    ds_read_b128 v[36:39], v14 offset:5120
    ds_read_b128 v[48:51], v14 offset:8192
    ds_read_b128 v[52:55], v14 offset:9216
    v_smfmac_f32_16x16x64_bf16 v[56:59], v[40:43], a[0:7], v2
    v_smfmac_f32_16x16x64_bf16 v[60:63], v[40:43], a[8:15], v2
    v_smfmac_f32_16x16x64_bf16 v[64:67], v[40:43], a[16:23], v2
    v_smfmac_f32_16x16x64_bf16 v[56:59], v[44:47], a[24:31], v2
    v_smfmac_f32_16x16x64_bf16 v[60:63], v[44:47], a[32:39], v2
    v_smfmac_f32_16x16x64_bf16 v[64:67], v[44:47], a[40:47], v2
    s_waitcnt lgkmcnt(7)
    v_smfmac_f32_16x16x64_bf16 v[56:59], v[16:19], a[48:55], v2
    v_smfmac_f32_16x16x64_bf16 v[60:63], v[16:19], a[56:63], v2
    v_smfmac_f32_16x16x64_bf16 v[64:67], v[16:19], a[64:71], v2
    s_waitcnt lgkmcnt(6)
    v_smfmac_f32_16x16x64_bf16 v[56:59], v[20:23], v[116:123], v2
    ds_read_b128 v[116:119], v13 offset:8192
    ds_read_b128 v[120:123], v13 offset:9216
    v_smfmac_f32_16x16x64_bf16 v[60:63], v[20:23], a[72:79], v2
    v_smfmac_f32_16x16x64_bf16 v[64:67], v[20:23], v[124:131], v2
    ds_read_b128 v[124:127], v13 offset:10240
    ds_read_b128 v[128:131], v13 offset:11264
    s_waitcnt lgkmcnt(9)
    v_smfmac_f32_16x16x64_bf16 v[56:59], v[24:27], a[80:87], v2
    v_smfmac_f32_16x16x64_bf16 v[60:63], v[24:27], v[132:139], v2
    ds_read_b128 v[132:135], v13 offset:12288
    ds_read_b128 v[136:139], v13 offset:13312
    v_smfmac_f32_16x16x64_bf16 v[64:67], v[24:27], a[88:95], v2
    s_waitcnt lgkmcnt(10)
    v_smfmac_f32_16x16x64_bf16 v[56:59], v[28:31], v[140:147], v2
    ds_read_b128 v[140:143], v13 offset:14336
    ds_read_b128 v[144:147], v13 offset:15360
    v_smfmac_f32_16x16x64_bf16 v[60:63], v[28:31], a[96:103], v2
    s_waitcnt lgkmcnt(6)
    v_smfmac_f32_16x16x64_bf16 v[64:67], v[28:31], v[116:123], v2
    ds_read_b128 v[116:119], v13 offset:16384
    ds_read_b128 v[120:123], v13 offset:17408
    v_smfmac_f32_16x16x64_bf16 v[56:59], v[32:35], a[104:111], v2
    s_waitcnt lgkmcnt(6)
    v_smfmac_f32_16x16x64_bf16 v[60:63], v[32:35], v[124:131], v2
    ds_read_b128 v[124:127], v13 offset:18432
    ds_read_b128 v[128:131], v13 offset:19456
    v_smfmac_f32_16x16x64_bf16 v[64:67], v[32:35], a[112:119], v2
    s_waitcnt lgkmcnt(6)
    v_smfmac_f32_16x16x64_bf16 v[56:59], v[36:39], v[132:139], v2
    ds_read_b128 v[132:135], v13 offset:20480
    ds_read_b128 v[136:139], v13 offset:21504
    v_smfmac_f32_16x16x64_bf16 v[60:63], v[36:39], a[120:127], v2
    s_waitcnt lgkmcnt(6)
    v_smfmac_f32_16x16x64_bf16 v[64:67], v[36:39], v[140:147], v2
    ds_read_b128 v[140:143], v13 offset:22528
    ds_read_b128 v[144:147], v13 offset:23552
    v_smfmac_f32_16x16x64_bf16 v[56:59], v[48:51], a[128:135], v2
    s_waitcnt lgkmcnt(6)
    v_smfmac_f32_16x16x64_bf16 v[60:63], v[48:51], v[116:123], v2
    ds_read_b128 v[116:119], v13 offset:24576
    ds_read_b128 v[120:123], v13 offset:25600
    v_smfmac_f32_16x16x64_bf16 v[64:67], v[48:51], a[136:143], v2
    s_waitcnt lgkmcnt(6)
    v_smfmac_f32_16x16x64_bf16 v[56:59], v[52:55], v[124:131], v2
    ds_read_b128 v[124:127], v13 offset:26624
    ds_read_b128 v[128:131], v13 offset:27648
    v_smfmac_f32_16x16x64_bf16 v[60:63], v[52:55], a[144:151], v2
    s_waitcnt lgkmcnt(6)
    v_smfmac_f32_16x16x64_bf16 v[64:67], v[52:55], v[132:139], v2
    ds_read_b128 v[132:135], v13 offset:28672
    ds_read_b128 v[136:139], v13 offset:29696
    v_smfmac_f32_16x16x64_bf16 v[68:71], v[16:19], a[152:159], v2
    v_smfmac_f32_16x16x64_bf16 v[68:71], v[20:23], a[160:167], v2
    v_permlane32_swap_b32 v56, v58
    v_permlane32_swap_b32 v57, v59
    v_smfmac_f32_16x16x64_bf16 v[68:71], v[24:27], a[168:175], v2
    v_add_f32 v56, v56, v58
    v_add_f32 v57, v57, v59
    v_smfmac_f32_16x16x64_bf16 v[68:71], v[28:31], a[176:183], v2
    v_cvt_pk_bf16_f32 v56, v56, v57
    ds_write_b16 v3, v56 offset:0
    v_smfmac_f32_16x16x64_bf16 v[68:71], v[32:35], a[184:191], v2
    ds_write_b16_d16_hi v3, v56 offset:400
    v_permlane32_swap_b32 v60, v62
    v_smfmac_f32_16x16x64_bf16 v[68:71], v[36:39], a[192:199], v2
    v_permlane32_swap_b32 v61, v63
    v_add_f32 v60, v60, v62
    v_smfmac_f32_16x16x64_bf16 v[68:71], v[40:43], a[200:207], v2
    v_add_f32 v61, v61, v63
    v_cvt_pk_bf16_f32 v60, v60, v61
    v_smfmac_f32_16x16x64_bf16 v[68:71], v[44:47], a[208:215], v2
    ds_write_b16 v3, v60 offset:32
    ds_write_b16_d16_hi v3, v60 offset:432
    v_smfmac_f32_16x16x64_bf16 v[68:71], v[48:51], a[216:223], v2
    v_permlane32_swap_b32 v64, v66
    v_permlane32_swap_b32 v65, v67
    v_smfmac_f32_16x16x64_bf16 v[68:71], v[52:55], a[224:231], v2
    v_add_f32 v64, v64, v66
    v_add_f32 v65, v65, v67
    v_smfmac_f32_16x16x64_bf16 v[72:75], v[16:19], a[232:239], v2
    v_cvt_pk_bf16_f32 v64, v64, v65
    ds_write_b16 v3, v64 offset:64
    v_smfmac_f32_16x16x64_bf16 v[72:75], v[20:23], a[240:247], v2
    ds_write_b16_d16_hi v3, v64 offset:464
    v_smfmac_f32_16x16x64_bf16 v[72:75], v[24:27], a[248:255], v2
    v_smfmac_f32_16x16x64_bf16 v[72:75], v[28:31], v[148:155], v2
    s_waitcnt lgkmcnt(0)
    s_barrier
    ds_read_b128 v[88:91], v4 offset:0
    v_smfmac_f32_16x16x64_bf16 v[72:75], v[32:35], v[140:147], v2
    ds_read_b128 v[92:95], v4 offset:128
    ds_read_b128 v[96:99], v4 offset:256
    v_smfmac_f32_16x16x64_bf16 v[72:75], v[36:39], v[156:163], v2
    v_permlane32_swap_b32 v68, v70
    v_permlane32_swap_b32 v69, v71
    v_smfmac_f32_16x16x64_bf16 v[72:75], v[40:43], v[164:171], v2
    v_add_f32 v68, v68, v70
    v_add_f32 v69, v69, v71
    v_smfmac_f32_16x16x64_bf16 v[72:75], v[44:47], v[172:179], v2
    v_cvt_pk_bf16_f32 v68, v68, v69
    ds_write_b16 v3, v68 offset:3200
    v_smfmac_f32_16x16x64_bf16 v[72:75], v[48:51], v[116:123], v2
    ds_write_b16_d16_hi v3, v68 offset:3600
    v_smfmac_f32_16x16x64_bf16 v[72:75], v[52:55], v[180:187], v2
    s_waitcnt lgkmcnt(2)
    v_smfmac_f32_16x16x64_bf16 v[80:83], v[96:99], v[100:107], v2
    v_smfmac_f32_16x16x64_bf16 v[76:79], v[16:19], v[188:195], v2
    v_smfmac_f32_16x16x64_bf16 v[76:79], v[20:23], v[196:203], v2
    v_smfmac_f32_16x16x64_bf16 v[76:79], v[24:27], v[124:131], v2
    v_permlane32_swap_b32 v72, v74
    v_permlane32_swap_b32 v73, v75
    v_smfmac_f32_16x16x64_bf16 v[76:79], v[28:31], v[204:211], v2
    v_add_f32 v72, v72, v74
    v_add_f32 v73, v73, v75
    ds_write_b128 v15, v[80:83]
    v_smfmac_f32_16x16x64_bf16 v[76:79], v[32:35], v[212:219], v2
    v_cvt_pk_bf16_f32 v72, v72, v73
    ds_write_b16 v3, v72 offset:3232
    v_smfmac_f32_16x16x64_bf16 v[76:79], v[36:39], v[220:227], v2
    ds_write_b16_d16_hi v3, v72 offset:3632
    v_smfmac_f32_16x16x64_bf16 v[76:79], v[40:43], v[132:139], v2
    v_smfmac_f32_16x16x64_bf16 v[76:79], v[44:47], v[228:235], v2
    v_smfmac_f32_16x16x64_bf16 v[76:79], v[48:51], v[236:243], v2
    v_smfmac_f32_16x16x64_bf16 v[76:79], v[52:55], v[244:251], v2
    s_nop 7
    v_permlane32_swap_b32 v76, v78
    v_permlane32_swap_b32 v77, v79
    v_add_f32 v76, v76, v78
    v_add_f32 v77, v77, v79
    v_cvt_pk_bf16_f32 v76, v76, v77
    ds_write_b16 v3, v76 offset:3264
    ds_write_b16_d16_hi v3, v76 offset:3664
    s_waitcnt lgkmcnt(0)
    s_barrier
    ds_read2st64_b32 v[40:41], v6 offset0:0 offset1:2
    ds_read2st64_b32 v[42:43], v6 offset0:8 offset1:10
    ds_read_b128 v[16:19], v5 offset:0
    ds_read_b128 v[20:23], v5 offset:16
    ds_read_b128 v[24:27], v5 offset:128
    ds_read_b128 v[28:31], v5 offset:144
    ds_read_b128 v[32:35], v5 offset:256
    ds_read_b128 v[36:39], v5 offset:272
    s_waitcnt lgkmcnt(6)
    v_add_f32 v40, v40, v41
    v_add_f32 v42, v42, v43
    v_add_f32 v44, v40, v42
    v_mul_f32 v44, 0x3dd53b95, v44
    s_waitcnt lgkmcnt(4)
    v_smfmac_f32_16x16x64_bf16 v[84:87], v[88:91], v[16:23], v2
    s_waitcnt lgkmcnt(2)
    v_smfmac_f32_16x16x64_bf16 v[84:87], v[92:95], v[24:31], v2
    s_waitcnt lgkmcnt(0)
    v_smfmac_f32_16x16x64_bf16 v[84:87], v[96:99], v[32:39], v2
    v_max_f32_dpp v45, v44, v44 row_ror:8 row_mask:0xf bank_mask:0xf
    s_nop 1
    v_max_f32_dpp v45, v45, v45 row_ror:4 row_mask:0xf bank_mask:0xf
    s_nop 1
    v_max_f32_dpp v45, v45, v45 row_ror:2 row_mask:0xf bank_mask:0xf
    s_nop 1
    v_max_f32_dpp v45, v45, v45 row_ror:1 row_mask:0xf bank_mask:0xf
    v_mov_b32 v47, v45
    s_nop 1
    v_permlane32_swap_b32 v45, v47
    v_max_f32 v45, v45, v47
    v_mov_b32 v47, v86
    s_nop 1
    v_permlane32_swap_b32 v86, v47
    v_add_f32 v48, v86, v47
    v_mul_f32 v48, 0x3dd53b95, v48
    s_nop 1
    v_max_f32_dpp v46, v48, v48 row_ror:4 row_mask:0xf bank_mask:0xf
    s_nop 1
    v_max_f32_dpp v46, v46, v46 row_ror:2 row_mask:0xf bank_mask:0xf
    s_nop 1
    v_max_f32_dpp v46, v46, v46 row_ror:1 row_mask:0xf bank_mask:0xf
    v_max_f32 v45, v45, v46
    v_sub_f32 v49, v44, v45
    v_sub_f32 v50, v48, v45
    v_exp_f32 v49, v49
    v_exp_f32 v50, v50
    s_nop 0
    v_fma_f32 v51, v50, v12, v49
    s_nop 1
    v_add_f32_dpp v51, v51, v51 row_ror:8 row_mask:0xf bank_mask:0xf
    s_nop 1
    v_add_f32_dpp v51, v51, v51 row_ror:4 row_mask:0xf bank_mask:0xf
    s_nop 1
    v_add_f32_dpp v51, v51, v51 row_ror:2 row_mask:0xf bank_mask:0xf
    s_nop 1
    v_add_f32_dpp v51, v51, v51 row_ror:1 row_mask:0xf bank_mask:0xf
    v_mov_b32 v47, v51
    s_nop 1
    v_permlane32_swap_b32 v51, v47
    v_add_f32 v51, v51, v47
    v_rcp_f32 v51, v51
    s_nop 0
    v_mul_f32 v49, v49, v51
    v_mul_f32 v50, v50, v51
    s_nop 0
    v_mov_b32_dpp v46, v49 quad_perm:[1,0,3,2] row_mask:0xf bank_mask:0xf
    v_mov_b32_dpp v47, v50 quad_perm:[1,0,3,2] row_mask:0xf bank_mask:0xf
    v_cvt_pk_bf16_f32 v16, v49, v46
    v_cvt_pk_bf16_f32 v20, v50, v47
    s_nop 0
    v_mov_b32_dpp v17, v16 row_shl:2 row_mask:0xf bank_mask:0xf
    v_mov_b32_dpp v18, v16 row_shl:4 row_mask:0xf bank_mask:0xf
    v_mov_b32_dpp v19, v16 row_shl:6 row_mask:0xf bank_mask:0xf
    v_mov_b32_dpp v21, v20 row_shl:2 row_mask:0xf bank_mask:0xf
    v_mov_b32_dpp v22, v20 row_shl:4 row_mask:0xf bank_mask:0xf
    v_mov_b32_dpp v23, v20 row_shl:6 row_mask:0xf bank_mask:0xf
    s_mov_b64 exec, s[40:41]
    buffer_store_dwordx4 v[16:19], v7, s[8:11], s18 offen sc1
    s_mov_b64 exec, s[42:43]
    buffer_store_dwordx4 v[20:23], v8, s[8:11], s18 offen sc1
    s_mov_b64 exec, -1
    ds_read_b128 v[40:43], v10
    s_add_u32 s28, s14, 1
    s_min_u32 s28, s28, 63
    s_mul_i32 s20, s28, 393216
    s_add_u32 s20, s20, s44
    s_add_u32 s21, s20, 8192
    buffer_load_dwordx4 v[100:103], v9, s[8:11], s21 offen offset:0
    buffer_load_dwordx4 v[104:107], v9, s[8:11], s21 offen offset:512
    v_mov_b32 v56, 0
    v_mov_b32 v57, 0
    v_mov_b32 v58, 0
    v_mov_b32 v59, 0
    v_mov_b32 v60, 0
    v_mov_b32 v61, 0
    v_mov_b32 v62, 0
    v_mov_b32 v63, 0
    v_mov_b32 v64, 0
    v_mov_b32 v65, 0
    v_mov_b32 v66, 0
    v_mov_b32 v67, 0
    v_mov_b32 v68, 0
    v_mov_b32 v69, 0
    v_mov_b32 v70, 0
    v_mov_b32 v71, 0
    v_mov_b32 v72, 0
    v_mov_b32 v73, 0
    v_mov_b32 v74, 0
    v_mov_b32 v75, 0
    v_mov_b32 v76, 0
    v_mov_b32 v77, 0
    v_mov_b32 v78, 0
    v_mov_b32 v79, 0
    v_mov_b32 v80, 0
    v_mov_b32 v81, 0
    v_mov_b32 v82, 0
    v_mov_b32 v83, 0
    v_mov_b32 v84, 0
    v_mov_b32 v85, 0
    v_mov_b32 v86, 0
    v_mov_b32 v87, 0
    s_waitcnt lgkmcnt(0)
    s_mul_i32 s20, s14, 98304
    s_add_u32 s20, s20, s45
    buffer_store_dwordx4 v[40:43], v11, s[8:11], s20 offen
    ds_read_b128 v[116:119], v13 offset:0
    ds_read_b128 v[120:123], v13 offset:1024
    ds_read_b128 v[124:127], v13 offset:2048
    ds_read_b128 v[128:131], v13 offset:3072
    ds_read_b128 v[132:135], v13 offset:4096
    ds_read_b128 v[136:139], v13 offset:5120
    ds_read_b128 v[140:143], v13 offset:6144
    ds_read_b128 v[144:147], v13 offset:7168
    s_waitcnt lgkmcnt(0)
    s_add_u32 s14, s14, 1
    s_cmp_lt_u32 s14, 64
    s_cbranch_scc1 chain1_kernel_p2_step
    s_branch chain1_kernel_end
chain1_kernel_p3_start:
    v_lshrrev_b32 v16, 4, v0
    v_and_b32 v17, 15, v0
    v_and_b32 v18, 1, v16
    v_lshlrev_b32 v18, 2, v18
    v_lshrrev_b32 v19, 1, v16
    v_lshl_add_u32 v18, v19, 1, v18
    v_mul_u32_u24 v18, 400, v18
    v_lshl_add_u32 v18, v17, 1, v18
    v_add_u32 v3, 133408, v18
    v_and_b32 v18, 7, v0
    v_mul_u32_u24 v18, 400, v18
    v_lshrrev_b32 v19, 3, v0
    v_lshl_add_u32 v18, v19, 4, v18
    v_add_u32 v4, 133120, v18
    v_and_b32 v18, 7, v0
    v_mul_u32_u24 v18, 400, v18
    v_lshl_add_u32 v18, v16, 5, v18
    v_add_u32 v5, 136320, v18
    v_lshrrev_b32 v18, 1, v16
    v_lshlrev_b32 v18, 10, v18
    v_and_b32 v19, 31, v0
    v_lshl_add_u32 v18, v19, 4, v18
    v_add_u32 v6, 139532, v18
    v_add_u32 v15, 142592, v1
    v_lshrrev_b32 v18, 1, v16
    v_lshlrev_b32 v18, 1, v18
    v_lshrrev_b32 v19, 3, v17
    v_add3_u32 v18, v18, v19, 1
    v_lshrrev_b32 v19, 1, v18
    v_lshlrev_b32 v19, 14, v19
    v_and_b32 v18, 1, v18
    v_lshl_add_u32 v18, v18, 12, v19
    v_and_b32 v19, 1, v16
    v_lshlrev_b32 v19, 4, v19
    v_add_u32 v19, 96, v19
    s_lshl_b32 s20, s12, 7
    v_add_u32 v8, s20, v19
    v_add_u32 v7, v8, v18
    v_lshlrev_b32 v18, 4, v17
    v_lshl_add_u32 v18, v16, 10, v18
    v_add_u32 v9, 256, v18
    v_add_u32 v18, 192, v0
    v_mul_u32_u24 v19, 2731, v18
    v_lshrrev_b32 v19, 16, v19
    v_mul_u32_u24 v20, 24, v19
    v_sub_u32 v20, v18, v20
    v_mul_u32_u24 v21, 400, v19
    v_lshl_add_u32 v21, v20, 4, v21
    v_add_u32 v10, 136320, v21
    v_lshlrev_b32 v21, 4, v19
    v_lshl_add_u32 v11, v20, 7, v21
    v_and_b32 v18, 0x28, v0
    v_cmp_eq_u32 vcc, 0, v18
    v_mov_b32 v18, 1.0
    v_mov_b32 v19, 0
    v_cndmask_b32 v12, v19, v18, vcc
    v_add_u32 v13, 92160, v1
    v_add_u32 v14, 122880, v1
    s_mul_i32 s44, s12, 12288
    s_add_u32 s44, s44, 53477376
    s_mul_i32 s45, s12, 3072
    s_add_u32 s45, s45, 208666624
    s_mul_i32 s20, s12, 491520
    s_add_u32 s20, s20, 11902976
    s_add_u32 s21, s20, 2048
    buffer_load_dwordx4 v[16:19], v1, s[8:11], s21 offen offset:0
    buffer_load_dwordx4 v[20:23], v1, s[8:11], s21 offen offset:1024
    s_add_u32 s21, s20, 43008
    buffer_load_dwordx4 v[24:27], v1, s[8:11], s21 offen offset:0
    buffer_load_dwordx4 v[28:31], v1, s[8:11], s21 offen offset:1024
    s_add_u32 s21, s20, 24576
    buffer_load_dwordx4 v[32:35], v1, s[8:11], s21 offen offset:0
    buffer_load_dwordx4 v[36:39], v1, s[8:11], s21 offen offset:1024
    s_add_u32 s21, s20, 6144
    buffer_load_dwordx4 v[40:43], v1, s[8:11], s21 offen offset:0
    buffer_load_dwordx4 v[44:47], v1, s[8:11], s21 offen offset:1024
    s_add_u32 s21, s20, 47104
    buffer_load_dwordx4 v[48:51], v1, s[8:11], s21 offen offset:0
    buffer_load_dwordx4 v[52:55], v1, s[8:11], s21 offen offset:1024
    s_add_u32 s21, s20, 28672
    buffer_load_dwordx4 v[56:59], v1, s[8:11], s21 offen offset:0
    buffer_load_dwordx4 v[60:63], v1, s[8:11], s21 offen offset:1024
    s_add_u32 s21, s20, 10240
    buffer_load_dwordx4 v[64:67], v1, s[8:11], s21 offen offset:0
    buffer_load_dwordx4 v[68:71], v1, s[8:11], s21 offen offset:1024
    s_add_u32 s21, s20, 51200
    buffer_load_dwordx4 v[72:75], v1, s[8:11], s21 offen offset:0
    buffer_load_dwordx4 v[76:79], v1, s[8:11], s21 offen offset:1024
    s_add_u32 s21, s20, 32768
    buffer_load_dwordx4 v[80:83], v1, s[8:11], s21 offen offset:0
    buffer_load_dwordx4 v[84:87], v1, s[8:11], s21 offen offset:1024
    s_add_u32 s21, s20, 14336
    buffer_load_dwordx4 v[88:91], v1, s[8:11], s21 offen offset:0
    buffer_load_dwordx4 v[92:95], v1, s[8:11], s21 offen offset:1024
    s_add_u32 s21, s20, 55296
    buffer_load_dwordx4 v[96:99], v1, s[8:11], s21 offen offset:0
    buffer_load_dwordx4 v[100:103], v1, s[8:11], s21 offen offset:1024
    s_add_u32 s21, s20, 90112
    buffer_load_dwordx4 v[104:107], v1, s[8:11], s21 offen offset:0
    buffer_load_dwordx4 v[108:111], v1, s[8:11], s21 offen offset:1024
    s_add_u32 s21, s20, 98304
    buffer_load_dwordx4 v[112:115], v1, s[8:11], s21 offen offset:0
    buffer_load_dwordx4 v[116:119], v1, s[8:11], s21 offen offset:1024
    s_add_u32 s21, s20, 106496
    buffer_load_dwordx4 v[120:123], v1, s[8:11], s21 offen offset:0
    buffer_load_dwordx4 v[124:127], v1, s[8:11], s21 offen offset:1024
    s_add_u32 s21, s20, 114688
    buffer_load_dwordx4 v[128:131], v1, s[8:11], s21 offen offset:0
    buffer_load_dwordx4 v[132:135], v1, s[8:11], s21 offen offset:1024
    s_add_u32 s21, s20, 16384
    buffer_load_dwordx4 a[0:3], v1, s[8:11], s21 offen offset:0
    buffer_load_dwordx4 a[4:7], v1, s[8:11], s21 offen offset:1024
    s_add_u32 s21, s20, 36864
    buffer_load_dwordx4 a[8:11], v1, s[8:11], s21 offen offset:0
    buffer_load_dwordx4 a[12:15], v1, s[8:11], s21 offen offset:1024
    s_add_u32 s21, s20, 57344
    buffer_load_dwordx4 a[16:19], v1, s[8:11], s21 offen offset:0
    buffer_load_dwordx4 a[20:23], v1, s[8:11], s21 offen offset:1024
    s_add_u32 s21, s20, 18432
    buffer_load_dwordx4 a[24:27], v1, s[8:11], s21 offen offset:0
    buffer_load_dwordx4 a[28:31], v1, s[8:11], s21 offen offset:1024
    s_add_u32 s21, s20, 38912
    buffer_load_dwordx4 a[32:35], v1, s[8:11], s21 offen offset:0
    buffer_load_dwordx4 a[36:39], v1, s[8:11], s21 offen offset:1024
    s_add_u32 s21, s20, 59392
    buffer_load_dwordx4 a[40:43], v1, s[8:11], s21 offen offset:0
    buffer_load_dwordx4 a[44:47], v1, s[8:11], s21 offen offset:1024
    s_add_u32 s21, s20, 0
    buffer_load_dwordx4 a[48:51], v1, s[8:11], s21 offen offset:0
    buffer_load_dwordx4 a[52:55], v1, s[8:11], s21 offen offset:1024
    s_add_u32 s21, s20, 20480
    buffer_load_dwordx4 a[56:59], v1, s[8:11], s21 offen offset:0
    buffer_load_dwordx4 a[60:63], v1, s[8:11], s21 offen offset:1024
    s_add_u32 s21, s20, 40960
    buffer_load_dwordx4 a[64:67], v1, s[8:11], s21 offen offset:0
    buffer_load_dwordx4 a[68:71], v1, s[8:11], s21 offen offset:1024
    s_add_u32 s21, s20, 22528
    buffer_load_dwordx4 a[72:75], v1, s[8:11], s21 offen offset:0
    buffer_load_dwordx4 a[76:79], v1, s[8:11], s21 offen offset:1024
    s_add_u32 s21, s20, 4096
    buffer_load_dwordx4 a[80:83], v1, s[8:11], s21 offen offset:0
    buffer_load_dwordx4 a[84:87], v1, s[8:11], s21 offen offset:1024
    s_add_u32 s21, s20, 45056
    buffer_load_dwordx4 a[88:91], v1, s[8:11], s21 offen offset:0
    buffer_load_dwordx4 a[92:95], v1, s[8:11], s21 offen offset:1024
    s_add_u32 s21, s20, 26624
    buffer_load_dwordx4 a[96:99], v1, s[8:11], s21 offen offset:0
    buffer_load_dwordx4 a[100:103], v1, s[8:11], s21 offen offset:1024
    s_add_u32 s21, s20, 8192
    buffer_load_dwordx4 a[104:107], v1, s[8:11], s21 offen offset:0
    buffer_load_dwordx4 a[108:111], v1, s[8:11], s21 offen offset:1024
    s_add_u32 s21, s20, 49152
    buffer_load_dwordx4 a[112:115], v1, s[8:11], s21 offen offset:0
    buffer_load_dwordx4 a[116:119], v1, s[8:11], s21 offen offset:1024
    s_add_u32 s21, s20, 30720
    buffer_load_dwordx4 a[120:123], v1, s[8:11], s21 offen offset:0
    buffer_load_dwordx4 a[124:127], v1, s[8:11], s21 offen offset:1024
    s_waitcnt vmcnt(32)
    ds_write_b128 v13, v[16:19] offset:0
    ds_write_b128 v13, v[20:23] offset:1024
    ds_write_b128 v13, v[24:27] offset:2048
    ds_write_b128 v13, v[28:31] offset:3072
    ds_write_b128 v13, v[32:35] offset:4096
    ds_write_b128 v13, v[36:39] offset:5120
    ds_write_b128 v13, v[40:43] offset:6144
    ds_write_b128 v13, v[44:47] offset:7168
    ds_write_b128 v13, v[48:51] offset:8192
    ds_write_b128 v13, v[52:55] offset:9216
    ds_write_b128 v13, v[56:59] offset:10240
    ds_write_b128 v13, v[60:63] offset:11264
    ds_write_b128 v13, v[64:67] offset:12288
    ds_write_b128 v13, v[68:71] offset:13312
    ds_write_b128 v13, v[72:75] offset:14336
    ds_write_b128 v13, v[76:79] offset:15360
    ds_write_b128 v13, v[80:83] offset:16384
    ds_write_b128 v13, v[84:87] offset:17408
    ds_write_b128 v13, v[88:91] offset:18432
    ds_write_b128 v13, v[92:95] offset:19456
    ds_write_b128 v13, v[96:99] offset:20480
    ds_write_b128 v13, v[100:103] offset:21504
    ds_write_b128 v13, v[104:107] offset:22528
    ds_write_b128 v13, v[108:111] offset:23552
    ds_write_b128 v13, v[112:115] offset:24576
    ds_write_b128 v13, v[116:119] offset:25600
    ds_write_b128 v13, v[120:123] offset:26624
    ds_write_b128 v13, v[124:127] offset:27648
    ds_write_b128 v13, v[128:131] offset:28672
    ds_write_b128 v13, v[132:135] offset:29696
    s_add_u32 s21, s20, 12288
    buffer_load_dwordx4 a[128:131], v1, s[8:11], s21 offen offset:0
    buffer_load_dwordx4 a[132:135], v1, s[8:11], s21 offen offset:1024
    s_add_u32 s21, s20, 53248
    buffer_load_dwordx4 a[136:139], v1, s[8:11], s21 offen offset:0
    buffer_load_dwordx4 a[140:143], v1, s[8:11], s21 offen offset:1024
    s_add_u32 s21, s20, 34816
    buffer_load_dwordx4 a[144:147], v1, s[8:11], s21 offen offset:0
    buffer_load_dwordx4 a[148:151], v1, s[8:11], s21 offen offset:1024
    s_add_u32 s21, s20, 61440
    buffer_load_dwordx4 a[152:155], v1, s[8:11], s21 offen offset:0
    buffer_load_dwordx4 a[156:159], v1, s[8:11], s21 offen offset:1024
    s_add_u32 s21, s20, 63488
    buffer_load_dwordx4 a[160:163], v1, s[8:11], s21 offen offset:0
    buffer_load_dwordx4 a[164:167], v1, s[8:11], s21 offen offset:1024
    s_add_u32 s21, s20, 65536
    buffer_load_dwordx4 a[168:171], v1, s[8:11], s21 offen offset:0
    buffer_load_dwordx4 a[172:175], v1, s[8:11], s21 offen offset:1024
    s_add_u32 s21, s20, 67584
    buffer_load_dwordx4 a[176:179], v1, s[8:11], s21 offen offset:0
    buffer_load_dwordx4 a[180:183], v1, s[8:11], s21 offen offset:1024
    s_add_u32 s21, s20, 69632
    buffer_load_dwordx4 a[184:187], v1, s[8:11], s21 offen offset:0
    buffer_load_dwordx4 a[188:191], v1, s[8:11], s21 offen offset:1024
    s_add_u32 s21, s20, 71680
    buffer_load_dwordx4 a[192:195], v1, s[8:11], s21 offen offset:0
    buffer_load_dwordx4 a[196:199], v1, s[8:11], s21 offen offset:1024
    s_add_u32 s21, s20, 73728
    buffer_load_dwordx4 a[200:203], v1, s[8:11], s21 offen offset:0
    buffer_load_dwordx4 a[204:207], v1, s[8:11], s21 offen offset:1024
    s_add_u32 s21, s20, 75776
    buffer_load_dwordx4 a[208:211], v1, s[8:11], s21 offen offset:0
    buffer_load_dwordx4 a[212:215], v1, s[8:11], s21 offen offset:1024
    s_add_u32 s21, s20, 77824
    buffer_load_dwordx4 a[216:219], v1, s[8:11], s21 offen offset:0
    buffer_load_dwordx4 a[220:223], v1, s[8:11], s21 offen offset:1024
    s_add_u32 s21, s20, 79872
    buffer_load_dwordx4 a[224:227], v1, s[8:11], s21 offen offset:0
    buffer_load_dwordx4 a[228:231], v1, s[8:11], s21 offen offset:1024
    s_add_u32 s21, s20, 81920
    buffer_load_dwordx4 a[232:235], v1, s[8:11], s21 offen offset:0
    buffer_load_dwordx4 a[236:239], v1, s[8:11], s21 offen offset:1024
    s_add_u32 s21, s20, 83968
    buffer_load_dwordx4 a[240:243], v1, s[8:11], s21 offen offset:0
    buffer_load_dwordx4 a[244:247], v1, s[8:11], s21 offen offset:1024
    s_add_u32 s21, s20, 86016
    buffer_load_dwordx4 a[248:251], v1, s[8:11], s21 offen offset:0
    buffer_load_dwordx4 a[252:255], v1, s[8:11], s21 offen offset:1024
    s_add_u32 s21, s20, 88064
    buffer_load_dwordx4 v[148:151], v1, s[8:11], s21 offen offset:0
    buffer_load_dwordx4 v[152:155], v1, s[8:11], s21 offen offset:1024
    s_add_u32 s21, s20, 92160
    buffer_load_dwordx4 v[156:159], v1, s[8:11], s21 offen offset:0
    buffer_load_dwordx4 v[160:163], v1, s[8:11], s21 offen offset:1024
    s_add_u32 s21, s20, 94208
    buffer_load_dwordx4 v[164:167], v1, s[8:11], s21 offen offset:0
    buffer_load_dwordx4 v[168:171], v1, s[8:11], s21 offen offset:1024
    s_add_u32 s21, s20, 96256
    buffer_load_dwordx4 v[172:175], v1, s[8:11], s21 offen offset:0
    buffer_load_dwordx4 v[176:179], v1, s[8:11], s21 offen offset:1024
    s_add_u32 s21, s20, 100352
    buffer_load_dwordx4 v[180:183], v1, s[8:11], s21 offen offset:0
    buffer_load_dwordx4 v[184:187], v1, s[8:11], s21 offen offset:1024
    s_add_u32 s21, s20, 102400
    buffer_load_dwordx4 v[188:191], v1, s[8:11], s21 offen offset:0
    buffer_load_dwordx4 v[192:195], v1, s[8:11], s21 offen offset:1024
    s_add_u32 s21, s20, 104448
    buffer_load_dwordx4 v[196:199], v1, s[8:11], s21 offen offset:0
    buffer_load_dwordx4 v[200:203], v1, s[8:11], s21 offen offset:1024
    s_add_u32 s21, s20, 108544
    buffer_load_dwordx4 v[204:207], v1, s[8:11], s21 offen offset:0
    buffer_load_dwordx4 v[208:211], v1, s[8:11], s21 offen offset:1024
    s_add_u32 s21, s20, 110592
    buffer_load_dwordx4 v[212:215], v1, s[8:11], s21 offen offset:0
    buffer_load_dwordx4 v[216:219], v1, s[8:11], s21 offen offset:1024
    s_add_u32 s21, s20, 112640
    buffer_load_dwordx4 v[220:223], v1, s[8:11], s21 offen offset:0
    buffer_load_dwordx4 v[224:227], v1, s[8:11], s21 offen offset:1024
    s_add_u32 s21, s20, 116736
    buffer_load_dwordx4 v[228:231], v1, s[8:11], s21 offen offset:0
    buffer_load_dwordx4 v[232:235], v1, s[8:11], s21 offen offset:1024
    s_add_u32 s21, s20, 118784
    buffer_load_dwordx4 v[236:239], v1, s[8:11], s21 offen offset:0
    buffer_load_dwordx4 v[240:243], v1, s[8:11], s21 offen offset:1024
    s_add_u32 s21, s20, 120832
    buffer_load_dwordx4 v[244:247], v1, s[8:11], s21 offen offset:0
    buffer_load_dwordx4 v[248:251], v1, s[8:11], s21 offen offset:1024
    s_waitcnt lgkmcnt(0)
    s_mov_b32 s14, 0
    s_mul_i32 s20, s14, 393216
    s_add_u32 s20, s20, s44
    s_add_u32 s21, s20, 8192
    buffer_load_dwordx4 v[100:103], v9, s[8:11], s21 offen offset:0
    buffer_load_dwordx4 v[104:107], v9, s[8:11], s21 offen offset:512
    v_mov_b32 v56, 0
    v_mov_b32 v57, 0
    v_mov_b32 v58, 0
    v_mov_b32 v59, 0
    v_mov_b32 v60, 0
    v_mov_b32 v61, 0
    v_mov_b32 v62, 0
    v_mov_b32 v63, 0
    v_mov_b32 v64, 0
    v_mov_b32 v65, 0
    v_mov_b32 v66, 0
    v_mov_b32 v67, 0
    v_mov_b32 v68, 0
    v_mov_b32 v69, 0
    v_mov_b32 v70, 0
    v_mov_b32 v71, 0
    v_mov_b32 v72, 0
    v_mov_b32 v73, 0
    v_mov_b32 v74, 0
    v_mov_b32 v75, 0
    v_mov_b32 v76, 0
    v_mov_b32 v77, 0
    v_mov_b32 v78, 0
    v_mov_b32 v79, 0
    v_mov_b32 v80, 0
    v_mov_b32 v81, 0
    v_mov_b32 v82, 0
    v_mov_b32 v83, 0
    v_mov_b32 v84, 0
    v_mov_b32 v85, 0
    v_mov_b32 v86, 0
    v_mov_b32 v87, 0
    ds_read_b128 v[116:119], v13 offset:0
    ds_read_b128 v[120:123], v13 offset:1024
    ds_read_b128 v[124:127], v13 offset:2048
    ds_read_b128 v[128:131], v13 offset:3072
    ds_read_b128 v[132:135], v13 offset:4096
    ds_read_b128 v[136:139], v13 offset:5120
    ds_read_b128 v[140:143], v13 offset:6144
    ds_read_b128 v[144:147], v13 offset:7168
    s_waitcnt lgkmcnt(0)
chain1_kernel_p3_step:
    s_cmp_lt_u32 s14, 32
    s_cselect_b32 s18, s16, s17
    s_and_b32 s20, s14, 31
    s_lshl_b32 s20, s20, 16
    s_add_u32 s18, s18, s20
    s_add_u32 s22, s18, 53248
    s_add_u32 s23, s18, 54272
chain1_kernel_p3_poll:
    buffer_load_dwordx4 v[48:51], v1, s[8:11], s22 offen sc1
    buffer_load_dwordx4 v[52:55], v1, s[8:11], s23 offen sc1
    s_waitcnt vmcnt(0)
    ds_write_b128 v14, v[48:51] offset:8192
    ds_write_b128 v14, v[52:55] offset:9216
    v_max3_u32 v88, v48, v49, v50
    v_max3_u32 v88, v88, v51, v52
    v_max3_u32 v88, v88, v53, v54
    v_max_u32 v88, v88, v55
    v_cmp_eq_u32 vcc, -1, v88
    s_sub_u32 s15, s15, 1
    s_cbranch_scc1 chain1_kernel_bail
    s_cbranch_vccnz chain1_kernel_p3_poll
    s_waitcnt lgkmcnt(0)
    s_barrier
    ds_read_b128 v[16:19], v14 offset:0
    ds_read_b128 v[20:23], v14 offset:1024
    ds_read_b128 v[24:27], v14 offset:2048
    ds_read_b128 v[28:31], v14 offset:3072
    ds_read_b128 v[32:35], v14 offset:4096
    ds_read_b128 v[36:39], v14 offset:5120
    ds_read_b128 v[40:43], v14 offset:6144
    ds_read_b128 v[44:47], v14 offset:7168
    v_smfmac_f32_16x16x64_bf16 v[56:59], v[48:51], a[0:7], v2
    v_smfmac_f32_16x16x64_bf16 v[60:63], v[48:51], a[8:15], v2
    v_smfmac_f32_16x16x64_bf16 v[64:67], v[48:51], a[16:23], v2
    v_smfmac_f32_16x16x64_bf16 v[56:59], v[52:55], a[24:31], v2
    v_smfmac_f32_16x16x64_bf16 v[60:63], v[52:55], a[32:39], v2
    v_smfmac_f32_16x16x64_bf16 v[64:67], v[52:55], a[40:47], v2
    s_waitcnt lgkmcnt(7)
    v_smfmac_f32_16x16x64_bf16 v[56:59], v[16:19], a[48:55], v2
    v_smfmac_f32_16x16x64_bf16 v[60:63], v[16:19], a[56:63], v2
    v_smfmac_f32_16x16x64_bf16 v[64:67], v[16:19], a[64:71], v2
    s_waitcnt lgkmcnt(6)
    v_smfmac_f32_16x16x64_bf16 v[56:59], v[20:23], v[116:123], v2
    ds_read_b128 v[116:119], v13 offset:8192
    ds_read_b128 v[120:123], v13 offset:9216
    v_smfmac_f32_16x16x64_bf16 v[60:63], v[20:23], a[72:79], v2
    v_smfmac_f32_16x16x64_bf16 v[64:67], v[20:23], v[124:131], v2
    ds_read_b128 v[124:127], v13 offset:10240
    ds_read_b128 v[128:131], v13 offset:11264
    s_waitcnt lgkmcnt(9)
    v_smfmac_f32_16x16x64_bf16 v[56:59], v[24:27], a[80:87], v2
    v_smfmac_f32_16x16x64_bf16 v[60:63], v[24:27], v[132:139], v2
    ds_read_b128 v[132:135], v13 offset:12288
    ds_read_b128 v[136:139], v13 offset:13312
    v_smfmac_f32_16x16x64_bf16 v[64:67], v[24:27], a[88:95], v2
    s_waitcnt lgkmcnt(10)
    v_smfmac_f32_16x16x64_bf16 v[56:59], v[28:31], v[140:147], v2
    ds_read_b128 v[140:143], v13 offset:14336
    ds_read_b128 v[144:147], v13 offset:15360
    v_smfmac_f32_16x16x64_bf16 v[60:63], v[28:31], a[96:103], v2
    s_waitcnt lgkmcnt(6)
    v_smfmac_f32_16x16x64_bf16 v[64:67], v[28:31], v[116:123], v2
    ds_read_b128 v[116:119], v13 offset:16384
    ds_read_b128 v[120:123], v13 offset:17408
    v_smfmac_f32_16x16x64_bf16 v[56:59], v[32:35], a[104:111], v2
    s_waitcnt lgkmcnt(6)
    v_smfmac_f32_16x16x64_bf16 v[60:63], v[32:35], v[124:131], v2
    ds_read_b128 v[124:127], v13 offset:18432
    ds_read_b128 v[128:131], v13 offset:19456
    v_smfmac_f32_16x16x64_bf16 v[64:67], v[32:35], a[112:119], v2
    s_waitcnt lgkmcnt(6)
    v_smfmac_f32_16x16x64_bf16 v[56:59], v[36:39], v[132:139], v2
    ds_read_b128 v[132:135], v13 offset:20480
    ds_read_b128 v[136:139], v13 offset:21504
    v_smfmac_f32_16x16x64_bf16 v[60:63], v[36:39], a[120:127], v2
    s_waitcnt lgkmcnt(6)
    v_smfmac_f32_16x16x64_bf16 v[64:67], v[36:39], v[140:147], v2
    ds_read_b128 v[140:143], v13 offset:22528
    ds_read_b128 v[144:147], v13 offset:23552
    v_smfmac_f32_16x16x64_bf16 v[56:59], v[40:43], a[128:135], v2
    s_waitcnt lgkmcnt(6)
    v_smfmac_f32_16x16x64_bf16 v[60:63], v[40:43], v[116:123], v2
    ds_read_b128 v[116:119], v13 offset:24576
    ds_read_b128 v[120:123], v13 offset:25600
    v_smfmac_f32_16x16x64_bf16 v[64:67], v[40:43], a[136:143], v2
    s_waitcnt lgkmcnt(6)
    v_smfmac_f32_16x16x64_bf16 v[56:59], v[44:47], v[124:131], v2
    ds_read_b128 v[124:127], v13 offset:26624
    ds_read_b128 v[128:131], v13 offset:27648
    v_smfmac_f32_16x16x64_bf16 v[60:63], v[44:47], a[144:151], v2
    s_waitcnt lgkmcnt(6)
    v_smfmac_f32_16x16x64_bf16 v[64:67], v[44:47], v[132:139], v2
    ds_read_b128 v[132:135], v13 offset:28672
    ds_read_b128 v[136:139], v13 offset:29696
    v_smfmac_f32_16x16x64_bf16 v[68:71], v[16:19], a[152:159], v2
    v_smfmac_f32_16x16x64_bf16 v[68:71], v[20:23], a[160:167], v2
    v_permlane32_swap_b32 v56, v58
    v_permlane32_swap_b32 v57, v59
    v_smfmac_f32_16x16x64_bf16 v[68:71], v[24:27], a[168:175], v2
    v_add_f32 v56, v56, v58
    v_add_f32 v57, v57, v59
    v_smfmac_f32_16x16x64_bf16 v[68:71], v[28:31], a[176:183], v2
    v_cvt_pk_bf16_f32 v56, v56, v57
    ds_write_b16 v3, v56 offset:0
    v_smfmac_f32_16x16x64_bf16 v[68:71], v[32:35], a[184:191], v2
    ds_write_b16_d16_hi v3, v56 offset:400
    v_permlane32_swap_b32 v60, v62
    v_smfmac_f32_16x16x64_bf16 v[68:71], v[36:39], a[192:199], v2
    v_permlane32_swap_b32 v61, v63
    v_add_f32 v60, v60, v62
    v_smfmac_f32_16x16x64_bf16 v[68:71], v[40:43], a[200:207], v2
    v_add_f32 v61, v61, v63
    v_cvt_pk_bf16_f32 v60, v60, v61
    v_smfmac_f32_16x16x64_bf16 v[68:71], v[44:47], a[208:215], v2
    ds_write_b16 v3, v60 offset:32
    ds_write_b16_d16_hi v3, v60 offset:432
    v_smfmac_f32_16x16x64_bf16 v[68:71], v[48:51], a[216:223], v2
    v_permlane32_swap_b32 v64, v66
    v_permlane32_swap_b32 v65, v67
    v_smfmac_f32_16x16x64_bf16 v[68:71], v[52:55], a[224:231], v2
    v_add_f32 v64, v64, v66
    v_add_f32 v65, v65, v67
    v_smfmac_f32_16x16x64_bf16 v[72:75], v[16:19], a[232:239], v2
    v_cvt_pk_bf16_f32 v64, v64, v65
    ds_write_b16 v3, v64 offset:64
    v_smfmac_f32_16x16x64_bf16 v[72:75], v[20:23], a[240:247], v2
    ds_write_b16_d16_hi v3, v64 offset:464
    v_smfmac_f32_16x16x64_bf16 v[72:75], v[24:27], a[248:255], v2
    v_smfmac_f32_16x16x64_bf16 v[72:75], v[28:31], v[148:155], v2
    s_waitcnt lgkmcnt(0)
    s_barrier
    ds_read_b128 v[88:91], v4 offset:0
    v_smfmac_f32_16x16x64_bf16 v[72:75], v[32:35], v[140:147], v2
    ds_read_b128 v[92:95], v4 offset:128
    ds_read_b128 v[96:99], v4 offset:256
    v_smfmac_f32_16x16x64_bf16 v[72:75], v[36:39], v[156:163], v2
    v_permlane32_swap_b32 v68, v70
    v_permlane32_swap_b32 v69, v71
    v_smfmac_f32_16x16x64_bf16 v[72:75], v[40:43], v[164:171], v2
    v_add_f32 v68, v68, v70
    v_add_f32 v69, v69, v71
    v_smfmac_f32_16x16x64_bf16 v[72:75], v[44:47], v[172:179], v2
    v_cvt_pk_bf16_f32 v68, v68, v69
    ds_write_b16 v3, v68 offset:3200
    v_smfmac_f32_16x16x64_bf16 v[72:75], v[48:51], v[116:123], v2
    ds_write_b16_d16_hi v3, v68 offset:3600
    v_smfmac_f32_16x16x64_bf16 v[72:75], v[52:55], v[180:187], v2
    s_waitcnt lgkmcnt(2)
    v_smfmac_f32_16x16x64_bf16 v[80:83], v[96:99], v[100:107], v2
    v_smfmac_f32_16x16x64_bf16 v[76:79], v[16:19], v[188:195], v2
    v_smfmac_f32_16x16x64_bf16 v[76:79], v[20:23], v[196:203], v2
    v_smfmac_f32_16x16x64_bf16 v[76:79], v[24:27], v[124:131], v2
    v_permlane32_swap_b32 v72, v74
    v_permlane32_swap_b32 v73, v75
    v_smfmac_f32_16x16x64_bf16 v[76:79], v[28:31], v[204:211], v2
    v_add_f32 v72, v72, v74
    v_add_f32 v73, v73, v75
    ds_write_b128 v15, v[80:83]
    v_smfmac_f32_16x16x64_bf16 v[76:79], v[32:35], v[212:219], v2
    v_cvt_pk_bf16_f32 v72, v72, v73
    ds_write_b16 v3, v72 offset:3232
    v_smfmac_f32_16x16x64_bf16 v[76:79], v[36:39], v[220:227], v2
    ds_write_b16_d16_hi v3, v72 offset:3632
    v_smfmac_f32_16x16x64_bf16 v[76:79], v[40:43], v[132:139], v2
    v_smfmac_f32_16x16x64_bf16 v[76:79], v[44:47], v[228:235], v2
    v_smfmac_f32_16x16x64_bf16 v[76:79], v[48:51], v[236:243], v2
    v_smfmac_f32_16x16x64_bf16 v[76:79], v[52:55], v[244:251], v2
    s_nop 7
    v_permlane32_swap_b32 v76, v78
    v_permlane32_swap_b32 v77, v79
    v_add_f32 v76, v76, v78
    v_add_f32 v77, v77, v79
    v_cvt_pk_bf16_f32 v76, v76, v77
    ds_write_b16 v3, v76 offset:3264
    ds_write_b16_d16_hi v3, v76 offset:3664
    s_waitcnt lgkmcnt(0)
    s_barrier
    ds_read2st64_b32 v[40:41], v6 offset0:0 offset1:2
    ds_read2st64_b32 v[42:43], v6 offset0:8 offset1:10
    ds_read_b128 v[16:19], v5 offset:0
    ds_read_b128 v[20:23], v5 offset:16
    ds_read_b128 v[24:27], v5 offset:128
    ds_read_b128 v[28:31], v5 offset:144
    ds_read_b128 v[32:35], v5 offset:256
    ds_read_b128 v[36:39], v5 offset:272
    s_waitcnt lgkmcnt(6)
    v_add_f32 v40, v40, v41
    v_add_f32 v42, v42, v43
    v_add_f32 v44, v40, v42
    v_mul_f32 v44, 0x3dd53b95, v44
    s_waitcnt lgkmcnt(4)
    v_smfmac_f32_16x16x64_bf16 v[84:87], v[88:91], v[16:23], v2
    s_waitcnt lgkmcnt(2)
    v_smfmac_f32_16x16x64_bf16 v[84:87], v[92:95], v[24:31], v2
    s_waitcnt lgkmcnt(0)
    v_smfmac_f32_16x16x64_bf16 v[84:87], v[96:99], v[32:39], v2
    v_max_f32_dpp v45, v44, v44 row_ror:8 row_mask:0xf bank_mask:0xf
    s_nop 1
    v_max_f32_dpp v45, v45, v45 row_ror:4 row_mask:0xf bank_mask:0xf
    s_nop 1
    v_max_f32_dpp v45, v45, v45 row_ror:2 row_mask:0xf bank_mask:0xf
    s_nop 1
    v_max_f32_dpp v45, v45, v45 row_ror:1 row_mask:0xf bank_mask:0xf
    v_mov_b32 v47, v45
    s_nop 1
    v_permlane32_swap_b32 v45, v47
    v_max_f32 v45, v45, v47
    v_mov_b32 v47, v87
    s_nop 1
    v_permlane32_swap_b32 v87, v47
    v_add_f32 v48, v87, v47
    v_mul_f32 v48, 0x3dd53b95, v48
    s_nop 1
    v_max_f32_dpp v46, v48, v48 row_ror:4 row_mask:0xf bank_mask:0xf
    s_nop 1
    v_max_f32_dpp v46, v46, v46 row_ror:2 row_mask:0xf bank_mask:0xf
    s_nop 1
    v_max_f32_dpp v46, v46, v46 row_ror:1 row_mask:0xf bank_mask:0xf
    v_max_f32 v45, v45, v46
    v_sub_f32 v49, v44, v45
    v_sub_f32 v50, v48, v45
    v_exp_f32 v49, v49
    v_exp_f32 v50, v50
    s_nop 0
    v_fma_f32 v51, v50, v12, v49
    s_nop 1
    v_add_f32_dpp v51, v51, v51 row_ror:8 row_mask:0xf bank_mask:0xf
    s_nop 1
    v_add_f32_dpp v51, v51, v51 row_ror:4 row_mask:0xf bank_mask:0xf
    s_nop 1
    v_add_f32_dpp v51, v51, v51 row_ror:2 row_mask:0xf bank_mask:0xf
    s_nop 1
    v_add_f32_dpp v51, v51, v51 row_ror:1 row_mask:0xf bank_mask:0xf
    v_mov_b32 v47, v51
    s_nop 1
    v_permlane32_swap_b32 v51, v47
    v_add_f32 v51, v51, v47
    v_rcp_f32 v51, v51
    s_nop 0
    v_mul_f32 v49, v49, v51
    v_mul_f32 v50, v50, v51
    s_nop 0
    v_mov_b32_dpp v46, v49 quad_perm:[1,0,3,2] row_mask:0xf bank_mask:0xf
    v_mov_b32_dpp v47, v50 quad_perm:[1,0,3,2] row_mask:0xf bank_mask:0xf
    v_cvt_pk_bf16_f32 v16, v49, v46
    v_cvt_pk_bf16_f32 v20, v50, v47
    s_nop 0
    v_mov_b32_dpp v17, v16 row_shl:2 row_mask:0xf bank_mask:0xf
    v_mov_b32_dpp v18, v16 row_shl:4 row_mask:0xf bank_mask:0xf
    v_mov_b32_dpp v19, v16 row_shl:6 row_mask:0xf bank_mask:0xf
    v_mov_b32_dpp v21, v20 row_shl:2 row_mask:0xf bank_mask:0xf
    v_mov_b32_dpp v22, v20 row_shl:4 row_mask:0xf bank_mask:0xf
    v_mov_b32_dpp v23, v20 row_shl:6 row_mask:0xf bank_mask:0xf
    s_mov_b64 exec, s[40:41]
    buffer_store_dwordx4 v[16:19], v7, s[8:11], s18 offen sc1
    s_mov_b64 exec, s[42:43]
    buffer_store_dwordx4 v[20:23], v8, s[8:11], s18 offen sc1
    s_mov_b64 exec, -1
    s_add_u32 s28, s14, 1
    s_min_u32 s28, s28, 63
    s_mul_i32 s20, s28, 393216
    s_add_u32 s20, s20, s44
    s_add_u32 s21, s20, 8192
    buffer_load_dwordx4 v[100:103], v9, s[8:11], s21 offen offset:0
    buffer_load_dwordx4 v[104:107], v9, s[8:11], s21 offen offset:512
    v_mov_b32 v56, 0
    v_mov_b32 v57, 0
    v_mov_b32 v58, 0
    v_mov_b32 v59, 0
    v_mov_b32 v60, 0
    v_mov_b32 v61, 0
    v_mov_b32 v62, 0
    v_mov_b32 v63, 0
    v_mov_b32 v64, 0
    v_mov_b32 v65, 0
    v_mov_b32 v66, 0
    v_mov_b32 v67, 0
    v_mov_b32 v68, 0
    v_mov_b32 v69, 0
    v_mov_b32 v70, 0
    v_mov_b32 v71, 0
    v_mov_b32 v72, 0
    v_mov_b32 v73, 0
    v_mov_b32 v74, 0
    v_mov_b32 v75, 0
    v_mov_b32 v76, 0
    v_mov_b32 v77, 0
    v_mov_b32 v78, 0
    v_mov_b32 v79, 0
    v_mov_b32 v80, 0
    v_mov_b32 v81, 0
    v_mov_b32 v82, 0
    v_mov_b32 v83, 0
    v_mov_b32 v84, 0
    v_mov_b32 v85, 0
    v_mov_b32 v86, 0
    v_mov_b32 v87, 0
    ds_read_b128 v[116:119], v13 offset:0
    ds_read_b128 v[120:123], v13 offset:1024
    ds_read_b128 v[124:127], v13 offset:2048
    ds_read_b128 v[128:131], v13 offset:3072
    ds_read_b128 v[132:135], v13 offset:4096
    ds_read_b128 v[136:139], v13 offset:5120
    ds_read_b128 v[140:143], v13 offset:6144
    ds_read_b128 v[144:147], v13 offset:7168
    s_waitcnt lgkmcnt(0)
    s_add_u32 s14, s14, 1
    s_cmp_lt_u32 s14, 64
    s_cbranch_scc1 chain1_kernel_p3_step
    s_branch chain1_kernel_end
chain1_kernel_y0_start:
    v_lshrrev_b32 v16, 4, v0
    v_and_b32 v17, 7, v0
    v_lshrrev_b32 v18, 3, v0
    v_and_b32 v18, 1, v18
    v_lshl_add_u32 v19, v18, 2, v16
    v_add_u32 v19, 0, v19
    v_mul_u32_u24 v20, 640, v19
    v_lshl_add_u32 v4, v17, 4, v20
    v_and_b32 v20, 3, v17
    v_lshlrev_b32 v20, 1, v20
    v_lshrrev_b32 v21, 2, v17
    v_add_u32 v20, v20, v21
    v_lshlrev_b32 v20, 4, v20
    v_lshl_add_u32 v5, v19, 7, v20
    v_add_u32 v3, 0, v1
    v_lshlrev_b32 v20, 8, v18
    v_lshl_add_u32 v20, v17, 5, v20
    v_and_b32 v21, 1, v16
    v_lshl_add_u32 v20, v21, 4, v20
    v_add_u32 v20, 10240, v20
    v_add_u32 v21, 12288, v1
    v_lshrrev_b32 v22, 1, v16
    v_cmp_eq_u32 vcc, v22, v18
    s_nop 1
    v_cndmask_b32 v6, v21, v20, vcc
    v_lshrrev_b32 v20, 3, v0
    v_lshlrev_b32 v20, 2, v20
    v_lshl_add_u32 v20, v17, 5, v20
    v_add_u32 v7, 10240, v20
    s_lshl_b32 s20, s12, 7
    s_add_u32 s20, s20, 20480
    s_lshr_b32 s21, s20, 13
    s_lshl_b32 s21, s21, 14
    s_and_b32 s20, s20, 8191
    s_add_u32 s20, s20, s21
    v_lshrrev_b32 v20, 3, v0
    v_lshlrev_b32 v20, 4, v20
    v_add_u32 v8, s20, v20
    s_mul_i32 s46, s12, 20480
    s_add_u32 s46, s46, 103809024
    s_mul_i32 s20, s12, 327680
    s_add_u32 s20, s20, 27262976
    s_add_u32 s21, s20, 0
    buffer_load_dwordx4 a[0:3], v1, s[8:11], s21 offen offset:0
    buffer_load_dwordx4 a[4:7], v1, s[8:11], s21 offen offset:1024
    s_add_u32 s21, s20, 2048
    buffer_load_dwordx4 a[8:11], v1, s[8:11], s21 offen offset:0
    buffer_load_dwordx4 a[12:15], v1, s[8:11], s21 offen offset:1024
    s_add_u32 s21, s20, 4096
    buffer_load_dwordx4 a[16:19], v1, s[8:11], s21 offen offset:0
    buffer_load_dwordx4 a[20:23], v1, s[8:11], s21 offen offset:1024
    s_add_u32 s21, s20, 6144
    buffer_load_dwordx4 a[24:27], v1, s[8:11], s21 offen offset:0
    buffer_load_dwordx4 a[28:31], v1, s[8:11], s21 offen offset:1024
    s_add_u32 s21, s20, 8192
    buffer_load_dwordx4 a[32:35], v1, s[8:11], s21 offen offset:0
    buffer_load_dwordx4 a[36:39], v1, s[8:11], s21 offen offset:1024
    s_add_u32 s21, s20, 10240
    buffer_load_dwordx4 a[40:43], v1, s[8:11], s21 offen offset:0
    buffer_load_dwordx4 a[44:47], v1, s[8:11], s21 offen offset:1024
    s_add_u32 s21, s20, 12288
    buffer_load_dwordx4 a[48:51], v1, s[8:11], s21 offen offset:0
    buffer_load_dwordx4 a[52:55], v1, s[8:11], s21 offen offset:1024
    s_add_u32 s21, s20, 14336
    buffer_load_dwordx4 a[56:59], v1, s[8:11], s21 offen offset:0
    buffer_load_dwordx4 a[60:63], v1, s[8:11], s21 offen offset:1024
    s_add_u32 s21, s20, 16384
    buffer_load_dwordx4 a[64:67], v1, s[8:11], s21 offen offset:0
    buffer_load_dwordx4 a[68:71], v1, s[8:11], s21 offen offset:1024
    s_add_u32 s21, s20, 18432
    buffer_load_dwordx4 a[72:75], v1, s[8:11], s21 offen offset:0
    buffer_load_dwordx4 a[76:79], v1, s[8:11], s21 offen offset:1024
    s_add_u32 s21, s20, 20480
    buffer_load_dwordx4 a[80:83], v1, s[8:11], s21 offen offset:0
    buffer_load_dwordx4 a[84:87], v1, s[8:11], s21 offen offset:1024
    s_add_u32 s21, s20, 22528
    buffer_load_dwordx4 a[88:91], v1, s[8:11], s21 offen offset:0
    buffer_load_dwordx4 a[92:95], v1, s[8:11], s21 offen offset:1024
    s_add_u32 s21, s20, 24576
    buffer_load_dwordx4 a[96:99], v1, s[8:11], s21 offen offset:0
    buffer_load_dwordx4 a[100:103], v1, s[8:11], s21 offen offset:1024
    s_add_u32 s21, s20, 26624
    buffer_load_dwordx4 a[104:107], v1, s[8:11], s21 offen offset:0
    buffer_load_dwordx4 a[108:111], v1, s[8:11], s21 offen offset:1024
    s_add_u32 s21, s20, 28672
    buffer_load_dwordx4 a[112:115], v1, s[8:11], s21 offen offset:0
    buffer_load_dwordx4 a[116:119], v1, s[8:11], s21 offen offset:1024
    s_add_u32 s21, s20, 30720
    buffer_load_dwordx4 a[120:123], v1, s[8:11], s21 offen offset:0
    buffer_load_dwordx4 a[124:127], v1, s[8:11], s21 offen offset:1024
    s_add_u32 s21, s20, 32768
    buffer_load_dwordx4 a[128:131], v1, s[8:11], s21 offen offset:0
    buffer_load_dwordx4 a[132:135], v1, s[8:11], s21 offen offset:1024
    s_add_u32 s21, s20, 34816
    buffer_load_dwordx4 a[136:139], v1, s[8:11], s21 offen offset:0
    buffer_load_dwordx4 a[140:143], v1, s[8:11], s21 offen offset:1024
    s_add_u32 s21, s20, 36864
    buffer_load_dwordx4 a[144:147], v1, s[8:11], s21 offen offset:0
    buffer_load_dwordx4 a[148:151], v1, s[8:11], s21 offen offset:1024
    s_add_u32 s21, s20, 38912
    buffer_load_dwordx4 a[152:155], v1, s[8:11], s21 offen offset:0
    buffer_load_dwordx4 a[156:159], v1, s[8:11], s21 offen offset:1024
    s_add_u32 s21, s20, 40960
    buffer_load_dwordx4 a[160:163], v1, s[8:11], s21 offen offset:0
    buffer_load_dwordx4 a[164:167], v1, s[8:11], s21 offen offset:1024
    s_add_u32 s21, s20, 43008
    buffer_load_dwordx4 a[168:171], v1, s[8:11], s21 offen offset:0
    buffer_load_dwordx4 a[172:175], v1, s[8:11], s21 offen offset:1024
    s_add_u32 s21, s20, 45056
    buffer_load_dwordx4 a[176:179], v1, s[8:11], s21 offen offset:0
    buffer_load_dwordx4 a[180:183], v1, s[8:11], s21 offen offset:1024
    s_add_u32 s21, s20, 47104
    buffer_load_dwordx4 a[184:187], v1, s[8:11], s21 offen offset:0
    buffer_load_dwordx4 a[188:191], v1, s[8:11], s21 offen offset:1024
    s_add_u32 s21, s20, 49152
    buffer_load_dwordx4 a[192:195], v1, s[8:11], s21 offen offset:0
    buffer_load_dwordx4 a[196:199], v1, s[8:11], s21 offen offset:1024
    s_add_u32 s21, s20, 51200
    buffer_load_dwordx4 a[200:203], v1, s[8:11], s21 offen offset:0
    buffer_load_dwordx4 a[204:207], v1, s[8:11], s21 offen offset:1024
    s_add_u32 s21, s20, 53248
    buffer_load_dwordx4 a[208:211], v1, s[8:11], s21 offen offset:0
    buffer_load_dwordx4 a[212:215], v1, s[8:11], s21 offen offset:1024
    s_add_u32 s21, s20, 55296
    buffer_load_dwordx4 a[216:219], v1, s[8:11], s21 offen offset:0
    buffer_load_dwordx4 a[220:223], v1, s[8:11], s21 offen offset:1024
    s_add_u32 s21, s20, 57344
    buffer_load_dwordx4 a[224:227], v1, s[8:11], s21 offen offset:0
    buffer_load_dwordx4 a[228:231], v1, s[8:11], s21 offen offset:1024
    s_add_u32 s21, s20, 59392
    buffer_load_dwordx4 a[232:235], v1, s[8:11], s21 offen offset:0
    buffer_load_dwordx4 a[236:239], v1, s[8:11], s21 offen offset:1024
    s_add_u32 s21, s20, 61440
    buffer_load_dwordx4 a[240:243], v1, s[8:11], s21 offen offset:0
    buffer_load_dwordx4 a[244:247], v1, s[8:11], s21 offen offset:1024
    s_add_u32 s21, s20, 63488
    buffer_load_dwordx4 a[248:251], v1, s[8:11], s21 offen offset:0
    buffer_load_dwordx4 a[252:255], v1, s[8:11], s21 offen offset:1024
    s_add_u32 s21, s20, 65536
    buffer_load_dwordx4 v[176:179], v1, s[8:11], s21 offen offset:0
    buffer_load_dwordx4 v[180:183], v1, s[8:11], s21 offen offset:1024
    s_add_u32 s21, s20, 67584
    buffer_load_dwordx4 v[184:187], v1, s[8:11], s21 offen offset:0
    buffer_load_dwordx4 v[188:191], v1, s[8:11], s21 offen offset:1024
    s_add_u32 s21, s20, 69632
    buffer_load_dwordx4 v[192:195], v1, s[8:11], s21 offen offset:0
    buffer_load_dwordx4 v[196:199], v1, s[8:11], s21 offen offset:1024
    s_add_u32 s21, s20, 71680
    buffer_load_dwordx4 v[200:203], v1, s[8:11], s21 offen offset:0
    buffer_load_dwordx4 v[204:207], v1, s[8:11], s21 offen offset:1024
    s_add_u32 s21, s20, 73728
    buffer_load_dwordx4 v[208:211], v1, s[8:11], s21 offen offset:0
    buffer_load_dwordx4 v[212:215], v1, s[8:11], s21 offen offset:1024
    s_add_u32 s21, s20, 75776
    buffer_load_dwordx4 v[216:219], v1, s[8:11], s21 offen offset:0
    buffer_load_dwordx4 v[220:223], v1, s[8:11], s21 offen offset:1024
    s_add_u32 s21, s20, 77824
    buffer_load_dwordx4 v[224:227], v1, s[8:11], s21 offen offset:0
    buffer_load_dwordx4 v[228:231], v1, s[8:11], s21 offen offset:1024
    s_add_u32 s21, s20, 79872
    buffer_load_dwordx4 v[232:235], v1, s[8:11], s21 offen offset:0
    buffer_load_dwordx4 v[236:239], v1, s[8:11], s21 offen offset:1024
    s_mov_b32 s14, 0
chain1_kernel_y0_step:
    s_cmp_lt_u32 s14, 32
    s_cselect_b32 s18, s16, s17
    s_and_b32 s20, s14, 31
    s_lshl_b32 s20, s20, 16
    s_add_u32 s18, s18, s20
    s_mul_i32 s28, s14, 1638400
    s_add_u32 s28, s28, s46
    buffer_load_dwordx4 v[76:79], v4, s[8:11], s28 offen offset:128
    buffer_load_dwordx4 v[80:83], v4, s[8:11], s28 offen offset:256
    buffer_load_dwordx4 v[84:87], v4, s[8:11], s28 offen offset:384
    buffer_load_dwordx4 v[88:91], v4, s[8:11], s28 offen offset:512
    v_mov_b32 v56, 0
    v_mov_b32 v57, 0
    v_mov_b32 v58, 0
    v_mov_b32 v59, 0
    v_mov_b32 v60, 0
    v_mov_b32 v61, 0
    v_mov_b32 v62, 0
    v_mov_b32 v63, 0
    v_mov_b32 v64, 0
    v_mov_b32 v65, 0
    v_mov_b32 v66, 0
    v_mov_b32 v67, 0
    v_mov_b32 v68, 0
    v_mov_b32 v69, 0
    v_mov_b32 v70, 0
    v_mov_b32 v71, 0
    s_add_u32 s22, s18, 36864
    s_add_u32 s23, s18, 37888
    s_add_u32 s24, s18, 38912
chain1_kernel_y0_poll:
    buffer_load_dwordx4 v[16:19], v1, s[8:11], s22 offen sc1
    buffer_load_dwordx4 v[20:23], v1, s[8:11], s23 offen sc1
    buffer_load_dwordx4 v[24:27], v1, s[8:11], s24 offen sc1
    s_waitcnt vmcnt(0)
    ds_write_b128 v3, v[16:19] offset:0
    ds_write_b128 v3, v[20:23] offset:1024
    ds_write_b128 v3, v[24:27] offset:2048
    v_max3_u32 v116, v16, v17, v18
    v_max3_u32 v116, v116, v19, v20
    v_max3_u32 v116, v116, v21, v22
    v_max3_u32 v116, v116, v23, v24
    v_max3_u32 v116, v116, v25, v26
    v_max_u32 v116, v116, v27
    v_cmp_eq_u32 vcc, -1, v116
    s_sub_u32 s15, s15, 1
    s_cbranch_scc1 chain1_kernel_bail
    s_cbranch_vccnz chain1_kernel_y0_poll
    s_waitcnt lgkmcnt(0)
    s_barrier
    ds_read_b128 v[28:31], v3 offset:3072
    ds_read_b128 v[32:35], v3 offset:4096
    ds_read_b128 v[36:39], v3 offset:5120
    ds_read_b128 v[40:43], v3 offset:6144
    ds_read_b128 v[44:47], v3 offset:7168
    ds_read_b128 v[48:51], v3 offset:8192
    ds_read_b128 v[52:55], v3 offset:9216
    v_smfmac_f32_16x16x64_bf16 v[56:59], v[16:19], a[0:7], v2
    v_smfmac_f32_16x16x64_bf16 v[60:63], v[16:19], a[80:87], v2
    v_smfmac_f32_16x16x64_bf16 v[64:67], v[16:19], a[160:167], v2
    v_smfmac_f32_16x16x64_bf16 v[68:71], v[16:19], a[240:247], v2
    v_smfmac_f32_16x16x64_bf16 v[56:59], v[20:23], a[8:15], v2
    v_smfmac_f32_16x16x64_bf16 v[60:63], v[20:23], a[88:95], v2
    v_smfmac_f32_16x16x64_bf16 v[64:67], v[20:23], a[168:175], v2
    v_smfmac_f32_16x16x64_bf16 v[68:71], v[20:23], a[248:255], v2
    v_smfmac_f32_16x16x64_bf16 v[56:59], v[24:27], a[16:23], v2
    v_smfmac_f32_16x16x64_bf16 v[60:63], v[24:27], a[96:103], v2
    v_smfmac_f32_16x16x64_bf16 v[64:67], v[24:27], a[176:183], v2
    v_smfmac_f32_16x16x64_bf16 v[68:71], v[24:27], v[176:183], v2
    s_waitcnt lgkmcnt(6)
    v_smfmac_f32_16x16x64_bf16 v[56:59], v[28:31], a[24:31], v2
    v_smfmac_f32_16x16x64_bf16 v[60:63], v[28:31], a[104:111], v2
    v_smfmac_f32_16x16x64_bf16 v[64:67], v[28:31], a[184:191], v2
    v_smfmac_f32_16x16x64_bf16 v[68:71], v[28:31], v[184:191], v2
    s_waitcnt lgkmcnt(5)
    v_smfmac_f32_16x16x64_bf16 v[56:59], v[32:35], a[32:39], v2
    v_smfmac_f32_16x16x64_bf16 v[60:63], v[32:35], a[112:119], v2
    v_smfmac_f32_16x16x64_bf16 v[64:67], v[32:35], a[192:199], v2
    v_smfmac_f32_16x16x64_bf16 v[68:71], v[32:35], v[192:199], v2
    s_waitcnt lgkmcnt(4)
    v_smfmac_f32_16x16x64_bf16 v[56:59], v[36:39], a[40:47], v2
    v_smfmac_f32_16x16x64_bf16 v[60:63], v[36:39], a[120:127], v2
    v_smfmac_f32_16x16x64_bf16 v[64:67], v[36:39], a[200:207], v2
    v_smfmac_f32_16x16x64_bf16 v[68:71], v[36:39], v[200:207], v2
    s_waitcnt lgkmcnt(3)
    v_smfmac_f32_16x16x64_bf16 v[56:59], v[40:43], a[48:55], v2
    v_smfmac_f32_16x16x64_bf16 v[60:63], v[40:43], a[128:135], v2
    v_smfmac_f32_16x16x64_bf16 v[64:67], v[40:43], a[208:215], v2
    v_smfmac_f32_16x16x64_bf16 v[68:71], v[40:43], v[208:215], v2
    s_waitcnt lgkmcnt(2)
    v_smfmac_f32_16x16x64_bf16 v[56:59], v[44:47], a[56:63], v2
    v_smfmac_f32_16x16x64_bf16 v[60:63], v[44:47], a[136:143], v2
    v_smfmac_f32_16x16x64_bf16 v[64:67], v[44:47], a[216:223], v2
    v_smfmac_f32_16x16x64_bf16 v[68:71], v[44:47], v[216:223], v2
    s_waitcnt lgkmcnt(1)
    v_smfmac_f32_16x16x64_bf16 v[56:59], v[48:51], a[64:71], v2
    v_smfmac_f32_16x16x64_bf16 v[60:63], v[48:51], a[144:151], v2
    v_smfmac_f32_16x16x64_bf16 v[64:67], v[48:51], a[224:231], v2
    v_smfmac_f32_16x16x64_bf16 v[68:71], v[48:51], v[224:231], v2
    s_waitcnt lgkmcnt(0)
    v_smfmac_f32_16x16x64_bf16 v[56:59], v[52:55], a[72:79], v2
    v_smfmac_f32_16x16x64_bf16 v[60:63], v[52:55], a[152:159], v2
    v_smfmac_f32_16x16x64_bf16 v[64:67], v[52:55], a[232:239], v2
    v_smfmac_f32_16x16x64_bf16 v[68:71], v[52:55], v[232:239], v2
    s_nop 7
    v_permlane32_swap_b32 v56, v64
    v_permlane32_swap_b32 v60, v68
    v_permlane32_swap_b32 v57, v65
    v_permlane32_swap_b32 v61, v69
    v_permlane32_swap_b32 v58, v66
    v_permlane32_swap_b32 v62, v70
    v_permlane32_swap_b32 v59, v67
    v_permlane32_swap_b32 v63, v71
    v_add_f32 v56, v56, v64
    v_add_f32 v60, v60, v68
    v_add_f32 v57, v57, v65
    v_add_f32 v61, v61, v69
    v_add_f32 v58, v58, v66
    v_add_f32 v62, v62, v70
    v_add_f32 v59, v59, v67
    v_add_f32 v63, v63, v71
    s_nop 1
    v_permlane16_swap_b32 v56, v60
    v_permlane16_swap_b32 v57, v61
    v_permlane16_swap_b32 v58, v62
    v_permlane16_swap_b32 v59, v63
    s_nop 1
    v_cvt_pk_bf16_f32 v72, v56, v57
    v_cvt_pk_bf16_f32 v73, v58, v59
    v_cvt_pk_bf16_f32 v74, v60, v61
    v_cvt_pk_bf16_f32 v75, v62, v63
    buffer_store_dwordx4 v[72:75], v4, s[8:11], s28 offen
    s_cmp_eq_u32 s14, 63
    s_cbranch_scc1 chain1_kernel_end
    s_add_u32 s30, s18, 0
    s_add_u32 s31, s18, 4096
    s_add_u32 s32, s18, 16384
    s_add_u32 s33, s18, 20480
    s_add_u32 s34, s18, 32768
    s_add_u32 s29, s14, 1
    s_cmp_lt_u32 s29, 32
    s_cselect_b32 s19, s16, s17
    s_and_b32 s20, s29, 31
    s_lshl_b32 s20, s20, 16
    s_add_u32 s19, s19, s20
chain1_kernel_y0_ppoll:
    buffer_load_dwordx4 v[92:95], v5, s[8:11], s30 offen sc1
    buffer_load_dwordx4 v[96:99], v5, s[8:11], s31 offen sc1
    buffer_load_dwordx4 v[100:103], v5, s[8:11], s32 offen sc1
    buffer_load_dwordx4 v[104:107], v5, s[8:11], s33 offen sc1
    buffer_load_dwordx4 v[108:111], v5, s[8:11], s34 offen sc1
    s_waitcnt vmcnt(0)
    v_mfma_f32_16x16x32_bf16 v[112:115], v[92:95], v[72:75], 0
    v_mfma_f32_16x16x32_bf16 v[112:115], v[96:99], v[76:79], v[112:115]
    v_mfma_f32_16x16x32_bf16 v[112:115], v[100:103], v[80:83], v[112:115]
    v_mfma_f32_16x16x32_bf16 v[112:115], v[104:107], v[84:87], v[112:115]
    v_mfma_f32_16x16x32_bf16 v[112:115], v[108:111], v[88:91], v[112:115]
    v_max3_u32 v116, v92, v93, v94
    v_max3_u32 v116, v116, v95, v96
    v_max3_u32 v116, v116, v97, v98
    v_max3_u32 v116, v116, v99, v100
    v_max3_u32 v116, v116, v101, v102
    v_max3_u32 v116, v116, v103, v104
    v_max3_u32 v116, v116, v105, v106
    v_max3_u32 v116, v116, v107, v108
    v_max3_u32 v116, v116, v109, v110
    v_max_u32 v116, v116, v111
    v_cmp_eq_u32 vcc, -1, v116
    s_sub_u32 s15, s15, 1
    s_cbranch_scc1 chain1_kernel_bail
    s_cbranch_vccnz chain1_kernel_y0_ppoll
    ds_write_b128 v6, v[112:115]
    s_waitcnt lgkmcnt(0)
    s_barrier
    ds_read2st64_b32 v[116:117], v7 offset0:0 offset1:1
    ds_read2st64_b32 v[118:119], v7 offset0:2 offset1:3
    ds_read2st64_b32 v[120:121], v7 offset0:4 offset1:5
    ds_read2st64_b32 v[122:123], v7 offset0:6 offset1:7
    s_waitcnt lgkmcnt(2)
    v_add_f32 v116, v116, v117
    v_add_f32 v118, v118, v119
    s_waitcnt lgkmcnt(0)
    v_add_f32 v120, v120, v121
    v_add_f32 v122, v122, v123
    v_add_f32 v116, v116, v118
    v_add_f32 v120, v120, v122
    v_add_f32 v116, v116, v120
    s_nop 1
    v_mov_b32_dpp v117, v116 quad_perm:[1,0,3,2] row_mask:0xf bank_mask:0xf
    v_cvt_pk_bf16_f32 v124, v116, v117
    s_nop 1
    v_mov_b32_dpp v125, v124 row_shl:2 row_mask:0xf bank_mask:0xf
    v_mov_b32_dpp v126, v124 row_shl:4 row_mask:0xf bank_mask:0xf
    v_mov_b32_dpp v127, v124 row_shl:6 row_mask:0xf bank_mask:0xf
    s_mov_b64 exec, s[40:41]
    buffer_store_dwordx4 v[124:127], v8, s[8:11], s19 offen sc1
    s_mov_b64 exec, -1
    s_add_u32 s14, s14, 1
    s_branch chain1_kernel_y0_step
chain1_kernel_y1_start:
    v_lshrrev_b32 v16, 4, v0
    v_and_b32 v17, 7, v0
    v_lshrrev_b32 v18, 3, v0
    v_and_b32 v18, 1, v18
    v_lshl_add_u32 v19, v18, 2, v16
    v_add_u32 v19, 8, v19
    v_mul_u32_u24 v20, 640, v19
    v_lshl_add_u32 v4, v17, 4, v20
    v_and_b32 v20, 3, v17
    v_lshlrev_b32 v20, 1, v20
    v_lshrrev_b32 v21, 2, v17
    v_add_u32 v20, v20, v21
    v_lshlrev_b32 v20, 4, v20
    v_lshl_add_u32 v5, v19, 7, v20
    v_add_u32 v3, 0, v1
    v_lshlrev_b32 v20, 8, v18
    v_lshl_add_u32 v20, v17, 5, v20
    v_and_b32 v21, 1, v16
    v_lshl_add_u32 v20, v21, 4, v20
    v_add_u32 v20, 10752, v20
    v_add_u32 v21, 12288, v1
    v_lshrrev_b32 v22, 1, v16
    v_cmp_eq_u32 vcc, v22, v18
    s_nop 1
    v_cndmask_b32 v6, v21, v20, vcc
    v_lshrrev_b32 v20, 3, v0
    v_lshlrev_b32 v20, 2, v20
    v_lshl_add_u32 v20, v17, 5, v20
    v_add_u32 v7, 10240, v20
    s_lshl_b32 s20, s12, 7
    s_add_u32 s20, s20, 20480
    s_lshr_b32 s21, s20, 13
    s_lshl_b32 s21, s21, 14
    s_and_b32 s20, s20, 8191
    s_add_u32 s20, s20, s21
    v_lshrrev_b32 v20, 3, v0
    v_lshlrev_b32 v20, 4, v20
    v_add_u32 v8, s20, v20
    s_mul_i32 s46, s12, 20480
    s_add_u32 s46, s46, 103809024
    s_mul_i32 s20, s12, 327680
    s_add_u32 s20, s20, 27344896
    s_add_u32 s21, s20, 0
    buffer_load_dwordx4 a[0:3], v1, s[8:11], s21 offen offset:0
    buffer_load_dwordx4 a[4:7], v1, s[8:11], s21 offen offset:1024
    s_add_u32 s21, s20, 2048
    buffer_load_dwordx4 a[8:11], v1, s[8:11], s21 offen offset:0
    buffer_load_dwordx4 a[12:15], v1, s[8:11], s21 offen offset:1024
    s_add_u32 s21, s20, 4096
    buffer_load_dwordx4 a[16:19], v1, s[8:11], s21 offen offset:0
    buffer_load_dwordx4 a[20:23], v1, s[8:11], s21 offen offset:1024
    s_add_u32 s21, s20, 6144
    buffer_load_dwordx4 a[24:27], v1, s[8:11], s21 offen offset:0
    buffer_load_dwordx4 a[28:31], v1, s[8:11], s21 offen offset:1024
    s_add_u32 s21, s20, 8192
    buffer_load_dwordx4 a[32:35], v1, s[8:11], s21 offen offset:0
    buffer_load_dwordx4 a[36:39], v1, s[8:11], s21 offen offset:1024
    s_add_u32 s21, s20, 10240
    buffer_load_dwordx4 a[40:43], v1, s[8:11], s21 offen offset:0
    buffer_load_dwordx4 a[44:47], v1, s[8:11], s21 offen offset:1024
    s_add_u32 s21, s20, 12288
    buffer_load_dwordx4 a[48:51], v1, s[8:11], s21 offen offset:0
    buffer_load_dwordx4 a[52:55], v1, s[8:11], s21 offen offset:1024
    s_add_u32 s21, s20, 14336
    buffer_load_dwordx4 a[56:59], v1, s[8:11], s21 offen offset:0
    buffer_load_dwordx4 a[60:63], v1, s[8:11], s21 offen offset:1024
    s_add_u32 s21, s20, 16384
    buffer_load_dwordx4 a[64:67], v1, s[8:11], s21 offen offset:0
    buffer_load_dwordx4 a[68:71], v1, s[8:11], s21 offen offset:1024
    s_add_u32 s21, s20, 18432
    buffer_load_dwordx4 a[72:75], v1, s[8:11], s21 offen offset:0
    buffer_load_dwordx4 a[76:79], v1, s[8:11], s21 offen offset:1024
    s_add_u32 s21, s20, 20480
    buffer_load_dwordx4 a[80:83], v1, s[8:11], s21 offen offset:0
    buffer_load_dwordx4 a[84:87], v1, s[8:11], s21 offen offset:1024
    s_add_u32 s21, s20, 22528
    buffer_load_dwordx4 a[88:91], v1, s[8:11], s21 offen offset:0
    buffer_load_dwordx4 a[92:95], v1, s[8:11], s21 offen offset:1024
    s_add_u32 s21, s20, 24576
    buffer_load_dwordx4 a[96:99], v1, s[8:11], s21 offen offset:0
    buffer_load_dwordx4 a[100:103], v1, s[8:11], s21 offen offset:1024
    s_add_u32 s21, s20, 26624
    buffer_load_dwordx4 a[104:107], v1, s[8:11], s21 offen offset:0
    buffer_load_dwordx4 a[108:111], v1, s[8:11], s21 offen offset:1024
    s_add_u32 s21, s20, 28672
    buffer_load_dwordx4 a[112:115], v1, s[8:11], s21 offen offset:0
    buffer_load_dwordx4 a[116:119], v1, s[8:11], s21 offen offset:1024
    s_add_u32 s21, s20, 30720
    buffer_load_dwordx4 a[120:123], v1, s[8:11], s21 offen offset:0
    buffer_load_dwordx4 a[124:127], v1, s[8:11], s21 offen offset:1024
    s_add_u32 s21, s20, 32768
    buffer_load_dwordx4 a[128:131], v1, s[8:11], s21 offen offset:0
    buffer_load_dwordx4 a[132:135], v1, s[8:11], s21 offen offset:1024
    s_add_u32 s21, s20, 34816
    buffer_load_dwordx4 a[136:139], v1, s[8:11], s21 offen offset:0
    buffer_load_dwordx4 a[140:143], v1, s[8:11], s21 offen offset:1024
    s_add_u32 s21, s20, 36864
    buffer_load_dwordx4 a[144:147], v1, s[8:11], s21 offen offset:0
    buffer_load_dwordx4 a[148:151], v1, s[8:11], s21 offen offset:1024
    s_add_u32 s21, s20, 38912
    buffer_load_dwordx4 a[152:155], v1, s[8:11], s21 offen offset:0
    buffer_load_dwordx4 a[156:159], v1, s[8:11], s21 offen offset:1024
    s_add_u32 s21, s20, 40960
    buffer_load_dwordx4 a[160:163], v1, s[8:11], s21 offen offset:0
    buffer_load_dwordx4 a[164:167], v1, s[8:11], s21 offen offset:1024
    s_add_u32 s21, s20, 43008
    buffer_load_dwordx4 a[168:171], v1, s[8:11], s21 offen offset:0
    buffer_load_dwordx4 a[172:175], v1, s[8:11], s21 offen offset:1024
    s_add_u32 s21, s20, 45056
    buffer_load_dwordx4 a[176:179], v1, s[8:11], s21 offen offset:0
    buffer_load_dwordx4 a[180:183], v1, s[8:11], s21 offen offset:1024
    s_add_u32 s21, s20, 47104
    buffer_load_dwordx4 a[184:187], v1, s[8:11], s21 offen offset:0
    buffer_load_dwordx4 a[188:191], v1, s[8:11], s21 offen offset:1024
    s_add_u32 s21, s20, 49152
    buffer_load_dwordx4 a[192:195], v1, s[8:11], s21 offen offset:0
    buffer_load_dwordx4 a[196:199], v1, s[8:11], s21 offen offset:1024
    s_add_u32 s21, s20, 51200
    buffer_load_dwordx4 a[200:203], v1, s[8:11], s21 offen offset:0
    buffer_load_dwordx4 a[204:207], v1, s[8:11], s21 offen offset:1024
    s_add_u32 s21, s20, 53248
    buffer_load_dwordx4 a[208:211], v1, s[8:11], s21 offen offset:0
    buffer_load_dwordx4 a[212:215], v1, s[8:11], s21 offen offset:1024
    s_add_u32 s21, s20, 55296
    buffer_load_dwordx4 a[216:219], v1, s[8:11], s21 offen offset:0
    buffer_load_dwordx4 a[220:223], v1, s[8:11], s21 offen offset:1024
    s_add_u32 s21, s20, 57344
    buffer_load_dwordx4 a[224:227], v1, s[8:11], s21 offen offset:0
    buffer_load_dwordx4 a[228:231], v1, s[8:11], s21 offen offset:1024
    s_add_u32 s21, s20, 59392
    buffer_load_dwordx4 a[232:235], v1, s[8:11], s21 offen offset:0
    buffer_load_dwordx4 a[236:239], v1, s[8:11], s21 offen offset:1024
    s_add_u32 s21, s20, 61440
    buffer_load_dwordx4 a[240:243], v1, s[8:11], s21 offen offset:0
    buffer_load_dwordx4 a[244:247], v1, s[8:11], s21 offen offset:1024
    s_add_u32 s21, s20, 63488
    buffer_load_dwordx4 a[248:251], v1, s[8:11], s21 offen offset:0
    buffer_load_dwordx4 a[252:255], v1, s[8:11], s21 offen offset:1024
    s_add_u32 s21, s20, 65536
    buffer_load_dwordx4 v[176:179], v1, s[8:11], s21 offen offset:0
    buffer_load_dwordx4 v[180:183], v1, s[8:11], s21 offen offset:1024
    s_add_u32 s21, s20, 67584
    buffer_load_dwordx4 v[184:187], v1, s[8:11], s21 offen offset:0
    buffer_load_dwordx4 v[188:191], v1, s[8:11], s21 offen offset:1024
    s_add_u32 s21, s20, 69632
    buffer_load_dwordx4 v[192:195], v1, s[8:11], s21 offen offset:0
    buffer_load_dwordx4 v[196:199], v1, s[8:11], s21 offen offset:1024
    s_add_u32 s21, s20, 71680
    buffer_load_dwordx4 v[200:203], v1, s[8:11], s21 offen offset:0
    buffer_load_dwordx4 v[204:207], v1, s[8:11], s21 offen offset:1024
    s_add_u32 s21, s20, 73728
    buffer_load_dwordx4 v[208:211], v1, s[8:11], s21 offen offset:0
    buffer_load_dwordx4 v[212:215], v1, s[8:11], s21 offen offset:1024
    s_add_u32 s21, s20, 75776
    buffer_load_dwordx4 v[216:219], v1, s[8:11], s21 offen offset:0
    buffer_load_dwordx4 v[220:223], v1, s[8:11], s21 offen offset:1024
    s_add_u32 s21, s20, 77824
    buffer_load_dwordx4 v[224:227], v1, s[8:11], s21 offen offset:0
    buffer_load_dwordx4 v[228:231], v1, s[8:11], s21 offen offset:1024
    s_add_u32 s21, s20, 79872
    buffer_load_dwordx4 v[232:235], v1, s[8:11], s21 offen offset:0
    buffer_load_dwordx4 v[236:239], v1, s[8:11], s21 offen offset:1024
    s_mov_b32 s14, 0
chain1_kernel_y1_step:
    s_cmp_lt_u32 s14, 32
    s_cselect_b32 s18, s16, s17
    s_and_b32 s20, s14, 31
    s_lshl_b32 s20, s20, 16
    s_add_u32 s18, s18, s20
    s_mul_i32 s28, s14, 1638400
    s_add_u32 s28, s28, s46
    buffer_load_dwordx4 v[76:79], v4, s[8:11], s28 offen offset:128
    buffer_load_dwordx4 v[80:83], v4, s[8:11], s28 offen offset:256
    buffer_load_dwordx4 v[84:87], v4, s[8:11], s28 offen offset:384
    buffer_load_dwordx4 v[88:91], v4, s[8:11], s28 offen offset:512
    v_mov_b32 v56, 0
    v_mov_b32 v57, 0
    v_mov_b32 v58, 0
    v_mov_b32 v59, 0
    v_mov_b32 v60, 0
    v_mov_b32 v61, 0
    v_mov_b32 v62, 0
    v_mov_b32 v63, 0
    v_mov_b32 v64, 0
    v_mov_b32 v65, 0
    v_mov_b32 v66, 0
    v_mov_b32 v67, 0
    v_mov_b32 v68, 0
    v_mov_b32 v69, 0
    v_mov_b32 v70, 0
    v_mov_b32 v71, 0
    s_add_u32 s22, s18, 39936
    s_add_u32 s23, s18, 49152
    s_add_u32 s24, s18, 50176
chain1_kernel_y1_poll:
    buffer_load_dwordx4 v[28:31], v1, s[8:11], s22 offen sc1
    buffer_load_dwordx4 v[32:35], v1, s[8:11], s23 offen sc1
    buffer_load_dwordx4 v[36:39], v1, s[8:11], s24 offen sc1
    s_waitcnt vmcnt(0)
    ds_write_b128 v3, v[28:31] offset:3072
    ds_write_b128 v3, v[32:35] offset:4096
    ds_write_b128 v3, v[36:39] offset:5120
    v_max3_u32 v116, v28, v29, v30
    v_max3_u32 v116, v116, v31, v32
    v_max3_u32 v116, v116, v33, v34
    v_max3_u32 v116, v116, v35, v36
    v_max3_u32 v116, v116, v37, v38
    v_max_u32 v116, v116, v39
    v_cmp_eq_u32 vcc, -1, v116
    s_sub_u32 s15, s15, 1
    s_cbranch_scc1 chain1_kernel_bail
    s_cbranch_vccnz chain1_kernel_y1_poll
    s_waitcnt lgkmcnt(0)
    s_barrier
    ds_read_b128 v[16:19], v3 offset:0
    ds_read_b128 v[20:23], v3 offset:1024
    ds_read_b128 v[24:27], v3 offset:2048
    ds_read_b128 v[40:43], v3 offset:6144
    ds_read_b128 v[44:47], v3 offset:7168
    ds_read_b128 v[48:51], v3 offset:8192
    ds_read_b128 v[52:55], v3 offset:9216
    v_smfmac_f32_16x16x64_bf16 v[56:59], v[28:31], a[24:31], v2
    v_smfmac_f32_16x16x64_bf16 v[60:63], v[28:31], a[104:111], v2
    v_smfmac_f32_16x16x64_bf16 v[64:67], v[28:31], a[184:191], v2
    v_smfmac_f32_16x16x64_bf16 v[68:71], v[28:31], v[184:191], v2
    v_smfmac_f32_16x16x64_bf16 v[56:59], v[32:35], a[32:39], v2
    v_smfmac_f32_16x16x64_bf16 v[60:63], v[32:35], a[112:119], v2
    v_smfmac_f32_16x16x64_bf16 v[64:67], v[32:35], a[192:199], v2
    v_smfmac_f32_16x16x64_bf16 v[68:71], v[32:35], v[192:199], v2
    v_smfmac_f32_16x16x64_bf16 v[56:59], v[36:39], a[40:47], v2
    v_smfmac_f32_16x16x64_bf16 v[60:63], v[36:39], a[120:127], v2
    v_smfmac_f32_16x16x64_bf16 v[64:67], v[36:39], a[200:207], v2
    v_smfmac_f32_16x16x64_bf16 v[68:71], v[36:39], v[200:207], v2
    s_waitcnt lgkmcnt(6)
    v_smfmac_f32_16x16x64_bf16 v[56:59], v[16:19], a[0:7], v2
    v_smfmac_f32_16x16x64_bf16 v[60:63], v[16:19], a[80:87], v2
    v_smfmac_f32_16x16x64_bf16 v[64:67], v[16:19], a[160:167], v2
    v_smfmac_f32_16x16x64_bf16 v[68:71], v[16:19], a[240:247], v2
    s_waitcnt lgkmcnt(5)
    v_smfmac_f32_16x16x64_bf16 v[56:59], v[20:23], a[8:15], v2
    v_smfmac_f32_16x16x64_bf16 v[60:63], v[20:23], a[88:95], v2
    v_smfmac_f32_16x16x64_bf16 v[64:67], v[20:23], a[168:175], v2
    v_smfmac_f32_16x16x64_bf16 v[68:71], v[20:23], a[248:255], v2
    s_waitcnt lgkmcnt(4)
    v_smfmac_f32_16x16x64_bf16 v[56:59], v[24:27], a[16:23], v2
    v_smfmac_f32_16x16x64_bf16 v[60:63], v[24:27], a[96:103], v2
    v_smfmac_f32_16x16x64_bf16 v[64:67], v[24:27], a[176:183], v2
    v_smfmac_f32_16x16x64_bf16 v[68:71], v[24:27], v[176:183], v2
    s_waitcnt lgkmcnt(3)
    v_smfmac_f32_16x16x64_bf16 v[56:59], v[40:43], a[48:55], v2
    v_smfmac_f32_16x16x64_bf16 v[60:63], v[40:43], a[128:135], v2
    v_smfmac_f32_16x16x64_bf16 v[64:67], v[40:43], a[208:215], v2
    v_smfmac_f32_16x16x64_bf16 v[68:71], v[40:43], v[208:215], v2
    s_waitcnt lgkmcnt(2)
    v_smfmac_f32_16x16x64_bf16 v[56:59], v[44:47], a[56:63], v2
    v_smfmac_f32_16x16x64_bf16 v[60:63], v[44:47], a[136:143], v2
    v_smfmac_f32_16x16x64_bf16 v[64:67], v[44:47], a[216:223], v2
    v_smfmac_f32_16x16x64_bf16 v[68:71], v[44:47], v[216:223], v2
    s_waitcnt lgkmcnt(1)
    v_smfmac_f32_16x16x64_bf16 v[56:59], v[48:51], a[64:71], v2
    v_smfmac_f32_16x16x64_bf16 v[60:63], v[48:51], a[144:151], v2
    v_smfmac_f32_16x16x64_bf16 v[64:67], v[48:51], a[224:231], v2
    v_smfmac_f32_16x16x64_bf16 v[68:71], v[48:51], v[224:231], v2
    s_waitcnt lgkmcnt(0)
    v_smfmac_f32_16x16x64_bf16 v[56:59], v[52:55], a[72:79], v2
    v_smfmac_f32_16x16x64_bf16 v[60:63], v[52:55], a[152:159], v2
    v_smfmac_f32_16x16x64_bf16 v[64:67], v[52:55], a[232:239], v2
    v_smfmac_f32_16x16x64_bf16 v[68:71], v[52:55], v[232:239], v2
    s_nop 7
    v_permlane32_swap_b32 v56, v64
    v_permlane32_swap_b32 v60, v68
    v_permlane32_swap_b32 v57, v65
    v_permlane32_swap_b32 v61, v69
    v_permlane32_swap_b32 v58, v66
    v_permlane32_swap_b32 v62, v70
    v_permlane32_swap_b32 v59, v67
    v_permlane32_swap_b32 v63, v71
    v_add_f32 v56, v56, v64
    v_add_f32 v60, v60, v68
    v_add_f32 v57, v57, v65
    v_add_f32 v61, v61, v69
    v_add_f32 v58, v58, v66
    v_add_f32 v62, v62, v70
    v_add_f32 v59, v59, v67
    v_add_f32 v63, v63, v71
    s_nop 1
    v_permlane16_swap_b32 v56, v60
    v_permlane16_swap_b32 v57, v61
    v_permlane16_swap_b32 v58, v62
    v_permlane16_swap_b32 v59, v63
    s_nop 1
    v_cvt_pk_bf16_f32 v72, v56, v57
    v_cvt_pk_bf16_f32 v73, v58, v59
    v_cvt_pk_bf16_f32 v74, v60, v61
    v_cvt_pk_bf16_f32 v75, v62, v63
    buffer_store_dwordx4 v[72:75], v4, s[8:11], s28 offen
    s_cmp_eq_u32 s14, 63
    s_cbranch_scc1 chain1_kernel_end
    s_add_u32 s30, s18, 0
    s_add_u32 s31, s18, 4096
    s_add_u32 s32, s18, 16384
    s_add_u32 s33, s18, 20480
    s_add_u32 s34, s18, 32768
    s_add_u32 s29, s14, 1
    s_cmp_lt_u32 s29, 32
    s_cselect_b32 s19, s16, s17
    s_and_b32 s20, s29, 31
    s_lshl_b32 s20, s20, 16
    s_add_u32 s19, s19, s20
chain1_kernel_y1_ppoll:
    buffer_load_dwordx4 v[92:95], v5, s[8:11], s30 offen sc1
    buffer_load_dwordx4 v[96:99], v5, s[8:11], s31 offen sc1
    buffer_load_dwordx4 v[100:103], v5, s[8:11], s32 offen sc1
    buffer_load_dwordx4 v[104:107], v5, s[8:11], s33 offen sc1
    buffer_load_dwordx4 v[108:111], v5, s[8:11], s34 offen sc1
    s_waitcnt vmcnt(0)
    v_mfma_f32_16x16x32_bf16 v[112:115], v[92:95], v[72:75], 0
    v_mfma_f32_16x16x32_bf16 v[112:115], v[96:99], v[76:79], v[112:115]
    v_mfma_f32_16x16x32_bf16 v[112:115], v[100:103], v[80:83], v[112:115]
    v_mfma_f32_16x16x32_bf16 v[112:115], v[104:107], v[84:87], v[112:115]
    v_mfma_f32_16x16x32_bf16 v[112:115], v[108:111], v[88:91], v[112:115]
    v_max3_u32 v116, v92, v93, v94
    v_max3_u32 v116, v116, v95, v96
    v_max3_u32 v116, v116, v97, v98
    v_max3_u32 v116, v116, v99, v100
    v_max3_u32 v116, v116, v101, v102
    v_max3_u32 v116, v116, v103, v104
    v_max3_u32 v116, v116, v105, v106
    v_max3_u32 v116, v116, v107, v108
    v_max3_u32 v116, v116, v109, v110
    v_max_u32 v116, v116, v111
    v_cmp_eq_u32 vcc, -1, v116
    s_sub_u32 s15, s15, 1
    s_cbranch_scc1 chain1_kernel_bail
    s_cbranch_vccnz chain1_kernel_y1_ppoll
    ds_write_b128 v6, v[112:115]
    s_waitcnt lgkmcnt(0)
    s_barrier
    s_add_u32 s14, s14, 1
    s_branch chain1_kernel_y1_step
chain1_kernel_y2_start:
    v_lshrrev_b32 v16, 4, v0
    v_and_b32 v17, 7, v0
    v_lshrrev_b32 v18, 3, v0
    v_and_b32 v18, 1, v18
    v_lshl_add_u32 v19, v18, 2, v16
    v_add_u32 v19, 16, v19
    v_mul_u32_u24 v20, 640, v19
    v_lshl_add_u32 v4, v17, 4, v20
    v_and_b32 v20, 3, v17
    v_lshlrev_b32 v20, 1, v20
    v_lshrrev_b32 v21, 2, v17
    v_add_u32 v20, v20, v21
    v_lshlrev_b32 v20, 4, v20
    v_lshl_add_u32 v5, v19, 7, v20
    v_add_u32 v3, 0, v1
    v_lshlrev_b32 v20, 8, v18
    v_lshl_add_u32 v20, v17, 5, v20
    v_and_b32 v21, 1, v16
    v_lshl_add_u32 v20, v21, 4, v20
    v_add_u32 v20, 11264, v20
    v_add_u32 v21, 12288, v1
    v_lshrrev_b32 v22, 1, v16
    v_cmp_eq_u32 vcc, v22, v18
    s_nop 1
    v_cndmask_b32 v6, v21, v20, vcc
    v_lshrrev_b32 v20, 3, v0
    v_lshlrev_b32 v20, 2, v20
    v_lshl_add_u32 v20, v17, 5, v20
    v_add_u32 v7, 10240, v20
    s_lshl_b32 s20, s12, 7
    s_add_u32 s20, s20, 20480
    s_lshr_b32 s21, s20, 13
    s_lshl_b32 s21, s21, 14
    s_and_b32 s20, s20, 8191
    s_add_u32 s20, s20, s21
    v_lshrrev_b32 v20, 3, v0
    v_lshlrev_b32 v20, 4, v20
    v_add_u32 v8, s20, v20
    s_mul_i32 s46, s12, 20480
    s_add_u32 s46, s46, 103809024
    s_mul_i32 s20, s12, 327680
    s_add_u32 s20, s20, 27426816
    s_add_u32 s21, s20, 0
    buffer_load_dwordx4 a[0:3], v1, s[8:11], s21 offen offset:0
    buffer_load_dwordx4 a[4:7], v1, s[8:11], s21 offen offset:1024
    s_add_u32 s21, s20, 2048
    buffer_load_dwordx4 a[8:11], v1, s[8:11], s21 offen offset:0
    buffer_load_dwordx4 a[12:15], v1, s[8:11], s21 offen offset:1024
    s_add_u32 s21, s20, 4096
    buffer_load_dwordx4 a[16:19], v1, s[8:11], s21 offen offset:0
    buffer_load_dwordx4 a[20:23], v1, s[8:11], s21 offen offset:1024
    s_add_u32 s21, s20, 6144
    buffer_load_dwordx4 a[24:27], v1, s[8:11], s21 offen offset:0
    buffer_load_dwordx4 a[28:31], v1, s[8:11], s21 offen offset:1024
    s_add_u32 s21, s20, 8192
    buffer_load_dwordx4 a[32:35], v1, s[8:11], s21 offen offset:0
    buffer_load_dwordx4 a[36:39], v1, s[8:11], s21 offen offset:1024
    s_add_u32 s21, s20, 10240
    buffer_load_dwordx4 a[40:43], v1, s[8:11], s21 offen offset:0
    buffer_load_dwordx4 a[44:47], v1, s[8:11], s21 offen offset:1024
    s_add_u32 s21, s20, 12288
    buffer_load_dwordx4 a[48:51], v1, s[8:11], s21 offen offset:0
    buffer_load_dwordx4 a[52:55], v1, s[8:11], s21 offen offset:1024
    s_add_u32 s21, s20, 14336
    buffer_load_dwordx4 a[56:59], v1, s[8:11], s21 offen offset:0
    buffer_load_dwordx4 a[60:63], v1, s[8:11], s21 offen offset:1024
    s_add_u32 s21, s20, 16384
    buffer_load_dwordx4 a[64:67], v1, s[8:11], s21 offen offset:0
    buffer_load_dwordx4 a[68:71], v1, s[8:11], s21 offen offset:1024
    s_add_u32 s21, s20, 18432
    buffer_load_dwordx4 a[72:75], v1, s[8:11], s21 offen offset:0
    buffer_load_dwordx4 a[76:79], v1, s[8:11], s21 offen offset:1024
    s_add_u32 s21, s20, 20480
    buffer_load_dwordx4 a[80:83], v1, s[8:11], s21 offen offset:0
    buffer_load_dwordx4 a[84:87], v1, s[8:11], s21 offen offset:1024
    s_add_u32 s21, s20, 22528
    buffer_load_dwordx4 a[88:91], v1, s[8:11], s21 offen offset:0
    buffer_load_dwordx4 a[92:95], v1, s[8:11], s21 offen offset:1024
    s_add_u32 s21, s20, 24576
    buffer_load_dwordx4 a[96:99], v1, s[8:11], s21 offen offset:0
    buffer_load_dwordx4 a[100:103], v1, s[8:11], s21 offen offset:1024
    s_add_u32 s21, s20, 26624
    buffer_load_dwordx4 a[104:107], v1, s[8:11], s21 offen offset:0
    buffer_load_dwordx4 a[108:111], v1, s[8:11], s21 offen offset:1024
    s_add_u32 s21, s20, 28672
    buffer_load_dwordx4 a[112:115], v1, s[8:11], s21 offen offset:0
    buffer_load_dwordx4 a[116:119], v1, s[8:11], s21 offen offset:1024
    s_add_u32 s21, s20, 30720
    buffer_load_dwordx4 a[120:123], v1, s[8:11], s21 offen offset:0
    buffer_load_dwordx4 a[124:127], v1, s[8:11], s21 offen offset:1024
    s_add_u32 s21, s20, 32768
    buffer_load_dwordx4 a[128:131], v1, s[8:11], s21 offen offset:0
    buffer_load_dwordx4 a[132:135], v1, s[8:11], s21 offen offset:1024
    s_add_u32 s21, s20, 34816
    buffer_load_dwordx4 a[136:139], v1, s[8:11], s21 offen offset:0
    buffer_load_dwordx4 a[140:143], v1, s[8:11], s21 offen offset:1024
    s_add_u32 s21, s20, 36864
    buffer_load_dwordx4 a[144:147], v1, s[8:11], s21 offen offset:0
    buffer_load_dwordx4 a[148:151], v1, s[8:11], s21 offen offset:1024
    s_add_u32 s21, s20, 38912
    buffer_load_dwordx4 a[152:155], v1, s[8:11], s21 offen offset:0
    buffer_load_dwordx4 a[156:159], v1, s[8:11], s21 offen offset:1024
    s_add_u32 s21, s20, 40960
    buffer_load_dwordx4 a[160:163], v1, s[8:11], s21 offen offset:0
    buffer_load_dwordx4 a[164:167], v1, s[8:11], s21 offen offset:1024
    s_add_u32 s21, s20, 43008
    buffer_load_dwordx4 a[168:171], v1, s[8:11], s21 offen offset:0
    buffer_load_dwordx4 a[172:175], v1, s[8:11], s21 offen offset:1024
    s_add_u32 s21, s20, 45056
    buffer_load_dwordx4 a[176:179], v1, s[8:11], s21 offen offset:0
    buffer_load_dwordx4 a[180:183], v1, s[8:11], s21 offen offset:1024
    s_add_u32 s21, s20, 47104
    buffer_load_dwordx4 a[184:187], v1, s[8:11], s21 offen offset:0
    buffer_load_dwordx4 a[188:191], v1, s[8:11], s21 offen offset:1024
    s_add_u32 s21, s20, 49152
    buffer_load_dwordx4 a[192:195], v1, s[8:11], s21 offen offset:0
    buffer_load_dwordx4 a[196:199], v1, s[8:11], s21 offen offset:1024
    s_add_u32 s21, s20, 51200
    buffer_load_dwordx4 a[200:203], v1, s[8:11], s21 offen offset:0
    buffer_load_dwordx4 a[204:207], v1, s[8:11], s21 offen offset:1024
    s_add_u32 s21, s20, 53248
    buffer_load_dwordx4 a[208:211], v1, s[8:11], s21 offen offset:0
    buffer_load_dwordx4 a[212:215], v1, s[8:11], s21 offen offset:1024
    s_add_u32 s21, s20, 55296
    buffer_load_dwordx4 a[216:219], v1, s[8:11], s21 offen offset:0
    buffer_load_dwordx4 a[220:223], v1, s[8:11], s21 offen offset:1024
    s_add_u32 s21, s20, 57344
    buffer_load_dwordx4 a[224:227], v1, s[8:11], s21 offen offset:0
    buffer_load_dwordx4 a[228:231], v1, s[8:11], s21 offen offset:1024
    s_add_u32 s21, s20, 59392
    buffer_load_dwordx4 a[232:235], v1, s[8:11], s21 offen offset:0
    buffer_load_dwordx4 a[236:239], v1, s[8:11], s21 offen offset:1024
    s_add_u32 s21, s20, 61440
    buffer_load_dwordx4 a[240:243], v1, s[8:11], s21 offen offset:0
    buffer_load_dwordx4 a[244:247], v1, s[8:11], s21 offen offset:1024
    s_add_u32 s21, s20, 63488
    buffer_load_dwordx4 a[248:251], v1, s[8:11], s21 offen offset:0
    buffer_load_dwordx4 a[252:255], v1, s[8:11], s21 offen offset:1024
    s_add_u32 s21, s20, 65536
    buffer_load_dwordx4 v[176:179], v1, s[8:11], s21 offen offset:0
    buffer_load_dwordx4 v[180:183], v1, s[8:11], s21 offen offset:1024
    s_add_u32 s21, s20, 67584
    buffer_load_dwordx4 v[184:187], v1, s[8:11], s21 offen offset:0
    buffer_load_dwordx4 v[188:191], v1, s[8:11], s21 offen offset:1024
    s_add_u32 s21, s20, 69632
    buffer_load_dwordx4 v[192:195], v1, s[8:11], s21 offen offset:0
    buffer_load_dwordx4 v[196:199], v1, s[8:11], s21 offen offset:1024
    s_add_u32 s21, s20, 71680
    buffer_load_dwordx4 v[200:203], v1, s[8:11], s21 offen offset:0
    buffer_load_dwordx4 v[204:207], v1, s[8:11], s21 offen offset:1024
    s_add_u32 s21, s20, 73728
    buffer_load_dwordx4 v[208:211], v1, s[8:11], s21 offen offset:0
    buffer_load_dwordx4 v[212:215], v1, s[8:11], s21 offen offset:1024
    s_add_u32 s21, s20, 75776
    buffer_load_dwordx4 v[216:219], v1, s[8:11], s21 offen offset:0
    buffer_load_dwordx4 v[220:223], v1, s[8:11], s21 offen offset:1024
    s_add_u32 s21, s20, 77824
    buffer_load_dwordx4 v[224:227], v1, s[8:11], s21 offen offset:0
    buffer_load_dwordx4 v[228:231], v1, s[8:11], s21 offen offset:1024
    s_add_u32 s21, s20, 79872
    buffer_load_dwordx4 v[232:235], v1, s[8:11], s21 offen offset:0
    buffer_load_dwordx4 v[236:239], v1, s[8:11], s21 offen offset:1024
    s_mov_b32 s14, 0
chain1_kernel_y2_step:
    s_cmp_lt_u32 s14, 32
    s_cselect_b32 s18, s16, s17
    s_and_b32 s20, s14, 31
    s_lshl_b32 s20, s20, 16
    s_add_u32 s18, s18, s20
    s_mul_i32 s28, s14, 1638400
    s_add_u32 s28, s28, s46
    buffer_load_dwordx4 v[76:79], v4, s[8:11], s28 offen offset:128
    buffer_load_dwordx4 v[80:83], v4, s[8:11], s28 offen offset:256
    buffer_load_dwordx4 v[84:87], v4, s[8:11], s28 offen offset:384
    buffer_load_dwordx4 v[88:91], v4, s[8:11], s28 offen offset:512
    v_mov_b32 v56, 0
    v_mov_b32 v57, 0
    v_mov_b32 v58, 0
    v_mov_b32 v59, 0
    v_mov_b32 v60, 0
    v_mov_b32 v61, 0
    v_mov_b32 v62, 0
    v_mov_b32 v63, 0
    v_mov_b32 v64, 0
    v_mov_b32 v65, 0
    v_mov_b32 v66, 0
    v_mov_b32 v67, 0
    v_mov_b32 v68, 0
    v_mov_b32 v69, 0
    v_mov_b32 v70, 0
    v_mov_b32 v71, 0
    s_add_u32 s22, s18, 51200
    s_add_u32 s23, s18, 52224
chain1_kernel_y2_poll:
    buffer_load_dwordx4 v[40:43], v1, s[8:11], s22 offen sc1
    buffer_load_dwordx4 v[44:47], v1, s[8:11], s23 offen sc1
    s_waitcnt vmcnt(0)
    ds_write_b128 v3, v[40:43] offset:6144
    ds_write_b128 v3, v[44:47] offset:7168
    v_max3_u32 v116, v40, v41, v42
    v_max3_u32 v116, v116, v43, v44
    v_max3_u32 v116, v116, v45, v46
    v_max_u32 v116, v116, v47
    v_cmp_eq_u32 vcc, -1, v116
    s_sub_u32 s15, s15, 1
    s_cbranch_scc1 chain1_kernel_bail
    s_cbranch_vccnz chain1_kernel_y2_poll
    s_waitcnt lgkmcnt(0)
    s_barrier
    ds_read_b128 v[16:19], v3 offset:0
    ds_read_b128 v[20:23], v3 offset:1024
    ds_read_b128 v[24:27], v3 offset:2048
    ds_read_b128 v[28:31], v3 offset:3072
    ds_read_b128 v[32:35], v3 offset:4096
    ds_read_b128 v[36:39], v3 offset:5120
    ds_read_b128 v[48:51], v3 offset:8192
    ds_read_b128 v[52:55], v3 offset:9216
    v_smfmac_f32_16x16x64_bf16 v[56:59], v[40:43], a[48:55], v2
    v_smfmac_f32_16x16x64_bf16 v[60:63], v[40:43], a[128:135], v2
    v_smfmac_f32_16x16x64_bf16 v[64:67], v[40:43], a[208:215], v2
    v_smfmac_f32_16x16x64_bf16 v[68:71], v[40:43], v[208:215], v2
    v_smfmac_f32_16x16x64_bf16 v[56:59], v[44:47], a[56:63], v2
    v_smfmac_f32_16x16x64_bf16 v[60:63], v[44:47], a[136:143], v2
    v_smfmac_f32_16x16x64_bf16 v[64:67], v[44:47], a[216:223], v2
    v_smfmac_f32_16x16x64_bf16 v[68:71], v[44:47], v[216:223], v2
    s_waitcnt lgkmcnt(7)
    v_smfmac_f32_16x16x64_bf16 v[56:59], v[16:19], a[0:7], v2
    v_smfmac_f32_16x16x64_bf16 v[60:63], v[16:19], a[80:87], v2
    v_smfmac_f32_16x16x64_bf16 v[64:67], v[16:19], a[160:167], v2
    v_smfmac_f32_16x16x64_bf16 v[68:71], v[16:19], a[240:247], v2
    s_waitcnt lgkmcnt(6)
    v_smfmac_f32_16x16x64_bf16 v[56:59], v[20:23], a[8:15], v2
    v_smfmac_f32_16x16x64_bf16 v[60:63], v[20:23], a[88:95], v2
    v_smfmac_f32_16x16x64_bf16 v[64:67], v[20:23], a[168:175], v2
    v_smfmac_f32_16x16x64_bf16 v[68:71], v[20:23], a[248:255], v2
    s_waitcnt lgkmcnt(5)
    v_smfmac_f32_16x16x64_bf16 v[56:59], v[24:27], a[16:23], v2
    v_smfmac_f32_16x16x64_bf16 v[60:63], v[24:27], a[96:103], v2
    v_smfmac_f32_16x16x64_bf16 v[64:67], v[24:27], a[176:183], v2
    v_smfmac_f32_16x16x64_bf16 v[68:71], v[24:27], v[176:183], v2
    s_waitcnt lgkmcnt(4)
    v_smfmac_f32_16x16x64_bf16 v[56:59], v[28:31], a[24:31], v2
    v_smfmac_f32_16x16x64_bf16 v[60:63], v[28:31], a[104:111], v2
    v_smfmac_f32_16x16x64_bf16 v[64:67], v[28:31], a[184:191], v2
    v_smfmac_f32_16x16x64_bf16 v[68:71], v[28:31], v[184:191], v2
    s_waitcnt lgkmcnt(3)
    v_smfmac_f32_16x16x64_bf16 v[56:59], v[32:35], a[32:39], v2
    v_smfmac_f32_16x16x64_bf16 v[60:63], v[32:35], a[112:119], v2
    v_smfmac_f32_16x16x64_bf16 v[64:67], v[32:35], a[192:199], v2
    v_smfmac_f32_16x16x64_bf16 v[68:71], v[32:35], v[192:199], v2
    s_waitcnt lgkmcnt(2)
    v_smfmac_f32_16x16x64_bf16 v[56:59], v[36:39], a[40:47], v2
    v_smfmac_f32_16x16x64_bf16 v[60:63], v[36:39], a[120:127], v2
    v_smfmac_f32_16x16x64_bf16 v[64:67], v[36:39], a[200:207], v2
    v_smfmac_f32_16x16x64_bf16 v[68:71], v[36:39], v[200:207], v2
    s_waitcnt lgkmcnt(1)
    v_smfmac_f32_16x16x64_bf16 v[56:59], v[48:51], a[64:71], v2
    v_smfmac_f32_16x16x64_bf16 v[60:63], v[48:51], a[144:151], v2
    v_smfmac_f32_16x16x64_bf16 v[64:67], v[48:51], a[224:231], v2
    v_smfmac_f32_16x16x64_bf16 v[68:71], v[48:51], v[224:231], v2
    s_waitcnt lgkmcnt(0)
    v_smfmac_f32_16x16x64_bf16 v[56:59], v[52:55], a[72:79], v2
    v_smfmac_f32_16x16x64_bf16 v[60:63], v[52:55], a[152:159], v2
    v_smfmac_f32_16x16x64_bf16 v[64:67], v[52:55], a[232:239], v2
    v_smfmac_f32_16x16x64_bf16 v[68:71], v[52:55], v[232:239], v2
    s_nop 7
    v_permlane32_swap_b32 v56, v64
    v_permlane32_swap_b32 v60, v68
    v_permlane32_swap_b32 v57, v65
    v_permlane32_swap_b32 v61, v69
    v_permlane32_swap_b32 v58, v66
    v_permlane32_swap_b32 v62, v70
    v_permlane32_swap_b32 v59, v67
    v_permlane32_swap_b32 v63, v71
    v_add_f32 v56, v56, v64
    v_add_f32 v60, v60, v68
    v_add_f32 v57, v57, v65
    v_add_f32 v61, v61, v69
    v_add_f32 v58, v58, v66
    v_add_f32 v62, v62, v70
    v_add_f32 v59, v59, v67
    v_add_f32 v63, v63, v71
    s_nop 1
    v_permlane16_swap_b32 v56, v60
    v_permlane16_swap_b32 v57, v61
    v_permlane16_swap_b32 v58, v62
    v_permlane16_swap_b32 v59, v63
    s_nop 1
    v_cvt_pk_bf16_f32 v72, v56, v57
    v_cvt_pk_bf16_f32 v73, v58, v59
    v_cvt_pk_bf16_f32 v74, v60, v61
    v_cvt_pk_bf16_f32 v75, v62, v63
    buffer_store_dwordx4 v[72:75], v4, s[8:11], s28 offen
    s_cmp_eq_u32 s14, 63
    s_cbranch_scc1 chain1_kernel_end
    s_add_u32 s30, s18, 0
    s_add_u32 s31, s18, 4096
    s_add_u32 s32, s18, 16384
    s_add_u32 s33, s18, 20480
    s_add_u32 s34, s18, 32768
    s_add_u32 s29, s14, 1
    s_cmp_lt_u32 s29, 32
    s_cselect_b32 s19, s16, s17
    s_and_b32 s20, s29, 31
    s_lshl_b32 s20, s20, 16
    s_add_u32 s19, s19, s20
chain1_kernel_y2_ppoll:
    buffer_load_dwordx4 v[92:95], v5, s[8:11], s30 offen sc1
    buffer_load_dwordx4 v[96:99], v5, s[8:11], s31 offen sc1
    buffer_load_dwordx4 v[100:103], v5, s[8:11], s32 offen sc1
    buffer_load_dwordx4 v[104:107], v5, s[8:11], s33 offen sc1
    buffer_load_dwordx4 v[108:111], v5, s[8:11], s34 offen sc1
    s_waitcnt vmcnt(0)
    v_mfma_f32_16x16x32_bf16 v[112:115], v[92:95], v[72:75], 0
    v_mfma_f32_16x16x32_bf16 v[112:115], v[96:99], v[76:79], v[112:115]
    v_mfma_f32_16x16x32_bf16 v[112:115], v[100:103], v[80:83], v[112:115]
    v_mfma_f32_16x16x32_bf16 v[112:115], v[104:107], v[84:87], v[112:115]
    v_mfma_f32_16x16x32_bf16 v[112:115], v[108:111], v[88:91], v[112:115]
    v_max3_u32 v116, v92, v93, v94
    v_max3_u32 v116, v116, v95, v96
    v_max3_u32 v116, v116, v97, v98
    v_max3_u32 v116, v116, v99, v100
    v_max3_u32 v116, v116, v101, v102
    v_max3_u32 v116, v116, v103, v104
    v_max3_u32 v116, v116, v105, v106
    v_max3_u32 v116, v116, v107, v108
    v_max3_u32 v116, v116, v109, v110
    v_max_u32 v116, v116, v111
    v_cmp_eq_u32 vcc, -1, v116
    s_sub_u32 s15, s15, 1
    s_cbranch_scc1 chain1_kernel_bail
    s_cbranch_vccnz chain1_kernel_y2_ppoll
    ds_write_b128 v6, v[112:115]
    s_waitcnt lgkmcnt(0)
    s_barrier
    s_add_u32 s14, s14, 1
    s_branch chain1_kernel_y2_step
chain1_kernel_y3_start:
    v_lshrrev_b32 v16, 4, v0
    v_and_b32 v17, 7, v0
    v_lshrrev_b32 v18, 3, v0
    v_and_b32 v18, 1, v18
    v_lshl_add_u32 v19, v18, 2, v16
    v_add_u32 v19, 24, v19
    v_mul_u32_u24 v20, 640, v19
    v_lshl_add_u32 v4, v17, 4, v20
    v_and_b32 v20, 3, v17
    v_lshlrev_b32 v20, 1, v20
    v_lshrrev_b32 v21, 2, v17
    v_add_u32 v20, v20, v21
    v_lshlrev_b32 v20, 4, v20
    v_lshl_add_u32 v5, v19, 7, v20
    v_add_u32 v3, 0, v1
    v_lshlrev_b32 v20, 8, v18
    v_lshl_add_u32 v20, v17, 5, v20
    v_and_b32 v21, 1, v16
    v_lshl_add_u32 v20, v21, 4, v20
    v_add_u32 v20, 11776, v20
    v_add_u32 v21, 12288, v1
    v_lshrrev_b32 v22, 1, v16
    v_cmp_eq_u32 vcc, v22, v18
    s_nop 1
    v_cndmask_b32 v6, v21, v20, vcc
    v_lshrrev_b32 v20, 3, v0
    v_lshlrev_b32 v20, 2, v20
    v_lshl_add_u32 v20, v17, 5, v20
    v_add_u32 v7, 10240, v20
    s_lshl_b32 s20, s12, 7
    s_add_u32 s20, s20, 20480
    s_lshr_b32 s21, s20, 13
    s_lshl_b32 s21, s21, 14
    s_and_b32 s20, s20, 8191
    s_add_u32 s20, s20, s21
    v_lshrrev_b32 v20, 3, v0
    v_lshlrev_b32 v20, 4, v20
    v_add_u32 v8, s20, v20
    s_mul_i32 s46, s12, 20480
    s_add_u32 s46, s46, 103809024
    s_mul_i32 s20, s12, 327680
    s_add_u32 s20, s20, 27508736
    s_add_u32 s21, s20, 0
    buffer_load_dwordx4 a[0:3], v1, s[8:11], s21 offen offset:0
    buffer_load_dwordx4 a[4:7], v1, s[8:11], s21 offen offset:1024
    s_add_u32 s21, s20, 2048
    buffer_load_dwordx4 a[8:11], v1, s[8:11], s21 offen offset:0
    buffer_load_dwordx4 a[12:15], v1, s[8:11], s21 offen offset:1024
    s_add_u32 s21, s20, 4096
    buffer_load_dwordx4 a[16:19], v1, s[8:11], s21 offen offset:0
    buffer_load_dwordx4 a[20:23], v1, s[8:11], s21 offen offset:1024
    s_add_u32 s21, s20, 6144
    buffer_load_dwordx4 a[24:27], v1, s[8:11], s21 offen offset:0
    buffer_load_dwordx4 a[28:31], v1, s[8:11], s21 offen offset:1024
    s_add_u32 s21, s20, 8192
    buffer_load_dwordx4 a[32:35], v1, s[8:11], s21 offen offset:0
    buffer_load_dwordx4 a[36:39], v1, s[8:11], s21 offen offset:1024
    s_add_u32 s21, s20, 10240
    buffer_load_dwordx4 a[40:43], v1, s[8:11], s21 offen offset:0
    buffer_load_dwordx4 a[44:47], v1, s[8:11], s21 offen offset:1024
    s_add_u32 s21, s20, 12288
    buffer_load_dwordx4 a[48:51], v1, s[8:11], s21 offen offset:0
    buffer_load_dwordx4 a[52:55], v1, s[8:11], s21 offen offset:1024
    s_add_u32 s21, s20, 14336
    buffer_load_dwordx4 a[56:59], v1, s[8:11], s21 offen offset:0
    buffer_load_dwordx4 a[60:63], v1, s[8:11], s21 offen offset:1024
    s_add_u32 s21, s20, 16384
    buffer_load_dwordx4 a[64:67], v1, s[8:11], s21 offen offset:0
    buffer_load_dwordx4 a[68:71], v1, s[8:11], s21 offen offset:1024
    s_add_u32 s21, s20, 18432
    buffer_load_dwordx4 a[72:75], v1, s[8:11], s21 offen offset:0
    buffer_load_dwordx4 a[76:79], v1, s[8:11], s21 offen offset:1024
    s_add_u32 s21, s20, 20480
    buffer_load_dwordx4 a[80:83], v1, s[8:11], s21 offen offset:0
    buffer_load_dwordx4 a[84:87], v1, s[8:11], s21 offen offset:1024
    s_add_u32 s21, s20, 22528
    buffer_load_dwordx4 a[88:91], v1, s[8:11], s21 offen offset:0
    buffer_load_dwordx4 a[92:95], v1, s[8:11], s21 offen offset:1024
    s_add_u32 s21, s20, 24576
    buffer_load_dwordx4 a[96:99], v1, s[8:11], s21 offen offset:0
    buffer_load_dwordx4 a[100:103], v1, s[8:11], s21 offen offset:1024
    s_add_u32 s21, s20, 26624
    buffer_load_dwordx4 a[104:107], v1, s[8:11], s21 offen offset:0
    buffer_load_dwordx4 a[108:111], v1, s[8:11], s21 offen offset:1024
    s_add_u32 s21, s20, 28672
    buffer_load_dwordx4 a[112:115], v1, s[8:11], s21 offen offset:0
    buffer_load_dwordx4 a[116:119], v1, s[8:11], s21 offen offset:1024
    s_add_u32 s21, s20, 30720
    buffer_load_dwordx4 a[120:123], v1, s[8:11], s21 offen offset:0
    buffer_load_dwordx4 a[124:127], v1, s[8:11], s21 offen offset:1024
    s_add_u32 s21, s20, 32768
    buffer_load_dwordx4 a[128:131], v1, s[8:11], s21 offen offset:0
    buffer_load_dwordx4 a[132:135], v1, s[8:11], s21 offen offset:1024
    s_add_u32 s21, s20, 34816
    buffer_load_dwordx4 a[136:139], v1, s[8:11], s21 offen offset:0
    buffer_load_dwordx4 a[140:143], v1, s[8:11], s21 offen offset:1024
    s_add_u32 s21, s20, 36864
    buffer_load_dwordx4 a[144:147], v1, s[8:11], s21 offen offset:0
    buffer_load_dwordx4 a[148:151], v1, s[8:11], s21 offen offset:1024
    s_add_u32 s21, s20, 38912
    buffer_load_dwordx4 a[152:155], v1, s[8:11], s21 offen offset:0
    buffer_load_dwordx4 a[156:159], v1, s[8:11], s21 offen offset:1024
    s_add_u32 s21, s20, 40960
    buffer_load_dwordx4 a[160:163], v1, s[8:11], s21 offen offset:0
    buffer_load_dwordx4 a[164:167], v1, s[8:11], s21 offen offset:1024
    s_add_u32 s21, s20, 43008
    buffer_load_dwordx4 a[168:171], v1, s[8:11], s21 offen offset:0
    buffer_load_dwordx4 a[172:175], v1, s[8:11], s21 offen offset:1024
    s_add_u32 s21, s20, 45056
    buffer_load_dwordx4 a[176:179], v1, s[8:11], s21 offen offset:0
    buffer_load_dwordx4 a[180:183], v1, s[8:11], s21 offen offset:1024
    s_add_u32 s21, s20, 47104
    buffer_load_dwordx4 a[184:187], v1, s[8:11], s21 offen offset:0
    buffer_load_dwordx4 a[188:191], v1, s[8:11], s21 offen offset:1024
    s_add_u32 s21, s20, 49152
    buffer_load_dwordx4 a[192:195], v1, s[8:11], s21 offen offset:0
    buffer_load_dwordx4 a[196:199], v1, s[8:11], s21 offen offset:1024
    s_add_u32 s21, s20, 51200
    buffer_load_dwordx4 a[200:203], v1, s[8:11], s21 offen offset:0
    buffer_load_dwordx4 a[204:207], v1, s[8:11], s21 offen offset:1024
    s_add_u32 s21, s20, 53248
    buffer_load_dwordx4 a[208:211], v1, s[8:11], s21 offen offset:0
    buffer_load_dwordx4 a[212:215], v1, s[8:11], s21 offen offset:1024
    s_add_u32 s21, s20, 55296
    buffer_load_dwordx4 a[216:219], v1, s[8:11], s21 offen offset:0
    buffer_load_dwordx4 a[220:223], v1, s[8:11], s21 offen offset:1024
    s_add_u32 s21, s20, 57344
    buffer_load_dwordx4 a[224:227], v1, s[8:11], s21 offen offset:0
    buffer_load_dwordx4 a[228:231], v1, s[8:11], s21 offen offset:1024
    s_add_u32 s21, s20, 59392
    buffer_load_dwordx4 a[232:235], v1, s[8:11], s21 offen offset:0
    buffer_load_dwordx4 a[236:239], v1, s[8:11], s21 offen offset:1024
    s_add_u32 s21, s20, 61440
    buffer_load_dwordx4 a[240:243], v1, s[8:11], s21 offen offset:0
    buffer_load_dwordx4 a[244:247], v1, s[8:11], s21 offen offset:1024
    s_add_u32 s21, s20, 63488
    buffer_load_dwordx4 a[248:251], v1, s[8:11], s21 offen offset:0
    buffer_load_dwordx4 a[252:255], v1, s[8:11], s21 offen offset:1024
    s_add_u32 s21, s20, 65536
    buffer_load_dwordx4 v[176:179], v1, s[8:11], s21 offen offset:0
    buffer_load_dwordx4 v[180:183], v1, s[8:11], s21 offen offset:1024
    s_add_u32 s21, s20, 67584
    buffer_load_dwordx4 v[184:187], v1, s[8:11], s21 offen offset:0
    buffer_load_dwordx4 v[188:191], v1, s[8:11], s21 offen offset:1024
    s_add_u32 s21, s20, 69632
    buffer_load_dwordx4 v[192:195], v1, s[8:11], s21 offen offset:0
    buffer_load_dwordx4 v[196:199], v1, s[8:11], s21 offen offset:1024
    s_add_u32 s21, s20, 71680
    buffer_load_dwordx4 v[200:203], v1, s[8:11], s21 offen offset:0
    buffer_load_dwordx4 v[204:207], v1, s[8:11], s21 offen offset:1024
    s_add_u32 s21, s20, 73728
    buffer_load_dwordx4 v[208:211], v1, s[8:11], s21 offen offset:0
    buffer_load_dwordx4 v[212:215], v1, s[8:11], s21 offen offset:1024
    s_add_u32 s21, s20, 75776
    buffer_load_dwordx4 v[216:219], v1, s[8:11], s21 offen offset:0
    buffer_load_dwordx4 v[220:223], v1, s[8:11], s21 offen offset:1024
    s_add_u32 s21, s20, 77824
    buffer_load_dwordx4 v[224:227], v1, s[8:11], s21 offen offset:0
    buffer_load_dwordx4 v[228:231], v1, s[8:11], s21 offen offset:1024
    s_add_u32 s21, s20, 79872
    buffer_load_dwordx4 v[232:235], v1, s[8:11], s21 offen offset:0
    buffer_load_dwordx4 v[236:239], v1, s[8:11], s21 offen offset:1024
    s_mov_b32 s14, 0
chain1_kernel_y3_step:
    s_cmp_lt_u32 s14, 32
    s_cselect_b32 s18, s16, s17
    s_and_b32 s20, s14, 31
    s_lshl_b32 s20, s20, 16
    s_add_u32 s18, s18, s20
    s_mul_i32 s28, s14, 1638400
    s_add_u32 s28, s28, s46
    buffer_load_dwordx4 v[76:79], v4, s[8:11], s28 offen offset:128
    buffer_load_dwordx4 v[80:83], v4, s[8:11], s28 offen offset:256
    buffer_load_dwordx4 v[84:87], v4, s[8:11], s28 offen offset:384
    buffer_load_dwordx4 v[88:91], v4, s[8:11], s28 offen offset:512
    v_mov_b32 v56, 0
    v_mov_b32 v57, 0
    v_mov_b32 v58, 0
    v_mov_b32 v59, 0
    v_mov_b32 v60, 0
    v_mov_b32 v61, 0
    v_mov_b32 v62, 0
    v_mov_b32 v63, 0
    v_mov_b32 v64, 0
    v_mov_b32 v65, 0
    v_mov_b32 v66, 0
    v_mov_b32 v67, 0
    v_mov_b32 v68, 0
    v_mov_b32 v69, 0
    v_mov_b32 v70, 0
    v_mov_b32 v71, 0
    s_add_u32 s22, s18, 53248
    s_add_u32 s23, s18, 54272
chain1_kernel_y3_poll:
    buffer_load_dwordx4 v[48:51], v1, s[8:11], s22 offen sc1
    buffer_load_dwordx4 v[52:55], v1, s[8:11], s23 offen sc1
    s_waitcnt vmcnt(0)
    ds_write_b128 v3, v[48:51] offset:8192
    ds_write_b128 v3, v[52:55] offset:9216
    v_max3_u32 v116, v48, v49, v50
    v_max3_u32 v116, v116, v51, v52
    v_max3_u32 v116, v116, v53, v54
    v_max_u32 v116, v116, v55
    v_cmp_eq_u32 vcc, -1, v116
    s_sub_u32 s15, s15, 1
    s_cbranch_scc1 chain1_kernel_bail
    s_cbranch_vccnz chain1_kernel_y3_poll
    s_waitcnt lgkmcnt(0)
    s_barrier
    ds_read_b128 v[16:19], v3 offset:0
    ds_read_b128 v[20:23], v3 offset:1024
    ds_read_b128 v[24:27], v3 offset:2048
    ds_read_b128 v[28:31], v3 offset:3072
    ds_read_b128 v[32:35], v3 offset:4096
    ds_read_b128 v[36:39], v3 offset:5120
    ds_read_b128 v[40:43], v3 offset:6144
    ds_read_b128 v[44:47], v3 offset:7168
    v_smfmac_f32_16x16x64_bf16 v[56:59], v[48:51], a[64:71], v2
    v_smfmac_f32_16x16x64_bf16 v[60:63], v[48:51], a[144:151], v2
    v_smfmac_f32_16x16x64_bf16 v[64:67], v[48:51], a[224:231], v2
    v_smfmac_f32_16x16x64_bf16 v[68:71], v[48:51], v[224:231], v2
    v_smfmac_f32_16x16x64_bf16 v[56:59], v[52:55], a[72:79], v2
    v_smfmac_f32_16x16x64_bf16 v[60:63], v[52:55], a[152:159], v2
    v_smfmac_f32_16x16x64_bf16 v[64:67], v[52:55], a[232:239], v2
    v_smfmac_f32_16x16x64_bf16 v[68:71], v[52:55], v[232:239], v2
    s_waitcnt lgkmcnt(7)
    v_smfmac_f32_16x16x64_bf16 v[56:59], v[16:19], a[0:7], v2
    v_smfmac_f32_16x16x64_bf16 v[60:63], v[16:19], a[80:87], v2
    v_smfmac_f32_16x16x64_bf16 v[64:67], v[16:19], a[160:167], v2
    v_smfmac_f32_16x16x64_bf16 v[68:71], v[16:19], a[240:247], v2
    s_waitcnt lgkmcnt(6)
    v_smfmac_f32_16x16x64_bf16 v[56:59], v[20:23], a[8:15], v2
    v_smfmac_f32_16x16x64_bf16 v[60:63], v[20:23], a[88:95], v2
    v_smfmac_f32_16x16x64_bf16 v[64:67], v[20:23], a[168:175], v2
    v_smfmac_f32_16x16x64_bf16 v[68:71], v[20:23], a[248:255], v2
    s_waitcnt lgkmcnt(5)
    v_smfmac_f32_16x16x64_bf16 v[56:59], v[24:27], a[16:23], v2
    v_smfmac_f32_16x16x64_bf16 v[60:63], v[24:27], a[96:103], v2
    v_smfmac_f32_16x16x64_bf16 v[64:67], v[24:27], a[176:183], v2
    v_smfmac_f32_16x16x64_bf16 v[68:71], v[24:27], v[176:183], v2
    s_waitcnt lgkmcnt(4)
    v_smfmac_f32_16x16x64_bf16 v[56:59], v[28:31], a[24:31], v2
    v_smfmac_f32_16x16x64_bf16 v[60:63], v[28:31], a[104:111], v2
    v_smfmac_f32_16x16x64_bf16 v[64:67], v[28:31], a[184:191], v2
    v_smfmac_f32_16x16x64_bf16 v[68:71], v[28:31], v[184:191], v2
    s_waitcnt lgkmcnt(3)
    v_smfmac_f32_16x16x64_bf16 v[56:59], v[32:35], a[32:39], v2
    v_smfmac_f32_16x16x64_bf16 v[60:63], v[32:35], a[112:119], v2
    v_smfmac_f32_16x16x64_bf16 v[64:67], v[32:35], a[192:199], v2
    v_smfmac_f32_16x16x64_bf16 v[68:71], v[32:35], v[192:199], v2
    s_waitcnt lgkmcnt(2)
    v_smfmac_f32_16x16x64_bf16 v[56:59], v[36:39], a[40:47], v2
    v_smfmac_f32_16x16x64_bf16 v[60:63], v[36:39], a[120:127], v2
    v_smfmac_f32_16x16x64_bf16 v[64:67], v[36:39], a[200:207], v2
    v_smfmac_f32_16x16x64_bf16 v[68:71], v[36:39], v[200:207], v2
    s_waitcnt lgkmcnt(1)
    v_smfmac_f32_16x16x64_bf16 v[56:59], v[40:43], a[48:55], v2
    v_smfmac_f32_16x16x64_bf16 v[60:63], v[40:43], a[128:135], v2
    v_smfmac_f32_16x16x64_bf16 v[64:67], v[40:43], a[208:215], v2
    v_smfmac_f32_16x16x64_bf16 v[68:71], v[40:43], v[208:215], v2
    s_waitcnt lgkmcnt(0)
    v_smfmac_f32_16x16x64_bf16 v[56:59], v[44:47], a[56:63], v2
    v_smfmac_f32_16x16x64_bf16 v[60:63], v[44:47], a[136:143], v2
    v_smfmac_f32_16x16x64_bf16 v[64:67], v[44:47], a[216:223], v2
    v_smfmac_f32_16x16x64_bf16 v[68:71], v[44:47], v[216:223], v2
    s_nop 7
    v_permlane32_swap_b32 v56, v64
    v_permlane32_swap_b32 v60, v68
    v_permlane32_swap_b32 v57, v65
    v_permlane32_swap_b32 v61, v69
    v_permlane32_swap_b32 v58, v66
    v_permlane32_swap_b32 v62, v70
    v_permlane32_swap_b32 v59, v67
    v_permlane32_swap_b32 v63, v71
    v_add_f32 v56, v56, v64
    v_add_f32 v60, v60, v68
    v_add_f32 v57, v57, v65
    v_add_f32 v61, v61, v69
    v_add_f32 v58, v58, v66
    v_add_f32 v62, v62, v70
    v_add_f32 v59, v59, v67
    v_add_f32 v63, v63, v71
    s_nop 1
    v_permlane16_swap_b32 v56, v60
    v_permlane16_swap_b32 v57, v61
    v_permlane16_swap_b32 v58, v62
    v_permlane16_swap_b32 v59, v63
    s_nop 1
    v_cvt_pk_bf16_f32 v72, v56, v57
    v_cvt_pk_bf16_f32 v73, v58, v59
    v_cvt_pk_bf16_f32 v74, v60, v61
    v_cvt_pk_bf16_f32 v75, v62, v63
    buffer_store_dwordx4 v[72:75], v4, s[8:11], s28 offen
    s_cmp_eq_u32 s14, 63
    s_cbranch_scc1 chain1_kernel_end
    s_add_u32 s30, s18, 0
    s_add_u32 s31, s18, 4096
    s_add_u32 s32, s18, 16384
    s_add_u32 s33, s18, 20480
    s_add_u32 s34, s18, 32768
    s_add_u32 s29, s14, 1
    s_cmp_lt_u32 s29, 32
    s_cselect_b32 s19, s16, s17
    s_and_b32 s20, s29, 31
    s_lshl_b32 s20, s20, 16
    s_add_u32 s19, s19, s20
chain1_kernel_y3_ppoll:
    buffer_load_dwordx4 v[92:95], v5, s[8:11], s30 offen sc1
    buffer_load_dwordx4 v[96:99], v5, s[8:11], s31 offen sc1
    buffer_load_dwordx4 v[100:103], v5, s[8:11], s32 offen sc1
    buffer_load_dwordx4 v[104:107], v5, s[8:11], s33 offen sc1
    buffer_load_dwordx4 v[108:111], v5, s[8:11], s34 offen sc1
    s_waitcnt vmcnt(0)
    v_mfma_f32_16x16x32_bf16 v[112:115], v[92:95], v[72:75], 0
    v_mfma_f32_16x16x32_bf16 v[112:115], v[96:99], v[76:79], v[112:115]
    v_mfma_f32_16x16x32_bf16 v[112:115], v[100:103], v[80:83], v[112:115]
    v_mfma_f32_16x16x32_bf16 v[112:115], v[104:107], v[84:87], v[112:115]
    v_mfma_f32_16x16x32_bf16 v[112:115], v[108:111], v[88:91], v[112:115]
    v_max3_u32 v116, v92, v93, v94
    v_max3_u32 v116, v116, v95, v96
    v_max3_u32 v116, v116, v97, v98
    v_max3_u32 v116, v116, v99, v100
    v_max3_u32 v116, v116, v101, v102
    v_max3_u32 v116, v116, v103, v104
    v_max3_u32 v116, v116, v105, v106
    v_max3_u32 v116, v116, v107, v108
    v_max3_u32 v116, v116, v109, v110
    v_max_u32 v116, v116, v111
    v_cmp_eq_u32 vcc, -1, v116
    s_sub_u32 s15, s15, 1
    s_cbranch_scc1 chain1_kernel_bail
    s_cbranch_vccnz chain1_kernel_y3_ppoll
    ds_write_b128 v6, v[112:115]
    s_waitcnt lgkmcnt(0)
    s_barrier
    s_add_u32 s14, s14, 1
    s_branch chain1_kernel_y3_step
chain1_kernel_bail:
    s_mov_b64 exec, 1
    s_load_dwordx2 s[6:7], s[0:1], 88
    s_waitcnt lgkmcnt(0)
    s_mov_b32 s24, s6
    s_mov_b32 s25, s7
    s_mov_b32 s26, 256
    s_mov_b32 s27, 0x00020000
    v_mov_b32 v1, 0xdead
    v_mov_b32 v2, s14
    v_mov_b32 v3, 0
    buffer_store_dword v1, v3, s[24:27], 0 offen
    buffer_store_dword v2, v3, s[24:27], 0 offen offset:4
chain1_kernel_end:
    s_endpgm
.section .rodata,"a"
.p2align 6
.amdhsa_kernel chain1_kernel
  .amdhsa_next_free_vgpr 512
  .amdhsa_next_free_sgpr 100
  .amdhsa_accum_offset 256
  .amdhsa_group_segment_fixed_size 0
  .amdhsa_kernarg_size 104
  .amdhsa_user_sgpr_count 2
  .amdhsa_user_sgpr_kernarg_segment_ptr 1
  .amdhsa_system_sgpr_workgroup_id_x 1
.end_amdhsa_kernel
.text
.globl w3a_kernel
.p2align 8
.type w3a_kernel,@function
w3a_kernel:
    s_cmp_ge_u32 s2, 512
    s_cbranch_scc1 w3a_kernel_end
    s_load_dwordx2 s[4:5], s[0:1], 96
    v_lshrrev_b32 v1, 6, v0
    v_and_b32 v0, 63, v0
    s_nop 0
    v_readfirstlane_b32 s13, v1
    s_waitcnt lgkmcnt(0)
    s_mov_b32 s8, s4
    s_mov_b32 s9, s5
    s_mov_b32 s10, 268435456
    s_mov_b32 s11, 0x00020000
    s_lshl_b32 s20, s2, 2
    s_add_u32 s20, s20, s13
    s_lshr_b32 s21, s20, 5
    s_and_b32 s22, s20, 31
    v_lshlrev_b32 v1, 4, v0
    v_and_b32 v2, 31, v0
    v_lshrrev_b32 v3, 5, v0
    s_lshl_b32 s24, s21, 5
    s_add_u32 s24, s24, s22
    s_mul_i32 s25, s24, 12288
    s_add_u32 s26, s25, 78643200
    s_add_u32 s27, s25, 53477376
    s_mul_i32 s28, s24, 3072
    s_add_u32 s28, s28, 208666624
    v_and_b32 v4, 7, v0
    v_lshlrev_b32 v4, 4, v4
    v_lshl_add_u32 v4, v3, 7, v4
    buffer_load_dwordx4 v[16:19], v1, s[8:11], s26 offen offset:0
    buffer_load_dwordx4 v[64:67], v1, s[8:11], s27 offen offset:0
    buffer_load_dwordx4 v[112:115], v4, s[8:11], s28 offen offset:0
    buffer_load_dwordx4 v[20:23], v1, s[8:11], s26 offen offset:1024
    buffer_load_dwordx4 v[68:71], v1, s[8:11], s27 offen offset:1024
    buffer_load_dwordx4 v[116:119], v4, s[8:11], s28 offen offset:256
    buffer_load_dwordx4 v[24:27], v1, s[8:11], s26 offen offset:2048
    buffer_load_dwordx4 v[72:75], v1, s[8:11], s27 offen offset:2048
    buffer_load_dwordx4 v[120:123], v4, s[8:11], s28 offen offset:512
    buffer_load_dwordx4 v[28:31], v1, s[8:11], s26 offen offset:3072
    buffer_load_dwordx4 v[76:79], v1, s[8:11], s27 offen offset:3072
    buffer_load_dwordx4 v[124:127], v4, s[8:11], s28 offen offset:768
    s_add_u32 s26, s26, 4096
    s_add_u32 s27, s27, 4096
    buffer_load_dwordx4 v[32:35], v1, s[8:11], s26 offen offset:0
    buffer_load_dwordx4 v[80:83], v1, s[8:11], s27 offen offset:0
    buffer_load_dwordx4 v[128:131], v4, s[8:11], s28 offen offset:1024
    buffer_load_dwordx4 v[36:39], v1, s[8:11], s26 offen offset:1024
    buffer_load_dwordx4 v[84:87], v1, s[8:11], s27 offen offset:1024
    buffer_load_dwordx4 v[132:135], v4, s[8:11], s28 offen offset:1280
    buffer_load_dwordx4 v[40:43], v1, s[8:11], s26 offen offset:2048
    buffer_load_dwordx4 v[88:91], v1, s[8:11], s27 offen offset:2048
    buffer_load_dwordx4 v[136:139], v4, s[8:11], s28 offen offset:1536
    buffer_load_dwordx4 v[44:47], v1, s[8:11], s26 offen offset:3072
    buffer_load_dwordx4 v[92:95], v1, s[8:11], s27 offen offset:3072
    buffer_load_dwordx4 v[140:143], v4, s[8:11], s28 offen offset:1792
    s_add_u32 s26, s26, 4096
    s_add_u32 s27, s27, 4096
    buffer_load_dwordx4 v[48:51], v1, s[8:11], s26 offen offset:0
    buffer_load_dwordx4 v[96:99], v1, s[8:11], s27 offen offset:0
    buffer_load_dwordx4 v[144:147], v4, s[8:11], s28 offen offset:2048
    buffer_load_dwordx4 v[52:55], v1, s[8:11], s26 offen offset:1024
    buffer_load_dwordx4 v[100:103], v1, s[8:11], s27 offen offset:1024
    buffer_load_dwordx4 v[148:151], v4, s[8:11], s28 offen offset:2304
    buffer_load_dwordx4 v[56:59], v1, s[8:11], s26 offen offset:2048
    buffer_load_dwordx4 v[104:107], v1, s[8:11], s27 offen offset:2048
    buffer_load_dwordx4 v[152:155], v4, s[8:11], s28 offen offset:2560
    buffer_load_dwordx4 v[60:63], v1, s[8:11], s26 offen offset:3072
    buffer_load_dwordx4 v[108:111], v1, s[8:11], s27 offen offset:3072
    buffer_load_dwordx4 v[156:159], v4, s[8:11], s28 offen offset:2816
    v_lshlrev_b32 v5, 2, v3
    v_sub_u32 v5, v2, v5
    v_mov_b32 v6, 0xf149f2ca
    v_cmp_gt_i32 vcc, 0, v5
    s_nop 1
    v_cndmask_b32 v192, 0, v6, vcc
    v_cmp_gt_i32 vcc, 1, v5
    s_nop 1
    v_cndmask_b32 v193, 0, v6, vcc
    v_cmp_gt_i32 vcc, 2, v5
    s_nop 1
    v_cndmask_b32 v194, 0, v6, vcc
    v_cmp_gt_i32 vcc, 3, v5
    s_nop 1
    v_cndmask_b32 v195, 0, v6, vcc
    v_cmp_gt_i32 vcc, 8, v5
    s_nop 1
    v_cndmask_b32 v196, 0, v6, vcc
    v_cmp_gt_i32 vcc, 9, v5
    s_nop 1
    v_cndmask_b32 v197, 0, v6, vcc
    v_cmp_gt_i32 vcc, 10, v5
    s_nop 1
    v_cndmask_b32 v198, 0, v6, vcc
    v_cmp_gt_i32 vcc, 11, v5
    s_nop 1
    v_cndmask_b32 v199, 0, v6, vcc
    v_cmp_gt_i32 vcc, 16, v5
    s_nop 1
    v_cndmask_b32 v200, 0, v6, vcc
    v_cmp_gt_i32 vcc, 17, v5
    s_nop 1
    v_cndmask_b32 v201, 0, v6, vcc
    v_cmp_gt_i32 vcc, 18, v5
    s_nop 1
    v_cndmask_b32 v202, 0, v6, vcc
    v_cmp_gt_i32 vcc, 19, v5
    s_nop 1
    v_cndmask_b32 v203, 0, v6, vcc
    v_cmp_gt_i32 vcc, 24, v5
    s_nop 1
    v_cndmask_b32 v204, 0, v6, vcc
    v_cmp_gt_i32 vcc, 25, v5
    s_nop 1
    v_cndmask_b32 v205, 0, v6, vcc
    v_cmp_gt_i32 vcc, 26, v5
    s_nop 1
    v_cndmask_b32 v206, 0, v6, vcc
    v_cmp_gt_i32 vcc, 27, v5
    s_nop 1
    v_cndmask_b32 v207, 0, v6, vcc
    s_waitcnt vmcnt(33)
    v_mfma_f32_32x32x16_bf16 v[160:175], v[64:67], v[16:19], 0
    v_mfma_f32_32x32x16_bf16 v[176:191], v[112:115], v[16:19], 0
    s_waitcnt vmcnt(30)
    v_mfma_f32_32x32x16_bf16 v[160:175], v[68:71], v[20:23], v[160:175]
    v_mfma_f32_32x32x16_bf16 v[176:191], v[116:119], v[20:23], v[176:191]
    s_waitcnt vmcnt(27)
    v_mfma_f32_32x32x16_bf16 v[160:175], v[72:75], v[24:27], v[160:175]
    v_mfma_f32_32x32x16_bf16 v[176:191], v[120:123], v[24:27], v[176:191]
    s_waitcnt vmcnt(24)
    v_mfma_f32_32x32x16_bf16 v[160:175], v[76:79], v[28:31], v[160:175]
    v_mfma_f32_32x32x16_bf16 v[176:191], v[124:127], v[28:31], v[176:191]
    s_waitcnt vmcnt(21)
    v_mfma_f32_32x32x16_bf16 v[160:175], v[80:83], v[32:35], v[160:175]
    v_mfma_f32_32x32x16_bf16 v[176:191], v[128:131], v[32:35], v[176:191]
    s_waitcnt vmcnt(18)
    v_mfma_f32_32x32x16_bf16 v[160:175], v[84:87], v[36:39], v[160:175]
    v_mfma_f32_32x32x16_bf16 v[176:191], v[132:135], v[36:39], v[176:191]
    s_waitcnt vmcnt(15)
    v_mfma_f32_32x32x16_bf16 v[160:175], v[88:91], v[40:43], v[160:175]
    v_mfma_f32_32x32x16_bf16 v[176:191], v[136:139], v[40:43], v[176:191]
    s_waitcnt vmcnt(12)
    v_mfma_f32_32x32x16_bf16 v[160:175], v[92:95], v[44:47], v[160:175]
    v_mfma_f32_32x32x16_bf16 v[176:191], v[140:143], v[44:47], v[176:191]
    s_waitcnt vmcnt(9)
    v_mfma_f32_32x32x16_bf16 v[160:175], v[96:99], v[48:51], v[160:175]
    v_mfma_f32_32x32x16_bf16 v[176:191], v[144:147], v[48:51], v[176:191]
    s_waitcnt vmcnt(6)
    v_mfma_f32_32x32x16_bf16 v[160:175], v[100:103], v[52:55], v[160:175]
    v_mfma_f32_32x32x16_bf16 v[176:191], v[148:151], v[52:55], v[176:191]
    s_waitcnt vmcnt(3)
    v_mfma_f32_32x32x16_bf16 v[160:175], v[104:107], v[56:59], v[160:175]
    v_mfma_f32_32x32x16_bf16 v[176:191], v[152:155], v[56:59], v[176:191]
    s_waitcnt vmcnt(0)
    v_mfma_f32_32x32x16_bf16 v[160:175], v[108:111], v[60:63], v[160:175]
    v_mfma_f32_32x32x16_bf16 v[176:191], v[156:159], v[60:63], v[176:191]
    s_nop 7
    s_nop 7
    v_mov_b32 v7, 0x3dd53b95
    v_fma_f32 v160, v160, v7, v192
    v_fma_f32 v161, v161, v7, v193
    v_fma_f32 v162, v162, v7, v194
    v_fma_f32 v163, v163, v7, v195
    v_fma_f32 v164, v164, v7, v196
    v_fma_f32 v165, v165, v7, v197
    v_fma_f32 v166, v166, v7, v198
    v_fma_f32 v167, v167, v7, v199
    v_fma_f32 v168, v168, v7, v200
    v_fma_f32 v169, v169, v7, v201
    v_fma_f32 v170, v170, v7, v202
    v_fma_f32 v171, v171, v7, v203
    v_fma_f32 v172, v172, v7, v204
    v_fma_f32 v173, v173, v7, v205
    v_fma_f32 v174, v174, v7, v206
    v_fma_f32 v175, v175, v7, v207
    v_mul_f32 v176, v176, v7
    v_mul_f32 v177, v177, v7
    v_mul_f32 v178, v178, v7
    v_mul_f32 v179, v179, v7
    v_max3_f32 v208, v160, v161, v162
    v_max3_f32 v208, v208, v163, v164
    v_max3_f32 v208, v208, v165, v166
    v_max3_f32 v208, v208, v167, v168
    v_max3_f32 v208, v208, v169, v170
    v_max3_f32 v208, v208, v171, v172
    v_max3_f32 v208, v208, v173, v174
    v_max3_f32 v208, v208, v175, v176
    v_max3_f32 v208, v208, v177, v178
    v_max_f32 v208, v208, v179
    v_mov_b32 v209, v208
    s_nop 1
    v_permlane32_swap_b32 v208, v209
    v_max_f32 v208, v208, v209
    v_sub_f32 v160, v160, v208
    v_sub_f32 v161, v161, v208
    v_sub_f32 v162, v162, v208
    v_sub_f32 v163, v163, v208
    v_sub_f32 v164, v164, v208
    v_sub_f32 v165, v165, v208
    v_sub_f32 v166, v166, v208
    v_sub_f32 v167, v167, v208
    v_sub_f32 v168, v168, v208
    v_sub_f32 v169, v169, v208
    v_sub_f32 v170, v170, v208
    v_sub_f32 v171, v171, v208
    v_sub_f32 v172, v172, v208
    v_sub_f32 v173, v173, v208
    v_sub_f32 v174, v174, v208
    v_sub_f32 v175, v175, v208
    v_sub_f32 v176, v176, v208
    v_sub_f32 v177, v177, v208
    v_sub_f32 v178, v178, v208
    v_sub_f32 v179, v179, v208
    v_exp_f32 v160, v160
    v_exp_f32 v161, v161
    v_exp_f32 v162, v162
    v_exp_f32 v163, v163
    v_exp_f32 v164, v164
    v_exp_f32 v165, v165
    v_exp_f32 v166, v166
    v_exp_f32 v167, v167
    v_exp_f32 v168, v168
    v_exp_f32 v169, v169
    v_exp_f32 v170, v170
    v_exp_f32 v171, v171
    v_exp_f32 v172, v172
    v_exp_f32 v173, v173
    v_exp_f32 v174, v174
    v_exp_f32 v175, v175
    v_exp_f32 v176, v176
    v_exp_f32 v177, v177
    v_exp_f32 v178, v178
    v_exp_f32 v179, v179
    s_nop 0
    v_add_f32 v210, v160, v161
    v_add_f32 v210, v210, v162
    v_add_f32 v210, v210, v163
    v_add_f32 v210, v210, v164
    v_add_f32 v210, v210, v165
    v_add_f32 v210, v210, v166
    v_add_f32 v210, v210, v167
    v_add_f32 v210, v210, v168
    v_add_f32 v210, v210, v169
    v_add_f32 v210, v210, v170
    v_add_f32 v210, v210, v171
    v_add_f32 v210, v210, v172
    v_add_f32 v210, v210, v173
    v_add_f32 v210, v210, v174
    v_add_f32 v210, v210, v175
    v_add_f32 v210, v210, v176
    v_add_f32 v210, v210, v177
    v_add_f32 v210, v210, v178
    v_add_f32 v210, v210, v179
    v_mov_b32 v209, v210
    s_nop 1
    v_permlane32_swap_b32 v210, v209
    v_add_f32 v210, v210, v209
    v_rcp_f32 v210, v210
    s_nop 0
    v_mul_f32 v160, v160, v210
    v_mul_f32 v161, v161, v210
    v_mul_f32 v162, v162, v210
    v_mul_f32 v163, v163, v210
    v_mul_f32 v164, v164, v210
    v_mul_f32 v165, v165, v210
    v_mul_f32 v166, v166, v210
    v_mul_f32 v167, v167, v210
    v_mul_f32 v168, v168, v210
    v_mul_f32 v169, v169, v210
    v_mul_f32 v170, v170, v210
    v_mul_f32 v171, v171, v210
    v_mul_f32 v172, v172, v210
    v_mul_f32 v173, v173, v210
    v_mul_f32 v174, v174, v210
    v_mul_f32 v175, v175, v210
    v_mul_f32 v176, v176, v210
    v_mul_f32 v177, v177, v210
    v_mul_f32 v178, v178, v210
    v_mul_f32 v179, v179, v210
    s_mul_i32 s25, s21, 81920
    s_mul_i32 s26, s22, 2560
    s_add_u32 s25, s25, s26
    s_add_u32 s25, s25, 214958080
    v_cvt_pk_bf16_f32 v16, v160, v161
    v_cvt_pk_bf16_f32 v17, v162, v163
    v_cvt_pk_bf16_f32 v18, v164, v165
    v_cvt_pk_bf16_f32 v19, v166, v167
    s_nop 1
    v_permlane32_swap_b32 v16, v18
    v_permlane32_swap_b32 v17, v19
    buffer_store_dwordx4 v[16:19], v1, s[8:11], s25 offen offset:512
    v_cvt_pk_bf16_f32 v20, v168, v169
    v_cvt_pk_bf16_f32 v21, v170, v171
    v_cvt_pk_bf16_f32 v22, v172, v173
    v_cvt_pk_bf16_f32 v23, v174, v175
    s_nop 1
    v_permlane32_swap_b32 v20, v22
    v_permlane32_swap_b32 v21, v23
    buffer_store_dwordx4 v[20:23], v1, s[8:11], s25 offen offset:1536
    v_cvt_pk_bf16_f32 v24, v176, v177
    v_cvt_pk_bf16_f32 v25, v178, v179
    v_lshlrev_b32 v4, 4, v2
    v_lshl_add_u32 v4, v3, 3, v4
    buffer_store_dwordx2 v[24:25], v4, s[8:11], s25 offen
w3a_kernel_end:
    s_endpgm
.section .rodata,"a"
.p2align 6
.amdhsa_kernel w3a_kernel
  .amdhsa_next_free_vgpr 216
  .amdhsa_next_free_sgpr 48
  .amdhsa_accum_offset 216
  .amdhsa_group_segment_fixed_size 0
  .amdhsa_kernarg_size 104
  .amdhsa_user_sgpr_count 2
  .amdhsa_user_sgpr_kernarg_segment_ptr 1
  .amdhsa_system_sgpr_workgroup_id_x 1
.end_amdhsa_kernel
.text
.globl w3b1_kernel
.p2align 8
.type w3b1_kernel,@function
w3b1_kernel:
    s_cmp_ge_u32 s2, 320
    s_cbranch_scc1 w3b1_kernel_end
    s_load_dwordx2 s[4:5], s[0:1], 96
    s_load_dwordx2 s[6:7], s[0:1], 80
    v_lshrrev_b32 v1, 6, v0
    v_and_b32 v0, 63, v0
    s_nop 0
    v_readfirstlane_b32 s13, v1
    s_waitcnt lgkmcnt(0)
    s_mov_b32 s8, s4
    s_mov_b32 s9, s5
    s_mov_b32 s10, 268435456
    s_mov_b32 s11, 0x00020000
    s_mov_b32 s16, s6
    s_mov_b32 s17, s7
    s_mov_b32 s18, 2621440
    s_mov_b32 s19, 0x00020000
    s_lshl_b32 s20, s2, 2
    s_add_u32 s20, s20, s13
    s_mul_i32 s21, s20, 3277
    s_lshr_b32 s21, s21, 16
    s_mul_i32 s22, s21, 20
    s_sub_u32 s22, s20, s22
    v_lshlrev_b32 v1, 4, v0
    v_and_b32 v2, 31, v0
    v_lshrrev_b32 v3, 5, v0
    v_lshrrev_b32 v4, 3, v2
    v_mul_u32_u24 v4, 20480, v4
    v_and_b32 v5, 7, v2
    v_lshl_add_u32 v4, v5, 4, v4
    v_lshl_add_u32 v4, v3, 7, v4
    s_mul_i32 s24, s21, 1638400
    s_mul_i32 s25, s22, 81920
    s_add_u32 s24, s24, s25
    s_add_u32 s24, s24, 103809024
    s_mul_i32 s25, s21, 81920
    s_add_u32 s25, s25, 214958080
    v_mul_u32_u24 v6, 1280, v2
    v_lshl_add_u32 v6, v3, 4, v6
    s_mul_i32 s26, s21, 40960
    s_lshl_b32 s27, s22, 6
    s_add_u32 s26, s26, s27
    s_add_u32 s27, s26, 226492416
    buffer_load_dwordx4 v[8:11], v6, s[8:11], s27 offen offset:0
    buffer_load_dwordx4 v[12:15], v6, s[8:11], s27 offen offset:32
    buffer_load_dwordx4 v[32:35], v4, s[8:11], s24 offen offset:0
    buffer_load_dwordx4 v[36:39], v1, s[8:11], s25 offen offset:0
    buffer_load_dwordx4 v[40:43], v4, s[8:11], s24 offen offset:256
    buffer_load_dwordx4 v[44:47], v1, s[8:11], s25 offen offset:1024
    buffer_load_dwordx4 v[48:51], v4, s[8:11], s24 offen offset:512
    buffer_load_dwordx4 v[52:55], v1, s[8:11], s25 offen offset:2048
    buffer_load_dwordx4 v[56:59], v4, s[8:11], s24 offen offset:768
    buffer_load_dwordx4 v[60:63], v1, s[8:11], s25 offen offset:3072
    s_add_u32 s25, s25, 4096
    buffer_load_dwordx4 v[64:67], v4, s[8:11], s24 offen offset:1024
    buffer_load_dwordx4 v[68:71], v1, s[8:11], s25 offen offset:0
    buffer_load_dwordx4 v[72:75], v4, s[8:11], s24 offen offset:1280
    buffer_load_dwordx4 v[76:79], v1, s[8:11], s25 offen offset:1024
    buffer_load_dwordx4 v[80:83], v4, s[8:11], s24 offen offset:1536
    buffer_load_dwordx4 v[84:87], v1, s[8:11], s25 offen offset:2048
    buffer_load_dwordx4 v[88:91], v4, s[8:11], s24 offen offset:1792
    buffer_load_dwordx4 v[92:95], v1, s[8:11], s25 offen offset:3072
    s_add_u32 s25, s25, 4096
    buffer_load_dwordx4 v[96:99], v4, s[8:11], s24 offen offset:2048
    buffer_load_dwordx4 v[100:103], v1, s[8:11], s25 offen offset:0
    buffer_load_dwordx4 v[104:107], v4, s[8:11], s24 offen offset:2304
    buffer_load_dwordx4 v[108:111], v1, s[8:11], s25 offen offset:1024
    buffer_load_dwordx4 v[112:115], v4, s[8:11], s24 offen offset:2560
    buffer_load_dwordx4 v[116:119], v1, s[8:11], s25 offen offset:2048
    buffer_load_dwordx4 v[120:123], v4, s[8:11], s24 offen offset:2816
    buffer_load_dwordx4 v[124:127], v1, s[8:11], s25 offen offset:3072
    s_waitcnt vmcnt(22)
    v_mfma_f32_32x32x16_bf16 v[16:31], v[32:35], v[36:39], 0
    s_waitcnt vmcnt(20)
    v_mfma_f32_32x32x16_bf16 v[16:31], v[40:43], v[44:47], v[16:31]
    s_add_u32 s25, s25, 4096
    buffer_load_dwordx4 v[32:35], v4, s[8:11], s24 offen offset:3072
    buffer_load_dwordx4 v[36:39], v1, s[8:11], s25 offen offset:0
    s_waitcnt vmcnt(20)
    v_mfma_f32_32x32x16_bf16 v[16:31], v[48:51], v[52:55], v[16:31]
    buffer_load_dwordx4 v[40:43], v4, s[8:11], s24 offen offset:3328
    buffer_load_dwordx4 v[44:47], v1, s[8:11], s25 offen offset:1024
    s_waitcnt vmcnt(20)
    v_mfma_f32_32x32x16_bf16 v[16:31], v[56:59], v[60:63], v[16:31]
    buffer_load_dwordx4 v[48:51], v4, s[8:11], s24 offen offset:3584
    buffer_load_dwordx4 v[52:55], v1, s[8:11], s25 offen offset:2048
    s_waitcnt vmcnt(20)
    v_mfma_f32_32x32x16_bf16 v[16:31], v[64:67], v[68:71], v[16:31]
    buffer_load_dwordx4 v[56:59], v4, s[8:11], s24 offen offset:3840
    buffer_load_dwordx4 v[60:63], v1, s[8:11], s25 offen offset:3072
    s_waitcnt vmcnt(20)
    v_mfma_f32_32x32x16_bf16 v[16:31], v[72:75], v[76:79], v[16:31]
    s_add_u32 s24, s24, 4096
    s_add_u32 s25, s25, 4096
    buffer_load_dwordx4 v[64:67], v4, s[8:11], s24 offen offset:0
    buffer_load_dwordx4 v[68:71], v1, s[8:11], s25 offen offset:0
    s_waitcnt vmcnt(20)
    v_mfma_f32_32x32x16_bf16 v[16:31], v[80:83], v[84:87], v[16:31]
    buffer_load_dwordx4 v[72:75], v4, s[8:11], s24 offen offset:256
    buffer_load_dwordx4 v[76:79], v1, s[8:11], s25 offen offset:1024
    s_waitcnt vmcnt(20)
    v_mfma_f32_32x32x16_bf16 v[16:31], v[88:91], v[92:95], v[16:31]
    buffer_load_dwordx4 v[80:83], v4, s[8:11], s24 offen offset:512
    buffer_load_dwordx4 v[84:87], v1, s[8:11], s25 offen offset:2048
    s_waitcnt vmcnt(20)
    v_mfma_f32_32x32x16_bf16 v[16:31], v[96:99], v[100:103], v[16:31]
    buffer_load_dwordx4 v[88:91], v4, s[8:11], s24 offen offset:768
    buffer_load_dwordx4 v[92:95], v1, s[8:11], s25 offen offset:3072
    s_waitcnt vmcnt(20)
    v_mfma_f32_32x32x16_bf16 v[16:31], v[104:107], v[108:111], v[16:31]
    s_add_u32 s25, s25, 4096
    buffer_load_dwordx4 v[96:99], v4, s[8:11], s24 offen offset:1024
    buffer_load_dwordx4 v[100:103], v1, s[8:11], s25 offen offset:0
    s_waitcnt vmcnt(20)
    v_mfma_f32_32x32x16_bf16 v[16:31], v[112:115], v[116:119], v[16:31]
    buffer_load_dwordx4 v[104:107], v4, s[8:11], s24 offen offset:1280
    buffer_load_dwordx4 v[108:111], v1, s[8:11], s25 offen offset:1024
    s_waitcnt vmcnt(20)
    v_mfma_f32_32x32x16_bf16 v[16:31], v[120:123], v[124:127], v[16:31]
    buffer_load_dwordx4 v[112:115], v4, s[8:11], s24 offen offset:1536
    buffer_load_dwordx4 v[116:119], v1, s[8:11], s25 offen offset:2048
    s_waitcnt vmcnt(20)
    v_mfma_f32_32x32x16_bf16 v[16:31], v[32:35], v[36:39], v[16:31]
    buffer_load_dwordx4 v[120:123], v4, s[8:11], s24 offen offset:1792
    buffer_load_dwordx4 v[124:127], v1, s[8:11], s25 offen offset:3072
    s_waitcnt vmcnt(20)
    v_mfma_f32_32x32x16_bf16 v[16:31], v[40:43], v[44:47], v[16:31]
    s_add_u32 s25, s25, 4096
    buffer_load_dwordx4 v[32:35], v4, s[8:11], s24 offen offset:2048
    buffer_load_dwordx4 v[36:39], v1, s[8:11], s25 offen offset:0
    s_waitcnt vmcnt(20)
    v_mfma_f32_32x32x16_bf16 v[16:31], v[48:51], v[52:55], v[16:31]
    buffer_load_dwordx4 v[40:43], v4, s[8:11], s24 offen offset:2304
    buffer_load_dwordx4 v[44:47], v1, s[8:11], s25 offen offset:1024
    s_waitcnt vmcnt(20)
    v_mfma_f32_32x32x16_bf16 v[16:31], v[56:59], v[60:63], v[16:31]
    buffer_load_dwordx4 v[48:51], v4, s[8:11], s24 offen offset:2560
    buffer_load_dwordx4 v[52:55], v1, s[8:11], s25 offen offset:2048
    s_waitcnt vmcnt(20)
    v_mfma_f32_32x32x16_bf16 v[16:31], v[64:67], v[68:71], v[16:31]
    buffer_load_dwordx4 v[56:59], v4, s[8:11], s24 offen offset:2816
    buffer_load_dwordx4 v[60:63], v1, s[8:11], s25 offen offset:3072
    s_waitcnt vmcnt(20)
    v_mfma_f32_32x32x16_bf16 v[16:31], v[72:75], v[76:79], v[16:31]
    s_add_u32 s25, s25, 4096
    buffer_load_dwordx4 v[64:67], v4, s[8:11], s24 offen offset:3072
    buffer_load_dwordx4 v[68:71], v1, s[8:11], s25 offen offset:0
    s_waitcnt vmcnt(20)
    v_mfma_f32_32x32x16_bf16 v[16:31], v[80:83], v[84:87], v[16:31]
    buffer_load_dwordx4 v[72:75], v4, s[8:11], s24 offen offset:3328
    buffer_load_dwordx4 v[76:79], v1, s[8:11], s25 offen offset:1024
    s_waitcnt vmcnt(20)
    v_mfma_f32_32x32x16_bf16 v[16:31], v[88:91], v[92:95], v[16:31]
    buffer_load_dwordx4 v[80:83], v4, s[8:11], s24 offen offset:3584
    buffer_load_dwordx4 v[84:87], v1, s[8:11], s25 offen offset:2048
    s_waitcnt vmcnt(20)
    v_mfma_f32_32x32x16_bf16 v[16:31], v[96:99], v[100:103], v[16:31]
    buffer_load_dwordx4 v[88:91], v4, s[8:11], s24 offen offset:3840
    buffer_load_dwordx4 v[92:95], v1, s[8:11], s25 offen offset:3072
    s_waitcnt vmcnt(20)
    v_mfma_f32_32x32x16_bf16 v[16:31], v[104:107], v[108:111], v[16:31]
    s_add_u32 s24, s24, 4096
    s_add_u32 s25, s25, 4096
    buffer_load_dwordx4 v[96:99], v4, s[8:11], s24 offen offset:0
    buffer_load_dwordx4 v[100:103], v1, s[8:11], s25 offen offset:0
    s_waitcnt vmcnt(20)
    v_mfma_f32_32x32x16_bf16 v[16:31], v[112:115], v[116:119], v[16:31]
    buffer_load_dwordx4 v[104:107], v4, s[8:11], s24 offen offset:256
    buffer_load_dwordx4 v[108:111], v1, s[8:11], s25 offen offset:1024
    s_waitcnt vmcnt(20)
    v_mfma_f32_32x32x16_bf16 v[16:31], v[120:123], v[124:127], v[16:31]
    buffer_load_dwordx4 v[112:115], v4, s[8:11], s24 offen offset:512
    buffer_load_dwordx4 v[116:119], v1, s[8:11], s25 offen offset:2048
    s_waitcnt vmcnt(20)
    v_mfma_f32_32x32x16_bf16 v[16:31], v[32:35], v[36:39], v[16:31]
    buffer_load_dwordx4 v[120:123], v4, s[8:11], s24 offen offset:768
    buffer_load_dwordx4 v[124:127], v1, s[8:11], s25 offen offset:3072
    s_waitcnt vmcnt(20)
    v_mfma_f32_32x32x16_bf16 v[16:31], v[40:43], v[44:47], v[16:31]
    s_add_u32 s25, s25, 4096
    buffer_load_dwordx4 v[32:35], v4, s[8:11], s24 offen offset:1024
    buffer_load_dwordx4 v[36:39], v1, s[8:11], s25 offen offset:0
    s_waitcnt vmcnt(20)
    v_mfma_f32_32x32x16_bf16 v[16:31], v[48:51], v[52:55], v[16:31]
    buffer_load_dwordx4 v[40:43], v4, s[8:11], s24 offen offset:1280
    buffer_load_dwordx4 v[44:47], v1, s[8:11], s25 offen offset:1024
    s_waitcnt vmcnt(20)
    v_mfma_f32_32x32x16_bf16 v[16:31], v[56:59], v[60:63], v[16:31]
    buffer_load_dwordx4 v[48:51], v4, s[8:11], s24 offen offset:1536
    buffer_load_dwordx4 v[52:55], v1, s[8:11], s25 offen offset:2048
    s_waitcnt vmcnt(20)
    v_mfma_f32_32x32x16_bf16 v[16:31], v[64:67], v[68:71], v[16:31]
    buffer_load_dwordx4 v[56:59], v4, s[8:11], s24 offen offset:1792
    buffer_load_dwordx4 v[60:63], v1, s[8:11], s25 offen offset:3072
    s_waitcnt vmcnt(20)
    v_mfma_f32_32x32x16_bf16 v[16:31], v[72:75], v[76:79], v[16:31]
    s_add_u32 s25, s25, 4096
    buffer_load_dwordx4 v[64:67], v4, s[8:11], s24 offen offset:2048
    buffer_load_dwordx4 v[68:71], v1, s[8:11], s25 offen offset:0
    s_waitcnt vmcnt(20)
    v_mfma_f32_32x32x16_bf16 v[16:31], v[80:83], v[84:87], v[16:31]
    buffer_load_dwordx4 v[72:75], v4, s[8:11], s24 offen offset:2304
    buffer_load_dwordx4 v[76:79], v1, s[8:11], s25 offen offset:1024
    s_waitcnt vmcnt(20)
    v_mfma_f32_32x32x16_bf16 v[16:31], v[88:91], v[92:95], v[16:31]
    buffer_load_dwordx4 v[80:83], v4, s[8:11], s24 offen offset:2560
    buffer_load_dwordx4 v[84:87], v1, s[8:11], s25 offen offset:2048
    s_waitcnt vmcnt(20)
    v_mfma_f32_32x32x16_bf16 v[16:31], v[96:99], v[100:103], v[16:31]
    buffer_load_dwordx4 v[88:91], v4, s[8:11], s24 offen offset:2816
    buffer_load_dwordx4 v[92:95], v1, s[8:11], s25 offen offset:3072
    s_waitcnt vmcnt(20)
    v_mfma_f32_32x32x16_bf16 v[16:31], v[104:107], v[108:111], v[16:31]
    s_add_u32 s25, s25, 4096
    buffer_load_dwordx4 v[96:99], v4, s[8:11], s24 offen offset:3072
    buffer_load_dwordx4 v[100:103], v1, s[8:11], s25 offen offset:0
    s_waitcnt vmcnt(20)
    v_mfma_f32_32x32x16_bf16 v[16:31], v[112:115], v[116:119], v[16:31]
    buffer_load_dwordx4 v[104:107], v4, s[8:11], s24 offen offset:3328
    buffer_load_dwordx4 v[108:111], v1, s[8:11], s25 offen offset:1024
    s_waitcnt vmcnt(20)
    v_mfma_f32_32x32x16_bf16 v[16:31], v[120:123], v[124:127], v[16:31]
    buffer_load_dwordx4 v[112:115], v4, s[8:11], s24 offen offset:3584
    buffer_load_dwordx4 v[116:119], v1, s[8:11], s25 offen offset:2048
    s_waitcnt vmcnt(20)
    v_mfma_f32_32x32x16_bf16 v[16:31], v[32:35], v[36:39], v[16:31]
    buffer_load_dwordx4 v[120:123], v4, s[8:11], s24 offen offset:3840
    buffer_load_dwordx4 v[124:127], v1, s[8:11], s25 offen offset:3072
    s_waitcnt vmcnt(20)
    v_mfma_f32_32x32x16_bf16 v[16:31], v[40:43], v[44:47], v[16:31]
    s_add_u32 s24, s24, 4096
    s_add_u32 s25, s25, 4096
    buffer_load_dwordx4 v[32:35], v4, s[8:11], s24 offen offset:0
    buffer_load_dwordx4 v[36:39], v1, s[8:11], s25 offen offset:0
    s_waitcnt vmcnt(20)
    v_mfma_f32_32x32x16_bf16 v[16:31], v[48:51], v[52:55], v[16:31]
    buffer_load_dwordx4 v[40:43], v4, s[8:11], s24 offen offset:256
    buffer_load_dwordx4 v[44:47], v1, s[8:11], s25 offen offset:1024
    s_waitcnt vmcnt(20)
    v_mfma_f32_32x32x16_bf16 v[16:31], v[56:59], v[60:63], v[16:31]
    buffer_load_dwordx4 v[48:51], v4, s[8:11], s24 offen offset:512
    buffer_load_dwordx4 v[52:55], v1, s[8:11], s25 offen offset:2048
    s_waitcnt vmcnt(20)
    v_mfma_f32_32x32x16_bf16 v[16:31], v[64:67], v[68:71], v[16:31]
    buffer_load_dwordx4 v[56:59], v4, s[8:11], s24 offen offset:768
    buffer_load_dwordx4 v[60:63], v1, s[8:11], s25 offen offset:3072
    s_waitcnt vmcnt(20)
    v_mfma_f32_32x32x16_bf16 v[16:31], v[72:75], v[76:79], v[16:31]
    s_add_u32 s25, s25, 4096
    buffer_load_dwordx4 v[64:67], v4, s[8:11], s24 offen offset:1024
    buffer_load_dwordx4 v[68:71], v1, s[8:11], s25 offen offset:0
    s_waitcnt vmcnt(20)
    v_mfma_f32_32x32x16_bf16 v[16:31], v[80:83], v[84:87], v[16:31]
    buffer_load_dwordx4 v[72:75], v4, s[8:11], s24 offen offset:1280
    buffer_load_dwordx4 v[76:79], v1, s[8:11], s25 offen offset:1024
    s_waitcnt vmcnt(20)
    v_mfma_f32_32x32x16_bf16 v[16:31], v[88:91], v[92:95], v[16:31]
    buffer_load_dwordx4 v[80:83], v4, s[8:11], s24 offen offset:1536
    buffer_load_dwordx4 v[84:87], v1, s[8:11], s25 offen offset:2048
    s_waitcnt vmcnt(20)
    v_mfma_f32_32x32x16_bf16 v[16:31], v[96:99], v[100:103], v[16:31]
    buffer_load_dwordx4 v[88:91], v4, s[8:11], s24 offen offset:1792
    buffer_load_dwordx4 v[92:95], v1, s[8:11], s25 offen offset:3072
    s_waitcnt vmcnt(20)
    v_mfma_f32_32x32x16_bf16 v[16:31], v[104:107], v[108:111], v[16:31]
    s_add_u32 s25, s25, 4096
    buffer_load_dwordx4 v[96:99], v4, s[8:11], s24 offen offset:2048
    buffer_load_dwordx4 v[100:103], v1, s[8:11], s25 offen offset:0
    s_waitcnt vmcnt(20)
    v_mfma_f32_32x32x16_bf16 v[16:31], v[112:115], v[116:119], v[16:31]
    buffer_load_dwordx4 v[104:107], v4, s[8:11], s24 offen offset:2304
    buffer_load_dwordx4 v[108:111], v1, s[8:11], s25 offen offset:1024
    s_waitcnt vmcnt(20)
    v_mfma_f32_32x32x16_bf16 v[16:31], v[120:123], v[124:127], v[16:31]
    buffer_load_dwordx4 v[112:115], v4, s[8:11], s24 offen offset:2560
    buffer_load_dwordx4 v[116:119], v1, s[8:11], s25 offen offset:2048
    s_waitcnt vmcnt(20)
    v_mfma_f32_32x32x16_bf16 v[16:31], v[32:35], v[36:39], v[16:31]
    buffer_load_dwordx4 v[120:123], v4, s[8:11], s24 offen offset:2816
    buffer_load_dwordx4 v[124:127], v1, s[8:11], s25 offen offset:3072
    s_waitcnt vmcnt(20)
    v_mfma_f32_32x32x16_bf16 v[16:31], v[40:43], v[44:47], v[16:31]
    s_add_u32 s25, s25, 4096
    buffer_load_dwordx4 v[32:35], v4, s[8:11], s24 offen offset:3072
    buffer_load_dwordx4 v[36:39], v1, s[8:11], s25 offen offset:0
    s_waitcnt vmcnt(20)
    v_mfma_f32_32x32x16_bf16 v[16:31], v[48:51], v[52:55], v[16:31]
    buffer_load_dwordx4 v[40:43], v4, s[8:11], s24 offen offset:3328
    buffer_load_dwordx4 v[44:47], v1, s[8:11], s25 offen offset:1024
    s_waitcnt vmcnt(20)
    v_mfma_f32_32x32x16_bf16 v[16:31], v[56:59], v[60:63], v[16:31]
    buffer_load_dwordx4 v[48:51], v4, s[8:11], s24 offen offset:3584
    buffer_load_dwordx4 v[52:55], v1, s[8:11], s25 offen offset:2048
    s_waitcnt vmcnt(20)
    v_mfma_f32_32x32x16_bf16 v[16:31], v[64:67], v[68:71], v[16:31]
    buffer_load_dwordx4 v[56:59], v4, s[8:11], s24 offen offset:3840
    buffer_load_dwordx4 v[60:63], v1, s[8:11], s25 offen offset:3072
    s_waitcnt vmcnt(20)
    v_mfma_f32_32x32x16_bf16 v[16:31], v[72:75], v[76:79], v[16:31]
    s_add_u32 s24, s24, 4096
    s_add_u32 s25, s25, 4096
    buffer_load_dwordx4 v[64:67], v4, s[8:11], s24 offen offset:0
    buffer_load_dwordx4 v[68:71], v1, s[8:11], s25 offen offset:0
    s_waitcnt vmcnt(20)
    v_mfma_f32_32x32x16_bf16 v[16:31], v[80:83], v[84:87], v[16:31]
    buffer_load_dwordx4 v[72:75], v4, s[8:11], s24 offen offset:256
    buffer_load_dwordx4 v[76:79], v1, s[8:11], s25 offen offset:1024
    s_waitcnt vmcnt(20)
    v_mfma_f32_32x32x16_bf16 v[16:31], v[88:91], v[92:95], v[16:31]
    buffer_load_dwordx4 v[80:83], v4, s[8:11], s24 offen offset:512
    buffer_load_dwordx4 v[84:87], v1, s[8:11], s25 offen offset:2048
    s_waitcnt vmcnt(20)
    v_mfma_f32_32x32x16_bf16 v[16:31], v[96:99], v[100:103], v[16:31]
    buffer_load_dwordx4 v[88:91], v4, s[8:11], s24 offen offset:768
    buffer_load_dwordx4 v[92:95], v1, s[8:11], s25 offen offset:3072
    s_waitcnt vmcnt(20)
    v_mfma_f32_32x32x16_bf16 v[16:31], v[104:107], v[108:111], v[16:31]
    s_add_u32 s25, s25, 4096
    buffer_load_dwordx4 v[96:99], v4, s[8:11], s24 offen offset:1024
    buffer_load_dwordx4 v[100:103], v1, s[8:11], s25 offen offset:0
    s_waitcnt vmcnt(20)
    v_mfma_f32_32x32x16_bf16 v[16:31], v[112:115], v[116:119], v[16:31]
    buffer_load_dwordx4 v[104:107], v4, s[8:11], s24 offen offset:1280
    buffer_load_dwordx4 v[108:111], v1, s[8:11], s25 offen offset:1024
    s_waitcnt vmcnt(20)
    v_mfma_f32_32x32x16_bf16 v[16:31], v[120:123], v[124:127], v[16:31]
    buffer_load_dwordx4 v[112:115], v4, s[8:11], s24 offen offset:1536
    buffer_load_dwordx4 v[116:119], v1, s[8:11], s25 offen offset:2048
    s_waitcnt vmcnt(20)
    v_mfma_f32_32x32x16_bf16 v[16:31], v[32:35], v[36:39], v[16:31]
    buffer_load_dwordx4 v[120:123], v4, s[8:11], s24 offen offset:1792
    buffer_load_dwordx4 v[124:127], v1, s[8:11], s25 offen offset:3072
    s_waitcnt vmcnt(20)
    v_mfma_f32_32x32x16_bf16 v[16:31], v[40:43], v[44:47], v[16:31]
    s_add_u32 s25, s25, 4096
    buffer_load_dwordx4 v[32:35], v4, s[8:11], s24 offen offset:2048
    buffer_load_dwordx4 v[36:39], v1, s[8:11], s25 offen offset:0
    s_waitcnt vmcnt(20)
    v_mfma_f32_32x32x16_bf16 v[16:31], v[48:51], v[52:55], v[16:31]
    buffer_load_dwordx4 v[40:43], v4, s[8:11], s24 offen offset:2304
    buffer_load_dwordx4 v[44:47], v1, s[8:11], s25 offen offset:1024
    s_waitcnt vmcnt(20)
    v_mfma_f32_32x32x16_bf16 v[16:31], v[56:59], v[60:63], v[16:31]
    buffer_load_dwordx4 v[48:51], v4, s[8:11], s24 offen offset:2560
    buffer_load_dwordx4 v[52:55], v1, s[8:11], s25 offen offset:2048
    s_waitcnt vmcnt(20)
    v_mfma_f32_32x32x16_bf16 v[16:31], v[64:67], v[68:71], v[16:31]
    buffer_load_dwordx4 v[56:59], v4, s[8:11], s24 offen offset:2816
    buffer_load_dwordx4 v[60:63], v1, s[8:11], s25 offen offset:3072
    s_waitcnt vmcnt(20)
    v_mfma_f32_32x32x16_bf16 v[16:31], v[72:75], v[76:79], v[16:31]
    s_add_u32 s25, s25, 4096
    buffer_load_dwordx4 v[64:67], v4, s[8:11], s24 offen offset:3072
    buffer_load_dwordx4 v[68:71], v1, s[8:11], s25 offen offset:0
    s_waitcnt vmcnt(20)
    v_mfma_f32_32x32x16_bf16 v[16:31], v[80:83], v[84:87], v[16:31]
    buffer_load_dwordx4 v[72:75], v4, s[8:11], s24 offen offset:3328
    buffer_load_dwordx4 v[76:79], v1, s[8:11], s25 offen offset:1024
    s_waitcnt vmcnt(20)
    v_mfma_f32_32x32x16_bf16 v[16:31], v[88:91], v[92:95], v[16:31]
    buffer_load_dwordx4 v[80:83], v4, s[8:11], s24 offen offset:3584
    buffer_load_dwordx4 v[84:87], v1, s[8:11], s25 offen offset:2048
    s_waitcnt vmcnt(20)
    v_mfma_f32_32x32x16_bf16 v[16:31], v[96:99], v[100:103], v[16:31]
    buffer_load_dwordx4 v[88:91], v4, s[8:11], s24 offen offset:3840
    buffer_load_dwordx4 v[92:95], v1, s[8:11], s25 offen offset:3072
    s_waitcnt vmcnt(20)
    v_mfma_f32_32x32x16_bf16 v[16:31], v[104:107], v[108:111], v[16:31]
    s_waitcnt vmcnt(18)
    v_mfma_f32_32x32x16_bf16 v[16:31], v[112:115], v[116:119], v[16:31]
    s_waitcnt vmcnt(16)
    v_mfma_f32_32x32x16_bf16 v[16:31], v[120:123], v[124:127], v[16:31]
    s_waitcnt vmcnt(14)
    v_mfma_f32_32x32x16_bf16 v[16:31], v[32:35], v[36:39], v[16:31]
    s_waitcnt vmcnt(12)
    v_mfma_f32_32x32x16_bf16 v[16:31], v[40:43], v[44:47], v[16:31]
    s_waitcnt vmcnt(10)
    v_mfma_f32_32x32x16_bf16 v[16:31], v[48:51], v[52:55], v[16:31]
    s_waitcnt vmcnt(8)
    v_mfma_f32_32x32x16_bf16 v[16:31], v[56:59], v[60:63], v[16:31]
    s_waitcnt vmcnt(6)
    v_mfma_f32_32x32x16_bf16 v[16:31], v[64:67], v[68:71], v[16:31]
    s_waitcnt vmcnt(4)
    v_mfma_f32_32x32x16_bf16 v[16:31], v[72:75], v[76:79], v[16:31]
    s_waitcnt vmcnt(2)
    v_mfma_f32_32x32x16_bf16 v[16:31], v[80:83], v[84:87], v[16:31]
    s_waitcnt vmcnt(0)
    v_mfma_f32_32x32x16_bf16 v[16:31], v[88:91], v[92:95], v[16:31]
    s_nop 7
    s_nop 7
    v_cvt_pk_bf16_f32 v32, v16, v17
    v_cvt_pk_bf16_f32 v33, v18, v19
    v_cvt_pk_bf16_f32 v34, v20, v21
    v_cvt_pk_bf16_f32 v35, v22, v23
    s_nop 1
    v_permlane32_swap_b32 v32, v34
    v_permlane32_swap_b32 v33, v35
    s_nop 1
    v_lshlrev_b32 v40, 16, v32
    v_and_b32 v41, 0xffff0000, v32
    v_lshlrev_b32 v42, 16, v8
    v_and_b32 v43, 0xffff0000, v8
    v_add_f32 v40, v40, v42
    v_add_f32 v41, v41, v43
    v_cvt_pk_bf16_f32 v32, v40, v41
    v_lshlrev_b32 v40, 16, v33
    v_and_b32 v41, 0xffff0000, v33
    v_lshlrev_b32 v42, 16, v9
    v_and_b32 v43, 0xffff0000, v9
    v_add_f32 v40, v40, v42
    v_add_f32 v41, v41, v43
    v_cvt_pk_bf16_f32 v33, v40, v41
    v_lshlrev_b32 v40, 16, v34
    v_and_b32 v41, 0xffff0000, v34
    v_lshlrev_b32 v42, 16, v10
    v_and_b32 v43, 0xffff0000, v10
    v_add_f32 v40, v40, v42
    v_add_f32 v41, v41, v43
    v_cvt_pk_bf16_f32 v34, v40, v41
    v_lshlrev_b32 v40, 16, v35
    v_and_b32 v41, 0xffff0000, v35
    v_lshlrev_b32 v42, 16, v11
    v_and_b32 v43, 0xffff0000, v11
    v_add_f32 v40, v40, v42
    v_add_f32 v41, v41, v43
    v_cvt_pk_bf16_f32 v35, v40, v41
    s_add_u32 s27, s26, 247463936
    buffer_store_dwordx4 v[32:35], v6, s[8:11], s27 offen offset:0
    v_cvt_pk_bf16_f32 v36, v24, v25
    v_cvt_pk_bf16_f32 v37, v26, v27
    v_cvt_pk_bf16_f32 v38, v28, v29
    v_cvt_pk_bf16_f32 v39, v30, v31
    s_nop 1
    v_permlane32_swap_b32 v36, v38
    v_permlane32_swap_b32 v37, v39
    s_nop 1
    v_lshlrev_b32 v40, 16, v36
    v_and_b32 v41, 0xffff0000, v36
    v_lshlrev_b32 v42, 16, v12
    v_and_b32 v43, 0xffff0000, v12
    v_add_f32 v40, v40, v42
    v_add_f32 v41, v41, v43
    v_cvt_pk_bf16_f32 v36, v40, v41
    v_lshlrev_b32 v40, 16, v37
    v_and_b32 v41, 0xffff0000, v37
    v_lshlrev_b32 v42, 16, v13
    v_and_b32 v43, 0xffff0000, v13
    v_add_f32 v40, v40, v42
    v_add_f32 v41, v41, v43
    v_cvt_pk_bf16_f32 v37, v40, v41
    v_lshlrev_b32 v40, 16, v38
    v_and_b32 v41, 0xffff0000, v38
    v_lshlrev_b32 v42, 16, v14
    v_and_b32 v43, 0xffff0000, v14
    v_add_f32 v40, v40, v42
    v_add_f32 v41, v41, v43
    v_cvt_pk_bf16_f32 v38, v40, v41
    v_lshlrev_b32 v40, 16, v39
    v_and_b32 v41, 0xffff0000, v39
    v_lshlrev_b32 v42, 16, v15
    v_and_b32 v43, 0xffff0000, v15
    v_add_f32 v40, v40, v42
    v_add_f32 v41, v41, v43
    v_cvt_pk_bf16_f32 v39, v40, v41
    s_add_u32 s27, s26, 247463936
    buffer_store_dwordx4 v[36:39], v6, s[8:11], s27 offen offset:32
w3b1_kernel_end:
    s_endpgm
.section .rodata,"a"
.p2align 6
.amdhsa_kernel w3b1_kernel
  .amdhsa_next_free_vgpr 128
  .amdhsa_next_free_sgpr 48
  .amdhsa_accum_offset 128
  .amdhsa_group_segment_fixed_size 0
  .amdhsa_kernarg_size 104
  .amdhsa_user_sgpr_count 2
  .amdhsa_user_sgpr_kernarg_segment_ptr 1
  .amdhsa_system_sgpr_workgroup_id_x 1
.end_amdhsa_kernel
.text
.globl ln_a2_kernel
.p2align 8
.type ln_a2_kernel,@function
ln_a2_kernel:
    v_lshrrev_b32 v1, 6, v0
    v_and_b32 v2, 63, v0
    s_nop 0
    v_readfirstlane_b32 s3, v1
    s_lshl_b32 s4, s2, 2
    s_add_u32 s4, s4, s3
    s_cmp_ge_u32 s4, 2048
    s_cbranch_scc1 ln_a2_kernel_end
    s_load_dwordx2 s[6:7], s[0:1], 96
    s_load_dwordx2 s[12:13], s[0:1], 96
    s_waitcnt lgkmcnt(0)
    s_add_u32 s8, s6, 247463936
    s_addc_u32 s9, s7, 0
    s_mov_b32 s10, 2621440
    s_mov_b32 s11, 0x00020000
    s_add_u32 s16, s12, 223346688
    s_addc_u32 s17, s13, 0
    s_mov_b32 s18, 2621440
    s_mov_b32 s19, 0x00020000
    s_mul_i32 s5, s4, 1280
    v_lshlrev_b32 v3, 2, v2
    v_add_u32 v3, s5, v3
    buffer_load_dword v4, v3, s[8:11], 0 offen offset:0
    buffer_load_dword v5, v3, s[8:11], 0 offen offset:256
    buffer_load_dword v6, v3, s[8:11], 0 offen offset:512
    buffer_load_dword v7, v3, s[8:11], 0 offen offset:768
    buffer_load_dword v8, v3, s[8:11], 0 offen offset:1024
    s_waitcnt vmcnt(0)
    v_lshlrev_b32 v10, 16, v4
    v_and_b32 v11, 0xffff0000, v4
    v_lshlrev_b32 v12, 16, v5
    v_and_b32 v13, 0xffff0000, v5
    v_lshlrev_b32 v14, 16, v6
    v_and_b32 v15, 0xffff0000, v6
    v_lshlrev_b32 v16, 16, v7
    v_and_b32 v17, 0xffff0000, v7
    v_lshlrev_b32 v18, 16, v8
    v_and_b32 v19, 0xffff0000, v8
    v_add_f32 v20, v10, v11
    v_add_f32 v20, v20, v12
    v_add_f32 v20, v20, v13
    v_add_f32 v20, v20, v14
    v_add_f32 v20, v20, v15
    v_add_f32 v20, v20, v16
    v_add_f32 v20, v20, v17
    v_add_f32 v20, v20, v18
    v_add_f32 v20, v20, v19
    s_nop 1
    v_add_f32 v21, v20, v20 quad_perm:[1,0,3,2] row_mask:0xf bank_mask:0xf
    s_nop 1
    v_add_f32 v21, v21, v21 quad_perm:[2,3,0,1] row_mask:0xf bank_mask:0xf
    s_nop 1
    v_add_f32 v21, v21, v21 row_half_mirror row_mask:0xf bank_mask:0xf
    s_nop 1
    v_add_f32 v21, v21, v21 row_mirror row_mask:0xf bank_mask:0xf
    s_nop 1
    v_readlane_b32 s24, v21, 0
    v_readlane_b32 s25, v21, 16
    v_readlane_b32 s26, v21, 32
    v_readlane_b32 s27, v21, 48
    s_nop 1
    v_mov_b32 v20, s24
    v_add_f32 v20, s25, v20
    v_add_f32 v20, s26, v20
    v_add_f32 v20, s27, v20
    v_mul_f32 v20, 0.0015625, v20
    v_sub_f32 v10, v10, v20
    v_sub_f32 v11, v11, v20
    v_sub_f32 v12, v12, v20
    v_sub_f32 v13, v13, v20
    v_sub_f32 v14, v14, v20
    v_sub_f32 v15, v15, v20
    v_sub_f32 v16, v16, v20
    v_sub_f32 v17, v17, v20
    v_sub_f32 v18, v18, v20
    v_sub_f32 v19, v19, v20
    v_mul_f32 v21, v10, v10
    v_fmac_f32 v21, v11, v11
    v_fmac_f32 v21, v12, v12
    v_fmac_f32 v21, v13, v13
    v_fmac_f32 v21, v14, v14
    v_fmac_f32 v21, v15, v15
    v_fmac_f32 v21, v16, v16
    v_fmac_f32 v21, v17, v17
    v_fmac_f32 v21, v18, v18
    v_fmac_f32 v21, v19, v19
    s_nop 1
    v_add_f32 v22, v21, v21 quad_perm:[1,0,3,2] row_mask:0xf bank_mask:0xf
    s_nop 1
    v_add_f32 v22, v22, v22 quad_perm:[2,3,0,1] row_mask:0xf bank_mask:0xf
    s_nop 1
    v_add_f32 v22, v22, v22 row_half_mirror row_mask:0xf bank_mask:0xf
    s_nop 1
    v_add_f32 v22, v22, v22 row_mirror row_mask:0xf bank_mask:0xf
    s_nop 1
    v_readlane_b32 s24, v22, 0
    v_readlane_b32 s25, v22, 16
    v_readlane_b32 s26, v22, 32
    v_readlane_b32 s27, v22, 48
    s_nop 1
    v_mov_b32 v21, s24
    v_add_f32 v21, s25, v21
    v_add_f32 v21, s26, v21
    v_add_f32 v21, s27, v21
    v_mov_b32 v22, 0x3727c5ac
    v_fmac_f32 v22, 0.0015625, v21
    v_rsq_f32 v22, v22
    s_nop 0
    v_mul_f32 v10, v10, v22
    v_mul_f32 v11, v11, v22
    v_mul_f32 v12, v12, v22
    v_mul_f32 v13, v13, v22
    v_mul_f32 v14, v14, v22
    v_mul_f32 v15, v15, v22
    v_mul_f32 v16, v16, v22
    v_mul_f32 v17, v17, v22
    v_mul_f32 v18, v18, v22
    v_mul_f32 v19, v19, v22
    v_cvt_pk_bf16_f32 v4, v10, v11
    v_cvt_pk_bf16_f32 v5, v12, v13
    v_cvt_pk_bf16_f32 v6, v14, v15
    v_cvt_pk_bf16_f32 v7, v16, v17
    v_cvt_pk_bf16_f32 v8, v18, v19
    buffer_store_dword v4, v3, s[16:19], 0 offen offset:0
    buffer_store_dword v5, v3, s[16:19], 0 offen offset:256
    buffer_store_dword v6, v3, s[16:19], 0 offen offset:512
    buffer_store_dword v7, v3, s[16:19], 0 offen offset:768
    buffer_store_dword v8, v3, s[16:19], 0 offen offset:1024
ln_a2_kernel_end:
    s_endpgm
.section .rodata,"a"
.p2align 6
.amdhsa_kernel ln_a2_kernel
  .amdhsa_next_free_vgpr 32
  .amdhsa_next_free_sgpr 40
  .amdhsa_accum_offset 32
  .amdhsa_group_segment_fixed_size 0
  .amdhsa_kernarg_size 104
  .amdhsa_user_sgpr_count 2
  .amdhsa_user_sgpr_kernarg_segment_ptr 1
  .amdhsa_system_sgpr_workgroup_id_x 1
.end_amdhsa_kernel
.text
.globl kvz_a2_kernel
.p2align 8
.type kvz_a2_kernel,@function
kvz_a2_kernel:
    v_lshrrev_b32 v1, 6, v0
    v_and_b32 v2, 63, v0
    s_nop 0
    v_readfirstlane_b32 s3, v1
    s_lshl_b32 s4, s2, 2
    s_add_u32 s4, s4, s3
    s_cmp_ge_u32 s4, 512
    s_cbranch_scc1 kvz_a2_kernel_end
    s_load_dwordx2 s[6:7], s[0:1], 96
    s_waitcnt lgkmcnt(0)
    s_mov_b32 s8, s6
    s_mov_b32 s9, s7
    s_mov_b32 s10, 268435456
    s_mov_b32 s11, 0x00020000
    s_lshr_b32 s5, s4, 4
    s_and_b32 s12, s4, 15
    s_mul_i32 s13, s5, 20
    v_and_b32 v3, 15, v2
    v_lshrrev_b32 v4, 4, v2
    s_lshl_b32 s14, s12, 7
    v_lshlrev_b32 v5, 3, v4
    v_add_u32 v5, s14, v5
    v_add_u32 v6, 0, v3
    v_min_u32 v8, 19, v6
    v_add_u32 v8, s13, v8
    v_lshlrev_b32 v8, 11, v8
    v_add_u32 v8, v8, v5
    v_lshlrev_b32 v8, 1, v8
    v_add_u32 v8, 232783872, v8
    v_add_u32 v10, 2621440, v8
    v_add_u32 v7, 16, v3
    v_min_u32 v9, 19, v7
    v_add_u32 v9, s13, v9
    v_lshlrev_b32 v9, 11, v9
    v_add_u32 v9, v9, v5
    v_lshlrev_b32 v9, 1, v9
    v_add_u32 v9, 232783872, v9
    v_add_u32 v11, 2621440, v9
    v_accvgpr_write_b32 a0, 0
    v_accvgpr_write_b32 a1, 0
    v_accvgpr_write_b32 a2, 0
    v_accvgpr_write_b32 a3, 0
    v_accvgpr_write_b32 a4, 0
    v_accvgpr_write_b32 a5, 0
    v_accvgpr_write_b32 a6, 0
    v_accvgpr_write_b32 a7, 0
    v_accvgpr_write_b32 a8, 0
    v_accvgpr_write_b32 a9, 0
    v_accvgpr_write_b32 a10, 0
    v_accvgpr_write_b32 a11, 0
    v_accvgpr_write_b32 a12, 0
    v_accvgpr_write_b32 a13, 0
    v_accvgpr_write_b32 a14, 0
    v_accvgpr_write_b32 a15, 0
    v_cmp_gt_u32 s[16:17], 20, v7
    v_cmp_eq_u32 s[18:19], 20, v7
    buffer_load_dwordx4 v[16:19], v8, s[8:11], 0 offen offset:0
    buffer_load_dwordx4 v[24:27], v10, s[8:11], 0 offen offset:0
    buffer_load_dwordx4 v[20:23], v9, s[8:11], 0 offen offset:0
    buffer_load_dwordx4 v[28:31], v11, s[8:11], 0 offen offset:0
    s_waitcnt vmcnt(0)
    v_lshlrev_b32 v32, 16, v16
    v_and_b32 v33, 0xffff0000, v16
    v_mul_f32 v36, 1.4426950408889634, v32
    v_exp_f32 v36, v36
    v_add_f32 v34, 1.0, v32
    v_cmp_lt_f32 vcc, 0, v32
    s_nop 1
    v_cndmask_b32 v34, v36, v34, vcc
    v_add_f32 v34, 0x358637bd, v34
    v_mul_f32 v36, 1.4426950408889634, v33
    v_exp_f32 v36, v36
    v_add_f32 v35, 1.0, v33
    v_cmp_lt_f32 vcc, 0, v33
    s_nop 1
    v_cndmask_b32 v35, v36, v35, vcc
    v_add_f32 v35, 0x358637bd, v35
    v_cvt_pk_bf16_f32 v16, v34, v35
    v_lshlrev_b32 v32, 16, v17
    v_and_b32 v33, 0xffff0000, v17
    v_mul_f32 v36, 1.4426950408889634, v32
    v_exp_f32 v36, v36
    v_add_f32 v34, 1.0, v32
    v_cmp_lt_f32 vcc, 0, v32
    s_nop 1
    v_cndmask_b32 v34, v36, v34, vcc
    v_add_f32 v34, 0x358637bd, v34
    v_mul_f32 v36, 1.4426950408889634, v33
    v_exp_f32 v36, v36
    v_add_f32 v35, 1.0, v33
    v_cmp_lt_f32 vcc, 0, v33
    s_nop 1
    v_cndmask_b32 v35, v36, v35, vcc
    v_add_f32 v35, 0x358637bd, v35
    v_cvt_pk_bf16_f32 v17, v34, v35
    v_lshlrev_b32 v32, 16, v18
    v_and_b32 v33, 0xffff0000, v18
    v_mul_f32 v36, 1.4426950408889634, v32
    v_exp_f32 v36, v36
    v_add_f32 v34, 1.0, v32
    v_cmp_lt_f32 vcc, 0, v32
    s_nop 1
    v_cndmask_b32 v34, v36, v34, vcc
    v_add_f32 v34, 0x358637bd, v34
    v_mul_f32 v36, 1.4426950408889634, v33
    v_exp_f32 v36, v36
    v_add_f32 v35, 1.0, v33
    v_cmp_lt_f32 vcc, 0, v33
    s_nop 1
    v_cndmask_b32 v35, v36, v35, vcc
    v_add_f32 v35, 0x358637bd, v35
    v_cvt_pk_bf16_f32 v18, v34, v35
    v_lshlrev_b32 v32, 16, v19
    v_and_b32 v33, 0xffff0000, v19
    v_mul_f32 v36, 1.4426950408889634, v32
    v_exp_f32 v36, v36
    v_add_f32 v34, 1.0, v32
    v_cmp_lt_f32 vcc, 0, v32
    s_nop 1
    v_cndmask_b32 v34, v36, v34, vcc
    v_add_f32 v34, 0x358637bd, v34
    v_mul_f32 v36, 1.4426950408889634, v33
    v_exp_f32 v36, v36
    v_add_f32 v35, 1.0, v33
    v_cmp_lt_f32 vcc, 0, v33
    s_nop 1
    v_cndmask_b32 v35, v36, v35, vcc
    v_add_f32 v35, 0x358637bd, v35
    v_cvt_pk_bf16_f32 v19, v34, v35
    v_lshlrev_b32 v32, 16, v20
    v_and_b32 v33, 0xffff0000, v20
    v_mul_f32 v36, 1.4426950408889634, v32
    v_exp_f32 v36, v36
    v_add_f32 v34, 1.0, v32
    v_cmp_lt_f32 vcc, 0, v32
    s_nop 1
    v_cndmask_b32 v34, v36, v34, vcc
    v_add_f32 v34, 0x358637bd, v34
    v_mul_f32 v36, 1.4426950408889634, v33
    v_exp_f32 v36, v36
    v_add_f32 v35, 1.0, v33
    v_cmp_lt_f32 vcc, 0, v33
    s_nop 1
    v_cndmask_b32 v35, v36, v35, vcc
    v_add_f32 v35, 0x358637bd, v35
    v_cvt_pk_bf16_f32 v20, v34, v35
    v_lshlrev_b32 v32, 16, v21
    v_and_b32 v33, 0xffff0000, v21
    v_mul_f32 v36, 1.4426950408889634, v32
    v_exp_f32 v36, v36
    v_add_f32 v34, 1.0, v32
    v_cmp_lt_f32 vcc, 0, v32
    s_nop 1
    v_cndmask_b32 v34, v36, v34, vcc
    v_add_f32 v34, 0x358637bd, v34
    v_mul_f32 v36, 1.4426950408889634, v33
    v_exp_f32 v36, v36
    v_add_f32 v35, 1.0, v33
    v_cmp_lt_f32 vcc, 0, v33
    s_nop 1
    v_cndmask_b32 v35, v36, v35, vcc
    v_add_f32 v35, 0x358637bd, v35
    v_cvt_pk_bf16_f32 v21, v34, v35
    v_lshlrev_b32 v32, 16, v22
    v_and_b32 v33, 0xffff0000, v22
    v_mul_f32 v36, 1.4426950408889634, v32
    v_exp_f32 v36, v36
    v_add_f32 v34, 1.0, v32
    v_cmp_lt_f32 vcc, 0, v32
    s_nop 1
    v_cndmask_b32 v34, v36, v34, vcc
    v_add_f32 v34, 0x358637bd, v34
    v_mul_f32 v36, 1.4426950408889634, v33
    v_exp_f32 v36, v36
    v_add_f32 v35, 1.0, v33
    v_cmp_lt_f32 vcc, 0, v33
    s_nop 1
    v_cndmask_b32 v35, v36, v35, vcc
    v_add_f32 v35, 0x358637bd, v35
    v_cvt_pk_bf16_f32 v22, v34, v35
    v_lshlrev_b32 v32, 16, v23
    v_and_b32 v33, 0xffff0000, v23
    v_mul_f32 v36, 1.4426950408889634, v32
    v_exp_f32 v36, v36
    v_add_f32 v34, 1.0, v32
    v_cmp_lt_f32 vcc, 0, v32
    s_nop 1
    v_cndmask_b32 v34, v36, v34, vcc
    v_add_f32 v34, 0x358637bd, v34
    v_mul_f32 v36, 1.4426950408889634, v33
    v_exp_f32 v36, v36
    v_add_f32 v35, 1.0, v33
    v_cmp_lt_f32 vcc, 0, v33
    s_nop 1
    v_cndmask_b32 v35, v36, v35, vcc
    v_add_f32 v35, 0x358637bd, v35
    v_cvt_pk_bf16_f32 v23, v34, v35
    v_mov_b32 v37, 0x3f803f80
    v_cndmask_b32 v20, 0, v20, s[16:17]
    v_cndmask_b32 v28, 0, v28, s[16:17]
    v_cndmask_b32 v28, v28, v37, s[18:19]
    v_cndmask_b32 v21, 0, v21, s[16:17]
    v_cndmask_b32 v29, 0, v29, s[16:17]
    v_cndmask_b32 v29, v29, v37, s[18:19]
    v_cndmask_b32 v22, 0, v22, s[16:17]
    v_cndmask_b32 v30, 0, v30, s[16:17]
    v_cndmask_b32 v30, v30, v37, s[18:19]
    v_cndmask_b32 v23, 0, v23, s[16:17]
    v_cndmask_b32 v31, 0, v31, s[16:17]
    v_cndmask_b32 v31, v31, v37, s[18:19]
    s_nop 1
    v_mfma_f32_16x16x32_bf16 a[0:3], v[24:27], v[16:19], a[0:3]
    v_mfma_f32_16x16x32_bf16 a[4:7], v[24:27], v[20:23], a[4:7]
    v_mfma_f32_16x16x32_bf16 a[8:11], v[28:31], v[16:19], a[8:11]
    v_mfma_f32_16x16x32_bf16 a[12:15], v[28:31], v[20:23], a[12:15]
    buffer_load_dwordx4 v[16:19], v8, s[8:11], 0 offen offset:64
    buffer_load_dwordx4 v[24:27], v10, s[8:11], 0 offen offset:64
    buffer_load_dwordx4 v[20:23], v9, s[8:11], 0 offen offset:64
    buffer_load_dwordx4 v[28:31], v11, s[8:11], 0 offen offset:64
    s_waitcnt vmcnt(0)
    v_lshlrev_b32 v32, 16, v16
    v_and_b32 v33, 0xffff0000, v16
    v_mul_f32 v36, 1.4426950408889634, v32
    v_exp_f32 v36, v36
    v_add_f32 v34, 1.0, v32
    v_cmp_lt_f32 vcc, 0, v32
    s_nop 1
    v_cndmask_b32 v34, v36, v34, vcc
    v_add_f32 v34, 0x358637bd, v34
    v_mul_f32 v36, 1.4426950408889634, v33
    v_exp_f32 v36, v36
    v_add_f32 v35, 1.0, v33
    v_cmp_lt_f32 vcc, 0, v33
    s_nop 1
    v_cndmask_b32 v35, v36, v35, vcc
    v_add_f32 v35, 0x358637bd, v35
    v_cvt_pk_bf16_f32 v16, v34, v35
    v_lshlrev_b32 v32, 16, v17
    v_and_b32 v33, 0xffff0000, v17
    v_mul_f32 v36, 1.4426950408889634, v32
    v_exp_f32 v36, v36
    v_add_f32 v34, 1.0, v32
    v_cmp_lt_f32 vcc, 0, v32
    s_nop 1
    v_cndmask_b32 v34, v36, v34, vcc
    v_add_f32 v34, 0x358637bd, v34
    v_mul_f32 v36, 1.4426950408889634, v33
    v_exp_f32 v36, v36
    v_add_f32 v35, 1.0, v33
    v_cmp_lt_f32 vcc, 0, v33
    s_nop 1
    v_cndmask_b32 v35, v36, v35, vcc
    v_add_f32 v35, 0x358637bd, v35
    v_cvt_pk_bf16_f32 v17, v34, v35
    v_lshlrev_b32 v32, 16, v18
    v_and_b32 v33, 0xffff0000, v18
    v_mul_f32 v36, 1.4426950408889634, v32
    v_exp_f32 v36, v36
    v_add_f32 v34, 1.0, v32
    v_cmp_lt_f32 vcc, 0, v32
    s_nop 1
    v_cndmask_b32 v34, v36, v34, vcc
    v_add_f32 v34, 0x358637bd, v34
    v_mul_f32 v36, 1.4426950408889634, v33
    v_exp_f32 v36, v36
    v_add_f32 v35, 1.0, v33
    v_cmp_lt_f32 vcc, 0, v33
    s_nop 1
    v_cndmask_b32 v35, v36, v35, vcc
    v_add_f32 v35, 0x358637bd, v35
    v_cvt_pk_bf16_f32 v18, v34, v35
    v_lshlrev_b32 v32, 16, v19
    v_and_b32 v33, 0xffff0000, v19
    v_mul_f32 v36, 1.4426950408889634, v32
    v_exp_f32 v36, v36
    v_add_f32 v34, 1.0, v32
    v_cmp_lt_f32 vcc, 0, v32
    s_nop 1
    v_cndmask_b32 v34, v36, v34, vcc
    v_add_f32 v34, 0x358637bd, v34
    v_mul_f32 v36, 1.4426950408889634, v33
    v_exp_f32 v36, v36
    v_add_f32 v35, 1.0, v33
    v_cmp_lt_f32 vcc, 0, v33
    s_nop 1
    v_cndmask_b32 v35, v36, v35, vcc
    v_add_f32 v35, 0x358637bd, v35
    v_cvt_pk_bf16_f32 v19, v34, v35
    v_lshlrev_b32 v32, 16, v20
    v_and_b32 v33, 0xffff0000, v20
    v_mul_f32 v36, 1.4426950408889634, v32
    v_exp_f32 v36, v36
    v_add_f32 v34, 1.0, v32
    v_cmp_lt_f32 vcc, 0, v32
    s_nop 1
    v_cndmask_b32 v34, v36, v34, vcc
    v_add_f32 v34, 0x358637bd, v34
    v_mul_f32 v36, 1.4426950408889634, v33
    v_exp_f32 v36, v36
    v_add_f32 v35, 1.0, v33
    v_cmp_lt_f32 vcc, 0, v33
    s_nop 1
    v_cndmask_b32 v35, v36, v35, vcc
    v_add_f32 v35, 0x358637bd, v35
    v_cvt_pk_bf16_f32 v20, v34, v35
    v_lshlrev_b32 v32, 16, v21
    v_and_b32 v33, 0xffff0000, v21
    v_mul_f32 v36, 1.4426950408889634, v32
    v_exp_f32 v36, v36
    v_add_f32 v34, 1.0, v32
    v_cmp_lt_f32 vcc, 0, v32
    s_nop 1
    v_cndmask_b32 v34, v36, v34, vcc
    v_add_f32 v34, 0x358637bd, v34
    v_mul_f32 v36, 1.4426950408889634, v33
    v_exp_f32 v36, v36
    v_add_f32 v35, 1.0, v33
    v_cmp_lt_f32 vcc, 0, v33
    s_nop 1
    v_cndmask_b32 v35, v36, v35, vcc
    v_add_f32 v35, 0x358637bd, v35
    v_cvt_pk_bf16_f32 v21, v34, v35
    v_lshlrev_b32 v32, 16, v22
    v_and_b32 v33, 0xffff0000, v22
    v_mul_f32 v36, 1.4426950408889634, v32
    v_exp_f32 v36, v36
    v_add_f32 v34, 1.0, v32
    v_cmp_lt_f32 vcc, 0, v32
    s_nop 1
    v_cndmask_b32 v34, v36, v34, vcc
    v_add_f32 v34, 0x358637bd, v34
    v_mul_f32 v36, 1.4426950408889634, v33
    v_exp_f32 v36, v36
    v_add_f32 v35, 1.0, v33
    v_cmp_lt_f32 vcc, 0, v33
    s_nop 1
    v_cndmask_b32 v35, v36, v35, vcc
    v_add_f32 v35, 0x358637bd, v35
    v_cvt_pk_bf16_f32 v22, v34, v35
    v_lshlrev_b32 v32, 16, v23
    v_and_b32 v33, 0xffff0000, v23
    v_mul_f32 v36, 1.4426950408889634, v32
    v_exp_f32 v36, v36
    v_add_f32 v34, 1.0, v32
    v_cmp_lt_f32 vcc, 0, v32
    s_nop 1
    v_cndmask_b32 v34, v36, v34, vcc
    v_add_f32 v34, 0x358637bd, v34
    v_mul_f32 v36, 1.4426950408889634, v33
    v_exp_f32 v36, v36
    v_add_f32 v35, 1.0, v33
    v_cmp_lt_f32 vcc, 0, v33
    s_nop 1
    v_cndmask_b32 v35, v36, v35, vcc
    v_add_f32 v35, 0x358637bd, v35
    v_cvt_pk_bf16_f32 v23, v34, v35
    v_mov_b32 v37, 0x3f803f80
    v_cndmask_b32 v20, 0, v20, s[16:17]
    v_cndmask_b32 v28, 0, v28, s[16:17]
    v_cndmask_b32 v28, v28, v37, s[18:19]
    v_cndmask_b32 v21, 0, v21, s[16:17]
    v_cndmask_b32 v29, 0, v29, s[16:17]
    v_cndmask_b32 v29, v29, v37, s[18:19]
    v_cndmask_b32 v22, 0, v22, s[16:17]
    v_cndmask_b32 v30, 0, v30, s[16:17]
    v_cndmask_b32 v30, v30, v37, s[18:19]
    v_cndmask_b32 v23, 0, v23, s[16:17]
    v_cndmask_b32 v31, 0, v31, s[16:17]
    v_cndmask_b32 v31, v31, v37, s[18:19]
    s_nop 1
    v_mfma_f32_16x16x32_bf16 a[0:3], v[24:27], v[16:19], a[0:3]
    v_mfma_f32_16x16x32_bf16 a[4:7], v[24:27], v[20:23], a[4:7]
    v_mfma_f32_16x16x32_bf16 a[8:11], v[28:31], v[16:19], a[8:11]
    v_mfma_f32_16x16x32_bf16 a[12:15], v[28:31], v[20:23], a[12:15]
    buffer_load_dwordx4 v[16:19], v8, s[8:11], 0 offen offset:128
    buffer_load_dwordx4 v[24:27], v10, s[8:11], 0 offen offset:128
    buffer_load_dwordx4 v[20:23], v9, s[8:11], 0 offen offset:128
    buffer_load_dwordx4 v[28:31], v11, s[8:11], 0 offen offset:128
    s_waitcnt vmcnt(0)
    v_lshlrev_b32 v32, 16, v16
    v_and_b32 v33, 0xffff0000, v16
    v_mul_f32 v36, 1.4426950408889634, v32
    v_exp_f32 v36, v36
    v_add_f32 v34, 1.0, v32
    v_cmp_lt_f32 vcc, 0, v32
    s_nop 1
    v_cndmask_b32 v34, v36, v34, vcc
    v_add_f32 v34, 0x358637bd, v34
    v_mul_f32 v36, 1.4426950408889634, v33
    v_exp_f32 v36, v36
    v_add_f32 v35, 1.0, v33
    v_cmp_lt_f32 vcc, 0, v33
    s_nop 1
    v_cndmask_b32 v35, v36, v35, vcc
    v_add_f32 v35, 0x358637bd, v35
    v_cvt_pk_bf16_f32 v16, v34, v35
    v_lshlrev_b32 v32, 16, v17
    v_and_b32 v33, 0xffff0000, v17
    v_mul_f32 v36, 1.4426950408889634, v32
    v_exp_f32 v36, v36
    v_add_f32 v34, 1.0, v32
    v_cmp_lt_f32 vcc, 0, v32
    s_nop 1
    v_cndmask_b32 v34, v36, v34, vcc
    v_add_f32 v34, 0x358637bd, v34
    v_mul_f32 v36, 1.4426950408889634, v33
    v_exp_f32 v36, v36
    v_add_f32 v35, 1.0, v33
    v_cmp_lt_f32 vcc, 0, v33
    s_nop 1
    v_cndmask_b32 v35, v36, v35, vcc
    v_add_f32 v35, 0x358637bd, v35
    v_cvt_pk_bf16_f32 v17, v34, v35
    v_lshlrev_b32 v32, 16, v18
    v_and_b32 v33, 0xffff0000, v18
    v_mul_f32 v36, 1.4426950408889634, v32
    v_exp_f32 v36, v36
    v_add_f32 v34, 1.0, v32
    v_cmp_lt_f32 vcc, 0, v32
    s_nop 1
    v_cndmask_b32 v34, v36, v34, vcc
    v_add_f32 v34, 0x358637bd, v34
    v_mul_f32 v36, 1.4426950408889634, v33
    v_exp_f32 v36, v36
    v_add_f32 v35, 1.0, v33
    v_cmp_lt_f32 vcc, 0, v33
    s_nop 1
    v_cndmask_b32 v35, v36, v35, vcc
    v_add_f32 v35, 0x358637bd, v35
    v_cvt_pk_bf16_f32 v18, v34, v35
    v_lshlrev_b32 v32, 16, v19
    v_and_b32 v33, 0xffff0000, v19
    v_mul_f32 v36, 1.4426950408889634, v32
    v_exp_f32 v36, v36
    v_add_f32 v34, 1.0, v32
    v_cmp_lt_f32 vcc, 0, v32
    s_nop 1
    v_cndmask_b32 v34, v36, v34, vcc
    v_add_f32 v34, 0x358637bd, v34
    v_mul_f32 v36, 1.4426950408889634, v33
    v_exp_f32 v36, v36
    v_add_f32 v35, 1.0, v33
    v_cmp_lt_f32 vcc, 0, v33
    s_nop 1
    v_cndmask_b32 v35, v36, v35, vcc
    v_add_f32 v35, 0x358637bd, v35
    v_cvt_pk_bf16_f32 v19, v34, v35
    v_lshlrev_b32 v32, 16, v20
    v_and_b32 v33, 0xffff0000, v20
    v_mul_f32 v36, 1.4426950408889634, v32
    v_exp_f32 v36, v36
    v_add_f32 v34, 1.0, v32
    v_cmp_lt_f32 vcc, 0, v32
    s_nop 1
    v_cndmask_b32 v34, v36, v34, vcc
    v_add_f32 v34, 0x358637bd, v34
    v_mul_f32 v36, 1.4426950408889634, v33
    v_exp_f32 v36, v36
    v_add_f32 v35, 1.0, v33
    v_cmp_lt_f32 vcc, 0, v33
    s_nop 1
    v_cndmask_b32 v35, v36, v35, vcc
    v_add_f32 v35, 0x358637bd, v35
    v_cvt_pk_bf16_f32 v20, v34, v35
    v_lshlrev_b32 v32, 16, v21
    v_and_b32 v33, 0xffff0000, v21
    v_mul_f32 v36, 1.4426950408889634, v32
    v_exp_f32 v36, v36
    v_add_f32 v34, 1.0, v32
    v_cmp_lt_f32 vcc, 0, v32
    s_nop 1
    v_cndmask_b32 v34, v36, v34, vcc
    v_add_f32 v34, 0x358637bd, v34
    v_mul_f32 v36, 1.4426950408889634, v33
    v_exp_f32 v36, v36
    v_add_f32 v35, 1.0, v33
    v_cmp_lt_f32 vcc, 0, v33
    s_nop 1
    v_cndmask_b32 v35, v36, v35, vcc
    v_add_f32 v35, 0x358637bd, v35
    v_cvt_pk_bf16_f32 v21, v34, v35
    v_lshlrev_b32 v32, 16, v22
    v_and_b32 v33, 0xffff0000, v22
    v_mul_f32 v36, 1.4426950408889634, v32
    v_exp_f32 v36, v36
    v_add_f32 v34, 1.0, v32
    v_cmp_lt_f32 vcc, 0, v32
    s_nop 1
    v_cndmask_b32 v34, v36, v34, vcc
    v_add_f32 v34, 0x358637bd, v34
    v_mul_f32 v36, 1.4426950408889634, v33
    v_exp_f32 v36, v36
    v_add_f32 v35, 1.0, v33
    v_cmp_lt_f32 vcc, 0, v33
    s_nop 1
    v_cndmask_b32 v35, v36, v35, vcc
    v_add_f32 v35, 0x358637bd, v35
    v_cvt_pk_bf16_f32 v22, v34, v35
    v_lshlrev_b32 v32, 16, v23
    v_and_b32 v33, 0xffff0000, v23
    v_mul_f32 v36, 1.4426950408889634, v32
    v_exp_f32 v36, v36
    v_add_f32 v34, 1.0, v32
    v_cmp_lt_f32 vcc, 0, v32
    s_nop 1
    v_cndmask_b32 v34, v36, v34, vcc
    v_add_f32 v34, 0x358637bd, v34
    v_mul_f32 v36, 1.4426950408889634, v33
    v_exp_f32 v36, v36
    v_add_f32 v35, 1.0, v33
    v_cmp_lt_f32 vcc, 0, v33
    s_nop 1
    v_cndmask_b32 v35, v36, v35, vcc
    v_add_f32 v35, 0x358637bd, v35
    v_cvt_pk_bf16_f32 v23, v34, v35
    v_mov_b32 v37, 0x3f803f80
    v_cndmask_b32 v20, 0, v20, s[16:17]
    v_cndmask_b32 v28, 0, v28, s[16:17]
    v_cndmask_b32 v28, v28, v37, s[18:19]
    v_cndmask_b32 v21, 0, v21, s[16:17]
    v_cndmask_b32 v29, 0, v29, s[16:17]
    v_cndmask_b32 v29, v29, v37, s[18:19]
    v_cndmask_b32 v22, 0, v22, s[16:17]
    v_cndmask_b32 v30, 0, v30, s[16:17]
    v_cndmask_b32 v30, v30, v37, s[18:19]
    v_cndmask_b32 v23, 0, v23, s[16:17]
    v_cndmask_b32 v31, 0, v31, s[16:17]
    v_cndmask_b32 v31, v31, v37, s[18:19]
    s_nop 1
    v_mfma_f32_16x16x32_bf16 a[0:3], v[24:27], v[16:19], a[0:3]
    v_mfma_f32_16x16x32_bf16 a[4:7], v[24:27], v[20:23], a[4:7]
    v_mfma_f32_16x16x32_bf16 a[8:11], v[28:31], v[16:19], a[8:11]
    v_mfma_f32_16x16x32_bf16 a[12:15], v[28:31], v[20:23], a[12:15]
    buffer_load_dwordx4 v[16:19], v8, s[8:11], 0 offen offset:192
    buffer_load_dwordx4 v[24:27], v10, s[8:11], 0 offen offset:192
    buffer_load_dwordx4 v[20:23], v9, s[8:11], 0 offen offset:192
    buffer_load_dwordx4 v[28:31], v11, s[8:11], 0 offen offset:192
    s_waitcnt vmcnt(0)
    v_lshlrev_b32 v32, 16, v16
    v_and_b32 v33, 0xffff0000, v16
    v_mul_f32 v36, 1.4426950408889634, v32
    v_exp_f32 v36, v36
    v_add_f32 v34, 1.0, v32
    v_cmp_lt_f32 vcc, 0, v32
    s_nop 1
    v_cndmask_b32 v34, v36, v34, vcc
    v_add_f32 v34, 0x358637bd, v34
    v_mul_f32 v36, 1.4426950408889634, v33
    v_exp_f32 v36, v36
    v_add_f32 v35, 1.0, v33
    v_cmp_lt_f32 vcc, 0, v33
    s_nop 1
    v_cndmask_b32 v35, v36, v35, vcc
    v_add_f32 v35, 0x358637bd, v35
    v_cvt_pk_bf16_f32 v16, v34, v35
    v_lshlrev_b32 v32, 16, v17
    v_and_b32 v33, 0xffff0000, v17
    v_mul_f32 v36, 1.4426950408889634, v32
    v_exp_f32 v36, v36
    v_add_f32 v34, 1.0, v32
    v_cmp_lt_f32 vcc, 0, v32
    s_nop 1
    v_cndmask_b32 v34, v36, v34, vcc
    v_add_f32 v34, 0x358637bd, v34
    v_mul_f32 v36, 1.4426950408889634, v33
    v_exp_f32 v36, v36
    v_add_f32 v35, 1.0, v33
    v_cmp_lt_f32 vcc, 0, v33
    s_nop 1
    v_cndmask_b32 v35, v36, v35, vcc
    v_add_f32 v35, 0x358637bd, v35
    v_cvt_pk_bf16_f32 v17, v34, v35
    v_lshlrev_b32 v32, 16, v18
    v_and_b32 v33, 0xffff0000, v18
    v_mul_f32 v36, 1.4426950408889634, v32
    v_exp_f32 v36, v36
    v_add_f32 v34, 1.0, v32
    v_cmp_lt_f32 vcc, 0, v32
    s_nop 1
    v_cndmask_b32 v34, v36, v34, vcc
    v_add_f32 v34, 0x358637bd, v34
    v_mul_f32 v36, 1.4426950408889634, v33
    v_exp_f32 v36, v36
    v_add_f32 v35, 1.0, v33
    v_cmp_lt_f32 vcc, 0, v33
    s_nop 1
    v_cndmask_b32 v35, v36, v35, vcc
    v_add_f32 v35, 0x358637bd, v35
    v_cvt_pk_bf16_f32 v18, v34, v35
    v_lshlrev_b32 v32, 16, v19
    v_and_b32 v33, 0xffff0000, v19
    v_mul_f32 v36, 1.4426950408889634, v32
    v_exp_f32 v36, v36
    v_add_f32 v34, 1.0, v32
    v_cmp_lt_f32 vcc, 0, v32
    s_nop 1
    v_cndmask_b32 v34, v36, v34, vcc
    v_add_f32 v34, 0x358637bd, v34
    v_mul_f32 v36, 1.4426950408889634, v33
    v_exp_f32 v36, v36
    v_add_f32 v35, 1.0, v33
    v_cmp_lt_f32 vcc, 0, v33
    s_nop 1
    v_cndmask_b32 v35, v36, v35, vcc
    v_add_f32 v35, 0x358637bd, v35
    v_cvt_pk_bf16_f32 v19, v34, v35
    v_lshlrev_b32 v32, 16, v20
    v_and_b32 v33, 0xffff0000, v20
    v_mul_f32 v36, 1.4426950408889634, v32
    v_exp_f32 v36, v36
    v_add_f32 v34, 1.0, v32
    v_cmp_lt_f32 vcc, 0, v32
    s_nop 1
    v_cndmask_b32 v34, v36, v34, vcc
    v_add_f32 v34, 0x358637bd, v34
    v_mul_f32 v36, 1.4426950408889634, v33
    v_exp_f32 v36, v36
    v_add_f32 v35, 1.0, v33
    v_cmp_lt_f32 vcc, 0, v33
    s_nop 1
    v_cndmask_b32 v35, v36, v35, vcc
    v_add_f32 v35, 0x358637bd, v35
    v_cvt_pk_bf16_f32 v20, v34, v35
    v_lshlrev_b32 v32, 16, v21
    v_and_b32 v33, 0xffff0000, v21
    v_mul_f32 v36, 1.4426950408889634, v32
    v_exp_f32 v36, v36
    v_add_f32 v34, 1.0, v32
    v_cmp_lt_f32 vcc, 0, v32
    s_nop 1
    v_cndmask_b32 v34, v36, v34, vcc
    v_add_f32 v34, 0x358637bd, v34
    v_mul_f32 v36, 1.4426950408889634, v33
    v_exp_f32 v36, v36
    v_add_f32 v35, 1.0, v33
    v_cmp_lt_f32 vcc, 0, v33
    s_nop 1
    v_cndmask_b32 v35, v36, v35, vcc
    v_add_f32 v35, 0x358637bd, v35
    v_cvt_pk_bf16_f32 v21, v34, v35
    v_lshlrev_b32 v32, 16, v22
    v_and_b32 v33, 0xffff0000, v22
    v_mul_f32 v36, 1.4426950408889634, v32
    v_exp_f32 v36, v36
    v_add_f32 v34, 1.0, v32
    v_cmp_lt_f32 vcc, 0, v32
    s_nop 1
    v_cndmask_b32 v34, v36, v34, vcc
    v_add_f32 v34, 0x358637bd, v34
    v_mul_f32 v36, 1.4426950408889634, v33
    v_exp_f32 v36, v36
    v_add_f32 v35, 1.0, v33
    v_cmp_lt_f32 vcc, 0, v33
    s_nop 1
    v_cndmask_b32 v35, v36, v35, vcc
    v_add_f32 v35, 0x358637bd, v35
    v_cvt_pk_bf16_f32 v22, v34, v35
    v_lshlrev_b32 v32, 16, v23
    v_and_b32 v33, 0xffff0000, v23
    v_mul_f32 v36, 1.4426950408889634, v32
    v_exp_f32 v36, v36
    v_add_f32 v34, 1.0, v32
    v_cmp_lt_f32 vcc, 0, v32
    s_nop 1
    v_cndmask_b32 v34, v36, v34, vcc
    v_add_f32 v34, 0x358637bd, v34
    v_mul_f32 v36, 1.4426950408889634, v33
    v_exp_f32 v36, v36
    v_add_f32 v35, 1.0, v33
    v_cmp_lt_f32 vcc, 0, v33
    s_nop 1
    v_cndmask_b32 v35, v36, v35, vcc
    v_add_f32 v35, 0x358637bd, v35
    v_cvt_pk_bf16_f32 v23, v34, v35
    v_mov_b32 v37, 0x3f803f80
    v_cndmask_b32 v20, 0, v20, s[16:17]
    v_cndmask_b32 v28, 0, v28, s[16:17]
    v_cndmask_b32 v28, v28, v37, s[18:19]
    v_cndmask_b32 v21, 0, v21, s[16:17]
    v_cndmask_b32 v29, 0, v29, s[16:17]
    v_cndmask_b32 v29, v29, v37, s[18:19]
    v_cndmask_b32 v22, 0, v22, s[16:17]
    v_cndmask_b32 v30, 0, v30, s[16:17]
    v_cndmask_b32 v30, v30, v37, s[18:19]
    v_cndmask_b32 v23, 0, v23, s[16:17]
    v_cndmask_b32 v31, 0, v31, s[16:17]
    v_cndmask_b32 v31, v31, v37, s[18:19]
    s_nop 1
    v_mfma_f32_16x16x32_bf16 a[0:3], v[24:27], v[16:19], a[0:3]
    v_mfma_f32_16x16x32_bf16 a[4:7], v[24:27], v[20:23], a[4:7]
    v_mfma_f32_16x16x32_bf16 a[8:11], v[28:31], v[16:19], a[8:11]
    v_mfma_f32_16x16x32_bf16 a[12:15], v[28:31], v[20:23], a[12:15]
    s_nop 7
    s_nop 7
    v_lshlrev_b32 v5, 2, v4
    v_lshlrev_b32 v5, 5, v5
    v_add_u32 v5, v5, v3
    v_lshlrev_b32 v5, 2, v5
    s_lshl_b32 s14, s5, 12
    s_add_u32 s14, s14, 242352128
    v_add_u32 v5, s14, v5
    v_accvgpr_read_b32 v40, a0
    v_accvgpr_read_b32 v41, a1
    v_accvgpr_read_b32 v42, a2
    v_accvgpr_read_b32 v43, a3
    buffer_atomic_add_f32 v40, v5, s[8:11], 0 offen offset:0
    buffer_atomic_add_f32 v41, v5, s[8:11], 0 offen offset:128
    buffer_atomic_add_f32 v42, v5, s[8:11], 0 offen offset:256
    buffer_atomic_add_f32 v43, v5, s[8:11], 0 offen offset:384
    v_accvgpr_read_b32 v40, a4
    v_accvgpr_read_b32 v41, a5
    v_accvgpr_read_b32 v42, a6
    v_accvgpr_read_b32 v43, a7
    buffer_atomic_add_f32 v40, v5, s[8:11], 0 offen offset:64
    buffer_atomic_add_f32 v41, v5, s[8:11], 0 offen offset:192
    buffer_atomic_add_f32 v42, v5, s[8:11], 0 offen offset:320
    buffer_atomic_add_f32 v43, v5, s[8:11], 0 offen offset:448
    v_accvgpr_read_b32 v40, a8
    v_accvgpr_read_b32 v41, a9
    v_accvgpr_read_b32 v42, a10
    v_accvgpr_read_b32 v43, a11
    buffer_atomic_add_f32 v40, v5, s[8:11], 0 offen offset:2048
    buffer_atomic_add_f32 v41, v5, s[8:11], 0 offen offset:2176
    buffer_atomic_add_f32 v42, v5, s[8:11], 0 offen offset:2304
    buffer_atomic_add_f32 v43, v5, s[8:11], 0 offen offset:2432
    v_accvgpr_read_b32 v40, a12
    v_accvgpr_read_b32 v41, a13
    v_accvgpr_read_b32 v42, a14
    v_accvgpr_read_b32 v43, a15
    buffer_atomic_add_f32 v40, v5, s[8:11], 0 offen offset:2112
    buffer_atomic_add_f32 v41, v5, s[8:11], 0 offen offset:2240
    buffer_atomic_add_f32 v42, v5, s[8:11], 0 offen offset:2368
    buffer_atomic_add_f32 v43, v5, s[8:11], 0 offen offset:2496
kvz_a2_kernel_end:
    s_endpgm
.section .rodata,"a"
.p2align 6
.amdhsa_kernel kvz_a2_kernel
  .amdhsa_next_free_vgpr 80
  .amdhsa_next_free_sgpr 40
  .amdhsa_accum_offset 64
  .amdhsa_group_segment_fixed_size 0
  .amdhsa_kernarg_size 104
  .amdhsa_user_sgpr_count 2
  .amdhsa_user_sgpr_kernarg_segment_ptr 1
  .amdhsa_system_sgpr_workgroup_id_x 1
.end_amdhsa_kernel
.text
.globl attn_a2_kernel
.p2align 8
.type attn_a2_kernel,@function
attn_a2_kernel:
    s_cmp_ge_u32 s2, 256
    s_cbranch_scc1 attn_a2_kernel_end
    s_load_dwordx2 s[6:7], s[0:1], 96
    s_waitcnt lgkmcnt(0)
    s_mov_b32 s8, s6
    s_mov_b32 s9, s7
    s_mov_b32 s10, 268435456
    s_mov_b32 s11, 0x00020000
    v_mov_b32 v1, v0
    v_add_u32 v2, 0, v1
    s_mov_b32 s12, 3121
    v_mul_lo_u32 v3, v2, s12
    v_lshrrev_b32 v3, 19, v3
    v_mul_u32_u24 v4, 168, v3
    v_sub_u32 v4, v2, v4
    v_lshlrev_b32 v5, 12, v3
    v_lshlrev_b32 v6, 4, v4
    v_add_u32 v5, v5, v6
    v_add_u32 v5, 242352128, v5
    buffer_load_dwordx4 v[8:11], v5, s[8:11], 0 offen
    v_mul_u32_u24 v7, 2688, v3
    v_add_u32 v7, v7, v6
    s_waitcnt vmcnt(0)
    ds_write_b128 v7, v[8:11]
    v_add_u32 v2, 256, v1
    s_mov_b32 s12, 3121
    v_mul_lo_u32 v3, v2, s12
    v_lshrrev_b32 v3, 19, v3
    v_mul_u32_u24 v4, 168, v3
    v_sub_u32 v4, v2, v4
    v_lshlrev_b32 v5, 12, v3
    v_lshlrev_b32 v6, 4, v4
    v_add_u32 v5, v5, v6
    v_add_u32 v5, 242352128, v5
    buffer_load_dwordx4 v[8:11], v5, s[8:11], 0 offen
    v_mul_u32_u24 v7, 2688, v3
    v_add_u32 v7, v7, v6
    s_waitcnt vmcnt(0)
    ds_write_b128 v7, v[8:11]
    v_add_u32 v2, 512, v1
    s_mov_b32 s12, 3121
    v_mul_lo_u32 v3, v2, s12
    v_lshrrev_b32 v3, 19, v3
    v_mul_u32_u24 v4, 168, v3
    v_sub_u32 v4, v2, v4
    v_lshlrev_b32 v5, 12, v3
    v_lshlrev_b32 v6, 4, v4
    v_add_u32 v5, v5, v6
    v_add_u32 v5, 242352128, v5
    buffer_load_dwordx4 v[8:11], v5, s[8:11], 0 offen
    v_mul_u32_u24 v7, 2688, v3
    v_add_u32 v7, v7, v6
    s_waitcnt vmcnt(0)
    ds_write_b128 v7, v[8:11]
    v_add_u32 v2, 768, v1
    s_mov_b32 s12, 3121
    v_mul_lo_u32 v3, v2, s12
    v_lshrrev_b32 v3, 19, v3
    v_mul_u32_u24 v4, 168, v3
    v_sub_u32 v4, v2, v4
    v_lshlrev_b32 v5, 12, v3
    v_lshlrev_b32 v6, 4, v4
    v_add_u32 v5, v5, v6
    v_add_u32 v5, 242352128, v5
    buffer_load_dwordx4 v[8:11], v5, s[8:11], 0 offen
    v_mul_u32_u24 v7, 2688, v3
    v_add_u32 v7, v7, v6
    s_waitcnt vmcnt(0)
    ds_write_b128 v7, v[8:11]
    v_add_u32 v2, 1024, v1
    s_mov_b32 s12, 3121
    v_mul_lo_u32 v3, v2, s12
    v_lshrrev_b32 v3, 19, v3
    v_mul_u32_u24 v4, 168, v3
    v_sub_u32 v4, v2, v4
    v_lshlrev_b32 v5, 12, v3
    v_lshlrev_b32 v6, 4, v4
    v_add_u32 v5, v5, v6
    v_add_u32 v5, 242352128, v5
    buffer_load_dwordx4 v[8:11], v5, s[8:11], 0 offen
    v_mul_u32_u24 v7, 2688, v3
    v_add_u32 v7, v7, v6
    s_waitcnt vmcnt(0)
    ds_write_b128 v7, v[8:11]
    v_add_u32 v2, 1280, v1
    s_mov_b32 s12, 3121
    v_mul_lo_u32 v3, v2, s12
    v_lshrrev_b32 v3, 19, v3
    v_mul_u32_u24 v4, 168, v3
    v_sub_u32 v4, v2, v4
    v_lshlrev_b32 v5, 12, v3
    v_lshlrev_b32 v6, 4, v4
    v_add_u32 v5, v5, v6
    v_add_u32 v5, 242352128, v5
    buffer_load_dwordx4 v[8:11], v5, s[8:11], 0 offen
    v_mul_u32_u24 v7, 2688, v3
    v_add_u32 v7, v7, v6
    s_waitcnt vmcnt(0)
    ds_write_b128 v7, v[8:11]
    v_add_u32 v2, 1536, v1
    s_mov_b32 s12, 3121
    v_mul_lo_u32 v3, v2, s12
    v_lshrrev_b32 v3, 19, v3
    v_mul_u32_u24 v4, 168, v3
    v_sub_u32 v4, v2, v4
    v_lshlrev_b32 v5, 12, v3
    v_lshlrev_b32 v6, 4, v4
    v_add_u32 v5, v5, v6
    v_add_u32 v5, 242352128, v5
    buffer_load_dwordx4 v[8:11], v5, s[8:11], 0 offen
    v_mul_u32_u24 v7, 2688, v3
    v_add_u32 v7, v7, v6
    s_waitcnt vmcnt(0)
    ds_write_b128 v7, v[8:11]
    v_add_u32 v2, 1792, v1
    s_mov_b32 s12, 3121
    v_mul_lo_u32 v3, v2, s12
    v_lshrrev_b32 v3, 19, v3
    v_mul_u32_u24 v4, 168, v3
    v_sub_u32 v4, v2, v4
    v_lshlrev_b32 v5, 12, v3
    v_lshlrev_b32 v6, 4, v4
    v_add_u32 v5, v5, v6
    v_add_u32 v5, 242352128, v5
    buffer_load_dwordx4 v[8:11], v5, s[8:11], 0 offen
    v_mul_u32_u24 v7, 2688, v3
    v_add_u32 v7, v7, v6
    s_waitcnt vmcnt(0)
    ds_write_b128 v7, v[8:11]
    v_add_u32 v2, 2048, v1
    s_mov_b32 s12, 3121
    v_mul_lo_u32 v3, v2, s12
    v_lshrrev_b32 v3, 19, v3
    v_mul_u32_u24 v4, 168, v3
    v_sub_u32 v4, v2, v4
    v_lshlrev_b32 v5, 12, v3
    v_lshlrev_b32 v6, 4, v4
    v_add_u32 v5, v5, v6
    v_add_u32 v5, 242352128, v5
    buffer_load_dwordx4 v[8:11], v5, s[8:11], 0 offen
    v_mul_u32_u24 v7, 2688, v3
    v_add_u32 v7, v7, v6
    s_waitcnt vmcnt(0)
    ds_write_b128 v7, v[8:11]
    v_add_u32 v2, 2304, v1
    s_mov_b32 s12, 3121
    v_mul_lo_u32 v3, v2, s12
    v_lshrrev_b32 v3, 19, v3
    v_mul_u32_u24 v4, 168, v3
    v_sub_u32 v4, v2, v4
    v_lshlrev_b32 v5, 12, v3
    v_lshlrev_b32 v6, 4, v4
    v_add_u32 v5, v5, v6
    v_add_u32 v5, 242352128, v5
    buffer_load_dwordx4 v[8:11], v5, s[8:11], 0 offen
    v_mul_u32_u24 v7, 2688, v3
    v_add_u32 v7, v7, v6
    s_waitcnt vmcnt(0)
    ds_write_b128 v7, v[8:11]
    v_add_u32 v2, 2560, v1
    s_mov_b32 s12, 3121
    v_mul_lo_u32 v3, v2, s12
    v_lshrrev_b32 v3, 19, v3
    v_mul_u32_u24 v4, 168, v3
    v_sub_u32 v4, v2, v4
    v_lshlrev_b32 v5, 12, v3
    v_lshlrev_b32 v6, 4, v4
    v_add_u32 v5, v5, v6
    v_add_u32 v5, 242352128, v5
    buffer_load_dwordx4 v[8:11], v5, s[8:11], 0 offen
    v_mul_u32_u24 v7, 2688, v3
    v_add_u32 v7, v7, v6
    s_waitcnt vmcnt(0)
    ds_write_b128 v7, v[8:11]
    v_add_u32 v2, 2816, v1
    s_mov_b32 s12, 3121
    v_mul_lo_u32 v3, v2, s12
    v_lshrrev_b32 v3, 19, v3
    v_mul_u32_u24 v4, 168, v3
    v_sub_u32 v4, v2, v4
    v_lshlrev_b32 v5, 12, v3
    v_lshlrev_b32 v6, 4, v4
    v_add_u32 v5, v5, v6
    v_add_u32 v5, 242352128, v5
    buffer_load_dwordx4 v[8:11], v5, s[8:11], 0 offen
    v_mul_u32_u24 v7, 2688, v3
    v_add_u32 v7, v7, v6
    s_waitcnt vmcnt(0)
    ds_write_b128 v7, v[8:11]
    v_add_u32 v2, 3072, v1
    s_mov_b32 s12, 3121
    v_mul_lo_u32 v3, v2, s12
    v_lshrrev_b32 v3, 19, v3
    v_mul_u32_u24 v4, 168, v3
    v_sub_u32 v4, v2, v4
    v_lshlrev_b32 v5, 12, v3
    v_lshlrev_b32 v6, 4, v4
    v_add_u32 v5, v5, v6
    v_add_u32 v5, 242352128, v5
    buffer_load_dwordx4 v[8:11], v5, s[8:11], 0 offen
    v_mul_u32_u24 v7, 2688, v3
    v_add_u32 v7, v7, v6
    s_waitcnt vmcnt(0)
    ds_write_b128 v7, v[8:11]
    v_add_u32 v2, 3328, v1
    s_mov_b32 s12, 3121
    v_mul_lo_u32 v3, v2, s12
    v_lshrrev_b32 v3, 19, v3
    v_mul_u32_u24 v4, 168, v3
    v_sub_u32 v4, v2, v4
    v_lshlrev_b32 v5, 12, v3
    v_lshlrev_b32 v6, 4, v4
    v_add_u32 v5, v5, v6
    v_add_u32 v5, 242352128, v5
    buffer_load_dwordx4 v[8:11], v5, s[8:11], 0 offen
    v_mul_u32_u24 v7, 2688, v3
    v_add_u32 v7, v7, v6
    s_waitcnt vmcnt(0)
    ds_write_b128 v7, v[8:11]
    v_add_u32 v2, 3584, v1
    s_mov_b32 s12, 3121
    v_mul_lo_u32 v3, v2, s12
    v_lshrrev_b32 v3, 19, v3
    v_mul_u32_u24 v4, 168, v3
    v_sub_u32 v4, v2, v4
    v_lshlrev_b32 v5, 12, v3
    v_lshlrev_b32 v6, 4, v4
    v_add_u32 v5, v5, v6
    v_add_u32 v5, 242352128, v5
    buffer_load_dwordx4 v[8:11], v5, s[8:11], 0 offen
    v_mul_u32_u24 v7, 2688, v3
    v_add_u32 v7, v7, v6
    s_waitcnt vmcnt(0)
    ds_write_b128 v7, v[8:11]
    v_add_u32 v2, 3840, v1
    s_mov_b32 s12, 3121
    v_mul_lo_u32 v3, v2, s12
    v_lshrrev_b32 v3, 19, v3
    v_mul_u32_u24 v4, 168, v3
    v_sub_u32 v4, v2, v4
    v_lshlrev_b32 v5, 12, v3
    v_lshlrev_b32 v6, 4, v4
    v_add_u32 v5, v5, v6
    v_add_u32 v5, 242352128, v5
    buffer_load_dwordx4 v[8:11], v5, s[8:11], 0 offen
    v_mul_u32_u24 v7, 2688, v3
    v_add_u32 v7, v7, v6
    s_waitcnt vmcnt(0)
    ds_write_b128 v7, v[8:11]
    v_add_u32 v2, 4096, v1
    s_mov_b32 s12, 3121
    v_mul_lo_u32 v3, v2, s12
    v_lshrrev_b32 v3, 19, v3
    v_mul_u32_u24 v4, 168, v3
    v_sub_u32 v4, v2, v4
    v_lshlrev_b32 v5, 12, v3
    v_lshlrev_b32 v6, 4, v4
    v_add_u32 v5, v5, v6
    v_add_u32 v5, 242352128, v5
    buffer_load_dwordx4 v[8:11], v5, s[8:11], 0 offen
    v_mul_u32_u24 v7, 2688, v3
    v_add_u32 v7, v7, v6
    s_waitcnt vmcnt(0)
    ds_write_b128 v7, v[8:11]
    v_add_u32 v2, 4352, v1
    s_mov_b32 s12, 3121
    v_mul_lo_u32 v3, v2, s12
    v_lshrrev_b32 v3, 19, v3
    v_mul_u32_u24 v4, 168, v3
    v_sub_u32 v4, v2, v4
    v_lshlrev_b32 v5, 12, v3
    v_lshlrev_b32 v6, 4, v4
    v_add_u32 v5, v5, v6
    v_add_u32 v5, 242352128, v5
    buffer_load_dwordx4 v[8:11], v5, s[8:11], 0 offen
    v_mul_u32_u24 v7, 2688, v3
    v_add_u32 v7, v7, v6
    s_waitcnt vmcnt(0)
    ds_write_b128 v7, v[8:11]
    v_add_u32 v2, 4608, v1
    s_mov_b32 s12, 3121
    v_mul_lo_u32 v3, v2, s12
    v_lshrrev_b32 v3, 19, v3
    v_mul_u32_u24 v4, 168, v3
    v_sub_u32 v4, v2, v4
    v_lshlrev_b32 v5, 12, v3
    v_lshlrev_b32 v6, 4, v4
    v_add_u32 v5, v5, v6
    v_add_u32 v5, 242352128, v5
    buffer_load_dwordx4 v[8:11], v5, s[8:11], 0 offen
    v_mul_u32_u24 v7, 2688, v3
    v_add_u32 v7, v7, v6
    s_waitcnt vmcnt(0)
    ds_write_b128 v7, v[8:11]
    v_add_u32 v2, 4864, v1
    s_mov_b32 s12, 3121
    v_mul_lo_u32 v3, v2, s12
    v_lshrrev_b32 v3, 19, v3
    v_mul_u32_u24 v4, 168, v3
    v_sub_u32 v4, v2, v4
    v_lshlrev_b32 v5, 12, v3
    v_lshlrev_b32 v6, 4, v4
    v_add_u32 v5, v5, v6
    v_add_u32 v5, 242352128, v5
    buffer_load_dwordx4 v[8:11], v5, s[8:11], 0 offen
    v_mul_u32_u24 v7, 2688, v3
    v_add_u32 v7, v7, v6
    s_waitcnt vmcnt(0)
    ds_write_b128 v7, v[8:11]
    v_add_u32 v2, 5120, v1
    s_mov_b32 s12, 3121
    v_mul_lo_u32 v3, v2, s12
    v_lshrrev_b32 v3, 19, v3
    v_mul_u32_u24 v4, 168, v3
    v_sub_u32 v4, v2, v4
    v_lshlrev_b32 v5, 12, v3
    v_lshlrev_b32 v6, 4, v4
    v_add_u32 v5, v5, v6
    v_add_u32 v5, 242352128, v5
    buffer_load_dwordx4 v[8:11], v5, s[8:11], 0 offen
    v_mul_u32_u24 v7, 2688, v3
    v_add_u32 v7, v7, v6
    s_waitcnt vmcnt(0)
    ds_write_b128 v7, v[8:11]
    s_waitcnt lgkmcnt(0)
    s_barrier
    v_and_b32 v2, 31, v0
    v_lshrrev_b32 v3, 5, v0
    s_lshl_b32 s12, s2, 3
    v_add_u32 v3, s12, v3
    v_mul_u32_u24 v4, 1280, v3
    v_mul_u32_u24 v5, 40, v2
    v_add_u32 v4, v4, v5
    v_add_u32 v6, 229638144, v4
    buffer_load_dwordx2 v[8:9], v6, s[8:11], 0 offen offset:0
    buffer_load_dwordx2 v[10:11], v6, s[8:11], 0 offen offset:8
    buffer_load_dwordx2 v[12:13], v6, s[8:11], 0 offen offset:16
    buffer_load_dwordx2 v[14:15], v6, s[8:11], 0 offen offset:24
    buffer_load_dwordx2 v[16:17], v6, s[8:11], 0 offen offset:32
    s_waitcnt vmcnt(0)
    v_lshlrev_b32 v40, 16, v8
    v_and_b32 v41, 0xffff0000, v8
    v_mul_f32 v44, 1.4426950408889634, v40
    v_exp_f32 v44, v44
    v_add_f32 v42, 1.0, v40
    v_cmp_lt_f32 vcc, 0, v40
    s_nop 1
    v_cndmask_b32 v42, v44, v42, vcc
    v_add_f32 v42, 0x358637bd, v42
    v_mul_f32 v44, 1.4426950408889634, v41
    v_exp_f32 v44, v44
    v_add_f32 v43, 1.0, v41
    v_cmp_lt_f32 vcc, 0, v41
    s_nop 1
    v_cndmask_b32 v43, v44, v43, vcc
    v_add_f32 v43, 0x358637bd, v43
    v_cvt_pk_bf16_f32 v45, v42, v43
    v_lshlrev_b32 v20, 16, v45
    v_and_b32 v21, 0xffff0000, v45
    v_lshlrev_b32 v40, 16, v9
    v_and_b32 v41, 0xffff0000, v9
    v_mul_f32 v44, 1.4426950408889634, v40
    v_exp_f32 v44, v44
    v_add_f32 v42, 1.0, v40
    v_cmp_lt_f32 vcc, 0, v40
    s_nop 1
    v_cndmask_b32 v42, v44, v42, vcc
    v_add_f32 v42, 0x358637bd, v42
    v_mul_f32 v44, 1.4426950408889634, v41
    v_exp_f32 v44, v44
    v_add_f32 v43, 1.0, v41
    v_cmp_lt_f32 vcc, 0, v41
    s_nop 1
    v_cndmask_b32 v43, v44, v43, vcc
    v_add_f32 v43, 0x358637bd, v43
    v_cvt_pk_bf16_f32 v45, v42, v43
    v_lshlrev_b32 v22, 16, v45
    v_and_b32 v23, 0xffff0000, v45
    v_lshlrev_b32 v40, 16, v10
    v_and_b32 v41, 0xffff0000, v10
    v_mul_f32 v44, 1.4426950408889634, v40
    v_exp_f32 v44, v44
    v_add_f32 v42, 1.0, v40
    v_cmp_lt_f32 vcc, 0, v40
    s_nop 1
    v_cndmask_b32 v42, v44, v42, vcc
    v_add_f32 v42, 0x358637bd, v42
    v_mul_f32 v44, 1.4426950408889634, v41
    v_exp_f32 v44, v44
    v_add_f32 v43, 1.0, v41
    v_cmp_lt_f32 vcc, 0, v41
    s_nop 1
    v_cndmask_b32 v43, v44, v43, vcc
    v_add_f32 v43, 0x358637bd, v43
    v_cvt_pk_bf16_f32 v45, v42, v43
    v_lshlrev_b32 v24, 16, v45
    v_and_b32 v25, 0xffff0000, v45
    v_lshlrev_b32 v40, 16, v11
    v_and_b32 v41, 0xffff0000, v11
    v_mul_f32 v44, 1.4426950408889634, v40
    v_exp_f32 v44, v44
    v_add_f32 v42, 1.0, v40
    v_cmp_lt_f32 vcc, 0, v40
    s_nop 1
    v_cndmask_b32 v42, v44, v42, vcc
    v_add_f32 v42, 0x358637bd, v42
    v_mul_f32 v44, 1.4426950408889634, v41
    v_exp_f32 v44, v44
    v_add_f32 v43, 1.0, v41
    v_cmp_lt_f32 vcc, 0, v41
    s_nop 1
    v_cndmask_b32 v43, v44, v43, vcc
    v_add_f32 v43, 0x358637bd, v43
    v_cvt_pk_bf16_f32 v45, v42, v43
    v_lshlrev_b32 v26, 16, v45
    v_and_b32 v27, 0xffff0000, v45
    v_lshlrev_b32 v40, 16, v12
    v_and_b32 v41, 0xffff0000, v12
    v_mul_f32 v44, 1.4426950408889634, v40
    v_exp_f32 v44, v44
    v_add_f32 v42, 1.0, v40
    v_cmp_lt_f32 vcc, 0, v40
    s_nop 1
    v_cndmask_b32 v42, v44, v42, vcc
    v_add_f32 v42, 0x358637bd, v42
    v_mul_f32 v44, 1.4426950408889634, v41
    v_exp_f32 v44, v44
    v_add_f32 v43, 1.0, v41
    v_cmp_lt_f32 vcc, 0, v41
    s_nop 1
    v_cndmask_b32 v43, v44, v43, vcc
    v_add_f32 v43, 0x358637bd, v43
    v_cvt_pk_bf16_f32 v45, v42, v43
    v_lshlrev_b32 v28, 16, v45
    v_and_b32 v29, 0xffff0000, v45
    v_lshlrev_b32 v40, 16, v13
    v_and_b32 v41, 0xffff0000, v13
    v_mul_f32 v44, 1.4426950408889634, v40
    v_exp_f32 v44, v44
    v_add_f32 v42, 1.0, v40
    v_cmp_lt_f32 vcc, 0, v40
    s_nop 1
    v_cndmask_b32 v42, v44, v42, vcc
    v_add_f32 v42, 0x358637bd, v42
    v_mul_f32 v44, 1.4426950408889634, v41
    v_exp_f32 v44, v44
    v_add_f32 v43, 1.0, v41
    v_cmp_lt_f32 vcc, 0, v41
    s_nop 1
    v_cndmask_b32 v43, v44, v43, vcc
    v_add_f32 v43, 0x358637bd, v43
    v_cvt_pk_bf16_f32 v45, v42, v43
    v_lshlrev_b32 v30, 16, v45
    v_and_b32 v31, 0xffff0000, v45
    v_lshlrev_b32 v40, 16, v14
    v_and_b32 v41, 0xffff0000, v14
    v_mul_f32 v44, 1.4426950408889634, v40
    v_exp_f32 v44, v44
    v_add_f32 v42, 1.0, v40
    v_cmp_lt_f32 vcc, 0, v40
    s_nop 1
    v_cndmask_b32 v42, v44, v42, vcc
    v_add_f32 v42, 0x358637bd, v42
    v_mul_f32 v44, 1.4426950408889634, v41
    v_exp_f32 v44, v44
    v_add_f32 v43, 1.0, v41
    v_cmp_lt_f32 vcc, 0, v41
    s_nop 1
    v_cndmask_b32 v43, v44, v43, vcc
    v_add_f32 v43, 0x358637bd, v43
    v_cvt_pk_bf16_f32 v45, v42, v43
    v_lshlrev_b32 v32, 16, v45
    v_and_b32 v33, 0xffff0000, v45
    v_lshlrev_b32 v40, 16, v15
    v_and_b32 v41, 0xffff0000, v15
    v_mul_f32 v44, 1.4426950408889634, v40
    v_exp_f32 v44, v44
    v_add_f32 v42, 1.0, v40
    v_cmp_lt_f32 vcc, 0, v40
    s_nop 1
    v_cndmask_b32 v42, v44, v42, vcc
    v_add_f32 v42, 0x358637bd, v42
    v_mul_f32 v44, 1.4426950408889634, v41
    v_exp_f32 v44, v44
    v_add_f32 v43, 1.0, v41
    v_cmp_lt_f32 vcc, 0, v41
    s_nop 1
    v_cndmask_b32 v43, v44, v43, vcc
    v_add_f32 v43, 0x358637bd, v43
    v_cvt_pk_bf16_f32 v45, v42, v43
    v_lshlrev_b32 v34, 16, v45
    v_and_b32 v35, 0xffff0000, v45
    v_lshlrev_b32 v40, 16, v16
    v_and_b32 v41, 0xffff0000, v16
    v_mul_f32 v44, 1.4426950408889634, v40
    v_exp_f32 v44, v44
    v_add_f32 v42, 1.0, v40
    v_cmp_lt_f32 vcc, 0, v40
    s_nop 1
    v_cndmask_b32 v42, v44, v42, vcc
    v_add_f32 v42, 0x358637bd, v42
    v_mul_f32 v44, 1.4426950408889634, v41
    v_exp_f32 v44, v44
    v_add_f32 v43, 1.0, v41
    v_cmp_lt_f32 vcc, 0, v41
    s_nop 1
    v_cndmask_b32 v43, v44, v43, vcc
    v_add_f32 v43, 0x358637bd, v43
    v_cvt_pk_bf16_f32 v45, v42, v43
    v_lshlrev_b32 v36, 16, v45
    v_and_b32 v37, 0xffff0000, v45
    v_lshlrev_b32 v40, 16, v17
    v_and_b32 v41, 0xffff0000, v17
    v_mul_f32 v44, 1.4426950408889634, v40
    v_exp_f32 v44, v44
    v_add_f32 v42, 1.0, v40
    v_cmp_lt_f32 vcc, 0, v40
    s_nop 1
    v_cndmask_b32 v42, v44, v42, vcc
    v_add_f32 v42, 0x358637bd, v42
    v_mul_f32 v44, 1.4426950408889634, v41
    v_exp_f32 v44, v44
    v_add_f32 v43, 1.0, v41
    v_cmp_lt_f32 vcc, 0, v41
    s_nop 1
    v_cndmask_b32 v43, v44, v43, vcc
    v_add_f32 v43, 0x358637bd, v43
    v_cvt_pk_bf16_f32 v45, v42, v43
    v_lshlrev_b32 v38, 16, v45
    v_and_b32 v39, 0xffff0000, v45
    v_mul_u32_u24 v7, 2688, v2
    ds_read_b128 v[72:75], v7 offset:0
    ds_read_b128 v[76:79], v7 offset:16
    ds_read_b128 v[80:83], v7 offset:32
    ds_read_b128 v[84:87], v7 offset:48
    ds_read_b128 v[88:91], v7 offset:64
    s_waitcnt lgkmcnt(0)
    v_mul_f32 v50, v20, v72
    v_fmac_f32 v50, v21, v73
    v_fmac_f32 v50, v22, v74
    v_fmac_f32 v50, v23, v75
    v_fmac_f32 v50, v24, v76
    v_fmac_f32 v50, v25, v77
    v_fmac_f32 v50, v26, v78
    v_fmac_f32 v50, v27, v79
    v_fmac_f32 v50, v28, v80
    v_fmac_f32 v50, v29, v81
    v_fmac_f32 v50, v30, v82
    v_fmac_f32 v50, v31, v83
    v_fmac_f32 v50, v32, v84
    v_fmac_f32 v50, v33, v85
    v_fmac_f32 v50, v34, v86
    v_fmac_f32 v50, v35, v87
    v_fmac_f32 v50, v36, v88
    v_fmac_f32 v50, v37, v89
    v_fmac_f32 v50, v38, v90
    v_fmac_f32 v50, v39, v91
    ds_read_b128 v[72:75], v7 offset:128
    ds_read_b128 v[76:79], v7 offset:144
    ds_read_b128 v[80:83], v7 offset:160
    ds_read_b128 v[84:87], v7 offset:176
    ds_read_b128 v[88:91], v7 offset:192
    s_waitcnt lgkmcnt(0)
    v_mul_f32 v51, v20, v72
    v_fmac_f32 v51, v21, v73
    v_fmac_f32 v51, v22, v74
    v_fmac_f32 v51, v23, v75
    v_fmac_f32 v51, v24, v76
    v_fmac_f32 v51, v25, v77
    v_fmac_f32 v51, v26, v78
    v_fmac_f32 v51, v27, v79
    v_fmac_f32 v51, v28, v80
    v_fmac_f32 v51, v29, v81
    v_fmac_f32 v51, v30, v82
    v_fmac_f32 v51, v31, v83
    v_fmac_f32 v51, v32, v84
    v_fmac_f32 v51, v33, v85
    v_fmac_f32 v51, v34, v86
    v_fmac_f32 v51, v35, v87
    v_fmac_f32 v51, v36, v88
    v_fmac_f32 v51, v37, v89
    v_fmac_f32 v51, v38, v90
    v_fmac_f32 v51, v39, v91
    ds_read_b128 v[72:75], v7 offset:256
    ds_read_b128 v[76:79], v7 offset:272
    ds_read_b128 v[80:83], v7 offset:288
    ds_read_b128 v[84:87], v7 offset:304
    ds_read_b128 v[88:91], v7 offset:320
    s_waitcnt lgkmcnt(0)
    v_mul_f32 v52, v20, v72
    v_fmac_f32 v52, v21, v73
    v_fmac_f32 v52, v22, v74
    v_fmac_f32 v52, v23, v75
    v_fmac_f32 v52, v24, v76
    v_fmac_f32 v52, v25, v77
    v_fmac_f32 v52, v26, v78
    v_fmac_f32 v52, v27, v79
    v_fmac_f32 v52, v28, v80
    v_fmac_f32 v52, v29, v81
    v_fmac_f32 v52, v30, v82
    v_fmac_f32 v52, v31, v83
    v_fmac_f32 v52, v32, v84
    v_fmac_f32 v52, v33, v85
    v_fmac_f32 v52, v34, v86
    v_fmac_f32 v52, v35, v87
    v_fmac_f32 v52, v36, v88
    v_fmac_f32 v52, v37, v89
    v_fmac_f32 v52, v38, v90
    v_fmac_f32 v52, v39, v91
    ds_read_b128 v[72:75], v7 offset:384
    ds_read_b128 v[76:79], v7 offset:400
    ds_read_b128 v[80:83], v7 offset:416
    ds_read_b128 v[84:87], v7 offset:432
    ds_read_b128 v[88:91], v7 offset:448
    s_waitcnt lgkmcnt(0)
    v_mul_f32 v53, v20, v72
    v_fmac_f32 v53, v21, v73
    v_fmac_f32 v53, v22, v74
    v_fmac_f32 v53, v23, v75
    v_fmac_f32 v53, v24, v76
    v_fmac_f32 v53, v25, v77
    v_fmac_f32 v53, v26, v78
    v_fmac_f32 v53, v27, v79
    v_fmac_f32 v53, v28, v80
    v_fmac_f32 v53, v29, v81
    v_fmac_f32 v53, v30, v82
    v_fmac_f32 v53, v31, v83
    v_fmac_f32 v53, v32, v84
    v_fmac_f32 v53, v33, v85
    v_fmac_f32 v53, v34, v86
    v_fmac_f32 v53, v35, v87
    v_fmac_f32 v53, v36, v88
    v_fmac_f32 v53, v37, v89
    v_fmac_f32 v53, v38, v90
    v_fmac_f32 v53, v39, v91
    ds_read_b128 v[72:75], v7 offset:512
    ds_read_b128 v[76:79], v7 offset:528
    ds_read_b128 v[80:83], v7 offset:544
    ds_read_b128 v[84:87], v7 offset:560
    ds_read_b128 v[88:91], v7 offset:576
    s_waitcnt lgkmcnt(0)
    v_mul_f32 v54, v20, v72
    v_fmac_f32 v54, v21, v73
    v_fmac_f32 v54, v22, v74
    v_fmac_f32 v54, v23, v75
    v_fmac_f32 v54, v24, v76
    v_fmac_f32 v54, v25, v77
    v_fmac_f32 v54, v26, v78
    v_fmac_f32 v54, v27, v79
    v_fmac_f32 v54, v28, v80
    v_fmac_f32 v54, v29, v81
    v_fmac_f32 v54, v30, v82
    v_fmac_f32 v54, v31, v83
    v_fmac_f32 v54, v32, v84
    v_fmac_f32 v54, v33, v85
    v_fmac_f32 v54, v34, v86
    v_fmac_f32 v54, v35, v87
    v_fmac_f32 v54, v36, v88
    v_fmac_f32 v54, v37, v89
    v_fmac_f32 v54, v38, v90
    v_fmac_f32 v54, v39, v91
    ds_read_b128 v[72:75], v7 offset:640
    ds_read_b128 v[76:79], v7 offset:656
    ds_read_b128 v[80:83], v7 offset:672
    ds_read_b128 v[84:87], v7 offset:688
    ds_read_b128 v[88:91], v7 offset:704
    s_waitcnt lgkmcnt(0)
    v_mul_f32 v55, v20, v72
    v_fmac_f32 v55, v21, v73
    v_fmac_f32 v55, v22, v74
    v_fmac_f32 v55, v23, v75
    v_fmac_f32 v55, v24, v76
    v_fmac_f32 v55, v25, v77
    v_fmac_f32 v55, v26, v78
    v_fmac_f32 v55, v27, v79
    v_fmac_f32 v55, v28, v80
    v_fmac_f32 v55, v29, v81
    v_fmac_f32 v55, v30, v82
    v_fmac_f32 v55, v31, v83
    v_fmac_f32 v55, v32, v84
    v_fmac_f32 v55, v33, v85
    v_fmac_f32 v55, v34, v86
    v_fmac_f32 v55, v35, v87
    v_fmac_f32 v55, v36, v88
    v_fmac_f32 v55, v37, v89
    v_fmac_f32 v55, v38, v90
    v_fmac_f32 v55, v39, v91
    ds_read_b128 v[72:75], v7 offset:768
    ds_read_b128 v[76:79], v7 offset:784
    ds_read_b128 v[80:83], v7 offset:800
    ds_read_b128 v[84:87], v7 offset:816
    ds_read_b128 v[88:91], v7 offset:832
    s_waitcnt lgkmcnt(0)
    v_mul_f32 v56, v20, v72
    v_fmac_f32 v56, v21, v73
    v_fmac_f32 v56, v22, v74
    v_fmac_f32 v56, v23, v75
    v_fmac_f32 v56, v24, v76
    v_fmac_f32 v56, v25, v77
    v_fmac_f32 v56, v26, v78
    v_fmac_f32 v56, v27, v79
    v_fmac_f32 v56, v28, v80
    v_fmac_f32 v56, v29, v81
    v_fmac_f32 v56, v30, v82
    v_fmac_f32 v56, v31, v83
    v_fmac_f32 v56, v32, v84
    v_fmac_f32 v56, v33, v85
    v_fmac_f32 v56, v34, v86
    v_fmac_f32 v56, v35, v87
    v_fmac_f32 v56, v36, v88
    v_fmac_f32 v56, v37, v89
    v_fmac_f32 v56, v38, v90
    v_fmac_f32 v56, v39, v91
    ds_read_b128 v[72:75], v7 offset:896
    ds_read_b128 v[76:79], v7 offset:912
    ds_read_b128 v[80:83], v7 offset:928
    ds_read_b128 v[84:87], v7 offset:944
    ds_read_b128 v[88:91], v7 offset:960
    s_waitcnt lgkmcnt(0)
    v_mul_f32 v57, v20, v72
    v_fmac_f32 v57, v21, v73
    v_fmac_f32 v57, v22, v74
    v_fmac_f32 v57, v23, v75
    v_fmac_f32 v57, v24, v76
    v_fmac_f32 v57, v25, v77
    v_fmac_f32 v57, v26, v78
    v_fmac_f32 v57, v27, v79
    v_fmac_f32 v57, v28, v80
    v_fmac_f32 v57, v29, v81
    v_fmac_f32 v57, v30, v82
    v_fmac_f32 v57, v31, v83
    v_fmac_f32 v57, v32, v84
    v_fmac_f32 v57, v33, v85
    v_fmac_f32 v57, v34, v86
    v_fmac_f32 v57, v35, v87
    v_fmac_f32 v57, v36, v88
    v_fmac_f32 v57, v37, v89
    v_fmac_f32 v57, v38, v90
    v_fmac_f32 v57, v39, v91
    ds_read_b128 v[72:75], v7 offset:1024
    ds_read_b128 v[76:79], v7 offset:1040
    ds_read_b128 v[80:83], v7 offset:1056
    ds_read_b128 v[84:87], v7 offset:1072
    ds_read_b128 v[88:91], v7 offset:1088
    s_waitcnt lgkmcnt(0)
    v_mul_f32 v58, v20, v72
    v_fmac_f32 v58, v21, v73
    v_fmac_f32 v58, v22, v74
    v_fmac_f32 v58, v23, v75
    v_fmac_f32 v58, v24, v76
    v_fmac_f32 v58, v25, v77
    v_fmac_f32 v58, v26, v78
    v_fmac_f32 v58, v27, v79
    v_fmac_f32 v58, v28, v80
    v_fmac_f32 v58, v29, v81
    v_fmac_f32 v58, v30, v82
    v_fmac_f32 v58, v31, v83
    v_fmac_f32 v58, v32, v84
    v_fmac_f32 v58, v33, v85
    v_fmac_f32 v58, v34, v86
    v_fmac_f32 v58, v35, v87
    v_fmac_f32 v58, v36, v88
    v_fmac_f32 v58, v37, v89
    v_fmac_f32 v58, v38, v90
    v_fmac_f32 v58, v39, v91
    ds_read_b128 v[72:75], v7 offset:1152
    ds_read_b128 v[76:79], v7 offset:1168
    ds_read_b128 v[80:83], v7 offset:1184
    ds_read_b128 v[84:87], v7 offset:1200
    ds_read_b128 v[88:91], v7 offset:1216
    s_waitcnt lgkmcnt(0)
    v_mul_f32 v59, v20, v72
    v_fmac_f32 v59, v21, v73
    v_fmac_f32 v59, v22, v74
    v_fmac_f32 v59, v23, v75
    v_fmac_f32 v59, v24, v76
    v_fmac_f32 v59, v25, v77
    v_fmac_f32 v59, v26, v78
    v_fmac_f32 v59, v27, v79
    v_fmac_f32 v59, v28, v80
    v_fmac_f32 v59, v29, v81
    v_fmac_f32 v59, v30, v82
    v_fmac_f32 v59, v31, v83
    v_fmac_f32 v59, v32, v84
    v_fmac_f32 v59, v33, v85
    v_fmac_f32 v59, v34, v86
    v_fmac_f32 v59, v35, v87
    v_fmac_f32 v59, v36, v88
    v_fmac_f32 v59, v37, v89
    v_fmac_f32 v59, v38, v90
    v_fmac_f32 v59, v39, v91
    ds_read_b128 v[72:75], v7 offset:1280
    ds_read_b128 v[76:79], v7 offset:1296
    ds_read_b128 v[80:83], v7 offset:1312
    ds_read_b128 v[84:87], v7 offset:1328
    ds_read_b128 v[88:91], v7 offset:1344
    s_waitcnt lgkmcnt(0)
    v_mul_f32 v60, v20, v72
    v_fmac_f32 v60, v21, v73
    v_fmac_f32 v60, v22, v74
    v_fmac_f32 v60, v23, v75
    v_fmac_f32 v60, v24, v76
    v_fmac_f32 v60, v25, v77
    v_fmac_f32 v60, v26, v78
    v_fmac_f32 v60, v27, v79
    v_fmac_f32 v60, v28, v80
    v_fmac_f32 v60, v29, v81
    v_fmac_f32 v60, v30, v82
    v_fmac_f32 v60, v31, v83
    v_fmac_f32 v60, v32, v84
    v_fmac_f32 v60, v33, v85
    v_fmac_f32 v60, v34, v86
    v_fmac_f32 v60, v35, v87
    v_fmac_f32 v60, v36, v88
    v_fmac_f32 v60, v37, v89
    v_fmac_f32 v60, v38, v90
    v_fmac_f32 v60, v39, v91
    ds_read_b128 v[72:75], v7 offset:1408
    ds_read_b128 v[76:79], v7 offset:1424
    ds_read_b128 v[80:83], v7 offset:1440
    ds_read_b128 v[84:87], v7 offset:1456
    ds_read_b128 v[88:91], v7 offset:1472
    s_waitcnt lgkmcnt(0)
    v_mul_f32 v61, v20, v72
    v_fmac_f32 v61, v21, v73
    v_fmac_f32 v61, v22, v74
    v_fmac_f32 v61, v23, v75
    v_fmac_f32 v61, v24, v76
    v_fmac_f32 v61, v25, v77
    v_fmac_f32 v61, v26, v78
    v_fmac_f32 v61, v27, v79
    v_fmac_f32 v61, v28, v80
    v_fmac_f32 v61, v29, v81
    v_fmac_f32 v61, v30, v82
    v_fmac_f32 v61, v31, v83
    v_fmac_f32 v61, v32, v84
    v_fmac_f32 v61, v33, v85
    v_fmac_f32 v61, v34, v86
    v_fmac_f32 v61, v35, v87
    v_fmac_f32 v61, v36, v88
    v_fmac_f32 v61, v37, v89
    v_fmac_f32 v61, v38, v90
    v_fmac_f32 v61, v39, v91
    ds_read_b128 v[72:75], v7 offset:1536
    ds_read_b128 v[76:79], v7 offset:1552
    ds_read_b128 v[80:83], v7 offset:1568
    ds_read_b128 v[84:87], v7 offset:1584
    ds_read_b128 v[88:91], v7 offset:1600
    s_waitcnt lgkmcnt(0)
    v_mul_f32 v62, v20, v72
    v_fmac_f32 v62, v21, v73
    v_fmac_f32 v62, v22, v74
    v_fmac_f32 v62, v23, v75
    v_fmac_f32 v62, v24, v76
    v_fmac_f32 v62, v25, v77
    v_fmac_f32 v62, v26, v78
    v_fmac_f32 v62, v27, v79
    v_fmac_f32 v62, v28, v80
    v_fmac_f32 v62, v29, v81
    v_fmac_f32 v62, v30, v82
    v_fmac_f32 v62, v31, v83
    v_fmac_f32 v62, v32, v84
    v_fmac_f32 v62, v33, v85
    v_fmac_f32 v62, v34, v86
    v_fmac_f32 v62, v35, v87
    v_fmac_f32 v62, v36, v88
    v_fmac_f32 v62, v37, v89
    v_fmac_f32 v62, v38, v90
    v_fmac_f32 v62, v39, v91
    ds_read_b128 v[72:75], v7 offset:1664
    ds_read_b128 v[76:79], v7 offset:1680
    ds_read_b128 v[80:83], v7 offset:1696
    ds_read_b128 v[84:87], v7 offset:1712
    ds_read_b128 v[88:91], v7 offset:1728
    s_waitcnt lgkmcnt(0)
    v_mul_f32 v63, v20, v72
    v_fmac_f32 v63, v21, v73
    v_fmac_f32 v63, v22, v74
    v_fmac_f32 v63, v23, v75
    v_fmac_f32 v63, v24, v76
    v_fmac_f32 v63, v25, v77
    v_fmac_f32 v63, v26, v78
    v_fmac_f32 v63, v27, v79
    v_fmac_f32 v63, v28, v80
    v_fmac_f32 v63, v29, v81
    v_fmac_f32 v63, v30, v82
    v_fmac_f32 v63, v31, v83
    v_fmac_f32 v63, v32, v84
    v_fmac_f32 v63, v33, v85
    v_fmac_f32 v63, v34, v86
    v_fmac_f32 v63, v35, v87
    v_fmac_f32 v63, v36, v88
    v_fmac_f32 v63, v37, v89
    v_fmac_f32 v63, v38, v90
    v_fmac_f32 v63, v39, v91
    ds_read_b128 v[72:75], v7 offset:1792
    ds_read_b128 v[76:79], v7 offset:1808
    ds_read_b128 v[80:83], v7 offset:1824
    ds_read_b128 v[84:87], v7 offset:1840
    ds_read_b128 v[88:91], v7 offset:1856
    s_waitcnt lgkmcnt(0)
    v_mul_f32 v64, v20, v72
    v_fmac_f32 v64, v21, v73
    v_fmac_f32 v64, v22, v74
    v_fmac_f32 v64, v23, v75
    v_fmac_f32 v64, v24, v76
    v_fmac_f32 v64, v25, v77
    v_fmac_f32 v64, v26, v78
    v_fmac_f32 v64, v27, v79
    v_fmac_f32 v64, v28, v80
    v_fmac_f32 v64, v29, v81
    v_fmac_f32 v64, v30, v82
    v_fmac_f32 v64, v31, v83
    v_fmac_f32 v64, v32, v84
    v_fmac_f32 v64, v33, v85
    v_fmac_f32 v64, v34, v86
    v_fmac_f32 v64, v35, v87
    v_fmac_f32 v64, v36, v88
    v_fmac_f32 v64, v37, v89
    v_fmac_f32 v64, v38, v90
    v_fmac_f32 v64, v39, v91
    ds_read_b128 v[72:75], v7 offset:1920
    ds_read_b128 v[76:79], v7 offset:1936
    ds_read_b128 v[80:83], v7 offset:1952
    ds_read_b128 v[84:87], v7 offset:1968
    ds_read_b128 v[88:91], v7 offset:1984
    s_waitcnt lgkmcnt(0)
    v_mul_f32 v65, v20, v72
    v_fmac_f32 v65, v21, v73
    v_fmac_f32 v65, v22, v74
    v_fmac_f32 v65, v23, v75
    v_fmac_f32 v65, v24, v76
    v_fmac_f32 v65, v25, v77
    v_fmac_f32 v65, v26, v78
    v_fmac_f32 v65, v27, v79
    v_fmac_f32 v65, v28, v80
    v_fmac_f32 v65, v29, v81
    v_fmac_f32 v65, v30, v82
    v_fmac_f32 v65, v31, v83
    v_fmac_f32 v65, v32, v84
    v_fmac_f32 v65, v33, v85
    v_fmac_f32 v65, v34, v86
    v_fmac_f32 v65, v35, v87
    v_fmac_f32 v65, v36, v88
    v_fmac_f32 v65, v37, v89
    v_fmac_f32 v65, v38, v90
    v_fmac_f32 v65, v39, v91
    ds_read_b128 v[72:75], v7 offset:2048
    ds_read_b128 v[76:79], v7 offset:2064
    ds_read_b128 v[80:83], v7 offset:2080
    ds_read_b128 v[84:87], v7 offset:2096
    ds_read_b128 v[88:91], v7 offset:2112
    s_waitcnt lgkmcnt(0)
    v_mul_f32 v66, v20, v72
    v_fmac_f32 v66, v21, v73
    v_fmac_f32 v66, v22, v74
    v_fmac_f32 v66, v23, v75
    v_fmac_f32 v66, v24, v76
    v_fmac_f32 v66, v25, v77
    v_fmac_f32 v66, v26, v78
    v_fmac_f32 v66, v27, v79
    v_fmac_f32 v66, v28, v80
    v_fmac_f32 v66, v29, v81
    v_fmac_f32 v66, v30, v82
    v_fmac_f32 v66, v31, v83
    v_fmac_f32 v66, v32, v84
    v_fmac_f32 v66, v33, v85
    v_fmac_f32 v66, v34, v86
    v_fmac_f32 v66, v35, v87
    v_fmac_f32 v66, v36, v88
    v_fmac_f32 v66, v37, v89
    v_fmac_f32 v66, v38, v90
    v_fmac_f32 v66, v39, v91
    ds_read_b128 v[72:75], v7 offset:2176
    ds_read_b128 v[76:79], v7 offset:2192
    ds_read_b128 v[80:83], v7 offset:2208
    ds_read_b128 v[84:87], v7 offset:2224
    ds_read_b128 v[88:91], v7 offset:2240
    s_waitcnt lgkmcnt(0)
    v_mul_f32 v67, v20, v72
    v_fmac_f32 v67, v21, v73
    v_fmac_f32 v67, v22, v74
    v_fmac_f32 v67, v23, v75
    v_fmac_f32 v67, v24, v76
    v_fmac_f32 v67, v25, v77
    v_fmac_f32 v67, v26, v78
    v_fmac_f32 v67, v27, v79
    v_fmac_f32 v67, v28, v80
    v_fmac_f32 v67, v29, v81
    v_fmac_f32 v67, v30, v82
    v_fmac_f32 v67, v31, v83
    v_fmac_f32 v67, v32, v84
    v_fmac_f32 v67, v33, v85
    v_fmac_f32 v67, v34, v86
    v_fmac_f32 v67, v35, v87
    v_fmac_f32 v67, v36, v88
    v_fmac_f32 v67, v37, v89
    v_fmac_f32 v67, v38, v90
    v_fmac_f32 v67, v39, v91
    ds_read_b128 v[72:75], v7 offset:2304
    ds_read_b128 v[76:79], v7 offset:2320
    ds_read_b128 v[80:83], v7 offset:2336
    ds_read_b128 v[84:87], v7 offset:2352
    ds_read_b128 v[88:91], v7 offset:2368
    s_waitcnt lgkmcnt(0)
    v_mul_f32 v68, v20, v72
    v_fmac_f32 v68, v21, v73
    v_fmac_f32 v68, v22, v74
    v_fmac_f32 v68, v23, v75
    v_fmac_f32 v68, v24, v76
    v_fmac_f32 v68, v25, v77
    v_fmac_f32 v68, v26, v78
    v_fmac_f32 v68, v27, v79
    v_fmac_f32 v68, v28, v80
    v_fmac_f32 v68, v29, v81
    v_fmac_f32 v68, v30, v82
    v_fmac_f32 v68, v31, v83
    v_fmac_f32 v68, v32, v84
    v_fmac_f32 v68, v33, v85
    v_fmac_f32 v68, v34, v86
    v_fmac_f32 v68, v35, v87
    v_fmac_f32 v68, v36, v88
    v_fmac_f32 v68, v37, v89
    v_fmac_f32 v68, v38, v90
    v_fmac_f32 v68, v39, v91
    ds_read_b128 v[72:75], v7 offset:2432
    ds_read_b128 v[76:79], v7 offset:2448
    ds_read_b128 v[80:83], v7 offset:2464
    ds_read_b128 v[84:87], v7 offset:2480
    ds_read_b128 v[88:91], v7 offset:2496
    s_waitcnt lgkmcnt(0)
    v_mul_f32 v69, v20, v72
    v_fmac_f32 v69, v21, v73
    v_fmac_f32 v69, v22, v74
    v_fmac_f32 v69, v23, v75
    v_fmac_f32 v69, v24, v76
    v_fmac_f32 v69, v25, v77
    v_fmac_f32 v69, v26, v78
    v_fmac_f32 v69, v27, v79
    v_fmac_f32 v69, v28, v80
    v_fmac_f32 v69, v29, v81
    v_fmac_f32 v69, v30, v82
    v_fmac_f32 v69, v31, v83
    v_fmac_f32 v69, v32, v84
    v_fmac_f32 v69, v33, v85
    v_fmac_f32 v69, v34, v86
    v_fmac_f32 v69, v35, v87
    v_fmac_f32 v69, v36, v88
    v_fmac_f32 v69, v37, v89
    v_fmac_f32 v69, v38, v90
    v_fmac_f32 v69, v39, v91
    ds_read_b128 v[72:75], v7 offset:2560
    ds_read_b128 v[76:79], v7 offset:2576
    ds_read_b128 v[80:83], v7 offset:2592
    ds_read_b128 v[84:87], v7 offset:2608
    ds_read_b128 v[88:91], v7 offset:2624
    s_waitcnt lgkmcnt(0)
    v_mul_f32 v70, v20, v72
    v_fmac_f32 v70, v21, v73
    v_fmac_f32 v70, v22, v74
    v_fmac_f32 v70, v23, v75
    v_fmac_f32 v70, v24, v76
    v_fmac_f32 v70, v25, v77
    v_fmac_f32 v70, v26, v78
    v_fmac_f32 v70, v27, v79
    v_fmac_f32 v70, v28, v80
    v_fmac_f32 v70, v29, v81
    v_fmac_f32 v70, v30, v82
    v_fmac_f32 v70, v31, v83
    v_fmac_f32 v70, v32, v84
    v_fmac_f32 v70, v33, v85
    v_fmac_f32 v70, v34, v86
    v_fmac_f32 v70, v35, v87
    v_fmac_f32 v70, v36, v88
    v_fmac_f32 v70, v37, v89
    v_fmac_f32 v70, v38, v90
    v_fmac_f32 v70, v39, v91
    v_add_f32 v70, 0x358637bd, v70
    v_rcp_f32 v70, v70
    s_nop 0
    v_mul_f32 v50, v50, v70
    v_mul_f32 v51, v51, v70
    v_mul_f32 v52, v52, v70
    v_mul_f32 v53, v53, v70
    v_mul_f32 v54, v54, v70
    v_mul_f32 v55, v55, v70
    v_mul_f32 v56, v56, v70
    v_mul_f32 v57, v57, v70
    v_mul_f32 v58, v58, v70
    v_mul_f32 v59, v59, v70
    v_mul_f32 v60, v60, v70
    v_mul_f32 v61, v61, v70
    v_mul_f32 v62, v62, v70
    v_mul_f32 v63, v63, v70
    v_mul_f32 v64, v64, v70
    v_mul_f32 v65, v65, v70
    v_mul_f32 v66, v66, v70
    v_mul_f32 v67, v67, v70
    v_mul_f32 v68, v68, v70
    v_mul_f32 v69, v69, v70
    v_cvt_pk_bf16_f32 v8, v50, v51
    v_cvt_pk_bf16_f32 v9, v52, v53
    v_cvt_pk_bf16_f32 v10, v54, v55
    v_cvt_pk_bf16_f32 v11, v56, v57
    v_cvt_pk_bf16_f32 v12, v58, v59
    v_cvt_pk_bf16_f32 v13, v60, v61
    v_cvt_pk_bf16_f32 v14, v62, v63
    v_cvt_pk_bf16_f32 v15, v64, v65
    v_cvt_pk_bf16_f32 v16, v66, v67
    v_cvt_pk_bf16_f32 v17, v68, v69
    v_add_u32 v6, 239075328, v4
    buffer_store_dwordx2 v[8:9], v6, s[8:11], 0 offen offset:0
    buffer_store_dwordx2 v[10:11], v6, s[8:11], 0 offen offset:8
    buffer_store_dwordx2 v[12:13], v6, s[8:11], 0 offen offset:16
    buffer_store_dwordx2 v[14:15], v6, s[8:11], 0 offen offset:24
    buffer_store_dwordx2 v[16:17], v6, s[8:11], 0 offen offset:32
attn_a2_kernel_end:
    s_endpgm
.section .rodata,"a"
.p2align 6
.amdhsa_kernel attn_a2_kernel
  .amdhsa_next_free_vgpr 96
  .amdhsa_next_free_sgpr 40
  .amdhsa_accum_offset 96
  .amdhsa_group_segment_fixed_size 0
  .amdhsa_kernarg_size 104
  .amdhsa_user_sgpr_count 2
  .amdhsa_user_sgpr_kernarg_segment_ptr 1
  .amdhsa_system_sgpr_workgroup_id_x 1
.end_amdhsa_kernel
.text
.globl wo_a2_kernel
.p2align 8
.type wo_a2_kernel,@function
wo_a2_kernel:
    v_lshrrev_b32 v1, 6, v0
    v_and_b32 v2, 63, v0
    s_nop 0
    v_readfirstlane_b32 s3, v1
    s_cmp_ge_u32 s2, 128
    s_cbranch_scc1 wo_a2_kernel_end
    s_load_dwordx2 s[4:5], s[0:1], 96
    s_load_dwordx2 s[6:7], s[0:1], 80
    s_mul_i32 s20, s2, 1
    s_lshr_b32 s20, s20, 3
    s_mul_i32 s21, s20, 8
    s_sub_u32 s21, s2, s21
    s_lshl_b32 s20, s20, 2
    s_add_u32 s20, s20, s3
    s_mul_i32 s22, s20, 32
    s_mul_i32 s23, s21, 80
    s_waitcnt lgkmcnt(0)
    s_mov_b32 s8, s4
    s_mov_b32 s9, s5
    s_mov_b32 s10, 268435456
    s_mov_b32 s11, 0x00020000
    v_and_b32 v3, 15, v2
    v_lshrrev_b32 v4, 4, v2
    s_mov_b32 s24, 1280
    v_add_u32 v5, s22, v3
    v_mul_lo_u32 v5, v5, s24
    v_lshlrev_b32 v6, 4, v4
    v_add_u32 v5, v5, v6
    v_add_u32 v5, 239075328, v5
    v_mov_b32 v8, v5
    v_add_u32 v9, 20480, v5
    v_lshlrev_b32 v7, 4, v2
    s_mov_b32 s25, 0
    s_mov_b32 s26, 0
    s_mul_i32 s27, s21, 102400
    s_add_u32 s27, s27, s26
    s_add_u32 s27, s27, 246415360
    s_add_u32 s32, s27, 0
    s_add_u32 s33, s27, 20480
    s_add_u32 s34, s27, 40960
    s_add_u32 s35, s27, 61440
    s_add_u32 s36, s27, 81920
    v_accvgpr_write_b32 a0, 0
    v_accvgpr_write_b32 a1, 0
    v_accvgpr_write_b32 a2, 0
    v_accvgpr_write_b32 a3, 0
    v_accvgpr_write_b32 a4, 0
    v_accvgpr_write_b32 a5, 0
    v_accvgpr_write_b32 a6, 0
    v_accvgpr_write_b32 a7, 0
    v_accvgpr_write_b32 a8, 0
    v_accvgpr_write_b32 a9, 0
    v_accvgpr_write_b32 a10, 0
    v_accvgpr_write_b32 a11, 0
    v_accvgpr_write_b32 a12, 0
    v_accvgpr_write_b32 a13, 0
    v_accvgpr_write_b32 a14, 0
    v_accvgpr_write_b32 a15, 0
    v_accvgpr_write_b32 a16, 0
    v_accvgpr_write_b32 a17, 0
    v_accvgpr_write_b32 a18, 0
    v_accvgpr_write_b32 a19, 0
    v_accvgpr_write_b32 a20, 0
    v_accvgpr_write_b32 a21, 0
    v_accvgpr_write_b32 a22, 0
    v_accvgpr_write_b32 a23, 0
    v_accvgpr_write_b32 a24, 0
    v_accvgpr_write_b32 a25, 0
    v_accvgpr_write_b32 a26, 0
    v_accvgpr_write_b32 a27, 0
    v_accvgpr_write_b32 a28, 0
    v_accvgpr_write_b32 a29, 0
    v_accvgpr_write_b32 a30, 0
    v_accvgpr_write_b32 a31, 0
    v_accvgpr_write_b32 a32, 0
    v_accvgpr_write_b32 a33, 0
    v_accvgpr_write_b32 a34, 0
    v_accvgpr_write_b32 a35, 0
    v_accvgpr_write_b32 a36, 0
    v_accvgpr_write_b32 a37, 0
    v_accvgpr_write_b32 a38, 0
    v_accvgpr_write_b32 a39, 0
    buffer_load_dwordx4 v[16:19], v8, s[8:11], s25 offen
    buffer_load_dwordx4 v[20:23], v9, s[8:11], s25 offen
    buffer_load_dwordx4 v[24:27], v7, s[8:11], s32 offen
    buffer_load_dwordx4 v[28:31], v7, s[8:11], s33 offen
    buffer_load_dwordx4 v[32:35], v7, s[8:11], s34 offen
    buffer_load_dwordx4 v[36:39], v7, s[8:11], s35 offen
    buffer_load_dwordx4 v[40:43], v7, s[8:11], s36 offen
    s_mov_b32 s28, 10
wo_a2_kernel_loop0:
    s_add_u32 s25, s25, 64
    s_add_u32 s32, s32, 1024
    s_add_u32 s33, s33, 1024
    s_add_u32 s34, s34, 1024
    s_add_u32 s35, s35, 1024
    s_add_u32 s36, s36, 1024
    buffer_load_dwordx4 v[44:47], v8, s[8:11], s25 offen
    buffer_load_dwordx4 v[48:51], v9, s[8:11], s25 offen
    buffer_load_dwordx4 v[52:55], v7, s[8:11], s32 offen
    buffer_load_dwordx4 v[56:59], v7, s[8:11], s33 offen
    buffer_load_dwordx4 v[60:63], v7, s[8:11], s34 offen
    buffer_load_dwordx4 v[64:67], v7, s[8:11], s35 offen
    buffer_load_dwordx4 v[68:71], v7, s[8:11], s36 offen
    s_waitcnt vmcnt(7)
    v_mfma_f32_16x16x32_bf16 a[0:3], v[24:27], v[16:19], a[0:3]
    v_mfma_f32_16x16x32_bf16 a[20:23], v[24:27], v[20:23], a[20:23]
    v_mfma_f32_16x16x32_bf16 a[4:7], v[28:31], v[16:19], a[4:7]
    v_mfma_f32_16x16x32_bf16 a[24:27], v[28:31], v[20:23], a[24:27]
    v_mfma_f32_16x16x32_bf16 a[8:11], v[32:35], v[16:19], a[8:11]
    v_mfma_f32_16x16x32_bf16 a[28:31], v[32:35], v[20:23], a[28:31]
    v_mfma_f32_16x16x32_bf16 a[12:15], v[36:39], v[16:19], a[12:15]
    v_mfma_f32_16x16x32_bf16 a[32:35], v[36:39], v[20:23], a[32:35]
    v_mfma_f32_16x16x32_bf16 a[16:19], v[40:43], v[16:19], a[16:19]
    v_mfma_f32_16x16x32_bf16 a[36:39], v[40:43], v[20:23], a[36:39]
    s_sub_u32 s28, s28, 1
    s_cmp_eq_u32 s28, 0
    s_cbranch_scc1 wo_a2_kernel_loop0_last
    s_add_u32 s25, s25, 64
    s_add_u32 s32, s32, 1024
    s_add_u32 s33, s33, 1024
    s_add_u32 s34, s34, 1024
    s_add_u32 s35, s35, 1024
    s_add_u32 s36, s36, 1024
    buffer_load_dwordx4 v[16:19], v8, s[8:11], s25 offen
    buffer_load_dwordx4 v[20:23], v9, s[8:11], s25 offen
    buffer_load_dwordx4 v[24:27], v7, s[8:11], s32 offen
    buffer_load_dwordx4 v[28:31], v7, s[8:11], s33 offen
    buffer_load_dwordx4 v[32:35], v7, s[8:11], s34 offen
    buffer_load_dwordx4 v[36:39], v7, s[8:11], s35 offen
    buffer_load_dwordx4 v[40:43], v7, s[8:11], s36 offen
    s_waitcnt vmcnt(7)
    v_mfma_f32_16x16x32_bf16 a[0:3], v[52:55], v[44:47], a[0:3]
    v_mfma_f32_16x16x32_bf16 a[20:23], v[52:55], v[48:51], a[20:23]
    v_mfma_f32_16x16x32_bf16 a[4:7], v[56:59], v[44:47], a[4:7]
    v_mfma_f32_16x16x32_bf16 a[24:27], v[56:59], v[48:51], a[24:27]
    v_mfma_f32_16x16x32_bf16 a[8:11], v[60:63], v[44:47], a[8:11]
    v_mfma_f32_16x16x32_bf16 a[28:31], v[60:63], v[48:51], a[28:31]
    v_mfma_f32_16x16x32_bf16 a[12:15], v[64:67], v[44:47], a[12:15]
    v_mfma_f32_16x16x32_bf16 a[32:35], v[64:67], v[48:51], a[32:35]
    v_mfma_f32_16x16x32_bf16 a[16:19], v[68:71], v[44:47], a[16:19]
    v_mfma_f32_16x16x32_bf16 a[36:39], v[68:71], v[48:51], a[36:39]
    s_branch wo_a2_kernel_loop0
wo_a2_kernel_loop0_last:
    s_waitcnt vmcnt(0)
    v_mfma_f32_16x16x32_bf16 a[0:3], v[52:55], v[44:47], a[0:3]
    v_mfma_f32_16x16x32_bf16 a[20:23], v[52:55], v[48:51], a[20:23]
    v_mfma_f32_16x16x32_bf16 a[4:7], v[56:59], v[44:47], a[4:7]
    v_mfma_f32_16x16x32_bf16 a[24:27], v[56:59], v[48:51], a[24:27]
    v_mfma_f32_16x16x32_bf16 a[8:11], v[60:63], v[44:47], a[8:11]
    v_mfma_f32_16x16x32_bf16 a[28:31], v[60:63], v[48:51], a[28:31]
    v_mfma_f32_16x16x32_bf16 a[12:15], v[64:67], v[44:47], a[12:15]
    v_mfma_f32_16x16x32_bf16 a[32:35], v[64:67], v[48:51], a[32:35]
    v_mfma_f32_16x16x32_bf16 a[16:19], v[68:71], v[44:47], a[16:19]
    v_mfma_f32_16x16x32_bf16 a[36:39], v[68:71], v[48:51], a[36:39]
    s_nop 7
    s_nop 7
    s_mov_b32 s24, 1280
    v_add_u32 v5, s22, v3
    v_mul_lo_u32 v5, v5, s24
    v_lshlrev_b32 v6, 3, v4
    s_lshl_b32 s29, s23, 1
    v_add3_u32 v5, v5, v6, s29
    v_add_u32 v6, 247463936, v5
    buffer_load_dwordx2 v[72:73], v6, s[8:11], 0 offen
    v_accvgpr_read_b32 v76, a0
    v_accvgpr_read_b32 v77, a1
    v_accvgpr_read_b32 v78, a2
    v_accvgpr_read_b32 v79, a3
    v_cvt_pk_bf16_f32 v80, v76, v77
    v_cvt_pk_bf16_f32 v81, v78, v79
    s_waitcnt vmcnt(0)
    v_lshlrev_b32 v76, 16, v80
    v_and_b32 v77, 0xffff0000, v80
    v_lshlrev_b32 v82, 16, v72
    v_and_b32 v83, 0xffff0000, v72
    v_add_f32 v76, v76, v82
    v_add_f32 v77, v77, v83
    v_lshlrev_b32 v78, 16, v81
    v_and_b32 v79, 0xffff0000, v81
    v_lshlrev_b32 v82, 16, v73
    v_and_b32 v83, 0xffff0000, v73
    v_add_f32 v78, v78, v82
    v_add_f32 v79, v79, v83
    v_cvt_pk_bf16_f32 v80, v76, v77
    v_cvt_pk_bf16_f32 v81, v78, v79
    v_add_u32 v6, 226492416, v5
    buffer_store_dwordx2 v[80:81], v6, s[8:11], 0 offen
    v_add_u32 v6, 247463968, v5
    buffer_load_dwordx2 v[72:73], v6, s[8:11], 0 offen
    v_accvgpr_read_b32 v76, a4
    v_accvgpr_read_b32 v77, a5
    v_accvgpr_read_b32 v78, a6
    v_accvgpr_read_b32 v79, a7
    v_cvt_pk_bf16_f32 v80, v76, v77
    v_cvt_pk_bf16_f32 v81, v78, v79
    s_waitcnt vmcnt(0)
    v_lshlrev_b32 v76, 16, v80
    v_and_b32 v77, 0xffff0000, v80
    v_lshlrev_b32 v82, 16, v72
    v_and_b32 v83, 0xffff0000, v72
    v_add_f32 v76, v76, v82
    v_add_f32 v77, v77, v83
    v_lshlrev_b32 v78, 16, v81
    v_and_b32 v79, 0xffff0000, v81
    v_lshlrev_b32 v82, 16, v73
    v_and_b32 v83, 0xffff0000, v73
    v_add_f32 v78, v78, v82
    v_add_f32 v79, v79, v83
    v_cvt_pk_bf16_f32 v80, v76, v77
    v_cvt_pk_bf16_f32 v81, v78, v79
    v_add_u32 v6, 226492448, v5
    buffer_store_dwordx2 v[80:81], v6, s[8:11], 0 offen
    v_add_u32 v6, 247464000, v5
    buffer_load_dwordx2 v[72:73], v6, s[8:11], 0 offen
    v_accvgpr_read_b32 v76, a8
    v_accvgpr_read_b32 v77, a9
    v_accvgpr_read_b32 v78, a10
    v_accvgpr_read_b32 v79, a11
    v_cvt_pk_bf16_f32 v80, v76, v77
    v_cvt_pk_bf16_f32 v81, v78, v79
    s_waitcnt vmcnt(0)
    v_lshlrev_b32 v76, 16, v80
    v_and_b32 v77, 0xffff0000, v80
    v_lshlrev_b32 v82, 16, v72
    v_and_b32 v83, 0xffff0000, v72
    v_add_f32 v76, v76, v82
    v_add_f32 v77, v77, v83
    v_lshlrev_b32 v78, 16, v81
    v_and_b32 v79, 0xffff0000, v81
    v_lshlrev_b32 v82, 16, v73
    v_and_b32 v83, 0xffff0000, v73
    v_add_f32 v78, v78, v82
    v_add_f32 v79, v79, v83
    v_cvt_pk_bf16_f32 v80, v76, v77
    v_cvt_pk_bf16_f32 v81, v78, v79
    v_add_u32 v6, 226492480, v5
    buffer_store_dwordx2 v[80:81], v6, s[8:11], 0 offen
    v_add_u32 v6, 247464032, v5
    buffer_load_dwordx2 v[72:73], v6, s[8:11], 0 offen
    v_accvgpr_read_b32 v76, a12
    v_accvgpr_read_b32 v77, a13
    v_accvgpr_read_b32 v78, a14
    v_accvgpr_read_b32 v79, a15
    v_cvt_pk_bf16_f32 v80, v76, v77
    v_cvt_pk_bf16_f32 v81, v78, v79
    s_waitcnt vmcnt(0)
    v_lshlrev_b32 v76, 16, v80
    v_and_b32 v77, 0xffff0000, v80
    v_lshlrev_b32 v82, 16, v72
    v_and_b32 v83, 0xffff0000, v72
    v_add_f32 v76, v76, v82
    v_add_f32 v77, v77, v83
    v_lshlrev_b32 v78, 16, v81
    v_and_b32 v79, 0xffff0000, v81
    v_lshlrev_b32 v82, 16, v73
    v_and_b32 v83, 0xffff0000, v73
    v_add_f32 v78, v78, v82
    v_add_f32 v79, v79, v83
    v_cvt_pk_bf16_f32 v80, v76, v77
    v_cvt_pk_bf16_f32 v81, v78, v79
    v_add_u32 v6, 226492512, v5
    buffer_store_dwordx2 v[80:81], v6, s[8:11], 0 offen
    v_add_u32 v6, 247464064, v5
    buffer_load_dwordx2 v[72:73], v6, s[8:11], 0 offen
    v_accvgpr_read_b32 v76, a16
    v_accvgpr_read_b32 v77, a17
    v_accvgpr_read_b32 v78, a18
    v_accvgpr_read_b32 v79, a19
    v_cvt_pk_bf16_f32 v80, v76, v77
    v_cvt_pk_bf16_f32 v81, v78, v79
    s_waitcnt vmcnt(0)
    v_lshlrev_b32 v76, 16, v80
    v_and_b32 v77, 0xffff0000, v80
    v_lshlrev_b32 v82, 16, v72
    v_and_b32 v83, 0xffff0000, v72
    v_add_f32 v76, v76, v82
    v_add_f32 v77, v77, v83
    v_lshlrev_b32 v78, 16, v81
    v_and_b32 v79, 0xffff0000, v81
    v_lshlrev_b32 v82, 16, v73
    v_and_b32 v83, 0xffff0000, v73
    v_add_f32 v78, v78, v82
    v_add_f32 v79, v79, v83
    v_cvt_pk_bf16_f32 v80, v76, v77
    v_cvt_pk_bf16_f32 v81, v78, v79
    v_add_u32 v6, 226492544, v5
    buffer_store_dwordx2 v[80:81], v6, s[8:11], 0 offen
    v_add_u32 v6, 247484416, v5
    buffer_load_dwordx2 v[72:73], v6, s[8:11], 0 offen
    v_accvgpr_read_b32 v76, a20
    v_accvgpr_read_b32 v77, a21
    v_accvgpr_read_b32 v78, a22
    v_accvgpr_read_b32 v79, a23
    v_cvt_pk_bf16_f32 v80, v76, v77
    v_cvt_pk_bf16_f32 v81, v78, v79
    s_waitcnt vmcnt(0)
    v_lshlrev_b32 v76, 16, v80
    v_and_b32 v77, 0xffff0000, v80
    v_lshlrev_b32 v82, 16, v72
    v_and_b32 v83, 0xffff0000, v72
    v_add_f32 v76, v76, v82
    v_add_f32 v77, v77, v83
    v_lshlrev_b32 v78, 16, v81
    v_and_b32 v79, 0xffff0000, v81
    v_lshlrev_b32 v82, 16, v73
    v_and_b32 v83, 0xffff0000, v73
    v_add_f32 v78, v78, v82
    v_add_f32 v79, v79, v83
    v_cvt_pk_bf16_f32 v80, v76, v77
    v_cvt_pk_bf16_f32 v81, v78, v79
    v_add_u32 v6, 226512896, v5
    buffer_store_dwordx2 v[80:81], v6, s[8:11], 0 offen
    v_add_u32 v6, 247484448, v5
    buffer_load_dwordx2 v[72:73], v6, s[8:11], 0 offen
    v_accvgpr_read_b32 v76, a24
    v_accvgpr_read_b32 v77, a25
    v_accvgpr_read_b32 v78, a26
    v_accvgpr_read_b32 v79, a27
    v_cvt_pk_bf16_f32 v80, v76, v77
    v_cvt_pk_bf16_f32 v81, v78, v79
    s_waitcnt vmcnt(0)
    v_lshlrev_b32 v76, 16, v80
    v_and_b32 v77, 0xffff0000, v80
    v_lshlrev_b32 v82, 16, v72
    v_and_b32 v83, 0xffff0000, v72
    v_add_f32 v76, v76, v82
    v_add_f32 v77, v77, v83
    v_lshlrev_b32 v78, 16, v81
    v_and_b32 v79, 0xffff0000, v81
    v_lshlrev_b32 v82, 16, v73
    v_and_b32 v83, 0xffff0000, v73
    v_add_f32 v78, v78, v82
    v_add_f32 v79, v79, v83
    v_cvt_pk_bf16_f32 v80, v76, v77
    v_cvt_pk_bf16_f32 v81, v78, v79
    v_add_u32 v6, 226512928, v5
    buffer_store_dwordx2 v[80:81], v6, s[8:11], 0 offen
    v_add_u32 v6, 247484480, v5
    buffer_load_dwordx2 v[72:73], v6, s[8:11], 0 offen
    v_accvgpr_read_b32 v76, a28
    v_accvgpr_read_b32 v77, a29
    v_accvgpr_read_b32 v78, a30
    v_accvgpr_read_b32 v79, a31
    v_cvt_pk_bf16_f32 v80, v76, v77
    v_cvt_pk_bf16_f32 v81, v78, v79
    s_waitcnt vmcnt(0)
    v_lshlrev_b32 v76, 16, v80
    v_and_b32 v77, 0xffff0000, v80
    v_lshlrev_b32 v82, 16, v72
    v_and_b32 v83, 0xffff0000, v72
    v_add_f32 v76, v76, v82
    v_add_f32 v77, v77, v83
    v_lshlrev_b32 v78, 16, v81
    v_and_b32 v79, 0xffff0000, v81
    v_lshlrev_b32 v82, 16, v73
    v_and_b32 v83, 0xffff0000, v73
    v_add_f32 v78, v78, v82
    v_add_f32 v79, v79, v83
    v_cvt_pk_bf16_f32 v80, v76, v77
    v_cvt_pk_bf16_f32 v81, v78, v79
    v_add_u32 v6, 226512960, v5
    buffer_store_dwordx2 v[80:81], v6, s[8:11], 0 offen
    v_add_u32 v6, 247484512, v5
    buffer_load_dwordx2 v[72:73], v6, s[8:11], 0 offen
    v_accvgpr_read_b32 v76, a32
    v_accvgpr_read_b32 v77, a33
    v_accvgpr_read_b32 v78, a34
    v_accvgpr_read_b32 v79, a35
    v_cvt_pk_bf16_f32 v80, v76, v77
    v_cvt_pk_bf16_f32 v81, v78, v79
    s_waitcnt vmcnt(0)
    v_lshlrev_b32 v76, 16, v80
    v_and_b32 v77, 0xffff0000, v80
    v_lshlrev_b32 v82, 16, v72
    v_and_b32 v83, 0xffff0000, v72
    v_add_f32 v76, v76, v82
    v_add_f32 v77, v77, v83
    v_lshlrev_b32 v78, 16, v81
    v_and_b32 v79, 0xffff0000, v81
    v_lshlrev_b32 v82, 16, v73
    v_and_b32 v83, 0xffff0000, v73
    v_add_f32 v78, v78, v82
    v_add_f32 v79, v79, v83
    v_cvt_pk_bf16_f32 v80, v76, v77
    v_cvt_pk_bf16_f32 v81, v78, v79
    v_add_u32 v6, 226512992, v5
    buffer_store_dwordx2 v[80:81], v6, s[8:11], 0 offen
    v_add_u32 v6, 247484544, v5
    buffer_load_dwordx2 v[72:73], v6, s[8:11], 0 offen
    v_accvgpr_read_b32 v76, a36
    v_accvgpr_read_b32 v77, a37
    v_accvgpr_read_b32 v78, a38
    v_accvgpr_read_b32 v79, a39
    v_cvt_pk_bf16_f32 v80, v76, v77
    v_cvt_pk_bf16_f32 v81, v78, v79
    s_waitcnt vmcnt(0)
    v_lshlrev_b32 v76, 16, v80
    v_and_b32 v77, 0xffff0000, v80
    v_lshlrev_b32 v82, 16, v72
    v_and_b32 v83, 0xffff0000, v72
    v_add_f32 v76, v76, v82
    v_add_f32 v77, v77, v83
    v_lshlrev_b32 v78, 16, v81
    v_and_b32 v79, 0xffff0000, v81
    v_lshlrev_b32 v82, 16, v73
    v_and_b32 v83, 0xffff0000, v73
    v_add_f32 v78, v78, v82
    v_add_f32 v79, v79, v83
    v_cvt_pk_bf16_f32 v80, v76, v77
    v_cvt_pk_bf16_f32 v81, v78, v79
    v_add_u32 v6, 226513024, v5
    buffer_store_dwordx2 v[80:81], v6, s[8:11], 0 offen
wo_a2_kernel_end:
    s_endpgm
.section .rodata,"a"
.p2align 6
.amdhsa_kernel wo_a2_kernel
  .amdhsa_next_free_vgpr 136
  .amdhsa_next_free_sgpr 64
  .amdhsa_accum_offset 96
  .amdhsa_group_segment_fixed_size 0
  .amdhsa_kernarg_size 104
  .amdhsa_user_sgpr_count 2
  .amdhsa_user_sgpr_kernarg_segment_ptr 1
  .amdhsa_system_sgpr_workgroup_id_x 1
.end_amdhsa_kernel
.text
.globl ln_b2_kernel
.p2align 8
.type ln_b2_kernel,@function
ln_b2_kernel:
    s_cmp_gt_u32 s2, 512
    s_cbranch_scc1 ln_b2_kernel_end
    s_load_dwordx2 s[4:5], s[0:1], 96
    s_load_dwordx2 s[6:7], s[0:1], 32
    v_lshrrev_b32 v1, 6, v0
    v_and_b32 v0, 63, v0
    s_nop 0
    v_readfirstlane_b32 s13, v1
    s_waitcnt lgkmcnt(0)
    s_mov_b32 s8, s4
    s_mov_b32 s9, s5
    s_mov_b32 s10, 268435456
    s_mov_b32 s11, 0x00020000
    s_cmp_eq_u32 s2, 512
    s_cbranch_scc1 ln_b2_kernel_mem0
    s_lshl_b32 s20, s2, 2
    s_add_u32 s20, s20, s13
    s_mul_i32 s21, s20, 1280
    s_add_u32 s21, s21, 226492416
    v_lshlrev_b32 v3, 2, v0
    buffer_load_dword v4, v3, s[8:11], s21 offen offset:0
    buffer_load_dword v5, v3, s[8:11], s21 offen offset:256
    buffer_load_dword v6, v3, s[8:11], s21 offen offset:512
    buffer_load_dword v7, v3, s[8:11], s21 offen offset:768
    buffer_load_dword v8, v3, s[8:11], s21 offen offset:1024
    v_lshrrev_b32 v20, 4, v0
    v_lshlrev_b32 v20, 2, v20
    v_bfe_u32 v21, v0, 3, 1
    v_lshl_add_u32 v20, v21, 1, v20
    v_bfe_u32 v21, v0, 1, 1
    v_add_u32 v20, v20, v21
    v_lshlrev_b32 v20, 9, v20
    v_and_b32 v21, 1, v0
    v_lshl_add_u32 v20, v21, 3, v20
    v_bfe_u32 v21, v0, 2, 1
    v_lshl_add_u32 v23, v21, 2, v20
    s_lshr_b32 s22, s20, 5
    s_mul_i32 s22, s22, 40960
    s_and_b32 s23, s20, 31
    s_lshl_b32 s23, s23, 4
    s_add_u32 s22, s22, s23
    s_add_u32 s22, s22, 220200960
    s_waitcnt vmcnt(0)
    v_lshlrev_b32 v10, 16, v4
    v_and_b32 v11, 0xffff0000, v4
    v_lshlrev_b32 v12, 16, v5
    v_and_b32 v13, 0xffff0000, v5
    v_lshlrev_b32 v14, 16, v6
    v_and_b32 v15, 0xffff0000, v6
    v_lshlrev_b32 v16, 16, v7
    v_and_b32 v17, 0xffff0000, v7
    v_lshlrev_b32 v18, 16, v8
    v_and_b32 v19, 0xffff0000, v8
    v_add_f32 v20, v10, v11
    v_add_f32 v20, v20, v12
    v_add_f32 v20, v20, v13
    v_add_f32 v20, v20, v14
    v_add_f32 v20, v20, v15
    v_add_f32 v20, v20, v16
    v_add_f32 v20, v20, v17
    v_add_f32 v20, v20, v18
    v_add_f32 v20, v20, v19
    s_nop 1
    v_add_f32 v21, v20, v20 quad_perm:[1,0,3,2] row_mask:0xf bank_mask:0xf
    s_nop 1
    v_add_f32 v21, v21, v21 quad_perm:[2,3,0,1] row_mask:0xf bank_mask:0xf
    s_nop 1
    v_add_f32 v21, v21, v21 row_half_mirror row_mask:0xf bank_mask:0xf
    s_nop 1
    v_add_f32 v21, v21, v21 row_mirror row_mask:0xf bank_mask:0xf
    s_nop 1
    v_readlane_b32 s24, v21, 0
    v_readlane_b32 s25, v21, 16
    v_readlane_b32 s26, v21, 32
    v_readlane_b32 s27, v21, 48
    s_nop 1
    v_mov_b32 v20, s24
    v_add_f32 v20, s25, v20
    v_add_f32 v20, s26, v20
    v_add_f32 v20, s27, v20
    v_mul_f32 v20, 0x3acccccd, v20
    v_sub_f32 v10, v10, v20
    v_sub_f32 v11, v11, v20
    v_sub_f32 v12, v12, v20
    v_sub_f32 v13, v13, v20
    v_sub_f32 v14, v14, v20
    v_sub_f32 v15, v15, v20
    v_sub_f32 v16, v16, v20
    v_sub_f32 v17, v17, v20
    v_sub_f32 v18, v18, v20
    v_sub_f32 v19, v19, v20
    v_mul_f32 v21, v10, v10
    v_fmac_f32 v21, v11, v11
    v_fmac_f32 v21, v12, v12
    v_fmac_f32 v21, v13, v13
    v_fmac_f32 v21, v14, v14
    v_fmac_f32 v21, v15, v15
    v_fmac_f32 v21, v16, v16
    v_fmac_f32 v21, v17, v17
    v_fmac_f32 v21, v18, v18
    v_fmac_f32 v21, v19, v19
    s_nop 1
    v_add_f32 v22, v21, v21 quad_perm:[1,0,3,2] row_mask:0xf bank_mask:0xf
    s_nop 1
    v_add_f32 v22, v22, v22 quad_perm:[2,3,0,1] row_mask:0xf bank_mask:0xf
    s_nop 1
    v_add_f32 v22, v22, v22 row_half_mirror row_mask:0xf bank_mask:0xf
    s_nop 1
    v_add_f32 v22, v22, v22 row_mirror row_mask:0xf bank_mask:0xf
    s_nop 1
    v_readlane_b32 s24, v22, 0
    v_readlane_b32 s25, v22, 16
    v_readlane_b32 s26, v22, 32
    v_readlane_b32 s27, v22, 48
    s_nop 1
    v_mov_b32 v21, s24
    v_add_f32 v21, s25, v21
    v_add_f32 v21, s26, v21
    v_add_f32 v21, s27, v21
    v_mov_b32 v22, 0x3727c5ac
    v_fmac_f32 v22, 0x3acccccd, v21
    v_rsq_f32 v22, v22
    s_nop 0
    v_mul_f32 v10, v10, v22
    v_mul_f32 v11, v11, v22
    v_mul_f32 v12, v12, v22
    v_mul_f32 v13, v13, v22
    v_mul_f32 v14, v14, v22
    v_mul_f32 v15, v15, v22
    v_mul_f32 v16, v16, v22
    v_mul_f32 v17, v17, v22
    v_mul_f32 v18, v18, v22
    v_mul_f32 v19, v19, v22
    v_cvt_pk_bf16_f32 v4, v10, v11
    v_cvt_pk_bf16_f32 v5, v12, v13
    v_cvt_pk_bf16_f32 v6, v14, v15
    v_cvt_pk_bf16_f32 v7, v16, v17
    v_cvt_pk_bf16_f32 v8, v18, v19
    s_add_u32 s23, s22, 0
    buffer_store_dword v4, v23, s[8:11], s23 offen
    s_add_u32 s23, s22, 8192
    buffer_store_dword v5, v23, s[8:11], s23 offen
    s_add_u32 s23, s22, 16384
    buffer_store_dword v6, v23, s[8:11], s23 offen
    s_add_u32 s23, s22, 24576
    buffer_store_dword v7, v23, s[8:11], s23 offen
    s_add_u32 s23, s22, 32768
    buffer_store_dword v8, v23, s[8:11], s23 offen
    s_branch ln_b2_kernel_end
ln_b2_kernel_mem0:
    s_mov_b32 s16, s6
    s_mov_b32 s17, s7
    s_mov_b32 s18, 10240
    s_mov_b32 s19, 0x00020000
    s_sub_u32 s22, 0, s4
    s_and_b32 s22, s22, 0x1fffff
    s_mov_b32 s23, 10551304
    s_buffer_load_dword s24, s[8:11], s23
    s_waitcnt lgkmcnt(0)
    s_and_b32 s24, s24, 8192
    s_add_u32 s22, s22, s24
    s_add_u32 s22, s22, 4194304
    s_lshl_b32 s25, s13, 6
    v_add_u32 v1, s25, v0
    v_add_u32 v2, 0, v1
    v_and_b32 v3, 7, v2
    v_mul_u32_u24 v3, 1280, v3
    v_lshrrev_b32 v4, 3, v2
    v_lshl_add_u32 v3, v4, 4, v3
    v_lshlrev_b32 v5, 4, v2
    v_add_u32 v5, 20480, v5
    v_lshrrev_b32 v6, 13, v5
    v_lshlrev_b32 v6, 14, v6
    v_and_b32 v5, 8191, v5
    v_add_u32 v5, v5, v6
    v_cmp_gt_u32 vcc, 640, v2
    s_and_saveexec_b64 s[30:31], vcc
    s_cbranch_execz ln_b2_kernel_m0s0
    buffer_load_dwordx4 v[8:11], v3, s[16:19], 0 offen
    s_waitcnt vmcnt(0)
    buffer_store_dwordx4 v[8:11], v5, s[8:11], s22 offen
ln_b2_kernel_m0s0:
    s_mov_b64 exec, s[30:31]
    v_add_u32 v2, 256, v1
    v_and_b32 v3, 7, v2
    v_mul_u32_u24 v3, 1280, v3
    v_lshrrev_b32 v4, 3, v2
    v_lshl_add_u32 v3, v4, 4, v3
    v_lshlrev_b32 v5, 4, v2
    v_add_u32 v5, 20480, v5
    v_lshrrev_b32 v6, 13, v5
    v_lshlrev_b32 v6, 14, v6
    v_and_b32 v5, 8191, v5
    v_add_u32 v5, v5, v6
    v_cmp_gt_u32 vcc, 640, v2
    s_and_saveexec_b64 s[30:31], vcc
    s_cbranch_execz ln_b2_kernel_m0s1
    buffer_load_dwordx4 v[8:11], v3, s[16:19], 0 offen
    s_waitcnt vmcnt(0)
    buffer_store_dwordx4 v[8:11], v5, s[8:11], s22 offen
ln_b2_kernel_m0s1:
    s_mov_b64 exec, s[30:31]
    v_add_u32 v2, 512, v1
    v_and_b32 v3, 7, v2
    v_mul_u32_u24 v3, 1280, v3
    v_lshrrev_b32 v4, 3, v2
    v_lshl_add_u32 v3, v4, 4, v3
    v_lshlrev_b32 v5, 4, v2
    v_add_u32 v5, 20480, v5
    v_lshrrev_b32 v6, 13, v5
    v_lshlrev_b32 v6, 14, v6
    v_and_b32 v5, 8191, v5
    v_add_u32 v5, v5, v6
    v_cmp_gt_u32 vcc, 640, v2
    s_and_saveexec_b64 s[30:31], vcc
    s_cbranch_execz ln_b2_kernel_m0s2
    buffer_load_dwordx4 v[8:11], v3, s[16:19], 0 offen
    s_waitcnt vmcnt(0)
    buffer_store_dwordx4 v[8:11], v5, s[8:11], s22 offen
ln_b2_kernel_m0s2:
    s_mov_b64 exec, s[30:31]
ln_b2_kernel_end:
    s_endpgm
.section .rodata,"a"
.p2align 6
.amdhsa_kernel ln_b2_kernel
  .amdhsa_next_free_vgpr 32
  .amdhsa_next_free_sgpr 48
  .amdhsa_accum_offset 32
  .amdhsa_group_segment_fixed_size 0
  .amdhsa_kernarg_size 104
  .amdhsa_user_sgpr_count 2
  .amdhsa_user_sgpr_kernarg_segment_ptr 1
  .amdhsa_system_sgpr_workgroup_id_x 1
.end_amdhsa_kernel
.text
.globl chain2_kernel
.p2align 8
.type chain2_kernel,@function
chain2_kernel:
    s_cmp_ge_u32 s2, 256
    s_cbranch_scc1 chain2_kernel_end
    s_load_dwordx2 s[4:5], s[0:1], 96
    v_lshrrev_b32 v1, 6, v0
    v_and_b32 v0, 63, v0
    s_nop 0
    v_readfirstlane_b32 s13, v1
    s_mov_b32 s15, 400000
    s_waitcnt lgkmcnt(0)
    s_mov_b32 s8, s4
    s_mov_b32 s9, s5
    s_mov_b32 s10, 268435456
    s_mov_b32 s11, 0x00020000
    s_getreg_b32 s20, hwreg(HW_REG_XCC_ID)
    s_and_b32 s20, s20, 7
    s_cmp_lg_u32 s13, 0
    s_cbranch_scc1 chain2_kernel_tk_wait
    s_lshl_b32 s22, s20, 8
    s_add_u32 s22, s22, 10487808
    s_mov_b64 exec, 1
    v_mov_b32 v2, 0
    v_mov_b32 v3, 1
    buffer_atomic_add v3, v2, s[8:11], s22 offen sc0 sc1
    s_waitcnt vmcnt(0)
    s_mov_b64 exec, -1
    s_nop 0
    v_readfirstlane_b32 s21, v3
    s_cmp_lt_u32 s21, 32
    s_cbranch_scc1 chain2_kernel_tk_pub
    v_lshlrev_b32 v2, 8, v0
    v_and_b32 v2, 0x7ff, v2
    s_mov_b32 s22, 10487808
chain2_kernel_tk_poll:
    buffer_load_dword v3, v2, s[8:11], s22 offen sc1
    s_waitcnt vmcnt(0)
    s_mov_b32 s23, 0
    v_readlane_b32 s24, v3, 0
    s_nop 0
    s_add_u32 s23, s23, s24
    v_readlane_b32 s25, v3, 1
    s_nop 0
    s_add_u32 s23, s23, s25
    v_readlane_b32 s26, v3, 2
    s_nop 0
    s_add_u32 s23, s23, s26
    v_readlane_b32 s27, v3, 3
    s_nop 0
    s_add_u32 s23, s23, s27
    v_readlane_b32 s28, v3, 4
    s_nop 0
    s_add_u32 s23, s23, s28
    v_readlane_b32 s29, v3, 5
    s_nop 0
    s_add_u32 s23, s23, s29
    v_readlane_b32 s30, v3, 6
    s_nop 0
    s_add_u32 s23, s23, s30
    v_readlane_b32 s31, v3, 7
    s_nop 0
    s_add_u32 s23, s23, s31
    s_sub_u32 s15, s15, 1
    s_cbranch_scc1 chain2_kernel_bail
    s_cmp_lt_u32 s23, 256
    s_cbranch_scc1 chain2_kernel_tk_poll
    s_sub_u32 s21, s21, 32
    s_max_u32 s23, s24, 32
    s_sub_u32 s23, s23, 32
    s_cmp_gt_u32 s20, 0
    s_cselect_b32 s23, s23, 0
    s_add_u32 s21, s21, s23
    s_max_u32 s23, s25, 32
    s_sub_u32 s23, s23, 32
    s_cmp_gt_u32 s20, 1
    s_cselect_b32 s23, s23, 0
    s_add_u32 s21, s21, s23
    s_max_u32 s23, s26, 32
    s_sub_u32 s23, s23, 32
    s_cmp_gt_u32 s20, 2
    s_cselect_b32 s23, s23, 0
    s_add_u32 s21, s21, s23
    s_max_u32 s23, s27, 32
    s_sub_u32 s23, s23, 32
    s_cmp_gt_u32 s20, 3
    s_cselect_b32 s23, s23, 0
    s_add_u32 s21, s21, s23
    s_max_u32 s23, s28, 32
    s_sub_u32 s23, s23, 32
    s_cmp_gt_u32 s20, 4
    s_cselect_b32 s23, s23, 0
    s_add_u32 s21, s21, s23
    s_max_u32 s23, s29, 32
    s_sub_u32 s23, s23, 32
    s_cmp_gt_u32 s20, 5
    s_cselect_b32 s23, s23, 0
    s_add_u32 s21, s21, s23
    s_max_u32 s23, s30, 32
    s_sub_u32 s23, s23, 32
    s_cmp_gt_u32 s20, 6
    s_cselect_b32 s23, s23, 0
    s_add_u32 s21, s21, s23
    s_min_u32 s23, s24, 32
    s_sub_u32 s22, 32, s23
    s_cmp_lt_u32 s21, s22
    s_cbranch_scc0 chain2_kernel_tk_n0
    s_mov_b32 s20, 0
    s_add_u32 s21, s21, s23
    s_branch chain2_kernel_tk_pub
chain2_kernel_tk_n0:
    s_sub_u32 s21, s21, s22
    s_min_u32 s23, s25, 32
    s_sub_u32 s22, 32, s23
    s_cmp_lt_u32 s21, s22
    s_cbranch_scc0 chain2_kernel_tk_n1
    s_mov_b32 s20, 1
    s_add_u32 s21, s21, s23
    s_branch chain2_kernel_tk_pub
chain2_kernel_tk_n1:
    s_sub_u32 s21, s21, s22
    s_min_u32 s23, s26, 32
    s_sub_u32 s22, 32, s23
    s_cmp_lt_u32 s21, s22
    s_cbranch_scc0 chain2_kernel_tk_n2
    s_mov_b32 s20, 2
    s_add_u32 s21, s21, s23
    s_branch chain2_kernel_tk_pub
chain2_kernel_tk_n2:
    s_sub_u32 s21, s21, s22
    s_min_u32 s23, s27, 32
    s_sub_u32 s22, 32, s23
    s_cmp_lt_u32 s21, s22
    s_cbranch_scc0 chain2_kernel_tk_n3
    s_mov_b32 s20, 3
    s_add_u32 s21, s21, s23
    s_branch chain2_kernel_tk_pub
chain2_kernel_tk_n3:
    s_sub_u32 s21, s21, s22
    s_min_u32 s23, s28, 32
    s_sub_u32 s22, 32, s23
    s_cmp_lt_u32 s21, s22
    s_cbranch_scc0 chain2_kernel_tk_n4
    s_mov_b32 s20, 4
    s_add_u32 s21, s21, s23
    s_branch chain2_kernel_tk_pub
chain2_kernel_tk_n4:
    s_sub_u32 s21, s21, s22
    s_min_u32 s23, s29, 32
    s_sub_u32 s22, 32, s23
    s_cmp_lt_u32 s21, s22
    s_cbranch_scc0 chain2_kernel_tk_n5
    s_mov_b32 s20, 5
    s_add_u32 s21, s21, s23
    s_branch chain2_kernel_tk_pub
chain2_kernel_tk_n5:
    s_sub_u32 s21, s21, s22
    s_min_u32 s23, s30, 32
    s_sub_u32 s22, 32, s23
    s_cmp_lt_u32 s21, s22
    s_cbranch_scc0 chain2_kernel_tk_n6
    s_mov_b32 s20, 6
    s_add_u32 s21, s21, s23
    s_branch chain2_kernel_tk_pub
chain2_kernel_tk_n6:
    s_sub_u32 s21, s21, s22
    s_min_u32 s23, s31, 32
    s_sub_u32 s22, 32, s23
    s_cmp_lt_u32 s21, s22
    s_cbranch_scc0 chain2_kernel_tk_n7
    s_mov_b32 s20, 7
    s_add_u32 s21, s21, s23
    s_branch chain2_kernel_tk_pub
chain2_kernel_tk_n7:
    s_sub_u32 s21, s21, s22
    s_branch chain2_kernel_bail
chain2_kernel_tk_pub:
    s_lshl_b32 s22, s20, 8
    s_or_b32 s22, s22, s21
    v_mov_b32 v2, 0
    v_mov_b32 v3, s22
    ds_write_b32 v2, v3
    s_waitcnt lgkmcnt(0)
chain2_kernel_tk_wait:
    s_barrier
    v_mov_b32 v2, 0
    ds_read_b32 v3, v2
    s_waitcnt lgkmcnt(0)
    v_readfirstlane_b32 s22, v3
    s_barrier
    s_lshr_b32 s20, s22, 8
    s_and_b32 s21, s22, 255
    s_sub_u32 s22, 0, s4
    s_and_b32 s22, s22, 0x1fffff
    s_mov_b32 s23, 10551304
    s_buffer_load_dwordx2 s[24:25], s[8:11], s23
    s_waitcnt lgkmcnt(0)
    s_and_b32 s24, s24, 8192
    s_and_b32 s25, s25, 8192
    s_add_u32 s22, s22, 4194304
    s_add_u32 s16, s22, s24
    s_add_u32 s17, s22, s25
    s_add_u32 s17, s17, 2097152
    s_mov_b32 s40, 0x01010101
    s_mov_b32 s41, 0x01010101
    s_mov_b32 s42, 0x00010001
    s_mov_b32 s43, 0
    v_lshlrev_b32 v1, 4, v0
    v_and_b32 v16, 8, v0
    v_cmp_eq_u32 vcc, 0, v16
    v_mov_b32 v17, 0xeeeeeeee
    v_mov_b32 v18, 0x44444444
    v_cndmask_b32 v2, v17, v18, vcc
    s_cmp_eq_u32 s20, 0
    s_cbranch_scc0 chain2_kernel_notp
    s_mov_b32 s12, s21
    s_cmp_eq_u32 s13, 0
    s_cbranch_scc1 chain2_kernel_p0_start
    s_cmp_eq_u32 s13, 1
    s_cbranch_scc1 chain2_kernel_p1_start
    s_cmp_eq_u32 s13, 2
    s_cbranch_scc1 chain2_kernel_p2_start
    s_cmp_eq_u32 s13, 3
    s_cbranch_scc1 chain2_kernel_p3_start
chain2_kernel_notp:
    s_cmp_ge_u32 s20, 4
    s_cbranch_scc1 chain2_kernel_end
    s_cmp_ge_u32 s21, 27
    s_cbranch_scc1 chain2_kernel_end
    s_sub_u32 s22, s20, 1
    s_mul_i32 s22, s22, 27
    s_add_u32 s12, s22, s21
    s_cmp_ge_u32 s12, 80
    s_cbranch_scc1 chain2_kernel_end
    s_cmp_eq_u32 s13, 0
    s_cbranch_scc1 chain2_kernel_y0_start
    s_cmp_eq_u32 s13, 1
    s_cbranch_scc1 chain2_kernel_y1_start
    s_cmp_eq_u32 s13, 2
    s_cbranch_scc1 chain2_kernel_y2_start
    s_cmp_eq_u32 s13, 3
    s_cbranch_scc1 chain2_kernel_y3_start
    s_branch chain2_kernel_end
chain2_kernel_p0_start:
    v_lshrrev_b32 v16, 4, v0
    v_and_b32 v17, 15, v0
    v_and_b32 v18, 1, v16
    v_lshlrev_b32 v18, 2, v18
    v_lshrrev_b32 v19, 1, v16
    v_lshl_add_u32 v18, v19, 1, v18
    v_mul_u32_u24 v18, 400, v18
    v_lshl_add_u32 v18, v17, 1, v18
    v_add_u32 v3, 133120, v18
    v_and_b32 v18, 7, v0
    v_mul_u32_u24 v18, 400, v18
    v_lshrrev_b32 v19, 3, v0
    v_lshl_add_u32 v18, v19, 4, v18
    v_add_u32 v4, 133120, v18
    v_and_b32 v18, 7, v0
    v_mul_u32_u24 v18, 400, v18
    v_lshl_add_u32 v18, v16, 5, v18
    v_add_u32 v5, 136320, v18
    v_lshrrev_b32 v18, 1, v16
    v_lshlrev_b32 v18, 10, v18
    v_and_b32 v19, 31, v0
    v_lshl_add_u32 v18, v19, 4, v18
    v_add_u32 v6, 139520, v18
    v_add_u32 v15, 139520, v1
    v_lshrrev_b32 v18, 1, v16
    v_lshlrev_b32 v18, 1, v18
    v_lshrrev_b32 v19, 3, v17
    v_add3_u32 v18, v18, v19, 1
    v_lshrrev_b32 v19, 1, v18
    v_lshlrev_b32 v19, 14, v19
    v_and_b32 v18, 1, v18
    v_lshl_add_u32 v18, v18, 12, v19
    v_and_b32 v19, 1, v16
    v_lshlrev_b32 v19, 4, v19
    v_add_u32 v19, 0, v19
    s_lshl_b32 s20, s12, 7
    v_add_u32 v8, s20, v19
    v_add_u32 v7, v8, v18
    v_lshlrev_b32 v18, 4, v17
    v_lshl_add_u32 v18, v16, 10, v18
    v_add_u32 v9, 0, v18
    v_add_u32 v18, 0, v0
    v_mul_u32_u24 v19, 2731, v18
    v_lshrrev_b32 v19, 16, v19
    v_mul_u32_u24 v20, 24, v19
    v_sub_u32 v20, v18, v20
    v_mul_u32_u24 v21, 400, v19
    v_lshl_add_u32 v21, v20, 4, v21
    v_add_u32 v10, 136320, v21
    v_lshlrev_b32 v21, 4, v19
    v_lshl_add_u32 v11, v20, 7, v21
    v_and_b32 v18, 0x28, v0
    v_cmp_eq_u32 vcc, 0, v18
    v_mov_b32 v18, 1.0
    v_mov_b32 v19, 0
    v_cndmask_b32 v12, v19, v18, vcc
    v_add_u32 v13, 0, v1
    v_add_u32 v14, 122880, v1
    s_mul_i32 s44, s12, 12288
    s_add_u32 s44, s44, 53477376
    s_mul_i32 s45, s12, 3072
    s_add_u32 s45, s45, 208666624
    s_mul_i32 s20, s12, 491520
    s_add_u32 s20, s20, 11534336
    s_add_u32 s21, s20, 6144
    buffer_load_dwordx4 v[16:19], v1, s[8:11], s21 offen offset:0
    buffer_load_dwordx4 v[20:23], v1, s[8:11], s21 offen offset:1024
    s_add_u32 s21, s20, 47104
    buffer_load_dwordx4 v[24:27], v1, s[8:11], s21 offen offset:0
    buffer_load_dwordx4 v[28:31], v1, s[8:11], s21 offen offset:1024
    s_add_u32 s21, s20, 28672
    buffer_load_dwordx4 v[32:35], v1, s[8:11], s21 offen offset:0
    buffer_load_dwordx4 v[36:39], v1, s[8:11], s21 offen offset:1024
    s_add_u32 s21, s20, 10240
    buffer_load_dwordx4 v[40:43], v1, s[8:11], s21 offen offset:0
    buffer_load_dwordx4 v[44:47], v1, s[8:11], s21 offen offset:1024
    s_add_u32 s21, s20, 51200
    buffer_load_dwordx4 v[48:51], v1, s[8:11], s21 offen offset:0
    buffer_load_dwordx4 v[52:55], v1, s[8:11], s21 offen offset:1024
    s_add_u32 s21, s20, 32768
    buffer_load_dwordx4 v[56:59], v1, s[8:11], s21 offen offset:0
    buffer_load_dwordx4 v[60:63], v1, s[8:11], s21 offen offset:1024
    s_add_u32 s21, s20, 14336
    buffer_load_dwordx4 v[64:67], v1, s[8:11], s21 offen offset:0
    buffer_load_dwordx4 v[68:71], v1, s[8:11], s21 offen offset:1024
    s_add_u32 s21, s20, 55296
    buffer_load_dwordx4 v[72:75], v1, s[8:11], s21 offen offset:0
    buffer_load_dwordx4 v[76:79], v1, s[8:11], s21 offen offset:1024
    s_add_u32 s21, s20, 36864
    buffer_load_dwordx4 v[80:83], v1, s[8:11], s21 offen offset:0
    buffer_load_dwordx4 v[84:87], v1, s[8:11], s21 offen offset:1024
    s_add_u32 s21, s20, 18432
    buffer_load_dwordx4 v[88:91], v1, s[8:11], s21 offen offset:0
    buffer_load_dwordx4 v[92:95], v1, s[8:11], s21 offen offset:1024
    s_add_u32 s21, s20, 59392
    buffer_load_dwordx4 v[96:99], v1, s[8:11], s21 offen offset:0
    buffer_load_dwordx4 v[100:103], v1, s[8:11], s21 offen offset:1024
    s_add_u32 s21, s20, 90112
    buffer_load_dwordx4 v[104:107], v1, s[8:11], s21 offen offset:0
    buffer_load_dwordx4 v[108:111], v1, s[8:11], s21 offen offset:1024
    s_add_u32 s21, s20, 98304
    buffer_load_dwordx4 v[112:115], v1, s[8:11], s21 offen offset:0
    buffer_load_dwordx4 v[116:119], v1, s[8:11], s21 offen offset:1024
    s_add_u32 s21, s20, 106496
    buffer_load_dwordx4 v[120:123], v1, s[8:11], s21 offen offset:0
    buffer_load_dwordx4 v[124:127], v1, s[8:11], s21 offen offset:1024
    s_add_u32 s21, s20, 114688
    buffer_load_dwordx4 v[128:131], v1, s[8:11], s21 offen offset:0
    buffer_load_dwordx4 v[132:135], v1, s[8:11], s21 offen offset:1024
    s_add_u32 s21, s20, 0
    buffer_load_dwordx4 a[0:3], v1, s[8:11], s21 offen offset:0
    buffer_load_dwordx4 a[4:7], v1, s[8:11], s21 offen offset:1024
    s_add_u32 s21, s20, 20480
    buffer_load_dwordx4 a[8:11], v1, s[8:11], s21 offen offset:0
    buffer_load_dwordx4 a[12:15], v1, s[8:11], s21 offen offset:1024
    s_add_u32 s21, s20, 40960
    buffer_load_dwordx4 a[16:19], v1, s[8:11], s21 offen offset:0
    buffer_load_dwordx4 a[20:23], v1, s[8:11], s21 offen offset:1024
    s_add_u32 s21, s20, 2048
    buffer_load_dwordx4 a[24:27], v1, s[8:11], s21 offen offset:0
    buffer_load_dwordx4 a[28:31], v1, s[8:11], s21 offen offset:1024
    s_add_u32 s21, s20, 22528
    buffer_load_dwordx4 a[32:35], v1, s[8:11], s21 offen offset:0
    buffer_load_dwordx4 a[36:39], v1, s[8:11], s21 offen offset:1024
    s_add_u32 s21, s20, 43008
    buffer_load_dwordx4 a[40:43], v1, s[8:11], s21 offen offset:0
    buffer_load_dwordx4 a[44:47], v1, s[8:11], s21 offen offset:1024
    s_add_u32 s21, s20, 4096
    buffer_load_dwordx4 a[48:51], v1, s[8:11], s21 offen offset:0
    buffer_load_dwordx4 a[52:55], v1, s[8:11], s21 offen offset:1024
    s_add_u32 s21, s20, 24576
    buffer_load_dwordx4 a[56:59], v1, s[8:11], s21 offen offset:0
    buffer_load_dwordx4 a[60:63], v1, s[8:11], s21 offen offset:1024
    s_add_u32 s21, s20, 45056
    buffer_load_dwordx4 a[64:67], v1, s[8:11], s21 offen offset:0
    buffer_load_dwordx4 a[68:71], v1, s[8:11], s21 offen offset:1024
    s_add_u32 s21, s20, 26624
    buffer_load_dwordx4 a[72:75], v1, s[8:11], s21 offen offset:0
    buffer_load_dwordx4 a[76:79], v1, s[8:11], s21 offen offset:1024
    s_add_u32 s21, s20, 8192
    buffer_load_dwordx4 a[80:83], v1, s[8:11], s21 offen offset:0
    buffer_load_dwordx4 a[84:87], v1, s[8:11], s21 offen offset:1024
    s_add_u32 s21, s20, 49152
    buffer_load_dwordx4 a[88:91], v1, s[8:11], s21 offen offset:0
    buffer_load_dwordx4 a[92:95], v1, s[8:11], s21 offen offset:1024
    s_add_u32 s21, s20, 30720
    buffer_load_dwordx4 a[96:99], v1, s[8:11], s21 offen offset:0
    buffer_load_dwordx4 a[100:103], v1, s[8:11], s21 offen offset:1024
    s_add_u32 s21, s20, 12288
    buffer_load_dwordx4 a[104:107], v1, s[8:11], s21 offen offset:0
    buffer_load_dwordx4 a[108:111], v1, s[8:11], s21 offen offset:1024
    s_add_u32 s21, s20, 53248
    buffer_load_dwordx4 a[112:115], v1, s[8:11], s21 offen offset:0
    buffer_load_dwordx4 a[116:119], v1, s[8:11], s21 offen offset:1024
    s_add_u32 s21, s20, 34816
    buffer_load_dwordx4 a[120:123], v1, s[8:11], s21 offen offset:0
    buffer_load_dwordx4 a[124:127], v1, s[8:11], s21 offen offset:1024
    s_waitcnt vmcnt(32)
    ds_write_b128 v13, v[16:19] offset:0
    ds_write_b128 v13, v[20:23] offset:1024
    ds_write_b128 v13, v[24:27] offset:2048
    ds_write_b128 v13, v[28:31] offset:3072
    ds_write_b128 v13, v[32:35] offset:4096
    ds_write_b128 v13, v[36:39] offset:5120
    ds_write_b128 v13, v[40:43] offset:6144
    ds_write_b128 v13, v[44:47] offset:7168
    ds_write_b128 v13, v[48:51] offset:8192
    ds_write_b128 v13, v[52:55] offset:9216
    ds_write_b128 v13, v[56:59] offset:10240
    ds_write_b128 v13, v[60:63] offset:11264
    ds_write_b128 v13, v[64:67] offset:12288
    ds_write_b128 v13, v[68:71] offset:13312
    ds_write_b128 v13, v[72:75] offset:14336
    ds_write_b128 v13, v[76:79] offset:15360
    ds_write_b128 v13, v[80:83] offset:16384
    ds_write_b128 v13, v[84:87] offset:17408
    ds_write_b128 v13, v[88:91] offset:18432
    ds_write_b128 v13, v[92:95] offset:19456
    ds_write_b128 v13, v[96:99] offset:20480
    ds_write_b128 v13, v[100:103] offset:21504
    ds_write_b128 v13, v[104:107] offset:22528
    ds_write_b128 v13, v[108:111] offset:23552
    ds_write_b128 v13, v[112:115] offset:24576
    ds_write_b128 v13, v[116:119] offset:25600
    ds_write_b128 v13, v[120:123] offset:26624
    ds_write_b128 v13, v[124:127] offset:27648
    ds_write_b128 v13, v[128:131] offset:28672
    ds_write_b128 v13, v[132:135] offset:29696
    s_add_u32 s21, s20, 16384
    buffer_load_dwordx4 a[128:131], v1, s[8:11], s21 offen offset:0
    buffer_load_dwordx4 a[132:135], v1, s[8:11], s21 offen offset:1024
    s_add_u32 s21, s20, 57344
    buffer_load_dwordx4 a[136:139], v1, s[8:11], s21 offen offset:0
    buffer_load_dwordx4 a[140:143], v1, s[8:11], s21 offen offset:1024
    s_add_u32 s21, s20, 38912
    buffer_load_dwordx4 a[144:147], v1, s[8:11], s21 offen offset:0
    buffer_load_dwordx4 a[148:151], v1, s[8:11], s21 offen offset:1024
    s_add_u32 s21, s20, 61440
    buffer_load_dwordx4 a[152:155], v1, s[8:11], s21 offen offset:0
    buffer_load_dwordx4 a[156:159], v1, s[8:11], s21 offen offset:1024
    s_add_u32 s21, s20, 63488
    buffer_load_dwordx4 a[160:163], v1, s[8:11], s21 offen offset:0
    buffer_load_dwordx4 a[164:167], v1, s[8:11], s21 offen offset:1024
    s_add_u32 s21, s20, 65536
    buffer_load_dwordx4 a[168:171], v1, s[8:11], s21 offen offset:0
    buffer_load_dwordx4 a[172:175], v1, s[8:11], s21 offen offset:1024
    s_add_u32 s21, s20, 67584
    buffer_load_dwordx4 a[176:179], v1, s[8:11], s21 offen offset:0
    buffer_load_dwordx4 a[180:183], v1, s[8:11], s21 offen offset:1024
    s_add_u32 s21, s20, 69632
    buffer_load_dwordx4 a[184:187], v1, s[8:11], s21 offen offset:0
    buffer_load_dwordx4 a[188:191], v1, s[8:11], s21 offen offset:1024
    s_add_u32 s21, s20, 71680
    buffer_load_dwordx4 a[192:195], v1, s[8:11], s21 offen offset:0
    buffer_load_dwordx4 a[196:199], v1, s[8:11], s21 offen offset:1024
    s_add_u32 s21, s20, 73728
    buffer_load_dwordx4 a[200:203], v1, s[8:11], s21 offen offset:0
    buffer_load_dwordx4 a[204:207], v1, s[8:11], s21 offen offset:1024
    s_add_u32 s21, s20, 75776
    buffer_load_dwordx4 a[208:211], v1, s[8:11], s21 offen offset:0
    buffer_load_dwordx4 a[212:215], v1, s[8:11], s21 offen offset:1024
    s_add_u32 s21, s20, 77824
    buffer_load_dwordx4 a[216:219], v1, s[8:11], s21 offen offset:0
    buffer_load_dwordx4 a[220:223], v1, s[8:11], s21 offen offset:1024
    s_add_u32 s21, s20, 79872
    buffer_load_dwordx4 a[224:227], v1, s[8:11], s21 offen offset:0
    buffer_load_dwordx4 a[228:231], v1, s[8:11], s21 offen offset:1024
    s_add_u32 s21, s20, 81920
    buffer_load_dwordx4 a[232:235], v1, s[8:11], s21 offen offset:0
    buffer_load_dwordx4 a[236:239], v1, s[8:11], s21 offen offset:1024
    s_add_u32 s21, s20, 83968
    buffer_load_dwordx4 a[240:243], v1, s[8:11], s21 offen offset:0
    buffer_load_dwordx4 a[244:247], v1, s[8:11], s21 offen offset:1024
    s_add_u32 s21, s20, 86016
    buffer_load_dwordx4 a[248:251], v1, s[8:11], s21 offen offset:0
    buffer_load_dwordx4 a[252:255], v1, s[8:11], s21 offen offset:1024
    s_add_u32 s21, s20, 88064
    buffer_load_dwordx4 v[148:151], v1, s[8:11], s21 offen offset:0
    buffer_load_dwordx4 v[152:155], v1, s[8:11], s21 offen offset:1024
    s_add_u32 s21, s20, 92160
    buffer_load_dwordx4 v[156:159], v1, s[8:11], s21 offen offset:0
    buffer_load_dwordx4 v[160:163], v1, s[8:11], s21 offen offset:1024
    s_add_u32 s21, s20, 94208
    buffer_load_dwordx4 v[164:167], v1, s[8:11], s21 offen offset:0
    buffer_load_dwordx4 v[168:171], v1, s[8:11], s21 offen offset:1024
    s_add_u32 s21, s20, 96256
    buffer_load_dwordx4 v[172:175], v1, s[8:11], s21 offen offset:0
    buffer_load_dwordx4 v[176:179], v1, s[8:11], s21 offen offset:1024
    s_add_u32 s21, s20, 100352
    buffer_load_dwordx4 v[180:183], v1, s[8:11], s21 offen offset:0
    buffer_load_dwordx4 v[184:187], v1, s[8:11], s21 offen offset:1024
    s_add_u32 s21, s20, 102400
    buffer_load_dwordx4 v[188:191], v1, s[8:11], s21 offen offset:0
    buffer_load_dwordx4 v[192:195], v1, s[8:11], s21 offen offset:1024
    s_add_u32 s21, s20, 104448
    buffer_load_dwordx4 v[196:199], v1, s[8:11], s21 offen offset:0
    buffer_load_dwordx4 v[200:203], v1, s[8:11], s21 offen offset:1024
    s_add_u32 s21, s20, 108544
    buffer_load_dwordx4 v[204:207], v1, s[8:11], s21 offen offset:0
    buffer_load_dwordx4 v[208:211], v1, s[8:11], s21 offen offset:1024
    s_add_u32 s21, s20, 110592
    buffer_load_dwordx4 v[212:215], v1, s[8:11], s21 offen offset:0
    buffer_load_dwordx4 v[216:219], v1, s[8:11], s21 offen offset:1024
    s_add_u32 s21, s20, 112640
    buffer_load_dwordx4 v[220:223], v1, s[8:11], s21 offen offset:0
    buffer_load_dwordx4 v[224:227], v1, s[8:11], s21 offen offset:1024
    s_add_u32 s21, s20, 116736
    buffer_load_dwordx4 v[228:231], v1, s[8:11], s21 offen offset:0
    buffer_load_dwordx4 v[232:235], v1, s[8:11], s21 offen offset:1024
    s_add_u32 s21, s20, 118784
    buffer_load_dwordx4 v[236:239], v1, s[8:11], s21 offen offset:0
    buffer_load_dwordx4 v[240:243], v1, s[8:11], s21 offen offset:1024
    s_add_u32 s21, s20, 120832
    buffer_load_dwordx4 v[244:247], v1, s[8:11], s21 offen offset:0
    buffer_load_dwordx4 v[248:251], v1, s[8:11], s21 offen offset:1024
    s_waitcnt lgkmcnt(0)
    s_mov_b32 s14, 0
    s_mul_i32 s20, s14, 393216
    s_add_u32 s20, s20, s44
    s_add_u32 s21, s20, 0
    buffer_load_dwordx4 v[100:103], v9, s[8:11], s21 offen offset:0
    buffer_load_dwordx4 v[104:107], v9, s[8:11], s21 offen offset:512
    s_add_u32 s21, s20, 4096
    buffer_load_dwordx4 v[108:111], v9, s[8:11], s21 offen offset:0
    buffer_load_dwordx4 v[112:115], v9, s[8:11], s21 offen offset:512
    v_mov_b32 v56, 0
    v_mov_b32 v57, 0
    v_mov_b32 v58, 0
    v_mov_b32 v59, 0
    v_mov_b32 v60, 0
    v_mov_b32 v61, 0
    v_mov_b32 v62, 0
    v_mov_b32 v63, 0
    v_mov_b32 v64, 0
    v_mov_b32 v65, 0
    v_mov_b32 v66, 0
    v_mov_b32 v67, 0
    v_mov_b32 v68, 0
    v_mov_b32 v69, 0
    v_mov_b32 v70, 0
    v_mov_b32 v71, 0
    v_mov_b32 v72, 0
    v_mov_b32 v73, 0
    v_mov_b32 v74, 0
    v_mov_b32 v75, 0
    v_mov_b32 v76, 0
    v_mov_b32 v77, 0
    v_mov_b32 v78, 0
    v_mov_b32 v79, 0
    v_mov_b32 v80, 0
    v_mov_b32 v81, 0
    v_mov_b32 v82, 0
    v_mov_b32 v83, 0
    v_mov_b32 v84, 0
    v_mov_b32 v85, 0
    v_mov_b32 v86, 0
    v_mov_b32 v87, 0
    ds_read_b128 v[116:119], v13 offset:0
    ds_read_b128 v[120:123], v13 offset:1024
    ds_read_b128 v[124:127], v13 offset:2048
    ds_read_b128 v[128:131], v13 offset:3072
    ds_read_b128 v[132:135], v13 offset:4096
    ds_read_b128 v[136:139], v13 offset:5120
    ds_read_b128 v[140:143], v13 offset:6144
    ds_read_b128 v[144:147], v13 offset:7168
    s_waitcnt lgkmcnt(0)
chain2_kernel_p0_step:
    s_cmp_lt_u32 s14, 32
    s_cselect_b32 s18, s16, s17
    s_and_b32 s20, s14, 31
    s_lshl_b32 s20, s20, 16
    s_add_u32 s18, s18, s20
    s_add_u32 s22, s18, 36864
    s_add_u32 s23, s18, 37888
    s_add_u32 s24, s18, 38912
chain2_kernel_p0_poll:
    buffer_load_dwordx4 v[16:19], v1, s[8:11], s22 offen sc1
    buffer_load_dwordx4 v[20:23], v1, s[8:11], s23 offen sc1
    buffer_load_dwordx4 v[24:27], v1, s[8:11], s24 offen sc1
    s_waitcnt vmcnt(0)
    ds_write_b128 v14, v[16:19] offset:0
    ds_write_b128 v14, v[20:23] offset:1024
    ds_write_b128 v14, v[24:27] offset:2048
    v_max3_u32 v88, v16, v17, v18
    v_max3_u32 v88, v88, v19, v20
    v_max3_u32 v88, v88, v21, v22
    v_max3_u32 v88, v88, v23, v24
    v_max3_u32 v88, v88, v25, v26
    v_max_u32 v88, v88, v27
    v_cmp_eq_u32 vcc, -1, v88
    s_sub_u32 s15, s15, 1
    s_cbranch_scc1 chain2_kernel_bail
    s_cbranch_vccnz chain2_kernel_p0_poll
    s_waitcnt lgkmcnt(0)
    s_barrier
    ds_read_b128 v[28:31], v14 offset:3072
    ds_read_b128 v[32:35], v14 offset:4096
    ds_read_b128 v[36:39], v14 offset:5120
    ds_read_b128 v[40:43], v14 offset:6144
    ds_read_b128 v[44:47], v14 offset:7168
    ds_read_b128 v[48:51], v14 offset:8192
    ds_read_b128 v[52:55], v14 offset:9216
    v_smfmac_f32_16x16x64_bf16 v[56:59], v[16:19], a[0:7], v2
    v_smfmac_f32_16x16x64_bf16 v[60:63], v[16:19], a[8:15], v2
    v_smfmac_f32_16x16x64_bf16 v[64:67], v[16:19], a[16:23], v2
    v_smfmac_f32_16x16x64_bf16 v[56:59], v[20:23], a[24:31], v2
    v_smfmac_f32_16x16x64_bf16 v[60:63], v[20:23], a[32:39], v2
    v_smfmac_f32_16x16x64_bf16 v[64:67], v[20:23], a[40:47], v2
    v_smfmac_f32_16x16x64_bf16 v[56:59], v[24:27], a[48:55], v2
    v_smfmac_f32_16x16x64_bf16 v[60:63], v[24:27], a[56:63], v2
    v_smfmac_f32_16x16x64_bf16 v[64:67], v[24:27], a[64:71], v2
    s_waitcnt lgkmcnt(6)
    v_smfmac_f32_16x16x64_bf16 v[56:59], v[28:31], v[116:123], v2
    ds_read_b128 v[116:119], v13 offset:8192
    ds_read_b128 v[120:123], v13 offset:9216
    v_smfmac_f32_16x16x64_bf16 v[60:63], v[28:31], a[72:79], v2
    v_smfmac_f32_16x16x64_bf16 v[64:67], v[28:31], v[124:131], v2
    ds_read_b128 v[124:127], v13 offset:10240
    ds_read_b128 v[128:131], v13 offset:11264
    s_waitcnt lgkmcnt(9)
    v_smfmac_f32_16x16x64_bf16 v[56:59], v[32:35], a[80:87], v2
    v_smfmac_f32_16x16x64_bf16 v[60:63], v[32:35], v[132:139], v2
    ds_read_b128 v[132:135], v13 offset:12288
    ds_read_b128 v[136:139], v13 offset:13312
    v_smfmac_f32_16x16x64_bf16 v[64:67], v[32:35], a[88:95], v2
    s_waitcnt lgkmcnt(10)
    v_smfmac_f32_16x16x64_bf16 v[56:59], v[36:39], v[140:147], v2
    ds_read_b128 v[140:143], v13 offset:14336
    ds_read_b128 v[144:147], v13 offset:15360
    v_smfmac_f32_16x16x64_bf16 v[60:63], v[36:39], a[96:103], v2
    s_waitcnt lgkmcnt(6)
    v_smfmac_f32_16x16x64_bf16 v[64:67], v[36:39], v[116:123], v2
    ds_read_b128 v[116:119], v13 offset:16384
    ds_read_b128 v[120:123], v13 offset:17408
    v_smfmac_f32_16x16x64_bf16 v[56:59], v[40:43], a[104:111], v2
    s_waitcnt lgkmcnt(6)
    v_smfmac_f32_16x16x64_bf16 v[60:63], v[40:43], v[124:131], v2
    ds_read_b128 v[124:127], v13 offset:18432
    ds_read_b128 v[128:131], v13 offset:19456
    v_smfmac_f32_16x16x64_bf16 v[64:67], v[40:43], a[112:119], v2
    s_waitcnt lgkmcnt(6)
    v_smfmac_f32_16x16x64_bf16 v[56:59], v[44:47], v[132:139], v2
    ds_read_b128 v[132:135], v13 offset:20480
    ds_read_b128 v[136:139], v13 offset:21504
    v_smfmac_f32_16x16x64_bf16 v[60:63], v[44:47], a[120:127], v2
    s_waitcnt lgkmcnt(6)
    v_smfmac_f32_16x16x64_bf16 v[64:67], v[44:47], v[140:147], v2
    ds_read_b128 v[140:143], v13 offset:22528
    ds_read_b128 v[144:147], v13 offset:23552
    v_smfmac_f32_16x16x64_bf16 v[56:59], v[48:51], a[128:135], v2
    s_waitcnt lgkmcnt(6)
    v_smfmac_f32_16x16x64_bf16 v[60:63], v[48:51], v[116:123], v2
    ds_read_b128 v[116:119], v13 offset:24576
    ds_read_b128 v[120:123], v13 offset:25600
    v_smfmac_f32_16x16x64_bf16 v[64:67], v[48:51], a[136:143], v2
    s_waitcnt lgkmcnt(6)
    v_smfmac_f32_16x16x64_bf16 v[56:59], v[52:55], v[124:131], v2
    ds_read_b128 v[124:127], v13 offset:26624
    ds_read_b128 v[128:131], v13 offset:27648
    v_smfmac_f32_16x16x64_bf16 v[60:63], v[52:55], a[144:151], v2
    s_waitcnt lgkmcnt(6)
    v_smfmac_f32_16x16x64_bf16 v[64:67], v[52:55], v[132:139], v2
    ds_read_b128 v[132:135], v13 offset:28672
    ds_read_b128 v[136:139], v13 offset:29696
    v_smfmac_f32_16x16x64_bf16 v[68:71], v[16:19], a[152:159], v2
    v_smfmac_f32_16x16x64_bf16 v[68:71], v[20:23], a[160:167], v2
    v_permlane32_swap_b32 v56, v58
    v_permlane32_swap_b32 v57, v59
    v_smfmac_f32_16x16x64_bf16 v[68:71], v[24:27], a[168:175], v2
    v_add_f32 v56, v56, v58
    v_add_f32 v57, v57, v59
    v_smfmac_f32_16x16x64_bf16 v[68:71], v[28:31], a[176:183], v2
    v_cvt_pk_bf16_f32 v56, v56, v57
    ds_write_b16 v3, v56 offset:0
    v_smfmac_f32_16x16x64_bf16 v[68:71], v[32:35], a[184:191], v2
    ds_write_b16_d16_hi v3, v56 offset:400
    v_permlane32_swap_b32 v60, v62
    v_smfmac_f32_16x16x64_bf16 v[68:71], v[36:39], a[192:199], v2
    v_permlane32_swap_b32 v61, v63
    v_add_f32 v60, v60, v62
    v_smfmac_f32_16x16x64_bf16 v[68:71], v[40:43], a[200:207], v2
    v_add_f32 v61, v61, v63
    v_cvt_pk_bf16_f32 v60, v60, v61
    v_smfmac_f32_16x16x64_bf16 v[68:71], v[44:47], a[208:215], v2
    ds_write_b16 v3, v60 offset:32
    ds_write_b16_d16_hi v3, v60 offset:432
    v_smfmac_f32_16x16x64_bf16 v[68:71], v[48:51], a[216:223], v2
    v_permlane32_swap_b32 v64, v66
    v_permlane32_swap_b32 v65, v67
    v_smfmac_f32_16x16x64_bf16 v[68:71], v[52:55], a[224:231], v2
    v_add_f32 v64, v64, v66
    v_add_f32 v65, v65, v67
    v_smfmac_f32_16x16x64_bf16 v[72:75], v[16:19], a[232:239], v2
    v_cvt_pk_bf16_f32 v64, v64, v65
    ds_write_b16 v3, v64 offset:64
    v_smfmac_f32_16x16x64_bf16 v[72:75], v[20:23], a[240:247], v2
    ds_write_b16_d16_hi v3, v64 offset:464
    v_smfmac_f32_16x16x64_bf16 v[72:75], v[24:27], a[248:255], v2
    v_smfmac_f32_16x16x64_bf16 v[72:75], v[28:31], v[148:155], v2
    s_waitcnt lgkmcnt(0)
    s_barrier
    ds_read_b128 v[88:91], v4 offset:0
    v_smfmac_f32_16x16x64_bf16 v[72:75], v[32:35], v[140:147], v2
    ds_read_b128 v[92:95], v4 offset:128
    ds_read_b128 v[96:99], v4 offset:256
    v_smfmac_f32_16x16x64_bf16 v[72:75], v[36:39], v[156:163], v2
    v_permlane32_swap_b32 v68, v70
    v_permlane32_swap_b32 v69, v71
    v_smfmac_f32_16x16x64_bf16 v[72:75], v[40:43], v[164:171], v2
    v_add_f32 v68, v68, v70
    v_add_f32 v69, v69, v71
    v_smfmac_f32_16x16x64_bf16 v[72:75], v[44:47], v[172:179], v2
    v_cvt_pk_bf16_f32 v68, v68, v69
    ds_write_b16 v3, v68 offset:3200
    v_smfmac_f32_16x16x64_bf16 v[72:75], v[48:51], v[116:123], v2
    ds_write_b16_d16_hi v3, v68 offset:3600
    v_smfmac_f32_16x16x64_bf16 v[72:75], v[52:55], v[180:187], v2
    s_waitcnt lgkmcnt(2)
    v_smfmac_f32_16x16x64_bf16 v[80:83], v[88:91], v[100:107], v2
    v_smfmac_f32_16x16x64_bf16 v[80:83], v[92:95], v[108:115], v2
    v_smfmac_f32_16x16x64_bf16 v[76:79], v[16:19], v[188:195], v2
    v_smfmac_f32_16x16x64_bf16 v[76:79], v[20:23], v[196:203], v2
    v_smfmac_f32_16x16x64_bf16 v[76:79], v[24:27], v[124:131], v2
    v_permlane32_swap_b32 v72, v74
    v_permlane32_swap_b32 v73, v75
    v_smfmac_f32_16x16x64_bf16 v[76:79], v[28:31], v[204:211], v2
    v_add_f32 v72, v72, v74
    v_add_f32 v73, v73, v75
    ds_write_b128 v15, v[80:83]
    v_smfmac_f32_16x16x64_bf16 v[76:79], v[32:35], v[212:219], v2
    v_cvt_pk_bf16_f32 v72, v72, v73
    ds_write_b16 v3, v72 offset:3232
    v_smfmac_f32_16x16x64_bf16 v[76:79], v[36:39], v[220:227], v2
    ds_write_b16_d16_hi v3, v72 offset:3632
    v_smfmac_f32_16x16x64_bf16 v[76:79], v[40:43], v[132:139], v2
    v_smfmac_f32_16x16x64_bf16 v[76:79], v[44:47], v[228:235], v2
    v_smfmac_f32_16x16x64_bf16 v[76:79], v[48:51], v[236:243], v2
    v_smfmac_f32_16x16x64_bf16 v[76:79], v[52:55], v[244:251], v2
    s_nop 7
    v_permlane32_swap_b32 v76, v78
    v_permlane32_swap_b32 v77, v79
    v_add_f32 v76, v76, v78
    v_add_f32 v77, v77, v79
    v_cvt_pk_bf16_f32 v76, v76, v77
    ds_write_b16 v3, v76 offset:3264
    ds_write_b16_d16_hi v3, v76 offset:3664
    s_waitcnt lgkmcnt(0)
    s_barrier
    ds_read2st64_b32 v[40:41], v6 offset0:0 offset1:2
    ds_read2st64_b32 v[42:43], v6 offset0:8 offset1:10
    ds_read_b128 v[16:19], v5 offset:0
    ds_read_b128 v[20:23], v5 offset:16
    ds_read_b128 v[24:27], v5 offset:128
    ds_read_b128 v[28:31], v5 offset:144
    ds_read_b128 v[32:35], v5 offset:256
    ds_read_b128 v[36:39], v5 offset:272
    s_waitcnt lgkmcnt(6)
    v_add_f32 v40, v40, v41
    v_add_f32 v42, v42, v43
    v_add_f32 v44, v40, v42
    v_mul_f32 v44, 0x3dd53b95, v44
    s_waitcnt lgkmcnt(4)
    v_smfmac_f32_16x16x64_bf16 v[84:87], v[88:91], v[16:23], v2
    s_waitcnt lgkmcnt(2)
    v_smfmac_f32_16x16x64_bf16 v[84:87], v[92:95], v[24:31], v2
    s_waitcnt lgkmcnt(0)
    v_smfmac_f32_16x16x64_bf16 v[84:87], v[96:99], v[32:39], v2
    v_max_f32_dpp v45, v44, v44 row_ror:8 row_mask:0xf bank_mask:0xf
    s_nop 1
    v_max_f32_dpp v45, v45, v45 row_ror:4 row_mask:0xf bank_mask:0xf
    s_nop 1
    v_max_f32_dpp v45, v45, v45 row_ror:2 row_mask:0xf bank_mask:0xf
    s_nop 1
    v_max_f32_dpp v45, v45, v45 row_ror:1 row_mask:0xf bank_mask:0xf
    v_mov_b32 v47, v45
    s_nop 1
    v_permlane32_swap_b32 v45, v47
    v_max_f32 v45, v45, v47
    v_mov_b32 v47, v84
    s_nop 1
    v_permlane32_swap_b32 v84, v47
    v_add_f32 v48, v84, v47
    v_mul_f32 v48, 0x3dd53b95, v48
    s_nop 1
    v_max_f32_dpp v46, v48, v48 row_ror:4 row_mask:0xf bank_mask:0xf
    s_nop 1
    v_max_f32_dpp v46, v46, v46 row_ror:2 row_mask:0xf bank_mask:0xf
    s_nop 1
    v_max_f32_dpp v46, v46, v46 row_ror:1 row_mask:0xf bank_mask:0xf
    v_max_f32 v45, v45, v46
    v_sub_f32 v49, v44, v45
    v_sub_f32 v50, v48, v45
    v_exp_f32 v49, v49
    v_exp_f32 v50, v50
    s_nop 0
    v_fma_f32 v51, v50, v12, v49
    s_nop 1
    v_add_f32_dpp v51, v51, v51 row_ror:8 row_mask:0xf bank_mask:0xf
    s_nop 1
    v_add_f32_dpp v51, v51, v51 row_ror:4 row_mask:0xf bank_mask:0xf
    s_nop 1
    v_add_f32_dpp v51, v51, v51 row_ror:2 row_mask:0xf bank_mask:0xf
    s_nop 1
    v_add_f32_dpp v51, v51, v51 row_ror:1 row_mask:0xf bank_mask:0xf
    v_mov_b32 v47, v51
    s_nop 1
    v_permlane32_swap_b32 v51, v47
    v_add_f32 v51, v51, v47
    v_rcp_f32 v51, v51
    s_nop 0
    v_mul_f32 v49, v49, v51
    v_mul_f32 v50, v50, v51
    s_nop 0
    v_mov_b32_dpp v46, v49 quad_perm:[1,0,3,2] row_mask:0xf bank_mask:0xf
    v_mov_b32_dpp v47, v50 quad_perm:[1,0,3,2] row_mask:0xf bank_mask:0xf
    v_cvt_pk_bf16_f32 v16, v49, v46
    v_cvt_pk_bf16_f32 v20, v50, v47
    s_nop 0
    v_mov_b32_dpp v17, v16 row_shl:2 row_mask:0xf bank_mask:0xf
    v_mov_b32_dpp v18, v16 row_shl:4 row_mask:0xf bank_mask:0xf
    v_mov_b32_dpp v19, v16 row_shl:6 row_mask:0xf bank_mask:0xf
    v_mov_b32_dpp v21, v20 row_shl:2 row_mask:0xf bank_mask:0xf
    v_mov_b32_dpp v22, v20 row_shl:4 row_mask:0xf bank_mask:0xf
    v_mov_b32_dpp v23, v20 row_shl:6 row_mask:0xf bank_mask:0xf
    s_mov_b64 exec, s[40:41]
    buffer_store_dwordx4 v[16:19], v7, s[8:11], s18 offen sc1
    s_mov_b64 exec, s[42:43]
    buffer_store_dwordx4 v[20:23], v8, s[8:11], s18 offen sc1
    s_mov_b64 exec, -1
    ds_read_b128 v[40:43], v10
    s_add_u32 s28, s14, 1
    s_min_u32 s28, s28, 63
    s_mul_i32 s20, s28, 393216
    s_add_u32 s20, s20, s44
    s_add_u32 s21, s20, 0
    buffer_load_dwordx4 v[100:103], v9, s[8:11], s21 offen offset:0
    buffer_load_dwordx4 v[104:107], v9, s[8:11], s21 offen offset:512
    s_add_u32 s21, s20, 4096
    buffer_load_dwordx4 v[108:111], v9, s[8:11], s21 offen offset:0
    buffer_load_dwordx4 v[112:115], v9, s[8:11], s21 offen offset:512
    v_mov_b32 v56, 0
    v_mov_b32 v57, 0
    v_mov_b32 v58, 0
    v_mov_b32 v59, 0
    v_mov_b32 v60, 0
    v_mov_b32 v61, 0
    v_mov_b32 v62, 0
    v_mov_b32 v63, 0
    v_mov_b32 v64, 0
    v_mov_b32 v65, 0
    v_mov_b32 v66, 0
    v_mov_b32 v67, 0
    v_mov_b32 v68, 0
    v_mov_b32 v69, 0
    v_mov_b32 v70, 0
    v_mov_b32 v71, 0
    v_mov_b32 v72, 0
    v_mov_b32 v73, 0
    v_mov_b32 v74, 0
    v_mov_b32 v75, 0
    v_mov_b32 v76, 0
    v_mov_b32 v77, 0
    v_mov_b32 v78, 0
    v_mov_b32 v79, 0
    v_mov_b32 v80, 0
    v_mov_b32 v81, 0
    v_mov_b32 v82, 0
    v_mov_b32 v83, 0
    v_mov_b32 v84, 0
    v_mov_b32 v85, 0
    v_mov_b32 v86, 0
    v_mov_b32 v87, 0
    s_waitcnt lgkmcnt(0)
    s_mul_i32 s20, s14, 98304
    s_add_u32 s20, s20, s45
    buffer_store_dwordx4 v[40:43], v11, s[8:11], s20 offen
    ds_read_b128 v[116:119], v13 offset:0
    ds_read_b128 v[120:123], v13 offset:1024
    ds_read_b128 v[124:127], v13 offset:2048
    ds_read_b128 v[128:131], v13 offset:3072
    ds_read_b128 v[132:135], v13 offset:4096
    ds_read_b128 v[136:139], v13 offset:5120
    ds_read_b128 v[140:143], v13 offset:6144
    ds_read_b128 v[144:147], v13 offset:7168
    s_waitcnt lgkmcnt(0)
    s_add_u32 s14, s14, 1
    s_cmp_lt_u32 s14, 64
    s_cbranch_scc1 chain2_kernel_p0_step
    s_branch chain2_kernel_end
chain2_kernel_p1_start:
    v_lshrrev_b32 v16, 4, v0
    v_and_b32 v17, 15, v0
    v_and_b32 v18, 1, v16
    v_lshlrev_b32 v18, 2, v18
    v_lshrrev_b32 v19, 1, v16
    v_lshl_add_u32 v18, v19, 1, v18
    v_mul_u32_u24 v18, 400, v18
    v_lshl_add_u32 v18, v17, 1, v18
    v_add_u32 v3, 133216, v18
    v_and_b32 v18, 7, v0
    v_mul_u32_u24 v18, 400, v18
    v_lshrrev_b32 v19, 3, v0
    v_lshl_add_u32 v18, v19, 4, v18
    v_add_u32 v4, 133120, v18
    v_and_b32 v18, 7, v0
    v_mul_u32_u24 v18, 400, v18
    v_lshl_add_u32 v18, v16, 5, v18
    v_add_u32 v5, 136320, v18
    v_lshrrev_b32 v18, 1, v16
    v_lshlrev_b32 v18, 10, v18
    v_and_b32 v19, 31, v0
    v_lshl_add_u32 v18, v19, 4, v18
    v_add_u32 v6, 139524, v18
    v_add_u32 v15, 140544, v1
    v_lshrrev_b32 v18, 1, v16
    v_lshlrev_b32 v18, 1, v18
    v_lshrrev_b32 v19, 3, v17
    v_add3_u32 v18, v18, v19, 1
    v_lshrrev_b32 v19, 1, v18
    v_lshlrev_b32 v19, 14, v19
    v_and_b32 v18, 1, v18
    v_lshl_add_u32 v18, v18, 12, v19
    v_and_b32 v19, 1, v16
    v_lshlrev_b32 v19, 4, v19
    v_add_u32 v19, 32, v19
    s_lshl_b32 s20, s12, 7
    v_add_u32 v8, s20, v19
    v_add_u32 v7, v8, v18
    v_lshlrev_b32 v18, 4, v17
    v_lshl_add_u32 v18, v16, 10, v18
    v_add_u32 v9, 256, v18
    v_add_u32 v18, 64, v0
    v_mul_u32_u24 v19, 2731, v18
    v_lshrrev_b32 v19, 16, v19
    v_mul_u32_u24 v20, 24, v19
    v_sub_u32 v20, v18, v20
    v_mul_u32_u24 v21, 400, v19
    v_lshl_add_u32 v21, v20, 4, v21
    v_add_u32 v10, 136320, v21
    v_lshlrev_b32 v21, 4, v19
    v_lshl_add_u32 v11, v20, 7, v21
    v_and_b32 v18, 0x28, v0
    v_cmp_eq_u32 vcc, 0, v18
    v_mov_b32 v18, 1.0
    v_mov_b32 v19, 0
    v_cndmask_b32 v12, v19, v18, vcc
    v_add_u32 v13, 30720, v1
    v_add_u32 v14, 122880, v1
    s_mul_i32 s44, s12, 12288
    s_add_u32 s44, s44, 53477376
    s_mul_i32 s45, s12, 3072
    s_add_u32 s45, s45, 208666624
    s_mul_i32 s20, s12, 491520
    s_add_u32 s20, s20, 11657216
    s_add_u32 s21, s20, 0
    buffer_load_dwordx4 v[16:19], v1, s[8:11], s21 offen offset:0
    buffer_load_dwordx4 v[20:23], v1, s[8:11], s21 offen offset:1024
    s_add_u32 s21, s20, 40960
    buffer_load_dwordx4 v[24:27], v1, s[8:11], s21 offen offset:0
    buffer_load_dwordx4 v[28:31], v1, s[8:11], s21 offen offset:1024
    s_add_u32 s21, s20, 22528
    buffer_load_dwordx4 v[32:35], v1, s[8:11], s21 offen offset:0
    buffer_load_dwordx4 v[36:39], v1, s[8:11], s21 offen offset:1024
    s_add_u32 s21, s20, 4096
    buffer_load_dwordx4 v[40:43], v1, s[8:11], s21 offen offset:0
    buffer_load_dwordx4 v[44:47], v1, s[8:11], s21 offen offset:1024
    s_add_u32 s21, s20, 45056
    buffer_load_dwordx4 v[48:51], v1, s[8:11], s21 offen offset:0
    buffer_load_dwordx4 v[52:55], v1, s[8:11], s21 offen offset:1024
    s_add_u32 s21, s20, 32768
    buffer_load_dwordx4 v[56:59], v1, s[8:11], s21 offen offset:0
    buffer_load_dwordx4 v[60:63], v1, s[8:11], s21 offen offset:1024
    s_add_u32 s21, s20, 14336
    buffer_load_dwordx4 v[64:67], v1, s[8:11], s21 offen offset:0
    buffer_load_dwordx4 v[68:71], v1, s[8:11], s21 offen offset:1024
    s_add_u32 s21, s20, 55296
    buffer_load_dwordx4 v[72:75], v1, s[8:11], s21 offen offset:0
    buffer_load_dwordx4 v[76:79], v1, s[8:11], s21 offen offset:1024
    s_add_u32 s21, s20, 36864
    buffer_load_dwordx4 v[80:83], v1, s[8:11], s21 offen offset:0
    buffer_load_dwordx4 v[84:87], v1, s[8:11], s21 offen offset:1024
    s_add_u32 s21, s20, 18432
    buffer_load_dwordx4 v[88:91], v1, s[8:11], s21 offen offset:0
    buffer_load_dwordx4 v[92:95], v1, s[8:11], s21 offen offset:1024
    s_add_u32 s21, s20, 59392
    buffer_load_dwordx4 v[96:99], v1, s[8:11], s21 offen offset:0
    buffer_load_dwordx4 v[100:103], v1, s[8:11], s21 offen offset:1024
    s_add_u32 s21, s20, 90112
    buffer_load_dwordx4 v[104:107], v1, s[8:11], s21 offen offset:0
    buffer_load_dwordx4 v[108:111], v1, s[8:11], s21 offen offset:1024
    s_add_u32 s21, s20, 98304
    buffer_load_dwordx4 v[112:115], v1, s[8:11], s21 offen offset:0
    buffer_load_dwordx4 v[116:119], v1, s[8:11], s21 offen offset:1024
    s_add_u32 s21, s20, 106496
    buffer_load_dwordx4 v[120:123], v1, s[8:11], s21 offen offset:0
    buffer_load_dwordx4 v[124:127], v1, s[8:11], s21 offen offset:1024
    s_add_u32 s21, s20, 114688
    buffer_load_dwordx4 v[128:131], v1, s[8:11], s21 offen offset:0
    buffer_load_dwordx4 v[132:135], v1, s[8:11], s21 offen offset:1024
    s_add_u32 s21, s20, 6144
    buffer_load_dwordx4 a[0:3], v1, s[8:11], s21 offen offset:0
    buffer_load_dwordx4 a[4:7], v1, s[8:11], s21 offen offset:1024
    s_add_u32 s21, s20, 26624
    buffer_load_dwordx4 a[8:11], v1, s[8:11], s21 offen offset:0
    buffer_load_dwordx4 a[12:15], v1, s[8:11], s21 offen offset:1024
    s_add_u32 s21, s20, 47104
    buffer_load_dwordx4 a[16:19], v1, s[8:11], s21 offen offset:0
    buffer_load_dwordx4 a[20:23], v1, s[8:11], s21 offen offset:1024
    s_add_u32 s21, s20, 8192
    buffer_load_dwordx4 a[24:27], v1, s[8:11], s21 offen offset:0
    buffer_load_dwordx4 a[28:31], v1, s[8:11], s21 offen offset:1024
    s_add_u32 s21, s20, 28672
    buffer_load_dwordx4 a[32:35], v1, s[8:11], s21 offen offset:0
    buffer_load_dwordx4 a[36:39], v1, s[8:11], s21 offen offset:1024
    s_add_u32 s21, s20, 49152
    buffer_load_dwordx4 a[40:43], v1, s[8:11], s21 offen offset:0
    buffer_load_dwordx4 a[44:47], v1, s[8:11], s21 offen offset:1024
    s_add_u32 s21, s20, 10240
    buffer_load_dwordx4 a[48:51], v1, s[8:11], s21 offen offset:0
    buffer_load_dwordx4 a[52:55], v1, s[8:11], s21 offen offset:1024
    s_add_u32 s21, s20, 30720
    buffer_load_dwordx4 a[56:59], v1, s[8:11], s21 offen offset:0
    buffer_load_dwordx4 a[60:63], v1, s[8:11], s21 offen offset:1024
    s_add_u32 s21, s20, 51200
    buffer_load_dwordx4 a[64:67], v1, s[8:11], s21 offen offset:0
    buffer_load_dwordx4 a[68:71], v1, s[8:11], s21 offen offset:1024
    s_add_u32 s21, s20, 20480
    buffer_load_dwordx4 a[72:75], v1, s[8:11], s21 offen offset:0
    buffer_load_dwordx4 a[76:79], v1, s[8:11], s21 offen offset:1024
    s_add_u32 s21, s20, 2048
    buffer_load_dwordx4 a[80:83], v1, s[8:11], s21 offen offset:0
    buffer_load_dwordx4 a[84:87], v1, s[8:11], s21 offen offset:1024
    s_add_u32 s21, s20, 43008
    buffer_load_dwordx4 a[88:91], v1, s[8:11], s21 offen offset:0
    buffer_load_dwordx4 a[92:95], v1, s[8:11], s21 offen offset:1024
    s_add_u32 s21, s20, 24576
    buffer_load_dwordx4 a[96:99], v1, s[8:11], s21 offen offset:0
    buffer_load_dwordx4 a[100:103], v1, s[8:11], s21 offen offset:1024
    s_add_u32 s21, s20, 12288
    buffer_load_dwordx4 a[104:107], v1, s[8:11], s21 offen offset:0
    buffer_load_dwordx4 a[108:111], v1, s[8:11], s21 offen offset:1024
    s_add_u32 s21, s20, 53248
    buffer_load_dwordx4 a[112:115], v1, s[8:11], s21 offen offset:0
    buffer_load_dwordx4 a[116:119], v1, s[8:11], s21 offen offset:1024
    s_add_u32 s21, s20, 34816
    buffer_load_dwordx4 a[120:123], v1, s[8:11], s21 offen offset:0
    buffer_load_dwordx4 a[124:127], v1, s[8:11], s21 offen offset:1024
    s_waitcnt vmcnt(32)
    ds_write_b128 v13, v[16:19] offset:0
    ds_write_b128 v13, v[20:23] offset:1024
    ds_write_b128 v13, v[24:27] offset:2048
    ds_write_b128 v13, v[28:31] offset:3072
    ds_write_b128 v13, v[32:35] offset:4096
    ds_write_b128 v13, v[36:39] offset:5120
    ds_write_b128 v13, v[40:43] offset:6144
    ds_write_b128 v13, v[44:47] offset:7168
    ds_write_b128 v13, v[48:51] offset:8192
    ds_write_b128 v13, v[52:55] offset:9216
    ds_write_b128 v13, v[56:59] offset:10240
    ds_write_b128 v13, v[60:63] offset:11264
    ds_write_b128 v13, v[64:67] offset:12288
    ds_write_b128 v13, v[68:71] offset:13312
    ds_write_b128 v13, v[72:75] offset:14336
    ds_write_b128 v13, v[76:79] offset:15360
    ds_write_b128 v13, v[80:83] offset:16384
    ds_write_b128 v13, v[84:87] offset:17408
    ds_write_b128 v13, v[88:91] offset:18432
    ds_write_b128 v13, v[92:95] offset:19456
    ds_write_b128 v13, v[96:99] offset:20480
    ds_write_b128 v13, v[100:103] offset:21504
    ds_write_b128 v13, v[104:107] offset:22528
    ds_write_b128 v13, v[108:111] offset:23552
    ds_write_b128 v13, v[112:115] offset:24576
    ds_write_b128 v13, v[116:119] offset:25600
    ds_write_b128 v13, v[120:123] offset:26624
    ds_write_b128 v13, v[124:127] offset:27648
    ds_write_b128 v13, v[128:131] offset:28672
    ds_write_b128 v13, v[132:135] offset:29696
    s_add_u32 s21, s20, 16384
    buffer_load_dwordx4 a[128:131], v1, s[8:11], s21 offen offset:0
    buffer_load_dwordx4 a[132:135], v1, s[8:11], s21 offen offset:1024
    s_add_u32 s21, s20, 57344
    buffer_load_dwordx4 a[136:139], v1, s[8:11], s21 offen offset:0
    buffer_load_dwordx4 a[140:143], v1, s[8:11], s21 offen offset:1024
    s_add_u32 s21, s20, 38912
    buffer_load_dwordx4 a[144:147], v1, s[8:11], s21 offen offset:0
    buffer_load_dwordx4 a[148:151], v1, s[8:11], s21 offen offset:1024
    s_add_u32 s21, s20, 61440
    buffer_load_dwordx4 a[152:155], v1, s[8:11], s21 offen offset:0
    buffer_load_dwordx4 a[156:159], v1, s[8:11], s21 offen offset:1024
    s_add_u32 s21, s20, 63488
    buffer_load_dwordx4 a[160:163], v1, s[8:11], s21 offen offset:0
    buffer_load_dwordx4 a[164:167], v1, s[8:11], s21 offen offset:1024
    s_add_u32 s21, s20, 65536
    buffer_load_dwordx4 a[168:171], v1, s[8:11], s21 offen offset:0
    buffer_load_dwordx4 a[172:175], v1, s[8:11], s21 offen offset:1024
    s_add_u32 s21, s20, 67584
    buffer_load_dwordx4 a[176:179], v1, s[8:11], s21 offen offset:0
    buffer_load_dwordx4 a[180:183], v1, s[8:11], s21 offen offset:1024
    s_add_u32 s21, s20, 69632
    buffer_load_dwordx4 a[184:187], v1, s[8:11], s21 offen offset:0
    buffer_load_dwordx4 a[188:191], v1, s[8:11], s21 offen offset:1024
    s_add_u32 s21, s20, 71680
    buffer_load_dwordx4 a[192:195], v1, s[8:11], s21 offen offset:0
    buffer_load_dwordx4 a[196:199], v1, s[8:11], s21 offen offset:1024
    s_add_u32 s21, s20, 73728
    buffer_load_dwordx4 a[200:203], v1, s[8:11], s21 offen offset:0
    buffer_load_dwordx4 a[204:207], v1, s[8:11], s21 offen offset:1024
    s_add_u32 s21, s20, 75776
    buffer_load_dwordx4 a[208:211], v1, s[8:11], s21 offen offset:0
    buffer_load_dwordx4 a[212:215], v1, s[8:11], s21 offen offset:1024
    s_add_u32 s21, s20, 77824
    buffer_load_dwordx4 a[216:219], v1, s[8:11], s21 offen offset:0
    buffer_load_dwordx4 a[220:223], v1, s[8:11], s21 offen offset:1024
    s_add_u32 s21, s20, 79872
    buffer_load_dwordx4 a[224:227], v1, s[8:11], s21 offen offset:0
    buffer_load_dwordx4 a[228:231], v1, s[8:11], s21 offen offset:1024
    s_add_u32 s21, s20, 81920
    buffer_load_dwordx4 a[232:235], v1, s[8:11], s21 offen offset:0
    buffer_load_dwordx4 a[236:239], v1, s[8:11], s21 offen offset:1024
    s_add_u32 s21, s20, 83968
    buffer_load_dwordx4 a[240:243], v1, s[8:11], s21 offen offset:0
    buffer_load_dwordx4 a[244:247], v1, s[8:11], s21 offen offset:1024
    s_add_u32 s21, s20, 86016
    buffer_load_dwordx4 a[248:251], v1, s[8:11], s21 offen offset:0
    buffer_load_dwordx4 a[252:255], v1, s[8:11], s21 offen offset:1024
    s_add_u32 s21, s20, 88064
    buffer_load_dwordx4 v[148:151], v1, s[8:11], s21 offen offset:0
    buffer_load_dwordx4 v[152:155], v1, s[8:11], s21 offen offset:1024
    s_add_u32 s21, s20, 92160
    buffer_load_dwordx4 v[156:159], v1, s[8:11], s21 offen offset:0
    buffer_load_dwordx4 v[160:163], v1, s[8:11], s21 offen offset:1024
    s_add_u32 s21, s20, 94208
    buffer_load_dwordx4 v[164:167], v1, s[8:11], s21 offen offset:0
    buffer_load_dwordx4 v[168:171], v1, s[8:11], s21 offen offset:1024
    s_add_u32 s21, s20, 96256
    buffer_load_dwordx4 v[172:175], v1, s[8:11], s21 offen offset:0
    buffer_load_dwordx4 v[176:179], v1, s[8:11], s21 offen offset:1024
    s_add_u32 s21, s20, 100352
    buffer_load_dwordx4 v[180:183], v1, s[8:11], s21 offen offset:0
    buffer_load_dwordx4 v[184:187], v1, s[8:11], s21 offen offset:1024
    s_add_u32 s21, s20, 102400
    buffer_load_dwordx4 v[188:191], v1, s[8:11], s21 offen offset:0
    buffer_load_dwordx4 v[192:195], v1, s[8:11], s21 offen offset:1024
    s_add_u32 s21, s20, 104448
    buffer_load_dwordx4 v[196:199], v1, s[8:11], s21 offen offset:0
    buffer_load_dwordx4 v[200:203], v1, s[8:11], s21 offen offset:1024
    s_add_u32 s21, s20, 108544
    buffer_load_dwordx4 v[204:207], v1, s[8:11], s21 offen offset:0
    buffer_load_dwordx4 v[208:211], v1, s[8:11], s21 offen offset:1024
    s_add_u32 s21, s20, 110592
    buffer_load_dwordx4 v[212:215], v1, s[8:11], s21 offen offset:0
    buffer_load_dwordx4 v[216:219], v1, s[8:11], s21 offen offset:1024
    s_add_u32 s21, s20, 112640
    buffer_load_dwordx4 v[220:223], v1, s[8:11], s21 offen offset:0
    buffer_load_dwordx4 v[224:227], v1, s[8:11], s21 offen offset:1024
    s_add_u32 s21, s20, 116736
    buffer_load_dwordx4 v[228:231], v1, s[8:11], s21 offen offset:0
    buffer_load_dwordx4 v[232:235], v1, s[8:11], s21 offen offset:1024
    s_add_u32 s21, s20, 118784
    buffer_load_dwordx4 v[236:239], v1, s[8:11], s21 offen offset:0
    buffer_load_dwordx4 v[240:243], v1, s[8:11], s21 offen offset:1024
    s_add_u32 s21, s20, 120832
    buffer_load_dwordx4 v[244:247], v1, s[8:11], s21 offen offset:0
    buffer_load_dwordx4 v[248:251], v1, s[8:11], s21 offen offset:1024
    s_waitcnt lgkmcnt(0)
    s_mov_b32 s14, 0
    s_mul_i32 s20, s14, 393216
    s_add_u32 s20, s20, s44
    s_add_u32 s21, s20, 0
    buffer_load_dwordx4 v[100:103], v9, s[8:11], s21 offen offset:0
    buffer_load_dwordx4 v[104:107], v9, s[8:11], s21 offen offset:512
    s_add_u32 s21, s20, 4096
    buffer_load_dwordx4 v[108:111], v9, s[8:11], s21 offen offset:0
    buffer_load_dwordx4 v[112:115], v9, s[8:11], s21 offen offset:512
    v_mov_b32 v56, 0
    v_mov_b32 v57, 0
    v_mov_b32 v58, 0
    v_mov_b32 v59, 0
    v_mov_b32 v60, 0
    v_mov_b32 v61, 0
    v_mov_b32 v62, 0
    v_mov_b32 v63, 0
    v_mov_b32 v64, 0
    v_mov_b32 v65, 0
    v_mov_b32 v66, 0
    v_mov_b32 v67, 0
    v_mov_b32 v68, 0
    v_mov_b32 v69, 0
    v_mov_b32 v70, 0
    v_mov_b32 v71, 0
    v_mov_b32 v72, 0
    v_mov_b32 v73, 0
    v_mov_b32 v74, 0
    v_mov_b32 v75, 0
    v_mov_b32 v76, 0
    v_mov_b32 v77, 0
    v_mov_b32 v78, 0
    v_mov_b32 v79, 0
    v_mov_b32 v80, 0
    v_mov_b32 v81, 0
    v_mov_b32 v82, 0
    v_mov_b32 v83, 0
    v_mov_b32 v84, 0
    v_mov_b32 v85, 0
    v_mov_b32 v86, 0
    v_mov_b32 v87, 0
    ds_read_b128 v[116:119], v13 offset:0
    ds_read_b128 v[120:123], v13 offset:1024
    ds_read_b128 v[124:127], v13 offset:2048
    ds_read_b128 v[128:131], v13 offset:3072
    ds_read_b128 v[132:135], v13 offset:4096
    ds_read_b128 v[136:139], v13 offset:5120
    ds_read_b128 v[140:143], v13 offset:6144
    ds_read_b128 v[144:147], v13 offset:7168
    s_waitcnt lgkmcnt(0)
chain2_kernel_p1_step:
    s_cmp_lt_u32 s14, 32
    s_cselect_b32 s18, s16, s17
    s_and_b32 s20, s14, 31
    s_lshl_b32 s20, s20, 16
    s_add_u32 s18, s18, s20
    s_add_u32 s22, s18, 39936
    s_add_u32 s23, s18, 49152
    s_add_u32 s24, s18, 50176
chain2_kernel_p1_poll:
    buffer_load_dwordx4 v[28:31], v1, s[8:11], s22 offen sc1
    buffer_load_dwordx4 v[32:35], v1, s[8:11], s23 offen sc1
    buffer_load_dwordx4 v[36:39], v1, s[8:11], s24 offen sc1
    s_waitcnt vmcnt(0)
    ds_write_b128 v14, v[28:31] offset:3072
    ds_write_b128 v14, v[32:35] offset:4096
    ds_write_b128 v14, v[36:39] offset:5120
    v_max3_u32 v88, v28, v29, v30
    v_max3_u32 v88, v88, v31, v32
    v_max3_u32 v88, v88, v33, v34
    v_max3_u32 v88, v88, v35, v36
    v_max3_u32 v88, v88, v37, v38
    v_max_u32 v88, v88, v39
    v_cmp_eq_u32 vcc, -1, v88
    s_sub_u32 s15, s15, 1
    s_cbranch_scc1 chain2_kernel_bail
    s_cbranch_vccnz chain2_kernel_p1_poll
    s_waitcnt lgkmcnt(0)
    s_barrier
    ds_read_b128 v[16:19], v14 offset:0
    ds_read_b128 v[20:23], v14 offset:1024
    ds_read_b128 v[24:27], v14 offset:2048
    ds_read_b128 v[40:43], v14 offset:6144
    ds_read_b128 v[44:47], v14 offset:7168
    ds_read_b128 v[48:51], v14 offset:8192
    ds_read_b128 v[52:55], v14 offset:9216
    v_smfmac_f32_16x16x64_bf16 v[56:59], v[28:31], a[0:7], v2
    v_smfmac_f32_16x16x64_bf16 v[60:63], v[28:31], a[8:15], v2
    v_smfmac_f32_16x16x64_bf16 v[64:67], v[28:31], a[16:23], v2
    v_smfmac_f32_16x16x64_bf16 v[56:59], v[32:35], a[24:31], v2
    v_smfmac_f32_16x16x64_bf16 v[60:63], v[32:35], a[32:39], v2
    v_smfmac_f32_16x16x64_bf16 v[64:67], v[32:35], a[40:47], v2
    v_smfmac_f32_16x16x64_bf16 v[56:59], v[36:39], a[48:55], v2
    v_smfmac_f32_16x16x64_bf16 v[60:63], v[36:39], a[56:63], v2
    v_smfmac_f32_16x16x64_bf16 v[64:67], v[36:39], a[64:71], v2
    s_waitcnt lgkmcnt(6)
    v_smfmac_f32_16x16x64_bf16 v[56:59], v[16:19], v[116:123], v2
    ds_read_b128 v[116:119], v13 offset:8192
    ds_read_b128 v[120:123], v13 offset:9216
    v_smfmac_f32_16x16x64_bf16 v[60:63], v[16:19], a[72:79], v2
    v_smfmac_f32_16x16x64_bf16 v[64:67], v[16:19], v[124:131], v2
    ds_read_b128 v[124:127], v13 offset:10240
    ds_read_b128 v[128:131], v13 offset:11264
    s_waitcnt lgkmcnt(9)
    v_smfmac_f32_16x16x64_bf16 v[56:59], v[20:23], a[80:87], v2
    v_smfmac_f32_16x16x64_bf16 v[60:63], v[20:23], v[132:139], v2
    ds_read_b128 v[132:135], v13 offset:12288
    ds_read_b128 v[136:139], v13 offset:13312
    v_smfmac_f32_16x16x64_bf16 v[64:67], v[20:23], a[88:95], v2
    s_waitcnt lgkmcnt(10)
    v_smfmac_f32_16x16x64_bf16 v[56:59], v[24:27], v[140:147], v2
    ds_read_b128 v[140:143], v13 offset:14336
    ds_read_b128 v[144:147], v13 offset:15360
    v_smfmac_f32_16x16x64_bf16 v[60:63], v[24:27], a[96:103], v2
    s_waitcnt lgkmcnt(6)
    v_smfmac_f32_16x16x64_bf16 v[64:67], v[24:27], v[116:123], v2
    ds_read_b128 v[116:119], v13 offset:16384
    ds_read_b128 v[120:123], v13 offset:17408
    v_smfmac_f32_16x16x64_bf16 v[56:59], v[40:43], a[104:111], v2
    s_waitcnt lgkmcnt(6)
    v_smfmac_f32_16x16x64_bf16 v[60:63], v[40:43], v[124:131], v2
    ds_read_b128 v[124:127], v13 offset:18432
    ds_read_b128 v[128:131], v13 offset:19456
    v_smfmac_f32_16x16x64_bf16 v[64:67], v[40:43], a[112:119], v2
    s_waitcnt lgkmcnt(6)
    v_smfmac_f32_16x16x64_bf16 v[56:59], v[44:47], v[132:139], v2
    ds_read_b128 v[132:135], v13 offset:20480
    ds_read_b128 v[136:139], v13 offset:21504
    v_smfmac_f32_16x16x64_bf16 v[60:63], v[44:47], a[120:127], v2
    s_waitcnt lgkmcnt(6)
    v_smfmac_f32_16x16x64_bf16 v[64:67], v[44:47], v[140:147], v2
    ds_read_b128 v[140:143], v13 offset:22528
    ds_read_b128 v[144:147], v13 offset:23552
    v_smfmac_f32_16x16x64_bf16 v[56:59], v[48:51], a[128:135], v2
    s_waitcnt lgkmcnt(6)
    v_smfmac_f32_16x16x64_bf16 v[60:63], v[48:51], v[116:123], v2
    ds_read_b128 v[116:119], v13 offset:24576
    ds_read_b128 v[120:123], v13 offset:25600
    v_smfmac_f32_16x16x64_bf16 v[64:67], v[48:51], a[136:143], v2
    s_waitcnt lgkmcnt(6)
    v_smfmac_f32_16x16x64_bf16 v[56:59], v[52:55], v[124:131], v2
    ds_read_b128 v[124:127], v13 offset:26624
    ds_read_b128 v[128:131], v13 offset:27648
    v_smfmac_f32_16x16x64_bf16 v[60:63], v[52:55], a[144:151], v2
    s_waitcnt lgkmcnt(6)
    v_smfmac_f32_16x16x64_bf16 v[64:67], v[52:55], v[132:139], v2
    ds_read_b128 v[132:135], v13 offset:28672
    ds_read_b128 v[136:139], v13 offset:29696
    v_smfmac_f32_16x16x64_bf16 v[68:71], v[16:19], a[152:159], v2
    v_smfmac_f32_16x16x64_bf16 v[68:71], v[20:23], a[160:167], v2
    v_permlane32_swap_b32 v56, v58
    v_permlane32_swap_b32 v57, v59
    v_smfmac_f32_16x16x64_bf16 v[68:71], v[24:27], a[168:175], v2
    v_add_f32 v56, v56, v58
    v_add_f32 v57, v57, v59
    v_smfmac_f32_16x16x64_bf16 v[68:71], v[28:31], a[176:183], v2
    v_cvt_pk_bf16_f32 v56, v56, v57
    ds_write_b16 v3, v56 offset:0
    v_smfmac_f32_16x16x64_bf16 v[68:71], v[32:35], a[184:191], v2
    ds_write_b16_d16_hi v3, v56 offset:400
    v_permlane32_swap_b32 v60, v62
    v_smfmac_f32_16x16x64_bf16 v[68:71], v[36:39], a[192:199], v2
    v_permlane32_swap_b32 v61, v63
    v_add_f32 v60, v60, v62
    v_smfmac_f32_16x16x64_bf16 v[68:71], v[40:43], a[200:207], v2
    v_add_f32 v61, v61, v63
    v_cvt_pk_bf16_f32 v60, v60, v61
    v_smfmac_f32_16x16x64_bf16 v[68:71], v[44:47], a[208:215], v2
    ds_write_b16 v3, v60 offset:32
    ds_write_b16_d16_hi v3, v60 offset:432
    v_smfmac_f32_16x16x64_bf16 v[68:71], v[48:51], a[216:223], v2
    v_permlane32_swap_b32 v64, v66
    v_permlane32_swap_b32 v65, v67
    v_smfmac_f32_16x16x64_bf16 v[68:71], v[52:55], a[224:231], v2
    v_add_f32 v64, v64, v66
    v_add_f32 v65, v65, v67
    v_smfmac_f32_16x16x64_bf16 v[72:75], v[16:19], a[232:239], v2
    v_cvt_pk_bf16_f32 v64, v64, v65
    ds_write_b16 v3, v64 offset:64
    v_smfmac_f32_16x16x64_bf16 v[72:75], v[20:23], a[240:247], v2
    ds_write_b16_d16_hi v3, v64 offset:464
    v_smfmac_f32_16x16x64_bf16 v[72:75], v[24:27], a[248:255], v2
    v_smfmac_f32_16x16x64_bf16 v[72:75], v[28:31], v[148:155], v2
    s_waitcnt lgkmcnt(0)
    s_barrier
    ds_read_b128 v[88:91], v4 offset:0
    v_smfmac_f32_16x16x64_bf16 v[72:75], v[32:35], v[140:147], v2
    ds_read_b128 v[92:95], v4 offset:128
    ds_read_b128 v[96:99], v4 offset:256
    v_smfmac_f32_16x16x64_bf16 v[72:75], v[36:39], v[156:163], v2
    v_permlane32_swap_b32 v68, v70
    v_permlane32_swap_b32 v69, v71
    v_smfmac_f32_16x16x64_bf16 v[72:75], v[40:43], v[164:171], v2
    v_add_f32 v68, v68, v70
    v_add_f32 v69, v69, v71
    v_smfmac_f32_16x16x64_bf16 v[72:75], v[44:47], v[172:179], v2
    v_cvt_pk_bf16_f32 v68, v68, v69
    ds_write_b16 v3, v68 offset:3200
    v_smfmac_f32_16x16x64_bf16 v[72:75], v[48:51], v[116:123], v2
    ds_write_b16_d16_hi v3, v68 offset:3600
    v_smfmac_f32_16x16x64_bf16 v[72:75], v[52:55], v[180:187], v2
    s_waitcnt lgkmcnt(2)
    v_smfmac_f32_16x16x64_bf16 v[80:83], v[88:91], v[100:107], v2
    v_smfmac_f32_16x16x64_bf16 v[80:83], v[92:95], v[108:115], v2
    v_smfmac_f32_16x16x64_bf16 v[76:79], v[16:19], v[188:195], v2
    v_smfmac_f32_16x16x64_bf16 v[76:79], v[20:23], v[196:203], v2
    v_smfmac_f32_16x16x64_bf16 v[76:79], v[24:27], v[124:131], v2
    v_permlane32_swap_b32 v72, v74
    v_permlane32_swap_b32 v73, v75
    v_smfmac_f32_16x16x64_bf16 v[76:79], v[28:31], v[204:211], v2
    v_add_f32 v72, v72, v74
    v_add_f32 v73, v73, v75
    ds_write_b128 v15, v[80:83]
    v_smfmac_f32_16x16x64_bf16 v[76:79], v[32:35], v[212:219], v2
    v_cvt_pk_bf16_f32 v72, v72, v73
    ds_write_b16 v3, v72 offset:3232
    v_smfmac_f32_16x16x64_bf16 v[76:79], v[36:39], v[220:227], v2
    ds_write_b16_d16_hi v3, v72 offset:3632
    v_smfmac_f32_16x16x64_bf16 v[76:79], v[40:43], v[132:139], v2
    v_smfmac_f32_16x16x64_bf16 v[76:79], v[44:47], v[228:235], v2
    v_smfmac_f32_16x16x64_bf16 v[76:79], v[48:51], v[236:243], v2
    v_smfmac_f32_16x16x64_bf16 v[76:79], v[52:55], v[244:251], v2
    s_nop 7
    v_permlane32_swap_b32 v76, v78
    v_permlane32_swap_b32 v77, v79
    v_add_f32 v76, v76, v78
    v_add_f32 v77, v77, v79
    v_cvt_pk_bf16_f32 v76, v76, v77
    ds_write_b16 v3, v76 offset:3264
    ds_write_b16_d16_hi v3, v76 offset:3664
    s_waitcnt lgkmcnt(0)
    s_barrier
    ds_read2st64_b32 v[40:41], v6 offset0:0 offset1:2
    ds_read2st64_b32 v[42:43], v6 offset0:8 offset1:10
    ds_read_b128 v[16:19], v5 offset:0
    ds_read_b128 v[20:23], v5 offset:16
    ds_read_b128 v[24:27], v5 offset:128
    ds_read_b128 v[28:31], v5 offset:144
    ds_read_b128 v[32:35], v5 offset:256
    ds_read_b128 v[36:39], v5 offset:272
    s_waitcnt lgkmcnt(6)
    v_add_f32 v40, v40, v41
    v_add_f32 v42, v42, v43
    v_add_f32 v44, v40, v42
    v_mul_f32 v44, 0x3dd53b95, v44
    s_waitcnt lgkmcnt(4)
    v_smfmac_f32_16x16x64_bf16 v[84:87], v[88:91], v[16:23], v2
    s_waitcnt lgkmcnt(2)
    v_smfmac_f32_16x16x64_bf16 v[84:87], v[92:95], v[24:31], v2
    s_waitcnt lgkmcnt(0)
    v_smfmac_f32_16x16x64_bf16 v[84:87], v[96:99], v[32:39], v2
    v_max_f32_dpp v45, v44, v44 row_ror:8 row_mask:0xf bank_mask:0xf
    s_nop 1
    v_max_f32_dpp v45, v45, v45 row_ror:4 row_mask:0xf bank_mask:0xf
    s_nop 1
    v_max_f32_dpp v45, v45, v45 row_ror:2 row_mask:0xf bank_mask:0xf
    s_nop 1
    v_max_f32_dpp v45, v45, v45 row_ror:1 row_mask:0xf bank_mask:0xf
    v_mov_b32 v47, v45
    s_nop 1
    v_permlane32_swap_b32 v45, v47
    v_max_f32 v45, v45, v47
    v_mov_b32 v47, v85
    s_nop 1
    v_permlane32_swap_b32 v85, v47
    v_add_f32 v48, v85, v47
    v_mul_f32 v48, 0x3dd53b95, v48
    s_nop 1
    v_max_f32_dpp v46, v48, v48 row_ror:4 row_mask:0xf bank_mask:0xf
    s_nop 1
    v_max_f32_dpp v46, v46, v46 row_ror:2 row_mask:0xf bank_mask:0xf
    s_nop 1
    v_max_f32_dpp v46, v46, v46 row_ror:1 row_mask:0xf bank_mask:0xf
    v_max_f32 v45, v45, v46
    v_sub_f32 v49, v44, v45
    v_sub_f32 v50, v48, v45
    v_exp_f32 v49, v49
    v_exp_f32 v50, v50
    s_nop 0
    v_fma_f32 v51, v50, v12, v49
    s_nop 1
    v_add_f32_dpp v51, v51, v51 row_ror:8 row_mask:0xf bank_mask:0xf
    s_nop 1
    v_add_f32_dpp v51, v51, v51 row_ror:4 row_mask:0xf bank_mask:0xf
    s_nop 1
    v_add_f32_dpp v51, v51, v51 row_ror:2 row_mask:0xf bank_mask:0xf
    s_nop 1
    v_add_f32_dpp v51, v51, v51 row_ror:1 row_mask:0xf bank_mask:0xf
    v_mov_b32 v47, v51
    s_nop 1
    v_permlane32_swap_b32 v51, v47
    v_add_f32 v51, v51, v47
    v_rcp_f32 v51, v51
    s_nop 0
    v_mul_f32 v49, v49, v51
    v_mul_f32 v50, v50, v51
    s_nop 0
    v_mov_b32_dpp v46, v49 quad_perm:[1,0,3,2] row_mask:0xf bank_mask:0xf
    v_mov_b32_dpp v47, v50 quad_perm:[1,0,3,2] row_mask:0xf bank_mask:0xf
    v_cvt_pk_bf16_f32 v16, v49, v46
    v_cvt_pk_bf16_f32 v20, v50, v47
    s_nop 0
    v_mov_b32_dpp v17, v16 row_shl:2 row_mask:0xf bank_mask:0xf
    v_mov_b32_dpp v18, v16 row_shl:4 row_mask:0xf bank_mask:0xf
    v_mov_b32_dpp v19, v16 row_shl:6 row_mask:0xf bank_mask:0xf
    v_mov_b32_dpp v21, v20 row_shl:2 row_mask:0xf bank_mask:0xf
    v_mov_b32_dpp v22, v20 row_shl:4 row_mask:0xf bank_mask:0xf
    v_mov_b32_dpp v23, v20 row_shl:6 row_mask:0xf bank_mask:0xf
    s_mov_b64 exec, s[40:41]
    buffer_store_dwordx4 v[16:19], v7, s[8:11], s18 offen sc1
    s_mov_b64 exec, s[42:43]
    buffer_store_dwordx4 v[20:23], v8, s[8:11], s18 offen sc1
    s_mov_b64 exec, -1
    ds_read_b128 v[40:43], v10
    s_add_u32 s28, s14, 1
    s_min_u32 s28, s28, 63
    s_mul_i32 s20, s28, 393216
    s_add_u32 s20, s20, s44
    s_add_u32 s21, s20, 0
    buffer_load_dwordx4 v[100:103], v9, s[8:11], s21 offen offset:0
    buffer_load_dwordx4 v[104:107], v9, s[8:11], s21 offen offset:512
    s_add_u32 s21, s20, 4096
    buffer_load_dwordx4 v[108:111], v9, s[8:11], s21 offen offset:0
    buffer_load_dwordx4 v[112:115], v9, s[8:11], s21 offen offset:512
    v_mov_b32 v56, 0
    v_mov_b32 v57, 0
    v_mov_b32 v58, 0
    v_mov_b32 v59, 0
    v_mov_b32 v60, 0
    v_mov_b32 v61, 0
    v_mov_b32 v62, 0
    v_mov_b32 v63, 0
    v_mov_b32 v64, 0
    v_mov_b32 v65, 0
    v_mov_b32 v66, 0
    v_mov_b32 v67, 0
    v_mov_b32 v68, 0
    v_mov_b32 v69, 0
    v_mov_b32 v70, 0
    v_mov_b32 v71, 0
    v_mov_b32 v72, 0
    v_mov_b32 v73, 0
    v_mov_b32 v74, 0
    v_mov_b32 v75, 0
    v_mov_b32 v76, 0
    v_mov_b32 v77, 0
    v_mov_b32 v78, 0
    v_mov_b32 v79, 0
    v_mov_b32 v80, 0
    v_mov_b32 v81, 0
    v_mov_b32 v82, 0
    v_mov_b32 v83, 0
    v_mov_b32 v84, 0
    v_mov_b32 v85, 0
    v_mov_b32 v86, 0
    v_mov_b32 v87, 0
    s_waitcnt lgkmcnt(0)
    s_mul_i32 s20, s14, 98304
    s_add_u32 s20, s20, s45
    buffer_store_dwordx4 v[40:43], v11, s[8:11], s20 offen
    ds_read_b128 v[116:119], v13 offset:0
    ds_read_b128 v[120:123], v13 offset:1024
    ds_read_b128 v[124:127], v13 offset:2048
    ds_read_b128 v[128:131], v13 offset:3072
    ds_read_b128 v[132:135], v13 offset:4096
    ds_read_b128 v[136:139], v13 offset:5120
    ds_read_b128 v[140:143], v13 offset:6144
    ds_read_b128 v[144:147], v13 offset:7168
    s_waitcnt lgkmcnt(0)
    s_add_u32 s14, s14, 1
    s_cmp_lt_u32 s14, 64
    s_cbranch_scc1 chain2_kernel_p1_step
    s_branch chain2_kernel_end
chain2_kernel_p2_start:
    v_lshrrev_b32 v16, 4, v0
    v_and_b32 v17, 15, v0
    v_and_b32 v18, 1, v16
    v_lshlrev_b32 v18, 2, v18
    v_lshrrev_b32 v19, 1, v16
    v_lshl_add_u32 v18, v19, 1, v18
    v_mul_u32_u24 v18, 400, v18
    v_lshl_add_u32 v18, v17, 1, v18
    v_add_u32 v3, 133312, v18
    v_and_b32 v18, 7, v0
    v_mul_u32_u24 v18, 400, v18
    v_lshrrev_b32 v19, 3, v0
    v_lshl_add_u32 v18, v19, 4, v18
    v_add_u32 v4, 133120, v18
    v_and_b32 v18, 7, v0
    v_mul_u32_u24 v18, 400, v18
    v_lshl_add_u32 v18, v16, 5, v18
    v_add_u32 v5, 136320, v18
    v_lshrrev_b32 v18, 1, v16
    v_lshlrev_b32 v18, 10, v18
    v_and_b32 v19, 31, v0
    v_lshl_add_u32 v18, v19, 4, v18
    v_add_u32 v6, 139528, v18
    v_add_u32 v15, 141568, v1
    v_lshrrev_b32 v18, 1, v16
    v_lshlrev_b32 v18, 1, v18
    v_lshrrev_b32 v19, 3, v17
    v_add3_u32 v18, v18, v19, 1
    v_lshrrev_b32 v19, 1, v18
    v_lshlrev_b32 v19, 14, v19
    v_and_b32 v18, 1, v18
    v_lshl_add_u32 v18, v18, 12, v19
    v_and_b32 v19, 1, v16
    v_lshlrev_b32 v19, 4, v19
    v_add_u32 v19, 64, v19
    s_lshl_b32 s20, s12, 7
    v_add_u32 v8, s20, v19
    v_add_u32 v7, v8, v18
    v_lshlrev_b32 v18, 4, v17
    v_lshl_add_u32 v18, v16, 10, v18
    v_add_u32 v9, 0, v18
    v_add_u32 v18, 128, v0
    v_mul_u32_u24 v19, 2731, v18
    v_lshrrev_b32 v19, 16, v19
    v_mul_u32_u24 v20, 24, v19
    v_sub_u32 v20, v18, v20
    v_mul_u32_u24 v21, 400, v19
    v_lshl_add_u32 v21, v20, 4, v21
    v_add_u32 v10, 136320, v21
    v_lshlrev_b32 v21, 4, v19
    v_lshl_add_u32 v11, v20, 7, v21
    v_and_b32 v18, 0x28, v0
    v_cmp_eq_u32 vcc, 0, v18
    v_mov_b32 v18, 1.0
    v_mov_b32 v19, 0
    v_cndmask_b32 v12, v19, v18, vcc
    v_add_u32 v13, 61440, v1
    v_add_u32 v14, 122880, v1
    s_mul_i32 s44, s12, 12288
    s_add_u32 s44, s44, 53477376
    s_mul_i32 s45, s12, 3072
    s_add_u32 s45, s45, 208666624
    s_mul_i32 s20, s12, 491520
    s_add_u32 s20, s20, 11780096
    s_add_u32 s21, s20, 2048
    buffer_load_dwordx4 v[16:19], v1, s[8:11], s21 offen offset:0
    buffer_load_dwordx4 v[20:23], v1, s[8:11], s21 offen offset:1024
    s_add_u32 s21, s20, 43008
    buffer_load_dwordx4 v[24:27], v1, s[8:11], s21 offen offset:0
    buffer_load_dwordx4 v[28:31], v1, s[8:11], s21 offen offset:1024
    s_add_u32 s21, s20, 24576
    buffer_load_dwordx4 v[32:35], v1, s[8:11], s21 offen offset:0
    buffer_load_dwordx4 v[36:39], v1, s[8:11], s21 offen offset:1024
    s_add_u32 s21, s20, 6144
    buffer_load_dwordx4 v[40:43], v1, s[8:11], s21 offen offset:0
    buffer_load_dwordx4 v[44:47], v1, s[8:11], s21 offen offset:1024
    s_add_u32 s21, s20, 47104
    buffer_load_dwordx4 v[48:51], v1, s[8:11], s21 offen offset:0
    buffer_load_dwordx4 v[52:55], v1, s[8:11], s21 offen offset:1024
    s_add_u32 s21, s20, 28672
    buffer_load_dwordx4 v[56:59], v1, s[8:11], s21 offen offset:0
    buffer_load_dwordx4 v[60:63], v1, s[8:11], s21 offen offset:1024
    s_add_u32 s21, s20, 10240
    buffer_load_dwordx4 v[64:67], v1, s[8:11], s21 offen offset:0
    buffer_load_dwordx4 v[68:71], v1, s[8:11], s21 offen offset:1024
    s_add_u32 s21, s20, 51200
    buffer_load_dwordx4 v[72:75], v1, s[8:11], s21 offen offset:0
    buffer_load_dwordx4 v[76:79], v1, s[8:11], s21 offen offset:1024
    s_add_u32 s21, s20, 36864
    buffer_load_dwordx4 v[80:83], v1, s[8:11], s21 offen offset:0
    buffer_load_dwordx4 v[84:87], v1, s[8:11], s21 offen offset:1024
    s_add_u32 s21, s20, 18432
    buffer_load_dwordx4 v[88:91], v1, s[8:11], s21 offen offset:0
    buffer_load_dwordx4 v[92:95], v1, s[8:11], s21 offen offset:1024
    s_add_u32 s21, s20, 59392
    buffer_load_dwordx4 v[96:99], v1, s[8:11], s21 offen offset:0
    buffer_load_dwordx4 v[100:103], v1, s[8:11], s21 offen offset:1024
    s_add_u32 s21, s20, 90112
    buffer_load_dwordx4 v[104:107], v1, s[8:11], s21 offen offset:0
    buffer_load_dwordx4 v[108:111], v1, s[8:11], s21 offen offset:1024
    s_add_u32 s21, s20, 98304
    buffer_load_dwordx4 v[112:115], v1, s[8:11], s21 offen offset:0
    buffer_load_dwordx4 v[116:119], v1, s[8:11], s21 offen offset:1024
    s_add_u32 s21, s20, 106496
    buffer_load_dwordx4 v[120:123], v1, s[8:11], s21 offen offset:0
    buffer_load_dwordx4 v[124:127], v1, s[8:11], s21 offen offset:1024
    s_add_u32 s21, s20, 114688
    buffer_load_dwordx4 v[128:131], v1, s[8:11], s21 offen offset:0
    buffer_load_dwordx4 v[132:135], v1, s[8:11], s21 offen offset:1024
    s_add_u32 s21, s20, 12288
    buffer_load_dwordx4 a[0:3], v1, s[8:11], s21 offen offset:0
    buffer_load_dwordx4 a[4:7], v1, s[8:11], s21 offen offset:1024
    s_add_u32 s21, s20, 32768
    buffer_load_dwordx4 a[8:11], v1, s[8:11], s21 offen offset:0
    buffer_load_dwordx4 a[12:15], v1, s[8:11], s21 offen offset:1024
    s_add_u32 s21, s20, 53248
    buffer_load_dwordx4 a[16:19], v1, s[8:11], s21 offen offset:0
    buffer_load_dwordx4 a[20:23], v1, s[8:11], s21 offen offset:1024
    s_add_u32 s21, s20, 14336
    buffer_load_dwordx4 a[24:27], v1, s[8:11], s21 offen offset:0
    buffer_load_dwordx4 a[28:31], v1, s[8:11], s21 offen offset:1024
    s_add_u32 s21, s20, 34816
    buffer_load_dwordx4 a[32:35], v1, s[8:11], s21 offen offset:0
    buffer_load_dwordx4 a[36:39], v1, s[8:11], s21 offen offset:1024
    s_add_u32 s21, s20, 55296
    buffer_load_dwordx4 a[40:43], v1, s[8:11], s21 offen offset:0
    buffer_load_dwordx4 a[44:47], v1, s[8:11], s21 offen offset:1024
    s_add_u32 s21, s20, 0
    buffer_load_dwordx4 a[48:51], v1, s[8:11], s21 offen offset:0
    buffer_load_dwordx4 a[52:55], v1, s[8:11], s21 offen offset:1024
    s_add_u32 s21, s20, 20480
    buffer_load_dwordx4 a[56:59], v1, s[8:11], s21 offen offset:0
    buffer_load_dwordx4 a[60:63], v1, s[8:11], s21 offen offset:1024
    s_add_u32 s21, s20, 40960
    buffer_load_dwordx4 a[64:67], v1, s[8:11], s21 offen offset:0
    buffer_load_dwordx4 a[68:71], v1, s[8:11], s21 offen offset:1024
    s_add_u32 s21, s20, 22528
    buffer_load_dwordx4 a[72:75], v1, s[8:11], s21 offen offset:0
    buffer_load_dwordx4 a[76:79], v1, s[8:11], s21 offen offset:1024
    s_add_u32 s21, s20, 4096
    buffer_load_dwordx4 a[80:83], v1, s[8:11], s21 offen offset:0
    buffer_load_dwordx4 a[84:87], v1, s[8:11], s21 offen offset:1024
    s_add_u32 s21, s20, 45056
    buffer_load_dwordx4 a[88:91], v1, s[8:11], s21 offen offset:0
    buffer_load_dwordx4 a[92:95], v1, s[8:11], s21 offen offset:1024
    s_add_u32 s21, s20, 26624
    buffer_load_dwordx4 a[96:99], v1, s[8:11], s21 offen offset:0
    buffer_load_dwordx4 a[100:103], v1, s[8:11], s21 offen offset:1024
    s_add_u32 s21, s20, 8192
    buffer_load_dwordx4 a[104:107], v1, s[8:11], s21 offen offset:0
    buffer_load_dwordx4 a[108:111], v1, s[8:11], s21 offen offset:1024
    s_add_u32 s21, s20, 49152
    buffer_load_dwordx4 a[112:115], v1, s[8:11], s21 offen offset:0
    buffer_load_dwordx4 a[116:119], v1, s[8:11], s21 offen offset:1024
    s_add_u32 s21, s20, 30720
    buffer_load_dwordx4 a[120:123], v1, s[8:11], s21 offen offset:0
    buffer_load_dwordx4 a[124:127], v1, s[8:11], s21 offen offset:1024
    s_waitcnt vmcnt(32)
    ds_write_b128 v13, v[16:19] offset:0
    ds_write_b128 v13, v[20:23] offset:1024
    ds_write_b128 v13, v[24:27] offset:2048
    ds_write_b128 v13, v[28:31] offset:3072
    ds_write_b128 v13, v[32:35] offset:4096
    ds_write_b128 v13, v[36:39] offset:5120
    ds_write_b128 v13, v[40:43] offset:6144
    ds_write_b128 v13, v[44:47] offset:7168
    ds_write_b128 v13, v[48:51] offset:8192
    ds_write_b128 v13, v[52:55] offset:9216
    ds_write_b128 v13, v[56:59] offset:10240
    ds_write_b128 v13, v[60:63] offset:11264
    ds_write_b128 v13, v[64:67] offset:12288
    ds_write_b128 v13, v[68:71] offset:13312
    ds_write_b128 v13, v[72:75] offset:14336
    ds_write_b128 v13, v[76:79] offset:15360
    ds_write_b128 v13, v[80:83] offset:16384
    ds_write_b128 v13, v[84:87] offset:17408
    ds_write_b128 v13, v[88:91] offset:18432
    ds_write_b128 v13, v[92:95] offset:19456
    ds_write_b128 v13, v[96:99] offset:20480
    ds_write_b128 v13, v[100:103] offset:21504
    ds_write_b128 v13, v[104:107] offset:22528
    ds_write_b128 v13, v[108:111] offset:23552
    ds_write_b128 v13, v[112:115] offset:24576
    ds_write_b128 v13, v[116:119] offset:25600
    ds_write_b128 v13, v[120:123] offset:26624
    ds_write_b128 v13, v[124:127] offset:27648
    ds_write_b128 v13, v[128:131] offset:28672
    ds_write_b128 v13, v[132:135] offset:29696
    s_add_u32 s21, s20, 16384
    buffer_load_dwordx4 a[128:131], v1, s[8:11], s21 offen offset:0
    buffer_load_dwordx4 a[132:135], v1, s[8:11], s21 offen offset:1024
    s_add_u32 s21, s20, 57344
    buffer_load_dwordx4 a[136:139], v1, s[8:11], s21 offen offset:0
    buffer_load_dwordx4 a[140:143], v1, s[8:11], s21 offen offset:1024
    s_add_u32 s21, s20, 38912
    buffer_load_dwordx4 a[144:147], v1, s[8:11], s21 offen offset:0
    buffer_load_dwordx4 a[148:151], v1, s[8:11], s21 offen offset:1024
    s_add_u32 s21, s20, 61440
    buffer_load_dwordx4 a[152:155], v1, s[8:11], s21 offen offset:0
    buffer_load_dwordx4 a[156:159], v1, s[8:11], s21 offen offset:1024
    s_add_u32 s21, s20, 63488
    buffer_load_dwordx4 a[160:163], v1, s[8:11], s21 offen offset:0
    buffer_load_dwordx4 a[164:167], v1, s[8:11], s21 offen offset:1024
    s_add_u32 s21, s20, 65536
    buffer_load_dwordx4 a[168:171], v1, s[8:11], s21 offen offset:0
    buffer_load_dwordx4 a[172:175], v1, s[8:11], s21 offen offset:1024
    s_add_u32 s21, s20, 67584
    buffer_load_dwordx4 a[176:179], v1, s[8:11], s21 offen offset:0
    buffer_load_dwordx4 a[180:183], v1, s[8:11], s21 offen offset:1024
    s_add_u32 s21, s20, 69632
    buffer_load_dwordx4 a[184:187], v1, s[8:11], s21 offen offset:0
    buffer_load_dwordx4 a[188:191], v1, s[8:11], s21 offen offset:1024
    s_add_u32 s21, s20, 71680
    buffer_load_dwordx4 a[192:195], v1, s[8:11], s21 offen offset:0
    buffer_load_dwordx4 a[196:199], v1, s[8:11], s21 offen offset:1024
    s_add_u32 s21, s20, 73728
    buffer_load_dwordx4 a[200:203], v1, s[8:11], s21 offen offset:0
    buffer_load_dwordx4 a[204:207], v1, s[8:11], s21 offen offset:1024
    s_add_u32 s21, s20, 75776
    buffer_load_dwordx4 a[208:211], v1, s[8:11], s21 offen offset:0
    buffer_load_dwordx4 a[212:215], v1, s[8:11], s21 offen offset:1024
    s_add_u32 s21, s20, 77824
    buffer_load_dwordx4 a[216:219], v1, s[8:11], s21 offen offset:0
    buffer_load_dwordx4 a[220:223], v1, s[8:11], s21 offen offset:1024
    s_add_u32 s21, s20, 79872
    buffer_load_dwordx4 a[224:227], v1, s[8:11], s21 offen offset:0
    buffer_load_dwordx4 a[228:231], v1, s[8:11], s21 offen offset:1024
    s_add_u32 s21, s20, 81920
    buffer_load_dwordx4 a[232:235], v1, s[8:11], s21 offen offset:0
    buffer_load_dwordx4 a[236:239], v1, s[8:11], s21 offen offset:1024
    s_add_u32 s21, s20, 83968
    buffer_load_dwordx4 a[240:243], v1, s[8:11], s21 offen offset:0
    buffer_load_dwordx4 a[244:247], v1, s[8:11], s21 offen offset:1024
    s_add_u32 s21, s20, 86016
    buffer_load_dwordx4 a[248:251], v1, s[8:11], s21 offen offset:0
    buffer_load_dwordx4 a[252:255], v1, s[8:11], s21 offen offset:1024
    s_add_u32 s21, s20, 88064
    buffer_load_dwordx4 v[148:151], v1, s[8:11], s21 offen offset:0
    buffer_load_dwordx4 v[152:155], v1, s[8:11], s21 offen offset:1024
    s_add_u32 s21, s20, 92160
    buffer_load_dwordx4 v[156:159], v1, s[8:11], s21 offen offset:0
    buffer_load_dwordx4 v[160:163], v1, s[8:11], s21 offen offset:1024
    s_add_u32 s21, s20, 94208
    buffer_load_dwordx4 v[164:167], v1, s[8:11], s21 offen offset:0
    buffer_load_dwordx4 v[168:171], v1, s[8:11], s21 offen offset:1024
    s_add_u32 s21, s20, 96256
    buffer_load_dwordx4 v[172:175], v1, s[8:11], s21 offen offset:0
    buffer_load_dwordx4 v[176:179], v1, s[8:11], s21 offen offset:1024
    s_add_u32 s21, s20, 100352
    buffer_load_dwordx4 v[180:183], v1, s[8:11], s21 offen offset:0
    buffer_load_dwordx4 v[184:187], v1, s[8:11], s21 offen offset:1024
    s_add_u32 s21, s20, 102400
    buffer_load_dwordx4 v[188:191], v1, s[8:11], s21 offen offset:0
    buffer_load_dwordx4 v[192:195], v1, s[8:11], s21 offen offset:1024
    s_add_u32 s21, s20, 104448
    buffer_load_dwordx4 v[196:199], v1, s[8:11], s21 offen offset:0
    buffer_load_dwordx4 v[200:203], v1, s[8:11], s21 offen offset:1024
    s_add_u32 s21, s20, 108544
    buffer_load_dwordx4 v[204:207], v1, s[8:11], s21 offen offset:0
    buffer_load_dwordx4 v[208:211], v1, s[8:11], s21 offen offset:1024
    s_add_u32 s21, s20, 110592
    buffer_load_dwordx4 v[212:215], v1, s[8:11], s21 offen offset:0
    buffer_load_dwordx4 v[216:219], v1, s[8:11], s21 offen offset:1024
    s_add_u32 s21, s20, 112640
    buffer_load_dwordx4 v[220:223], v1, s[8:11], s21 offen offset:0
    buffer_load_dwordx4 v[224:227], v1, s[8:11], s21 offen offset:1024
    s_add_u32 s21, s20, 116736
    buffer_load_dwordx4 v[228:231], v1, s[8:11], s21 offen offset:0
    buffer_load_dwordx4 v[232:235], v1, s[8:11], s21 offen offset:1024
    s_add_u32 s21, s20, 118784
    buffer_load_dwordx4 v[236:239], v1, s[8:11], s21 offen offset:0
    buffer_load_dwordx4 v[240:243], v1, s[8:11], s21 offen offset:1024
    s_add_u32 s21, s20, 120832
    buffer_load_dwordx4 v[244:247], v1, s[8:11], s21 offen offset:0
    buffer_load_dwordx4 v[248:251], v1, s[8:11], s21 offen offset:1024
    s_waitcnt lgkmcnt(0)
    s_mov_b32 s14, 0
    s_mul_i32 s20, s14, 393216
    s_add_u32 s20, s20, s44
    s_add_u32 s21, s20, 8192
    buffer_load_dwordx4 v[100:103], v9, s[8:11], s21 offen offset:0
    buffer_load_dwordx4 v[104:107], v9, s[8:11], s21 offen offset:512
    v_mov_b32 v56, 0
    v_mov_b32 v57, 0
    v_mov_b32 v58, 0
    v_mov_b32 v59, 0
    v_mov_b32 v60, 0
    v_mov_b32 v61, 0
    v_mov_b32 v62, 0
    v_mov_b32 v63, 0
    v_mov_b32 v64, 0
    v_mov_b32 v65, 0
    v_mov_b32 v66, 0
    v_mov_b32 v67, 0
    v_mov_b32 v68, 0
    v_mov_b32 v69, 0
    v_mov_b32 v70, 0
    v_mov_b32 v71, 0
    v_mov_b32 v72, 0
    v_mov_b32 v73, 0
    v_mov_b32 v74, 0
    v_mov_b32 v75, 0
    v_mov_b32 v76, 0
    v_mov_b32 v77, 0
    v_mov_b32 v78, 0
    v_mov_b32 v79, 0
    v_mov_b32 v80, 0
    v_mov_b32 v81, 0
    v_mov_b32 v82, 0
    v_mov_b32 v83, 0
    v_mov_b32 v84, 0
    v_mov_b32 v85, 0
    v_mov_b32 v86, 0
    v_mov_b32 v87, 0
    ds_read_b128 v[116:119], v13 offset:0
    ds_read_b128 v[120:123], v13 offset:1024
    ds_read_b128 v[124:127], v13 offset:2048
    ds_read_b128 v[128:131], v13 offset:3072
    ds_read_b128 v[132:135], v13 offset:4096
    ds_read_b128 v[136:139], v13 offset:5120
    ds_read_b128 v[140:143], v13 offset:6144
    ds_read_b128 v[144:147], v13 offset:7168
    s_waitcnt lgkmcnt(0)
chain2_kernel_p2_step:
    s_cmp_lt_u32 s14, 32
    s_cselect_b32 s18, s16, s17
    s_and_b32 s20, s14, 31
    s_lshl_b32 s20, s20, 16
    s_add_u32 s18, s18, s20
    s_add_u32 s22, s18, 51200
    s_add_u32 s23, s18, 52224
chain2_kernel_p2_poll:
    buffer_load_dwordx4 v[40:43], v1, s[8:11], s22 offen sc1
    buffer_load_dwordx4 v[44:47], v1, s[8:11], s23 offen sc1
    s_waitcnt vmcnt(0)
    ds_write_b128 v14, v[40:43] offset:6144
    ds_write_b128 v14, v[44:47] offset:7168
    v_max3_u32 v88, v40, v41, v42
    v_max3_u32 v88, v88, v43, v44
    v_max3_u32 v88, v88, v45, v46
    v_max_u32 v88, v88, v47
    v_cmp_eq_u32 vcc, -1, v88
    s_sub_u32 s15, s15, 1
    s_cbranch_scc1 chain2_kernel_bail
    s_cbranch_vccnz chain2_kernel_p2_poll
    s_waitcnt lgkmcnt(0)
    s_barrier
    ds_read_b128 v[16:19], v14 offset:0
    ds_read_b128 v[20:23], v14 offset:1024
    ds_read_b128 v[24:27], v14 offset:2048
    ds_read_b128 v[28:31], v14 offset:3072
    ds_read_b128 v[32:35], v14 offset:4096
    ds_read_b128 v[36:39], v14 offset:5120
    ds_read_b128 v[48:51], v14 offset:8192
    ds_read_b128 v[52:55], v14 offset:9216
    v_smfmac_f32_16x16x64_bf16 v[56:59], v[40:43], a[0:7], v2
    v_smfmac_f32_16x16x64_bf16 v[60:63], v[40:43], a[8:15], v2
    v_smfmac_f32_16x16x64_bf16 v[64:67], v[40:43], a[16:23], v2
    v_smfmac_f32_16x16x64_bf16 v[56:59], v[44:47], a[24:31], v2
    v_smfmac_f32_16x16x64_bf16 v[60:63], v[44:47], a[32:39], v2
    v_smfmac_f32_16x16x64_bf16 v[64:67], v[44:47], a[40:47], v2
    s_waitcnt lgkmcnt(7)
    v_smfmac_f32_16x16x64_bf16 v[56:59], v[16:19], a[48:55], v2
    v_smfmac_f32_16x16x64_bf16 v[60:63], v[16:19], a[56:63], v2
    v_smfmac_f32_16x16x64_bf16 v[64:67], v[16:19], a[64:71], v2
    s_waitcnt lgkmcnt(6)
    v_smfmac_f32_16x16x64_bf16 v[56:59], v[20:23], v[116:123], v2
    ds_read_b128 v[116:119], v13 offset:8192
    ds_read_b128 v[120:123], v13 offset:9216
    v_smfmac_f32_16x16x64_bf16 v[60:63], v[20:23], a[72:79], v2
    v_smfmac_f32_16x16x64_bf16 v[64:67], v[20:23], v[124:131], v2
    ds_read_b128 v[124:127], v13 offset:10240
    ds_read_b128 v[128:131], v13 offset:11264
    s_waitcnt lgkmcnt(9)
    v_smfmac_f32_16x16x64_bf16 v[56:59], v[24:27], a[80:87], v2
    v_smfmac_f32_16x16x64_bf16 v[60:63], v[24:27], v[132:139], v2
    ds_read_b128 v[132:135], v13 offset:12288
    ds_read_b128 v[136:139], v13 offset:13312
    v_smfmac_f32_16x16x64_bf16 v[64:67], v[24:27], a[88:95], v2
    s_waitcnt lgkmcnt(10)
    v_smfmac_f32_16x16x64_bf16 v[56:59], v[28:31], v[140:147], v2
    ds_read_b128 v[140:143], v13 offset:14336
    ds_read_b128 v[144:147], v13 offset:15360
    v_smfmac_f32_16x16x64_bf16 v[60:63], v[28:31], a[96:103], v2
    s_waitcnt lgkmcnt(6)
    v_smfmac_f32_16x16x64_bf16 v[64:67], v[28:31], v[116:123], v2
    ds_read_b128 v[116:119], v13 offset:16384
    ds_read_b128 v[120:123], v13 offset:17408
    v_smfmac_f32_16x16x64_bf16 v[56:59], v[32:35], a[104:111], v2
    s_waitcnt lgkmcnt(6)
    v_smfmac_f32_16x16x64_bf16 v[60:63], v[32:35], v[124:131], v2
    ds_read_b128 v[124:127], v13 offset:18432
    ds_read_b128 v[128:131], v13 offset:19456
    v_smfmac_f32_16x16x64_bf16 v[64:67], v[32:35], a[112:119], v2
    s_waitcnt lgkmcnt(6)
    v_smfmac_f32_16x16x64_bf16 v[56:59], v[36:39], v[132:139], v2
    ds_read_b128 v[132:135], v13 offset:20480
    ds_read_b128 v[136:139], v13 offset:21504
    v_smfmac_f32_16x16x64_bf16 v[60:63], v[36:39], a[120:127], v2
    s_waitcnt lgkmcnt(6)
    v_smfmac_f32_16x16x64_bf16 v[64:67], v[36:39], v[140:147], v2
    ds_read_b128 v[140:143], v13 offset:22528
    ds_read_b128 v[144:147], v13 offset:23552
    v_smfmac_f32_16x16x64_bf16 v[56:59], v[48:51], a[128:135], v2
    s_waitcnt lgkmcnt(6)
    v_smfmac_f32_16x16x64_bf16 v[60:63], v[48:51], v[116:123], v2
    ds_read_b128 v[116:119], v13 offset:24576
    ds_read_b128 v[120:123], v13 offset:25600
    v_smfmac_f32_16x16x64_bf16 v[64:67], v[48:51], a[136:143], v2
    s_waitcnt lgkmcnt(6)
    v_smfmac_f32_16x16x64_bf16 v[56:59], v[52:55], v[124:131], v2
    ds_read_b128 v[124:127], v13 offset:26624
    ds_read_b128 v[128:131], v13 offset:27648
    v_smfmac_f32_16x16x64_bf16 v[60:63], v[52:55], a[144:151], v2
    s_waitcnt lgkmcnt(6)
    v_smfmac_f32_16x16x64_bf16 v[64:67], v[52:55], v[132:139], v2
    ds_read_b128 v[132:135], v13 offset:28672
    ds_read_b128 v[136:139], v13 offset:29696
    v_smfmac_f32_16x16x64_bf16 v[68:71], v[16:19], a[152:159], v2
    v_smfmac_f32_16x16x64_bf16 v[68:71], v[20:23], a[160:167], v2
    v_permlane32_swap_b32 v56, v58
    v_permlane32_swap_b32 v57, v59
    v_smfmac_f32_16x16x64_bf16 v[68:71], v[24:27], a[168:175], v2
    v_add_f32 v56, v56, v58
    v_add_f32 v57, v57, v59
    v_smfmac_f32_16x16x64_bf16 v[68:71], v[28:31], a[176:183], v2
    v_cvt_pk_bf16_f32 v56, v56, v57
    ds_write_b16 v3, v56 offset:0
    v_smfmac_f32_16x16x64_bf16 v[68:71], v[32:35], a[184:191], v2
    ds_write_b16_d16_hi v3, v56 offset:400
    v_permlane32_swap_b32 v60, v62
    v_smfmac_f32_16x16x64_bf16 v[68:71], v[36:39], a[192:199], v2
    v_permlane32_swap_b32 v61, v63
    v_add_f32 v60, v60, v62
    v_smfmac_f32_16x16x64_bf16 v[68:71], v[40:43], a[200:207], v2
    v_add_f32 v61, v61, v63
    v_cvt_pk_bf16_f32 v60, v60, v61
    v_smfmac_f32_16x16x64_bf16 v[68:71], v[44:47], a[208:215], v2
    ds_write_b16 v3, v60 offset:32
    ds_write_b16_d16_hi v3, v60 offset:432
    v_smfmac_f32_16x16x64_bf16 v[68:71], v[48:51], a[216:223], v2
    v_permlane32_swap_b32 v64, v66
    v_permlane32_swap_b32 v65, v67
    v_smfmac_f32_16x16x64_bf16 v[68:71], v[52:55], a[224:231], v2
    v_add_f32 v64, v64, v66
    v_add_f32 v65, v65, v67
    v_smfmac_f32_16x16x64_bf16 v[72:75], v[16:19], a[232:239], v2
    v_cvt_pk_bf16_f32 v64, v64, v65
    ds_write_b16 v3, v64 offset:64
    v_smfmac_f32_16x16x64_bf16 v[72:75], v[20:23], a[240:247], v2
    ds_write_b16_d16_hi v3, v64 offset:464
    v_smfmac_f32_16x16x64_bf16 v[72:75], v[24:27], a[248:255], v2
    v_smfmac_f32_16x16x64_bf16 v[72:75], v[28:31], v[148:155], v2
    s_waitcnt lgkmcnt(0)
    s_barrier
    ds_read_b128 v[88:91], v4 offset:0
    v_smfmac_f32_16x16x64_bf16 v[72:75], v[32:35], v[140:147], v2
    ds_read_b128 v[92:95], v4 offset:128
    ds_read_b128 v[96:99], v4 offset:256
    v_smfmac_f32_16x16x64_bf16 v[72:75], v[36:39], v[156:163], v2
    v_permlane32_swap_b32 v68, v70
    v_permlane32_swap_b32 v69, v71
    v_smfmac_f32_16x16x64_bf16 v[72:75], v[40:43], v[164:171], v2
    v_add_f32 v68, v68, v70
    v_add_f32 v69, v69, v71
    v_smfmac_f32_16x16x64_bf16 v[72:75], v[44:47], v[172:179], v2
    v_cvt_pk_bf16_f32 v68, v68, v69
    ds_write_b16 v3, v68 offset:3200
    v_smfmac_f32_16x16x64_bf16 v[72:75], v[48:51], v[116:123], v2
    ds_write_b16_d16_hi v3, v68 offset:3600
    v_smfmac_f32_16x16x64_bf16 v[72:75], v[52:55], v[180:187], v2
    s_waitcnt lgkmcnt(2)
    v_smfmac_f32_16x16x64_bf16 v[80:83], v[96:99], v[100:107], v2
    v_smfmac_f32_16x16x64_bf16 v[76:79], v[16:19], v[188:195], v2
    v_smfmac_f32_16x16x64_bf16 v[76:79], v[20:23], v[196:203], v2
    v_smfmac_f32_16x16x64_bf16 v[76:79], v[24:27], v[124:131], v2
    v_permlane32_swap_b32 v72, v74
    v_permlane32_swap_b32 v73, v75
    v_smfmac_f32_16x16x64_bf16 v[76:79], v[28:31], v[204:211], v2
    v_add_f32 v72, v72, v74
    v_add_f32 v73, v73, v75
    ds_write_b128 v15, v[80:83]
    v_smfmac_f32_16x16x64_bf16 v[76:79], v[32:35], v[212:219], v2
    v_cvt_pk_bf16_f32 v72, v72, v73
    ds_write_b16 v3, v72 offset:3232
    v_smfmac_f32_16x16x64_bf16 v[76:79], v[36:39], v[220:227], v2
    ds_write_b16_d16_hi v3, v72 offset:3632
    v_smfmac_f32_16x16x64_bf16 v[76:79], v[40:43], v[132:139], v2
    v_smfmac_f32_16x16x64_bf16 v[76:79], v[44:47], v[228:235], v2
    v_smfmac_f32_16x16x64_bf16 v[76:79], v[48:51], v[236:243], v2
    v_smfmac_f32_16x16x64_bf16 v[76:79], v[52:55], v[244:251], v2
    s_nop 7
    v_permlane32_swap_b32 v76, v78
    v_permlane32_swap_b32 v77, v79
    v_add_f32 v76, v76, v78
    v_add_f32 v77, v77, v79
    v_cvt_pk_bf16_f32 v76, v76, v77
    ds_write_b16 v3, v76 offset:3264
    ds_write_b16_d16_hi v3, v76 offset:3664
    s_waitcnt lgkmcnt(0)
    s_barrier
    ds_read2st64_b32 v[40:41], v6 offset0:0 offset1:2
    ds_read2st64_b32 v[42:43], v6 offset0:8 offset1:10
    ds_read_b128 v[16:19], v5 offset:0
    ds_read_b128 v[20:23], v5 offset:16
    ds_read_b128 v[24:27], v5 offset:128
    ds_read_b128 v[28:31], v5 offset:144
    ds_read_b128 v[32:35], v5 offset:256
    ds_read_b128 v[36:39], v5 offset:272
    s_waitcnt lgkmcnt(6)
    v_add_f32 v40, v40, v41
    v_add_f32 v42, v42, v43
    v_add_f32 v44, v40, v42
    v_mul_f32 v44, 0x3dd53b95, v44
    s_waitcnt lgkmcnt(4)
    v_smfmac_f32_16x16x64_bf16 v[84:87], v[88:91], v[16:23], v2
    s_waitcnt lgkmcnt(2)
    v_smfmac_f32_16x16x64_bf16 v[84:87], v[92:95], v[24:31], v2
    s_waitcnt lgkmcnt(0)
    v_smfmac_f32_16x16x64_bf16 v[84:87], v[96:99], v[32:39], v2
    v_max_f32_dpp v45, v44, v44 row_ror:8 row_mask:0xf bank_mask:0xf
    s_nop 1
    v_max_f32_dpp v45, v45, v45 row_ror:4 row_mask:0xf bank_mask:0xf
    s_nop 1
    v_max_f32_dpp v45, v45, v45 row_ror:2 row_mask:0xf bank_mask:0xf
    s_nop 1
    v_max_f32_dpp v45, v45, v45 row_ror:1 row_mask:0xf bank_mask:0xf
    v_mov_b32 v47, v45
    s_nop 1
    v_permlane32_swap_b32 v45, v47
    v_max_f32 v45, v45, v47
    v_mov_b32 v47, v86
    s_nop 1
    v_permlane32_swap_b32 v86, v47
    v_add_f32 v48, v86, v47
    v_mul_f32 v48, 0x3dd53b95, v48
    s_nop 1
    v_max_f32_dpp v46, v48, v48 row_ror:4 row_mask:0xf bank_mask:0xf
    s_nop 1
    v_max_f32_dpp v46, v46, v46 row_ror:2 row_mask:0xf bank_mask:0xf
    s_nop 1
    v_max_f32_dpp v46, v46, v46 row_ror:1 row_mask:0xf bank_mask:0xf
    v_max_f32 v45, v45, v46
    v_sub_f32 v49, v44, v45
    v_sub_f32 v50, v48, v45
    v_exp_f32 v49, v49
    v_exp_f32 v50, v50
    s_nop 0
    v_fma_f32 v51, v50, v12, v49
    s_nop 1
    v_add_f32_dpp v51, v51, v51 row_ror:8 row_mask:0xf bank_mask:0xf
    s_nop 1
    v_add_f32_dpp v51, v51, v51 row_ror:4 row_mask:0xf bank_mask:0xf
    s_nop 1
    v_add_f32_dpp v51, v51, v51 row_ror:2 row_mask:0xf bank_mask:0xf
    s_nop 1
    v_add_f32_dpp v51, v51, v51 row_ror:1 row_mask:0xf bank_mask:0xf
    v_mov_b32 v47, v51
    s_nop 1
    v_permlane32_swap_b32 v51, v47
    v_add_f32 v51, v51, v47
    v_rcp_f32 v51, v51
    s_nop 0
    v_mul_f32 v49, v49, v51
    v_mul_f32 v50, v50, v51
    s_nop 0
    v_mov_b32_dpp v46, v49 quad_perm:[1,0,3,2] row_mask:0xf bank_mask:0xf
    v_mov_b32_dpp v47, v50 quad_perm:[1,0,3,2] row_mask:0xf bank_mask:0xf
    v_cvt_pk_bf16_f32 v16, v49, v46
    v_cvt_pk_bf16_f32 v20, v50, v47
    s_nop 0
    v_mov_b32_dpp v17, v16 row_shl:2 row_mask:0xf bank_mask:0xf
    v_mov_b32_dpp v18, v16 row_shl:4 row_mask:0xf bank_mask:0xf
    v_mov_b32_dpp v19, v16 row_shl:6 row_mask:0xf bank_mask:0xf
    v_mov_b32_dpp v21, v20 row_shl:2 row_mask:0xf bank_mask:0xf
    v_mov_b32_dpp v22, v20 row_shl:4 row_mask:0xf bank_mask:0xf
    v_mov_b32_dpp v23, v20 row_shl:6 row_mask:0xf bank_mask:0xf
    s_mov_b64 exec, s[40:41]
    buffer_store_dwordx4 v[16:19], v7, s[8:11], s18 offen sc1
    s_mov_b64 exec, s[42:43]
    buffer_store_dwordx4 v[20:23], v8, s[8:11], s18 offen sc1
    s_mov_b64 exec, -1
    ds_read_b128 v[40:43], v10
    s_add_u32 s28, s14, 1
    s_min_u32 s28, s28, 63
    s_mul_i32 s20, s28, 393216
    s_add_u32 s20, s20, s44
    s_add_u32 s21, s20, 8192
    buffer_load_dwordx4 v[100:103], v9, s[8:11], s21 offen offset:0
    buffer_load_dwordx4 v[104:107], v9, s[8:11], s21 offen offset:512
    v_mov_b32 v56, 0
    v_mov_b32 v57, 0
    v_mov_b32 v58, 0
    v_mov_b32 v59, 0
    v_mov_b32 v60, 0
    v_mov_b32 v61, 0
    v_mov_b32 v62, 0
    v_mov_b32 v63, 0
    v_mov_b32 v64, 0
    v_mov_b32 v65, 0
    v_mov_b32 v66, 0
    v_mov_b32 v67, 0
    v_mov_b32 v68, 0
    v_mov_b32 v69, 0
    v_mov_b32 v70, 0
    v_mov_b32 v71, 0
    v_mov_b32 v72, 0
    v_mov_b32 v73, 0
    v_mov_b32 v74, 0
    v_mov_b32 v75, 0
    v_mov_b32 v76, 0
    v_mov_b32 v77, 0
    v_mov_b32 v78, 0
    v_mov_b32 v79, 0
    v_mov_b32 v80, 0
    v_mov_b32 v81, 0
    v_mov_b32 v82, 0
    v_mov_b32 v83, 0
    v_mov_b32 v84, 0
    v_mov_b32 v85, 0
    v_mov_b32 v86, 0
    v_mov_b32 v87, 0
    s_waitcnt lgkmcnt(0)
    s_mul_i32 s20, s14, 98304
    s_add_u32 s20, s20, s45
    buffer_store_dwordx4 v[40:43], v11, s[8:11], s20 offen
    ds_read_b128 v[116:119], v13 offset:0
    ds_read_b128 v[120:123], v13 offset:1024
    ds_read_b128 v[124:127], v13 offset:2048
    ds_read_b128 v[128:131], v13 offset:3072
    ds_read_b128 v[132:135], v13 offset:4096
    ds_read_b128 v[136:139], v13 offset:5120
    ds_read_b128 v[140:143], v13 offset:6144
    ds_read_b128 v[144:147], v13 offset:7168
    s_waitcnt lgkmcnt(0)
    s_add_u32 s14, s14, 1
    s_cmp_lt_u32 s14, 64
    s_cbranch_scc1 chain2_kernel_p2_step
    s_branch chain2_kernel_end
chain2_kernel_p3_start:
    v_lshrrev_b32 v16, 4, v0
    v_and_b32 v17, 15, v0
    v_and_b32 v18, 1, v16
    v_lshlrev_b32 v18, 2, v18
    v_lshrrev_b32 v19, 1, v16
    v_lshl_add_u32 v18, v19, 1, v18
    v_mul_u32_u24 v18, 400, v18
    v_lshl_add_u32 v18, v17, 1, v18
    v_add_u32 v3, 133408, v18
    v_and_b32 v18, 7, v0
    v_mul_u32_u24 v18, 400, v18
    v_lshrrev_b32 v19, 3, v0
    v_lshl_add_u32 v18, v19, 4, v18
    v_add_u32 v4, 133120, v18
    v_and_b32 v18, 7, v0
    v_mul_u32_u24 v18, 400, v18
    v_lshl_add_u32 v18, v16, 5, v18
    v_add_u32 v5, 136320, v18
    v_lshrrev_b32 v18, 1, v16
    v_lshlrev_b32 v18, 10, v18
    v_and_b32 v19, 31, v0
    v_lshl_add_u32 v18, v19, 4, v18
    v_add_u32 v6, 139532, v18
    v_add_u32 v15, 142592, v1
    v_lshrrev_b32 v18, 1, v16
    v_lshlrev_b32 v18, 1, v18
    v_lshrrev_b32 v19, 3, v17
    v_add3_u32 v18, v18, v19, 1
    v_lshrrev_b32 v19, 1, v18
    v_lshlrev_b32 v19, 14, v19
    v_and_b32 v18, 1, v18
    v_lshl_add_u32 v18, v18, 12, v19
    v_and_b32 v19, 1, v16
    v_lshlrev_b32 v19, 4, v19
    v_add_u32 v19, 96, v19
    s_lshl_b32 s20, s12, 7
    v_add_u32 v8, s20, v19
    v_add_u32 v7, v8, v18
    v_lshlrev_b32 v18, 4, v17
    v_lshl_add_u32 v18, v16, 10, v18
    v_add_u32 v9, 256, v18
    v_add_u32 v18, 192, v0
    v_mul_u32_u24 v19, 2731, v18
    v_lshrrev_b32 v19, 16, v19
    v_mul_u32_u24 v20, 24, v19
    v_sub_u32 v20, v18, v20
    v_mul_u32_u24 v21, 400, v19
    v_lshl_add_u32 v21, v20, 4, v21
    v_add_u32 v10, 136320, v21
    v_lshlrev_b32 v21, 4, v19
    v_lshl_add_u32 v11, v20, 7, v21
    v_and_b32 v18, 0x28, v0
    v_cmp_eq_u32 vcc, 0, v18
    v_mov_b32 v18, 1.0
    v_mov_b32 v19, 0
    v_cndmask_b32 v12, v19, v18, vcc
    v_add_u32 v13, 92160, v1
    v_add_u32 v14, 122880, v1
    s_mul_i32 s44, s12, 12288
    s_add_u32 s44, s44, 53477376
    s_mul_i32 s45, s12, 3072
    s_add_u32 s45, s45, 208666624
    s_mul_i32 s20, s12, 491520
    s_add_u32 s20, s20, 11902976
    s_add_u32 s21, s20, 2048
    buffer_load_dwordx4 v[16:19], v1, s[8:11], s21 offen offset:0
    buffer_load_dwordx4 v[20:23], v1, s[8:11], s21 offen offset:1024
    s_add_u32 s21, s20, 43008
    buffer_load_dwordx4 v[24:27], v1, s[8:11], s21 offen offset:0
    buffer_load_dwordx4 v[28:31], v1, s[8:11], s21 offen offset:1024
    s_add_u32 s21, s20, 24576
    buffer_load_dwordx4 v[32:35], v1, s[8:11], s21 offen offset:0
    buffer_load_dwordx4 v[36:39], v1, s[8:11], s21 offen offset:1024
    s_add_u32 s21, s20, 6144
    buffer_load_dwordx4 v[40:43], v1, s[8:11], s21 offen offset:0
    buffer_load_dwordx4 v[44:47], v1, s[8:11], s21 offen offset:1024
    s_add_u32 s21, s20, 47104
    buffer_load_dwordx4 v[48:51], v1, s[8:11], s21 offen offset:0
    buffer_load_dwordx4 v[52:55], v1, s[8:11], s21 offen offset:1024
    s_add_u32 s21, s20, 28672
    buffer_load_dwordx4 v[56:59], v1, s[8:11], s21 offen offset:0
    buffer_load_dwordx4 v[60:63], v1, s[8:11], s21 offen offset:1024
    s_add_u32 s21, s20, 10240
    buffer_load_dwordx4 v[64:67], v1, s[8:11], s21 offen offset:0
    buffer_load_dwordx4 v[68:71], v1, s[8:11], s21 offen offset:1024
    s_add_u32 s21, s20, 51200
    buffer_load_dwordx4 v[72:75], v1, s[8:11], s21 offen offset:0
    buffer_load_dwordx4 v[76:79], v1, s[8:11], s21 offen offset:1024
    s_add_u32 s21, s20, 32768
    buffer_load_dwordx4 v[80:83], v1, s[8:11], s21 offen offset:0
    buffer_load_dwordx4 v[84:87], v1, s[8:11], s21 offen offset:1024
    s_add_u32 s21, s20, 14336
    buffer_load_dwordx4 v[88:91], v1, s[8:11], s21 offen offset:0
    buffer_load_dwordx4 v[92:95], v1, s[8:11], s21 offen offset:1024
    s_add_u32 s21, s20, 55296
    buffer_load_dwordx4 v[96:99], v1, s[8:11], s21 offen offset:0
    buffer_load_dwordx4 v[100:103], v1, s[8:11], s21 offen offset:1024
    s_add_u32 s21, s20, 90112
    buffer_load_dwordx4 v[104:107], v1, s[8:11], s21 offen offset:0
    buffer_load_dwordx4 v[108:111], v1, s[8:11], s21 offen offset:1024
    s_add_u32 s21, s20, 98304
    buffer_load_dwordx4 v[112:115], v1, s[8:11], s21 offen offset:0
    buffer_load_dwordx4 v[116:119], v1, s[8:11], s21 offen offset:1024
    s_add_u32 s21, s20, 106496
    buffer_load_dwordx4 v[120:123], v1, s[8:11], s21 offen offset:0
    buffer_load_dwordx4 v[124:127], v1, s[8:11], s21 offen offset:1024
    s_add_u32 s21, s20, 114688
    buffer_load_dwordx4 v[128:131], v1, s[8:11], s21 offen offset:0
    buffer_load_dwordx4 v[132:135], v1, s[8:11], s21 offen offset:1024
    s_add_u32 s21, s20, 16384
    buffer_load_dwordx4 a[0:3], v1, s[8:11], s21 offen offset:0
    buffer_load_dwordx4 a[4:7], v1, s[8:11], s21 offen offset:1024
    s_add_u32 s21, s20, 36864
    buffer_load_dwordx4 a[8:11], v1, s[8:11], s21 offen offset:0
    buffer_load_dwordx4 a[12:15], v1, s[8:11], s21 offen offset:1024
    s_add_u32 s21, s20, 57344
    buffer_load_dwordx4 a[16:19], v1, s[8:11], s21 offen offset:0
    buffer_load_dwordx4 a[20:23], v1, s[8:11], s21 offen offset:1024
    s_add_u32 s21, s20, 18432
    buffer_load_dwordx4 a[24:27], v1, s[8:11], s21 offen offset:0
    buffer_load_dwordx4 a[28:31], v1, s[8:11], s21 offen offset:1024
    s_add_u32 s21, s20, 38912
    buffer_load_dwordx4 a[32:35], v1, s[8:11], s21 offen offset:0
    buffer_load_dwordx4 a[36:39], v1, s[8:11], s21 offen offset:1024
    s_add_u32 s21, s20, 59392
    buffer_load_dwordx4 a[40:43], v1, s[8:11], s21 offen offset:0
    buffer_load_dwordx4 a[44:47], v1, s[8:11], s21 offen offset:1024
    s_add_u32 s21, s20, 0
    buffer_load_dwordx4 a[48:51], v1, s[8:11], s21 offen offset:0
    buffer_load_dwordx4 a[52:55], v1, s[8:11], s21 offen offset:1024
    s_add_u32 s21, s20, 20480
    buffer_load_dwordx4 a[56:59], v1, s[8:11], s21 offen offset:0
    buffer_load_dwordx4 a[60:63], v1, s[8:11], s21 offen offset:1024
    s_add_u32 s21, s20, 40960
    buffer_load_dwordx4 a[64:67], v1, s[8:11], s21 offen offset:0
    buffer_load_dwordx4 a[68:71], v1, s[8:11], s21 offen offset:1024
    s_add_u32 s21, s20, 22528
    buffer_load_dwordx4 a[72:75], v1, s[8:11], s21 offen offset:0
    buffer_load_dwordx4 a[76:79], v1, s[8:11], s21 offen offset:1024
    s_add_u32 s21, s20, 4096
    buffer_load_dwordx4 a[80:83], v1, s[8:11], s21 offen offset:0
    buffer_load_dwordx4 a[84:87], v1, s[8:11], s21 offen offset:1024
    s_add_u32 s21, s20, 45056
    buffer_load_dwordx4 a[88:91], v1, s[8:11], s21 offen offset:0
    buffer_load_dwordx4 a[92:95], v1, s[8:11], s21 offen offset:1024
    s_add_u32 s21, s20, 26624
    buffer_load_dwordx4 a[96:99], v1, s[8:11], s21 offen offset:0
    buffer_load_dwordx4 a[100:103], v1, s[8:11], s21 offen offset:1024
    s_add_u32 s21, s20, 8192
    buffer_load_dwordx4 a[104:107], v1, s[8:11], s21 offen offset:0
    buffer_load_dwordx4 a[108:111], v1, s[8:11], s21 offen offset:1024
    s_add_u32 s21, s20, 49152
    buffer_load_dwordx4 a[112:115], v1, s[8:11], s21 offen offset:0
    buffer_load_dwordx4 a[116:119], v1, s[8:11], s21 offen offset:1024
    s_add_u32 s21, s20, 30720
    buffer_load_dwordx4 a[120:123], v1, s[8:11], s21 offen offset:0
    buffer_load_dwordx4 a[124:127], v1, s[8:11], s21 offen offset:1024
    s_waitcnt vmcnt(32)
    ds_write_b128 v13, v[16:19] offset:0
    ds_write_b128 v13, v[20:23] offset:1024
    ds_write_b128 v13, v[24:27] offset:2048
    ds_write_b128 v13, v[28:31] offset:3072
    ds_write_b128 v13, v[32:35] offset:4096
    ds_write_b128 v13, v[36:39] offset:5120
    ds_write_b128 v13, v[40:43] offset:6144
    ds_write_b128 v13, v[44:47] offset:7168
    ds_write_b128 v13, v[48:51] offset:8192
    ds_write_b128 v13, v[52:55] offset:9216
    ds_write_b128 v13, v[56:59] offset:10240
    ds_write_b128 v13, v[60:63] offset:11264
    ds_write_b128 v13, v[64:67] offset:12288
    ds_write_b128 v13, v[68:71] offset:13312
    ds_write_b128 v13, v[72:75] offset:14336
    ds_write_b128 v13, v[76:79] offset:15360
    ds_write_b128 v13, v[80:83] offset:16384
    ds_write_b128 v13, v[84:87] offset:17408
    ds_write_b128 v13, v[88:91] offset:18432
    ds_write_b128 v13, v[92:95] offset:19456
    ds_write_b128 v13, v[96:99] offset:20480
    ds_write_b128 v13, v[100:103] offset:21504
    ds_write_b128 v13, v[104:107] offset:22528
    ds_write_b128 v13, v[108:111] offset:23552
    ds_write_b128 v13, v[112:115] offset:24576
    ds_write_b128 v13, v[116:119] offset:25600
    ds_write_b128 v13, v[120:123] offset:26624
    ds_write_b128 v13, v[124:127] offset:27648
    ds_write_b128 v13, v[128:131] offset:28672
    ds_write_b128 v13, v[132:135] offset:29696
    s_add_u32 s21, s20, 12288
    buffer_load_dwordx4 a[128:131], v1, s[8:11], s21 offen offset:0
    buffer_load_dwordx4 a[132:135], v1, s[8:11], s21 offen offset:1024
    s_add_u32 s21, s20, 53248
    buffer_load_dwordx4 a[136:139], v1, s[8:11], s21 offen offset:0
    buffer_load_dwordx4 a[140:143], v1, s[8:11], s21 offen offset:1024
    s_add_u32 s21, s20, 34816
    buffer_load_dwordx4 a[144:147], v1, s[8:11], s21 offen offset:0
    buffer_load_dwordx4 a[148:151], v1, s[8:11], s21 offen offset:1024
    s_add_u32 s21, s20, 61440
    buffer_load_dwordx4 a[152:155], v1, s[8:11], s21 offen offset:0
    buffer_load_dwordx4 a[156:159], v1, s[8:11], s21 offen offset:1024
    s_add_u32 s21, s20, 63488
    buffer_load_dwordx4 a[160:163], v1, s[8:11], s21 offen offset:0
    buffer_load_dwordx4 a[164:167], v1, s[8:11], s21 offen offset:1024
    s_add_u32 s21, s20, 65536
    buffer_load_dwordx4 a[168:171], v1, s[8:11], s21 offen offset:0
    buffer_load_dwordx4 a[172:175], v1, s[8:11], s21 offen offset:1024
    s_add_u32 s21, s20, 67584
    buffer_load_dwordx4 a[176:179], v1, s[8:11], s21 offen offset:0
    buffer_load_dwordx4 a[180:183], v1, s[8:11], s21 offen offset:1024
    s_add_u32 s21, s20, 69632
    buffer_load_dwordx4 a[184:187], v1, s[8:11], s21 offen offset:0
    buffer_load_dwordx4 a[188:191], v1, s[8:11], s21 offen offset:1024
    s_add_u32 s21, s20, 71680
    buffer_load_dwordx4 a[192:195], v1, s[8:11], s21 offen offset:0
    buffer_load_dwordx4 a[196:199], v1, s[8:11], s21 offen offset:1024
    s_add_u32 s21, s20, 73728
    buffer_load_dwordx4 a[200:203], v1, s[8:11], s21 offen offset:0
    buffer_load_dwordx4 a[204:207], v1, s[8:11], s21 offen offset:1024
    s_add_u32 s21, s20, 75776
    buffer_load_dwordx4 a[208:211], v1, s[8:11], s21 offen offset:0
    buffer_load_dwordx4 a[212:215], v1, s[8:11], s21 offen offset:1024
    s_add_u32 s21, s20, 77824
    buffer_load_dwordx4 a[216:219], v1, s[8:11], s21 offen offset:0
    buffer_load_dwordx4 a[220:223], v1, s[8:11], s21 offen offset:1024
    s_add_u32 s21, s20, 79872
    buffer_load_dwordx4 a[224:227], v1, s[8:11], s21 offen offset:0
    buffer_load_dwordx4 a[228:231], v1, s[8:11], s21 offen offset:1024
    s_add_u32 s21, s20, 81920
    buffer_load_dwordx4 a[232:235], v1, s[8:11], s21 offen offset:0
    buffer_load_dwordx4 a[236:239], v1, s[8:11], s21 offen offset:1024
    s_add_u32 s21, s20, 83968
    buffer_load_dwordx4 a[240:243], v1, s[8:11], s21 offen offset:0
    buffer_load_dwordx4 a[244:247], v1, s[8:11], s21 offen offset:1024
    s_add_u32 s21, s20, 86016
    buffer_load_dwordx4 a[248:251], v1, s[8:11], s21 offen offset:0
    buffer_load_dwordx4 a[252:255], v1, s[8:11], s21 offen offset:1024
    s_add_u32 s21, s20, 88064
    buffer_load_dwordx4 v[148:151], v1, s[8:11], s21 offen offset:0
    buffer_load_dwordx4 v[152:155], v1, s[8:11], s21 offen offset:1024
    s_add_u32 s21, s20, 92160
    buffer_load_dwordx4 v[156:159], v1, s[8:11], s21 offen offset:0
    buffer_load_dwordx4 v[160:163], v1, s[8:11], s21 offen offset:1024
    s_add_u32 s21, s20, 94208
    buffer_load_dwordx4 v[164:167], v1, s[8:11], s21 offen offset:0
    buffer_load_dwordx4 v[168:171], v1, s[8:11], s21 offen offset:1024
    s_add_u32 s21, s20, 96256
    buffer_load_dwordx4 v[172:175], v1, s[8:11], s21 offen offset:0
    buffer_load_dwordx4 v[176:179], v1, s[8:11], s21 offen offset:1024
    s_add_u32 s21, s20, 100352
    buffer_load_dwordx4 v[180:183], v1, s[8:11], s21 offen offset:0
    buffer_load_dwordx4 v[184:187], v1, s[8:11], s21 offen offset:1024
    s_add_u32 s21, s20, 102400
    buffer_load_dwordx4 v[188:191], v1, s[8:11], s21 offen offset:0
    buffer_load_dwordx4 v[192:195], v1, s[8:11], s21 offen offset:1024
    s_add_u32 s21, s20, 104448
    buffer_load_dwordx4 v[196:199], v1, s[8:11], s21 offen offset:0
    buffer_load_dwordx4 v[200:203], v1, s[8:11], s21 offen offset:1024
    s_add_u32 s21, s20, 108544
    buffer_load_dwordx4 v[204:207], v1, s[8:11], s21 offen offset:0
    buffer_load_dwordx4 v[208:211], v1, s[8:11], s21 offen offset:1024
    s_add_u32 s21, s20, 110592
    buffer_load_dwordx4 v[212:215], v1, s[8:11], s21 offen offset:0
    buffer_load_dwordx4 v[216:219], v1, s[8:11], s21 offen offset:1024
    s_add_u32 s21, s20, 112640
    buffer_load_dwordx4 v[220:223], v1, s[8:11], s21 offen offset:0
    buffer_load_dwordx4 v[224:227], v1, s[8:11], s21 offen offset:1024
    s_add_u32 s21, s20, 116736
    buffer_load_dwordx4 v[228:231], v1, s[8:11], s21 offen offset:0
    buffer_load_dwordx4 v[232:235], v1, s[8:11], s21 offen offset:1024
    s_add_u32 s21, s20, 118784
    buffer_load_dwordx4 v[236:239], v1, s[8:11], s21 offen offset:0
    buffer_load_dwordx4 v[240:243], v1, s[8:11], s21 offen offset:1024
    s_add_u32 s21, s20, 120832
    buffer_load_dwordx4 v[244:247], v1, s[8:11], s21 offen offset:0
    buffer_load_dwordx4 v[248:251], v1, s[8:11], s21 offen offset:1024
    s_waitcnt lgkmcnt(0)
    s_mov_b32 s14, 0
    s_mul_i32 s20, s14, 393216
    s_add_u32 s20, s20, s44
    s_add_u32 s21, s20, 8192
    buffer_load_dwordx4 v[100:103], v9, s[8:11], s21 offen offset:0
    buffer_load_dwordx4 v[104:107], v9, s[8:11], s21 offen offset:512
    v_mov_b32 v56, 0
    v_mov_b32 v57, 0
    v_mov_b32 v58, 0
    v_mov_b32 v59, 0
    v_mov_b32 v60, 0
    v_mov_b32 v61, 0
    v_mov_b32 v62, 0
    v_mov_b32 v63, 0
    v_mov_b32 v64, 0
    v_mov_b32 v65, 0
    v_mov_b32 v66, 0
    v_mov_b32 v67, 0
    v_mov_b32 v68, 0
    v_mov_b32 v69, 0
    v_mov_b32 v70, 0
    v_mov_b32 v71, 0
    v_mov_b32 v72, 0
    v_mov_b32 v73, 0
    v_mov_b32 v74, 0
    v_mov_b32 v75, 0
    v_mov_b32 v76, 0
    v_mov_b32 v77, 0
    v_mov_b32 v78, 0
    v_mov_b32 v79, 0
    v_mov_b32 v80, 0
    v_mov_b32 v81, 0
    v_mov_b32 v82, 0
    v_mov_b32 v83, 0
    v_mov_b32 v84, 0
    v_mov_b32 v85, 0
    v_mov_b32 v86, 0
    v_mov_b32 v87, 0
    ds_read_b128 v[116:119], v13 offset:0
    ds_read_b128 v[120:123], v13 offset:1024
    ds_read_b128 v[124:127], v13 offset:2048
    ds_read_b128 v[128:131], v13 offset:3072
    ds_read_b128 v[132:135], v13 offset:4096
    ds_read_b128 v[136:139], v13 offset:5120
    ds_read_b128 v[140:143], v13 offset:6144
    ds_read_b128 v[144:147], v13 offset:7168
    s_waitcnt lgkmcnt(0)
chain2_kernel_p3_step:
    s_cmp_lt_u32 s14, 32
    s_cselect_b32 s18, s16, s17
    s_and_b32 s20, s14, 31
    s_lshl_b32 s20, s20, 16
    s_add_u32 s18, s18, s20
    s_add_u32 s22, s18, 53248
    s_add_u32 s23, s18, 54272
chain2_kernel_p3_poll:
    buffer_load_dwordx4 v[48:51], v1, s[8:11], s22 offen sc1
    buffer_load_dwordx4 v[52:55], v1, s[8:11], s23 offen sc1
    s_waitcnt vmcnt(0)
    ds_write_b128 v14, v[48:51] offset:8192
    ds_write_b128 v14, v[52:55] offset:9216
    v_max3_u32 v88, v48, v49, v50
    v_max3_u32 v88, v88, v51, v52
    v_max3_u32 v88, v88, v53, v54
    v_max_u32 v88, v88, v55
    v_cmp_eq_u32 vcc, -1, v88
    s_sub_u32 s15, s15, 1
    s_cbranch_scc1 chain2_kernel_bail
    s_cbranch_vccnz chain2_kernel_p3_poll
    s_waitcnt lgkmcnt(0)
    s_barrier
    ds_read_b128 v[16:19], v14 offset:0
    ds_read_b128 v[20:23], v14 offset:1024
    ds_read_b128 v[24:27], v14 offset:2048
    ds_read_b128 v[28:31], v14 offset:3072
    ds_read_b128 v[32:35], v14 offset:4096
    ds_read_b128 v[36:39], v14 offset:5120
    ds_read_b128 v[40:43], v14 offset:6144
    ds_read_b128 v[44:47], v14 offset:7168
    v_smfmac_f32_16x16x64_bf16 v[56:59], v[48:51], a[0:7], v2
    v_smfmac_f32_16x16x64_bf16 v[60:63], v[48:51], a[8:15], v2
    v_smfmac_f32_16x16x64_bf16 v[64:67], v[48:51], a[16:23], v2
    v_smfmac_f32_16x16x64_bf16 v[56:59], v[52:55], a[24:31], v2
    v_smfmac_f32_16x16x64_bf16 v[60:63], v[52:55], a[32:39], v2
    v_smfmac_f32_16x16x64_bf16 v[64:67], v[52:55], a[40:47], v2
    s_waitcnt lgkmcnt(7)
    v_smfmac_f32_16x16x64_bf16 v[56:59], v[16:19], a[48:55], v2
    v_smfmac_f32_16x16x64_bf16 v[60:63], v[16:19], a[56:63], v2
    v_smfmac_f32_16x16x64_bf16 v[64:67], v[16:19], a[64:71], v2
    s_waitcnt lgkmcnt(6)
    v_smfmac_f32_16x16x64_bf16 v[56:59], v[20:23], v[116:123], v2
    ds_read_b128 v[116:119], v13 offset:8192
    ds_read_b128 v[120:123], v13 offset:9216
    v_smfmac_f32_16x16x64_bf16 v[60:63], v[20:23], a[72:79], v2
    v_smfmac_f32_16x16x64_bf16 v[64:67], v[20:23], v[124:131], v2
    ds_read_b128 v[124:127], v13 offset:10240
    ds_read_b128 v[128:131], v13 offset:11264
    s_waitcnt lgkmcnt(9)
    v_smfmac_f32_16x16x64_bf16 v[56:59], v[24:27], a[80:87], v2
    v_smfmac_f32_16x16x64_bf16 v[60:63], v[24:27], v[132:139], v2
    ds_read_b128 v[132:135], v13 offset:12288
    ds_read_b128 v[136:139], v13 offset:13312
    v_smfmac_f32_16x16x64_bf16 v[64:67], v[24:27], a[88:95], v2
    s_waitcnt lgkmcnt(10)
    v_smfmac_f32_16x16x64_bf16 v[56:59], v[28:31], v[140:147], v2
    ds_read_b128 v[140:143], v13 offset:14336
    ds_read_b128 v[144:147], v13 offset:15360
    v_smfmac_f32_16x16x64_bf16 v[60:63], v[28:31], a[96:103], v2
    s_waitcnt lgkmcnt(6)
    v_smfmac_f32_16x16x64_bf16 v[64:67], v[28:31], v[116:123], v2
    ds_read_b128 v[116:119], v13 offset:16384
    ds_read_b128 v[120:123], v13 offset:17408
    v_smfmac_f32_16x16x64_bf16 v[56:59], v[32:35], a[104:111], v2
    s_waitcnt lgkmcnt(6)
    v_smfmac_f32_16x16x64_bf16 v[60:63], v[32:35], v[124:131], v2
    ds_read_b128 v[124:127], v13 offset:18432
    ds_read_b128 v[128:131], v13 offset:19456
    v_smfmac_f32_16x16x64_bf16 v[64:67], v[32:35], a[112:119], v2
    s_waitcnt lgkmcnt(6)
    v_smfmac_f32_16x16x64_bf16 v[56:59], v[36:39], v[132:139], v2
    ds_read_b128 v[132:135], v13 offset:20480
    ds_read_b128 v[136:139], v13 offset:21504
    v_smfmac_f32_16x16x64_bf16 v[60:63], v[36:39], a[120:127], v2
    s_waitcnt lgkmcnt(6)
    v_smfmac_f32_16x16x64_bf16 v[64:67], v[36:39], v[140:147], v2
    ds_read_b128 v[140:143], v13 offset:22528
    ds_read_b128 v[144:147], v13 offset:23552
    v_smfmac_f32_16x16x64_bf16 v[56:59], v[40:43], a[128:135], v2
    s_waitcnt lgkmcnt(6)
    v_smfmac_f32_16x16x64_bf16 v[60:63], v[40:43], v[116:123], v2
    ds_read_b128 v[116:119], v13 offset:24576
    ds_read_b128 v[120:123], v13 offset:25600
    v_smfmac_f32_16x16x64_bf16 v[64:67], v[40:43], a[136:143], v2
    s_waitcnt lgkmcnt(6)
    v_smfmac_f32_16x16x64_bf16 v[56:59], v[44:47], v[124:131], v2
    ds_read_b128 v[124:127], v13 offset:26624
    ds_read_b128 v[128:131], v13 offset:27648
    v_smfmac_f32_16x16x64_bf16 v[60:63], v[44:47], a[144:151], v2
    s_waitcnt lgkmcnt(6)
    v_smfmac_f32_16x16x64_bf16 v[64:67], v[44:47], v[132:139], v2
    ds_read_b128 v[132:135], v13 offset:28672
    ds_read_b128 v[136:139], v13 offset:29696
    v_smfmac_f32_16x16x64_bf16 v[68:71], v[16:19], a[152:159], v2
    v_smfmac_f32_16x16x64_bf16 v[68:71], v[20:23], a[160:167], v2
    v_permlane32_swap_b32 v56, v58
    v_permlane32_swap_b32 v57, v59
    v_smfmac_f32_16x16x64_bf16 v[68:71], v[24:27], a[168:175], v2
    v_add_f32 v56, v56, v58
    v_add_f32 v57, v57, v59
    v_smfmac_f32_16x16x64_bf16 v[68:71], v[28:31], a[176:183], v2
    v_cvt_pk_bf16_f32 v56, v56, v57
    ds_write_b16 v3, v56 offset:0
    v_smfmac_f32_16x16x64_bf16 v[68:71], v[32:35], a[184:191], v2
    ds_write_b16_d16_hi v3, v56 offset:400
    v_permlane32_swap_b32 v60, v62
    v_smfmac_f32_16x16x64_bf16 v[68:71], v[36:39], a[192:199], v2
    v_permlane32_swap_b32 v61, v63
    v_add_f32 v60, v60, v62
    v_smfmac_f32_16x16x64_bf16 v[68:71], v[40:43], a[200:207], v2
    v_add_f32 v61, v61, v63
    v_cvt_pk_bf16_f32 v60, v60, v61
    v_smfmac_f32_16x16x64_bf16 v[68:71], v[44:47], a[208:215], v2
    ds_write_b16 v3, v60 offset:32
    ds_write_b16_d16_hi v3, v60 offset:432
    v_smfmac_f32_16x16x64_bf16 v[68:71], v[48:51], a[216:223], v2
    v_permlane32_swap_b32 v64, v66
    v_permlane32_swap_b32 v65, v67
    v_smfmac_f32_16x16x64_bf16 v[68:71], v[52:55], a[224:231], v2
    v_add_f32 v64, v64, v66
    v_add_f32 v65, v65, v67
    v_smfmac_f32_16x16x64_bf16 v[72:75], v[16:19], a[232:239], v2
    v_cvt_pk_bf16_f32 v64, v64, v65
    ds_write_b16 v3, v64 offset:64
    v_smfmac_f32_16x16x64_bf16 v[72:75], v[20:23], a[240:247], v2
    ds_write_b16_d16_hi v3, v64 offset:464
    v_smfmac_f32_16x16x64_bf16 v[72:75], v[24:27], a[248:255], v2
    v_smfmac_f32_16x16x64_bf16 v[72:75], v[28:31], v[148:155], v2
    s_waitcnt lgkmcnt(0)
    s_barrier
    ds_read_b128 v[88:91], v4 offset:0
    v_smfmac_f32_16x16x64_bf16 v[72:75], v[32:35], v[140:147], v2
    ds_read_b128 v[92:95], v4 offset:128
    ds_read_b128 v[96:99], v4 offset:256
    v_smfmac_f32_16x16x64_bf16 v[72:75], v[36:39], v[156:163], v2
    v_permlane32_swap_b32 v68, v70
    v_permlane32_swap_b32 v69, v71
    v_smfmac_f32_16x16x64_bf16 v[72:75], v[40:43], v[164:171], v2
    v_add_f32 v68, v68, v70
    v_add_f32 v69, v69, v71
    v_smfmac_f32_16x16x64_bf16 v[72:75], v[44:47], v[172:179], v2
    v_cvt_pk_bf16_f32 v68, v68, v69
    ds_write_b16 v3, v68 offset:3200
    v_smfmac_f32_16x16x64_bf16 v[72:75], v[48:51], v[116:123], v2
    ds_write_b16_d16_hi v3, v68 offset:3600
    v_smfmac_f32_16x16x64_bf16 v[72:75], v[52:55], v[180:187], v2
    s_waitcnt lgkmcnt(2)
    v_smfmac_f32_16x16x64_bf16 v[80:83], v[96:99], v[100:107], v2
    v_smfmac_f32_16x16x64_bf16 v[76:79], v[16:19], v[188:195], v2
    v_smfmac_f32_16x16x64_bf16 v[76:79], v[20:23], v[196:203], v2
    v_smfmac_f32_16x16x64_bf16 v[76:79], v[24:27], v[124:131], v2
    v_permlane32_swap_b32 v72, v74
    v_permlane32_swap_b32 v73, v75
    v_smfmac_f32_16x16x64_bf16 v[76:79], v[28:31], v[204:211], v2
    v_add_f32 v72, v72, v74
    v_add_f32 v73, v73, v75
    ds_write_b128 v15, v[80:83]
    v_smfmac_f32_16x16x64_bf16 v[76:79], v[32:35], v[212:219], v2
    v_cvt_pk_bf16_f32 v72, v72, v73
    ds_write_b16 v3, v72 offset:3232
    v_smfmac_f32_16x16x64_bf16 v[76:79], v[36:39], v[220:227], v2
    ds_write_b16_d16_hi v3, v72 offset:3632
    v_smfmac_f32_16x16x64_bf16 v[76:79], v[40:43], v[132:139], v2
    v_smfmac_f32_16x16x64_bf16 v[76:79], v[44:47], v[228:235], v2
    v_smfmac_f32_16x16x64_bf16 v[76:79], v[48:51], v[236:243], v2
    v_smfmac_f32_16x16x64_bf16 v[76:79], v[52:55], v[244:251], v2
    s_nop 7
    v_permlane32_swap_b32 v76, v78
    v_permlane32_swap_b32 v77, v79
    v_add_f32 v76, v76, v78
    v_add_f32 v77, v77, v79
    v_cvt_pk_bf16_f32 v76, v76, v77
    ds_write_b16 v3, v76 offset:3264
    ds_write_b16_d16_hi v3, v76 offset:3664
    s_waitcnt lgkmcnt(0)
    s_barrier
    ds_read2st64_b32 v[40:41], v6 offset0:0 offset1:2
    ds_read2st64_b32 v[42:43], v6 offset0:8 offset1:10
    ds_read_b128 v[16:19], v5 offset:0
    ds_read_b128 v[20:23], v5 offset:16
    ds_read_b128 v[24:27], v5 offset:128
    ds_read_b128 v[28:31], v5 offset:144
    ds_read_b128 v[32:35], v5 offset:256
    ds_read_b128 v[36:39], v5 offset:272
    s_waitcnt lgkmcnt(6)
    v_add_f32 v40, v40, v41
    v_add_f32 v42, v42, v43
    v_add_f32 v44, v40, v42
    v_mul_f32 v44, 0x3dd53b95, v44
    s_waitcnt lgkmcnt(4)
    v_smfmac_f32_16x16x64_bf16 v[84:87], v[88:91], v[16:23], v2
    s_waitcnt lgkmcnt(2)
    v_smfmac_f32_16x16x64_bf16 v[84:87], v[92:95], v[24:31], v2
    s_waitcnt lgkmcnt(0)
    v_smfmac_f32_16x16x64_bf16 v[84:87], v[96:99], v[32:39], v2
    v_max_f32_dpp v45, v44, v44 row_ror:8 row_mask:0xf bank_mask:0xf
    s_nop 1
    v_max_f32_dpp v45, v45, v45 row_ror:4 row_mask:0xf bank_mask:0xf
    s_nop 1
    v_max_f32_dpp v45, v45, v45 row_ror:2 row_mask:0xf bank_mask:0xf
    s_nop 1
    v_max_f32_dpp v45, v45, v45 row_ror:1 row_mask:0xf bank_mask:0xf
    v_mov_b32 v47, v45
    s_nop 1
    v_permlane32_swap_b32 v45, v47
    v_max_f32 v45, v45, v47
    v_mov_b32 v47, v87
    s_nop 1
    v_permlane32_swap_b32 v87, v47
    v_add_f32 v48, v87, v47
    v_mul_f32 v48, 0x3dd53b95, v48
    s_nop 1
    v_max_f32_dpp v46, v48, v48 row_ror:4 row_mask:0xf bank_mask:0xf
    s_nop 1
    v_max_f32_dpp v46, v46, v46 row_ror:2 row_mask:0xf bank_mask:0xf
    s_nop 1
    v_max_f32_dpp v46, v46, v46 row_ror:1 row_mask:0xf bank_mask:0xf
    v_max_f32 v45, v45, v46
    v_sub_f32 v49, v44, v45
    v_sub_f32 v50, v48, v45
    v_exp_f32 v49, v49
    v_exp_f32 v50, v50
    s_nop 0
    v_fma_f32 v51, v50, v12, v49
    s_nop 1
    v_add_f32_dpp v51, v51, v51 row_ror:8 row_mask:0xf bank_mask:0xf
    s_nop 1
    v_add_f32_dpp v51, v51, v51 row_ror:4 row_mask:0xf bank_mask:0xf
    s_nop 1
    v_add_f32_dpp v51, v51, v51 row_ror:2 row_mask:0xf bank_mask:0xf
    s_nop 1
    v_add_f32_dpp v51, v51, v51 row_ror:1 row_mask:0xf bank_mask:0xf
    v_mov_b32 v47, v51
    s_nop 1
    v_permlane32_swap_b32 v51, v47
    v_add_f32 v51, v51, v47
    v_rcp_f32 v51, v51
    s_nop 0
    v_mul_f32 v49, v49, v51
    v_mul_f32 v50, v50, v51
    s_nop 0
    v_mov_b32_dpp v46, v49 quad_perm:[1,0,3,2] row_mask:0xf bank_mask:0xf
    v_mov_b32_dpp v47, v50 quad_perm:[1,0,3,2] row_mask:0xf bank_mask:0xf
    v_cvt_pk_bf16_f32 v16, v49, v46
    v_cvt_pk_bf16_f32 v20, v50, v47
    s_nop 0
    v_mov_b32_dpp v17, v16 row_shl:2 row_mask:0xf bank_mask:0xf
    v_mov_b32_dpp v18, v16 row_shl:4 row_mask:0xf bank_mask:0xf
    v_mov_b32_dpp v19, v16 row_shl:6 row_mask:0xf bank_mask:0xf
    v_mov_b32_dpp v21, v20 row_shl:2 row_mask:0xf bank_mask:0xf
    v_mov_b32_dpp v22, v20 row_shl:4 row_mask:0xf bank_mask:0xf
    v_mov_b32_dpp v23, v20 row_shl:6 row_mask:0xf bank_mask:0xf
    s_mov_b64 exec, s[40:41]
    buffer_store_dwordx4 v[16:19], v7, s[8:11], s18 offen sc1
    s_mov_b64 exec, s[42:43]
    buffer_store_dwordx4 v[20:23], v8, s[8:11], s18 offen sc1
    s_mov_b64 exec, -1
    s_add_u32 s28, s14, 1
    s_min_u32 s28, s28, 63
    s_mul_i32 s20, s28, 393216
    s_add_u32 s20, s20, s44
    s_add_u32 s21, s20, 8192
    buffer_load_dwordx4 v[100:103], v9, s[8:11], s21 offen offset:0
    buffer_load_dwordx4 v[104:107], v9, s[8:11], s21 offen offset:512
    v_mov_b32 v56, 0
    v_mov_b32 v57, 0
    v_mov_b32 v58, 0
    v_mov_b32 v59, 0
    v_mov_b32 v60, 0
    v_mov_b32 v61, 0
    v_mov_b32 v62, 0
    v_mov_b32 v63, 0
    v_mov_b32 v64, 0
    v_mov_b32 v65, 0
    v_mov_b32 v66, 0
    v_mov_b32 v67, 0
    v_mov_b32 v68, 0
    v_mov_b32 v69, 0
    v_mov_b32 v70, 0
    v_mov_b32 v71, 0
    v_mov_b32 v72, 0
    v_mov_b32 v73, 0
    v_mov_b32 v74, 0
    v_mov_b32 v75, 0
    v_mov_b32 v76, 0
    v_mov_b32 v77, 0
    v_mov_b32 v78, 0
    v_mov_b32 v79, 0
    v_mov_b32 v80, 0
    v_mov_b32 v81, 0
    v_mov_b32 v82, 0
    v_mov_b32 v83, 0
    v_mov_b32 v84, 0
    v_mov_b32 v85, 0
    v_mov_b32 v86, 0
    v_mov_b32 v87, 0
    ds_read_b128 v[116:119], v13 offset:0
    ds_read_b128 v[120:123], v13 offset:1024
    ds_read_b128 v[124:127], v13 offset:2048
    ds_read_b128 v[128:131], v13 offset:3072
    ds_read_b128 v[132:135], v13 offset:4096
    ds_read_b128 v[136:139], v13 offset:5120
    ds_read_b128 v[140:143], v13 offset:6144
    ds_read_b128 v[144:147], v13 offset:7168
    s_waitcnt lgkmcnt(0)
    s_add_u32 s14, s14, 1
    s_cmp_lt_u32 s14, 64
    s_cbranch_scc1 chain2_kernel_p3_step
    s_branch chain2_kernel_end
chain2_kernel_y0_start:
    v_lshrrev_b32 v16, 4, v0
    v_and_b32 v17, 7, v0
    v_lshrrev_b32 v18, 3, v0
    v_and_b32 v18, 1, v18
    v_lshl_add_u32 v19, v18, 2, v16
    v_add_u32 v19, 0, v19
    v_mul_u32_u24 v20, 640, v19
    v_lshl_add_u32 v4, v17, 4, v20
    v_and_b32 v20, 3, v17
    v_lshlrev_b32 v20, 1, v20
    v_lshrrev_b32 v21, 2, v17
    v_add_u32 v20, v20, v21
    v_lshlrev_b32 v20, 4, v20
    v_lshl_add_u32 v5, v19, 7, v20
    v_add_u32 v3, 0, v1
    v_lshlrev_b32 v20, 8, v18
    v_lshl_add_u32 v20, v17, 5, v20
    v_and_b32 v21, 1, v16
    v_lshl_add_u32 v20, v21, 4, v20
    v_add_u32 v20, 10240, v20
    v_add_u32 v21, 12288, v1
    v_lshrrev_b32 v22, 1, v16
    v_cmp_eq_u32 vcc, v22, v18
    s_nop 1
    v_cndmask_b32 v6, v21, v20, vcc
    v_lshrrev_b32 v20, 3, v0
    v_lshlrev_b32 v20, 2, v20
    v_lshl_add_u32 v20, v17, 5, v20
    v_add_u32 v7, 10240, v20
    s_lshl_b32 s20, s12, 7
    s_add_u32 s20, s20, 20480
    s_lshr_b32 s21, s20, 13
    s_lshl_b32 s21, s21, 14
    s_and_b32 s20, s20, 8191
    s_add_u32 s20, s20, s21
    v_lshrrev_b32 v20, 3, v0
    v_lshlrev_b32 v20, 4, v20
    v_add_u32 v8, s20, v20
    s_mul_i32 s46, s12, 20480
    s_add_u32 s46, s46, 103809024
    s_mul_i32 s20, s12, 327680
    s_add_u32 s20, s20, 27262976
    s_add_u32 s21, s20, 0
    buffer_load_dwordx4 a[0:3], v1, s[8:11], s21 offen offset:0
    buffer_load_dwordx4 a[4:7], v1, s[8:11], s21 offen offset:1024
    s_add_u32 s21, s20, 2048
    buffer_load_dwordx4 a[8:11], v1, s[8:11], s21 offen offset:0
    buffer_load_dwordx4 a[12:15], v1, s[8:11], s21 offen offset:1024
    s_add_u32 s21, s20, 4096
    buffer_load_dwordx4 a[16:19], v1, s[8:11], s21 offen offset:0
    buffer_load_dwordx4 a[20:23], v1, s[8:11], s21 offen offset:1024
    s_add_u32 s21, s20, 6144
    buffer_load_dwordx4 a[24:27], v1, s[8:11], s21 offen offset:0
    buffer_load_dwordx4 a[28:31], v1, s[8:11], s21 offen offset:1024
    s_add_u32 s21, s20, 8192
    buffer_load_dwordx4 a[32:35], v1, s[8:11], s21 offen offset:0
    buffer_load_dwordx4 a[36:39], v1, s[8:11], s21 offen offset:1024
    s_add_u32 s21, s20, 10240
    buffer_load_dwordx4 a[40:43], v1, s[8:11], s21 offen offset:0
    buffer_load_dwordx4 a[44:47], v1, s[8:11], s21 offen offset:1024
    s_add_u32 s21, s20, 12288
    buffer_load_dwordx4 a[48:51], v1, s[8:11], s21 offen offset:0
    buffer_load_dwordx4 a[52:55], v1, s[8:11], s21 offen offset:1024
    s_add_u32 s21, s20, 14336
    buffer_load_dwordx4 a[56:59], v1, s[8:11], s21 offen offset:0
    buffer_load_dwordx4 a[60:63], v1, s[8:11], s21 offen offset:1024
    s_add_u32 s21, s20, 16384
    buffer_load_dwordx4 a[64:67], v1, s[8:11], s21 offen offset:0
    buffer_load_dwordx4 a[68:71], v1, s[8:11], s21 offen offset:1024
    s_add_u32 s21, s20, 18432
    buffer_load_dwordx4 a[72:75], v1, s[8:11], s21 offen offset:0
    buffer_load_dwordx4 a[76:79], v1, s[8:11], s21 offen offset:1024
    s_add_u32 s21, s20, 20480
    buffer_load_dwordx4 a[80:83], v1, s[8:11], s21 offen offset:0
    buffer_load_dwordx4 a[84:87], v1, s[8:11], s21 offen offset:1024
    s_add_u32 s21, s20, 22528
    buffer_load_dwordx4 a[88:91], v1, s[8:11], s21 offen offset:0
    buffer_load_dwordx4 a[92:95], v1, s[8:11], s21 offen offset:1024
    s_add_u32 s21, s20, 24576
    buffer_load_dwordx4 a[96:99], v1, s[8:11], s21 offen offset:0
    buffer_load_dwordx4 a[100:103], v1, s[8:11], s21 offen offset:1024
    s_add_u32 s21, s20, 26624
    buffer_load_dwordx4 a[104:107], v1, s[8:11], s21 offen offset:0
    buffer_load_dwordx4 a[108:111], v1, s[8:11], s21 offen offset:1024
    s_add_u32 s21, s20, 28672
    buffer_load_dwordx4 a[112:115], v1, s[8:11], s21 offen offset:0
    buffer_load_dwordx4 a[116:119], v1, s[8:11], s21 offen offset:1024
    s_add_u32 s21, s20, 30720
    buffer_load_dwordx4 a[120:123], v1, s[8:11], s21 offen offset:0
    buffer_load_dwordx4 a[124:127], v1, s[8:11], s21 offen offset:1024
    s_add_u32 s21, s20, 32768
    buffer_load_dwordx4 a[128:131], v1, s[8:11], s21 offen offset:0
    buffer_load_dwordx4 a[132:135], v1, s[8:11], s21 offen offset:1024
    s_add_u32 s21, s20, 34816
    buffer_load_dwordx4 a[136:139], v1, s[8:11], s21 offen offset:0
    buffer_load_dwordx4 a[140:143], v1, s[8:11], s21 offen offset:1024
    s_add_u32 s21, s20, 36864
    buffer_load_dwordx4 a[144:147], v1, s[8:11], s21 offen offset:0
    buffer_load_dwordx4 a[148:151], v1, s[8:11], s21 offen offset:1024
    s_add_u32 s21, s20, 38912
    buffer_load_dwordx4 a[152:155], v1, s[8:11], s21 offen offset:0
    buffer_load_dwordx4 a[156:159], v1, s[8:11], s21 offen offset:1024
    s_add_u32 s21, s20, 40960
    buffer_load_dwordx4 a[160:163], v1, s[8:11], s21 offen offset:0
    buffer_load_dwordx4 a[164:167], v1, s[8:11], s21 offen offset:1024
    s_add_u32 s21, s20, 43008
    buffer_load_dwordx4 a[168:171], v1, s[8:11], s21 offen offset:0
    buffer_load_dwordx4 a[172:175], v1, s[8:11], s21 offen offset:1024
    s_add_u32 s21, s20, 45056
    buffer_load_dwordx4 a[176:179], v1, s[8:11], s21 offen offset:0
    buffer_load_dwordx4 a[180:183], v1, s[8:11], s21 offen offset:1024
    s_add_u32 s21, s20, 47104
    buffer_load_dwordx4 a[184:187], v1, s[8:11], s21 offen offset:0
    buffer_load_dwordx4 a[188:191], v1, s[8:11], s21 offen offset:1024
    s_add_u32 s21, s20, 49152
    buffer_load_dwordx4 a[192:195], v1, s[8:11], s21 offen offset:0
    buffer_load_dwordx4 a[196:199], v1, s[8:11], s21 offen offset:1024
    s_add_u32 s21, s20, 51200
    buffer_load_dwordx4 a[200:203], v1, s[8:11], s21 offen offset:0
    buffer_load_dwordx4 a[204:207], v1, s[8:11], s21 offen offset:1024
    s_add_u32 s21, s20, 53248
    buffer_load_dwordx4 a[208:211], v1, s[8:11], s21 offen offset:0
    buffer_load_dwordx4 a[212:215], v1, s[8:11], s21 offen offset:1024
    s_add_u32 s21, s20, 55296
    buffer_load_dwordx4 a[216:219], v1, s[8:11], s21 offen offset:0
    buffer_load_dwordx4 a[220:223], v1, s[8:11], s21 offen offset:1024
    s_add_u32 s21, s20, 57344
    buffer_load_dwordx4 a[224:227], v1, s[8:11], s21 offen offset:0
    buffer_load_dwordx4 a[228:231], v1, s[8:11], s21 offen offset:1024
    s_add_u32 s21, s20, 59392
    buffer_load_dwordx4 a[232:235], v1, s[8:11], s21 offen offset:0
    buffer_load_dwordx4 a[236:239], v1, s[8:11], s21 offen offset:1024
    s_add_u32 s21, s20, 61440
    buffer_load_dwordx4 a[240:243], v1, s[8:11], s21 offen offset:0
    buffer_load_dwordx4 a[244:247], v1, s[8:11], s21 offen offset:1024
    s_add_u32 s21, s20, 63488
    buffer_load_dwordx4 a[248:251], v1, s[8:11], s21 offen offset:0
    buffer_load_dwordx4 a[252:255], v1, s[8:11], s21 offen offset:1024
    s_add_u32 s21, s20, 65536
    buffer_load_dwordx4 v[176:179], v1, s[8:11], s21 offen offset:0
    buffer_load_dwordx4 v[180:183], v1, s[8:11], s21 offen offset:1024
    s_add_u32 s21, s20, 67584
    buffer_load_dwordx4 v[184:187], v1, s[8:11], s21 offen offset:0
    buffer_load_dwordx4 v[188:191], v1, s[8:11], s21 offen offset:1024
    s_add_u32 s21, s20, 69632
    buffer_load_dwordx4 v[192:195], v1, s[8:11], s21 offen offset:0
    buffer_load_dwordx4 v[196:199], v1, s[8:11], s21 offen offset:1024
    s_add_u32 s21, s20, 71680
    buffer_load_dwordx4 v[200:203], v1, s[8:11], s21 offen offset:0
    buffer_load_dwordx4 v[204:207], v1, s[8:11], s21 offen offset:1024
    s_add_u32 s21, s20, 73728
    buffer_load_dwordx4 v[208:211], v1, s[8:11], s21 offen offset:0
    buffer_load_dwordx4 v[212:215], v1, s[8:11], s21 offen offset:1024
    s_add_u32 s21, s20, 75776
    buffer_load_dwordx4 v[216:219], v1, s[8:11], s21 offen offset:0
    buffer_load_dwordx4 v[220:223], v1, s[8:11], s21 offen offset:1024
    s_add_u32 s21, s20, 77824
    buffer_load_dwordx4 v[224:227], v1, s[8:11], s21 offen offset:0
    buffer_load_dwordx4 v[228:231], v1, s[8:11], s21 offen offset:1024
    s_add_u32 s21, s20, 79872
    buffer_load_dwordx4 v[232:235], v1, s[8:11], s21 offen offset:0
    buffer_load_dwordx4 v[236:239], v1, s[8:11], s21 offen offset:1024
    s_mov_b32 s14, 0
chain2_kernel_y0_step:
    s_cmp_lt_u32 s14, 32
    s_cselect_b32 s18, s16, s17
    s_and_b32 s20, s14, 31
    s_lshl_b32 s20, s20, 16
    s_add_u32 s18, s18, s20
    s_mul_i32 s28, s14, 1638400
    s_add_u32 s28, s28, s46
    buffer_load_dwordx4 v[76:79], v4, s[8:11], s28 offen offset:128
    buffer_load_dwordx4 v[80:83], v4, s[8:11], s28 offen offset:256
    buffer_load_dwordx4 v[84:87], v4, s[8:11], s28 offen offset:384
    buffer_load_dwordx4 v[88:91], v4, s[8:11], s28 offen offset:512
    v_mov_b32 v56, 0
    v_mov_b32 v57, 0
    v_mov_b32 v58, 0
    v_mov_b32 v59, 0
    v_mov_b32 v60, 0
    v_mov_b32 v61, 0
    v_mov_b32 v62, 0
    v_mov_b32 v63, 0
    v_mov_b32 v64, 0
    v_mov_b32 v65, 0
    v_mov_b32 v66, 0
    v_mov_b32 v67, 0
    v_mov_b32 v68, 0
    v_mov_b32 v69, 0
    v_mov_b32 v70, 0
    v_mov_b32 v71, 0
    s_add_u32 s22, s18, 36864
    s_add_u32 s23, s18, 37888
    s_add_u32 s24, s18, 38912
chain2_kernel_y0_poll:
    buffer_load_dwordx4 v[16:19], v1, s[8:11], s22 offen sc1
    buffer_load_dwordx4 v[20:23], v1, s[8:11], s23 offen sc1
    buffer_load_dwordx4 v[24:27], v1, s[8:11], s24 offen sc1
    s_waitcnt vmcnt(0)
    ds_write_b128 v3, v[16:19] offset:0
    ds_write_b128 v3, v[20:23] offset:1024
    ds_write_b128 v3, v[24:27] offset:2048
    v_max3_u32 v116, v16, v17, v18
    v_max3_u32 v116, v116, v19, v20
    v_max3_u32 v116, v116, v21, v22
    v_max3_u32 v116, v116, v23, v24
    v_max3_u32 v116, v116, v25, v26
    v_max_u32 v116, v116, v27
    v_cmp_eq_u32 vcc, -1, v116
    s_sub_u32 s15, s15, 1
    s_cbranch_scc1 chain2_kernel_bail
    s_cbranch_vccnz chain2_kernel_y0_poll
    s_waitcnt lgkmcnt(0)
    s_barrier
    ds_read_b128 v[28:31], v3 offset:3072
    ds_read_b128 v[32:35], v3 offset:4096
    ds_read_b128 v[36:39], v3 offset:5120
    ds_read_b128 v[40:43], v3 offset:6144
    ds_read_b128 v[44:47], v3 offset:7168
    ds_read_b128 v[48:51], v3 offset:8192
    ds_read_b128 v[52:55], v3 offset:9216
    v_smfmac_f32_16x16x64_bf16 v[56:59], v[16:19], a[0:7], v2
    v_smfmac_f32_16x16x64_bf16 v[60:63], v[16:19], a[80:87], v2
    v_smfmac_f32_16x16x64_bf16 v[64:67], v[16:19], a[160:167], v2
    v_smfmac_f32_16x16x64_bf16 v[68:71], v[16:19], a[240:247], v2
    v_smfmac_f32_16x16x64_bf16 v[56:59], v[20:23], a[8:15], v2
    v_smfmac_f32_16x16x64_bf16 v[60:63], v[20:23], a[88:95], v2
    v_smfmac_f32_16x16x64_bf16 v[64:67], v[20:23], a[168:175], v2
    v_smfmac_f32_16x16x64_bf16 v[68:71], v[20:23], a[248:255], v2
    v_smfmac_f32_16x16x64_bf16 v[56:59], v[24:27], a[16:23], v2
    v_smfmac_f32_16x16x64_bf16 v[60:63], v[24:27], a[96:103], v2
    v_smfmac_f32_16x16x64_bf16 v[64:67], v[24:27], a[176:183], v2
    v_smfmac_f32_16x16x64_bf16 v[68:71], v[24:27], v[176:183], v2
    s_waitcnt lgkmcnt(6)
    v_smfmac_f32_16x16x64_bf16 v[56:59], v[28:31], a[24:31], v2
    v_smfmac_f32_16x16x64_bf16 v[60:63], v[28:31], a[104:111], v2
    v_smfmac_f32_16x16x64_bf16 v[64:67], v[28:31], a[184:191], v2
    v_smfmac_f32_16x16x64_bf16 v[68:71], v[28:31], v[184:191], v2
    s_waitcnt lgkmcnt(5)
    v_smfmac_f32_16x16x64_bf16 v[56:59], v[32:35], a[32:39], v2
    v_smfmac_f32_16x16x64_bf16 v[60:63], v[32:35], a[112:119], v2
    v_smfmac_f32_16x16x64_bf16 v[64:67], v[32:35], a[192:199], v2
    v_smfmac_f32_16x16x64_bf16 v[68:71], v[32:35], v[192:199], v2
    s_waitcnt lgkmcnt(4)
    v_smfmac_f32_16x16x64_bf16 v[56:59], v[36:39], a[40:47], v2
    v_smfmac_f32_16x16x64_bf16 v[60:63], v[36:39], a[120:127], v2
    v_smfmac_f32_16x16x64_bf16 v[64:67], v[36:39], a[200:207], v2
    v_smfmac_f32_16x16x64_bf16 v[68:71], v[36:39], v[200:207], v2
    s_waitcnt lgkmcnt(3)
    v_smfmac_f32_16x16x64_bf16 v[56:59], v[40:43], a[48:55], v2
    v_smfmac_f32_16x16x64_bf16 v[60:63], v[40:43], a[128:135], v2
    v_smfmac_f32_16x16x64_bf16 v[64:67], v[40:43], a[208:215], v2
    v_smfmac_f32_16x16x64_bf16 v[68:71], v[40:43], v[208:215], v2
    s_waitcnt lgkmcnt(2)
    v_smfmac_f32_16x16x64_bf16 v[56:59], v[44:47], a[56:63], v2
    v_smfmac_f32_16x16x64_bf16 v[60:63], v[44:47], a[136:143], v2
    v_smfmac_f32_16x16x64_bf16 v[64:67], v[44:47], a[216:223], v2
    v_smfmac_f32_16x16x64_bf16 v[68:71], v[44:47], v[216:223], v2
    s_waitcnt lgkmcnt(1)
    v_smfmac_f32_16x16x64_bf16 v[56:59], v[48:51], a[64:71], v2
    v_smfmac_f32_16x16x64_bf16 v[60:63], v[48:51], a[144:151], v2
    v_smfmac_f32_16x16x64_bf16 v[64:67], v[48:51], a[224:231], v2
    v_smfmac_f32_16x16x64_bf16 v[68:71], v[48:51], v[224:231], v2
    s_waitcnt lgkmcnt(0)
    v_smfmac_f32_16x16x64_bf16 v[56:59], v[52:55], a[72:79], v2
    v_smfmac_f32_16x16x64_bf16 v[60:63], v[52:55], a[152:159], v2
    v_smfmac_f32_16x16x64_bf16 v[64:67], v[52:55], a[232:239], v2
    v_smfmac_f32_16x16x64_bf16 v[68:71], v[52:55], v[232:239], v2
    s_nop 7
    v_permlane32_swap_b32 v56, v64
    v_permlane32_swap_b32 v60, v68
    v_permlane32_swap_b32 v57, v65
    v_permlane32_swap_b32 v61, v69
    v_permlane32_swap_b32 v58, v66
    v_permlane32_swap_b32 v62, v70
    v_permlane32_swap_b32 v59, v67
    v_permlane32_swap_b32 v63, v71
    v_add_f32 v56, v56, v64
    v_add_f32 v60, v60, v68
    v_add_f32 v57, v57, v65
    v_add_f32 v61, v61, v69
    v_add_f32 v58, v58, v66
    v_add_f32 v62, v62, v70
    v_add_f32 v59, v59, v67
    v_add_f32 v63, v63, v71
    s_nop 1
    v_permlane16_swap_b32 v56, v60
    v_permlane16_swap_b32 v57, v61
    v_permlane16_swap_b32 v58, v62
    v_permlane16_swap_b32 v59, v63
    s_nop 1
    v_cvt_pk_bf16_f32 v72, v56, v57
    v_cvt_pk_bf16_f32 v73, v58, v59
    v_cvt_pk_bf16_f32 v74, v60, v61
    v_cvt_pk_bf16_f32 v75, v62, v63
    buffer_store_dwordx4 v[72:75], v4, s[8:11], s28 offen
    s_cmp_eq_u32 s14, 63
    s_cbranch_scc1 chain2_kernel_end
    s_add_u32 s30, s18, 0
    s_add_u32 s31, s18, 4096
    s_add_u32 s32, s18, 16384
    s_add_u32 s33, s18, 20480
    s_add_u32 s34, s18, 32768
    s_add_u32 s29, s14, 1
    s_cmp_lt_u32 s29, 32
    s_cselect_b32 s19, s16, s17
    s_and_b32 s20, s29, 31
    s_lshl_b32 s20, s20, 16
    s_add_u32 s19, s19, s20
chain2_kernel_y0_ppoll:
    buffer_load_dwordx4 v[92:95], v5, s[8:11], s30 offen sc1
    buffer_load_dwordx4 v[96:99], v5, s[8:11], s31 offen sc1
    buffer_load_dwordx4 v[100:103], v5, s[8:11], s32 offen sc1
    buffer_load_dwordx4 v[104:107], v5, s[8:11], s33 offen sc1
    buffer_load_dwordx4 v[108:111], v5, s[8:11], s34 offen sc1
    s_waitcnt vmcnt(0)
    v_mfma_f32_16x16x32_bf16 v[112:115], v[92:95], v[72:75], 0
    v_mfma_f32_16x16x32_bf16 v[112:115], v[96:99], v[76:79], v[112:115]
    v_mfma_f32_16x16x32_bf16 v[112:115], v[100:103], v[80:83], v[112:115]
    v_mfma_f32_16x16x32_bf16 v[112:115], v[104:107], v[84:87], v[112:115]
    v_mfma_f32_16x16x32_bf16 v[112:115], v[108:111], v[88:91], v[112:115]
    v_max3_u32 v116, v92, v93, v94
    v_max3_u32 v116, v116, v95, v96
    v_max3_u32 v116, v116, v97, v98
    v_max3_u32 v116, v116, v99, v100
    v_max3_u32 v116, v116, v101, v102
    v_max3_u32 v116, v116, v103, v104
    v_max3_u32 v116, v116, v105, v106
    v_max3_u32 v116, v116, v107, v108
    v_max3_u32 v116, v116, v109, v110
    v_max_u32 v116, v116, v111
    v_cmp_eq_u32 vcc, -1, v116
    s_sub_u32 s15, s15, 1
    s_cbranch_scc1 chain2_kernel_bail
    s_cbranch_vccnz chain2_kernel_y0_ppoll
    ds_write_b128 v6, v[112:115]
    s_waitcnt lgkmcnt(0)
    s_barrier
    ds_read2st64_b32 v[116:117], v7 offset0:0 offset1:1
    ds_read2st64_b32 v[118:119], v7 offset0:2 offset1:3
    ds_read2st64_b32 v[120:121], v7 offset0:4 offset1:5
    ds_read2st64_b32 v[122:123], v7 offset0:6 offset1:7
    s_waitcnt lgkmcnt(2)
    v_add_f32 v116, v116, v117
    v_add_f32 v118, v118, v119
    s_waitcnt lgkmcnt(0)
    v_add_f32 v120, v120, v121
    v_add_f32 v122, v122, v123
    v_add_f32 v116, v116, v118
    v_add_f32 v120, v120, v122
    v_add_f32 v116, v116, v120
    s_nop 1
    v_mov_b32_dpp v117, v116 quad_perm:[1,0,3,2] row_mask:0xf bank_mask:0xf
    v_cvt_pk_bf16_f32 v124, v116, v117
    s_nop 1
    v_mov_b32_dpp v125, v124 row_shl:2 row_mask:0xf bank_mask:0xf
    v_mov_b32_dpp v126, v124 row_shl:4 row_mask:0xf bank_mask:0xf
    v_mov_b32_dpp v127, v124 row_shl:6 row_mask:0xf bank_mask:0xf
    s_mov_b64 exec, s[40:41]
    buffer_store_dwordx4 v[124:127], v8, s[8:11], s19 offen sc1
    s_mov_b64 exec, -1
    s_add_u32 s14, s14, 1
    s_branch chain2_kernel_y0_step
chain2_kernel_y1_start:
    v_lshrrev_b32 v16, 4, v0
    v_and_b32 v17, 7, v0
    v_lshrrev_b32 v18, 3, v0
    v_and_b32 v18, 1, v18
    v_lshl_add_u32 v19, v18, 2, v16
    v_add_u32 v19, 8, v19
    v_mul_u32_u24 v20, 640, v19
    v_lshl_add_u32 v4, v17, 4, v20
    v_and_b32 v20, 3, v17
    v_lshlrev_b32 v20, 1, v20
    v_lshrrev_b32 v21, 2, v17
    v_add_u32 v20, v20, v21
    v_lshlrev_b32 v20, 4, v20
    v_lshl_add_u32 v5, v19, 7, v20
    v_add_u32 v3, 0, v1
    v_lshlrev_b32 v20, 8, v18
    v_lshl_add_u32 v20, v17, 5, v20
    v_and_b32 v21, 1, v16
    v_lshl_add_u32 v20, v21, 4, v20
    v_add_u32 v20, 10752, v20
    v_add_u32 v21, 12288, v1
    v_lshrrev_b32 v22, 1, v16
    v_cmp_eq_u32 vcc, v22, v18
    s_nop 1
    v_cndmask_b32 v6, v21, v20, vcc
    v_lshrrev_b32 v20, 3, v0
    v_lshlrev_b32 v20, 2, v20
    v_lshl_add_u32 v20, v17, 5, v20
    v_add_u32 v7, 10240, v20
    s_lshl_b32 s20, s12, 7
    s_add_u32 s20, s20, 20480
    s_lshr_b32 s21, s20, 13
    s_lshl_b32 s21, s21, 14
    s_and_b32 s20, s20, 8191
    s_add_u32 s20, s20, s21
    v_lshrrev_b32 v20, 3, v0
    v_lshlrev_b32 v20, 4, v20
    v_add_u32 v8, s20, v20
    s_mul_i32 s46, s12, 20480
    s_add_u32 s46, s46, 103809024
    s_mul_i32 s20, s12, 327680
    s_add_u32 s20, s20, 27344896
    s_add_u32 s21, s20, 0
    buffer_load_dwordx4 a[0:3], v1, s[8:11], s21 offen offset:0
    buffer_load_dwordx4 a[4:7], v1, s[8:11], s21 offen offset:1024
    s_add_u32 s21, s20, 2048
    buffer_load_dwordx4 a[8:11], v1, s[8:11], s21 offen offset:0
    buffer_load_dwordx4 a[12:15], v1, s[8:11], s21 offen offset:1024
    s_add_u32 s21, s20, 4096
    buffer_load_dwordx4 a[16:19], v1, s[8:11], s21 offen offset:0
    buffer_load_dwordx4 a[20:23], v1, s[8:11], s21 offen offset:1024
    s_add_u32 s21, s20, 6144
    buffer_load_dwordx4 a[24:27], v1, s[8:11], s21 offen offset:0
    buffer_load_dwordx4 a[28:31], v1, s[8:11], s21 offen offset:1024
    s_add_u32 s21, s20, 8192
    buffer_load_dwordx4 a[32:35], v1, s[8:11], s21 offen offset:0
    buffer_load_dwordx4 a[36:39], v1, s[8:11], s21 offen offset:1024
    s_add_u32 s21, s20, 10240
    buffer_load_dwordx4 a[40:43], v1, s[8:11], s21 offen offset:0
    buffer_load_dwordx4 a[44:47], v1, s[8:11], s21 offen offset:1024
    s_add_u32 s21, s20, 12288
    buffer_load_dwordx4 a[48:51], v1, s[8:11], s21 offen offset:0
    buffer_load_dwordx4 a[52:55], v1, s[8:11], s21 offen offset:1024
    s_add_u32 s21, s20, 14336
    buffer_load_dwordx4 a[56:59], v1, s[8:11], s21 offen offset:0
    buffer_load_dwordx4 a[60:63], v1, s[8:11], s21 offen offset:1024
    s_add_u32 s21, s20, 16384
    buffer_load_dwordx4 a[64:67], v1, s[8:11], s21 offen offset:0
    buffer_load_dwordx4 a[68:71], v1, s[8:11], s21 offen offset:1024
    s_add_u32 s21, s20, 18432
    buffer_load_dwordx4 a[72:75], v1, s[8:11], s21 offen offset:0
    buffer_load_dwordx4 a[76:79], v1, s[8:11], s21 offen offset:1024
    s_add_u32 s21, s20, 20480
    buffer_load_dwordx4 a[80:83], v1, s[8:11], s21 offen offset:0
    buffer_load_dwordx4 a[84:87], v1, s[8:11], s21 offen offset:1024
    s_add_u32 s21, s20, 22528
    buffer_load_dwordx4 a[88:91], v1, s[8:11], s21 offen offset:0
    buffer_load_dwordx4 a[92:95], v1, s[8:11], s21 offen offset:1024
    s_add_u32 s21, s20, 24576
    buffer_load_dwordx4 a[96:99], v1, s[8:11], s21 offen offset:0
    buffer_load_dwordx4 a[100:103], v1, s[8:11], s21 offen offset:1024
    s_add_u32 s21, s20, 26624
    buffer_load_dwordx4 a[104:107], v1, s[8:11], s21 offen offset:0
    buffer_load_dwordx4 a[108:111], v1, s[8:11], s21 offen offset:1024
    s_add_u32 s21, s20, 28672
    buffer_load_dwordx4 a[112:115], v1, s[8:11], s21 offen offset:0
    buffer_load_dwordx4 a[116:119], v1, s[8:11], s21 offen offset:1024
    s_add_u32 s21, s20, 30720
    buffer_load_dwordx4 a[120:123], v1, s[8:11], s21 offen offset:0
    buffer_load_dwordx4 a[124:127], v1, s[8:11], s21 offen offset:1024
    s_add_u32 s21, s20, 32768
    buffer_load_dwordx4 a[128:131], v1, s[8:11], s21 offen offset:0
    buffer_load_dwordx4 a[132:135], v1, s[8:11], s21 offen offset:1024
    s_add_u32 s21, s20, 34816
    buffer_load_dwordx4 a[136:139], v1, s[8:11], s21 offen offset:0
    buffer_load_dwordx4 a[140:143], v1, s[8:11], s21 offen offset:1024
    s_add_u32 s21, s20, 36864
    buffer_load_dwordx4 a[144:147], v1, s[8:11], s21 offen offset:0
    buffer_load_dwordx4 a[148:151], v1, s[8:11], s21 offen offset:1024
    s_add_u32 s21, s20, 38912
    buffer_load_dwordx4 a[152:155], v1, s[8:11], s21 offen offset:0
    buffer_load_dwordx4 a[156:159], v1, s[8:11], s21 offen offset:1024
    s_add_u32 s21, s20, 40960
    buffer_load_dwordx4 a[160:163], v1, s[8:11], s21 offen offset:0
    buffer_load_dwordx4 a[164:167], v1, s[8:11], s21 offen offset:1024
    s_add_u32 s21, s20, 43008
    buffer_load_dwordx4 a[168:171], v1, s[8:11], s21 offen offset:0
    buffer_load_dwordx4 a[172:175], v1, s[8:11], s21 offen offset:1024
    s_add_u32 s21, s20, 45056
    buffer_load_dwordx4 a[176:179], v1, s[8:11], s21 offen offset:0
    buffer_load_dwordx4 a[180:183], v1, s[8:11], s21 offen offset:1024
    s_add_u32 s21, s20, 47104
    buffer_load_dwordx4 a[184:187], v1, s[8:11], s21 offen offset:0
    buffer_load_dwordx4 a[188:191], v1, s[8:11], s21 offen offset:1024
    s_add_u32 s21, s20, 49152
    buffer_load_dwordx4 a[192:195], v1, s[8:11], s21 offen offset:0
    buffer_load_dwordx4 a[196:199], v1, s[8:11], s21 offen offset:1024
    s_add_u32 s21, s20, 51200
    buffer_load_dwordx4 a[200:203], v1, s[8:11], s21 offen offset:0
    buffer_load_dwordx4 a[204:207], v1, s[8:11], s21 offen offset:1024
    s_add_u32 s21, s20, 53248
    buffer_load_dwordx4 a[208:211], v1, s[8:11], s21 offen offset:0
    buffer_load_dwordx4 a[212:215], v1, s[8:11], s21 offen offset:1024
    s_add_u32 s21, s20, 55296
    buffer_load_dwordx4 a[216:219], v1, s[8:11], s21 offen offset:0
    buffer_load_dwordx4 a[220:223], v1, s[8:11], s21 offen offset:1024
    s_add_u32 s21, s20, 57344
    buffer_load_dwordx4 a[224:227], v1, s[8:11], s21 offen offset:0
    buffer_load_dwordx4 a[228:231], v1, s[8:11], s21 offen offset:1024
    s_add_u32 s21, s20, 59392
    buffer_load_dwordx4 a[232:235], v1, s[8:11], s21 offen offset:0
    buffer_load_dwordx4 a[236:239], v1, s[8:11], s21 offen offset:1024
    s_add_u32 s21, s20, 61440
    buffer_load_dwordx4 a[240:243], v1, s[8:11], s21 offen offset:0
    buffer_load_dwordx4 a[244:247], v1, s[8:11], s21 offen offset:1024
    s_add_u32 s21, s20, 63488
    buffer_load_dwordx4 a[248:251], v1, s[8:11], s21 offen offset:0
    buffer_load_dwordx4 a[252:255], v1, s[8:11], s21 offen offset:1024
    s_add_u32 s21, s20, 65536
    buffer_load_dwordx4 v[176:179], v1, s[8:11], s21 offen offset:0
    buffer_load_dwordx4 v[180:183], v1, s[8:11], s21 offen offset:1024
    s_add_u32 s21, s20, 67584
    buffer_load_dwordx4 v[184:187], v1, s[8:11], s21 offen offset:0
    buffer_load_dwordx4 v[188:191], v1, s[8:11], s21 offen offset:1024
    s_add_u32 s21, s20, 69632
    buffer_load_dwordx4 v[192:195], v1, s[8:11], s21 offen offset:0
    buffer_load_dwordx4 v[196:199], v1, s[8:11], s21 offen offset:1024
    s_add_u32 s21, s20, 71680
    buffer_load_dwordx4 v[200:203], v1, s[8:11], s21 offen offset:0
    buffer_load_dwordx4 v[204:207], v1, s[8:11], s21 offen offset:1024
    s_add_u32 s21, s20, 73728
    buffer_load_dwordx4 v[208:211], v1, s[8:11], s21 offen offset:0
    buffer_load_dwordx4 v[212:215], v1, s[8:11], s21 offen offset:1024
    s_add_u32 s21, s20, 75776
    buffer_load_dwordx4 v[216:219], v1, s[8:11], s21 offen offset:0
    buffer_load_dwordx4 v[220:223], v1, s[8:11], s21 offen offset:1024
    s_add_u32 s21, s20, 77824
    buffer_load_dwordx4 v[224:227], v1, s[8:11], s21 offen offset:0
    buffer_load_dwordx4 v[228:231], v1, s[8:11], s21 offen offset:1024
    s_add_u32 s21, s20, 79872
    buffer_load_dwordx4 v[232:235], v1, s[8:11], s21 offen offset:0
    buffer_load_dwordx4 v[236:239], v1, s[8:11], s21 offen offset:1024
    s_mov_b32 s14, 0
chain2_kernel_y1_step:
    s_cmp_lt_u32 s14, 32
    s_cselect_b32 s18, s16, s17
    s_and_b32 s20, s14, 31
    s_lshl_b32 s20, s20, 16
    s_add_u32 s18, s18, s20
    s_mul_i32 s28, s14, 1638400
    s_add_u32 s28, s28, s46
    buffer_load_dwordx4 v[76:79], v4, s[8:11], s28 offen offset:128
    buffer_load_dwordx4 v[80:83], v4, s[8:11], s28 offen offset:256
    buffer_load_dwordx4 v[84:87], v4, s[8:11], s28 offen offset:384
    buffer_load_dwordx4 v[88:91], v4, s[8:11], s28 offen offset:512
    v_mov_b32 v56, 0
    v_mov_b32 v57, 0
    v_mov_b32 v58, 0
    v_mov_b32 v59, 0
    v_mov_b32 v60, 0
    v_mov_b32 v61, 0
    v_mov_b32 v62, 0
    v_mov_b32 v63, 0
    v_mov_b32 v64, 0
    v_mov_b32 v65, 0
    v_mov_b32 v66, 0
    v_mov_b32 v67, 0
    v_mov_b32 v68, 0
    v_mov_b32 v69, 0
    v_mov_b32 v70, 0
    v_mov_b32 v71, 0
    s_add_u32 s22, s18, 39936
    s_add_u32 s23, s18, 49152
    s_add_u32 s24, s18, 50176
chain2_kernel_y1_poll:
    buffer_load_dwordx4 v[28:31], v1, s[8:11], s22 offen sc1
    buffer_load_dwordx4 v[32:35], v1, s[8:11], s23 offen sc1
    buffer_load_dwordx4 v[36:39], v1, s[8:11], s24 offen sc1
    s_waitcnt vmcnt(0)
    ds_write_b128 v3, v[28:31] offset:3072
    ds_write_b128 v3, v[32:35] offset:4096
    ds_write_b128 v3, v[36:39] offset:5120
    v_max3_u32 v116, v28, v29, v30
    v_max3_u32 v116, v116, v31, v32
    v_max3_u32 v116, v116, v33, v34
    v_max3_u32 v116, v116, v35, v36
    v_max3_u32 v116, v116, v37, v38
    v_max_u32 v116, v116, v39
    v_cmp_eq_u32 vcc, -1, v116
    s_sub_u32 s15, s15, 1
    s_cbranch_scc1 chain2_kernel_bail
    s_cbranch_vccnz chain2_kernel_y1_poll
    s_waitcnt lgkmcnt(0)
    s_barrier
    ds_read_b128 v[16:19], v3 offset:0
    ds_read_b128 v[20:23], v3 offset:1024
    ds_read_b128 v[24:27], v3 offset:2048
    ds_read_b128 v[40:43], v3 offset:6144
    ds_read_b128 v[44:47], v3 offset:7168
    ds_read_b128 v[48:51], v3 offset:8192
    ds_read_b128 v[52:55], v3 offset:9216
    v_smfmac_f32_16x16x64_bf16 v[56:59], v[28:31], a[24:31], v2
    v_smfmac_f32_16x16x64_bf16 v[60:63], v[28:31], a[104:111], v2
    v_smfmac_f32_16x16x64_bf16 v[64:67], v[28:31], a[184:191], v2
    v_smfmac_f32_16x16x64_bf16 v[68:71], v[28:31], v[184:191], v2
    v_smfmac_f32_16x16x64_bf16 v[56:59], v[32:35], a[32:39], v2
    v_smfmac_f32_16x16x64_bf16 v[60:63], v[32:35], a[112:119], v2
    v_smfmac_f32_16x16x64_bf16 v[64:67], v[32:35], a[192:199], v2
    v_smfmac_f32_16x16x64_bf16 v[68:71], v[32:35], v[192:199], v2
    v_smfmac_f32_16x16x64_bf16 v[56:59], v[36:39], a[40:47], v2
    v_smfmac_f32_16x16x64_bf16 v[60:63], v[36:39], a[120:127], v2
    v_smfmac_f32_16x16x64_bf16 v[64:67], v[36:39], a[200:207], v2
    v_smfmac_f32_16x16x64_bf16 v[68:71], v[36:39], v[200:207], v2
    s_waitcnt lgkmcnt(6)
    v_smfmac_f32_16x16x64_bf16 v[56:59], v[16:19], a[0:7], v2
    v_smfmac_f32_16x16x64_bf16 v[60:63], v[16:19], a[80:87], v2
    v_smfmac_f32_16x16x64_bf16 v[64:67], v[16:19], a[160:167], v2
    v_smfmac_f32_16x16x64_bf16 v[68:71], v[16:19], a[240:247], v2
    s_waitcnt lgkmcnt(5)
    v_smfmac_f32_16x16x64_bf16 v[56:59], v[20:23], a[8:15], v2
    v_smfmac_f32_16x16x64_bf16 v[60:63], v[20:23], a[88:95], v2
    v_smfmac_f32_16x16x64_bf16 v[64:67], v[20:23], a[168:175], v2
    v_smfmac_f32_16x16x64_bf16 v[68:71], v[20:23], a[248:255], v2
    s_waitcnt lgkmcnt(4)
    v_smfmac_f32_16x16x64_bf16 v[56:59], v[24:27], a[16:23], v2
    v_smfmac_f32_16x16x64_bf16 v[60:63], v[24:27], a[96:103], v2
    v_smfmac_f32_16x16x64_bf16 v[64:67], v[24:27], a[176:183], v2
    v_smfmac_f32_16x16x64_bf16 v[68:71], v[24:27], v[176:183], v2
    s_waitcnt lgkmcnt(3)
    v_smfmac_f32_16x16x64_bf16 v[56:59], v[40:43], a[48:55], v2
    v_smfmac_f32_16x16x64_bf16 v[60:63], v[40:43], a[128:135], v2
    v_smfmac_f32_16x16x64_bf16 v[64:67], v[40:43], a[208:215], v2
    v_smfmac_f32_16x16x64_bf16 v[68:71], v[40:43], v[208:215], v2
    s_waitcnt lgkmcnt(2)
    v_smfmac_f32_16x16x64_bf16 v[56:59], v[44:47], a[56:63], v2
    v_smfmac_f32_16x16x64_bf16 v[60:63], v[44:47], a[136:143], v2
    v_smfmac_f32_16x16x64_bf16 v[64:67], v[44:47], a[216:223], v2
    v_smfmac_f32_16x16x64_bf16 v[68:71], v[44:47], v[216:223], v2
    s_waitcnt lgkmcnt(1)
    v_smfmac_f32_16x16x64_bf16 v[56:59], v[48:51], a[64:71], v2
    v_smfmac_f32_16x16x64_bf16 v[60:63], v[48:51], a[144:151], v2
    v_smfmac_f32_16x16x64_bf16 v[64:67], v[48:51], a[224:231], v2
    v_smfmac_f32_16x16x64_bf16 v[68:71], v[48:51], v[224:231], v2
    s_waitcnt lgkmcnt(0)
    v_smfmac_f32_16x16x64_bf16 v[56:59], v[52:55], a[72:79], v2
    v_smfmac_f32_16x16x64_bf16 v[60:63], v[52:55], a[152:159], v2
    v_smfmac_f32_16x16x64_bf16 v[64:67], v[52:55], a[232:239], v2
    v_smfmac_f32_16x16x64_bf16 v[68:71], v[52:55], v[232:239], v2
    s_nop 7
    v_permlane32_swap_b32 v56, v64
    v_permlane32_swap_b32 v60, v68
    v_permlane32_swap_b32 v57, v65
    v_permlane32_swap_b32 v61, v69
    v_permlane32_swap_b32 v58, v66
    v_permlane32_swap_b32 v62, v70
    v_permlane32_swap_b32 v59, v67
    v_permlane32_swap_b32 v63, v71
    v_add_f32 v56, v56, v64
    v_add_f32 v60, v60, v68
    v_add_f32 v57, v57, v65
    v_add_f32 v61, v61, v69
    v_add_f32 v58, v58, v66
    v_add_f32 v62, v62, v70
    v_add_f32 v59, v59, v67
    v_add_f32 v63, v63, v71
    s_nop 1
    v_permlane16_swap_b32 v56, v60
    v_permlane16_swap_b32 v57, v61
    v_permlane16_swap_b32 v58, v62
    v_permlane16_swap_b32 v59, v63
    s_nop 1
    v_cvt_pk_bf16_f32 v72, v56, v57
    v_cvt_pk_bf16_f32 v73, v58, v59
    v_cvt_pk_bf16_f32 v74, v60, v61
    v_cvt_pk_bf16_f32 v75, v62, v63
    buffer_store_dwordx4 v[72:75], v4, s[8:11], s28 offen
    s_cmp_eq_u32 s14, 63
    s_cbranch_scc1 chain2_kernel_end
    s_add_u32 s30, s18, 0
    s_add_u32 s31, s18, 4096
    s_add_u32 s32, s18, 16384
    s_add_u32 s33, s18, 20480
    s_add_u32 s34, s18, 32768
    s_add_u32 s29, s14, 1
    s_cmp_lt_u32 s29, 32
    s_cselect_b32 s19, s16, s17
    s_and_b32 s20, s29, 31
    s_lshl_b32 s20, s20, 16
    s_add_u32 s19, s19, s20
chain2_kernel_y1_ppoll:
    buffer_load_dwordx4 v[92:95], v5, s[8:11], s30 offen sc1
    buffer_load_dwordx4 v[96:99], v5, s[8:11], s31 offen sc1
    buffer_load_dwordx4 v[100:103], v5, s[8:11], s32 offen sc1
    buffer_load_dwordx4 v[104:107], v5, s[8:11], s33 offen sc1
    buffer_load_dwordx4 v[108:111], v5, s[8:11], s34 offen sc1
    s_waitcnt vmcnt(0)
    v_mfma_f32_16x16x32_bf16 v[112:115], v[92:95], v[72:75], 0
    v_mfma_f32_16x16x32_bf16 v[112:115], v[96:99], v[76:79], v[112:115]
    v_mfma_f32_16x16x32_bf16 v[112:115], v[100:103], v[80:83], v[112:115]
    v_mfma_f32_16x16x32_bf16 v[112:115], v[104:107], v[84:87], v[112:115]
    v_mfma_f32_16x16x32_bf16 v[112:115], v[108:111], v[88:91], v[112:115]
    v_max3_u32 v116, v92, v93, v94
    v_max3_u32 v116, v116, v95, v96
    v_max3_u32 v116, v116, v97, v98
    v_max3_u32 v116, v116, v99, v100
    v_max3_u32 v116, v116, v101, v102
    v_max3_u32 v116, v116, v103, v104
    v_max3_u32 v116, v116, v105, v106
    v_max3_u32 v116, v116, v107, v108
    v_max3_u32 v116, v116, v109, v110
    v_max_u32 v116, v116, v111
    v_cmp_eq_u32 vcc, -1, v116
    s_sub_u32 s15, s15, 1
    s_cbranch_scc1 chain2_kernel_bail
    s_cbranch_vccnz chain2_kernel_y1_ppoll
    ds_write_b128 v6, v[112:115]
    s_waitcnt lgkmcnt(0)
    s_barrier
    s_add_u32 s14, s14, 1
    s_branch chain2_kernel_y1_step
chain2_kernel_y2_start:
    v_lshrrev_b32 v16, 4, v0
    v_and_b32 v17, 7, v0
    v_lshrrev_b32 v18, 3, v0
    v_and_b32 v18, 1, v18
    v_lshl_add_u32 v19, v18, 2, v16
    v_add_u32 v19, 16, v19
    v_mul_u32_u24 v20, 640, v19
    v_lshl_add_u32 v4, v17, 4, v20
    v_and_b32 v20, 3, v17
    v_lshlrev_b32 v20, 1, v20
    v_lshrrev_b32 v21, 2, v17
    v_add_u32 v20, v20, v21
    v_lshlrev_b32 v20, 4, v20
    v_lshl_add_u32 v5, v19, 7, v20
    v_add_u32 v3, 0, v1
    v_lshlrev_b32 v20, 8, v18
    v_lshl_add_u32 v20, v17, 5, v20
    v_and_b32 v21, 1, v16
    v_lshl_add_u32 v20, v21, 4, v20
    v_add_u32 v20, 11264, v20
    v_add_u32 v21, 12288, v1
    v_lshrrev_b32 v22, 1, v16
    v_cmp_eq_u32 vcc, v22, v18
    s_nop 1
    v_cndmask_b32 v6, v21, v20, vcc
    v_lshrrev_b32 v20, 3, v0
    v_lshlrev_b32 v20, 2, v20
    v_lshl_add_u32 v20, v17, 5, v20
    v_add_u32 v7, 10240, v20
    s_lshl_b32 s20, s12, 7
    s_add_u32 s20, s20, 20480
    s_lshr_b32 s21, s20, 13
    s_lshl_b32 s21, s21, 14
    s_and_b32 s20, s20, 8191
    s_add_u32 s20, s20, s21
    v_lshrrev_b32 v20, 3, v0
    v_lshlrev_b32 v20, 4, v20
    v_add_u32 v8, s20, v20
    s_mul_i32 s46, s12, 20480
    s_add_u32 s46, s46, 103809024
    s_mul_i32 s20, s12, 327680
    s_add_u32 s20, s20, 27426816
    s_add_u32 s21, s20, 0
    buffer_load_dwordx4 a[0:3], v1, s[8:11], s21 offen offset:0
    buffer_load_dwordx4 a[4:7], v1, s[8:11], s21 offen offset:1024
    s_add_u32 s21, s20, 2048
    buffer_load_dwordx4 a[8:11], v1, s[8:11], s21 offen offset:0
    buffer_load_dwordx4 a[12:15], v1, s[8:11], s21 offen offset:1024
    s_add_u32 s21, s20, 4096
    buffer_load_dwordx4 a[16:19], v1, s[8:11], s21 offen offset:0
    buffer_load_dwordx4 a[20:23], v1, s[8:11], s21 offen offset:1024
    s_add_u32 s21, s20, 6144
    buffer_load_dwordx4 a[24:27], v1, s[8:11], s21 offen offset:0
    buffer_load_dwordx4 a[28:31], v1, s[8:11], s21 offen offset:1024
    s_add_u32 s21, s20, 8192
    buffer_load_dwordx4 a[32:35], v1, s[8:11], s21 offen offset:0
    buffer_load_dwordx4 a[36:39], v1, s[8:11], s21 offen offset:1024
    s_add_u32 s21, s20, 10240
    buffer_load_dwordx4 a[40:43], v1, s[8:11], s21 offen offset:0
    buffer_load_dwordx4 a[44:47], v1, s[8:11], s21 offen offset:1024
    s_add_u32 s21, s20, 12288
    buffer_load_dwordx4 a[48:51], v1, s[8:11], s21 offen offset:0
    buffer_load_dwordx4 a[52:55], v1, s[8:11], s21 offen offset:1024
    s_add_u32 s21, s20, 14336
    buffer_load_dwordx4 a[56:59], v1, s[8:11], s21 offen offset:0
    buffer_load_dwordx4 a[60:63], v1, s[8:11], s21 offen offset:1024
    s_add_u32 s21, s20, 16384
    buffer_load_dwordx4 a[64:67], v1, s[8:11], s21 offen offset:0
    buffer_load_dwordx4 a[68:71], v1, s[8:11], s21 offen offset:1024
    s_add_u32 s21, s20, 18432
    buffer_load_dwordx4 a[72:75], v1, s[8:11], s21 offen offset:0
    buffer_load_dwordx4 a[76:79], v1, s[8:11], s21 offen offset:1024
    s_add_u32 s21, s20, 20480
    buffer_load_dwordx4 a[80:83], v1, s[8:11], s21 offen offset:0
    buffer_load_dwordx4 a[84:87], v1, s[8:11], s21 offen offset:1024
    s_add_u32 s21, s20, 22528
    buffer_load_dwordx4 a[88:91], v1, s[8:11], s21 offen offset:0
    buffer_load_dwordx4 a[92:95], v1, s[8:11], s21 offen offset:1024
    s_add_u32 s21, s20, 24576
    buffer_load_dwordx4 a[96:99], v1, s[8:11], s21 offen offset:0
    buffer_load_dwordx4 a[100:103], v1, s[8:11], s21 offen offset:1024
    s_add_u32 s21, s20, 26624
    buffer_load_dwordx4 a[104:107], v1, s[8:11], s21 offen offset:0
    buffer_load_dwordx4 a[108:111], v1, s[8:11], s21 offen offset:1024
    s_add_u32 s21, s20, 28672
    buffer_load_dwordx4 a[112:115], v1, s[8:11], s21 offen offset:0
    buffer_load_dwordx4 a[116:119], v1, s[8:11], s21 offen offset:1024
    s_add_u32 s21, s20, 30720
    buffer_load_dwordx4 a[120:123], v1, s[8:11], s21 offen offset:0
    buffer_load_dwordx4 a[124:127], v1, s[8:11], s21 offen offset:1024
    s_add_u32 s21, s20, 32768
    buffer_load_dwordx4 a[128:131], v1, s[8:11], s21 offen offset:0
    buffer_load_dwordx4 a[132:135], v1, s[8:11], s21 offen offset:1024
    s_add_u32 s21, s20, 34816
    buffer_load_dwordx4 a[136:139], v1, s[8:11], s21 offen offset:0
    buffer_load_dwordx4 a[140:143], v1, s[8:11], s21 offen offset:1024
    s_add_u32 s21, s20, 36864
    buffer_load_dwordx4 a[144:147], v1, s[8:11], s21 offen offset:0
    buffer_load_dwordx4 a[148:151], v1, s[8:11], s21 offen offset:1024
    s_add_u32 s21, s20, 38912
    buffer_load_dwordx4 a[152:155], v1, s[8:11], s21 offen offset:0
    buffer_load_dwordx4 a[156:159], v1, s[8:11], s21 offen offset:1024
    s_add_u32 s21, s20, 40960
    buffer_load_dwordx4 a[160:163], v1, s[8:11], s21 offen offset:0
    buffer_load_dwordx4 a[164:167], v1, s[8:11], s21 offen offset:1024
    s_add_u32 s21, s20, 43008
    buffer_load_dwordx4 a[168:171], v1, s[8:11], s21 offen offset:0
    buffer_load_dwordx4 a[172:175], v1, s[8:11], s21 offen offset:1024
    s_add_u32 s21, s20, 45056
    buffer_load_dwordx4 a[176:179], v1, s[8:11], s21 offen offset:0
    buffer_load_dwordx4 a[180:183], v1, s[8:11], s21 offen offset:1024
    s_add_u32 s21, s20, 47104
    buffer_load_dwordx4 a[184:187], v1, s[8:11], s21 offen offset:0
    buffer_load_dwordx4 a[188:191], v1, s[8:11], s21 offen offset:1024
    s_add_u32 s21, s20, 49152
    buffer_load_dwordx4 a[192:195], v1, s[8:11], s21 offen offset:0
    buffer_load_dwordx4 a[196:199], v1, s[8:11], s21 offen offset:1024
    s_add_u32 s21, s20, 51200
    buffer_load_dwordx4 a[200:203], v1, s[8:11], s21 offen offset:0
    buffer_load_dwordx4 a[204:207], v1, s[8:11], s21 offen offset:1024
    s_add_u32 s21, s20, 53248
    buffer_load_dwordx4 a[208:211], v1, s[8:11], s21 offen offset:0
    buffer_load_dwordx4 a[212:215], v1, s[8:11], s21 offen offset:1024
    s_add_u32 s21, s20, 55296
    buffer_load_dwordx4 a[216:219], v1, s[8:11], s21 offen offset:0
    buffer_load_dwordx4 a[220:223], v1, s[8:11], s21 offen offset:1024
    s_add_u32 s21, s20, 57344
    buffer_load_dwordx4 a[224:227], v1, s[8:11], s21 offen offset:0
    buffer_load_dwordx4 a[228:231], v1, s[8:11], s21 offen offset:1024
    s_add_u32 s21, s20, 59392
    buffer_load_dwordx4 a[232:235], v1, s[8:11], s21 offen offset:0
    buffer_load_dwordx4 a[236:239], v1, s[8:11], s21 offen offset:1024
    s_add_u32 s21, s20, 61440
    buffer_load_dwordx4 a[240:243], v1, s[8:11], s21 offen offset:0
    buffer_load_dwordx4 a[244:247], v1, s[8:11], s21 offen offset:1024
    s_add_u32 s21, s20, 63488
    buffer_load_dwordx4 a[248:251], v1, s[8:11], s21 offen offset:0
    buffer_load_dwordx4 a[252:255], v1, s[8:11], s21 offen offset:1024
    s_add_u32 s21, s20, 65536
    buffer_load_dwordx4 v[176:179], v1, s[8:11], s21 offen offset:0
    buffer_load_dwordx4 v[180:183], v1, s[8:11], s21 offen offset:1024
    s_add_u32 s21, s20, 67584
    buffer_load_dwordx4 v[184:187], v1, s[8:11], s21 offen offset:0
    buffer_load_dwordx4 v[188:191], v1, s[8:11], s21 offen offset:1024
    s_add_u32 s21, s20, 69632
    buffer_load_dwordx4 v[192:195], v1, s[8:11], s21 offen offset:0
    buffer_load_dwordx4 v[196:199], v1, s[8:11], s21 offen offset:1024
    s_add_u32 s21, s20, 71680
    buffer_load_dwordx4 v[200:203], v1, s[8:11], s21 offen offset:0
    buffer_load_dwordx4 v[204:207], v1, s[8:11], s21 offen offset:1024
    s_add_u32 s21, s20, 73728
    buffer_load_dwordx4 v[208:211], v1, s[8:11], s21 offen offset:0
    buffer_load_dwordx4 v[212:215], v1, s[8:11], s21 offen offset:1024
    s_add_u32 s21, s20, 75776
    buffer_load_dwordx4 v[216:219], v1, s[8:11], s21 offen offset:0
    buffer_load_dwordx4 v[220:223], v1, s[8:11], s21 offen offset:1024
    s_add_u32 s21, s20, 77824
    buffer_load_dwordx4 v[224:227], v1, s[8:11], s21 offen offset:0
    buffer_load_dwordx4 v[228:231], v1, s[8:11], s21 offen offset:1024
    s_add_u32 s21, s20, 79872
    buffer_load_dwordx4 v[232:235], v1, s[8:11], s21 offen offset:0
    buffer_load_dwordx4 v[236:239], v1, s[8:11], s21 offen offset:1024
    s_mov_b32 s14, 0
chain2_kernel_y2_step:
    s_cmp_lt_u32 s14, 32
    s_cselect_b32 s18, s16, s17
    s_and_b32 s20, s14, 31
    s_lshl_b32 s20, s20, 16
    s_add_u32 s18, s18, s20
    s_mul_i32 s28, s14, 1638400
    s_add_u32 s28, s28, s46
    buffer_load_dwordx4 v[76:79], v4, s[8:11], s28 offen offset:128
    buffer_load_dwordx4 v[80:83], v4, s[8:11], s28 offen offset:256
    buffer_load_dwordx4 v[84:87], v4, s[8:11], s28 offen offset:384
    buffer_load_dwordx4 v[88:91], v4, s[8:11], s28 offen offset:512
    v_mov_b32 v56, 0
    v_mov_b32 v57, 0
    v_mov_b32 v58, 0
    v_mov_b32 v59, 0
    v_mov_b32 v60, 0
    v_mov_b32 v61, 0
    v_mov_b32 v62, 0
    v_mov_b32 v63, 0
    v_mov_b32 v64, 0
    v_mov_b32 v65, 0
    v_mov_b32 v66, 0
    v_mov_b32 v67, 0
    v_mov_b32 v68, 0
    v_mov_b32 v69, 0
    v_mov_b32 v70, 0
    v_mov_b32 v71, 0
    s_add_u32 s22, s18, 51200
    s_add_u32 s23, s18, 52224
chain2_kernel_y2_poll:
    buffer_load_dwordx4 v[40:43], v1, s[8:11], s22 offen sc1
    buffer_load_dwordx4 v[44:47], v1, s[8:11], s23 offen sc1
    s_waitcnt vmcnt(0)
    ds_write_b128 v3, v[40:43] offset:6144
    ds_write_b128 v3, v[44:47] offset:7168
    v_max3_u32 v116, v40, v41, v42
    v_max3_u32 v116, v116, v43, v44
    v_max3_u32 v116, v116, v45, v46
    v_max_u32 v116, v116, v47
    v_cmp_eq_u32 vcc, -1, v116
    s_sub_u32 s15, s15, 1
    s_cbranch_scc1 chain2_kernel_bail
    s_cbranch_vccnz chain2_kernel_y2_poll
    s_waitcnt lgkmcnt(0)
    s_barrier
    ds_read_b128 v[16:19], v3 offset:0
    ds_read_b128 v[20:23], v3 offset:1024
    ds_read_b128 v[24:27], v3 offset:2048
    ds_read_b128 v[28:31], v3 offset:3072
    ds_read_b128 v[32:35], v3 offset:4096
    ds_read_b128 v[36:39], v3 offset:5120
    ds_read_b128 v[48:51], v3 offset:8192
    ds_read_b128 v[52:55], v3 offset:9216
    v_smfmac_f32_16x16x64_bf16 v[56:59], v[40:43], a[48:55], v2
    v_smfmac_f32_16x16x64_bf16 v[60:63], v[40:43], a[128:135], v2
    v_smfmac_f32_16x16x64_bf16 v[64:67], v[40:43], a[208:215], v2
    v_smfmac_f32_16x16x64_bf16 v[68:71], v[40:43], v[208:215], v2
    v_smfmac_f32_16x16x64_bf16 v[56:59], v[44:47], a[56:63], v2
    v_smfmac_f32_16x16x64_bf16 v[60:63], v[44:47], a[136:143], v2
    v_smfmac_f32_16x16x64_bf16 v[64:67], v[44:47], a[216:223], v2
    v_smfmac_f32_16x16x64_bf16 v[68:71], v[44:47], v[216:223], v2
    s_waitcnt lgkmcnt(7)
    v_smfmac_f32_16x16x64_bf16 v[56:59], v[16:19], a[0:7], v2
    v_smfmac_f32_16x16x64_bf16 v[60:63], v[16:19], a[80:87], v2
    v_smfmac_f32_16x16x64_bf16 v[64:67], v[16:19], a[160:167], v2
    v_smfmac_f32_16x16x64_bf16 v[68:71], v[16:19], a[240:247], v2
    s_waitcnt lgkmcnt(6)
    v_smfmac_f32_16x16x64_bf16 v[56:59], v[20:23], a[8:15], v2
    v_smfmac_f32_16x16x64_bf16 v[60:63], v[20:23], a[88:95], v2
    v_smfmac_f32_16x16x64_bf16 v[64:67], v[20:23], a[168:175], v2
    v_smfmac_f32_16x16x64_bf16 v[68:71], v[20:23], a[248:255], v2
    s_waitcnt lgkmcnt(5)
    v_smfmac_f32_16x16x64_bf16 v[56:59], v[24:27], a[16:23], v2
    v_smfmac_f32_16x16x64_bf16 v[60:63], v[24:27], a[96:103], v2
    v_smfmac_f32_16x16x64_bf16 v[64:67], v[24:27], a[176:183], v2
    v_smfmac_f32_16x16x64_bf16 v[68:71], v[24:27], v[176:183], v2
    s_waitcnt lgkmcnt(4)
    v_smfmac_f32_16x16x64_bf16 v[56:59], v[28:31], a[24:31], v2
    v_smfmac_f32_16x16x64_bf16 v[60:63], v[28:31], a[104:111], v2
    v_smfmac_f32_16x16x64_bf16 v[64:67], v[28:31], a[184:191], v2
    v_smfmac_f32_16x16x64_bf16 v[68:71], v[28:31], v[184:191], v2
    s_waitcnt lgkmcnt(3)
    v_smfmac_f32_16x16x64_bf16 v[56:59], v[32:35], a[32:39], v2
    v_smfmac_f32_16x16x64_bf16 v[60:63], v[32:35], a[112:119], v2
    v_smfmac_f32_16x16x64_bf16 v[64:67], v[32:35], a[192:199], v2
    v_smfmac_f32_16x16x64_bf16 v[68:71], v[32:35], v[192:199], v2
    s_waitcnt lgkmcnt(2)
    v_smfmac_f32_16x16x64_bf16 v[56:59], v[36:39], a[40:47], v2
    v_smfmac_f32_16x16x64_bf16 v[60:63], v[36:39], a[120:127], v2
    v_smfmac_f32_16x16x64_bf16 v[64:67], v[36:39], a[200:207], v2
    v_smfmac_f32_16x16x64_bf16 v[68:71], v[36:39], v[200:207], v2
    s_waitcnt lgkmcnt(1)
    v_smfmac_f32_16x16x64_bf16 v[56:59], v[48:51], a[64:71], v2
    v_smfmac_f32_16x16x64_bf16 v[60:63], v[48:51], a[144:151], v2
    v_smfmac_f32_16x16x64_bf16 v[64:67], v[48:51], a[224:231], v2
    v_smfmac_f32_16x16x64_bf16 v[68:71], v[48:51], v[224:231], v2
    s_waitcnt lgkmcnt(0)
    v_smfmac_f32_16x16x64_bf16 v[56:59], v[52:55], a[72:79], v2
    v_smfmac_f32_16x16x64_bf16 v[60:63], v[52:55], a[152:159], v2
    v_smfmac_f32_16x16x64_bf16 v[64:67], v[52:55], a[232:239], v2
    v_smfmac_f32_16x16x64_bf16 v[68:71], v[52:55], v[232:239], v2
    s_nop 7
    v_permlane32_swap_b32 v56, v64
    v_permlane32_swap_b32 v60, v68
    v_permlane32_swap_b32 v57, v65
    v_permlane32_swap_b32 v61, v69
    v_permlane32_swap_b32 v58, v66
    v_permlane32_swap_b32 v62, v70
    v_permlane32_swap_b32 v59, v67
    v_permlane32_swap_b32 v63, v71
    v_add_f32 v56, v56, v64
    v_add_f32 v60, v60, v68
    v_add_f32 v57, v57, v65
    v_add_f32 v61, v61, v69
    v_add_f32 v58, v58, v66
    v_add_f32 v62, v62, v70
    v_add_f32 v59, v59, v67
    v_add_f32 v63, v63, v71
    s_nop 1
    v_permlane16_swap_b32 v56, v60
    v_permlane16_swap_b32 v57, v61
    v_permlane16_swap_b32 v58, v62
    v_permlane16_swap_b32 v59, v63
    s_nop 1
    v_cvt_pk_bf16_f32 v72, v56, v57
    v_cvt_pk_bf16_f32 v73, v58, v59
    v_cvt_pk_bf16_f32 v74, v60, v61
    v_cvt_pk_bf16_f32 v75, v62, v63
    buffer_store_dwordx4 v[72:75], v4, s[8:11], s28 offen
    s_cmp_eq_u32 s14, 63
    s_cbranch_scc1 chain2_kernel_end
    s_add_u32 s30, s18, 0
    s_add_u32 s31, s18, 4096
    s_add_u32 s32, s18, 16384
    s_add_u32 s33, s18, 20480
    s_add_u32 s34, s18, 32768
    s_add_u32 s29, s14, 1
    s_cmp_lt_u32 s29, 32
    s_cselect_b32 s19, s16, s17
    s_and_b32 s20, s29, 31
    s_lshl_b32 s20, s20, 16
    s_add_u32 s19, s19, s20
chain2_kernel_y2_ppoll:
    buffer_load_dwordx4 v[92:95], v5, s[8:11], s30 offen sc1
    buffer_load_dwordx4 v[96:99], v5, s[8:11], s31 offen sc1
    buffer_load_dwordx4 v[100:103], v5, s[8:11], s32 offen sc1
    buffer_load_dwordx4 v[104:107], v5, s[8:11], s33 offen sc1
    buffer_load_dwordx4 v[108:111], v5, s[8:11], s34 offen sc1
    s_waitcnt vmcnt(0)
    v_mfma_f32_16x16x32_bf16 v[112:115], v[92:95], v[72:75], 0
    v_mfma_f32_16x16x32_bf16 v[112:115], v[96:99], v[76:79], v[112:115]
    v_mfma_f32_16x16x32_bf16 v[112:115], v[100:103], v[80:83], v[112:115]
    v_mfma_f32_16x16x32_bf16 v[112:115], v[104:107], v[84:87], v[112:115]
    v_mfma_f32_16x16x32_bf16 v[112:115], v[108:111], v[88:91], v[112:115]
    v_max3_u32 v116, v92, v93, v94
    v_max3_u32 v116, v116, v95, v96
    v_max3_u32 v116, v116, v97, v98
    v_max3_u32 v116, v116, v99, v100
    v_max3_u32 v116, v116, v101, v102
    v_max3_u32 v116, v116, v103, v104
    v_max3_u32 v116, v116, v105, v106
    v_max3_u32 v116, v116, v107, v108
    v_max3_u32 v116, v116, v109, v110
    v_max_u32 v116, v116, v111
    v_cmp_eq_u32 vcc, -1, v116
    s_sub_u32 s15, s15, 1
    s_cbranch_scc1 chain2_kernel_bail
    s_cbranch_vccnz chain2_kernel_y2_ppoll
    ds_write_b128 v6, v[112:115]
    s_waitcnt lgkmcnt(0)
    s_barrier
    s_add_u32 s14, s14, 1
    s_branch chain2_kernel_y2_step
chain2_kernel_y3_start:
    v_lshrrev_b32 v16, 4, v0
    v_and_b32 v17, 7, v0
    v_lshrrev_b32 v18, 3, v0
    v_and_b32 v18, 1, v18
    v_lshl_add_u32 v19, v18, 2, v16
    v_add_u32 v19, 24, v19
    v_mul_u32_u24 v20, 640, v19
    v_lshl_add_u32 v4, v17, 4, v20
    v_and_b32 v20, 3, v17
    v_lshlrev_b32 v20, 1, v20
    v_lshrrev_b32 v21, 2, v17
    v_add_u32 v20, v20, v21
    v_lshlrev_b32 v20, 4, v20
    v_lshl_add_u32 v5, v19, 7, v20
    v_add_u32 v3, 0, v1
    v_lshlrev_b32 v20, 8, v18
    v_lshl_add_u32 v20, v17, 5, v20
    v_and_b32 v21, 1, v16
    v_lshl_add_u32 v20, v21, 4, v20
    v_add_u32 v20, 11776, v20
    v_add_u32 v21, 12288, v1
    v_lshrrev_b32 v22, 1, v16
    v_cmp_eq_u32 vcc, v22, v18
    s_nop 1
    v_cndmask_b32 v6, v21, v20, vcc
    v_lshrrev_b32 v20, 3, v0
    v_lshlrev_b32 v20, 2, v20
    v_lshl_add_u32 v20, v17, 5, v20
    v_add_u32 v7, 10240, v20
    s_lshl_b32 s20, s12, 7
    s_add_u32 s20, s20, 20480
    s_lshr_b32 s21, s20, 13
    s_lshl_b32 s21, s21, 14
    s_and_b32 s20, s20, 8191
    s_add_u32 s20, s20, s21
    v_lshrrev_b32 v20, 3, v0
    v_lshlrev_b32 v20, 4, v20
    v_add_u32 v8, s20, v20
    s_mul_i32 s46, s12, 20480
    s_add_u32 s46, s46, 103809024
    s_mul_i32 s20, s12, 327680
    s_add_u32 s20, s20, 27508736
    s_add_u32 s21, s20, 0
    buffer_load_dwordx4 a[0:3], v1, s[8:11], s21 offen offset:0
    buffer_load_dwordx4 a[4:7], v1, s[8:11], s21 offen offset:1024
    s_add_u32 s21, s20, 2048
    buffer_load_dwordx4 a[8:11], v1, s[8:11], s21 offen offset:0
    buffer_load_dwordx4 a[12:15], v1, s[8:11], s21 offen offset:1024
    s_add_u32 s21, s20, 4096
    buffer_load_dwordx4 a[16:19], v1, s[8:11], s21 offen offset:0
    buffer_load_dwordx4 a[20:23], v1, s[8:11], s21 offen offset:1024
    s_add_u32 s21, s20, 6144
    buffer_load_dwordx4 a[24:27], v1, s[8:11], s21 offen offset:0
    buffer_load_dwordx4 a[28:31], v1, s[8:11], s21 offen offset:1024
    s_add_u32 s21, s20, 8192
    buffer_load_dwordx4 a[32:35], v1, s[8:11], s21 offen offset:0
    buffer_load_dwordx4 a[36:39], v1, s[8:11], s21 offen offset:1024
    s_add_u32 s21, s20, 10240
    buffer_load_dwordx4 a[40:43], v1, s[8:11], s21 offen offset:0
    buffer_load_dwordx4 a[44:47], v1, s[8:11], s21 offen offset:1024
    s_add_u32 s21, s20, 12288
    buffer_load_dwordx4 a[48:51], v1, s[8:11], s21 offen offset:0
    buffer_load_dwordx4 a[52:55], v1, s[8:11], s21 offen offset:1024
    s_add_u32 s21, s20, 14336
    buffer_load_dwordx4 a[56:59], v1, s[8:11], s21 offen offset:0
    buffer_load_dwordx4 a[60:63], v1, s[8:11], s21 offen offset:1024
    s_add_u32 s21, s20, 16384
    buffer_load_dwordx4 a[64:67], v1, s[8:11], s21 offen offset:0
    buffer_load_dwordx4 a[68:71], v1, s[8:11], s21 offen offset:1024
    s_add_u32 s21, s20, 18432
    buffer_load_dwordx4 a[72:75], v1, s[8:11], s21 offen offset:0
    buffer_load_dwordx4 a[76:79], v1, s[8:11], s21 offen offset:1024
    s_add_u32 s21, s20, 20480
    buffer_load_dwordx4 a[80:83], v1, s[8:11], s21 offen offset:0
    buffer_load_dwordx4 a[84:87], v1, s[8:11], s21 offen offset:1024
    s_add_u32 s21, s20, 22528
    buffer_load_dwordx4 a[88:91], v1, s[8:11], s21 offen offset:0
    buffer_load_dwordx4 a[92:95], v1, s[8:11], s21 offen offset:1024
    s_add_u32 s21, s20, 24576
    buffer_load_dwordx4 a[96:99], v1, s[8:11], s21 offen offset:0
    buffer_load_dwordx4 a[100:103], v1, s[8:11], s21 offen offset:1024
    s_add_u32 s21, s20, 26624
    buffer_load_dwordx4 a[104:107], v1, s[8:11], s21 offen offset:0
    buffer_load_dwordx4 a[108:111], v1, s[8:11], s21 offen offset:1024
    s_add_u32 s21, s20, 28672
    buffer_load_dwordx4 a[112:115], v1, s[8:11], s21 offen offset:0
    buffer_load_dwordx4 a[116:119], v1, s[8:11], s21 offen offset:1024
    s_add_u32 s21, s20, 30720
    buffer_load_dwordx4 a[120:123], v1, s[8:11], s21 offen offset:0
    buffer_load_dwordx4 a[124:127], v1, s[8:11], s21 offen offset:1024
    s_add_u32 s21, s20, 32768
    buffer_load_dwordx4 a[128:131], v1, s[8:11], s21 offen offset:0
    buffer_load_dwordx4 a[132:135], v1, s[8:11], s21 offen offset:1024
    s_add_u32 s21, s20, 34816
    buffer_load_dwordx4 a[136:139], v1, s[8:11], s21 offen offset:0
    buffer_load_dwordx4 a[140:143], v1, s[8:11], s21 offen offset:1024
    s_add_u32 s21, s20, 36864
    buffer_load_dwordx4 a[144:147], v1, s[8:11], s21 offen offset:0
    buffer_load_dwordx4 a[148:151], v1, s[8:11], s21 offen offset:1024
    s_add_u32 s21, s20, 38912
    buffer_load_dwordx4 a[152:155], v1, s[8:11], s21 offen offset:0
    buffer_load_dwordx4 a[156:159], v1, s[8:11], s21 offen offset:1024
    s_add_u32 s21, s20, 40960
    buffer_load_dwordx4 a[160:163], v1, s[8:11], s21 offen offset:0
    buffer_load_dwordx4 a[164:167], v1, s[8:11], s21 offen offset:1024
    s_add_u32 s21, s20, 43008
    buffer_load_dwordx4 a[168:171], v1, s[8:11], s21 offen offset:0
    buffer_load_dwordx4 a[172:175], v1, s[8:11], s21 offen offset:1024
    s_add_u32 s21, s20, 45056
    buffer_load_dwordx4 a[176:179], v1, s[8:11], s21 offen offset:0
    buffer_load_dwordx4 a[180:183], v1, s[8:11], s21 offen offset:1024
    s_add_u32 s21, s20, 47104
    buffer_load_dwordx4 a[184:187], v1, s[8:11], s21 offen offset:0
    buffer_load_dwordx4 a[188:191], v1, s[8:11], s21 offen offset:1024
    s_add_u32 s21, s20, 49152
    buffer_load_dwordx4 a[192:195], v1, s[8:11], s21 offen offset:0
    buffer_load_dwordx4 a[196:199], v1, s[8:11], s21 offen offset:1024
    s_add_u32 s21, s20, 51200
    buffer_load_dwordx4 a[200:203], v1, s[8:11], s21 offen offset:0
    buffer_load_dwordx4 a[204:207], v1, s[8:11], s21 offen offset:1024
    s_add_u32 s21, s20, 53248
    buffer_load_dwordx4 a[208:211], v1, s[8:11], s21 offen offset:0
    buffer_load_dwordx4 a[212:215], v1, s[8:11], s21 offen offset:1024
    s_add_u32 s21, s20, 55296
    buffer_load_dwordx4 a[216:219], v1, s[8:11], s21 offen offset:0
    buffer_load_dwordx4 a[220:223], v1, s[8:11], s21 offen offset:1024
    s_add_u32 s21, s20, 57344
    buffer_load_dwordx4 a[224:227], v1, s[8:11], s21 offen offset:0
    buffer_load_dwordx4 a[228:231], v1, s[8:11], s21 offen offset:1024
    s_add_u32 s21, s20, 59392
    buffer_load_dwordx4 a[232:235], v1, s[8:11], s21 offen offset:0
    buffer_load_dwordx4 a[236:239], v1, s[8:11], s21 offen offset:1024
    s_add_u32 s21, s20, 61440
    buffer_load_dwordx4 a[240:243], v1, s[8:11], s21 offen offset:0
    buffer_load_dwordx4 a[244:247], v1, s[8:11], s21 offen offset:1024
    s_add_u32 s21, s20, 63488
    buffer_load_dwordx4 a[248:251], v1, s[8:11], s21 offen offset:0
    buffer_load_dwordx4 a[252:255], v1, s[8:11], s21 offen offset:1024
    s_add_u32 s21, s20, 65536
    buffer_load_dwordx4 v[176:179], v1, s[8:11], s21 offen offset:0
    buffer_load_dwordx4 v[180:183], v1, s[8:11], s21 offen offset:1024
    s_add_u32 s21, s20, 67584
    buffer_load_dwordx4 v[184:187], v1, s[8:11], s21 offen offset:0
    buffer_load_dwordx4 v[188:191], v1, s[8:11], s21 offen offset:1024
    s_add_u32 s21, s20, 69632
    buffer_load_dwordx4 v[192:195], v1, s[8:11], s21 offen offset:0
    buffer_load_dwordx4 v[196:199], v1, s[8:11], s21 offen offset:1024
    s_add_u32 s21, s20, 71680
    buffer_load_dwordx4 v[200:203], v1, s[8:11], s21 offen offset:0
    buffer_load_dwordx4 v[204:207], v1, s[8:11], s21 offen offset:1024
    s_add_u32 s21, s20, 73728
    buffer_load_dwordx4 v[208:211], v1, s[8:11], s21 offen offset:0
    buffer_load_dwordx4 v[212:215], v1, s[8:11], s21 offen offset:1024
    s_add_u32 s21, s20, 75776
    buffer_load_dwordx4 v[216:219], v1, s[8:11], s21 offen offset:0
    buffer_load_dwordx4 v[220:223], v1, s[8:11], s21 offen offset:1024
    s_add_u32 s21, s20, 77824
    buffer_load_dwordx4 v[224:227], v1, s[8:11], s21 offen offset:0
    buffer_load_dwordx4 v[228:231], v1, s[8:11], s21 offen offset:1024
    s_add_u32 s21, s20, 79872
    buffer_load_dwordx4 v[232:235], v1, s[8:11], s21 offen offset:0
    buffer_load_dwordx4 v[236:239], v1, s[8:11], s21 offen offset:1024
    s_mov_b32 s14, 0
chain2_kernel_y3_step:
    s_cmp_lt_u32 s14, 32
    s_cselect_b32 s18, s16, s17
    s_and_b32 s20, s14, 31
    s_lshl_b32 s20, s20, 16
    s_add_u32 s18, s18, s20
    s_mul_i32 s28, s14, 1638400
    s_add_u32 s28, s28, s46
    buffer_load_dwordx4 v[76:79], v4, s[8:11], s28 offen offset:128
    buffer_load_dwordx4 v[80:83], v4, s[8:11], s28 offen offset:256
    buffer_load_dwordx4 v[84:87], v4, s[8:11], s28 offen offset:384
    buffer_load_dwordx4 v[88:91], v4, s[8:11], s28 offen offset:512
    v_mov_b32 v56, 0
    v_mov_b32 v57, 0
    v_mov_b32 v58, 0
    v_mov_b32 v59, 0
    v_mov_b32 v60, 0
    v_mov_b32 v61, 0
    v_mov_b32 v62, 0
    v_mov_b32 v63, 0
    v_mov_b32 v64, 0
    v_mov_b32 v65, 0
    v_mov_b32 v66, 0
    v_mov_b32 v67, 0
    v_mov_b32 v68, 0
    v_mov_b32 v69, 0
    v_mov_b32 v70, 0
    v_mov_b32 v71, 0
    s_add_u32 s22, s18, 53248
    s_add_u32 s23, s18, 54272
chain2_kernel_y3_poll:
    buffer_load_dwordx4 v[48:51], v1, s[8:11], s22 offen sc1
    buffer_load_dwordx4 v[52:55], v1, s[8:11], s23 offen sc1
    s_waitcnt vmcnt(0)
    ds_write_b128 v3, v[48:51] offset:8192
    ds_write_b128 v3, v[52:55] offset:9216
    v_max3_u32 v116, v48, v49, v50
    v_max3_u32 v116, v116, v51, v52
    v_max3_u32 v116, v116, v53, v54
    v_max_u32 v116, v116, v55
    v_cmp_eq_u32 vcc, -1, v116
    s_sub_u32 s15, s15, 1
    s_cbranch_scc1 chain2_kernel_bail
    s_cbranch_vccnz chain2_kernel_y3_poll
    s_waitcnt lgkmcnt(0)
    s_barrier
    ds_read_b128 v[16:19], v3 offset:0
    ds_read_b128 v[20:23], v3 offset:1024
    ds_read_b128 v[24:27], v3 offset:2048
    ds_read_b128 v[28:31], v3 offset:3072
    ds_read_b128 v[32:35], v3 offset:4096
    ds_read_b128 v[36:39], v3 offset:5120
    ds_read_b128 v[40:43], v3 offset:6144
    ds_read_b128 v[44:47], v3 offset:7168
    v_smfmac_f32_16x16x64_bf16 v[56:59], v[48:51], a[64:71], v2
    v_smfmac_f32_16x16x64_bf16 v[60:63], v[48:51], a[144:151], v2
    v_smfmac_f32_16x16x64_bf16 v[64:67], v[48:51], a[224:231], v2
    v_smfmac_f32_16x16x64_bf16 v[68:71], v[48:51], v[224:231], v2
    v_smfmac_f32_16x16x64_bf16 v[56:59], v[52:55], a[72:79], v2
    v_smfmac_f32_16x16x64_bf16 v[60:63], v[52:55], a[152:159], v2
    v_smfmac_f32_16x16x64_bf16 v[64:67], v[52:55], a[232:239], v2
    v_smfmac_f32_16x16x64_bf16 v[68:71], v[52:55], v[232:239], v2
    s_waitcnt lgkmcnt(7)
    v_smfmac_f32_16x16x64_bf16 v[56:59], v[16:19], a[0:7], v2
    v_smfmac_f32_16x16x64_bf16 v[60:63], v[16:19], a[80:87], v2
    v_smfmac_f32_16x16x64_bf16 v[64:67], v[16:19], a[160:167], v2
    v_smfmac_f32_16x16x64_bf16 v[68:71], v[16:19], a[240:247], v2
    s_waitcnt lgkmcnt(6)
    v_smfmac_f32_16x16x64_bf16 v[56:59], v[20:23], a[8:15], v2
    v_smfmac_f32_16x16x64_bf16 v[60:63], v[20:23], a[88:95], v2
    v_smfmac_f32_16x16x64_bf16 v[64:67], v[20:23], a[168:175], v2
    v_smfmac_f32_16x16x64_bf16 v[68:71], v[20:23], a[248:255], v2
    s_waitcnt lgkmcnt(5)
    v_smfmac_f32_16x16x64_bf16 v[56:59], v[24:27], a[16:23], v2
    v_smfmac_f32_16x16x64_bf16 v[60:63], v[24:27], a[96:103], v2
    v_smfmac_f32_16x16x64_bf16 v[64:67], v[24:27], a[176:183], v2
    v_smfmac_f32_16x16x64_bf16 v[68:71], v[24:27], v[176:183], v2
    s_waitcnt lgkmcnt(4)
    v_smfmac_f32_16x16x64_bf16 v[56:59], v[28:31], a[24:31], v2
    v_smfmac_f32_16x16x64_bf16 v[60:63], v[28:31], a[104:111], v2
    v_smfmac_f32_16x16x64_bf16 v[64:67], v[28:31], a[184:191], v2
    v_smfmac_f32_16x16x64_bf16 v[68:71], v[28:31], v[184:191], v2
    s_waitcnt lgkmcnt(3)
    v_smfmac_f32_16x16x64_bf16 v[56:59], v[32:35], a[32:39], v2
    v_smfmac_f32_16x16x64_bf16 v[60:63], v[32:35], a[112:119], v2
    v_smfmac_f32_16x16x64_bf16 v[64:67], v[32:35], a[192:199], v2
    v_smfmac_f32_16x16x64_bf16 v[68:71], v[32:35], v[192:199], v2
    s_waitcnt lgkmcnt(2)
    v_smfmac_f32_16x16x64_bf16 v[56:59], v[36:39], a[40:47], v2
    v_smfmac_f32_16x16x64_bf16 v[60:63], v[36:39], a[120:127], v2
    v_smfmac_f32_16x16x64_bf16 v[64:67], v[36:39], a[200:207], v2
    v_smfmac_f32_16x16x64_bf16 v[68:71], v[36:39], v[200:207], v2
    s_waitcnt lgkmcnt(1)
    v_smfmac_f32_16x16x64_bf16 v[56:59], v[40:43], a[48:55], v2
    v_smfmac_f32_16x16x64_bf16 v[60:63], v[40:43], a[128:135], v2
    v_smfmac_f32_16x16x64_bf16 v[64:67], v[40:43], a[208:215], v2
    v_smfmac_f32_16x16x64_bf16 v[68:71], v[40:43], v[208:215], v2
    s_waitcnt lgkmcnt(0)
    v_smfmac_f32_16x16x64_bf16 v[56:59], v[44:47], a[56:63], v2
    v_smfmac_f32_16x16x64_bf16 v[60:63], v[44:47], a[136:143], v2
    v_smfmac_f32_16x16x64_bf16 v[64:67], v[44:47], a[216:223], v2
    v_smfmac_f32_16x16x64_bf16 v[68:71], v[44:47], v[216:223], v2
    s_nop 7
    v_permlane32_swap_b32 v56, v64
    v_permlane32_swap_b32 v60, v68
    v_permlane32_swap_b32 v57, v65
    v_permlane32_swap_b32 v61, v69
    v_permlane32_swap_b32 v58, v66
    v_permlane32_swap_b32 v62, v70
    v_permlane32_swap_b32 v59, v67
    v_permlane32_swap_b32 v63, v71
    v_add_f32 v56, v56, v64
    v_add_f32 v60, v60, v68
    v_add_f32 v57, v57, v65
    v_add_f32 v61, v61, v69
    v_add_f32 v58, v58, v66
    v_add_f32 v62, v62, v70
    v_add_f32 v59, v59, v67
    v_add_f32 v63, v63, v71
    s_nop 1
    v_permlane16_swap_b32 v56, v60
    v_permlane16_swap_b32 v57, v61
    v_permlane16_swap_b32 v58, v62
    v_permlane16_swap_b32 v59, v63
    s_nop 1
    v_cvt_pk_bf16_f32 v72, v56, v57
    v_cvt_pk_bf16_f32 v73, v58, v59
    v_cvt_pk_bf16_f32 v74, v60, v61
    v_cvt_pk_bf16_f32 v75, v62, v63
    buffer_store_dwordx4 v[72:75], v4, s[8:11], s28 offen
    s_cmp_eq_u32 s14, 63
    s_cbranch_scc1 chain2_kernel_end
    s_add_u32 s30, s18, 0
    s_add_u32 s31, s18, 4096
    s_add_u32 s32, s18, 16384
    s_add_u32 s33, s18, 20480
    s_add_u32 s34, s18, 32768
    s_add_u32 s29, s14, 1
    s_cmp_lt_u32 s29, 32
    s_cselect_b32 s19, s16, s17
    s_and_b32 s20, s29, 31
    s_lshl_b32 s20, s20, 16
    s_add_u32 s19, s19, s20
chain2_kernel_y3_ppoll:
    buffer_load_dwordx4 v[92:95], v5, s[8:11], s30 offen sc1
    buffer_load_dwordx4 v[96:99], v5, s[8:11], s31 offen sc1
    buffer_load_dwordx4 v[100:103], v5, s[8:11], s32 offen sc1
    buffer_load_dwordx4 v[104:107], v5, s[8:11], s33 offen sc1
    buffer_load_dwordx4 v[108:111], v5, s[8:11], s34 offen sc1
    s_waitcnt vmcnt(0)
    v_mfma_f32_16x16x32_bf16 v[112:115], v[92:95], v[72:75], 0
    v_mfma_f32_16x16x32_bf16 v[112:115], v[96:99], v[76:79], v[112:115]
    v_mfma_f32_16x16x32_bf16 v[112:115], v[100:103], v[80:83], v[112:115]
    v_mfma_f32_16x16x32_bf16 v[112:115], v[104:107], v[84:87], v[112:115]
    v_mfma_f32_16x16x32_bf16 v[112:115], v[108:111], v[88:91], v[112:115]
    v_max3_u32 v116, v92, v93, v94
    v_max3_u32 v116, v116, v95, v96
    v_max3_u32 v116, v116, v97, v98
    v_max3_u32 v116, v116, v99, v100
    v_max3_u32 v116, v116, v101, v102
    v_max3_u32 v116, v116, v103, v104
    v_max3_u32 v116, v116, v105, v106
    v_max3_u32 v116, v116, v107, v108
    v_max3_u32 v116, v116, v109, v110
    v_max_u32 v116, v116, v111
    v_cmp_eq_u32 vcc, -1, v116
    s_sub_u32 s15, s15, 1
    s_cbranch_scc1 chain2_kernel_bail
    s_cbranch_vccnz chain2_kernel_y3_ppoll
    ds_write_b128 v6, v[112:115]
    s_waitcnt lgkmcnt(0)
    s_barrier
    s_add_u32 s14, s14, 1
    s_branch chain2_kernel_y3_step
chain2_kernel_bail:
    s_mov_b64 exec, 1
    s_load_dwordx2 s[6:7], s[0:1], 88
    s_waitcnt lgkmcnt(0)
    s_mov_b32 s24, s6
    s_mov_b32 s25, s7
    s_mov_b32 s26, 256
    s_mov_b32 s27, 0x00020000
    v_mov_b32 v1, 0xdead
    v_mov_b32 v2, s14
    v_mov_b32 v3, 0
    buffer_store_dword v1, v3, s[24:27], 0 offen
    buffer_store_dword v2, v3, s[24:27], 0 offen offset:4
chain2_kernel_end:
    s_endpgm
.section .rodata,"a"
.p2align 6
.amdhsa_kernel chain2_kernel
  .amdhsa_next_free_vgpr 512
  .amdhsa_next_free_sgpr 100
  .amdhsa_accum_offset 256
  .amdhsa_group_segment_fixed_size 0
  .amdhsa_kernarg_size 104
  .amdhsa_user_sgpr_count 2
  .amdhsa_user_sgpr_kernarg_segment_ptr 1
  .amdhsa_system_sgpr_workgroup_id_x 1
.end_amdhsa_kernel
.text
.globl w3b2_kernel
.p2align 8
.type w3b2_kernel,@function
w3b2_kernel:
    s_cmp_ge_u32 s2, 320
    s_cbranch_scc1 w3b2_kernel_end
    s_load_dwordx2 s[4:5], s[0:1], 96
    s_load_dwordx2 s[6:7], s[0:1], 80
    v_lshrrev_b32 v1, 6, v0
    v_and_b32 v0, 63, v0
    s_nop 0
    v_readfirstlane_b32 s13, v1
    s_waitcnt lgkmcnt(0)
    s_mov_b32 s8, s4
    s_mov_b32 s9, s5
    s_mov_b32 s10, 268435456
    s_mov_b32 s11, 0x00020000
    s_mov_b32 s16, s6
    s_mov_b32 s17, s7
    s_mov_b32 s18, 2621440
    s_mov_b32 s19, 0x00020000
    s_lshl_b32 s20, s2, 2
    s_add_u32 s20, s20, s13
    s_mul_i32 s21, s20, 3277
    s_lshr_b32 s21, s21, 16
    s_mul_i32 s22, s21, 20
    s_sub_u32 s22, s20, s22
    v_lshlrev_b32 v1, 4, v0
    v_and_b32 v2, 31, v0
    v_lshrrev_b32 v3, 5, v0
    v_lshrrev_b32 v4, 3, v2
    v_mul_u32_u24 v4, 20480, v4
    v_and_b32 v5, 7, v2
    v_lshl_add_u32 v4, v5, 4, v4
    v_lshl_add_u32 v4, v3, 7, v4
    s_mul_i32 s24, s21, 1638400
    s_mul_i32 s25, s22, 81920
    s_add_u32 s24, s24, s25
    s_add_u32 s24, s24, 103809024
    s_mul_i32 s25, s21, 81920
    s_add_u32 s25, s25, 214958080
    v_mul_u32_u24 v6, 1280, v2
    v_lshl_add_u32 v6, v3, 4, v6
    s_mul_i32 s26, s21, 40960
    s_lshl_b32 s27, s22, 6
    s_add_u32 s26, s26, s27
    s_add_u32 s27, s26, 226492416
    buffer_load_dwordx4 v[8:11], v6, s[8:11], s27 offen offset:0
    buffer_load_dwordx4 v[12:15], v6, s[8:11], s27 offen offset:32
    buffer_load_dwordx4 v[32:35], v4, s[8:11], s24 offen offset:0
    buffer_load_dwordx4 v[36:39], v1, s[8:11], s25 offen offset:0
    buffer_load_dwordx4 v[40:43], v4, s[8:11], s24 offen offset:256
    buffer_load_dwordx4 v[44:47], v1, s[8:11], s25 offen offset:1024
    buffer_load_dwordx4 v[48:51], v4, s[8:11], s24 offen offset:512
    buffer_load_dwordx4 v[52:55], v1, s[8:11], s25 offen offset:2048
    buffer_load_dwordx4 v[56:59], v4, s[8:11], s24 offen offset:768
    buffer_load_dwordx4 v[60:63], v1, s[8:11], s25 offen offset:3072
    s_add_u32 s25, s25, 4096
    buffer_load_dwordx4 v[64:67], v4, s[8:11], s24 offen offset:1024
    buffer_load_dwordx4 v[68:71], v1, s[8:11], s25 offen offset:0
    buffer_load_dwordx4 v[72:75], v4, s[8:11], s24 offen offset:1280
    buffer_load_dwordx4 v[76:79], v1, s[8:11], s25 offen offset:1024
    buffer_load_dwordx4 v[80:83], v4, s[8:11], s24 offen offset:1536
    buffer_load_dwordx4 v[84:87], v1, s[8:11], s25 offen offset:2048
    buffer_load_dwordx4 v[88:91], v4, s[8:11], s24 offen offset:1792
    buffer_load_dwordx4 v[92:95], v1, s[8:11], s25 offen offset:3072
    s_add_u32 s25, s25, 4096
    buffer_load_dwordx4 v[96:99], v4, s[8:11], s24 offen offset:2048
    buffer_load_dwordx4 v[100:103], v1, s[8:11], s25 offen offset:0
    buffer_load_dwordx4 v[104:107], v4, s[8:11], s24 offen offset:2304
    buffer_load_dwordx4 v[108:111], v1, s[8:11], s25 offen offset:1024
    buffer_load_dwordx4 v[112:115], v4, s[8:11], s24 offen offset:2560
    buffer_load_dwordx4 v[116:119], v1, s[8:11], s25 offen offset:2048
    buffer_load_dwordx4 v[120:123], v4, s[8:11], s24 offen offset:2816
    buffer_load_dwordx4 v[124:127], v1, s[8:11], s25 offen offset:3072
    s_waitcnt vmcnt(22)
    v_mfma_f32_32x32x16_bf16 v[16:31], v[32:35], v[36:39], 0
    s_waitcnt vmcnt(20)
    v_mfma_f32_32x32x16_bf16 v[16:31], v[40:43], v[44:47], v[16:31]
    s_add_u32 s25, s25, 4096
    buffer_load_dwordx4 v[32:35], v4, s[8:11], s24 offen offset:3072
    buffer_load_dwordx4 v[36:39], v1, s[8:11], s25 offen offset:0
    s_waitcnt vmcnt(20)
    v_mfma_f32_32x32x16_bf16 v[16:31], v[48:51], v[52:55], v[16:31]
    buffer_load_dwordx4 v[40:43], v4, s[8:11], s24 offen offset:3328
    buffer_load_dwordx4 v[44:47], v1, s[8:11], s25 offen offset:1024
    s_waitcnt vmcnt(20)
    v_mfma_f32_32x32x16_bf16 v[16:31], v[56:59], v[60:63], v[16:31]
    buffer_load_dwordx4 v[48:51], v4, s[8:11], s24 offen offset:3584
    buffer_load_dwordx4 v[52:55], v1, s[8:11], s25 offen offset:2048
    s_waitcnt vmcnt(20)
    v_mfma_f32_32x32x16_bf16 v[16:31], v[64:67], v[68:71], v[16:31]
    buffer_load_dwordx4 v[56:59], v4, s[8:11], s24 offen offset:3840
    buffer_load_dwordx4 v[60:63], v1, s[8:11], s25 offen offset:3072
    s_waitcnt vmcnt(20)
    v_mfma_f32_32x32x16_bf16 v[16:31], v[72:75], v[76:79], v[16:31]
    s_add_u32 s24, s24, 4096
    s_add_u32 s25, s25, 4096
    buffer_load_dwordx4 v[64:67], v4, s[8:11], s24 offen offset:0
    buffer_load_dwordx4 v[68:71], v1, s[8:11], s25 offen offset:0
    s_waitcnt vmcnt(20)
    v_mfma_f32_32x32x16_bf16 v[16:31], v[80:83], v[84:87], v[16:31]
    buffer_load_dwordx4 v[72:75], v4, s[8:11], s24 offen offset:256
    buffer_load_dwordx4 v[76:79], v1, s[8:11], s25 offen offset:1024
    s_waitcnt vmcnt(20)
    v_mfma_f32_32x32x16_bf16 v[16:31], v[88:91], v[92:95], v[16:31]
    buffer_load_dwordx4 v[80:83], v4, s[8:11], s24 offen offset:512
    buffer_load_dwordx4 v[84:87], v1, s[8:11], s25 offen offset:2048
    s_waitcnt vmcnt(20)
    v_mfma_f32_32x32x16_bf16 v[16:31], v[96:99], v[100:103], v[16:31]
    buffer_load_dwordx4 v[88:91], v4, s[8:11], s24 offen offset:768
    buffer_load_dwordx4 v[92:95], v1, s[8:11], s25 offen offset:3072
    s_waitcnt vmcnt(20)
    v_mfma_f32_32x32x16_bf16 v[16:31], v[104:107], v[108:111], v[16:31]
    s_add_u32 s25, s25, 4096
    buffer_load_dwordx4 v[96:99], v4, s[8:11], s24 offen offset:1024
    buffer_load_dwordx4 v[100:103], v1, s[8:11], s25 offen offset:0
    s_waitcnt vmcnt(20)
    v_mfma_f32_32x32x16_bf16 v[16:31], v[112:115], v[116:119], v[16:31]
    buffer_load_dwordx4 v[104:107], v4, s[8:11], s24 offen offset:1280
    buffer_load_dwordx4 v[108:111], v1, s[8:11], s25 offen offset:1024
    s_waitcnt vmcnt(20)
    v_mfma_f32_32x32x16_bf16 v[16:31], v[120:123], v[124:127], v[16:31]
    buffer_load_dwordx4 v[112:115], v4, s[8:11], s24 offen offset:1536
    buffer_load_dwordx4 v[116:119], v1, s[8:11], s25 offen offset:2048
    s_waitcnt vmcnt(20)
    v_mfma_f32_32x32x16_bf16 v[16:31], v[32:35], v[36:39], v[16:31]
    buffer_load_dwordx4 v[120:123], v4, s[8:11], s24 offen offset:1792
    buffer_load_dwordx4 v[124:127], v1, s[8:11], s25 offen offset:3072
    s_waitcnt vmcnt(20)
    v_mfma_f32_32x32x16_bf16 v[16:31], v[40:43], v[44:47], v[16:31]
    s_add_u32 s25, s25, 4096
    buffer_load_dwordx4 v[32:35], v4, s[8:11], s24 offen offset:2048
    buffer_load_dwordx4 v[36:39], v1, s[8:11], s25 offen offset:0
    s_waitcnt vmcnt(20)
    v_mfma_f32_32x32x16_bf16 v[16:31], v[48:51], v[52:55], v[16:31]
    buffer_load_dwordx4 v[40:43], v4, s[8:11], s24 offen offset:2304
    buffer_load_dwordx4 v[44:47], v1, s[8:11], s25 offen offset:1024
    s_waitcnt vmcnt(20)
    v_mfma_f32_32x32x16_bf16 v[16:31], v[56:59], v[60:63], v[16:31]
    buffer_load_dwordx4 v[48:51], v4, s[8:11], s24 offen offset:2560
    buffer_load_dwordx4 v[52:55], v1, s[8:11], s25 offen offset:2048
    s_waitcnt vmcnt(20)
    v_mfma_f32_32x32x16_bf16 v[16:31], v[64:67], v[68:71], v[16:31]
    buffer_load_dwordx4 v[56:59], v4, s[8:11], s24 offen offset:2816
    buffer_load_dwordx4 v[60:63], v1, s[8:11], s25 offen offset:3072
    s_waitcnt vmcnt(20)
    v_mfma_f32_32x32x16_bf16 v[16:31], v[72:75], v[76:79], v[16:31]
    s_add_u32 s25, s25, 4096
    buffer_load_dwordx4 v[64:67], v4, s[8:11], s24 offen offset:3072
    buffer_load_dwordx4 v[68:71], v1, s[8:11], s25 offen offset:0
    s_waitcnt vmcnt(20)
    v_mfma_f32_32x32x16_bf16 v[16:31], v[80:83], v[84:87], v[16:31]
    buffer_load_dwordx4 v[72:75], v4, s[8:11], s24 offen offset:3328
    buffer_load_dwordx4 v[76:79], v1, s[8:11], s25 offen offset:1024
    s_waitcnt vmcnt(20)
    v_mfma_f32_32x32x16_bf16 v[16:31], v[88:91], v[92:95], v[16:31]
    buffer_load_dwordx4 v[80:83], v4, s[8:11], s24 offen offset:3584
    buffer_load_dwordx4 v[84:87], v1, s[8:11], s25 offen offset:2048
    s_waitcnt vmcnt(20)
    v_mfma_f32_32x32x16_bf16 v[16:31], v[96:99], v[100:103], v[16:31]
    buffer_load_dwordx4 v[88:91], v4, s[8:11], s24 offen offset:3840
    buffer_load_dwordx4 v[92:95], v1, s[8:11], s25 offen offset:3072
    s_waitcnt vmcnt(20)
    v_mfma_f32_32x32x16_bf16 v[16:31], v[104:107], v[108:111], v[16:31]
    s_add_u32 s24, s24, 4096
    s_add_u32 s25, s25, 4096
    buffer_load_dwordx4 v[96:99], v4, s[8:11], s24 offen offset:0
    buffer_load_dwordx4 v[100:103], v1, s[8:11], s25 offen offset:0
    s_waitcnt vmcnt(20)
    v_mfma_f32_32x32x16_bf16 v[16:31], v[112:115], v[116:119], v[16:31]
    buffer_load_dwordx4 v[104:107], v4, s[8:11], s24 offen offset:256
    buffer_load_dwordx4 v[108:111], v1, s[8:11], s25 offen offset:1024
    s_waitcnt vmcnt(20)
    v_mfma_f32_32x32x16_bf16 v[16:31], v[120:123], v[124:127], v[16:31]
    buffer_load_dwordx4 v[112:115], v4, s[8:11], s24 offen offset:512
    buffer_load_dwordx4 v[116:119], v1, s[8:11], s25 offen offset:2048
    s_waitcnt vmcnt(20)
    v_mfma_f32_32x32x16_bf16 v[16:31], v[32:35], v[36:39], v[16:31]
    buffer_load_dwordx4 v[120:123], v4, s[8:11], s24 offen offset:768
    buffer_load_dwordx4 v[124:127], v1, s[8:11], s25 offen offset:3072
    s_waitcnt vmcnt(20)
    v_mfma_f32_32x32x16_bf16 v[16:31], v[40:43], v[44:47], v[16:31]
    s_add_u32 s25, s25, 4096
    buffer_load_dwordx4 v[32:35], v4, s[8:11], s24 offen offset:1024
    buffer_load_dwordx4 v[36:39], v1, s[8:11], s25 offen offset:0
    s_waitcnt vmcnt(20)
    v_mfma_f32_32x32x16_bf16 v[16:31], v[48:51], v[52:55], v[16:31]
    buffer_load_dwordx4 v[40:43], v4, s[8:11], s24 offen offset:1280
    buffer_load_dwordx4 v[44:47], v1, s[8:11], s25 offen offset:1024
    s_waitcnt vmcnt(20)
    v_mfma_f32_32x32x16_bf16 v[16:31], v[56:59], v[60:63], v[16:31]
    buffer_load_dwordx4 v[48:51], v4, s[8:11], s24 offen offset:1536
    buffer_load_dwordx4 v[52:55], v1, s[8:11], s25 offen offset:2048
    s_waitcnt vmcnt(20)
    v_mfma_f32_32x32x16_bf16 v[16:31], v[64:67], v[68:71], v[16:31]
    buffer_load_dwordx4 v[56:59], v4, s[8:11], s24 offen offset:1792
    buffer_load_dwordx4 v[60:63], v1, s[8:11], s25 offen offset:3072
    s_waitcnt vmcnt(20)
    v_mfma_f32_32x32x16_bf16 v[16:31], v[72:75], v[76:79], v[16:31]
    s_add_u32 s25, s25, 4096
    buffer_load_dwordx4 v[64:67], v4, s[8:11], s24 offen offset:2048
    buffer_load_dwordx4 v[68:71], v1, s[8:11], s25 offen offset:0
    s_waitcnt vmcnt(20)
    v_mfma_f32_32x32x16_bf16 v[16:31], v[80:83], v[84:87], v[16:31]
    buffer_load_dwordx4 v[72:75], v4, s[8:11], s24 offen offset:2304
    buffer_load_dwordx4 v[76:79], v1, s[8:11], s25 offen offset:1024
    s_waitcnt vmcnt(20)
    v_mfma_f32_32x32x16_bf16 v[16:31], v[88:91], v[92:95], v[16:31]
    buffer_load_dwordx4 v[80:83], v4, s[8:11], s24 offen offset:2560
    buffer_load_dwordx4 v[84:87], v1, s[8:11], s25 offen offset:2048
    s_waitcnt vmcnt(20)
    v_mfma_f32_32x32x16_bf16 v[16:31], v[96:99], v[100:103], v[16:31]
    buffer_load_dwordx4 v[88:91], v4, s[8:11], s24 offen offset:2816
    buffer_load_dwordx4 v[92:95], v1, s[8:11], s25 offen offset:3072
    s_waitcnt vmcnt(20)
    v_mfma_f32_32x32x16_bf16 v[16:31], v[104:107], v[108:111], v[16:31]
    s_add_u32 s25, s25, 4096
    buffer_load_dwordx4 v[96:99], v4, s[8:11], s24 offen offset:3072
    buffer_load_dwordx4 v[100:103], v1, s[8:11], s25 offen offset:0
    s_waitcnt vmcnt(20)
    v_mfma_f32_32x32x16_bf16 v[16:31], v[112:115], v[116:119], v[16:31]
    buffer_load_dwordx4 v[104:107], v4, s[8:11], s24 offen offset:3328
    buffer_load_dwordx4 v[108:111], v1, s[8:11], s25 offen offset:1024
    s_waitcnt vmcnt(20)
    v_mfma_f32_32x32x16_bf16 v[16:31], v[120:123], v[124:127], v[16:31]
    buffer_load_dwordx4 v[112:115], v4, s[8:11], s24 offen offset:3584
    buffer_load_dwordx4 v[116:119], v1, s[8:11], s25 offen offset:2048
    s_waitcnt vmcnt(20)
    v_mfma_f32_32x32x16_bf16 v[16:31], v[32:35], v[36:39], v[16:31]
    buffer_load_dwordx4 v[120:123], v4, s[8:11], s24 offen offset:3840
    buffer_load_dwordx4 v[124:127], v1, s[8:11], s25 offen offset:3072
    s_waitcnt vmcnt(20)
    v_mfma_f32_32x32x16_bf16 v[16:31], v[40:43], v[44:47], v[16:31]
    s_add_u32 s24, s24, 4096
    s_add_u32 s25, s25, 4096
    buffer_load_dwordx4 v[32:35], v4, s[8:11], s24 offen offset:0
    buffer_load_dwordx4 v[36:39], v1, s[8:11], s25 offen offset:0
    s_waitcnt vmcnt(20)
    v_mfma_f32_32x32x16_bf16 v[16:31], v[48:51], v[52:55], v[16:31]
    buffer_load_dwordx4 v[40:43], v4, s[8:11], s24 offen offset:256
    buffer_load_dwordx4 v[44:47], v1, s[8:11], s25 offen offset:1024
    s_waitcnt vmcnt(20)
    v_mfma_f32_32x32x16_bf16 v[16:31], v[56:59], v[60:63], v[16:31]
    buffer_load_dwordx4 v[48:51], v4, s[8:11], s24 offen offset:512
    buffer_load_dwordx4 v[52:55], v1, s[8:11], s25 offen offset:2048
    s_waitcnt vmcnt(20)
    v_mfma_f32_32x32x16_bf16 v[16:31], v[64:67], v[68:71], v[16:31]
    buffer_load_dwordx4 v[56:59], v4, s[8:11], s24 offen offset:768
    buffer_load_dwordx4 v[60:63], v1, s[8:11], s25 offen offset:3072
    s_waitcnt vmcnt(20)
    v_mfma_f32_32x32x16_bf16 v[16:31], v[72:75], v[76:79], v[16:31]
    s_add_u32 s25, s25, 4096
    buffer_load_dwordx4 v[64:67], v4, s[8:11], s24 offen offset:1024
    buffer_load_dwordx4 v[68:71], v1, s[8:11], s25 offen offset:0
    s_waitcnt vmcnt(20)
    v_mfma_f32_32x32x16_bf16 v[16:31], v[80:83], v[84:87], v[16:31]
    buffer_load_dwordx4 v[72:75], v4, s[8:11], s24 offen offset:1280
    buffer_load_dwordx4 v[76:79], v1, s[8:11], s25 offen offset:1024
    s_waitcnt vmcnt(20)
    v_mfma_f32_32x32x16_bf16 v[16:31], v[88:91], v[92:95], v[16:31]
    buffer_load_dwordx4 v[80:83], v4, s[8:11], s24 offen offset:1536
    buffer_load_dwordx4 v[84:87], v1, s[8:11], s25 offen offset:2048
    s_waitcnt vmcnt(20)
    v_mfma_f32_32x32x16_bf16 v[16:31], v[96:99], v[100:103], v[16:31]
    buffer_load_dwordx4 v[88:91], v4, s[8:11], s24 offen offset:1792
    buffer_load_dwordx4 v[92:95], v1, s[8:11], s25 offen offset:3072
    s_waitcnt vmcnt(20)
    v_mfma_f32_32x32x16_bf16 v[16:31], v[104:107], v[108:111], v[16:31]
    s_add_u32 s25, s25, 4096
    buffer_load_dwordx4 v[96:99], v4, s[8:11], s24 offen offset:2048
    buffer_load_dwordx4 v[100:103], v1, s[8:11], s25 offen offset:0
    s_waitcnt vmcnt(20)
    v_mfma_f32_32x32x16_bf16 v[16:31], v[112:115], v[116:119], v[16:31]
    buffer_load_dwordx4 v[104:107], v4, s[8:11], s24 offen offset:2304
    buffer_load_dwordx4 v[108:111], v1, s[8:11], s25 offen offset:1024
    s_waitcnt vmcnt(20)
    v_mfma_f32_32x32x16_bf16 v[16:31], v[120:123], v[124:127], v[16:31]
    buffer_load_dwordx4 v[112:115], v4, s[8:11], s24 offen offset:2560
    buffer_load_dwordx4 v[116:119], v1, s[8:11], s25 offen offset:2048
    s_waitcnt vmcnt(20)
    v_mfma_f32_32x32x16_bf16 v[16:31], v[32:35], v[36:39], v[16:31]
    buffer_load_dwordx4 v[120:123], v4, s[8:11], s24 offen offset:2816
    buffer_load_dwordx4 v[124:127], v1, s[8:11], s25 offen offset:3072
    s_waitcnt vmcnt(20)
    v_mfma_f32_32x32x16_bf16 v[16:31], v[40:43], v[44:47], v[16:31]
    s_add_u32 s25, s25, 4096
    buffer_load_dwordx4 v[32:35], v4, s[8:11], s24 offen offset:3072
    buffer_load_dwordx4 v[36:39], v1, s[8:11], s25 offen offset:0
    s_waitcnt vmcnt(20)
    v_mfma_f32_32x32x16_bf16 v[16:31], v[48:51], v[52:55], v[16:31]
    buffer_load_dwordx4 v[40:43], v4, s[8:11], s24 offen offset:3328
    buffer_load_dwordx4 v[44:47], v1, s[8:11], s25 offen offset:1024
    s_waitcnt vmcnt(20)
    v_mfma_f32_32x32x16_bf16 v[16:31], v[56:59], v[60:63], v[16:31]
    buffer_load_dwordx4 v[48:51], v4, s[8:11], s24 offen offset:3584
    buffer_load_dwordx4 v[52:55], v1, s[8:11], s25 offen offset:2048
    s_waitcnt vmcnt(20)
    v_mfma_f32_32x32x16_bf16 v[16:31], v[64:67], v[68:71], v[16:31]
    buffer_load_dwordx4 v[56:59], v4, s[8:11], s24 offen offset:3840
    buffer_load_dwordx4 v[60:63], v1, s[8:11], s25 offen offset:3072
    s_waitcnt vmcnt(20)
    v_mfma_f32_32x32x16_bf16 v[16:31], v[72:75], v[76:79], v[16:31]
    s_add_u32 s24, s24, 4096
    s_add_u32 s25, s25, 4096
    buffer_load_dwordx4 v[64:67], v4, s[8:11], s24 offen offset:0
    buffer_load_dwordx4 v[68:71], v1, s[8:11], s25 offen offset:0
    s_waitcnt vmcnt(20)
    v_mfma_f32_32x32x16_bf16 v[16:31], v[80:83], v[84:87], v[16:31]
    buffer_load_dwordx4 v[72:75], v4, s[8:11], s24 offen offset:256
    buffer_load_dwordx4 v[76:79], v1, s[8:11], s25 offen offset:1024
    s_waitcnt vmcnt(20)
    v_mfma_f32_32x32x16_bf16 v[16:31], v[88:91], v[92:95], v[16:31]
    buffer_load_dwordx4 v[80:83], v4, s[8:11], s24 offen offset:512
    buffer_load_dwordx4 v[84:87], v1, s[8:11], s25 offen offset:2048
    s_waitcnt vmcnt(20)
    v_mfma_f32_32x32x16_bf16 v[16:31], v[96:99], v[100:103], v[16:31]
    buffer_load_dwordx4 v[88:91], v4, s[8:11], s24 offen offset:768
    buffer_load_dwordx4 v[92:95], v1, s[8:11], s25 offen offset:3072
    s_waitcnt vmcnt(20)
    v_mfma_f32_32x32x16_bf16 v[16:31], v[104:107], v[108:111], v[16:31]
    s_add_u32 s25, s25, 4096
    buffer_load_dwordx4 v[96:99], v4, s[8:11], s24 offen offset:1024
    buffer_load_dwordx4 v[100:103], v1, s[8:11], s25 offen offset:0
    s_waitcnt vmcnt(20)
    v_mfma_f32_32x32x16_bf16 v[16:31], v[112:115], v[116:119], v[16:31]
    buffer_load_dwordx4 v[104:107], v4, s[8:11], s24 offen offset:1280
    buffer_load_dwordx4 v[108:111], v1, s[8:11], s25 offen offset:1024
    s_waitcnt vmcnt(20)
    v_mfma_f32_32x32x16_bf16 v[16:31], v[120:123], v[124:127], v[16:31]
    buffer_load_dwordx4 v[112:115], v4, s[8:11], s24 offen offset:1536
    buffer_load_dwordx4 v[116:119], v1, s[8:11], s25 offen offset:2048
    s_waitcnt vmcnt(20)
    v_mfma_f32_32x32x16_bf16 v[16:31], v[32:35], v[36:39], v[16:31]
    buffer_load_dwordx4 v[120:123], v4, s[8:11], s24 offen offset:1792
    buffer_load_dwordx4 v[124:127], v1, s[8:11], s25 offen offset:3072
    s_waitcnt vmcnt(20)
    v_mfma_f32_32x32x16_bf16 v[16:31], v[40:43], v[44:47], v[16:31]
    s_add_u32 s25, s25, 4096
    buffer_load_dwordx4 v[32:35], v4, s[8:11], s24 offen offset:2048
    buffer_load_dwordx4 v[36:39], v1, s[8:11], s25 offen offset:0
    s_waitcnt vmcnt(20)
    v_mfma_f32_32x32x16_bf16 v[16:31], v[48:51], v[52:55], v[16:31]
    buffer_load_dwordx4 v[40:43], v4, s[8:11], s24 offen offset:2304
    buffer_load_dwordx4 v[44:47], v1, s[8:11], s25 offen offset:1024
    s_waitcnt vmcnt(20)
    v_mfma_f32_32x32x16_bf16 v[16:31], v[56:59], v[60:63], v[16:31]
    buffer_load_dwordx4 v[48:51], v4, s[8:11], s24 offen offset:2560
    buffer_load_dwordx4 v[52:55], v1, s[8:11], s25 offen offset:2048
    s_waitcnt vmcnt(20)
    v_mfma_f32_32x32x16_bf16 v[16:31], v[64:67], v[68:71], v[16:31]
    buffer_load_dwordx4 v[56:59], v4, s[8:11], s24 offen offset:2816
    buffer_load_dwordx4 v[60:63], v1, s[8:11], s25 offen offset:3072
    s_waitcnt vmcnt(20)
    v_mfma_f32_32x32x16_bf16 v[16:31], v[72:75], v[76:79], v[16:31]
    s_add_u32 s25, s25, 4096
    buffer_load_dwordx4 v[64:67], v4, s[8:11], s24 offen offset:3072
    buffer_load_dwordx4 v[68:71], v1, s[8:11], s25 offen offset:0
    s_waitcnt vmcnt(20)
    v_mfma_f32_32x32x16_bf16 v[16:31], v[80:83], v[84:87], v[16:31]
    buffer_load_dwordx4 v[72:75], v4, s[8:11], s24 offen offset:3328
    buffer_load_dwordx4 v[76:79], v1, s[8:11], s25 offen offset:1024
    s_waitcnt vmcnt(20)
    v_mfma_f32_32x32x16_bf16 v[16:31], v[88:91], v[92:95], v[16:31]
    buffer_load_dwordx4 v[80:83], v4, s[8:11], s24 offen offset:3584
    buffer_load_dwordx4 v[84:87], v1, s[8:11], s25 offen offset:2048
    s_waitcnt vmcnt(20)
    v_mfma_f32_32x32x16_bf16 v[16:31], v[96:99], v[100:103], v[16:31]
    buffer_load_dwordx4 v[88:91], v4, s[8:11], s24 offen offset:3840
    buffer_load_dwordx4 v[92:95], v1, s[8:11], s25 offen offset:3072
    s_waitcnt vmcnt(20)
    v_mfma_f32_32x32x16_bf16 v[16:31], v[104:107], v[108:111], v[16:31]
    s_waitcnt vmcnt(18)
    v_mfma_f32_32x32x16_bf16 v[16:31], v[112:115], v[116:119], v[16:31]
    s_waitcnt vmcnt(16)
    v_mfma_f32_32x32x16_bf16 v[16:31], v[120:123], v[124:127], v[16:31]
    s_waitcnt vmcnt(14)
    v_mfma_f32_32x32x16_bf16 v[16:31], v[32:35], v[36:39], v[16:31]
    s_waitcnt vmcnt(12)
    v_mfma_f32_32x32x16_bf16 v[16:31], v[40:43], v[44:47], v[16:31]
    s_waitcnt vmcnt(10)
    v_mfma_f32_32x32x16_bf16 v[16:31], v[48:51], v[52:55], v[16:31]
    s_waitcnt vmcnt(8)
    v_mfma_f32_32x32x16_bf16 v[16:31], v[56:59], v[60:63], v[16:31]
    s_waitcnt vmcnt(6)
    v_mfma_f32_32x32x16_bf16 v[16:31], v[64:67], v[68:71], v[16:31]
    s_waitcnt vmcnt(4)
    v_mfma_f32_32x32x16_bf16 v[16:31], v[72:75], v[76:79], v[16:31]
    s_waitcnt vmcnt(2)
    v_mfma_f32_32x32x16_bf16 v[16:31], v[80:83], v[84:87], v[16:31]
    s_waitcnt vmcnt(0)
    v_mfma_f32_32x32x16_bf16 v[16:31], v[88:91], v[92:95], v[16:31]
    s_nop 7
    s_nop 7
    v_cvt_pk_bf16_f32 v32, v16, v17
    v_cvt_pk_bf16_f32 v33, v18, v19
    v_cvt_pk_bf16_f32 v34, v20, v21
    v_cvt_pk_bf16_f32 v35, v22, v23
    s_nop 1
    v_permlane32_swap_b32 v32, v34
    v_permlane32_swap_b32 v33, v35
    s_nop 1
    v_lshlrev_b32 v40, 16, v32
    v_and_b32 v41, 0xffff0000, v32
    v_lshlrev_b32 v42, 16, v8
    v_and_b32 v43, 0xffff0000, v8
    v_add_f32 v40, v40, v42
    v_add_f32 v41, v41, v43
    v_cvt_pk_bf16_f32 v32, v40, v41
    v_lshlrev_b32 v40, 16, v33
    v_and_b32 v41, 0xffff0000, v33
    v_lshlrev_b32 v42, 16, v9
    v_and_b32 v43, 0xffff0000, v9
    v_add_f32 v40, v40, v42
    v_add_f32 v41, v41, v43
    v_cvt_pk_bf16_f32 v33, v40, v41
    v_lshlrev_b32 v40, 16, v34
    v_and_b32 v41, 0xffff0000, v34
    v_lshlrev_b32 v42, 16, v10
    v_and_b32 v43, 0xffff0000, v10
    v_add_f32 v40, v40, v42
    v_add_f32 v41, v41, v43
    v_cvt_pk_bf16_f32 v34, v40, v41
    v_lshlrev_b32 v40, 16, v35
    v_and_b32 v41, 0xffff0000, v35
    v_lshlrev_b32 v42, 16, v11
    v_and_b32 v43, 0xffff0000, v11
    v_add_f32 v40, v40, v42
    v_add_f32 v41, v41, v43
    v_cvt_pk_bf16_f32 v35, v40, v41
    buffer_store_dwordx4 v[32:35], v6, s[16:19], s26 offen offset:0
    v_cvt_pk_bf16_f32 v36, v24, v25
    v_cvt_pk_bf16_f32 v37, v26, v27
    v_cvt_pk_bf16_f32 v38, v28, v29
    v_cvt_pk_bf16_f32 v39, v30, v31
    s_nop 1
    v_permlane32_swap_b32 v36, v38
    v_permlane32_swap_b32 v37, v39
    s_nop 1
    v_lshlrev_b32 v40, 16, v36
    v_and_b32 v41, 0xffff0000, v36
    v_lshlrev_b32 v42, 16, v12
    v_and_b32 v43, 0xffff0000, v12
    v_add_f32 v40, v40, v42
    v_add_f32 v41, v41, v43
    v_cvt_pk_bf16_f32 v36, v40, v41
    v_lshlrev_b32 v40, 16, v37
    v_and_b32 v41, 0xffff0000, v37
    v_lshlrev_b32 v42, 16, v13
    v_and_b32 v43, 0xffff0000, v13
    v_add_f32 v40, v40, v42
    v_add_f32 v41, v41, v43
    v_cvt_pk_bf16_f32 v37, v40, v41
    v_lshlrev_b32 v40, 16, v38
    v_and_b32 v41, 0xffff0000, v38
    v_lshlrev_b32 v42, 16, v14
    v_and_b32 v43, 0xffff0000, v14
    v_add_f32 v40, v40, v42
    v_add_f32 v41, v41, v43
    v_cvt_pk_bf16_f32 v38, v40, v41
    v_lshlrev_b32 v40, 16, v39
    v_and_b32 v41, 0xffff0000, v39
    v_lshlrev_b32 v42, 16, v15
    v_and_b32 v43, 0xffff0000, v15
    v_add_f32 v40, v40, v42
    v_add_f32 v41, v41, v43
    v_cvt_pk_bf16_f32 v39, v40, v41
    buffer_store_dwordx4 v[36:39], v6, s[16:19], s26 offen offset:32
w3b2_kernel_end:
    s_endpgm
.section .rodata,"a"
.p2align 6
.amdhsa_kernel w3b2_kernel
  .amdhsa_next_free_vgpr 128
  .amdhsa_next_free_sgpr 48
  .amdhsa_accum_offset 128
  .amdhsa_group_segment_fixed_size 0
  .amdhsa_kernarg_size 104
  .amdhsa_user_sgpr_count 2
  .amdhsa_user_sgpr_kernarg_segment_ptr 1
  .amdhsa_system_sgpr_workgroup_id_x 1
.end_amdhsa_kernel
```

```asm
; @launch kernel=pack_kernel grid=(864,1,1) block=(256,1,1) lds=0
; @launch kernel=prep_kernel grid=(465,1,1) block=(256,1,1) lds=0
; @launch kernel=ln_a1_kernel grid=(512,1,1) block=(256,1,1) lds=0
; @launch kernel=qkv_a_kernel grid=(192,1,1) block=(256,1,1) lds=0
; @launch kernel=kvz_a1_kernel grid=(128,1,1) block=(256,1,1) lds=0
; @launch kernel=attn_a1_kernel grid=(256,1,1) block=(256,1,1) lds=86016
; @launch kernel=wo_a1_kernel grid=(128,1,1) block=(256,1,1) lds=0
; @launch kernel=ln_b1_kernel grid=(513,1,1) block=(256,1,1) lds=0
; @launch kernel=layerb1_kernel grid=(256,1,1) block=(256,1,1) lds=143616
; @launch kernel=ln_a2_kernel grid=(512,1,1) block=(256,1,1) lds=0
; @launch kernel=qkv_a_kernel grid=(192,1,1) block=(256,1,1) lds=0
; @launch kernel=kvz_a2_kernel grid=(128,1,1) block=(256,1,1) lds=0
; @launch kernel=attn_a2_kernel grid=(256,1,1) block=(256,1,1) lds=86016
; @launch kernel=wo_a2_kernel grid=(128,1,1) block=(256,1,1) lds=0
; @launch kernel=ln_b2_kernel grid=(513,1,1) block=(256,1,1) lds=0
; @launch kernel=layerb2_kernel grid=(256,1,1) block=(256,1,1) lds=143616
.amdgcn_target "amdgcn-amd-amdhsa--gfx950"
.text
.globl pack_kernel
.p2align 8
.type pack_kernel,@function
pack_kernel:
    v_lshrrev_b32 v1, 6, v0
    v_and_b32 v2, 63, v0
    s_nop 0
    v_readfirstlane_b32 s3, v1
    s_lshl_b32 s4, s2, 2
    s_add_u32 s4, s4, s3
    s_load_dwordx2 s[6:7], s[0:1], 96
    s_waitcnt lgkmcnt(0)
    s_mov_b32 s8, s6
    s_mov_b32 s9, s7
    s_mov_b32 s10, 268435456
    s_mov_b32 s11, 0x00020000
    s_cmp_lt_u32 s4, 3200
    s_cbranch_scc1 pack_kernel_pk
    s_cmp_ge_u32 s4, 3456
    s_cbranch_scc1 pack_kernel_end
    s_sub_u32 s4, s4, 3200
    s_lshl_b32 s5, s4, 10
    v_lshlrev_b32 v3, 4, v2
    v_add_u32 v3, s5, v3
    v_add_u32 v4, 242221056, v3
    s_cmp_lt_u32 s5, 0
    s_cbranch_scc1 pack_kernel_clr
    v_add_u32 v4, 242221056, v3
pack_kernel_clr:
    v_mov_b32 v8, 0
    v_mov_b32 v9, 0
    v_mov_b32 v10, 0
    v_mov_b32 v11, 0
    buffer_store_dwordx4 v[8:11], v4, s[8:11], 0 offen
    s_branch pack_kernel_end
pack_kernel_pk:
    s_cmp_lt_u32 s4, 2400
    s_cbranch_scc0 pack_kernel_nx0
    s_sub_u32 s4, s4, 0
    s_load_dwordx2 s[12:13], s[0:1], 8
    s_mov_b32 s20, 1920
    s_mov_b32 s21, 20
    s_mov_b32 s22, 243269632
    s_mov_b32 s23, 2457600
    s_mul_i32 s24, s4, 1639
    s_lshr_b32 s24, s24, 15
    s_branch pack_kernel_go
pack_kernel_nx0:
    s_cmp_lt_u32 s4, 3200
    s_cbranch_scc0 pack_kernel_nx1
    s_sub_u32 s4, s4, 2400
    s_load_dwordx2 s[12:13], s[0:1], 16
    s_mov_b32 s20, 640
    s_mov_b32 s21, 20
    s_mov_b32 s22, 246415360
    s_mov_b32 s23, 819200
    s_mul_i32 s24, s4, 205
    s_lshr_b32 s24, s24, 12
    s_branch pack_kernel_go
pack_kernel_nx1:
    s_branch pack_kernel_end
pack_kernel_go:
    s_waitcnt lgkmcnt(0)
    s_mov_b32 s16, s12
    s_mov_b32 s17, s13
    s_mov_b32 s18, s23
    s_mov_b32 s19, 0x00020000
    s_mul_i32 s25, s24, s21
    s_sub_u32 s25, s4, s25
    v_lshrrev_b32 v3, 4, v2
    v_lshlrev_b32 v3, 3, v3
    s_lshl_b32 s26, s25, 5
    v_add_u32 v3, s26, v3
    v_mul_lo_u32 v3, v3, s20
    v_and_b32 v4, 15, v2
    s_lshl_b32 s27, s24, 4
    v_add3_u32 v3, v3, v4, s27
    v_lshlrev_b32 v3, 1, v3
    s_lshl_b32 s28, s20, 1
    s_mov_b32 s29, 0
    buffer_load_ushort v12, v3, s[16:19], s29 offen
    s_add_u32 s29, s29, s28
    buffer_load_ushort v13, v3, s[16:19], s29 offen
    s_add_u32 s29, s29, s28
    buffer_load_ushort v14, v3, s[16:19], s29 offen
    s_add_u32 s29, s29, s28
    buffer_load_ushort v15, v3, s[16:19], s29 offen
    s_add_u32 s29, s29, s28
    buffer_load_ushort v16, v3, s[16:19], s29 offen
    s_add_u32 s29, s29, s28
    buffer_load_ushort v17, v3, s[16:19], s29 offen
    s_add_u32 s29, s29, s28
    buffer_load_ushort v18, v3, s[16:19], s29 offen
    s_add_u32 s29, s29, s28
    buffer_load_ushort v19, v3, s[16:19], s29 offen
    s_lshl_b32 s5, s4, 10
    s_add_u32 s5, s5, s22
    v_lshlrev_b32 v5, 4, v2
    v_add_u32 v5, s5, v5
    s_waitcnt vmcnt(0)
    v_lshl_or_b32 v8, v13, 16, v12
    v_lshl_or_b32 v9, v15, 16, v14
    v_lshl_or_b32 v10, v17, 16, v16
    v_lshl_or_b32 v11, v19, 16, v18
    buffer_store_dwordx4 v[8:11], v5, s[8:11], 0 offen
pack_kernel_end:
    s_endpgm
.section .rodata,"a"
.p2align 6
.amdhsa_kernel pack_kernel
  .amdhsa_next_free_vgpr 24
  .amdhsa_next_free_sgpr 40
  .amdhsa_accum_offset 24
  .amdhsa_group_segment_fixed_size 0
  .amdhsa_kernarg_size 104
  .amdhsa_user_sgpr_count 2
  .amdhsa_user_sgpr_kernarg_segment_ptr 1
  .amdhsa_system_sgpr_workgroup_id_x 1
.end_amdhsa_kernel
.text
.globl prep_kernel
.p2align 8
.type prep_kernel,@function
prep_kernel:
    s_cmp_ge_u32 s2, 465
    s_cbranch_scc1 prep_kernel_end
    s_load_dwordx2 s[4:5], s[0:1], 96
    v_lshrrev_b32 v1, 6, v0
    v_and_b32 v0, 63, v0
    s_nop 0
    v_readfirstlane_b32 s13, v1
    s_waitcnt lgkmcnt(0)
    s_mov_b32 s8, s4
    s_mov_b32 s9, s5
    s_mov_b32 s10, 268435456
    s_mov_b32 s11, 0x00020000
    s_cmp_eq_u32 s2, 0
    s_cbranch_scc1 prep_kernel_r_ctl
    s_sub_u32 s20, s2, 1
    s_cmp_lt_u32 s20, 160
    s_cbranch_scc1 prep_kernel_r_wvo
    s_sub_u32 s20, s20, 160
    s_cmp_lt_u32 s20, 240
    s_cbranch_scc1 prep_kernel_r_pwp
    s_sub_u32 s20, s20, 240
    s_sub_u32 s21, 0, s4
    s_and_b32 s21, s21, 0x1fffff
    s_mul_i32 s22, s20, 131072
    s_add_u32 s21, s21, s22
    s_lshl_b32 s22, s13, 10
    s_add_u32 s21, s21, s22
    v_lshlrev_b32 v1, 4, v0
    v_mov_b32 v4, -1
    v_mov_b32 v5, -1
    v_mov_b32 v6, -1
    v_mov_b32 v7, -1
    s_mov_b32 s22, 32
prep_kernel_clr_loop:
    buffer_store_dwordx4 v[4:7], v1, s[8:11], s21 offen
    s_add_u32 s21, s21, 4096
    s_sub_u32 s22, s22, 1
    s_cmp_lg_u32 s22, 0
    s_cbranch_scc1 prep_kernel_clr_loop
    s_branch prep_kernel_end
prep_kernel_r_ctl:
    v_lshlrev_b32 v1, 4, v0
    v_mov_b32 v4, 0
    v_mov_b32 v5, 0
    v_mov_b32 v6, 0
    v_mov_b32 v7, 0
    s_lshl_b32 s21, s13, 10
    s_add_u32 s21, s21, 10485760
    buffer_store_dwordx4 v[4:7], v1, s[8:11], s21 offen
    s_lshl_b32 s21, s13, 14
    s_add_u32 s21, s21, 10616832
    buffer_store_dwordx4 v[4:7], v1, s[8:11], s21 offen offset:0
    buffer_store_dwordx4 v[4:7], v1, s[8:11], s21 offen offset:1024
    buffer_store_dwordx4 v[4:7], v1, s[8:11], s21 offen offset:2048
    buffer_store_dwordx4 v[4:7], v1, s[8:11], s21 offen offset:3072
    s_add_u32 s21, s21, 4096
    buffer_store_dwordx4 v[4:7], v1, s[8:11], s21 offen offset:0
    buffer_store_dwordx4 v[4:7], v1, s[8:11], s21 offen offset:1024
    buffer_store_dwordx4 v[4:7], v1, s[8:11], s21 offen offset:2048
    buffer_store_dwordx4 v[4:7], v1, s[8:11], s21 offen offset:3072
    s_add_u32 s21, s21, 4096
    buffer_store_dwordx4 v[4:7], v1, s[8:11], s21 offen offset:0
    buffer_store_dwordx4 v[4:7], v1, s[8:11], s21 offen offset:1024
    buffer_store_dwordx4 v[4:7], v1, s[8:11], s21 offen offset:2048
    buffer_store_dwordx4 v[4:7], v1, s[8:11], s21 offen offset:3072
    s_add_u32 s21, s21, 4096
    buffer_store_dwordx4 v[4:7], v1, s[8:11], s21 offen offset:0
    buffer_store_dwordx4 v[4:7], v1, s[8:11], s21 offen offset:1024
    buffer_store_dwordx4 v[4:7], v1, s[8:11], s21 offen offset:2048
    buffer_store_dwordx4 v[4:7], v1, s[8:11], s21 offen offset:3072
    s_add_u32 s21, s21, 4096
    s_sub_u32 s22, 0, s4
    s_and_b32 s22, s22, 0x1fffff
    s_getreg_b32 s23, hwreg(HW_REG_XCC_ID)
    s_bfe_u32 s23, s23, 0x10002
    s_mov_b64 exec, 1
    v_mov_b32 v1, 0
    s_mul_i32 s24, s13, 2097152
    s_add_u32 s22, s22, s24
    s_add_u32 s22, s22, 2086912
    s_mov_b32 s30, -1
    s_mov_b32 s31, -1
    s_mov_b32 s25, 5
prep_kernel_cal:
    s_add_u32 s24, s22, 0
    s_memrealtime s[26:27]
    s_waitcnt lgkmcnt(0)
    buffer_store_dword v1, v1, s[8:11], s24 offen sc1
    s_waitcnt vmcnt(0)
    buffer_load_dword v2, v1, s[8:11], s24 offen sc1
    s_waitcnt vmcnt(0)
    s_memrealtime s[28:29]
    s_waitcnt lgkmcnt(0)
    s_sub_u32 s26, s28, s26
    s_min_u32 s30, s30, s26
    s_add_u32 s24, s22, 8192
    s_memrealtime s[26:27]
    s_waitcnt lgkmcnt(0)
    buffer_store_dword v1, v1, s[8:11], s24 offen sc1
    s_waitcnt vmcnt(0)
    buffer_load_dword v2, v1, s[8:11], s24 offen sc1
    s_waitcnt vmcnt(0)
    s_memrealtime s[28:29]
    s_waitcnt lgkmcnt(0)
    s_sub_u32 s26, s28, s26
    s_min_u32 s31, s31, s26
    s_sub_u32 s25, s25, 1
    s_cmp_lg_u32 s25, 0
    s_cbranch_scc1 prep_kernel_cal
    s_cmp_lt_u32 s31, s30
    s_cselect_b32 s24, 1, 0
    s_xor_b32 s24, s24, s23
    s_lshl_b32 s24, s24, 13
    v_mov_b32 v3, s24
    s_lshl_b32 s25, s13, 2
    s_add_u32 s25, s25, 10551296
    buffer_store_dword v3, v1, s[8:11], s25 offen
    s_lshl_b32 s26, s30, 16
    s_or_b32 s26, s26, s31
    v_mov_b32 v3, s26
    buffer_store_dword v3, v1, s[8:11], s25 offen offset:64
    s_branch prep_kernel_end
prep_kernel_r_wvo:
    s_lshl_b32 s20, s20, 2
    s_add_u32 s20, s20, s13
    s_load_dwordx2 s[24:25], s[0:1], 56
    s_load_dwordx2 s[26:27], s[0:1], 64
    s_and_b32 s21, s20, 1
    s_lshr_b32 s22, s20, 1
    s_mul_i32 s23, s22, 205
    s_lshr_b32 s23, s23, 11
    s_mul_i32 s28, s23, 10
    s_sub_u32 s22, s22, s28
    s_waitcnt lgkmcnt(0)
    s_mov_b32 s32, s24
    s_mov_b32 s33, s25
    s_mov_b32 s34, 7864320
    s_mov_b32 s35, 0x00020000
    s_mov_b32 s36, s26
    s_mov_b32 s37, s27
    s_mov_b32 s38, 7864320
    s_mov_b32 s39, 0x00020000
    v_and_b32 v1, 31, v0
    v_lshrrev_b32 v2, 5, v0
    v_mul_u32_u24 v3, 10240, v2
    v_lshl_add_u32 v3, v1, 2, v3
    s_mul_i32 s28, s23, 245760
    s_lshl_b32 s29, s22, 7
    s_add_u32 s28, s28, s29
    s_add_u32 s29, s28, 0
    buffer_load_dword v112, v3, s[36:39], s29 offen
    s_add_u32 s29, s28, 1280
    buffer_load_dword v113, v3, s[36:39], s29 offen
    s_add_u32 s29, s28, 2560
    buffer_load_dword v114, v3, s[36:39], s29 offen
    s_add_u32 s29, s28, 3840
    buffer_load_dword v115, v3, s[36:39], s29 offen
    s_add_u32 s29, s28, 5120
    buffer_load_dword v116, v3, s[36:39], s29 offen
    s_add_u32 s29, s28, 6400
    buffer_load_dword v117, v3, s[36:39], s29 offen
    s_add_u32 s29, s28, 7680
    buffer_load_dword v118, v3, s[36:39], s29 offen
    s_add_u32 s29, s28, 8960
    buffer_load_dword v119, v3, s[36:39], s29 offen
    s_add_u32 s29, s28, 20480
    buffer_load_dword v120, v3, s[36:39], s29 offen
    s_add_u32 s29, s28, 21760
    buffer_load_dword v121, v3, s[36:39], s29 offen
    s_add_u32 s29, s28, 23040
    buffer_load_dword v122, v3, s[36:39], s29 offen
    s_add_u32 s29, s28, 24320
    buffer_load_dword v123, v3, s[36:39], s29 offen
    s_add_u32 s29, s28, 25600
    buffer_load_dword v124, v3, s[36:39], s29 offen
    s_add_u32 s29, s28, 26880
    buffer_load_dword v125, v3, s[36:39], s29 offen
    s_add_u32 s29, s28, 28160
    buffer_load_dword v126, v3, s[36:39], s29 offen
    s_add_u32 s29, s28, 29440
    buffer_load_dword v127, v3, s[36:39], s29 offen
    s_add_u32 s29, s28, 40960
    buffer_load_dword v128, v3, s[36:39], s29 offen
    s_add_u32 s29, s28, 42240
    buffer_load_dword v129, v3, s[36:39], s29 offen
    s_add_u32 s29, s28, 43520
    buffer_load_dword v130, v3, s[36:39], s29 offen
    s_add_u32 s29, s28, 44800
    buffer_load_dword v131, v3, s[36:39], s29 offen
    s_add_u32 s29, s28, 46080
    buffer_load_dword v132, v3, s[36:39], s29 offen
    s_add_u32 s29, s28, 47360
    buffer_load_dword v133, v3, s[36:39], s29 offen
    s_add_u32 s29, s28, 48640
    buffer_load_dword v134, v3, s[36:39], s29 offen
    s_add_u32 s29, s28, 49920
    buffer_load_dword v135, v3, s[36:39], s29 offen
    s_add_u32 s29, s28, 61440
    buffer_load_dword v136, v3, s[36:39], s29 offen
    s_add_u32 s29, s28, 62720
    buffer_load_dword v137, v3, s[36:39], s29 offen
    s_add_u32 s29, s28, 64000
    buffer_load_dword v138, v3, s[36:39], s29 offen
    s_add_u32 s29, s28, 65280
    buffer_load_dword v139, v3, s[36:39], s29 offen
    s_add_u32 s29, s28, 66560
    buffer_load_dword v140, v3, s[36:39], s29 offen
    s_add_u32 s29, s28, 67840
    buffer_load_dword v141, v3, s[36:39], s29 offen
    s_add_u32 s29, s28, 69120
    buffer_load_dword v142, v3, s[36:39], s29 offen
    s_add_u32 s29, s28, 70400
    buffer_load_dword v143, v3, s[36:39], s29 offen
    s_add_u32 s29, s28, 81920
    buffer_load_dword v144, v3, s[36:39], s29 offen
    s_add_u32 s29, s28, 83200
    buffer_load_dword v145, v3, s[36:39], s29 offen
    s_add_u32 s29, s28, 84480
    buffer_load_dword v146, v3, s[36:39], s29 offen
    s_add_u32 s29, s28, 85760
    buffer_load_dword v147, v3, s[36:39], s29 offen
    s_add_u32 s29, s28, 87040
    buffer_load_dword v148, v3, s[36:39], s29 offen
    s_add_u32 s29, s28, 88320
    buffer_load_dword v149, v3, s[36:39], s29 offen
    s_add_u32 s29, s28, 89600
    buffer_load_dword v150, v3, s[36:39], s29 offen
    s_add_u32 s29, s28, 90880
    buffer_load_dword v151, v3, s[36:39], s29 offen
    s_add_u32 s29, s28, 102400
    buffer_load_dword v152, v3, s[36:39], s29 offen
    s_add_u32 s29, s28, 103680
    buffer_load_dword v153, v3, s[36:39], s29 offen
    s_add_u32 s29, s28, 104960
    buffer_load_dword v154, v3, s[36:39], s29 offen
    s_add_u32 s29, s28, 106240
    buffer_load_dword v155, v3, s[36:39], s29 offen
    s_add_u32 s29, s28, 107520
    buffer_load_dword v156, v3, s[36:39], s29 offen
    s_add_u32 s29, s28, 108800
    buffer_load_dword v157, v3, s[36:39], s29 offen
    s_add_u32 s29, s28, 110080
    buffer_load_dword v158, v3, s[36:39], s29 offen
    s_add_u32 s29, s28, 111360
    buffer_load_dword v159, v3, s[36:39], s29 offen
    v_mov_b32 v4, 0x05040100
    v_mov_b32 v5, 0x07060302
    s_waitcnt vmcnt(0)
    v_perm_b32 v16, v113, v112, v4
    v_perm_b32 v64, v113, v112, v5
    v_perm_b32 v17, v115, v114, v4
    v_perm_b32 v65, v115, v114, v5
    v_perm_b32 v18, v117, v116, v4
    v_perm_b32 v66, v117, v116, v5
    v_perm_b32 v19, v119, v118, v4
    v_perm_b32 v67, v119, v118, v5
    v_perm_b32 v20, v121, v120, v4
    v_perm_b32 v68, v121, v120, v5
    v_perm_b32 v21, v123, v122, v4
    v_perm_b32 v69, v123, v122, v5
    v_perm_b32 v22, v125, v124, v4
    v_perm_b32 v70, v125, v124, v5
    v_perm_b32 v23, v127, v126, v4
    v_perm_b32 v71, v127, v126, v5
    v_perm_b32 v24, v129, v128, v4
    v_perm_b32 v72, v129, v128, v5
    v_perm_b32 v25, v131, v130, v4
    v_perm_b32 v73, v131, v130, v5
    v_perm_b32 v26, v133, v132, v4
    v_perm_b32 v74, v133, v132, v5
    v_perm_b32 v27, v135, v134, v4
    v_perm_b32 v75, v135, v134, v5
    v_perm_b32 v28, v137, v136, v4
    v_perm_b32 v76, v137, v136, v5
    v_perm_b32 v29, v139, v138, v4
    v_perm_b32 v77, v139, v138, v5
    v_perm_b32 v30, v141, v140, v4
    v_perm_b32 v78, v141, v140, v5
    v_perm_b32 v31, v143, v142, v4
    v_perm_b32 v79, v143, v142, v5
    v_perm_b32 v32, v145, v144, v4
    v_perm_b32 v80, v145, v144, v5
    v_perm_b32 v33, v147, v146, v4
    v_perm_b32 v81, v147, v146, v5
    v_perm_b32 v34, v149, v148, v4
    v_perm_b32 v82, v149, v148, v5
    v_perm_b32 v35, v151, v150, v4
    v_perm_b32 v83, v151, v150, v5
    v_perm_b32 v36, v153, v152, v4
    v_perm_b32 v84, v153, v152, v5
    v_perm_b32 v37, v155, v154, v4
    v_perm_b32 v85, v155, v154, v5
    v_perm_b32 v38, v157, v156, v4
    v_perm_b32 v86, v157, v156, v5
    v_perm_b32 v39, v159, v158, v4
    v_perm_b32 v87, v159, v158, v5
    s_add_u32 s29, s28, 122880
    buffer_load_dword v112, v3, s[36:39], s29 offen
    s_add_u32 s29, s28, 124160
    buffer_load_dword v113, v3, s[36:39], s29 offen
    s_add_u32 s29, s28, 125440
    buffer_load_dword v114, v3, s[36:39], s29 offen
    s_add_u32 s29, s28, 126720
    buffer_load_dword v115, v3, s[36:39], s29 offen
    s_add_u32 s29, s28, 128000
    buffer_load_dword v116, v3, s[36:39], s29 offen
    s_add_u32 s29, s28, 129280
    buffer_load_dword v117, v3, s[36:39], s29 offen
    s_add_u32 s29, s28, 130560
    buffer_load_dword v118, v3, s[36:39], s29 offen
    s_add_u32 s29, s28, 131840
    buffer_load_dword v119, v3, s[36:39], s29 offen
    s_add_u32 s29, s28, 143360
    buffer_load_dword v120, v3, s[36:39], s29 offen
    s_add_u32 s29, s28, 144640
    buffer_load_dword v121, v3, s[36:39], s29 offen
    s_add_u32 s29, s28, 145920
    buffer_load_dword v122, v3, s[36:39], s29 offen
    s_add_u32 s29, s28, 147200
    buffer_load_dword v123, v3, s[36:39], s29 offen
    s_add_u32 s29, s28, 148480
    buffer_load_dword v124, v3, s[36:39], s29 offen
    s_add_u32 s29, s28, 149760
    buffer_load_dword v125, v3, s[36:39], s29 offen
    s_add_u32 s29, s28, 151040
    buffer_load_dword v126, v3, s[36:39], s29 offen
    s_add_u32 s29, s28, 152320
    buffer_load_dword v127, v3, s[36:39], s29 offen
    s_add_u32 s29, s28, 163840
    buffer_load_dword v128, v3, s[36:39], s29 offen
    s_add_u32 s29, s28, 165120
    buffer_load_dword v129, v3, s[36:39], s29 offen
    s_add_u32 s29, s28, 166400
    buffer_load_dword v130, v3, s[36:39], s29 offen
    s_add_u32 s29, s28, 167680
    buffer_load_dword v131, v3, s[36:39], s29 offen
    s_add_u32 s29, s28, 168960
    buffer_load_dword v132, v3, s[36:39], s29 offen
    s_add_u32 s29, s28, 170240
    buffer_load_dword v133, v3, s[36:39], s29 offen
    s_add_u32 s29, s28, 171520
    buffer_load_dword v134, v3, s[36:39], s29 offen
    s_add_u32 s29, s28, 172800
    buffer_load_dword v135, v3, s[36:39], s29 offen
    s_add_u32 s29, s28, 184320
    buffer_load_dword v136, v3, s[36:39], s29 offen
    s_add_u32 s29, s28, 185600
    buffer_load_dword v137, v3, s[36:39], s29 offen
    s_add_u32 s29, s28, 186880
    buffer_load_dword v138, v3, s[36:39], s29 offen
    s_add_u32 s29, s28, 188160
    buffer_load_dword v139, v3, s[36:39], s29 offen
    s_add_u32 s29, s28, 189440
    buffer_load_dword v140, v3, s[36:39], s29 offen
    s_add_u32 s29, s28, 190720
    buffer_load_dword v141, v3, s[36:39], s29 offen
    s_add_u32 s29, s28, 192000
    buffer_load_dword v142, v3, s[36:39], s29 offen
    s_add_u32 s29, s28, 193280
    buffer_load_dword v143, v3, s[36:39], s29 offen
    s_add_u32 s29, s28, 204800
    buffer_load_dword v144, v3, s[36:39], s29 offen
    s_add_u32 s29, s28, 206080
    buffer_load_dword v145, v3, s[36:39], s29 offen
    s_add_u32 s29, s28, 207360
    buffer_load_dword v146, v3, s[36:39], s29 offen
    s_add_u32 s29, s28, 208640
    buffer_load_dword v147, v3, s[36:39], s29 offen
    s_add_u32 s29, s28, 209920
    buffer_load_dword v148, v3, s[36:39], s29 offen
    s_add_u32 s29, s28, 211200
    buffer_load_dword v149, v3, s[36:39], s29 offen
    s_add_u32 s29, s28, 212480
    buffer_load_dword v150, v3, s[36:39], s29 offen
    s_add_u32 s29, s28, 213760
    buffer_load_dword v151, v3, s[36:39], s29 offen
    s_add_u32 s29, s28, 225280
    buffer_load_dword v152, v3, s[36:39], s29 offen
    s_add_u32 s29, s28, 226560
    buffer_load_dword v153, v3, s[36:39], s29 offen
    s_add_u32 s29, s28, 227840
    buffer_load_dword v154, v3, s[36:39], s29 offen
    s_add_u32 s29, s28, 229120
    buffer_load_dword v155, v3, s[36:39], s29 offen
    s_add_u32 s29, s28, 230400
    buffer_load_dword v156, v3, s[36:39], s29 offen
    s_add_u32 s29, s28, 231680
    buffer_load_dword v157, v3, s[36:39], s29 offen
    s_add_u32 s29, s28, 232960
    buffer_load_dword v158, v3, s[36:39], s29 offen
    s_add_u32 s29, s28, 234240
    buffer_load_dword v159, v3, s[36:39], s29 offen
    v_mov_b32 v4, 0x05040100
    v_mov_b32 v5, 0x07060302
    s_waitcnt vmcnt(0)
    v_perm_b32 v40, v113, v112, v4
    v_perm_b32 v88, v113, v112, v5
    v_perm_b32 v41, v115, v114, v4
    v_perm_b32 v89, v115, v114, v5
    v_perm_b32 v42, v117, v116, v4
    v_perm_b32 v90, v117, v116, v5
    v_perm_b32 v43, v119, v118, v4
    v_perm_b32 v91, v119, v118, v5
    v_perm_b32 v44, v121, v120, v4
    v_perm_b32 v92, v121, v120, v5
    v_perm_b32 v45, v123, v122, v4
    v_perm_b32 v93, v123, v122, v5
    v_perm_b32 v46, v125, v124, v4
    v_perm_b32 v94, v125, v124, v5
    v_perm_b32 v47, v127, v126, v4
    v_perm_b32 v95, v127, v126, v5
    v_perm_b32 v48, v129, v128, v4
    v_perm_b32 v96, v129, v128, v5
    v_perm_b32 v49, v131, v130, v4
    v_perm_b32 v97, v131, v130, v5
    v_perm_b32 v50, v133, v132, v4
    v_perm_b32 v98, v133, v132, v5
    v_perm_b32 v51, v135, v134, v4
    v_perm_b32 v99, v135, v134, v5
    v_perm_b32 v52, v137, v136, v4
    v_perm_b32 v100, v137, v136, v5
    v_perm_b32 v53, v139, v138, v4
    v_perm_b32 v101, v139, v138, v5
    v_perm_b32 v54, v141, v140, v4
    v_perm_b32 v102, v141, v140, v5
    v_perm_b32 v55, v143, v142, v4
    v_perm_b32 v103, v143, v142, v5
    v_perm_b32 v56, v145, v144, v4
    v_perm_b32 v104, v145, v144, v5
    v_perm_b32 v57, v147, v146, v4
    v_perm_b32 v105, v147, v146, v5
    v_perm_b32 v58, v149, v148, v4
    v_perm_b32 v106, v149, v148, v5
    v_perm_b32 v59, v151, v150, v4
    v_perm_b32 v107, v151, v150, v5
    v_perm_b32 v60, v153, v152, v4
    v_perm_b32 v108, v153, v152, v5
    v_perm_b32 v61, v155, v154, v4
    v_perm_b32 v109, v155, v154, v5
    v_perm_b32 v62, v157, v156, v4
    v_perm_b32 v110, v157, v156, v5
    v_perm_b32 v63, v159, v158, v4
    v_perm_b32 v111, v159, v158, v5
    v_lshrrev_b32 v6, 3, v1
    v_lshrrev_b32 v7, 2, v6
    v_lshlrev_b32 v7, 5, v7
    v_and_b32 v8, 2, v6
    v_lshl_add_u32 v7, v8, 3, v7
    v_and_b32 v8, 1, v6
    v_lshl_add_u32 v7, v8, 2, v7
    v_and_b32 v8, 7, v1
    v_and_b32 v9, 1, v8
    v_add_u32 v7, v7, v9
    v_and_b32 v9, 2, v8
    v_lshl_add_u32 v7, v9, 2, v7
    v_lshrrev_b32 v9, 2, v8
    v_lshl_add_u32 v7, v9, 1, v7
    v_mul_u32_u24 v7, 12288, v7
    v_lshl_add_u32 v7, v2, 4, v7
    s_mul_i32 s28, s23, 384
    s_mul_i32 s29, s21, 3932160
    s_add_u32 s28, s28, s29
    v_lshrrev_b32 v10, 2, v1
    v_mul_u32_u24 v10, 20480, v10
    v_lshlrev_b32 v10, 4, v10
    v_and_b32 v11, 3, v1
    v_lshl_add_u32 v10, v11, 5, v10
    v_lshl_add_u32 v10, v2, 8, v10
    s_mul_i32 s30, s22, 2621440
    s_lshr_b32 s31, s23, 3
    s_mul_i32 s31, s31, 81920
    s_add_u32 s30, s30, s31
    s_and_b32 s31, s23, 3
    s_mul_i32 s31, s31, 20480
    s_add_u32 s30, s30, s31
    s_bfe_u32 s31, s23, 0x10002
    s_lshl_b32 s31, s31, 7
    s_add_u32 s30, s30, s31
    s_mul_i32 s31, s21, 10240
    s_add_u32 s30, s30, s31
    s_add_u32 s30, s30, 27262976
    buffer_load_dwordx4 v[112:115], v7, s[32:35], s28 offen offset:0
    buffer_load_dwordx4 v[116:119], v7, s[32:35], s28 offen offset:32
    buffer_load_dwordx4 v[120:123], v7, s[32:35], s28 offen offset:64
    buffer_load_dwordx4 v[124:127], v7, s[32:35], s28 offen offset:96
    buffer_load_dwordx4 v[128:131], v7, s[32:35], s28 offen offset:128
    buffer_load_dwordx4 v[132:135], v7, s[32:35], s28 offen offset:160
    buffer_load_dwordx4 v[136:139], v7, s[32:35], s28 offen offset:192
    buffer_load_dwordx4 v[140:143], v7, s[32:35], s28 offen offset:224
    buffer_load_dwordx4 v[144:147], v7, s[32:35], s28 offen offset:256
    buffer_load_dwordx4 v[148:151], v7, s[32:35], s28 offen offset:288
    buffer_load_dwordx4 v[152:155], v7, s[32:35], s28 offen offset:320
    buffer_load_dwordx4 v[156:159], v7, s[32:35], s28 offen offset:352
    s_add_u32 s28, s28, 393216
    s_mov_b32 s31, 5
prep_kernel_wvo_loop:
    buffer_load_dwordx4 v[160:163], v7, s[32:35], s28 offen offset:0
    buffer_load_dwordx4 v[164:167], v7, s[32:35], s28 offen offset:32
    buffer_load_dwordx4 v[168:171], v7, s[32:35], s28 offen offset:64
    buffer_load_dwordx4 v[172:175], v7, s[32:35], s28 offen offset:96
    buffer_load_dwordx4 v[176:179], v7, s[32:35], s28 offen offset:128
    buffer_load_dwordx4 v[180:183], v7, s[32:35], s28 offen offset:160
    buffer_load_dwordx4 v[184:187], v7, s[32:35], s28 offen offset:192
    buffer_load_dwordx4 v[188:191], v7, s[32:35], s28 offen offset:224
    buffer_load_dwordx4 v[192:195], v7, s[32:35], s28 offen offset:256
    buffer_load_dwordx4 v[196:199], v7, s[32:35], s28 offen offset:288
    buffer_load_dwordx4 v[200:203], v7, s[32:35], s28 offen offset:320
    buffer_load_dwordx4 v[204:207], v7, s[32:35], s28 offen offset:352
    s_add_u32 s28, s28, 393216
    s_waitcnt vmcnt(12)
    v_mfma_f32_32x32x16_bf16 v[208:223], v[112:115], v[16:19], 0
    v_mfma_f32_32x32x16_bf16 v[224:239], v[112:115], v[64:67], 0
    v_mfma_f32_32x32x16_bf16 v[208:223], v[116:119], v[20:23], v[208:223]
    v_mfma_f32_32x32x16_bf16 v[224:239], v[116:119], v[68:71], v[224:239]
    v_mfma_f32_32x32x16_bf16 v[208:223], v[120:123], v[24:27], v[208:223]
    v_mfma_f32_32x32x16_bf16 v[224:239], v[120:123], v[72:75], v[224:239]
    v_mfma_f32_32x32x16_bf16 v[208:223], v[124:127], v[28:31], v[208:223]
    v_mfma_f32_32x32x16_bf16 v[224:239], v[124:127], v[76:79], v[224:239]
    v_mfma_f32_32x32x16_bf16 v[208:223], v[128:131], v[32:35], v[208:223]
    v_mfma_f32_32x32x16_bf16 v[224:239], v[128:131], v[80:83], v[224:239]
    v_mfma_f32_32x32x16_bf16 v[208:223], v[132:135], v[36:39], v[208:223]
    v_mfma_f32_32x32x16_bf16 v[224:239], v[132:135], v[84:87], v[224:239]
    v_mfma_f32_32x32x16_bf16 v[208:223], v[136:139], v[40:43], v[208:223]
    v_mfma_f32_32x32x16_bf16 v[224:239], v[136:139], v[88:91], v[224:239]
    v_mfma_f32_32x32x16_bf16 v[208:223], v[140:143], v[44:47], v[208:223]
    v_mfma_f32_32x32x16_bf16 v[224:239], v[140:143], v[92:95], v[224:239]
    v_mfma_f32_32x32x16_bf16 v[208:223], v[144:147], v[48:51], v[208:223]
    v_mfma_f32_32x32x16_bf16 v[224:239], v[144:147], v[96:99], v[224:239]
    v_mfma_f32_32x32x16_bf16 v[208:223], v[148:151], v[52:55], v[208:223]
    v_mfma_f32_32x32x16_bf16 v[224:239], v[148:151], v[100:103], v[224:239]
    v_mfma_f32_32x32x16_bf16 v[208:223], v[152:155], v[56:59], v[208:223]
    v_mfma_f32_32x32x16_bf16 v[224:239], v[152:155], v[104:107], v[224:239]
    v_mfma_f32_32x32x16_bf16 v[208:223], v[156:159], v[60:63], v[208:223]
    v_mfma_f32_32x32x16_bf16 v[224:239], v[156:159], v[108:111], v[224:239]
    s_nop 7
    s_nop 7
    v_cvt_pk_bf16_f32 v240, v208, v209
    v_cvt_pk_bf16_f32 v241, v210, v211
    v_cvt_pk_bf16_f32 v242, v212, v213
    v_cvt_pk_bf16_f32 v243, v214, v215
    s_nop 1
    v_permlane32_swap_b32 v240, v242
    v_permlane32_swap_b32 v241, v243
    buffer_store_dwordx4 v[240:243], v10, s[8:11], s30 offen offset:0
    v_cvt_pk_bf16_f32 v244, v216, v217
    v_cvt_pk_bf16_f32 v245, v218, v219
    v_cvt_pk_bf16_f32 v246, v220, v221
    v_cvt_pk_bf16_f32 v247, v222, v223
    s_nop 1
    v_permlane32_swap_b32 v244, v246
    v_permlane32_swap_b32 v245, v247
    buffer_store_dwordx4 v[244:247], v10, s[8:11], s30 offen offset:512
    s_nop 1
    v_cvt_pk_bf16_f32 v240, v224, v225
    v_cvt_pk_bf16_f32 v241, v226, v227
    v_cvt_pk_bf16_f32 v242, v228, v229
    v_cvt_pk_bf16_f32 v243, v230, v231
    s_nop 1
    v_permlane32_swap_b32 v240, v242
    v_permlane32_swap_b32 v241, v243
    buffer_store_dwordx4 v[240:243], v10, s[8:11], s30 offen offset:16
    v_cvt_pk_bf16_f32 v244, v232, v233
    v_cvt_pk_bf16_f32 v245, v234, v235
    v_cvt_pk_bf16_f32 v246, v236, v237
    v_cvt_pk_bf16_f32 v247, v238, v239
    s_nop 1
    v_permlane32_swap_b32 v244, v246
    v_permlane32_swap_b32 v245, v247
    buffer_store_dwordx4 v[244:247], v10, s[8:11], s30 offen offset:528
    s_nop 1
    s_add_u32 s30, s30, 1024
    s_cmp_eq_u32 s31, 1
    s_cbranch_scc1 prep_kernel_wvo_last
    buffer_load_dwordx4 v[112:115], v7, s[32:35], s28 offen offset:0
    buffer_load_dwordx4 v[116:119], v7, s[32:35], s28 offen offset:32
    buffer_load_dwordx4 v[120:123], v7, s[32:35], s28 offen offset:64
    buffer_load_dwordx4 v[124:127], v7, s[32:35], s28 offen offset:96
    buffer_load_dwordx4 v[128:131], v7, s[32:35], s28 offen offset:128
    buffer_load_dwordx4 v[132:135], v7, s[32:35], s28 offen offset:160
    buffer_load_dwordx4 v[136:139], v7, s[32:35], s28 offen offset:192
    buffer_load_dwordx4 v[140:143], v7, s[32:35], s28 offen offset:224
    buffer_load_dwordx4 v[144:147], v7, s[32:35], s28 offen offset:256
    buffer_load_dwordx4 v[148:151], v7, s[32:35], s28 offen offset:288
    buffer_load_dwordx4 v[152:155], v7, s[32:35], s28 offen offset:320
    buffer_load_dwordx4 v[156:159], v7, s[32:35], s28 offen offset:352
    s_add_u32 s28, s28, 393216
    s_waitcnt vmcnt(12)
    v_mfma_f32_32x32x16_bf16 v[208:223], v[160:163], v[16:19], 0
    v_mfma_f32_32x32x16_bf16 v[224:239], v[160:163], v[64:67], 0
    v_mfma_f32_32x32x16_bf16 v[208:223], v[164:167], v[20:23], v[208:223]
    v_mfma_f32_32x32x16_bf16 v[224:239], v[164:167], v[68:71], v[224:239]
    v_mfma_f32_32x32x16_bf16 v[208:223], v[168:171], v[24:27], v[208:223]
    v_mfma_f32_32x32x16_bf16 v[224:239], v[168:171], v[72:75], v[224:239]
    v_mfma_f32_32x32x16_bf16 v[208:223], v[172:175], v[28:31], v[208:223]
    v_mfma_f32_32x32x16_bf16 v[224:239], v[172:175], v[76:79], v[224:239]
    v_mfma_f32_32x32x16_bf16 v[208:223], v[176:179], v[32:35], v[208:223]
    v_mfma_f32_32x32x16_bf16 v[224:239], v[176:179], v[80:83], v[224:239]
    v_mfma_f32_32x32x16_bf16 v[208:223], v[180:183], v[36:39], v[208:223]
    v_mfma_f32_32x32x16_bf16 v[224:239], v[180:183], v[84:87], v[224:239]
    v_mfma_f32_32x32x16_bf16 v[208:223], v[184:187], v[40:43], v[208:223]
    v_mfma_f32_32x32x16_bf16 v[224:239], v[184:187], v[88:91], v[224:239]
    v_mfma_f32_32x32x16_bf16 v[208:223], v[188:191], v[44:47], v[208:223]
    v_mfma_f32_32x32x16_bf16 v[224:239], v[188:191], v[92:95], v[224:239]
    v_mfma_f32_32x32x16_bf16 v[208:223], v[192:195], v[48:51], v[208:223]
    v_mfma_f32_32x32x16_bf16 v[224:239], v[192:195], v[96:99], v[224:239]
    v_mfma_f32_32x32x16_bf16 v[208:223], v[196:199], v[52:55], v[208:223]
    v_mfma_f32_32x32x16_bf16 v[224:239], v[196:199], v[100:103], v[224:239]
    v_mfma_f32_32x32x16_bf16 v[208:223], v[200:203], v[56:59], v[208:223]
    v_mfma_f32_32x32x16_bf16 v[224:239], v[200:203], v[104:107], v[224:239]
    v_mfma_f32_32x32x16_bf16 v[208:223], v[204:207], v[60:63], v[208:223]
    v_mfma_f32_32x32x16_bf16 v[224:239], v[204:207], v[108:111], v[224:239]
    s_nop 7
    s_nop 7
    v_cvt_pk_bf16_f32 v240, v208, v209
    v_cvt_pk_bf16_f32 v241, v210, v211
    v_cvt_pk_bf16_f32 v242, v212, v213
    v_cvt_pk_bf16_f32 v243, v214, v215
    s_nop 1
    v_permlane32_swap_b32 v240, v242
    v_permlane32_swap_b32 v241, v243
    buffer_store_dwordx4 v[240:243], v10, s[8:11], s30 offen offset:0
    v_cvt_pk_bf16_f32 v244, v216, v217
    v_cvt_pk_bf16_f32 v245, v218, v219
    v_cvt_pk_bf16_f32 v246, v220, v221
    v_cvt_pk_bf16_f32 v247, v222, v223
    s_nop 1
    v_permlane32_swap_b32 v244, v246
    v_permlane32_swap_b32 v245, v247
    buffer_store_dwordx4 v[244:247], v10, s[8:11], s30 offen offset:512
    s_nop 1
    v_cvt_pk_bf16_f32 v240, v224, v225
    v_cvt_pk_bf16_f32 v241, v226, v227
    v_cvt_pk_bf16_f32 v242, v228, v229
    v_cvt_pk_bf16_f32 v243, v230, v231
    s_nop 1
    v_permlane32_swap_b32 v240, v242
    v_permlane32_swap_b32 v241, v243
    buffer_store_dwordx4 v[240:243], v10, s[8:11], s30 offen offset:16
    v_cvt_pk_bf16_f32 v244, v232, v233
    v_cvt_pk_bf16_f32 v245, v234, v235
    v_cvt_pk_bf16_f32 v246, v236, v237
    v_cvt_pk_bf16_f32 v247, v238, v239
    s_nop 1
    v_permlane32_swap_b32 v244, v246
    v_permlane32_swap_b32 v245, v247
    buffer_store_dwordx4 v[244:247], v10, s[8:11], s30 offen offset:528
    s_nop 1
    s_add_u32 s30, s30, 1024
    s_sub_u32 s31, s31, 1
    s_branch prep_kernel_wvo_loop
prep_kernel_wvo_last:
    s_waitcnt vmcnt(0)
    v_mfma_f32_32x32x16_bf16 v[208:223], v[160:163], v[16:19], 0
    v_mfma_f32_32x32x16_bf16 v[224:239], v[160:163], v[64:67], 0
    v_mfma_f32_32x32x16_bf16 v[208:223], v[164:167], v[20:23], v[208:223]
    v_mfma_f32_32x32x16_bf16 v[224:239], v[164:167], v[68:71], v[224:239]
    v_mfma_f32_32x32x16_bf16 v[208:223], v[168:171], v[24:27], v[208:223]
    v_mfma_f32_32x32x16_bf16 v[224:239], v[168:171], v[72:75], v[224:239]
    v_mfma_f32_32x32x16_bf16 v[208:223], v[172:175], v[28:31], v[208:223]
    v_mfma_f32_32x32x16_bf16 v[224:239], v[172:175], v[76:79], v[224:239]
    v_mfma_f32_32x32x16_bf16 v[208:223], v[176:179], v[32:35], v[208:223]
    v_mfma_f32_32x32x16_bf16 v[224:239], v[176:179], v[80:83], v[224:239]
    v_mfma_f32_32x32x16_bf16 v[208:223], v[180:183], v[36:39], v[208:223]
    v_mfma_f32_32x32x16_bf16 v[224:239], v[180:183], v[84:87], v[224:239]
    v_mfma_f32_32x32x16_bf16 v[208:223], v[184:187], v[40:43], v[208:223]
    v_mfma_f32_32x32x16_bf16 v[224:239], v[184:187], v[88:91], v[224:239]
    v_mfma_f32_32x32x16_bf16 v[208:223], v[188:191], v[44:47], v[208:223]
    v_mfma_f32_32x32x16_bf16 v[224:239], v[188:191], v[92:95], v[224:239]
    v_mfma_f32_32x32x16_bf16 v[208:223], v[192:195], v[48:51], v[208:223]
    v_mfma_f32_32x32x16_bf16 v[224:239], v[192:195], v[96:99], v[224:239]
    v_mfma_f32_32x32x16_bf16 v[208:223], v[196:199], v[52:55], v[208:223]
    v_mfma_f32_32x32x16_bf16 v[224:239], v[196:199], v[100:103], v[224:239]
    v_mfma_f32_32x32x16_bf16 v[208:223], v[200:203], v[56:59], v[208:223]
    v_mfma_f32_32x32x16_bf16 v[224:239], v[200:203], v[104:107], v[224:239]
    v_mfma_f32_32x32x16_bf16 v[208:223], v[204:207], v[60:63], v[208:223]
    v_mfma_f32_32x32x16_bf16 v[224:239], v[204:207], v[108:111], v[224:239]
    s_nop 7
    s_nop 7
    v_cvt_pk_bf16_f32 v240, v208, v209
    v_cvt_pk_bf16_f32 v241, v210, v211
    v_cvt_pk_bf16_f32 v242, v212, v213
    v_cvt_pk_bf16_f32 v243, v214, v215
    s_nop 1
    v_permlane32_swap_b32 v240, v242
    v_permlane32_swap_b32 v241, v243
    buffer_store_dwordx4 v[240:243], v10, s[8:11], s30 offen offset:0
    v_cvt_pk_bf16_f32 v244, v216, v217
    v_cvt_pk_bf16_f32 v245, v218, v219
    v_cvt_pk_bf16_f32 v246, v220, v221
    v_cvt_pk_bf16_f32 v247, v222, v223
    s_nop 1
    v_permlane32_swap_b32 v244, v246
    v_permlane32_swap_b32 v245, v247
    buffer_store_dwordx4 v[244:247], v10, s[8:11], s30 offen offset:512
    s_nop 1
    v_cvt_pk_bf16_f32 v240, v224, v225
    v_cvt_pk_bf16_f32 v241, v226, v227
    v_cvt_pk_bf16_f32 v242, v228, v229
    v_cvt_pk_bf16_f32 v243, v230, v231
    s_nop 1
    v_permlane32_swap_b32 v240, v242
    v_permlane32_swap_b32 v241, v243
    buffer_store_dwordx4 v[240:243], v10, s[8:11], s30 offen offset:16
    v_cvt_pk_bf16_f32 v244, v232, v233
    v_cvt_pk_bf16_f32 v245, v234, v235
    v_cvt_pk_bf16_f32 v246, v236, v237
    v_cvt_pk_bf16_f32 v247, v238, v239
    s_nop 1
    v_permlane32_swap_b32 v244, v246
    v_permlane32_swap_b32 v245, v247
    buffer_store_dwordx4 v[244:247], v10, s[8:11], s30 offen offset:528
    s_nop 1
    s_add_u32 s30, s30, 1024
    s_branch prep_kernel_end
prep_kernel_r_pwp:
    s_lshl_b32 s20, s20, 2
    s_add_u32 s20, s20, s13
    s_mul_i32 s21, s20, 13108
    s_lshr_b32 s21, s21, 16
    s_mul_i32 s22, s21, 5
    s_sub_u32 s22, s20, s22
    s_mul_i32 s23, s21, 21846
    s_lshr_b32 s23, s23, 16
    s_mul_i32 s28, s23, 3
    s_sub_u32 s21, s21, s28
    s_lshr_b32 s29, s23, 5
    s_and_b32 s23, s23, 31
    s_cmp_eq_u32 s29, 0
    s_cbranch_scc0 prep_kernel_pwp_k
    s_load_dwordx2 s[24:25], s[0:1], 40
    s_branch prep_kernel_pwp_go
prep_kernel_pwp_k:
    s_load_dwordx2 s[24:25], s[0:1], 48
prep_kernel_pwp_go:
    v_and_b32 v1, 31, v0
    v_lshrrev_b32 v2, 5, v0
    s_lshl_b32 s28, s21, 6
    v_lshlrev_b32 v3, 1, v1
    v_add_u32 v3, s28, v3
    v_and_b32 v4, 0xc1, v3
    v_and_b32 v5, 8, v3
    v_lshl_or_b32 v4, v5, 2, v4
    v_and_b32 v5, 32, v3
    v_lshrrev_b32 v5, 1, v5
    v_or_b32 v4, v4, v5
    v_and_b32 v5, 2, v3
    v_lshl_or_b32 v4, v5, 2, v4
    v_and_b32 v5, 16, v3
    v_lshrrev_b32 v5, 2, v5
    v_or_b32 v4, v4, v5
    v_and_b32 v5, 4, v3
    v_lshrrev_b32 v5, 1, v5
    v_or_b32 v4, v4, v5
    s_cmp_eq_u32 s29, 0
    s_cselect_b64 vcc, -1, 0
    s_nop 1
    v_cndmask_b32 v4, v4, v3, vcc
    v_lshrrev_b32 v5, 4, v3
    v_mul_u32_u24 v6, 11, v5
    v_lshrrev_b32 v6, 5, v6
    v_mul_u32_u24 v6, 3, v6
    v_add_u32 v5, v5, v6
    v_mul_u32_u24 v5, 20480, v5
    v_and_b32 v6, 15, v3
    v_lshl_add_u32 v7, v6, 4, v5
    s_mul_i32 s30, s29, 61440
    s_mul_i32 s31, s23, 491520
    s_add_u32 s30, s30, s31
    s_add_u32 s30, s30, 11534336
    s_lshl_b32 s31, s22, 4
    v_add_u32 v8, s31, v2
    s_waitcnt lgkmcnt(0)
    s_mov_b32 s32, s24
    s_mov_b32 s33, s25
    s_mov_b32 s34, 7864320
    s_mov_b32 s35, 0x00020000
    s_mul_i32 s28, s23, 384
    v_add_u32 v9, 0, v8
    v_lshrrev_b32 v10, 2, v9
    v_lshlrev_b32 v10, 5, v10
    v_and_b32 v11, 2, v9
    v_lshl_add_u32 v10, v11, 3, v10
    v_and_b32 v11, 1, v9
    v_lshl_add_u32 v10, v11, 2, v10
    v_mul_u32_u24 v10, 12288, v10
    v_lshl_add_u32 v10, v4, 1, v10
    s_add_u32 s31, s28, 0
    buffer_load_dword v16, v10, s[32:35], s31 offen
    s_add_u32 s31, s28, 12288
    buffer_load_dword v17, v10, s[32:35], s31 offen
    s_add_u32 s31, s28, 98304
    buffer_load_dword v18, v10, s[32:35], s31 offen
    s_add_u32 s31, s28, 110592
    buffer_load_dword v19, v10, s[32:35], s31 offen
    s_add_u32 s31, s28, 24576
    buffer_load_dword v20, v10, s[32:35], s31 offen
    s_add_u32 s31, s28, 36864
    buffer_load_dword v21, v10, s[32:35], s31 offen
    s_add_u32 s31, s28, 122880
    buffer_load_dword v22, v10, s[32:35], s31 offen
    s_add_u32 s31, s28, 135168
    buffer_load_dword v23, v10, s[32:35], s31 offen
    v_add_u32 v9, 2, v8
    v_lshrrev_b32 v10, 2, v9
    v_lshlrev_b32 v10, 5, v10
    v_and_b32 v11, 2, v9
    v_lshl_add_u32 v10, v11, 3, v10
    v_and_b32 v11, 1, v9
    v_lshl_add_u32 v10, v11, 2, v10
    v_mul_u32_u24 v10, 12288, v10
    v_lshl_add_u32 v10, v4, 1, v10
    s_add_u32 s31, s28, 0
    buffer_load_dword v24, v10, s[32:35], s31 offen
    s_add_u32 s31, s28, 12288
    buffer_load_dword v25, v10, s[32:35], s31 offen
    s_add_u32 s31, s28, 98304
    buffer_load_dword v26, v10, s[32:35], s31 offen
    s_add_u32 s31, s28, 110592
    buffer_load_dword v27, v10, s[32:35], s31 offen
    s_add_u32 s31, s28, 24576
    buffer_load_dword v28, v10, s[32:35], s31 offen
    s_add_u32 s31, s28, 36864
    buffer_load_dword v29, v10, s[32:35], s31 offen
    s_add_u32 s31, s28, 122880
    buffer_load_dword v30, v10, s[32:35], s31 offen
    s_add_u32 s31, s28, 135168
    buffer_load_dword v31, v10, s[32:35], s31 offen
    v_add_u32 v9, 4, v8
    v_lshrrev_b32 v10, 2, v9
    v_lshlrev_b32 v10, 5, v10
    v_and_b32 v11, 2, v9
    v_lshl_add_u32 v10, v11, 3, v10
    v_and_b32 v11, 1, v9
    v_lshl_add_u32 v10, v11, 2, v10
    v_mul_u32_u24 v10, 12288, v10
    v_lshl_add_u32 v10, v4, 1, v10
    s_add_u32 s31, s28, 0
    buffer_load_dword v32, v10, s[32:35], s31 offen
    s_add_u32 s31, s28, 12288
    buffer_load_dword v33, v10, s[32:35], s31 offen
    s_add_u32 s31, s28, 98304
    buffer_load_dword v34, v10, s[32:35], s31 offen
    s_add_u32 s31, s28, 110592
    buffer_load_dword v35, v10, s[32:35], s31 offen
    s_add_u32 s31, s28, 24576
    buffer_load_dword v36, v10, s[32:35], s31 offen
    s_add_u32 s31, s28, 36864
    buffer_load_dword v37, v10, s[32:35], s31 offen
    s_add_u32 s31, s28, 122880
    buffer_load_dword v38, v10, s[32:35], s31 offen
    s_add_u32 s31, s28, 135168
    buffer_load_dword v39, v10, s[32:35], s31 offen
    v_add_u32 v9, 6, v8
    v_lshrrev_b32 v10, 2, v9
    v_lshlrev_b32 v10, 5, v10
    v_and_b32 v11, 2, v9
    v_lshl_add_u32 v10, v11, 3, v10
    v_and_b32 v11, 1, v9
    v_lshl_add_u32 v10, v11, 2, v10
    v_mul_u32_u24 v10, 12288, v10
    v_lshl_add_u32 v10, v4, 1, v10
    s_add_u32 s31, s28, 0
    buffer_load_dword v40, v10, s[32:35], s31 offen
    s_add_u32 s31, s28, 12288
    buffer_load_dword v41, v10, s[32:35], s31 offen
    s_add_u32 s31, s28, 98304
    buffer_load_dword v42, v10, s[32:35], s31 offen
    s_add_u32 s31, s28, 110592
    buffer_load_dword v43, v10, s[32:35], s31 offen
    s_add_u32 s31, s28, 24576
    buffer_load_dword v44, v10, s[32:35], s31 offen
    s_add_u32 s31, s28, 36864
    buffer_load_dword v45, v10, s[32:35], s31 offen
    s_add_u32 s31, s28, 122880
    buffer_load_dword v46, v10, s[32:35], s31 offen
    s_add_u32 s31, s28, 135168
    buffer_load_dword v47, v10, s[32:35], s31 offen
    v_add_u32 v9, 8, v8
    v_lshrrev_b32 v10, 2, v9
    v_lshlrev_b32 v10, 5, v10
    v_and_b32 v11, 2, v9
    v_lshl_add_u32 v10, v11, 3, v10
    v_and_b32 v11, 1, v9
    v_lshl_add_u32 v10, v11, 2, v10
    v_mul_u32_u24 v10, 12288, v10
    v_lshl_add_u32 v10, v4, 1, v10
    s_add_u32 s31, s28, 0
    buffer_load_dword v48, v10, s[32:35], s31 offen
    s_add_u32 s31, s28, 12288
    buffer_load_dword v49, v10, s[32:35], s31 offen
    s_add_u32 s31, s28, 98304
    buffer_load_dword v50, v10, s[32:35], s31 offen
    s_add_u32 s31, s28, 110592
    buffer_load_dword v51, v10, s[32:35], s31 offen
    s_add_u32 s31, s28, 24576
    buffer_load_dword v52, v10, s[32:35], s31 offen
    s_add_u32 s31, s28, 36864
    buffer_load_dword v53, v10, s[32:35], s31 offen
    s_add_u32 s31, s28, 122880
    buffer_load_dword v54, v10, s[32:35], s31 offen
    s_add_u32 s31, s28, 135168
    buffer_load_dword v55, v10, s[32:35], s31 offen
    v_add_u32 v9, 10, v8
    v_lshrrev_b32 v10, 2, v9
    v_lshlrev_b32 v10, 5, v10
    v_and_b32 v11, 2, v9
    v_lshl_add_u32 v10, v11, 3, v10
    v_and_b32 v11, 1, v9
    v_lshl_add_u32 v10, v11, 2, v10
    v_mul_u32_u24 v10, 12288, v10
    v_lshl_add_u32 v10, v4, 1, v10
    s_add_u32 s31, s28, 0
    buffer_load_dword v56, v10, s[32:35], s31 offen
    s_add_u32 s31, s28, 12288
    buffer_load_dword v57, v10, s[32:35], s31 offen
    s_add_u32 s31, s28, 98304
    buffer_load_dword v58, v10, s[32:35], s31 offen
    s_add_u32 s31, s28, 110592
    buffer_load_dword v59, v10, s[32:35], s31 offen
    s_add_u32 s31, s28, 24576
    buffer_load_dword v60, v10, s[32:35], s31 offen
    s_add_u32 s31, s28, 36864
    buffer_load_dword v61, v10, s[32:35], s31 offen
    s_add_u32 s31, s28, 122880
    buffer_load_dword v62, v10, s[32:35], s31 offen
    s_add_u32 s31, s28, 135168
    buffer_load_dword v63, v10, s[32:35], s31 offen
    v_add_u32 v9, 12, v8
    v_lshrrev_b32 v10, 2, v9
    v_lshlrev_b32 v10, 5, v10
    v_and_b32 v11, 2, v9
    v_lshl_add_u32 v10, v11, 3, v10
    v_and_b32 v11, 1, v9
    v_lshl_add_u32 v10, v11, 2, v10
    v_mul_u32_u24 v10, 12288, v10
    v_lshl_add_u32 v10, v4, 1, v10
    s_add_u32 s31, s28, 0
    buffer_load_dword v64, v10, s[32:35], s31 offen
    s_add_u32 s31, s28, 12288
    buffer_load_dword v65, v10, s[32:35], s31 offen
    s_add_u32 s31, s28, 98304
    buffer_load_dword v66, v10, s[32:35], s31 offen
    s_add_u32 s31, s28, 110592
    buffer_load_dword v67, v10, s[32:35], s31 offen
    s_add_u32 s31, s28, 24576
    buffer_load_dword v68, v10, s[32:35], s31 offen
    s_add_u32 s31, s28, 36864
    buffer_load_dword v69, v10, s[32:35], s31 offen
    s_add_u32 s31, s28, 122880
    buffer_load_dword v70, v10, s[32:35], s31 offen
    s_add_u32 s31, s28, 135168
    buffer_load_dword v71, v10, s[32:35], s31 offen
    v_add_u32 v9, 14, v8
    v_lshrrev_b32 v10, 2, v9
    v_lshlrev_b32 v10, 5, v10
    v_and_b32 v11, 2, v9
    v_lshl_add_u32 v10, v11, 3, v10
    v_and_b32 v11, 1, v9
    v_lshl_add_u32 v10, v11, 2, v10
    v_mul_u32_u24 v10, 12288, v10
    v_lshl_add_u32 v10, v4, 1, v10
    s_add_u32 s31, s28, 0
    buffer_load_dword v72, v10, s[32:35], s31 offen
    s_add_u32 s31, s28, 12288
    buffer_load_dword v73, v10, s[32:35], s31 offen
    s_add_u32 s31, s28, 98304
    buffer_load_dword v74, v10, s[32:35], s31 offen
    s_add_u32 s31, s28, 110592
    buffer_load_dword v75, v10, s[32:35], s31 offen
    s_add_u32 s31, s28, 24576
    buffer_load_dword v76, v10, s[32:35], s31 offen
    s_add_u32 s31, s28, 36864
    buffer_load_dword v77, v10, s[32:35], s31 offen
    s_add_u32 s31, s28, 122880
    buffer_load_dword v78, v10, s[32:35], s31 offen
    s_add_u32 s31, s28, 135168
    buffer_load_dword v79, v10, s[32:35], s31 offen
    v_lshl_add_u32 v7, v8, 8, v7
    v_mov_b32 v4, 0x05040100
    v_mov_b32 v5, 0x07060302
    s_waitcnt vmcnt(56)
    v_perm_b32 v80, v17, v16, v4
    v_perm_b32 v84, v17, v16, v5
    v_perm_b32 v81, v19, v18, v4
    v_perm_b32 v85, v19, v18, v5
    v_perm_b32 v82, v21, v20, v4
    v_perm_b32 v86, v21, v20, v5
    v_perm_b32 v83, v23, v22, v4
    v_perm_b32 v87, v23, v22, v5
    buffer_store_dwordx4 v[80:83], v7, s[8:11], s30 offen offset:0
    buffer_store_dwordx4 v[84:87], v7, s[8:11], s30 offen offset:16
    s_waitcnt vmcnt(48)
    v_perm_b32 v88, v25, v24, v4
    v_perm_b32 v92, v25, v24, v5
    v_perm_b32 v89, v27, v26, v4
    v_perm_b32 v93, v27, v26, v5
    v_perm_b32 v90, v29, v28, v4
    v_perm_b32 v94, v29, v28, v5
    v_perm_b32 v91, v31, v30, v4
    v_perm_b32 v95, v31, v30, v5
    buffer_store_dwordx4 v[88:91], v7, s[8:11], s30 offen offset:512
    buffer_store_dwordx4 v[92:95], v7, s[8:11], s30 offen offset:528
    s_nop 0
    s_waitcnt vmcnt(40)
    v_perm_b32 v80, v33, v32, v4
    v_perm_b32 v84, v33, v32, v5
    v_perm_b32 v81, v35, v34, v4
    v_perm_b32 v85, v35, v34, v5
    v_perm_b32 v82, v37, v36, v4
    v_perm_b32 v86, v37, v36, v5
    v_perm_b32 v83, v39, v38, v4
    v_perm_b32 v87, v39, v38, v5
    buffer_store_dwordx4 v[80:83], v7, s[8:11], s30 offen offset:1024
    buffer_store_dwordx4 v[84:87], v7, s[8:11], s30 offen offset:1040
    s_nop 0
    s_waitcnt vmcnt(32)
    v_perm_b32 v88, v41, v40, v4
    v_perm_b32 v92, v41, v40, v5
    v_perm_b32 v89, v43, v42, v4
    v_perm_b32 v93, v43, v42, v5
    v_perm_b32 v90, v45, v44, v4
    v_perm_b32 v94, v45, v44, v5
    v_perm_b32 v91, v47, v46, v4
    v_perm_b32 v95, v47, v46, v5
    buffer_store_dwordx4 v[88:91], v7, s[8:11], s30 offen offset:1536
    buffer_store_dwordx4 v[92:95], v7, s[8:11], s30 offen offset:1552
    s_nop 0
    s_waitcnt vmcnt(24)
    v_perm_b32 v80, v49, v48, v4
    v_perm_b32 v84, v49, v48, v5
    v_perm_b32 v81, v51, v50, v4
    v_perm_b32 v85, v51, v50, v5
    v_perm_b32 v82, v53, v52, v4
    v_perm_b32 v86, v53, v52, v5
    v_perm_b32 v83, v55, v54, v4
    v_perm_b32 v87, v55, v54, v5
    buffer_store_dwordx4 v[80:83], v7, s[8:11], s30 offen offset:2048
    buffer_store_dwordx4 v[84:87], v7, s[8:11], s30 offen offset:2064
    s_nop 0
    s_waitcnt vmcnt(16)
    v_perm_b32 v88, v57, v56, v4
    v_perm_b32 v92, v57, v56, v5
    v_perm_b32 v89, v59, v58, v4
    v_perm_b32 v93, v59, v58, v5
    v_perm_b32 v90, v61, v60, v4
    v_perm_b32 v94, v61, v60, v5
    v_perm_b32 v91, v63, v62, v4
    v_perm_b32 v95, v63, v62, v5
    buffer_store_dwordx4 v[88:91], v7, s[8:11], s30 offen offset:2560
    buffer_store_dwordx4 v[92:95], v7, s[8:11], s30 offen offset:2576
    s_nop 0
    s_waitcnt vmcnt(8)
    v_perm_b32 v80, v65, v64, v4
    v_perm_b32 v84, v65, v64, v5
    v_perm_b32 v81, v67, v66, v4
    v_perm_b32 v85, v67, v66, v5
    v_perm_b32 v82, v69, v68, v4
    v_perm_b32 v86, v69, v68, v5
    v_perm_b32 v83, v71, v70, v4
    v_perm_b32 v87, v71, v70, v5
    buffer_store_dwordx4 v[80:83], v7, s[8:11], s30 offen offset:3072
    buffer_store_dwordx4 v[84:87], v7, s[8:11], s30 offen offset:3088
    s_nop 0
    s_waitcnt vmcnt(0)
    v_perm_b32 v88, v73, v72, v4
    v_perm_b32 v92, v73, v72, v5
    v_perm_b32 v89, v75, v74, v4
    v_perm_b32 v93, v75, v74, v5
    v_perm_b32 v90, v77, v76, v4
    v_perm_b32 v94, v77, v76, v5
    v_perm_b32 v91, v79, v78, v4
    v_perm_b32 v95, v79, v78, v5
    buffer_store_dwordx4 v[88:91], v7, s[8:11], s30 offen offset:3584
    buffer_store_dwordx4 v[92:95], v7, s[8:11], s30 offen offset:3600
    s_nop 0
    s_branch prep_kernel_end
prep_kernel_end:
    s_endpgm
.section .rodata,"a"
.p2align 6
.amdhsa_kernel prep_kernel
  .amdhsa_next_free_vgpr 248
  .amdhsa_next_free_sgpr 64
  .amdhsa_accum_offset 248
  .amdhsa_group_segment_fixed_size 0
  .amdhsa_kernarg_size 104
  .amdhsa_user_sgpr_count 2
  .amdhsa_user_sgpr_kernarg_segment_ptr 1
  .amdhsa_system_sgpr_workgroup_id_x 1
.end_amdhsa_kernel
.text
.globl ln_a1_kernel
.p2align 8
.type ln_a1_kernel,@function
ln_a1_kernel:
    v_lshrrev_b32 v1, 6, v0
    v_and_b32 v2, 63, v0
    s_nop 0
    v_readfirstlane_b32 s3, v1
    s_lshl_b32 s4, s2, 2
    s_add_u32 s4, s4, s3
    s_cmp_ge_u32 s4, 2048
    s_cbranch_scc1 ln_a1_kernel_end
    s_load_dwordx2 s[6:7], s[0:1], 0
    s_load_dwordx2 s[12:13], s[0:1], 96
    s_waitcnt lgkmcnt(0)
    s_mov_b32 s8, s6
    s_mov_b32 s9, s7
    s_mov_b32 s10, 2621440
    s_mov_b32 s11, 0x00020000
    s_add_u32 s16, s12, 223346688
    s_addc_u32 s17, s13, 0
    s_mov_b32 s18, 2621440
    s_mov_b32 s19, 0x00020000
    s_mul_i32 s5, s4, 1280
    v_lshlrev_b32 v3, 2, v2
    v_add_u32 v3, s5, v3
    buffer_load_dword v4, v3, s[8:11], 0 offen offset:0
    buffer_load_dword v5, v3, s[8:11], 0 offen offset:256
    buffer_load_dword v6, v3, s[8:11], 0 offen offset:512
    buffer_load_dword v7, v3, s[8:11], 0 offen offset:768
    buffer_load_dword v8, v3, s[8:11], 0 offen offset:1024
    s_waitcnt vmcnt(0)
    v_lshlrev_b32 v10, 16, v4
    v_and_b32 v11, 0xffff0000, v4
    v_lshlrev_b32 v12, 16, v5
    v_and_b32 v13, 0xffff0000, v5
    v_lshlrev_b32 v14, 16, v6
    v_and_b32 v15, 0xffff0000, v6
    v_lshlrev_b32 v16, 16, v7
    v_and_b32 v17, 0xffff0000, v7
    v_lshlrev_b32 v18, 16, v8
    v_and_b32 v19, 0xffff0000, v8
    v_add_f32 v20, v10, v11
    v_add_f32 v20, v20, v12
    v_add_f32 v20, v20, v13
    v_add_f32 v20, v20, v14
    v_add_f32 v20, v20, v15
    v_add_f32 v20, v20, v16
    v_add_f32 v20, v20, v17
    v_add_f32 v20, v20, v18
    v_add_f32 v20, v20, v19
    s_nop 1
    v_add_f32 v21, v20, v20 quad_perm:[1,0,3,2] row_mask:0xf bank_mask:0xf
    s_nop 1
    v_add_f32 v21, v21, v21 quad_perm:[2,3,0,1] row_mask:0xf bank_mask:0xf
    s_nop 1
    v_add_f32 v21, v21, v21 row_half_mirror row_mask:0xf bank_mask:0xf
    s_nop 1
    v_add_f32 v21, v21, v21 row_mirror row_mask:0xf bank_mask:0xf
    s_nop 1
    v_readlane_b32 s24, v21, 0
    v_readlane_b32 s25, v21, 16
    v_readlane_b32 s26, v21, 32
    v_readlane_b32 s27, v21, 48
    s_nop 1
    v_mov_b32 v20, s24
    v_add_f32 v20, s25, v20
    v_add_f32 v20, s26, v20
    v_add_f32 v20, s27, v20
    v_mul_f32 v20, 0.0015625, v20
    v_sub_f32 v10, v10, v20
    v_sub_f32 v11, v11, v20
    v_sub_f32 v12, v12, v20
    v_sub_f32 v13, v13, v20
    v_sub_f32 v14, v14, v20
    v_sub_f32 v15, v15, v20
    v_sub_f32 v16, v16, v20
    v_sub_f32 v17, v17, v20
    v_sub_f32 v18, v18, v20
    v_sub_f32 v19, v19, v20
    v_mul_f32 v21, v10, v10
    v_fmac_f32 v21, v11, v11
    v_fmac_f32 v21, v12, v12
    v_fmac_f32 v21, v13, v13
    v_fmac_f32 v21, v14, v14
    v_fmac_f32 v21, v15, v15
    v_fmac_f32 v21, v16, v16
    v_fmac_f32 v21, v17, v17
    v_fmac_f32 v21, v18, v18
    v_fmac_f32 v21, v19, v19
    s_nop 1
    v_add_f32 v22, v21, v21 quad_perm:[1,0,3,2] row_mask:0xf bank_mask:0xf
    s_nop 1
    v_add_f32 v22, v22, v22 quad_perm:[2,3,0,1] row_mask:0xf bank_mask:0xf
    s_nop 1
    v_add_f32 v22, v22, v22 row_half_mirror row_mask:0xf bank_mask:0xf
    s_nop 1
    v_add_f32 v22, v22, v22 row_mirror row_mask:0xf bank_mask:0xf
    s_nop 1
    v_readlane_b32 s24, v22, 0
    v_readlane_b32 s25, v22, 16
    v_readlane_b32 s26, v22, 32
    v_readlane_b32 s27, v22, 48
    s_nop 1
    v_mov_b32 v21, s24
    v_add_f32 v21, s25, v21
    v_add_f32 v21, s26, v21
    v_add_f32 v21, s27, v21
    v_mov_b32 v22, 0x3727c5ac
    v_fmac_f32 v22, 0.0015625, v21
    v_rsq_f32 v22, v22
    s_nop 0
    v_mul_f32 v10, v10, v22
    v_mul_f32 v11, v11, v22
    v_mul_f32 v12, v12, v22
    v_mul_f32 v13, v13, v22
    v_mul_f32 v14, v14, v22
    v_mul_f32 v15, v15, v22
    v_mul_f32 v16, v16, v22
    v_mul_f32 v17, v17, v22
    v_mul_f32 v18, v18, v22
    v_mul_f32 v19, v19, v22
    v_cvt_pk_bf16_f32 v4, v10, v11
    v_cvt_pk_bf16_f32 v5, v12, v13
    v_cvt_pk_bf16_f32 v6, v14, v15
    v_cvt_pk_bf16_f32 v7, v16, v17
    v_cvt_pk_bf16_f32 v8, v18, v19
    buffer_store_dword v4, v3, s[16:19], 0 offen offset:0
    buffer_store_dword v5, v3, s[16:19], 0 offen offset:256
    buffer_store_dword v6, v3, s[16:19], 0 offen offset:512
    buffer_store_dword v7, v3, s[16:19], 0 offen offset:768
    buffer_store_dword v8, v3, s[16:19], 0 offen offset:1024
ln_a1_kernel_end:
    s_endpgm
.section .rodata,"a"
.p2align 6
.amdhsa_kernel ln_a1_kernel
  .amdhsa_next_free_vgpr 32
  .amdhsa_next_free_sgpr 40
  .amdhsa_accum_offset 32
  .amdhsa_group_segment_fixed_size 0
  .amdhsa_kernarg_size 104
  .amdhsa_user_sgpr_count 2
  .amdhsa_user_sgpr_kernarg_segment_ptr 1
  .amdhsa_system_sgpr_workgroup_id_x 1
.end_amdhsa_kernel
.text
.globl qkv_a_kernel
.p2align 8
.type qkv_a_kernel,@function
qkv_a_kernel:
    v_lshrrev_b32 v1, 6, v0
    v_and_b32 v2, 63, v0
    s_nop 0
    v_readfirstlane_b32 s3, v1
    s_cmp_ge_u32 s2, 192
    s_cbranch_scc1 qkv_a_kernel_end
    s_load_dwordx2 s[4:5], s[0:1], 96
    s_load_dwordx2 s[6:7], s[0:1], 80
    s_mul_i32 s20, s2, 171
    s_lshr_b32 s20, s20, 12
    s_mul_i32 s21, s20, 24
    s_sub_u32 s21, s2, s21
    s_lshl_b32 s20, s20, 2
    s_add_u32 s20, s20, s3
    s_mul_i32 s22, s20, 64
    s_mul_i32 s23, s21, 80
    s_waitcnt lgkmcnt(0)
    s_mov_b32 s8, s4
    s_mov_b32 s9, s5
    s_mov_b32 s10, 268435456
    s_mov_b32 s11, 0x00020000
    v_and_b32 v3, 15, v2
    v_lshrrev_b32 v4, 4, v2
    s_mov_b32 s24, 1280
    v_add_u32 v5, s22, v3
    v_mul_lo_u32 v5, v5, s24
    v_lshlrev_b32 v6, 4, v4
    v_add_u32 v5, v5, v6
    v_add_u32 v5, 223346688, v5
    v_mov_b32 v8, v5
    v_add_u32 v9, 20480, v5
    v_add_u32 v10, 40960, v5
    v_add_u32 v11, 61440, v5
    v_lshlrev_b32 v7, 4, v2
    s_mov_b32 s25, 0
    s_mov_b32 s26, 0
    s_mul_i32 s27, s21, 102400
    s_add_u32 s27, s27, s26
    s_add_u32 s27, s27, 243269632
    s_add_u32 s32, s27, 0
    s_add_u32 s33, s27, 20480
    s_add_u32 s34, s27, 40960
    s_add_u32 s35, s27, 61440
    s_add_u32 s36, s27, 81920
    v_accvgpr_write_b32 a0, 0
    v_accvgpr_write_b32 a1, 0
    v_accvgpr_write_b32 a2, 0
    v_accvgpr_write_b32 a3, 0
    v_accvgpr_write_b32 a4, 0
    v_accvgpr_write_b32 a5, 0
    v_accvgpr_write_b32 a6, 0
    v_accvgpr_write_b32 a7, 0
    v_accvgpr_write_b32 a8, 0
    v_accvgpr_write_b32 a9, 0
    v_accvgpr_write_b32 a10, 0
    v_accvgpr_write_b32 a11, 0
    v_accvgpr_write_b32 a12, 0
    v_accvgpr_write_b32 a13, 0
    v_accvgpr_write_b32 a14, 0
    v_accvgpr_write_b32 a15, 0
    v_accvgpr_write_b32 a16, 0
    v_accvgpr_write_b32 a17, 0
    v_accvgpr_write_b32 a18, 0
    v_accvgpr_write_b32 a19, 0
    v_accvgpr_write_b32 a20, 0
    v_accvgpr_write_b32 a21, 0
    v_accvgpr_write_b32 a22, 0
    v_accvgpr_write_b32 a23, 0
    v_accvgpr_write_b32 a24, 0
    v_accvgpr_write_b32 a25, 0
    v_accvgpr_write_b32 a26, 0
    v_accvgpr_write_b32 a27, 0
    v_accvgpr_write_b32 a28, 0
    v_accvgpr_write_b32 a29, 0
    v_accvgpr_write_b32 a30, 0
    v_accvgpr_write_b32 a31, 0
    v_accvgpr_write_b32 a32, 0
    v_accvgpr_write_b32 a33, 0
    v_accvgpr_write_b32 a34, 0
    v_accvgpr_write_b32 a35, 0
    v_accvgpr_write_b32 a36, 0
    v_accvgpr_write_b32 a37, 0
    v_accvgpr_write_b32 a38, 0
    v_accvgpr_write_b32 a39, 0
    v_accvgpr_write_b32 a40, 0
    v_accvgpr_write_b32 a41, 0
    v_accvgpr_write_b32 a42, 0
    v_accvgpr_write_b32 a43, 0
    v_accvgpr_write_b32 a44, 0
    v_accvgpr_write_b32 a45, 0
    v_accvgpr_write_b32 a46, 0
    v_accvgpr_write_b32 a47, 0
    v_accvgpr_write_b32 a48, 0
    v_accvgpr_write_b32 a49, 0
    v_accvgpr_write_b32 a50, 0
    v_accvgpr_write_b32 a51, 0
    v_accvgpr_write_b32 a52, 0
    v_accvgpr_write_b32 a53, 0
    v_accvgpr_write_b32 a54, 0
    v_accvgpr_write_b32 a55, 0
    v_accvgpr_write_b32 a56, 0
    v_accvgpr_write_b32 a57, 0
    v_accvgpr_write_b32 a58, 0
    v_accvgpr_write_b32 a59, 0
    v_accvgpr_write_b32 a60, 0
    v_accvgpr_write_b32 a61, 0
    v_accvgpr_write_b32 a62, 0
    v_accvgpr_write_b32 a63, 0
    v_accvgpr_write_b32 a64, 0
    v_accvgpr_write_b32 a65, 0
    v_accvgpr_write_b32 a66, 0
    v_accvgpr_write_b32 a67, 0
    v_accvgpr_write_b32 a68, 0
    v_accvgpr_write_b32 a69, 0
    v_accvgpr_write_b32 a70, 0
    v_accvgpr_write_b32 a71, 0
    v_accvgpr_write_b32 a72, 0
    v_accvgpr_write_b32 a73, 0
    v_accvgpr_write_b32 a74, 0
    v_accvgpr_write_b32 a75, 0
    v_accvgpr_write_b32 a76, 0
    v_accvgpr_write_b32 a77, 0
    v_accvgpr_write_b32 a78, 0
    v_accvgpr_write_b32 a79, 0
    s_cmp_ge_u32 s23, 640
    s_cbranch_scc1 qkv_a_kernel_nrm
    buffer_load_dwordx4 v[16:19], v8, s[8:11], s25 offen
    buffer_load_dwordx4 v[20:23], v9, s[8:11], s25 offen
    buffer_load_dwordx4 v[24:27], v10, s[8:11], s25 offen
    buffer_load_dwordx4 v[28:31], v11, s[8:11], s25 offen
    buffer_load_dwordx4 v[32:35], v7, s[8:11], s32 offen
    buffer_load_dwordx4 v[36:39], v7, s[8:11], s33 offen
    buffer_load_dwordx4 v[40:43], v7, s[8:11], s34 offen
    buffer_load_dwordx4 v[44:47], v7, s[8:11], s35 offen
    buffer_load_dwordx4 v[48:51], v7, s[8:11], s36 offen
    s_mov_b32 s28, 10
qkv_a_kernel_loop0:
    s_add_u32 s25, s25, 64
    s_add_u32 s32, s32, 1024
    s_add_u32 s33, s33, 1024
    s_add_u32 s34, s34, 1024
    s_add_u32 s35, s35, 1024
    s_add_u32 s36, s36, 1024
    buffer_load_dwordx4 v[52:55], v8, s[8:11], s25 offen
    buffer_load_dwordx4 v[56:59], v9, s[8:11], s25 offen
    buffer_load_dwordx4 v[60:63], v10, s[8:11], s25 offen
    buffer_load_dwordx4 v[64:67], v11, s[8:11], s25 offen
    buffer_load_dwordx4 v[68:71], v7, s[8:11], s32 offen
    buffer_load_dwordx4 v[72:75], v7, s[8:11], s33 offen
    buffer_load_dwordx4 v[76:79], v7, s[8:11], s34 offen
    buffer_load_dwordx4 v[80:83], v7, s[8:11], s35 offen
    buffer_load_dwordx4 v[84:87], v7, s[8:11], s36 offen
    s_waitcnt vmcnt(9)
    v_mfma_f32_16x16x32_bf16 a[0:3], v[32:35], v[16:19], a[0:3]
    v_mfma_f32_16x16x32_bf16 a[20:23], v[32:35], v[20:23], a[20:23]
    v_mfma_f32_16x16x32_bf16 a[40:43], v[32:35], v[24:27], a[40:43]
    v_mfma_f32_16x16x32_bf16 a[60:63], v[32:35], v[28:31], a[60:63]
    v_mfma_f32_16x16x32_bf16 a[4:7], v[36:39], v[16:19], a[4:7]
    v_mfma_f32_16x16x32_bf16 a[24:27], v[36:39], v[20:23], a[24:27]
    v_mfma_f32_16x16x32_bf16 a[44:47], v[36:39], v[24:27], a[44:47]
    v_mfma_f32_16x16x32_bf16 a[64:67], v[36:39], v[28:31], a[64:67]
    v_mfma_f32_16x16x32_bf16 a[8:11], v[40:43], v[16:19], a[8:11]
    v_mfma_f32_16x16x32_bf16 a[28:31], v[40:43], v[20:23], a[28:31]
    v_mfma_f32_16x16x32_bf16 a[48:51], v[40:43], v[24:27], a[48:51]
    v_mfma_f32_16x16x32_bf16 a[68:71], v[40:43], v[28:31], a[68:71]
    v_mfma_f32_16x16x32_bf16 a[12:15], v[44:47], v[16:19], a[12:15]
    v_mfma_f32_16x16x32_bf16 a[32:35], v[44:47], v[20:23], a[32:35]
    v_mfma_f32_16x16x32_bf16 a[52:55], v[44:47], v[24:27], a[52:55]
    v_mfma_f32_16x16x32_bf16 a[72:75], v[44:47], v[28:31], a[72:75]
    v_mfma_f32_16x16x32_bf16 a[16:19], v[48:51], v[16:19], a[16:19]
    v_mfma_f32_16x16x32_bf16 a[36:39], v[48:51], v[20:23], a[36:39]
    v_mfma_f32_16x16x32_bf16 a[56:59], v[48:51], v[24:27], a[56:59]
    v_mfma_f32_16x16x32_bf16 a[76:79], v[48:51], v[28:31], a[76:79]
    s_sub_u32 s28, s28, 1
    s_cmp_eq_u32 s28, 0
    s_cbranch_scc1 qkv_a_kernel_loop0_last
    s_add_u32 s25, s25, 64
    s_add_u32 s32, s32, 1024
    s_add_u32 s33, s33, 1024
    s_add_u32 s34, s34, 1024
    s_add_u32 s35, s35, 1024
    s_add_u32 s36, s36, 1024
    buffer_load_dwordx4 v[16:19], v8, s[8:11], s25 offen
    buffer_load_dwordx4 v[20:23], v9, s[8:11], s25 offen
    buffer_load_dwordx4 v[24:27], v10, s[8:11], s25 offen
    buffer_load_dwordx4 v[28:31], v11, s[8:11], s25 offen
    buffer_load_dwordx4 v[32:35], v7, s[8:11], s32 offen
    buffer_load_dwordx4 v[36:39], v7, s[8:11], s33 offen
    buffer_load_dwordx4 v[40:43], v7, s[8:11], s34 offen
    buffer_load_dwordx4 v[44:47], v7, s[8:11], s35 offen
    buffer_load_dwordx4 v[48:51], v7, s[8:11], s36 offen
    s_waitcnt vmcnt(9)
    v_mfma_f32_16x16x32_bf16 a[0:3], v[68:71], v[52:55], a[0:3]
    v_mfma_f32_16x16x32_bf16 a[20:23], v[68:71], v[56:59], a[20:23]
    v_mfma_f32_16x16x32_bf16 a[40:43], v[68:71], v[60:63], a[40:43]
    v_mfma_f32_16x16x32_bf16 a[60:63], v[68:71], v[64:67], a[60:63]
    v_mfma_f32_16x16x32_bf16 a[4:7], v[72:75], v[52:55], a[4:7]
    v_mfma_f32_16x16x32_bf16 a[24:27], v[72:75], v[56:59], a[24:27]
    v_mfma_f32_16x16x32_bf16 a[44:47], v[72:75], v[60:63], a[44:47]
    v_mfma_f32_16x16x32_bf16 a[64:67], v[72:75], v[64:67], a[64:67]
    v_mfma_f32_16x16x32_bf16 a[8:11], v[76:79], v[52:55], a[8:11]
    v_mfma_f32_16x16x32_bf16 a[28:31], v[76:79], v[56:59], a[28:31]
    v_mfma_f32_16x16x32_bf16 a[48:51], v[76:79], v[60:63], a[48:51]
    v_mfma_f32_16x16x32_bf16 a[68:71], v[76:79], v[64:67], a[68:71]
    v_mfma_f32_16x16x32_bf16 a[12:15], v[80:83], v[52:55], a[12:15]
    v_mfma_f32_16x16x32_bf16 a[32:35], v[80:83], v[56:59], a[32:35]
    v_mfma_f32_16x16x32_bf16 a[52:55], v[80:83], v[60:63], a[52:55]
    v_mfma_f32_16x16x32_bf16 a[72:75], v[80:83], v[64:67], a[72:75]
    v_mfma_f32_16x16x32_bf16 a[16:19], v[84:87], v[52:55], a[16:19]
    v_mfma_f32_16x16x32_bf16 a[36:39], v[84:87], v[56:59], a[36:39]
    v_mfma_f32_16x16x32_bf16 a[56:59], v[84:87], v[60:63], a[56:59]
    v_mfma_f32_16x16x32_bf16 a[76:79], v[84:87], v[64:67], a[76:79]
    s_branch qkv_a_kernel_loop0
qkv_a_kernel_loop0_last:
    s_waitcnt vmcnt(0)
    v_mfma_f32_16x16x32_bf16 a[0:3], v[68:71], v[52:55], a[0:3]
    v_mfma_f32_16x16x32_bf16 a[20:23], v[68:71], v[56:59], a[20:23]
    v_mfma_f32_16x16x32_bf16 a[40:43], v[68:71], v[60:63], a[40:43]
    v_mfma_f32_16x16x32_bf16 a[60:63], v[68:71], v[64:67], a[60:63]
    v_mfma_f32_16x16x32_bf16 a[4:7], v[72:75], v[52:55], a[4:7]
    v_mfma_f32_16x16x32_bf16 a[24:27], v[72:75], v[56:59], a[24:27]
    v_mfma_f32_16x16x32_bf16 a[44:47], v[72:75], v[60:63], a[44:47]
    v_mfma_f32_16x16x32_bf16 a[64:67], v[72:75], v[64:67], a[64:67]
    v_mfma_f32_16x16x32_bf16 a[8:11], v[76:79], v[52:55], a[8:11]
    v_mfma_f32_16x16x32_bf16 a[28:31], v[76:79], v[56:59], a[28:31]
    v_mfma_f32_16x16x32_bf16 a[48:51], v[76:79], v[60:63], a[48:51]
    v_mfma_f32_16x16x32_bf16 a[68:71], v[76:79], v[64:67], a[68:71]
    v_mfma_f32_16x16x32_bf16 a[12:15], v[80:83], v[52:55], a[12:15]
    v_mfma_f32_16x16x32_bf16 a[32:35], v[80:83], v[56:59], a[32:35]
    v_mfma_f32_16x16x32_bf16 a[52:55], v[80:83], v[60:63], a[52:55]
    v_mfma_f32_16x16x32_bf16 a[72:75], v[80:83], v[64:67], a[72:75]
    v_mfma_f32_16x16x32_bf16 a[16:19], v[84:87], v[52:55], a[16:19]
    v_mfma_f32_16x16x32_bf16 a[36:39], v[84:87], v[56:59], a[36:39]
    v_mfma_f32_16x16x32_bf16 a[56:59], v[84:87], v[60:63], a[56:59]
    v_mfma_f32_16x16x32_bf16 a[76:79], v[84:87], v[64:67], a[76:79]
    s_nop 7
    s_nop 7
    s_mov_b32 s24, 1280
    s_lshl_b32 s29, s23, 1
    s_add_u32 s29, s29, 229638144
    v_add_u32 v5, s22, v3
    v_mul_lo_u32 v5, v5, s24
    v_lshlrev_b32 v6, 3, v4
    v_add3_u32 v5, v5, v6, s29
    v_accvgpr_read_b32 v92, a0
    v_accvgpr_read_b32 v93, a1
    v_accvgpr_read_b32 v94, a2
    v_accvgpr_read_b32 v95, a3
    v_cvt_pk_bf16_f32 v96, v92, v93
    v_cvt_pk_bf16_f32 v97, v94, v95
    v_add_u32 v6, 0, v5
    buffer_store_dwordx2 v[96:97], v6, s[8:11], 0 offen
    v_accvgpr_read_b32 v92, a4
    v_accvgpr_read_b32 v93, a5
    v_accvgpr_read_b32 v94, a6
    v_accvgpr_read_b32 v95, a7
    v_cvt_pk_bf16_f32 v96, v92, v93
    v_cvt_pk_bf16_f32 v97, v94, v95
    v_add_u32 v6, 32, v5
    buffer_store_dwordx2 v[96:97], v6, s[8:11], 0 offen
    v_accvgpr_read_b32 v92, a8
    v_accvgpr_read_b32 v93, a9
    v_accvgpr_read_b32 v94, a10
    v_accvgpr_read_b32 v95, a11
    v_cvt_pk_bf16_f32 v96, v92, v93
    v_cvt_pk_bf16_f32 v97, v94, v95
    v_add_u32 v6, 64, v5
    buffer_store_dwordx2 v[96:97], v6, s[8:11], 0 offen
    v_accvgpr_read_b32 v92, a12
    v_accvgpr_read_b32 v93, a13
    v_accvgpr_read_b32 v94, a14
    v_accvgpr_read_b32 v95, a15
    v_cvt_pk_bf16_f32 v96, v92, v93
    v_cvt_pk_bf16_f32 v97, v94, v95
    v_add_u32 v6, 96, v5
    buffer_store_dwordx2 v[96:97], v6, s[8:11], 0 offen
    v_accvgpr_read_b32 v92, a16
    v_accvgpr_read_b32 v93, a17
    v_accvgpr_read_b32 v94, a18
    v_accvgpr_read_b32 v95, a19
    v_cvt_pk_bf16_f32 v96, v92, v93
    v_cvt_pk_bf16_f32 v97, v94, v95
    v_add_u32 v6, 128, v5
    buffer_store_dwordx2 v[96:97], v6, s[8:11], 0 offen
    v_accvgpr_read_b32 v92, a20
    v_accvgpr_read_b32 v93, a21
    v_accvgpr_read_b32 v94, a22
    v_accvgpr_read_b32 v95, a23
    v_cvt_pk_bf16_f32 v96, v92, v93
    v_cvt_pk_bf16_f32 v97, v94, v95
    v_add_u32 v6, 20480, v5
    buffer_store_dwordx2 v[96:97], v6, s[8:11], 0 offen
    v_accvgpr_read_b32 v92, a24
    v_accvgpr_read_b32 v93, a25
    v_accvgpr_read_b32 v94, a26
    v_accvgpr_read_b32 v95, a27
    v_cvt_pk_bf16_f32 v96, v92, v93
    v_cvt_pk_bf16_f32 v97, v94, v95
    v_add_u32 v6, 20512, v5
    buffer_store_dwordx2 v[96:97], v6, s[8:11], 0 offen
    v_accvgpr_read_b32 v92, a28
    v_accvgpr_read_b32 v93, a29
    v_accvgpr_read_b32 v94, a30
    v_accvgpr_read_b32 v95, a31
    v_cvt_pk_bf16_f32 v96, v92, v93
    v_cvt_pk_bf16_f32 v97, v94, v95
    v_add_u32 v6, 20544, v5
    buffer_store_dwordx2 v[96:97], v6, s[8:11], 0 offen
    v_accvgpr_read_b32 v92, a32
    v_accvgpr_read_b32 v93, a33
    v_accvgpr_read_b32 v94, a34
    v_accvgpr_read_b32 v95, a35
    v_cvt_pk_bf16_f32 v96, v92, v93
    v_cvt_pk_bf16_f32 v97, v94, v95
    v_add_u32 v6, 20576, v5
    buffer_store_dwordx2 v[96:97], v6, s[8:11], 0 offen
    v_accvgpr_read_b32 v92, a36
    v_accvgpr_read_b32 v93, a37
    v_accvgpr_read_b32 v94, a38
    v_accvgpr_read_b32 v95, a39
    v_cvt_pk_bf16_f32 v96, v92, v93
    v_cvt_pk_bf16_f32 v97, v94, v95
    v_add_u32 v6, 20608, v5
    buffer_store_dwordx2 v[96:97], v6, s[8:11], 0 offen
    v_accvgpr_read_b32 v92, a40
    v_accvgpr_read_b32 v93, a41
    v_accvgpr_read_b32 v94, a42
    v_accvgpr_read_b32 v95, a43
    v_cvt_pk_bf16_f32 v96, v92, v93
    v_cvt_pk_bf16_f32 v97, v94, v95
    v_add_u32 v6, 40960, v5
    buffer_store_dwordx2 v[96:97], v6, s[8:11], 0 offen
    v_accvgpr_read_b32 v92, a44
    v_accvgpr_read_b32 v93, a45
    v_accvgpr_read_b32 v94, a46
    v_accvgpr_read_b32 v95, a47
    v_cvt_pk_bf16_f32 v96, v92, v93
    v_cvt_pk_bf16_f32 v97, v94, v95
    v_add_u32 v6, 40992, v5
    buffer_store_dwordx2 v[96:97], v6, s[8:11], 0 offen
    v_accvgpr_read_b32 v92, a48
    v_accvgpr_read_b32 v93, a49
    v_accvgpr_read_b32 v94, a50
    v_accvgpr_read_b32 v95, a51
    v_cvt_pk_bf16_f32 v96, v92, v93
    v_cvt_pk_bf16_f32 v97, v94, v95
    v_add_u32 v6, 41024, v5
    buffer_store_dwordx2 v[96:97], v6, s[8:11], 0 offen
    v_accvgpr_read_b32 v92, a52
    v_accvgpr_read_b32 v93, a53
    v_accvgpr_read_b32 v94, a54
    v_accvgpr_read_b32 v95, a55
    v_cvt_pk_bf16_f32 v96, v92, v93
    v_cvt_pk_bf16_f32 v97, v94, v95
    v_add_u32 v6, 41056, v5
    buffer_store_dwordx2 v[96:97], v6, s[8:11], 0 offen
    v_accvgpr_read_b32 v92, a56
    v_accvgpr_read_b32 v93, a57
    v_accvgpr_read_b32 v94, a58
    v_accvgpr_read_b32 v95, a59
    v_cvt_pk_bf16_f32 v96, v92, v93
    v_cvt_pk_bf16_f32 v97, v94, v95
    v_add_u32 v6, 41088, v5
    buffer_store_dwordx2 v[96:97], v6, s[8:11], 0 offen
    v_accvgpr_read_b32 v92, a60
    v_accvgpr_read_b32 v93, a61
    v_accvgpr_read_b32 v94, a62
    v_accvgpr_read_b32 v95, a63
    v_cvt_pk_bf16_f32 v96, v92, v93
    v_cvt_pk_bf16_f32 v97, v94, v95
    v_add_u32 v6, 61440, v5
    buffer_store_dwordx2 v[96:97], v6, s[8:11], 0 offen
    v_accvgpr_read_b32 v92, a64
    v_accvgpr_read_b32 v93, a65
    v_accvgpr_read_b32 v94, a66
    v_accvgpr_read_b32 v95, a67
    v_cvt_pk_bf16_f32 v96, v92, v93
    v_cvt_pk_bf16_f32 v97, v94, v95
    v_add_u32 v6, 61472, v5
    buffer_store_dwordx2 v[96:97], v6, s[8:11], 0 offen
    v_accvgpr_read_b32 v92, a68
    v_accvgpr_read_b32 v93, a69
    v_accvgpr_read_b32 v94, a70
    v_accvgpr_read_b32 v95, a71
    v_cvt_pk_bf16_f32 v96, v92, v93
    v_cvt_pk_bf16_f32 v97, v94, v95
    v_add_u32 v6, 61504, v5
    buffer_store_dwordx2 v[96:97], v6, s[8:11], 0 offen
    v_accvgpr_read_b32 v92, a72
    v_accvgpr_read_b32 v93, a73
    v_accvgpr_read_b32 v94, a74
    v_accvgpr_read_b32 v95, a75
    v_cvt_pk_bf16_f32 v96, v92, v93
    v_cvt_pk_bf16_f32 v97, v94, v95
    v_add_u32 v6, 61536, v5
    buffer_store_dwordx2 v[96:97], v6, s[8:11], 0 offen
    v_accvgpr_read_b32 v92, a76
    v_accvgpr_read_b32 v93, a77
    v_accvgpr_read_b32 v94, a78
    v_accvgpr_read_b32 v95, a79
    v_cvt_pk_bf16_f32 v96, v92, v93
    v_cvt_pk_bf16_f32 v97, v94, v95
    v_add_u32 v6, 61568, v5
    buffer_store_dwordx2 v[96:97], v6, s[8:11], 0 offen
    s_branch qkv_a_kernel_end
qkv_a_kernel_nrm:
    buffer_load_dwordx4 v[16:19], v8, s[8:11], s25 offen
    buffer_load_dwordx4 v[20:23], v9, s[8:11], s25 offen
    buffer_load_dwordx4 v[24:27], v10, s[8:11], s25 offen
    buffer_load_dwordx4 v[28:31], v11, s[8:11], s25 offen
    buffer_load_dwordx4 v[32:35], v7, s[8:11], s32 offen
    buffer_load_dwordx4 v[36:39], v7, s[8:11], s33 offen
    buffer_load_dwordx4 v[40:43], v7, s[8:11], s34 offen
    buffer_load_dwordx4 v[44:47], v7, s[8:11], s35 offen
    buffer_load_dwordx4 v[48:51], v7, s[8:11], s36 offen
    s_mov_b32 s28, 10
qkv_a_kernel_loop1:
    s_add_u32 s25, s25, 64
    s_add_u32 s32, s32, 1024
    s_add_u32 s33, s33, 1024
    s_add_u32 s34, s34, 1024
    s_add_u32 s35, s35, 1024
    s_add_u32 s36, s36, 1024
    buffer_load_dwordx4 v[52:55], v8, s[8:11], s25 offen
    buffer_load_dwordx4 v[56:59], v9, s[8:11], s25 offen
    buffer_load_dwordx4 v[60:63], v10, s[8:11], s25 offen
    buffer_load_dwordx4 v[64:67], v11, s[8:11], s25 offen
    buffer_load_dwordx4 v[68:71], v7, s[8:11], s32 offen
    buffer_load_dwordx4 v[72:75], v7, s[8:11], s33 offen
    buffer_load_dwordx4 v[76:79], v7, s[8:11], s34 offen
    buffer_load_dwordx4 v[80:83], v7, s[8:11], s35 offen
    buffer_load_dwordx4 v[84:87], v7, s[8:11], s36 offen
    s_waitcnt vmcnt(9)
    v_mfma_f32_16x16x32_bf16 a[0:3], v[16:19], v[32:35], a[0:3]
    v_mfma_f32_16x16x32_bf16 a[20:23], v[20:23], v[32:35], a[20:23]
    v_mfma_f32_16x16x32_bf16 a[40:43], v[24:27], v[32:35], a[40:43]
    v_mfma_f32_16x16x32_bf16 a[60:63], v[28:31], v[32:35], a[60:63]
    v_mfma_f32_16x16x32_bf16 a[4:7], v[16:19], v[36:39], a[4:7]
    v_mfma_f32_16x16x32_bf16 a[24:27], v[20:23], v[36:39], a[24:27]
    v_mfma_f32_16x16x32_bf16 a[44:47], v[24:27], v[36:39], a[44:47]
    v_mfma_f32_16x16x32_bf16 a[64:67], v[28:31], v[36:39], a[64:67]
    v_mfma_f32_16x16x32_bf16 a[8:11], v[16:19], v[40:43], a[8:11]
    v_mfma_f32_16x16x32_bf16 a[28:31], v[20:23], v[40:43], a[28:31]
    v_mfma_f32_16x16x32_bf16 a[48:51], v[24:27], v[40:43], a[48:51]
    v_mfma_f32_16x16x32_bf16 a[68:71], v[28:31], v[40:43], a[68:71]
    v_mfma_f32_16x16x32_bf16 a[12:15], v[16:19], v[44:47], a[12:15]
    v_mfma_f32_16x16x32_bf16 a[32:35], v[20:23], v[44:47], a[32:35]
    v_mfma_f32_16x16x32_bf16 a[52:55], v[24:27], v[44:47], a[52:55]
    v_mfma_f32_16x16x32_bf16 a[72:75], v[28:31], v[44:47], a[72:75]
    v_mfma_f32_16x16x32_bf16 a[16:19], v[16:19], v[48:51], a[16:19]
    v_mfma_f32_16x16x32_bf16 a[36:39], v[20:23], v[48:51], a[36:39]
    v_mfma_f32_16x16x32_bf16 a[56:59], v[24:27], v[48:51], a[56:59]
    v_mfma_f32_16x16x32_bf16 a[76:79], v[28:31], v[48:51], a[76:79]
    s_sub_u32 s28, s28, 1
    s_cmp_eq_u32 s28, 0
    s_cbranch_scc1 qkv_a_kernel_loop1_last
    s_add_u32 s25, s25, 64
    s_add_u32 s32, s32, 1024
    s_add_u32 s33, s33, 1024
    s_add_u32 s34, s34, 1024
    s_add_u32 s35, s35, 1024
    s_add_u32 s36, s36, 1024
    buffer_load_dwordx4 v[16:19], v8, s[8:11], s25 offen
    buffer_load_dwordx4 v[20:23], v9, s[8:11], s25 offen
    buffer_load_dwordx4 v[24:27], v10, s[8:11], s25 offen
    buffer_load_dwordx4 v[28:31], v11, s[8:11], s25 offen
    buffer_load_dwordx4 v[32:35], v7, s[8:11], s32 offen
    buffer_load_dwordx4 v[36:39], v7, s[8:11], s33 offen
    buffer_load_dwordx4 v[40:43], v7, s[8:11], s34 offen
    buffer_load_dwordx4 v[44:47], v7, s[8:11], s35 offen
    buffer_load_dwordx4 v[48:51], v7, s[8:11], s36 offen
    s_waitcnt vmcnt(9)
    v_mfma_f32_16x16x32_bf16 a[0:3], v[52:55], v[68:71], a[0:3]
    v_mfma_f32_16x16x32_bf16 a[20:23], v[56:59], v[68:71], a[20:23]
    v_mfma_f32_16x16x32_bf16 a[40:43], v[60:63], v[68:71], a[40:43]
    v_mfma_f32_16x16x32_bf16 a[60:63], v[64:67], v[68:71], a[60:63]
    v_mfma_f32_16x16x32_bf16 a[4:7], v[52:55], v[72:75], a[4:7]
    v_mfma_f32_16x16x32_bf16 a[24:27], v[56:59], v[72:75], a[24:27]
    v_mfma_f32_16x16x32_bf16 a[44:47], v[60:63], v[72:75], a[44:47]
    v_mfma_f32_16x16x32_bf16 a[64:67], v[64:67], v[72:75], a[64:67]
    v_mfma_f32_16x16x32_bf16 a[8:11], v[52:55], v[76:79], a[8:11]
    v_mfma_f32_16x16x32_bf16 a[28:31], v[56:59], v[76:79], a[28:31]
    v_mfma_f32_16x16x32_bf16 a[48:51], v[60:63], v[76:79], a[48:51]
    v_mfma_f32_16x16x32_bf16 a[68:71], v[64:67], v[76:79], a[68:71]
    v_mfma_f32_16x16x32_bf16 a[12:15], v[52:55], v[80:83], a[12:15]
    v_mfma_f32_16x16x32_bf16 a[32:35], v[56:59], v[80:83], a[32:35]
    v_mfma_f32_16x16x32_bf16 a[52:55], v[60:63], v[80:83], a[52:55]
    v_mfma_f32_16x16x32_bf16 a[72:75], v[64:67], v[80:83], a[72:75]
    v_mfma_f32_16x16x32_bf16 a[16:19], v[52:55], v[84:87], a[16:19]
    v_mfma_f32_16x16x32_bf16 a[36:39], v[56:59], v[84:87], a[36:39]
    v_mfma_f32_16x16x32_bf16 a[56:59], v[60:63], v[84:87], a[56:59]
    v_mfma_f32_16x16x32_bf16 a[76:79], v[64:67], v[84:87], a[76:79]
    s_branch qkv_a_kernel_loop1
qkv_a_kernel_loop1_last:
    s_waitcnt vmcnt(0)
    v_mfma_f32_16x16x32_bf16 a[0:3], v[52:55], v[68:71], a[0:3]
    v_mfma_f32_16x16x32_bf16 a[20:23], v[56:59], v[68:71], a[20:23]
    v_mfma_f32_16x16x32_bf16 a[40:43], v[60:63], v[68:71], a[40:43]
    v_mfma_f32_16x16x32_bf16 a[60:63], v[64:67], v[68:71], a[60:63]
    v_mfma_f32_16x16x32_bf16 a[4:7], v[52:55], v[72:75], a[4:7]
    v_mfma_f32_16x16x32_bf16 a[24:27], v[56:59], v[72:75], a[24:27]
    v_mfma_f32_16x16x32_bf16 a[44:47], v[60:63], v[72:75], a[44:47]
    v_mfma_f32_16x16x32_bf16 a[64:67], v[64:67], v[72:75], a[64:67]
    v_mfma_f32_16x16x32_bf16 a[8:11], v[52:55], v[76:79], a[8:11]
    v_mfma_f32_16x16x32_bf16 a[28:31], v[56:59], v[76:79], a[28:31]
    v_mfma_f32_16x16x32_bf16 a[48:51], v[60:63], v[76:79], a[48:51]
    v_mfma_f32_16x16x32_bf16 a[68:71], v[64:67], v[76:79], a[68:71]
    v_mfma_f32_16x16x32_bf16 a[12:15], v[52:55], v[80:83], a[12:15]
    v_mfma_f32_16x16x32_bf16 a[32:35], v[56:59], v[80:83], a[32:35]
    v_mfma_f32_16x16x32_bf16 a[52:55], v[60:63], v[80:83], a[52:55]
    v_mfma_f32_16x16x32_bf16 a[72:75], v[64:67], v[80:83], a[72:75]
    v_mfma_f32_16x16x32_bf16 a[16:19], v[52:55], v[84:87], a[16:19]
    v_mfma_f32_16x16x32_bf16 a[36:39], v[56:59], v[84:87], a[36:39]
    v_mfma_f32_16x16x32_bf16 a[56:59], v[60:63], v[84:87], a[56:59]
    v_mfma_f32_16x16x32_bf16 a[76:79], v[64:67], v[84:87], a[76:79]
    s_nop 7
    s_nop 7
    s_sub_u32 s29, s23, 640
    v_add_u32 v5, s29, v3
    v_lshlrev_b32 v5, 11, v5
    v_lshlrev_b32 v6, 2, v4
    v_add3_u32 v5, v5, v6, s22
    v_lshlrev_b32 v5, 1, v5
    v_add_u32 v5, 232783872, v5
    v_accvgpr_read_b32 v92, a0
    v_accvgpr_read_b32 v93, a1
    v_accvgpr_read_b32 v94, a2
    v_accvgpr_read_b32 v95, a3
    v_cvt_pk_bf16_f32 v96, v92, v93
    v_cvt_pk_bf16_f32 v97, v94, v95
    v_add_u32 v6, 0, v5
    buffer_store_dwordx2 v[96:97], v6, s[8:11], 0 offen
    v_accvgpr_read_b32 v92, a4
    v_accvgpr_read_b32 v93, a5
    v_accvgpr_read_b32 v94, a6
    v_accvgpr_read_b32 v95, a7
    v_cvt_pk_bf16_f32 v96, v92, v93
    v_cvt_pk_bf16_f32 v97, v94, v95
    v_add_u32 v6, 65536, v5
    buffer_store_dwordx2 v[96:97], v6, s[8:11], 0 offen
    v_accvgpr_read_b32 v92, a8
    v_accvgpr_read_b32 v93, a9
    v_accvgpr_read_b32 v94, a10
    v_accvgpr_read_b32 v95, a11
    v_cvt_pk_bf16_f32 v96, v92, v93
    v_cvt_pk_bf16_f32 v97, v94, v95
    v_add_u32 v6, 131072, v5
    buffer_store_dwordx2 v[96:97], v6, s[8:11], 0 offen
    v_accvgpr_read_b32 v92, a12
    v_accvgpr_read_b32 v93, a13
    v_accvgpr_read_b32 v94, a14
    v_accvgpr_read_b32 v95, a15
    v_cvt_pk_bf16_f32 v96, v92, v93
    v_cvt_pk_bf16_f32 v97, v94, v95
    v_add_u32 v6, 196608, v5
    buffer_store_dwordx2 v[96:97], v6, s[8:11], 0 offen
    v_accvgpr_read_b32 v92, a16
    v_accvgpr_read_b32 v93, a17
    v_accvgpr_read_b32 v94, a18
    v_accvgpr_read_b32 v95, a19
    v_cvt_pk_bf16_f32 v96, v92, v93
    v_cvt_pk_bf16_f32 v97, v94, v95
    v_add_u32 v6, 262144, v5
    buffer_store_dwordx2 v[96:97], v6, s[8:11], 0 offen
    v_accvgpr_read_b32 v92, a20
    v_accvgpr_read_b32 v93, a21
    v_accvgpr_read_b32 v94, a22
    v_accvgpr_read_b32 v95, a23
    v_cvt_pk_bf16_f32 v96, v92, v93
    v_cvt_pk_bf16_f32 v97, v94, v95
    v_add_u32 v6, 32, v5
    buffer_store_dwordx2 v[96:97], v6, s[8:11], 0 offen
    v_accvgpr_read_b32 v92, a24
    v_accvgpr_read_b32 v93, a25
    v_accvgpr_read_b32 v94, a26
    v_accvgpr_read_b32 v95, a27
    v_cvt_pk_bf16_f32 v96, v92, v93
    v_cvt_pk_bf16_f32 v97, v94, v95
    v_add_u32 v6, 65568, v5
    buffer_store_dwordx2 v[96:97], v6, s[8:11], 0 offen
    v_accvgpr_read_b32 v92, a28
    v_accvgpr_read_b32 v93, a29
    v_accvgpr_read_b32 v94, a30
    v_accvgpr_read_b32 v95, a31
    v_cvt_pk_bf16_f32 v96, v92, v93
    v_cvt_pk_bf16_f32 v97, v94, v95
    v_add_u32 v6, 131104, v5
    buffer_store_dwordx2 v[96:97], v6, s[8:11], 0 offen
    v_accvgpr_read_b32 v92, a32
    v_accvgpr_read_b32 v93, a33
    v_accvgpr_read_b32 v94, a34
    v_accvgpr_read_b32 v95, a35
    v_cvt_pk_bf16_f32 v96, v92, v93
    v_cvt_pk_bf16_f32 v97, v94, v95
    v_add_u32 v6, 196640, v5
    buffer_store_dwordx2 v[96:97], v6, s[8:11], 0 offen
    v_accvgpr_read_b32 v92, a36
    v_accvgpr_read_b32 v93, a37
    v_accvgpr_read_b32 v94, a38
    v_accvgpr_read_b32 v95, a39
    v_cvt_pk_bf16_f32 v96, v92, v93
    v_cvt_pk_bf16_f32 v97, v94, v95
    v_add_u32 v6, 262176, v5
    buffer_store_dwordx2 v[96:97], v6, s[8:11], 0 offen
    v_accvgpr_read_b32 v92, a40
    v_accvgpr_read_b32 v93, a41
    v_accvgpr_read_b32 v94, a42
    v_accvgpr_read_b32 v95, a43
    v_cvt_pk_bf16_f32 v96, v92, v93
    v_cvt_pk_bf16_f32 v97, v94, v95
    v_add_u32 v6, 64, v5
    buffer_store_dwordx2 v[96:97], v6, s[8:11], 0 offen
    v_accvgpr_read_b32 v92, a44
    v_accvgpr_read_b32 v93, a45
    v_accvgpr_read_b32 v94, a46
    v_accvgpr_read_b32 v95, a47
    v_cvt_pk_bf16_f32 v96, v92, v93
    v_cvt_pk_bf16_f32 v97, v94, v95
    v_add_u32 v6, 65600, v5
    buffer_store_dwordx2 v[96:97], v6, s[8:11], 0 offen
    v_accvgpr_read_b32 v92, a48
    v_accvgpr_read_b32 v93, a49
    v_accvgpr_read_b32 v94, a50
    v_accvgpr_read_b32 v95, a51
    v_cvt_pk_bf16_f32 v96, v92, v93
    v_cvt_pk_bf16_f32 v97, v94, v95
    v_add_u32 v6, 131136, v5
    buffer_store_dwordx2 v[96:97], v6, s[8:11], 0 offen
    v_accvgpr_read_b32 v92, a52
    v_accvgpr_read_b32 v93, a53
    v_accvgpr_read_b32 v94, a54
    v_accvgpr_read_b32 v95, a55
    v_cvt_pk_bf16_f32 v96, v92, v93
    v_cvt_pk_bf16_f32 v97, v94, v95
    v_add_u32 v6, 196672, v5
    buffer_store_dwordx2 v[96:97], v6, s[8:11], 0 offen
    v_accvgpr_read_b32 v92, a56
    v_accvgpr_read_b32 v93, a57
    v_accvgpr_read_b32 v94, a58
    v_accvgpr_read_b32 v95, a59
    v_cvt_pk_bf16_f32 v96, v92, v93
    v_cvt_pk_bf16_f32 v97, v94, v95
    v_add_u32 v6, 262208, v5
    buffer_store_dwordx2 v[96:97], v6, s[8:11], 0 offen
    v_accvgpr_read_b32 v92, a60
    v_accvgpr_read_b32 v93, a61
    v_accvgpr_read_b32 v94, a62
    v_accvgpr_read_b32 v95, a63
    v_cvt_pk_bf16_f32 v96, v92, v93
    v_cvt_pk_bf16_f32 v97, v94, v95
    v_add_u32 v6, 96, v5
    buffer_store_dwordx2 v[96:97], v6, s[8:11], 0 offen
    v_accvgpr_read_b32 v92, a64
    v_accvgpr_read_b32 v93, a65
    v_accvgpr_read_b32 v94, a66
    v_accvgpr_read_b32 v95, a67
    v_cvt_pk_bf16_f32 v96, v92, v93
    v_cvt_pk_bf16_f32 v97, v94, v95
    v_add_u32 v6, 65632, v5
    buffer_store_dwordx2 v[96:97], v6, s[8:11], 0 offen
    v_accvgpr_read_b32 v92, a68
    v_accvgpr_read_b32 v93, a69
    v_accvgpr_read_b32 v94, a70
    v_accvgpr_read_b32 v95, a71
    v_cvt_pk_bf16_f32 v96, v92, v93
    v_cvt_pk_bf16_f32 v97, v94, v95
    v_add_u32 v6, 131168, v5
    buffer_store_dwordx2 v[96:97], v6, s[8:11], 0 offen
    v_accvgpr_read_b32 v92, a72
    v_accvgpr_read_b32 v93, a73
    v_accvgpr_read_b32 v94, a74
    v_accvgpr_read_b32 v95, a75
    v_cvt_pk_bf16_f32 v96, v92, v93
    v_cvt_pk_bf16_f32 v97, v94, v95
    v_add_u32 v6, 196704, v5
    buffer_store_dwordx2 v[96:97], v6, s[8:11], 0 offen
    v_accvgpr_read_b32 v92, a76
    v_accvgpr_read_b32 v93, a77
    v_accvgpr_read_b32 v94, a78
    v_accvgpr_read_b32 v95, a79
    v_cvt_pk_bf16_f32 v96, v92, v93
    v_cvt_pk_bf16_f32 v97, v94, v95
    v_add_u32 v6, 262240, v5
    buffer_store_dwordx2 v[96:97], v6, s[8:11], 0 offen
qkv_a_kernel_end:
    s_endpgm
.section .rodata,"a"
.p2align 6
.amdhsa_kernel qkv_a_kernel
  .amdhsa_next_free_vgpr 192
  .amdhsa_next_free_sgpr 64
  .amdhsa_accum_offset 112
  .amdhsa_group_segment_fixed_size 0
  .amdhsa_kernarg_size 104
  .amdhsa_user_sgpr_count 2
  .amdhsa_user_sgpr_kernarg_segment_ptr 1
  .amdhsa_system_sgpr_workgroup_id_x 1
.end_amdhsa_kernel
.text
.globl kvz_a1_kernel
.p2align 8
.type kvz_a1_kernel,@function
kvz_a1_kernel:
    v_lshrrev_b32 v1, 6, v0
    v_and_b32 v2, 63, v0
    s_nop 0
    v_readfirstlane_b32 s3, v1
    s_lshl_b32 s4, s2, 2
    s_add_u32 s4, s4, s3
    s_cmp_ge_u32 s4, 512
    s_cbranch_scc1 kvz_a1_kernel_end
    s_load_dwordx2 s[6:7], s[0:1], 96
    s_waitcnt lgkmcnt(0)
    s_mov_b32 s8, s6
    s_mov_b32 s9, s7
    s_mov_b32 s10, 268435456
    s_mov_b32 s11, 0x00020000
    s_lshr_b32 s5, s4, 4
    s_and_b32 s12, s4, 15
    s_mul_i32 s13, s5, 20
    v_and_b32 v3, 15, v2
    v_lshrrev_b32 v4, 4, v2
    s_lshl_b32 s14, s12, 7
    v_lshlrev_b32 v5, 3, v4
    v_add_u32 v5, s14, v5
    v_add_u32 v6, 0, v3
    v_min_u32 v8, 19, v6
    v_add_u32 v8, s13, v8
    v_lshlrev_b32 v8, 11, v8
    v_add_u32 v8, v8, v5
    v_lshlrev_b32 v8, 1, v8
    v_add_u32 v8, 232783872, v8
    v_add_u32 v10, 2621440, v8
    v_add_u32 v7, 16, v3
    v_min_u32 v9, 19, v7
    v_add_u32 v9, s13, v9
    v_lshlrev_b32 v9, 11, v9
    v_add_u32 v9, v9, v5
    v_lshlrev_b32 v9, 1, v9
    v_add_u32 v9, 232783872, v9
    v_add_u32 v11, 2621440, v9
    v_accvgpr_write_b32 a0, 0
    v_accvgpr_write_b32 a1, 0
    v_accvgpr_write_b32 a2, 0
    v_accvgpr_write_b32 a3, 0
    v_accvgpr_write_b32 a4, 0
    v_accvgpr_write_b32 a5, 0
    v_accvgpr_write_b32 a6, 0
    v_accvgpr_write_b32 a7, 0
    v_accvgpr_write_b32 a8, 0
    v_accvgpr_write_b32 a9, 0
    v_accvgpr_write_b32 a10, 0
    v_accvgpr_write_b32 a11, 0
    v_accvgpr_write_b32 a12, 0
    v_accvgpr_write_b32 a13, 0
    v_accvgpr_write_b32 a14, 0
    v_accvgpr_write_b32 a15, 0
    v_cmp_gt_u32 s[16:17], 20, v7
    v_cmp_eq_u32 s[18:19], 20, v7
    buffer_load_dwordx4 v[16:19], v8, s[8:11], 0 offen offset:0
    buffer_load_dwordx4 v[24:27], v10, s[8:11], 0 offen offset:0
    buffer_load_dwordx4 v[20:23], v9, s[8:11], 0 offen offset:0
    buffer_load_dwordx4 v[28:31], v11, s[8:11], 0 offen offset:0
    s_waitcnt vmcnt(0)
    v_lshlrev_b32 v32, 16, v16
    v_and_b32 v33, 0xffff0000, v16
    v_mul_f32 v36, 1.4426950408889634, v32
    v_exp_f32 v36, v36
    v_add_f32 v34, 1.0, v32
    v_cmp_lt_f32 vcc, 0, v32
    s_nop 1
    v_cndmask_b32 v34, v36, v34, vcc
    v_add_f32 v34, 0x358637bd, v34
    v_mul_f32 v36, 1.4426950408889634, v33
    v_exp_f32 v36, v36
    v_add_f32 v35, 1.0, v33
    v_cmp_lt_f32 vcc, 0, v33
    s_nop 1
    v_cndmask_b32 v35, v36, v35, vcc
    v_add_f32 v35, 0x358637bd, v35
    v_cvt_pk_bf16_f32 v16, v34, v35
    v_lshlrev_b32 v32, 16, v17
    v_and_b32 v33, 0xffff0000, v17
    v_mul_f32 v36, 1.4426950408889634, v32
    v_exp_f32 v36, v36
    v_add_f32 v34, 1.0, v32
    v_cmp_lt_f32 vcc, 0, v32
    s_nop 1
    v_cndmask_b32 v34, v36, v34, vcc
    v_add_f32 v34, 0x358637bd, v34
    v_mul_f32 v36, 1.4426950408889634, v33
    v_exp_f32 v36, v36
    v_add_f32 v35, 1.0, v33
    v_cmp_lt_f32 vcc, 0, v33
    s_nop 1
    v_cndmask_b32 v35, v36, v35, vcc
    v_add_f32 v35, 0x358637bd, v35
    v_cvt_pk_bf16_f32 v17, v34, v35
    v_lshlrev_b32 v32, 16, v18
    v_and_b32 v33, 0xffff0000, v18
    v_mul_f32 v36, 1.4426950408889634, v32
    v_exp_f32 v36, v36
    v_add_f32 v34, 1.0, v32
    v_cmp_lt_f32 vcc, 0, v32
    s_nop 1
    v_cndmask_b32 v34, v36, v34, vcc
    v_add_f32 v34, 0x358637bd, v34
    v_mul_f32 v36, 1.4426950408889634, v33
    v_exp_f32 v36, v36
    v_add_f32 v35, 1.0, v33
    v_cmp_lt_f32 vcc, 0, v33
    s_nop 1
    v_cndmask_b32 v35, v36, v35, vcc
    v_add_f32 v35, 0x358637bd, v35
    v_cvt_pk_bf16_f32 v18, v34, v35
    v_lshlrev_b32 v32, 16, v19
    v_and_b32 v33, 0xffff0000, v19
    v_mul_f32 v36, 1.4426950408889634, v32
    v_exp_f32 v36, v36
    v_add_f32 v34, 1.0, v32
    v_cmp_lt_f32 vcc, 0, v32
    s_nop 1
    v_cndmask_b32 v34, v36, v34, vcc
    v_add_f32 v34, 0x358637bd, v34
    v_mul_f32 v36, 1.4426950408889634, v33
    v_exp_f32 v36, v36
    v_add_f32 v35, 1.0, v33
    v_cmp_lt_f32 vcc, 0, v33
    s_nop 1
    v_cndmask_b32 v35, v36, v35, vcc
    v_add_f32 v35, 0x358637bd, v35
    v_cvt_pk_bf16_f32 v19, v34, v35
    v_lshlrev_b32 v32, 16, v20
    v_and_b32 v33, 0xffff0000, v20
    v_mul_f32 v36, 1.4426950408889634, v32
    v_exp_f32 v36, v36
    v_add_f32 v34, 1.0, v32
    v_cmp_lt_f32 vcc, 0, v32
    s_nop 1
    v_cndmask_b32 v34, v36, v34, vcc
    v_add_f32 v34, 0x358637bd, v34
    v_mul_f32 v36, 1.4426950408889634, v33
    v_exp_f32 v36, v36
    v_add_f32 v35, 1.0, v33
    v_cmp_lt_f32 vcc, 0, v33
    s_nop 1
    v_cndmask_b32 v35, v36, v35, vcc
    v_add_f32 v35, 0x358637bd, v35
    v_cvt_pk_bf16_f32 v20, v34, v35
    v_lshlrev_b32 v32, 16, v21
    v_and_b32 v33, 0xffff0000, v21
    v_mul_f32 v36, 1.4426950408889634, v32
    v_exp_f32 v36, v36
    v_add_f32 v34, 1.0, v32
    v_cmp_lt_f32 vcc, 0, v32
    s_nop 1
    v_cndmask_b32 v34, v36, v34, vcc
    v_add_f32 v34, 0x358637bd, v34
    v_mul_f32 v36, 1.4426950408889634, v33
    v_exp_f32 v36, v36
    v_add_f32 v35, 1.0, v33
    v_cmp_lt_f32 vcc, 0, v33
    s_nop 1
    v_cndmask_b32 v35, v36, v35, vcc
    v_add_f32 v35, 0x358637bd, v35
    v_cvt_pk_bf16_f32 v21, v34, v35
    v_lshlrev_b32 v32, 16, v22
    v_and_b32 v33, 0xffff0000, v22
    v_mul_f32 v36, 1.4426950408889634, v32
    v_exp_f32 v36, v36
    v_add_f32 v34, 1.0, v32
    v_cmp_lt_f32 vcc, 0, v32
    s_nop 1
    v_cndmask_b32 v34, v36, v34, vcc
    v_add_f32 v34, 0x358637bd, v34
    v_mul_f32 v36, 1.4426950408889634, v33
    v_exp_f32 v36, v36
    v_add_f32 v35, 1.0, v33
    v_cmp_lt_f32 vcc, 0, v33
    s_nop 1
    v_cndmask_b32 v35, v36, v35, vcc
    v_add_f32 v35, 0x358637bd, v35
    v_cvt_pk_bf16_f32 v22, v34, v35
    v_lshlrev_b32 v32, 16, v23
    v_and_b32 v33, 0xffff0000, v23
    v_mul_f32 v36, 1.4426950408889634, v32
    v_exp_f32 v36, v36
    v_add_f32 v34, 1.0, v32
    v_cmp_lt_f32 vcc, 0, v32
    s_nop 1
    v_cndmask_b32 v34, v36, v34, vcc
    v_add_f32 v34, 0x358637bd, v34
    v_mul_f32 v36, 1.4426950408889634, v33
    v_exp_f32 v36, v36
    v_add_f32 v35, 1.0, v33
    v_cmp_lt_f32 vcc, 0, v33
    s_nop 1
    v_cndmask_b32 v35, v36, v35, vcc
    v_add_f32 v35, 0x358637bd, v35
    v_cvt_pk_bf16_f32 v23, v34, v35
    v_mov_b32 v37, 0x3f803f80
    v_cndmask_b32 v20, 0, v20, s[16:17]
    v_cndmask_b32 v28, 0, v28, s[16:17]
    v_cndmask_b32 v28, v28, v37, s[18:19]
    v_cndmask_b32 v21, 0, v21, s[16:17]
    v_cndmask_b32 v29, 0, v29, s[16:17]
    v_cndmask_b32 v29, v29, v37, s[18:19]
    v_cndmask_b32 v22, 0, v22, s[16:17]
    v_cndmask_b32 v30, 0, v30, s[16:17]
    v_cndmask_b32 v30, v30, v37, s[18:19]
    v_cndmask_b32 v23, 0, v23, s[16:17]
    v_cndmask_b32 v31, 0, v31, s[16:17]
    v_cndmask_b32 v31, v31, v37, s[18:19]
    s_nop 1
    v_mfma_f32_16x16x32_bf16 a[0:3], v[24:27], v[16:19], a[0:3]
    v_mfma_f32_16x16x32_bf16 a[4:7], v[24:27], v[20:23], a[4:7]
    v_mfma_f32_16x16x32_bf16 a[8:11], v[28:31], v[16:19], a[8:11]
    v_mfma_f32_16x16x32_bf16 a[12:15], v[28:31], v[20:23], a[12:15]
    buffer_load_dwordx4 v[16:19], v8, s[8:11], 0 offen offset:64
    buffer_load_dwordx4 v[24:27], v10, s[8:11], 0 offen offset:64
    buffer_load_dwordx4 v[20:23], v9, s[8:11], 0 offen offset:64
    buffer_load_dwordx4 v[28:31], v11, s[8:11], 0 offen offset:64
    s_waitcnt vmcnt(0)
    v_lshlrev_b32 v32, 16, v16
    v_and_b32 v33, 0xffff0000, v16
    v_mul_f32 v36, 1.4426950408889634, v32
    v_exp_f32 v36, v36
    v_add_f32 v34, 1.0, v32
    v_cmp_lt_f32 vcc, 0, v32
    s_nop 1
    v_cndmask_b32 v34, v36, v34, vcc
    v_add_f32 v34, 0x358637bd, v34
    v_mul_f32 v36, 1.4426950408889634, v33
    v_exp_f32 v36, v36
    v_add_f32 v35, 1.0, v33
    v_cmp_lt_f32 vcc, 0, v33
    s_nop 1
    v_cndmask_b32 v35, v36, v35, vcc
    v_add_f32 v35, 0x358637bd, v35
    v_cvt_pk_bf16_f32 v16, v34, v35
    v_lshlrev_b32 v32, 16, v17
    v_and_b32 v33, 0xffff0000, v17
    v_mul_f32 v36, 1.4426950408889634, v32
    v_exp_f32 v36, v36
    v_add_f32 v34, 1.0, v32
    v_cmp_lt_f32 vcc, 0, v32
    s_nop 1
    v_cndmask_b32 v34, v36, v34, vcc
    v_add_f32 v34, 0x358637bd, v34
    v_mul_f32 v36, 1.4426950408889634, v33
    v_exp_f32 v36, v36
    v_add_f32 v35, 1.0, v33
    v_cmp_lt_f32 vcc, 0, v33
    s_nop 1
    v_cndmask_b32 v35, v36, v35, vcc
    v_add_f32 v35, 0x358637bd, v35
    v_cvt_pk_bf16_f32 v17, v34, v35
    v_lshlrev_b32 v32, 16, v18
    v_and_b32 v33, 0xffff0000, v18
    v_mul_f32 v36, 1.4426950408889634, v32
    v_exp_f32 v36, v36
    v_add_f32 v34, 1.0, v32
    v_cmp_lt_f32 vcc, 0, v32
    s_nop 1
    v_cndmask_b32 v34, v36, v34, vcc
    v_add_f32 v34, 0x358637bd, v34
    v_mul_f32 v36, 1.4426950408889634, v33
    v_exp_f32 v36, v36
    v_add_f32 v35, 1.0, v33
    v_cmp_lt_f32 vcc, 0, v33
    s_nop 1
    v_cndmask_b32 v35, v36, v35, vcc
    v_add_f32 v35, 0x358637bd, v35
    v_cvt_pk_bf16_f32 v18, v34, v35
    v_lshlrev_b32 v32, 16, v19
    v_and_b32 v33, 0xffff0000, v19
    v_mul_f32 v36, 1.4426950408889634, v32
    v_exp_f32 v36, v36
    v_add_f32 v34, 1.0, v32
    v_cmp_lt_f32 vcc, 0, v32
    s_nop 1
    v_cndmask_b32 v34, v36, v34, vcc
    v_add_f32 v34, 0x358637bd, v34
    v_mul_f32 v36, 1.4426950408889634, v33
    v_exp_f32 v36, v36
    v_add_f32 v35, 1.0, v33
    v_cmp_lt_f32 vcc, 0, v33
    s_nop 1
    v_cndmask_b32 v35, v36, v35, vcc
    v_add_f32 v35, 0x358637bd, v35
    v_cvt_pk_bf16_f32 v19, v34, v35
    v_lshlrev_b32 v32, 16, v20
    v_and_b32 v33, 0xffff0000, v20
    v_mul_f32 v36, 1.4426950408889634, v32
    v_exp_f32 v36, v36
    v_add_f32 v34, 1.0, v32
    v_cmp_lt_f32 vcc, 0, v32
    s_nop 1
    v_cndmask_b32 v34, v36, v34, vcc
    v_add_f32 v34, 0x358637bd, v34
    v_mul_f32 v36, 1.4426950408889634, v33
    v_exp_f32 v36, v36
    v_add_f32 v35, 1.0, v33
    v_cmp_lt_f32 vcc, 0, v33
    s_nop 1
    v_cndmask_b32 v35, v36, v35, vcc
    v_add_f32 v35, 0x358637bd, v35
    v_cvt_pk_bf16_f32 v20, v34, v35
    v_lshlrev_b32 v32, 16, v21
    v_and_b32 v33, 0xffff0000, v21
    v_mul_f32 v36, 1.4426950408889634, v32
    v_exp_f32 v36, v36
    v_add_f32 v34, 1.0, v32
    v_cmp_lt_f32 vcc, 0, v32
    s_nop 1
    v_cndmask_b32 v34, v36, v34, vcc
    v_add_f32 v34, 0x358637bd, v34
    v_mul_f32 v36, 1.4426950408889634, v33
    v_exp_f32 v36, v36
    v_add_f32 v35, 1.0, v33
    v_cmp_lt_f32 vcc, 0, v33
    s_nop 1
    v_cndmask_b32 v35, v36, v35, vcc
    v_add_f32 v35, 0x358637bd, v35
    v_cvt_pk_bf16_f32 v21, v34, v35
    v_lshlrev_b32 v32, 16, v22
    v_and_b32 v33, 0xffff0000, v22
    v_mul_f32 v36, 1.4426950408889634, v32
    v_exp_f32 v36, v36
    v_add_f32 v34, 1.0, v32
    v_cmp_lt_f32 vcc, 0, v32
    s_nop 1
    v_cndmask_b32 v34, v36, v34, vcc
    v_add_f32 v34, 0x358637bd, v34
    v_mul_f32 v36, 1.4426950408889634, v33
    v_exp_f32 v36, v36
    v_add_f32 v35, 1.0, v33
    v_cmp_lt_f32 vcc, 0, v33
    s_nop 1
    v_cndmask_b32 v35, v36, v35, vcc
    v_add_f32 v35, 0x358637bd, v35
    v_cvt_pk_bf16_f32 v22, v34, v35
    v_lshlrev_b32 v32, 16, v23
    v_and_b32 v33, 0xffff0000, v23
    v_mul_f32 v36, 1.4426950408889634, v32
    v_exp_f32 v36, v36
    v_add_f32 v34, 1.0, v32
    v_cmp_lt_f32 vcc, 0, v32
    s_nop 1
    v_cndmask_b32 v34, v36, v34, vcc
    v_add_f32 v34, 0x358637bd, v34
    v_mul_f32 v36, 1.4426950408889634, v33
    v_exp_f32 v36, v36
    v_add_f32 v35, 1.0, v33
    v_cmp_lt_f32 vcc, 0, v33
    s_nop 1
    v_cndmask_b32 v35, v36, v35, vcc
    v_add_f32 v35, 0x358637bd, v35
    v_cvt_pk_bf16_f32 v23, v34, v35
    v_mov_b32 v37, 0x3f803f80
    v_cndmask_b32 v20, 0, v20, s[16:17]
    v_cndmask_b32 v28, 0, v28, s[16:17]
    v_cndmask_b32 v28, v28, v37, s[18:19]
    v_cndmask_b32 v21, 0, v21, s[16:17]
    v_cndmask_b32 v29, 0, v29, s[16:17]
    v_cndmask_b32 v29, v29, v37, s[18:19]
    v_cndmask_b32 v22, 0, v22, s[16:17]
    v_cndmask_b32 v30, 0, v30, s[16:17]
    v_cndmask_b32 v30, v30, v37, s[18:19]
    v_cndmask_b32 v23, 0, v23, s[16:17]
    v_cndmask_b32 v31, 0, v31, s[16:17]
    v_cndmask_b32 v31, v31, v37, s[18:19]
    s_nop 1
    v_mfma_f32_16x16x32_bf16 a[0:3], v[24:27], v[16:19], a[0:3]
    v_mfma_f32_16x16x32_bf16 a[4:7], v[24:27], v[20:23], a[4:7]
    v_mfma_f32_16x16x32_bf16 a[8:11], v[28:31], v[16:19], a[8:11]
    v_mfma_f32_16x16x32_bf16 a[12:15], v[28:31], v[20:23], a[12:15]
    buffer_load_dwordx4 v[16:19], v8, s[8:11], 0 offen offset:128
    buffer_load_dwordx4 v[24:27], v10, s[8:11], 0 offen offset:128
    buffer_load_dwordx4 v[20:23], v9, s[8:11], 0 offen offset:128
    buffer_load_dwordx4 v[28:31], v11, s[8:11], 0 offen offset:128
    s_waitcnt vmcnt(0)
    v_lshlrev_b32 v32, 16, v16
    v_and_b32 v33, 0xffff0000, v16
    v_mul_f32 v36, 1.4426950408889634, v32
    v_exp_f32 v36, v36
    v_add_f32 v34, 1.0, v32
    v_cmp_lt_f32 vcc, 0, v32
    s_nop 1
    v_cndmask_b32 v34, v36, v34, vcc
    v_add_f32 v34, 0x358637bd, v34
    v_mul_f32 v36, 1.4426950408889634, v33
    v_exp_f32 v36, v36
    v_add_f32 v35, 1.0, v33
    v_cmp_lt_f32 vcc, 0, v33
    s_nop 1
    v_cndmask_b32 v35, v36, v35, vcc
    v_add_f32 v35, 0x358637bd, v35
    v_cvt_pk_bf16_f32 v16, v34, v35
    v_lshlrev_b32 v32, 16, v17
    v_and_b32 v33, 0xffff0000, v17
    v_mul_f32 v36, 1.4426950408889634, v32
    v_exp_f32 v36, v36
    v_add_f32 v34, 1.0, v32
    v_cmp_lt_f32 vcc, 0, v32
    s_nop 1
    v_cndmask_b32 v34, v36, v34, vcc
    v_add_f32 v34, 0x358637bd, v34
    v_mul_f32 v36, 1.4426950408889634, v33
    v_exp_f32 v36, v36
    v_add_f32 v35, 1.0, v33
    v_cmp_lt_f32 vcc, 0, v33
    s_nop 1
    v_cndmask_b32 v35, v36, v35, vcc
    v_add_f32 v35, 0x358637bd, v35
    v_cvt_pk_bf16_f32 v17, v34, v35
    v_lshlrev_b32 v32, 16, v18
    v_and_b32 v33, 0xffff0000, v18
    v_mul_f32 v36, 1.4426950408889634, v32
    v_exp_f32 v36, v36
    v_add_f32 v34, 1.0, v32
    v_cmp_lt_f32 vcc, 0, v32
    s_nop 1
    v_cndmask_b32 v34, v36, v34, vcc
    v_add_f32 v34, 0x358637bd, v34
    v_mul_f32 v36, 1.4426950408889634, v33
    v_exp_f32 v36, v36
    v_add_f32 v35, 1.0, v33
    v_cmp_lt_f32 vcc, 0, v33
    s_nop 1
    v_cndmask_b32 v35, v36, v35, vcc
    v_add_f32 v35, 0x358637bd, v35
    v_cvt_pk_bf16_f32 v18, v34, v35
    v_lshlrev_b32 v32, 16, v19
    v_and_b32 v33, 0xffff0000, v19
    v_mul_f32 v36, 1.4426950408889634, v32
    v_exp_f32 v36, v36
    v_add_f32 v34, 1.0, v32
    v_cmp_lt_f32 vcc, 0, v32
    s_nop 1
    v_cndmask_b32 v34, v36, v34, vcc
    v_add_f32 v34, 0x358637bd, v34
    v_mul_f32 v36, 1.4426950408889634, v33
    v_exp_f32 v36, v36
    v_add_f32 v35, 1.0, v33
    v_cmp_lt_f32 vcc, 0, v33
    s_nop 1
    v_cndmask_b32 v35, v36, v35, vcc
    v_add_f32 v35, 0x358637bd, v35
    v_cvt_pk_bf16_f32 v19, v34, v35
    v_lshlrev_b32 v32, 16, v20
    v_and_b32 v33, 0xffff0000, v20
    v_mul_f32 v36, 1.4426950408889634, v32
    v_exp_f32 v36, v36
    v_add_f32 v34, 1.0, v32
    v_cmp_lt_f32 vcc, 0, v32
    s_nop 1
    v_cndmask_b32 v34, v36, v34, vcc
    v_add_f32 v34, 0x358637bd, v34
    v_mul_f32 v36, 1.4426950408889634, v33
    v_exp_f32 v36, v36
    v_add_f32 v35, 1.0, v33
    v_cmp_lt_f32 vcc, 0, v33
    s_nop 1
    v_cndmask_b32 v35, v36, v35, vcc
    v_add_f32 v35, 0x358637bd, v35
    v_cvt_pk_bf16_f32 v20, v34, v35
    v_lshlrev_b32 v32, 16, v21
    v_and_b32 v33, 0xffff0000, v21
    v_mul_f32 v36, 1.4426950408889634, v32
    v_exp_f32 v36, v36
    v_add_f32 v34, 1.0, v32
    v_cmp_lt_f32 vcc, 0, v32
    s_nop 1
    v_cndmask_b32 v34, v36, v34, vcc
    v_add_f32 v34, 0x358637bd, v34
    v_mul_f32 v36, 1.4426950408889634, v33
    v_exp_f32 v36, v36
    v_add_f32 v35, 1.0, v33
    v_cmp_lt_f32 vcc, 0, v33
    s_nop 1
    v_cndmask_b32 v35, v36, v35, vcc
    v_add_f32 v35, 0x358637bd, v35
    v_cvt_pk_bf16_f32 v21, v34, v35
    v_lshlrev_b32 v32, 16, v22
    v_and_b32 v33, 0xffff0000, v22
    v_mul_f32 v36, 1.4426950408889634, v32
    v_exp_f32 v36, v36
    v_add_f32 v34, 1.0, v32
    v_cmp_lt_f32 vcc, 0, v32
    s_nop 1
    v_cndmask_b32 v34, v36, v34, vcc
    v_add_f32 v34, 0x358637bd, v34
    v_mul_f32 v36, 1.4426950408889634, v33
    v_exp_f32 v36, v36
    v_add_f32 v35, 1.0, v33
    v_cmp_lt_f32 vcc, 0, v33
    s_nop 1
    v_cndmask_b32 v35, v36, v35, vcc
    v_add_f32 v35, 0x358637bd, v35
    v_cvt_pk_bf16_f32 v22, v34, v35
    v_lshlrev_b32 v32, 16, v23
    v_and_b32 v33, 0xffff0000, v23
    v_mul_f32 v36, 1.4426950408889634, v32
    v_exp_f32 v36, v36
    v_add_f32 v34, 1.0, v32
    v_cmp_lt_f32 vcc, 0, v32
    s_nop 1
    v_cndmask_b32 v34, v36, v34, vcc
    v_add_f32 v34, 0x358637bd, v34
    v_mul_f32 v36, 1.4426950408889634, v33
    v_exp_f32 v36, v36
    v_add_f32 v35, 1.0, v33
    v_cmp_lt_f32 vcc, 0, v33
    s_nop 1
    v_cndmask_b32 v35, v36, v35, vcc
    v_add_f32 v35, 0x358637bd, v35
    v_cvt_pk_bf16_f32 v23, v34, v35
    v_mov_b32 v37, 0x3f803f80
    v_cndmask_b32 v20, 0, v20, s[16:17]
    v_cndmask_b32 v28, 0, v28, s[16:17]
    v_cndmask_b32 v28, v28, v37, s[18:19]
    v_cndmask_b32 v21, 0, v21, s[16:17]
    v_cndmask_b32 v29, 0, v29, s[16:17]
    v_cndmask_b32 v29, v29, v37, s[18:19]
    v_cndmask_b32 v22, 0, v22, s[16:17]
    v_cndmask_b32 v30, 0, v30, s[16:17]
    v_cndmask_b32 v30, v30, v37, s[18:19]
    v_cndmask_b32 v23, 0, v23, s[16:17]
    v_cndmask_b32 v31, 0, v31, s[16:17]
    v_cndmask_b32 v31, v31, v37, s[18:19]
    s_nop 1
    v_mfma_f32_16x16x32_bf16 a[0:3], v[24:27], v[16:19], a[0:3]
    v_mfma_f32_16x16x32_bf16 a[4:7], v[24:27], v[20:23], a[4:7]
    v_mfma_f32_16x16x32_bf16 a[8:11], v[28:31], v[16:19], a[8:11]
    v_mfma_f32_16x16x32_bf16 a[12:15], v[28:31], v[20:23], a[12:15]
    buffer_load_dwordx4 v[16:19], v8, s[8:11], 0 offen offset:192
    buffer_load_dwordx4 v[24:27], v10, s[8:11], 0 offen offset:192
    buffer_load_dwordx4 v[20:23], v9, s[8:11], 0 offen offset:192
    buffer_load_dwordx4 v[28:31], v11, s[8:11], 0 offen offset:192
    s_waitcnt vmcnt(0)
    v_lshlrev_b32 v32, 16, v16
    v_and_b32 v33, 0xffff0000, v16
    v_mul_f32 v36, 1.4426950408889634, v32
    v_exp_f32 v36, v36
    v_add_f32 v34, 1.0, v32
    v_cmp_lt_f32 vcc, 0, v32
    s_nop 1
    v_cndmask_b32 v34, v36, v34, vcc
    v_add_f32 v34, 0x358637bd, v34
    v_mul_f32 v36, 1.4426950408889634, v33
    v_exp_f32 v36, v36
    v_add_f32 v35, 1.0, v33
    v_cmp_lt_f32 vcc, 0, v33
    s_nop 1
    v_cndmask_b32 v35, v36, v35, vcc
    v_add_f32 v35, 0x358637bd, v35
    v_cvt_pk_bf16_f32 v16, v34, v35
    v_lshlrev_b32 v32, 16, v17
    v_and_b32 v33, 0xffff0000, v17
    v_mul_f32 v36, 1.4426950408889634, v32
    v_exp_f32 v36, v36
    v_add_f32 v34, 1.0, v32
    v_cmp_lt_f32 vcc, 0, v32
    s_nop 1
    v_cndmask_b32 v34, v36, v34, vcc
    v_add_f32 v34, 0x358637bd, v34
    v_mul_f32 v36, 1.4426950408889634, v33
    v_exp_f32 v36, v36
    v_add_f32 v35, 1.0, v33
    v_cmp_lt_f32 vcc, 0, v33
    s_nop 1
    v_cndmask_b32 v35, v36, v35, vcc
    v_add_f32 v35, 0x358637bd, v35
    v_cvt_pk_bf16_f32 v17, v34, v35
    v_lshlrev_b32 v32, 16, v18
    v_and_b32 v33, 0xffff0000, v18
    v_mul_f32 v36, 1.4426950408889634, v32
    v_exp_f32 v36, v36
    v_add_f32 v34, 1.0, v32
    v_cmp_lt_f32 vcc, 0, v32
    s_nop 1
    v_cndmask_b32 v34, v36, v34, vcc
    v_add_f32 v34, 0x358637bd, v34
    v_mul_f32 v36, 1.4426950408889634, v33
    v_exp_f32 v36, v36
    v_add_f32 v35, 1.0, v33
    v_cmp_lt_f32 vcc, 0, v33
    s_nop 1
    v_cndmask_b32 v35, v36, v35, vcc
    v_add_f32 v35, 0x358637bd, v35
    v_cvt_pk_bf16_f32 v18, v34, v35
    v_lshlrev_b32 v32, 16, v19
    v_and_b32 v33, 0xffff0000, v19
    v_mul_f32 v36, 1.4426950408889634, v32
    v_exp_f32 v36, v36
    v_add_f32 v34, 1.0, v32
    v_cmp_lt_f32 vcc, 0, v32
    s_nop 1
    v_cndmask_b32 v34, v36, v34, vcc
    v_add_f32 v34, 0x358637bd, v34
    v_mul_f32 v36, 1.4426950408889634, v33
    v_exp_f32 v36, v36
    v_add_f32 v35, 1.0, v33
    v_cmp_lt_f32 vcc, 0, v33
    s_nop 1
    v_cndmask_b32 v35, v36, v35, vcc
    v_add_f32 v35, 0x358637bd, v35
    v_cvt_pk_bf16_f32 v19, v34, v35
    v_lshlrev_b32 v32, 16, v20
    v_and_b32 v33, 0xffff0000, v20
    v_mul_f32 v36, 1.4426950408889634, v32
    v_exp_f32 v36, v36
    v_add_f32 v34, 1.0, v32
    v_cmp_lt_f32 vcc, 0, v32
    s_nop 1
    v_cndmask_b32 v34, v36, v34, vcc
    v_add_f32 v34, 0x358637bd, v34
    v_mul_f32 v36, 1.4426950408889634, v33
    v_exp_f32 v36, v36
    v_add_f32 v35, 1.0, v33
    v_cmp_lt_f32 vcc, 0, v33
    s_nop 1
    v_cndmask_b32 v35, v36, v35, vcc
    v_add_f32 v35, 0x358637bd, v35
    v_cvt_pk_bf16_f32 v20, v34, v35
    v_lshlrev_b32 v32, 16, v21
    v_and_b32 v33, 0xffff0000, v21
    v_mul_f32 v36, 1.4426950408889634, v32
    v_exp_f32 v36, v36
    v_add_f32 v34, 1.0, v32
    v_cmp_lt_f32 vcc, 0, v32
    s_nop 1
    v_cndmask_b32 v34, v36, v34, vcc
    v_add_f32 v34, 0x358637bd, v34
    v_mul_f32 v36, 1.4426950408889634, v33
    v_exp_f32 v36, v36
    v_add_f32 v35, 1.0, v33
    v_cmp_lt_f32 vcc, 0, v33
    s_nop 1
    v_cndmask_b32 v35, v36, v35, vcc
    v_add_f32 v35, 0x358637bd, v35
    v_cvt_pk_bf16_f32 v21, v34, v35
    v_lshlrev_b32 v32, 16, v22
    v_and_b32 v33, 0xffff0000, v22
    v_mul_f32 v36, 1.4426950408889634, v32
    v_exp_f32 v36, v36
    v_add_f32 v34, 1.0, v32
    v_cmp_lt_f32 vcc, 0, v32
    s_nop 1
    v_cndmask_b32 v34, v36, v34, vcc
    v_add_f32 v34, 0x358637bd, v34
    v_mul_f32 v36, 1.4426950408889634, v33
    v_exp_f32 v36, v36
    v_add_f32 v35, 1.0, v33
    v_cmp_lt_f32 vcc, 0, v33
    s_nop 1
    v_cndmask_b32 v35, v36, v35, vcc
    v_add_f32 v35, 0x358637bd, v35
    v_cvt_pk_bf16_f32 v22, v34, v35
    v_lshlrev_b32 v32, 16, v23
    v_and_b32 v33, 0xffff0000, v23
    v_mul_f32 v36, 1.4426950408889634, v32
    v_exp_f32 v36, v36
    v_add_f32 v34, 1.0, v32
    v_cmp_lt_f32 vcc, 0, v32
    s_nop 1
    v_cndmask_b32 v34, v36, v34, vcc
    v_add_f32 v34, 0x358637bd, v34
    v_mul_f32 v36, 1.4426950408889634, v33
    v_exp_f32 v36, v36
    v_add_f32 v35, 1.0, v33
    v_cmp_lt_f32 vcc, 0, v33
    s_nop 1
    v_cndmask_b32 v35, v36, v35, vcc
    v_add_f32 v35, 0x358637bd, v35
    v_cvt_pk_bf16_f32 v23, v34, v35
    v_mov_b32 v37, 0x3f803f80
    v_cndmask_b32 v20, 0, v20, s[16:17]
    v_cndmask_b32 v28, 0, v28, s[16:17]
    v_cndmask_b32 v28, v28, v37, s[18:19]
    v_cndmask_b32 v21, 0, v21, s[16:17]
    v_cndmask_b32 v29, 0, v29, s[16:17]
    v_cndmask_b32 v29, v29, v37, s[18:19]
    v_cndmask_b32 v22, 0, v22, s[16:17]
    v_cndmask_b32 v30, 0, v30, s[16:17]
    v_cndmask_b32 v30, v30, v37, s[18:19]
    v_cndmask_b32 v23, 0, v23, s[16:17]
    v_cndmask_b32 v31, 0, v31, s[16:17]
    v_cndmask_b32 v31, v31, v37, s[18:19]
    s_nop 1
    v_mfma_f32_16x16x32_bf16 a[0:3], v[24:27], v[16:19], a[0:3]
    v_mfma_f32_16x16x32_bf16 a[4:7], v[24:27], v[20:23], a[4:7]
    v_mfma_f32_16x16x32_bf16 a[8:11], v[28:31], v[16:19], a[8:11]
    v_mfma_f32_16x16x32_bf16 a[12:15], v[28:31], v[20:23], a[12:15]
    s_nop 7
    s_nop 7
    v_lshlrev_b32 v5, 2, v4
    v_lshlrev_b32 v5, 5, v5
    v_add_u32 v5, v5, v3
    v_lshlrev_b32 v5, 2, v5
    s_lshl_b32 s14, s5, 12
    s_add_u32 s14, s14, 242221056
    v_add_u32 v5, s14, v5
    v_accvgpr_read_b32 v40, a0
    v_accvgpr_read_b32 v41, a1
    v_accvgpr_read_b32 v42, a2
    v_accvgpr_read_b32 v43, a3
    buffer_atomic_add_f32 v40, v5, s[8:11], 0 offen offset:0
    buffer_atomic_add_f32 v41, v5, s[8:11], 0 offen offset:128
    buffer_atomic_add_f32 v42, v5, s[8:11], 0 offen offset:256
    buffer_atomic_add_f32 v43, v5, s[8:11], 0 offen offset:384
    v_accvgpr_read_b32 v40, a4
    v_accvgpr_read_b32 v41, a5
    v_accvgpr_read_b32 v42, a6
    v_accvgpr_read_b32 v43, a7
    buffer_atomic_add_f32 v40, v5, s[8:11], 0 offen offset:64
    buffer_atomic_add_f32 v41, v5, s[8:11], 0 offen offset:192
    buffer_atomic_add_f32 v42, v5, s[8:11], 0 offen offset:320
    buffer_atomic_add_f32 v43, v5, s[8:11], 0 offen offset:448
    v_accvgpr_read_b32 v40, a8
    v_accvgpr_read_b32 v41, a9
    v_accvgpr_read_b32 v42, a10
    v_accvgpr_read_b32 v43, a11
    buffer_atomic_add_f32 v40, v5, s[8:11], 0 offen offset:2048
    buffer_atomic_add_f32 v41, v5, s[8:11], 0 offen offset:2176
    buffer_atomic_add_f32 v42, v5, s[8:11], 0 offen offset:2304
    buffer_atomic_add_f32 v43, v5, s[8:11], 0 offen offset:2432
    v_accvgpr_read_b32 v40, a12
    v_accvgpr_read_b32 v41, a13
    v_accvgpr_read_b32 v42, a14
    v_accvgpr_read_b32 v43, a15
    buffer_atomic_add_f32 v40, v5, s[8:11], 0 offen offset:2112
    buffer_atomic_add_f32 v41, v5, s[8:11], 0 offen offset:2240
    buffer_atomic_add_f32 v42, v5, s[8:11], 0 offen offset:2368
    buffer_atomic_add_f32 v43, v5, s[8:11], 0 offen offset:2496
kvz_a1_kernel_end:
    s_endpgm
.section .rodata,"a"
.p2align 6
.amdhsa_kernel kvz_a1_kernel
  .amdhsa_next_free_vgpr 80
  .amdhsa_next_free_sgpr 40
  .amdhsa_accum_offset 64
  .amdhsa_group_segment_fixed_size 0
  .amdhsa_kernarg_size 104
  .amdhsa_user_sgpr_count 2
  .amdhsa_user_sgpr_kernarg_segment_ptr 1
  .amdhsa_system_sgpr_workgroup_id_x 1
.end_amdhsa_kernel
.text
.globl attn_a1_kernel
.p2align 8
.type attn_a1_kernel,@function
attn_a1_kernel:
    s_cmp_ge_u32 s2, 256
    s_cbranch_scc1 attn_a1_kernel_end
    s_load_dwordx2 s[6:7], s[0:1], 96
    s_waitcnt lgkmcnt(0)
    s_mov_b32 s8, s6
    s_mov_b32 s9, s7
    s_mov_b32 s10, 268435456
    s_mov_b32 s11, 0x00020000
    v_mov_b32 v1, v0
    v_add_u32 v2, 0, v1
    s_mov_b32 s12, 3121
    v_mul_lo_u32 v3, v2, s12
    v_lshrrev_b32 v3, 19, v3
    v_mul_u32_u24 v4, 168, v3
    v_sub_u32 v4, v2, v4
    v_lshlrev_b32 v5, 12, v3
    v_lshlrev_b32 v6, 4, v4
    v_add_u32 v5, v5, v6
    v_add_u32 v5, 242221056, v5
    buffer_load_dwordx4 v[8:11], v5, s[8:11], 0 offen
    v_mul_u32_u24 v7, 2688, v3
    v_add_u32 v7, v7, v6
    s_waitcnt vmcnt(0)
    ds_write_b128 v7, v[8:11]
    v_add_u32 v2, 256, v1
    s_mov_b32 s12, 3121
    v_mul_lo_u32 v3, v2, s12
    v_lshrrev_b32 v3, 19, v3
    v_mul_u32_u24 v4, 168, v3
    v_sub_u32 v4, v2, v4
    v_lshlrev_b32 v5, 12, v3
    v_lshlrev_b32 v6, 4, v4
    v_add_u32 v5, v5, v6
    v_add_u32 v5, 242221056, v5
    buffer_load_dwordx4 v[8:11], v5, s[8:11], 0 offen
    v_mul_u32_u24 v7, 2688, v3
    v_add_u32 v7, v7, v6
    s_waitcnt vmcnt(0)
    ds_write_b128 v7, v[8:11]
    v_add_u32 v2, 512, v1
    s_mov_b32 s12, 3121
    v_mul_lo_u32 v3, v2, s12
    v_lshrrev_b32 v3, 19, v3
    v_mul_u32_u24 v4, 168, v3
    v_sub_u32 v4, v2, v4
    v_lshlrev_b32 v5, 12, v3
    v_lshlrev_b32 v6, 4, v4
    v_add_u32 v5, v5, v6
    v_add_u32 v5, 242221056, v5
    buffer_load_dwordx4 v[8:11], v5, s[8:11], 0 offen
    v_mul_u32_u24 v7, 2688, v3
    v_add_u32 v7, v7, v6
    s_waitcnt vmcnt(0)
    ds_write_b128 v7, v[8:11]
    v_add_u32 v2, 768, v1
    s_mov_b32 s12, 3121
    v_mul_lo_u32 v3, v2, s12
    v_lshrrev_b32 v3, 19, v3
    v_mul_u32_u24 v4, 168, v3
    v_sub_u32 v4, v2, v4
    v_lshlrev_b32 v5, 12, v3
    v_lshlrev_b32 v6, 4, v4
    v_add_u32 v5, v5, v6
    v_add_u32 v5, 242221056, v5
    buffer_load_dwordx4 v[8:11], v5, s[8:11], 0 offen
    v_mul_u32_u24 v7, 2688, v3
    v_add_u32 v7, v7, v6
    s_waitcnt vmcnt(0)
    ds_write_b128 v7, v[8:11]
    v_add_u32 v2, 1024, v1
    s_mov_b32 s12, 3121
    v_mul_lo_u32 v3, v2, s12
    v_lshrrev_b32 v3, 19, v3
    v_mul_u32_u24 v4, 168, v3
    v_sub_u32 v4, v2, v4
    v_lshlrev_b32 v5, 12, v3
    v_lshlrev_b32 v6, 4, v4
    v_add_u32 v5, v5, v6
    v_add_u32 v5, 242221056, v5
    buffer_load_dwordx4 v[8:11], v5, s[8:11], 0 offen
    v_mul_u32_u24 v7, 2688, v3
    v_add_u32 v7, v7, v6
    s_waitcnt vmcnt(0)
    ds_write_b128 v7, v[8:11]
    v_add_u32 v2, 1280, v1
    s_mov_b32 s12, 3121
    v_mul_lo_u32 v3, v2, s12
    v_lshrrev_b32 v3, 19, v3
    v_mul_u32_u24 v4, 168, v3
    v_sub_u32 v4, v2, v4
    v_lshlrev_b32 v5, 12, v3
    v_lshlrev_b32 v6, 4, v4
    v_add_u32 v5, v5, v6
    v_add_u32 v5, 242221056, v5
    buffer_load_dwordx4 v[8:11], v5, s[8:11], 0 offen
    v_mul_u32_u24 v7, 2688, v3
    v_add_u32 v7, v7, v6
    s_waitcnt vmcnt(0)
    ds_write_b128 v7, v[8:11]
    v_add_u32 v2, 1536, v1
    s_mov_b32 s12, 3121
    v_mul_lo_u32 v3, v2, s12
    v_lshrrev_b32 v3, 19, v3
    v_mul_u32_u24 v4, 168, v3
    v_sub_u32 v4, v2, v4
    v_lshlrev_b32 v5, 12, v3
    v_lshlrev_b32 v6, 4, v4
    v_add_u32 v5, v5, v6
    v_add_u32 v5, 242221056, v5
    buffer_load_dwordx4 v[8:11], v5, s[8:11], 0 offen
    v_mul_u32_u24 v7, 2688, v3
    v_add_u32 v7, v7, v6
    s_waitcnt vmcnt(0)
    ds_write_b128 v7, v[8:11]
    v_add_u32 v2, 1792, v1
    s_mov_b32 s12, 3121
    v_mul_lo_u32 v3, v2, s12
    v_lshrrev_b32 v3, 19, v3
    v_mul_u32_u24 v4, 168, v3
    v_sub_u32 v4, v2, v4
    v_lshlrev_b32 v5, 12, v3
    v_lshlrev_b32 v6, 4, v4
    v_add_u32 v5, v5, v6
    v_add_u32 v5, 242221056, v5
    buffer_load_dwordx4 v[8:11], v5, s[8:11], 0 offen
    v_mul_u32_u24 v7, 2688, v3
    v_add_u32 v7, v7, v6
    s_waitcnt vmcnt(0)
    ds_write_b128 v7, v[8:11]
    v_add_u32 v2, 2048, v1
    s_mov_b32 s12, 3121
    v_mul_lo_u32 v3, v2, s12
    v_lshrrev_b32 v3, 19, v3
    v_mul_u32_u24 v4, 168, v3
    v_sub_u32 v4, v2, v4
    v_lshlrev_b32 v5, 12, v3
    v_lshlrev_b32 v6, 4, v4
    v_add_u32 v5, v5, v6
    v_add_u32 v5, 242221056, v5
    buffer_load_dwordx4 v[8:11], v5, s[8:11], 0 offen
    v_mul_u32_u24 v7, 2688, v3
    v_add_u32 v7, v7, v6
    s_waitcnt vmcnt(0)
    ds_write_b128 v7, v[8:11]
    v_add_u32 v2, 2304, v1
    s_mov_b32 s12, 3121
    v_mul_lo_u32 v3, v2, s12
    v_lshrrev_b32 v3, 19, v3
    v_mul_u32_u24 v4, 168, v3
    v_sub_u32 v4, v2, v4
    v_lshlrev_b32 v5, 12, v3
    v_lshlrev_b32 v6, 4, v4
    v_add_u32 v5, v5, v6
    v_add_u32 v5, 242221056, v5
    buffer_load_dwordx4 v[8:11], v5, s[8:11], 0 offen
    v_mul_u32_u24 v7, 2688, v3
    v_add_u32 v7, v7, v6
    s_waitcnt vmcnt(0)
    ds_write_b128 v7, v[8:11]
    v_add_u32 v2, 2560, v1
    s_mov_b32 s12, 3121
    v_mul_lo_u32 v3, v2, s12
    v_lshrrev_b32 v3, 19, v3
    v_mul_u32_u24 v4, 168, v3
    v_sub_u32 v4, v2, v4
    v_lshlrev_b32 v5, 12, v3
    v_lshlrev_b32 v6, 4, v4
    v_add_u32 v5, v5, v6
    v_add_u32 v5, 242221056, v5
    buffer_load_dwordx4 v[8:11], v5, s[8:11], 0 offen
    v_mul_u32_u24 v7, 2688, v3
    v_add_u32 v7, v7, v6
    s_waitcnt vmcnt(0)
    ds_write_b128 v7, v[8:11]
    v_add_u32 v2, 2816, v1
    s_mov_b32 s12, 3121
    v_mul_lo_u32 v3, v2, s12
    v_lshrrev_b32 v3, 19, v3
    v_mul_u32_u24 v4, 168, v3
    v_sub_u32 v4, v2, v4
    v_lshlrev_b32 v5, 12, v3
    v_lshlrev_b32 v6, 4, v4
    v_add_u32 v5, v5, v6
    v_add_u32 v5, 242221056, v5
    buffer_load_dwordx4 v[8:11], v5, s[8:11], 0 offen
    v_mul_u32_u24 v7, 2688, v3
    v_add_u32 v7, v7, v6
    s_waitcnt vmcnt(0)
    ds_write_b128 v7, v[8:11]
    v_add_u32 v2, 3072, v1
    s_mov_b32 s12, 3121
    v_mul_lo_u32 v3, v2, s12
    v_lshrrev_b32 v3, 19, v3
    v_mul_u32_u24 v4, 168, v3
    v_sub_u32 v4, v2, v4
    v_lshlrev_b32 v5, 12, v3
    v_lshlrev_b32 v6, 4, v4
    v_add_u32 v5, v5, v6
    v_add_u32 v5, 242221056, v5
    buffer_load_dwordx4 v[8:11], v5, s[8:11], 0 offen
    v_mul_u32_u24 v7, 2688, v3
    v_add_u32 v7, v7, v6
    s_waitcnt vmcnt(0)
    ds_write_b128 v7, v[8:11]
    v_add_u32 v2, 3328, v1
    s_mov_b32 s12, 3121
    v_mul_lo_u32 v3, v2, s12
    v_lshrrev_b32 v3, 19, v3
    v_mul_u32_u24 v4, 168, v3
    v_sub_u32 v4, v2, v4
    v_lshlrev_b32 v5, 12, v3
    v_lshlrev_b32 v6, 4, v4
    v_add_u32 v5, v5, v6
    v_add_u32 v5, 242221056, v5
    buffer_load_dwordx4 v[8:11], v5, s[8:11], 0 offen
    v_mul_u32_u24 v7, 2688, v3
    v_add_u32 v7, v7, v6
    s_waitcnt vmcnt(0)
    ds_write_b128 v7, v[8:11]
    v_add_u32 v2, 3584, v1
    s_mov_b32 s12, 3121
    v_mul_lo_u32 v3, v2, s12
    v_lshrrev_b32 v3, 19, v3
    v_mul_u32_u24 v4, 168, v3
    v_sub_u32 v4, v2, v4
    v_lshlrev_b32 v5, 12, v3
    v_lshlrev_b32 v6, 4, v4
    v_add_u32 v5, v5, v6
    v_add_u32 v5, 242221056, v5
    buffer_load_dwordx4 v[8:11], v5, s[8:11], 0 offen
    v_mul_u32_u24 v7, 2688, v3
    v_add_u32 v7, v7, v6
    s_waitcnt vmcnt(0)
    ds_write_b128 v7, v[8:11]
    v_add_u32 v2, 3840, v1
    s_mov_b32 s12, 3121
    v_mul_lo_u32 v3, v2, s12
    v_lshrrev_b32 v3, 19, v3
    v_mul_u32_u24 v4, 168, v3
    v_sub_u32 v4, v2, v4
    v_lshlrev_b32 v5, 12, v3
    v_lshlrev_b32 v6, 4, v4
    v_add_u32 v5, v5, v6
    v_add_u32 v5, 242221056, v5
    buffer_load_dwordx4 v[8:11], v5, s[8:11], 0 offen
    v_mul_u32_u24 v7, 2688, v3
    v_add_u32 v7, v7, v6
    s_waitcnt vmcnt(0)
    ds_write_b128 v7, v[8:11]
    v_add_u32 v2, 4096, v1
    s_mov_b32 s12, 3121
    v_mul_lo_u32 v3, v2, s12
    v_lshrrev_b32 v3, 19, v3
    v_mul_u32_u24 v4, 168, v3
    v_sub_u32 v4, v2, v4
    v_lshlrev_b32 v5, 12, v3
    v_lshlrev_b32 v6, 4, v4
    v_add_u32 v5, v5, v6
    v_add_u32 v5, 242221056, v5
    buffer_load_dwordx4 v[8:11], v5, s[8:11], 0 offen
    v_mul_u32_u24 v7, 2688, v3
    v_add_u32 v7, v7, v6
    s_waitcnt vmcnt(0)
    ds_write_b128 v7, v[8:11]
    v_add_u32 v2, 4352, v1
    s_mov_b32 s12, 3121
    v_mul_lo_u32 v3, v2, s12
    v_lshrrev_b32 v3, 19, v3
    v_mul_u32_u24 v4, 168, v3
    v_sub_u32 v4, v2, v4
    v_lshlrev_b32 v5, 12, v3
    v_lshlrev_b32 v6, 4, v4
    v_add_u32 v5, v5, v6
    v_add_u32 v5, 242221056, v5
    buffer_load_dwordx4 v[8:11], v5, s[8:11], 0 offen
    v_mul_u32_u24 v7, 2688, v3
    v_add_u32 v7, v7, v6
    s_waitcnt vmcnt(0)
    ds_write_b128 v7, v[8:11]
    v_add_u32 v2, 4608, v1
    s_mov_b32 s12, 3121
    v_mul_lo_u32 v3, v2, s12
    v_lshrrev_b32 v3, 19, v3
    v_mul_u32_u24 v4, 168, v3
    v_sub_u32 v4, v2, v4
    v_lshlrev_b32 v5, 12, v3
    v_lshlrev_b32 v6, 4, v4
    v_add_u32 v5, v5, v6
    v_add_u32 v5, 242221056, v5
    buffer_load_dwordx4 v[8:11], v5, s[8:11], 0 offen
    v_mul_u32_u24 v7, 2688, v3
    v_add_u32 v7, v7, v6
    s_waitcnt vmcnt(0)
    ds_write_b128 v7, v[8:11]
    v_add_u32 v2, 4864, v1
    s_mov_b32 s12, 3121
    v_mul_lo_u32 v3, v2, s12
    v_lshrrev_b32 v3, 19, v3
    v_mul_u32_u24 v4, 168, v3
    v_sub_u32 v4, v2, v4
    v_lshlrev_b32 v5, 12, v3
    v_lshlrev_b32 v6, 4, v4
    v_add_u32 v5, v5, v6
    v_add_u32 v5, 242221056, v5
    buffer_load_dwordx4 v[8:11], v5, s[8:11], 0 offen
    v_mul_u32_u24 v7, 2688, v3
    v_add_u32 v7, v7, v6
    s_waitcnt vmcnt(0)
    ds_write_b128 v7, v[8:11]
    v_add_u32 v2, 5120, v1
    s_mov_b32 s12, 3121
    v_mul_lo_u32 v3, v2, s12
    v_lshrrev_b32 v3, 19, v3
    v_mul_u32_u24 v4, 168, v3
    v_sub_u32 v4, v2, v4
    v_lshlrev_b32 v5, 12, v3
    v_lshlrev_b32 v6, 4, v4
    v_add_u32 v5, v5, v6
    v_add_u32 v5, 242221056, v5
    buffer_load_dwordx4 v[8:11], v5, s[8:11], 0 offen
    v_mul_u32_u24 v7, 2688, v3
    v_add_u32 v7, v7, v6
    s_waitcnt vmcnt(0)
    ds_write_b128 v7, v[8:11]
    s_waitcnt lgkmcnt(0)
    s_barrier
    v_and_b32 v2, 31, v0
    v_lshrrev_b32 v3, 5, v0
    s_lshl_b32 s12, s2, 3
    v_add_u32 v3, s12, v3
    v_mul_u32_u24 v4, 1280, v3
    v_mul_u32_u24 v5, 40, v2
    v_add_u32 v4, v4, v5
    v_add_u32 v6, 229638144, v4
    buffer_load_dwordx2 v[8:9], v6, s[8:11], 0 offen offset:0
    buffer_load_dwordx2 v[10:11], v6, s[8:11], 0 offen offset:8
    buffer_load_dwordx2 v[12:13], v6, s[8:11], 0 offen offset:16
    buffer_load_dwordx2 v[14:15], v6, s[8:11], 0 offen offset:24
    buffer_load_dwordx2 v[16:17], v6, s[8:11], 0 offen offset:32
    s_waitcnt vmcnt(0)
    v_lshlrev_b32 v40, 16, v8
    v_and_b32 v41, 0xffff0000, v8
    v_mul_f32 v44, 1.4426950408889634, v40
    v_exp_f32 v44, v44
    v_add_f32 v42, 1.0, v40
    v_cmp_lt_f32 vcc, 0, v40
    s_nop 1
    v_cndmask_b32 v42, v44, v42, vcc
    v_add_f32 v42, 0x358637bd, v42
    v_mul_f32 v44, 1.4426950408889634, v41
    v_exp_f32 v44, v44
    v_add_f32 v43, 1.0, v41
    v_cmp_lt_f32 vcc, 0, v41
    s_nop 1
    v_cndmask_b32 v43, v44, v43, vcc
    v_add_f32 v43, 0x358637bd, v43
    v_cvt_pk_bf16_f32 v45, v42, v43
    v_lshlrev_b32 v20, 16, v45
    v_and_b32 v21, 0xffff0000, v45
    v_lshlrev_b32 v40, 16, v9
    v_and_b32 v41, 0xffff0000, v9
    v_mul_f32 v44, 1.4426950408889634, v40
    v_exp_f32 v44, v44
    v_add_f32 v42, 1.0, v40
    v_cmp_lt_f32 vcc, 0, v40
    s_nop 1
    v_cndmask_b32 v42, v44, v42, vcc
    v_add_f32 v42, 0x358637bd, v42
    v_mul_f32 v44, 1.4426950408889634, v41
    v_exp_f32 v44, v44
    v_add_f32 v43, 1.0, v41
    v_cmp_lt_f32 vcc, 0, v41
    s_nop 1
    v_cndmask_b32 v43, v44, v43, vcc
    v_add_f32 v43, 0x358637bd, v43
    v_cvt_pk_bf16_f32 v45, v42, v43
    v_lshlrev_b32 v22, 16, v45
    v_and_b32 v23, 0xffff0000, v45
    v_lshlrev_b32 v40, 16, v10
    v_and_b32 v41, 0xffff0000, v10
    v_mul_f32 v44, 1.4426950408889634, v40
    v_exp_f32 v44, v44
    v_add_f32 v42, 1.0, v40
    v_cmp_lt_f32 vcc, 0, v40
    s_nop 1
    v_cndmask_b32 v42, v44, v42, vcc
    v_add_f32 v42, 0x358637bd, v42
    v_mul_f32 v44, 1.4426950408889634, v41
    v_exp_f32 v44, v44
    v_add_f32 v43, 1.0, v41
    v_cmp_lt_f32 vcc, 0, v41
    s_nop 1
    v_cndmask_b32 v43, v44, v43, vcc
    v_add_f32 v43, 0x358637bd, v43
    v_cvt_pk_bf16_f32 v45, v42, v43
    v_lshlrev_b32 v24, 16, v45
    v_and_b32 v25, 0xffff0000, v45
    v_lshlrev_b32 v40, 16, v11
    v_and_b32 v41, 0xffff0000, v11
    v_mul_f32 v44, 1.4426950408889634, v40
    v_exp_f32 v44, v44
    v_add_f32 v42, 1.0, v40
    v_cmp_lt_f32 vcc, 0, v40
    s_nop 1
    v_cndmask_b32 v42, v44, v42, vcc
    v_add_f32 v42, 0x358637bd, v42
    v_mul_f32 v44, 1.4426950408889634, v41
    v_exp_f32 v44, v44
    v_add_f32 v43, 1.0, v41
    v_cmp_lt_f32 vcc, 0, v41
    s_nop 1
    v_cndmask_b32 v43, v44, v43, vcc
    v_add_f32 v43, 0x358637bd, v43
    v_cvt_pk_bf16_f32 v45, v42, v43
    v_lshlrev_b32 v26, 16, v45
    v_and_b32 v27, 0xffff0000, v45
    v_lshlrev_b32 v40, 16, v12
    v_and_b32 v41, 0xffff0000, v12
    v_mul_f32 v44, 1.4426950408889634, v40
    v_exp_f32 v44, v44
    v_add_f32 v42, 1.0, v40
    v_cmp_lt_f32 vcc, 0, v40
    s_nop 1
    v_cndmask_b32 v42, v44, v42, vcc
    v_add_f32 v42, 0x358637bd, v42
    v_mul_f32 v44, 1.4426950408889634, v41
    v_exp_f32 v44, v44
    v_add_f32 v43, 1.0, v41
    v_cmp_lt_f32 vcc, 0, v41
    s_nop 1
    v_cndmask_b32 v43, v44, v43, vcc
    v_add_f32 v43, 0x358637bd, v43
    v_cvt_pk_bf16_f32 v45, v42, v43
    v_lshlrev_b32 v28, 16, v45
    v_and_b32 v29, 0xffff0000, v45
    v_lshlrev_b32 v40, 16, v13
    v_and_b32 v41, 0xffff0000, v13
    v_mul_f32 v44, 1.4426950408889634, v40
    v_exp_f32 v44, v44
    v_add_f32 v42, 1.0, v40
    v_cmp_lt_f32 vcc, 0, v40
    s_nop 1
    v_cndmask_b32 v42, v44, v42, vcc
    v_add_f32 v42, 0x358637bd, v42
    v_mul_f32 v44, 1.4426950408889634, v41
    v_exp_f32 v44, v44
    v_add_f32 v43, 1.0, v41
    v_cmp_lt_f32 vcc, 0, v41
    s_nop 1
    v_cndmask_b32 v43, v44, v43, vcc
    v_add_f32 v43, 0x358637bd, v43
    v_cvt_pk_bf16_f32 v45, v42, v43
    v_lshlrev_b32 v30, 16, v45
    v_and_b32 v31, 0xffff0000, v45
    v_lshlrev_b32 v40, 16, v14
    v_and_b32 v41, 0xffff0000, v14
    v_mul_f32 v44, 1.4426950408889634, v40
    v_exp_f32 v44, v44
    v_add_f32 v42, 1.0, v40
    v_cmp_lt_f32 vcc, 0, v40
    s_nop 1
    v_cndmask_b32 v42, v44, v42, vcc
    v_add_f32 v42, 0x358637bd, v42
    v_mul_f32 v44, 1.4426950408889634, v41
    v_exp_f32 v44, v44
    v_add_f32 v43, 1.0, v41
    v_cmp_lt_f32 vcc, 0, v41
    s_nop 1
    v_cndmask_b32 v43, v44, v43, vcc
    v_add_f32 v43, 0x358637bd, v43
    v_cvt_pk_bf16_f32 v45, v42, v43
    v_lshlrev_b32 v32, 16, v45
    v_and_b32 v33, 0xffff0000, v45
    v_lshlrev_b32 v40, 16, v15
    v_and_b32 v41, 0xffff0000, v15
    v_mul_f32 v44, 1.4426950408889634, v40
    v_exp_f32 v44, v44
    v_add_f32 v42, 1.0, v40
    v_cmp_lt_f32 vcc, 0, v40
    s_nop 1
    v_cndmask_b32 v42, v44, v42, vcc
    v_add_f32 v42, 0x358637bd, v42
    v_mul_f32 v44, 1.4426950408889634, v41
    v_exp_f32 v44, v44
    v_add_f32 v43, 1.0, v41
    v_cmp_lt_f32 vcc, 0, v41
    s_nop 1
    v_cndmask_b32 v43, v44, v43, vcc
    v_add_f32 v43, 0x358637bd, v43
    v_cvt_pk_bf16_f32 v45, v42, v43
    v_lshlrev_b32 v34, 16, v45
    v_and_b32 v35, 0xffff0000, v45
    v_lshlrev_b32 v40, 16, v16
    v_and_b32 v41, 0xffff0000, v16
    v_mul_f32 v44, 1.4426950408889634, v40
    v_exp_f32 v44, v44
    v_add_f32 v42, 1.0, v40
    v_cmp_lt_f32 vcc, 0, v40
    s_nop 1
    v_cndmask_b32 v42, v44, v42, vcc
    v_add_f32 v42, 0x358637bd, v42
    v_mul_f32 v44, 1.4426950408889634, v41
    v_exp_f32 v44, v44
    v_add_f32 v43, 1.0, v41
    v_cmp_lt_f32 vcc, 0, v41
    s_nop 1
    v_cndmask_b32 v43, v44, v43, vcc
    v_add_f32 v43, 0x358637bd, v43
    v_cvt_pk_bf16_f32 v45, v42, v43
    v_lshlrev_b32 v36, 16, v45
    v_and_b32 v37, 0xffff0000, v45
    v_lshlrev_b32 v40, 16, v17
    v_and_b32 v41, 0xffff0000, v17
    v_mul_f32 v44, 1.4426950408889634, v40
    v_exp_f32 v44, v44
    v_add_f32 v42, 1.0, v40
    v_cmp_lt_f32 vcc, 0, v40
    s_nop 1
    v_cndmask_b32 v42, v44, v42, vcc
    v_add_f32 v42, 0x358637bd, v42
    v_mul_f32 v44, 1.4426950408889634, v41
    v_exp_f32 v44, v44
    v_add_f32 v43, 1.0, v41
    v_cmp_lt_f32 vcc, 0, v41
    s_nop 1
    v_cndmask_b32 v43, v44, v43, vcc
    v_add_f32 v43, 0x358637bd, v43
    v_cvt_pk_bf16_f32 v45, v42, v43
    v_lshlrev_b32 v38, 16, v45
    v_and_b32 v39, 0xffff0000, v45
    v_mul_u32_u24 v7, 2688, v2
    ds_read_b128 v[72:75], v7 offset:0
    ds_read_b128 v[76:79], v7 offset:16
    ds_read_b128 v[80:83], v7 offset:32
    ds_read_b128 v[84:87], v7 offset:48
    ds_read_b128 v[88:91], v7 offset:64
    s_waitcnt lgkmcnt(0)
    v_mul_f32 v50, v20, v72
    v_fmac_f32 v50, v21, v73
    v_fmac_f32 v50, v22, v74
    v_fmac_f32 v50, v23, v75
    v_fmac_f32 v50, v24, v76
    v_fmac_f32 v50, v25, v77
    v_fmac_f32 v50, v26, v78
    v_fmac_f32 v50, v27, v79
    v_fmac_f32 v50, v28, v80
    v_fmac_f32 v50, v29, v81
    v_fmac_f32 v50, v30, v82
    v_fmac_f32 v50, v31, v83
    v_fmac_f32 v50, v32, v84
    v_fmac_f32 v50, v33, v85
    v_fmac_f32 v50, v34, v86
    v_fmac_f32 v50, v35, v87
    v_fmac_f32 v50, v36, v88
    v_fmac_f32 v50, v37, v89
    v_fmac_f32 v50, v38, v90
    v_fmac_f32 v50, v39, v91
    ds_read_b128 v[72:75], v7 offset:128
    ds_read_b128 v[76:79], v7 offset:144
    ds_read_b128 v[80:83], v7 offset:160
    ds_read_b128 v[84:87], v7 offset:176
    ds_read_b128 v[88:91], v7 offset:192
    s_waitcnt lgkmcnt(0)
    v_mul_f32 v51, v20, v72
    v_fmac_f32 v51, v21, v73
    v_fmac_f32 v51, v22, v74
    v_fmac_f32 v51, v23, v75
    v_fmac_f32 v51, v24, v76
    v_fmac_f32 v51, v25, v77
    v_fmac_f32 v51, v26, v78
    v_fmac_f32 v51, v27, v79
    v_fmac_f32 v51, v28, v80
    v_fmac_f32 v51, v29, v81
    v_fmac_f32 v51, v30, v82
    v_fmac_f32 v51, v31, v83
    v_fmac_f32 v51, v32, v84
    v_fmac_f32 v51, v33, v85
    v_fmac_f32 v51, v34, v86
    v_fmac_f32 v51, v35, v87
    v_fmac_f32 v51, v36, v88
    v_fmac_f32 v51, v37, v89
    v_fmac_f32 v51, v38, v90
    v_fmac_f32 v51, v39, v91
    ds_read_b128 v[72:75], v7 offset:256
    ds_read_b128 v[76:79], v7 offset:272
    ds_read_b128 v[80:83], v7 offset:288
    ds_read_b128 v[84:87], v7 offset:304
    ds_read_b128 v[88:91], v7 offset:320
    s_waitcnt lgkmcnt(0)
    v_mul_f32 v52, v20, v72
    v_fmac_f32 v52, v21, v73
    v_fmac_f32 v52, v22, v74
    v_fmac_f32 v52, v23, v75
    v_fmac_f32 v52, v24, v76
    v_fmac_f32 v52, v25, v77
    v_fmac_f32 v52, v26, v78
    v_fmac_f32 v52, v27, v79
    v_fmac_f32 v52, v28, v80
    v_fmac_f32 v52, v29, v81
    v_fmac_f32 v52, v30, v82
    v_fmac_f32 v52, v31, v83
    v_fmac_f32 v52, v32, v84
    v_fmac_f32 v52, v33, v85
    v_fmac_f32 v52, v34, v86
    v_fmac_f32 v52, v35, v87
    v_fmac_f32 v52, v36, v88
    v_fmac_f32 v52, v37, v89
    v_fmac_f32 v52, v38, v90
    v_fmac_f32 v52, v39, v91
    ds_read_b128 v[72:75], v7 offset:384
    ds_read_b128 v[76:79], v7 offset:400
    ds_read_b128 v[80:83], v7 offset:416
    ds_read_b128 v[84:87], v7 offset:432
    ds_read_b128 v[88:91], v7 offset:448
    s_waitcnt lgkmcnt(0)
    v_mul_f32 v53, v20, v72
    v_fmac_f32 v53, v21, v73
    v_fmac_f32 v53, v22, v74
    v_fmac_f32 v53, v23, v75
    v_fmac_f32 v53, v24, v76
    v_fmac_f32 v53, v25, v77
    v_fmac_f32 v53, v26, v78
    v_fmac_f32 v53, v27, v79
    v_fmac_f32 v53, v28, v80
    v_fmac_f32 v53, v29, v81
    v_fmac_f32 v53, v30, v82
    v_fmac_f32 v53, v31, v83
    v_fmac_f32 v53, v32, v84
    v_fmac_f32 v53, v33, v85
    v_fmac_f32 v53, v34, v86
    v_fmac_f32 v53, v35, v87
    v_fmac_f32 v53, v36, v88
    v_fmac_f32 v53, v37, v89
    v_fmac_f32 v53, v38, v90
    v_fmac_f32 v53, v39, v91
    ds_read_b128 v[72:75], v7 offset:512
    ds_read_b128 v[76:79], v7 offset:528
    ds_read_b128 v[80:83], v7 offset:544
    ds_read_b128 v[84:87], v7 offset:560
    ds_read_b128 v[88:91], v7 offset:576
    s_waitcnt lgkmcnt(0)
    v_mul_f32 v54, v20, v72
    v_fmac_f32 v54, v21, v73
    v_fmac_f32 v54, v22, v74
    v_fmac_f32 v54, v23, v75
    v_fmac_f32 v54, v24, v76
    v_fmac_f32 v54, v25, v77
    v_fmac_f32 v54, v26, v78
    v_fmac_f32 v54, v27, v79
    v_fmac_f32 v54, v28, v80
    v_fmac_f32 v54, v29, v81
    v_fmac_f32 v54, v30, v82
    v_fmac_f32 v54, v31, v83
    v_fmac_f32 v54, v32, v84
    v_fmac_f32 v54, v33, v85
    v_fmac_f32 v54, v34, v86
    v_fmac_f32 v54, v35, v87
    v_fmac_f32 v54, v36, v88
    v_fmac_f32 v54, v37, v89
    v_fmac_f32 v54, v38, v90
    v_fmac_f32 v54, v39, v91
    ds_read_b128 v[72:75], v7 offset:640
    ds_read_b128 v[76:79], v7 offset:656
    ds_read_b128 v[80:83], v7 offset:672
    ds_read_b128 v[84:87], v7 offset:688
    ds_read_b128 v[88:91], v7 offset:704
    s_waitcnt lgkmcnt(0)
    v_mul_f32 v55, v20, v72
    v_fmac_f32 v55, v21, v73
    v_fmac_f32 v55, v22, v74
    v_fmac_f32 v55, v23, v75
    v_fmac_f32 v55, v24, v76
    v_fmac_f32 v55, v25, v77
    v_fmac_f32 v55, v26, v78
    v_fmac_f32 v55, v27, v79
    v_fmac_f32 v55, v28, v80
    v_fmac_f32 v55, v29, v81
    v_fmac_f32 v55, v30, v82
    v_fmac_f32 v55, v31, v83
    v_fmac_f32 v55, v32, v84
    v_fmac_f32 v55, v33, v85
    v_fmac_f32 v55, v34, v86
    v_fmac_f32 v55, v35, v87
    v_fmac_f32 v55, v36, v88
    v_fmac_f32 v55, v37, v89
    v_fmac_f32 v55, v38, v90
    v_fmac_f32 v55, v39, v91
    ds_read_b128 v[72:75], v7 offset:768
    ds_read_b128 v[76:79], v7 offset:784
    ds_read_b128 v[80:83], v7 offset:800
    ds_read_b128 v[84:87], v7 offset:816
    ds_read_b128 v[88:91], v7 offset:832
    s_waitcnt lgkmcnt(0)
    v_mul_f32 v56, v20, v72
    v_fmac_f32 v56, v21, v73
    v_fmac_f32 v56, v22, v74
    v_fmac_f32 v56, v23, v75
    v_fmac_f32 v56, v24, v76
    v_fmac_f32 v56, v25, v77
    v_fmac_f32 v56, v26, v78
    v_fmac_f32 v56, v27, v79
    v_fmac_f32 v56, v28, v80
    v_fmac_f32 v56, v29, v81
    v_fmac_f32 v56, v30, v82
    v_fmac_f32 v56, v31, v83
    v_fmac_f32 v56, v32, v84
    v_fmac_f32 v56, v33, v85
    v_fmac_f32 v56, v34, v86
    v_fmac_f32 v56, v35, v87
    v_fmac_f32 v56, v36, v88
    v_fmac_f32 v56, v37, v89
    v_fmac_f32 v56, v38, v90
    v_fmac_f32 v56, v39, v91
    ds_read_b128 v[72:75], v7 offset:896
    ds_read_b128 v[76:79], v7 offset:912
    ds_read_b128 v[80:83], v7 offset:928
    ds_read_b128 v[84:87], v7 offset:944
    ds_read_b128 v[88:91], v7 offset:960
    s_waitcnt lgkmcnt(0)
    v_mul_f32 v57, v20, v72
    v_fmac_f32 v57, v21, v73
    v_fmac_f32 v57, v22, v74
    v_fmac_f32 v57, v23, v75
    v_fmac_f32 v57, v24, v76
    v_fmac_f32 v57, v25, v77
    v_fmac_f32 v57, v26, v78
    v_fmac_f32 v57, v27, v79
    v_fmac_f32 v57, v28, v80
    v_fmac_f32 v57, v29, v81
    v_fmac_f32 v57, v30, v82
    v_fmac_f32 v57, v31, v83
    v_fmac_f32 v57, v32, v84
    v_fmac_f32 v57, v33, v85
    v_fmac_f32 v57, v34, v86
    v_fmac_f32 v57, v35, v87
    v_fmac_f32 v57, v36, v88
    v_fmac_f32 v57, v37, v89
    v_fmac_f32 v57, v38, v90
    v_fmac_f32 v57, v39, v91
    ds_read_b128 v[72:75], v7 offset:1024
    ds_read_b128 v[76:79], v7 offset:1040
    ds_read_b128 v[80:83], v7 offset:1056
    ds_read_b128 v[84:87], v7 offset:1072
    ds_read_b128 v[88:91], v7 offset:1088
    s_waitcnt lgkmcnt(0)
    v_mul_f32 v58, v20, v72
    v_fmac_f32 v58, v21, v73
    v_fmac_f32 v58, v22, v74
    v_fmac_f32 v58, v23, v75
    v_fmac_f32 v58, v24, v76
    v_fmac_f32 v58, v25, v77
    v_fmac_f32 v58, v26, v78
    v_fmac_f32 v58, v27, v79
    v_fmac_f32 v58, v28, v80
    v_fmac_f32 v58, v29, v81
    v_fmac_f32 v58, v30, v82
    v_fmac_f32 v58, v31, v83
    v_fmac_f32 v58, v32, v84
    v_fmac_f32 v58, v33, v85
    v_fmac_f32 v58, v34, v86
    v_fmac_f32 v58, v35, v87
    v_fmac_f32 v58, v36, v88
    v_fmac_f32 v58, v37, v89
    v_fmac_f32 v58, v38, v90
    v_fmac_f32 v58, v39, v91
    ds_read_b128 v[72:75], v7 offset:1152
    ds_read_b128 v[76:79], v7 offset:1168
    ds_read_b128 v[80:83], v7 offset:1184
    ds_read_b128 v[84:87], v7 offset:1200
    ds_read_b128 v[88:91], v7 offset:1216
    s_waitcnt lgkmcnt(0)
    v_mul_f32 v59, v20, v72
    v_fmac_f32 v59, v21, v73
    v_fmac_f32 v59, v22, v74
    v_fmac_f32 v59, v23, v75
    v_fmac_f32 v59, v24, v76
    v_fmac_f32 v59, v25, v77
    v_fmac_f32 v59, v26, v78
    v_fmac_f32 v59, v27, v79
    v_fmac_f32 v59, v28, v80
    v_fmac_f32 v59, v29, v81
    v_fmac_f32 v59, v30, v82
    v_fmac_f32 v59, v31, v83
    v_fmac_f32 v59, v32, v84
    v_fmac_f32 v59, v33, v85
    v_fmac_f32 v59, v34, v86
    v_fmac_f32 v59, v35, v87
    v_fmac_f32 v59, v36, v88
    v_fmac_f32 v59, v37, v89
    v_fmac_f32 v59, v38, v90
    v_fmac_f32 v59, v39, v91
    ds_read_b128 v[72:75], v7 offset:1280
    ds_read_b128 v[76:79], v7 offset:1296
    ds_read_b128 v[80:83], v7 offset:1312
    ds_read_b128 v[84:87], v7 offset:1328
    ds_read_b128 v[88:91], v7 offset:1344
    s_waitcnt lgkmcnt(0)
    v_mul_f32 v60, v20, v72
    v_fmac_f32 v60, v21, v73
    v_fmac_f32 v60, v22, v74
    v_fmac_f32 v60, v23, v75
    v_fmac_f32 v60, v24, v76
    v_fmac_f32 v60, v25, v77
    v_fmac_f32 v60, v26, v78
    v_fmac_f32 v60, v27, v79
    v_fmac_f32 v60, v28, v80
    v_fmac_f32 v60, v29, v81
    v_fmac_f32 v60, v30, v82
    v_fmac_f32 v60, v31, v83
    v_fmac_f32 v60, v32, v84
    v_fmac_f32 v60, v33, v85
    v_fmac_f32 v60, v34, v86
    v_fmac_f32 v60, v35, v87
    v_fmac_f32 v60, v36, v88
    v_fmac_f32 v60, v37, v89
    v_fmac_f32 v60, v38, v90
    v_fmac_f32 v60, v39, v91
    ds_read_b128 v[72:75], v7 offset:1408
    ds_read_b128 v[76:79], v7 offset:1424
    ds_read_b128 v[80:83], v7 offset:1440
    ds_read_b128 v[84:87], v7 offset:1456
    ds_read_b128 v[88:91], v7 offset:1472
    s_waitcnt lgkmcnt(0)
    v_mul_f32 v61, v20, v72
    v_fmac_f32 v61, v21, v73
    v_fmac_f32 v61, v22, v74
    v_fmac_f32 v61, v23, v75
    v_fmac_f32 v61, v24, v76
    v_fmac_f32 v61, v25, v77
    v_fmac_f32 v61, v26, v78
    v_fmac_f32 v61, v27, v79
    v_fmac_f32 v61, v28, v80
    v_fmac_f32 v61, v29, v81
    v_fmac_f32 v61, v30, v82
    v_fmac_f32 v61, v31, v83
    v_fmac_f32 v61, v32, v84
    v_fmac_f32 v61, v33, v85
    v_fmac_f32 v61, v34, v86
    v_fmac_f32 v61, v35, v87
    v_fmac_f32 v61, v36, v88
    v_fmac_f32 v61, v37, v89
    v_fmac_f32 v61, v38, v90
    v_fmac_f32 v61, v39, v91
    ds_read_b128 v[72:75], v7 offset:1536
    ds_read_b128 v[76:79], v7 offset:1552
    ds_read_b128 v[80:83], v7 offset:1568
    ds_read_b128 v[84:87], v7 offset:1584
    ds_read_b128 v[88:91], v7 offset:1600
    s_waitcnt lgkmcnt(0)
    v_mul_f32 v62, v20, v72
    v_fmac_f32 v62, v21, v73
    v_fmac_f32 v62, v22, v74
    v_fmac_f32 v62, v23, v75
    v_fmac_f32 v62, v24, v76
    v_fmac_f32 v62, v25, v77
    v_fmac_f32 v62, v26, v78
    v_fmac_f32 v62, v27, v79
    v_fmac_f32 v62, v28, v80
    v_fmac_f32 v62, v29, v81
    v_fmac_f32 v62, v30, v82
    v_fmac_f32 v62, v31, v83
    v_fmac_f32 v62, v32, v84
    v_fmac_f32 v62, v33, v85
    v_fmac_f32 v62, v34, v86
    v_fmac_f32 v62, v35, v87
    v_fmac_f32 v62, v36, v88
    v_fmac_f32 v62, v37, v89
    v_fmac_f32 v62, v38, v90
    v_fmac_f32 v62, v39, v91
    ds_read_b128 v[72:75], v7 offset:1664
    ds_read_b128 v[76:79], v7 offset:1680
    ds_read_b128 v[80:83], v7 offset:1696
    ds_read_b128 v[84:87], v7 offset:1712
    ds_read_b128 v[88:91], v7 offset:1728
    s_waitcnt lgkmcnt(0)
    v_mul_f32 v63, v20, v72
    v_fmac_f32 v63, v21, v73
    v_fmac_f32 v63, v22, v74
    v_fmac_f32 v63, v23, v75
    v_fmac_f32 v63, v24, v76
    v_fmac_f32 v63, v25, v77
    v_fmac_f32 v63, v26, v78
    v_fmac_f32 v63, v27, v79
    v_fmac_f32 v63, v28, v80
    v_fmac_f32 v63, v29, v81
    v_fmac_f32 v63, v30, v82
    v_fmac_f32 v63, v31, v83
    v_fmac_f32 v63, v32, v84
    v_fmac_f32 v63, v33, v85
    v_fmac_f32 v63, v34, v86
    v_fmac_f32 v63, v35, v87
    v_fmac_f32 v63, v36, v88
    v_fmac_f32 v63, v37, v89
    v_fmac_f32 v63, v38, v90
    v_fmac_f32 v63, v39, v91
    ds_read_b128 v[72:75], v7 offset:1792
    ds_read_b128 v[76:79], v7 offset:1808
    ds_read_b128 v[80:83], v7 offset:1824
    ds_read_b128 v[84:87], v7 offset:1840
    ds_read_b128 v[88:91], v7 offset:1856
    s_waitcnt lgkmcnt(0)
    v_mul_f32 v64, v20, v72
    v_fmac_f32 v64, v21, v73
    v_fmac_f32 v64, v22, v74
    v_fmac_f32 v64, v23, v75
    v_fmac_f32 v64, v24, v76
    v_fmac_f32 v64, v25, v77
    v_fmac_f32 v64, v26, v78
    v_fmac_f32 v64, v27, v79
    v_fmac_f32 v64, v28, v80
    v_fmac_f32 v64, v29, v81
    v_fmac_f32 v64, v30, v82
    v_fmac_f32 v64, v31, v83
    v_fmac_f32 v64, v32, v84
    v_fmac_f32 v64, v33, v85
    v_fmac_f32 v64, v34, v86
    v_fmac_f32 v64, v35, v87
    v_fmac_f32 v64, v36, v88
    v_fmac_f32 v64, v37, v89
    v_fmac_f32 v64, v38, v90
    v_fmac_f32 v64, v39, v91
    ds_read_b128 v[72:75], v7 offset:1920
    ds_read_b128 v[76:79], v7 offset:1936
    ds_read_b128 v[80:83], v7 offset:1952
    ds_read_b128 v[84:87], v7 offset:1968
    ds_read_b128 v[88:91], v7 offset:1984
    s_waitcnt lgkmcnt(0)
    v_mul_f32 v65, v20, v72
    v_fmac_f32 v65, v21, v73
    v_fmac_f32 v65, v22, v74
    v_fmac_f32 v65, v23, v75
    v_fmac_f32 v65, v24, v76
    v_fmac_f32 v65, v25, v77
    v_fmac_f32 v65, v26, v78
    v_fmac_f32 v65, v27, v79
    v_fmac_f32 v65, v28, v80
    v_fmac_f32 v65, v29, v81
    v_fmac_f32 v65, v30, v82
    v_fmac_f32 v65, v31, v83
    v_fmac_f32 v65, v32, v84
    v_fmac_f32 v65, v33, v85
    v_fmac_f32 v65, v34, v86
    v_fmac_f32 v65, v35, v87
    v_fmac_f32 v65, v36, v88
    v_fmac_f32 v65, v37, v89
    v_fmac_f32 v65, v38, v90
    v_fmac_f32 v65, v39, v91
    ds_read_b128 v[72:75], v7 offset:2048
    ds_read_b128 v[76:79], v7 offset:2064
    ds_read_b128 v[80:83], v7 offset:2080
    ds_read_b128 v[84:87], v7 offset:2096
    ds_read_b128 v[88:91], v7 offset:2112
    s_waitcnt lgkmcnt(0)
    v_mul_f32 v66, v20, v72
    v_fmac_f32 v66, v21, v73
    v_fmac_f32 v66, v22, v74
    v_fmac_f32 v66, v23, v75
    v_fmac_f32 v66, v24, v76
    v_fmac_f32 v66, v25, v77
    v_fmac_f32 v66, v26, v78
    v_fmac_f32 v66, v27, v79
    v_fmac_f32 v66, v28, v80
    v_fmac_f32 v66, v29, v81
    v_fmac_f32 v66, v30, v82
    v_fmac_f32 v66, v31, v83
    v_fmac_f32 v66, v32, v84
    v_fmac_f32 v66, v33, v85
    v_fmac_f32 v66, v34, v86
    v_fmac_f32 v66, v35, v87
    v_fmac_f32 v66, v36, v88
    v_fmac_f32 v66, v37, v89
    v_fmac_f32 v66, v38, v90
    v_fmac_f32 v66, v39, v91
    ds_read_b128 v[72:75], v7 offset:2176
    ds_read_b128 v[76:79], v7 offset:2192
    ds_read_b128 v[80:83], v7 offset:2208
    ds_read_b128 v[84:87], v7 offset:2224
    ds_read_b128 v[88:91], v7 offset:2240
    s_waitcnt lgkmcnt(0)
    v_mul_f32 v67, v20, v72
    v_fmac_f32 v67, v21, v73
    v_fmac_f32 v67, v22, v74
    v_fmac_f32 v67, v23, v75
    v_fmac_f32 v67, v24, v76
    v_fmac_f32 v67, v25, v77
    v_fmac_f32 v67, v26, v78
    v_fmac_f32 v67, v27, v79
    v_fmac_f32 v67, v28, v80
    v_fmac_f32 v67, v29, v81
    v_fmac_f32 v67, v30, v82
    v_fmac_f32 v67, v31, v83
    v_fmac_f32 v67, v32, v84
    v_fmac_f32 v67, v33, v85
    v_fmac_f32 v67, v34, v86
    v_fmac_f32 v67, v35, v87
    v_fmac_f32 v67, v36, v88
    v_fmac_f32 v67, v37, v89
    v_fmac_f32 v67, v38, v90
    v_fmac_f32 v67, v39, v91
    ds_read_b128 v[72:75], v7 offset:2304
    ds_read_b128 v[76:79], v7 offset:2320
    ds_read_b128 v[80:83], v7 offset:2336
    ds_read_b128 v[84:87], v7 offset:2352
    ds_read_b128 v[88:91], v7 offset:2368
    s_waitcnt lgkmcnt(0)
    v_mul_f32 v68, v20, v72
    v_fmac_f32 v68, v21, v73
    v_fmac_f32 v68, v22, v74
    v_fmac_f32 v68, v23, v75
    v_fmac_f32 v68, v24, v76
    v_fmac_f32 v68, v25, v77
    v_fmac_f32 v68, v26, v78
    v_fmac_f32 v68, v27, v79
    v_fmac_f32 v68, v28, v80
    v_fmac_f32 v68, v29, v81
    v_fmac_f32 v68, v30, v82
    v_fmac_f32 v68, v31, v83
    v_fmac_f32 v68, v32, v84
    v_fmac_f32 v68, v33, v85
    v_fmac_f32 v68, v34, v86
    v_fmac_f32 v68, v35, v87
    v_fmac_f32 v68, v36, v88
    v_fmac_f32 v68, v37, v89
    v_fmac_f32 v68, v38, v90
    v_fmac_f32 v68, v39, v91
    ds_read_b128 v[72:75], v7 offset:2432
    ds_read_b128 v[76:79], v7 offset:2448
    ds_read_b128 v[80:83], v7 offset:2464
    ds_read_b128 v[84:87], v7 offset:2480
    ds_read_b128 v[88:91], v7 offset:2496
    s_waitcnt lgkmcnt(0)
    v_mul_f32 v69, v20, v72
    v_fmac_f32 v69, v21, v73
    v_fmac_f32 v69, v22, v74
    v_fmac_f32 v69, v23, v75
    v_fmac_f32 v69, v24, v76
    v_fmac_f32 v69, v25, v77
    v_fmac_f32 v69, v26, v78
    v_fmac_f32 v69, v27, v79
    v_fmac_f32 v69, v28, v80
    v_fmac_f32 v69, v29, v81
    v_fmac_f32 v69, v30, v82
    v_fmac_f32 v69, v31, v83
    v_fmac_f32 v69, v32, v84
    v_fmac_f32 v69, v33, v85
    v_fmac_f32 v69, v34, v86
    v_fmac_f32 v69, v35, v87
    v_fmac_f32 v69, v36, v88
    v_fmac_f32 v69, v37, v89
    v_fmac_f32 v69, v38, v90
    v_fmac_f32 v69, v39, v91
    ds_read_b128 v[72:75], v7 offset:2560
    ds_read_b128 v[76:79], v7 offset:2576
    ds_read_b128 v[80:83], v7 offset:2592
    ds_read_b128 v[84:87], v7 offset:2608
    ds_read_b128 v[88:91], v7 offset:2624
    s_waitcnt lgkmcnt(0)
    v_mul_f32 v70, v20, v72
    v_fmac_f32 v70, v21, v73
    v_fmac_f32 v70, v22, v74
    v_fmac_f32 v70, v23, v75
    v_fmac_f32 v70, v24, v76
    v_fmac_f32 v70, v25, v77
    v_fmac_f32 v70, v26, v78
    v_fmac_f32 v70, v27, v79
    v_fmac_f32 v70, v28, v80
    v_fmac_f32 v70, v29, v81
    v_fmac_f32 v70, v30, v82
    v_fmac_f32 v70, v31, v83
    v_fmac_f32 v70, v32, v84
    v_fmac_f32 v70, v33, v85
    v_fmac_f32 v70, v34, v86
    v_fmac_f32 v70, v35, v87
    v_fmac_f32 v70, v36, v88
    v_fmac_f32 v70, v37, v89
    v_fmac_f32 v70, v38, v90
    v_fmac_f32 v70, v39, v91
    v_add_f32 v70, 0x358637bd, v70
    v_rcp_f32 v70, v70
    s_nop 0
    v_mul_f32 v50, v50, v70
    v_mul_f32 v51, v51, v70
    v_mul_f32 v52, v52, v70
    v_mul_f32 v53, v53, v70
    v_mul_f32 v54, v54, v70
    v_mul_f32 v55, v55, v70
    v_mul_f32 v56, v56, v70
    v_mul_f32 v57, v57, v70
    v_mul_f32 v58, v58, v70
    v_mul_f32 v59, v59, v70
    v_mul_f32 v60, v60, v70
    v_mul_f32 v61, v61, v70
    v_mul_f32 v62, v62, v70
    v_mul_f32 v63, v63, v70
    v_mul_f32 v64, v64, v70
    v_mul_f32 v65, v65, v70
    v_mul_f32 v66, v66, v70
    v_mul_f32 v67, v67, v70
    v_mul_f32 v68, v68, v70
    v_mul_f32 v69, v69, v70
    v_cvt_pk_bf16_f32 v8, v50, v51
    v_cvt_pk_bf16_f32 v9, v52, v53
    v_cvt_pk_bf16_f32 v10, v54, v55
    v_cvt_pk_bf16_f32 v11, v56, v57
    v_cvt_pk_bf16_f32 v12, v58, v59
    v_cvt_pk_bf16_f32 v13, v60, v61
    v_cvt_pk_bf16_f32 v14, v62, v63
    v_cvt_pk_bf16_f32 v15, v64, v65
    v_cvt_pk_bf16_f32 v16, v66, v67
    v_cvt_pk_bf16_f32 v17, v68, v69
    v_add_u32 v6, 239075328, v4
    buffer_store_dwordx2 v[8:9], v6, s[8:11], 0 offen offset:0
    buffer_store_dwordx2 v[10:11], v6, s[8:11], 0 offen offset:8
    buffer_store_dwordx2 v[12:13], v6, s[8:11], 0 offen offset:16
    buffer_store_dwordx2 v[14:15], v6, s[8:11], 0 offen offset:24
    buffer_store_dwordx2 v[16:17], v6, s[8:11], 0 offen offset:32
attn_a1_kernel_end:
    s_endpgm
.section .rodata,"a"
.p2align 6
.amdhsa_kernel attn_a1_kernel
  .amdhsa_next_free_vgpr 96
  .amdhsa_next_free_sgpr 40
  .amdhsa_accum_offset 96
  .amdhsa_group_segment_fixed_size 0
  .amdhsa_kernarg_size 104
  .amdhsa_user_sgpr_count 2
  .amdhsa_user_sgpr_kernarg_segment_ptr 1
  .amdhsa_system_sgpr_workgroup_id_x 1
.end_amdhsa_kernel
.text
.globl wo_a1_kernel
.p2align 8
.type wo_a1_kernel,@function
wo_a1_kernel:
    v_lshrrev_b32 v1, 6, v0
    v_and_b32 v2, 63, v0
    s_nop 0
    v_readfirstlane_b32 s3, v1
    s_cmp_ge_u32 s2, 128
    s_cbranch_scc1 wo_a1_kernel_end
    s_load_dwordx2 s[4:5], s[0:1], 96
    s_load_dwordx2 s[6:7], s[0:1], 80
    s_load_dwordx2 s[42:43], s[0:1], 0
    s_mul_i32 s20, s2, 1
    s_lshr_b32 s20, s20, 3
    s_mul_i32 s21, s20, 8
    s_sub_u32 s21, s2, s21
    s_lshl_b32 s20, s20, 2
    s_add_u32 s20, s20, s3
    s_mul_i32 s22, s20, 32
    s_mul_i32 s23, s21, 80
    s_waitcnt lgkmcnt(0)
    s_mov_b32 s8, s4
    s_mov_b32 s9, s5
    s_mov_b32 s10, 268435456
    s_mov_b32 s11, 0x00020000
    v_and_b32 v3, 15, v2
    v_lshrrev_b32 v4, 4, v2
    s_mov_b32 s24, 1280
    v_add_u32 v5, s22, v3
    v_mul_lo_u32 v5, v5, s24
    v_lshlrev_b32 v6, 4, v4
    v_add_u32 v5, v5, v6
    v_add_u32 v5, 239075328, v5
    v_mov_b32 v8, v5
    v_add_u32 v9, 20480, v5
    v_lshlrev_b32 v7, 4, v2
    s_mov_b32 s25, 0
    s_mov_b32 s26, 0
    s_mul_i32 s27, s21, 102400
    s_add_u32 s27, s27, s26
    s_add_u32 s27, s27, 246415360
    s_add_u32 s32, s27, 0
    s_add_u32 s33, s27, 20480
    s_add_u32 s34, s27, 40960
    s_add_u32 s35, s27, 61440
    s_add_u32 s36, s27, 81920
    v_accvgpr_write_b32 a0, 0
    v_accvgpr_write_b32 a1, 0
    v_accvgpr_write_b32 a2, 0
    v_accvgpr_write_b32 a3, 0
    v_accvgpr_write_b32 a4, 0
    v_accvgpr_write_b32 a5, 0
    v_accvgpr_write_b32 a6, 0
    v_accvgpr_write_b32 a7, 0
    v_accvgpr_write_b32 a8, 0
    v_accvgpr_write_b32 a9, 0
    v_accvgpr_write_b32 a10, 0
    v_accvgpr_write_b32 a11, 0
    v_accvgpr_write_b32 a12, 0
    v_accvgpr_write_b32 a13, 0
    v_accvgpr_write_b32 a14, 0
    v_accvgpr_write_b32 a15, 0
    v_accvgpr_write_b32 a16, 0
    v_accvgpr_write_b32 a17, 0
    v_accvgpr_write_b32 a18, 0
    v_accvgpr_write_b32 a19, 0
    v_accvgpr_write_b32 a20, 0
    v_accvgpr_write_b32 a21, 0
    v_accvgpr_write_b32 a22, 0
    v_accvgpr_write_b32 a23, 0
    v_accvgpr_write_b32 a24, 0
    v_accvgpr_write_b32 a25, 0
    v_accvgpr_write_b32 a26, 0
    v_accvgpr_write_b32 a27, 0
    v_accvgpr_write_b32 a28, 0
    v_accvgpr_write_b32 a29, 0
    v_accvgpr_write_b32 a30, 0
    v_accvgpr_write_b32 a31, 0
    v_accvgpr_write_b32 a32, 0
    v_accvgpr_write_b32 a33, 0
    v_accvgpr_write_b32 a34, 0
    v_accvgpr_write_b32 a35, 0
    v_accvgpr_write_b32 a36, 0
    v_accvgpr_write_b32 a37, 0
    v_accvgpr_write_b32 a38, 0
    v_accvgpr_write_b32 a39, 0
    buffer_load_dwordx4 v[16:19], v8, s[8:11], s25 offen
    buffer_load_dwordx4 v[20:23], v9, s[8:11], s25 offen
    buffer_load_dwordx4 v[24:27], v7, s[8:11], s32 offen
    buffer_load_dwordx4 v[28:31], v7, s[8:11], s33 offen
    buffer_load_dwordx4 v[32:35], v7, s[8:11], s34 offen
    buffer_load_dwordx4 v[36:39], v7, s[8:11], s35 offen
    buffer_load_dwordx4 v[40:43], v7, s[8:11], s36 offen
    s_mov_b32 s28, 10
wo_a1_kernel_loop0:
    s_add_u32 s25, s25, 64
    s_add_u32 s32, s32, 1024
    s_add_u32 s33, s33, 1024
    s_add_u32 s34, s34, 1024
    s_add_u32 s35, s35, 1024
    s_add_u32 s36, s36, 1024
    buffer_load_dwordx4 v[44:47], v8, s[8:11], s25 offen
    buffer_load_dwordx4 v[48:51], v9, s[8:11], s25 offen
    buffer_load_dwordx4 v[52:55], v7, s[8:11], s32 offen
    buffer_load_dwordx4 v[56:59], v7, s[8:11], s33 offen
    buffer_load_dwordx4 v[60:63], v7, s[8:11], s34 offen
    buffer_load_dwordx4 v[64:67], v7, s[8:11], s35 offen
    buffer_load_dwordx4 v[68:71], v7, s[8:11], s36 offen
    s_waitcnt vmcnt(7)
    v_mfma_f32_16x16x32_bf16 a[0:3], v[24:27], v[16:19], a[0:3]
    v_mfma_f32_16x16x32_bf16 a[20:23], v[24:27], v[20:23], a[20:23]
    v_mfma_f32_16x16x32_bf16 a[4:7], v[28:31], v[16:19], a[4:7]
    v_mfma_f32_16x16x32_bf16 a[24:27], v[28:31], v[20:23], a[24:27]
    v_mfma_f32_16x16x32_bf16 a[8:11], v[32:35], v[16:19], a[8:11]
    v_mfma_f32_16x16x32_bf16 a[28:31], v[32:35], v[20:23], a[28:31]
    v_mfma_f32_16x16x32_bf16 a[12:15], v[36:39], v[16:19], a[12:15]
    v_mfma_f32_16x16x32_bf16 a[32:35], v[36:39], v[20:23], a[32:35]
    v_mfma_f32_16x16x32_bf16 a[16:19], v[40:43], v[16:19], a[16:19]
    v_mfma_f32_16x16x32_bf16 a[36:39], v[40:43], v[20:23], a[36:39]
    s_sub_u32 s28, s28, 1
    s_cmp_eq_u32 s28, 0
    s_cbranch_scc1 wo_a1_kernel_loop0_last
    s_add_u32 s25, s25, 64
    s_add_u32 s32, s32, 1024
    s_add_u32 s33, s33, 1024
    s_add_u32 s34, s34, 1024
    s_add_u32 s35, s35, 1024
    s_add_u32 s36, s36, 1024
    buffer_load_dwordx4 v[16:19], v8, s[8:11], s25 offen
    buffer_load_dwordx4 v[20:23], v9, s[8:11], s25 offen
    buffer_load_dwordx4 v[24:27], v7, s[8:11], s32 offen
    buffer_load_dwordx4 v[28:31], v7, s[8:11], s33 offen
    buffer_load_dwordx4 v[32:35], v7, s[8:11], s34 offen
    buffer_load_dwordx4 v[36:39], v7, s[8:11], s35 offen
    buffer_load_dwordx4 v[40:43], v7, s[8:11], s36 offen
    s_waitcnt vmcnt(7)
    v_mfma_f32_16x16x32_bf16 a[0:3], v[52:55], v[44:47], a[0:3]
    v_mfma_f32_16x16x32_bf16 a[20:23], v[52:55], v[48:51], a[20:23]
    v_mfma_f32_16x16x32_bf16 a[4:7], v[56:59], v[44:47], a[4:7]
    v_mfma_f32_16x16x32_bf16 a[24:27], v[56:59], v[48:51], a[24:27]
    v_mfma_f32_16x16x32_bf16 a[8:11], v[60:63], v[44:47], a[8:11]
    v_mfma_f32_16x16x32_bf16 a[28:31], v[60:63], v[48:51], a[28:31]
    v_mfma_f32_16x16x32_bf16 a[12:15], v[64:67], v[44:47], a[12:15]
    v_mfma_f32_16x16x32_bf16 a[32:35], v[64:67], v[48:51], a[32:35]
    v_mfma_f32_16x16x32_bf16 a[16:19], v[68:71], v[44:47], a[16:19]
    v_mfma_f32_16x16x32_bf16 a[36:39], v[68:71], v[48:51], a[36:39]
    s_branch wo_a1_kernel_loop0
wo_a1_kernel_loop0_last:
    s_waitcnt vmcnt(0)
    v_mfma_f32_16x16x32_bf16 a[0:3], v[52:55], v[44:47], a[0:3]
    v_mfma_f32_16x16x32_bf16 a[20:23], v[52:55], v[48:51], a[20:23]
    v_mfma_f32_16x16x32_bf16 a[4:7], v[56:59], v[44:47], a[4:7]
    v_mfma_f32_16x16x32_bf16 a[24:27], v[56:59], v[48:51], a[24:27]
    v_mfma_f32_16x16x32_bf16 a[8:11], v[60:63], v[44:47], a[8:11]
    v_mfma_f32_16x16x32_bf16 a[28:31], v[60:63], v[48:51], a[28:31]
    v_mfma_f32_16x16x32_bf16 a[12:15], v[64:67], v[44:47], a[12:15]
    v_mfma_f32_16x16x32_bf16 a[32:35], v[64:67], v[48:51], a[32:35]
    v_mfma_f32_16x16x32_bf16 a[16:19], v[68:71], v[44:47], a[16:19]
    v_mfma_f32_16x16x32_bf16 a[36:39], v[68:71], v[48:51], a[36:39]
    s_nop 7
    s_nop 7
    s_mov_b32 s44, s42
    s_mov_b32 s45, s43
    s_mov_b32 s46, 2621440
    s_mov_b32 s47, 0x00020000
    s_mov_b32 s24, 1280
    v_add_u32 v5, s22, v3
    v_mul_lo_u32 v5, v5, s24
    v_lshlrev_b32 v6, 3, v4
    s_lshl_b32 s29, s23, 1
    v_add3_u32 v5, v5, v6, s29
    v_add_u32 v6, 0, v5
    buffer_load_dwordx2 v[72:73], v6, s[44:47], 0 offen
    v_accvgpr_read_b32 v76, a0
    v_accvgpr_read_b32 v77, a1
    v_accvgpr_read_b32 v78, a2
    v_accvgpr_read_b32 v79, a3
    v_cvt_pk_bf16_f32 v80, v76, v77
    v_cvt_pk_bf16_f32 v81, v78, v79
    s_waitcnt vmcnt(0)
    v_lshlrev_b32 v76, 16, v80
    v_and_b32 v77, 0xffff0000, v80
    v_lshlrev_b32 v82, 16, v72
    v_and_b32 v83, 0xffff0000, v72
    v_add_f32 v76, v76, v82
    v_add_f32 v77, v77, v83
    v_lshlrev_b32 v78, 16, v81
    v_and_b32 v79, 0xffff0000, v81
    v_lshlrev_b32 v82, 16, v73
    v_and_b32 v83, 0xffff0000, v73
    v_add_f32 v78, v78, v82
    v_add_f32 v79, v79, v83
    v_cvt_pk_bf16_f32 v80, v76, v77
    v_cvt_pk_bf16_f32 v81, v78, v79
    v_add_u32 v6, 226492416, v5
    buffer_store_dwordx2 v[80:81], v6, s[8:11], 0 offen
    v_add_u32 v6, 32, v5
    buffer_load_dwordx2 v[72:73], v6, s[44:47], 0 offen
    v_accvgpr_read_b32 v76, a4
    v_accvgpr_read_b32 v77, a5
    v_accvgpr_read_b32 v78, a6
    v_accvgpr_read_b32 v79, a7
    v_cvt_pk_bf16_f32 v80, v76, v77
    v_cvt_pk_bf16_f32 v81, v78, v79
    s_waitcnt vmcnt(0)
    v_lshlrev_b32 v76, 16, v80
    v_and_b32 v77, 0xffff0000, v80
    v_lshlrev_b32 v82, 16, v72
    v_and_b32 v83, 0xffff0000, v72
    v_add_f32 v76, v76, v82
    v_add_f32 v77, v77, v83
    v_lshlrev_b32 v78, 16, v81
    v_and_b32 v79, 0xffff0000, v81
    v_lshlrev_b32 v82, 16, v73
    v_and_b32 v83, 0xffff0000, v73
    v_add_f32 v78, v78, v82
    v_add_f32 v79, v79, v83
    v_cvt_pk_bf16_f32 v80, v76, v77
    v_cvt_pk_bf16_f32 v81, v78, v79
    v_add_u32 v6, 226492448, v5
    buffer_store_dwordx2 v[80:81], v6, s[8:11], 0 offen
    v_add_u32 v6, 64, v5
    buffer_load_dwordx2 v[72:73], v6, s[44:47], 0 offen
    v_accvgpr_read_b32 v76, a8
    v_accvgpr_read_b32 v77, a9
    v_accvgpr_read_b32 v78, a10
    v_accvgpr_read_b32 v79, a11
    v_cvt_pk_bf16_f32 v80, v76, v77
    v_cvt_pk_bf16_f32 v81, v78, v79
    s_waitcnt vmcnt(0)
    v_lshlrev_b32 v76, 16, v80
    v_and_b32 v77, 0xffff0000, v80
    v_lshlrev_b32 v82, 16, v72
    v_and_b32 v83, 0xffff0000, v72
    v_add_f32 v76, v76, v82
    v_add_f32 v77, v77, v83
    v_lshlrev_b32 v78, 16, v81
    v_and_b32 v79, 0xffff0000, v81
    v_lshlrev_b32 v82, 16, v73
    v_and_b32 v83, 0xffff0000, v73
    v_add_f32 v78, v78, v82
    v_add_f32 v79, v79, v83
    v_cvt_pk_bf16_f32 v80, v76, v77
    v_cvt_pk_bf16_f32 v81, v78, v79
    v_add_u32 v6, 226492480, v5
    buffer_store_dwordx2 v[80:81], v6, s[8:11], 0 offen
    v_add_u32 v6, 96, v5
    buffer_load_dwordx2 v[72:73], v6, s[44:47], 0 offen
    v_accvgpr_read_b32 v76, a12
    v_accvgpr_read_b32 v77, a13
    v_accvgpr_read_b32 v78, a14
    v_accvgpr_read_b32 v79, a15
    v_cvt_pk_bf16_f32 v80, v76, v77
    v_cvt_pk_bf16_f32 v81, v78, v79
    s_waitcnt vmcnt(0)
    v_lshlrev_b32 v76, 16, v80
    v_and_b32 v77, 0xffff0000, v80
    v_lshlrev_b32 v82, 16, v72
    v_and_b32 v83, 0xffff0000, v72
    v_add_f32 v76, v76, v82
    v_add_f32 v77, v77, v83
    v_lshlrev_b32 v78, 16, v81
    v_and_b32 v79, 0xffff0000, v81
    v_lshlrev_b32 v82, 16, v73
    v_and_b32 v83, 0xffff0000, v73
    v_add_f32 v78, v78, v82
    v_add_f32 v79, v79, v83
    v_cvt_pk_bf16_f32 v80, v76, v77
    v_cvt_pk_bf16_f32 v81, v78, v79
    v_add_u32 v6, 226492512, v5
    buffer_store_dwordx2 v[80:81], v6, s[8:11], 0 offen
    v_add_u32 v6, 128, v5
    buffer_load_dwordx2 v[72:73], v6, s[44:47], 0 offen
    v_accvgpr_read_b32 v76, a16
    v_accvgpr_read_b32 v77, a17
    v_accvgpr_read_b32 v78, a18
    v_accvgpr_read_b32 v79, a19
    v_cvt_pk_bf16_f32 v80, v76, v77
    v_cvt_pk_bf16_f32 v81, v78, v79
    s_waitcnt vmcnt(0)
    v_lshlrev_b32 v76, 16, v80
    v_and_b32 v77, 0xffff0000, v80
    v_lshlrev_b32 v82, 16, v72
    v_and_b32 v83, 0xffff0000, v72
    v_add_f32 v76, v76, v82
    v_add_f32 v77, v77, v83
    v_lshlrev_b32 v78, 16, v81
    v_and_b32 v79, 0xffff0000, v81
    v_lshlrev_b32 v82, 16, v73
    v_and_b32 v83, 0xffff0000, v73
    v_add_f32 v78, v78, v82
    v_add_f32 v79, v79, v83
    v_cvt_pk_bf16_f32 v80, v76, v77
    v_cvt_pk_bf16_f32 v81, v78, v79
    v_add_u32 v6, 226492544, v5
    buffer_store_dwordx2 v[80:81], v6, s[8:11], 0 offen
    v_add_u32 v6, 20480, v5
    buffer_load_dwordx2 v[72:73], v6, s[44:47], 0 offen
    v_accvgpr_read_b32 v76, a20
    v_accvgpr_read_b32 v77, a21
    v_accvgpr_read_b32 v78, a22
    v_accvgpr_read_b32 v79, a23
    v_cvt_pk_bf16_f32 v80, v76, v77
    v_cvt_pk_bf16_f32 v81, v78, v79
    s_waitcnt vmcnt(0)
    v_lshlrev_b32 v76, 16, v80
    v_and_b32 v77, 0xffff0000, v80
    v_lshlrev_b32 v82, 16, v72
    v_and_b32 v83, 0xffff0000, v72
    v_add_f32 v76, v76, v82
    v_add_f32 v77, v77, v83
    v_lshlrev_b32 v78, 16, v81
    v_and_b32 v79, 0xffff0000, v81
    v_lshlrev_b32 v82, 16, v73
    v_and_b32 v83, 0xffff0000, v73
    v_add_f32 v78, v78, v82
    v_add_f32 v79, v79, v83
    v_cvt_pk_bf16_f32 v80, v76, v77
    v_cvt_pk_bf16_f32 v81, v78, v79
    v_add_u32 v6, 226512896, v5
    buffer_store_dwordx2 v[80:81], v6, s[8:11], 0 offen
    v_add_u32 v6, 20512, v5
    buffer_load_dwordx2 v[72:73], v6, s[44:47], 0 offen
    v_accvgpr_read_b32 v76, a24
    v_accvgpr_read_b32 v77, a25
    v_accvgpr_read_b32 v78, a26
    v_accvgpr_read_b32 v79, a27
    v_cvt_pk_bf16_f32 v80, v76, v77
    v_cvt_pk_bf16_f32 v81, v78, v79
    s_waitcnt vmcnt(0)
    v_lshlrev_b32 v76, 16, v80
    v_and_b32 v77, 0xffff0000, v80
    v_lshlrev_b32 v82, 16, v72
    v_and_b32 v83, 0xffff0000, v72
    v_add_f32 v76, v76, v82
    v_add_f32 v77, v77, v83
    v_lshlrev_b32 v78, 16, v81
    v_and_b32 v79, 0xffff0000, v81
    v_lshlrev_b32 v82, 16, v73
    v_and_b32 v83, 0xffff0000, v73
    v_add_f32 v78, v78, v82
    v_add_f32 v79, v79, v83
    v_cvt_pk_bf16_f32 v80, v76, v77
    v_cvt_pk_bf16_f32 v81, v78, v79
    v_add_u32 v6, 226512928, v5
    buffer_store_dwordx2 v[80:81], v6, s[8:11], 0 offen
    v_add_u32 v6, 20544, v5
    buffer_load_dwordx2 v[72:73], v6, s[44:47], 0 offen
    v_accvgpr_read_b32 v76, a28
    v_accvgpr_read_b32 v77, a29
    v_accvgpr_read_b32 v78, a30
    v_accvgpr_read_b32 v79, a31
    v_cvt_pk_bf16_f32 v80, v76, v77
    v_cvt_pk_bf16_f32 v81, v78, v79
    s_waitcnt vmcnt(0)
    v_lshlrev_b32 v76, 16, v80
    v_and_b32 v77, 0xffff0000, v80
    v_lshlrev_b32 v82, 16, v72
    v_and_b32 v83, 0xffff0000, v72
    v_add_f32 v76, v76, v82
    v_add_f32 v77, v77, v83
    v_lshlrev_b32 v78, 16, v81
    v_and_b32 v79, 0xffff0000, v81
    v_lshlrev_b32 v82, 16, v73
    v_and_b32 v83, 0xffff0000, v73
    v_add_f32 v78, v78, v82
    v_add_f32 v79, v79, v83
    v_cvt_pk_bf16_f32 v80, v76, v77
    v_cvt_pk_bf16_f32 v81, v78, v79
    v_add_u32 v6, 226512960, v5
    buffer_store_dwordx2 v[80:81], v6, s[8:11], 0 offen
    v_add_u32 v6, 20576, v5
    buffer_load_dwordx2 v[72:73], v6, s[44:47], 0 offen
    v_accvgpr_read_b32 v76, a32
    v_accvgpr_read_b32 v77, a33
    v_accvgpr_read_b32 v78, a34
    v_accvgpr_read_b32 v79, a35
    v_cvt_pk_bf16_f32 v80, v76, v77
    v_cvt_pk_bf16_f32 v81, v78, v79
    s_waitcnt vmcnt(0)
    v_lshlrev_b32 v76, 16, v80
    v_and_b32 v77, 0xffff0000, v80
    v_lshlrev_b32 v82, 16, v72
    v_and_b32 v83, 0xffff0000, v72
    v_add_f32 v76, v76, v82
    v_add_f32 v77, v77, v83
    v_lshlrev_b32 v78, 16, v81
    v_and_b32 v79, 0xffff0000, v81
    v_lshlrev_b32 v82, 16, v73
    v_and_b32 v83, 0xffff0000, v73
    v_add_f32 v78, v78, v82
    v_add_f32 v79, v79, v83
    v_cvt_pk_bf16_f32 v80, v76, v77
    v_cvt_pk_bf16_f32 v81, v78, v79
    v_add_u32 v6, 226512992, v5
    buffer_store_dwordx2 v[80:81], v6, s[8:11], 0 offen
    v_add_u32 v6, 20608, v5
    buffer_load_dwordx2 v[72:73], v6, s[44:47], 0 offen
    v_accvgpr_read_b32 v76, a36
    v_accvgpr_read_b32 v77, a37
    v_accvgpr_read_b32 v78, a38
    v_accvgpr_read_b32 v79, a39
    v_cvt_pk_bf16_f32 v80, v76, v77
    v_cvt_pk_bf16_f32 v81, v78, v79
    s_waitcnt vmcnt(0)
    v_lshlrev_b32 v76, 16, v80
    v_and_b32 v77, 0xffff0000, v80
    v_lshlrev_b32 v82, 16, v72
    v_and_b32 v83, 0xffff0000, v72
    v_add_f32 v76, v76, v82
    v_add_f32 v77, v77, v83
    v_lshlrev_b32 v78, 16, v81
    v_and_b32 v79, 0xffff0000, v81
    v_lshlrev_b32 v82, 16, v73
    v_and_b32 v83, 0xffff0000, v73
    v_add_f32 v78, v78, v82
    v_add_f32 v79, v79, v83
    v_cvt_pk_bf16_f32 v80, v76, v77
    v_cvt_pk_bf16_f32 v81, v78, v79
    v_add_u32 v6, 226513024, v5
    buffer_store_dwordx2 v[80:81], v6, s[8:11], 0 offen
wo_a1_kernel_end:
    s_endpgm
.section .rodata,"a"
.p2align 6
.amdhsa_kernel wo_a1_kernel
  .amdhsa_next_free_vgpr 136
  .amdhsa_next_free_sgpr 64
  .amdhsa_accum_offset 96
  .amdhsa_group_segment_fixed_size 0
  .amdhsa_kernarg_size 104
  .amdhsa_user_sgpr_count 2
  .amdhsa_user_sgpr_kernarg_segment_ptr 1
  .amdhsa_system_sgpr_workgroup_id_x 1
.end_amdhsa_kernel
.text
.globl ln_b1_kernel
.p2align 8
.type ln_b1_kernel,@function
ln_b1_kernel:
    s_cmp_gt_u32 s2, 512
    s_cbranch_scc1 ln_b1_kernel_end
    s_load_dwordx2 s[4:5], s[0:1], 96
    s_load_dwordx2 s[6:7], s[0:1], 32
    v_lshrrev_b32 v1, 6, v0
    v_and_b32 v0, 63, v0
    s_nop 0
    v_readfirstlane_b32 s13, v1
    s_waitcnt lgkmcnt(0)
    s_mov_b32 s8, s4
    s_mov_b32 s9, s5
    s_mov_b32 s10, 268435456
    s_mov_b32 s11, 0x00020000
    s_cmp_eq_u32 s2, 512
    s_cbranch_scc1 ln_b1_kernel_mem0
    s_lshl_b32 s20, s2, 2
    s_add_u32 s20, s20, s13
    s_mul_i32 s21, s20, 1280
    s_add_u32 s21, s21, 226492416
    v_lshlrev_b32 v3, 2, v0
    buffer_load_dword v4, v3, s[8:11], s21 offen offset:0
    buffer_load_dword v5, v3, s[8:11], s21 offen offset:256
    buffer_load_dword v6, v3, s[8:11], s21 offen offset:512
    buffer_load_dword v7, v3, s[8:11], s21 offen offset:768
    buffer_load_dword v8, v3, s[8:11], s21 offen offset:1024
    v_lshrrev_b32 v20, 4, v0
    v_lshlrev_b32 v20, 2, v20
    v_bfe_u32 v21, v0, 3, 1
    v_lshl_add_u32 v20, v21, 1, v20
    v_bfe_u32 v21, v0, 1, 1
    v_add_u32 v20, v20, v21
    v_lshlrev_b32 v20, 9, v20
    v_and_b32 v21, 1, v0
    v_lshl_add_u32 v20, v21, 3, v20
    v_bfe_u32 v21, v0, 2, 1
    v_lshl_add_u32 v23, v21, 2, v20
    s_lshr_b32 s22, s20, 5
    s_mul_i32 s22, s22, 40960
    s_and_b32 s23, s20, 31
    s_lshl_b32 s23, s23, 4
    s_add_u32 s22, s22, s23
    s_add_u32 s22, s22, 220200960
    s_waitcnt vmcnt(0)
    v_lshlrev_b32 v10, 16, v4
    v_and_b32 v11, 0xffff0000, v4
    v_lshlrev_b32 v12, 16, v5
    v_and_b32 v13, 0xffff0000, v5
    v_lshlrev_b32 v14, 16, v6
    v_and_b32 v15, 0xffff0000, v6
    v_lshlrev_b32 v16, 16, v7
    v_and_b32 v17, 0xffff0000, v7
    v_lshlrev_b32 v18, 16, v8
    v_and_b32 v19, 0xffff0000, v8
    v_add_f32 v20, v10, v11
    v_add_f32 v20, v20, v12
    v_add_f32 v20, v20, v13
    v_add_f32 v20, v20, v14
    v_add_f32 v20, v20, v15
    v_add_f32 v20, v20, v16
    v_add_f32 v20, v20, v17
    v_add_f32 v20, v20, v18
    v_add_f32 v20, v20, v19
    s_nop 1
    v_add_f32 v21, v20, v20 quad_perm:[1,0,3,2] row_mask:0xf bank_mask:0xf
    s_nop 1
    v_add_f32 v21, v21, v21 quad_perm:[2,3,0,1] row_mask:0xf bank_mask:0xf
    s_nop 1
    v_add_f32 v21, v21, v21 row_half_mirror row_mask:0xf bank_mask:0xf
    s_nop 1
    v_add_f32 v21, v21, v21 row_mirror row_mask:0xf bank_mask:0xf
    s_nop 1
    v_readlane_b32 s24, v21, 0
    v_readlane_b32 s25, v21, 16
    v_readlane_b32 s26, v21, 32
    v_readlane_b32 s27, v21, 48
    s_nop 1
    v_mov_b32 v20, s24
    v_add_f32 v20, s25, v20
    v_add_f32 v20, s26, v20
    v_add_f32 v20, s27, v20
    v_mul_f32 v20, 0x3acccccd, v20
    v_sub_f32 v10, v10, v20
    v_sub_f32 v11, v11, v20
    v_sub_f32 v12, v12, v20
    v_sub_f32 v13, v13, v20
    v_sub_f32 v14, v14, v20
    v_sub_f32 v15, v15, v20
    v_sub_f32 v16, v16, v20
    v_sub_f32 v17, v17, v20
    v_sub_f32 v18, v18, v20
    v_sub_f32 v19, v19, v20
    v_mul_f32 v21, v10, v10
    v_fmac_f32 v21, v11, v11
    v_fmac_f32 v21, v12, v12
    v_fmac_f32 v21, v13, v13
    v_fmac_f32 v21, v14, v14
    v_fmac_f32 v21, v15, v15
    v_fmac_f32 v21, v16, v16
    v_fmac_f32 v21, v17, v17
    v_fmac_f32 v21, v18, v18
    v_fmac_f32 v21, v19, v19
    s_nop 1
    v_add_f32 v22, v21, v21 quad_perm:[1,0,3,2] row_mask:0xf bank_mask:0xf
    s_nop 1
    v_add_f32 v22, v22, v22 quad_perm:[2,3,0,1] row_mask:0xf bank_mask:0xf
    s_nop 1
    v_add_f32 v22, v22, v22 row_half_mirror row_mask:0xf bank_mask:0xf
    s_nop 1
    v_add_f32 v22, v22, v22 row_mirror row_mask:0xf bank_mask:0xf
    s_nop 1
    v_readlane_b32 s24, v22, 0
    v_readlane_b32 s25, v22, 16
    v_readlane_b32 s26, v22, 32
    v_readlane_b32 s27, v22, 48
    s_nop 1
    v_mov_b32 v21, s24
    v_add_f32 v21, s25, v21
    v_add_f32 v21, s26, v21
    v_add_f32 v21, s27, v21
    v_mov_b32 v22, 0x3727c5ac
    v_fmac_f32 v22, 0x3acccccd, v21
    v_rsq_f32 v22, v22
    s_nop 0
    v_mul_f32 v10, v10, v22
    v_mul_f32 v11, v11, v22
    v_mul_f32 v12, v12, v22
    v_mul_f32 v13, v13, v22
    v_mul_f32 v14, v14, v22
    v_mul_f32 v15, v15, v22
    v_mul_f32 v16, v16, v22
    v_mul_f32 v17, v17, v22
    v_mul_f32 v18, v18, v22
    v_mul_f32 v19, v19, v22
    v_cvt_pk_bf16_f32 v4, v10, v11
    v_cvt_pk_bf16_f32 v5, v12, v13
    v_cvt_pk_bf16_f32 v6, v14, v15
    v_cvt_pk_bf16_f32 v7, v16, v17
    v_cvt_pk_bf16_f32 v8, v18, v19
    s_add_u32 s23, s22, 0
    buffer_store_dword v4, v23, s[8:11], s23 offen
    s_add_u32 s23, s22, 8192
    buffer_store_dword v5, v23, s[8:11], s23 offen
    s_add_u32 s23, s22, 16384
    buffer_store_dword v6, v23, s[8:11], s23 offen
    s_add_u32 s23, s22, 24576
    buffer_store_dword v7, v23, s[8:11], s23 offen
    s_add_u32 s23, s22, 32768
    buffer_store_dword v8, v23, s[8:11], s23 offen
    s_branch ln_b1_kernel_end
ln_b1_kernel_mem0:
    s_mov_b32 s16, s6
    s_mov_b32 s17, s7
    s_mov_b32 s18, 10240
    s_mov_b32 s19, 0x00020000
    s_sub_u32 s22, 0, s4
    s_and_b32 s22, s22, 0x1fffff
    s_mov_b32 s23, 10551296
    s_buffer_load_dword s24, s[8:11], s23
    s_waitcnt lgkmcnt(0)
    s_and_b32 s24, s24, 8192
    s_add_u32 s22, s22, s24
    s_add_u32 s22, s22, 0
    s_lshl_b32 s25, s13, 6
    v_add_u32 v1, s25, v0
    v_add_u32 v2, 0, v1
    v_and_b32 v3, 7, v2
    v_mul_u32_u24 v3, 1280, v3
    v_lshrrev_b32 v4, 3, v2
    v_lshl_add_u32 v3, v4, 4, v3
    v_lshlrev_b32 v5, 4, v2
    v_add_u32 v5, 20480, v5
    v_lshrrev_b32 v6, 13, v5
    v_lshlrev_b32 v6, 14, v6
    v_and_b32 v5, 8191, v5
    v_add_u32 v5, v5, v6
    v_cmp_gt_u32 vcc, 640, v2
    s_and_saveexec_b64 s[30:31], vcc
    s_cbranch_execz ln_b1_kernel_m0s0
    buffer_load_dwordx4 v[8:11], v3, s[16:19], 0 offen
    s_waitcnt vmcnt(0)
    buffer_store_dwordx4 v[8:11], v5, s[8:11], s22 offen
ln_b1_kernel_m0s0:
    s_mov_b64 exec, s[30:31]
    v_add_u32 v2, 256, v1
    v_and_b32 v3, 7, v2
    v_mul_u32_u24 v3, 1280, v3
    v_lshrrev_b32 v4, 3, v2
    v_lshl_add_u32 v3, v4, 4, v3
    v_lshlrev_b32 v5, 4, v2
    v_add_u32 v5, 20480, v5
    v_lshrrev_b32 v6, 13, v5
    v_lshlrev_b32 v6, 14, v6
    v_and_b32 v5, 8191, v5
    v_add_u32 v5, v5, v6
    v_cmp_gt_u32 vcc, 640, v2
    s_and_saveexec_b64 s[30:31], vcc
    s_cbranch_execz ln_b1_kernel_m0s1
    buffer_load_dwordx4 v[8:11], v3, s[16:19], 0 offen
    s_waitcnt vmcnt(0)
    buffer_store_dwordx4 v[8:11], v5, s[8:11], s22 offen
ln_b1_kernel_m0s1:
    s_mov_b64 exec, s[30:31]
    v_add_u32 v2, 512, v1
    v_and_b32 v3, 7, v2
    v_mul_u32_u24 v3, 1280, v3
    v_lshrrev_b32 v4, 3, v2
    v_lshl_add_u32 v3, v4, 4, v3
    v_lshlrev_b32 v5, 4, v2
    v_add_u32 v5, 20480, v5
    v_lshrrev_b32 v6, 13, v5
    v_lshlrev_b32 v6, 14, v6
    v_and_b32 v5, 8191, v5
    v_add_u32 v5, v5, v6
    v_cmp_gt_u32 vcc, 640, v2
    s_and_saveexec_b64 s[30:31], vcc
    s_cbranch_execz ln_b1_kernel_m0s2
    buffer_load_dwordx4 v[8:11], v3, s[16:19], 0 offen
    s_waitcnt vmcnt(0)
    buffer_store_dwordx4 v[8:11], v5, s[8:11], s22 offen
ln_b1_kernel_m0s2:
    s_mov_b64 exec, s[30:31]
ln_b1_kernel_end:
    s_endpgm
.section .rodata,"a"
.p2align 6
.amdhsa_kernel ln_b1_kernel
  .amdhsa_next_free_vgpr 32
  .amdhsa_next_free_sgpr 48
  .amdhsa_accum_offset 32
  .amdhsa_group_segment_fixed_size 0
  .amdhsa_kernarg_size 104
  .amdhsa_user_sgpr_count 2
  .amdhsa_user_sgpr_kernarg_segment_ptr 1
  .amdhsa_system_sgpr_workgroup_id_x 1
.end_amdhsa_kernel
.text
.globl layerb2_kernel
.p2align 8
.type layerb2_kernel,@function
layerb2_kernel:
    s_mov_b32 s49, 1
    s_branch layerb1_kernel_body
    s_endpgm
.section .rodata,"a"
.p2align 6
.amdhsa_kernel layerb2_kernel
  .amdhsa_next_free_vgpr 512
  .amdhsa_next_free_sgpr 100
  .amdhsa_accum_offset 256
  .amdhsa_group_segment_fixed_size 0
  .amdhsa_kernarg_size 104
  .amdhsa_user_sgpr_count 2
  .amdhsa_user_sgpr_kernarg_segment_ptr 1
  .amdhsa_system_sgpr_workgroup_id_x 1
.end_amdhsa_kernel
.text
.globl layerb1_kernel
.p2align 8
.type layerb1_kernel,@function
layerb1_kernel:
    s_mov_b32 s49, 0
layerb1_kernel_body:
    s_cmp_ge_u32 s2, 256
    s_cbranch_scc1 layerb1_kernel_end0
    s_load_dwordx2 s[4:5], s[0:1], 96
    s_load_dwordx2 s[6:7], s[0:1], 80
    v_lshrrev_b32 v1, 6, v0
    v_and_b32 v0, 63, v0
    s_nop 0
    v_readfirstlane_b32 s13, v1
    s_mov_b32 s15, 400000
    s_waitcnt lgkmcnt(0)
    s_mov_b32 s8, s4
    s_mov_b32 s9, s5
    s_mov_b32 s10, 268435456
    s_mov_b32 s11, 0x00020000
    s_add_u32 s22, s4, 247463936
    s_addc_u32 s23, s5, 0
    s_cmp_eq_u32 s49, 0
    s_cselect_b32 s84, s22, s6
    s_cselect_b32 s85, s23, s7
    s_mov_b32 s86, 2621440
    s_mov_b32 s87, 0x00020000
    s_mul_i32 s48, s49, 32768
    s_add_u32 s48, s48, 10616832
    s_lshl_b32 s19, s49, 11
    s_add_u32 s19, s19, 10485760
    s_getreg_b32 s20, hwreg(HW_REG_XCC_ID)
    s_and_b32 s20, s20, 7
    s_cmp_lg_u32 s13, 0
    s_cbranch_scc1 layerb1_kernel_tk_wait
    s_lshl_b32 s22, s20, 8
    s_add_u32 s22, s22, s19
    s_mov_b64 exec, 1
    v_mov_b32 v2, 0
    v_mov_b32 v3, 1
    buffer_atomic_add v3, v2, s[8:11], s22 offen sc0 sc1
    s_waitcnt vmcnt(0)
    s_mov_b64 exec, -1
    s_nop 0
    v_readfirstlane_b32 s21, v3
    s_cmp_lt_u32 s21, 32
    s_cbranch_scc1 layerb1_kernel_tk_pub
    v_lshlrev_b32 v2, 8, v0
    v_and_b32 v2, 0x7ff, v2
    s_mov_b32 s22, s19
layerb1_kernel_tk_poll:
    buffer_load_dword v3, v2, s[8:11], s22 offen sc1
    s_waitcnt vmcnt(0)
    s_mov_b32 s23, 0
    v_readlane_b32 s24, v3, 0
    s_nop 0
    s_add_u32 s23, s23, s24
    v_readlane_b32 s25, v3, 1
    s_nop 0
    s_add_u32 s23, s23, s25
    v_readlane_b32 s26, v3, 2
    s_nop 0
    s_add_u32 s23, s23, s26
    v_readlane_b32 s27, v3, 3
    s_nop 0
    s_add_u32 s23, s23, s27
    v_readlane_b32 s28, v3, 4
    s_nop 0
    s_add_u32 s23, s23, s28
    v_readlane_b32 s29, v3, 5
    s_nop 0
    s_add_u32 s23, s23, s29
    v_readlane_b32 s30, v3, 6
    s_nop 0
    s_add_u32 s23, s23, s30
    v_readlane_b32 s31, v3, 7
    s_nop 0
    s_add_u32 s23, s23, s31
    s_sub_u32 s15, s15, 1
    s_cbranch_scc1 layerb1_kernel_bail
    s_cmp_lt_u32 s23, 256
    s_cbranch_scc1 layerb1_kernel_tk_poll
    s_sub_u32 s21, s21, 32
    s_max_u32 s23, s24, 32
    s_sub_u32 s23, s23, 32
    s_cmp_gt_u32 s20, 0
    s_cselect_b32 s23, s23, 0
    s_add_u32 s21, s21, s23
    s_max_u32 s23, s25, 32
    s_sub_u32 s23, s23, 32
    s_cmp_gt_u32 s20, 1
    s_cselect_b32 s23, s23, 0
    s_add_u32 s21, s21, s23
    s_max_u32 s23, s26, 32
    s_sub_u32 s23, s23, 32
    s_cmp_gt_u32 s20, 2
    s_cselect_b32 s23, s23, 0
    s_add_u32 s21, s21, s23
    s_max_u32 s23, s27, 32
    s_sub_u32 s23, s23, 32
    s_cmp_gt_u32 s20, 3
    s_cselect_b32 s23, s23, 0
    s_add_u32 s21, s21, s23
    s_max_u32 s23, s28, 32
    s_sub_u32 s23, s23, 32
    s_cmp_gt_u32 s20, 4
    s_cselect_b32 s23, s23, 0
    s_add_u32 s21, s21, s23
    s_max_u32 s23, s29, 32
    s_sub_u32 s23, s23, 32
    s_cmp_gt_u32 s20, 5
    s_cselect_b32 s23, s23, 0
    s_add_u32 s21, s21, s23
    s_max_u32 s23, s30, 32
    s_sub_u32 s23, s23, 32
    s_cmp_gt_u32 s20, 6
    s_cselect_b32 s23, s23, 0
    s_add_u32 s21, s21, s23
    s_min_u32 s23, s24, 32
    s_sub_u32 s22, 32, s23
    s_cmp_lt_u32 s21, s22
    s_cbranch_scc0 layerb1_kernel_tk_n0
    s_mov_b32 s20, 0
    s_add_u32 s21, s21, s23
    s_branch layerb1_kernel_tk_pub
layerb1_kernel_tk_n0:
    s_sub_u32 s21, s21, s22
    s_min_u32 s23, s25, 32
    s_sub_u32 s22, 32, s23
    s_cmp_lt_u32 s21, s22
    s_cbranch_scc0 layerb1_kernel_tk_n1
    s_mov_b32 s20, 1
    s_add_u32 s21, s21, s23
    s_branch layerb1_kernel_tk_pub
layerb1_kernel_tk_n1:
    s_sub_u32 s21, s21, s22
    s_min_u32 s23, s26, 32
    s_sub_u32 s22, 32, s23
    s_cmp_lt_u32 s21, s22
    s_cbranch_scc0 layerb1_kernel_tk_n2
    s_mov_b32 s20, 2
    s_add_u32 s21, s21, s23
    s_branch layerb1_kernel_tk_pub
layerb1_kernel_tk_n2:
    s_sub_u32 s21, s21, s22
    s_min_u32 s23, s27, 32
    s_sub_u32 s22, 32, s23
    s_cmp_lt_u32 s21, s22
    s_cbranch_scc0 layerb1_kernel_tk_n3
    s_mov_b32 s20, 3
    s_add_u32 s21, s21, s23
    s_branch layerb1_kernel_tk_pub
layerb1_kernel_tk_n3:
    s_sub_u32 s21, s21, s22
    s_min_u32 s23, s28, 32
    s_sub_u32 s22, 32, s23
    s_cmp_lt_u32 s21, s22
    s_cbranch_scc0 layerb1_kernel_tk_n4
    s_mov_b32 s20, 4
    s_add_u32 s21, s21, s23
    s_branch layerb1_kernel_tk_pub
layerb1_kernel_tk_n4:
    s_sub_u32 s21, s21, s22
    s_min_u32 s23, s29, 32
    s_sub_u32 s22, 32, s23
    s_cmp_lt_u32 s21, s22
    s_cbranch_scc0 layerb1_kernel_tk_n5
    s_mov_b32 s20, 5
    s_add_u32 s21, s21, s23
    s_branch layerb1_kernel_tk_pub
layerb1_kernel_tk_n5:
    s_sub_u32 s21, s21, s22
    s_min_u32 s23, s30, 32
    s_sub_u32 s22, 32, s23
    s_cmp_lt_u32 s21, s22
    s_cbranch_scc0 layerb1_kernel_tk_n6
    s_mov_b32 s20, 6
    s_add_u32 s21, s21, s23
    s_branch layerb1_kernel_tk_pub
layerb1_kernel_tk_n6:
    s_sub_u32 s21, s21, s22
    s_min_u32 s23, s31, 32
    s_sub_u32 s22, 32, s23
    s_cmp_lt_u32 s21, s22
    s_cbranch_scc0 layerb1_kernel_tk_n7
    s_mov_b32 s20, 7
    s_add_u32 s21, s21, s23
    s_branch layerb1_kernel_tk_pub
layerb1_kernel_tk_n7:
    s_sub_u32 s21, s21, s22
    s_branch layerb1_kernel_bail
layerb1_kernel_tk_pub:
    s_lshl_b32 s22, s20, 8
    s_or_b32 s22, s22, s21
    v_mov_b32 v2, 0
    v_mov_b32 v3, s22
    ds_write_b32 v2, v3
    s_waitcnt lgkmcnt(0)
layerb1_kernel_tk_wait:
    s_barrier
    v_mov_b32 v2, 0
    ds_read_b32 v3, v2
    s_waitcnt lgkmcnt(0)
    v_readfirstlane_b32 s22, v3
    s_barrier
    s_lshr_b32 s20, s22, 8
    s_and_b32 s21, s22, 255
    s_sub_u32 s22, 0, s4
    s_and_b32 s22, s22, 0x1fffff
    s_lshl_b32 s23, s49, 3
    s_add_u32 s23, s23, 10551296
    s_buffer_load_dwordx2 s[24:25], s[8:11], s23
    s_waitcnt lgkmcnt(0)
    s_and_b32 s24, s24, 8192
    s_and_b32 s25, s25, 8192
    s_mul_i32 s23, s49, 4194304
    s_add_u32 s22, s22, s23
    s_add_u32 s16, s22, s24
    s_add_u32 s17, s22, s25
    s_add_u32 s17, s17, 2097152
    s_mov_b32 s40, 0x01010101
    s_mov_b32 s41, 0x01010101
    s_mov_b32 s42, 0x00010001
    s_mov_b32 s43, 0
    v_lshlrev_b32 v1, 4, v0
    v_and_b32 v16, 8, v0
    v_cmp_eq_u32 vcc, 0, v16
    v_mov_b32 v17, 0xeeeeeeee
    v_mov_b32 v18, 0x44444444
    v_cndmask_b32 v2, v17, v18, vcc
    s_cmp_eq_u32 s20, 0
    s_cbranch_scc0 layerb1_kernel_notp
    s_mov_b32 s12, s21
    s_cmp_eq_u32 s13, 0
    s_cbranch_scc1 layerb1_kernel_p0_start
    s_cmp_eq_u32 s13, 1
    s_cbranch_scc1 layerb1_kernel_p1_start
    s_cmp_eq_u32 s13, 2
    s_cbranch_scc1 layerb1_kernel_p2_start
    s_cmp_eq_u32 s13, 3
    s_cbranch_scc1 layerb1_kernel_p3_start
layerb1_kernel_notp:
    s_cmp_ge_u32 s20, 4
    s_cbranch_scc1 layerb1_kernel_proj
    s_cmp_ge_u32 s21, 27
    s_cbranch_scc1 layerb1_kernel_w3
    s_sub_u32 s22, s20, 1
    s_mul_i32 s22, s22, 27
    s_add_u32 s12, s22, s21
    s_cmp_ge_u32 s12, 80
    s_cbranch_scc1 layerb1_kernel_w3
    s_cmp_eq_u32 s13, 0
    s_cbranch_scc1 layerb1_kernel_y0_start
    s_cmp_eq_u32 s13, 1
    s_cbranch_scc1 layerb1_kernel_y1_start
    s_cmp_eq_u32 s13, 2
    s_cbranch_scc1 layerb1_kernel_y2_start
    s_cmp_eq_u32 s13, 3
    s_cbranch_scc1 layerb1_kernel_y3_start
    s_branch layerb1_kernel_end
layerb1_kernel_p0_start:
    v_lshrrev_b32 v16, 4, v0
    v_and_b32 v17, 15, v0
    v_and_b32 v18, 1, v16
    v_lshlrev_b32 v18, 2, v18
    v_lshrrev_b32 v19, 1, v16
    v_lshl_add_u32 v18, v19, 1, v18
    v_mul_u32_u24 v18, 400, v18
    v_lshl_add_u32 v18, v17, 1, v18
    v_add_u32 v3, 133120, v18
    v_and_b32 v18, 7, v0
    v_mul_u32_u24 v18, 400, v18
    v_lshrrev_b32 v19, 3, v0
    v_lshl_add_u32 v18, v19, 4, v18
    v_add_u32 v4, 133120, v18
    v_and_b32 v18, 7, v0
    v_mul_u32_u24 v18, 400, v18
    v_lshl_add_u32 v18, v16, 5, v18
    v_add_u32 v5, 136320, v18
    v_lshrrev_b32 v18, 1, v16
    v_lshlrev_b32 v18, 10, v18
    v_and_b32 v19, 31, v0
    v_lshl_add_u32 v18, v19, 4, v18
    v_add_u32 v6, 139520, v18
    v_add_u32 v15, 139520, v1
    v_lshrrev_b32 v18, 1, v16
    v_lshlrev_b32 v18, 1, v18
    v_lshrrev_b32 v19, 3, v17
    v_add3_u32 v18, v18, v19, 1
    v_lshrrev_b32 v19, 1, v18
    v_lshlrev_b32 v19, 14, v19
    v_and_b32 v18, 1, v18
    v_lshl_add_u32 v18, v18, 12, v19
    v_and_b32 v19, 1, v16
    v_lshlrev_b32 v19, 4, v19
    v_add_u32 v19, 0, v19
    s_lshl_b32 s20, s12, 7
    v_add_u32 v8, s20, v19
    v_add_u32 v7, v8, v18
    v_lshlrev_b32 v18, 4, v17
    v_lshl_add_u32 v18, v16, 10, v18
    v_add_u32 v9, 0, v18
    v_add_u32 v18, 0, v0
    v_mul_u32_u24 v19, 2731, v18
    v_lshrrev_b32 v19, 16, v19
    v_mul_u32_u24 v20, 24, v19
    v_sub_u32 v20, v18, v20
    v_mul_u32_u24 v21, 400, v19
    v_lshl_add_u32 v21, v20, 4, v21
    v_add_u32 v10, 136320, v21
    v_lshlrev_b32 v21, 4, v19
    v_lshl_add_u32 v11, v20, 7, v21
    v_and_b32 v18, 0x28, v0
    v_cmp_eq_u32 vcc, 0, v18
    v_mov_b32 v18, 1.0
    v_mov_b32 v19, 0
    v_cndmask_b32 v12, v19, v18, vcc
    v_add_u32 v13, 0, v1
    v_add_u32 v14, 122880, v1
    s_mul_i32 s44, s12, 12288
    s_add_u32 s44, s44, 53477376
    s_mul_i32 s45, s12, 3072
    s_add_u32 s45, s45, 208666624
    s_mul_i32 s20, s12, 6
    s_add_u32 s21, s20, 5
    s_lshr_b32 s20, s20, 3
    s_lshr_b32 s21, s21, 3
    s_add_u32 s20, s20, 80
    s_add_u32 s21, s21, 80
    s_lshl_b32 s20, s20, 7
    s_lshl_b32 s21, s21, 7
    v_mov_b32 v255, s21
    v_mov_b32 v253, s20
    v_cmp_eq_u32 vcc, 0, v0
    s_nop 1
    v_cndmask_b32 v255, v255, v253, vcc
    s_mov_b32 s47, 0
    s_mul_i32 s20, s12, 491520
    s_add_u32 s20, s20, 11534336
    s_add_u32 s21, s20, 6144
    buffer_load_dwordx4 v[16:19], v1, s[8:11], s21 offen offset:0
    buffer_load_dwordx4 v[20:23], v1, s[8:11], s21 offen offset:1024
    s_add_u32 s21, s20, 47104
    buffer_load_dwordx4 v[24:27], v1, s[8:11], s21 offen offset:0
    buffer_load_dwordx4 v[28:31], v1, s[8:11], s21 offen offset:1024
    s_add_u32 s21, s20, 28672
    buffer_load_dwordx4 v[32:35], v1, s[8:11], s21 offen offset:0
    buffer_load_dwordx4 v[36:39], v1, s[8:11], s21 offen offset:1024
    s_add_u32 s21, s20, 10240
    buffer_load_dwordx4 v[40:43], v1, s[8:11], s21 offen offset:0
    buffer_load_dwordx4 v[44:47], v1, s[8:11], s21 offen offset:1024
    s_add_u32 s21, s20, 51200
    buffer_load_dwordx4 v[48:51], v1, s[8:11], s21 offen offset:0
    buffer_load_dwordx4 v[52:55], v1, s[8:11], s21 offen offset:1024
    s_add_u32 s21, s20, 32768
    buffer_load_dwordx4 v[56:59], v1, s[8:11], s21 offen offset:0
    buffer_load_dwordx4 v[60:63], v1, s[8:11], s21 offen offset:1024
    s_add_u32 s21, s20, 14336
    buffer_load_dwordx4 v[64:67], v1, s[8:11], s21 offen offset:0
    buffer_load_dwordx4 v[68:71], v1, s[8:11], s21 offen offset:1024
    s_add_u32 s21, s20, 55296
    buffer_load_dwordx4 v[72:75], v1, s[8:11], s21 offen offset:0
    buffer_load_dwordx4 v[76:79], v1, s[8:11], s21 offen offset:1024
    s_add_u32 s21, s20, 36864
    buffer_load_dwordx4 v[80:83], v1, s[8:11], s21 offen offset:0
    buffer_load_dwordx4 v[84:87], v1, s[8:11], s21 offen offset:1024
    s_add_u32 s21, s20, 18432
    buffer_load_dwordx4 v[88:91], v1, s[8:11], s21 offen offset:0
    buffer_load_dwordx4 v[92:95], v1, s[8:11], s21 offen offset:1024
    s_add_u32 s21, s20, 59392
    buffer_load_dwordx4 v[96:99], v1, s[8:11], s21 offen offset:0
    buffer_load_dwordx4 v[100:103], v1, s[8:11], s21 offen offset:1024
    s_add_u32 s21, s20, 90112
    buffer_load_dwordx4 v[104:107], v1, s[8:11], s21 offen offset:0
    buffer_load_dwordx4 v[108:111], v1, s[8:11], s21 offen offset:1024
    s_add_u32 s21, s20, 98304
    buffer_load_dwordx4 v[112:115], v1, s[8:11], s21 offen offset:0
    buffer_load_dwordx4 v[116:119], v1, s[8:11], s21 offen offset:1024
    s_add_u32 s21, s20, 106496
    buffer_load_dwordx4 v[120:123], v1, s[8:11], s21 offen offset:0
    buffer_load_dwordx4 v[124:127], v1, s[8:11], s21 offen offset:1024
    s_add_u32 s21, s20, 114688
    buffer_load_dwordx4 v[128:131], v1, s[8:11], s21 offen offset:0
    buffer_load_dwordx4 v[132:135], v1, s[8:11], s21 offen offset:1024
    s_add_u32 s21, s20, 0
    buffer_load_dwordx4 a[0:3], v1, s[8:11], s21 offen offset:0
    buffer_load_dwordx4 a[4:7], v1, s[8:11], s21 offen offset:1024
    s_add_u32 s21, s20, 20480
    buffer_load_dwordx4 a[8:11], v1, s[8:11], s21 offen offset:0
    buffer_load_dwordx4 a[12:15], v1, s[8:11], s21 offen offset:1024
    s_add_u32 s21, s20, 40960
    buffer_load_dwordx4 a[16:19], v1, s[8:11], s21 offen offset:0
    buffer_load_dwordx4 a[20:23], v1, s[8:11], s21 offen offset:1024
    s_add_u32 s21, s20, 2048
    buffer_load_dwordx4 a[24:27], v1, s[8:11], s21 offen offset:0
    buffer_load_dwordx4 a[28:31], v1, s[8:11], s21 offen offset:1024
    s_add_u32 s21, s20, 22528
    buffer_load_dwordx4 a[32:35], v1, s[8:11], s21 offen offset:0
    buffer_load_dwordx4 a[36:39], v1, s[8:11], s21 offen offset:1024
    s_add_u32 s21, s20, 43008
    buffer_load_dwordx4 a[40:43], v1, s[8:11], s21 offen offset:0
    buffer_load_dwordx4 a[44:47], v1, s[8:11], s21 offen offset:1024
    s_add_u32 s21, s20, 4096
    buffer_load_dwordx4 a[48:51], v1, s[8:11], s21 offen offset:0
    buffer_load_dwordx4 a[52:55], v1, s[8:11], s21 offen offset:1024
    s_add_u32 s21, s20, 24576
    buffer_load_dwordx4 a[56:59], v1, s[8:11], s21 offen offset:0
    buffer_load_dwordx4 a[60:63], v1, s[8:11], s21 offen offset:1024
    s_add_u32 s21, s20, 45056
    buffer_load_dwordx4 a[64:67], v1, s[8:11], s21 offen offset:0
    buffer_load_dwordx4 a[68:71], v1, s[8:11], s21 offen offset:1024
    s_add_u32 s21, s20, 26624
    buffer_load_dwordx4 a[72:75], v1, s[8:11], s21 offen offset:0
    buffer_load_dwordx4 a[76:79], v1, s[8:11], s21 offen offset:1024
    s_add_u32 s21, s20, 8192
    buffer_load_dwordx4 a[80:83], v1, s[8:11], s21 offen offset:0
    buffer_load_dwordx4 a[84:87], v1, s[8:11], s21 offen offset:1024
    s_add_u32 s21, s20, 49152
    buffer_load_dwordx4 a[88:91], v1, s[8:11], s21 offen offset:0
    buffer_load_dwordx4 a[92:95], v1, s[8:11], s21 offen offset:1024
    s_add_u32 s21, s20, 30720
    buffer_load_dwordx4 a[96:99], v1, s[8:11], s21 offen offset:0
    buffer_load_dwordx4 a[100:103], v1, s[8:11], s21 offen offset:1024
    s_add_u32 s21, s20, 12288
    buffer_load_dwordx4 a[104:107], v1, s[8:11], s21 offen offset:0
    buffer_load_dwordx4 a[108:111], v1, s[8:11], s21 offen offset:1024
    s_add_u32 s21, s20, 53248
    buffer_load_dwordx4 a[112:115], v1, s[8:11], s21 offen offset:0
    buffer_load_dwordx4 a[116:119], v1, s[8:11], s21 offen offset:1024
    s_add_u32 s21, s20, 34816
    buffer_load_dwordx4 a[120:123], v1, s[8:11], s21 offen offset:0
    buffer_load_dwordx4 a[124:127], v1, s[8:11], s21 offen offset:1024
    s_waitcnt vmcnt(32)
    ds_write_b128 v13, v[16:19] offset:0
    ds_write_b128 v13, v[20:23] offset:1024
    ds_write_b128 v13, v[24:27] offset:2048
    ds_write_b128 v13, v[28:31] offset:3072
    ds_write_b128 v13, v[32:35] offset:4096
    ds_write_b128 v13, v[36:39] offset:5120
    ds_write_b128 v13, v[40:43] offset:6144
    ds_write_b128 v13, v[44:47] offset:7168
    ds_write_b128 v13, v[48:51] offset:8192
    ds_write_b128 v13, v[52:55] offset:9216
    ds_write_b128 v13, v[56:59] offset:10240
    ds_write_b128 v13, v[60:63] offset:11264
    ds_write_b128 v13, v[64:67] offset:12288
    ds_write_b128 v13, v[68:71] offset:13312
    ds_write_b128 v13, v[72:75] offset:14336
    ds_write_b128 v13, v[76:79] offset:15360
    ds_write_b128 v13, v[80:83] offset:16384
    ds_write_b128 v13, v[84:87] offset:17408
    ds_write_b128 v13, v[88:91] offset:18432
    ds_write_b128 v13, v[92:95] offset:19456
    ds_write_b128 v13, v[96:99] offset:20480
    ds_write_b128 v13, v[100:103] offset:21504
    ds_write_b128 v13, v[104:107] offset:22528
    ds_write_b128 v13, v[108:111] offset:23552
    ds_write_b128 v13, v[112:115] offset:24576
    ds_write_b128 v13, v[116:119] offset:25600
    ds_write_b128 v13, v[120:123] offset:26624
    ds_write_b128 v13, v[124:127] offset:27648
    ds_write_b128 v13, v[128:131] offset:28672
    ds_write_b128 v13, v[132:135] offset:29696
    s_add_u32 s21, s20, 16384
    buffer_load_dwordx4 a[128:131], v1, s[8:11], s21 offen offset:0
    buffer_load_dwordx4 a[132:135], v1, s[8:11], s21 offen offset:1024
    s_add_u32 s21, s20, 57344
    buffer_load_dwordx4 a[136:139], v1, s[8:11], s21 offen offset:0
    buffer_load_dwordx4 a[140:143], v1, s[8:11], s21 offen offset:1024
    s_add_u32 s21, s20, 38912
    buffer_load_dwordx4 a[144:147], v1, s[8:11], s21 offen offset:0
    buffer_load_dwordx4 a[148:151], v1, s[8:11], s21 offen offset:1024
    s_add_u32 s21, s20, 61440
    buffer_load_dwordx4 a[152:155], v1, s[8:11], s21 offen offset:0
    buffer_load_dwordx4 a[156:159], v1, s[8:11], s21 offen offset:1024
    s_add_u32 s21, s20, 63488
    buffer_load_dwordx4 a[160:163], v1, s[8:11], s21 offen offset:0
    buffer_load_dwordx4 a[164:167], v1, s[8:11], s21 offen offset:1024
    s_add_u32 s21, s20, 65536
    buffer_load_dwordx4 a[168:171], v1, s[8:11], s21 offen offset:0
    buffer_load_dwordx4 a[172:175], v1, s[8:11], s21 offen offset:1024
    s_add_u32 s21, s20, 67584
    buffer_load_dwordx4 a[176:179], v1, s[8:11], s21 offen offset:0
    buffer_load_dwordx4 a[180:183], v1, s[8:11], s21 offen offset:1024
    s_add_u32 s21, s20, 69632
    buffer_load_dwordx4 a[184:187], v1, s[8:11], s21 offen offset:0
    buffer_load_dwordx4 a[188:191], v1, s[8:11], s21 offen offset:1024
    s_add_u32 s21, s20, 71680
    buffer_load_dwordx4 a[192:195], v1, s[8:11], s21 offen offset:0
    buffer_load_dwordx4 a[196:199], v1, s[8:11], s21 offen offset:1024
    s_add_u32 s21, s20, 73728
    buffer_load_dwordx4 a[200:203], v1, s[8:11], s21 offen offset:0
    buffer_load_dwordx4 a[204:207], v1, s[8:11], s21 offen offset:1024
    s_add_u32 s21, s20, 75776
    buffer_load_dwordx4 a[208:211], v1, s[8:11], s21 offen offset:0
    buffer_load_dwordx4 a[212:215], v1, s[8:11], s21 offen offset:1024
    s_add_u32 s21, s20, 77824
    buffer_load_dwordx4 a[216:219], v1, s[8:11], s21 offen offset:0
    buffer_load_dwordx4 a[220:223], v1, s[8:11], s21 offen offset:1024
    s_add_u32 s21, s20, 79872
    buffer_load_dwordx4 a[224:227], v1, s[8:11], s21 offen offset:0
    buffer_load_dwordx4 a[228:231], v1, s[8:11], s21 offen offset:1024
    s_add_u32 s21, s20, 81920
    buffer_load_dwordx4 a[232:235], v1, s[8:11], s21 offen offset:0
    buffer_load_dwordx4 a[236:239], v1, s[8:11], s21 offen offset:1024
    s_add_u32 s21, s20, 83968
    buffer_load_dwordx4 a[240:243], v1, s[8:11], s21 offen offset:0
    buffer_load_dwordx4 a[244:247], v1, s[8:11], s21 offen offset:1024
    s_add_u32 s21, s20, 86016
    buffer_load_dwordx4 a[248:251], v1, s[8:11], s21 offen offset:0
    buffer_load_dwordx4 a[252:255], v1, s[8:11], s21 offen offset:1024
    s_add_u32 s21, s20, 88064
    buffer_load_dwordx4 v[148:151], v1, s[8:11], s21 offen offset:0
    buffer_load_dwordx4 v[152:155], v1, s[8:11], s21 offen offset:1024
    s_add_u32 s21, s20, 92160
    buffer_load_dwordx4 v[156:159], v1, s[8:11], s21 offen offset:0
    buffer_load_dwordx4 v[160:163], v1, s[8:11], s21 offen offset:1024
    s_add_u32 s21, s20, 94208
    buffer_load_dwordx4 v[164:167], v1, s[8:11], s21 offen offset:0
    buffer_load_dwordx4 v[168:171], v1, s[8:11], s21 offen offset:1024
    s_add_u32 s21, s20, 96256
    buffer_load_dwordx4 v[172:175], v1, s[8:11], s21 offen offset:0
    buffer_load_dwordx4 v[176:179], v1, s[8:11], s21 offen offset:1024
    s_add_u32 s21, s20, 100352
    buffer_load_dwordx4 v[180:183], v1, s[8:11], s21 offen offset:0
    buffer_load_dwordx4 v[184:187], v1, s[8:11], s21 offen offset:1024
    s_add_u32 s21, s20, 102400
    buffer_load_dwordx4 v[188:191], v1, s[8:11], s21 offen offset:0
    buffer_load_dwordx4 v[192:195], v1, s[8:11], s21 offen offset:1024
    s_add_u32 s21, s20, 104448
    buffer_load_dwordx4 v[196:199], v1, s[8:11], s21 offen offset:0
    buffer_load_dwordx4 v[200:203], v1, s[8:11], s21 offen offset:1024
    s_add_u32 s21, s20, 108544
    buffer_load_dwordx4 v[204:207], v1, s[8:11], s21 offen offset:0
    buffer_load_dwordx4 v[208:211], v1, s[8:11], s21 offen offset:1024
    s_add_u32 s21, s20, 110592
    buffer_load_dwordx4 v[212:215], v1, s[8:11], s21 offen offset:0
    buffer_load_dwordx4 v[216:219], v1, s[8:11], s21 offen offset:1024
    s_add_u32 s21, s20, 112640
    buffer_load_dwordx4 v[220:223], v1, s[8:11], s21 offen offset:0
    buffer_load_dwordx4 v[224:227], v1, s[8:11], s21 offen offset:1024
    s_add_u32 s21, s20, 116736
    buffer_load_dwordx4 v[228:231], v1, s[8:11], s21 offen offset:0
    buffer_load_dwordx4 v[232:235], v1, s[8:11], s21 offen offset:1024
    s_add_u32 s21, s20, 118784
    buffer_load_dwordx4 v[236:239], v1, s[8:11], s21 offen offset:0
    buffer_load_dwordx4 v[240:243], v1, s[8:11], s21 offen offset:1024
    s_add_u32 s21, s20, 120832
    buffer_load_dwordx4 v[244:247], v1, s[8:11], s21 offen offset:0
    buffer_load_dwordx4 v[248:251], v1, s[8:11], s21 offen offset:1024
    s_waitcnt lgkmcnt(0)
    s_mov_b32 s14, 0
    s_cmp_gt_u32 s47, s14
    s_cbranch_scc1 layerb1_kernel_p0_gw1_ok
layerb1_kernel_p0_gw1_lp:
    buffer_load_dword v253, v255, s[8:11], s48 offen sc1
    s_waitcnt vmcnt(0)
    v_readlane_b32 s47, v253, 0
    v_readlane_b32 s29, v253, 1
    s_nop 0
    s_min_u32 s47, s47, s29
    s_sub_u32 s15, s15, 1
    s_cbranch_scc1 layerb1_kernel_bail
    s_cmp_gt_u32 s47, s14
    s_cbranch_scc0 layerb1_kernel_p0_gw1_lp
layerb1_kernel_p0_gw1_ok:
    s_mul_i32 s20, s14, 393216
    s_add_u32 s20, s20, s44
    s_add_u32 s21, s20, 0
    buffer_load_dwordx4 v[100:103], v9, s[8:11], s21 offen offset:0 sc1
    buffer_load_dwordx4 v[104:107], v9, s[8:11], s21 offen offset:512 sc1
    s_add_u32 s21, s20, 4096
    buffer_load_dwordx4 v[108:111], v9, s[8:11], s21 offen offset:0 sc1
    buffer_load_dwordx4 v[112:115], v9, s[8:11], s21 offen offset:512 sc1
    v_mov_b32 v56, 0
    v_mov_b32 v57, 0
    v_mov_b32 v58, 0
    v_mov_b32 v59, 0
    v_mov_b32 v60, 0
    v_mov_b32 v61, 0
    v_mov_b32 v62, 0
    v_mov_b32 v63, 0
    v_mov_b32 v64, 0
    v_mov_b32 v65, 0
    v_mov_b32 v66, 0
    v_mov_b32 v67, 0
    v_mov_b32 v68, 0
    v_mov_b32 v69, 0
    v_mov_b32 v70, 0
    v_mov_b32 v71, 0
    v_mov_b32 v72, 0
    v_mov_b32 v73, 0
    v_mov_b32 v74, 0
    v_mov_b32 v75, 0
    v_mov_b32 v76, 0
    v_mov_b32 v77, 0
    v_mov_b32 v78, 0
    v_mov_b32 v79, 0
    v_mov_b32 v80, 0
    v_mov_b32 v81, 0
    v_mov_b32 v82, 0
    v_mov_b32 v83, 0
    v_mov_b32 v84, 0
    v_mov_b32 v85, 0
    v_mov_b32 v86, 0
    v_mov_b32 v87, 0
    ds_read_b128 v[116:119], v13 offset:0
    ds_read_b128 v[120:123], v13 offset:1024
    ds_read_b128 v[124:127], v13 offset:2048
    ds_read_b128 v[128:131], v13 offset:3072
    ds_read_b128 v[132:135], v13 offset:4096
    ds_read_b128 v[136:139], v13 offset:5120
    ds_read_b128 v[140:143], v13 offset:6144
    ds_read_b128 v[144:147], v13 offset:7168
    s_waitcnt lgkmcnt(0)
layerb1_kernel_p0_step:
    s_cmp_lt_u32 s14, 32
    s_cselect_b32 s18, s16, s17
    s_and_b32 s20, s14, 31
    s_lshl_b32 s20, s20, 16
    s_add_u32 s18, s18, s20
    s_add_u32 s22, s18, 36864
    s_add_u32 s23, s18, 37888
    s_add_u32 s24, s18, 38912
layerb1_kernel_p0_poll:
    buffer_load_dwordx4 v[16:19], v1, s[8:11], s22 offen sc1
    buffer_load_dwordx4 v[20:23], v1, s[8:11], s23 offen sc1
    buffer_load_dwordx4 v[24:27], v1, s[8:11], s24 offen sc1
    s_waitcnt vmcnt(0)
    ds_write_b128 v14, v[16:19] offset:0
    ds_write_b128 v14, v[20:23] offset:1024
    ds_write_b128 v14, v[24:27] offset:2048
    v_max3_u32 v88, v16, v17, v18
    v_max3_u32 v88, v88, v19, v20
    v_max3_u32 v88, v88, v21, v22
    v_max3_u32 v88, v88, v23, v24
    v_max3_u32 v88, v88, v25, v26
    v_max_u32 v88, v88, v27
    v_cmp_eq_u32 vcc, -1, v88
    s_sub_u32 s15, s15, 1
    s_cbranch_scc1 layerb1_kernel_bail
    s_cbranch_vccnz layerb1_kernel_p0_poll
    s_waitcnt lgkmcnt(0)
    s_barrier
    ds_read_b128 v[28:31], v14 offset:3072
    ds_read_b128 v[32:35], v14 offset:4096
    ds_read_b128 v[36:39], v14 offset:5120
    ds_read_b128 v[40:43], v14 offset:6144
    ds_read_b128 v[44:47], v14 offset:7168
    ds_read_b128 v[48:51], v14 offset:8192
    ds_read_b128 v[52:55], v14 offset:9216
    v_smfmac_f32_16x16x64_bf16 v[56:59], v[16:19], a[0:7], v2
    v_smfmac_f32_16x16x64_bf16 v[60:63], v[16:19], a[8:15], v2
    v_smfmac_f32_16x16x64_bf16 v[64:67], v[16:19], a[16:23], v2
    v_smfmac_f32_16x16x64_bf16 v[56:59], v[20:23], a[24:31], v2
    v_smfmac_f32_16x16x64_bf16 v[60:63], v[20:23], a[32:39], v2
    v_smfmac_f32_16x16x64_bf16 v[64:67], v[20:23], a[40:47], v2
    v_smfmac_f32_16x16x64_bf16 v[56:59], v[24:27], a[48:55], v2
    v_smfmac_f32_16x16x64_bf16 v[60:63], v[24:27], a[56:63], v2
    v_smfmac_f32_16x16x64_bf16 v[64:67], v[24:27], a[64:71], v2
    s_waitcnt lgkmcnt(6)
    v_smfmac_f32_16x16x64_bf16 v[56:59], v[28:31], v[116:123], v2
    ds_read_b128 v[116:119], v13 offset:8192
    ds_read_b128 v[120:123], v13 offset:9216
    v_smfmac_f32_16x16x64_bf16 v[60:63], v[28:31], a[72:79], v2
    v_smfmac_f32_16x16x64_bf16 v[64:67], v[28:31], v[124:131], v2
    ds_read_b128 v[124:127], v13 offset:10240
    ds_read_b128 v[128:131], v13 offset:11264
    s_waitcnt lgkmcnt(9)
    v_smfmac_f32_16x16x64_bf16 v[56:59], v[32:35], a[80:87], v2
    v_smfmac_f32_16x16x64_bf16 v[60:63], v[32:35], v[132:139], v2
    ds_read_b128 v[132:135], v13 offset:12288
    ds_read_b128 v[136:139], v13 offset:13312
    v_smfmac_f32_16x16x64_bf16 v[64:67], v[32:35], a[88:95], v2
    s_waitcnt lgkmcnt(10)
    v_smfmac_f32_16x16x64_bf16 v[56:59], v[36:39], v[140:147], v2
    ds_read_b128 v[140:143], v13 offset:14336
    ds_read_b128 v[144:147], v13 offset:15360
    v_smfmac_f32_16x16x64_bf16 v[60:63], v[36:39], a[96:103], v2
    s_waitcnt lgkmcnt(6)
    v_smfmac_f32_16x16x64_bf16 v[64:67], v[36:39], v[116:123], v2
    ds_read_b128 v[116:119], v13 offset:16384
    ds_read_b128 v[120:123], v13 offset:17408
    v_smfmac_f32_16x16x64_bf16 v[56:59], v[40:43], a[104:111], v2
    s_waitcnt lgkmcnt(6)
    v_smfmac_f32_16x16x64_bf16 v[60:63], v[40:43], v[124:131], v2
    ds_read_b128 v[124:127], v13 offset:18432
    ds_read_b128 v[128:131], v13 offset:19456
    v_smfmac_f32_16x16x64_bf16 v[64:67], v[40:43], a[112:119], v2
    s_waitcnt lgkmcnt(6)
    v_smfmac_f32_16x16x64_bf16 v[56:59], v[44:47], v[132:139], v2
    ds_read_b128 v[132:135], v13 offset:20480
    ds_read_b128 v[136:139], v13 offset:21504
    v_smfmac_f32_16x16x64_bf16 v[60:63], v[44:47], a[120:127], v2
    s_waitcnt lgkmcnt(6)
    v_smfmac_f32_16x16x64_bf16 v[64:67], v[44:47], v[140:147], v2
    ds_read_b128 v[140:143], v13 offset:22528
    ds_read_b128 v[144:147], v13 offset:23552
    v_smfmac_f32_16x16x64_bf16 v[56:59], v[48:51], a[128:135], v2
    s_waitcnt lgkmcnt(6)
    v_smfmac_f32_16x16x64_bf16 v[60:63], v[48:51], v[116:123], v2
    ds_read_b128 v[116:119], v13 offset:24576
    ds_read_b128 v[120:123], v13 offset:25600
    v_smfmac_f32_16x16x64_bf16 v[64:67], v[48:51], a[136:143], v2
    s_waitcnt lgkmcnt(6)
    v_smfmac_f32_16x16x64_bf16 v[56:59], v[52:55], v[124:131], v2
    ds_read_b128 v[124:127], v13 offset:26624
    ds_read_b128 v[128:131], v13 offset:27648
    v_smfmac_f32_16x16x64_bf16 v[60:63], v[52:55], a[144:151], v2
    s_waitcnt lgkmcnt(6)
    v_smfmac_f32_16x16x64_bf16 v[64:67], v[52:55], v[132:139], v2
    ds_read_b128 v[132:135], v13 offset:28672
    ds_read_b128 v[136:139], v13 offset:29696
    v_smfmac_f32_16x16x64_bf16 v[68:71], v[16:19], a[152:159], v2
    v_smfmac_f32_16x16x64_bf16 v[68:71], v[20:23], a[160:167], v2
    v_permlane32_swap_b32 v56, v58
    v_permlane32_swap_b32 v57, v59
    v_smfmac_f32_16x16x64_bf16 v[68:71], v[24:27], a[168:175], v2
    v_add_f32 v56, v56, v58
    v_add_f32 v57, v57, v59
    v_smfmac_f32_16x16x64_bf16 v[68:71], v[28:31], a[176:183], v2
    v_cvt_pk_bf16_f32 v56, v56, v57
    ds_write_b16 v3, v56 offset:0
    v_smfmac_f32_16x16x64_bf16 v[68:71], v[32:35], a[184:191], v2
    ds_write_b16_d16_hi v3, v56 offset:400
    v_permlane32_swap_b32 v60, v62
    v_smfmac_f32_16x16x64_bf16 v[68:71], v[36:39], a[192:199], v2
    v_permlane32_swap_b32 v61, v63
    v_add_f32 v60, v60, v62
    v_smfmac_f32_16x16x64_bf16 v[68:71], v[40:43], a[200:207], v2
    v_add_f32 v61, v61, v63
    v_cvt_pk_bf16_f32 v60, v60, v61
    v_smfmac_f32_16x16x64_bf16 v[68:71], v[44:47], a[208:215], v2
    ds_write_b16 v3, v60 offset:32
    ds_write_b16_d16_hi v3, v60 offset:432
    v_smfmac_f32_16x16x64_bf16 v[68:71], v[48:51], a[216:223], v2
    v_permlane32_swap_b32 v64, v66
    v_permlane32_swap_b32 v65, v67
    v_smfmac_f32_16x16x64_bf16 v[68:71], v[52:55], a[224:231], v2
    v_add_f32 v64, v64, v66
    v_add_f32 v65, v65, v67
    v_smfmac_f32_16x16x64_bf16 v[72:75], v[16:19], a[232:239], v2
    v_cvt_pk_bf16_f32 v64, v64, v65
    ds_write_b16 v3, v64 offset:64
    v_smfmac_f32_16x16x64_bf16 v[72:75], v[20:23], a[240:247], v2
    ds_write_b16_d16_hi v3, v64 offset:464
    v_smfmac_f32_16x16x64_bf16 v[72:75], v[24:27], a[248:255], v2
    v_smfmac_f32_16x16x64_bf16 v[72:75], v[28:31], v[148:155], v2
    s_waitcnt lgkmcnt(0)
    s_barrier
    ds_read_b128 v[88:91], v4 offset:0
    v_smfmac_f32_16x16x64_bf16 v[72:75], v[32:35], v[140:147], v2
    ds_read_b128 v[92:95], v4 offset:128
    ds_read_b128 v[96:99], v4 offset:256
    v_smfmac_f32_16x16x64_bf16 v[72:75], v[36:39], v[156:163], v2
    v_permlane32_swap_b32 v68, v70
    v_permlane32_swap_b32 v69, v71
    v_smfmac_f32_16x16x64_bf16 v[72:75], v[40:43], v[164:171], v2
    v_add_f32 v68, v68, v70
    v_add_f32 v69, v69, v71
    v_smfmac_f32_16x16x64_bf16 v[72:75], v[44:47], v[172:179], v2
    v_cvt_pk_bf16_f32 v68, v68, v69
    ds_write_b16 v3, v68 offset:3200
    v_smfmac_f32_16x16x64_bf16 v[72:75], v[48:51], v[116:123], v2
    ds_write_b16_d16_hi v3, v68 offset:3600
    v_smfmac_f32_16x16x64_bf16 v[72:75], v[52:55], v[180:187], v2
    s_waitcnt lgkmcnt(2)
    v_smfmac_f32_16x16x64_bf16 v[80:83], v[88:91], v[100:107], v2
    v_smfmac_f32_16x16x64_bf16 v[80:83], v[92:95], v[108:115], v2
    v_smfmac_f32_16x16x64_bf16 v[76:79], v[16:19], v[188:195], v2
    v_smfmac_f32_16x16x64_bf16 v[76:79], v[20:23], v[196:203], v2
    v_smfmac_f32_16x16x64_bf16 v[76:79], v[24:27], v[124:131], v2
    v_permlane32_swap_b32 v72, v74
    v_permlane32_swap_b32 v73, v75
    v_smfmac_f32_16x16x64_bf16 v[76:79], v[28:31], v[204:211], v2
    v_add_f32 v72, v72, v74
    v_add_f32 v73, v73, v75
    ds_write_b128 v15, v[80:83]
    v_smfmac_f32_16x16x64_bf16 v[76:79], v[32:35], v[212:219], v2
    v_cvt_pk_bf16_f32 v72, v72, v73
    ds_write_b16 v3, v72 offset:3232
    v_smfmac_f32_16x16x64_bf16 v[76:79], v[36:39], v[220:227], v2
    ds_write_b16_d16_hi v3, v72 offset:3632
    v_smfmac_f32_16x16x64_bf16 v[76:79], v[40:43], v[132:139], v2
    v_smfmac_f32_16x16x64_bf16 v[76:79], v[44:47], v[228:235], v2
    v_smfmac_f32_16x16x64_bf16 v[76:79], v[48:51], v[236:243], v2
    v_smfmac_f32_16x16x64_bf16 v[76:79], v[52:55], v[244:251], v2
    s_nop 7
    v_permlane32_swap_b32 v76, v78
    v_permlane32_swap_b32 v77, v79
    v_add_f32 v76, v76, v78
    v_add_f32 v77, v77, v79
    v_cvt_pk_bf16_f32 v76, v76, v77
    ds_write_b16 v3, v76 offset:3264
    ds_write_b16_d16_hi v3, v76 offset:3664
    s_waitcnt lgkmcnt(0)
    s_barrier
    ds_read2st64_b32 v[40:41], v6 offset0:0 offset1:2
    ds_read2st64_b32 v[42:43], v6 offset0:8 offset1:10
    ds_read_b128 v[16:19], v5 offset:0
    ds_read_b128 v[20:23], v5 offset:16
    ds_read_b128 v[24:27], v5 offset:128
    ds_read_b128 v[28:31], v5 offset:144
    ds_read_b128 v[32:35], v5 offset:256
    ds_read_b128 v[36:39], v5 offset:272
    s_waitcnt lgkmcnt(6)
    v_add_f32 v40, v40, v41
    v_add_f32 v42, v42, v43
    v_add_f32 v44, v40, v42
    v_mul_f32 v44, 0x3dd53b95, v44
    s_waitcnt lgkmcnt(4)
    v_smfmac_f32_16x16x64_bf16 v[84:87], v[88:91], v[16:23], v2
    s_waitcnt lgkmcnt(2)
    v_smfmac_f32_16x16x64_bf16 v[84:87], v[92:95], v[24:31], v2
    s_waitcnt lgkmcnt(0)
    v_smfmac_f32_16x16x64_bf16 v[84:87], v[96:99], v[32:39], v2
    v_max_f32_dpp v45, v44, v44 row_ror:8 row_mask:0xf bank_mask:0xf
    s_nop 1
    v_max_f32_dpp v45, v45, v45 row_ror:4 row_mask:0xf bank_mask:0xf
    s_nop 1
    v_max_f32_dpp v45, v45, v45 row_ror:2 row_mask:0xf bank_mask:0xf
    s_nop 1
    v_max_f32_dpp v45, v45, v45 row_ror:1 row_mask:0xf bank_mask:0xf
    v_mov_b32 v47, v45
    s_nop 1
    v_permlane32_swap_b32 v45, v47
    v_max_f32 v45, v45, v47
    v_mov_b32 v47, v84
    s_nop 1
    v_permlane32_swap_b32 v84, v47
    v_add_f32 v48, v84, v47
    v_mul_f32 v48, 0x3dd53b95, v48
    s_nop 1
    v_max_f32_dpp v46, v48, v48 row_ror:4 row_mask:0xf bank_mask:0xf
    s_nop 1
    v_max_f32_dpp v46, v46, v46 row_ror:2 row_mask:0xf bank_mask:0xf
    s_nop 1
    v_max_f32_dpp v46, v46, v46 row_ror:1 row_mask:0xf bank_mask:0xf
    v_max_f32 v45, v45, v46
    v_sub_f32 v49, v44, v45
    v_sub_f32 v50, v48, v45
    v_exp_f32 v49, v49
    v_exp_f32 v50, v50
    s_nop 0
    v_fma_f32 v51, v50, v12, v49
    s_nop 1
    v_add_f32_dpp v51, v51, v51 row_ror:8 row_mask:0xf bank_mask:0xf
    s_nop 1
    v_add_f32_dpp v51, v51, v51 row_ror:4 row_mask:0xf bank_mask:0xf
    s_nop 1
    v_add_f32_dpp v51, v51, v51 row_ror:2 row_mask:0xf bank_mask:0xf
    s_nop 1
    v_add_f32_dpp v51, v51, v51 row_ror:1 row_mask:0xf bank_mask:0xf
    v_mov_b32 v47, v51
    s_nop 1
    v_permlane32_swap_b32 v51, v47
    v_add_f32 v51, v51, v47
    v_rcp_f32 v51, v51
    s_nop 0
    v_mul_f32 v49, v49, v51
    v_mul_f32 v50, v50, v51
    s_nop 0
    v_mov_b32_dpp v46, v49 quad_perm:[1,0,3,2] row_mask:0xf bank_mask:0xf
    v_mov_b32_dpp v47, v50 quad_perm:[1,0,3,2] row_mask:0xf bank_mask:0xf
    v_cvt_pk_bf16_f32 v16, v49, v46
    v_cvt_pk_bf16_f32 v20, v50, v47
    s_nop 0
    v_mov_b32_dpp v17, v16 row_shl:2 row_mask:0xf bank_mask:0xf
    v_mov_b32_dpp v18, v16 row_shl:4 row_mask:0xf bank_mask:0xf
    v_mov_b32_dpp v19, v16 row_shl:6 row_mask:0xf bank_mask:0xf
    v_mov_b32_dpp v21, v20 row_shl:2 row_mask:0xf bank_mask:0xf
    v_mov_b32_dpp v22, v20 row_shl:4 row_mask:0xf bank_mask:0xf
    v_mov_b32_dpp v23, v20 row_shl:6 row_mask:0xf bank_mask:0xf
    s_mov_b64 exec, s[40:41]
    buffer_store_dwordx4 v[16:19], v7, s[8:11], s18 offen sc1
    s_mov_b64 exec, s[42:43]
    buffer_store_dwordx4 v[20:23], v8, s[8:11], s18 offen sc1
    s_mov_b64 exec, -1
    ds_read_b128 v[40:43], v10
    s_add_u32 s28, s14, 1
    s_min_u32 s28, s28, 63
    s_cmp_gt_u32 s47, s28
    s_cbranch_scc1 layerb1_kernel_p0_gw2_ok
layerb1_kernel_p0_gw2_lp:
    buffer_load_dword v253, v255, s[8:11], s48 offen sc1
    s_waitcnt vmcnt(0)
    v_readlane_b32 s47, v253, 0
    v_readlane_b32 s29, v253, 1
    s_nop 0
    s_min_u32 s47, s47, s29
    s_sub_u32 s15, s15, 1
    s_cbranch_scc1 layerb1_kernel_bail
    s_cmp_gt_u32 s47, s28
    s_cbranch_scc0 layerb1_kernel_p0_gw2_lp
layerb1_kernel_p0_gw2_ok:
    s_mul_i32 s20, s28, 393216
    s_add_u32 s20, s20, s44
    s_add_u32 s21, s20, 0
    buffer_load_dwordx4 v[100:103], v9, s[8:11], s21 offen offset:0 sc1
    buffer_load_dwordx4 v[104:107], v9, s[8:11], s21 offen offset:512 sc1
    s_add_u32 s21, s20, 4096
    buffer_load_dwordx4 v[108:111], v9, s[8:11], s21 offen offset:0 sc1
    buffer_load_dwordx4 v[112:115], v9, s[8:11], s21 offen offset:512 sc1
    v_mov_b32 v56, 0
    v_mov_b32 v57, 0
    v_mov_b32 v58, 0
    v_mov_b32 v59, 0
    v_mov_b32 v60, 0
    v_mov_b32 v61, 0
    v_mov_b32 v62, 0
    v_mov_b32 v63, 0
    v_mov_b32 v64, 0
    v_mov_b32 v65, 0
    v_mov_b32 v66, 0
    v_mov_b32 v67, 0
    v_mov_b32 v68, 0
    v_mov_b32 v69, 0
    v_mov_b32 v70, 0
    v_mov_b32 v71, 0
    v_mov_b32 v72, 0
    v_mov_b32 v73, 0
    v_mov_b32 v74, 0
    v_mov_b32 v75, 0
    v_mov_b32 v76, 0
    v_mov_b32 v77, 0
    v_mov_b32 v78, 0
    v_mov_b32 v79, 0
    v_mov_b32 v80, 0
    v_mov_b32 v81, 0
    v_mov_b32 v82, 0
    v_mov_b32 v83, 0
    v_mov_b32 v84, 0
    v_mov_b32 v85, 0
    v_mov_b32 v86, 0
    v_mov_b32 v87, 0
    s_waitcnt lgkmcnt(0)
    s_mul_i32 s20, s14, 98304
    s_add_u32 s20, s20, s45
    buffer_store_dwordx4 v[40:43], v11, s[8:11], s20 offen sc1
    ds_read_b128 v[116:119], v13 offset:0
    ds_read_b128 v[120:123], v13 offset:1024
    ds_read_b128 v[124:127], v13 offset:2048
    ds_read_b128 v[128:131], v13 offset:3072
    ds_read_b128 v[132:135], v13 offset:4096
    ds_read_b128 v[136:139], v13 offset:5120
    ds_read_b128 v[140:143], v13 offset:6144
    ds_read_b128 v[144:147], v13 offset:7168
    s_waitcnt lgkmcnt(0)
    s_add_u32 s14, s14, 1
    s_cmp_lt_u32 s14, 64
    s_cbranch_scc1 layerb1_kernel_p0_step
    s_waitcnt vmcnt(0)
    s_barrier
    s_branch layerb1_kernel_end
layerb1_kernel_p1_start:
    v_lshrrev_b32 v16, 4, v0
    v_and_b32 v17, 15, v0
    v_and_b32 v18, 1, v16
    v_lshlrev_b32 v18, 2, v18
    v_lshrrev_b32 v19, 1, v16
    v_lshl_add_u32 v18, v19, 1, v18
    v_mul_u32_u24 v18, 400, v18
    v_lshl_add_u32 v18, v17, 1, v18
    v_add_u32 v3, 133216, v18
    v_and_b32 v18, 7, v0
    v_mul_u32_u24 v18, 400, v18
    v_lshrrev_b32 v19, 3, v0
    v_lshl_add_u32 v18, v19, 4, v18
    v_add_u32 v4, 133120, v18
    v_and_b32 v18, 7, v0
    v_mul_u32_u24 v18, 400, v18
    v_lshl_add_u32 v18, v16, 5, v18
    v_add_u32 v5, 136320, v18
    v_lshrrev_b32 v18, 1, v16
    v_lshlrev_b32 v18, 10, v18
    v_and_b32 v19, 31, v0
    v_lshl_add_u32 v18, v19, 4, v18
    v_add_u32 v6, 139524, v18
    v_add_u32 v15, 140544, v1
    v_lshrrev_b32 v18, 1, v16
    v_lshlrev_b32 v18, 1, v18
    v_lshrrev_b32 v19, 3, v17
    v_add3_u32 v18, v18, v19, 1
    v_lshrrev_b32 v19, 1, v18
    v_lshlrev_b32 v19, 14, v19
    v_and_b32 v18, 1, v18
    v_lshl_add_u32 v18, v18, 12, v19
    v_and_b32 v19, 1, v16
    v_lshlrev_b32 v19, 4, v19
    v_add_u32 v19, 32, v19
    s_lshl_b32 s20, s12, 7
    v_add_u32 v8, s20, v19
    v_add_u32 v7, v8, v18
    v_lshlrev_b32 v18, 4, v17
    v_lshl_add_u32 v18, v16, 10, v18
    v_add_u32 v9, 256, v18
    v_add_u32 v18, 64, v0
    v_mul_u32_u24 v19, 2731, v18
    v_lshrrev_b32 v19, 16, v19
    v_mul_u32_u24 v20, 24, v19
    v_sub_u32 v20, v18, v20
    v_mul_u32_u24 v21, 400, v19
    v_lshl_add_u32 v21, v20, 4, v21
    v_add_u32 v10, 136320, v21
    v_lshlrev_b32 v21, 4, v19
    v_lshl_add_u32 v11, v20, 7, v21
    v_and_b32 v18, 0x28, v0
    v_cmp_eq_u32 vcc, 0, v18
    v_mov_b32 v18, 1.0
    v_mov_b32 v19, 0
    v_cndmask_b32 v12, v19, v18, vcc
    v_add_u32 v13, 30720, v1
    v_add_u32 v14, 122880, v1
    s_mul_i32 s44, s12, 12288
    s_add_u32 s44, s44, 53477376
    s_mul_i32 s45, s12, 3072
    s_add_u32 s45, s45, 208666624
    s_mul_i32 s20, s12, 6
    s_add_u32 s21, s20, 5
    s_lshr_b32 s20, s20, 3
    s_lshr_b32 s21, s21, 3
    s_add_u32 s20, s20, 80
    s_add_u32 s21, s21, 80
    s_lshl_b32 s20, s20, 7
    s_lshl_b32 s21, s21, 7
    v_mov_b32 v255, s21
    v_mov_b32 v253, s20
    v_cmp_eq_u32 vcc, 0, v0
    s_nop 1
    v_cndmask_b32 v255, v255, v253, vcc
    s_mov_b32 s47, 0
    s_mul_i32 s20, s12, 491520
    s_add_u32 s20, s20, 11657216
    s_add_u32 s21, s20, 0
    buffer_load_dwordx4 v[16:19], v1, s[8:11], s21 offen offset:0
    buffer_load_dwordx4 v[20:23], v1, s[8:11], s21 offen offset:1024
    s_add_u32 s21, s20, 40960
    buffer_load_dwordx4 v[24:27], v1, s[8:11], s21 offen offset:0
    buffer_load_dwordx4 v[28:31], v1, s[8:11], s21 offen offset:1024
    s_add_u32 s21, s20, 22528
    buffer_load_dwordx4 v[32:35], v1, s[8:11], s21 offen offset:0
    buffer_load_dwordx4 v[36:39], v1, s[8:11], s21 offen offset:1024
    s_add_u32 s21, s20, 4096
    buffer_load_dwordx4 v[40:43], v1, s[8:11], s21 offen offset:0
    buffer_load_dwordx4 v[44:47], v1, s[8:11], s21 offen offset:1024
    s_add_u32 s21, s20, 45056
    buffer_load_dwordx4 v[48:51], v1, s[8:11], s21 offen offset:0
    buffer_load_dwordx4 v[52:55], v1, s[8:11], s21 offen offset:1024
    s_add_u32 s21, s20, 32768
    buffer_load_dwordx4 v[56:59], v1, s[8:11], s21 offen offset:0
    buffer_load_dwordx4 v[60:63], v1, s[8:11], s21 offen offset:1024
    s_add_u32 s21, s20, 14336
    buffer_load_dwordx4 v[64:67], v1, s[8:11], s21 offen offset:0
    buffer_load_dwordx4 v[68:71], v1, s[8:11], s21 offen offset:1024
    s_add_u32 s21, s20, 55296
    buffer_load_dwordx4 v[72:75], v1, s[8:11], s21 offen offset:0
    buffer_load_dwordx4 v[76:79], v1, s[8:11], s21 offen offset:1024
    s_add_u32 s21, s20, 36864
    buffer_load_dwordx4 v[80:83], v1, s[8:11], s21 offen offset:0
    buffer_load_dwordx4 v[84:87], v1, s[8:11], s21 offen offset:1024
    s_add_u32 s21, s20, 18432
    buffer_load_dwordx4 v[88:91], v1, s[8:11], s21 offen offset:0
    buffer_load_dwordx4 v[92:95], v1, s[8:11], s21 offen offset:1024
    s_add_u32 s21, s20, 59392
    buffer_load_dwordx4 v[96:99], v1, s[8:11], s21 offen offset:0
    buffer_load_dwordx4 v[100:103], v1, s[8:11], s21 offen offset:1024
    s_add_u32 s21, s20, 90112
    buffer_load_dwordx4 v[104:107], v1, s[8:11], s21 offen offset:0
    buffer_load_dwordx4 v[108:111], v1, s[8:11], s21 offen offset:1024
    s_add_u32 s21, s20, 98304
    buffer_load_dwordx4 v[112:115], v1, s[8:11], s21 offen offset:0
    buffer_load_dwordx4 v[116:119], v1, s[8:11], s21 offen offset:1024
    s_add_u32 s21, s20, 106496
    buffer_load_dwordx4 v[120:123], v1, s[8:11], s21 offen offset:0
    buffer_load_dwordx4 v[124:127], v1, s[8:11], s21 offen offset:1024
    s_add_u32 s21, s20, 114688
    buffer_load_dwordx4 v[128:131], v1, s[8:11], s21 offen offset:0
    buffer_load_dwordx4 v[132:135], v1, s[8:11], s21 offen offset:1024
    s_add_u32 s21, s20, 6144
    buffer_load_dwordx4 a[0:3], v1, s[8:11], s21 offen offset:0
    buffer_load_dwordx4 a[4:7], v1, s[8:11], s21 offen offset:1024
    s_add_u32 s21, s20, 26624
    buffer_load_dwordx4 a[8:11], v1, s[8:11], s21 offen offset:0
    buffer_load_dwordx4 a[12:15], v1, s[8:11], s21 offen offset:1024
    s_add_u32 s21, s20, 47104
    buffer_load_dwordx4 a[16:19], v1, s[8:11], s21 offen offset:0
    buffer_load_dwordx4 a[20:23], v1, s[8:11], s21 offen offset:1024
    s_add_u32 s21, s20, 8192
    buffer_load_dwordx4 a[24:27], v1, s[8:11], s21 offen offset:0
    buffer_load_dwordx4 a[28:31], v1, s[8:11], s21 offen offset:1024
    s_add_u32 s21, s20, 28672
    buffer_load_dwordx4 a[32:35], v1, s[8:11], s21 offen offset:0
    buffer_load_dwordx4 a[36:39], v1, s[8:11], s21 offen offset:1024
    s_add_u32 s21, s20, 49152
    buffer_load_dwordx4 a[40:43], v1, s[8:11], s21 offen offset:0
    buffer_load_dwordx4 a[44:47], v1, s[8:11], s21 offen offset:1024
    s_add_u32 s21, s20, 10240
    buffer_load_dwordx4 a[48:51], v1, s[8:11], s21 offen offset:0
    buffer_load_dwordx4 a[52:55], v1, s[8:11], s21 offen offset:1024
    s_add_u32 s21, s20, 30720
    buffer_load_dwordx4 a[56:59], v1, s[8:11], s21 offen offset:0
    buffer_load_dwordx4 a[60:63], v1, s[8:11], s21 offen offset:1024
    s_add_u32 s21, s20, 51200
    buffer_load_dwordx4 a[64:67], v1, s[8:11], s21 offen offset:0
    buffer_load_dwordx4 a[68:71], v1, s[8:11], s21 offen offset:1024
    s_add_u32 s21, s20, 20480
    buffer_load_dwordx4 a[72:75], v1, s[8:11], s21 offen offset:0
    buffer_load_dwordx4 a[76:79], v1, s[8:11], s21 offen offset:1024
    s_add_u32 s21, s20, 2048
    buffer_load_dwordx4 a[80:83], v1, s[8:11], s21 offen offset:0
    buffer_load_dwordx4 a[84:87], v1, s[8:11], s21 offen offset:1024
    s_add_u32 s21, s20, 43008
    buffer_load_dwordx4 a[88:91], v1, s[8:11], s21 offen offset:0
    buffer_load_dwordx4 a[92:95], v1, s[8:11], s21 offen offset:1024
    s_add_u32 s21, s20, 24576
    buffer_load_dwordx4 a[96:99], v1, s[8:11], s21 offen offset:0
    buffer_load_dwordx4 a[100:103], v1, s[8:11], s21 offen offset:1024
    s_add_u32 s21, s20, 12288
    buffer_load_dwordx4 a[104:107], v1, s[8:11], s21 offen offset:0
    buffer_load_dwordx4 a[108:111], v1, s[8:11], s21 offen offset:1024
    s_add_u32 s21, s20, 53248
    buffer_load_dwordx4 a[112:115], v1, s[8:11], s21 offen offset:0
    buffer_load_dwordx4 a[116:119], v1, s[8:11], s21 offen offset:1024
    s_add_u32 s21, s20, 34816
    buffer_load_dwordx4 a[120:123], v1, s[8:11], s21 offen offset:0
    buffer_load_dwordx4 a[124:127], v1, s[8:11], s21 offen offset:1024
    s_waitcnt vmcnt(32)
    ds_write_b128 v13, v[16:19] offset:0
    ds_write_b128 v13, v[20:23] offset:1024
    ds_write_b128 v13, v[24:27] offset:2048
    ds_write_b128 v13, v[28:31] offset:3072
    ds_write_b128 v13, v[32:35] offset:4096
    ds_write_b128 v13, v[36:39] offset:5120
    ds_write_b128 v13, v[40:43] offset:6144
    ds_write_b128 v13, v[44:47] offset:7168
    ds_write_b128 v13, v[48:51] offset:8192
    ds_write_b128 v13, v[52:55] offset:9216
    ds_write_b128 v13, v[56:59] offset:10240
    ds_write_b128 v13, v[60:63] offset:11264
    ds_write_b128 v13, v[64:67] offset:12288
    ds_write_b128 v13, v[68:71] offset:13312
    ds_write_b128 v13, v[72:75] offset:14336
    ds_write_b128 v13, v[76:79] offset:15360
    ds_write_b128 v13, v[80:83] offset:16384
    ds_write_b128 v13, v[84:87] offset:17408
    ds_write_b128 v13, v[88:91] offset:18432
    ds_write_b128 v13, v[92:95] offset:19456
    ds_write_b128 v13, v[96:99] offset:20480
    ds_write_b128 v13, v[100:103] offset:21504
    ds_write_b128 v13, v[104:107] offset:22528
    ds_write_b128 v13, v[108:111] offset:23552
    ds_write_b128 v13, v[112:115] offset:24576
    ds_write_b128 v13, v[116:119] offset:25600
    ds_write_b128 v13, v[120:123] offset:26624
    ds_write_b128 v13, v[124:127] offset:27648
    ds_write_b128 v13, v[128:131] offset:28672
    ds_write_b128 v13, v[132:135] offset:29696
    s_add_u32 s21, s20, 16384
    buffer_load_dwordx4 a[128:131], v1, s[8:11], s21 offen offset:0
    buffer_load_dwordx4 a[132:135], v1, s[8:11], s21 offen offset:1024
    s_add_u32 s21, s20, 57344
    buffer_load_dwordx4 a[136:139], v1, s[8:11], s21 offen offset:0
    buffer_load_dwordx4 a[140:143], v1, s[8:11], s21 offen offset:1024
    s_add_u32 s21, s20, 38912
    buffer_load_dwordx4 a[144:147], v1, s[8:11], s21 offen offset:0
    buffer_load_dwordx4 a[148:151], v1, s[8:11], s21 offen offset:1024
    s_add_u32 s21, s20, 61440
    buffer_load_dwordx4 a[152:155], v1, s[8:11], s21 offen offset:0
    buffer_load_dwordx4 a[156:159], v1, s[8:11], s21 offen offset:1024
    s_add_u32 s21, s20, 63488
    buffer_load_dwordx4 a[160:163], v1, s[8:11], s21 offen offset:0
    buffer_load_dwordx4 a[164:167], v1, s[8:11], s21 offen offset:1024
    s_add_u32 s21, s20, 65536
    buffer_load_dwordx4 a[168:171], v1, s[8:11], s21 offen offset:0
    buffer_load_dwordx4 a[172:175], v1, s[8:11], s21 offen offset:1024
    s_add_u32 s21, s20, 67584
    buffer_load_dwordx4 a[176:179], v1, s[8:11], s21 offen offset:0
    buffer_load_dwordx4 a[180:183], v1, s[8:11], s21 offen offset:1024
    s_add_u32 s21, s20, 69632
    buffer_load_dwordx4 a[184:187], v1, s[8:11], s21 offen offset:0
    buffer_load_dwordx4 a[188:191], v1, s[8:11], s21 offen offset:1024
    s_add_u32 s21, s20, 71680
    buffer_load_dwordx4 a[192:195], v1, s[8:11], s21 offen offset:0
    buffer_load_dwordx4 a[196:199], v1, s[8:11], s21 offen offset:1024
    s_add_u32 s21, s20, 73728
    buffer_load_dwordx4 a[200:203], v1, s[8:11], s21 offen offset:0
    buffer_load_dwordx4 a[204:207], v1, s[8:11], s21 offen offset:1024
    s_add_u32 s21, s20, 75776
    buffer_load_dwordx4 a[208:211], v1, s[8:11], s21 offen offset:0
    buffer_load_dwordx4 a[212:215], v1, s[8:11], s21 offen offset:1024
    s_add_u32 s21, s20, 77824
    buffer_load_dwordx4 a[216:219], v1, s[8:11], s21 offen offset:0
    buffer_load_dwordx4 a[220:223], v1, s[8:11], s21 offen offset:1024
    s_add_u32 s21, s20, 79872
    buffer_load_dwordx4 a[224:227], v1, s[8:11], s21 offen offset:0
    buffer_load_dwordx4 a[228:231], v1, s[8:11], s21 offen offset:1024
    s_add_u32 s21, s20, 81920
    buffer_load_dwordx4 a[232:235], v1, s[8:11], s21 offen offset:0
    buffer_load_dwordx4 a[236:239], v1, s[8:11], s21 offen offset:1024
    s_add_u32 s21, s20, 83968
    buffer_load_dwordx4 a[240:243], v1, s[8:11], s21 offen offset:0
    buffer_load_dwordx4 a[244:247], v1, s[8:11], s21 offen offset:1024
    s_add_u32 s21, s20, 86016
    buffer_load_dwordx4 a[248:251], v1, s[8:11], s21 offen offset:0
    buffer_load_dwordx4 a[252:255], v1, s[8:11], s21 offen offset:1024
    s_add_u32 s21, s20, 88064
    buffer_load_dwordx4 v[148:151], v1, s[8:11], s21 offen offset:0
    buffer_load_dwordx4 v[152:155], v1, s[8:11], s21 offen offset:1024
    s_add_u32 s21, s20, 92160
    buffer_load_dwordx4 v[156:159], v1, s[8:11], s21 offen offset:0
    buffer_load_dwordx4 v[160:163], v1, s[8:11], s21 offen offset:1024
    s_add_u32 s21, s20, 94208
    buffer_load_dwordx4 v[164:167], v1, s[8:11], s21 offen offset:0
    buffer_load_dwordx4 v[168:171], v1, s[8:11], s21 offen offset:1024
    s_add_u32 s21, s20, 96256
    buffer_load_dwordx4 v[172:175], v1, s[8:11], s21 offen offset:0
    buffer_load_dwordx4 v[176:179], v1, s[8:11], s21 offen offset:1024
    s_add_u32 s21, s20, 100352
    buffer_load_dwordx4 v[180:183], v1, s[8:11], s21 offen offset:0
    buffer_load_dwordx4 v[184:187], v1, s[8:11], s21 offen offset:1024
    s_add_u32 s21, s20, 102400
    buffer_load_dwordx4 v[188:191], v1, s[8:11], s21 offen offset:0
    buffer_load_dwordx4 v[192:195], v1, s[8:11], s21 offen offset:1024
    s_add_u32 s21, s20, 104448
    buffer_load_dwordx4 v[196:199], v1, s[8:11], s21 offen offset:0
    buffer_load_dwordx4 v[200:203], v1, s[8:11], s21 offen offset:1024
    s_add_u32 s21, s20, 108544
    buffer_load_dwordx4 v[204:207], v1, s[8:11], s21 offen offset:0
    buffer_load_dwordx4 v[208:211], v1, s[8:11], s21 offen offset:1024
    s_add_u32 s21, s20, 110592
    buffer_load_dwordx4 v[212:215], v1, s[8:11], s21 offen offset:0
    buffer_load_dwordx4 v[216:219], v1, s[8:11], s21 offen offset:1024
    s_add_u32 s21, s20, 112640
    buffer_load_dwordx4 v[220:223], v1, s[8:11], s21 offen offset:0
    buffer_load_dwordx4 v[224:227], v1, s[8:11], s21 offen offset:1024
    s_add_u32 s21, s20, 116736
    buffer_load_dwordx4 v[228:231], v1, s[8:11], s21 offen offset:0
    buffer_load_dwordx4 v[232:235], v1, s[8:11], s21 offen offset:1024
    s_add_u32 s21, s20, 118784
    buffer_load_dwordx4 v[236:239], v1, s[8:11], s21 offen offset:0
    buffer_load_dwordx4 v[240:243], v1, s[8:11], s21 offen offset:1024
    s_add_u32 s21, s20, 120832
    buffer_load_dwordx4 v[244:247], v1, s[8:11], s21 offen offset:0
    buffer_load_dwordx4 v[248:251], v1, s[8:11], s21 offen offset:1024
    s_waitcnt lgkmcnt(0)
    s_mov_b32 s14, 0
    s_cmp_gt_u32 s47, s14
    s_cbranch_scc1 layerb1_kernel_p1_gw1_ok
layerb1_kernel_p1_gw1_lp:
    buffer_load_dword v253, v255, s[8:11], s48 offen sc1
    s_waitcnt vmcnt(0)
    v_readlane_b32 s47, v253, 0
    v_readlane_b32 s29, v253, 1
    s_nop 0
    s_min_u32 s47, s47, s29
    s_sub_u32 s15, s15, 1
    s_cbranch_scc1 layerb1_kernel_bail
    s_cmp_gt_u32 s47, s14
    s_cbranch_scc0 layerb1_kernel_p1_gw1_lp
layerb1_kernel_p1_gw1_ok:
    s_mul_i32 s20, s14, 393216
    s_add_u32 s20, s20, s44
    s_add_u32 s21, s20, 0
    buffer_load_dwordx4 v[100:103], v9, s[8:11], s21 offen offset:0 sc1
    buffer_load_dwordx4 v[104:107], v9, s[8:11], s21 offen offset:512 sc1
    s_add_u32 s21, s20, 4096
    buffer_load_dwordx4 v[108:111], v9, s[8:11], s21 offen offset:0 sc1
    buffer_load_dwordx4 v[112:115], v9, s[8:11], s21 offen offset:512 sc1
    v_mov_b32 v56, 0
    v_mov_b32 v57, 0
    v_mov_b32 v58, 0
    v_mov_b32 v59, 0
    v_mov_b32 v60, 0
    v_mov_b32 v61, 0
    v_mov_b32 v62, 0
    v_mov_b32 v63, 0
    v_mov_b32 v64, 0
    v_mov_b32 v65, 0
    v_mov_b32 v66, 0
    v_mov_b32 v67, 0
    v_mov_b32 v68, 0
    v_mov_b32 v69, 0
    v_mov_b32 v70, 0
    v_mov_b32 v71, 0
    v_mov_b32 v72, 0
    v_mov_b32 v73, 0
    v_mov_b32 v74, 0
    v_mov_b32 v75, 0
    v_mov_b32 v76, 0
    v_mov_b32 v77, 0
    v_mov_b32 v78, 0
    v_mov_b32 v79, 0
    v_mov_b32 v80, 0
    v_mov_b32 v81, 0
    v_mov_b32 v82, 0
    v_mov_b32 v83, 0
    v_mov_b32 v84, 0
    v_mov_b32 v85, 0
    v_mov_b32 v86, 0
    v_mov_b32 v87, 0
    ds_read_b128 v[116:119], v13 offset:0
    ds_read_b128 v[120:123], v13 offset:1024
    ds_read_b128 v[124:127], v13 offset:2048
    ds_read_b128 v[128:131], v13 offset:3072
    ds_read_b128 v[132:135], v13 offset:4096
    ds_read_b128 v[136:139], v13 offset:5120
    ds_read_b128 v[140:143], v13 offset:6144
    ds_read_b128 v[144:147], v13 offset:7168
    s_waitcnt lgkmcnt(0)
layerb1_kernel_p1_step:
    s_cmp_lt_u32 s14, 32
    s_cselect_b32 s18, s16, s17
    s_and_b32 s20, s14, 31
    s_lshl_b32 s20, s20, 16
    s_add_u32 s18, s18, s20
    s_add_u32 s22, s18, 39936
    s_add_u32 s23, s18, 49152
    s_add_u32 s24, s18, 50176
layerb1_kernel_p1_poll:
    buffer_load_dwordx4 v[28:31], v1, s[8:11], s22 offen sc1
    buffer_load_dwordx4 v[32:35], v1, s[8:11], s23 offen sc1
    buffer_load_dwordx4 v[36:39], v1, s[8:11], s24 offen sc1
    s_waitcnt vmcnt(0)
    ds_write_b128 v14, v[28:31] offset:3072
    ds_write_b128 v14, v[32:35] offset:4096
    ds_write_b128 v14, v[36:39] offset:5120
    v_max3_u32 v88, v28, v29, v30
    v_max3_u32 v88, v88, v31, v32
    v_max3_u32 v88, v88, v33, v34
    v_max3_u32 v88, v88, v35, v36
    v_max3_u32 v88, v88, v37, v38
    v_max_u32 v88, v88, v39
    v_cmp_eq_u32 vcc, -1, v88
    s_sub_u32 s15, s15, 1
    s_cbranch_scc1 layerb1_kernel_bail
    s_cbranch_vccnz layerb1_kernel_p1_poll
    s_waitcnt lgkmcnt(0)
    s_barrier
    ds_read_b128 v[16:19], v14 offset:0
    ds_read_b128 v[20:23], v14 offset:1024
    ds_read_b128 v[24:27], v14 offset:2048
    ds_read_b128 v[40:43], v14 offset:6144
    ds_read_b128 v[44:47], v14 offset:7168
    ds_read_b128 v[48:51], v14 offset:8192
    ds_read_b128 v[52:55], v14 offset:9216
    v_smfmac_f32_16x16x64_bf16 v[56:59], v[28:31], a[0:7], v2
    v_smfmac_f32_16x16x64_bf16 v[60:63], v[28:31], a[8:15], v2
    v_smfmac_f32_16x16x64_bf16 v[64:67], v[28:31], a[16:23], v2
    v_smfmac_f32_16x16x64_bf16 v[56:59], v[32:35], a[24:31], v2
    v_smfmac_f32_16x16x64_bf16 v[60:63], v[32:35], a[32:39], v2
    v_smfmac_f32_16x16x64_bf16 v[64:67], v[32:35], a[40:47], v2
    v_smfmac_f32_16x16x64_bf16 v[56:59], v[36:39], a[48:55], v2
    v_smfmac_f32_16x16x64_bf16 v[60:63], v[36:39], a[56:63], v2
    v_smfmac_f32_16x16x64_bf16 v[64:67], v[36:39], a[64:71], v2
    s_waitcnt lgkmcnt(6)
    v_smfmac_f32_16x16x64_bf16 v[56:59], v[16:19], v[116:123], v2
    ds_read_b128 v[116:119], v13 offset:8192
    ds_read_b128 v[120:123], v13 offset:9216
    v_smfmac_f32_16x16x64_bf16 v[60:63], v[16:19], a[72:79], v2
    v_smfmac_f32_16x16x64_bf16 v[64:67], v[16:19], v[124:131], v2
    ds_read_b128 v[124:127], v13 offset:10240
    ds_read_b128 v[128:131], v13 offset:11264
    s_waitcnt lgkmcnt(9)
    v_smfmac_f32_16x16x64_bf16 v[56:59], v[20:23], a[80:87], v2
    v_smfmac_f32_16x16x64_bf16 v[60:63], v[20:23], v[132:139], v2
    ds_read_b128 v[132:135], v13 offset:12288
    ds_read_b128 v[136:139], v13 offset:13312
    v_smfmac_f32_16x16x64_bf16 v[64:67], v[20:23], a[88:95], v2
    s_waitcnt lgkmcnt(10)
    v_smfmac_f32_16x16x64_bf16 v[56:59], v[24:27], v[140:147], v2
    ds_read_b128 v[140:143], v13 offset:14336
    ds_read_b128 v[144:147], v13 offset:15360
    v_smfmac_f32_16x16x64_bf16 v[60:63], v[24:27], a[96:103], v2
    s_waitcnt lgkmcnt(6)
    v_smfmac_f32_16x16x64_bf16 v[64:67], v[24:27], v[116:123], v2
    ds_read_b128 v[116:119], v13 offset:16384
    ds_read_b128 v[120:123], v13 offset:17408
    v_smfmac_f32_16x16x64_bf16 v[56:59], v[40:43], a[104:111], v2
    s_waitcnt lgkmcnt(6)
    v_smfmac_f32_16x16x64_bf16 v[60:63], v[40:43], v[124:131], v2
    ds_read_b128 v[124:127], v13 offset:18432
    ds_read_b128 v[128:131], v13 offset:19456
    v_smfmac_f32_16x16x64_bf16 v[64:67], v[40:43], a[112:119], v2
    s_waitcnt lgkmcnt(6)
    v_smfmac_f32_16x16x64_bf16 v[56:59], v[44:47], v[132:139], v2
    ds_read_b128 v[132:135], v13 offset:20480
    ds_read_b128 v[136:139], v13 offset:21504
    v_smfmac_f32_16x16x64_bf16 v[60:63], v[44:47], a[120:127], v2
    s_waitcnt lgkmcnt(6)
    v_smfmac_f32_16x16x64_bf16 v[64:67], v[44:47], v[140:147], v2
    ds_read_b128 v[140:143], v13 offset:22528
    ds_read_b128 v[144:147], v13 offset:23552
    v_smfmac_f32_16x16x64_bf16 v[56:59], v[48:51], a[128:135], v2
    s_waitcnt lgkmcnt(6)
    v_smfmac_f32_16x16x64_bf16 v[60:63], v[48:51], v[116:123], v2
    ds_read_b128 v[116:119], v13 offset:24576
    ds_read_b128 v[120:123], v13 offset:25600
    v_smfmac_f32_16x16x64_bf16 v[64:67], v[48:51], a[136:143], v2
    s_waitcnt lgkmcnt(6)
    v_smfmac_f32_16x16x64_bf16 v[56:59], v[52:55], v[124:131], v2
    ds_read_b128 v[124:127], v13 offset:26624
    ds_read_b128 v[128:131], v13 offset:27648
    v_smfmac_f32_16x16x64_bf16 v[60:63], v[52:55], a[144:151], v2
    s_waitcnt lgkmcnt(6)
    v_smfmac_f32_16x16x64_bf16 v[64:67], v[52:55], v[132:139], v2
    ds_read_b128 v[132:135], v13 offset:28672
    ds_read_b128 v[136:139], v13 offset:29696
    v_smfmac_f32_16x16x64_bf16 v[68:71], v[16:19], a[152:159], v2
    v_smfmac_f32_16x16x64_bf16 v[68:71], v[20:23], a[160:167], v2
    v_permlane32_swap_b32 v56, v58
    v_permlane32_swap_b32 v57, v59
    v_smfmac_f32_16x16x64_bf16 v[68:71], v[24:27], a[168:175], v2
    v_add_f32 v56, v56, v58
    v_add_f32 v57, v57, v59
    v_smfmac_f32_16x16x64_bf16 v[68:71], v[28:31], a[176:183], v2
    v_cvt_pk_bf16_f32 v56, v56, v57
    ds_write_b16 v3, v56 offset:0
    v_smfmac_f32_16x16x64_bf16 v[68:71], v[32:35], a[184:191], v2
    ds_write_b16_d16_hi v3, v56 offset:400
    v_permlane32_swap_b32 v60, v62
    v_smfmac_f32_16x16x64_bf16 v[68:71], v[36:39], a[192:199], v2
    v_permlane32_swap_b32 v61, v63
    v_add_f32 v60, v60, v62
    v_smfmac_f32_16x16x64_bf16 v[68:71], v[40:43], a[200:207], v2
    v_add_f32 v61, v61, v63
    v_cvt_pk_bf16_f32 v60, v60, v61
    v_smfmac_f32_16x16x64_bf16 v[68:71], v[44:47], a[208:215], v2
    ds_write_b16 v3, v60 offset:32
    ds_write_b16_d16_hi v3, v60 offset:432
    v_smfmac_f32_16x16x64_bf16 v[68:71], v[48:51], a[216:223], v2
    v_permlane32_swap_b32 v64, v66
    v_permlane32_swap_b32 v65, v67
    v_smfmac_f32_16x16x64_bf16 v[68:71], v[52:55], a[224:231], v2
    v_add_f32 v64, v64, v66
    v_add_f32 v65, v65, v67
    v_smfmac_f32_16x16x64_bf16 v[72:75], v[16:19], a[232:239], v2
    v_cvt_pk_bf16_f32 v64, v64, v65
    ds_write_b16 v3, v64 offset:64
    v_smfmac_f32_16x16x64_bf16 v[72:75], v[20:23], a[240:247], v2
    ds_write_b16_d16_hi v3, v64 offset:464
    v_smfmac_f32_16x16x64_bf16 v[72:75], v[24:27], a[248:255], v2
    v_smfmac_f32_16x16x64_bf16 v[72:75], v[28:31], v[148:155], v2
    s_waitcnt lgkmcnt(0)
    s_barrier
    ds_read_b128 v[88:91], v4 offset:0
    v_smfmac_f32_16x16x64_bf16 v[72:75], v[32:35], v[140:147], v2
    ds_read_b128 v[92:95], v4 offset:128
    ds_read_b128 v[96:99], v4 offset:256
    v_smfmac_f32_16x16x64_bf16 v[72:75], v[36:39], v[156:163], v2
    v_permlane32_swap_b32 v68, v70
    v_permlane32_swap_b32 v69, v71
    v_smfmac_f32_16x16x64_bf16 v[72:75], v[40:43], v[164:171], v2
    v_add_f32 v68, v68, v70
    v_add_f32 v69, v69, v71
    v_smfmac_f32_16x16x64_bf16 v[72:75], v[44:47], v[172:179], v2
    v_cvt_pk_bf16_f32 v68, v68, v69
    ds_write_b16 v3, v68 offset:3200
    v_smfmac_f32_16x16x64_bf16 v[72:75], v[48:51], v[116:123], v2
    ds_write_b16_d16_hi v3, v68 offset:3600
    v_smfmac_f32_16x16x64_bf16 v[72:75], v[52:55], v[180:187], v2
    s_waitcnt lgkmcnt(2)
    v_smfmac_f32_16x16x64_bf16 v[80:83], v[88:91], v[100:107], v2
    v_smfmac_f32_16x16x64_bf16 v[80:83], v[92:95], v[108:115], v2
    v_smfmac_f32_16x16x64_bf16 v[76:79], v[16:19], v[188:195], v2
    v_smfmac_f32_16x16x64_bf16 v[76:79], v[20:23], v[196:203], v2
    v_smfmac_f32_16x16x64_bf16 v[76:79], v[24:27], v[124:131], v2
    v_permlane32_swap_b32 v72, v74
    v_permlane32_swap_b32 v73, v75
    v_smfmac_f32_16x16x64_bf16 v[76:79], v[28:31], v[204:211], v2
    v_add_f32 v72, v72, v74
    v_add_f32 v73, v73, v75
    ds_write_b128 v15, v[80:83]
    v_smfmac_f32_16x16x64_bf16 v[76:79], v[32:35], v[212:219], v2
    v_cvt_pk_bf16_f32 v72, v72, v73
    ds_write_b16 v3, v72 offset:3232
    v_smfmac_f32_16x16x64_bf16 v[76:79], v[36:39], v[220:227], v2
    ds_write_b16_d16_hi v3, v72 offset:3632
    v_smfmac_f32_16x16x64_bf16 v[76:79], v[40:43], v[132:139], v2
    v_smfmac_f32_16x16x64_bf16 v[76:79], v[44:47], v[228:235], v2
    v_smfmac_f32_16x16x64_bf16 v[76:79], v[48:51], v[236:243], v2
    v_smfmac_f32_16x16x64_bf16 v[76:79], v[52:55], v[244:251], v2
    s_nop 7
    v_permlane32_swap_b32 v76, v78
    v_permlane32_swap_b32 v77, v79
    v_add_f32 v76, v76, v78
    v_add_f32 v77, v77, v79
    v_cvt_pk_bf16_f32 v76, v76, v77
    ds_write_b16 v3, v76 offset:3264
    ds_write_b16_d16_hi v3, v76 offset:3664
    s_waitcnt lgkmcnt(0)
    s_barrier
    ds_read2st64_b32 v[40:41], v6 offset0:0 offset1:2
    ds_read2st64_b32 v[42:43], v6 offset0:8 offset1:10
    ds_read_b128 v[16:19], v5 offset:0
    ds_read_b128 v[20:23], v5 offset:16
    ds_read_b128 v[24:27], v5 offset:128
    ds_read_b128 v[28:31], v5 offset:144
    ds_read_b128 v[32:35], v5 offset:256
    ds_read_b128 v[36:39], v5 offset:272
    s_waitcnt lgkmcnt(6)
    v_add_f32 v40, v40, v41
    v_add_f32 v42, v42, v43
    v_add_f32 v44, v40, v42
    v_mul_f32 v44, 0x3dd53b95, v44
    s_waitcnt lgkmcnt(4)
    v_smfmac_f32_16x16x64_bf16 v[84:87], v[88:91], v[16:23], v2
    s_waitcnt lgkmcnt(2)
    v_smfmac_f32_16x16x64_bf16 v[84:87], v[92:95], v[24:31], v2
    s_waitcnt lgkmcnt(0)
    v_smfmac_f32_16x16x64_bf16 v[84:87], v[96:99], v[32:39], v2
    v_max_f32_dpp v45, v44, v44 row_ror:8 row_mask:0xf bank_mask:0xf
    s_nop 1
    v_max_f32_dpp v45, v45, v45 row_ror:4 row_mask:0xf bank_mask:0xf
    s_nop 1
    v_max_f32_dpp v45, v45, v45 row_ror:2 row_mask:0xf bank_mask:0xf
    s_nop 1
    v_max_f32_dpp v45, v45, v45 row_ror:1 row_mask:0xf bank_mask:0xf
    v_mov_b32 v47, v45
    s_nop 1
    v_permlane32_swap_b32 v45, v47
    v_max_f32 v45, v45, v47
    v_mov_b32 v47, v85
    s_nop 1
    v_permlane32_swap_b32 v85, v47
    v_add_f32 v48, v85, v47
    v_mul_f32 v48, 0x3dd53b95, v48
    s_nop 1
    v_max_f32_dpp v46, v48, v48 row_ror:4 row_mask:0xf bank_mask:0xf
    s_nop 1
    v_max_f32_dpp v46, v46, v46 row_ror:2 row_mask:0xf bank_mask:0xf
    s_nop 1
    v_max_f32_dpp v46, v46, v46 row_ror:1 row_mask:0xf bank_mask:0xf
    v_max_f32 v45, v45, v46
    v_sub_f32 v49, v44, v45
    v_sub_f32 v50, v48, v45
    v_exp_f32 v49, v49
    v_exp_f32 v50, v50
    s_nop 0
    v_fma_f32 v51, v50, v12, v49
    s_nop 1
    v_add_f32_dpp v51, v51, v51 row_ror:8 row_mask:0xf bank_mask:0xf
    s_nop 1
    v_add_f32_dpp v51, v51, v51 row_ror:4 row_mask:0xf bank_mask:0xf
    s_nop 1
    v_add_f32_dpp v51, v51, v51 row_ror:2 row_mask:0xf bank_mask:0xf
    s_nop 1
    v_add_f32_dpp v51, v51, v51 row_ror:1 row_mask:0xf bank_mask:0xf
    v_mov_b32 v47, v51
    s_nop 1
    v_permlane32_swap_b32 v51, v47
    v_add_f32 v51, v51, v47
    v_rcp_f32 v51, v51
    s_nop 0
    v_mul_f32 v49, v49, v51
    v_mul_f32 v50, v50, v51
    s_nop 0
    v_mov_b32_dpp v46, v49 quad_perm:[1,0,3,2] row_mask:0xf bank_mask:0xf
    v_mov_b32_dpp v47, v50 quad_perm:[1,0,3,2] row_mask:0xf bank_mask:0xf
    v_cvt_pk_bf16_f32 v16, v49, v46
    v_cvt_pk_bf16_f32 v20, v50, v47
    s_nop 0
    v_mov_b32_dpp v17, v16 row_shl:2 row_mask:0xf bank_mask:0xf
    v_mov_b32_dpp v18, v16 row_shl:4 row_mask:0xf bank_mask:0xf
    v_mov_b32_dpp v19, v16 row_shl:6 row_mask:0xf bank_mask:0xf
    v_mov_b32_dpp v21, v20 row_shl:2 row_mask:0xf bank_mask:0xf
    v_mov_b32_dpp v22, v20 row_shl:4 row_mask:0xf bank_mask:0xf
    v_mov_b32_dpp v23, v20 row_shl:6 row_mask:0xf bank_mask:0xf
    s_mov_b64 exec, s[40:41]
    buffer_store_dwordx4 v[16:19], v7, s[8:11], s18 offen sc1
    s_mov_b64 exec, s[42:43]
    buffer_store_dwordx4 v[20:23], v8, s[8:11], s18 offen sc1
    s_mov_b64 exec, -1
    ds_read_b128 v[40:43], v10
    s_add_u32 s28, s14, 1
    s_min_u32 s28, s28, 63
    s_cmp_gt_u32 s47, s28
    s_cbranch_scc1 layerb1_kernel_p1_gw2_ok
layerb1_kernel_p1_gw2_lp:
    buffer_load_dword v253, v255, s[8:11], s48 offen sc1
    s_waitcnt vmcnt(0)
    v_readlane_b32 s47, v253, 0
    v_readlane_b32 s29, v253, 1
    s_nop 0
    s_min_u32 s47, s47, s29
    s_sub_u32 s15, s15, 1
    s_cbranch_scc1 layerb1_kernel_bail
    s_cmp_gt_u32 s47, s28
    s_cbranch_scc0 layerb1_kernel_p1_gw2_lp
layerb1_kernel_p1_gw2_ok:
    s_mul_i32 s20, s28, 393216
    s_add_u32 s20, s20, s44
    s_add_u32 s21, s20, 0
    buffer_load_dwordx4 v[100:103], v9, s[8:11], s21 offen offset:0 sc1
    buffer_load_dwordx4 v[104:107], v9, s[8:11], s21 offen offset:512 sc1
    s_add_u32 s21, s20, 4096
    buffer_load_dwordx4 v[108:111], v9, s[8:11], s21 offen offset:0 sc1
    buffer_load_dwordx4 v[112:115], v9, s[8:11], s21 offen offset:512 sc1
    v_mov_b32 v56, 0
    v_mov_b32 v57, 0
    v_mov_b32 v58, 0
    v_mov_b32 v59, 0
    v_mov_b32 v60, 0
    v_mov_b32 v61, 0
    v_mov_b32 v62, 0
    v_mov_b32 v63, 0
    v_mov_b32 v64, 0
    v_mov_b32 v65, 0
    v_mov_b32 v66, 0
    v_mov_b32 v67, 0
    v_mov_b32 v68, 0
    v_mov_b32 v69, 0
    v_mov_b32 v70, 0
    v_mov_b32 v71, 0
    v_mov_b32 v72, 0
    v_mov_b32 v73, 0
    v_mov_b32 v74, 0
    v_mov_b32 v75, 0
    v_mov_b32 v76, 0
    v_mov_b32 v77, 0
    v_mov_b32 v78, 0
    v_mov_b32 v79, 0
    v_mov_b32 v80, 0
    v_mov_b32 v81, 0
    v_mov_b32 v82, 0
    v_mov_b32 v83, 0
    v_mov_b32 v84, 0
    v_mov_b32 v85, 0
    v_mov_b32 v86, 0
    v_mov_b32 v87, 0
    s_waitcnt lgkmcnt(0)
    s_mul_i32 s20, s14, 98304
    s_add_u32 s20, s20, s45
    buffer_store_dwordx4 v[40:43], v11, s[8:11], s20 offen sc1
    ds_read_b128 v[116:119], v13 offset:0
    ds_read_b128 v[120:123], v13 offset:1024
    ds_read_b128 v[124:127], v13 offset:2048
    ds_read_b128 v[128:131], v13 offset:3072
    ds_read_b128 v[132:135], v13 offset:4096
    ds_read_b128 v[136:139], v13 offset:5120
    ds_read_b128 v[140:143], v13 offset:6144
    ds_read_b128 v[144:147], v13 offset:7168
    s_waitcnt lgkmcnt(0)
    s_add_u32 s14, s14, 1
    s_cmp_lt_u32 s14, 64
    s_cbranch_scc1 layerb1_kernel_p1_step
    s_waitcnt vmcnt(0)
    s_barrier
    s_branch layerb1_kernel_end
layerb1_kernel_p2_start:
    v_lshrrev_b32 v16, 4, v0
    v_and_b32 v17, 15, v0
    v_and_b32 v18, 1, v16
    v_lshlrev_b32 v18, 2, v18
    v_lshrrev_b32 v19, 1, v16
    v_lshl_add_u32 v18, v19, 1, v18
    v_mul_u32_u24 v18, 400, v18
    v_lshl_add_u32 v18, v17, 1, v18
    v_add_u32 v3, 133312, v18
    v_and_b32 v18, 7, v0
    v_mul_u32_u24 v18, 400, v18
    v_lshrrev_b32 v19, 3, v0
    v_lshl_add_u32 v18, v19, 4, v18
    v_add_u32 v4, 133120, v18
    v_and_b32 v18, 7, v0
    v_mul_u32_u24 v18, 400, v18
    v_lshl_add_u32 v18, v16, 5, v18
    v_add_u32 v5, 136320, v18
    v_lshrrev_b32 v18, 1, v16
    v_lshlrev_b32 v18, 10, v18
    v_and_b32 v19, 31, v0
    v_lshl_add_u32 v18, v19, 4, v18
    v_add_u32 v6, 139528, v18
    v_add_u32 v15, 141568, v1
    v_lshrrev_b32 v18, 1, v16
    v_lshlrev_b32 v18, 1, v18
    v_lshrrev_b32 v19, 3, v17
    v_add3_u32 v18, v18, v19, 1
    v_lshrrev_b32 v19, 1, v18
    v_lshlrev_b32 v19, 14, v19
    v_and_b32 v18, 1, v18
    v_lshl_add_u32 v18, v18, 12, v19
    v_and_b32 v19, 1, v16
    v_lshlrev_b32 v19, 4, v19
    v_add_u32 v19, 64, v19
    s_lshl_b32 s20, s12, 7
    v_add_u32 v8, s20, v19
    v_add_u32 v7, v8, v18
    v_lshlrev_b32 v18, 4, v17
    v_lshl_add_u32 v18, v16, 10, v18
    v_add_u32 v9, 0, v18
    v_add_u32 v18, 128, v0
    v_mul_u32_u24 v19, 2731, v18
    v_lshrrev_b32 v19, 16, v19
    v_mul_u32_u24 v20, 24, v19
    v_sub_u32 v20, v18, v20
    v_mul_u32_u24 v21, 400, v19
    v_lshl_add_u32 v21, v20, 4, v21
    v_add_u32 v10, 136320, v21
    v_lshlrev_b32 v21, 4, v19
    v_lshl_add_u32 v11, v20, 7, v21
    v_and_b32 v18, 0x28, v0
    v_cmp_eq_u32 vcc, 0, v18
    v_mov_b32 v18, 1.0
    v_mov_b32 v19, 0
    v_cndmask_b32 v12, v19, v18, vcc
    v_add_u32 v13, 61440, v1
    v_add_u32 v14, 122880, v1
    s_mul_i32 s44, s12, 12288
    s_add_u32 s44, s44, 53477376
    s_mul_i32 s45, s12, 3072
    s_add_u32 s45, s45, 208666624
    s_mul_i32 s20, s12, 6
    s_add_u32 s21, s20, 5
    s_lshr_b32 s20, s20, 3
    s_lshr_b32 s21, s21, 3
    s_add_u32 s20, s20, 80
    s_add_u32 s21, s21, 80
    s_lshl_b32 s20, s20, 7
    s_lshl_b32 s21, s21, 7
    v_mov_b32 v255, s21
    v_mov_b32 v253, s20
    v_cmp_eq_u32 vcc, 0, v0
    s_nop 1
    v_cndmask_b32 v255, v255, v253, vcc
    s_mov_b32 s47, 0
    s_mul_i32 s20, s12, 491520
    s_add_u32 s20, s20, 11780096
    s_add_u32 s21, s20, 2048
    buffer_load_dwordx4 v[16:19], v1, s[8:11], s21 offen offset:0
    buffer_load_dwordx4 v[20:23], v1, s[8:11], s21 offen offset:1024
    s_add_u32 s21, s20, 43008
    buffer_load_dwordx4 v[24:27], v1, s[8:11], s21 offen offset:0
    buffer_load_dwordx4 v[28:31], v1, s[8:11], s21 offen offset:1024
    s_add_u32 s21, s20, 24576
    buffer_load_dwordx4 v[32:35], v1, s[8:11], s21 offen offset:0
    buffer_load_dwordx4 v[36:39], v1, s[8:11], s21 offen offset:1024
    s_add_u32 s21, s20, 6144
    buffer_load_dwordx4 v[40:43], v1, s[8:11], s21 offen offset:0
    buffer_load_dwordx4 v[44:47], v1, s[8:11], s21 offen offset:1024
    s_add_u32 s21, s20, 47104
    buffer_load_dwordx4 v[48:51], v1, s[8:11], s21 offen offset:0
    buffer_load_dwordx4 v[52:55], v1, s[8:11], s21 offen offset:1024
    s_add_u32 s21, s20, 28672
    buffer_load_dwordx4 v[56:59], v1, s[8:11], s21 offen offset:0
    buffer_load_dwordx4 v[60:63], v1, s[8:11], s21 offen offset:1024
    s_add_u32 s21, s20, 10240
    buffer_load_dwordx4 v[64:67], v1, s[8:11], s21 offen offset:0
    buffer_load_dwordx4 v[68:71], v1, s[8:11], s21 offen offset:1024
    s_add_u32 s21, s20, 51200
    buffer_load_dwordx4 v[72:75], v1, s[8:11], s21 offen offset:0
    buffer_load_dwordx4 v[76:79], v1, s[8:11], s21 offen offset:1024
    s_add_u32 s21, s20, 36864
    buffer_load_dwordx4 v[80:83], v1, s[8:11], s21 offen offset:0
    buffer_load_dwordx4 v[84:87], v1, s[8:11], s21 offen offset:1024
    s_add_u32 s21, s20, 18432
    buffer_load_dwordx4 v[88:91], v1, s[8:11], s21 offen offset:0
    buffer_load_dwordx4 v[92:95], v1, s[8:11], s21 offen offset:1024
    s_add_u32 s21, s20, 59392
    buffer_load_dwordx4 v[96:99], v1, s[8:11], s21 offen offset:0
    buffer_load_dwordx4 v[100:103], v1, s[8:11], s21 offen offset:1024
    s_add_u32 s21, s20, 90112
    buffer_load_dwordx4 v[104:107], v1, s[8:11], s21 offen offset:0
    buffer_load_dwordx4 v[108:111], v1, s[8:11], s21 offen offset:1024
    s_add_u32 s21, s20, 98304
    buffer_load_dwordx4 v[112:115], v1, s[8:11], s21 offen offset:0
    buffer_load_dwordx4 v[116:119], v1, s[8:11], s21 offen offset:1024
    s_add_u32 s21, s20, 106496
    buffer_load_dwordx4 v[120:123], v1, s[8:11], s21 offen offset:0
    buffer_load_dwordx4 v[124:127], v1, s[8:11], s21 offen offset:1024
    s_add_u32 s21, s20, 114688
    buffer_load_dwordx4 v[128:131], v1, s[8:11], s21 offen offset:0
    buffer_load_dwordx4 v[132:135], v1, s[8:11], s21 offen offset:1024
    s_add_u32 s21, s20, 12288
    buffer_load_dwordx4 a[0:3], v1, s[8:11], s21 offen offset:0
    buffer_load_dwordx4 a[4:7], v1, s[8:11], s21 offen offset:1024
    s_add_u32 s21, s20, 32768
    buffer_load_dwordx4 a[8:11], v1, s[8:11], s21 offen offset:0
    buffer_load_dwordx4 a[12:15], v1, s[8:11], s21 offen offset:1024
    s_add_u32 s21, s20, 53248
    buffer_load_dwordx4 a[16:19], v1, s[8:11], s21 offen offset:0
    buffer_load_dwordx4 a[20:23], v1, s[8:11], s21 offen offset:1024
    s_add_u32 s21, s20, 14336
    buffer_load_dwordx4 a[24:27], v1, s[8:11], s21 offen offset:0
    buffer_load_dwordx4 a[28:31], v1, s[8:11], s21 offen offset:1024
    s_add_u32 s21, s20, 34816
    buffer_load_dwordx4 a[32:35], v1, s[8:11], s21 offen offset:0
    buffer_load_dwordx4 a[36:39], v1, s[8:11], s21 offen offset:1024
    s_add_u32 s21, s20, 55296
    buffer_load_dwordx4 a[40:43], v1, s[8:11], s21 offen offset:0
    buffer_load_dwordx4 a[44:47], v1, s[8:11], s21 offen offset:1024
    s_add_u32 s21, s20, 0
    buffer_load_dwordx4 a[48:51], v1, s[8:11], s21 offen offset:0
    buffer_load_dwordx4 a[52:55], v1, s[8:11], s21 offen offset:1024
    s_add_u32 s21, s20, 20480
    buffer_load_dwordx4 a[56:59], v1, s[8:11], s21 offen offset:0
    buffer_load_dwordx4 a[60:63], v1, s[8:11], s21 offen offset:1024
    s_add_u32 s21, s20, 40960
    buffer_load_dwordx4 a[64:67], v1, s[8:11], s21 offen offset:0
    buffer_load_dwordx4 a[68:71], v1, s[8:11], s21 offen offset:1024
    s_add_u32 s21, s20, 22528
    buffer_load_dwordx4 a[72:75], v1, s[8:11], s21 offen offset:0
    buffer_load_dwordx4 a[76:79], v1, s[8:11], s21 offen offset:1024
    s_add_u32 s21, s20, 4096
    buffer_load_dwordx4 a[80:83], v1, s[8:11], s21 offen offset:0
    buffer_load_dwordx4 a[84:87], v1, s[8:11], s21 offen offset:1024
    s_add_u32 s21, s20, 45056
    buffer_load_dwordx4 a[88:91], v1, s[8:11], s21 offen offset:0
    buffer_load_dwordx4 a[92:95], v1, s[8:11], s21 offen offset:1024
    s_add_u32 s21, s20, 26624
    buffer_load_dwordx4 a[96:99], v1, s[8:11], s21 offen offset:0
    buffer_load_dwordx4 a[100:103], v1, s[8:11], s21 offen offset:1024
    s_add_u32 s21, s20, 8192
    buffer_load_dwordx4 a[104:107], v1, s[8:11], s21 offen offset:0
    buffer_load_dwordx4 a[108:111], v1, s[8:11], s21 offen offset:1024
    s_add_u32 s21, s20, 49152
    buffer_load_dwordx4 a[112:115], v1, s[8:11], s21 offen offset:0
    buffer_load_dwordx4 a[116:119], v1, s[8:11], s21 offen offset:1024
    s_add_u32 s21, s20, 30720
    buffer_load_dwordx4 a[120:123], v1, s[8:11], s21 offen offset:0
    buffer_load_dwordx4 a[124:127], v1, s[8:11], s21 offen offset:1024
    s_waitcnt vmcnt(32)
    ds_write_b128 v13, v[16:19] offset:0
    ds_write_b128 v13, v[20:23] offset:1024
    ds_write_b128 v13, v[24:27] offset:2048
    ds_write_b128 v13, v[28:31] offset:3072
    ds_write_b128 v13, v[32:35] offset:4096
    ds_write_b128 v13, v[36:39] offset:5120
    ds_write_b128 v13, v[40:43] offset:6144
    ds_write_b128 v13, v[44:47] offset:7168
    ds_write_b128 v13, v[48:51] offset:8192
    ds_write_b128 v13, v[52:55] offset:9216
    ds_write_b128 v13, v[56:59] offset:10240
    ds_write_b128 v13, v[60:63] offset:11264
    ds_write_b128 v13, v[64:67] offset:12288
    ds_write_b128 v13, v[68:71] offset:13312
    ds_write_b128 v13, v[72:75] offset:14336
    ds_write_b128 v13, v[76:79] offset:15360
    ds_write_b128 v13, v[80:83] offset:16384
    ds_write_b128 v13, v[84:87] offset:17408
    ds_write_b128 v13, v[88:91] offset:18432
    ds_write_b128 v13, v[92:95] offset:19456
    ds_write_b128 v13, v[96:99] offset:20480
    ds_write_b128 v13, v[100:103] offset:21504
    ds_write_b128 v13, v[104:107] offset:22528
    ds_write_b128 v13, v[108:111] offset:23552
    ds_write_b128 v13, v[112:115] offset:24576
    ds_write_b128 v13, v[116:119] offset:25600
    ds_write_b128 v13, v[120:123] offset:26624
    ds_write_b128 v13, v[124:127] offset:27648
    ds_write_b128 v13, v[128:131] offset:28672
    ds_write_b128 v13, v[132:135] offset:29696
    s_add_u32 s21, s20, 16384
    buffer_load_dwordx4 a[128:131], v1, s[8:11], s21 offen offset:0
    buffer_load_dwordx4 a[132:135], v1, s[8:11], s21 offen offset:1024
    s_add_u32 s21, s20, 57344
    buffer_load_dwordx4 a[136:139], v1, s[8:11], s21 offen offset:0
    buffer_load_dwordx4 a[140:143], v1, s[8:11], s21 offen offset:1024
    s_add_u32 s21, s20, 38912
    buffer_load_dwordx4 a[144:147], v1, s[8:11], s21 offen offset:0
    buffer_load_dwordx4 a[148:151], v1, s[8:11], s21 offen offset:1024
    s_add_u32 s21, s20, 61440
    buffer_load_dwordx4 a[152:155], v1, s[8:11], s21 offen offset:0
    buffer_load_dwordx4 a[156:159], v1, s[8:11], s21 offen offset:1024
    s_add_u32 s21, s20, 63488
    buffer_load_dwordx4 a[160:163], v1, s[8:11], s21 offen offset:0
    buffer_load_dwordx4 a[164:167], v1, s[8:11], s21 offen offset:1024
    s_add_u32 s21, s20, 65536
    buffer_load_dwordx4 a[168:171], v1, s[8:11], s21 offen offset:0
    buffer_load_dwordx4 a[172:175], v1, s[8:11], s21 offen offset:1024
    s_add_u32 s21, s20, 67584
    buffer_load_dwordx4 a[176:179], v1, s[8:11], s21 offen offset:0
    buffer_load_dwordx4 a[180:183], v1, s[8:11], s21 offen offset:1024
    s_add_u32 s21, s20, 69632
    buffer_load_dwordx4 a[184:187], v1, s[8:11], s21 offen offset:0
    buffer_load_dwordx4 a[188:191], v1, s[8:11], s21 offen offset:1024
    s_add_u32 s21, s20, 71680
    buffer_load_dwordx4 a[192:195], v1, s[8:11], s21 offen offset:0
    buffer_load_dwordx4 a[196:199], v1, s[8:11], s21 offen offset:1024
    s_add_u32 s21, s20, 73728
    buffer_load_dwordx4 a[200:203], v1, s[8:11], s21 offen offset:0
    buffer_load_dwordx4 a[204:207], v1, s[8:11], s21 offen offset:1024
    s_add_u32 s21, s20, 75776
    buffer_load_dwordx4 a[208:211], v1, s[8:11], s21 offen offset:0
    buffer_load_dwordx4 a[212:215], v1, s[8:11], s21 offen offset:1024
    s_add_u32 s21, s20, 77824
    buffer_load_dwordx4 a[216:219], v1, s[8:11], s21 offen offset:0
    buffer_load_dwordx4 a[220:223], v1, s[8:11], s21 offen offset:1024
    s_add_u32 s21, s20, 79872
    buffer_load_dwordx4 a[224:227], v1, s[8:11], s21 offen offset:0
    buffer_load_dwordx4 a[228:231], v1, s[8:11], s21 offen offset:1024
    s_add_u32 s21, s20, 81920
    buffer_load_dwordx4 a[232:235], v1, s[8:11], s21 offen offset:0
    buffer_load_dwordx4 a[236:239], v1, s[8:11], s21 offen offset:1024
    s_add_u32 s21, s20, 83968
    buffer_load_dwordx4 a[240:243], v1, s[8:11], s21 offen offset:0
    buffer_load_dwordx4 a[244:247], v1, s[8:11], s21 offen offset:1024
    s_add_u32 s21, s20, 86016
    buffer_load_dwordx4 a[248:251], v1, s[8:11], s21 offen offset:0
    buffer_load_dwordx4 a[252:255], v1, s[8:11], s21 offen offset:1024
    s_add_u32 s21, s20, 88064
    buffer_load_dwordx4 v[148:151], v1, s[8:11], s21 offen offset:0
    buffer_load_dwordx4 v[152:155], v1, s[8:11], s21 offen offset:1024
    s_add_u32 s21, s20, 92160
    buffer_load_dwordx4 v[156:159], v1, s[8:11], s21 offen offset:0
    buffer_load_dwordx4 v[160:163], v1, s[8:11], s21 offen offset:1024
    s_add_u32 s21, s20, 94208
    buffer_load_dwordx4 v[164:167], v1, s[8:11], s21 offen offset:0
    buffer_load_dwordx4 v[168:171], v1, s[8:11], s21 offen offset:1024
    s_add_u32 s21, s20, 96256
    buffer_load_dwordx4 v[172:175], v1, s[8:11], s21 offen offset:0
    buffer_load_dwordx4 v[176:179], v1, s[8:11], s21 offen offset:1024
    s_add_u32 s21, s20, 100352
    buffer_load_dwordx4 v[180:183], v1, s[8:11], s21 offen offset:0
    buffer_load_dwordx4 v[184:187], v1, s[8:11], s21 offen offset:1024
    s_add_u32 s21, s20, 102400
    buffer_load_dwordx4 v[188:191], v1, s[8:11], s21 offen offset:0
    buffer_load_dwordx4 v[192:195], v1, s[8:11], s21 offen offset:1024
    s_add_u32 s21, s20, 104448
    buffer_load_dwordx4 v[196:199], v1, s[8:11], s21 offen offset:0
    buffer_load_dwordx4 v[200:203], v1, s[8:11], s21 offen offset:1024
    s_add_u32 s21, s20, 108544
    buffer_load_dwordx4 v[204:207], v1, s[8:11], s21 offen offset:0
    buffer_load_dwordx4 v[208:211], v1, s[8:11], s21 offen offset:1024
    s_add_u32 s21, s20, 110592
    buffer_load_dwordx4 v[212:215], v1, s[8:11], s21 offen offset:0
    buffer_load_dwordx4 v[216:219], v1, s[8:11], s21 offen offset:1024
    s_add_u32 s21, s20, 112640
    buffer_load_dwordx4 v[220:223], v1, s[8:11], s21 offen offset:0
    buffer_load_dwordx4 v[224:227], v1, s[8:11], s21 offen offset:1024
    s_add_u32 s21, s20, 116736
    buffer_load_dwordx4 v[228:231], v1, s[8:11], s21 offen offset:0
    buffer_load_dwordx4 v[232:235], v1, s[8:11], s21 offen offset:1024
    s_add_u32 s21, s20, 118784
    buffer_load_dwordx4 v[236:239], v1, s[8:11], s21 offen offset:0
    buffer_load_dwordx4 v[240:243], v1, s[8:11], s21 offen offset:1024
    s_add_u32 s21, s20, 120832
    buffer_load_dwordx4 v[244:247], v1, s[8:11], s21 offen offset:0
    buffer_load_dwordx4 v[248:251], v1, s[8:11], s21 offen offset:1024
    s_waitcnt lgkmcnt(0)
    s_mov_b32 s14, 0
    s_cmp_gt_u32 s47, s14
    s_cbranch_scc1 layerb1_kernel_p2_gw1_ok
layerb1_kernel_p2_gw1_lp:
    buffer_load_dword v253, v255, s[8:11], s48 offen sc1
    s_waitcnt vmcnt(0)
    v_readlane_b32 s47, v253, 0
    v_readlane_b32 s29, v253, 1
    s_nop 0
    s_min_u32 s47, s47, s29
    s_sub_u32 s15, s15, 1
    s_cbranch_scc1 layerb1_kernel_bail
    s_cmp_gt_u32 s47, s14
    s_cbranch_scc0 layerb1_kernel_p2_gw1_lp
layerb1_kernel_p2_gw1_ok:
    s_mul_i32 s20, s14, 393216
    s_add_u32 s20, s20, s44
    s_add_u32 s21, s20, 8192
    buffer_load_dwordx4 v[100:103], v9, s[8:11], s21 offen offset:0 sc1
    buffer_load_dwordx4 v[104:107], v9, s[8:11], s21 offen offset:512 sc1
    v_mov_b32 v56, 0
    v_mov_b32 v57, 0
    v_mov_b32 v58, 0
    v_mov_b32 v59, 0
    v_mov_b32 v60, 0
    v_mov_b32 v61, 0
    v_mov_b32 v62, 0
    v_mov_b32 v63, 0
    v_mov_b32 v64, 0
    v_mov_b32 v65, 0
    v_mov_b32 v66, 0
    v_mov_b32 v67, 0
    v_mov_b32 v68, 0
    v_mov_b32 v69, 0
    v_mov_b32 v70, 0
    v_mov_b32 v71, 0
    v_mov_b32 v72, 0
    v_mov_b32 v73, 0
    v_mov_b32 v74, 0
    v_mov_b32 v75, 0
    v_mov_b32 v76, 0
    v_mov_b32 v77, 0
    v_mov_b32 v78, 0
    v_mov_b32 v79, 0
    v_mov_b32 v80, 0
    v_mov_b32 v81, 0
    v_mov_b32 v82, 0
    v_mov_b32 v83, 0
    v_mov_b32 v84, 0
    v_mov_b32 v85, 0
    v_mov_b32 v86, 0
    v_mov_b32 v87, 0
    ds_read_b128 v[116:119], v13 offset:0
    ds_read_b128 v[120:123], v13 offset:1024
    ds_read_b128 v[124:127], v13 offset:2048
    ds_read_b128 v[128:131], v13 offset:3072
    ds_read_b128 v[132:135], v13 offset:4096
    ds_read_b128 v[136:139], v13 offset:5120
    ds_read_b128 v[140:143], v13 offset:6144
    ds_read_b128 v[144:147], v13 offset:7168
    s_waitcnt lgkmcnt(0)
layerb1_kernel_p2_step:
    s_cmp_lt_u32 s14, 32
    s_cselect_b32 s18, s16, s17
    s_and_b32 s20, s14, 31
    s_lshl_b32 s20, s20, 16
    s_add_u32 s18, s18, s20
    s_add_u32 s22, s18, 51200
    s_add_u32 s23, s18, 52224
layerb1_kernel_p2_poll:
    buffer_load_dwordx4 v[40:43], v1, s[8:11], s22 offen sc1
    buffer_load_dwordx4 v[44:47], v1, s[8:11], s23 offen sc1
    s_waitcnt vmcnt(0)
    ds_write_b128 v14, v[40:43] offset:6144
    ds_write_b128 v14, v[44:47] offset:7168
    v_max3_u32 v88, v40, v41, v42
    v_max3_u32 v88, v88, v43, v44
    v_max3_u32 v88, v88, v45, v46
    v_max_u32 v88, v88, v47
    v_cmp_eq_u32 vcc, -1, v88
    s_sub_u32 s15, s15, 1
    s_cbranch_scc1 layerb1_kernel_bail
    s_cbranch_vccnz layerb1_kernel_p2_poll
    s_waitcnt lgkmcnt(0)
    s_barrier
    ds_read_b128 v[16:19], v14 offset:0
    ds_read_b128 v[20:23], v14 offset:1024
    ds_read_b128 v[24:27], v14 offset:2048
    ds_read_b128 v[28:31], v14 offset:3072
    ds_read_b128 v[32:35], v14 offset:4096
    ds_read_b128 v[36:39], v14 offset:5120
    ds_read_b128 v[48:51], v14 offset:8192
    ds_read_b128 v[52:55], v14 offset:9216
    v_smfmac_f32_16x16x64_bf16 v[56:59], v[40:43], a[0:7], v2
    v_smfmac_f32_16x16x64_bf16 v[60:63], v[40:43], a[8:15], v2
    v_smfmac_f32_16x16x64_bf16 v[64:67], v[40:43], a[16:23], v2
    v_smfmac_f32_16x16x64_bf16 v[56:59], v[44:47], a[24:31], v2
    v_smfmac_f32_16x16x64_bf16 v[60:63], v[44:47], a[32:39], v2
    v_smfmac_f32_16x16x64_bf16 v[64:67], v[44:47], a[40:47], v2
    s_waitcnt lgkmcnt(7)
    v_smfmac_f32_16x16x64_bf16 v[56:59], v[16:19], a[48:55], v2
    v_smfmac_f32_16x16x64_bf16 v[60:63], v[16:19], a[56:63], v2
    v_smfmac_f32_16x16x64_bf16 v[64:67], v[16:19], a[64:71], v2
    s_waitcnt lgkmcnt(6)
    v_smfmac_f32_16x16x64_bf16 v[56:59], v[20:23], v[116:123], v2
    ds_read_b128 v[116:119], v13 offset:8192
    ds_read_b128 v[120:123], v13 offset:9216
    v_smfmac_f32_16x16x64_bf16 v[60:63], v[20:23], a[72:79], v2
    v_smfmac_f32_16x16x64_bf16 v[64:67], v[20:23], v[124:131], v2
    ds_read_b128 v[124:127], v13 offset:10240
    ds_read_b128 v[128:131], v13 offset:11264
    s_waitcnt lgkmcnt(9)
    v_smfmac_f32_16x16x64_bf16 v[56:59], v[24:27], a[80:87], v2
    v_smfmac_f32_16x16x64_bf16 v[60:63], v[24:27], v[132:139], v2
    ds_read_b128 v[132:135], v13 offset:12288
    ds_read_b128 v[136:139], v13 offset:13312
    v_smfmac_f32_16x16x64_bf16 v[64:67], v[24:27], a[88:95], v2
    s_waitcnt lgkmcnt(10)
    v_smfmac_f32_16x16x64_bf16 v[56:59], v[28:31], v[140:147], v2
    ds_read_b128 v[140:143], v13 offset:14336
    ds_read_b128 v[144:147], v13 offset:15360
    v_smfmac_f32_16x16x64_bf16 v[60:63], v[28:31], a[96:103], v2
    s_waitcnt lgkmcnt(6)
    v_smfmac_f32_16x16x64_bf16 v[64:67], v[28:31], v[116:123], v2
    ds_read_b128 v[116:119], v13 offset:16384
    ds_read_b128 v[120:123], v13 offset:17408
    v_smfmac_f32_16x16x64_bf16 v[56:59], v[32:35], a[104:111], v2
    s_waitcnt lgkmcnt(6)
    v_smfmac_f32_16x16x64_bf16 v[60:63], v[32:35], v[124:131], v2
    ds_read_b128 v[124:127], v13 offset:18432
    ds_read_b128 v[128:131], v13 offset:19456
    v_smfmac_f32_16x16x64_bf16 v[64:67], v[32:35], a[112:119], v2
    s_waitcnt lgkmcnt(6)
    v_smfmac_f32_16x16x64_bf16 v[56:59], v[36:39], v[132:139], v2
    ds_read_b128 v[132:135], v13 offset:20480
    ds_read_b128 v[136:139], v13 offset:21504
    v_smfmac_f32_16x16x64_bf16 v[60:63], v[36:39], a[120:127], v2
    s_waitcnt lgkmcnt(6)
    v_smfmac_f32_16x16x64_bf16 v[64:67], v[36:39], v[140:147], v2
    ds_read_b128 v[140:143], v13 offset:22528
    ds_read_b128 v[144:147], v13 offset:23552
    v_smfmac_f32_16x16x64_bf16 v[56:59], v[48:51], a[128:135], v2
    s_waitcnt lgkmcnt(6)
    v_smfmac_f32_16x16x64_bf16 v[60:63], v[48:51], v[116:123], v2
    ds_read_b128 v[116:119], v13 offset:24576
    ds_read_b128 v[120:123], v13 offset:25600
    v_smfmac_f32_16x16x64_bf16 v[64:67], v[48:51], a[136:143], v2
    s_waitcnt lgkmcnt(6)
    v_smfmac_f32_16x16x64_bf16 v[56:59], v[52:55], v[124:131], v2
    ds_read_b128 v[124:127], v13 offset:26624
    ds_read_b128 v[128:131], v13 offset:27648
    v_smfmac_f32_16x16x64_bf16 v[60:63], v[52:55], a[144:151], v2
    s_waitcnt lgkmcnt(6)
    v_smfmac_f32_16x16x64_bf16 v[64:67], v[52:55], v[132:139], v2
    ds_read_b128 v[132:135], v13 offset:28672
    ds_read_b128 v[136:139], v13 offset:29696
    v_smfmac_f32_16x16x64_bf16 v[68:71], v[16:19], a[152:159], v2
    v_smfmac_f32_16x16x64_bf16 v[68:71], v[20:23], a[160:167], v2
    v_permlane32_swap_b32 v56, v58
    v_permlane32_swap_b32 v57, v59
    v_smfmac_f32_16x16x64_bf16 v[68:71], v[24:27], a[168:175], v2
    v_add_f32 v56, v56, v58
    v_add_f32 v57, v57, v59
    v_smfmac_f32_16x16x64_bf16 v[68:71], v[28:31], a[176:183], v2
    v_cvt_pk_bf16_f32 v56, v56, v57
    ds_write_b16 v3, v56 offset:0
    v_smfmac_f32_16x16x64_bf16 v[68:71], v[32:35], a[184:191], v2
    ds_write_b16_d16_hi v3, v56 offset:400
    v_permlane32_swap_b32 v60, v62
    v_smfmac_f32_16x16x64_bf16 v[68:71], v[36:39], a[192:199], v2
    v_permlane32_swap_b32 v61, v63
    v_add_f32 v60, v60, v62
    v_smfmac_f32_16x16x64_bf16 v[68:71], v[40:43], a[200:207], v2
    v_add_f32 v61, v61, v63
    v_cvt_pk_bf16_f32 v60, v60, v61
    v_smfmac_f32_16x16x64_bf16 v[68:71], v[44:47], a[208:215], v2
    ds_write_b16 v3, v60 offset:32
    ds_write_b16_d16_hi v3, v60 offset:432
    v_smfmac_f32_16x16x64_bf16 v[68:71], v[48:51], a[216:223], v2
    v_permlane32_swap_b32 v64, v66
    v_permlane32_swap_b32 v65, v67
    v_smfmac_f32_16x16x64_bf16 v[68:71], v[52:55], a[224:231], v2
    v_add_f32 v64, v64, v66
    v_add_f32 v65, v65, v67
    v_smfmac_f32_16x16x64_bf16 v[72:75], v[16:19], a[232:239], v2
    v_cvt_pk_bf16_f32 v64, v64, v65
    ds_write_b16 v3, v64 offset:64
    v_smfmac_f32_16x16x64_bf16 v[72:75], v[20:23], a[240:247], v2
    ds_write_b16_d16_hi v3, v64 offset:464
    v_smfmac_f32_16x16x64_bf16 v[72:75], v[24:27], a[248:255], v2
    v_smfmac_f32_16x16x64_bf16 v[72:75], v[28:31], v[148:155], v2
    s_waitcnt lgkmcnt(0)
    s_barrier
    ds_read_b128 v[88:91], v4 offset:0
    v_smfmac_f32_16x16x64_bf16 v[72:75], v[32:35], v[140:147], v2
    ds_read_b128 v[92:95], v4 offset:128
    ds_read_b128 v[96:99], v4 offset:256
    v_smfmac_f32_16x16x64_bf16 v[72:75], v[36:39], v[156:163], v2
    v_permlane32_swap_b32 v68, v70
    v_permlane32_swap_b32 v69, v71
    v_smfmac_f32_16x16x64_bf16 v[72:75], v[40:43], v[164:171], v2
    v_add_f32 v68, v68, v70
    v_add_f32 v69, v69, v71
    v_smfmac_f32_16x16x64_bf16 v[72:75], v[44:47], v[172:179], v2
    v_cvt_pk_bf16_f32 v68, v68, v69
    ds_write_b16 v3, v68 offset:3200
    v_smfmac_f32_16x16x64_bf16 v[72:75], v[48:51], v[116:123], v2
    ds_write_b16_d16_hi v3, v68 offset:3600
    v_smfmac_f32_16x16x64_bf16 v[72:75], v[52:55], v[180:187], v2
    s_waitcnt lgkmcnt(2)
    v_smfmac_f32_16x16x64_bf16 v[80:83], v[96:99], v[100:107], v2
    v_smfmac_f32_16x16x64_bf16 v[76:79], v[16:19], v[188:195], v2
    v_smfmac_f32_16x16x64_bf16 v[76:79], v[20:23], v[196:203], v2
    v_smfmac_f32_16x16x64_bf16 v[76:79], v[24:27], v[124:131], v2
    v_permlane32_swap_b32 v72, v74
    v_permlane32_swap_b32 v73, v75
    v_smfmac_f32_16x16x64_bf16 v[76:79], v[28:31], v[204:211], v2
    v_add_f32 v72, v72, v74
    v_add_f32 v73, v73, v75
    ds_write_b128 v15, v[80:83]
    v_smfmac_f32_16x16x64_bf16 v[76:79], v[32:35], v[212:219], v2
    v_cvt_pk_bf16_f32 v72, v72, v73
    ds_write_b16 v3, v72 offset:3232
    v_smfmac_f32_16x16x64_bf16 v[76:79], v[36:39], v[220:227], v2
    ds_write_b16_d16_hi v3, v72 offset:3632
    v_smfmac_f32_16x16x64_bf16 v[76:79], v[40:43], v[132:139], v2
    v_smfmac_f32_16x16x64_bf16 v[76:79], v[44:47], v[228:235], v2
    v_smfmac_f32_16x16x64_bf16 v[76:79], v[48:51], v[236:243], v2
    v_smfmac_f32_16x16x64_bf16 v[76:79], v[52:55], v[244:251], v2
    s_nop 7
    v_permlane32_swap_b32 v76, v78
    v_permlane32_swap_b32 v77, v79
    v_add_f32 v76, v76, v78
    v_add_f32 v77, v77, v79
    v_cvt_pk_bf16_f32 v76, v76, v77
    ds_write_b16 v3, v76 offset:3264
    ds_write_b16_d16_hi v3, v76 offset:3664
    s_waitcnt lgkmcnt(0)
    s_barrier
    ds_read2st64_b32 v[40:41], v6 offset0:0 offset1:2
    ds_read2st64_b32 v[42:43], v6 offset0:8 offset1:10
    ds_read_b128 v[16:19], v5 offset:0
    ds_read_b128 v[20:23], v5 offset:16
    ds_read_b128 v[24:27], v5 offset:128
    ds_read_b128 v[28:31], v5 offset:144
    ds_read_b128 v[32:35], v5 offset:256
    ds_read_b128 v[36:39], v5 offset:272
    s_waitcnt lgkmcnt(6)
    v_add_f32 v40, v40, v41
    v_add_f32 v42, v42, v43
    v_add_f32 v44, v40, v42
    v_mul_f32 v44, 0x3dd53b95, v44
    s_waitcnt lgkmcnt(4)
    v_smfmac_f32_16x16x64_bf16 v[84:87], v[88:91], v[16:23], v2
    s_waitcnt lgkmcnt(2)
    v_smfmac_f32_16x16x64_bf16 v[84:87], v[92:95], v[24:31], v2
    s_waitcnt lgkmcnt(0)
    v_smfmac_f32_16x16x64_bf16 v[84:87], v[96:99], v[32:39], v2
    v_max_f32_dpp v45, v44, v44 row_ror:8 row_mask:0xf bank_mask:0xf
    s_nop 1
    v_max_f32_dpp v45, v45, v45 row_ror:4 row_mask:0xf bank_mask:0xf
    s_nop 1
    v_max_f32_dpp v45, v45, v45 row_ror:2 row_mask:0xf bank_mask:0xf
    s_nop 1
    v_max_f32_dpp v45, v45, v45 row_ror:1 row_mask:0xf bank_mask:0xf
    v_mov_b32 v47, v45
    s_nop 1
    v_permlane32_swap_b32 v45, v47
    v_max_f32 v45, v45, v47
    v_mov_b32 v47, v86
    s_nop 1
    v_permlane32_swap_b32 v86, v47
    v_add_f32 v48, v86, v47
    v_mul_f32 v48, 0x3dd53b95, v48
    s_nop 1
    v_max_f32_dpp v46, v48, v48 row_ror:4 row_mask:0xf bank_mask:0xf
    s_nop 1
    v_max_f32_dpp v46, v46, v46 row_ror:2 row_mask:0xf bank_mask:0xf
    s_nop 1
    v_max_f32_dpp v46, v46, v46 row_ror:1 row_mask:0xf bank_mask:0xf
    v_max_f32 v45, v45, v46
    v_sub_f32 v49, v44, v45
    v_sub_f32 v50, v48, v45
    v_exp_f32 v49, v49
    v_exp_f32 v50, v50
    s_nop 0
    v_fma_f32 v51, v50, v12, v49
    s_nop 1
    v_add_f32_dpp v51, v51, v51 row_ror:8 row_mask:0xf bank_mask:0xf
    s_nop 1
    v_add_f32_dpp v51, v51, v51 row_ror:4 row_mask:0xf bank_mask:0xf
    s_nop 1
    v_add_f32_dpp v51, v51, v51 row_ror:2 row_mask:0xf bank_mask:0xf
    s_nop 1
    v_add_f32_dpp v51, v51, v51 row_ror:1 row_mask:0xf bank_mask:0xf
    v_mov_b32 v47, v51
    s_nop 1
    v_permlane32_swap_b32 v51, v47
    v_add_f32 v51, v51, v47
    v_rcp_f32 v51, v51
    s_nop 0
    v_mul_f32 v49, v49, v51
    v_mul_f32 v50, v50, v51
    s_nop 0
    v_mov_b32_dpp v46, v49 quad_perm:[1,0,3,2] row_mask:0xf bank_mask:0xf
    v_mov_b32_dpp v47, v50 quad_perm:[1,0,3,2] row_mask:0xf bank_mask:0xf
    v_cvt_pk_bf16_f32 v16, v49, v46
    v_cvt_pk_bf16_f32 v20, v50, v47
    s_nop 0
    v_mov_b32_dpp v17, v16 row_shl:2 row_mask:0xf bank_mask:0xf
    v_mov_b32_dpp v18, v16 row_shl:4 row_mask:0xf bank_mask:0xf
    v_mov_b32_dpp v19, v16 row_shl:6 row_mask:0xf bank_mask:0xf
    v_mov_b32_dpp v21, v20 row_shl:2 row_mask:0xf bank_mask:0xf
    v_mov_b32_dpp v22, v20 row_shl:4 row_mask:0xf bank_mask:0xf
    v_mov_b32_dpp v23, v20 row_shl:6 row_mask:0xf bank_mask:0xf
    s_mov_b64 exec, s[40:41]
    buffer_store_dwordx4 v[16:19], v7, s[8:11], s18 offen sc1
    s_mov_b64 exec, s[42:43]
    buffer_store_dwordx4 v[20:23], v8, s[8:11], s18 offen sc1
    s_mov_b64 exec, -1
    ds_read_b128 v[40:43], v10
    s_add_u32 s28, s14, 1
    s_min_u32 s28, s28, 63
    s_cmp_gt_u32 s47, s28
    s_cbranch_scc1 layerb1_kernel_p2_gw2_ok
layerb1_kernel_p2_gw2_lp:
    buffer_load_dword v253, v255, s[8:11], s48 offen sc1
    s_waitcnt vmcnt(0)
    v_readlane_b32 s47, v253, 0
    v_readlane_b32 s29, v253, 1
    s_nop 0
    s_min_u32 s47, s47, s29
    s_sub_u32 s15, s15, 1
    s_cbranch_scc1 layerb1_kernel_bail
    s_cmp_gt_u32 s47, s28
    s_cbranch_scc0 layerb1_kernel_p2_gw2_lp
layerb1_kernel_p2_gw2_ok:
    s_mul_i32 s20, s28, 393216
    s_add_u32 s20, s20, s44
    s_add_u32 s21, s20, 8192
    buffer_load_dwordx4 v[100:103], v9, s[8:11], s21 offen offset:0 sc1
    buffer_load_dwordx4 v[104:107], v9, s[8:11], s21 offen offset:512 sc1
    v_mov_b32 v56, 0
    v_mov_b32 v57, 0
    v_mov_b32 v58, 0
    v_mov_b32 v59, 0
    v_mov_b32 v60, 0
    v_mov_b32 v61, 0
    v_mov_b32 v62, 0
    v_mov_b32 v63, 0
    v_mov_b32 v64, 0
    v_mov_b32 v65, 0
    v_mov_b32 v66, 0
    v_mov_b32 v67, 0
    v_mov_b32 v68, 0
    v_mov_b32 v69, 0
    v_mov_b32 v70, 0
    v_mov_b32 v71, 0
    v_mov_b32 v72, 0
    v_mov_b32 v73, 0
    v_mov_b32 v74, 0
    v_mov_b32 v75, 0
    v_mov_b32 v76, 0
    v_mov_b32 v77, 0
    v_mov_b32 v78, 0
    v_mov_b32 v79, 0
    v_mov_b32 v80, 0
    v_mov_b32 v81, 0
    v_mov_b32 v82, 0
    v_mov_b32 v83, 0
    v_mov_b32 v84, 0
    v_mov_b32 v85, 0
    v_mov_b32 v86, 0
    v_mov_b32 v87, 0
    s_waitcnt lgkmcnt(0)
    s_mul_i32 s20, s14, 98304
    s_add_u32 s20, s20, s45
    buffer_store_dwordx4 v[40:43], v11, s[8:11], s20 offen sc1
    ds_read_b128 v[116:119], v13 offset:0
    ds_read_b128 v[120:123], v13 offset:1024
    ds_read_b128 v[124:127], v13 offset:2048
    ds_read_b128 v[128:131], v13 offset:3072
    ds_read_b128 v[132:135], v13 offset:4096
    ds_read_b128 v[136:139], v13 offset:5120
    ds_read_b128 v[140:143], v13 offset:6144
    ds_read_b128 v[144:147], v13 offset:7168
    s_waitcnt lgkmcnt(0)
    s_add_u32 s14, s14, 1
    s_cmp_lt_u32 s14, 64
    s_cbranch_scc1 layerb1_kernel_p2_step
    s_waitcnt vmcnt(0)
    s_barrier
    s_branch layerb1_kernel_end
layerb1_kernel_p3_start:
    v_lshrrev_b32 v16, 4, v0
    v_and_b32 v17, 15, v0
    v_and_b32 v18, 1, v16
    v_lshlrev_b32 v18, 2, v18
    v_lshrrev_b32 v19, 1, v16
    v_lshl_add_u32 v18, v19, 1, v18
    v_mul_u32_u24 v18, 400, v18
    v_lshl_add_u32 v18, v17, 1, v18
    v_add_u32 v3, 133408, v18
    v_and_b32 v18, 7, v0
    v_mul_u32_u24 v18, 400, v18
    v_lshrrev_b32 v19, 3, v0
    v_lshl_add_u32 v18, v19, 4, v18
    v_add_u32 v4, 133120, v18
    v_and_b32 v18, 7, v0
    v_mul_u32_u24 v18, 400, v18
    v_lshl_add_u32 v18, v16, 5, v18
    v_add_u32 v5, 136320, v18
    v_lshrrev_b32 v18, 1, v16
    v_lshlrev_b32 v18, 10, v18
    v_and_b32 v19, 31, v0
    v_lshl_add_u32 v18, v19, 4, v18
    v_add_u32 v6, 139532, v18
    v_add_u32 v15, 142592, v1
    v_lshrrev_b32 v18, 1, v16
    v_lshlrev_b32 v18, 1, v18
    v_lshrrev_b32 v19, 3, v17
    v_add3_u32 v18, v18, v19, 1
    v_lshrrev_b32 v19, 1, v18
    v_lshlrev_b32 v19, 14, v19
    v_and_b32 v18, 1, v18
    v_lshl_add_u32 v18, v18, 12, v19
    v_and_b32 v19, 1, v16
    v_lshlrev_b32 v19, 4, v19
    v_add_u32 v19, 96, v19
    s_lshl_b32 s20, s12, 7
    v_add_u32 v8, s20, v19
    v_add_u32 v7, v8, v18
    v_lshlrev_b32 v18, 4, v17
    v_lshl_add_u32 v18, v16, 10, v18
    v_add_u32 v9, 256, v18
    v_add_u32 v18, 192, v0
    v_mul_u32_u24 v19, 2731, v18
    v_lshrrev_b32 v19, 16, v19
    v_mul_u32_u24 v20, 24, v19
    v_sub_u32 v20, v18, v20
    v_mul_u32_u24 v21, 400, v19
    v_lshl_add_u32 v21, v20, 4, v21
    v_add_u32 v10, 136320, v21
    v_lshlrev_b32 v21, 4, v19
    v_lshl_add_u32 v11, v20, 7, v21
    v_and_b32 v18, 0x28, v0
    v_cmp_eq_u32 vcc, 0, v18
    v_mov_b32 v18, 1.0
    v_mov_b32 v19, 0
    v_cndmask_b32 v12, v19, v18, vcc
    v_add_u32 v13, 92160, v1
    v_add_u32 v14, 122880, v1
    s_mul_i32 s44, s12, 12288
    s_add_u32 s44, s44, 53477376
    s_mul_i32 s45, s12, 3072
    s_add_u32 s45, s45, 208666624
    s_mul_i32 s20, s12, 6
    s_add_u32 s21, s20, 5
    s_lshr_b32 s20, s20, 3
    s_lshr_b32 s21, s21, 3
    s_add_u32 s20, s20, 80
    s_add_u32 s21, s21, 80
    s_lshl_b32 s20, s20, 7
    s_lshl_b32 s21, s21, 7
    v_mov_b32 v255, s21
    v_mov_b32 v253, s20
    v_cmp_eq_u32 vcc, 0, v0
    s_nop 1
    v_cndmask_b32 v255, v255, v253, vcc
    s_mov_b32 s47, 0
    s_mul_i32 s20, s12, 491520
    s_add_u32 s20, s20, 11902976
    s_add_u32 s21, s20, 2048
    buffer_load_dwordx4 v[16:19], v1, s[8:11], s21 offen offset:0
    buffer_load_dwordx4 v[20:23], v1, s[8:11], s21 offen offset:1024
    s_add_u32 s21, s20, 43008
    buffer_load_dwordx4 v[24:27], v1, s[8:11], s21 offen offset:0
    buffer_load_dwordx4 v[28:31], v1, s[8:11], s21 offen offset:1024
    s_add_u32 s21, s20, 24576
    buffer_load_dwordx4 v[32:35], v1, s[8:11], s21 offen offset:0
    buffer_load_dwordx4 v[36:39], v1, s[8:11], s21 offen offset:1024
    s_add_u32 s21, s20, 6144
    buffer_load_dwordx4 v[40:43], v1, s[8:11], s21 offen offset:0
    buffer_load_dwordx4 v[44:47], v1, s[8:11], s21 offen offset:1024
    s_add_u32 s21, s20, 47104
    buffer_load_dwordx4 v[48:51], v1, s[8:11], s21 offen offset:0
    buffer_load_dwordx4 v[52:55], v1, s[8:11], s21 offen offset:1024
    s_add_u32 s21, s20, 28672
    buffer_load_dwordx4 v[56:59], v1, s[8:11], s21 offen offset:0
    buffer_load_dwordx4 v[60:63], v1, s[8:11], s21 offen offset:1024
    s_add_u32 s21, s20, 10240
    buffer_load_dwordx4 v[64:67], v1, s[8:11], s21 offen offset:0
    buffer_load_dwordx4 v[68:71], v1, s[8:11], s21 offen offset:1024
    s_add_u32 s21, s20, 51200
    buffer_load_dwordx4 v[72:75], v1, s[8:11], s21 offen offset:0
    buffer_load_dwordx4 v[76:79], v1, s[8:11], s21 offen offset:1024
    s_add_u32 s21, s20, 32768
    buffer_load_dwordx4 v[80:83], v1, s[8:11], s21 offen offset:0
    buffer_load_dwordx4 v[84:87], v1, s[8:11], s21 offen offset:1024
    s_add_u32 s21, s20, 14336
    buffer_load_dwordx4 v[88:91], v1, s[8:11], s21 offen offset:0
    buffer_load_dwordx4 v[92:95], v1, s[8:11], s21 offen offset:1024
    s_add_u32 s21, s20, 55296
    buffer_load_dwordx4 v[96:99], v1, s[8:11], s21 offen offset:0
    buffer_load_dwordx4 v[100:103], v1, s[8:11], s21 offen offset:1024
    s_add_u32 s21, s20, 90112
    buffer_load_dwordx4 v[104:107], v1, s[8:11], s21 offen offset:0
    buffer_load_dwordx4 v[108:111], v1, s[8:11], s21 offen offset:1024
    s_add_u32 s21, s20, 98304
    buffer_load_dwordx4 v[112:115], v1, s[8:11], s21 offen offset:0
    buffer_load_dwordx4 v[116:119], v1, s[8:11], s21 offen offset:1024
    s_add_u32 s21, s20, 106496
    buffer_load_dwordx4 v[120:123], v1, s[8:11], s21 offen offset:0
    buffer_load_dwordx4 v[124:127], v1, s[8:11], s21 offen offset:1024
    s_add_u32 s21, s20, 114688
    buffer_load_dwordx4 v[128:131], v1, s[8:11], s21 offen offset:0
    buffer_load_dwordx4 v[132:135], v1, s[8:11], s21 offen offset:1024
    s_add_u32 s21, s20, 16384
    buffer_load_dwordx4 a[0:3], v1, s[8:11], s21 offen offset:0
    buffer_load_dwordx4 a[4:7], v1, s[8:11], s21 offen offset:1024
    s_add_u32 s21, s20, 36864
    buffer_load_dwordx4 a[8:11], v1, s[8:11], s21 offen offset:0
    buffer_load_dwordx4 a[12:15], v1, s[8:11], s21 offen offset:1024
    s_add_u32 s21, s20, 57344
    buffer_load_dwordx4 a[16:19], v1, s[8:11], s21 offen offset:0
    buffer_load_dwordx4 a[20:23], v1, s[8:11], s21 offen offset:1024
    s_add_u32 s21, s20, 18432
    buffer_load_dwordx4 a[24:27], v1, s[8:11], s21 offen offset:0
    buffer_load_dwordx4 a[28:31], v1, s[8:11], s21 offen offset:1024
    s_add_u32 s21, s20, 38912
    buffer_load_dwordx4 a[32:35], v1, s[8:11], s21 offen offset:0
    buffer_load_dwordx4 a[36:39], v1, s[8:11], s21 offen offset:1024
    s_add_u32 s21, s20, 59392
    buffer_load_dwordx4 a[40:43], v1, s[8:11], s21 offen offset:0
    buffer_load_dwordx4 a[44:47], v1, s[8:11], s21 offen offset:1024
    s_add_u32 s21, s20, 0
    buffer_load_dwordx4 a[48:51], v1, s[8:11], s21 offen offset:0
    buffer_load_dwordx4 a[52:55], v1, s[8:11], s21 offen offset:1024
    s_add_u32 s21, s20, 20480
    buffer_load_dwordx4 a[56:59], v1, s[8:11], s21 offen offset:0
    buffer_load_dwordx4 a[60:63], v1, s[8:11], s21 offen offset:1024
    s_add_u32 s21, s20, 40960
    buffer_load_dwordx4 a[64:67], v1, s[8:11], s21 offen offset:0
    buffer_load_dwordx4 a[68:71], v1, s[8:11], s21 offen offset:1024
    s_add_u32 s21, s20, 22528
    buffer_load_dwordx4 a[72:75], v1, s[8:11], s21 offen offset:0
    buffer_load_dwordx4 a[76:79], v1, s[8:11], s21 offen offset:1024
    s_add_u32 s21, s20, 4096
    buffer_load_dwordx4 a[80:83], v1, s[8:11], s21 offen offset:0
    buffer_load_dwordx4 a[84:87], v1, s[8:11], s21 offen offset:1024
    s_add_u32 s21, s20, 45056
    buffer_load_dwordx4 a[88:91], v1, s[8:11], s21 offen offset:0
    buffer_load_dwordx4 a[92:95], v1, s[8:11], s21 offen offset:1024
    s_add_u32 s21, s20, 26624
    buffer_load_dwordx4 a[96:99], v1, s[8:11], s21 offen offset:0
    buffer_load_dwordx4 a[100:103], v1, s[8:11], s21 offen offset:1024
    s_add_u32 s21, s20, 8192
    buffer_load_dwordx4 a[104:107], v1, s[8:11], s21 offen offset:0
    buffer_load_dwordx4 a[108:111], v1, s[8:11], s21 offen offset:1024
    s_add_u32 s21, s20, 49152
    buffer_load_dwordx4 a[112:115], v1, s[8:11], s21 offen offset:0
    buffer_load_dwordx4 a[116:119], v1, s[8:11], s21 offen offset:1024
    s_add_u32 s21, s20, 30720
    buffer_load_dwordx4 a[120:123], v1, s[8:11], s21 offen offset:0
    buffer_load_dwordx4 a[124:127], v1, s[8:11], s21 offen offset:1024
    s_waitcnt vmcnt(32)
    ds_write_b128 v13, v[16:19] offset:0
    ds_write_b128 v13, v[20:23] offset:1024
    ds_write_b128 v13, v[24:27] offset:2048
    ds_write_b128 v13, v[28:31] offset:3072
    ds_write_b128 v13, v[32:35] offset:4096
    ds_write_b128 v13, v[36:39] offset:5120
    ds_write_b128 v13, v[40:43] offset:6144
    ds_write_b128 v13, v[44:47] offset:7168
    ds_write_b128 v13, v[48:51] offset:8192
    ds_write_b128 v13, v[52:55] offset:9216
    ds_write_b128 v13, v[56:59] offset:10240
    ds_write_b128 v13, v[60:63] offset:11264
    ds_write_b128 v13, v[64:67] offset:12288
    ds_write_b128 v13, v[68:71] offset:13312
    ds_write_b128 v13, v[72:75] offset:14336
    ds_write_b128 v13, v[76:79] offset:15360
    ds_write_b128 v13, v[80:83] offset:16384
    ds_write_b128 v13, v[84:87] offset:17408
    ds_write_b128 v13, v[88:91] offset:18432
    ds_write_b128 v13, v[92:95] offset:19456
    ds_write_b128 v13, v[96:99] offset:20480
    ds_write_b128 v13, v[100:103] offset:21504
    ds_write_b128 v13, v[104:107] offset:22528
    ds_write_b128 v13, v[108:111] offset:23552
    ds_write_b128 v13, v[112:115] offset:24576
    ds_write_b128 v13, v[116:119] offset:25600
    ds_write_b128 v13, v[120:123] offset:26624
    ds_write_b128 v13, v[124:127] offset:27648
    ds_write_b128 v13, v[128:131] offset:28672
    ds_write_b128 v13, v[132:135] offset:29696
    s_add_u32 s21, s20, 12288
    buffer_load_dwordx4 a[128:131], v1, s[8:11], s21 offen offset:0
    buffer_load_dwordx4 a[132:135], v1, s[8:11], s21 offen offset:1024
    s_add_u32 s21, s20, 53248
    buffer_load_dwordx4 a[136:139], v1, s[8:11], s21 offen offset:0
    buffer_load_dwordx4 a[140:143], v1, s[8:11], s21 offen offset:1024
    s_add_u32 s21, s20, 34816
    buffer_load_dwordx4 a[144:147], v1, s[8:11], s21 offen offset:0
    buffer_load_dwordx4 a[148:151], v1, s[8:11], s21 offen offset:1024
    s_add_u32 s21, s20, 61440
    buffer_load_dwordx4 a[152:155], v1, s[8:11], s21 offen offset:0
    buffer_load_dwordx4 a[156:159], v1, s[8:11], s21 offen offset:1024
    s_add_u32 s21, s20, 63488
    buffer_load_dwordx4 a[160:163], v1, s[8:11], s21 offen offset:0
    buffer_load_dwordx4 a[164:167], v1, s[8:11], s21 offen offset:1024
    s_add_u32 s21, s20, 65536
    buffer_load_dwordx4 a[168:171], v1, s[8:11], s21 offen offset:0
    buffer_load_dwordx4 a[172:175], v1, s[8:11], s21 offen offset:1024
    s_add_u32 s21, s20, 67584
    buffer_load_dwordx4 a[176:179], v1, s[8:11], s21 offen offset:0
    buffer_load_dwordx4 a[180:183], v1, s[8:11], s21 offen offset:1024
    s_add_u32 s21, s20, 69632
    buffer_load_dwordx4 a[184:187], v1, s[8:11], s21 offen offset:0
    buffer_load_dwordx4 a[188:191], v1, s[8:11], s21 offen offset:1024
    s_add_u32 s21, s20, 71680
    buffer_load_dwordx4 a[192:195], v1, s[8:11], s21 offen offset:0
    buffer_load_dwordx4 a[196:199], v1, s[8:11], s21 offen offset:1024
    s_add_u32 s21, s20, 73728
    buffer_load_dwordx4 a[200:203], v1, s[8:11], s21 offen offset:0
    buffer_load_dwordx4 a[204:207], v1, s[8:11], s21 offen offset:1024
    s_add_u32 s21, s20, 75776
    buffer_load_dwordx4 a[208:211], v1, s[8:11], s21 offen offset:0
    buffer_load_dwordx4 a[212:215], v1, s[8:11], s21 offen offset:1024
    s_add_u32 s21, s20, 77824
    buffer_load_dwordx4 a[216:219], v1, s[8:11], s21 offen offset:0
    buffer_load_dwordx4 a[220:223], v1, s[8:11], s21 offen offset:1024
    s_add_u32 s21, s20, 79872
    buffer_load_dwordx4 a[224:227], v1, s[8:11], s21 offen offset:0
    buffer_load_dwordx4 a[228:231], v1, s[8:11], s21 offen offset:1024
    s_add_u32 s21, s20, 81920
    buffer_load_dwordx4 a[232:235], v1, s[8:11], s21 offen offset:0
    buffer_load_dwordx4 a[236:239], v1, s[8:11], s21 offen offset:1024
    s_add_u32 s21, s20, 83968
    buffer_load_dwordx4 a[240:243], v1, s[8:11], s21 offen offset:0
    buffer_load_dwordx4 a[244:247], v1, s[8:11], s21 offen offset:1024
    s_add_u32 s21, s20, 86016
    buffer_load_dwordx4 a[248:251], v1, s[8:11], s21 offen offset:0
    buffer_load_dwordx4 a[252:255], v1, s[8:11], s21 offen offset:1024
    s_add_u32 s21, s20, 88064
    buffer_load_dwordx4 v[148:151], v1, s[8:11], s21 offen offset:0
    buffer_load_dwordx4 v[152:155], v1, s[8:11], s21 offen offset:1024
    s_add_u32 s21, s20, 92160
    buffer_load_dwordx4 v[156:159], v1, s[8:11], s21 offen offset:0
    buffer_load_dwordx4 v[160:163], v1, s[8:11], s21 offen offset:1024
    s_add_u32 s21, s20, 94208
    buffer_load_dwordx4 v[164:167], v1, s[8:11], s21 offen offset:0
    buffer_load_dwordx4 v[168:171], v1, s[8:11], s21 offen offset:1024
    s_add_u32 s21, s20, 96256
    buffer_load_dwordx4 v[172:175], v1, s[8:11], s21 offen offset:0
    buffer_load_dwordx4 v[176:179], v1, s[8:11], s21 offen offset:1024
    s_add_u32 s21, s20, 100352
    buffer_load_dwordx4 v[180:183], v1, s[8:11], s21 offen offset:0
    buffer_load_dwordx4 v[184:187], v1, s[8:11], s21 offen offset:1024
    s_add_u32 s21, s20, 102400
    buffer_load_dwordx4 v[188:191], v1, s[8:11], s21 offen offset:0
    buffer_load_dwordx4 v[192:195], v1, s[8:11], s21 offen offset:1024
    s_add_u32 s21, s20, 104448
    buffer_load_dwordx4 v[196:199], v1, s[8:11], s21 offen offset:0
    buffer_load_dwordx4 v[200:203], v1, s[8:11], s21 offen offset:1024
    s_add_u32 s21, s20, 108544
    buffer_load_dwordx4 v[204:207], v1, s[8:11], s21 offen offset:0
    buffer_load_dwordx4 v[208:211], v1, s[8:11], s21 offen offset:1024
    s_add_u32 s21, s20, 110592
    buffer_load_dwordx4 v[212:215], v1, s[8:11], s21 offen offset:0
    buffer_load_dwordx4 v[216:219], v1, s[8:11], s21 offen offset:1024
    s_add_u32 s21, s20, 112640
    buffer_load_dwordx4 v[220:223], v1, s[8:11], s21 offen offset:0
    buffer_load_dwordx4 v[224:227], v1, s[8:11], s21 offen offset:1024
    s_add_u32 s21, s20, 116736
    buffer_load_dwordx4 v[228:231], v1, s[8:11], s21 offen offset:0
    buffer_load_dwordx4 v[232:235], v1, s[8:11], s21 offen offset:1024
    s_add_u32 s21, s20, 118784
    buffer_load_dwordx4 v[236:239], v1, s[8:11], s21 offen offset:0
    buffer_load_dwordx4 v[240:243], v1, s[8:11], s21 offen offset:1024
    s_add_u32 s21, s20, 120832
    buffer_load_dwordx4 v[244:247], v1, s[8:11], s21 offen offset:0
    buffer_load_dwordx4 v[248:251], v1, s[8:11], s21 offen offset:1024
    s_waitcnt lgkmcnt(0)
    s_mov_b32 s14, 0
    s_cmp_gt_u32 s47, s14
    s_cbranch_scc1 layerb1_kernel_p3_gw1_ok
layerb1_kernel_p3_gw1_lp:
    buffer_load_dword v253, v255, s[8:11], s48 offen sc1
    s_waitcnt vmcnt(0)
    v_readlane_b32 s47, v253, 0
    v_readlane_b32 s29, v253, 1
    s_nop 0
    s_min_u32 s47, s47, s29
    s_sub_u32 s15, s15, 1
    s_cbranch_scc1 layerb1_kernel_bail
    s_cmp_gt_u32 s47, s14
    s_cbranch_scc0 layerb1_kernel_p3_gw1_lp
layerb1_kernel_p3_gw1_ok:
    s_mul_i32 s20, s14, 393216
    s_add_u32 s20, s20, s44
    s_add_u32 s21, s20, 8192
    buffer_load_dwordx4 v[100:103], v9, s[8:11], s21 offen offset:0 sc1
    buffer_load_dwordx4 v[104:107], v9, s[8:11], s21 offen offset:512 sc1
    v_mov_b32 v56, 0
    v_mov_b32 v57, 0
    v_mov_b32 v58, 0
    v_mov_b32 v59, 0
    v_mov_b32 v60, 0
    v_mov_b32 v61, 0
    v_mov_b32 v62, 0
    v_mov_b32 v63, 0
    v_mov_b32 v64, 0
    v_mov_b32 v65, 0
    v_mov_b32 v66, 0
    v_mov_b32 v67, 0
    v_mov_b32 v68, 0
    v_mov_b32 v69, 0
    v_mov_b32 v70, 0
    v_mov_b32 v71, 0
    v_mov_b32 v72, 0
    v_mov_b32 v73, 0
    v_mov_b32 v74, 0
    v_mov_b32 v75, 0
    v_mov_b32 v76, 0
    v_mov_b32 v77, 0
    v_mov_b32 v78, 0
    v_mov_b32 v79, 0
    v_mov_b32 v80, 0
    v_mov_b32 v81, 0
    v_mov_b32 v82, 0
    v_mov_b32 v83, 0
    v_mov_b32 v84, 0
    v_mov_b32 v85, 0
    v_mov_b32 v86, 0
    v_mov_b32 v87, 0
    ds_read_b128 v[116:119], v13 offset:0
    ds_read_b128 v[120:123], v13 offset:1024
    ds_read_b128 v[124:127], v13 offset:2048
    ds_read_b128 v[128:131], v13 offset:3072
    ds_read_b128 v[132:135], v13 offset:4096
    ds_read_b128 v[136:139], v13 offset:5120
    ds_read_b128 v[140:143], v13 offset:6144
    ds_read_b128 v[144:147], v13 offset:7168
    s_waitcnt lgkmcnt(0)
layerb1_kernel_p3_step:
    s_cmp_lt_u32 s14, 32
    s_cselect_b32 s18, s16, s17
    s_and_b32 s20, s14, 31
    s_lshl_b32 s20, s20, 16
    s_add_u32 s18, s18, s20
    s_add_u32 s22, s18, 53248
    s_add_u32 s23, s18, 54272
layerb1_kernel_p3_poll:
    buffer_load_dwordx4 v[48:51], v1, s[8:11], s22 offen sc1
    buffer_load_dwordx4 v[52:55], v1, s[8:11], s23 offen sc1
    s_waitcnt vmcnt(0)
    ds_write_b128 v14, v[48:51] offset:8192
    ds_write_b128 v14, v[52:55] offset:9216
    v_max3_u32 v88, v48, v49, v50
    v_max3_u32 v88, v88, v51, v52
    v_max3_u32 v88, v88, v53, v54
    v_max_u32 v88, v88, v55
    v_cmp_eq_u32 vcc, -1, v88
    s_sub_u32 s15, s15, 1
    s_cbranch_scc1 layerb1_kernel_bail
    s_cbranch_vccnz layerb1_kernel_p3_poll
    s_waitcnt lgkmcnt(0)
    s_barrier
    ds_read_b128 v[16:19], v14 offset:0
    ds_read_b128 v[20:23], v14 offset:1024
    ds_read_b128 v[24:27], v14 offset:2048
    ds_read_b128 v[28:31], v14 offset:3072
    ds_read_b128 v[32:35], v14 offset:4096
    ds_read_b128 v[36:39], v14 offset:5120
    ds_read_b128 v[40:43], v14 offset:6144
    ds_read_b128 v[44:47], v14 offset:7168
    v_smfmac_f32_16x16x64_bf16 v[56:59], v[48:51], a[0:7], v2
    v_smfmac_f32_16x16x64_bf16 v[60:63], v[48:51], a[8:15], v2
    v_smfmac_f32_16x16x64_bf16 v[64:67], v[48:51], a[16:23], v2
    v_smfmac_f32_16x16x64_bf16 v[56:59], v[52:55], a[24:31], v2
    v_smfmac_f32_16x16x64_bf16 v[60:63], v[52:55], a[32:39], v2
    v_smfmac_f32_16x16x64_bf16 v[64:67], v[52:55], a[40:47], v2
    s_waitcnt lgkmcnt(7)
    v_smfmac_f32_16x16x64_bf16 v[56:59], v[16:19], a[48:55], v2
    v_smfmac_f32_16x16x64_bf16 v[60:63], v[16:19], a[56:63], v2
    v_smfmac_f32_16x16x64_bf16 v[64:67], v[16:19], a[64:71], v2
    s_waitcnt lgkmcnt(6)
    v_smfmac_f32_16x16x64_bf16 v[56:59], v[20:23], v[116:123], v2
    ds_read_b128 v[116:119], v13 offset:8192
    ds_read_b128 v[120:123], v13 offset:9216
    v_smfmac_f32_16x16x64_bf16 v[60:63], v[20:23], a[72:79], v2
    v_smfmac_f32_16x16x64_bf16 v[64:67], v[20:23], v[124:131], v2
    ds_read_b128 v[124:127], v13 offset:10240
    ds_read_b128 v[128:131], v13 offset:11264
    s_waitcnt lgkmcnt(9)
    v_smfmac_f32_16x16x64_bf16 v[56:59], v[24:27], a[80:87], v2
    v_smfmac_f32_16x16x64_bf16 v[60:63], v[24:27], v[132:139], v2
    ds_read_b128 v[132:135], v13 offset:12288
    ds_read_b128 v[136:139], v13 offset:13312
    v_smfmac_f32_16x16x64_bf16 v[64:67], v[24:27], a[88:95], v2
    s_waitcnt lgkmcnt(10)
    v_smfmac_f32_16x16x64_bf16 v[56:59], v[28:31], v[140:147], v2
    ds_read_b128 v[140:143], v13 offset:14336
    ds_read_b128 v[144:147], v13 offset:15360
    v_smfmac_f32_16x16x64_bf16 v[60:63], v[28:31], a[96:103], v2
    s_waitcnt lgkmcnt(6)
    v_smfmac_f32_16x16x64_bf16 v[64:67], v[28:31], v[116:123], v2
    ds_read_b128 v[116:119], v13 offset:16384
    ds_read_b128 v[120:123], v13 offset:17408
    v_smfmac_f32_16x16x64_bf16 v[56:59], v[32:35], a[104:111], v2
    s_waitcnt lgkmcnt(6)
    v_smfmac_f32_16x16x64_bf16 v[60:63], v[32:35], v[124:131], v2
    ds_read_b128 v[124:127], v13 offset:18432
    ds_read_b128 v[128:131], v13 offset:19456
    v_smfmac_f32_16x16x64_bf16 v[64:67], v[32:35], a[112:119], v2
    s_waitcnt lgkmcnt(6)
    v_smfmac_f32_16x16x64_bf16 v[56:59], v[36:39], v[132:139], v2
    ds_read_b128 v[132:135], v13 offset:20480
    ds_read_b128 v[136:139], v13 offset:21504
    v_smfmac_f32_16x16x64_bf16 v[60:63], v[36:39], a[120:127], v2
    s_waitcnt lgkmcnt(6)
    v_smfmac_f32_16x16x64_bf16 v[64:67], v[36:39], v[140:147], v2
    ds_read_b128 v[140:143], v13 offset:22528
    ds_read_b128 v[144:147], v13 offset:23552
    v_smfmac_f32_16x16x64_bf16 v[56:59], v[40:43], a[128:135], v2
    s_waitcnt lgkmcnt(6)
    v_smfmac_f32_16x16x64_bf16 v[60:63], v[40:43], v[116:123], v2
    ds_read_b128 v[116:119], v13 offset:24576
    ds_read_b128 v[120:123], v13 offset:25600
    v_smfmac_f32_16x16x64_bf16 v[64:67], v[40:43], a[136:143], v2
    s_waitcnt lgkmcnt(6)
    v_smfmac_f32_16x16x64_bf16 v[56:59], v[44:47], v[124:131], v2
    ds_read_b128 v[124:127], v13 offset:26624
    ds_read_b128 v[128:131], v13 offset:27648
    v_smfmac_f32_16x16x64_bf16 v[60:63], v[44:47], a[144:151], v2
    s_waitcnt lgkmcnt(6)
    v_smfmac_f32_16x16x64_bf16 v[64:67], v[44:47], v[132:139], v2
    ds_read_b128 v[132:135], v13 offset:28672
    ds_read_b128 v[136:139], v13 offset:29696
    v_smfmac_f32_16x16x64_bf16 v[68:71], v[16:19], a[152:159], v2
    v_smfmac_f32_16x16x64_bf16 v[68:71], v[20:23], a[160:167], v2
    v_permlane32_swap_b32 v56, v58
    v_permlane32_swap_b32 v57, v59
    v_smfmac_f32_16x16x64_bf16 v[68:71], v[24:27], a[168:175], v2
    v_add_f32 v56, v56, v58
    v_add_f32 v57, v57, v59
    v_smfmac_f32_16x16x64_bf16 v[68:71], v[28:31], a[176:183], v2
    v_cvt_pk_bf16_f32 v56, v56, v57
    ds_write_b16 v3, v56 offset:0
    v_smfmac_f32_16x16x64_bf16 v[68:71], v[32:35], a[184:191], v2
    ds_write_b16_d16_hi v3, v56 offset:400
    v_permlane32_swap_b32 v60, v62
    v_smfmac_f32_16x16x64_bf16 v[68:71], v[36:39], a[192:199], v2
    v_permlane32_swap_b32 v61, v63
    v_add_f32 v60, v60, v62
    v_smfmac_f32_16x16x64_bf16 v[68:71], v[40:43], a[200:207], v2
    v_add_f32 v61, v61, v63
    v_cvt_pk_bf16_f32 v60, v60, v61
    v_smfmac_f32_16x16x64_bf16 v[68:71], v[44:47], a[208:215], v2
    ds_write_b16 v3, v60 offset:32
    ds_write_b16_d16_hi v3, v60 offset:432
    v_smfmac_f32_16x16x64_bf16 v[68:71], v[48:51], a[216:223], v2
    v_permlane32_swap_b32 v64, v66
    v_permlane32_swap_b32 v65, v67
    v_smfmac_f32_16x16x64_bf16 v[68:71], v[52:55], a[224:231], v2
    v_add_f32 v64, v64, v66
    v_add_f32 v65, v65, v67
    v_smfmac_f32_16x16x64_bf16 v[72:75], v[16:19], a[232:239], v2
    v_cvt_pk_bf16_f32 v64, v64, v65
    ds_write_b16 v3, v64 offset:64
    v_smfmac_f32_16x16x64_bf16 v[72:75], v[20:23], a[240:247], v2
    ds_write_b16_d16_hi v3, v64 offset:464
    v_smfmac_f32_16x16x64_bf16 v[72:75], v[24:27], a[248:255], v2
    v_smfmac_f32_16x16x64_bf16 v[72:75], v[28:31], v[148:155], v2
    s_waitcnt lgkmcnt(0)
    s_barrier
    ds_read_b128 v[88:91], v4 offset:0
    v_smfmac_f32_16x16x64_bf16 v[72:75], v[32:35], v[140:147], v2
    ds_read_b128 v[92:95], v4 offset:128
    ds_read_b128 v[96:99], v4 offset:256
    v_smfmac_f32_16x16x64_bf16 v[72:75], v[36:39], v[156:163], v2
    v_permlane32_swap_b32 v68, v70
    v_permlane32_swap_b32 v69, v71
    v_smfmac_f32_16x16x64_bf16 v[72:75], v[40:43], v[164:171], v2
    v_add_f32 v68, v68, v70
    v_add_f32 v69, v69, v71
    v_smfmac_f32_16x16x64_bf16 v[72:75], v[44:47], v[172:179], v2
    v_cvt_pk_bf16_f32 v68, v68, v69
    ds_write_b16 v3, v68 offset:3200
    v_smfmac_f32_16x16x64_bf16 v[72:75], v[48:51], v[116:123], v2
    ds_write_b16_d16_hi v3, v68 offset:3600
    v_smfmac_f32_16x16x64_bf16 v[72:75], v[52:55], v[180:187], v2
    s_waitcnt lgkmcnt(2)
    v_smfmac_f32_16x16x64_bf16 v[80:83], v[96:99], v[100:107], v2
    v_smfmac_f32_16x16x64_bf16 v[76:79], v[16:19], v[188:195], v2
    v_smfmac_f32_16x16x64_bf16 v[76:79], v[20:23], v[196:203], v2
    v_smfmac_f32_16x16x64_bf16 v[76:79], v[24:27], v[124:131], v2
    v_permlane32_swap_b32 v72, v74
    v_permlane32_swap_b32 v73, v75
    v_smfmac_f32_16x16x64_bf16 v[76:79], v[28:31], v[204:211], v2
    v_add_f32 v72, v72, v74
    v_add_f32 v73, v73, v75
    ds_write_b128 v15, v[80:83]
    v_smfmac_f32_16x16x64_bf16 v[76:79], v[32:35], v[212:219], v2
    v_cvt_pk_bf16_f32 v72, v72, v73
    ds_write_b16 v3, v72 offset:3232
    v_smfmac_f32_16x16x64_bf16 v[76:79], v[36:39], v[220:227], v2
    ds_write_b16_d16_hi v3, v72 offset:3632
    v_smfmac_f32_16x16x64_bf16 v[76:79], v[40:43], v[132:139], v2
    v_smfmac_f32_16x16x64_bf16 v[76:79], v[44:47], v[228:235], v2
    v_smfmac_f32_16x16x64_bf16 v[76:79], v[48:51], v[236:243], v2
    v_smfmac_f32_16x16x64_bf16 v[76:79], v[52:55], v[244:251], v2
    s_nop 7
    v_permlane32_swap_b32 v76, v78
    v_permlane32_swap_b32 v77, v79
    v_add_f32 v76, v76, v78
    v_add_f32 v77, v77, v79
    v_cvt_pk_bf16_f32 v76, v76, v77
    ds_write_b16 v3, v76 offset:3264
    ds_write_b16_d16_hi v3, v76 offset:3664
    s_waitcnt lgkmcnt(0)
    s_barrier
    ds_read2st64_b32 v[40:41], v6 offset0:0 offset1:2
    ds_read2st64_b32 v[42:43], v6 offset0:8 offset1:10
    ds_read_b128 v[16:19], v5 offset:0
    ds_read_b128 v[20:23], v5 offset:16
    ds_read_b128 v[24:27], v5 offset:128
    ds_read_b128 v[28:31], v5 offset:144
    ds_read_b128 v[32:35], v5 offset:256
    ds_read_b128 v[36:39], v5 offset:272
    s_waitcnt lgkmcnt(6)
    v_add_f32 v40, v40, v41
    v_add_f32 v42, v42, v43
    v_add_f32 v44, v40, v42
    v_mul_f32 v44, 0x3dd53b95, v44
    s_waitcnt lgkmcnt(4)
    v_smfmac_f32_16x16x64_bf16 v[84:87], v[88:91], v[16:23], v2
    s_waitcnt lgkmcnt(2)
    v_smfmac_f32_16x16x64_bf16 v[84:87], v[92:95], v[24:31], v2
    s_waitcnt lgkmcnt(0)
    v_smfmac_f32_16x16x64_bf16 v[84:87], v[96:99], v[32:39], v2
    v_max_f32_dpp v45, v44, v44 row_ror:8 row_mask:0xf bank_mask:0xf
    s_nop 1
    v_max_f32_dpp v45, v45, v45 row_ror:4 row_mask:0xf bank_mask:0xf
    s_nop 1
    v_max_f32_dpp v45, v45, v45 row_ror:2 row_mask:0xf bank_mask:0xf
    s_nop 1
    v_max_f32_dpp v45, v45, v45 row_ror:1 row_mask:0xf bank_mask:0xf
    v_mov_b32 v47, v45
    s_nop 1
    v_permlane32_swap_b32 v45, v47
    v_max_f32 v45, v45, v47
    v_mov_b32 v47, v87
    s_nop 1
    v_permlane32_swap_b32 v87, v47
    v_add_f32 v48, v87, v47
    v_mul_f32 v48, 0x3dd53b95, v48
    s_nop 1
    v_max_f32_dpp v46, v48, v48 row_ror:4 row_mask:0xf bank_mask:0xf
    s_nop 1
    v_max_f32_dpp v46, v46, v46 row_ror:2 row_mask:0xf bank_mask:0xf
    s_nop 1
    v_max_f32_dpp v46, v46, v46 row_ror:1 row_mask:0xf bank_mask:0xf
    v_max_f32 v45, v45, v46
    v_sub_f32 v49, v44, v45
    v_sub_f32 v50, v48, v45
    v_exp_f32 v49, v49
    v_exp_f32 v50, v50
    s_nop 0
    v_fma_f32 v51, v50, v12, v49
    s_nop 1
    v_add_f32_dpp v51, v51, v51 row_ror:8 row_mask:0xf bank_mask:0xf
    s_nop 1
    v_add_f32_dpp v51, v51, v51 row_ror:4 row_mask:0xf bank_mask:0xf
    s_nop 1
    v_add_f32_dpp v51, v51, v51 row_ror:2 row_mask:0xf bank_mask:0xf
    s_nop 1
    v_add_f32_dpp v51, v51, v51 row_ror:1 row_mask:0xf bank_mask:0xf
    v_mov_b32 v47, v51
    s_nop 1
    v_permlane32_swap_b32 v51, v47
    v_add_f32 v51, v51, v47
    v_rcp_f32 v51, v51
    s_nop 0
    v_mul_f32 v49, v49, v51
    v_mul_f32 v50, v50, v51
    s_nop 0
    v_mov_b32_dpp v46, v49 quad_perm:[1,0,3,2] row_mask:0xf bank_mask:0xf
    v_mov_b32_dpp v47, v50 quad_perm:[1,0,3,2] row_mask:0xf bank_mask:0xf
    v_cvt_pk_bf16_f32 v16, v49, v46
    v_cvt_pk_bf16_f32 v20, v50, v47
    s_nop 0
    v_mov_b32_dpp v17, v16 row_shl:2 row_mask:0xf bank_mask:0xf
    v_mov_b32_dpp v18, v16 row_shl:4 row_mask:0xf bank_mask:0xf
    v_mov_b32_dpp v19, v16 row_shl:6 row_mask:0xf bank_mask:0xf
    v_mov_b32_dpp v21, v20 row_shl:2 row_mask:0xf bank_mask:0xf
    v_mov_b32_dpp v22, v20 row_shl:4 row_mask:0xf bank_mask:0xf
    v_mov_b32_dpp v23, v20 row_shl:6 row_mask:0xf bank_mask:0xf
    s_mov_b64 exec, s[40:41]
    buffer_store_dwordx4 v[16:19], v7, s[8:11], s18 offen sc1
    s_mov_b64 exec, s[42:43]
    buffer_store_dwordx4 v[20:23], v8, s[8:11], s18 offen sc1
    s_mov_b64 exec, -1
    s_add_u32 s28, s14, 1
    s_min_u32 s28, s28, 63
    s_cmp_gt_u32 s47, s28
    s_cbranch_scc1 layerb1_kernel_p3_gw2_ok
layerb1_kernel_p3_gw2_lp:
    buffer_load_dword v253, v255, s[8:11], s48 offen sc1
    s_waitcnt vmcnt(0)
    v_readlane_b32 s47, v253, 0
    v_readlane_b32 s29, v253, 1
    s_nop 0
    s_min_u32 s47, s47, s29
    s_sub_u32 s15, s15, 1
    s_cbranch_scc1 layerb1_kernel_bail
    s_cmp_gt_u32 s47, s28
    s_cbranch_scc0 layerb1_kernel_p3_gw2_lp
layerb1_kernel_p3_gw2_ok:
    s_mul_i32 s20, s28, 393216
    s_add_u32 s20, s20, s44
    s_add_u32 s21, s20, 8192
    buffer_load_dwordx4 v[100:103], v9, s[8:11], s21 offen offset:0 sc1
    buffer_load_dwordx4 v[104:107], v9, s[8:11], s21 offen offset:512 sc1
    v_mov_b32 v56, 0
    v_mov_b32 v57, 0
    v_mov_b32 v58, 0
    v_mov_b32 v59, 0
    v_mov_b32 v60, 0
    v_mov_b32 v61, 0
    v_mov_b32 v62, 0
    v_mov_b32 v63, 0
    v_mov_b32 v64, 0
    v_mov_b32 v65, 0
    v_mov_b32 v66, 0
    v_mov_b32 v67, 0
    v_mov_b32 v68, 0
    v_mov_b32 v69, 0
    v_mov_b32 v70, 0
    v_mov_b32 v71, 0
    v_mov_b32 v72, 0
    v_mov_b32 v73, 0
    v_mov_b32 v74, 0
    v_mov_b32 v75, 0
    v_mov_b32 v76, 0
    v_mov_b32 v77, 0
    v_mov_b32 v78, 0
    v_mov_b32 v79, 0
    v_mov_b32 v80, 0
    v_mov_b32 v81, 0
    v_mov_b32 v82, 0
    v_mov_b32 v83, 0
    v_mov_b32 v84, 0
    v_mov_b32 v85, 0
    v_mov_b32 v86, 0
    v_mov_b32 v87, 0
    s_lshl_b32 s20, s12, 7
    s_add_u32 s20, s20, 16384
    s_mov_b64 exec, 1
    v_mov_b32 v253, s20
    v_mov_b32 v254, s14
    buffer_store_dword v254, v253, s[8:11], s48 offen sc1
    s_mov_b64 exec, -1
    ds_read_b128 v[116:119], v13 offset:0
    ds_read_b128 v[120:123], v13 offset:1024
    ds_read_b128 v[124:127], v13 offset:2048
    ds_read_b128 v[128:131], v13 offset:3072
    ds_read_b128 v[132:135], v13 offset:4096
    ds_read_b128 v[136:139], v13 offset:5120
    ds_read_b128 v[140:143], v13 offset:6144
    ds_read_b128 v[144:147], v13 offset:7168
    s_waitcnt lgkmcnt(0)
    s_add_u32 s14, s14, 1
    s_cmp_lt_u32 s14, 64
    s_cbranch_scc1 layerb1_kernel_p3_step
    s_waitcnt vmcnt(0)
    s_barrier
    s_lshl_b32 s20, s12, 7
    s_add_u32 s20, s20, 16384
    s_mov_b64 exec, 1
    v_mov_b32 v253, s20
    v_mov_b32 v254, s14
    buffer_store_dword v254, v253, s[8:11], s48 offen sc1
    s_mov_b64 exec, -1
    s_branch layerb1_kernel_end
layerb1_kernel_y0_start:
    v_lshrrev_b32 v16, 4, v0
    v_and_b32 v17, 7, v0
    v_lshrrev_b32 v18, 3, v0
    v_and_b32 v18, 1, v18
    v_lshl_add_u32 v19, v18, 2, v16
    v_add_u32 v19, 0, v19
    v_mul_u32_u24 v20, 640, v19
    v_lshl_add_u32 v4, v17, 4, v20
    v_and_b32 v20, 3, v17
    v_lshlrev_b32 v20, 1, v20
    v_lshrrev_b32 v21, 2, v17
    v_add_u32 v20, v20, v21
    v_lshlrev_b32 v20, 4, v20
    v_lshl_add_u32 v5, v19, 7, v20
    v_add_u32 v3, 0, v1
    v_lshlrev_b32 v20, 8, v18
    v_lshl_add_u32 v20, v17, 5, v20
    v_and_b32 v21, 1, v16
    v_lshl_add_u32 v20, v21, 4, v20
    v_add_u32 v20, 10240, v20
    v_add_u32 v21, 12288, v1
    v_lshrrev_b32 v22, 1, v16
    v_cmp_eq_u32 vcc, v22, v18
    s_nop 1
    v_cndmask_b32 v6, v21, v20, vcc
    v_lshrrev_b32 v20, 3, v0
    v_lshlrev_b32 v20, 2, v20
    v_lshl_add_u32 v20, v17, 5, v20
    v_add_u32 v7, 10240, v20
    s_lshl_b32 s20, s12, 7
    s_add_u32 s20, s20, 20480
    s_lshr_b32 s21, s20, 13
    s_lshl_b32 s21, s21, 14
    s_and_b32 s20, s20, 8191
    s_add_u32 s20, s20, s21
    v_lshrrev_b32 v20, 3, v0
    v_lshlrev_b32 v20, 4, v20
    v_add_u32 v8, s20, v20
    s_mul_i32 s46, s12, 20480
    s_add_u32 s46, s46, 103809024
    s_mul_i32 s20, s12, 327680
    s_add_u32 s20, s20, 27262976
    s_add_u32 s21, s20, 0
    buffer_load_dwordx4 a[0:3], v1, s[8:11], s21 offen offset:0
    buffer_load_dwordx4 a[4:7], v1, s[8:11], s21 offen offset:1024
    s_add_u32 s21, s20, 2048
    buffer_load_dwordx4 a[8:11], v1, s[8:11], s21 offen offset:0
    buffer_load_dwordx4 a[12:15], v1, s[8:11], s21 offen offset:1024
    s_add_u32 s21, s20, 4096
    buffer_load_dwordx4 a[16:19], v1, s[8:11], s21 offen offset:0
    buffer_load_dwordx4 a[20:23], v1, s[8:11], s21 offen offset:1024
    s_add_u32 s21, s20, 6144
    buffer_load_dwordx4 a[24:27], v1, s[8:11], s21 offen offset:0
    buffer_load_dwordx4 a[28:31], v1, s[8:11], s21 offen offset:1024
    s_add_u32 s21, s20, 8192
    buffer_load_dwordx4 a[32:35], v1, s[8:11], s21 offen offset:0
    buffer_load_dwordx4 a[36:39], v1, s[8:11], s21 offen offset:1024
    s_add_u32 s21, s20, 10240
    buffer_load_dwordx4 a[40:43], v1, s[8:11], s21 offen offset:0
    buffer_load_dwordx4 a[44:47], v1, s[8:11], s21 offen offset:1024
    s_add_u32 s21, s20, 12288
    buffer_load_dwordx4 a[48:51], v1, s[8:11], s21 offen offset:0
    buffer_load_dwordx4 a[52:55], v1, s[8:11], s21 offen offset:1024
    s_add_u32 s21, s20, 14336
    buffer_load_dwordx4 a[56:59], v1, s[8:11], s21 offen offset:0
    buffer_load_dwordx4 a[60:63], v1, s[8:11], s21 offen offset:1024
    s_add_u32 s21, s20, 16384
    buffer_load_dwordx4 a[64:67], v1, s[8:11], s21 offen offset:0
    buffer_load_dwordx4 a[68:71], v1, s[8:11], s21 offen offset:1024
    s_add_u32 s21, s20, 18432
    buffer_load_dwordx4 a[72:75], v1, s[8:11], s21 offen offset:0
    buffer_load_dwordx4 a[76:79], v1, s[8:11], s21 offen offset:1024
    s_add_u32 s21, s20, 20480
    buffer_load_dwordx4 a[80:83], v1, s[8:11], s21 offen offset:0
    buffer_load_dwordx4 a[84:87], v1, s[8:11], s21 offen offset:1024
    s_add_u32 s21, s20, 22528
    buffer_load_dwordx4 a[88:91], v1, s[8:11], s21 offen offset:0
    buffer_load_dwordx4 a[92:95], v1, s[8:11], s21 offen offset:1024
    s_add_u32 s21, s20, 24576
    buffer_load_dwordx4 a[96:99], v1, s[8:11], s21 offen offset:0
    buffer_load_dwordx4 a[100:103], v1, s[8:11], s21 offen offset:1024
    s_add_u32 s21, s20, 26624
    buffer_load_dwordx4 a[104:107], v1, s[8:11], s21 offen offset:0
    buffer_load_dwordx4 a[108:111], v1, s[8:11], s21 offen offset:1024
    s_add_u32 s21, s20, 28672
    buffer_load_dwordx4 a[112:115], v1, s[8:11], s21 offen offset:0
    buffer_load_dwordx4 a[116:119], v1, s[8:11], s21 offen offset:1024
    s_add_u32 s21, s20, 30720
    buffer_load_dwordx4 a[120:123], v1, s[8:11], s21 offen offset:0
    buffer_load_dwordx4 a[124:127], v1, s[8:11], s21 offen offset:1024
    s_add_u32 s21, s20, 32768
    buffer_load_dwordx4 a[128:131], v1, s[8:11], s21 offen offset:0
    buffer_load_dwordx4 a[132:135], v1, s[8:11], s21 offen offset:1024
    s_add_u32 s21, s20, 34816
    buffer_load_dwordx4 a[136:139], v1, s[8:11], s21 offen offset:0
    buffer_load_dwordx4 a[140:143], v1, s[8:11], s21 offen offset:1024
    s_add_u32 s21, s20, 36864
    buffer_load_dwordx4 a[144:147], v1, s[8:11], s21 offen offset:0
    buffer_load_dwordx4 a[148:151], v1, s[8:11], s21 offen offset:1024
    s_add_u32 s21, s20, 38912
    buffer_load_dwordx4 a[152:155], v1, s[8:11], s21 offen offset:0
    buffer_load_dwordx4 a[156:159], v1, s[8:11], s21 offen offset:1024
    s_add_u32 s21, s20, 40960
    buffer_load_dwordx4 a[160:163], v1, s[8:11], s21 offen offset:0
    buffer_load_dwordx4 a[164:167], v1, s[8:11], s21 offen offset:1024
    s_add_u32 s21, s20, 43008
    buffer_load_dwordx4 a[168:171], v1, s[8:11], s21 offen offset:0
    buffer_load_dwordx4 a[172:175], v1, s[8:11], s21 offen offset:1024
    s_add_u32 s21, s20, 45056
    buffer_load_dwordx4 a[176:179], v1, s[8:11], s21 offen offset:0
    buffer_load_dwordx4 a[180:183], v1, s[8:11], s21 offen offset:1024
    s_add_u32 s21, s20, 47104
    buffer_load_dwordx4 a[184:187], v1, s[8:11], s21 offen offset:0
    buffer_load_dwordx4 a[188:191], v1, s[8:11], s21 offen offset:1024
    s_add_u32 s21, s20, 49152
    buffer_load_dwordx4 a[192:195], v1, s[8:11], s21 offen offset:0
    buffer_load_dwordx4 a[196:199], v1, s[8:11], s21 offen offset:1024
    s_add_u32 s21, s20, 51200
    buffer_load_dwordx4 a[200:203], v1, s[8:11], s21 offen offset:0
    buffer_load_dwordx4 a[204:207], v1, s[8:11], s21 offen offset:1024
    s_add_u32 s21, s20, 53248
    buffer_load_dwordx4 a[208:211], v1, s[8:11], s21 offen offset:0
    buffer_load_dwordx4 a[212:215], v1, s[8:11], s21 offen offset:1024
    s_add_u32 s21, s20, 55296
    buffer_load_dwordx4 a[216:219], v1, s[8:11], s21 offen offset:0
    buffer_load_dwordx4 a[220:223], v1, s[8:11], s21 offen offset:1024
    s_add_u32 s21, s20, 57344
    buffer_load_dwordx4 a[224:227], v1, s[8:11], s21 offen offset:0
    buffer_load_dwordx4 a[228:231], v1, s[8:11], s21 offen offset:1024
    s_add_u32 s21, s20, 59392
    buffer_load_dwordx4 a[232:235], v1, s[8:11], s21 offen offset:0
    buffer_load_dwordx4 a[236:239], v1, s[8:11], s21 offen offset:1024
    s_add_u32 s21, s20, 61440
    buffer_load_dwordx4 a[240:243], v1, s[8:11], s21 offen offset:0
    buffer_load_dwordx4 a[244:247], v1, s[8:11], s21 offen offset:1024
    s_add_u32 s21, s20, 63488
    buffer_load_dwordx4 a[248:251], v1, s[8:11], s21 offen offset:0
    buffer_load_dwordx4 a[252:255], v1, s[8:11], s21 offen offset:1024
    s_add_u32 s21, s20, 65536
    buffer_load_dwordx4 v[176:179], v1, s[8:11], s21 offen offset:0
    buffer_load_dwordx4 v[180:183], v1, s[8:11], s21 offen offset:1024
    s_add_u32 s21, s20, 67584
    buffer_load_dwordx4 v[184:187], v1, s[8:11], s21 offen offset:0
    buffer_load_dwordx4 v[188:191], v1, s[8:11], s21 offen offset:1024
    s_add_u32 s21, s20, 69632
    buffer_load_dwordx4 v[192:195], v1, s[8:11], s21 offen offset:0
    buffer_load_dwordx4 v[196:199], v1, s[8:11], s21 offen offset:1024
    s_add_u32 s21, s20, 71680
    buffer_load_dwordx4 v[200:203], v1, s[8:11], s21 offen offset:0
    buffer_load_dwordx4 v[204:207], v1, s[8:11], s21 offen offset:1024
    s_add_u32 s21, s20, 73728
    buffer_load_dwordx4 v[208:211], v1, s[8:11], s21 offen offset:0
    buffer_load_dwordx4 v[212:215], v1, s[8:11], s21 offen offset:1024
    s_add_u32 s21, s20, 75776
    buffer_load_dwordx4 v[216:219], v1, s[8:11], s21 offen offset:0
    buffer_load_dwordx4 v[220:223], v1, s[8:11], s21 offen offset:1024
    s_add_u32 s21, s20, 77824
    buffer_load_dwordx4 v[224:227], v1, s[8:11], s21 offen offset:0
    buffer_load_dwordx4 v[228:231], v1, s[8:11], s21 offen offset:1024
    s_add_u32 s21, s20, 79872
    buffer_load_dwordx4 v[232:235], v1, s[8:11], s21 offen offset:0
    buffer_load_dwordx4 v[236:239], v1, s[8:11], s21 offen offset:1024
    s_mov_b32 s14, 0
    s_lshl_b32 s20, s12, 7
    v_mov_b32 v9, s20
    s_mov_b32 s47, 0
layerb1_kernel_y0_step:
    s_cmp_lt_u32 s14, 32
    s_cselect_b32 s18, s16, s17
    s_and_b32 s20, s14, 31
    s_lshl_b32 s20, s20, 16
    s_add_u32 s18, s18, s20
    s_cmp_gt_u32 s47, s14
    s_cbranch_scc1 layerb1_kernel_y0_gw_ok
layerb1_kernel_y0_gw_lp:
    buffer_load_dword v116, v9, s[8:11], s48 offen sc1
    s_waitcnt vmcnt(0)
    v_readlane_b32 s47, v116, 0
    s_nop 0
    s_sub_u32 s15, s15, 1
    s_cbranch_scc1 layerb1_kernel_bail
    s_cmp_gt_u32 s47, s14
    s_cbranch_scc0 layerb1_kernel_y0_gw_lp
layerb1_kernel_y0_gw_ok:
    s_mul_i32 s28, s14, 1638400
    s_add_u32 s28, s28, s46
    buffer_load_dwordx4 v[76:79], v4, s[8:11], s28 offen offset:128 sc1
    buffer_load_dwordx4 v[80:83], v4, s[8:11], s28 offen offset:256 sc1
    buffer_load_dwordx4 v[84:87], v4, s[8:11], s28 offen offset:384 sc1
    buffer_load_dwordx4 v[88:91], v4, s[8:11], s28 offen offset:512 sc1
    v_mov_b32 v56, 0
    v_mov_b32 v57, 0
    v_mov_b32 v58, 0
    v_mov_b32 v59, 0
    v_mov_b32 v60, 0
    v_mov_b32 v61, 0
    v_mov_b32 v62, 0
    v_mov_b32 v63, 0
    v_mov_b32 v64, 0
    v_mov_b32 v65, 0
    v_mov_b32 v66, 0
    v_mov_b32 v67, 0
    v_mov_b32 v68, 0
    v_mov_b32 v69, 0
    v_mov_b32 v70, 0
    v_mov_b32 v71, 0
    s_add_u32 s22, s18, 36864
    s_add_u32 s23, s18, 37888
    s_add_u32 s24, s18, 38912
layerb1_kernel_y0_poll:
    buffer_load_dwordx4 v[16:19], v1, s[8:11], s22 offen sc1
    buffer_load_dwordx4 v[20:23], v1, s[8:11], s23 offen sc1
    buffer_load_dwordx4 v[24:27], v1, s[8:11], s24 offen sc1
    s_waitcnt vmcnt(0)
    ds_write_b128 v3, v[16:19] offset:0
    ds_write_b128 v3, v[20:23] offset:1024
    ds_write_b128 v3, v[24:27] offset:2048
    v_max3_u32 v116, v16, v17, v18
    v_max3_u32 v116, v116, v19, v20
    v_max3_u32 v116, v116, v21, v22
    v_max3_u32 v116, v116, v23, v24
    v_max3_u32 v116, v116, v25, v26
    v_max_u32 v116, v116, v27
    v_cmp_eq_u32 vcc, -1, v116
    s_sub_u32 s15, s15, 1
    s_cbranch_scc1 layerb1_kernel_bail
    s_cbranch_vccnz layerb1_kernel_y0_poll
    s_waitcnt lgkmcnt(0)
    s_barrier
    ds_read_b128 v[28:31], v3 offset:3072
    ds_read_b128 v[32:35], v3 offset:4096
    ds_read_b128 v[36:39], v3 offset:5120
    ds_read_b128 v[40:43], v3 offset:6144
    ds_read_b128 v[44:47], v3 offset:7168
    ds_read_b128 v[48:51], v3 offset:8192
    ds_read_b128 v[52:55], v3 offset:9216
    v_smfmac_f32_16x16x64_bf16 v[56:59], v[16:19], a[0:7], v2
    v_smfmac_f32_16x16x64_bf16 v[60:63], v[16:19], a[80:87], v2
    v_smfmac_f32_16x16x64_bf16 v[64:67], v[16:19], a[160:167], v2
    v_smfmac_f32_16x16x64_bf16 v[68:71], v[16:19], a[240:247], v2
    v_smfmac_f32_16x16x64_bf16 v[56:59], v[20:23], a[8:15], v2
    v_smfmac_f32_16x16x64_bf16 v[60:63], v[20:23], a[88:95], v2
    v_smfmac_f32_16x16x64_bf16 v[64:67], v[20:23], a[168:175], v2
    v_smfmac_f32_16x16x64_bf16 v[68:71], v[20:23], a[248:255], v2
    v_smfmac_f32_16x16x64_bf16 v[56:59], v[24:27], a[16:23], v2
    v_smfmac_f32_16x16x64_bf16 v[60:63], v[24:27], a[96:103], v2
    v_smfmac_f32_16x16x64_bf16 v[64:67], v[24:27], a[176:183], v2
    v_smfmac_f32_16x16x64_bf16 v[68:71], v[24:27], v[176:183], v2
    s_waitcnt lgkmcnt(6)
    v_smfmac_f32_16x16x64_bf16 v[56:59], v[28:31], a[24:31], v2
    v_smfmac_f32_16x16x64_bf16 v[60:63], v[28:31], a[104:111], v2
    v_smfmac_f32_16x16x64_bf16 v[64:67], v[28:31], a[184:191], v2
    v_smfmac_f32_16x16x64_bf16 v[68:71], v[28:31], v[184:191], v2
    s_waitcnt lgkmcnt(5)
    v_smfmac_f32_16x16x64_bf16 v[56:59], v[32:35], a[32:39], v2
    v_smfmac_f32_16x16x64_bf16 v[60:63], v[32:35], a[112:119], v2
    v_smfmac_f32_16x16x64_bf16 v[64:67], v[32:35], a[192:199], v2
    v_smfmac_f32_16x16x64_bf16 v[68:71], v[32:35], v[192:199], v2
    s_waitcnt lgkmcnt(4)
    v_smfmac_f32_16x16x64_bf16 v[56:59], v[36:39], a[40:47], v2
    v_smfmac_f32_16x16x64_bf16 v[60:63], v[36:39], a[120:127], v2
    v_smfmac_f32_16x16x64_bf16 v[64:67], v[36:39], a[200:207], v2
    v_smfmac_f32_16x16x64_bf16 v[68:71], v[36:39], v[200:207], v2
    s_waitcnt lgkmcnt(3)
    v_smfmac_f32_16x16x64_bf16 v[56:59], v[40:43], a[48:55], v2
    v_smfmac_f32_16x16x64_bf16 v[60:63], v[40:43], a[128:135], v2
    v_smfmac_f32_16x16x64_bf16 v[64:67], v[40:43], a[208:215], v2
    v_smfmac_f32_16x16x64_bf16 v[68:71], v[40:43], v[208:215], v2
    s_waitcnt lgkmcnt(2)
    v_smfmac_f32_16x16x64_bf16 v[56:59], v[44:47], a[56:63], v2
    v_smfmac_f32_16x16x64_bf16 v[60:63], v[44:47], a[136:143], v2
    v_smfmac_f32_16x16x64_bf16 v[64:67], v[44:47], a[216:223], v2
    v_smfmac_f32_16x16x64_bf16 v[68:71], v[44:47], v[216:223], v2
    s_waitcnt lgkmcnt(1)
    v_smfmac_f32_16x16x64_bf16 v[56:59], v[48:51], a[64:71], v2
    v_smfmac_f32_16x16x64_bf16 v[60:63], v[48:51], a[144:151], v2
    v_smfmac_f32_16x16x64_bf16 v[64:67], v[48:51], a[224:231], v2
    v_smfmac_f32_16x16x64_bf16 v[68:71], v[48:51], v[224:231], v2
    s_waitcnt lgkmcnt(0)
    v_smfmac_f32_16x16x64_bf16 v[56:59], v[52:55], a[72:79], v2
    v_smfmac_f32_16x16x64_bf16 v[60:63], v[52:55], a[152:159], v2
    v_smfmac_f32_16x16x64_bf16 v[64:67], v[52:55], a[232:239], v2
    v_smfmac_f32_16x16x64_bf16 v[68:71], v[52:55], v[232:239], v2
    s_nop 7
    v_permlane32_swap_b32 v56, v64
    v_permlane32_swap_b32 v60, v68
    v_permlane32_swap_b32 v57, v65
    v_permlane32_swap_b32 v61, v69
    v_permlane32_swap_b32 v58, v66
    v_permlane32_swap_b32 v62, v70
    v_permlane32_swap_b32 v59, v67
    v_permlane32_swap_b32 v63, v71
    v_add_f32 v56, v56, v64
    v_add_f32 v60, v60, v68
    v_add_f32 v57, v57, v65
    v_add_f32 v61, v61, v69
    v_add_f32 v58, v58, v66
    v_add_f32 v62, v62, v70
    v_add_f32 v59, v59, v67
    v_add_f32 v63, v63, v71
    s_nop 1
    v_permlane16_swap_b32 v56, v60
    v_permlane16_swap_b32 v57, v61
    v_permlane16_swap_b32 v58, v62
    v_permlane16_swap_b32 v59, v63
    s_nop 1
    v_cvt_pk_bf16_f32 v72, v56, v57
    v_cvt_pk_bf16_f32 v73, v58, v59
    v_cvt_pk_bf16_f32 v74, v60, v61
    v_cvt_pk_bf16_f32 v75, v62, v63
    buffer_store_dwordx4 v[72:75], v4, s[8:11], s28 offen sc1
    s_cmp_eq_u32 s14, 63
    s_cbranch_scc1 layerb1_kernel_y0_last
    s_add_u32 s30, s18, 0
    s_add_u32 s31, s18, 4096
    s_add_u32 s32, s18, 16384
    s_add_u32 s33, s18, 20480
    s_add_u32 s34, s18, 32768
    s_add_u32 s29, s14, 1
    s_cmp_lt_u32 s29, 32
    s_cselect_b32 s19, s16, s17
    s_and_b32 s20, s29, 31
    s_lshl_b32 s20, s20, 16
    s_add_u32 s19, s19, s20
layerb1_kernel_y0_ppoll:
    buffer_load_dwordx4 v[92:95], v5, s[8:11], s30 offen sc1
    buffer_load_dwordx4 v[96:99], v5, s[8:11], s31 offen sc1
    buffer_load_dwordx4 v[100:103], v5, s[8:11], s32 offen sc1
    buffer_load_dwordx4 v[104:107], v5, s[8:11], s33 offen sc1
    buffer_load_dwordx4 v[108:111], v5, s[8:11], s34 offen sc1
    s_waitcnt vmcnt(0)
    v_mfma_f32_16x16x32_bf16 v[112:115], v[92:95], v[72:75], 0
    v_mfma_f32_16x16x32_bf16 v[112:115], v[96:99], v[76:79], v[112:115]
    v_mfma_f32_16x16x32_bf16 v[112:115], v[100:103], v[80:83], v[112:115]
    v_mfma_f32_16x16x32_bf16 v[112:115], v[104:107], v[84:87], v[112:115]
    v_mfma_f32_16x16x32_bf16 v[112:115], v[108:111], v[88:91], v[112:115]
    v_max3_u32 v116, v92, v93, v94
    v_max3_u32 v116, v116, v95, v96
    v_max3_u32 v116, v116, v97, v98
    v_max3_u32 v116, v116, v99, v100
    v_max3_u32 v116, v116, v101, v102
    v_max3_u32 v116, v116, v103, v104
    v_max3_u32 v116, v116, v105, v106
    v_max3_u32 v116, v116, v107, v108
    v_max3_u32 v116, v116, v109, v110
    v_max_u32 v116, v116, v111
    v_cmp_eq_u32 vcc, -1, v116
    s_sub_u32 s15, s15, 1
    s_cbranch_scc1 layerb1_kernel_bail
    s_cbranch_vccnz layerb1_kernel_y0_ppoll
    ds_write_b128 v6, v[112:115]
    s_waitcnt lgkmcnt(0)
    s_barrier
    ds_read2st64_b32 v[116:117], v7 offset0:0 offset1:1
    ds_read2st64_b32 v[118:119], v7 offset0:2 offset1:3
    ds_read2st64_b32 v[120:121], v7 offset0:4 offset1:5
    ds_read2st64_b32 v[122:123], v7 offset0:6 offset1:7
    s_waitcnt lgkmcnt(2)
    v_add_f32 v116, v116, v117
    v_add_f32 v118, v118, v119
    s_waitcnt lgkmcnt(0)
    v_add_f32 v120, v120, v121
    v_add_f32 v122, v122, v123
    v_add_f32 v116, v116, v118
    v_add_f32 v120, v120, v122
    v_add_f32 v116, v116, v120
    s_nop 1
    v_mov_b32_dpp v117, v116 quad_perm:[1,0,3,2] row_mask:0xf bank_mask:0xf
    v_cvt_pk_bf16_f32 v124, v116, v117
    s_nop 1
    v_mov_b32_dpp v125, v124 row_shl:2 row_mask:0xf bank_mask:0xf
    v_mov_b32_dpp v126, v124 row_shl:4 row_mask:0xf bank_mask:0xf
    v_mov_b32_dpp v127, v124 row_shl:6 row_mask:0xf bank_mask:0xf
    s_mov_b64 exec, s[40:41]
    buffer_store_dwordx4 v[124:127], v8, s[8:11], s19 offen sc1
    s_mov_b64 exec, -1
    s_lshl_b32 s20, s12, 7
    s_add_u32 s20, s20, 20480
    s_mov_b64 exec, 1
    v_mov_b32 v116, s20
    v_mov_b32 v117, s29
    buffer_store_dword v117, v116, s[8:11], s48 offen sc1
    s_mov_b64 exec, -1
    s_add_u32 s14, s14, 1
    s_branch layerb1_kernel_y0_step
layerb1_kernel_y0_last:
    s_waitcnt vmcnt(0)
    s_barrier
    s_lshl_b32 s20, s12, 7
    s_add_u32 s20, s20, 20480
    s_mov_b32 s29, 64
    s_mov_b64 exec, 1
    v_mov_b32 v116, s20
    v_mov_b32 v117, s29
    buffer_store_dword v117, v116, s[8:11], s48 offen sc1
    s_mov_b64 exec, -1
    s_branch layerb1_kernel_end
layerb1_kernel_y1_start:
    v_lshrrev_b32 v16, 4, v0
    v_and_b32 v17, 7, v0
    v_lshrrev_b32 v18, 3, v0
    v_and_b32 v18, 1, v18
    v_lshl_add_u32 v19, v18, 2, v16
    v_add_u32 v19, 8, v19
    v_mul_u32_u24 v20, 640, v19
    v_lshl_add_u32 v4, v17, 4, v20
    v_and_b32 v20, 3, v17
    v_lshlrev_b32 v20, 1, v20
    v_lshrrev_b32 v21, 2, v17
    v_add_u32 v20, v20, v21
    v_lshlrev_b32 v20, 4, v20
    v_lshl_add_u32 v5, v19, 7, v20
    v_add_u32 v3, 0, v1
    v_lshlrev_b32 v20, 8, v18
    v_lshl_add_u32 v20, v17, 5, v20
    v_and_b32 v21, 1, v16
    v_lshl_add_u32 v20, v21, 4, v20
    v_add_u32 v20, 10752, v20
    v_add_u32 v21, 12288, v1
    v_lshrrev_b32 v22, 1, v16
    v_cmp_eq_u32 vcc, v22, v18
    s_nop 1
    v_cndmask_b32 v6, v21, v20, vcc
    v_lshrrev_b32 v20, 3, v0
    v_lshlrev_b32 v20, 2, v20
    v_lshl_add_u32 v20, v17, 5, v20
    v_add_u32 v7, 10240, v20
    s_lshl_b32 s20, s12, 7
    s_add_u32 s20, s20, 20480
    s_lshr_b32 s21, s20, 13
    s_lshl_b32 s21, s21, 14
    s_and_b32 s20, s20, 8191
    s_add_u32 s20, s20, s21
    v_lshrrev_b32 v20, 3, v0
    v_lshlrev_b32 v20, 4, v20
    v_add_u32 v8, s20, v20
    s_mul_i32 s46, s12, 20480
    s_add_u32 s46, s46, 103809024
    s_mul_i32 s20, s12, 327680
    s_add_u32 s20, s20, 27344896
    s_add_u32 s21, s20, 0
    buffer_load_dwordx4 a[0:3], v1, s[8:11], s21 offen offset:0
    buffer_load_dwordx4 a[4:7], v1, s[8:11], s21 offen offset:1024
    s_add_u32 s21, s20, 2048
    buffer_load_dwordx4 a[8:11], v1, s[8:11], s21 offen offset:0
    buffer_load_dwordx4 a[12:15], v1, s[8:11], s21 offen offset:1024
    s_add_u32 s21, s20, 4096
    buffer_load_dwordx4 a[16:19], v1, s[8:11], s21 offen offset:0
    buffer_load_dwordx4 a[20:23], v1, s[8:11], s21 offen offset:1024
    s_add_u32 s21, s20, 6144
    buffer_load_dwordx4 a[24:27], v1, s[8:11], s21 offen offset:0
    buffer_load_dwordx4 a[28:31], v1, s[8:11], s21 offen offset:1024
    s_add_u32 s21, s20, 8192
    buffer_load_dwordx4 a[32:35], v1, s[8:11], s21 offen offset:0
    buffer_load_dwordx4 a[36:39], v1, s[8:11], s21 offen offset:1024
    s_add_u32 s21, s20, 10240
    buffer_load_dwordx4 a[40:43], v1, s[8:11], s21 offen offset:0
    buffer_load_dwordx4 a[44:47], v1, s[8:11], s21 offen offset:1024
    s_add_u32 s21, s20, 12288
    buffer_load_dwordx4 a[48:51], v1, s[8:11], s21 offen offset:0
    buffer_load_dwordx4 a[52:55], v1, s[8:11], s21 offen offset:1024
    s_add_u32 s21, s20, 14336
    buffer_load_dwordx4 a[56:59], v1, s[8:11], s21 offen offset:0
    buffer_load_dwordx4 a[60:63], v1, s[8:11], s21 offen offset:1024
    s_add_u32 s21, s20, 16384
    buffer_load_dwordx4 a[64:67], v1, s[8:11], s21 offen offset:0
    buffer_load_dwordx4 a[68:71], v1, s[8:11], s21 offen offset:1024
    s_add_u32 s21, s20, 18432
    buffer_load_dwordx4 a[72:75], v1, s[8:11], s21 offen offset:0
    buffer_load_dwordx4 a[76:79], v1, s[8:11], s21 offen offset:1024
    s_add_u32 s21, s20, 20480
    buffer_load_dwordx4 a[80:83], v1, s[8:11], s21 offen offset:0
    buffer_load_dwordx4 a[84:87], v1, s[8:11], s21 offen offset:1024
    s_add_u32 s21, s20, 22528
    buffer_load_dwordx4 a[88:91], v1, s[8:11], s21 offen offset:0
    buffer_load_dwordx4 a[92:95], v1, s[8:11], s21 offen offset:1024
    s_add_u32 s21, s20, 24576
    buffer_load_dwordx4 a[96:99], v1, s[8:11], s21 offen offset:0
    buffer_load_dwordx4 a[100:103], v1, s[8:11], s21 offen offset:1024
    s_add_u32 s21, s20, 26624
    buffer_load_dwordx4 a[104:107], v1, s[8:11], s21 offen offset:0
    buffer_load_dwordx4 a[108:111], v1, s[8:11], s21 offen offset:1024
    s_add_u32 s21, s20, 28672
    buffer_load_dwordx4 a[112:115], v1, s[8:11], s21 offen offset:0
    buffer_load_dwordx4 a[116:119], v1, s[8:11], s21 offen offset:1024
    s_add_u32 s21, s20, 30720
    buffer_load_dwordx4 a[120:123], v1, s[8:11], s21 offen offset:0
    buffer_load_dwordx4 a[124:127], v1, s[8:11], s21 offen offset:1024
    s_add_u32 s21, s20, 32768
    buffer_load_dwordx4 a[128:131], v1, s[8:11], s21 offen offset:0
    buffer_load_dwordx4 a[132:135], v1, s[8:11], s21 offen offset:1024
    s_add_u32 s21, s20, 34816
    buffer_load_dwordx4 a[136:139], v1, s[8:11], s21 offen offset:0
    buffer_load_dwordx4 a[140:143], v1, s[8:11], s21 offen offset:1024
    s_add_u32 s21, s20, 36864
    buffer_load_dwordx4 a[144:147], v1, s[8:11], s21 offen offset:0
    buffer_load_dwordx4 a[148:151], v1, s[8:11], s21 offen offset:1024
    s_add_u32 s21, s20, 38912
    buffer_load_dwordx4 a[152:155], v1, s[8:11], s21 offen offset:0
    buffer_load_dwordx4 a[156:159], v1, s[8:11], s21 offen offset:1024
    s_add_u32 s21, s20, 40960
    buffer_load_dwordx4 a[160:163], v1, s[8:11], s21 offen offset:0
    buffer_load_dwordx4 a[164:167], v1, s[8:11], s21 offen offset:1024
    s_add_u32 s21, s20, 43008
    buffer_load_dwordx4 a[168:171], v1, s[8:11], s21 offen offset:0
    buffer_load_dwordx4 a[172:175], v1, s[8:11], s21 offen offset:1024
    s_add_u32 s21, s20, 45056
    buffer_load_dwordx4 a[176:179], v1, s[8:11], s21 offen offset:0
    buffer_load_dwordx4 a[180:183], v1, s[8:11], s21 offen offset:1024
    s_add_u32 s21, s20, 47104
    buffer_load_dwordx4 a[184:187], v1, s[8:11], s21 offen offset:0
    buffer_load_dwordx4 a[188:191], v1, s[8:11], s21 offen offset:1024
    s_add_u32 s21, s20, 49152
    buffer_load_dwordx4 a[192:195], v1, s[8:11], s21 offen offset:0
    buffer_load_dwordx4 a[196:199], v1, s[8:11], s21 offen offset:1024
    s_add_u32 s21, s20, 51200
    buffer_load_dwordx4 a[200:203], v1, s[8:11], s21 offen offset:0
    buffer_load_dwordx4 a[204:207], v1, s[8:11], s21 offen offset:1024
    s_add_u32 s21, s20, 53248
    buffer_load_dwordx4 a[208:211], v1, s[8:11], s21 offen offset:0
    buffer_load_dwordx4 a[212:215], v1, s[8:11], s21 offen offset:1024
    s_add_u32 s21, s20, 55296
    buffer_load_dwordx4 a[216:219], v1, s[8:11], s21 offen offset:0
    buffer_load_dwordx4 a[220:223], v1, s[8:11], s21 offen offset:1024
    s_add_u32 s21, s20, 57344
    buffer_load_dwordx4 a[224:227], v1, s[8:11], s21 offen offset:0
    buffer_load_dwordx4 a[228:231], v1, s[8:11], s21 offen offset:1024
    s_add_u32 s21, s20, 59392
    buffer_load_dwordx4 a[232:235], v1, s[8:11], s21 offen offset:0
    buffer_load_dwordx4 a[236:239], v1, s[8:11], s21 offen offset:1024
    s_add_u32 s21, s20, 61440
    buffer_load_dwordx4 a[240:243], v1, s[8:11], s21 offen offset:0
    buffer_load_dwordx4 a[244:247], v1, s[8:11], s21 offen offset:1024
    s_add_u32 s21, s20, 63488
    buffer_load_dwordx4 a[248:251], v1, s[8:11], s21 offen offset:0
    buffer_load_dwordx4 a[252:255], v1, s[8:11], s21 offen offset:1024
    s_add_u32 s21, s20, 65536
    buffer_load_dwordx4 v[176:179], v1, s[8:11], s21 offen offset:0
    buffer_load_dwordx4 v[180:183], v1, s[8:11], s21 offen offset:1024
    s_add_u32 s21, s20, 67584
    buffer_load_dwordx4 v[184:187], v1, s[8:11], s21 offen offset:0
    buffer_load_dwordx4 v[188:191], v1, s[8:11], s21 offen offset:1024
    s_add_u32 s21, s20, 69632
    buffer_load_dwordx4 v[192:195], v1, s[8:11], s21 offen offset:0
    buffer_load_dwordx4 v[196:199], v1, s[8:11], s21 offen offset:1024
    s_add_u32 s21, s20, 71680
    buffer_load_dwordx4 v[200:203], v1, s[8:11], s21 offen offset:0
    buffer_load_dwordx4 v[204:207], v1, s[8:11], s21 offen offset:1024
    s_add_u32 s21, s20, 73728
    buffer_load_dwordx4 v[208:211], v1, s[8:11], s21 offen offset:0
    buffer_load_dwordx4 v[212:215], v1, s[8:11], s21 offen offset:1024
    s_add_u32 s21, s20, 75776
    buffer_load_dwordx4 v[216:219], v1, s[8:11], s21 offen offset:0
    buffer_load_dwordx4 v[220:223], v1, s[8:11], s21 offen offset:1024
    s_add_u32 s21, s20, 77824
    buffer_load_dwordx4 v[224:227], v1, s[8:11], s21 offen offset:0
    buffer_load_dwordx4 v[228:231], v1, s[8:11], s21 offen offset:1024
    s_add_u32 s21, s20, 79872
    buffer_load_dwordx4 v[232:235], v1, s[8:11], s21 offen offset:0
    buffer_load_dwordx4 v[236:239], v1, s[8:11], s21 offen offset:1024
    s_mov_b32 s14, 0
    s_lshl_b32 s20, s12, 7
    v_mov_b32 v9, s20
    s_mov_b32 s47, 0
layerb1_kernel_y1_step:
    s_cmp_lt_u32 s14, 32
    s_cselect_b32 s18, s16, s17
    s_and_b32 s20, s14, 31
    s_lshl_b32 s20, s20, 16
    s_add_u32 s18, s18, s20
    s_cmp_gt_u32 s47, s14
    s_cbranch_scc1 layerb1_kernel_y1_gw_ok
layerb1_kernel_y1_gw_lp:
    buffer_load_dword v116, v9, s[8:11], s48 offen sc1
    s_waitcnt vmcnt(0)
    v_readlane_b32 s47, v116, 0
    s_nop 0
    s_sub_u32 s15, s15, 1
    s_cbranch_scc1 layerb1_kernel_bail
    s_cmp_gt_u32 s47, s14
    s_cbranch_scc0 layerb1_kernel_y1_gw_lp
layerb1_kernel_y1_gw_ok:
    s_mul_i32 s28, s14, 1638400
    s_add_u32 s28, s28, s46
    buffer_load_dwordx4 v[76:79], v4, s[8:11], s28 offen offset:128 sc1
    buffer_load_dwordx4 v[80:83], v4, s[8:11], s28 offen offset:256 sc1
    buffer_load_dwordx4 v[84:87], v4, s[8:11], s28 offen offset:384 sc1
    buffer_load_dwordx4 v[88:91], v4, s[8:11], s28 offen offset:512 sc1
    v_mov_b32 v56, 0
    v_mov_b32 v57, 0
    v_mov_b32 v58, 0
    v_mov_b32 v59, 0
    v_mov_b32 v60, 0
    v_mov_b32 v61, 0
    v_mov_b32 v62, 0
    v_mov_b32 v63, 0
    v_mov_b32 v64, 0
    v_mov_b32 v65, 0
    v_mov_b32 v66, 0
    v_mov_b32 v67, 0
    v_mov_b32 v68, 0
    v_mov_b32 v69, 0
    v_mov_b32 v70, 0
    v_mov_b32 v71, 0
    s_add_u32 s22, s18, 39936
    s_add_u32 s23, s18, 49152
    s_add_u32 s24, s18, 50176
layerb1_kernel_y1_poll:
    buffer_load_dwordx4 v[28:31], v1, s[8:11], s22 offen sc1
    buffer_load_dwordx4 v[32:35], v1, s[8:11], s23 offen sc1
    buffer_load_dwordx4 v[36:39], v1, s[8:11], s24 offen sc1
    s_waitcnt vmcnt(0)
    ds_write_b128 v3, v[28:31] offset:3072
    ds_write_b128 v3, v[32:35] offset:4096
    ds_write_b128 v3, v[36:39] offset:5120
    v_max3_u32 v116, v28, v29, v30
    v_max3_u32 v116, v116, v31, v32
    v_max3_u32 v116, v116, v33, v34
    v_max3_u32 v116, v116, v35, v36
    v_max3_u32 v116, v116, v37, v38
    v_max_u32 v116, v116, v39
    v_cmp_eq_u32 vcc, -1, v116
    s_sub_u32 s15, s15, 1
    s_cbranch_scc1 layerb1_kernel_bail
    s_cbranch_vccnz layerb1_kernel_y1_poll
    s_waitcnt lgkmcnt(0)
    s_barrier
    ds_read_b128 v[16:19], v3 offset:0
    ds_read_b128 v[20:23], v3 offset:1024
    ds_read_b128 v[24:27], v3 offset:2048
    ds_read_b128 v[40:43], v3 offset:6144
    ds_read_b128 v[44:47], v3 offset:7168
    ds_read_b128 v[48:51], v3 offset:8192
    ds_read_b128 v[52:55], v3 offset:9216
    v_smfmac_f32_16x16x64_bf16 v[56:59], v[28:31], a[24:31], v2
    v_smfmac_f32_16x16x64_bf16 v[60:63], v[28:31], a[104:111], v2
    v_smfmac_f32_16x16x64_bf16 v[64:67], v[28:31], a[184:191], v2
    v_smfmac_f32_16x16x64_bf16 v[68:71], v[28:31], v[184:191], v2
    v_smfmac_f32_16x16x64_bf16 v[56:59], v[32:35], a[32:39], v2
    v_smfmac_f32_16x16x64_bf16 v[60:63], v[32:35], a[112:119], v2
    v_smfmac_f32_16x16x64_bf16 v[64:67], v[32:35], a[192:199], v2
    v_smfmac_f32_16x16x64_bf16 v[68:71], v[32:35], v[192:199], v2
    v_smfmac_f32_16x16x64_bf16 v[56:59], v[36:39], a[40:47], v2
    v_smfmac_f32_16x16x64_bf16 v[60:63], v[36:39], a[120:127], v2
    v_smfmac_f32_16x16x64_bf16 v[64:67], v[36:39], a[200:207], v2
    v_smfmac_f32_16x16x64_bf16 v[68:71], v[36:39], v[200:207], v2
    s_waitcnt lgkmcnt(6)
    v_smfmac_f32_16x16x64_bf16 v[56:59], v[16:19], a[0:7], v2
    v_smfmac_f32_16x16x64_bf16 v[60:63], v[16:19], a[80:87], v2
    v_smfmac_f32_16x16x64_bf16 v[64:67], v[16:19], a[160:167], v2
    v_smfmac_f32_16x16x64_bf16 v[68:71], v[16:19], a[240:247], v2
    s_waitcnt lgkmcnt(5)
    v_smfmac_f32_16x16x64_bf16 v[56:59], v[20:23], a[8:15], v2
    v_smfmac_f32_16x16x64_bf16 v[60:63], v[20:23], a[88:95], v2
    v_smfmac_f32_16x16x64_bf16 v[64:67], v[20:23], a[168:175], v2
    v_smfmac_f32_16x16x64_bf16 v[68:71], v[20:23], a[248:255], v2
    s_waitcnt lgkmcnt(4)
    v_smfmac_f32_16x16x64_bf16 v[56:59], v[24:27], a[16:23], v2
    v_smfmac_f32_16x16x64_bf16 v[60:63], v[24:27], a[96:103], v2
    v_smfmac_f32_16x16x64_bf16 v[64:67], v[24:27], a[176:183], v2
    v_smfmac_f32_16x16x64_bf16 v[68:71], v[24:27], v[176:183], v2
    s_waitcnt lgkmcnt(3)
    v_smfmac_f32_16x16x64_bf16 v[56:59], v[40:43], a[48:55], v2
    v_smfmac_f32_16x16x64_bf16 v[60:63], v[40:43], a[128:135], v2
    v_smfmac_f32_16x16x64_bf16 v[64:67], v[40:43], a[208:215], v2
    v_smfmac_f32_16x16x64_bf16 v[68:71], v[40:43], v[208:215], v2
    s_waitcnt lgkmcnt(2)
    v_smfmac_f32_16x16x64_bf16 v[56:59], v[44:47], a[56:63], v2
    v_smfmac_f32_16x16x64_bf16 v[60:63], v[44:47], a[136:143], v2
    v_smfmac_f32_16x16x64_bf16 v[64:67], v[44:47], a[216:223], v2
    v_smfmac_f32_16x16x64_bf16 v[68:71], v[44:47], v[216:223], v2
    s_waitcnt lgkmcnt(1)
    v_smfmac_f32_16x16x64_bf16 v[56:59], v[48:51], a[64:71], v2
    v_smfmac_f32_16x16x64_bf16 v[60:63], v[48:51], a[144:151], v2
    v_smfmac_f32_16x16x64_bf16 v[64:67], v[48:51], a[224:231], v2
    v_smfmac_f32_16x16x64_bf16 v[68:71], v[48:51], v[224:231], v2
    s_waitcnt lgkmcnt(0)
    v_smfmac_f32_16x16x64_bf16 v[56:59], v[52:55], a[72:79], v2
    v_smfmac_f32_16x16x64_bf16 v[60:63], v[52:55], a[152:159], v2
    v_smfmac_f32_16x16x64_bf16 v[64:67], v[52:55], a[232:239], v2
    v_smfmac_f32_16x16x64_bf16 v[68:71], v[52:55], v[232:239], v2
    s_nop 7
    v_permlane32_swap_b32 v56, v64
    v_permlane32_swap_b32 v60, v68
    v_permlane32_swap_b32 v57, v65
    v_permlane32_swap_b32 v61, v69
    v_permlane32_swap_b32 v58, v66
    v_permlane32_swap_b32 v62, v70
    v_permlane32_swap_b32 v59, v67
    v_permlane32_swap_b32 v63, v71
    v_add_f32 v56, v56, v64
    v_add_f32 v60, v60, v68
    v_add_f32 v57, v57, v65
    v_add_f32 v61, v61, v69
    v_add_f32 v58, v58, v66
    v_add_f32 v62, v62, v70
    v_add_f32 v59, v59, v67
    v_add_f32 v63, v63, v71
    s_nop 1
    v_permlane16_swap_b32 v56, v60
    v_permlane16_swap_b32 v57, v61
    v_permlane16_swap_b32 v58, v62
    v_permlane16_swap_b32 v59, v63
    s_nop 1
    v_cvt_pk_bf16_f32 v72, v56, v57
    v_cvt_pk_bf16_f32 v73, v58, v59
    v_cvt_pk_bf16_f32 v74, v60, v61
    v_cvt_pk_bf16_f32 v75, v62, v63
    buffer_store_dwordx4 v[72:75], v4, s[8:11], s28 offen sc1
    s_cmp_eq_u32 s14, 63
    s_cbranch_scc1 layerb1_kernel_y1_last
    s_add_u32 s30, s18, 0
    s_add_u32 s31, s18, 4096
    s_add_u32 s32, s18, 16384
    s_add_u32 s33, s18, 20480
    s_add_u32 s34, s18, 32768
    s_add_u32 s29, s14, 1
    s_cmp_lt_u32 s29, 32
    s_cselect_b32 s19, s16, s17
    s_and_b32 s20, s29, 31
    s_lshl_b32 s20, s20, 16
    s_add_u32 s19, s19, s20
layerb1_kernel_y1_ppoll:
    buffer_load_dwordx4 v[92:95], v5, s[8:11], s30 offen sc1
    buffer_load_dwordx4 v[96:99], v5, s[8:11], s31 offen sc1
    buffer_load_dwordx4 v[100:103], v5, s[8:11], s32 offen sc1
    buffer_load_dwordx4 v[104:107], v5, s[8:11], s33 offen sc1
    buffer_load_dwordx4 v[108:111], v5, s[8:11], s34 offen sc1
    s_waitcnt vmcnt(0)
    v_mfma_f32_16x16x32_bf16 v[112:115], v[92:95], v[72:75], 0
    v_mfma_f32_16x16x32_bf16 v[112:115], v[96:99], v[76:79], v[112:115]
    v_mfma_f32_16x16x32_bf16 v[112:115], v[100:103], v[80:83], v[112:115]
    v_mfma_f32_16x16x32_bf16 v[112:115], v[104:107], v[84:87], v[112:115]
    v_mfma_f32_16x16x32_bf16 v[112:115], v[108:111], v[88:91], v[112:115]
    v_max3_u32 v116, v92, v93, v94
    v_max3_u32 v116, v116, v95, v96
    v_max3_u32 v116, v116, v97, v98
    v_max3_u32 v116, v116, v99, v100
    v_max3_u32 v116, v116, v101, v102
    v_max3_u32 v116, v116, v103, v104
    v_max3_u32 v116, v116, v105, v106
    v_max3_u32 v116, v116, v107, v108
    v_max3_u32 v116, v116, v109, v110
    v_max_u32 v116, v116, v111
    v_cmp_eq_u32 vcc, -1, v116
    s_sub_u32 s15, s15, 1
    s_cbranch_scc1 layerb1_kernel_bail
    s_cbranch_vccnz layerb1_kernel_y1_ppoll
    ds_write_b128 v6, v[112:115]
    s_waitcnt lgkmcnt(0)
    s_barrier
    s_add_u32 s14, s14, 1
    s_branch layerb1_kernel_y1_step
layerb1_kernel_y1_last:
    s_waitcnt vmcnt(0)
    s_barrier
    s_branch layerb1_kernel_end
layerb1_kernel_y2_start:
    v_lshrrev_b32 v16, 4, v0
    v_and_b32 v17, 7, v0
    v_lshrrev_b32 v18, 3, v0
    v_and_b32 v18, 1, v18
    v_lshl_add_u32 v19, v18, 2, v16
    v_add_u32 v19, 16, v19
    v_mul_u32_u24 v20, 640, v19
    v_lshl_add_u32 v4, v17, 4, v20
    v_and_b32 v20, 3, v17
    v_lshlrev_b32 v20, 1, v20
    v_lshrrev_b32 v21, 2, v17
    v_add_u32 v20, v20, v21
    v_lshlrev_b32 v20, 4, v20
    v_lshl_add_u32 v5, v19, 7, v20
    v_add_u32 v3, 0, v1
    v_lshlrev_b32 v20, 8, v18
    v_lshl_add_u32 v20, v17, 5, v20
    v_and_b32 v21, 1, v16
    v_lshl_add_u32 v20, v21, 4, v20
    v_add_u32 v20, 11264, v20
    v_add_u32 v21, 12288, v1
    v_lshrrev_b32 v22, 1, v16
    v_cmp_eq_u32 vcc, v22, v18
    s_nop 1
    v_cndmask_b32 v6, v21, v20, vcc
    v_lshrrev_b32 v20, 3, v0
    v_lshlrev_b32 v20, 2, v20
    v_lshl_add_u32 v20, v17, 5, v20
    v_add_u32 v7, 10240, v20
    s_lshl_b32 s20, s12, 7
    s_add_u32 s20, s20, 20480
    s_lshr_b32 s21, s20, 13
    s_lshl_b32 s21, s21, 14
    s_and_b32 s20, s20, 8191
    s_add_u32 s20, s20, s21
    v_lshrrev_b32 v20, 3, v0
    v_lshlrev_b32 v20, 4, v20
    v_add_u32 v8, s20, v20
    s_mul_i32 s46, s12, 20480
    s_add_u32 s46, s46, 103809024
    s_mul_i32 s20, s12, 327680
    s_add_u32 s20, s20, 27426816
    s_add_u32 s21, s20, 0
    buffer_load_dwordx4 a[0:3], v1, s[8:11], s21 offen offset:0
    buffer_load_dwordx4 a[4:7], v1, s[8:11], s21 offen offset:1024
    s_add_u32 s21, s20, 2048
    buffer_load_dwordx4 a[8:11], v1, s[8:11], s21 offen offset:0
    buffer_load_dwordx4 a[12:15], v1, s[8:11], s21 offen offset:1024
    s_add_u32 s21, s20, 4096
    buffer_load_dwordx4 a[16:19], v1, s[8:11], s21 offen offset:0
    buffer_load_dwordx4 a[20:23], v1, s[8:11], s21 offen offset:1024
    s_add_u32 s21, s20, 6144
    buffer_load_dwordx4 a[24:27], v1, s[8:11], s21 offen offset:0
    buffer_load_dwordx4 a[28:31], v1, s[8:11], s21 offen offset:1024
    s_add_u32 s21, s20, 8192
    buffer_load_dwordx4 a[32:35], v1, s[8:11], s21 offen offset:0
    buffer_load_dwordx4 a[36:39], v1, s[8:11], s21 offen offset:1024
    s_add_u32 s21, s20, 10240
    buffer_load_dwordx4 a[40:43], v1, s[8:11], s21 offen offset:0
    buffer_load_dwordx4 a[44:47], v1, s[8:11], s21 offen offset:1024
    s_add_u32 s21, s20, 12288
    buffer_load_dwordx4 a[48:51], v1, s[8:11], s21 offen offset:0
    buffer_load_dwordx4 a[52:55], v1, s[8:11], s21 offen offset:1024
    s_add_u32 s21, s20, 14336
    buffer_load_dwordx4 a[56:59], v1, s[8:11], s21 offen offset:0
    buffer_load_dwordx4 a[60:63], v1, s[8:11], s21 offen offset:1024
    s_add_u32 s21, s20, 16384
    buffer_load_dwordx4 a[64:67], v1, s[8:11], s21 offen offset:0
    buffer_load_dwordx4 a[68:71], v1, s[8:11], s21 offen offset:1024
    s_add_u32 s21, s20, 18432
    buffer_load_dwordx4 a[72:75], v1, s[8:11], s21 offen offset:0
    buffer_load_dwordx4 a[76:79], v1, s[8:11], s21 offen offset:1024
    s_add_u32 s21, s20, 20480
    buffer_load_dwordx4 a[80:83], v1, s[8:11], s21 offen offset:0
    buffer_load_dwordx4 a[84:87], v1, s[8:11], s21 offen offset:1024
    s_add_u32 s21, s20, 22528
    buffer_load_dwordx4 a[88:91], v1, s[8:11], s21 offen offset:0
    buffer_load_dwordx4 a[92:95], v1, s[8:11], s21 offen offset:1024
    s_add_u32 s21, s20, 24576
    buffer_load_dwordx4 a[96:99], v1, s[8:11], s21 offen offset:0
    buffer_load_dwordx4 a[100:103], v1, s[8:11], s21 offen offset:1024
    s_add_u32 s21, s20, 26624
    buffer_load_dwordx4 a[104:107], v1, s[8:11], s21 offen offset:0
    buffer_load_dwordx4 a[108:111], v1, s[8:11], s21 offen offset:1024
    s_add_u32 s21, s20, 28672
    buffer_load_dwordx4 a[112:115], v1, s[8:11], s21 offen offset:0
    buffer_load_dwordx4 a[116:119], v1, s[8:11], s21 offen offset:1024
    s_add_u32 s21, s20, 30720
    buffer_load_dwordx4 a[120:123], v1, s[8:11], s21 offen offset:0
    buffer_load_dwordx4 a[124:127], v1, s[8:11], s21 offen offset:1024
    s_add_u32 s21, s20, 32768
    buffer_load_dwordx4 a[128:131], v1, s[8:11], s21 offen offset:0
    buffer_load_dwordx4 a[132:135], v1, s[8:11], s21 offen offset:1024
    s_add_u32 s21, s20, 34816
    buffer_load_dwordx4 a[136:139], v1, s[8:11], s21 offen offset:0
    buffer_load_dwordx4 a[140:143], v1, s[8:11], s21 offen offset:1024
    s_add_u32 s21, s20, 36864
    buffer_load_dwordx4 a[144:147], v1, s[8:11], s21 offen offset:0
    buffer_load_dwordx4 a[148:151], v1, s[8:11], s21 offen offset:1024
    s_add_u32 s21, s20, 38912
    buffer_load_dwordx4 a[152:155], v1, s[8:11], s21 offen offset:0
    buffer_load_dwordx4 a[156:159], v1, s[8:11], s21 offen offset:1024
    s_add_u32 s21, s20, 40960
    buffer_load_dwordx4 a[160:163], v1, s[8:11], s21 offen offset:0
    buffer_load_dwordx4 a[164:167], v1, s[8:11], s21 offen offset:1024
    s_add_u32 s21, s20, 43008
    buffer_load_dwordx4 a[168:171], v1, s[8:11], s21 offen offset:0
    buffer_load_dwordx4 a[172:175], v1, s[8:11], s21 offen offset:1024
    s_add_u32 s21, s20, 45056
    buffer_load_dwordx4 a[176:179], v1, s[8:11], s21 offen offset:0
    buffer_load_dwordx4 a[180:183], v1, s[8:11], s21 offen offset:1024
    s_add_u32 s21, s20, 47104
    buffer_load_dwordx4 a[184:187], v1, s[8:11], s21 offen offset:0
    buffer_load_dwordx4 a[188:191], v1, s[8:11], s21 offen offset:1024
    s_add_u32 s21, s20, 49152
    buffer_load_dwordx4 a[192:195], v1, s[8:11], s21 offen offset:0
    buffer_load_dwordx4 a[196:199], v1, s[8:11], s21 offen offset:1024
    s_add_u32 s21, s20, 51200
    buffer_load_dwordx4 a[200:203], v1, s[8:11], s21 offen offset:0
    buffer_load_dwordx4 a[204:207], v1, s[8:11], s21 offen offset:1024
    s_add_u32 s21, s20, 53248
    buffer_load_dwordx4 a[208:211], v1, s[8:11], s21 offen offset:0
    buffer_load_dwordx4 a[212:215], v1, s[8:11], s21 offen offset:1024
    s_add_u32 s21, s20, 55296
    buffer_load_dwordx4 a[216:219], v1, s[8:11], s21 offen offset:0
    buffer_load_dwordx4 a[220:223], v1, s[8:11], s21 offen offset:1024
    s_add_u32 s21, s20, 57344
    buffer_load_dwordx4 a[224:227], v1, s[8:11], s21 offen offset:0
    buffer_load_dwordx4 a[228:231], v1, s[8:11], s21 offen offset:1024
    s_add_u32 s21, s20, 59392
    buffer_load_dwordx4 a[232:235], v1, s[8:11], s21 offen offset:0
    buffer_load_dwordx4 a[236:239], v1, s[8:11], s21 offen offset:1024
    s_add_u32 s21, s20, 61440
    buffer_load_dwordx4 a[240:243], v1, s[8:11], s21 offen offset:0
    buffer_load_dwordx4 a[244:247], v1, s[8:11], s21 offen offset:1024
    s_add_u32 s21, s20, 63488
    buffer_load_dwordx4 a[248:251], v1, s[8:11], s21 offen offset:0
    buffer_load_dwordx4 a[252:255], v1, s[8:11], s21 offen offset:1024
    s_add_u32 s21, s20, 65536
    buffer_load_dwordx4 v[176:179], v1, s[8:11], s21 offen offset:0
    buffer_load_dwordx4 v[180:183], v1, s[8:11], s21 offen offset:1024
    s_add_u32 s21, s20, 67584
    buffer_load_dwordx4 v[184:187], v1, s[8:11], s21 offen offset:0
    buffer_load_dwordx4 v[188:191], v1, s[8:11], s21 offen offset:1024
    s_add_u32 s21, s20, 69632
    buffer_load_dwordx4 v[192:195], v1, s[8:11], s21 offen offset:0
    buffer_load_dwordx4 v[196:199], v1, s[8:11], s21 offen offset:1024
    s_add_u32 s21, s20, 71680
    buffer_load_dwordx4 v[200:203], v1, s[8:11], s21 offen offset:0
    buffer_load_dwordx4 v[204:207], v1, s[8:11], s21 offen offset:1024
    s_add_u32 s21, s20, 73728
    buffer_load_dwordx4 v[208:211], v1, s[8:11], s21 offen offset:0
    buffer_load_dwordx4 v[212:215], v1, s[8:11], s21 offen offset:1024
    s_add_u32 s21, s20, 75776
    buffer_load_dwordx4 v[216:219], v1, s[8:11], s21 offen offset:0
    buffer_load_dwordx4 v[220:223], v1, s[8:11], s21 offen offset:1024
    s_add_u32 s21, s20, 77824
    buffer_load_dwordx4 v[224:227], v1, s[8:11], s21 offen offset:0
    buffer_load_dwordx4 v[228:231], v1, s[8:11], s21 offen offset:1024
    s_add_u32 s21, s20, 79872
    buffer_load_dwordx4 v[232:235], v1, s[8:11], s21 offen offset:0
    buffer_load_dwordx4 v[236:239], v1, s[8:11], s21 offen offset:1024
    s_mov_b32 s14, 0
    s_lshl_b32 s20, s12, 7
    v_mov_b32 v9, s20
    s_mov_b32 s47, 0
layerb1_kernel_y2_step:
    s_cmp_lt_u32 s14, 32
    s_cselect_b32 s18, s16, s17
    s_and_b32 s20, s14, 31
    s_lshl_b32 s20, s20, 16
    s_add_u32 s18, s18, s20
    s_cmp_gt_u32 s47, s14
    s_cbranch_scc1 layerb1_kernel_y2_gw_ok
layerb1_kernel_y2_gw_lp:
    buffer_load_dword v116, v9, s[8:11], s48 offen sc1
    s_waitcnt vmcnt(0)
    v_readlane_b32 s47, v116, 0
    s_nop 0
    s_sub_u32 s15, s15, 1
    s_cbranch_scc1 layerb1_kernel_bail
    s_cmp_gt_u32 s47, s14
    s_cbranch_scc0 layerb1_kernel_y2_gw_lp
layerb1_kernel_y2_gw_ok:
    s_mul_i32 s28, s14, 1638400
    s_add_u32 s28, s28, s46
    buffer_load_dwordx4 v[76:79], v4, s[8:11], s28 offen offset:128 sc1
    buffer_load_dwordx4 v[80:83], v4, s[8:11], s28 offen offset:256 sc1
    buffer_load_dwordx4 v[84:87], v4, s[8:11], s28 offen offset:384 sc1
    buffer_load_dwordx4 v[88:91], v4, s[8:11], s28 offen offset:512 sc1
    v_mov_b32 v56, 0
    v_mov_b32 v57, 0
    v_mov_b32 v58, 0
    v_mov_b32 v59, 0
    v_mov_b32 v60, 0
    v_mov_b32 v61, 0
    v_mov_b32 v62, 0
    v_mov_b32 v63, 0
    v_mov_b32 v64, 0
    v_mov_b32 v65, 0
    v_mov_b32 v66, 0
    v_mov_b32 v67, 0
    v_mov_b32 v68, 0
    v_mov_b32 v69, 0
    v_mov_b32 v70, 0
    v_mov_b32 v71, 0
    s_add_u32 s22, s18, 51200
    s_add_u32 s23, s18, 52224
layerb1_kernel_y2_poll:
    buffer_load_dwordx4 v[40:43], v1, s[8:11], s22 offen sc1
    buffer_load_dwordx4 v[44:47], v1, s[8:11], s23 offen sc1
    s_waitcnt vmcnt(0)
    ds_write_b128 v3, v[40:43] offset:6144
    ds_write_b128 v3, v[44:47] offset:7168
    v_max3_u32 v116, v40, v41, v42
    v_max3_u32 v116, v116, v43, v44
    v_max3_u32 v116, v116, v45, v46
    v_max_u32 v116, v116, v47
    v_cmp_eq_u32 vcc, -1, v116
    s_sub_u32 s15, s15, 1
    s_cbranch_scc1 layerb1_kernel_bail
    s_cbranch_vccnz layerb1_kernel_y2_poll
    s_waitcnt lgkmcnt(0)
    s_barrier
    ds_read_b128 v[16:19], v3 offset:0
    ds_read_b128 v[20:23], v3 offset:1024
    ds_read_b128 v[24:27], v3 offset:2048
    ds_read_b128 v[28:31], v3 offset:3072
    ds_read_b128 v[32:35], v3 offset:4096
    ds_read_b128 v[36:39], v3 offset:5120
    ds_read_b128 v[48:51], v3 offset:8192
    ds_read_b128 v[52:55], v3 offset:9216
    v_smfmac_f32_16x16x64_bf16 v[56:59], v[40:43], a[48:55], v2
    v_smfmac_f32_16x16x64_bf16 v[60:63], v[40:43], a[128:135], v2
    v_smfmac_f32_16x16x64_bf16 v[64:67], v[40:43], a[208:215], v2
    v_smfmac_f32_16x16x64_bf16 v[68:71], v[40:43], v[208:215], v2
    v_smfmac_f32_16x16x64_bf16 v[56:59], v[44:47], a[56:63], v2
    v_smfmac_f32_16x16x64_bf16 v[60:63], v[44:47], a[136:143], v2
    v_smfmac_f32_16x16x64_bf16 v[64:67], v[44:47], a[216:223], v2
    v_smfmac_f32_16x16x64_bf16 v[68:71], v[44:47], v[216:223], v2
    s_waitcnt lgkmcnt(7)
    v_smfmac_f32_16x16x64_bf16 v[56:59], v[16:19], a[0:7], v2
    v_smfmac_f32_16x16x64_bf16 v[60:63], v[16:19], a[80:87], v2
    v_smfmac_f32_16x16x64_bf16 v[64:67], v[16:19], a[160:167], v2
    v_smfmac_f32_16x16x64_bf16 v[68:71], v[16:19], a[240:247], v2
    s_waitcnt lgkmcnt(6)
    v_smfmac_f32_16x16x64_bf16 v[56:59], v[20:23], a[8:15], v2
    v_smfmac_f32_16x16x64_bf16 v[60:63], v[20:23], a[88:95], v2
    v_smfmac_f32_16x16x64_bf16 v[64:67], v[20:23], a[168:175], v2
    v_smfmac_f32_16x16x64_bf16 v[68:71], v[20:23], a[248:255], v2
    s_waitcnt lgkmcnt(5)
    v_smfmac_f32_16x16x64_bf16 v[56:59], v[24:27], a[16:23], v2
    v_smfmac_f32_16x16x64_bf16 v[60:63], v[24:27], a[96:103], v2
    v_smfmac_f32_16x16x64_bf16 v[64:67], v[24:27], a[176:183], v2
    v_smfmac_f32_16x16x64_bf16 v[68:71], v[24:27], v[176:183], v2
    s_waitcnt lgkmcnt(4)
    v_smfmac_f32_16x16x64_bf16 v[56:59], v[28:31], a[24:31], v2
    v_smfmac_f32_16x16x64_bf16 v[60:63], v[28:31], a[104:111], v2
    v_smfmac_f32_16x16x64_bf16 v[64:67], v[28:31], a[184:191], v2
    v_smfmac_f32_16x16x64_bf16 v[68:71], v[28:31], v[184:191], v2
    s_waitcnt lgkmcnt(3)
    v_smfmac_f32_16x16x64_bf16 v[56:59], v[32:35], a[32:39], v2
    v_smfmac_f32_16x16x64_bf16 v[60:63], v[32:35], a[112:119], v2
    v_smfmac_f32_16x16x64_bf16 v[64:67], v[32:35], a[192:199], v2
    v_smfmac_f32_16x16x64_bf16 v[68:71], v[32:35], v[192:199], v2
    s_waitcnt lgkmcnt(2)
    v_smfmac_f32_16x16x64_bf16 v[56:59], v[36:39], a[40:47], v2
    v_smfmac_f32_16x16x64_bf16 v[60:63], v[36:39], a[120:127], v2
    v_smfmac_f32_16x16x64_bf16 v[64:67], v[36:39], a[200:207], v2
    v_smfmac_f32_16x16x64_bf16 v[68:71], v[36:39], v[200:207], v2
    s_waitcnt lgkmcnt(1)
    v_smfmac_f32_16x16x64_bf16 v[56:59], v[48:51], a[64:71], v2
    v_smfmac_f32_16x16x64_bf16 v[60:63], v[48:51], a[144:151], v2
    v_smfmac_f32_16x16x64_bf16 v[64:67], v[48:51], a[224:231], v2
    v_smfmac_f32_16x16x64_bf16 v[68:71], v[48:51], v[224:231], v2
    s_waitcnt lgkmcnt(0)
    v_smfmac_f32_16x16x64_bf16 v[56:59], v[52:55], a[72:79], v2
    v_smfmac_f32_16x16x64_bf16 v[60:63], v[52:55], a[152:159], v2
    v_smfmac_f32_16x16x64_bf16 v[64:67], v[52:55], a[232:239], v2
    v_smfmac_f32_16x16x64_bf16 v[68:71], v[52:55], v[232:239], v2
    s_nop 7
    v_permlane32_swap_b32 v56, v64
    v_permlane32_swap_b32 v60, v68
    v_permlane32_swap_b32 v57, v65
    v_permlane32_swap_b32 v61, v69
    v_permlane32_swap_b32 v58, v66
    v_permlane32_swap_b32 v62, v70
    v_permlane32_swap_b32 v59, v67
    v_permlane32_swap_b32 v63, v71
    v_add_f32 v56, v56, v64
    v_add_f32 v60, v60, v68
    v_add_f32 v57, v57, v65
    v_add_f32 v61, v61, v69
    v_add_f32 v58, v58, v66
    v_add_f32 v62, v62, v70
    v_add_f32 v59, v59, v67
    v_add_f32 v63, v63, v71
    s_nop 1
    v_permlane16_swap_b32 v56, v60
    v_permlane16_swap_b32 v57, v61
    v_permlane16_swap_b32 v58, v62
    v_permlane16_swap_b32 v59, v63
    s_nop 1
    v_cvt_pk_bf16_f32 v72, v56, v57
    v_cvt_pk_bf16_f32 v73, v58, v59
    v_cvt_pk_bf16_f32 v74, v60, v61
    v_cvt_pk_bf16_f32 v75, v62, v63
    buffer_store_dwordx4 v[72:75], v4, s[8:11], s28 offen sc1
    s_cmp_eq_u32 s14, 63
    s_cbranch_scc1 layerb1_kernel_y2_last
    s_add_u32 s30, s18, 0
    s_add_u32 s31, s18, 4096
    s_add_u32 s32, s18, 16384
    s_add_u32 s33, s18, 20480
    s_add_u32 s34, s18, 32768
    s_add_u32 s29, s14, 1
    s_cmp_lt_u32 s29, 32
    s_cselect_b32 s19, s16, s17
    s_and_b32 s20, s29, 31
    s_lshl_b32 s20, s20, 16
    s_add_u32 s19, s19, s20
layerb1_kernel_y2_ppoll:
    buffer_load_dwordx4 v[92:95], v5, s[8:11], s30 offen sc1
    buffer_load_dwordx4 v[96:99], v5, s[8:11], s31 offen sc1
    buffer_load_dwordx4 v[100:103], v5, s[8:11], s32 offen sc1
    buffer_load_dwordx4 v[104:107], v5, s[8:11], s33 offen sc1
    buffer_load_dwordx4 v[108:111], v5, s[8:11], s34 offen sc1
    s_waitcnt vmcnt(0)
    v_mfma_f32_16x16x32_bf16 v[112:115], v[92:95], v[72:75], 0
    v_mfma_f32_16x16x32_bf16 v[112:115], v[96:99], v[76:79], v[112:115]
    v_mfma_f32_16x16x32_bf16 v[112:115], v[100:103], v[80:83], v[112:115]
    v_mfma_f32_16x16x32_bf16 v[112:115], v[104:107], v[84:87], v[112:115]
    v_mfma_f32_16x16x32_bf16 v[112:115], v[108:111], v[88:91], v[112:115]
    v_max3_u32 v116, v92, v93, v94
    v_max3_u32 v116, v116, v95, v96
    v_max3_u32 v116, v116, v97, v98
    v_max3_u32 v116, v116, v99, v100
    v_max3_u32 v116, v116, v101, v102
    v_max3_u32 v116, v116, v103, v104
    v_max3_u32 v116, v116, v105, v106
    v_max3_u32 v116, v116, v107, v108
    v_max3_u32 v116, v116, v109, v110
    v_max_u32 v116, v116, v111
    v_cmp_eq_u32 vcc, -1, v116
    s_sub_u32 s15, s15, 1
    s_cbranch_scc1 layerb1_kernel_bail
    s_cbranch_vccnz layerb1_kernel_y2_ppoll
    ds_write_b128 v6, v[112:115]
    s_waitcnt lgkmcnt(0)
    s_barrier
    s_add_u32 s14, s14, 1
    s_branch layerb1_kernel_y2_step
layerb1_kernel_y2_last:
    s_waitcnt vmcnt(0)
    s_barrier
    s_branch layerb1_kernel_end
layerb1_kernel_y3_start:
    v_lshrrev_b32 v16, 4, v0
    v_and_b32 v17, 7, v0
    v_lshrrev_b32 v18, 3, v0
    v_and_b32 v18, 1, v18
    v_lshl_add_u32 v19, v18, 2, v16
    v_add_u32 v19, 24, v19
    v_mul_u32_u24 v20, 640, v19
    v_lshl_add_u32 v4, v17, 4, v20
    v_and_b32 v20, 3, v17
    v_lshlrev_b32 v20, 1, v20
    v_lshrrev_b32 v21, 2, v17
    v_add_u32 v20, v20, v21
    v_lshlrev_b32 v20, 4, v20
    v_lshl_add_u32 v5, v19, 7, v20
    v_add_u32 v3, 0, v1
    v_lshlrev_b32 v20, 8, v18
    v_lshl_add_u32 v20, v17, 5, v20
    v_and_b32 v21, 1, v16
    v_lshl_add_u32 v20, v21, 4, v20
    v_add_u32 v20, 11776, v20
    v_add_u32 v21, 12288, v1
    v_lshrrev_b32 v22, 1, v16
    v_cmp_eq_u32 vcc, v22, v18
    s_nop 1
    v_cndmask_b32 v6, v21, v20, vcc
    v_lshrrev_b32 v20, 3, v0
    v_lshlrev_b32 v20, 2, v20
    v_lshl_add_u32 v20, v17, 5, v20
    v_add_u32 v7, 10240, v20
    s_lshl_b32 s20, s12, 7
    s_add_u32 s20, s20, 20480
    s_lshr_b32 s21, s20, 13
    s_lshl_b32 s21, s21, 14
    s_and_b32 s20, s20, 8191
    s_add_u32 s20, s20, s21
    v_lshrrev_b32 v20, 3, v0
    v_lshlrev_b32 v20, 4, v20
    v_add_u32 v8, s20, v20
    s_mul_i32 s46, s12, 20480
    s_add_u32 s46, s46, 103809024
    s_mul_i32 s20, s12, 327680
    s_add_u32 s20, s20, 27508736
    s_add_u32 s21, s20, 0
    buffer_load_dwordx4 a[0:3], v1, s[8:11], s21 offen offset:0
    buffer_load_dwordx4 a[4:7], v1, s[8:11], s21 offen offset:1024
    s_add_u32 s21, s20, 2048
    buffer_load_dwordx4 a[8:11], v1, s[8:11], s21 offen offset:0
    buffer_load_dwordx4 a[12:15], v1, s[8:11], s21 offen offset:1024
    s_add_u32 s21, s20, 4096
    buffer_load_dwordx4 a[16:19], v1, s[8:11], s21 offen offset:0
    buffer_load_dwordx4 a[20:23], v1, s[8:11], s21 offen offset:1024
    s_add_u32 s21, s20, 6144
    buffer_load_dwordx4 a[24:27], v1, s[8:11], s21 offen offset:0
    buffer_load_dwordx4 a[28:31], v1, s[8:11], s21 offen offset:1024
    s_add_u32 s21, s20, 8192
    buffer_load_dwordx4 a[32:35], v1, s[8:11], s21 offen offset:0
    buffer_load_dwordx4 a[36:39], v1, s[8:11], s21 offen offset:1024
    s_add_u32 s21, s20, 10240
    buffer_load_dwordx4 a[40:43], v1, s[8:11], s21 offen offset:0
    buffer_load_dwordx4 a[44:47], v1, s[8:11], s21 offen offset:1024
    s_add_u32 s21, s20, 12288
    buffer_load_dwordx4 a[48:51], v1, s[8:11], s21 offen offset:0
    buffer_load_dwordx4 a[52:55], v1, s[8:11], s21 offen offset:1024
    s_add_u32 s21, s20, 14336
    buffer_load_dwordx4 a[56:59], v1, s[8:11], s21 offen offset:0
    buffer_load_dwordx4 a[60:63], v1, s[8:11], s21 offen offset:1024
    s_add_u32 s21, s20, 16384
    buffer_load_dwordx4 a[64:67], v1, s[8:11], s21 offen offset:0
    buffer_load_dwordx4 a[68:71], v1, s[8:11], s21 offen offset:1024
    s_add_u32 s21, s20, 18432
    buffer_load_dwordx4 a[72:75], v1, s[8:11], s21 offen offset:0
    buffer_load_dwordx4 a[76:79], v1, s[8:11], s21 offen offset:1024
    s_add_u32 s21, s20, 20480
    buffer_load_dwordx4 a[80:83], v1, s[8:11], s21 offen offset:0
    buffer_load_dwordx4 a[84:87], v1, s[8:11], s21 offen offset:1024
    s_add_u32 s21, s20, 22528
    buffer_load_dwordx4 a[88:91], v1, s[8:11], s21 offen offset:0
    buffer_load_dwordx4 a[92:95], v1, s[8:11], s21 offen offset:1024
    s_add_u32 s21, s20, 24576
    buffer_load_dwordx4 a[96:99], v1, s[8:11], s21 offen offset:0
    buffer_load_dwordx4 a[100:103], v1, s[8:11], s21 offen offset:1024
    s_add_u32 s21, s20, 26624
    buffer_load_dwordx4 a[104:107], v1, s[8:11], s21 offen offset:0
    buffer_load_dwordx4 a[108:111], v1, s[8:11], s21 offen offset:1024
    s_add_u32 s21, s20, 28672
    buffer_load_dwordx4 a[112:115], v1, s[8:11], s21 offen offset:0
    buffer_load_dwordx4 a[116:119], v1, s[8:11], s21 offen offset:1024
    s_add_u32 s21, s20, 30720
    buffer_load_dwordx4 a[120:123], v1, s[8:11], s21 offen offset:0
    buffer_load_dwordx4 a[124:127], v1, s[8:11], s21 offen offset:1024
    s_add_u32 s21, s20, 32768
    buffer_load_dwordx4 a[128:131], v1, s[8:11], s21 offen offset:0
    buffer_load_dwordx4 a[132:135], v1, s[8:11], s21 offen offset:1024
    s_add_u32 s21, s20, 34816
    buffer_load_dwordx4 a[136:139], v1, s[8:11], s21 offen offset:0
    buffer_load_dwordx4 a[140:143], v1, s[8:11], s21 offen offset:1024
    s_add_u32 s21, s20, 36864
    buffer_load_dwordx4 a[144:147], v1, s[8:11], s21 offen offset:0
    buffer_load_dwordx4 a[148:151], v1, s[8:11], s21 offen offset:1024
    s_add_u32 s21, s20, 38912
    buffer_load_dwordx4 a[152:155], v1, s[8:11], s21 offen offset:0
    buffer_load_dwordx4 a[156:159], v1, s[8:11], s21 offen offset:1024
    s_add_u32 s21, s20, 40960
    buffer_load_dwordx4 a[160:163], v1, s[8:11], s21 offen offset:0
    buffer_load_dwordx4 a[164:167], v1, s[8:11], s21 offen offset:1024
    s_add_u32 s21, s20, 43008
    buffer_load_dwordx4 a[168:171], v1, s[8:11], s21 offen offset:0
    buffer_load_dwordx4 a[172:175], v1, s[8:11], s21 offen offset:1024
    s_add_u32 s21, s20, 45056
    buffer_load_dwordx4 a[176:179], v1, s[8:11], s21 offen offset:0
    buffer_load_dwordx4 a[180:183], v1, s[8:11], s21 offen offset:1024
    s_add_u32 s21, s20, 47104
    buffer_load_dwordx4 a[184:187], v1, s[8:11], s21 offen offset:0
    buffer_load_dwordx4 a[188:191], v1, s[8:11], s21 offen offset:1024
    s_add_u32 s21, s20, 49152
    buffer_load_dwordx4 a[192:195], v1, s[8:11], s21 offen offset:0
    buffer_load_dwordx4 a[196:199], v1, s[8:11], s21 offen offset:1024
    s_add_u32 s21, s20, 51200
    buffer_load_dwordx4 a[200:203], v1, s[8:11], s21 offen offset:0
    buffer_load_dwordx4 a[204:207], v1, s[8:11], s21 offen offset:1024
    s_add_u32 s21, s20, 53248
    buffer_load_dwordx4 a[208:211], v1, s[8:11], s21 offen offset:0
    buffer_load_dwordx4 a[212:215], v1, s[8:11], s21 offen offset:1024
    s_add_u32 s21, s20, 55296
    buffer_load_dwordx4 a[216:219], v1, s[8:11], s21 offen offset:0
    buffer_load_dwordx4 a[220:223], v1, s[8:11], s21 offen offset:1024
    s_add_u32 s21, s20, 57344
    buffer_load_dwordx4 a[224:227], v1, s[8:11], s21 offen offset:0
    buffer_load_dwordx4 a[228:231], v1, s[8:11], s21 offen offset:1024
    s_add_u32 s21, s20, 59392
    buffer_load_dwordx4 a[232:235], v1, s[8:11], s21 offen offset:0
    buffer_load_dwordx4 a[236:239], v1, s[8:11], s21 offen offset:1024
    s_add_u32 s21, s20, 61440
    buffer_load_dwordx4 a[240:243], v1, s[8:11], s21 offen offset:0
    buffer_load_dwordx4 a[244:247], v1, s[8:11], s21 offen offset:1024
    s_add_u32 s21, s20, 63488
    buffer_load_dwordx4 a[248:251], v1, s[8:11], s21 offen offset:0
    buffer_load_dwordx4 a[252:255], v1, s[8:11], s21 offen offset:1024
    s_add_u32 s21, s20, 65536
    buffer_load_dwordx4 v[176:179], v1, s[8:11], s21 offen offset:0
    buffer_load_dwordx4 v[180:183], v1, s[8:11], s21 offen offset:1024
    s_add_u32 s21, s20, 67584
    buffer_load_dwordx4 v[184:187], v1, s[8:11], s21 offen offset:0
    buffer_load_dwordx4 v[188:191], v1, s[8:11], s21 offen offset:1024
    s_add_u32 s21, s20, 69632
    buffer_load_dwordx4 v[192:195], v1, s[8:11], s21 offen offset:0
    buffer_load_dwordx4 v[196:199], v1, s[8:11], s21 offen offset:1024
    s_add_u32 s21, s20, 71680
    buffer_load_dwordx4 v[200:203], v1, s[8:11], s21 offen offset:0
    buffer_load_dwordx4 v[204:207], v1, s[8:11], s21 offen offset:1024
    s_add_u32 s21, s20, 73728
    buffer_load_dwordx4 v[208:211], v1, s[8:11], s21 offen offset:0
    buffer_load_dwordx4 v[212:215], v1, s[8:11], s21 offen offset:1024
    s_add_u32 s21, s20, 75776
    buffer_load_dwordx4 v[216:219], v1, s[8:11], s21 offen offset:0
    buffer_load_dwordx4 v[220:223], v1, s[8:11], s21 offen offset:1024
    s_add_u32 s21, s20, 77824
    buffer_load_dwordx4 v[224:227], v1, s[8:11], s21 offen offset:0
    buffer_load_dwordx4 v[228:231], v1, s[8:11], s21 offen offset:1024
    s_add_u32 s21, s20, 79872
    buffer_load_dwordx4 v[232:235], v1, s[8:11], s21 offen offset:0
    buffer_load_dwordx4 v[236:239], v1, s[8:11], s21 offen offset:1024
    s_mov_b32 s14, 0
    s_lshl_b32 s20, s12, 7
    v_mov_b32 v9, s20
    s_mov_b32 s47, 0
layerb1_kernel_y3_step:
    s_cmp_lt_u32 s14, 32
    s_cselect_b32 s18, s16, s17
    s_and_b32 s20, s14, 31
    s_lshl_b32 s20, s20, 16
    s_add_u32 s18, s18, s20
    s_cmp_gt_u32 s47, s14
    s_cbranch_scc1 layerb1_kernel_y3_gw_ok
layerb1_kernel_y3_gw_lp:
    buffer_load_dword v116, v9, s[8:11], s48 offen sc1
    s_waitcnt vmcnt(0)
    v_readlane_b32 s47, v116, 0
    s_nop 0
    s_sub_u32 s15, s15, 1
    s_cbranch_scc1 layerb1_kernel_bail
    s_cmp_gt_u32 s47, s14
    s_cbranch_scc0 layerb1_kernel_y3_gw_lp
layerb1_kernel_y3_gw_ok:
    s_mul_i32 s28, s14, 1638400
    s_add_u32 s28, s28, s46
    buffer_load_dwordx4 v[76:79], v4, s[8:11], s28 offen offset:128 sc1
    buffer_load_dwordx4 v[80:83], v4, s[8:11], s28 offen offset:256 sc1
    buffer_load_dwordx4 v[84:87], v4, s[8:11], s28 offen offset:384 sc1
    buffer_load_dwordx4 v[88:91], v4, s[8:11], s28 offen offset:512 sc1
    v_mov_b32 v56, 0
    v_mov_b32 v57, 0
    v_mov_b32 v58, 0
    v_mov_b32 v59, 0
    v_mov_b32 v60, 0
    v_mov_b32 v61, 0
    v_mov_b32 v62, 0
    v_mov_b32 v63, 0
    v_mov_b32 v64, 0
    v_mov_b32 v65, 0
    v_mov_b32 v66, 0
    v_mov_b32 v67, 0
    v_mov_b32 v68, 0
    v_mov_b32 v69, 0
    v_mov_b32 v70, 0
    v_mov_b32 v71, 0
    s_add_u32 s22, s18, 53248
    s_add_u32 s23, s18, 54272
layerb1_kernel_y3_poll:
    buffer_load_dwordx4 v[48:51], v1, s[8:11], s22 offen sc1
    buffer_load_dwordx4 v[52:55], v1, s[8:11], s23 offen sc1
    s_waitcnt vmcnt(0)
    ds_write_b128 v3, v[48:51] offset:8192
    ds_write_b128 v3, v[52:55] offset:9216
    v_max3_u32 v116, v48, v49, v50
    v_max3_u32 v116, v116, v51, v52
    v_max3_u32 v116, v116, v53, v54
    v_max_u32 v116, v116, v55
    v_cmp_eq_u32 vcc, -1, v116
    s_sub_u32 s15, s15, 1
    s_cbranch_scc1 layerb1_kernel_bail
    s_cbranch_vccnz layerb1_kernel_y3_poll
    s_waitcnt lgkmcnt(0)
    s_barrier
    ds_read_b128 v[16:19], v3 offset:0
    ds_read_b128 v[20:23], v3 offset:1024
    ds_read_b128 v[24:27], v3 offset:2048
    ds_read_b128 v[28:31], v3 offset:3072
    ds_read_b128 v[32:35], v3 offset:4096
    ds_read_b128 v[36:39], v3 offset:5120
    ds_read_b128 v[40:43], v3 offset:6144
    ds_read_b128 v[44:47], v3 offset:7168
    v_smfmac_f32_16x16x64_bf16 v[56:59], v[48:51], a[64:71], v2
    v_smfmac_f32_16x16x64_bf16 v[60:63], v[48:51], a[144:151], v2
    v_smfmac_f32_16x16x64_bf16 v[64:67], v[48:51], a[224:231], v2
    v_smfmac_f32_16x16x64_bf16 v[68:71], v[48:51], v[224:231], v2
    v_smfmac_f32_16x16x64_bf16 v[56:59], v[52:55], a[72:79], v2
    v_smfmac_f32_16x16x64_bf16 v[60:63], v[52:55], a[152:159], v2
    v_smfmac_f32_16x16x64_bf16 v[64:67], v[52:55], a[232:239], v2
    v_smfmac_f32_16x16x64_bf16 v[68:71], v[52:55], v[232:239], v2
    s_waitcnt lgkmcnt(7)
    v_smfmac_f32_16x16x64_bf16 v[56:59], v[16:19], a[0:7], v2
    v_smfmac_f32_16x16x64_bf16 v[60:63], v[16:19], a[80:87], v2
    v_smfmac_f32_16x16x64_bf16 v[64:67], v[16:19], a[160:167], v2
    v_smfmac_f32_16x16x64_bf16 v[68:71], v[16:19], a[240:247], v2
    s_waitcnt lgkmcnt(6)
    v_smfmac_f32_16x16x64_bf16 v[56:59], v[20:23], a[8:15], v2
    v_smfmac_f32_16x16x64_bf16 v[60:63], v[20:23], a[88:95], v2
    v_smfmac_f32_16x16x64_bf16 v[64:67], v[20:23], a[168:175], v2
    v_smfmac_f32_16x16x64_bf16 v[68:71], v[20:23], a[248:255], v2
    s_waitcnt lgkmcnt(5)
    v_smfmac_f32_16x16x64_bf16 v[56:59], v[24:27], a[16:23], v2
    v_smfmac_f32_16x16x64_bf16 v[60:63], v[24:27], a[96:103], v2
    v_smfmac_f32_16x16x64_bf16 v[64:67], v[24:27], a[176:183], v2
    v_smfmac_f32_16x16x64_bf16 v[68:71], v[24:27], v[176:183], v2
    s_waitcnt lgkmcnt(4)
    v_smfmac_f32_16x16x64_bf16 v[56:59], v[28:31], a[24:31], v2
    v_smfmac_f32_16x16x64_bf16 v[60:63], v[28:31], a[104:111], v2
    v_smfmac_f32_16x16x64_bf16 v[64:67], v[28:31], a[184:191], v2
    v_smfmac_f32_16x16x64_bf16 v[68:71], v[28:31], v[184:191], v2
    s_waitcnt lgkmcnt(3)
    v_smfmac_f32_16x16x64_bf16 v[56:59], v[32:35], a[32:39], v2
    v_smfmac_f32_16x16x64_bf16 v[60:63], v[32:35], a[112:119], v2
    v_smfmac_f32_16x16x64_bf16 v[64:67], v[32:35], a[192:199], v2
    v_smfmac_f32_16x16x64_bf16 v[68:71], v[32:35], v[192:199], v2
    s_waitcnt lgkmcnt(2)
    v_smfmac_f32_16x16x64_bf16 v[56:59], v[36:39], a[40:47], v2
    v_smfmac_f32_16x16x64_bf16 v[60:63], v[36:39], a[120:127], v2
    v_smfmac_f32_16x16x64_bf16 v[64:67], v[36:39], a[200:207], v2
    v_smfmac_f32_16x16x64_bf16 v[68:71], v[36:39], v[200:207], v2
    s_waitcnt lgkmcnt(1)
    v_smfmac_f32_16x16x64_bf16 v[56:59], v[40:43], a[48:55], v2
    v_smfmac_f32_16x16x64_bf16 v[60:63], v[40:43], a[128:135], v2
    v_smfmac_f32_16x16x64_bf16 v[64:67], v[40:43], a[208:215], v2
    v_smfmac_f32_16x16x64_bf16 v[68:71], v[40:43], v[208:215], v2
    s_waitcnt lgkmcnt(0)
    v_smfmac_f32_16x16x64_bf16 v[56:59], v[44:47], a[56:63], v2
    v_smfmac_f32_16x16x64_bf16 v[60:63], v[44:47], a[136:143], v2
    v_smfmac_f32_16x16x64_bf16 v[64:67], v[44:47], a[216:223], v2
    v_smfmac_f32_16x16x64_bf16 v[68:71], v[44:47], v[216:223], v2
    s_nop 7
    v_permlane32_swap_b32 v56, v64
    v_permlane32_swap_b32 v60, v68
    v_permlane32_swap_b32 v57, v65
    v_permlane32_swap_b32 v61, v69
    v_permlane32_swap_b32 v58, v66
    v_permlane32_swap_b32 v62, v70
    v_permlane32_swap_b32 v59, v67
    v_permlane32_swap_b32 v63, v71
    v_add_f32 v56, v56, v64
    v_add_f32 v60, v60, v68
    v_add_f32 v57, v57, v65
    v_add_f32 v61, v61, v69
    v_add_f32 v58, v58, v66
    v_add_f32 v62, v62, v70
    v_add_f32 v59, v59, v67
    v_add_f32 v63, v63, v71
    s_nop 1
    v_permlane16_swap_b32 v56, v60
    v_permlane16_swap_b32 v57, v61
    v_permlane16_swap_b32 v58, v62
    v_permlane16_swap_b32 v59, v63
    s_nop 1
    v_cvt_pk_bf16_f32 v72, v56, v57
    v_cvt_pk_bf16_f32 v73, v58, v59
    v_cvt_pk_bf16_f32 v74, v60, v61
    v_cvt_pk_bf16_f32 v75, v62, v63
    buffer_store_dwordx4 v[72:75], v4, s[8:11], s28 offen sc1
    s_cmp_eq_u32 s14, 63
    s_cbranch_scc1 layerb1_kernel_y3_last
    s_add_u32 s30, s18, 0
    s_add_u32 s31, s18, 4096
    s_add_u32 s32, s18, 16384
    s_add_u32 s33, s18, 20480
    s_add_u32 s34, s18, 32768
    s_add_u32 s29, s14, 1
    s_cmp_lt_u32 s29, 32
    s_cselect_b32 s19, s16, s17
    s_and_b32 s20, s29, 31
    s_lshl_b32 s20, s20, 16
    s_add_u32 s19, s19, s20
layerb1_kernel_y3_ppoll:
    buffer_load_dwordx4 v[92:95], v5, s[8:11], s30 offen sc1
    buffer_load_dwordx4 v[96:99], v5, s[8:11], s31 offen sc1
    buffer_load_dwordx4 v[100:103], v5, s[8:11], s32 offen sc1
    buffer_load_dwordx4 v[104:107], v5, s[8:11], s33 offen sc1
    buffer_load_dwordx4 v[108:111], v5, s[8:11], s34 offen sc1
    s_waitcnt vmcnt(0)
    v_mfma_f32_16x16x32_bf16 v[112:115], v[92:95], v[72:75], 0
    v_mfma_f32_16x16x32_bf16 v[112:115], v[96:99], v[76:79], v[112:115]
    v_mfma_f32_16x16x32_bf16 v[112:115], v[100:103], v[80:83], v[112:115]
    v_mfma_f32_16x16x32_bf16 v[112:115], v[104:107], v[84:87], v[112:115]
    v_mfma_f32_16x16x32_bf16 v[112:115], v[108:111], v[88:91], v[112:115]
    v_max3_u32 v116, v92, v93, v94
    v_max3_u32 v116, v116, v95, v96
    v_max3_u32 v116, v116, v97, v98
    v_max3_u32 v116, v116, v99, v100
    v_max3_u32 v116, v116, v101, v102
    v_max3_u32 v116, v116, v103, v104
    v_max3_u32 v116, v116, v105, v106
    v_max3_u32 v116, v116, v107, v108
    v_max3_u32 v116, v116, v109, v110
    v_max_u32 v116, v116, v111
    v_cmp_eq_u32 vcc, -1, v116
    s_sub_u32 s15, s15, 1
    s_cbranch_scc1 layerb1_kernel_bail
    s_cbranch_vccnz layerb1_kernel_y3_ppoll
    ds_write_b128 v6, v[112:115]
    s_waitcnt lgkmcnt(0)
    s_barrier
    s_add_u32 s14, s14, 1
    s_branch layerb1_kernel_y3_step
layerb1_kernel_y3_last:
    s_waitcnt vmcnt(0)
    s_barrier
    s_branch layerb1_kernel_end
layerb1_kernel_proj:
    s_sub_u32 s22, s20, 4
    s_lshl_b32 s22, s22, 5
    s_add_u32 s12, s22, s21
    s_mov_b32 s14, 0
    s_mov_b32 s15, 64
    v_lshlrev_b32 v1, 4, v0
    v_and_b32 v8, 31, v0
    v_lshrrev_b32 v9, 5, v0
    s_cmp_ge_u32 s12, 80
    s_cbranch_scc1 layerb1_kernel_g_qk
    v_lshrrev_b32 v10, 3, v8
    v_and_b32 v11, 7, v8
    v_mul_u32_u24 v12, 20480, v10
    v_lshl_add_u32 v12, v11, 4, v12
    v_lshl_add_u32 v4, v9, 8, v12
    s_mul_i32 s24, s12, 327680
    s_mul_i32 s25, s13, 81920
    s_add_u32 s24, s24, s25
    s_add_u32 s24, s24, 27262976
    buffer_load_dwordx4 a[0:3], v4, s[8:11], s24 offen offset:0
    buffer_load_dwordx4 a[4:7], v4, s[8:11], s24 offen offset:128
    buffer_load_dwordx4 a[8:11], v4, s[8:11], s24 offen offset:512
    buffer_load_dwordx4 a[12:15], v4, s[8:11], s24 offen offset:640
    buffer_load_dwordx4 a[16:19], v4, s[8:11], s24 offen offset:1024
    buffer_load_dwordx4 a[20:23], v4, s[8:11], s24 offen offset:1152
    buffer_load_dwordx4 a[24:27], v4, s[8:11], s24 offen offset:1536
    buffer_load_dwordx4 a[28:31], v4, s[8:11], s24 offen offset:1664
    buffer_load_dwordx4 a[32:35], v4, s[8:11], s24 offen offset:2048
    buffer_load_dwordx4 a[36:39], v4, s[8:11], s24 offen offset:2176
    buffer_load_dwordx4 a[40:43], v4, s[8:11], s24 offen offset:2560
    buffer_load_dwordx4 a[44:47], v4, s[8:11], s24 offen offset:2688
    buffer_load_dwordx4 a[48:51], v4, s[8:11], s24 offen offset:3072
    buffer_load_dwordx4 a[52:55], v4, s[8:11], s24 offen offset:3200
    s_add_u32 s24, s24, 3584
    buffer_load_dwordx4 a[56:59], v4, s[8:11], s24 offen offset:0
    buffer_load_dwordx4 a[60:63], v4, s[8:11], s24 offen offset:128
    buffer_load_dwordx4 a[64:67], v4, s[8:11], s24 offen offset:512
    buffer_load_dwordx4 a[68:71], v4, s[8:11], s24 offen offset:640
    buffer_load_dwordx4 a[72:75], v4, s[8:11], s24 offen offset:1024
    buffer_load_dwordx4 a[76:79], v4, s[8:11], s24 offen offset:1152
    buffer_load_dwordx4 a[80:83], v4, s[8:11], s24 offen offset:1536
    buffer_load_dwordx4 a[84:87], v4, s[8:11], s24 offen offset:1664
    buffer_load_dwordx4 a[88:91], v4, s[8:11], s24 offen offset:2048
    buffer_load_dwordx4 a[92:95], v4, s[8:11], s24 offen offset:2176
    buffer_load_dwordx4 a[96:99], v4, s[8:11], s24 offen offset:2560
    buffer_load_dwordx4 a[100:103], v4, s[8:11], s24 offen offset:2688
    buffer_load_dwordx4 a[104:107], v4, s[8:11], s24 offen offset:3072
    buffer_load_dwordx4 a[108:111], v4, s[8:11], s24 offen offset:3200
    s_add_u32 s24, s24, 3584
    buffer_load_dwordx4 a[112:115], v4, s[8:11], s24 offen offset:0
    buffer_load_dwordx4 a[116:119], v4, s[8:11], s24 offen offset:128
    buffer_load_dwordx4 a[120:123], v4, s[8:11], s24 offen offset:512
    buffer_load_dwordx4 a[124:127], v4, s[8:11], s24 offen offset:640
    buffer_load_dwordx4 a[128:131], v4, s[8:11], s24 offen offset:1024
    buffer_load_dwordx4 a[132:135], v4, s[8:11], s24 offen offset:1152
    buffer_load_dwordx4 a[136:139], v4, s[8:11], s24 offen offset:1536
    buffer_load_dwordx4 a[140:143], v4, s[8:11], s24 offen offset:1664
    buffer_load_dwordx4 a[144:147], v4, s[8:11], s24 offen offset:2048
    buffer_load_dwordx4 a[148:151], v4, s[8:11], s24 offen offset:2176
    buffer_load_dwordx4 a[152:155], v4, s[8:11], s24 offen offset:2560
    buffer_load_dwordx4 a[156:159], v4, s[8:11], s24 offen offset:2688
    buffer_load_dwordx4 a[160:163], v4, s[8:11], s24 offen offset:3072
    buffer_load_dwordx4 a[164:167], v4, s[8:11], s24 offen offset:3200
    s_add_u32 s24, s24, 3584
    buffer_load_dwordx4 a[168:171], v4, s[8:11], s24 offen offset:0
    buffer_load_dwordx4 a[172:175], v4, s[8:11], s24 offen offset:128
    buffer_load_dwordx4 a[176:179], v4, s[8:11], s24 offen offset:512
    buffer_load_dwordx4 a[180:183], v4, s[8:11], s24 offen offset:640
    buffer_load_dwordx4 a[184:187], v4, s[8:11], s24 offen offset:1024
    buffer_load_dwordx4 a[188:191], v4, s[8:11], s24 offen offset:1152
    buffer_load_dwordx4 a[192:195], v4, s[8:11], s24 offen offset:1536
    buffer_load_dwordx4 a[196:199], v4, s[8:11], s24 offen offset:1664
    buffer_load_dwordx4 a[200:203], v4, s[8:11], s24 offen offset:2048
    buffer_load_dwordx4 a[204:207], v4, s[8:11], s24 offen offset:2176
    buffer_load_dwordx4 a[208:211], v4, s[8:11], s24 offen offset:2560
    buffer_load_dwordx4 a[212:215], v4, s[8:11], s24 offen offset:2688
    buffer_load_dwordx4 a[216:219], v4, s[8:11], s24 offen offset:3072
    buffer_load_dwordx4 a[220:223], v4, s[8:11], s24 offen offset:3200
    s_add_u32 s24, s24, 3584
    buffer_load_dwordx4 a[224:227], v4, s[8:11], s24 offen offset:0
    buffer_load_dwordx4 a[228:231], v4, s[8:11], s24 offen offset:128
    buffer_load_dwordx4 a[232:235], v4, s[8:11], s24 offen offset:512
    buffer_load_dwordx4 a[236:239], v4, s[8:11], s24 offen offset:640
    buffer_load_dwordx4 a[240:243], v4, s[8:11], s24 offen offset:1024
    buffer_load_dwordx4 a[244:247], v4, s[8:11], s24 offen offset:1152
    buffer_load_dwordx4 a[248:251], v4, s[8:11], s24 offen offset:1536
    buffer_load_dwordx4 a[252:255], v4, s[8:11], s24 offen offset:1664
    buffer_load_dwordx4 v[192:195], v4, s[8:11], s24 offen offset:2048
    buffer_load_dwordx4 v[196:199], v4, s[8:11], s24 offen offset:2176
    buffer_load_dwordx4 v[200:203], v4, s[8:11], s24 offen offset:2560
    buffer_load_dwordx4 v[204:207], v4, s[8:11], s24 offen offset:2688
    buffer_load_dwordx4 v[208:211], v4, s[8:11], s24 offen offset:3072
    buffer_load_dwordx4 v[212:215], v4, s[8:11], s24 offen offset:3200
    s_add_u32 s24, s24, 3584
    buffer_load_dwordx4 v[216:219], v4, s[8:11], s24 offen offset:0
    buffer_load_dwordx4 v[220:223], v4, s[8:11], s24 offen offset:128
    buffer_load_dwordx4 v[224:227], v4, s[8:11], s24 offen offset:512
    buffer_load_dwordx4 v[228:231], v4, s[8:11], s24 offen offset:640
    buffer_load_dwordx4 v[232:235], v4, s[8:11], s24 offen offset:1024
    buffer_load_dwordx4 v[236:239], v4, s[8:11], s24 offen offset:1152
    buffer_load_dwordx4 v[240:243], v4, s[8:11], s24 offen offset:1536
    buffer_load_dwordx4 v[244:247], v4, s[8:11], s24 offen offset:1664
    buffer_load_dwordx4 v[248:251], v4, s[8:11], s24 offen offset:2048
    buffer_load_dwordx4 v[252:255], v4, s[8:11], s24 offen offset:2176
    s_lshl_b32 s25, s13, 3
    v_add_u32 v10, s25, v10
    v_mul_u32_u24 v10, 640, v10
    v_lshl_add_u32 v10, v9, 7, v10
    v_lshl_add_u32 v10, v11, 4, v10
    v_add_u32 v3, 128, v10
    s_mul_i32 s17, s12, 20480
    s_mul_i32 s25, s14, 1638400
    s_add_u32 s17, s17, s25
    s_add_u32 s17, s17, 103809024
    s_mov_b32 s20, 1638400
    s_mul_i32 s19, s13, 10240
    s_add_u32 s19, s19, 220200960
    s_mov_b32 s22, 0
    s_min_u32 s24, s14, 63
    s_mul_i32 s24, s24, 40960
    s_add_u32 s24, s24, s19
    s_mul_i32 s25, s13, 10240
    s_add_u32 s25, s25, s22
    s_mov_b32 m0, s25
    s_nop 0
    buffer_load_dwordx4 v1, s[8:11], s24 offen offset:0 lds
    buffer_load_dwordx4 v1, s[8:11], s24 offen offset:1024 lds
    buffer_load_dwordx4 v1, s[8:11], s24 offen offset:2048 lds
    buffer_load_dwordx4 v1, s[8:11], s24 offen offset:3072 lds
    s_add_u32 s24, s24, 4096
    s_add_u32 s25, s25, 4096
    s_mov_b32 m0, s25
    s_nop 0
    buffer_load_dwordx4 v1, s[8:11], s24 offen offset:0 lds
    buffer_load_dwordx4 v1, s[8:11], s24 offen offset:1024 lds
    buffer_load_dwordx4 v1, s[8:11], s24 offen offset:2048 lds
    buffer_load_dwordx4 v1, s[8:11], s24 offen offset:3072 lds
    s_add_u32 s24, s24, 4096
    s_add_u32 s25, s25, 4096
    s_mov_b32 m0, s25
    s_nop 0
    buffer_load_dwordx4 v1, s[8:11], s24 offen offset:0 lds
    buffer_load_dwordx4 v1, s[8:11], s24 offen offset:1024 lds
    s_mov_b32 s22, 40960
    s_add_u32 s23, s14, 1
    s_min_u32 s24, s23, 63
    s_mul_i32 s24, s24, 40960
    s_add_u32 s24, s24, s19
    s_mul_i32 s25, s13, 10240
    s_add_u32 s25, s25, s22
    s_mov_b32 m0, s25
    s_nop 0
    buffer_load_dwordx4 v1, s[8:11], s24 offen offset:0 lds
    buffer_load_dwordx4 v1, s[8:11], s24 offen offset:1024 lds
    buffer_load_dwordx4 v1, s[8:11], s24 offen offset:2048 lds
    buffer_load_dwordx4 v1, s[8:11], s24 offen offset:3072 lds
    s_add_u32 s24, s24, 4096
    s_add_u32 s25, s25, 4096
    s_mov_b32 m0, s25
    s_nop 0
    buffer_load_dwordx4 v1, s[8:11], s24 offen offset:0 lds
    buffer_load_dwordx4 v1, s[8:11], s24 offen offset:1024 lds
    buffer_load_dwordx4 v1, s[8:11], s24 offen offset:2048 lds
    buffer_load_dwordx4 v1, s[8:11], s24 offen offset:3072 lds
    s_add_u32 s24, s24, 4096
    s_add_u32 s25, s25, 4096
    s_mov_b32 m0, s25
    s_nop 0
    buffer_load_dwordx4 v1, s[8:11], s24 offen offset:0 lds
    buffer_load_dwordx4 v1, s[8:11], s24 offen offset:1024 lds
    s_mov_b32 s22, 81920
    s_mov_b32 s16, 0
    s_waitcnt vmcnt(10)
    s_barrier
    v_mov_b32 v2, v1
    ds_read_b128 v[8:11], v2 offset:0
    ds_read_b128 v[12:15], v2 offset:1024
    ds_read_b128 v[16:19], v2 offset:2048
    ds_read_b128 v[20:23], v2 offset:3072
    ds_read_b128 v[24:27], v2 offset:4096
    ds_read_b128 v[28:31], v2 offset:5120
    ds_read_b128 v[32:35], v2 offset:6144
    s_waitcnt lgkmcnt(6)
    v_mfma_f32_32x32x16_bf16 v[40:55], v[8:11], a[0:3], 0
    v_mfma_f32_32x32x16_bf16 v[56:71], v[8:11], a[4:7], 0
    ds_read_b128 v[36:39], v2 offset:7168
    s_waitcnt lgkmcnt(6)
    v_mfma_f32_32x32x16_bf16 v[40:55], v[12:15], a[8:11], v[40:55]
    v_mfma_f32_32x32x16_bf16 v[56:71], v[12:15], a[12:15], v[56:71]
    ds_read_b128 v[8:11], v2 offset:8192
    s_waitcnt lgkmcnt(6)
    v_mfma_f32_32x32x16_bf16 v[40:55], v[16:19], a[16:19], v[40:55]
    v_mfma_f32_32x32x16_bf16 v[56:71], v[16:19], a[20:23], v[56:71]
    ds_read_b128 v[12:15], v2 offset:9216
    s_waitcnt lgkmcnt(6)
    v_mfma_f32_32x32x16_bf16 v[40:55], v[20:23], a[24:27], v[40:55]
    v_mfma_f32_32x32x16_bf16 v[56:71], v[20:23], a[28:31], v[56:71]
    ds_read_b128 v[16:19], v2 offset:10240
    s_waitcnt lgkmcnt(6)
    v_mfma_f32_32x32x16_bf16 v[40:55], v[24:27], a[32:35], v[40:55]
    v_mfma_f32_32x32x16_bf16 v[56:71], v[24:27], a[36:39], v[56:71]
    ds_read_b128 v[20:23], v2 offset:11264
    s_waitcnt lgkmcnt(6)
    v_mfma_f32_32x32x16_bf16 v[40:55], v[28:31], a[40:43], v[40:55]
    v_mfma_f32_32x32x16_bf16 v[56:71], v[28:31], a[44:47], v[56:71]
    ds_read_b128 v[24:27], v2 offset:12288
    s_waitcnt lgkmcnt(6)
    v_mfma_f32_32x32x16_bf16 v[40:55], v[32:35], a[48:51], v[40:55]
    v_mfma_f32_32x32x16_bf16 v[56:71], v[32:35], a[52:55], v[56:71]
    ds_read_b128 v[28:31], v2 offset:13312
    s_waitcnt lgkmcnt(6)
    v_mfma_f32_32x32x16_bf16 v[40:55], v[36:39], a[56:59], v[40:55]
    v_mfma_f32_32x32x16_bf16 v[56:71], v[36:39], a[60:63], v[56:71]
    ds_read_b128 v[32:35], v2 offset:14336
    s_waitcnt lgkmcnt(6)
    v_mfma_f32_32x32x16_bf16 v[40:55], v[8:11], a[64:67], v[40:55]
    v_mfma_f32_32x32x16_bf16 v[56:71], v[8:11], a[68:71], v[56:71]
    ds_read_b128 v[36:39], v2 offset:15360
    s_waitcnt lgkmcnt(6)
    v_mfma_f32_32x32x16_bf16 v[40:55], v[12:15], a[72:75], v[40:55]
    v_mfma_f32_32x32x16_bf16 v[56:71], v[12:15], a[76:79], v[56:71]
    ds_read_b128 v[8:11], v2 offset:16384
    s_waitcnt lgkmcnt(6)
    v_mfma_f32_32x32x16_bf16 v[40:55], v[16:19], a[80:83], v[40:55]
    v_mfma_f32_32x32x16_bf16 v[56:71], v[16:19], a[84:87], v[56:71]
    ds_read_b128 v[12:15], v2 offset:17408
    s_waitcnt lgkmcnt(6)
    v_mfma_f32_32x32x16_bf16 v[40:55], v[20:23], a[88:91], v[40:55]
    v_mfma_f32_32x32x16_bf16 v[56:71], v[20:23], a[92:95], v[56:71]
    ds_read_b128 v[16:19], v2 offset:18432
    s_waitcnt lgkmcnt(6)
    v_mfma_f32_32x32x16_bf16 v[40:55], v[24:27], a[96:99], v[40:55]
    v_mfma_f32_32x32x16_bf16 v[56:71], v[24:27], a[100:103], v[56:71]
    ds_read_b128 v[20:23], v2 offset:19456
    s_waitcnt lgkmcnt(6)
    v_mfma_f32_32x32x16_bf16 v[40:55], v[28:31], a[104:107], v[40:55]
    v_mfma_f32_32x32x16_bf16 v[56:71], v[28:31], a[108:111], v[56:71]
    ds_read_b128 v[24:27], v2 offset:20480
    s_waitcnt lgkmcnt(6)
    v_mfma_f32_32x32x16_bf16 v[40:55], v[32:35], a[112:115], v[40:55]
    v_mfma_f32_32x32x16_bf16 v[56:71], v[32:35], a[116:119], v[56:71]
    ds_read_b128 v[28:31], v2 offset:21504
    s_waitcnt lgkmcnt(6)
    v_mfma_f32_32x32x16_bf16 v[40:55], v[36:39], a[120:123], v[40:55]
    v_mfma_f32_32x32x16_bf16 v[56:71], v[36:39], a[124:127], v[56:71]
    ds_read_b128 v[32:35], v2 offset:22528
    s_waitcnt lgkmcnt(6)
    v_mfma_f32_32x32x16_bf16 v[40:55], v[8:11], a[128:131], v[40:55]
    v_mfma_f32_32x32x16_bf16 v[56:71], v[8:11], a[132:135], v[56:71]
    ds_read_b128 v[36:39], v2 offset:23552
    s_waitcnt lgkmcnt(6)
    v_mfma_f32_32x32x16_bf16 v[40:55], v[12:15], a[136:139], v[40:55]
    v_mfma_f32_32x32x16_bf16 v[56:71], v[12:15], a[140:143], v[56:71]
    ds_read_b128 v[8:11], v2 offset:24576
    s_waitcnt lgkmcnt(6)
    v_mfma_f32_32x32x16_bf16 v[40:55], v[16:19], a[144:147], v[40:55]
    v_mfma_f32_32x32x16_bf16 v[56:71], v[16:19], a[148:151], v[56:71]
    ds_read_b128 v[12:15], v2 offset:25600
    s_waitcnt lgkmcnt(6)
    v_mfma_f32_32x32x16_bf16 v[40:55], v[20:23], a[152:155], v[40:55]
    v_mfma_f32_32x32x16_bf16 v[56:71], v[20:23], a[156:159], v[56:71]
    ds_read_b128 v[16:19], v2 offset:26624
    s_waitcnt lgkmcnt(6)
    v_mfma_f32_32x32x16_bf16 v[40:55], v[24:27], a[160:163], v[40:55]
    v_mfma_f32_32x32x16_bf16 v[56:71], v[24:27], a[164:167], v[56:71]
    ds_read_b128 v[20:23], v2 offset:27648
    s_waitcnt lgkmcnt(6)
    v_mfma_f32_32x32x16_bf16 v[40:55], v[28:31], a[168:171], v[40:55]
    v_mfma_f32_32x32x16_bf16 v[56:71], v[28:31], a[172:175], v[56:71]
    ds_read_b128 v[24:27], v2 offset:28672
    s_waitcnt lgkmcnt(6)
    v_mfma_f32_32x32x16_bf16 v[40:55], v[32:35], a[176:179], v[40:55]
    v_mfma_f32_32x32x16_bf16 v[56:71], v[32:35], a[180:183], v[56:71]
    ds_read_b128 v[28:31], v2 offset:29696
    s_waitcnt lgkmcnt(6)
    v_mfma_f32_32x32x16_bf16 v[40:55], v[36:39], a[184:187], v[40:55]
    v_mfma_f32_32x32x16_bf16 v[56:71], v[36:39], a[188:191], v[56:71]
    ds_read_b128 v[32:35], v2 offset:30720
    s_waitcnt lgkmcnt(6)
    v_mfma_f32_32x32x16_bf16 v[40:55], v[8:11], a[192:195], v[40:55]
    v_mfma_f32_32x32x16_bf16 v[56:71], v[8:11], a[196:199], v[56:71]
    ds_read_b128 v[36:39], v2 offset:31744
    s_waitcnt lgkmcnt(6)
    v_mfma_f32_32x32x16_bf16 v[40:55], v[12:15], a[200:203], v[40:55]
    v_mfma_f32_32x32x16_bf16 v[56:71], v[12:15], a[204:207], v[56:71]
    ds_read_b128 v[8:11], v2 offset:32768
    s_waitcnt lgkmcnt(6)
    v_mfma_f32_32x32x16_bf16 v[40:55], v[16:19], a[208:211], v[40:55]
    v_mfma_f32_32x32x16_bf16 v[56:71], v[16:19], a[212:215], v[56:71]
    ds_read_b128 v[12:15], v2 offset:33792
    s_waitcnt lgkmcnt(6)
    v_mfma_f32_32x32x16_bf16 v[40:55], v[20:23], a[216:219], v[40:55]
    v_mfma_f32_32x32x16_bf16 v[56:71], v[20:23], a[220:223], v[56:71]
    ds_read_b128 v[16:19], v2 offset:34816
    s_waitcnt lgkmcnt(6)
    v_mfma_f32_32x32x16_bf16 v[40:55], v[24:27], a[224:227], v[40:55]
    v_mfma_f32_32x32x16_bf16 v[56:71], v[24:27], a[228:231], v[56:71]
    s_waitcnt vmcnt(0)
    s_barrier
    s_add_u32 s21, s16, 40960
    s_cmp_eq_u32 s21, 122880
    s_cselect_b32 s21, 0, s21
    s_add_u32 s23, s14, 2
    s_min_u32 s24, s23, 63
    s_mul_i32 s24, s24, 40960
    s_add_u32 s24, s24, s19
    s_mul_i32 s25, s13, 10240
    s_add_u32 s25, s25, s22
    s_mov_b32 m0, s25
    s_nop 0
    buffer_load_dwordx4 v1, s[8:11], s24 offen offset:0 lds
    buffer_load_dwordx4 v1, s[8:11], s24 offen offset:1024 lds
    buffer_load_dwordx4 v1, s[8:11], s24 offen offset:2048 lds
    buffer_load_dwordx4 v1, s[8:11], s24 offen offset:3072 lds
    s_add_u32 s24, s24, 4096
    s_add_u32 s25, s25, 4096
    s_mov_b32 m0, s25
    s_nop 0
    buffer_load_dwordx4 v1, s[8:11], s24 offen offset:0 lds
    buffer_load_dwordx4 v1, s[8:11], s24 offen offset:1024 lds
    buffer_load_dwordx4 v1, s[8:11], s24 offen offset:2048 lds
    buffer_load_dwordx4 v1, s[8:11], s24 offen offset:3072 lds
    s_add_u32 s24, s24, 4096
    s_add_u32 s25, s25, 4096
    s_mov_b32 m0, s25
    s_nop 0
    buffer_load_dwordx4 v1, s[8:11], s24 offen offset:0 lds
    buffer_load_dwordx4 v1, s[8:11], s24 offen offset:1024 lds
    s_add_u32 s22, s22, 40960
    s_cmp_eq_u32 s22, 122880
    s_cselect_b32 s22, 0, s22
    ds_read_b128 v[20:23], v2 offset:35840
    s_waitcnt lgkmcnt(6)
    v_mfma_f32_32x32x16_bf16 v[40:55], v[28:31], a[232:235], v[40:55]
    v_mfma_f32_32x32x16_bf16 v[56:71], v[28:31], a[236:239], v[56:71]
    ds_read_b128 v[24:27], v2 offset:36864
    s_waitcnt lgkmcnt(6)
    v_mfma_f32_32x32x16_bf16 v[40:55], v[32:35], a[240:243], v[40:55]
    v_mfma_f32_32x32x16_bf16 v[56:71], v[32:35], a[244:247], v[56:71]
    ds_read_b128 v[28:31], v2 offset:37888
    s_waitcnt lgkmcnt(6)
    v_mfma_f32_32x32x16_bf16 v[40:55], v[36:39], a[248:251], v[40:55]
    v_mfma_f32_32x32x16_bf16 v[56:71], v[36:39], a[252:255], v[56:71]
    ds_read_b128 v[32:35], v2 offset:38912
    s_waitcnt lgkmcnt(6)
    v_mfma_f32_32x32x16_bf16 v[40:55], v[8:11], v[192:195], v[40:55]
    v_mfma_f32_32x32x16_bf16 v[56:71], v[8:11], v[196:199], v[56:71]
    ds_read_b128 v[36:39], v2 offset:39936
    s_waitcnt lgkmcnt(6)
    v_mfma_f32_32x32x16_bf16 v[40:55], v[12:15], v[200:203], v[40:55]
    v_mfma_f32_32x32x16_bf16 v[56:71], v[12:15], v[204:207], v[56:71]
    v_add_u32 v6, s21, v1
    ds_read_b128 v[8:11], v6 offset:0
    s_waitcnt lgkmcnt(6)
    v_mfma_f32_32x32x16_bf16 v[40:55], v[16:19], v[208:211], v[40:55]
    v_mfma_f32_32x32x16_bf16 v[56:71], v[16:19], v[212:215], v[56:71]
    ds_read_b128 v[12:15], v6 offset:1024
    s_waitcnt lgkmcnt(6)
    v_mfma_f32_32x32x16_bf16 v[40:55], v[20:23], v[216:219], v[40:55]
    v_mfma_f32_32x32x16_bf16 v[56:71], v[20:23], v[220:223], v[56:71]
    ds_read_b128 v[16:19], v6 offset:2048
    s_waitcnt lgkmcnt(6)
    v_mfma_f32_32x32x16_bf16 v[40:55], v[24:27], v[224:227], v[40:55]
    v_mfma_f32_32x32x16_bf16 v[56:71], v[24:27], v[228:231], v[56:71]
    ds_read_b128 v[20:23], v6 offset:3072
    s_waitcnt lgkmcnt(6)
    v_mfma_f32_32x32x16_bf16 v[40:55], v[28:31], v[232:235], v[40:55]
    v_mfma_f32_32x32x16_bf16 v[56:71], v[28:31], v[236:239], v[56:71]
    ds_read_b128 v[24:27], v6 offset:4096
    s_waitcnt lgkmcnt(6)
    v_mfma_f32_32x32x16_bf16 v[40:55], v[32:35], v[240:243], v[40:55]
    v_mfma_f32_32x32x16_bf16 v[56:71], v[32:35], v[244:247], v[56:71]
    ds_read_b128 v[28:31], v6 offset:5120
    s_waitcnt lgkmcnt(6)
    v_mfma_f32_32x32x16_bf16 v[40:55], v[36:39], v[248:251], v[40:55]
    v_mfma_f32_32x32x16_bf16 v[56:71], v[36:39], v[252:255], v[56:71]
    v_mov_b32 v2, v6
    s_mov_b32 s16, s21
    s_add_u32 s14, s14, 1
    s_cmp_ge_u32 s14, s15
    s_cbranch_scc1 layerb1_kernel_gu_fin0
layerb1_kernel_gu_loop:
    ds_read_b128 v[32:35], v2 offset:6144
    s_waitcnt lgkmcnt(6)
    v_mfma_f32_32x32x16_bf16 v[72:87], v[8:11], a[0:3], 0
    v_mfma_f32_32x32x16_bf16 v[88:103], v[8:11], a[4:7], 0
    ds_read_b128 v[36:39], v2 offset:7168
    s_waitcnt lgkmcnt(6)
    v_mfma_f32_32x32x16_bf16 v[72:87], v[12:15], a[8:11], v[72:87]
    v_mfma_f32_32x32x16_bf16 v[88:103], v[12:15], a[12:15], v[88:103]
    ds_read_b128 v[8:11], v2 offset:8192
    s_waitcnt lgkmcnt(6)
    v_mfma_f32_32x32x16_bf16 v[72:87], v[16:19], a[16:19], v[72:87]
    v_cvt_pk_bf16_f32 v104, v40, v41
    v_mfma_f32_32x32x16_bf16 v[88:103], v[16:19], a[20:23], v[88:103]
    v_cvt_pk_bf16_f32 v105, v42, v43
    ds_read_b128 v[12:15], v2 offset:9216
    s_waitcnt lgkmcnt(6)
    v_mfma_f32_32x32x16_bf16 v[72:87], v[20:23], a[24:27], v[72:87]
    v_cvt_pk_bf16_f32 v106, v44, v45
    v_mfma_f32_32x32x16_bf16 v[88:103], v[20:23], a[28:31], v[88:103]
    v_cvt_pk_bf16_f32 v107, v46, v47
    ds_read_b128 v[16:19], v2 offset:10240
    s_waitcnt lgkmcnt(6)
    v_mfma_f32_32x32x16_bf16 v[72:87], v[24:27], a[32:35], v[72:87]
    s_nop 1
    v_mfma_f32_32x32x16_bf16 v[88:103], v[24:27], a[36:39], v[88:103]
    v_permlane32_swap_b32 v104, v106
    ds_read_b128 v[20:23], v2 offset:11264
    s_waitcnt lgkmcnt(6)
    v_mfma_f32_32x32x16_bf16 v[72:87], v[28:31], a[40:43], v[72:87]
    v_permlane32_swap_b32 v105, v107
    v_mfma_f32_32x32x16_bf16 v[88:103], v[28:31], a[44:47], v[88:103]
    buffer_store_dwordx4 v[104:107], v3, s[8:11], s17 offen offset:0 sc1
    ds_read_b128 v[24:27], v2 offset:12288
    s_waitcnt lgkmcnt(6)
    v_mfma_f32_32x32x16_bf16 v[72:87], v[32:35], a[48:51], v[72:87]
    v_cvt_pk_bf16_f32 v108, v48, v49
    v_mfma_f32_32x32x16_bf16 v[88:103], v[32:35], a[52:55], v[88:103]
    v_cvt_pk_bf16_f32 v109, v50, v51
    ds_read_b128 v[28:31], v2 offset:13312
    s_waitcnt lgkmcnt(6)
    v_mfma_f32_32x32x16_bf16 v[72:87], v[36:39], a[56:59], v[72:87]
    v_cvt_pk_bf16_f32 v110, v52, v53
    v_mfma_f32_32x32x16_bf16 v[88:103], v[36:39], a[60:63], v[88:103]
    v_cvt_pk_bf16_f32 v111, v54, v55
    ds_read_b128 v[32:35], v2 offset:14336
    s_waitcnt lgkmcnt(6)
    v_mfma_f32_32x32x16_bf16 v[72:87], v[8:11], a[64:67], v[72:87]
    s_nop 1
    v_mfma_f32_32x32x16_bf16 v[88:103], v[8:11], a[68:71], v[88:103]
    v_permlane32_swap_b32 v108, v110
    ds_read_b128 v[36:39], v2 offset:15360
    s_waitcnt lgkmcnt(6)
    v_mfma_f32_32x32x16_bf16 v[72:87], v[12:15], a[72:75], v[72:87]
    v_permlane32_swap_b32 v109, v111
    v_mfma_f32_32x32x16_bf16 v[88:103], v[12:15], a[76:79], v[88:103]
    buffer_store_dwordx4 v[108:111], v3, s[8:11], s17 offen offset:256 sc1
    ds_read_b128 v[8:11], v2 offset:16384
    s_waitcnt lgkmcnt(6)
    v_mfma_f32_32x32x16_bf16 v[72:87], v[16:19], a[80:83], v[72:87]
    v_cvt_pk_bf16_f32 v112, v56, v57
    v_mfma_f32_32x32x16_bf16 v[88:103], v[16:19], a[84:87], v[88:103]
    v_cvt_pk_bf16_f32 v113, v58, v59
    ds_read_b128 v[12:15], v2 offset:17408
    s_waitcnt lgkmcnt(6)
    v_mfma_f32_32x32x16_bf16 v[72:87], v[20:23], a[88:91], v[72:87]
    v_cvt_pk_bf16_f32 v114, v60, v61
    v_mfma_f32_32x32x16_bf16 v[88:103], v[20:23], a[92:95], v[88:103]
    v_cvt_pk_bf16_f32 v115, v62, v63
    ds_read_b128 v[16:19], v2 offset:18432
    s_waitcnt lgkmcnt(6)
    v_mfma_f32_32x32x16_bf16 v[72:87], v[24:27], a[96:99], v[72:87]
    s_nop 1
    v_mfma_f32_32x32x16_bf16 v[88:103], v[24:27], a[100:103], v[88:103]
    v_permlane32_swap_b32 v112, v114
    ds_read_b128 v[20:23], v2 offset:19456
    s_waitcnt lgkmcnt(6)
    v_mfma_f32_32x32x16_bf16 v[72:87], v[28:31], a[104:107], v[72:87]
    v_permlane32_swap_b32 v113, v115
    v_mfma_f32_32x32x16_bf16 v[88:103], v[28:31], a[108:111], v[88:103]
    buffer_store_dwordx4 v[112:115], v3, s[8:11], s17 offen offset:2560 sc1
    ds_read_b128 v[24:27], v2 offset:20480
    s_waitcnt lgkmcnt(6)
    v_mfma_f32_32x32x16_bf16 v[72:87], v[32:35], a[112:115], v[72:87]
    v_cvt_pk_bf16_f32 v116, v64, v65
    v_mfma_f32_32x32x16_bf16 v[88:103], v[32:35], a[116:119], v[88:103]
    v_cvt_pk_bf16_f32 v117, v66, v67
    ds_read_b128 v[28:31], v2 offset:21504
    s_waitcnt lgkmcnt(6)
    v_mfma_f32_32x32x16_bf16 v[72:87], v[36:39], a[120:123], v[72:87]
    v_cvt_pk_bf16_f32 v118, v68, v69
    v_mfma_f32_32x32x16_bf16 v[88:103], v[36:39], a[124:127], v[88:103]
    v_cvt_pk_bf16_f32 v119, v70, v71
    ds_read_b128 v[32:35], v2 offset:22528
    s_waitcnt lgkmcnt(6)
    v_mfma_f32_32x32x16_bf16 v[72:87], v[8:11], a[128:131], v[72:87]
    s_nop 1
    v_mfma_f32_32x32x16_bf16 v[88:103], v[8:11], a[132:135], v[88:103]
    v_permlane32_swap_b32 v116, v118
    ds_read_b128 v[36:39], v2 offset:23552
    s_waitcnt lgkmcnt(6)
    v_mfma_f32_32x32x16_bf16 v[72:87], v[12:15], a[136:139], v[72:87]
    v_permlane32_swap_b32 v117, v119
    v_mfma_f32_32x32x16_bf16 v[88:103], v[12:15], a[140:143], v[88:103]
    buffer_store_dwordx4 v[116:119], v3, s[8:11], s17 offen offset:2816 sc1
    ds_read_b128 v[8:11], v2 offset:24576
    s_waitcnt lgkmcnt(6)
    v_mfma_f32_32x32x16_bf16 v[72:87], v[16:19], a[144:147], v[72:87]
    s_add_u32 s17, s17, s20
    v_mfma_f32_32x32x16_bf16 v[88:103], v[16:19], a[148:151], v[88:103]
    s_add_u32 s18, s18, s20
    ds_read_b128 v[12:15], v2 offset:25600
    s_waitcnt lgkmcnt(6)
    v_mfma_f32_32x32x16_bf16 v[72:87], v[20:23], a[152:155], v[72:87]
    v_mfma_f32_32x32x16_bf16 v[88:103], v[20:23], a[156:159], v[88:103]
    ds_read_b128 v[16:19], v2 offset:26624
    s_waitcnt lgkmcnt(6)
    v_mfma_f32_32x32x16_bf16 v[72:87], v[24:27], a[160:163], v[72:87]
    v_mfma_f32_32x32x16_bf16 v[88:103], v[24:27], a[164:167], v[88:103]
    ds_read_b128 v[20:23], v2 offset:27648
    s_waitcnt lgkmcnt(6)
    v_mfma_f32_32x32x16_bf16 v[72:87], v[28:31], a[168:171], v[72:87]
    v_mfma_f32_32x32x16_bf16 v[88:103], v[28:31], a[172:175], v[88:103]
    ds_read_b128 v[24:27], v2 offset:28672
    s_waitcnt lgkmcnt(6)
    v_mfma_f32_32x32x16_bf16 v[72:87], v[32:35], a[176:179], v[72:87]
    v_mfma_f32_32x32x16_bf16 v[88:103], v[32:35], a[180:183], v[88:103]
    ds_read_b128 v[28:31], v2 offset:29696
    s_waitcnt lgkmcnt(6)
    v_mfma_f32_32x32x16_bf16 v[72:87], v[36:39], a[184:187], v[72:87]
    v_mfma_f32_32x32x16_bf16 v[88:103], v[36:39], a[188:191], v[88:103]
    ds_read_b128 v[32:35], v2 offset:30720
    s_waitcnt lgkmcnt(6)
    v_mfma_f32_32x32x16_bf16 v[72:87], v[8:11], a[192:195], v[72:87]
    v_mfma_f32_32x32x16_bf16 v[88:103], v[8:11], a[196:199], v[88:103]
    ds_read_b128 v[36:39], v2 offset:31744
    s_waitcnt lgkmcnt(6)
    v_mfma_f32_32x32x16_bf16 v[72:87], v[12:15], a[200:203], v[72:87]
    v_mfma_f32_32x32x16_bf16 v[88:103], v[12:15], a[204:207], v[88:103]
    ds_read_b128 v[8:11], v2 offset:32768
    s_waitcnt lgkmcnt(6)
    v_mfma_f32_32x32x16_bf16 v[72:87], v[16:19], a[208:211], v[72:87]
    v_mfma_f32_32x32x16_bf16 v[88:103], v[16:19], a[212:215], v[88:103]
    ds_read_b128 v[12:15], v2 offset:33792
    s_waitcnt lgkmcnt(6)
    v_mfma_f32_32x32x16_bf16 v[72:87], v[20:23], a[216:219], v[72:87]
    v_mfma_f32_32x32x16_bf16 v[88:103], v[20:23], a[220:223], v[88:103]
    ds_read_b128 v[16:19], v2 offset:34816
    s_waitcnt lgkmcnt(6)
    v_mfma_f32_32x32x16_bf16 v[72:87], v[24:27], a[224:227], v[72:87]
    v_mfma_f32_32x32x16_bf16 v[88:103], v[24:27], a[228:231], v[88:103]
    s_cmp_gt_u32 s14, 2
    s_cbranch_scc1 layerb1_kernel_gu_dr1
    s_waitcnt vmcnt(0)
    s_mov_b32 s27, s14
    s_branch layerb1_kernel_gu_dq1
layerb1_kernel_gu_dr1:
    s_waitcnt vmcnt(4)
    s_sub_u32 s27, s14, 1
layerb1_kernel_gu_dq1:
    s_barrier
    s_cmp_lg_u32 s13, 0
    s_cbranch_scc1 layerb1_kernel_gu_fl2
    s_mov_b64 exec, 1
    s_lshl_b32 s26, s12, 7
    v_mov_b32 v7, s26
    v_mov_b32 v120, s27
    buffer_store_dword v120, v7, s[8:11], s48 offen sc1
    s_mov_b64 exec, -1
layerb1_kernel_gu_fl2:
    s_add_u32 s21, s16, 40960
    s_cmp_eq_u32 s21, 122880
    s_cselect_b32 s21, 0, s21
    s_add_u32 s23, s14, 2
    s_min_u32 s24, s23, 63
    s_mul_i32 s24, s24, 40960
    s_add_u32 s24, s24, s19
    s_mul_i32 s25, s13, 10240
    s_add_u32 s25, s25, s22
    s_mov_b32 m0, s25
    s_nop 0
    buffer_load_dwordx4 v1, s[8:11], s24 offen offset:0 lds
    buffer_load_dwordx4 v1, s[8:11], s24 offen offset:1024 lds
    buffer_load_dwordx4 v1, s[8:11], s24 offen offset:2048 lds
    buffer_load_dwordx4 v1, s[8:11], s24 offen offset:3072 lds
    s_add_u32 s24, s24, 4096
    s_add_u32 s25, s25, 4096
    s_mov_b32 m0, s25
    s_nop 0
    buffer_load_dwordx4 v1, s[8:11], s24 offen offset:0 lds
    buffer_load_dwordx4 v1, s[8:11], s24 offen offset:1024 lds
    buffer_load_dwordx4 v1, s[8:11], s24 offen offset:2048 lds
    buffer_load_dwordx4 v1, s[8:11], s24 offen offset:3072 lds
    s_add_u32 s24, s24, 4096
    s_add_u32 s25, s25, 4096
    s_mov_b32 m0, s25
    s_nop 0
    buffer_load_dwordx4 v1, s[8:11], s24 offen offset:0 lds
    buffer_load_dwordx4 v1, s[8:11], s24 offen offset:1024 lds
    s_add_u32 s22, s22, 40960
    s_cmp_eq_u32 s22, 122880
    s_cselect_b32 s22, 0, s22
    ds_read_b128 v[20:23], v2 offset:35840
    s_waitcnt lgkmcnt(6)
    v_mfma_f32_32x32x16_bf16 v[72:87], v[28:31], a[232:235], v[72:87]
    v_mfma_f32_32x32x16_bf16 v[88:103], v[28:31], a[236:239], v[88:103]
    ds_read_b128 v[24:27], v2 offset:36864
    s_waitcnt lgkmcnt(6)
    v_mfma_f32_32x32x16_bf16 v[72:87], v[32:35], a[240:243], v[72:87]
    v_mfma_f32_32x32x16_bf16 v[88:103], v[32:35], a[244:247], v[88:103]
    ds_read_b128 v[28:31], v2 offset:37888
    s_waitcnt lgkmcnt(6)
    v_mfma_f32_32x32x16_bf16 v[72:87], v[36:39], a[248:251], v[72:87]
    v_mfma_f32_32x32x16_bf16 v[88:103], v[36:39], a[252:255], v[88:103]
    ds_read_b128 v[32:35], v2 offset:38912
    s_waitcnt lgkmcnt(6)
    v_mfma_f32_32x32x16_bf16 v[72:87], v[8:11], v[192:195], v[72:87]
    v_mfma_f32_32x32x16_bf16 v[88:103], v[8:11], v[196:199], v[88:103]
    ds_read_b128 v[36:39], v2 offset:39936
    s_waitcnt lgkmcnt(6)
    v_mfma_f32_32x32x16_bf16 v[72:87], v[12:15], v[200:203], v[72:87]
    v_mfma_f32_32x32x16_bf16 v[88:103], v[12:15], v[204:207], v[88:103]
    v_add_u32 v6, s21, v1
    ds_read_b128 v[8:11], v6 offset:0
    s_waitcnt lgkmcnt(6)
    v_mfma_f32_32x32x16_bf16 v[72:87], v[16:19], v[208:211], v[72:87]
    v_mfma_f32_32x32x16_bf16 v[88:103], v[16:19], v[212:215], v[88:103]
    ds_read_b128 v[12:15], v6 offset:1024
    s_waitcnt lgkmcnt(6)
    v_mfma_f32_32x32x16_bf16 v[72:87], v[20:23], v[216:219], v[72:87]
    v_mfma_f32_32x32x16_bf16 v[88:103], v[20:23], v[220:223], v[88:103]
    ds_read_b128 v[16:19], v6 offset:2048
    s_waitcnt lgkmcnt(6)
    v_mfma_f32_32x32x16_bf16 v[72:87], v[24:27], v[224:227], v[72:87]
    v_mfma_f32_32x32x16_bf16 v[88:103], v[24:27], v[228:231], v[88:103]
    ds_read_b128 v[20:23], v6 offset:3072
    s_waitcnt lgkmcnt(6)
    v_mfma_f32_32x32x16_bf16 v[72:87], v[28:31], v[232:235], v[72:87]
    v_mfma_f32_32x32x16_bf16 v[88:103], v[28:31], v[236:239], v[88:103]
    ds_read_b128 v[24:27], v6 offset:4096
    s_waitcnt lgkmcnt(6)
    v_mfma_f32_32x32x16_bf16 v[72:87], v[32:35], v[240:243], v[72:87]
    v_mfma_f32_32x32x16_bf16 v[88:103], v[32:35], v[244:247], v[88:103]
    ds_read_b128 v[28:31], v6 offset:5120
    s_waitcnt lgkmcnt(6)
    v_mfma_f32_32x32x16_bf16 v[72:87], v[36:39], v[248:251], v[72:87]
    v_mfma_f32_32x32x16_bf16 v[88:103], v[36:39], v[252:255], v[88:103]
    v_mov_b32 v2, v6
    s_mov_b32 s16, s21
    s_add_u32 s14, s14, 1
    s_cmp_ge_u32 s14, s15
    s_cbranch_scc1 layerb1_kernel_gu_fin1
    ds_read_b128 v[32:35], v2 offset:6144
    s_waitcnt lgkmcnt(6)
    v_mfma_f32_32x32x16_bf16 v[40:55], v[8:11], a[0:3], 0
    v_mfma_f32_32x32x16_bf16 v[56:71], v[8:11], a[4:7], 0
    ds_read_b128 v[36:39], v2 offset:7168
    s_waitcnt lgkmcnt(6)
    v_mfma_f32_32x32x16_bf16 v[40:55], v[12:15], a[8:11], v[40:55]
    v_mfma_f32_32x32x16_bf16 v[56:71], v[12:15], a[12:15], v[56:71]
    ds_read_b128 v[8:11], v2 offset:8192
    s_waitcnt lgkmcnt(6)
    v_mfma_f32_32x32x16_bf16 v[40:55], v[16:19], a[16:19], v[40:55]
    v_cvt_pk_bf16_f32 v104, v72, v73
    v_mfma_f32_32x32x16_bf16 v[56:71], v[16:19], a[20:23], v[56:71]
    v_cvt_pk_bf16_f32 v105, v74, v75
    ds_read_b128 v[12:15], v2 offset:9216
    s_waitcnt lgkmcnt(6)
    v_mfma_f32_32x32x16_bf16 v[40:55], v[20:23], a[24:27], v[40:55]
    v_cvt_pk_bf16_f32 v106, v76, v77
    v_mfma_f32_32x32x16_bf16 v[56:71], v[20:23], a[28:31], v[56:71]
    v_cvt_pk_bf16_f32 v107, v78, v79
    ds_read_b128 v[16:19], v2 offset:10240
    s_waitcnt lgkmcnt(6)
    v_mfma_f32_32x32x16_bf16 v[40:55], v[24:27], a[32:35], v[40:55]
    s_nop 1
    v_mfma_f32_32x32x16_bf16 v[56:71], v[24:27], a[36:39], v[56:71]
    v_permlane32_swap_b32 v104, v106
    ds_read_b128 v[20:23], v2 offset:11264
    s_waitcnt lgkmcnt(6)
    v_mfma_f32_32x32x16_bf16 v[40:55], v[28:31], a[40:43], v[40:55]
    v_permlane32_swap_b32 v105, v107
    v_mfma_f32_32x32x16_bf16 v[56:71], v[28:31], a[44:47], v[56:71]
    buffer_store_dwordx4 v[104:107], v3, s[8:11], s17 offen offset:0 sc1
    ds_read_b128 v[24:27], v2 offset:12288
    s_waitcnt lgkmcnt(6)
    v_mfma_f32_32x32x16_bf16 v[40:55], v[32:35], a[48:51], v[40:55]
    v_cvt_pk_bf16_f32 v108, v80, v81
    v_mfma_f32_32x32x16_bf16 v[56:71], v[32:35], a[52:55], v[56:71]
    v_cvt_pk_bf16_f32 v109, v82, v83
    ds_read_b128 v[28:31], v2 offset:13312
    s_waitcnt lgkmcnt(6)
    v_mfma_f32_32x32x16_bf16 v[40:55], v[36:39], a[56:59], v[40:55]
    v_cvt_pk_bf16_f32 v110, v84, v85
    v_mfma_f32_32x32x16_bf16 v[56:71], v[36:39], a[60:63], v[56:71]
    v_cvt_pk_bf16_f32 v111, v86, v87
    ds_read_b128 v[32:35], v2 offset:14336
    s_waitcnt lgkmcnt(6)
    v_mfma_f32_32x32x16_bf16 v[40:55], v[8:11], a[64:67], v[40:55]
    s_nop 1
    v_mfma_f32_32x32x16_bf16 v[56:71], v[8:11], a[68:71], v[56:71]
    v_permlane32_swap_b32 v108, v110
    ds_read_b128 v[36:39], v2 offset:15360
    s_waitcnt lgkmcnt(6)
    v_mfma_f32_32x32x16_bf16 v[40:55], v[12:15], a[72:75], v[40:55]
    v_permlane32_swap_b32 v109, v111
    v_mfma_f32_32x32x16_bf16 v[56:71], v[12:15], a[76:79], v[56:71]
    buffer_store_dwordx4 v[108:111], v3, s[8:11], s17 offen offset:256 sc1
    ds_read_b128 v[8:11], v2 offset:16384
    s_waitcnt lgkmcnt(6)
    v_mfma_f32_32x32x16_bf16 v[40:55], v[16:19], a[80:83], v[40:55]
    v_cvt_pk_bf16_f32 v112, v88, v89
    v_mfma_f32_32x32x16_bf16 v[56:71], v[16:19], a[84:87], v[56:71]
    v_cvt_pk_bf16_f32 v113, v90, v91
    ds_read_b128 v[12:15], v2 offset:17408
    s_waitcnt lgkmcnt(6)
    v_mfma_f32_32x32x16_bf16 v[40:55], v[20:23], a[88:91], v[40:55]
    v_cvt_pk_bf16_f32 v114, v92, v93
    v_mfma_f32_32x32x16_bf16 v[56:71], v[20:23], a[92:95], v[56:71]
    v_cvt_pk_bf16_f32 v115, v94, v95
    ds_read_b128 v[16:19], v2 offset:18432
    s_waitcnt lgkmcnt(6)
    v_mfma_f32_32x32x16_bf16 v[40:55], v[24:27], a[96:99], v[40:55]
    s_nop 1
    v_mfma_f32_32x32x16_bf16 v[56:71], v[24:27], a[100:103], v[56:71]
    v_permlane32_swap_b32 v112, v114
    ds_read_b128 v[20:23], v2 offset:19456
    s_waitcnt lgkmcnt(6)
    v_mfma_f32_32x32x16_bf16 v[40:55], v[28:31], a[104:107], v[40:55]
    v_permlane32_swap_b32 v113, v115
    v_mfma_f32_32x32x16_bf16 v[56:71], v[28:31], a[108:111], v[56:71]
    buffer_store_dwordx4 v[112:115], v3, s[8:11], s17 offen offset:2560 sc1
    ds_read_b128 v[24:27], v2 offset:20480
    s_waitcnt lgkmcnt(6)
    v_mfma_f32_32x32x16_bf16 v[40:55], v[32:35], a[112:115], v[40:55]
    v_cvt_pk_bf16_f32 v116, v96, v97
    v_mfma_f32_32x32x16_bf16 v[56:71], v[32:35], a[116:119], v[56:71]
    v_cvt_pk_bf16_f32 v117, v98, v99
    ds_read_b128 v[28:31], v2 offset:21504
    s_waitcnt lgkmcnt(6)
    v_mfma_f32_32x32x16_bf16 v[40:55], v[36:39], a[120:123], v[40:55]
    v_cvt_pk_bf16_f32 v118, v100, v101
    v_mfma_f32_32x32x16_bf16 v[56:71], v[36:39], a[124:127], v[56:71]
    v_cvt_pk_bf16_f32 v119, v102, v103
    ds_read_b128 v[32:35], v2 offset:22528
    s_waitcnt lgkmcnt(6)
    v_mfma_f32_32x32x16_bf16 v[40:55], v[8:11], a[128:131], v[40:55]
    s_nop 1
    v_mfma_f32_32x32x16_bf16 v[56:71], v[8:11], a[132:135], v[56:71]
    v_permlane32_swap_b32 v116, v118
    ds_read_b128 v[36:39], v2 offset:23552
    s_waitcnt lgkmcnt(6)
    v_mfma_f32_32x32x16_bf16 v[40:55], v[12:15], a[136:139], v[40:55]
    v_permlane32_swap_b32 v117, v119
    v_mfma_f32_32x32x16_bf16 v[56:71], v[12:15], a[140:143], v[56:71]
    buffer_store_dwordx4 v[116:119], v3, s[8:11], s17 offen offset:2816 sc1
    ds_read_b128 v[8:11], v2 offset:24576
    s_waitcnt lgkmcnt(6)
    v_mfma_f32_32x32x16_bf16 v[40:55], v[16:19], a[144:147], v[40:55]
    s_add_u32 s17, s17, s20
    v_mfma_f32_32x32x16_bf16 v[56:71], v[16:19], a[148:151], v[56:71]
    s_add_u32 s18, s18, s20
    ds_read_b128 v[12:15], v2 offset:25600
    s_waitcnt lgkmcnt(6)
    v_mfma_f32_32x32x16_bf16 v[40:55], v[20:23], a[152:155], v[40:55]
    v_mfma_f32_32x32x16_bf16 v[56:71], v[20:23], a[156:159], v[56:71]
    ds_read_b128 v[16:19], v2 offset:26624
    s_waitcnt lgkmcnt(6)
    v_mfma_f32_32x32x16_bf16 v[40:55], v[24:27], a[160:163], v[40:55]
    v_mfma_f32_32x32x16_bf16 v[56:71], v[24:27], a[164:167], v[56:71]
    ds_read_b128 v[20:23], v2 offset:27648
    s_waitcnt lgkmcnt(6)
    v_mfma_f32_32x32x16_bf16 v[40:55], v[28:31], a[168:171], v[40:55]
    v_mfma_f32_32x32x16_bf16 v[56:71], v[28:31], a[172:175], v[56:71]
    ds_read_b128 v[24:27], v2 offset:28672
    s_waitcnt lgkmcnt(6)
    v_mfma_f32_32x32x16_bf16 v[40:55], v[32:35], a[176:179], v[40:55]
    v_mfma_f32_32x32x16_bf16 v[56:71], v[32:35], a[180:183], v[56:71]
    ds_read_b128 v[28:31], v2 offset:29696
    s_waitcnt lgkmcnt(6)
    v_mfma_f32_32x32x16_bf16 v[40:55], v[36:39], a[184:187], v[40:55]
    v_mfma_f32_32x32x16_bf16 v[56:71], v[36:39], a[188:191], v[56:71]
    ds_read_b128 v[32:35], v2 offset:30720
    s_waitcnt lgkmcnt(6)
    v_mfma_f32_32x32x16_bf16 v[40:55], v[8:11], a[192:195], v[40:55]
    v_mfma_f32_32x32x16_bf16 v[56:71], v[8:11], a[196:199], v[56:71]
    ds_read_b128 v[36:39], v2 offset:31744
    s_waitcnt lgkmcnt(6)
    v_mfma_f32_32x32x16_bf16 v[40:55], v[12:15], a[200:203], v[40:55]
    v_mfma_f32_32x32x16_bf16 v[56:71], v[12:15], a[204:207], v[56:71]
    ds_read_b128 v[8:11], v2 offset:32768
    s_waitcnt lgkmcnt(6)
    v_mfma_f32_32x32x16_bf16 v[40:55], v[16:19], a[208:211], v[40:55]
    v_mfma_f32_32x32x16_bf16 v[56:71], v[16:19], a[212:215], v[56:71]
    ds_read_b128 v[12:15], v2 offset:33792
    s_waitcnt lgkmcnt(6)
    v_mfma_f32_32x32x16_bf16 v[40:55], v[20:23], a[216:219], v[40:55]
    v_mfma_f32_32x32x16_bf16 v[56:71], v[20:23], a[220:223], v[56:71]
    ds_read_b128 v[16:19], v2 offset:34816
    s_waitcnt lgkmcnt(6)
    v_mfma_f32_32x32x16_bf16 v[40:55], v[24:27], a[224:227], v[40:55]
    v_mfma_f32_32x32x16_bf16 v[56:71], v[24:27], a[228:231], v[56:71]
    s_cmp_gt_u32 s14, 2
    s_cbranch_scc1 layerb1_kernel_gu_dr3
    s_waitcnt vmcnt(0)
    s_mov_b32 s27, s14
    s_branch layerb1_kernel_gu_dq3
layerb1_kernel_gu_dr3:
    s_waitcnt vmcnt(4)
    s_sub_u32 s27, s14, 1
layerb1_kernel_gu_dq3:
    s_barrier
    s_cmp_lg_u32 s13, 0
    s_cbranch_scc1 layerb1_kernel_gu_fl4
    s_mov_b64 exec, 1
    s_lshl_b32 s26, s12, 7
    v_mov_b32 v7, s26
    v_mov_b32 v120, s27
    buffer_store_dword v120, v7, s[8:11], s48 offen sc1
    s_mov_b64 exec, -1
layerb1_kernel_gu_fl4:
    s_add_u32 s21, s16, 40960
    s_cmp_eq_u32 s21, 122880
    s_cselect_b32 s21, 0, s21
    s_add_u32 s23, s14, 2
    s_min_u32 s24, s23, 63
    s_mul_i32 s24, s24, 40960
    s_add_u32 s24, s24, s19
    s_mul_i32 s25, s13, 10240
    s_add_u32 s25, s25, s22
    s_mov_b32 m0, s25
    s_nop 0
    buffer_load_dwordx4 v1, s[8:11], s24 offen offset:0 lds
    buffer_load_dwordx4 v1, s[8:11], s24 offen offset:1024 lds
    buffer_load_dwordx4 v1, s[8:11], s24 offen offset:2048 lds
    buffer_load_dwordx4 v1, s[8:11], s24 offen offset:3072 lds
    s_add_u32 s24, s24, 4096
    s_add_u32 s25, s25, 4096
    s_mov_b32 m0, s25
    s_nop 0
    buffer_load_dwordx4 v1, s[8:11], s24 offen offset:0 lds
    buffer_load_dwordx4 v1, s[8:11], s24 offen offset:1024 lds
    buffer_load_dwordx4 v1, s[8:11], s24 offen offset:2048 lds
    buffer_load_dwordx4 v1, s[8:11], s24 offen offset:3072 lds
    s_add_u32 s24, s24, 4096
    s_add_u32 s25, s25, 4096
    s_mov_b32 m0, s25
    s_nop 0
    buffer_load_dwordx4 v1, s[8:11], s24 offen offset:0 lds
    buffer_load_dwordx4 v1, s[8:11], s24 offen offset:1024 lds
    s_add_u32 s22, s22, 40960
    s_cmp_eq_u32 s22, 122880
    s_cselect_b32 s22, 0, s22
    ds_read_b128 v[20:23], v2 offset:35840
    s_waitcnt lgkmcnt(6)
    v_mfma_f32_32x32x16_bf16 v[40:55], v[28:31], a[232:235], v[40:55]
    v_mfma_f32_32x32x16_bf16 v[56:71], v[28:31], a[236:239], v[56:71]
    ds_read_b128 v[24:27], v2 offset:36864
    s_waitcnt lgkmcnt(6)
    v_mfma_f32_32x32x16_bf16 v[40:55], v[32:35], a[240:243], v[40:55]
    v_mfma_f32_32x32x16_bf16 v[56:71], v[32:35], a[244:247], v[56:71]
    ds_read_b128 v[28:31], v2 offset:37888
    s_waitcnt lgkmcnt(6)
    v_mfma_f32_32x32x16_bf16 v[40:55], v[36:39], a[248:251], v[40:55]
    v_mfma_f32_32x32x16_bf16 v[56:71], v[36:39], a[252:255], v[56:71]
    ds_read_b128 v[32:35], v2 offset:38912
    s_waitcnt lgkmcnt(6)
    v_mfma_f32_32x32x16_bf16 v[40:55], v[8:11], v[192:195], v[40:55]
    v_mfma_f32_32x32x16_bf16 v[56:71], v[8:11], v[196:199], v[56:71]
    ds_read_b128 v[36:39], v2 offset:39936
    s_waitcnt lgkmcnt(6)
    v_mfma_f32_32x32x16_bf16 v[40:55], v[12:15], v[200:203], v[40:55]
    v_mfma_f32_32x32x16_bf16 v[56:71], v[12:15], v[204:207], v[56:71]
    v_add_u32 v6, s21, v1
    ds_read_b128 v[8:11], v6 offset:0
    s_waitcnt lgkmcnt(6)
    v_mfma_f32_32x32x16_bf16 v[40:55], v[16:19], v[208:211], v[40:55]
    v_mfma_f32_32x32x16_bf16 v[56:71], v[16:19], v[212:215], v[56:71]
    ds_read_b128 v[12:15], v6 offset:1024
    s_waitcnt lgkmcnt(6)
    v_mfma_f32_32x32x16_bf16 v[40:55], v[20:23], v[216:219], v[40:55]
    v_mfma_f32_32x32x16_bf16 v[56:71], v[20:23], v[220:223], v[56:71]
    ds_read_b128 v[16:19], v6 offset:2048
    s_waitcnt lgkmcnt(6)
    v_mfma_f32_32x32x16_bf16 v[40:55], v[24:27], v[224:227], v[40:55]
    v_mfma_f32_32x32x16_bf16 v[56:71], v[24:27], v[228:231], v[56:71]
    ds_read_b128 v[20:23], v6 offset:3072
    s_waitcnt lgkmcnt(6)
    v_mfma_f32_32x32x16_bf16 v[40:55], v[28:31], v[232:235], v[40:55]
    v_mfma_f32_32x32x16_bf16 v[56:71], v[28:31], v[236:239], v[56:71]
    ds_read_b128 v[24:27], v6 offset:4096
    s_waitcnt lgkmcnt(6)
    v_mfma_f32_32x32x16_bf16 v[40:55], v[32:35], v[240:243], v[40:55]
    v_mfma_f32_32x32x16_bf16 v[56:71], v[32:35], v[244:247], v[56:71]
    ds_read_b128 v[28:31], v6 offset:5120
    s_waitcnt lgkmcnt(6)
    v_mfma_f32_32x32x16_bf16 v[40:55], v[36:39], v[248:251], v[40:55]
    v_mfma_f32_32x32x16_bf16 v[56:71], v[36:39], v[252:255], v[56:71]
    v_mov_b32 v2, v6
    s_mov_b32 s16, s21
    s_add_u32 s14, s14, 1
    s_cmp_lt_u32 s14, s15
    s_cbranch_scc1 layerb1_kernel_gu_loop
layerb1_kernel_gu_fin0:
    s_nop 7
    s_nop 7
    v_cvt_pk_bf16_f32 v104, v40, v41
    v_cvt_pk_bf16_f32 v105, v42, v43
    v_cvt_pk_bf16_f32 v106, v44, v45
    v_cvt_pk_bf16_f32 v107, v46, v47
    s_nop 1
    v_permlane32_swap_b32 v104, v106
    v_permlane32_swap_b32 v105, v107
    buffer_store_dwordx4 v[104:107], v3, s[8:11], s17 offen offset:0 sc1
    v_cvt_pk_bf16_f32 v108, v48, v49
    v_cvt_pk_bf16_f32 v109, v50, v51
    v_cvt_pk_bf16_f32 v110, v52, v53
    v_cvt_pk_bf16_f32 v111, v54, v55
    s_nop 1
    v_permlane32_swap_b32 v108, v110
    v_permlane32_swap_b32 v109, v111
    buffer_store_dwordx4 v[108:111], v3, s[8:11], s17 offen offset:256 sc1
    v_cvt_pk_bf16_f32 v112, v56, v57
    v_cvt_pk_bf16_f32 v113, v58, v59
    v_cvt_pk_bf16_f32 v114, v60, v61
    v_cvt_pk_bf16_f32 v115, v62, v63
    s_nop 1
    v_permlane32_swap_b32 v112, v114
    v_permlane32_swap_b32 v113, v115
    buffer_store_dwordx4 v[112:115], v3, s[8:11], s17 offen offset:2560 sc1
    v_cvt_pk_bf16_f32 v116, v64, v65
    v_cvt_pk_bf16_f32 v117, v66, v67
    v_cvt_pk_bf16_f32 v118, v68, v69
    v_cvt_pk_bf16_f32 v119, v70, v71
    s_nop 1
    v_permlane32_swap_b32 v116, v118
    v_permlane32_swap_b32 v117, v119
    buffer_store_dwordx4 v[116:119], v3, s[8:11], s17 offen offset:2816 sc1
    s_add_u32 s17, s17, s20
    s_add_u32 s18, s18, s20
    s_branch layerb1_kernel_gu_done
layerb1_kernel_gu_fin1:
    s_nop 7
    s_nop 7
    v_cvt_pk_bf16_f32 v104, v72, v73
    v_cvt_pk_bf16_f32 v105, v74, v75
    v_cvt_pk_bf16_f32 v106, v76, v77
    v_cvt_pk_bf16_f32 v107, v78, v79
    s_nop 1
    v_permlane32_swap_b32 v104, v106
    v_permlane32_swap_b32 v105, v107
    buffer_store_dwordx4 v[104:107], v3, s[8:11], s17 offen offset:0 sc1
    v_cvt_pk_bf16_f32 v108, v80, v81
    v_cvt_pk_bf16_f32 v109, v82, v83
    v_cvt_pk_bf16_f32 v110, v84, v85
    v_cvt_pk_bf16_f32 v111, v86, v87
    s_nop 1
    v_permlane32_swap_b32 v108, v110
    v_permlane32_swap_b32 v109, v111
    buffer_store_dwordx4 v[108:111], v3, s[8:11], s17 offen offset:256 sc1
    v_cvt_pk_bf16_f32 v112, v88, v89
    v_cvt_pk_bf16_f32 v113, v90, v91
    v_cvt_pk_bf16_f32 v114, v92, v93
    v_cvt_pk_bf16_f32 v115, v94, v95
    s_nop 1
    v_permlane32_swap_b32 v112, v114
    v_permlane32_swap_b32 v113, v115
    buffer_store_dwordx4 v[112:115], v3, s[8:11], s17 offen offset:2560 sc1
    v_cvt_pk_bf16_f32 v116, v96, v97
    v_cvt_pk_bf16_f32 v117, v98, v99
    v_cvt_pk_bf16_f32 v118, v100, v101
    v_cvt_pk_bf16_f32 v119, v102, v103
    s_nop 1
    v_permlane32_swap_b32 v116, v118
    v_permlane32_swap_b32 v117, v119
    buffer_store_dwordx4 v[116:119], v3, s[8:11], s17 offen offset:2816 sc1
    s_add_u32 s17, s17, s20
    s_add_u32 s18, s18, s20
layerb1_kernel_gu_done:
    s_waitcnt vmcnt(0) lgkmcnt(0)
    s_barrier
    s_cmp_lg_u32 s13, 0
    s_cbranch_scc1 layerb1_kernel_gu_fl5
    s_mov_b64 exec, 1
    s_lshl_b32 s26, s12, 7
    v_mov_b32 v7, s26
    v_mov_b32 v120, s14
    buffer_store_dword v120, v7, s[8:11], s48 offen sc1
    s_mov_b64 exec, -1
layerb1_kernel_gu_fl5:
    s_branch layerb1_kernel_g_done
layerb1_kernel_g_qk:
    s_sub_u32 s26, s12, 80
    s_cmp_ge_u32 s26, 24
    s_cselect_b32 s27, 1, 0
    s_cselect_b32 s28, 24, 0
    s_sub_u32 s26, s26, s28
    s_lshl_b32 s26, s26, 3
    s_lshl_b32 s28, s13, 1
    s_add_u32 s26, s26, s28
    s_add_u32 s28, s26, 0
    s_mul_i32 s29, s28, 171
    s_lshr_b32 s29, s29, 10
    s_mul_i32 s30, s29, 6
    s_sub_u32 s30, s28, s30
    s_mul_i32 s31, s29, 12288
    s_lshl_b32 s32, s30, 11
    s_add_u32 s31, s31, s32
    s_mul_i32 s32, s14, 393216
    s_add_u32 s31, s31, s32
    s_mul_i32 s32, s27, 25165824
    s_add_u32 s31, s31, s32
    s_add_u32 s17, s31, 53477376
    s_lshl_b32 s30, s30, 5
    v_add_u32 v10, s30, v8
    v_and_b32 v11, 0xc1, v10
    v_and_b32 v12, 8, v10
    v_lshl_or_b32 v11, v12, 2, v11
    v_and_b32 v12, 32, v10
    v_lshrrev_b32 v12, 1, v12
    v_or_b32 v11, v11, v12
    v_and_b32 v12, 2, v10
    v_lshl_or_b32 v11, v12, 2, v11
    v_and_b32 v12, 16, v10
    v_lshrrev_b32 v12, 2, v12
    v_or_b32 v11, v11, v12
    v_and_b32 v12, 4, v10
    v_lshrrev_b32 v12, 1, v12
    v_or_b32 v11, v11, v12
    s_cmp_eq_u32 s27, 1
    s_cselect_b64 vcc, -1, 0
    s_nop 1
    v_cndmask_b32 v10, v10, v11, vcc
    v_lshrrev_b32 v12, 4, v10
    v_mul_u32_u24 v13, 11, v12
    v_lshrrev_b32 v13, 5, v13
    v_mul_u32_u24 v13, 3, v13
    v_add_u32 v12, v12, v13
    v_mul_u32_u24 v12, 20480, v12
    v_and_b32 v13, 15, v10
    v_lshl_add_u32 v11, v13, 4, v12
    v_lshl_add_u32 v4, v9, 8, v11
    s_xor_b32 s30, s27, 1
    s_mul_i32 s30, s30, 61440
    s_mul_i32 s31, s29, 491520
    s_add_u32 s30, s30, s31
    s_add_u32 s34, s30, 11534336
    s_add_u32 s28, s26, 1
    s_mul_i32 s29, s28, 171
    s_lshr_b32 s29, s29, 10
    s_mul_i32 s30, s29, 6
    s_sub_u32 s30, s28, s30
    s_mul_i32 s31, s29, 12288
    s_lshl_b32 s32, s30, 11
    s_add_u32 s31, s31, s32
    s_mul_i32 s32, s14, 393216
    s_add_u32 s31, s31, s32
    s_mul_i32 s32, s27, 25165824
    s_add_u32 s31, s31, s32
    s_add_u32 s18, s31, 53477376
    s_lshl_b32 s30, s30, 5
    v_add_u32 v10, s30, v8
    v_and_b32 v11, 0xc1, v10
    v_and_b32 v12, 8, v10
    v_lshl_or_b32 v11, v12, 2, v11
    v_and_b32 v12, 32, v10
    v_lshrrev_b32 v12, 1, v12
    v_or_b32 v11, v11, v12
    v_and_b32 v12, 2, v10
    v_lshl_or_b32 v11, v12, 2, v11
    v_and_b32 v12, 16, v10
    v_lshrrev_b32 v12, 2, v12
    v_or_b32 v11, v11, v12
    v_and_b32 v12, 4, v10
    v_lshrrev_b32 v12, 1, v12
    v_or_b32 v11, v11, v12
    s_cmp_eq_u32 s27, 1
    s_cselect_b64 vcc, -1, 0
    s_nop 1
    v_cndmask_b32 v10, v10, v11, vcc
    v_lshrrev_b32 v12, 4, v10
    v_mul_u32_u24 v13, 11, v12
    v_lshrrev_b32 v13, 5, v13
    v_mul_u32_u24 v13, 3, v13
    v_add_u32 v12, v12, v13
    v_mul_u32_u24 v12, 20480, v12
    v_and_b32 v13, 15, v10
    v_lshl_add_u32 v11, v13, 4, v12
    v_lshl_add_u32 v5, v9, 8, v11
    s_xor_b32 s30, s27, 1
    s_mul_i32 s30, s30, 61440
    s_mul_i32 s31, s29, 491520
    s_add_u32 s30, s30, s31
    s_add_u32 s35, s30, 11534336
    buffer_load_dwordx4 a[0:3], v4, s[8:11], s34 offen offset:0
    buffer_load_dwordx4 a[4:7], v5, s[8:11], s35 offen offset:0
    buffer_load_dwordx4 a[8:11], v4, s[8:11], s34 offen offset:512
    buffer_load_dwordx4 a[12:15], v5, s[8:11], s35 offen offset:512
    buffer_load_dwordx4 a[16:19], v4, s[8:11], s34 offen offset:1024
    buffer_load_dwordx4 a[20:23], v5, s[8:11], s35 offen offset:1024
    buffer_load_dwordx4 a[24:27], v4, s[8:11], s34 offen offset:1536
    buffer_load_dwordx4 a[28:31], v5, s[8:11], s35 offen offset:1536
    buffer_load_dwordx4 a[32:35], v4, s[8:11], s34 offen offset:2048
    buffer_load_dwordx4 a[36:39], v5, s[8:11], s35 offen offset:2048
    buffer_load_dwordx4 a[40:43], v4, s[8:11], s34 offen offset:2560
    buffer_load_dwordx4 a[44:47], v5, s[8:11], s35 offen offset:2560
    buffer_load_dwordx4 a[48:51], v4, s[8:11], s34 offen offset:3072
    buffer_load_dwordx4 a[52:55], v5, s[8:11], s35 offen offset:3072
    buffer_load_dwordx4 a[56:59], v4, s[8:11], s34 offen offset:3584
    buffer_load_dwordx4 a[60:63], v5, s[8:11], s35 offen offset:3584
    s_add_u32 s34, s34, 4096
    s_add_u32 s35, s35, 4096
    buffer_load_dwordx4 a[64:67], v4, s[8:11], s34 offen offset:0
    buffer_load_dwordx4 a[68:71], v5, s[8:11], s35 offen offset:0
    buffer_load_dwordx4 a[72:75], v4, s[8:11], s34 offen offset:512
    buffer_load_dwordx4 a[76:79], v5, s[8:11], s35 offen offset:512
    buffer_load_dwordx4 a[80:83], v4, s[8:11], s34 offen offset:1024
    buffer_load_dwordx4 a[84:87], v5, s[8:11], s35 offen offset:1024
    buffer_load_dwordx4 a[88:91], v4, s[8:11], s34 offen offset:1536
    buffer_load_dwordx4 a[92:95], v5, s[8:11], s35 offen offset:1536
    buffer_load_dwordx4 a[96:99], v4, s[8:11], s34 offen offset:2048
    buffer_load_dwordx4 a[100:103], v5, s[8:11], s35 offen offset:2048
    buffer_load_dwordx4 a[104:107], v4, s[8:11], s34 offen offset:2560
    buffer_load_dwordx4 a[108:111], v5, s[8:11], s35 offen offset:2560
    buffer_load_dwordx4 a[112:115], v4, s[8:11], s34 offen offset:3072
    buffer_load_dwordx4 a[116:119], v5, s[8:11], s35 offen offset:3072
    buffer_load_dwordx4 a[120:123], v4, s[8:11], s34 offen offset:3584
    buffer_load_dwordx4 a[124:127], v5, s[8:11], s35 offen offset:3584
    s_add_u32 s34, s34, 4096
    s_add_u32 s35, s35, 4096
    buffer_load_dwordx4 a[128:131], v4, s[8:11], s34 offen offset:0
    buffer_load_dwordx4 a[132:135], v5, s[8:11], s35 offen offset:0
    buffer_load_dwordx4 a[136:139], v4, s[8:11], s34 offen offset:512
    buffer_load_dwordx4 a[140:143], v5, s[8:11], s35 offen offset:512
    buffer_load_dwordx4 a[144:147], v4, s[8:11], s34 offen offset:1024
    buffer_load_dwordx4 a[148:151], v5, s[8:11], s35 offen offset:1024
    buffer_load_dwordx4 a[152:155], v4, s[8:11], s34 offen offset:1536
    buffer_load_dwordx4 a[156:159], v5, s[8:11], s35 offen offset:1536
    buffer_load_dwordx4 a[160:163], v4, s[8:11], s34 offen offset:2048
    buffer_load_dwordx4 a[164:167], v5, s[8:11], s35 offen offset:2048
    buffer_load_dwordx4 a[168:171], v4, s[8:11], s34 offen offset:2560
    buffer_load_dwordx4 a[172:175], v5, s[8:11], s35 offen offset:2560
    buffer_load_dwordx4 a[176:179], v4, s[8:11], s34 offen offset:3072
    buffer_load_dwordx4 a[180:183], v5, s[8:11], s35 offen offset:3072
    buffer_load_dwordx4 a[184:187], v4, s[8:11], s34 offen offset:3584
    buffer_load_dwordx4 a[188:191], v5, s[8:11], s35 offen offset:3584
    s_add_u32 s34, s34, 4096
    s_add_u32 s35, s35, 4096
    buffer_load_dwordx4 a[192:195], v4, s[8:11], s34 offen offset:0
    buffer_load_dwordx4 a[196:199], v5, s[8:11], s35 offen offset:0
    buffer_load_dwordx4 a[200:203], v4, s[8:11], s34 offen offset:512
    buffer_load_dwordx4 a[204:207], v5, s[8:11], s35 offen offset:512
    buffer_load_dwordx4 a[208:211], v4, s[8:11], s34 offen offset:1024
    buffer_load_dwordx4 a[212:215], v5, s[8:11], s35 offen offset:1024
    buffer_load_dwordx4 a[216:219], v4, s[8:11], s34 offen offset:1536
    buffer_load_dwordx4 a[220:223], v5, s[8:11], s35 offen offset:1536
    buffer_load_dwordx4 a[224:227], v4, s[8:11], s34 offen offset:2048
    buffer_load_dwordx4 a[228:231], v5, s[8:11], s35 offen offset:2048
    buffer_load_dwordx4 a[232:235], v4, s[8:11], s34 offen offset:2560
    buffer_load_dwordx4 a[236:239], v5, s[8:11], s35 offen offset:2560
    buffer_load_dwordx4 a[240:243], v4, s[8:11], s34 offen offset:3072
    buffer_load_dwordx4 a[244:247], v5, s[8:11], s35 offen offset:3072
    buffer_load_dwordx4 a[248:251], v4, s[8:11], s34 offen offset:3584
    buffer_load_dwordx4 a[252:255], v5, s[8:11], s35 offen offset:3584
    s_add_u32 s34, s34, 4096
    s_add_u32 s35, s35, 4096
    buffer_load_dwordx4 v[192:195], v4, s[8:11], s34 offen offset:0
    buffer_load_dwordx4 v[196:199], v5, s[8:11], s35 offen offset:0
    buffer_load_dwordx4 v[200:203], v4, s[8:11], s34 offen offset:512
    buffer_load_dwordx4 v[204:207], v5, s[8:11], s35 offen offset:512
    buffer_load_dwordx4 v[208:211], v4, s[8:11], s34 offen offset:1024
    buffer_load_dwordx4 v[212:215], v5, s[8:11], s35 offen offset:1024
    buffer_load_dwordx4 v[216:219], v4, s[8:11], s34 offen offset:1536
    buffer_load_dwordx4 v[220:223], v5, s[8:11], s35 offen offset:1536
    buffer_load_dwordx4 v[224:227], v4, s[8:11], s34 offen offset:2048
    buffer_load_dwordx4 v[228:231], v5, s[8:11], s35 offen offset:2048
    buffer_load_dwordx4 v[232:235], v4, s[8:11], s34 offen offset:2560
    buffer_load_dwordx4 v[236:239], v5, s[8:11], s35 offen offset:2560
    buffer_load_dwordx4 v[240:243], v4, s[8:11], s34 offen offset:3072
    buffer_load_dwordx4 v[244:247], v5, s[8:11], s35 offen offset:3072
    buffer_load_dwordx4 v[248:251], v4, s[8:11], s34 offen offset:3584
    buffer_load_dwordx4 v[252:255], v5, s[8:11], s35 offen offset:3584
    v_mov_b32 v3, v1
    s_mov_b32 s20, 393216
    s_mul_i32 s19, s13, 10240
    s_add_u32 s19, s19, 220200960
    s_mov_b32 s22, 0
    s_min_u32 s24, s14, 63
    s_mul_i32 s24, s24, 40960
    s_add_u32 s24, s24, s19
    s_mul_i32 s25, s13, 10240
    s_add_u32 s25, s25, s22
    s_mov_b32 m0, s25
    s_nop 0
    buffer_load_dwordx4 v1, s[8:11], s24 offen offset:0 lds
    buffer_load_dwordx4 v1, s[8:11], s24 offen offset:1024 lds
    buffer_load_dwordx4 v1, s[8:11], s24 offen offset:2048 lds
    buffer_load_dwordx4 v1, s[8:11], s24 offen offset:3072 lds
    s_add_u32 s24, s24, 4096
    s_add_u32 s25, s25, 4096
    s_mov_b32 m0, s25
    s_nop 0
    buffer_load_dwordx4 v1, s[8:11], s24 offen offset:0 lds
    buffer_load_dwordx4 v1, s[8:11], s24 offen offset:1024 lds
    buffer_load_dwordx4 v1, s[8:11], s24 offen offset:2048 lds
    buffer_load_dwordx4 v1, s[8:11], s24 offen offset:3072 lds
    s_add_u32 s24, s24, 4096
    s_add_u32 s25, s25, 4096
    s_mov_b32 m0, s25
    s_nop 0
    buffer_load_dwordx4 v1, s[8:11], s24 offen offset:0 lds
    buffer_load_dwordx4 v1, s[8:11], s24 offen offset:1024 lds
    s_mov_b32 s22, 40960
    s_add_u32 s23, s14, 1
    s_min_u32 s24, s23, 63
    s_mul_i32 s24, s24, 40960
    s_add_u32 s24, s24, s19
    s_mul_i32 s25, s13, 10240
    s_add_u32 s25, s25, s22
    s_mov_b32 m0, s25
    s_nop 0
    buffer_load_dwordx4 v1, s[8:11], s24 offen offset:0 lds
    buffer_load_dwordx4 v1, s[8:11], s24 offen offset:1024 lds
    buffer_load_dwordx4 v1, s[8:11], s24 offen offset:2048 lds
    buffer_load_dwordx4 v1, s[8:11], s24 offen offset:3072 lds
    s_add_u32 s24, s24, 4096
    s_add_u32 s25, s25, 4096
    s_mov_b32 m0, s25
    s_nop 0
    buffer_load_dwordx4 v1, s[8:11], s24 offen offset:0 lds
    buffer_load_dwordx4 v1, s[8:11], s24 offen offset:1024 lds
    buffer_load_dwordx4 v1, s[8:11], s24 offen offset:2048 lds
    buffer_load_dwordx4 v1, s[8:11], s24 offen offset:3072 lds
    s_add_u32 s24, s24, 4096
    s_add_u32 s25, s25, 4096
    s_mov_b32 m0, s25
    s_nop 0
    buffer_load_dwordx4 v1, s[8:11], s24 offen offset:0 lds
    buffer_load_dwordx4 v1, s[8:11], s24 offen offset:1024 lds
    s_mov_b32 s22, 81920
    s_mov_b32 s16, 0
    s_waitcnt vmcnt(10)
    s_barrier
    v_mov_b32 v2, v1
    ds_read_b128 v[8:11], v2 offset:0
    ds_read_b128 v[12:15], v2 offset:1024
    ds_read_b128 v[16:19], v2 offset:2048
    ds_read_b128 v[20:23], v2 offset:3072
    ds_read_b128 v[24:27], v2 offset:4096
    ds_read_b128 v[28:31], v2 offset:5120
    ds_read_b128 v[32:35], v2 offset:6144
    s_waitcnt lgkmcnt(6)
    v_mfma_f32_32x32x16_bf16 v[40:55], a[0:3], v[8:11], 0
    v_mfma_f32_32x32x16_bf16 v[56:71], a[4:7], v[8:11], 0
    ds_read_b128 v[36:39], v2 offset:7168
    s_waitcnt lgkmcnt(6)
    v_mfma_f32_32x32x16_bf16 v[40:55], a[8:11], v[12:15], v[40:55]
    v_mfma_f32_32x32x16_bf16 v[56:71], a[12:15], v[12:15], v[56:71]
    ds_read_b128 v[8:11], v2 offset:8192
    s_waitcnt lgkmcnt(6)
    v_mfma_f32_32x32x16_bf16 v[40:55], a[16:19], v[16:19], v[40:55]
    v_mfma_f32_32x32x16_bf16 v[56:71], a[20:23], v[16:19], v[56:71]
    ds_read_b128 v[12:15], v2 offset:9216
    s_waitcnt lgkmcnt(6)
    v_mfma_f32_32x32x16_bf16 v[40:55], a[24:27], v[20:23], v[40:55]
    v_mfma_f32_32x32x16_bf16 v[56:71], a[28:31], v[20:23], v[56:71]
    ds_read_b128 v[16:19], v2 offset:10240
    s_waitcnt lgkmcnt(6)
    v_mfma_f32_32x32x16_bf16 v[40:55], a[32:35], v[24:27], v[40:55]
    v_mfma_f32_32x32x16_bf16 v[56:71], a[36:39], v[24:27], v[56:71]
    ds_read_b128 v[20:23], v2 offset:11264
    s_waitcnt lgkmcnt(6)
    v_mfma_f32_32x32x16_bf16 v[40:55], a[40:43], v[28:31], v[40:55]
    v_mfma_f32_32x32x16_bf16 v[56:71], a[44:47], v[28:31], v[56:71]
    ds_read_b128 v[24:27], v2 offset:12288
    s_waitcnt lgkmcnt(6)
    v_mfma_f32_32x32x16_bf16 v[40:55], a[48:51], v[32:35], v[40:55]
    v_mfma_f32_32x32x16_bf16 v[56:71], a[52:55], v[32:35], v[56:71]
    ds_read_b128 v[28:31], v2 offset:13312
    s_waitcnt lgkmcnt(6)
    v_mfma_f32_32x32x16_bf16 v[40:55], a[56:59], v[36:39], v[40:55]
    v_mfma_f32_32x32x16_bf16 v[56:71], a[60:63], v[36:39], v[56:71]
    ds_read_b128 v[32:35], v2 offset:14336
    s_waitcnt lgkmcnt(6)
    v_mfma_f32_32x32x16_bf16 v[40:55], a[64:67], v[8:11], v[40:55]
    v_mfma_f32_32x32x16_bf16 v[56:71], a[68:71], v[8:11], v[56:71]
    ds_read_b128 v[36:39], v2 offset:15360
    s_waitcnt lgkmcnt(6)
    v_mfma_f32_32x32x16_bf16 v[40:55], a[72:75], v[12:15], v[40:55]
    v_mfma_f32_32x32x16_bf16 v[56:71], a[76:79], v[12:15], v[56:71]
    ds_read_b128 v[8:11], v2 offset:16384
    s_waitcnt lgkmcnt(6)
    v_mfma_f32_32x32x16_bf16 v[40:55], a[80:83], v[16:19], v[40:55]
    v_mfma_f32_32x32x16_bf16 v[56:71], a[84:87], v[16:19], v[56:71]
    ds_read_b128 v[12:15], v2 offset:17408
    s_waitcnt lgkmcnt(6)
    v_mfma_f32_32x32x16_bf16 v[40:55], a[88:91], v[20:23], v[40:55]
    v_mfma_f32_32x32x16_bf16 v[56:71], a[92:95], v[20:23], v[56:71]
    ds_read_b128 v[16:19], v2 offset:18432
    s_waitcnt lgkmcnt(6)
    v_mfma_f32_32x32x16_bf16 v[40:55], a[96:99], v[24:27], v[40:55]
    v_mfma_f32_32x32x16_bf16 v[56:71], a[100:103], v[24:27], v[56:71]
    ds_read_b128 v[20:23], v2 offset:19456
    s_waitcnt lgkmcnt(6)
    v_mfma_f32_32x32x16_bf16 v[40:55], a[104:107], v[28:31], v[40:55]
    v_mfma_f32_32x32x16_bf16 v[56:71], a[108:111], v[28:31], v[56:71]
    ds_read_b128 v[24:27], v2 offset:20480
    s_waitcnt lgkmcnt(6)
    v_mfma_f32_32x32x16_bf16 v[40:55], a[112:115], v[32:35], v[40:55]
    v_mfma_f32_32x32x16_bf16 v[56:71], a[116:119], v[32:35], v[56:71]
    ds_read_b128 v[28:31], v2 offset:21504
    s_waitcnt lgkmcnt(6)
    v_mfma_f32_32x32x16_bf16 v[40:55], a[120:123], v[36:39], v[40:55]
    v_mfma_f32_32x32x16_bf16 v[56:71], a[124:127], v[36:39], v[56:71]
    ds_read_b128 v[32:35], v2 offset:22528
    s_waitcnt lgkmcnt(6)
    v_mfma_f32_32x32x16_bf16 v[40:55], a[128:131], v[8:11], v[40:55]
    v_mfma_f32_32x32x16_bf16 v[56:71], a[132:135], v[8:11], v[56:71]
    ds_read_b128 v[36:39], v2 offset:23552
    s_waitcnt lgkmcnt(6)
    v_mfma_f32_32x32x16_bf16 v[40:55], a[136:139], v[12:15], v[40:55]
    v_mfma_f32_32x32x16_bf16 v[56:71], a[140:143], v[12:15], v[56:71]
    ds_read_b128 v[8:11], v2 offset:24576
    s_waitcnt lgkmcnt(6)
    v_mfma_f32_32x32x16_bf16 v[40:55], a[144:147], v[16:19], v[40:55]
    v_mfma_f32_32x32x16_bf16 v[56:71], a[148:151], v[16:19], v[56:71]
    ds_read_b128 v[12:15], v2 offset:25600
    s_waitcnt lgkmcnt(6)
    v_mfma_f32_32x32x16_bf16 v[40:55], a[152:155], v[20:23], v[40:55]
    v_mfma_f32_32x32x16_bf16 v[56:71], a[156:159], v[20:23], v[56:71]
    ds_read_b128 v[16:19], v2 offset:26624
    s_waitcnt lgkmcnt(6)
    v_mfma_f32_32x32x16_bf16 v[40:55], a[160:163], v[24:27], v[40:55]
    v_mfma_f32_32x32x16_bf16 v[56:71], a[164:167], v[24:27], v[56:71]
    ds_read_b128 v[20:23], v2 offset:27648
    s_waitcnt lgkmcnt(6)
    v_mfma_f32_32x32x16_bf16 v[40:55], a[168:171], v[28:31], v[40:55]
    v_mfma_f32_32x32x16_bf16 v[56:71], a[172:175], v[28:31], v[56:71]
    ds_read_b128 v[24:27], v2 offset:28672
    s_waitcnt lgkmcnt(6)
    v_mfma_f32_32x32x16_bf16 v[40:55], a[176:179], v[32:35], v[40:55]
    v_mfma_f32_32x32x16_bf16 v[56:71], a[180:183], v[32:35], v[56:71]
    ds_read_b128 v[28:31], v2 offset:29696
    s_waitcnt lgkmcnt(6)
    v_mfma_f32_32x32x16_bf16 v[40:55], a[184:187], v[36:39], v[40:55]
    v_mfma_f32_32x32x16_bf16 v[56:71], a[188:191], v[36:39], v[56:71]
    ds_read_b128 v[32:35], v2 offset:30720
    s_waitcnt lgkmcnt(6)
    v_mfma_f32_32x32x16_bf16 v[40:55], a[192:195], v[8:11], v[40:55]
    v_mfma_f32_32x32x16_bf16 v[56:71], a[196:199], v[8:11], v[56:71]
    ds_read_b128 v[36:39], v2 offset:31744
    s_waitcnt lgkmcnt(6)
    v_mfma_f32_32x32x16_bf16 v[40:55], a[200:203], v[12:15], v[40:55]
    v_mfma_f32_32x32x16_bf16 v[56:71], a[204:207], v[12:15], v[56:71]
    ds_read_b128 v[8:11], v2 offset:32768
    s_waitcnt lgkmcnt(6)
    v_mfma_f32_32x32x16_bf16 v[40:55], a[208:211], v[16:19], v[40:55]
    v_mfma_f32_32x32x16_bf16 v[56:71], a[212:215], v[16:19], v[56:71]
    ds_read_b128 v[12:15], v2 offset:33792
    s_waitcnt lgkmcnt(6)
    v_mfma_f32_32x32x16_bf16 v[40:55], a[216:219], v[20:23], v[40:55]
    v_mfma_f32_32x32x16_bf16 v[56:71], a[220:223], v[20:23], v[56:71]
    ds_read_b128 v[16:19], v2 offset:34816
    s_waitcnt lgkmcnt(6)
    v_mfma_f32_32x32x16_bf16 v[40:55], a[224:227], v[24:27], v[40:55]
    v_mfma_f32_32x32x16_bf16 v[56:71], a[228:231], v[24:27], v[56:71]
    s_waitcnt vmcnt(0)
    s_barrier
    s_add_u32 s21, s16, 40960
    s_cmp_eq_u32 s21, 122880
    s_cselect_b32 s21, 0, s21
    s_add_u32 s23, s14, 2
    s_min_u32 s24, s23, 63
    s_mul_i32 s24, s24, 40960
    s_add_u32 s24, s24, s19
    s_mul_i32 s25, s13, 10240
    s_add_u32 s25, s25, s22
    s_mov_b32 m0, s25
    s_nop 0
    buffer_load_dwordx4 v1, s[8:11], s24 offen offset:0 lds
    buffer_load_dwordx4 v1, s[8:11], s24 offen offset:1024 lds
    buffer_load_dwordx4 v1, s[8:11], s24 offen offset:2048 lds
    buffer_load_dwordx4 v1, s[8:11], s24 offen offset:3072 lds
    s_add_u32 s24, s24, 4096
    s_add_u32 s25, s25, 4096
    s_mov_b32 m0, s25
    s_nop 0
    buffer_load_dwordx4 v1, s[8:11], s24 offen offset:0 lds
    buffer_load_dwordx4 v1, s[8:11], s24 offen offset:1024 lds
    buffer_load_dwordx4 v1, s[8:11], s24 offen offset:2048 lds
    buffer_load_dwordx4 v1, s[8:11], s24 offen offset:3072 lds
    s_add_u32 s24, s24, 4096
    s_add_u32 s25, s25, 4096
    s_mov_b32 m0, s25
    s_nop 0
    buffer_load_dwordx4 v1, s[8:11], s24 offen offset:0 lds
    buffer_load_dwordx4 v1, s[8:11], s24 offen offset:1024 lds
    s_add_u32 s22, s22, 40960
    s_cmp_eq_u32 s22, 122880
    s_cselect_b32 s22, 0, s22
    ds_read_b128 v[20:23], v2 offset:35840
    s_waitcnt lgkmcnt(6)
    v_mfma_f32_32x32x16_bf16 v[40:55], a[232:235], v[28:31], v[40:55]
    v_mfma_f32_32x32x16_bf16 v[56:71], a[236:239], v[28:31], v[56:71]
    ds_read_b128 v[24:27], v2 offset:36864
    s_waitcnt lgkmcnt(6)
    v_mfma_f32_32x32x16_bf16 v[40:55], a[240:243], v[32:35], v[40:55]
    v_mfma_f32_32x32x16_bf16 v[56:71], a[244:247], v[32:35], v[56:71]
    ds_read_b128 v[28:31], v2 offset:37888
    s_waitcnt lgkmcnt(6)
    v_mfma_f32_32x32x16_bf16 v[40:55], a[248:251], v[36:39], v[40:55]
    v_mfma_f32_32x32x16_bf16 v[56:71], a[252:255], v[36:39], v[56:71]
    ds_read_b128 v[32:35], v2 offset:38912
    s_waitcnt lgkmcnt(6)
    v_mfma_f32_32x32x16_bf16 v[40:55], v[192:195], v[8:11], v[40:55]
    v_mfma_f32_32x32x16_bf16 v[56:71], v[196:199], v[8:11], v[56:71]
    ds_read_b128 v[36:39], v2 offset:39936
    s_waitcnt lgkmcnt(6)
    v_mfma_f32_32x32x16_bf16 v[40:55], v[200:203], v[12:15], v[40:55]
    v_mfma_f32_32x32x16_bf16 v[56:71], v[204:207], v[12:15], v[56:71]
    v_add_u32 v6, s21, v1
    ds_read_b128 v[8:11], v6 offset:0
    s_waitcnt lgkmcnt(6)
    v_mfma_f32_32x32x16_bf16 v[40:55], v[208:211], v[16:19], v[40:55]
    v_mfma_f32_32x32x16_bf16 v[56:71], v[212:215], v[16:19], v[56:71]
    ds_read_b128 v[12:15], v6 offset:1024
    s_waitcnt lgkmcnt(6)
    v_mfma_f32_32x32x16_bf16 v[40:55], v[216:219], v[20:23], v[40:55]
    v_mfma_f32_32x32x16_bf16 v[56:71], v[220:223], v[20:23], v[56:71]
    ds_read_b128 v[16:19], v6 offset:2048
    s_waitcnt lgkmcnt(6)
    v_mfma_f32_32x32x16_bf16 v[40:55], v[224:227], v[24:27], v[40:55]
    v_mfma_f32_32x32x16_bf16 v[56:71], v[228:231], v[24:27], v[56:71]
    ds_read_b128 v[20:23], v6 offset:3072
    s_waitcnt lgkmcnt(6)
    v_mfma_f32_32x32x16_bf16 v[40:55], v[232:235], v[28:31], v[40:55]
    v_mfma_f32_32x32x16_bf16 v[56:71], v[236:239], v[28:31], v[56:71]
    ds_read_b128 v[24:27], v6 offset:4096
    s_waitcnt lgkmcnt(6)
    v_mfma_f32_32x32x16_bf16 v[40:55], v[240:243], v[32:35], v[40:55]
    v_mfma_f32_32x32x16_bf16 v[56:71], v[244:247], v[32:35], v[56:71]
    ds_read_b128 v[28:31], v6 offset:5120
    s_waitcnt lgkmcnt(6)
    v_mfma_f32_32x32x16_bf16 v[40:55], v[248:251], v[36:39], v[40:55]
    v_mfma_f32_32x32x16_bf16 v[56:71], v[252:255], v[36:39], v[56:71]
    v_mov_b32 v2, v6
    s_mov_b32 s16, s21
    s_add_u32 s14, s14, 1
    s_cmp_ge_u32 s14, s15
    s_cbranch_scc1 layerb1_kernel_gk_fin0
layerb1_kernel_gk_loop:
    ds_read_b128 v[32:35], v2 offset:6144
    s_waitcnt lgkmcnt(6)
    v_mfma_f32_32x32x16_bf16 v[72:87], a[0:3], v[8:11], 0
    v_mfma_f32_32x32x16_bf16 v[88:103], a[4:7], v[8:11], 0
    ds_read_b128 v[36:39], v2 offset:7168
    s_waitcnt lgkmcnt(6)
    v_mfma_f32_32x32x16_bf16 v[72:87], a[8:11], v[12:15], v[72:87]
    v_mfma_f32_32x32x16_bf16 v[88:103], a[12:15], v[12:15], v[88:103]
    ds_read_b128 v[8:11], v2 offset:8192
    s_waitcnt lgkmcnt(6)
    v_mfma_f32_32x32x16_bf16 v[72:87], a[16:19], v[16:19], v[72:87]
    v_cvt_pk_bf16_f32 v104, v40, v41
    v_mfma_f32_32x32x16_bf16 v[88:103], a[20:23], v[16:19], v[88:103]
    v_cvt_pk_bf16_f32 v105, v42, v43
    ds_read_b128 v[12:15], v2 offset:9216
    s_waitcnt lgkmcnt(6)
    v_mfma_f32_32x32x16_bf16 v[72:87], a[24:27], v[20:23], v[72:87]
    v_cvt_pk_bf16_f32 v106, v44, v45
    v_mfma_f32_32x32x16_bf16 v[88:103], a[28:31], v[20:23], v[88:103]
    v_cvt_pk_bf16_f32 v107, v46, v47
    ds_read_b128 v[16:19], v2 offset:10240
    s_waitcnt lgkmcnt(6)
    v_mfma_f32_32x32x16_bf16 v[72:87], a[32:35], v[24:27], v[72:87]
    s_nop 1
    v_mfma_f32_32x32x16_bf16 v[88:103], a[36:39], v[24:27], v[88:103]
    v_permlane32_swap_b32 v104, v106
    ds_read_b128 v[20:23], v2 offset:11264
    s_waitcnt lgkmcnt(6)
    v_mfma_f32_32x32x16_bf16 v[72:87], a[40:43], v[28:31], v[72:87]
    v_permlane32_swap_b32 v105, v107
    v_mfma_f32_32x32x16_bf16 v[88:103], a[44:47], v[28:31], v[88:103]
    buffer_store_dwordx4 v[104:107], v3, s[8:11], s17 offen offset:0 sc1
    ds_read_b128 v[24:27], v2 offset:12288
    s_waitcnt lgkmcnt(6)
    v_mfma_f32_32x32x16_bf16 v[72:87], a[48:51], v[32:35], v[72:87]
    v_cvt_pk_bf16_f32 v108, v48, v49
    v_mfma_f32_32x32x16_bf16 v[88:103], a[52:55], v[32:35], v[88:103]
    v_cvt_pk_bf16_f32 v109, v50, v51
    ds_read_b128 v[28:31], v2 offset:13312
    s_waitcnt lgkmcnt(6)
    v_mfma_f32_32x32x16_bf16 v[72:87], a[56:59], v[36:39], v[72:87]
    v_cvt_pk_bf16_f32 v110, v52, v53
    v_mfma_f32_32x32x16_bf16 v[88:103], a[60:63], v[36:39], v[88:103]
    v_cvt_pk_bf16_f32 v111, v54, v55
    ds_read_b128 v[32:35], v2 offset:14336
    s_waitcnt lgkmcnt(6)
    v_mfma_f32_32x32x16_bf16 v[72:87], a[64:67], v[8:11], v[72:87]
    s_nop 1
    v_mfma_f32_32x32x16_bf16 v[88:103], a[68:71], v[8:11], v[88:103]
    v_permlane32_swap_b32 v108, v110
    ds_read_b128 v[36:39], v2 offset:15360
    s_waitcnt lgkmcnt(6)
    v_mfma_f32_32x32x16_bf16 v[72:87], a[72:75], v[12:15], v[72:87]
    v_permlane32_swap_b32 v109, v111
    v_mfma_f32_32x32x16_bf16 v[88:103], a[76:79], v[12:15], v[88:103]
    buffer_store_dwordx4 v[108:111], v3, s[8:11], s17 offen offset:1024 sc1
    ds_read_b128 v[8:11], v2 offset:16384
    s_waitcnt lgkmcnt(6)
    v_mfma_f32_32x32x16_bf16 v[72:87], a[80:83], v[16:19], v[72:87]
    v_cvt_pk_bf16_f32 v112, v56, v57
    v_mfma_f32_32x32x16_bf16 v[88:103], a[84:87], v[16:19], v[88:103]
    v_cvt_pk_bf16_f32 v113, v58, v59
    ds_read_b128 v[12:15], v2 offset:17408
    s_waitcnt lgkmcnt(6)
    v_mfma_f32_32x32x16_bf16 v[72:87], a[88:91], v[20:23], v[72:87]
    v_cvt_pk_bf16_f32 v114, v60, v61
    v_mfma_f32_32x32x16_bf16 v[88:103], a[92:95], v[20:23], v[88:103]
    v_cvt_pk_bf16_f32 v115, v62, v63
    ds_read_b128 v[16:19], v2 offset:18432
    s_waitcnt lgkmcnt(6)
    v_mfma_f32_32x32x16_bf16 v[72:87], a[96:99], v[24:27], v[72:87]
    s_nop 1
    v_mfma_f32_32x32x16_bf16 v[88:103], a[100:103], v[24:27], v[88:103]
    v_permlane32_swap_b32 v112, v114
    ds_read_b128 v[20:23], v2 offset:19456
    s_waitcnt lgkmcnt(6)
    v_mfma_f32_32x32x16_bf16 v[72:87], a[104:107], v[28:31], v[72:87]
    v_permlane32_swap_b32 v113, v115
    v_mfma_f32_32x32x16_bf16 v[88:103], a[108:111], v[28:31], v[88:103]
    buffer_store_dwordx4 v[112:115], v3, s[8:11], s18 offen offset:0 sc1
    ds_read_b128 v[24:27], v2 offset:20480
    s_waitcnt lgkmcnt(6)
    v_mfma_f32_32x32x16_bf16 v[72:87], a[112:115], v[32:35], v[72:87]
    v_cvt_pk_bf16_f32 v116, v64, v65
    v_mfma_f32_32x32x16_bf16 v[88:103], a[116:119], v[32:35], v[88:103]
    v_cvt_pk_bf16_f32 v117, v66, v67
    ds_read_b128 v[28:31], v2 offset:21504
    s_waitcnt lgkmcnt(6)
    v_mfma_f32_32x32x16_bf16 v[72:87], a[120:123], v[36:39], v[72:87]
    v_cvt_pk_bf16_f32 v118, v68, v69
    v_mfma_f32_32x32x16_bf16 v[88:103], a[124:127], v[36:39], v[88:103]
    v_cvt_pk_bf16_f32 v119, v70, v71
    ds_read_b128 v[32:35], v2 offset:22528
    s_waitcnt lgkmcnt(6)
    v_mfma_f32_32x32x16_bf16 v[72:87], a[128:131], v[8:11], v[72:87]
    s_nop 1
    v_mfma_f32_32x32x16_bf16 v[88:103], a[132:135], v[8:11], v[88:103]
    v_permlane32_swap_b32 v116, v118
    ds_read_b128 v[36:39], v2 offset:23552
    s_waitcnt lgkmcnt(6)
    v_mfma_f32_32x32x16_bf16 v[72:87], a[136:139], v[12:15], v[72:87]
    v_permlane32_swap_b32 v117, v119
    v_mfma_f32_32x32x16_bf16 v[88:103], a[140:143], v[12:15], v[88:103]
    buffer_store_dwordx4 v[116:119], v3, s[8:11], s18 offen offset:1024 sc1
    ds_read_b128 v[8:11], v2 offset:24576
    s_waitcnt lgkmcnt(6)
    v_mfma_f32_32x32x16_bf16 v[72:87], a[144:147], v[16:19], v[72:87]
    s_add_u32 s17, s17, s20
    v_mfma_f32_32x32x16_bf16 v[88:103], a[148:151], v[16:19], v[88:103]
    s_add_u32 s18, s18, s20
    ds_read_b128 v[12:15], v2 offset:25600
    s_waitcnt lgkmcnt(6)
    v_mfma_f32_32x32x16_bf16 v[72:87], a[152:155], v[20:23], v[72:87]
    v_mfma_f32_32x32x16_bf16 v[88:103], a[156:159], v[20:23], v[88:103]
    ds_read_b128 v[16:19], v2 offset:26624
    s_waitcnt lgkmcnt(6)
    v_mfma_f32_32x32x16_bf16 v[72:87], a[160:163], v[24:27], v[72:87]
    v_mfma_f32_32x32x16_bf16 v[88:103], a[164:167], v[24:27], v[88:103]
    ds_read_b128 v[20:23], v2 offset:27648
    s_waitcnt lgkmcnt(6)
    v_mfma_f32_32x32x16_bf16 v[72:87], a[168:171], v[28:31], v[72:87]
    v_mfma_f32_32x32x16_bf16 v[88:103], a[172:175], v[28:31], v[88:103]
    ds_read_b128 v[24:27], v2 offset:28672
    s_waitcnt lgkmcnt(6)
    v_mfma_f32_32x32x16_bf16 v[72:87], a[176:179], v[32:35], v[72:87]
    v_mfma_f32_32x32x16_bf16 v[88:103], a[180:183], v[32:35], v[88:103]
    ds_read_b128 v[28:31], v2 offset:29696
    s_waitcnt lgkmcnt(6)
    v_mfma_f32_32x32x16_bf16 v[72:87], a[184:187], v[36:39], v[72:87]
    v_mfma_f32_32x32x16_bf16 v[88:103], a[188:191], v[36:39], v[88:103]
    ds_read_b128 v[32:35], v2 offset:30720
    s_waitcnt lgkmcnt(6)
    v_mfma_f32_32x32x16_bf16 v[72:87], a[192:195], v[8:11], v[72:87]
    v_mfma_f32_32x32x16_bf16 v[88:103], a[196:199], v[8:11], v[88:103]
    ds_read_b128 v[36:39], v2 offset:31744
    s_waitcnt lgkmcnt(6)
    v_mfma_f32_32x32x16_bf16 v[72:87], a[200:203], v[12:15], v[72:87]
    v_mfma_f32_32x32x16_bf16 v[88:103], a[204:207], v[12:15], v[88:103]
    ds_read_b128 v[8:11], v2 offset:32768
    s_waitcnt lgkmcnt(6)
    v_mfma_f32_32x32x16_bf16 v[72:87], a[208:211], v[16:19], v[72:87]
    v_mfma_f32_32x32x16_bf16 v[88:103], a[212:215], v[16:19], v[88:103]
    ds_read_b128 v[12:15], v2 offset:33792
    s_waitcnt lgkmcnt(6)
    v_mfma_f32_32x32x16_bf16 v[72:87], a[216:219], v[20:23], v[72:87]
    v_mfma_f32_32x32x16_bf16 v[88:103], a[220:223], v[20:23], v[88:103]
    ds_read_b128 v[16:19], v2 offset:34816
    s_waitcnt lgkmcnt(6)
    v_mfma_f32_32x32x16_bf16 v[72:87], a[224:227], v[24:27], v[72:87]
    v_mfma_f32_32x32x16_bf16 v[88:103], a[228:231], v[24:27], v[88:103]
    s_cmp_gt_u32 s14, 2
    s_cbranch_scc1 layerb1_kernel_gk_dr1
    s_waitcnt vmcnt(0)
    s_mov_b32 s27, s14
    s_branch layerb1_kernel_gk_dq1
layerb1_kernel_gk_dr1:
    s_waitcnt vmcnt(4)
    s_sub_u32 s27, s14, 1
layerb1_kernel_gk_dq1:
    s_barrier
    s_cmp_lg_u32 s13, 0
    s_cbranch_scc1 layerb1_kernel_gk_fl2
    s_mov_b64 exec, 1
    s_lshl_b32 s26, s12, 7
    v_mov_b32 v7, s26
    v_mov_b32 v120, s27
    buffer_store_dword v120, v7, s[8:11], s48 offen sc1
    s_mov_b64 exec, -1
layerb1_kernel_gk_fl2:
    s_add_u32 s21, s16, 40960
    s_cmp_eq_u32 s21, 122880
    s_cselect_b32 s21, 0, s21
    s_add_u32 s23, s14, 2
    s_min_u32 s24, s23, 63
    s_mul_i32 s24, s24, 40960
    s_add_u32 s24, s24, s19
    s_mul_i32 s25, s13, 10240
    s_add_u32 s25, s25, s22
    s_mov_b32 m0, s25
    s_nop 0
    buffer_load_dwordx4 v1, s[8:11], s24 offen offset:0 lds
    buffer_load_dwordx4 v1, s[8:11], s24 offen offset:1024 lds
    buffer_load_dwordx4 v1, s[8:11], s24 offen offset:2048 lds
    buffer_load_dwordx4 v1, s[8:11], s24 offen offset:3072 lds
    s_add_u32 s24, s24, 4096
    s_add_u32 s25, s25, 4096
    s_mov_b32 m0, s25
    s_nop 0
    buffer_load_dwordx4 v1, s[8:11], s24 offen offset:0 lds
    buffer_load_dwordx4 v1, s[8:11], s24 offen offset:1024 lds
    buffer_load_dwordx4 v1, s[8:11], s24 offen offset:2048 lds
    buffer_load_dwordx4 v1, s[8:11], s24 offen offset:3072 lds
    s_add_u32 s24, s24, 4096
    s_add_u32 s25, s25, 4096
    s_mov_b32 m0, s25
    s_nop 0
    buffer_load_dwordx4 v1, s[8:11], s24 offen offset:0 lds
    buffer_load_dwordx4 v1, s[8:11], s24 offen offset:1024 lds
    s_add_u32 s22, s22, 40960
    s_cmp_eq_u32 s22, 122880
    s_cselect_b32 s22, 0, s22
    ds_read_b128 v[20:23], v2 offset:35840
    s_waitcnt lgkmcnt(6)
    v_mfma_f32_32x32x16_bf16 v[72:87], a[232:235], v[28:31], v[72:87]
    v_mfma_f32_32x32x16_bf16 v[88:103], a[236:239], v[28:31], v[88:103]
    ds_read_b128 v[24:27], v2 offset:36864
    s_waitcnt lgkmcnt(6)
    v_mfma_f32_32x32x16_bf16 v[72:87], a[240:243], v[32:35], v[72:87]
    v_mfma_f32_32x32x16_bf16 v[88:103], a[244:247], v[32:35], v[88:103]
    ds_read_b128 v[28:31], v2 offset:37888
    s_waitcnt lgkmcnt(6)
    v_mfma_f32_32x32x16_bf16 v[72:87], a[248:251], v[36:39], v[72:87]
    v_mfma_f32_32x32x16_bf16 v[88:103], a[252:255], v[36:39], v[88:103]
    ds_read_b128 v[32:35], v2 offset:38912
    s_waitcnt lgkmcnt(6)
    v_mfma_f32_32x32x16_bf16 v[72:87], v[192:195], v[8:11], v[72:87]
    v_mfma_f32_32x32x16_bf16 v[88:103], v[196:199], v[8:11], v[88:103]
    ds_read_b128 v[36:39], v2 offset:39936
    s_waitcnt lgkmcnt(6)
    v_mfma_f32_32x32x16_bf16 v[72:87], v[200:203], v[12:15], v[72:87]
    v_mfma_f32_32x32x16_bf16 v[88:103], v[204:207], v[12:15], v[88:103]
    v_add_u32 v6, s21, v1
    ds_read_b128 v[8:11], v6 offset:0
    s_waitcnt lgkmcnt(6)
    v_mfma_f32_32x32x16_bf16 v[72:87], v[208:211], v[16:19], v[72:87]
    v_mfma_f32_32x32x16_bf16 v[88:103], v[212:215], v[16:19], v[88:103]
    ds_read_b128 v[12:15], v6 offset:1024
    s_waitcnt lgkmcnt(6)
    v_mfma_f32_32x32x16_bf16 v[72:87], v[216:219], v[20:23], v[72:87]
    v_mfma_f32_32x32x16_bf16 v[88:103], v[220:223], v[20:23], v[88:103]
    ds_read_b128 v[16:19], v6 offset:2048
    s_waitcnt lgkmcnt(6)
    v_mfma_f32_32x32x16_bf16 v[72:87], v[224:227], v[24:27], v[72:87]
    v_mfma_f32_32x32x16_bf16 v[88:103], v[228:231], v[24:27], v[88:103]
    ds_read_b128 v[20:23], v6 offset:3072
    s_waitcnt lgkmcnt(6)
    v_mfma_f32_32x32x16_bf16 v[72:87], v[232:235], v[28:31], v[72:87]
    v_mfma_f32_32x32x16_bf16 v[88:103], v[236:239], v[28:31], v[88:103]
    ds_read_b128 v[24:27], v6 offset:4096
    s_waitcnt lgkmcnt(6)
    v_mfma_f32_32x32x16_bf16 v[72:87], v[240:243], v[32:35], v[72:87]
    v_mfma_f32_32x32x16_bf16 v[88:103], v[244:247], v[32:35], v[88:103]
    ds_read_b128 v[28:31], v6 offset:5120
    s_waitcnt lgkmcnt(6)
    v_mfma_f32_32x32x16_bf16 v[72:87], v[248:251], v[36:39], v[72:87]
    v_mfma_f32_32x32x16_bf16 v[88:103], v[252:255], v[36:39], v[88:103]
    v_mov_b32 v2, v6
    s_mov_b32 s16, s21
    s_add_u32 s14, s14, 1
    s_cmp_ge_u32 s14, s15
    s_cbranch_scc1 layerb1_kernel_gk_fin1
    ds_read_b128 v[32:35], v2 offset:6144
    s_waitcnt lgkmcnt(6)
    v_mfma_f32_32x32x16_bf16 v[40:55], a[0:3], v[8:11], 0
    v_mfma_f32_32x32x16_bf16 v[56:71], a[4:7], v[8:11], 0
    ds_read_b128 v[36:39], v2 offset:7168
    s_waitcnt lgkmcnt(6)
    v_mfma_f32_32x32x16_bf16 v[40:55], a[8:11], v[12:15], v[40:55]
    v_mfma_f32_32x32x16_bf16 v[56:71], a[12:15], v[12:15], v[56:71]
    ds_read_b128 v[8:11], v2 offset:8192
    s_waitcnt lgkmcnt(6)
    v_mfma_f32_32x32x16_bf16 v[40:55], a[16:19], v[16:19], v[40:55]
    v_cvt_pk_bf16_f32 v104, v72, v73
    v_mfma_f32_32x32x16_bf16 v[56:71], a[20:23], v[16:19], v[56:71]
    v_cvt_pk_bf16_f32 v105, v74, v75
    ds_read_b128 v[12:15], v2 offset:9216
    s_waitcnt lgkmcnt(6)
    v_mfma_f32_32x32x16_bf16 v[40:55], a[24:27], v[20:23], v[40:55]
    v_cvt_pk_bf16_f32 v106, v76, v77
    v_mfma_f32_32x32x16_bf16 v[56:71], a[28:31], v[20:23], v[56:71]
    v_cvt_pk_bf16_f32 v107, v78, v79
    ds_read_b128 v[16:19], v2 offset:10240
    s_waitcnt lgkmcnt(6)
    v_mfma_f32_32x32x16_bf16 v[40:55], a[32:35], v[24:27], v[40:55]
    s_nop 1
    v_mfma_f32_32x32x16_bf16 v[56:71], a[36:39], v[24:27], v[56:71]
    v_permlane32_swap_b32 v104, v106
    ds_read_b128 v[20:23], v2 offset:11264
    s_waitcnt lgkmcnt(6)
    v_mfma_f32_32x32x16_bf16 v[40:55], a[40:43], v[28:31], v[40:55]
    v_permlane32_swap_b32 v105, v107
    v_mfma_f32_32x32x16_bf16 v[56:71], a[44:47], v[28:31], v[56:71]
    buffer_store_dwordx4 v[104:107], v3, s[8:11], s17 offen offset:0 sc1
    ds_read_b128 v[24:27], v2 offset:12288
    s_waitcnt lgkmcnt(6)
    v_mfma_f32_32x32x16_bf16 v[40:55], a[48:51], v[32:35], v[40:55]
    v_cvt_pk_bf16_f32 v108, v80, v81
    v_mfma_f32_32x32x16_bf16 v[56:71], a[52:55], v[32:35], v[56:71]
    v_cvt_pk_bf16_f32 v109, v82, v83
    ds_read_b128 v[28:31], v2 offset:13312
    s_waitcnt lgkmcnt(6)
    v_mfma_f32_32x32x16_bf16 v[40:55], a[56:59], v[36:39], v[40:55]
    v_cvt_pk_bf16_f32 v110, v84, v85
    v_mfma_f32_32x32x16_bf16 v[56:71], a[60:63], v[36:39], v[56:71]
    v_cvt_pk_bf16_f32 v111, v86, v87
    ds_read_b128 v[32:35], v2 offset:14336
    s_waitcnt lgkmcnt(6)
    v_mfma_f32_32x32x16_bf16 v[40:55], a[64:67], v[8:11], v[40:55]
    s_nop 1
    v_mfma_f32_32x32x16_bf16 v[56:71], a[68:71], v[8:11], v[56:71]
    v_permlane32_swap_b32 v108, v110
    ds_read_b128 v[36:39], v2 offset:15360
    s_waitcnt lgkmcnt(6)
    v_mfma_f32_32x32x16_bf16 v[40:55], a[72:75], v[12:15], v[40:55]
    v_permlane32_swap_b32 v109, v111
    v_mfma_f32_32x32x16_bf16 v[56:71], a[76:79], v[12:15], v[56:71]
    buffer_store_dwordx4 v[108:111], v3, s[8:11], s17 offen offset:1024 sc1
    ds_read_b128 v[8:11], v2 offset:16384
    s_waitcnt lgkmcnt(6)
    v_mfma_f32_32x32x16_bf16 v[40:55], a[80:83], v[16:19], v[40:55]
    v_cvt_pk_bf16_f32 v112, v88, v89
    v_mfma_f32_32x32x16_bf16 v[56:71], a[84:87], v[16:19], v[56:71]
    v_cvt_pk_bf16_f32 v113, v90, v91
    ds_read_b128 v[12:15], v2 offset:17408
    s_waitcnt lgkmcnt(6)
    v_mfma_f32_32x32x16_bf16 v[40:55], a[88:91], v[20:23], v[40:55]
    v_cvt_pk_bf16_f32 v114, v92, v93
    v_mfma_f32_32x32x16_bf16 v[56:71], a[92:95], v[20:23], v[56:71]
    v_cvt_pk_bf16_f32 v115, v94, v95
    ds_read_b128 v[16:19], v2 offset:18432
    s_waitcnt lgkmcnt(6)
    v_mfma_f32_32x32x16_bf16 v[40:55], a[96:99], v[24:27], v[40:55]
    s_nop 1
    v_mfma_f32_32x32x16_bf16 v[56:71], a[100:103], v[24:27], v[56:71]
    v_permlane32_swap_b32 v112, v114
    ds_read_b128 v[20:23], v2 offset:19456
    s_waitcnt lgkmcnt(6)
    v_mfma_f32_32x32x16_bf16 v[40:55], a[104:107], v[28:31], v[40:55]
    v_permlane32_swap_b32 v113, v115
    v_mfma_f32_32x32x16_bf16 v[56:71], a[108:111], v[28:31], v[56:71]
    buffer_store_dwordx4 v[112:115], v3, s[8:11], s18 offen offset:0 sc1
    ds_read_b128 v[24:27], v2 offset:20480
    s_waitcnt lgkmcnt(6)
    v_mfma_f32_32x32x16_bf16 v[40:55], a[112:115], v[32:35], v[40:55]
    v_cvt_pk_bf16_f32 v116, v96, v97
    v_mfma_f32_32x32x16_bf16 v[56:71], a[116:119], v[32:35], v[56:71]
    v_cvt_pk_bf16_f32 v117, v98, v99
    ds_read_b128 v[28:31], v2 offset:21504
    s_waitcnt lgkmcnt(6)
    v_mfma_f32_32x32x16_bf16 v[40:55], a[120:123], v[36:39], v[40:55]
    v_cvt_pk_bf16_f32 v118, v100, v101
    v_mfma_f32_32x32x16_bf16 v[56:71], a[124:127], v[36:39], v[56:71]
    v_cvt_pk_bf16_f32 v119, v102, v103
    ds_read_b128 v[32:35], v2 offset:22528
    s_waitcnt lgkmcnt(6)
    v_mfma_f32_32x32x16_bf16 v[40:55], a[128:131], v[8:11], v[40:55]
    s_nop 1
    v_mfma_f32_32x32x16_bf16 v[56:71], a[132:135], v[8:11], v[56:71]
    v_permlane32_swap_b32 v116, v118
    ds_read_b128 v[36:39], v2 offset:23552
    s_waitcnt lgkmcnt(6)
    v_mfma_f32_32x32x16_bf16 v[40:55], a[136:139], v[12:15], v[40:55]
    v_permlane32_swap_b32 v117, v119
    v_mfma_f32_32x32x16_bf16 v[56:71], a[140:143], v[12:15], v[56:71]
    buffer_store_dwordx4 v[116:119], v3, s[8:11], s18 offen offset:1024 sc1
    ds_read_b128 v[8:11], v2 offset:24576
    s_waitcnt lgkmcnt(6)
    v_mfma_f32_32x32x16_bf16 v[40:55], a[144:147], v[16:19], v[40:55]
    s_add_u32 s17, s17, s20
    v_mfma_f32_32x32x16_bf16 v[56:71], a[148:151], v[16:19], v[56:71]
    s_add_u32 s18, s18, s20
    ds_read_b128 v[12:15], v2 offset:25600
    s_waitcnt lgkmcnt(6)
    v_mfma_f32_32x32x16_bf16 v[40:55], a[152:155], v[20:23], v[40:55]
    v_mfma_f32_32x32x16_bf16 v[56:71], a[156:159], v[20:23], v[56:71]
    ds_read_b128 v[16:19], v2 offset:26624
    s_waitcnt lgkmcnt(6)
    v_mfma_f32_32x32x16_bf16 v[40:55], a[160:163], v[24:27], v[40:55]
    v_mfma_f32_32x32x16_bf16 v[56:71], a[164:167], v[24:27], v[56:71]
    ds_read_b128 v[20:23], v2 offset:27648
    s_waitcnt lgkmcnt(6)
    v_mfma_f32_32x32x16_bf16 v[40:55], a[168:171], v[28:31], v[40:55]
    v_mfma_f32_32x32x16_bf16 v[56:71], a[172:175], v[28:31], v[56:71]
    ds_read_b128 v[24:27], v2 offset:28672
    s_waitcnt lgkmcnt(6)
    v_mfma_f32_32x32x16_bf16 v[40:55], a[176:179], v[32:35], v[40:55]
    v_mfma_f32_32x32x16_bf16 v[56:71], a[180:183], v[32:35], v[56:71]
    ds_read_b128 v[28:31], v2 offset:29696
    s_waitcnt lgkmcnt(6)
    v_mfma_f32_32x32x16_bf16 v[40:55], a[184:187], v[36:39], v[40:55]
    v_mfma_f32_32x32x16_bf16 v[56:71], a[188:191], v[36:39], v[56:71]
    ds_read_b128 v[32:35], v2 offset:30720
    s_waitcnt lgkmcnt(6)
    v_mfma_f32_32x32x16_bf16 v[40:55], a[192:195], v[8:11], v[40:55]
    v_mfma_f32_32x32x16_bf16 v[56:71], a[196:199], v[8:11], v[56:71]
    ds_read_b128 v[36:39], v2 offset:31744
    s_waitcnt lgkmcnt(6)
    v_mfma_f32_32x32x16_bf16 v[40:55], a[200:203], v[12:15], v[40:55]
    v_mfma_f32_32x32x16_bf16 v[56:71], a[204:207], v[12:15], v[56:71]
    ds_read_b128 v[8:11], v2 offset:32768
    s_waitcnt lgkmcnt(6)
    v_mfma_f32_32x32x16_bf16 v[40:55], a[208:211], v[16:19], v[40:55]
    v_mfma_f32_32x32x16_bf16 v[56:71], a[212:215], v[16:19], v[56:71]
    ds_read_b128 v[12:15], v2 offset:33792
    s_waitcnt lgkmcnt(6)
    v_mfma_f32_32x32x16_bf16 v[40:55], a[216:219], v[20:23], v[40:55]
    v_mfma_f32_32x32x16_bf16 v[56:71], a[220:223], v[20:23], v[56:71]
    ds_read_b128 v[16:19], v2 offset:34816
    s_waitcnt lgkmcnt(6)
    v_mfma_f32_32x32x16_bf16 v[40:55], a[224:227], v[24:27], v[40:55]
    v_mfma_f32_32x32x16_bf16 v[56:71], a[228:231], v[24:27], v[56:71]
    s_cmp_gt_u32 s14, 2
    s_cbranch_scc1 layerb1_kernel_gk_dr3
    s_waitcnt vmcnt(0)
    s_mov_b32 s27, s14
    s_branch layerb1_kernel_gk_dq3
layerb1_kernel_gk_dr3:
    s_waitcnt vmcnt(4)
    s_sub_u32 s27, s14, 1
layerb1_kernel_gk_dq3:
    s_barrier
    s_cmp_lg_u32 s13, 0
    s_cbranch_scc1 layerb1_kernel_gk_fl4
    s_mov_b64 exec, 1
    s_lshl_b32 s26, s12, 7
    v_mov_b32 v7, s26
    v_mov_b32 v120, s27
    buffer_store_dword v120, v7, s[8:11], s48 offen sc1
    s_mov_b64 exec, -1
layerb1_kernel_gk_fl4:
    s_add_u32 s21, s16, 40960
    s_cmp_eq_u32 s21, 122880
    s_cselect_b32 s21, 0, s21
    s_add_u32 s23, s14, 2
    s_min_u32 s24, s23, 63
    s_mul_i32 s24, s24, 40960
    s_add_u32 s24, s24, s19
    s_mul_i32 s25, s13, 10240
    s_add_u32 s25, s25, s22
    s_mov_b32 m0, s25
    s_nop 0
    buffer_load_dwordx4 v1, s[8:11], s24 offen offset:0 lds
    buffer_load_dwordx4 v1, s[8:11], s24 offen offset:1024 lds
    buffer_load_dwordx4 v1, s[8:11], s24 offen offset:2048 lds
    buffer_load_dwordx4 v1, s[8:11], s24 offen offset:3072 lds
    s_add_u32 s24, s24, 4096
    s_add_u32 s25, s25, 4096
    s_mov_b32 m0, s25
    s_nop 0
    buffer_load_dwordx4 v1, s[8:11], s24 offen offset:0 lds
    buffer_load_dwordx4 v1, s[8:11], s24 offen offset:1024 lds
    buffer_load_dwordx4 v1, s[8:11], s24 offen offset:2048 lds
    buffer_load_dwordx4 v1, s[8:11], s24 offen offset:3072 lds
    s_add_u32 s24, s24, 4096
    s_add_u32 s25, s25, 4096
    s_mov_b32 m0, s25
    s_nop 0
    buffer_load_dwordx4 v1, s[8:11], s24 offen offset:0 lds
    buffer_load_dwordx4 v1, s[8:11], s24 offen offset:1024 lds
    s_add_u32 s22, s22, 40960
    s_cmp_eq_u32 s22, 122880
    s_cselect_b32 s22, 0, s22
    ds_read_b128 v[20:23], v2 offset:35840
    s_waitcnt lgkmcnt(6)
    v_mfma_f32_32x32x16_bf16 v[40:55], a[232:235], v[28:31], v[40:55]
    v_mfma_f32_32x32x16_bf16 v[56:71], a[236:239], v[28:31], v[56:71]
    ds_read_b128 v[24:27], v2 offset:36864
    s_waitcnt lgkmcnt(6)
    v_mfma_f32_32x32x16_bf16 v[40:55], a[240:243], v[32:35], v[40:55]
    v_mfma_f32_32x32x16_bf16 v[56:71], a[244:247], v[32:35], v[56:71]
    ds_read_b128 v[28:31], v2 offset:37888
    s_waitcnt lgkmcnt(6)
    v_mfma_f32_32x32x16_bf16 v[40:55], a[248:251], v[36:39], v[40:55]
    v_mfma_f32_32x32x16_bf16 v[56:71], a[252:255], v[36:39], v[56:71]
    ds_read_b128 v[32:35], v2 offset:38912
    s_waitcnt lgkmcnt(6)
    v_mfma_f32_32x32x16_bf16 v[40:55], v[192:195], v[8:11], v[40:55]
    v_mfma_f32_32x32x16_bf16 v[56:71], v[196:199], v[8:11], v[56:71]
    ds_read_b128 v[36:39], v2 offset:39936
    s_waitcnt lgkmcnt(6)
    v_mfma_f32_32x32x16_bf16 v[40:55], v[200:203], v[12:15], v[40:55]
    v_mfma_f32_32x32x16_bf16 v[56:71], v[204:207], v[12:15], v[56:71]
    v_add_u32 v6, s21, v1
    ds_read_b128 v[8:11], v6 offset:0
    s_waitcnt lgkmcnt(6)
    v_mfma_f32_32x32x16_bf16 v[40:55], v[208:211], v[16:19], v[40:55]
    v_mfma_f32_32x32x16_bf16 v[56:71], v[212:215], v[16:19], v[56:71]
    ds_read_b128 v[12:15], v6 offset:1024
    s_waitcnt lgkmcnt(6)
    v_mfma_f32_32x32x16_bf16 v[40:55], v[216:219], v[20:23], v[40:55]
    v_mfma_f32_32x32x16_bf16 v[56:71], v[220:223], v[20:23], v[56:71]
    ds_read_b128 v[16:19], v6 offset:2048
    s_waitcnt lgkmcnt(6)
    v_mfma_f32_32x32x16_bf16 v[40:55], v[224:227], v[24:27], v[40:55]
    v_mfma_f32_32x32x16_bf16 v[56:71], v[228:231], v[24:27], v[56:71]
    ds_read_b128 v[20:23], v6 offset:3072
    s_waitcnt lgkmcnt(6)
    v_mfma_f32_32x32x16_bf16 v[40:55], v[232:235], v[28:31], v[40:55]
    v_mfma_f32_32x32x16_bf16 v[56:71], v[236:239], v[28:31], v[56:71]
    ds_read_b128 v[24:27], v6 offset:4096
    s_waitcnt lgkmcnt(6)
    v_mfma_f32_32x32x16_bf16 v[40:55], v[240:243], v[32:35], v[40:55]
    v_mfma_f32_32x32x16_bf16 v[56:71], v[244:247], v[32:35], v[56:71]
    ds_read_b128 v[28:31], v6 offset:5120
    s_waitcnt lgkmcnt(6)
    v_mfma_f32_32x32x16_bf16 v[40:55], v[248:251], v[36:39], v[40:55]
    v_mfma_f32_32x32x16_bf16 v[56:71], v[252:255], v[36:39], v[56:71]
    v_mov_b32 v2, v6
    s_mov_b32 s16, s21
    s_add_u32 s14, s14, 1
    s_cmp_lt_u32 s14, s15
    s_cbranch_scc1 layerb1_kernel_gk_loop
layerb1_kernel_gk_fin0:
    s_nop 7
    s_nop 7
    v_cvt_pk_bf16_f32 v104, v40, v41
    v_cvt_pk_bf16_f32 v105, v42, v43
    v_cvt_pk_bf16_f32 v106, v44, v45
    v_cvt_pk_bf16_f32 v107, v46, v47
    s_nop 1
    v_permlane32_swap_b32 v104, v106
    v_permlane32_swap_b32 v105, v107
    buffer_store_dwordx4 v[104:107], v3, s[8:11], s17 offen offset:0 sc1
    v_cvt_pk_bf16_f32 v108, v48, v49
    v_cvt_pk_bf16_f32 v109, v50, v51
    v_cvt_pk_bf16_f32 v110, v52, v53
    v_cvt_pk_bf16_f32 v111, v54, v55
    s_nop 1
    v_permlane32_swap_b32 v108, v110
    v_permlane32_swap_b32 v109, v111
    buffer_store_dwordx4 v[108:111], v3, s[8:11], s17 offen offset:1024 sc1
    v_cvt_pk_bf16_f32 v112, v56, v57
    v_cvt_pk_bf16_f32 v113, v58, v59
    v_cvt_pk_bf16_f32 v114, v60, v61
    v_cvt_pk_bf16_f32 v115, v62, v63
    s_nop 1
    v_permlane32_swap_b32 v112, v114
    v_permlane32_swap_b32 v113, v115
    buffer_store_dwordx4 v[112:115], v3, s[8:11], s18 offen offset:0 sc1
    v_cvt_pk_bf16_f32 v116, v64, v65
    v_cvt_pk_bf16_f32 v117, v66, v67
    v_cvt_pk_bf16_f32 v118, v68, v69
    v_cvt_pk_bf16_f32 v119, v70, v71
    s_nop 1
    v_permlane32_swap_b32 v116, v118
    v_permlane32_swap_b32 v117, v119
    buffer_store_dwordx4 v[116:119], v3, s[8:11], s18 offen offset:1024 sc1
    s_add_u32 s17, s17, s20
    s_add_u32 s18, s18, s20
    s_branch layerb1_kernel_gk_done
layerb1_kernel_gk_fin1:
    s_nop 7
    s_nop 7
    v_cvt_pk_bf16_f32 v104, v72, v73
    v_cvt_pk_bf16_f32 v105, v74, v75
    v_cvt_pk_bf16_f32 v106, v76, v77
    v_cvt_pk_bf16_f32 v107, v78, v79
    s_nop 1
    v_permlane32_swap_b32 v104, v106
    v_permlane32_swap_b32 v105, v107
    buffer_store_dwordx4 v[104:107], v3, s[8:11], s17 offen offset:0 sc1
    v_cvt_pk_bf16_f32 v108, v80, v81
    v_cvt_pk_bf16_f32 v109, v82, v83
    v_cvt_pk_bf16_f32 v110, v84, v85
    v_cvt_pk_bf16_f32 v111, v86, v87
    s_nop 1
    v_permlane32_swap_b32 v108, v110
    v_permlane32_swap_b32 v109, v111
    buffer_store_dwordx4 v[108:111], v3, s[8:11], s17 offen offset:1024 sc1
    v_cvt_pk_bf16_f32 v112, v88, v89
    v_cvt_pk_bf16_f32 v113, v90, v91
    v_cvt_pk_bf16_f32 v114, v92, v93
    v_cvt_pk_bf16_f32 v115, v94, v95
    s_nop 1
    v_permlane32_swap_b32 v112, v114
    v_permlane32_swap_b32 v113, v115
    buffer_store_dwordx4 v[112:115], v3, s[8:11], s18 offen offset:0 sc1
    v_cvt_pk_bf16_f32 v116, v96, v97
    v_cvt_pk_bf16_f32 v117, v98, v99
    v_cvt_pk_bf16_f32 v118, v100, v101
    v_cvt_pk_bf16_f32 v119, v102, v103
    s_nop 1
    v_permlane32_swap_b32 v116, v118
    v_permlane32_swap_b32 v117, v119
    buffer_store_dwordx4 v[116:119], v3, s[8:11], s18 offen offset:1024 sc1
    s_add_u32 s17, s17, s20
    s_add_u32 s18, s18, s20
layerb1_kernel_gk_done:
    s_waitcnt vmcnt(0) lgkmcnt(0)
    s_barrier
    s_cmp_lg_u32 s13, 0
    s_cbranch_scc1 layerb1_kernel_gk_fl5
    s_mov_b64 exec, 1
    s_lshl_b32 s26, s12, 7
    v_mov_b32 v7, s26
    v_mov_b32 v120, s14
    buffer_store_dword v120, v7, s[8:11], s48 offen sc1
    s_mov_b64 exec, -1
layerb1_kernel_gk_fl5:
layerb1_kernel_g_done:
layerb1_kernel_w3:
    s_mov_b32 s15, 400000
layerb1_kernel_j_next:
    s_cmp_lg_u32 s13, 0
    s_cbranch_scc1 layerb1_kernel_j_rel
    s_mov_b64 exec, 1
    v_mov_b32 v2, 31744
    v_mov_b32 v3, 1
    buffer_atomic_add v3, v2, s[8:11], s48 offen sc0 sc1
    s_waitcnt vmcnt(0)
    s_mov_b64 exec, -1
    s_nop 0
    v_readfirstlane_b32 s38, v3
    s_cmp_ge_u32 s38, 1152
    s_cbranch_scc1 layerb1_kernel_j_pub
    s_mul_i32 s39, s38, 58255
    s_lshr_b32 s40, s39, 20
    s_mul_i32 s39, s40, 18
    s_sub_u32 s41, s38, s39
    s_add_u32 s42, s40, 1
    v_mov_b32 v4, s42
    s_cmp_ge_u32 s41, 8
    s_cbranch_scc1 layerb1_kernel_j_dep_b
    s_lshl_b32 s24, s41, 9
    s_add_u32 s24, s24, 16384
    v_lshlrev_b32 v2, 7, v0
    v_add_u32 v2, s24, v2
    s_mul_i32 s25, s41, 3
    s_add_u32 s25, s25, 104
    s_lshl_b32 s25, s25, 7
    v_writelane_b32 v2, s25, 4
    s_add_u32 s25, s25, 128
    v_writelane_b32 v2, s25, 5
    s_add_u32 s25, s25, 128
    v_writelane_b32 v2, s25, 6
    s_mov_b64 exec, 0x7f
    s_branch layerb1_kernel_j_poll
layerb1_kernel_j_dep_b:
    s_sub_u32 s24, s41, 8
    s_lshl_b32 s24, s24, 10
    s_add_u32 s24, s24, 20480
    v_lshlrev_b32 v2, 7, v0
    v_add_u32 v2, s24, v2
    s_lshl_b32 s25, s40, 4
    s_add_u32 s25, s25, 30720
    v_writelane_b32 v2, s25, 8
    s_mov_b32 s26, 8
    v_writelane_b32 v4, s26, 8
    s_mov_b64 exec, 0x1ff
layerb1_kernel_j_poll:
    buffer_load_dword v3, v2, s[8:11], s48 offen sc1
    s_waitcnt vmcnt(0)
    v_cmp_gt_u32 vcc, v4, v3
    s_sub_u32 s15, s15, 1
    s_cbranch_scc1 layerb1_kernel_j_giveup
    s_cbranch_vccnz layerb1_kernel_j_poll
    s_mov_b64 exec, -1
layerb1_kernel_j_pub:
    v_mov_b32 v2, 0
    v_mov_b32 v3, s38
    ds_write_b32 v2, v3 offset:32768
    s_waitcnt lgkmcnt(0)
layerb1_kernel_j_rel:
    s_barrier
    v_mov_b32 v2, 0
    ds_read_b32 v3, v2 offset:32768
    s_waitcnt lgkmcnt(0)
    v_readfirstlane_b32 s38, v3
    s_cmp_ge_u32 s38, 1152
    s_cbranch_scc1 layerb1_kernel_j_done
    s_mul_i32 s39, s38, 58255
    s_lshr_b32 s40, s39, 20
    s_mul_i32 s39, s40, 18
    s_sub_u32 s41, s38, s39
    s_cmp_ge_u32 s41, 8
    s_cbranch_scc1 layerb1_kernel_j_b
    s_lshl_b32 s41, s41, 2
    s_add_u32 s41, s41, s13
    v_lshlrev_b32 v1, 4, v0
    v_and_b32 v2, 31, v0
    v_lshrrev_b32 v3, 5, v0
    s_lshl_b32 s24, s40, 5
    s_add_u32 s24, s24, s41
    s_mul_i32 s25, s24, 12288
    s_add_u32 s26, s25, 78643200
    s_add_u32 s27, s25, 53477376
    s_mul_i32 s28, s24, 3072
    s_add_u32 s28, s28, 208666624
    v_and_b32 v4, 7, v0
    v_lshlrev_b32 v4, 4, v4
    v_lshl_add_u32 v4, v3, 7, v4
    buffer_load_dwordx4 v[16:19], v1, s[8:11], s26 offen offset:0 sc1
    buffer_load_dwordx4 v[64:67], v1, s[8:11], s27 offen offset:0 sc1
    buffer_load_dwordx4 v[112:115], v4, s[8:11], s28 offen offset:0 sc1
    buffer_load_dwordx4 v[20:23], v1, s[8:11], s26 offen offset:1024 sc1
    buffer_load_dwordx4 v[68:71], v1, s[8:11], s27 offen offset:1024 sc1
    buffer_load_dwordx4 v[116:119], v4, s[8:11], s28 offen offset:256 sc1
    buffer_load_dwordx4 v[24:27], v1, s[8:11], s26 offen offset:2048 sc1
    buffer_load_dwordx4 v[72:75], v1, s[8:11], s27 offen offset:2048 sc1
    buffer_load_dwordx4 v[120:123], v4, s[8:11], s28 offen offset:512 sc1
    buffer_load_dwordx4 v[28:31], v1, s[8:11], s26 offen offset:3072 sc1
    buffer_load_dwordx4 v[76:79], v1, s[8:11], s27 offen offset:3072 sc1
    buffer_load_dwordx4 v[124:127], v4, s[8:11], s28 offen offset:768 sc1
    s_add_u32 s26, s26, 4096
    s_add_u32 s27, s27, 4096
    buffer_load_dwordx4 v[32:35], v1, s[8:11], s26 offen offset:0 sc1
    buffer_load_dwordx4 v[80:83], v1, s[8:11], s27 offen offset:0 sc1
    buffer_load_dwordx4 v[128:131], v4, s[8:11], s28 offen offset:1024 sc1
    buffer_load_dwordx4 v[36:39], v1, s[8:11], s26 offen offset:1024 sc1
    buffer_load_dwordx4 v[84:87], v1, s[8:11], s27 offen offset:1024 sc1
    buffer_load_dwordx4 v[132:135], v4, s[8:11], s28 offen offset:1280 sc1
    buffer_load_dwordx4 v[40:43], v1, s[8:11], s26 offen offset:2048 sc1
    buffer_load_dwordx4 v[88:91], v1, s[8:11], s27 offen offset:2048 sc1
    buffer_load_dwordx4 v[136:139], v4, s[8:11], s28 offen offset:1536 sc1
    buffer_load_dwordx4 v[44:47], v1, s[8:11], s26 offen offset:3072 sc1
    buffer_load_dwordx4 v[92:95], v1, s[8:11], s27 offen offset:3072 sc1
    buffer_load_dwordx4 v[140:143], v4, s[8:11], s28 offen offset:1792 sc1
    s_add_u32 s26, s26, 4096
    s_add_u32 s27, s27, 4096
    buffer_load_dwordx4 v[48:51], v1, s[8:11], s26 offen offset:0 sc1
    buffer_load_dwordx4 v[96:99], v1, s[8:11], s27 offen offset:0 sc1
    buffer_load_dwordx4 v[144:147], v4, s[8:11], s28 offen offset:2048 sc1
    buffer_load_dwordx4 v[52:55], v1, s[8:11], s26 offen offset:1024 sc1
    buffer_load_dwordx4 v[100:103], v1, s[8:11], s27 offen offset:1024 sc1
    buffer_load_dwordx4 v[148:151], v4, s[8:11], s28 offen offset:2304 sc1
    buffer_load_dwordx4 v[56:59], v1, s[8:11], s26 offen offset:2048 sc1
    buffer_load_dwordx4 v[104:107], v1, s[8:11], s27 offen offset:2048 sc1
    buffer_load_dwordx4 v[152:155], v4, s[8:11], s28 offen offset:2560 sc1
    buffer_load_dwordx4 v[60:63], v1, s[8:11], s26 offen offset:3072 sc1
    buffer_load_dwordx4 v[108:111], v1, s[8:11], s27 offen offset:3072 sc1
    buffer_load_dwordx4 v[156:159], v4, s[8:11], s28 offen offset:2816 sc1
    v_lshlrev_b32 v5, 2, v3
    v_sub_u32 v5, v2, v5
    v_mov_b32 v6, 0xf149f2ca
    v_cmp_gt_i32 vcc, 0, v5
    s_nop 1
    v_cndmask_b32 v192, 0, v6, vcc
    v_cmp_gt_i32 vcc, 1, v5
    s_nop 1
    v_cndmask_b32 v193, 0, v6, vcc
    v_cmp_gt_i32 vcc, 2, v5
    s_nop 1
    v_cndmask_b32 v194, 0, v6, vcc
    v_cmp_gt_i32 vcc, 3, v5
    s_nop 1
    v_cndmask_b32 v195, 0, v6, vcc
    v_cmp_gt_i32 vcc, 8, v5
    s_nop 1
    v_cndmask_b32 v196, 0, v6, vcc
    v_cmp_gt_i32 vcc, 9, v5
    s_nop 1
    v_cndmask_b32 v197, 0, v6, vcc
    v_cmp_gt_i32 vcc, 10, v5
    s_nop 1
    v_cndmask_b32 v198, 0, v6, vcc
    v_cmp_gt_i32 vcc, 11, v5
    s_nop 1
    v_cndmask_b32 v199, 0, v6, vcc
    v_cmp_gt_i32 vcc, 16, v5
    s_nop 1
    v_cndmask_b32 v200, 0, v6, vcc
    v_cmp_gt_i32 vcc, 17, v5
    s_nop 1
    v_cndmask_b32 v201, 0, v6, vcc
    v_cmp_gt_i32 vcc, 18, v5
    s_nop 1
    v_cndmask_b32 v202, 0, v6, vcc
    v_cmp_gt_i32 vcc, 19, v5
    s_nop 1
    v_cndmask_b32 v203, 0, v6, vcc
    v_cmp_gt_i32 vcc, 24, v5
    s_nop 1
    v_cndmask_b32 v204, 0, v6, vcc
    v_cmp_gt_i32 vcc, 25, v5
    s_nop 1
    v_cndmask_b32 v205, 0, v6, vcc
    v_cmp_gt_i32 vcc, 26, v5
    s_nop 1
    v_cndmask_b32 v206, 0, v6, vcc
    v_cmp_gt_i32 vcc, 27, v5
    s_nop 1
    v_cndmask_b32 v207, 0, v6, vcc
    s_waitcnt vmcnt(33)
    v_mfma_f32_32x32x16_bf16 v[160:175], v[64:67], v[16:19], 0
    v_mfma_f32_32x32x16_bf16 v[176:191], v[112:115], v[16:19], 0
    s_waitcnt vmcnt(30)
    v_mfma_f32_32x32x16_bf16 v[160:175], v[68:71], v[20:23], v[160:175]
    v_mfma_f32_32x32x16_bf16 v[176:191], v[116:119], v[20:23], v[176:191]
    s_waitcnt vmcnt(27)
    v_mfma_f32_32x32x16_bf16 v[160:175], v[72:75], v[24:27], v[160:175]
    v_mfma_f32_32x32x16_bf16 v[176:191], v[120:123], v[24:27], v[176:191]
    s_waitcnt vmcnt(24)
    v_mfma_f32_32x32x16_bf16 v[160:175], v[76:79], v[28:31], v[160:175]
    v_mfma_f32_32x32x16_bf16 v[176:191], v[124:127], v[28:31], v[176:191]
    s_waitcnt vmcnt(21)
    v_mfma_f32_32x32x16_bf16 v[160:175], v[80:83], v[32:35], v[160:175]
    v_mfma_f32_32x32x16_bf16 v[176:191], v[128:131], v[32:35], v[176:191]
    s_waitcnt vmcnt(18)
    v_mfma_f32_32x32x16_bf16 v[160:175], v[84:87], v[36:39], v[160:175]
    v_mfma_f32_32x32x16_bf16 v[176:191], v[132:135], v[36:39], v[176:191]
    s_waitcnt vmcnt(15)
    v_mfma_f32_32x32x16_bf16 v[160:175], v[88:91], v[40:43], v[160:175]
    v_mfma_f32_32x32x16_bf16 v[176:191], v[136:139], v[40:43], v[176:191]
    s_waitcnt vmcnt(12)
    v_mfma_f32_32x32x16_bf16 v[160:175], v[92:95], v[44:47], v[160:175]
    v_mfma_f32_32x32x16_bf16 v[176:191], v[140:143], v[44:47], v[176:191]
    s_waitcnt vmcnt(9)
    v_mfma_f32_32x32x16_bf16 v[160:175], v[96:99], v[48:51], v[160:175]
    v_mfma_f32_32x32x16_bf16 v[176:191], v[144:147], v[48:51], v[176:191]
    s_waitcnt vmcnt(6)
    v_mfma_f32_32x32x16_bf16 v[160:175], v[100:103], v[52:55], v[160:175]
    v_mfma_f32_32x32x16_bf16 v[176:191], v[148:151], v[52:55], v[176:191]
    s_waitcnt vmcnt(3)
    v_mfma_f32_32x32x16_bf16 v[160:175], v[104:107], v[56:59], v[160:175]
    v_mfma_f32_32x32x16_bf16 v[176:191], v[152:155], v[56:59], v[176:191]
    s_waitcnt vmcnt(0)
    v_mfma_f32_32x32x16_bf16 v[160:175], v[108:111], v[60:63], v[160:175]
    v_mfma_f32_32x32x16_bf16 v[176:191], v[156:159], v[60:63], v[176:191]
    s_nop 7
    s_nop 7
    v_mov_b32 v7, 0x3dd53b95
    v_fma_f32 v160, v160, v7, v192
    v_fma_f32 v161, v161, v7, v193
    v_fma_f32 v162, v162, v7, v194
    v_fma_f32 v163, v163, v7, v195
    v_fma_f32 v164, v164, v7, v196
    v_fma_f32 v165, v165, v7, v197
    v_fma_f32 v166, v166, v7, v198
    v_fma_f32 v167, v167, v7, v199
    v_fma_f32 v168, v168, v7, v200
    v_fma_f32 v169, v169, v7, v201
    v_fma_f32 v170, v170, v7, v202
    v_fma_f32 v171, v171, v7, v203
    v_fma_f32 v172, v172, v7, v204
    v_fma_f32 v173, v173, v7, v205
    v_fma_f32 v174, v174, v7, v206
    v_fma_f32 v175, v175, v7, v207
    v_mul_f32 v176, v176, v7
    v_mul_f32 v177, v177, v7
    v_mul_f32 v178, v178, v7
    v_mul_f32 v179, v179, v7
    v_max3_f32 v208, v160, v161, v162
    v_max3_f32 v208, v208, v163, v164
    v_max3_f32 v208, v208, v165, v166
    v_max3_f32 v208, v208, v167, v168
    v_max3_f32 v208, v208, v169, v170
    v_max3_f32 v208, v208, v171, v172
    v_max3_f32 v208, v208, v173, v174
    v_max3_f32 v208, v208, v175, v176
    v_max3_f32 v208, v208, v177, v178
    v_max_f32 v208, v208, v179
    v_mov_b32 v209, v208
    s_nop 1
    v_permlane32_swap_b32 v208, v209
    v_max_f32 v208, v208, v209
    v_sub_f32 v160, v160, v208
    v_sub_f32 v161, v161, v208
    v_sub_f32 v162, v162, v208
    v_sub_f32 v163, v163, v208
    v_sub_f32 v164, v164, v208
    v_sub_f32 v165, v165, v208
    v_sub_f32 v166, v166, v208
    v_sub_f32 v167, v167, v208
    v_sub_f32 v168, v168, v208
    v_sub_f32 v169, v169, v208
    v_sub_f32 v170, v170, v208
    v_sub_f32 v171, v171, v208
    v_sub_f32 v172, v172, v208
    v_sub_f32 v173, v173, v208
    v_sub_f32 v174, v174, v208
    v_sub_f32 v175, v175, v208
    v_sub_f32 v176, v176, v208
    v_sub_f32 v177, v177, v208
    v_sub_f32 v178, v178, v208
    v_sub_f32 v179, v179, v208
    v_exp_f32 v160, v160
    v_exp_f32 v161, v161
    v_exp_f32 v162, v162
    v_exp_f32 v163, v163
    v_exp_f32 v164, v164
    v_exp_f32 v165, v165
    v_exp_f32 v166, v166
    v_exp_f32 v167, v167
    v_exp_f32 v168, v168
    v_exp_f32 v169, v169
    v_exp_f32 v170, v170
    v_exp_f32 v171, v171
    v_exp_f32 v172, v172
    v_exp_f32 v173, v173
    v_exp_f32 v174, v174
    v_exp_f32 v175, v175
    v_exp_f32 v176, v176
    v_exp_f32 v177, v177
    v_exp_f32 v178, v178
    v_exp_f32 v179, v179
    s_nop 0
    v_add_f32 v210, v160, v161
    v_add_f32 v210, v210, v162
    v_add_f32 v210, v210, v163
    v_add_f32 v210, v210, v164
    v_add_f32 v210, v210, v165
    v_add_f32 v210, v210, v166
    v_add_f32 v210, v210, v167
    v_add_f32 v210, v210, v168
    v_add_f32 v210, v210, v169
    v_add_f32 v210, v210, v170
    v_add_f32 v210, v210, v171
    v_add_f32 v210, v210, v172
    v_add_f32 v210, v210, v173
    v_add_f32 v210, v210, v174
    v_add_f32 v210, v210, v175
    v_add_f32 v210, v210, v176
    v_add_f32 v210, v210, v177
    v_add_f32 v210, v210, v178
    v_add_f32 v210, v210, v179
    v_mov_b32 v209, v210
    s_nop 1
    v_permlane32_swap_b32 v210, v209
    v_add_f32 v210, v210, v209
    v_rcp_f32 v210, v210
    s_nop 0
    v_mul_f32 v160, v160, v210
    v_mul_f32 v161, v161, v210
    v_mul_f32 v162, v162, v210
    v_mul_f32 v163, v163, v210
    v_mul_f32 v164, v164, v210
    v_mul_f32 v165, v165, v210
    v_mul_f32 v166, v166, v210
    v_mul_f32 v167, v167, v210
    v_mul_f32 v168, v168, v210
    v_mul_f32 v169, v169, v210
    v_mul_f32 v170, v170, v210
    v_mul_f32 v171, v171, v210
    v_mul_f32 v172, v172, v210
    v_mul_f32 v173, v173, v210
    v_mul_f32 v174, v174, v210
    v_mul_f32 v175, v175, v210
    v_mul_f32 v176, v176, v210
    v_mul_f32 v177, v177, v210
    v_mul_f32 v178, v178, v210
    v_mul_f32 v179, v179, v210
    s_mul_i32 s25, s40, 81920
    s_mul_i32 s26, s41, 2560
    s_add_u32 s25, s25, s26
    s_add_u32 s25, s25, 214958080
    v_cvt_pk_bf16_f32 v16, v160, v161
    v_cvt_pk_bf16_f32 v17, v162, v163
    v_cvt_pk_bf16_f32 v18, v164, v165
    v_cvt_pk_bf16_f32 v19, v166, v167
    s_nop 1
    v_permlane32_swap_b32 v16, v18
    v_permlane32_swap_b32 v17, v19
    buffer_store_dwordx4 v[16:19], v1, s[8:11], s25 offen offset:512 sc1
    v_cvt_pk_bf16_f32 v20, v168, v169
    v_cvt_pk_bf16_f32 v21, v170, v171
    v_cvt_pk_bf16_f32 v22, v172, v173
    v_cvt_pk_bf16_f32 v23, v174, v175
    s_nop 1
    v_permlane32_swap_b32 v20, v22
    v_permlane32_swap_b32 v21, v23
    buffer_store_dwordx4 v[20:23], v1, s[8:11], s25 offen offset:1536 sc1
    v_cvt_pk_bf16_f32 v24, v176, v177
    v_cvt_pk_bf16_f32 v25, v178, v179
    v_lshlrev_b32 v4, 4, v2
    v_lshl_add_u32 v4, v3, 3, v4
    buffer_store_dwordx2 v[24:25], v4, s[8:11], s25 offen sc1
    s_waitcnt vmcnt(0)
    s_barrier
    s_cmp_lg_u32 s13, 0
    s_cbranch_scc1 layerb1_kernel_j_next
    s_mov_b64 exec, 1
    s_lshl_b32 s24, s40, 4
    s_add_u32 s24, s24, 30720
    v_mov_b32 v2, s24
    v_mov_b32 v3, 1
    buffer_atomic_add v3, v2, s[8:11], s48 offen sc1
    s_mov_b64 exec, -1
    s_branch layerb1_kernel_j_next
layerb1_kernel_j_b:
    s_sub_u32 s41, s41, 8
    v_lshlrev_b32 v1, 4, v0
    v_and_b32 v2, 31, v0
    v_lshrrev_b32 v3, 5, v0
    v_lshrrev_b32 v4, 3, v2
    v_mul_u32_u24 v4, 20480, v4
    v_and_b32 v5, 7, v2
    v_lshl_add_u32 v4, v5, 4, v4
    v_lshl_add_u32 v4, v3, 7, v4
    s_mul_i32 s24, s40, 1638400
    s_mul_i32 s25, s41, 163840
    s_add_u32 s24, s24, s25
    s_mul_i32 s25, s13, 5120
    s_add_u32 s24, s24, s25
    s_add_u32 s24, s24, 103809024
    s_add_u32 s28, s24, 81920
    s_mul_i32 s25, s40, 81920
    s_mul_i32 s26, s13, 20480
    s_add_u32 s25, s25, s26
    s_add_u32 s25, s25, 214958080
    v_mul_u32_u24 v6, 1280, v2
    v_lshl_add_u32 v6, v3, 4, v6
    s_mul_i32 s26, s40, 40960
    s_lshl_b32 s27, s41, 7
    s_add_u32 s26, s26, s27
    s_lshl_b32 s27, s13, 5
    s_add_u32 s26, s26, s27
    s_add_u32 s27, s26, 226492416
    buffer_load_dwordx4 v[8:11], v6, s[8:11], s27 offen
    buffer_load_dwordx4 a[160:163], v1, s[8:11], s25 offen offset:0 sc1
    buffer_load_dwordx4 a[0:3], v4, s[8:11], s24 offen offset:0 sc1
    buffer_load_dwordx4 a[80:83], v4, s[8:11], s28 offen offset:0 sc1
    buffer_load_dwordx4 a[164:167], v1, s[8:11], s25 offen offset:1024 sc1
    buffer_load_dwordx4 a[4:7], v4, s[8:11], s24 offen offset:256 sc1
    buffer_load_dwordx4 a[84:87], v4, s[8:11], s28 offen offset:256 sc1
    buffer_load_dwordx4 a[168:171], v1, s[8:11], s25 offen offset:2048 sc1
    buffer_load_dwordx4 a[8:11], v4, s[8:11], s24 offen offset:512 sc1
    buffer_load_dwordx4 a[88:91], v4, s[8:11], s28 offen offset:512 sc1
    buffer_load_dwordx4 a[172:175], v1, s[8:11], s25 offen offset:3072 sc1
    buffer_load_dwordx4 a[12:15], v4, s[8:11], s24 offen offset:768 sc1
    buffer_load_dwordx4 a[92:95], v4, s[8:11], s28 offen offset:768 sc1
    s_add_u32 s25, s25, 4096
    buffer_load_dwordx4 a[176:179], v1, s[8:11], s25 offen offset:0 sc1
    buffer_load_dwordx4 a[16:19], v4, s[8:11], s24 offen offset:1024 sc1
    buffer_load_dwordx4 a[96:99], v4, s[8:11], s28 offen offset:1024 sc1
    buffer_load_dwordx4 a[180:183], v1, s[8:11], s25 offen offset:1024 sc1
    buffer_load_dwordx4 a[20:23], v4, s[8:11], s24 offen offset:1280 sc1
    buffer_load_dwordx4 a[100:103], v4, s[8:11], s28 offen offset:1280 sc1
    buffer_load_dwordx4 a[184:187], v1, s[8:11], s25 offen offset:2048 sc1
    buffer_load_dwordx4 a[24:27], v4, s[8:11], s24 offen offset:1536 sc1
    buffer_load_dwordx4 a[104:107], v4, s[8:11], s28 offen offset:1536 sc1
    buffer_load_dwordx4 a[188:191], v1, s[8:11], s25 offen offset:3072 sc1
    buffer_load_dwordx4 a[28:31], v4, s[8:11], s24 offen offset:1792 sc1
    buffer_load_dwordx4 a[108:111], v4, s[8:11], s28 offen offset:1792 sc1
    s_add_u32 s25, s25, 4096
    buffer_load_dwordx4 a[192:195], v1, s[8:11], s25 offen offset:0 sc1
    buffer_load_dwordx4 a[32:35], v4, s[8:11], s24 offen offset:2048 sc1
    buffer_load_dwordx4 a[112:115], v4, s[8:11], s28 offen offset:2048 sc1
    buffer_load_dwordx4 a[196:199], v1, s[8:11], s25 offen offset:1024 sc1
    buffer_load_dwordx4 a[36:39], v4, s[8:11], s24 offen offset:2304 sc1
    buffer_load_dwordx4 a[116:119], v4, s[8:11], s28 offen offset:2304 sc1
    buffer_load_dwordx4 a[200:203], v1, s[8:11], s25 offen offset:2048 sc1
    buffer_load_dwordx4 a[40:43], v4, s[8:11], s24 offen offset:2560 sc1
    buffer_load_dwordx4 a[120:123], v4, s[8:11], s28 offen offset:2560 sc1
    buffer_load_dwordx4 a[204:207], v1, s[8:11], s25 offen offset:3072 sc1
    buffer_load_dwordx4 a[44:47], v4, s[8:11], s24 offen offset:2816 sc1
    buffer_load_dwordx4 a[124:127], v4, s[8:11], s28 offen offset:2816 sc1
    s_add_u32 s25, s25, 4096
    buffer_load_dwordx4 a[208:211], v1, s[8:11], s25 offen offset:0 sc1
    buffer_load_dwordx4 a[48:51], v4, s[8:11], s24 offen offset:3072 sc1
    buffer_load_dwordx4 a[128:131], v4, s[8:11], s28 offen offset:3072 sc1
    buffer_load_dwordx4 a[212:215], v1, s[8:11], s25 offen offset:1024 sc1
    buffer_load_dwordx4 a[52:55], v4, s[8:11], s24 offen offset:3328 sc1
    buffer_load_dwordx4 a[132:135], v4, s[8:11], s28 offen offset:3328 sc1
    buffer_load_dwordx4 a[216:219], v1, s[8:11], s25 offen offset:2048 sc1
    buffer_load_dwordx4 a[56:59], v4, s[8:11], s24 offen offset:3584 sc1
    buffer_load_dwordx4 a[136:139], v4, s[8:11], s28 offen offset:3584 sc1
    buffer_load_dwordx4 a[220:223], v1, s[8:11], s25 offen offset:3072 sc1
    buffer_load_dwordx4 a[60:63], v4, s[8:11], s24 offen offset:3840 sc1
    buffer_load_dwordx4 a[140:143], v4, s[8:11], s28 offen offset:3840 sc1
    s_add_u32 s25, s25, 4096
    s_add_u32 s24, s24, 4096
    s_add_u32 s28, s28, 4096
    buffer_load_dwordx4 a[224:227], v1, s[8:11], s25 offen offset:0 sc1
    buffer_load_dwordx4 a[64:67], v4, s[8:11], s24 offen offset:0 sc1
    buffer_load_dwordx4 a[144:147], v4, s[8:11], s28 offen offset:0 sc1
    buffer_load_dwordx4 a[228:231], v1, s[8:11], s25 offen offset:1024 sc1
    buffer_load_dwordx4 a[68:71], v4, s[8:11], s24 offen offset:256 sc1
    buffer_load_dwordx4 a[148:151], v4, s[8:11], s28 offen offset:256 sc1
    buffer_load_dwordx4 a[232:235], v1, s[8:11], s25 offen offset:2048 sc1
    buffer_load_dwordx4 a[72:75], v4, s[8:11], s24 offen offset:512 sc1
    buffer_load_dwordx4 a[152:155], v4, s[8:11], s28 offen offset:512 sc1
    buffer_load_dwordx4 a[236:239], v1, s[8:11], s25 offen offset:3072 sc1
    buffer_load_dwordx4 a[76:79], v4, s[8:11], s24 offen offset:768 sc1
    buffer_load_dwordx4 a[156:159], v4, s[8:11], s28 offen offset:768 sc1
    s_waitcnt vmcnt(57)
    v_mfma_f32_32x32x16_bf16 v[16:31], a[0:3], a[160:163], 0
    v_mfma_f32_32x32x16_bf16 v[32:47], a[80:83], a[160:163], 0
    s_waitcnt vmcnt(54)
    v_mfma_f32_32x32x16_bf16 v[16:31], a[4:7], a[164:167], v[16:31]
    v_mfma_f32_32x32x16_bf16 v[32:47], a[84:87], a[164:167], v[32:47]
    s_waitcnt vmcnt(51)
    v_mfma_f32_32x32x16_bf16 v[16:31], a[8:11], a[168:171], v[16:31]
    v_mfma_f32_32x32x16_bf16 v[32:47], a[88:91], a[168:171], v[32:47]
    s_waitcnt vmcnt(48)
    v_mfma_f32_32x32x16_bf16 v[16:31], a[12:15], a[172:175], v[16:31]
    v_mfma_f32_32x32x16_bf16 v[32:47], a[92:95], a[172:175], v[32:47]
    s_waitcnt vmcnt(45)
    v_mfma_f32_32x32x16_bf16 v[16:31], a[16:19], a[176:179], v[16:31]
    v_mfma_f32_32x32x16_bf16 v[32:47], a[96:99], a[176:179], v[32:47]
    s_waitcnt vmcnt(42)
    v_mfma_f32_32x32x16_bf16 v[16:31], a[20:23], a[180:183], v[16:31]
    v_mfma_f32_32x32x16_bf16 v[32:47], a[100:103], a[180:183], v[32:47]
    s_waitcnt vmcnt(39)
    v_mfma_f32_32x32x16_bf16 v[16:31], a[24:27], a[184:187], v[16:31]
    v_mfma_f32_32x32x16_bf16 v[32:47], a[104:107], a[184:187], v[32:47]
    s_waitcnt vmcnt(36)
    v_mfma_f32_32x32x16_bf16 v[16:31], a[28:31], a[188:191], v[16:31]
    v_mfma_f32_32x32x16_bf16 v[32:47], a[108:111], a[188:191], v[32:47]
    s_waitcnt vmcnt(33)
    v_mfma_f32_32x32x16_bf16 v[16:31], a[32:35], a[192:195], v[16:31]
    v_mfma_f32_32x32x16_bf16 v[32:47], a[112:115], a[192:195], v[32:47]
    s_waitcnt vmcnt(30)
    v_mfma_f32_32x32x16_bf16 v[16:31], a[36:39], a[196:199], v[16:31]
    v_mfma_f32_32x32x16_bf16 v[32:47], a[116:119], a[196:199], v[32:47]
    s_waitcnt vmcnt(27)
    v_mfma_f32_32x32x16_bf16 v[16:31], a[40:43], a[200:203], v[16:31]
    v_mfma_f32_32x32x16_bf16 v[32:47], a[120:123], a[200:203], v[32:47]
    s_waitcnt vmcnt(24)
    v_mfma_f32_32x32x16_bf16 v[16:31], a[44:47], a[204:207], v[16:31]
    v_mfma_f32_32x32x16_bf16 v[32:47], a[124:127], a[204:207], v[32:47]
    s_waitcnt vmcnt(21)
    v_mfma_f32_32x32x16_bf16 v[16:31], a[48:51], a[208:211], v[16:31]
    v_mfma_f32_32x32x16_bf16 v[32:47], a[128:131], a[208:211], v[32:47]
    s_waitcnt vmcnt(18)
    v_mfma_f32_32x32x16_bf16 v[16:31], a[52:55], a[212:215], v[16:31]
    v_mfma_f32_32x32x16_bf16 v[32:47], a[132:135], a[212:215], v[32:47]
    s_waitcnt vmcnt(15)
    v_mfma_f32_32x32x16_bf16 v[16:31], a[56:59], a[216:219], v[16:31]
    v_mfma_f32_32x32x16_bf16 v[32:47], a[136:139], a[216:219], v[32:47]
    s_waitcnt vmcnt(12)
    v_mfma_f32_32x32x16_bf16 v[16:31], a[60:63], a[220:223], v[16:31]
    v_mfma_f32_32x32x16_bf16 v[32:47], a[140:143], a[220:223], v[32:47]
    s_waitcnt vmcnt(9)
    v_mfma_f32_32x32x16_bf16 v[16:31], a[64:67], a[224:227], v[16:31]
    v_mfma_f32_32x32x16_bf16 v[32:47], a[144:147], a[224:227], v[32:47]
    s_waitcnt vmcnt(6)
    v_mfma_f32_32x32x16_bf16 v[16:31], a[68:71], a[228:231], v[16:31]
    v_mfma_f32_32x32x16_bf16 v[32:47], a[148:151], a[228:231], v[32:47]
    s_waitcnt vmcnt(3)
    v_mfma_f32_32x32x16_bf16 v[16:31], a[72:75], a[232:235], v[16:31]
    v_mfma_f32_32x32x16_bf16 v[32:47], a[152:155], a[232:235], v[32:47]
    s_waitcnt vmcnt(0)
    v_mfma_f32_32x32x16_bf16 v[16:31], a[76:79], a[236:239], v[16:31]
    v_mfma_f32_32x32x16_bf16 v[32:47], a[156:159], a[236:239], v[32:47]
    s_lshl_b32 s27, s13, 11
    v_add_u32 v7, s27, v1
    s_nop 7
    s_nop 7
    ds_write_b128 v7, v[16:19] offset:0
    ds_write_b128 v7, v[20:23] offset:1024
    ds_write_b128 v7, v[24:27] offset:8192
    ds_write_b128 v7, v[28:31] offset:9216
    ds_write_b128 v7, v[32:35] offset:16384
    ds_write_b128 v7, v[36:39] offset:17408
    ds_write_b128 v7, v[40:43] offset:24576
    ds_write_b128 v7, v[44:47] offset:25600
    s_waitcnt lgkmcnt(0)
    s_barrier
    s_lshl_b32 s27, s13, 13
    v_add_u32 v7, s27, v1
    ds_read_b128 v[48:51], v7 offset:0
    ds_read_b128 v[52:55], v7 offset:1024
    ds_read_b128 v[56:59], v7 offset:2048
    ds_read_b128 v[60:63], v7 offset:3072
    ds_read_b128 v[64:67], v7 offset:4096
    ds_read_b128 v[68:71], v7 offset:5120
    ds_read_b128 v[72:75], v7 offset:6144
    ds_read_b128 v[76:79], v7 offset:7168
    s_waitcnt lgkmcnt(4)
    v_add_f32 v48, v48, v56
    v_add_f32 v49, v49, v57
    v_add_f32 v50, v50, v58
    v_add_f32 v51, v51, v59
    v_add_f32 v52, v52, v60
    v_add_f32 v53, v53, v61
    v_add_f32 v54, v54, v62
    v_add_f32 v55, v55, v63
    s_waitcnt lgkmcnt(0)
    v_add_f32 v64, v64, v72
    v_add_f32 v65, v65, v73
    v_add_f32 v66, v66, v74
    v_add_f32 v67, v67, v75
    v_add_f32 v68, v68, v76
    v_add_f32 v69, v69, v77
    v_add_f32 v70, v70, v78
    v_add_f32 v71, v71, v79
    v_add_f32 v48, v48, v64
    v_add_f32 v49, v49, v65
    v_add_f32 v50, v50, v66
    v_add_f32 v51, v51, v67
    v_add_f32 v52, v52, v68
    v_add_f32 v53, v53, v69
    v_add_f32 v54, v54, v70
    v_add_f32 v55, v55, v71
    v_cvt_pk_bf16_f32 v16, v48, v49
    v_cvt_pk_bf16_f32 v17, v50, v51
    v_cvt_pk_bf16_f32 v18, v52, v53
    v_cvt_pk_bf16_f32 v19, v54, v55
    s_nop 1
    v_permlane32_swap_b32 v16, v18
    v_permlane32_swap_b32 v17, v19
    s_nop 1
    v_lshlrev_b32 v48, 16, v16
    v_and_b32 v49, 0xffff0000, v16
    v_lshlrev_b32 v50, 16, v8
    v_and_b32 v51, 0xffff0000, v8
    v_add_f32 v48, v48, v50
    v_add_f32 v49, v49, v51
    v_cvt_pk_bf16_f32 v16, v48, v49
    v_lshlrev_b32 v48, 16, v17
    v_and_b32 v49, 0xffff0000, v17
    v_lshlrev_b32 v50, 16, v9
    v_and_b32 v51, 0xffff0000, v9
    v_add_f32 v48, v48, v50
    v_add_f32 v49, v49, v51
    v_cvt_pk_bf16_f32 v17, v48, v49
    v_lshlrev_b32 v48, 16, v18
    v_and_b32 v49, 0xffff0000, v18
    v_lshlrev_b32 v50, 16, v10
    v_and_b32 v51, 0xffff0000, v10
    v_add_f32 v48, v48, v50
    v_add_f32 v49, v49, v51
    v_cvt_pk_bf16_f32 v18, v48, v49
    v_lshlrev_b32 v48, 16, v19
    v_and_b32 v49, 0xffff0000, v19
    v_lshlrev_b32 v50, 16, v11
    v_and_b32 v51, 0xffff0000, v11
    v_add_f32 v48, v48, v50
    v_add_f32 v49, v49, v51
    v_cvt_pk_bf16_f32 v19, v48, v49
    buffer_store_dwordx4 v[16:19], v6, s[84:87], s26 offen
    s_branch layerb1_kernel_j_next
layerb1_kernel_j_giveup:
    s_mov_b64 exec, -1
    v_mov_b32 v2, 0
    v_mov_b32 v3, -1
    ds_write_b32 v2, v3 offset:32768
    s_waitcnt lgkmcnt(0)
    s_barrier
    s_branch layerb1_kernel_bail
layerb1_kernel_j_done:
    s_branch layerb1_kernel_end
layerb1_kernel_bail:
    s_mov_b64 exec, 1
    s_load_dwordx2 s[6:7], s[0:1], 88
    s_waitcnt lgkmcnt(0)
    s_mov_b32 s24, s6
    s_mov_b32 s25, s7
    s_mov_b32 s26, 256
    s_mov_b32 s27, 0x00020000
    v_mov_b32 v1, 0xdead
    v_mov_b32 v2, s14
    v_mov_b32 v3, 0
    buffer_store_dword v1, v3, s[24:27], 0 offen
    buffer_store_dword v2, v3, s[24:27], 0 offen offset:4
layerb1_kernel_end:
layerb1_kernel_end0:
    s_endpgm
.section .rodata,"a"
.p2align 6
.amdhsa_kernel layerb1_kernel
  .amdhsa_next_free_vgpr 512
  .amdhsa_next_free_sgpr 100
  .amdhsa_accum_offset 256
  .amdhsa_group_segment_fixed_size 0
  .amdhsa_kernarg_size 104
  .amdhsa_user_sgpr_count 2
  .amdhsa_user_sgpr_kernarg_segment_ptr 1
  .amdhsa_system_sgpr_workgroup_id_x 1
.end_amdhsa_kernel
.text
.globl ln_a2_kernel
.p2align 8
.type ln_a2_kernel,@function
ln_a2_kernel:
    v_lshrrev_b32 v1, 6, v0
    v_and_b32 v2, 63, v0
    s_nop 0
    v_readfirstlane_b32 s3, v1
    s_lshl_b32 s4, s2, 2
    s_add_u32 s4, s4, s3
    s_cmp_ge_u32 s4, 2048
    s_cbranch_scc1 ln_a2_kernel_end
    s_load_dwordx2 s[6:7], s[0:1], 96
    s_load_dwordx2 s[12:13], s[0:1], 96
    s_waitcnt lgkmcnt(0)
    s_add_u32 s8, s6, 247463936
    s_addc_u32 s9, s7, 0
    s_mov_b32 s10, 2621440
    s_mov_b32 s11, 0x00020000
    s_add_u32 s16, s12, 223346688
    s_addc_u32 s17, s13, 0
    s_mov_b32 s18, 2621440
    s_mov_b32 s19, 0x00020000
    s_mul_i32 s5, s4, 1280
    v_lshlrev_b32 v3, 2, v2
    v_add_u32 v3, s5, v3
    buffer_load_dword v4, v3, s[8:11], 0 offen offset:0
    buffer_load_dword v5, v3, s[8:11], 0 offen offset:256
    buffer_load_dword v6, v3, s[8:11], 0 offen offset:512
    buffer_load_dword v7, v3, s[8:11], 0 offen offset:768
    buffer_load_dword v8, v3, s[8:11], 0 offen offset:1024
    s_waitcnt vmcnt(0)
    v_lshlrev_b32 v10, 16, v4
    v_and_b32 v11, 0xffff0000, v4
    v_lshlrev_b32 v12, 16, v5
    v_and_b32 v13, 0xffff0000, v5
    v_lshlrev_b32 v14, 16, v6
    v_and_b32 v15, 0xffff0000, v6
    v_lshlrev_b32 v16, 16, v7
    v_and_b32 v17, 0xffff0000, v7
    v_lshlrev_b32 v18, 16, v8
    v_and_b32 v19, 0xffff0000, v8
    v_add_f32 v20, v10, v11
    v_add_f32 v20, v20, v12
    v_add_f32 v20, v20, v13
    v_add_f32 v20, v20, v14
    v_add_f32 v20, v20, v15
    v_add_f32 v20, v20, v16
    v_add_f32 v20, v20, v17
    v_add_f32 v20, v20, v18
    v_add_f32 v20, v20, v19
    s_nop 1
    v_add_f32 v21, v20, v20 quad_perm:[1,0,3,2] row_mask:0xf bank_mask:0xf
    s_nop 1
    v_add_f32 v21, v21, v21 quad_perm:[2,3,0,1] row_mask:0xf bank_mask:0xf
    s_nop 1
    v_add_f32 v21, v21, v21 row_half_mirror row_mask:0xf bank_mask:0xf
    s_nop 1
    v_add_f32 v21, v21, v21 row_mirror row_mask:0xf bank_mask:0xf
    s_nop 1
    v_readlane_b32 s24, v21, 0
    v_readlane_b32 s25, v21, 16
    v_readlane_b32 s26, v21, 32
    v_readlane_b32 s27, v21, 48
    s_nop 1
    v_mov_b32 v20, s24
    v_add_f32 v20, s25, v20
    v_add_f32 v20, s26, v20
    v_add_f32 v20, s27, v20
    v_mul_f32 v20, 0.0015625, v20
    v_sub_f32 v10, v10, v20
    v_sub_f32 v11, v11, v20
    v_sub_f32 v12, v12, v20
    v_sub_f32 v13, v13, v20
    v_sub_f32 v14, v14, v20
    v_sub_f32 v15, v15, v20
    v_sub_f32 v16, v16, v20
    v_sub_f32 v17, v17, v20
    v_sub_f32 v18, v18, v20
    v_sub_f32 v19, v19, v20
    v_mul_f32 v21, v10, v10
    v_fmac_f32 v21, v11, v11
    v_fmac_f32 v21, v12, v12
    v_fmac_f32 v21, v13, v13
    v_fmac_f32 v21, v14, v14
    v_fmac_f32 v21, v15, v15
    v_fmac_f32 v21, v16, v16
    v_fmac_f32 v21, v17, v17
    v_fmac_f32 v21, v18, v18
    v_fmac_f32 v21, v19, v19
    s_nop 1
    v_add_f32 v22, v21, v21 quad_perm:[1,0,3,2] row_mask:0xf bank_mask:0xf
    s_nop 1
    v_add_f32 v22, v22, v22 quad_perm:[2,3,0,1] row_mask:0xf bank_mask:0xf
    s_nop 1
    v_add_f32 v22, v22, v22 row_half_mirror row_mask:0xf bank_mask:0xf
    s_nop 1
    v_add_f32 v22, v22, v22 row_mirror row_mask:0xf bank_mask:0xf
    s_nop 1
    v_readlane_b32 s24, v22, 0
    v_readlane_b32 s25, v22, 16
    v_readlane_b32 s26, v22, 32
    v_readlane_b32 s27, v22, 48
    s_nop 1
    v_mov_b32 v21, s24
    v_add_f32 v21, s25, v21
    v_add_f32 v21, s26, v21
    v_add_f32 v21, s27, v21
    v_mov_b32 v22, 0x3727c5ac
    v_fmac_f32 v22, 0.0015625, v21
    v_rsq_f32 v22, v22
    s_nop 0
    v_mul_f32 v10, v10, v22
    v_mul_f32 v11, v11, v22
    v_mul_f32 v12, v12, v22
    v_mul_f32 v13, v13, v22
    v_mul_f32 v14, v14, v22
    v_mul_f32 v15, v15, v22
    v_mul_f32 v16, v16, v22
    v_mul_f32 v17, v17, v22
    v_mul_f32 v18, v18, v22
    v_mul_f32 v19, v19, v22
    v_cvt_pk_bf16_f32 v4, v10, v11
    v_cvt_pk_bf16_f32 v5, v12, v13
    v_cvt_pk_bf16_f32 v6, v14, v15
    v_cvt_pk_bf16_f32 v7, v16, v17
    v_cvt_pk_bf16_f32 v8, v18, v19
    buffer_store_dword v4, v3, s[16:19], 0 offen offset:0
    buffer_store_dword v5, v3, s[16:19], 0 offen offset:256
    buffer_store_dword v6, v3, s[16:19], 0 offen offset:512
    buffer_store_dword v7, v3, s[16:19], 0 offen offset:768
    buffer_store_dword v8, v3, s[16:19], 0 offen offset:1024
ln_a2_kernel_end:
    s_endpgm
.section .rodata,"a"
.p2align 6
.amdhsa_kernel ln_a2_kernel
  .amdhsa_next_free_vgpr 32
  .amdhsa_next_free_sgpr 40
  .amdhsa_accum_offset 32
  .amdhsa_group_segment_fixed_size 0
  .amdhsa_kernarg_size 104
  .amdhsa_user_sgpr_count 2
  .amdhsa_user_sgpr_kernarg_segment_ptr 1
  .amdhsa_system_sgpr_workgroup_id_x 1
.end_amdhsa_kernel
.text
.globl kvz_a2_kernel
.p2align 8
.type kvz_a2_kernel,@function
kvz_a2_kernel:
    v_lshrrev_b32 v1, 6, v0
    v_and_b32 v2, 63, v0
    s_nop 0
    v_readfirstlane_b32 s3, v1
    s_lshl_b32 s4, s2, 2
    s_add_u32 s4, s4, s3
    s_cmp_ge_u32 s4, 512
    s_cbranch_scc1 kvz_a2_kernel_end
    s_load_dwordx2 s[6:7], s[0:1], 96
    s_waitcnt lgkmcnt(0)
    s_mov_b32 s8, s6
    s_mov_b32 s9, s7
    s_mov_b32 s10, 268435456
    s_mov_b32 s11, 0x00020000
    s_lshr_b32 s5, s4, 4
    s_and_b32 s12, s4, 15
    s_mul_i32 s13, s5, 20
    v_and_b32 v3, 15, v2
    v_lshrrev_b32 v4, 4, v2
    s_lshl_b32 s14, s12, 7
    v_lshlrev_b32 v5, 3, v4
    v_add_u32 v5, s14, v5
    v_add_u32 v6, 0, v3
    v_min_u32 v8, 19, v6
    v_add_u32 v8, s13, v8
    v_lshlrev_b32 v8, 11, v8
    v_add_u32 v8, v8, v5
    v_lshlrev_b32 v8, 1, v8
    v_add_u32 v8, 232783872, v8
    v_add_u32 v10, 2621440, v8
    v_add_u32 v7, 16, v3
    v_min_u32 v9, 19, v7
    v_add_u32 v9, s13, v9
    v_lshlrev_b32 v9, 11, v9
    v_add_u32 v9, v9, v5
    v_lshlrev_b32 v9, 1, v9
    v_add_u32 v9, 232783872, v9
    v_add_u32 v11, 2621440, v9
    v_accvgpr_write_b32 a0, 0
    v_accvgpr_write_b32 a1, 0
    v_accvgpr_write_b32 a2, 0
    v_accvgpr_write_b32 a3, 0
    v_accvgpr_write_b32 a4, 0
    v_accvgpr_write_b32 a5, 0
    v_accvgpr_write_b32 a6, 0
    v_accvgpr_write_b32 a7, 0
    v_accvgpr_write_b32 a8, 0
    v_accvgpr_write_b32 a9, 0
    v_accvgpr_write_b32 a10, 0
    v_accvgpr_write_b32 a11, 0
    v_accvgpr_write_b32 a12, 0
    v_accvgpr_write_b32 a13, 0
    v_accvgpr_write_b32 a14, 0
    v_accvgpr_write_b32 a15, 0
    v_cmp_gt_u32 s[16:17], 20, v7
    v_cmp_eq_u32 s[18:19], 20, v7
    buffer_load_dwordx4 v[16:19], v8, s[8:11], 0 offen offset:0
    buffer_load_dwordx4 v[24:27], v10, s[8:11], 0 offen offset:0
    buffer_load_dwordx4 v[20:23], v9, s[8:11], 0 offen offset:0
    buffer_load_dwordx4 v[28:31], v11, s[8:11], 0 offen offset:0
    s_waitcnt vmcnt(0)
    v_lshlrev_b32 v32, 16, v16
    v_and_b32 v33, 0xffff0000, v16
    v_mul_f32 v36, 1.4426950408889634, v32
    v_exp_f32 v36, v36
    v_add_f32 v34, 1.0, v32
    v_cmp_lt_f32 vcc, 0, v32
    s_nop 1
    v_cndmask_b32 v34, v36, v34, vcc
    v_add_f32 v34, 0x358637bd, v34
    v_mul_f32 v36, 1.4426950408889634, v33
    v_exp_f32 v36, v36
    v_add_f32 v35, 1.0, v33
    v_cmp_lt_f32 vcc, 0, v33
    s_nop 1
    v_cndmask_b32 v35, v36, v35, vcc
    v_add_f32 v35, 0x358637bd, v35
    v_cvt_pk_bf16_f32 v16, v34, v35
    v_lshlrev_b32 v32, 16, v17
    v_and_b32 v33, 0xffff0000, v17
    v_mul_f32 v36, 1.4426950408889634, v32
    v_exp_f32 v36, v36
    v_add_f32 v34, 1.0, v32
    v_cmp_lt_f32 vcc, 0, v32
    s_nop 1
    v_cndmask_b32 v34, v36, v34, vcc
    v_add_f32 v34, 0x358637bd, v34
    v_mul_f32 v36, 1.4426950408889634, v33
    v_exp_f32 v36, v36
    v_add_f32 v35, 1.0, v33
    v_cmp_lt_f32 vcc, 0, v33
    s_nop 1
    v_cndmask_b32 v35, v36, v35, vcc
    v_add_f32 v35, 0x358637bd, v35
    v_cvt_pk_bf16_f32 v17, v34, v35
    v_lshlrev_b32 v32, 16, v18
    v_and_b32 v33, 0xffff0000, v18
    v_mul_f32 v36, 1.4426950408889634, v32
    v_exp_f32 v36, v36
    v_add_f32 v34, 1.0, v32
    v_cmp_lt_f32 vcc, 0, v32
    s_nop 1
    v_cndmask_b32 v34, v36, v34, vcc
    v_add_f32 v34, 0x358637bd, v34
    v_mul_f32 v36, 1.4426950408889634, v33
    v_exp_f32 v36, v36
    v_add_f32 v35, 1.0, v33
    v_cmp_lt_f32 vcc, 0, v33
    s_nop 1
    v_cndmask_b32 v35, v36, v35, vcc
    v_add_f32 v35, 0x358637bd, v35
    v_cvt_pk_bf16_f32 v18, v34, v35
    v_lshlrev_b32 v32, 16, v19
    v_and_b32 v33, 0xffff0000, v19
    v_mul_f32 v36, 1.4426950408889634, v32
    v_exp_f32 v36, v36
    v_add_f32 v34, 1.0, v32
    v_cmp_lt_f32 vcc, 0, v32
    s_nop 1
    v_cndmask_b32 v34, v36, v34, vcc
    v_add_f32 v34, 0x358637bd, v34
    v_mul_f32 v36, 1.4426950408889634, v33
    v_exp_f32 v36, v36
    v_add_f32 v35, 1.0, v33
    v_cmp_lt_f32 vcc, 0, v33
    s_nop 1
    v_cndmask_b32 v35, v36, v35, vcc
    v_add_f32 v35, 0x358637bd, v35
    v_cvt_pk_bf16_f32 v19, v34, v35
    v_lshlrev_b32 v32, 16, v20
    v_and_b32 v33, 0xffff0000, v20
    v_mul_f32 v36, 1.4426950408889634, v32
    v_exp_f32 v36, v36
    v_add_f32 v34, 1.0, v32
    v_cmp_lt_f32 vcc, 0, v32
    s_nop 1
    v_cndmask_b32 v34, v36, v34, vcc
    v_add_f32 v34, 0x358637bd, v34
    v_mul_f32 v36, 1.4426950408889634, v33
    v_exp_f32 v36, v36
    v_add_f32 v35, 1.0, v33
    v_cmp_lt_f32 vcc, 0, v33
    s_nop 1
    v_cndmask_b32 v35, v36, v35, vcc
    v_add_f32 v35, 0x358637bd, v35
    v_cvt_pk_bf16_f32 v20, v34, v35
    v_lshlrev_b32 v32, 16, v21
    v_and_b32 v33, 0xffff0000, v21
    v_mul_f32 v36, 1.4426950408889634, v32
    v_exp_f32 v36, v36
    v_add_f32 v34, 1.0, v32
    v_cmp_lt_f32 vcc, 0, v32
    s_nop 1
    v_cndmask_b32 v34, v36, v34, vcc
    v_add_f32 v34, 0x358637bd, v34
    v_mul_f32 v36, 1.4426950408889634, v33
    v_exp_f32 v36, v36
    v_add_f32 v35, 1.0, v33
    v_cmp_lt_f32 vcc, 0, v33
    s_nop 1
    v_cndmask_b32 v35, v36, v35, vcc
    v_add_f32 v35, 0x358637bd, v35
    v_cvt_pk_bf16_f32 v21, v34, v35
    v_lshlrev_b32 v32, 16, v22
    v_and_b32 v33, 0xffff0000, v22
    v_mul_f32 v36, 1.4426950408889634, v32
    v_exp_f32 v36, v36
    v_add_f32 v34, 1.0, v32
    v_cmp_lt_f32 vcc, 0, v32
    s_nop 1
    v_cndmask_b32 v34, v36, v34, vcc
    v_add_f32 v34, 0x358637bd, v34
    v_mul_f32 v36, 1.4426950408889634, v33
    v_exp_f32 v36, v36
    v_add_f32 v35, 1.0, v33
    v_cmp_lt_f32 vcc, 0, v33
    s_nop 1
    v_cndmask_b32 v35, v36, v35, vcc
    v_add_f32 v35, 0x358637bd, v35
    v_cvt_pk_bf16_f32 v22, v34, v35
    v_lshlrev_b32 v32, 16, v23
    v_and_b32 v33, 0xffff0000, v23
    v_mul_f32 v36, 1.4426950408889634, v32
    v_exp_f32 v36, v36
    v_add_f32 v34, 1.0, v32
    v_cmp_lt_f32 vcc, 0, v32
    s_nop 1
    v_cndmask_b32 v34, v36, v34, vcc
    v_add_f32 v34, 0x358637bd, v34
    v_mul_f32 v36, 1.4426950408889634, v33
    v_exp_f32 v36, v36
    v_add_f32 v35, 1.0, v33
    v_cmp_lt_f32 vcc, 0, v33
    s_nop 1
    v_cndmask_b32 v35, v36, v35, vcc
    v_add_f32 v35, 0x358637bd, v35
    v_cvt_pk_bf16_f32 v23, v34, v35
    v_mov_b32 v37, 0x3f803f80
    v_cndmask_b32 v20, 0, v20, s[16:17]
    v_cndmask_b32 v28, 0, v28, s[16:17]
    v_cndmask_b32 v28, v28, v37, s[18:19]
    v_cndmask_b32 v21, 0, v21, s[16:17]
    v_cndmask_b32 v29, 0, v29, s[16:17]
    v_cndmask_b32 v29, v29, v37, s[18:19]
    v_cndmask_b32 v22, 0, v22, s[16:17]
    v_cndmask_b32 v30, 0, v30, s[16:17]
    v_cndmask_b32 v30, v30, v37, s[18:19]
    v_cndmask_b32 v23, 0, v23, s[16:17]
    v_cndmask_b32 v31, 0, v31, s[16:17]
    v_cndmask_b32 v31, v31, v37, s[18:19]
    s_nop 1
    v_mfma_f32_16x16x32_bf16 a[0:3], v[24:27], v[16:19], a[0:3]
    v_mfma_f32_16x16x32_bf16 a[4:7], v[24:27], v[20:23], a[4:7]
    v_mfma_f32_16x16x32_bf16 a[8:11], v[28:31], v[16:19], a[8:11]
    v_mfma_f32_16x16x32_bf16 a[12:15], v[28:31], v[20:23], a[12:15]
    buffer_load_dwordx4 v[16:19], v8, s[8:11], 0 offen offset:64
    buffer_load_dwordx4 v[24:27], v10, s[8:11], 0 offen offset:64
    buffer_load_dwordx4 v[20:23], v9, s[8:11], 0 offen offset:64
    buffer_load_dwordx4 v[28:31], v11, s[8:11], 0 offen offset:64
    s_waitcnt vmcnt(0)
    v_lshlrev_b32 v32, 16, v16
    v_and_b32 v33, 0xffff0000, v16
    v_mul_f32 v36, 1.4426950408889634, v32
    v_exp_f32 v36, v36
    v_add_f32 v34, 1.0, v32
    v_cmp_lt_f32 vcc, 0, v32
    s_nop 1
    v_cndmask_b32 v34, v36, v34, vcc
    v_add_f32 v34, 0x358637bd, v34
    v_mul_f32 v36, 1.4426950408889634, v33
    v_exp_f32 v36, v36
    v_add_f32 v35, 1.0, v33
    v_cmp_lt_f32 vcc, 0, v33
    s_nop 1
    v_cndmask_b32 v35, v36, v35, vcc
    v_add_f32 v35, 0x358637bd, v35
    v_cvt_pk_bf16_f32 v16, v34, v35
    v_lshlrev_b32 v32, 16, v17
    v_and_b32 v33, 0xffff0000, v17
    v_mul_f32 v36, 1.4426950408889634, v32
    v_exp_f32 v36, v36
    v_add_f32 v34, 1.0, v32
    v_cmp_lt_f32 vcc, 0, v32
    s_nop 1
    v_cndmask_b32 v34, v36, v34, vcc
    v_add_f32 v34, 0x358637bd, v34
    v_mul_f32 v36, 1.4426950408889634, v33
    v_exp_f32 v36, v36
    v_add_f32 v35, 1.0, v33
    v_cmp_lt_f32 vcc, 0, v33
    s_nop 1
    v_cndmask_b32 v35, v36, v35, vcc
    v_add_f32 v35, 0x358637bd, v35
    v_cvt_pk_bf16_f32 v17, v34, v35
    v_lshlrev_b32 v32, 16, v18
    v_and_b32 v33, 0xffff0000, v18
    v_mul_f32 v36, 1.4426950408889634, v32
    v_exp_f32 v36, v36
    v_add_f32 v34, 1.0, v32
    v_cmp_lt_f32 vcc, 0, v32
    s_nop 1
    v_cndmask_b32 v34, v36, v34, vcc
    v_add_f32 v34, 0x358637bd, v34
    v_mul_f32 v36, 1.4426950408889634, v33
    v_exp_f32 v36, v36
    v_add_f32 v35, 1.0, v33
    v_cmp_lt_f32 vcc, 0, v33
    s_nop 1
    v_cndmask_b32 v35, v36, v35, vcc
    v_add_f32 v35, 0x358637bd, v35
    v_cvt_pk_bf16_f32 v18, v34, v35
    v_lshlrev_b32 v32, 16, v19
    v_and_b32 v33, 0xffff0000, v19
    v_mul_f32 v36, 1.4426950408889634, v32
    v_exp_f32 v36, v36
    v_add_f32 v34, 1.0, v32
    v_cmp_lt_f32 vcc, 0, v32
    s_nop 1
    v_cndmask_b32 v34, v36, v34, vcc
    v_add_f32 v34, 0x358637bd, v34
    v_mul_f32 v36, 1.4426950408889634, v33
    v_exp_f32 v36, v36
    v_add_f32 v35, 1.0, v33
    v_cmp_lt_f32 vcc, 0, v33
    s_nop 1
    v_cndmask_b32 v35, v36, v35, vcc
    v_add_f32 v35, 0x358637bd, v35
    v_cvt_pk_bf16_f32 v19, v34, v35
    v_lshlrev_b32 v32, 16, v20
    v_and_b32 v33, 0xffff0000, v20
    v_mul_f32 v36, 1.4426950408889634, v32
    v_exp_f32 v36, v36
    v_add_f32 v34, 1.0, v32
    v_cmp_lt_f32 vcc, 0, v32
    s_nop 1
    v_cndmask_b32 v34, v36, v34, vcc
    v_add_f32 v34, 0x358637bd, v34
    v_mul_f32 v36, 1.4426950408889634, v33
    v_exp_f32 v36, v36
    v_add_f32 v35, 1.0, v33
    v_cmp_lt_f32 vcc, 0, v33
    s_nop 1
    v_cndmask_b32 v35, v36, v35, vcc
    v_add_f32 v35, 0x358637bd, v35
    v_cvt_pk_bf16_f32 v20, v34, v35
    v_lshlrev_b32 v32, 16, v21
    v_and_b32 v33, 0xffff0000, v21
    v_mul_f32 v36, 1.4426950408889634, v32
    v_exp_f32 v36, v36
    v_add_f32 v34, 1.0, v32
    v_cmp_lt_f32 vcc, 0, v32
    s_nop 1
    v_cndmask_b32 v34, v36, v34, vcc
    v_add_f32 v34, 0x358637bd, v34
    v_mul_f32 v36, 1.4426950408889634, v33
    v_exp_f32 v36, v36
    v_add_f32 v35, 1.0, v33
    v_cmp_lt_f32 vcc, 0, v33
    s_nop 1
    v_cndmask_b32 v35, v36, v35, vcc
    v_add_f32 v35, 0x358637bd, v35
    v_cvt_pk_bf16_f32 v21, v34, v35
    v_lshlrev_b32 v32, 16, v22
    v_and_b32 v33, 0xffff0000, v22
    v_mul_f32 v36, 1.4426950408889634, v32
    v_exp_f32 v36, v36
    v_add_f32 v34, 1.0, v32
    v_cmp_lt_f32 vcc, 0, v32
    s_nop 1
    v_cndmask_b32 v34, v36, v34, vcc
    v_add_f32 v34, 0x358637bd, v34
    v_mul_f32 v36, 1.4426950408889634, v33
    v_exp_f32 v36, v36
    v_add_f32 v35, 1.0, v33
    v_cmp_lt_f32 vcc, 0, v33
    s_nop 1
    v_cndmask_b32 v35, v36, v35, vcc
    v_add_f32 v35, 0x358637bd, v35
    v_cvt_pk_bf16_f32 v22, v34, v35
    v_lshlrev_b32 v32, 16, v23
    v_and_b32 v33, 0xffff0000, v23
    v_mul_f32 v36, 1.4426950408889634, v32
    v_exp_f32 v36, v36
    v_add_f32 v34, 1.0, v32
    v_cmp_lt_f32 vcc, 0, v32
    s_nop 1
    v_cndmask_b32 v34, v36, v34, vcc
    v_add_f32 v34, 0x358637bd, v34
    v_mul_f32 v36, 1.4426950408889634, v33
    v_exp_f32 v36, v36
    v_add_f32 v35, 1.0, v33
    v_cmp_lt_f32 vcc, 0, v33
    s_nop 1
    v_cndmask_b32 v35, v36, v35, vcc
    v_add_f32 v35, 0x358637bd, v35
    v_cvt_pk_bf16_f32 v23, v34, v35
    v_mov_b32 v37, 0x3f803f80
    v_cndmask_b32 v20, 0, v20, s[16:17]
    v_cndmask_b32 v28, 0, v28, s[16:17]
    v_cndmask_b32 v28, v28, v37, s[18:19]
    v_cndmask_b32 v21, 0, v21, s[16:17]
    v_cndmask_b32 v29, 0, v29, s[16:17]
    v_cndmask_b32 v29, v29, v37, s[18:19]
    v_cndmask_b32 v22, 0, v22, s[16:17]
    v_cndmask_b32 v30, 0, v30, s[16:17]
    v_cndmask_b32 v30, v30, v37, s[18:19]
    v_cndmask_b32 v23, 0, v23, s[16:17]
    v_cndmask_b32 v31, 0, v31, s[16:17]
    v_cndmask_b32 v31, v31, v37, s[18:19]
    s_nop 1
    v_mfma_f32_16x16x32_bf16 a[0:3], v[24:27], v[16:19], a[0:3]
    v_mfma_f32_16x16x32_bf16 a[4:7], v[24:27], v[20:23], a[4:7]
    v_mfma_f32_16x16x32_bf16 a[8:11], v[28:31], v[16:19], a[8:11]
    v_mfma_f32_16x16x32_bf16 a[12:15], v[28:31], v[20:23], a[12:15]
    buffer_load_dwordx4 v[16:19], v8, s[8:11], 0 offen offset:128
    buffer_load_dwordx4 v[24:27], v10, s[8:11], 0 offen offset:128
    buffer_load_dwordx4 v[20:23], v9, s[8:11], 0 offen offset:128
    buffer_load_dwordx4 v[28:31], v11, s[8:11], 0 offen offset:128
    s_waitcnt vmcnt(0)
    v_lshlrev_b32 v32, 16, v16
    v_and_b32 v33, 0xffff0000, v16
    v_mul_f32 v36, 1.4426950408889634, v32
    v_exp_f32 v36, v36
    v_add_f32 v34, 1.0, v32
    v_cmp_lt_f32 vcc, 0, v32
    s_nop 1
    v_cndmask_b32 v34, v36, v34, vcc
    v_add_f32 v34, 0x358637bd, v34
    v_mul_f32 v36, 1.4426950408889634, v33
    v_exp_f32 v36, v36
    v_add_f32 v35, 1.0, v33
    v_cmp_lt_f32 vcc, 0, v33
    s_nop 1
    v_cndmask_b32 v35, v36, v35, vcc
    v_add_f32 v35, 0x358637bd, v35
    v_cvt_pk_bf16_f32 v16, v34, v35
    v_lshlrev_b32 v32, 16, v17
    v_and_b32 v33, 0xffff0000, v17
    v_mul_f32 v36, 1.4426950408889634, v32
    v_exp_f32 v36, v36
    v_add_f32 v34, 1.0, v32
    v_cmp_lt_f32 vcc, 0, v32
    s_nop 1
    v_cndmask_b32 v34, v36, v34, vcc
    v_add_f32 v34, 0x358637bd, v34
    v_mul_f32 v36, 1.4426950408889634, v33
    v_exp_f32 v36, v36
    v_add_f32 v35, 1.0, v33
    v_cmp_lt_f32 vcc, 0, v33
    s_nop 1
    v_cndmask_b32 v35, v36, v35, vcc
    v_add_f32 v35, 0x358637bd, v35
    v_cvt_pk_bf16_f32 v17, v34, v35
    v_lshlrev_b32 v32, 16, v18
    v_and_b32 v33, 0xffff0000, v18
    v_mul_f32 v36, 1.4426950408889634, v32
    v_exp_f32 v36, v36
    v_add_f32 v34, 1.0, v32
    v_cmp_lt_f32 vcc, 0, v32
    s_nop 1
    v_cndmask_b32 v34, v36, v34, vcc
    v_add_f32 v34, 0x358637bd, v34
    v_mul_f32 v36, 1.4426950408889634, v33
    v_exp_f32 v36, v36
    v_add_f32 v35, 1.0, v33
    v_cmp_lt_f32 vcc, 0, v33
    s_nop 1
    v_cndmask_b32 v35, v36, v35, vcc
    v_add_f32 v35, 0x358637bd, v35
    v_cvt_pk_bf16_f32 v18, v34, v35
    v_lshlrev_b32 v32, 16, v19
    v_and_b32 v33, 0xffff0000, v19
    v_mul_f32 v36, 1.4426950408889634, v32
    v_exp_f32 v36, v36
    v_add_f32 v34, 1.0, v32
    v_cmp_lt_f32 vcc, 0, v32
    s_nop 1
    v_cndmask_b32 v34, v36, v34, vcc
    v_add_f32 v34, 0x358637bd, v34
    v_mul_f32 v36, 1.4426950408889634, v33
    v_exp_f32 v36, v36
    v_add_f32 v35, 1.0, v33
    v_cmp_lt_f32 vcc, 0, v33
    s_nop 1
    v_cndmask_b32 v35, v36, v35, vcc
    v_add_f32 v35, 0x358637bd, v35
    v_cvt_pk_bf16_f32 v19, v34, v35
    v_lshlrev_b32 v32, 16, v20
    v_and_b32 v33, 0xffff0000, v20
    v_mul_f32 v36, 1.4426950408889634, v32
    v_exp_f32 v36, v36
    v_add_f32 v34, 1.0, v32
    v_cmp_lt_f32 vcc, 0, v32
    s_nop 1
    v_cndmask_b32 v34, v36, v34, vcc
    v_add_f32 v34, 0x358637bd, v34
    v_mul_f32 v36, 1.4426950408889634, v33
    v_exp_f32 v36, v36
    v_add_f32 v35, 1.0, v33
    v_cmp_lt_f32 vcc, 0, v33
    s_nop 1
    v_cndmask_b32 v35, v36, v35, vcc
    v_add_f32 v35, 0x358637bd, v35
    v_cvt_pk_bf16_f32 v20, v34, v35
    v_lshlrev_b32 v32, 16, v21
    v_and_b32 v33, 0xffff0000, v21
    v_mul_f32 v36, 1.4426950408889634, v32
    v_exp_f32 v36, v36
    v_add_f32 v34, 1.0, v32
    v_cmp_lt_f32 vcc, 0, v32
    s_nop 1
    v_cndmask_b32 v34, v36, v34, vcc
    v_add_f32 v34, 0x358637bd, v34
    v_mul_f32 v36, 1.4426950408889634, v33
    v_exp_f32 v36, v36
    v_add_f32 v35, 1.0, v33
    v_cmp_lt_f32 vcc, 0, v33
    s_nop 1
    v_cndmask_b32 v35, v36, v35, vcc
    v_add_f32 v35, 0x358637bd, v35
    v_cvt_pk_bf16_f32 v21, v34, v35
    v_lshlrev_b32 v32, 16, v22
    v_and_b32 v33, 0xffff0000, v22
    v_mul_f32 v36, 1.4426950408889634, v32
    v_exp_f32 v36, v36
    v_add_f32 v34, 1.0, v32
    v_cmp_lt_f32 vcc, 0, v32
    s_nop 1
    v_cndmask_b32 v34, v36, v34, vcc
    v_add_f32 v34, 0x358637bd, v34
    v_mul_f32 v36, 1.4426950408889634, v33
    v_exp_f32 v36, v36
    v_add_f32 v35, 1.0, v33
    v_cmp_lt_f32 vcc, 0, v33
    s_nop 1
    v_cndmask_b32 v35, v36, v35, vcc
    v_add_f32 v35, 0x358637bd, v35
    v_cvt_pk_bf16_f32 v22, v34, v35
    v_lshlrev_b32 v32, 16, v23
    v_and_b32 v33, 0xffff0000, v23
    v_mul_f32 v36, 1.4426950408889634, v32
    v_exp_f32 v36, v36
    v_add_f32 v34, 1.0, v32
    v_cmp_lt_f32 vcc, 0, v32
    s_nop 1
    v_cndmask_b32 v34, v36, v34, vcc
    v_add_f32 v34, 0x358637bd, v34
    v_mul_f32 v36, 1.4426950408889634, v33
    v_exp_f32 v36, v36
    v_add_f32 v35, 1.0, v33
    v_cmp_lt_f32 vcc, 0, v33
    s_nop 1
    v_cndmask_b32 v35, v36, v35, vcc
    v_add_f32 v35, 0x358637bd, v35
    v_cvt_pk_bf16_f32 v23, v34, v35
    v_mov_b32 v37, 0x3f803f80
    v_cndmask_b32 v20, 0, v20, s[16:17]
    v_cndmask_b32 v28, 0, v28, s[16:17]
    v_cndmask_b32 v28, v28, v37, s[18:19]
    v_cndmask_b32 v21, 0, v21, s[16:17]
    v_cndmask_b32 v29, 0, v29, s[16:17]
    v_cndmask_b32 v29, v29, v37, s[18:19]
    v_cndmask_b32 v22, 0, v22, s[16:17]
    v_cndmask_b32 v30, 0, v30, s[16:17]
    v_cndmask_b32 v30, v30, v37, s[18:19]
    v_cndmask_b32 v23, 0, v23, s[16:17]
    v_cndmask_b32 v31, 0, v31, s[16:17]
    v_cndmask_b32 v31, v31, v37, s[18:19]
    s_nop 1
    v_mfma_f32_16x16x32_bf16 a[0:3], v[24:27], v[16:19], a[0:3]
    v_mfma_f32_16x16x32_bf16 a[4:7], v[24:27], v[20:23], a[4:7]
    v_mfma_f32_16x16x32_bf16 a[8:11], v[28:31], v[16:19], a[8:11]
    v_mfma_f32_16x16x32_bf16 a[12:15], v[28:31], v[20:23], a[12:15]
    buffer_load_dwordx4 v[16:19], v8, s[8:11], 0 offen offset:192
    buffer_load_dwordx4 v[24:27], v10, s[8:11], 0 offen offset:192
    buffer_load_dwordx4 v[20:23], v9, s[8:11], 0 offen offset:192
    buffer_load_dwordx4 v[28:31], v11, s[8:11], 0 offen offset:192
    s_waitcnt vmcnt(0)
    v_lshlrev_b32 v32, 16, v16
    v_and_b32 v33, 0xffff0000, v16
    v_mul_f32 v36, 1.4426950408889634, v32
    v_exp_f32 v36, v36
    v_add_f32 v34, 1.0, v32
    v_cmp_lt_f32 vcc, 0, v32
    s_nop 1
    v_cndmask_b32 v34, v36, v34, vcc
    v_add_f32 v34, 0x358637bd, v34
    v_mul_f32 v36, 1.4426950408889634, v33
    v_exp_f32 v36, v36
    v_add_f32 v35, 1.0, v33
    v_cmp_lt_f32 vcc, 0, v33
    s_nop 1
    v_cndmask_b32 v35, v36, v35, vcc
    v_add_f32 v35, 0x358637bd, v35
    v_cvt_pk_bf16_f32 v16, v34, v35
    v_lshlrev_b32 v32, 16, v17
    v_and_b32 v33, 0xffff0000, v17
    v_mul_f32 v36, 1.4426950408889634, v32
    v_exp_f32 v36, v36
    v_add_f32 v34, 1.0, v32
    v_cmp_lt_f32 vcc, 0, v32
    s_nop 1
    v_cndmask_b32 v34, v36, v34, vcc
    v_add_f32 v34, 0x358637bd, v34
    v_mul_f32 v36, 1.4426950408889634, v33
    v_exp_f32 v36, v36
    v_add_f32 v35, 1.0, v33
    v_cmp_lt_f32 vcc, 0, v33
    s_nop 1
    v_cndmask_b32 v35, v36, v35, vcc
    v_add_f32 v35, 0x358637bd, v35
    v_cvt_pk_bf16_f32 v17, v34, v35
    v_lshlrev_b32 v32, 16, v18
    v_and_b32 v33, 0xffff0000, v18
    v_mul_f32 v36, 1.4426950408889634, v32
    v_exp_f32 v36, v36
    v_add_f32 v34, 1.0, v32
    v_cmp_lt_f32 vcc, 0, v32
    s_nop 1
    v_cndmask_b32 v34, v36, v34, vcc
    v_add_f32 v34, 0x358637bd, v34
    v_mul_f32 v36, 1.4426950408889634, v33
    v_exp_f32 v36, v36
    v_add_f32 v35, 1.0, v33
    v_cmp_lt_f32 vcc, 0, v33
    s_nop 1
    v_cndmask_b32 v35, v36, v35, vcc
    v_add_f32 v35, 0x358637bd, v35
    v_cvt_pk_bf16_f32 v18, v34, v35
    v_lshlrev_b32 v32, 16, v19
    v_and_b32 v33, 0xffff0000, v19
    v_mul_f32 v36, 1.4426950408889634, v32
    v_exp_f32 v36, v36
    v_add_f32 v34, 1.0, v32
    v_cmp_lt_f32 vcc, 0, v32
    s_nop 1
    v_cndmask_b32 v34, v36, v34, vcc
    v_add_f32 v34, 0x358637bd, v34
    v_mul_f32 v36, 1.4426950408889634, v33
    v_exp_f32 v36, v36
    v_add_f32 v35, 1.0, v33
    v_cmp_lt_f32 vcc, 0, v33
    s_nop 1
    v_cndmask_b32 v35, v36, v35, vcc
    v_add_f32 v35, 0x358637bd, v35
    v_cvt_pk_bf16_f32 v19, v34, v35
    v_lshlrev_b32 v32, 16, v20
    v_and_b32 v33, 0xffff0000, v20
    v_mul_f32 v36, 1.4426950408889634, v32
    v_exp_f32 v36, v36
    v_add_f32 v34, 1.0, v32
    v_cmp_lt_f32 vcc, 0, v32
    s_nop 1
    v_cndmask_b32 v34, v36, v34, vcc
    v_add_f32 v34, 0x358637bd, v34
    v_mul_f32 v36, 1.4426950408889634, v33
    v_exp_f32 v36, v36
    v_add_f32 v35, 1.0, v33
    v_cmp_lt_f32 vcc, 0, v33
    s_nop 1
    v_cndmask_b32 v35, v36, v35, vcc
    v_add_f32 v35, 0x358637bd, v35
    v_cvt_pk_bf16_f32 v20, v34, v35
    v_lshlrev_b32 v32, 16, v21
    v_and_b32 v33, 0xffff0000, v21
    v_mul_f32 v36, 1.4426950408889634, v32
    v_exp_f32 v36, v36
    v_add_f32 v34, 1.0, v32
    v_cmp_lt_f32 vcc, 0, v32
    s_nop 1
    v_cndmask_b32 v34, v36, v34, vcc
    v_add_f32 v34, 0x358637bd, v34
    v_mul_f32 v36, 1.4426950408889634, v33
    v_exp_f32 v36, v36
    v_add_f32 v35, 1.0, v33
    v_cmp_lt_f32 vcc, 0, v33
    s_nop 1
    v_cndmask_b32 v35, v36, v35, vcc
    v_add_f32 v35, 0x358637bd, v35
    v_cvt_pk_bf16_f32 v21, v34, v35
    v_lshlrev_b32 v32, 16, v22
    v_and_b32 v33, 0xffff0000, v22
    v_mul_f32 v36, 1.4426950408889634, v32
    v_exp_f32 v36, v36
    v_add_f32 v34, 1.0, v32
    v_cmp_lt_f32 vcc, 0, v32
    s_nop 1
    v_cndmask_b32 v34, v36, v34, vcc
    v_add_f32 v34, 0x358637bd, v34
    v_mul_f32 v36, 1.4426950408889634, v33
    v_exp_f32 v36, v36
    v_add_f32 v35, 1.0, v33
    v_cmp_lt_f32 vcc, 0, v33
    s_nop 1
    v_cndmask_b32 v35, v36, v35, vcc
    v_add_f32 v35, 0x358637bd, v35
    v_cvt_pk_bf16_f32 v22, v34, v35
    v_lshlrev_b32 v32, 16, v23
    v_and_b32 v33, 0xffff0000, v23
    v_mul_f32 v36, 1.4426950408889634, v32
    v_exp_f32 v36, v36
    v_add_f32 v34, 1.0, v32
    v_cmp_lt_f32 vcc, 0, v32
    s_nop 1
    v_cndmask_b32 v34, v36, v34, vcc
    v_add_f32 v34, 0x358637bd, v34
    v_mul_f32 v36, 1.4426950408889634, v33
    v_exp_f32 v36, v36
    v_add_f32 v35, 1.0, v33
    v_cmp_lt_f32 vcc, 0, v33
    s_nop 1
    v_cndmask_b32 v35, v36, v35, vcc
    v_add_f32 v35, 0x358637bd, v35
    v_cvt_pk_bf16_f32 v23, v34, v35
    v_mov_b32 v37, 0x3f803f80
    v_cndmask_b32 v20, 0, v20, s[16:17]
    v_cndmask_b32 v28, 0, v28, s[16:17]
    v_cndmask_b32 v28, v28, v37, s[18:19]
    v_cndmask_b32 v21, 0, v21, s[16:17]
    v_cndmask_b32 v29, 0, v29, s[16:17]
    v_cndmask_b32 v29, v29, v37, s[18:19]
    v_cndmask_b32 v22, 0, v22, s[16:17]
    v_cndmask_b32 v30, 0, v30, s[16:17]
    v_cndmask_b32 v30, v30, v37, s[18:19]
    v_cndmask_b32 v23, 0, v23, s[16:17]
    v_cndmask_b32 v31, 0, v31, s[16:17]
    v_cndmask_b32 v31, v31, v37, s[18:19]
    s_nop 1
    v_mfma_f32_16x16x32_bf16 a[0:3], v[24:27], v[16:19], a[0:3]
    v_mfma_f32_16x16x32_bf16 a[4:7], v[24:27], v[20:23], a[4:7]
    v_mfma_f32_16x16x32_bf16 a[8:11], v[28:31], v[16:19], a[8:11]
    v_mfma_f32_16x16x32_bf16 a[12:15], v[28:31], v[20:23], a[12:15]
    s_nop 7
    s_nop 7
    v_lshlrev_b32 v5, 2, v4
    v_lshlrev_b32 v5, 5, v5
    v_add_u32 v5, v5, v3
    v_lshlrev_b32 v5, 2, v5
    s_lshl_b32 s14, s5, 12
    s_add_u32 s14, s14, 242352128
    v_add_u32 v5, s14, v5
    v_accvgpr_read_b32 v40, a0
    v_accvgpr_read_b32 v41, a1
    v_accvgpr_read_b32 v42, a2
    v_accvgpr_read_b32 v43, a3
    buffer_atomic_add_f32 v40, v5, s[8:11], 0 offen offset:0
    buffer_atomic_add_f32 v41, v5, s[8:11], 0 offen offset:128
    buffer_atomic_add_f32 v42, v5, s[8:11], 0 offen offset:256
    buffer_atomic_add_f32 v43, v5, s[8:11], 0 offen offset:384
    v_accvgpr_read_b32 v40, a4
    v_accvgpr_read_b32 v41, a5
    v_accvgpr_read_b32 v42, a6
    v_accvgpr_read_b32 v43, a7
    buffer_atomic_add_f32 v40, v5, s[8:11], 0 offen offset:64
    buffer_atomic_add_f32 v41, v5, s[8:11], 0 offen offset:192
    buffer_atomic_add_f32 v42, v5, s[8:11], 0 offen offset:320
    buffer_atomic_add_f32 v43, v5, s[8:11], 0 offen offset:448
    v_accvgpr_read_b32 v40, a8
    v_accvgpr_read_b32 v41, a9
    v_accvgpr_read_b32 v42, a10
    v_accvgpr_read_b32 v43, a11
    buffer_atomic_add_f32 v40, v5, s[8:11], 0 offen offset:2048
    buffer_atomic_add_f32 v41, v5, s[8:11], 0 offen offset:2176
    buffer_atomic_add_f32 v42, v5, s[8:11], 0 offen offset:2304
    buffer_atomic_add_f32 v43, v5, s[8:11], 0 offen offset:2432
    v_accvgpr_read_b32 v40, a12
    v_accvgpr_read_b32 v41, a13
    v_accvgpr_read_b32 v42, a14
    v_accvgpr_read_b32 v43, a15
    buffer_atomic_add_f32 v40, v5, s[8:11], 0 offen offset:2112
    buffer_atomic_add_f32 v41, v5, s[8:11], 0 offen offset:2240
    buffer_atomic_add_f32 v42, v5, s[8:11], 0 offen offset:2368
    buffer_atomic_add_f32 v43, v5, s[8:11], 0 offen offset:2496
kvz_a2_kernel_end:
    s_endpgm
.section .rodata,"a"
.p2align 6
.amdhsa_kernel kvz_a2_kernel
  .amdhsa_next_free_vgpr 80
  .amdhsa_next_free_sgpr 40
  .amdhsa_accum_offset 64
  .amdhsa_group_segment_fixed_size 0
  .amdhsa_kernarg_size 104
  .amdhsa_user_sgpr_count 2
  .amdhsa_user_sgpr_kernarg_segment_ptr 1
  .amdhsa_system_sgpr_workgroup_id_x 1
.end_amdhsa_kernel
.text
.globl attn_a2_kernel
.p2align 8
.type attn_a2_kernel,@function
attn_a2_kernel:
    s_cmp_ge_u32 s2, 256
    s_cbranch_scc1 attn_a2_kernel_end
    s_load_dwordx2 s[6:7], s[0:1], 96
    s_waitcnt lgkmcnt(0)
    s_mov_b32 s8, s6
    s_mov_b32 s9, s7
    s_mov_b32 s10, 268435456
    s_mov_b32 s11, 0x00020000
    v_mov_b32 v1, v0
    v_add_u32 v2, 0, v1
    s_mov_b32 s12, 3121
    v_mul_lo_u32 v3, v2, s12
    v_lshrrev_b32 v3, 19, v3
    v_mul_u32_u24 v4, 168, v3
    v_sub_u32 v4, v2, v4
    v_lshlrev_b32 v5, 12, v3
    v_lshlrev_b32 v6, 4, v4
    v_add_u32 v5, v5, v6
    v_add_u32 v5, 242352128, v5
    buffer_load_dwordx4 v[8:11], v5, s[8:11], 0 offen
    v_mul_u32_u24 v7, 2688, v3
    v_add_u32 v7, v7, v6
    s_waitcnt vmcnt(0)
    ds_write_b128 v7, v[8:11]
    v_add_u32 v2, 256, v1
    s_mov_b32 s12, 3121
    v_mul_lo_u32 v3, v2, s12
    v_lshrrev_b32 v3, 19, v3
    v_mul_u32_u24 v4, 168, v3
    v_sub_u32 v4, v2, v4
    v_lshlrev_b32 v5, 12, v3
    v_lshlrev_b32 v6, 4, v4
    v_add_u32 v5, v5, v6
    v_add_u32 v5, 242352128, v5
    buffer_load_dwordx4 v[8:11], v5, s[8:11], 0 offen
    v_mul_u32_u24 v7, 2688, v3
    v_add_u32 v7, v7, v6
    s_waitcnt vmcnt(0)
    ds_write_b128 v7, v[8:11]
    v_add_u32 v2, 512, v1
    s_mov_b32 s12, 3121
    v_mul_lo_u32 v3, v2, s12
    v_lshrrev_b32 v3, 19, v3
    v_mul_u32_u24 v4, 168, v3
    v_sub_u32 v4, v2, v4
    v_lshlrev_b32 v5, 12, v3
    v_lshlrev_b32 v6, 4, v4
    v_add_u32 v5, v5, v6
    v_add_u32 v5, 242352128, v5
    buffer_load_dwordx4 v[8:11], v5, s[8:11], 0 offen
    v_mul_u32_u24 v7, 2688, v3
    v_add_u32 v7, v7, v6
    s_waitcnt vmcnt(0)
    ds_write_b128 v7, v[8:11]
    v_add_u32 v2, 768, v1
    s_mov_b32 s12, 3121
    v_mul_lo_u32 v3, v2, s12
    v_lshrrev_b32 v3, 19, v3
    v_mul_u32_u24 v4, 168, v3
    v_sub_u32 v4, v2, v4
    v_lshlrev_b32 v5, 12, v3
    v_lshlrev_b32 v6, 4, v4
    v_add_u32 v5, v5, v6
    v_add_u32 v5, 242352128, v5
    buffer_load_dwordx4 v[8:11], v5, s[8:11], 0 offen
    v_mul_u32_u24 v7, 2688, v3
    v_add_u32 v7, v7, v6
    s_waitcnt vmcnt(0)
    ds_write_b128 v7, v[8:11]
    v_add_u32 v2, 1024, v1
    s_mov_b32 s12, 3121
    v_mul_lo_u32 v3, v2, s12
    v_lshrrev_b32 v3, 19, v3
    v_mul_u32_u24 v4, 168, v3
    v_sub_u32 v4, v2, v4
    v_lshlrev_b32 v5, 12, v3
    v_lshlrev_b32 v6, 4, v4
    v_add_u32 v5, v5, v6
    v_add_u32 v5, 242352128, v5
    buffer_load_dwordx4 v[8:11], v5, s[8:11], 0 offen
    v_mul_u32_u24 v7, 2688, v3
    v_add_u32 v7, v7, v6
    s_waitcnt vmcnt(0)
    ds_write_b128 v7, v[8:11]
    v_add_u32 v2, 1280, v1
    s_mov_b32 s12, 3121
    v_mul_lo_u32 v3, v2, s12
    v_lshrrev_b32 v3, 19, v3
    v_mul_u32_u24 v4, 168, v3
    v_sub_u32 v4, v2, v4
    v_lshlrev_b32 v5, 12, v3
    v_lshlrev_b32 v6, 4, v4
    v_add_u32 v5, v5, v6
    v_add_u32 v5, 242352128, v5
    buffer_load_dwordx4 v[8:11], v5, s[8:11], 0 offen
    v_mul_u32_u24 v7, 2688, v3
    v_add_u32 v7, v7, v6
    s_waitcnt vmcnt(0)
    ds_write_b128 v7, v[8:11]
    v_add_u32 v2, 1536, v1
    s_mov_b32 s12, 3121
    v_mul_lo_u32 v3, v2, s12
    v_lshrrev_b32 v3, 19, v3
    v_mul_u32_u24 v4, 168, v3
    v_sub_u32 v4, v2, v4
    v_lshlrev_b32 v5, 12, v3
    v_lshlrev_b32 v6, 4, v4
    v_add_u32 v5, v5, v6
    v_add_u32 v5, 242352128, v5
    buffer_load_dwordx4 v[8:11], v5, s[8:11], 0 offen
    v_mul_u32_u24 v7, 2688, v3
    v_add_u32 v7, v7, v6
    s_waitcnt vmcnt(0)
    ds_write_b128 v7, v[8:11]
    v_add_u32 v2, 1792, v1
    s_mov_b32 s12, 3121
    v_mul_lo_u32 v3, v2, s12
    v_lshrrev_b32 v3, 19, v3
    v_mul_u32_u24 v4, 168, v3
    v_sub_u32 v4, v2, v4
    v_lshlrev_b32 v5, 12, v3
    v_lshlrev_b32 v6, 4, v4
    v_add_u32 v5, v5, v6
    v_add_u32 v5, 242352128, v5
    buffer_load_dwordx4 v[8:11], v5, s[8:11], 0 offen
    v_mul_u32_u24 v7, 2688, v3
    v_add_u32 v7, v7, v6
    s_waitcnt vmcnt(0)
    ds_write_b128 v7, v[8:11]
    v_add_u32 v2, 2048, v1
    s_mov_b32 s12, 3121
    v_mul_lo_u32 v3, v2, s12
    v_lshrrev_b32 v3, 19, v3
    v_mul_u32_u24 v4, 168, v3
    v_sub_u32 v4, v2, v4
    v_lshlrev_b32 v5, 12, v3
    v_lshlrev_b32 v6, 4, v4
    v_add_u32 v5, v5, v6
    v_add_u32 v5, 242352128, v5
    buffer_load_dwordx4 v[8:11], v5, s[8:11], 0 offen
    v_mul_u32_u24 v7, 2688, v3
    v_add_u32 v7, v7, v6
    s_waitcnt vmcnt(0)
    ds_write_b128 v7, v[8:11]
    v_add_u32 v2, 2304, v1
    s_mov_b32 s12, 3121
    v_mul_lo_u32 v3, v2, s12
    v_lshrrev_b32 v3, 19, v3
    v_mul_u32_u24 v4, 168, v3
    v_sub_u32 v4, v2, v4
    v_lshlrev_b32 v5, 12, v3
    v_lshlrev_b32 v6, 4, v4
    v_add_u32 v5, v5, v6
    v_add_u32 v5, 242352128, v5
    buffer_load_dwordx4 v[8:11], v5, s[8:11], 0 offen
    v_mul_u32_u24 v7, 2688, v3
    v_add_u32 v7, v7, v6
    s_waitcnt vmcnt(0)
    ds_write_b128 v7, v[8:11]
    v_add_u32 v2, 2560, v1
    s_mov_b32 s12, 3121
    v_mul_lo_u32 v3, v2, s12
    v_lshrrev_b32 v3, 19, v3
    v_mul_u32_u24 v4, 168, v3
    v_sub_u32 v4, v2, v4
    v_lshlrev_b32 v5, 12, v3
    v_lshlrev_b32 v6, 4, v4
    v_add_u32 v5, v5, v6
    v_add_u32 v5, 242352128, v5
    buffer_load_dwordx4 v[8:11], v5, s[8:11], 0 offen
    v_mul_u32_u24 v7, 2688, v3
    v_add_u32 v7, v7, v6
    s_waitcnt vmcnt(0)
    ds_write_b128 v7, v[8:11]
    v_add_u32 v2, 2816, v1
    s_mov_b32 s12, 3121
    v_mul_lo_u32 v3, v2, s12
    v_lshrrev_b32 v3, 19, v3
    v_mul_u32_u24 v4, 168, v3
    v_sub_u32 v4, v2, v4
    v_lshlrev_b32 v5, 12, v3
    v_lshlrev_b32 v6, 4, v4
    v_add_u32 v5, v5, v6
    v_add_u32 v5, 242352128, v5
    buffer_load_dwordx4 v[8:11], v5, s[8:11], 0 offen
    v_mul_u32_u24 v7, 2688, v3
    v_add_u32 v7, v7, v6
    s_waitcnt vmcnt(0)
    ds_write_b128 v7, v[8:11]
    v_add_u32 v2, 3072, v1
    s_mov_b32 s12, 3121
    v_mul_lo_u32 v3, v2, s12
    v_lshrrev_b32 v3, 19, v3
    v_mul_u32_u24 v4, 168, v3
    v_sub_u32 v4, v2, v4
    v_lshlrev_b32 v5, 12, v3
    v_lshlrev_b32 v6, 4, v4
    v_add_u32 v5, v5, v6
    v_add_u32 v5, 242352128, v5
    buffer_load_dwordx4 v[8:11], v5, s[8:11], 0 offen
    v_mul_u32_u24 v7, 2688, v3
    v_add_u32 v7, v7, v6
    s_waitcnt vmcnt(0)
    ds_write_b128 v7, v[8:11]
    v_add_u32 v2, 3328, v1
    s_mov_b32 s12, 3121
    v_mul_lo_u32 v3, v2, s12
    v_lshrrev_b32 v3, 19, v3
    v_mul_u32_u24 v4, 168, v3
    v_sub_u32 v4, v2, v4
    v_lshlrev_b32 v5, 12, v3
    v_lshlrev_b32 v6, 4, v4
    v_add_u32 v5, v5, v6
    v_add_u32 v5, 242352128, v5
    buffer_load_dwordx4 v[8:11], v5, s[8:11], 0 offen
    v_mul_u32_u24 v7, 2688, v3
    v_add_u32 v7, v7, v6
    s_waitcnt vmcnt(0)
    ds_write_b128 v7, v[8:11]
    v_add_u32 v2, 3584, v1
    s_mov_b32 s12, 3121
    v_mul_lo_u32 v3, v2, s12
    v_lshrrev_b32 v3, 19, v3
    v_mul_u32_u24 v4, 168, v3
    v_sub_u32 v4, v2, v4
    v_lshlrev_b32 v5, 12, v3
    v_lshlrev_b32 v6, 4, v4
    v_add_u32 v5, v5, v6
    v_add_u32 v5, 242352128, v5
    buffer_load_dwordx4 v[8:11], v5, s[8:11], 0 offen
    v_mul_u32_u24 v7, 2688, v3
    v_add_u32 v7, v7, v6
    s_waitcnt vmcnt(0)
    ds_write_b128 v7, v[8:11]
    v_add_u32 v2, 3840, v1
    s_mov_b32 s12, 3121
    v_mul_lo_u32 v3, v2, s12
    v_lshrrev_b32 v3, 19, v3
    v_mul_u32_u24 v4, 168, v3
    v_sub_u32 v4, v2, v4
    v_lshlrev_b32 v5, 12, v3
    v_lshlrev_b32 v6, 4, v4
    v_add_u32 v5, v5, v6
    v_add_u32 v5, 242352128, v5
    buffer_load_dwordx4 v[8:11], v5, s[8:11], 0 offen
    v_mul_u32_u24 v7, 2688, v3
    v_add_u32 v7, v7, v6
    s_waitcnt vmcnt(0)
    ds_write_b128 v7, v[8:11]
    v_add_u32 v2, 4096, v1
    s_mov_b32 s12, 3121
    v_mul_lo_u32 v3, v2, s12
    v_lshrrev_b32 v3, 19, v3
    v_mul_u32_u24 v4, 168, v3
    v_sub_u32 v4, v2, v4
    v_lshlrev_b32 v5, 12, v3
    v_lshlrev_b32 v6, 4, v4
    v_add_u32 v5, v5, v6
    v_add_u32 v5, 242352128, v5
    buffer_load_dwordx4 v[8:11], v5, s[8:11], 0 offen
    v_mul_u32_u24 v7, 2688, v3
    v_add_u32 v7, v7, v6
    s_waitcnt vmcnt(0)
    ds_write_b128 v7, v[8:11]
    v_add_u32 v2, 4352, v1
    s_mov_b32 s12, 3121
    v_mul_lo_u32 v3, v2, s12
    v_lshrrev_b32 v3, 19, v3
    v_mul_u32_u24 v4, 168, v3
    v_sub_u32 v4, v2, v4
    v_lshlrev_b32 v5, 12, v3
    v_lshlrev_b32 v6, 4, v4
    v_add_u32 v5, v5, v6
    v_add_u32 v5, 242352128, v5
    buffer_load_dwordx4 v[8:11], v5, s[8:11], 0 offen
    v_mul_u32_u24 v7, 2688, v3
    v_add_u32 v7, v7, v6
    s_waitcnt vmcnt(0)
    ds_write_b128 v7, v[8:11]
    v_add_u32 v2, 4608, v1
    s_mov_b32 s12, 3121
    v_mul_lo_u32 v3, v2, s12
    v_lshrrev_b32 v3, 19, v3
    v_mul_u32_u24 v4, 168, v3
    v_sub_u32 v4, v2, v4
    v_lshlrev_b32 v5, 12, v3
    v_lshlrev_b32 v6, 4, v4
    v_add_u32 v5, v5, v6
    v_add_u32 v5, 242352128, v5
    buffer_load_dwordx4 v[8:11], v5, s[8:11], 0 offen
    v_mul_u32_u24 v7, 2688, v3
    v_add_u32 v7, v7, v6
    s_waitcnt vmcnt(0)
    ds_write_b128 v7, v[8:11]
    v_add_u32 v2, 4864, v1
    s_mov_b32 s12, 3121
    v_mul_lo_u32 v3, v2, s12
    v_lshrrev_b32 v3, 19, v3
    v_mul_u32_u24 v4, 168, v3
    v_sub_u32 v4, v2, v4
    v_lshlrev_b32 v5, 12, v3
    v_lshlrev_b32 v6, 4, v4
    v_add_u32 v5, v5, v6
    v_add_u32 v5, 242352128, v5
    buffer_load_dwordx4 v[8:11], v5, s[8:11], 0 offen
    v_mul_u32_u24 v7, 2688, v3
    v_add_u32 v7, v7, v6
    s_waitcnt vmcnt(0)
    ds_write_b128 v7, v[8:11]
    v_add_u32 v2, 5120, v1
    s_mov_b32 s12, 3121
    v_mul_lo_u32 v3, v2, s12
    v_lshrrev_b32 v3, 19, v3
    v_mul_u32_u24 v4, 168, v3
    v_sub_u32 v4, v2, v4
    v_lshlrev_b32 v5, 12, v3
    v_lshlrev_b32 v6, 4, v4
    v_add_u32 v5, v5, v6
    v_add_u32 v5, 242352128, v5
    buffer_load_dwordx4 v[8:11], v5, s[8:11], 0 offen
    v_mul_u32_u24 v7, 2688, v3
    v_add_u32 v7, v7, v6
    s_waitcnt vmcnt(0)
    ds_write_b128 v7, v[8:11]
    s_waitcnt lgkmcnt(0)
    s_barrier
    v_and_b32 v2, 31, v0
    v_lshrrev_b32 v3, 5, v0
    s_lshl_b32 s12, s2, 3
    v_add_u32 v3, s12, v3
    v_mul_u32_u24 v4, 1280, v3
    v_mul_u32_u24 v5, 40, v2
    v_add_u32 v4, v4, v5
    v_add_u32 v6, 229638144, v4
    buffer_load_dwordx2 v[8:9], v6, s[8:11], 0 offen offset:0
    buffer_load_dwordx2 v[10:11], v6, s[8:11], 0 offen offset:8
    buffer_load_dwordx2 v[12:13], v6, s[8:11], 0 offen offset:16
    buffer_load_dwordx2 v[14:15], v6, s[8:11], 0 offen offset:24
    buffer_load_dwordx2 v[16:17], v6, s[8:11], 0 offen offset:32
    s_waitcnt vmcnt(0)
    v_lshlrev_b32 v40, 16, v8
    v_and_b32 v41, 0xffff0000, v8
    v_mul_f32 v44, 1.4426950408889634, v40
    v_exp_f32 v44, v44
    v_add_f32 v42, 1.0, v40
    v_cmp_lt_f32 vcc, 0, v40
    s_nop 1
    v_cndmask_b32 v42, v44, v42, vcc
    v_add_f32 v42, 0x358637bd, v42
    v_mul_f32 v44, 1.4426950408889634, v41
    v_exp_f32 v44, v44
    v_add_f32 v43, 1.0, v41
    v_cmp_lt_f32 vcc, 0, v41
    s_nop 1
    v_cndmask_b32 v43, v44, v43, vcc
    v_add_f32 v43, 0x358637bd, v43
    v_cvt_pk_bf16_f32 v45, v42, v43
    v_lshlrev_b32 v20, 16, v45
    v_and_b32 v21, 0xffff0000, v45
    v_lshlrev_b32 v40, 16, v9
    v_and_b32 v41, 0xffff0000, v9
    v_mul_f32 v44, 1.4426950408889634, v40
    v_exp_f32 v44, v44
    v_add_f32 v42, 1.0, v40
    v_cmp_lt_f32 vcc, 0, v40
    s_nop 1
    v_cndmask_b32 v42, v44, v42, vcc
    v_add_f32 v42, 0x358637bd, v42
    v_mul_f32 v44, 1.4426950408889634, v41
    v_exp_f32 v44, v44
    v_add_f32 v43, 1.0, v41
    v_cmp_lt_f32 vcc, 0, v41
    s_nop 1
    v_cndmask_b32 v43, v44, v43, vcc
    v_add_f32 v43, 0x358637bd, v43
    v_cvt_pk_bf16_f32 v45, v42, v43
    v_lshlrev_b32 v22, 16, v45
    v_and_b32 v23, 0xffff0000, v45
    v_lshlrev_b32 v40, 16, v10
    v_and_b32 v41, 0xffff0000, v10
    v_mul_f32 v44, 1.4426950408889634, v40
    v_exp_f32 v44, v44
    v_add_f32 v42, 1.0, v40
    v_cmp_lt_f32 vcc, 0, v40
    s_nop 1
    v_cndmask_b32 v42, v44, v42, vcc
    v_add_f32 v42, 0x358637bd, v42
    v_mul_f32 v44, 1.4426950408889634, v41
    v_exp_f32 v44, v44
    v_add_f32 v43, 1.0, v41
    v_cmp_lt_f32 vcc, 0, v41
    s_nop 1
    v_cndmask_b32 v43, v44, v43, vcc
    v_add_f32 v43, 0x358637bd, v43
    v_cvt_pk_bf16_f32 v45, v42, v43
    v_lshlrev_b32 v24, 16, v45
    v_and_b32 v25, 0xffff0000, v45
    v_lshlrev_b32 v40, 16, v11
    v_and_b32 v41, 0xffff0000, v11
    v_mul_f32 v44, 1.4426950408889634, v40
    v_exp_f32 v44, v44
    v_add_f32 v42, 1.0, v40
    v_cmp_lt_f32 vcc, 0, v40
    s_nop 1
    v_cndmask_b32 v42, v44, v42, vcc
    v_add_f32 v42, 0x358637bd, v42
    v_mul_f32 v44, 1.4426950408889634, v41
    v_exp_f32 v44, v44
    v_add_f32 v43, 1.0, v41
    v_cmp_lt_f32 vcc, 0, v41
    s_nop 1
    v_cndmask_b32 v43, v44, v43, vcc
    v_add_f32 v43, 0x358637bd, v43
    v_cvt_pk_bf16_f32 v45, v42, v43
    v_lshlrev_b32 v26, 16, v45
    v_and_b32 v27, 0xffff0000, v45
    v_lshlrev_b32 v40, 16, v12
    v_and_b32 v41, 0xffff0000, v12
    v_mul_f32 v44, 1.4426950408889634, v40
    v_exp_f32 v44, v44
    v_add_f32 v42, 1.0, v40
    v_cmp_lt_f32 vcc, 0, v40
    s_nop 1
    v_cndmask_b32 v42, v44, v42, vcc
    v_add_f32 v42, 0x358637bd, v42
    v_mul_f32 v44, 1.4426950408889634, v41
    v_exp_f32 v44, v44
    v_add_f32 v43, 1.0, v41
    v_cmp_lt_f32 vcc, 0, v41
    s_nop 1
    v_cndmask_b32 v43, v44, v43, vcc
    v_add_f32 v43, 0x358637bd, v43
    v_cvt_pk_bf16_f32 v45, v42, v43
    v_lshlrev_b32 v28, 16, v45
    v_and_b32 v29, 0xffff0000, v45
    v_lshlrev_b32 v40, 16, v13
    v_and_b32 v41, 0xffff0000, v13
    v_mul_f32 v44, 1.4426950408889634, v40
    v_exp_f32 v44, v44
    v_add_f32 v42, 1.0, v40
    v_cmp_lt_f32 vcc, 0, v40
    s_nop 1
    v_cndmask_b32 v42, v44, v42, vcc
    v_add_f32 v42, 0x358637bd, v42
    v_mul_f32 v44, 1.4426950408889634, v41
    v_exp_f32 v44, v44
    v_add_f32 v43, 1.0, v41
    v_cmp_lt_f32 vcc, 0, v41
    s_nop 1
    v_cndmask_b32 v43, v44, v43, vcc
    v_add_f32 v43, 0x358637bd, v43
    v_cvt_pk_bf16_f32 v45, v42, v43
    v_lshlrev_b32 v30, 16, v45
    v_and_b32 v31, 0xffff0000, v45
    v_lshlrev_b32 v40, 16, v14
    v_and_b32 v41, 0xffff0000, v14
    v_mul_f32 v44, 1.4426950408889634, v40
    v_exp_f32 v44, v44
    v_add_f32 v42, 1.0, v40
    v_cmp_lt_f32 vcc, 0, v40
    s_nop 1
    v_cndmask_b32 v42, v44, v42, vcc
    v_add_f32 v42, 0x358637bd, v42
    v_mul_f32 v44, 1.4426950408889634, v41
    v_exp_f32 v44, v44
    v_add_f32 v43, 1.0, v41
    v_cmp_lt_f32 vcc, 0, v41
    s_nop 1
    v_cndmask_b32 v43, v44, v43, vcc
    v_add_f32 v43, 0x358637bd, v43
    v_cvt_pk_bf16_f32 v45, v42, v43
    v_lshlrev_b32 v32, 16, v45
    v_and_b32 v33, 0xffff0000, v45
    v_lshlrev_b32 v40, 16, v15
    v_and_b32 v41, 0xffff0000, v15
    v_mul_f32 v44, 1.4426950408889634, v40
    v_exp_f32 v44, v44
    v_add_f32 v42, 1.0, v40
    v_cmp_lt_f32 vcc, 0, v40
    s_nop 1
    v_cndmask_b32 v42, v44, v42, vcc
    v_add_f32 v42, 0x358637bd, v42
    v_mul_f32 v44, 1.4426950408889634, v41
    v_exp_f32 v44, v44
    v_add_f32 v43, 1.0, v41
    v_cmp_lt_f32 vcc, 0, v41
    s_nop 1
    v_cndmask_b32 v43, v44, v43, vcc
    v_add_f32 v43, 0x358637bd, v43
    v_cvt_pk_bf16_f32 v45, v42, v43
    v_lshlrev_b32 v34, 16, v45
    v_and_b32 v35, 0xffff0000, v45
    v_lshlrev_b32 v40, 16, v16
    v_and_b32 v41, 0xffff0000, v16
    v_mul_f32 v44, 1.4426950408889634, v40
    v_exp_f32 v44, v44
    v_add_f32 v42, 1.0, v40
    v_cmp_lt_f32 vcc, 0, v40
    s_nop 1
    v_cndmask_b32 v42, v44, v42, vcc
    v_add_f32 v42, 0x358637bd, v42
    v_mul_f32 v44, 1.4426950408889634, v41
    v_exp_f32 v44, v44
    v_add_f32 v43, 1.0, v41
    v_cmp_lt_f32 vcc, 0, v41
    s_nop 1
    v_cndmask_b32 v43, v44, v43, vcc
    v_add_f32 v43, 0x358637bd, v43
    v_cvt_pk_bf16_f32 v45, v42, v43
    v_lshlrev_b32 v36, 16, v45
    v_and_b32 v37, 0xffff0000, v45
    v_lshlrev_b32 v40, 16, v17
    v_and_b32 v41, 0xffff0000, v17
    v_mul_f32 v44, 1.4426950408889634, v40
    v_exp_f32 v44, v44
    v_add_f32 v42, 1.0, v40
    v_cmp_lt_f32 vcc, 0, v40
    s_nop 1
    v_cndmask_b32 v42, v44, v42, vcc
    v_add_f32 v42, 0x358637bd, v42
    v_mul_f32 v44, 1.4426950408889634, v41
    v_exp_f32 v44, v44
    v_add_f32 v43, 1.0, v41
    v_cmp_lt_f32 vcc, 0, v41
    s_nop 1
    v_cndmask_b32 v43, v44, v43, vcc
    v_add_f32 v43, 0x358637bd, v43
    v_cvt_pk_bf16_f32 v45, v42, v43
    v_lshlrev_b32 v38, 16, v45
    v_and_b32 v39, 0xffff0000, v45
    v_mul_u32_u24 v7, 2688, v2
    ds_read_b128 v[72:75], v7 offset:0
    ds_read_b128 v[76:79], v7 offset:16
    ds_read_b128 v[80:83], v7 offset:32
    ds_read_b128 v[84:87], v7 offset:48
    ds_read_b128 v[88:91], v7 offset:64
    s_waitcnt lgkmcnt(0)
    v_mul_f32 v50, v20, v72
    v_fmac_f32 v50, v21, v73
    v_fmac_f32 v50, v22, v74
    v_fmac_f32 v50, v23, v75
    v_fmac_f32 v50, v24, v76
    v_fmac_f32 v50, v25, v77
    v_fmac_f32 v50, v26, v78
    v_fmac_f32 v50, v27, v79
    v_fmac_f32 v50, v28, v80
    v_fmac_f32 v50, v29, v81
    v_fmac_f32 v50, v30, v82
    v_fmac_f32 v50, v31, v83
    v_fmac_f32 v50, v32, v84
    v_fmac_f32 v50, v33, v85
    v_fmac_f32 v50, v34, v86
    v_fmac_f32 v50, v35, v87
    v_fmac_f32 v50, v36, v88
    v_fmac_f32 v50, v37, v89
    v_fmac_f32 v50, v38, v90
    v_fmac_f32 v50, v39, v91
    ds_read_b128 v[72:75], v7 offset:128
    ds_read_b128 v[76:79], v7 offset:144
    ds_read_b128 v[80:83], v7 offset:160
    ds_read_b128 v[84:87], v7 offset:176
    ds_read_b128 v[88:91], v7 offset:192
    s_waitcnt lgkmcnt(0)
    v_mul_f32 v51, v20, v72
    v_fmac_f32 v51, v21, v73
    v_fmac_f32 v51, v22, v74
    v_fmac_f32 v51, v23, v75
    v_fmac_f32 v51, v24, v76
    v_fmac_f32 v51, v25, v77
    v_fmac_f32 v51, v26, v78
    v_fmac_f32 v51, v27, v79
    v_fmac_f32 v51, v28, v80
    v_fmac_f32 v51, v29, v81
    v_fmac_f32 v51, v30, v82
    v_fmac_f32 v51, v31, v83
    v_fmac_f32 v51, v32, v84
    v_fmac_f32 v51, v33, v85
    v_fmac_f32 v51, v34, v86
    v_fmac_f32 v51, v35, v87
    v_fmac_f32 v51, v36, v88
    v_fmac_f32 v51, v37, v89
    v_fmac_f32 v51, v38, v90
    v_fmac_f32 v51, v39, v91
    ds_read_b128 v[72:75], v7 offset:256
    ds_read_b128 v[76:79], v7 offset:272
    ds_read_b128 v[80:83], v7 offset:288
    ds_read_b128 v[84:87], v7 offset:304
    ds_read_b128 v[88:91], v7 offset:320
    s_waitcnt lgkmcnt(0)
    v_mul_f32 v52, v20, v72
    v_fmac_f32 v52, v21, v73
    v_fmac_f32 v52, v22, v74
    v_fmac_f32 v52, v23, v75
    v_fmac_f32 v52, v24, v76
    v_fmac_f32 v52, v25, v77
    v_fmac_f32 v52, v26, v78
    v_fmac_f32 v52, v27, v79
    v_fmac_f32 v52, v28, v80
    v_fmac_f32 v52, v29, v81
    v_fmac_f32 v52, v30, v82
    v_fmac_f32 v52, v31, v83
    v_fmac_f32 v52, v32, v84
    v_fmac_f32 v52, v33, v85
    v_fmac_f32 v52, v34, v86
    v_fmac_f32 v52, v35, v87
    v_fmac_f32 v52, v36, v88
    v_fmac_f32 v52, v37, v89
    v_fmac_f32 v52, v38, v90
    v_fmac_f32 v52, v39, v91
    ds_read_b128 v[72:75], v7 offset:384
    ds_read_b128 v[76:79], v7 offset:400
    ds_read_b128 v[80:83], v7 offset:416
    ds_read_b128 v[84:87], v7 offset:432
    ds_read_b128 v[88:91], v7 offset:448
    s_waitcnt lgkmcnt(0)
    v_mul_f32 v53, v20, v72
    v_fmac_f32 v53, v21, v73
    v_fmac_f32 v53, v22, v74
    v_fmac_f32 v53, v23, v75
    v_fmac_f32 v53, v24, v76
    v_fmac_f32 v53, v25, v77
    v_fmac_f32 v53, v26, v78
    v_fmac_f32 v53, v27, v79
    v_fmac_f32 v53, v28, v80
    v_fmac_f32 v53, v29, v81
    v_fmac_f32 v53, v30, v82
    v_fmac_f32 v53, v31, v83
    v_fmac_f32 v53, v32, v84
    v_fmac_f32 v53, v33, v85
    v_fmac_f32 v53, v34, v86
    v_fmac_f32 v53, v35, v87
    v_fmac_f32 v53, v36, v88
    v_fmac_f32 v53, v37, v89
    v_fmac_f32 v53, v38, v90
    v_fmac_f32 v53, v39, v91
    ds_read_b128 v[72:75], v7 offset:512
    ds_read_b128 v[76:79], v7 offset:528
    ds_read_b128 v[80:83], v7 offset:544
    ds_read_b128 v[84:87], v7 offset:560
    ds_read_b128 v[88:91], v7 offset:576
    s_waitcnt lgkmcnt(0)
    v_mul_f32 v54, v20, v72
    v_fmac_f32 v54, v21, v73
    v_fmac_f32 v54, v22, v74
    v_fmac_f32 v54, v23, v75
    v_fmac_f32 v54, v24, v76
    v_fmac_f32 v54, v25, v77
    v_fmac_f32 v54, v26, v78
    v_fmac_f32 v54, v27, v79
    v_fmac_f32 v54, v28, v80
    v_fmac_f32 v54, v29, v81
    v_fmac_f32 v54, v30, v82
    v_fmac_f32 v54, v31, v83
    v_fmac_f32 v54, v32, v84
    v_fmac_f32 v54, v33, v85
    v_fmac_f32 v54, v34, v86
    v_fmac_f32 v54, v35, v87
    v_fmac_f32 v54, v36, v88
    v_fmac_f32 v54, v37, v89
    v_fmac_f32 v54, v38, v90
    v_fmac_f32 v54, v39, v91
    ds_read_b128 v[72:75], v7 offset:640
    ds_read_b128 v[76:79], v7 offset:656
    ds_read_b128 v[80:83], v7 offset:672
    ds_read_b128 v[84:87], v7 offset:688
    ds_read_b128 v[88:91], v7 offset:704
    s_waitcnt lgkmcnt(0)
    v_mul_f32 v55, v20, v72
    v_fmac_f32 v55, v21, v73
    v_fmac_f32 v55, v22, v74
    v_fmac_f32 v55, v23, v75
    v_fmac_f32 v55, v24, v76
    v_fmac_f32 v55, v25, v77
    v_fmac_f32 v55, v26, v78
    v_fmac_f32 v55, v27, v79
    v_fmac_f32 v55, v28, v80
    v_fmac_f32 v55, v29, v81
    v_fmac_f32 v55, v30, v82
    v_fmac_f32 v55, v31, v83
    v_fmac_f32 v55, v32, v84
    v_fmac_f32 v55, v33, v85
    v_fmac_f32 v55, v34, v86
    v_fmac_f32 v55, v35, v87
    v_fmac_f32 v55, v36, v88
    v_fmac_f32 v55, v37, v89
    v_fmac_f32 v55, v38, v90
    v_fmac_f32 v55, v39, v91
    ds_read_b128 v[72:75], v7 offset:768
    ds_read_b128 v[76:79], v7 offset:784
    ds_read_b128 v[80:83], v7 offset:800
    ds_read_b128 v[84:87], v7 offset:816
    ds_read_b128 v[88:91], v7 offset:832
    s_waitcnt lgkmcnt(0)
    v_mul_f32 v56, v20, v72
    v_fmac_f32 v56, v21, v73
    v_fmac_f32 v56, v22, v74
    v_fmac_f32 v56, v23, v75
    v_fmac_f32 v56, v24, v76
    v_fmac_f32 v56, v25, v77
    v_fmac_f32 v56, v26, v78
    v_fmac_f32 v56, v27, v79
    v_fmac_f32 v56, v28, v80
    v_fmac_f32 v56, v29, v81
    v_fmac_f32 v56, v30, v82
    v_fmac_f32 v56, v31, v83
    v_fmac_f32 v56, v32, v84
    v_fmac_f32 v56, v33, v85
    v_fmac_f32 v56, v34, v86
    v_fmac_f32 v56, v35, v87
    v_fmac_f32 v56, v36, v88
    v_fmac_f32 v56, v37, v89
    v_fmac_f32 v56, v38, v90
    v_fmac_f32 v56, v39, v91
    ds_read_b128 v[72:75], v7 offset:896
    ds_read_b128 v[76:79], v7 offset:912
    ds_read_b128 v[80:83], v7 offset:928
    ds_read_b128 v[84:87], v7 offset:944
    ds_read_b128 v[88:91], v7 offset:960
    s_waitcnt lgkmcnt(0)
    v_mul_f32 v57, v20, v72
    v_fmac_f32 v57, v21, v73
    v_fmac_f32 v57, v22, v74
    v_fmac_f32 v57, v23, v75
    v_fmac_f32 v57, v24, v76
    v_fmac_f32 v57, v25, v77
    v_fmac_f32 v57, v26, v78
    v_fmac_f32 v57, v27, v79
    v_fmac_f32 v57, v28, v80
    v_fmac_f32 v57, v29, v81
    v_fmac_f32 v57, v30, v82
    v_fmac_f32 v57, v31, v83
    v_fmac_f32 v57, v32, v84
    v_fmac_f32 v57, v33, v85
    v_fmac_f32 v57, v34, v86
    v_fmac_f32 v57, v35, v87
    v_fmac_f32 v57, v36, v88
    v_fmac_f32 v57, v37, v89
    v_fmac_f32 v57, v38, v90
    v_fmac_f32 v57, v39, v91
    ds_read_b128 v[72:75], v7 offset:1024
    ds_read_b128 v[76:79], v7 offset:1040
    ds_read_b128 v[80:83], v7 offset:1056
    ds_read_b128 v[84:87], v7 offset:1072
    ds_read_b128 v[88:91], v7 offset:1088
    s_waitcnt lgkmcnt(0)
    v_mul_f32 v58, v20, v72
    v_fmac_f32 v58, v21, v73
    v_fmac_f32 v58, v22, v74
    v_fmac_f32 v58, v23, v75
    v_fmac_f32 v58, v24, v76
    v_fmac_f32 v58, v25, v77
    v_fmac_f32 v58, v26, v78
    v_fmac_f32 v58, v27, v79
    v_fmac_f32 v58, v28, v80
    v_fmac_f32 v58, v29, v81
    v_fmac_f32 v58, v30, v82
    v_fmac_f32 v58, v31, v83
    v_fmac_f32 v58, v32, v84
    v_fmac_f32 v58, v33, v85
    v_fmac_f32 v58, v34, v86
    v_fmac_f32 v58, v35, v87
    v_fmac_f32 v58, v36, v88
    v_fmac_f32 v58, v37, v89
    v_fmac_f32 v58, v38, v90
    v_fmac_f32 v58, v39, v91
    ds_read_b128 v[72:75], v7 offset:1152
    ds_read_b128 v[76:79], v7 offset:1168
    ds_read_b128 v[80:83], v7 offset:1184
    ds_read_b128 v[84:87], v7 offset:1200
    ds_read_b128 v[88:91], v7 offset:1216
    s_waitcnt lgkmcnt(0)
    v_mul_f32 v59, v20, v72
    v_fmac_f32 v59, v21, v73
    v_fmac_f32 v59, v22, v74
    v_fmac_f32 v59, v23, v75
    v_fmac_f32 v59, v24, v76
    v_fmac_f32 v59, v25, v77
    v_fmac_f32 v59, v26, v78
    v_fmac_f32 v59, v27, v79
    v_fmac_f32 v59, v28, v80
    v_fmac_f32 v59, v29, v81
    v_fmac_f32 v59, v30, v82
    v_fmac_f32 v59, v31, v83
    v_fmac_f32 v59, v32, v84
    v_fmac_f32 v59, v33, v85
    v_fmac_f32 v59, v34, v86
    v_fmac_f32 v59, v35, v87
    v_fmac_f32 v59, v36, v88
    v_fmac_f32 v59, v37, v89
    v_fmac_f32 v59, v38, v90
    v_fmac_f32 v59, v39, v91
    ds_read_b128 v[72:75], v7 offset:1280
    ds_read_b128 v[76:79], v7 offset:1296
    ds_read_b128 v[80:83], v7 offset:1312
    ds_read_b128 v[84:87], v7 offset:1328
    ds_read_b128 v[88:91], v7 offset:1344
    s_waitcnt lgkmcnt(0)
    v_mul_f32 v60, v20, v72
    v_fmac_f32 v60, v21, v73
    v_fmac_f32 v60, v22, v74
    v_fmac_f32 v60, v23, v75
    v_fmac_f32 v60, v24, v76
    v_fmac_f32 v60, v25, v77
    v_fmac_f32 v60, v26, v78
    v_fmac_f32 v60, v27, v79
    v_fmac_f32 v60, v28, v80
    v_fmac_f32 v60, v29, v81
    v_fmac_f32 v60, v30, v82
    v_fmac_f32 v60, v31, v83
    v_fmac_f32 v60, v32, v84
    v_fmac_f32 v60, v33, v85
    v_fmac_f32 v60, v34, v86
    v_fmac_f32 v60, v35, v87
    v_fmac_f32 v60, v36, v88
    v_fmac_f32 v60, v37, v89
    v_fmac_f32 v60, v38, v90
    v_fmac_f32 v60, v39, v91
    ds_read_b128 v[72:75], v7 offset:1408
    ds_read_b128 v[76:79], v7 offset:1424
    ds_read_b128 v[80:83], v7 offset:1440
    ds_read_b128 v[84:87], v7 offset:1456
    ds_read_b128 v[88:91], v7 offset:1472
    s_waitcnt lgkmcnt(0)
    v_mul_f32 v61, v20, v72
    v_fmac_f32 v61, v21, v73
    v_fmac_f32 v61, v22, v74
    v_fmac_f32 v61, v23, v75
    v_fmac_f32 v61, v24, v76
    v_fmac_f32 v61, v25, v77
    v_fmac_f32 v61, v26, v78
    v_fmac_f32 v61, v27, v79
    v_fmac_f32 v61, v28, v80
    v_fmac_f32 v61, v29, v81
    v_fmac_f32 v61, v30, v82
    v_fmac_f32 v61, v31, v83
    v_fmac_f32 v61, v32, v84
    v_fmac_f32 v61, v33, v85
    v_fmac_f32 v61, v34, v86
    v_fmac_f32 v61, v35, v87
    v_fmac_f32 v61, v36, v88
    v_fmac_f32 v61, v37, v89
    v_fmac_f32 v61, v38, v90
    v_fmac_f32 v61, v39, v91
    ds_read_b128 v[72:75], v7 offset:1536
    ds_read_b128 v[76:79], v7 offset:1552
    ds_read_b128 v[80:83], v7 offset:1568
    ds_read_b128 v[84:87], v7 offset:1584
    ds_read_b128 v[88:91], v7 offset:1600
    s_waitcnt lgkmcnt(0)
    v_mul_f32 v62, v20, v72
    v_fmac_f32 v62, v21, v73
    v_fmac_f32 v62, v22, v74
    v_fmac_f32 v62, v23, v75
    v_fmac_f32 v62, v24, v76
    v_fmac_f32 v62, v25, v77
    v_fmac_f32 v62, v26, v78
    v_fmac_f32 v62, v27, v79
    v_fmac_f32 v62, v28, v80
    v_fmac_f32 v62, v29, v81
    v_fmac_f32 v62, v30, v82
    v_fmac_f32 v62, v31, v83
    v_fmac_f32 v62, v32, v84
    v_fmac_f32 v62, v33, v85
    v_fmac_f32 v62, v34, v86
    v_fmac_f32 v62, v35, v87
    v_fmac_f32 v62, v36, v88
    v_fmac_f32 v62, v37, v89
    v_fmac_f32 v62, v38, v90
    v_fmac_f32 v62, v39, v91
    ds_read_b128 v[72:75], v7 offset:1664
    ds_read_b128 v[76:79], v7 offset:1680
    ds_read_b128 v[80:83], v7 offset:1696
    ds_read_b128 v[84:87], v7 offset:1712
    ds_read_b128 v[88:91], v7 offset:1728
    s_waitcnt lgkmcnt(0)
    v_mul_f32 v63, v20, v72
    v_fmac_f32 v63, v21, v73
    v_fmac_f32 v63, v22, v74
    v_fmac_f32 v63, v23, v75
    v_fmac_f32 v63, v24, v76
    v_fmac_f32 v63, v25, v77
    v_fmac_f32 v63, v26, v78
    v_fmac_f32 v63, v27, v79
    v_fmac_f32 v63, v28, v80
    v_fmac_f32 v63, v29, v81
    v_fmac_f32 v63, v30, v82
    v_fmac_f32 v63, v31, v83
    v_fmac_f32 v63, v32, v84
    v_fmac_f32 v63, v33, v85
    v_fmac_f32 v63, v34, v86
    v_fmac_f32 v63, v35, v87
    v_fmac_f32 v63, v36, v88
    v_fmac_f32 v63, v37, v89
    v_fmac_f32 v63, v38, v90
    v_fmac_f32 v63, v39, v91
    ds_read_b128 v[72:75], v7 offset:1792
    ds_read_b128 v[76:79], v7 offset:1808
    ds_read_b128 v[80:83], v7 offset:1824
    ds_read_b128 v[84:87], v7 offset:1840
    ds_read_b128 v[88:91], v7 offset:1856
    s_waitcnt lgkmcnt(0)
    v_mul_f32 v64, v20, v72
    v_fmac_f32 v64, v21, v73
    v_fmac_f32 v64, v22, v74
    v_fmac_f32 v64, v23, v75
    v_fmac_f32 v64, v24, v76
    v_fmac_f32 v64, v25, v77
    v_fmac_f32 v64, v26, v78
    v_fmac_f32 v64, v27, v79
    v_fmac_f32 v64, v28, v80
    v_fmac_f32 v64, v29, v81
    v_fmac_f32 v64, v30, v82
    v_fmac_f32 v64, v31, v83
    v_fmac_f32 v64, v32, v84
    v_fmac_f32 v64, v33, v85
    v_fmac_f32 v64, v34, v86
    v_fmac_f32 v64, v35, v87
    v_fmac_f32 v64, v36, v88
    v_fmac_f32 v64, v37, v89
    v_fmac_f32 v64, v38, v90
    v_fmac_f32 v64, v39, v91
    ds_read_b128 v[72:75], v7 offset:1920
    ds_read_b128 v[76:79], v7 offset:1936
    ds_read_b128 v[80:83], v7 offset:1952
    ds_read_b128 v[84:87], v7 offset:1968
    ds_read_b128 v[88:91], v7 offset:1984
    s_waitcnt lgkmcnt(0)
    v_mul_f32 v65, v20, v72
    v_fmac_f32 v65, v21, v73
    v_fmac_f32 v65, v22, v74
    v_fmac_f32 v65, v23, v75
    v_fmac_f32 v65, v24, v76
    v_fmac_f32 v65, v25, v77
    v_fmac_f32 v65, v26, v78
    v_fmac_f32 v65, v27, v79
    v_fmac_f32 v65, v28, v80
    v_fmac_f32 v65, v29, v81
    v_fmac_f32 v65, v30, v82
    v_fmac_f32 v65, v31, v83
    v_fmac_f32 v65, v32, v84
    v_fmac_f32 v65, v33, v85
    v_fmac_f32 v65, v34, v86
    v_fmac_f32 v65, v35, v87
    v_fmac_f32 v65, v36, v88
    v_fmac_f32 v65, v37, v89
    v_fmac_f32 v65, v38, v90
    v_fmac_f32 v65, v39, v91
    ds_read_b128 v[72:75], v7 offset:2048
    ds_read_b128 v[76:79], v7 offset:2064
    ds_read_b128 v[80:83], v7 offset:2080
    ds_read_b128 v[84:87], v7 offset:2096
    ds_read_b128 v[88:91], v7 offset:2112
    s_waitcnt lgkmcnt(0)
    v_mul_f32 v66, v20, v72
    v_fmac_f32 v66, v21, v73
    v_fmac_f32 v66, v22, v74
    v_fmac_f32 v66, v23, v75
    v_fmac_f32 v66, v24, v76
    v_fmac_f32 v66, v25, v77
    v_fmac_f32 v66, v26, v78
    v_fmac_f32 v66, v27, v79
    v_fmac_f32 v66, v28, v80
    v_fmac_f32 v66, v29, v81
    v_fmac_f32 v66, v30, v82
    v_fmac_f32 v66, v31, v83
    v_fmac_f32 v66, v32, v84
    v_fmac_f32 v66, v33, v85
    v_fmac_f32 v66, v34, v86
    v_fmac_f32 v66, v35, v87
    v_fmac_f32 v66, v36, v88
    v_fmac_f32 v66, v37, v89
    v_fmac_f32 v66, v38, v90
    v_fmac_f32 v66, v39, v91
    ds_read_b128 v[72:75], v7 offset:2176
    ds_read_b128 v[76:79], v7 offset:2192
    ds_read_b128 v[80:83], v7 offset:2208
    ds_read_b128 v[84:87], v7 offset:2224
    ds_read_b128 v[88:91], v7 offset:2240
    s_waitcnt lgkmcnt(0)
    v_mul_f32 v67, v20, v72
    v_fmac_f32 v67, v21, v73
    v_fmac_f32 v67, v22, v74
    v_fmac_f32 v67, v23, v75
    v_fmac_f32 v67, v24, v76
    v_fmac_f32 v67, v25, v77
    v_fmac_f32 v67, v26, v78
    v_fmac_f32 v67, v27, v79
    v_fmac_f32 v67, v28, v80
    v_fmac_f32 v67, v29, v81
    v_fmac_f32 v67, v30, v82
    v_fmac_f32 v67, v31, v83
    v_fmac_f32 v67, v32, v84
    v_fmac_f32 v67, v33, v85
    v_fmac_f32 v67, v34, v86
    v_fmac_f32 v67, v35, v87
    v_fmac_f32 v67, v36, v88
    v_fmac_f32 v67, v37, v89
    v_fmac_f32 v67, v38, v90
    v_fmac_f32 v67, v39, v91
    ds_read_b128 v[72:75], v7 offset:2304
    ds_read_b128 v[76:79], v7 offset:2320
    ds_read_b128 v[80:83], v7 offset:2336
    ds_read_b128 v[84:87], v7 offset:2352
    ds_read_b128 v[88:91], v7 offset:2368
    s_waitcnt lgkmcnt(0)
    v_mul_f32 v68, v20, v72
    v_fmac_f32 v68, v21, v73
    v_fmac_f32 v68, v22, v74
    v_fmac_f32 v68, v23, v75
    v_fmac_f32 v68, v24, v76
    v_fmac_f32 v68, v25, v77
    v_fmac_f32 v68, v26, v78
    v_fmac_f32 v68, v27, v79
    v_fmac_f32 v68, v28, v80
    v_fmac_f32 v68, v29, v81
    v_fmac_f32 v68, v30, v82
    v_fmac_f32 v68, v31, v83
    v_fmac_f32 v68, v32, v84
    v_fmac_f32 v68, v33, v85
    v_fmac_f32 v68, v34, v86
    v_fmac_f32 v68, v35, v87
    v_fmac_f32 v68, v36, v88
    v_fmac_f32 v68, v37, v89
    v_fmac_f32 v68, v38, v90
    v_fmac_f32 v68, v39, v91
    ds_read_b128 v[72:75], v7 offset:2432
    ds_read_b128 v[76:79], v7 offset:2448
    ds_read_b128 v[80:83], v7 offset:2464
    ds_read_b128 v[84:87], v7 offset:2480
    ds_read_b128 v[88:91], v7 offset:2496
    s_waitcnt lgkmcnt(0)
    v_mul_f32 v69, v20, v72
    v_fmac_f32 v69, v21, v73
    v_fmac_f32 v69, v22, v74
    v_fmac_f32 v69, v23, v75
    v_fmac_f32 v69, v24, v76
    v_fmac_f32 v69, v25, v77
    v_fmac_f32 v69, v26, v78
    v_fmac_f32 v69, v27, v79
    v_fmac_f32 v69, v28, v80
    v_fmac_f32 v69, v29, v81
    v_fmac_f32 v69, v30, v82
    v_fmac_f32 v69, v31, v83
    v_fmac_f32 v69, v32, v84
    v_fmac_f32 v69, v33, v85
    v_fmac_f32 v69, v34, v86
    v_fmac_f32 v69, v35, v87
    v_fmac_f32 v69, v36, v88
    v_fmac_f32 v69, v37, v89
    v_fmac_f32 v69, v38, v90
    v_fmac_f32 v69, v39, v91
    ds_read_b128 v[72:75], v7 offset:2560
    ds_read_b128 v[76:79], v7 offset:2576
    ds_read_b128 v[80:83], v7 offset:2592
    ds_read_b128 v[84:87], v7 offset:2608
    ds_read_b128 v[88:91], v7 offset:2624
    s_waitcnt lgkmcnt(0)
    v_mul_f32 v70, v20, v72
    v_fmac_f32 v70, v21, v73
    v_fmac_f32 v70, v22, v74
    v_fmac_f32 v70, v23, v75
    v_fmac_f32 v70, v24, v76
    v_fmac_f32 v70, v25, v77
    v_fmac_f32 v70, v26, v78
    v_fmac_f32 v70, v27, v79
    v_fmac_f32 v70, v28, v80
    v_fmac_f32 v70, v29, v81
    v_fmac_f32 v70, v30, v82
    v_fmac_f32 v70, v31, v83
    v_fmac_f32 v70, v32, v84
    v_fmac_f32 v70, v33, v85
    v_fmac_f32 v70, v34, v86
    v_fmac_f32 v70, v35, v87
    v_fmac_f32 v70, v36, v88
    v_fmac_f32 v70, v37, v89
    v_fmac_f32 v70, v38, v90
    v_fmac_f32 v70, v39, v91
    v_add_f32 v70, 0x358637bd, v70
    v_rcp_f32 v70, v70
    s_nop 0
    v_mul_f32 v50, v50, v70
    v_mul_f32 v51, v51, v70
    v_mul_f32 v52, v52, v70
    v_mul_f32 v53, v53, v70
    v_mul_f32 v54, v54, v70
    v_mul_f32 v55, v55, v70
    v_mul_f32 v56, v56, v70
    v_mul_f32 v57, v57, v70
    v_mul_f32 v58, v58, v70
    v_mul_f32 v59, v59, v70
    v_mul_f32 v60, v60, v70
    v_mul_f32 v61, v61, v70
    v_mul_f32 v62, v62, v70
    v_mul_f32 v63, v63, v70
    v_mul_f32 v64, v64, v70
    v_mul_f32 v65, v65, v70
    v_mul_f32 v66, v66, v70
    v_mul_f32 v67, v67, v70
    v_mul_f32 v68, v68, v70
    v_mul_f32 v69, v69, v70
    v_cvt_pk_bf16_f32 v8, v50, v51
    v_cvt_pk_bf16_f32 v9, v52, v53
    v_cvt_pk_bf16_f32 v10, v54, v55
    v_cvt_pk_bf16_f32 v11, v56, v57
    v_cvt_pk_bf16_f32 v12, v58, v59
    v_cvt_pk_bf16_f32 v13, v60, v61
    v_cvt_pk_bf16_f32 v14, v62, v63
    v_cvt_pk_bf16_f32 v15, v64, v65
    v_cvt_pk_bf16_f32 v16, v66, v67
    v_cvt_pk_bf16_f32 v17, v68, v69
    v_add_u32 v6, 239075328, v4
    buffer_store_dwordx2 v[8:9], v6, s[8:11], 0 offen offset:0
    buffer_store_dwordx2 v[10:11], v6, s[8:11], 0 offen offset:8
    buffer_store_dwordx2 v[12:13], v6, s[8:11], 0 offen offset:16
    buffer_store_dwordx2 v[14:15], v6, s[8:11], 0 offen offset:24
    buffer_store_dwordx2 v[16:17], v6, s[8:11], 0 offen offset:32
attn_a2_kernel_end:
    s_endpgm
.section .rodata,"a"
.p2align 6
.amdhsa_kernel attn_a2_kernel
  .amdhsa_next_free_vgpr 96
  .amdhsa_next_free_sgpr 40
  .amdhsa_accum_offset 96
  .amdhsa_group_segment_fixed_size 0
  .amdhsa_kernarg_size 104
  .amdhsa_user_sgpr_count 2
  .amdhsa_user_sgpr_kernarg_segment_ptr 1
  .amdhsa_system_sgpr_workgroup_id_x 1
.end_amdhsa_kernel
.text
.globl wo_a2_kernel
.p2align 8
.type wo_a2_kernel,@function
wo_a2_kernel:
    v_lshrrev_b32 v1, 6, v0
    v_and_b32 v2, 63, v0
    s_nop 0
    v_readfirstlane_b32 s3, v1
    s_cmp_ge_u32 s2, 128
    s_cbranch_scc1 wo_a2_kernel_end
    s_load_dwordx2 s[4:5], s[0:1], 96
    s_load_dwordx2 s[6:7], s[0:1], 80
    s_mul_i32 s20, s2, 1
    s_lshr_b32 s20, s20, 3
    s_mul_i32 s21, s20, 8
    s_sub_u32 s21, s2, s21
    s_lshl_b32 s20, s20, 2
    s_add_u32 s20, s20, s3
    s_mul_i32 s22, s20, 32
    s_mul_i32 s23, s21, 80
    s_waitcnt lgkmcnt(0)
    s_mov_b32 s8, s4
    s_mov_b32 s9, s5
    s_mov_b32 s10, 268435456
    s_mov_b32 s11, 0x00020000
    v_and_b32 v3, 15, v2
    v_lshrrev_b32 v4, 4, v2
    s_mov_b32 s24, 1280
    v_add_u32 v5, s22, v3
    v_mul_lo_u32 v5, v5, s24
    v_lshlrev_b32 v6, 4, v4
    v_add_u32 v5, v5, v6
    v_add_u32 v5, 239075328, v5
    v_mov_b32 v8, v5
    v_add_u32 v9, 20480, v5
    v_lshlrev_b32 v7, 4, v2
    s_mov_b32 s25, 0
    s_mov_b32 s26, 0
    s_mul_i32 s27, s21, 102400
    s_add_u32 s27, s27, s26
    s_add_u32 s27, s27, 246415360
    s_add_u32 s32, s27, 0
    s_add_u32 s33, s27, 20480
    s_add_u32 s34, s27, 40960
    s_add_u32 s35, s27, 61440
    s_add_u32 s36, s27, 81920
    v_accvgpr_write_b32 a0, 0
    v_accvgpr_write_b32 a1, 0
    v_accvgpr_write_b32 a2, 0
    v_accvgpr_write_b32 a3, 0
    v_accvgpr_write_b32 a4, 0
    v_accvgpr_write_b32 a5, 0
    v_accvgpr_write_b32 a6, 0
    v_accvgpr_write_b32 a7, 0
    v_accvgpr_write_b32 a8, 0
    v_accvgpr_write_b32 a9, 0
    v_accvgpr_write_b32 a10, 0
    v_accvgpr_write_b32 a11, 0
    v_accvgpr_write_b32 a12, 0
    v_accvgpr_write_b32 a13, 0
    v_accvgpr_write_b32 a14, 0
    v_accvgpr_write_b32 a15, 0
    v_accvgpr_write_b32 a16, 0
    v_accvgpr_write_b32 a17, 0
    v_accvgpr_write_b32 a18, 0
    v_accvgpr_write_b32 a19, 0
    v_accvgpr_write_b32 a20, 0
    v_accvgpr_write_b32 a21, 0
    v_accvgpr_write_b32 a22, 0
    v_accvgpr_write_b32 a23, 0
    v_accvgpr_write_b32 a24, 0
    v_accvgpr_write_b32 a25, 0
    v_accvgpr_write_b32 a26, 0
    v_accvgpr_write_b32 a27, 0
    v_accvgpr_write_b32 a28, 0
    v_accvgpr_write_b32 a29, 0
    v_accvgpr_write_b32 a30, 0
    v_accvgpr_write_b32 a31, 0
    v_accvgpr_write_b32 a32, 0
    v_accvgpr_write_b32 a33, 0
    v_accvgpr_write_b32 a34, 0
    v_accvgpr_write_b32 a35, 0
    v_accvgpr_write_b32 a36, 0
    v_accvgpr_write_b32 a37, 0
    v_accvgpr_write_b32 a38, 0
    v_accvgpr_write_b32 a39, 0
    buffer_load_dwordx4 v[16:19], v8, s[8:11], s25 offen
    buffer_load_dwordx4 v[20:23], v9, s[8:11], s25 offen
    buffer_load_dwordx4 v[24:27], v7, s[8:11], s32 offen
    buffer_load_dwordx4 v[28:31], v7, s[8:11], s33 offen
    buffer_load_dwordx4 v[32:35], v7, s[8:11], s34 offen
    buffer_load_dwordx4 v[36:39], v7, s[8:11], s35 offen
    buffer_load_dwordx4 v[40:43], v7, s[8:11], s36 offen
    s_mov_b32 s28, 10
wo_a2_kernel_loop0:
    s_add_u32 s25, s25, 64
    s_add_u32 s32, s32, 1024
    s_add_u32 s33, s33, 1024
    s_add_u32 s34, s34, 1024
    s_add_u32 s35, s35, 1024
    s_add_u32 s36, s36, 1024
    buffer_load_dwordx4 v[44:47], v8, s[8:11], s25 offen
    buffer_load_dwordx4 v[48:51], v9, s[8:11], s25 offen
    buffer_load_dwordx4 v[52:55], v7, s[8:11], s32 offen
    buffer_load_dwordx4 v[56:59], v7, s[8:11], s33 offen
    buffer_load_dwordx4 v[60:63], v7, s[8:11], s34 offen
    buffer_load_dwordx4 v[64:67], v7, s[8:11], s35 offen
    buffer_load_dwordx4 v[68:71], v7, s[8:11], s36 offen
    s_waitcnt vmcnt(7)
    v_mfma_f32_16x16x32_bf16 a[0:3], v[24:27], v[16:19], a[0:3]
    v_mfma_f32_16x16x32_bf16 a[20:23], v[24:27], v[20:23], a[20:23]
    v_mfma_f32_16x16x32_bf16 a[4:7], v[28:31], v[16:19], a[4:7]
    v_mfma_f32_16x16x32_bf16 a[24:27], v[28:31], v[20:23], a[24:27]
    v_mfma_f32_16x16x32_bf16 a[8:11], v[32:35], v[16:19], a[8:11]
    v_mfma_f32_16x16x32_bf16 a[28:31], v[32:35], v[20:23], a[28:31]
    v_mfma_f32_16x16x32_bf16 a[12:15], v[36:39], v[16:19], a[12:15]
    v_mfma_f32_16x16x32_bf16 a[32:35], v[36:39], v[20:23], a[32:35]
    v_mfma_f32_16x16x32_bf16 a[16:19], v[40:43], v[16:19], a[16:19]
    v_mfma_f32_16x16x32_bf16 a[36:39], v[40:43], v[20:23], a[36:39]
    s_sub_u32 s28, s28, 1
    s_cmp_eq_u32 s28, 0
    s_cbranch_scc1 wo_a2_kernel_loop0_last
    s_add_u32 s25, s25, 64
    s_add_u32 s32, s32, 1024
    s_add_u32 s33, s33, 1024
    s_add_u32 s34, s34, 1024
    s_add_u32 s35, s35, 1024
    s_add_u32 s36, s36, 1024
    buffer_load_dwordx4 v[16:19], v8, s[8:11], s25 offen
    buffer_load_dwordx4 v[20:23], v9, s[8:11], s25 offen
    buffer_load_dwordx4 v[24:27], v7, s[8:11], s32 offen
    buffer_load_dwordx4 v[28:31], v7, s[8:11], s33 offen
    buffer_load_dwordx4 v[32:35], v7, s[8:11], s34 offen
    buffer_load_dwordx4 v[36:39], v7, s[8:11], s35 offen
    buffer_load_dwordx4 v[40:43], v7, s[8:11], s36 offen
    s_waitcnt vmcnt(7)
    v_mfma_f32_16x16x32_bf16 a[0:3], v[52:55], v[44:47], a[0:3]
    v_mfma_f32_16x16x32_bf16 a[20:23], v[52:55], v[48:51], a[20:23]
    v_mfma_f32_16x16x32_bf16 a[4:7], v[56:59], v[44:47], a[4:7]
    v_mfma_f32_16x16x32_bf16 a[24:27], v[56:59], v[48:51], a[24:27]
    v_mfma_f32_16x16x32_bf16 a[8:11], v[60:63], v[44:47], a[8:11]
    v_mfma_f32_16x16x32_bf16 a[28:31], v[60:63], v[48:51], a[28:31]
    v_mfma_f32_16x16x32_bf16 a[12:15], v[64:67], v[44:47], a[12:15]
    v_mfma_f32_16x16x32_bf16 a[32:35], v[64:67], v[48:51], a[32:35]
    v_mfma_f32_16x16x32_bf16 a[16:19], v[68:71], v[44:47], a[16:19]
    v_mfma_f32_16x16x32_bf16 a[36:39], v[68:71], v[48:51], a[36:39]
    s_branch wo_a2_kernel_loop0
wo_a2_kernel_loop0_last:
    s_waitcnt vmcnt(0)
    v_mfma_f32_16x16x32_bf16 a[0:3], v[52:55], v[44:47], a[0:3]
    v_mfma_f32_16x16x32_bf16 a[20:23], v[52:55], v[48:51], a[20:23]
    v_mfma_f32_16x16x32_bf16 a[4:7], v[56:59], v[44:47], a[4:7]
    v_mfma_f32_16x16x32_bf16 a[24:27], v[56:59], v[48:51], a[24:27]
    v_mfma_f32_16x16x32_bf16 a[8:11], v[60:63], v[44:47], a[8:11]
    v_mfma_f32_16x16x32_bf16 a[28:31], v[60:63], v[48:51], a[28:31]
    v_mfma_f32_16x16x32_bf16 a[12:15], v[64:67], v[44:47], a[12:15]
    v_mfma_f32_16x16x32_bf16 a[32:35], v[64:67], v[48:51], a[32:35]
    v_mfma_f32_16x16x32_bf16 a[16:19], v[68:71], v[44:47], a[16:19]
    v_mfma_f32_16x16x32_bf16 a[36:39], v[68:71], v[48:51], a[36:39]
    s_nop 7
    s_nop 7
    s_mov_b32 s24, 1280
    v_add_u32 v5, s22, v3
    v_mul_lo_u32 v5, v5, s24
    v_lshlrev_b32 v6, 3, v4
    s_lshl_b32 s29, s23, 1
    v_add3_u32 v5, v5, v6, s29
    v_add_u32 v6, 247463936, v5
    buffer_load_dwordx2 v[72:73], v6, s[8:11], 0 offen
    v_accvgpr_read_b32 v76, a0
    v_accvgpr_read_b32 v77, a1
    v_accvgpr_read_b32 v78, a2
    v_accvgpr_read_b32 v79, a3
    v_cvt_pk_bf16_f32 v80, v76, v77
    v_cvt_pk_bf16_f32 v81, v78, v79
    s_waitcnt vmcnt(0)
    v_lshlrev_b32 v76, 16, v80
    v_and_b32 v77, 0xffff0000, v80
    v_lshlrev_b32 v82, 16, v72
    v_and_b32 v83, 0xffff0000, v72
    v_add_f32 v76, v76, v82
    v_add_f32 v77, v77, v83
    v_lshlrev_b32 v78, 16, v81
    v_and_b32 v79, 0xffff0000, v81
    v_lshlrev_b32 v82, 16, v73
    v_and_b32 v83, 0xffff0000, v73
    v_add_f32 v78, v78, v82
    v_add_f32 v79, v79, v83
    v_cvt_pk_bf16_f32 v80, v76, v77
    v_cvt_pk_bf16_f32 v81, v78, v79
    v_add_u32 v6, 226492416, v5
    buffer_store_dwordx2 v[80:81], v6, s[8:11], 0 offen
    v_add_u32 v6, 247463968, v5
    buffer_load_dwordx2 v[72:73], v6, s[8:11], 0 offen
    v_accvgpr_read_b32 v76, a4
    v_accvgpr_read_b32 v77, a5
    v_accvgpr_read_b32 v78, a6
    v_accvgpr_read_b32 v79, a7
    v_cvt_pk_bf16_f32 v80, v76, v77
    v_cvt_pk_bf16_f32 v81, v78, v79
    s_waitcnt vmcnt(0)
    v_lshlrev_b32 v76, 16, v80
    v_and_b32 v77, 0xffff0000, v80
    v_lshlrev_b32 v82, 16, v72
    v_and_b32 v83, 0xffff0000, v72
    v_add_f32 v76, v76, v82
    v_add_f32 v77, v77, v83
    v_lshlrev_b32 v78, 16, v81
    v_and_b32 v79, 0xffff0000, v81
    v_lshlrev_b32 v82, 16, v73
    v_and_b32 v83, 0xffff0000, v73
    v_add_f32 v78, v78, v82
    v_add_f32 v79, v79, v83
    v_cvt_pk_bf16_f32 v80, v76, v77
    v_cvt_pk_bf16_f32 v81, v78, v79
    v_add_u32 v6, 226492448, v5
    buffer_store_dwordx2 v[80:81], v6, s[8:11], 0 offen
    v_add_u32 v6, 247464000, v5
    buffer_load_dwordx2 v[72:73], v6, s[8:11], 0 offen
    v_accvgpr_read_b32 v76, a8
    v_accvgpr_read_b32 v77, a9
    v_accvgpr_read_b32 v78, a10
    v_accvgpr_read_b32 v79, a11
    v_cvt_pk_bf16_f32 v80, v76, v77
    v_cvt_pk_bf16_f32 v81, v78, v79
    s_waitcnt vmcnt(0)
    v_lshlrev_b32 v76, 16, v80
    v_and_b32 v77, 0xffff0000, v80
    v_lshlrev_b32 v82, 16, v72
    v_and_b32 v83, 0xffff0000, v72
    v_add_f32 v76, v76, v82
    v_add_f32 v77, v77, v83
    v_lshlrev_b32 v78, 16, v81
    v_and_b32 v79, 0xffff0000, v81
    v_lshlrev_b32 v82, 16, v73
    v_and_b32 v83, 0xffff0000, v73
    v_add_f32 v78, v78, v82
    v_add_f32 v79, v79, v83
    v_cvt_pk_bf16_f32 v80, v76, v77
    v_cvt_pk_bf16_f32 v81, v78, v79
    v_add_u32 v6, 226492480, v5
    buffer_store_dwordx2 v[80:81], v6, s[8:11], 0 offen
    v_add_u32 v6, 247464032, v5
    buffer_load_dwordx2 v[72:73], v6, s[8:11], 0 offen
    v_accvgpr_read_b32 v76, a12
    v_accvgpr_read_b32 v77, a13
    v_accvgpr_read_b32 v78, a14
    v_accvgpr_read_b32 v79, a15
    v_cvt_pk_bf16_f32 v80, v76, v77
    v_cvt_pk_bf16_f32 v81, v78, v79
    s_waitcnt vmcnt(0)
    v_lshlrev_b32 v76, 16, v80
    v_and_b32 v77, 0xffff0000, v80
    v_lshlrev_b32 v82, 16, v72
    v_and_b32 v83, 0xffff0000, v72
    v_add_f32 v76, v76, v82
    v_add_f32 v77, v77, v83
    v_lshlrev_b32 v78, 16, v81
    v_and_b32 v79, 0xffff0000, v81
    v_lshlrev_b32 v82, 16, v73
    v_and_b32 v83, 0xffff0000, v73
    v_add_f32 v78, v78, v82
    v_add_f32 v79, v79, v83
    v_cvt_pk_bf16_f32 v80, v76, v77
    v_cvt_pk_bf16_f32 v81, v78, v79
    v_add_u32 v6, 226492512, v5
    buffer_store_dwordx2 v[80:81], v6, s[8:11], 0 offen
    v_add_u32 v6, 247464064, v5
    buffer_load_dwordx2 v[72:73], v6, s[8:11], 0 offen
    v_accvgpr_read_b32 v76, a16
    v_accvgpr_read_b32 v77, a17
    v_accvgpr_read_b32 v78, a18
    v_accvgpr_read_b32 v79, a19
    v_cvt_pk_bf16_f32 v80, v76, v77
    v_cvt_pk_bf16_f32 v81, v78, v79
    s_waitcnt vmcnt(0)
    v_lshlrev_b32 v76, 16, v80
    v_and_b32 v77, 0xffff0000, v80
    v_lshlrev_b32 v82, 16, v72
    v_and_b32 v83, 0xffff0000, v72
    v_add_f32 v76, v76, v82
    v_add_f32 v77, v77, v83
    v_lshlrev_b32 v78, 16, v81
    v_and_b32 v79, 0xffff0000, v81
    v_lshlrev_b32 v82, 16, v73
    v_and_b32 v83, 0xffff0000, v73
    v_add_f32 v78, v78, v82
    v_add_f32 v79, v79, v83
    v_cvt_pk_bf16_f32 v80, v76, v77
    v_cvt_pk_bf16_f32 v81, v78, v79
    v_add_u32 v6, 226492544, v5
    buffer_store_dwordx2 v[80:81], v6, s[8:11], 0 offen
    v_add_u32 v6, 247484416, v5
    buffer_load_dwordx2 v[72:73], v6, s[8:11], 0 offen
    v_accvgpr_read_b32 v76, a20
    v_accvgpr_read_b32 v77, a21
    v_accvgpr_read_b32 v78, a22
    v_accvgpr_read_b32 v79, a23
    v_cvt_pk_bf16_f32 v80, v76, v77
    v_cvt_pk_bf16_f32 v81, v78, v79
    s_waitcnt vmcnt(0)
    v_lshlrev_b32 v76, 16, v80
    v_and_b32 v77, 0xffff0000, v80
    v_lshlrev_b32 v82, 16, v72
    v_and_b32 v83, 0xffff0000, v72
    v_add_f32 v76, v76, v82
    v_add_f32 v77, v77, v83
    v_lshlrev_b32 v78, 16, v81
    v_and_b32 v79, 0xffff0000, v81
    v_lshlrev_b32 v82, 16, v73
    v_and_b32 v83, 0xffff0000, v73
    v_add_f32 v78, v78, v82
    v_add_f32 v79, v79, v83
    v_cvt_pk_bf16_f32 v80, v76, v77
    v_cvt_pk_bf16_f32 v81, v78, v79
    v_add_u32 v6, 226512896, v5
    buffer_store_dwordx2 v[80:81], v6, s[8:11], 0 offen
    v_add_u32 v6, 247484448, v5
    buffer_load_dwordx2 v[72:73], v6, s[8:11], 0 offen
    v_accvgpr_read_b32 v76, a24
    v_accvgpr_read_b32 v77, a25
    v_accvgpr_read_b32 v78, a26
    v_accvgpr_read_b32 v79, a27
    v_cvt_pk_bf16_f32 v80, v76, v77
    v_cvt_pk_bf16_f32 v81, v78, v79
    s_waitcnt vmcnt(0)
    v_lshlrev_b32 v76, 16, v80
    v_and_b32 v77, 0xffff0000, v80
    v_lshlrev_b32 v82, 16, v72
    v_and_b32 v83, 0xffff0000, v72
    v_add_f32 v76, v76, v82
    v_add_f32 v77, v77, v83
    v_lshlrev_b32 v78, 16, v81
    v_and_b32 v79, 0xffff0000, v81
    v_lshlrev_b32 v82, 16, v73
    v_and_b32 v83, 0xffff0000, v73
    v_add_f32 v78, v78, v82
    v_add_f32 v79, v79, v83
    v_cvt_pk_bf16_f32 v80, v76, v77
    v_cvt_pk_bf16_f32 v81, v78, v79
    v_add_u32 v6, 226512928, v5
    buffer_store_dwordx2 v[80:81], v6, s[8:11], 0 offen
    v_add_u32 v6, 247484480, v5
    buffer_load_dwordx2 v[72:73], v6, s[8:11], 0 offen
    v_accvgpr_read_b32 v76, a28
    v_accvgpr_read_b32 v77, a29
    v_accvgpr_read_b32 v78, a30
    v_accvgpr_read_b32 v79, a31
    v_cvt_pk_bf16_f32 v80, v76, v77
    v_cvt_pk_bf16_f32 v81, v78, v79
    s_waitcnt vmcnt(0)
    v_lshlrev_b32 v76, 16, v80
    v_and_b32 v77, 0xffff0000, v80
    v_lshlrev_b32 v82, 16, v72
    v_and_b32 v83, 0xffff0000, v72
    v_add_f32 v76, v76, v82
    v_add_f32 v77, v77, v83
    v_lshlrev_b32 v78, 16, v81
    v_and_b32 v79, 0xffff0000, v81
    v_lshlrev_b32 v82, 16, v73
    v_and_b32 v83, 0xffff0000, v73
    v_add_f32 v78, v78, v82
    v_add_f32 v79, v79, v83
    v_cvt_pk_bf16_f32 v80, v76, v77
    v_cvt_pk_bf16_f32 v81, v78, v79
    v_add_u32 v6, 226512960, v5
    buffer_store_dwordx2 v[80:81], v6, s[8:11], 0 offen
    v_add_u32 v6, 247484512, v5
    buffer_load_dwordx2 v[72:73], v6, s[8:11], 0 offen
    v_accvgpr_read_b32 v76, a32
    v_accvgpr_read_b32 v77, a33
    v_accvgpr_read_b32 v78, a34
    v_accvgpr_read_b32 v79, a35
    v_cvt_pk_bf16_f32 v80, v76, v77
    v_cvt_pk_bf16_f32 v81, v78, v79
    s_waitcnt vmcnt(0)
    v_lshlrev_b32 v76, 16, v80
    v_and_b32 v77, 0xffff0000, v80
    v_lshlrev_b32 v82, 16, v72
    v_and_b32 v83, 0xffff0000, v72
    v_add_f32 v76, v76, v82
    v_add_f32 v77, v77, v83
    v_lshlrev_b32 v78, 16, v81
    v_and_b32 v79, 0xffff0000, v81
    v_lshlrev_b32 v82, 16, v73
    v_and_b32 v83, 0xffff0000, v73
    v_add_f32 v78, v78, v82
    v_add_f32 v79, v79, v83
    v_cvt_pk_bf16_f32 v80, v76, v77
    v_cvt_pk_bf16_f32 v81, v78, v79
    v_add_u32 v6, 226512992, v5
    buffer_store_dwordx2 v[80:81], v6, s[8:11], 0 offen
    v_add_u32 v6, 247484544, v5
    buffer_load_dwordx2 v[72:73], v6, s[8:11], 0 offen
    v_accvgpr_read_b32 v76, a36
    v_accvgpr_read_b32 v77, a37
    v_accvgpr_read_b32 v78, a38
    v_accvgpr_read_b32 v79, a39
    v_cvt_pk_bf16_f32 v80, v76, v77
    v_cvt_pk_bf16_f32 v81, v78, v79
    s_waitcnt vmcnt(0)
    v_lshlrev_b32 v76, 16, v80
    v_and_b32 v77, 0xffff0000, v80
    v_lshlrev_b32 v82, 16, v72
    v_and_b32 v83, 0xffff0000, v72
    v_add_f32 v76, v76, v82
    v_add_f32 v77, v77, v83
    v_lshlrev_b32 v78, 16, v81
    v_and_b32 v79, 0xffff0000, v81
    v_lshlrev_b32 v82, 16, v73
    v_and_b32 v83, 0xffff0000, v73
    v_add_f32 v78, v78, v82
    v_add_f32 v79, v79, v83
    v_cvt_pk_bf16_f32 v80, v76, v77
    v_cvt_pk_bf16_f32 v81, v78, v79
    v_add_u32 v6, 226513024, v5
    buffer_store_dwordx2 v[80:81], v6, s[8:11], 0 offen
wo_a2_kernel_end:
    s_endpgm
.section .rodata,"a"
.p2align 6
.amdhsa_kernel wo_a2_kernel
  .amdhsa_next_free_vgpr 136
  .amdhsa_next_free_sgpr 64
  .amdhsa_accum_offset 96
  .amdhsa_group_segment_fixed_size 0
  .amdhsa_kernarg_size 104
  .amdhsa_user_sgpr_count 2
  .amdhsa_user_sgpr_kernarg_segment_ptr 1
  .amdhsa_system_sgpr_workgroup_id_x 1
.end_amdhsa_kernel
.text
.globl ln_b2_kernel
.p2align 8
.type ln_b2_kernel,@function
ln_b2_kernel:
    s_cmp_gt_u32 s2, 512
    s_cbranch_scc1 ln_b2_kernel_end
    s_load_dwordx2 s[4:5], s[0:1], 96
    s_load_dwordx2 s[6:7], s[0:1], 32
    v_lshrrev_b32 v1, 6, v0
    v_and_b32 v0, 63, v0
    s_nop 0
    v_readfirstlane_b32 s13, v1
    s_waitcnt lgkmcnt(0)
    s_mov_b32 s8, s4
    s_mov_b32 s9, s5
    s_mov_b32 s10, 268435456
    s_mov_b32 s11, 0x00020000
    s_cmp_eq_u32 s2, 512
    s_cbranch_scc1 ln_b2_kernel_mem0
    s_lshl_b32 s20, s2, 2
    s_add_u32 s20, s20, s13
    s_mul_i32 s21, s20, 1280
    s_add_u32 s21, s21, 226492416
    v_lshlrev_b32 v3, 2, v0
    buffer_load_dword v4, v3, s[8:11], s21 offen offset:0
    buffer_load_dword v5, v3, s[8:11], s21 offen offset:256
    buffer_load_dword v6, v3, s[8:11], s21 offen offset:512
    buffer_load_dword v7, v3, s[8:11], s21 offen offset:768
    buffer_load_dword v8, v3, s[8:11], s21 offen offset:1024
    v_lshrrev_b32 v20, 4, v0
    v_lshlrev_b32 v20, 2, v20
    v_bfe_u32 v21, v0, 3, 1
    v_lshl_add_u32 v20, v21, 1, v20
    v_bfe_u32 v21, v0, 1, 1
    v_add_u32 v20, v20, v21
    v_lshlrev_b32 v20, 9, v20
    v_and_b32 v21, 1, v0
    v_lshl_add_u32 v20, v21, 3, v20
    v_bfe_u32 v21, v0, 2, 1
    v_lshl_add_u32 v23, v21, 2, v20
    s_lshr_b32 s22, s20, 5
    s_mul_i32 s22, s22, 40960
    s_and_b32 s23, s20, 31
    s_lshl_b32 s23, s23, 4
    s_add_u32 s22, s22, s23
    s_add_u32 s22, s22, 220200960
    s_waitcnt vmcnt(0)
    v_lshlrev_b32 v10, 16, v4
    v_and_b32 v11, 0xffff0000, v4
    v_lshlrev_b32 v12, 16, v5
    v_and_b32 v13, 0xffff0000, v5
    v_lshlrev_b32 v14, 16, v6
    v_and_b32 v15, 0xffff0000, v6
    v_lshlrev_b32 v16, 16, v7
    v_and_b32 v17, 0xffff0000, v7
    v_lshlrev_b32 v18, 16, v8
    v_and_b32 v19, 0xffff0000, v8
    v_add_f32 v20, v10, v11
    v_add_f32 v20, v20, v12
    v_add_f32 v20, v20, v13
    v_add_f32 v20, v20, v14
    v_add_f32 v20, v20, v15
    v_add_f32 v20, v20, v16
    v_add_f32 v20, v20, v17
    v_add_f32 v20, v20, v18
    v_add_f32 v20, v20, v19
    s_nop 1
    v_add_f32 v21, v20, v20 quad_perm:[1,0,3,2] row_mask:0xf bank_mask:0xf
    s_nop 1
    v_add_f32 v21, v21, v21 quad_perm:[2,3,0,1] row_mask:0xf bank_mask:0xf
    s_nop 1
    v_add_f32 v21, v21, v21 row_half_mirror row_mask:0xf bank_mask:0xf
    s_nop 1
    v_add_f32 v21, v21, v21 row_mirror row_mask:0xf bank_mask:0xf
    s_nop 1
    v_readlane_b32 s24, v21, 0
    v_readlane_b32 s25, v21, 16
    v_readlane_b32 s26, v21, 32
    v_readlane_b32 s27, v21, 48
    s_nop 1
    v_mov_b32 v20, s24
    v_add_f32 v20, s25, v20
    v_add_f32 v20, s26, v20
    v_add_f32 v20, s27, v20
    v_mul_f32 v20, 0x3acccccd, v20
    v_sub_f32 v10, v10, v20
    v_sub_f32 v11, v11, v20
    v_sub_f32 v12, v12, v20
    v_sub_f32 v13, v13, v20
    v_sub_f32 v14, v14, v20
    v_sub_f32 v15, v15, v20
    v_sub_f32 v16, v16, v20
    v_sub_f32 v17, v17, v20
    v_sub_f32 v18, v18, v20
    v_sub_f32 v19, v19, v20
    v_mul_f32 v21, v10, v10
    v_fmac_f32 v21, v11, v11
    v_fmac_f32 v21, v12, v12
    v_fmac_f32 v21, v13, v13
    v_fmac_f32 v21, v14, v14
    v_fmac_f32 v21, v15, v15
    v_fmac_f32 v21, v16, v16
    v_fmac_f32 v21, v17, v17
    v_fmac_f32 v21, v18, v18
    v_fmac_f32 v21, v19, v19
    s_nop 1
    v_add_f32 v22, v21, v21 quad_perm:[1,0,3,2] row_mask:0xf bank_mask:0xf
    s_nop 1
    v_add_f32 v22, v22, v22 quad_perm:[2,3,0,1] row_mask:0xf bank_mask:0xf
    s_nop 1
    v_add_f32 v22, v22, v22 row_half_mirror row_mask:0xf bank_mask:0xf
    s_nop 1
    v_add_f32 v22, v22, v22 row_mirror row_mask:0xf bank_mask:0xf
    s_nop 1
    v_readlane_b32 s24, v22, 0
    v_readlane_b32 s25, v22, 16
    v_readlane_b32 s26, v22, 32
    v_readlane_b32 s27, v22, 48
    s_nop 1
    v_mov_b32 v21, s24
    v_add_f32 v21, s25, v21
    v_add_f32 v21, s26, v21
    v_add_f32 v21, s27, v21
    v_mov_b32 v22, 0x3727c5ac
    v_fmac_f32 v22, 0x3acccccd, v21
    v_rsq_f32 v22, v22
    s_nop 0
    v_mul_f32 v10, v10, v22
    v_mul_f32 v11, v11, v22
    v_mul_f32 v12, v12, v22
    v_mul_f32 v13, v13, v22
    v_mul_f32 v14, v14, v22
    v_mul_f32 v15, v15, v22
    v_mul_f32 v16, v16, v22
    v_mul_f32 v17, v17, v22
    v_mul_f32 v18, v18, v22
    v_mul_f32 v19, v19, v22
    v_cvt_pk_bf16_f32 v4, v10, v11
    v_cvt_pk_bf16_f32 v5, v12, v13
    v_cvt_pk_bf16_f32 v6, v14, v15
    v_cvt_pk_bf16_f32 v7, v16, v17
    v_cvt_pk_bf16_f32 v8, v18, v19
    s_add_u32 s23, s22, 0
    buffer_store_dword v4, v23, s[8:11], s23 offen
    s_add_u32 s23, s22, 8192
    buffer_store_dword v5, v23, s[8:11], s23 offen
    s_add_u32 s23, s22, 16384
    buffer_store_dword v6, v23, s[8:11], s23 offen
    s_add_u32 s23, s22, 24576
    buffer_store_dword v7, v23, s[8:11], s23 offen
    s_add_u32 s23, s22, 32768
    buffer_store_dword v8, v23, s[8:11], s23 offen
    s_branch ln_b2_kernel_end
ln_b2_kernel_mem0:
    s_mov_b32 s16, s6
    s_mov_b32 s17, s7
    s_mov_b32 s18, 10240
    s_mov_b32 s19, 0x00020000
    s_sub_u32 s22, 0, s4
    s_and_b32 s22, s22, 0x1fffff
    s_mov_b32 s23, 10551304
    s_buffer_load_dword s24, s[8:11], s23
    s_waitcnt lgkmcnt(0)
    s_and_b32 s24, s24, 8192
    s_add_u32 s22, s22, s24
    s_add_u32 s22, s22, 4194304
    s_lshl_b32 s25, s13, 6
    v_add_u32 v1, s25, v0
    v_add_u32 v2, 0, v1
    v_and_b32 v3, 7, v2
    v_mul_u32_u24 v3, 1280, v3
    v_lshrrev_b32 v4, 3, v2
    v_lshl_add_u32 v3, v4, 4, v3
    v_lshlrev_b32 v5, 4, v2
    v_add_u32 v5, 20480, v5
    v_lshrrev_b32 v6, 13, v5
    v_lshlrev_b32 v6, 14, v6
    v_and_b32 v5, 8191, v5
    v_add_u32 v5, v5, v6
    v_cmp_gt_u32 vcc, 640, v2
    s_and_saveexec_b64 s[30:31], vcc
    s_cbranch_execz ln_b2_kernel_m0s0
    buffer_load_dwordx4 v[8:11], v3, s[16:19], 0 offen
    s_waitcnt vmcnt(0)
    buffer_store_dwordx4 v[8:11], v5, s[8:11], s22 offen
ln_b2_kernel_m0s0:
    s_mov_b64 exec, s[30:31]
    v_add_u32 v2, 256, v1
    v_and_b32 v3, 7, v2
    v_mul_u32_u24 v3, 1280, v3
    v_lshrrev_b32 v4, 3, v2
    v_lshl_add_u32 v3, v4, 4, v3
    v_lshlrev_b32 v5, 4, v2
    v_add_u32 v5, 20480, v5
    v_lshrrev_b32 v6, 13, v5
    v_lshlrev_b32 v6, 14, v6
    v_and_b32 v5, 8191, v5
    v_add_u32 v5, v5, v6
    v_cmp_gt_u32 vcc, 640, v2
    s_and_saveexec_b64 s[30:31], vcc
    s_cbranch_execz ln_b2_kernel_m0s1
    buffer_load_dwordx4 v[8:11], v3, s[16:19], 0 offen
    s_waitcnt vmcnt(0)
    buffer_store_dwordx4 v[8:11], v5, s[8:11], s22 offen
ln_b2_kernel_m0s1:
    s_mov_b64 exec, s[30:31]
    v_add_u32 v2, 512, v1
    v_and_b32 v3, 7, v2
    v_mul_u32_u24 v3, 1280, v3
    v_lshrrev_b32 v4, 3, v2
    v_lshl_add_u32 v3, v4, 4, v3
    v_lshlrev_b32 v5, 4, v2
    v_add_u32 v5, 20480, v5
    v_lshrrev_b32 v6, 13, v5
    v_lshlrev_b32 v6, 14, v6
    v_and_b32 v5, 8191, v5
    v_add_u32 v5, v5, v6
    v_cmp_gt_u32 vcc, 640, v2
    s_and_saveexec_b64 s[30:31], vcc
    s_cbranch_execz ln_b2_kernel_m0s2
    buffer_load_dwordx4 v[8:11], v3, s[16:19], 0 offen
    s_waitcnt vmcnt(0)
    buffer_store_dwordx4 v[8:11], v5, s[8:11], s22 offen
ln_b2_kernel_m0s2:
    s_mov_b64 exec, s[30:31]
ln_b2_kernel_end:
    s_endpgm
.section .rodata,"a"
.p2align 6
.amdhsa_kernel ln_b2_kernel
  .amdhsa_next_free_vgpr 32
  .amdhsa_next_free_sgpr 48
  .amdhsa_accum_offset 32
  .amdhsa_group_segment_fixed_size 0
  .amdhsa_kernarg_size 104
  .amdhsa_user_sgpr_count 2
  .amdhsa_user_sgpr_kernarg_segment_ptr 1
  .amdhsa_system_sgpr_workgroup_id_x 1
.end_amdhsa_kernel
```

```asm
; @launch kernel=pack_kernel grid=(864,1,1) block=(256,1,1) lds=0
; @launch kernel=prep_kernel grid=(465,1,1) block=(256,1,1) lds=0
; @launch kernel=ln_a1_kernel grid=(512,1,1) block=(256,1,1) lds=0
; @launch kernel=qkv_a_kernel grid=(192,1,1) block=(256,1,1) lds=0
; @launch kernel=kvz_a1_kernel grid=(128,1,1) block=(256,1,1) lds=0
; @launch kernel=attn_a1_kernel grid=(256,1,1) block=(256,1,1) lds=86016
; @launch kernel=wo_a1_kernel grid=(128,1,1) block=(256,1,1) lds=0
; @launch kernel=ln_b1_kernel grid=(513,1,1) block=(256,1,1) lds=0
; @launch kernel=layerb1_kernel grid=(256,1,1) block=(256,1,1) lds=143616
; @launch kernel=ln_a2_kernel grid=(512,1,1) block=(256,1,1) lds=0
; @launch kernel=qkv_a_kernel grid=(192,1,1) block=(256,1,1) lds=0
; @launch kernel=kvz_a2_kernel grid=(128,1,1) block=(256,1,1) lds=0
; @launch kernel=attn_a2_kernel grid=(256,1,1) block=(256,1,1) lds=86016
; @launch kernel=wo_a2_kernel grid=(128,1,1) block=(256,1,1) lds=0
; @launch kernel=ln_b2_kernel grid=(513,1,1) block=(256,1,1) lds=0
; @launch kernel=layerb2_kernel grid=(256,1,1) block=(256,1,1) lds=143616
.amdgcn_target "amdgcn-amd-amdhsa--gfx950"
.text
.globl pack_kernel
.p2align 8
.type pack_kernel,@function
pack_kernel:
    v_lshrrev_b32 v1, 6, v0
    v_and_b32 v2, 63, v0
    s_nop 0
    v_readfirstlane_b32 s3, v1
    s_lshl_b32 s4, s2, 2
    s_add_u32 s4, s4, s3
    s_load_dwordx2 s[6:7], s[0:1], 96
    s_waitcnt lgkmcnt(0)
    s_mov_b32 s8, s6
    s_mov_b32 s9, s7
    s_mov_b32 s10, 268435456
    s_mov_b32 s11, 0x00020000
    s_cmp_lt_u32 s4, 3200
    s_cbranch_scc1 pack_kernel_pk
    s_cmp_ge_u32 s4, 3456
    s_cbranch_scc1 pack_kernel_end
    s_sub_u32 s4, s4, 3200
    s_lshl_b32 s5, s4, 10
    v_lshlrev_b32 v3, 4, v2
    v_add_u32 v3, s5, v3
    v_add_u32 v4, 242221056, v3
    s_cmp_lt_u32 s5, 0
    s_cbranch_scc1 pack_kernel_clr
    v_add_u32 v4, 242221056, v3
pack_kernel_clr:
    v_mov_b32 v8, 0
    v_mov_b32 v9, 0
    v_mov_b32 v10, 0
    v_mov_b32 v11, 0
    buffer_store_dwordx4 v[8:11], v4, s[8:11], 0 offen
    s_branch pack_kernel_end
pack_kernel_pk:
    s_cmp_lt_u32 s4, 2400
    s_cbranch_scc0 pack_kernel_nx0
    s_sub_u32 s4, s4, 0
    s_load_dwordx2 s[12:13], s[0:1], 8
    s_mov_b32 s20, 1920
    s_mov_b32 s21, 20
    s_mov_b32 s22, 243269632
    s_mov_b32 s23, 2457600
    s_mul_i32 s24, s4, 1639
    s_lshr_b32 s24, s24, 15
    s_branch pack_kernel_go
pack_kernel_nx0:
    s_cmp_lt_u32 s4, 3200
    s_cbranch_scc0 pack_kernel_nx1
    s_sub_u32 s4, s4, 2400
    s_load_dwordx2 s[12:13], s[0:1], 16
    s_mov_b32 s20, 640
    s_mov_b32 s21, 20
    s_mov_b32 s22, 246415360
    s_mov_b32 s23, 819200
    s_mul_i32 s24, s4, 205
    s_lshr_b32 s24, s24, 12
    s_branch pack_kernel_go
pack_kernel_nx1:
    s_branch pack_kernel_end
pack_kernel_go:
    s_waitcnt lgkmcnt(0)
    s_mov_b32 s16, s12
    s_mov_b32 s17, s13
    s_mov_b32 s18, s23
    s_mov_b32 s19, 0x00020000
    s_mul_i32 s25, s24, s21
    s_sub_u32 s25, s4, s25
    v_lshrrev_b32 v3, 4, v2
    v_lshlrev_b32 v3, 3, v3
    s_lshl_b32 s26, s25, 5
    v_add_u32 v3, s26, v3
    v_mul_lo_u32 v3, v3, s20
    v_and_b32 v4, 15, v2
    s_lshl_b32 s27, s24, 4
    v_add3_u32 v3, v3, v4, s27
    v_lshlrev_b32 v3, 1, v3
    s_lshl_b32 s28, s20, 1
    s_mov_b32 s29, 0
    buffer_load_ushort v12, v3, s[16:19], s29 offen
    s_add_u32 s29, s29, s28
    buffer_load_ushort v13, v3, s[16:19], s29 offen
    s_add_u32 s29, s29, s28
    buffer_load_ushort v14, v3, s[16:19], s29 offen
    s_add_u32 s29, s29, s28
    buffer_load_ushort v15, v3, s[16:19], s29 offen
    s_add_u32 s29, s29, s28
    buffer_load_ushort v16, v3, s[16:19], s29 offen
    s_add_u32 s29, s29, s28
    buffer_load_ushort v17, v3, s[16:19], s29 offen
    s_add_u32 s29, s29, s28
    buffer_load_ushort v18, v3, s[16:19], s29 offen
    s_add_u32 s29, s29, s28
    buffer_load_ushort v19, v3, s[16:19], s29 offen
    s_lshl_b32 s5, s4, 10
    s_add_u32 s5, s5, s22
    v_lshlrev_b32 v5, 4, v2
    v_add_u32 v5, s5, v5
    s_waitcnt vmcnt(0)
    v_lshl_or_b32 v8, v13, 16, v12
    v_lshl_or_b32 v9, v15, 16, v14
    v_lshl_or_b32 v10, v17, 16, v16
    v_lshl_or_b32 v11, v19, 16, v18
    buffer_store_dwordx4 v[8:11], v5, s[8:11], 0 offen
pack_kernel_end:
    s_endpgm
.section .rodata,"a"
.p2align 6
.amdhsa_kernel pack_kernel
  .amdhsa_next_free_vgpr 24
  .amdhsa_next_free_sgpr 40
  .amdhsa_accum_offset 24
  .amdhsa_group_segment_fixed_size 0
  .amdhsa_kernarg_size 104
  .amdhsa_user_sgpr_count 2
  .amdhsa_user_sgpr_kernarg_segment_ptr 1
  .amdhsa_system_sgpr_workgroup_id_x 1
.end_amdhsa_kernel
.text
.globl prep_kernel
.p2align 8
.type prep_kernel,@function
prep_kernel:
    s_cmp_ge_u32 s2, 465
    s_cbranch_scc1 prep_kernel_end
    s_load_dwordx2 s[4:5], s[0:1], 96
    v_lshrrev_b32 v1, 6, v0
    v_and_b32 v0, 63, v0
    s_nop 0
    v_readfirstlane_b32 s13, v1
    s_waitcnt lgkmcnt(0)
    s_mov_b32 s8, s4
    s_mov_b32 s9, s5
    s_mov_b32 s10, 268435456
    s_mov_b32 s11, 0x00020000
    s_cmp_eq_u32 s2, 0
    s_cbranch_scc1 prep_kernel_r_ctl
    s_sub_u32 s20, s2, 1
    s_cmp_lt_u32 s20, 160
    s_cbranch_scc1 prep_kernel_r_wvo
    s_sub_u32 s20, s20, 160
    s_cmp_lt_u32 s20, 240
    s_cbranch_scc1 prep_kernel_r_pwp
    s_sub_u32 s20, s20, 240
    s_sub_u32 s21, 0, s4
    s_and_b32 s21, s21, 0x1fffff
    s_mul_i32 s22, s20, 131072
    s_add_u32 s21, s21, s22
    s_lshl_b32 s22, s13, 10
    s_add_u32 s21, s21, s22
    v_lshlrev_b32 v1, 4, v0
    v_mov_b32 v4, -1
    v_mov_b32 v5, -1
    v_mov_b32 v6, -1
    v_mov_b32 v7, -1
    s_mov_b32 s22, 32
prep_kernel_clr_loop:
    buffer_store_dwordx4 v[4:7], v1, s[8:11], s21 offen
    s_add_u32 s21, s21, 4096
    s_sub_u32 s22, s22, 1
    s_cmp_lg_u32 s22, 0
    s_cbranch_scc1 prep_kernel_clr_loop
    s_branch prep_kernel_end
prep_kernel_r_ctl:
    v_lshlrev_b32 v1, 4, v0
    v_mov_b32 v4, 0
    v_mov_b32 v5, 0
    v_mov_b32 v6, 0
    v_mov_b32 v7, 0
    s_lshl_b32 s21, s13, 10
    s_add_u32 s21, s21, 10485760
    buffer_store_dwordx4 v[4:7], v1, s[8:11], s21 offen
    s_lshl_b32 s21, s13, 14
    s_add_u32 s21, s21, 10616832
    buffer_store_dwordx4 v[4:7], v1, s[8:11], s21 offen offset:0
    buffer_store_dwordx4 v[4:7], v1, s[8:11], s21 offen offset:1024
    buffer_store_dwordx4 v[4:7], v1, s[8:11], s21 offen offset:2048
    buffer_store_dwordx4 v[4:7], v1, s[8:11], s21 offen offset:3072
    s_add_u32 s21, s21, 4096
    buffer_store_dwordx4 v[4:7], v1, s[8:11], s21 offen offset:0
    buffer_store_dwordx4 v[4:7], v1, s[8:11], s21 offen offset:1024
    buffer_store_dwordx4 v[4:7], v1, s[8:11], s21 offen offset:2048
    buffer_store_dwordx4 v[4:7], v1, s[8:11], s21 offen offset:3072
    s_add_u32 s21, s21, 4096
    buffer_store_dwordx4 v[4:7], v1, s[8:11], s21 offen offset:0
    buffer_store_dwordx4 v[4:7], v1, s[8:11], s21 offen offset:1024
    buffer_store_dwordx4 v[4:7], v1, s[8:11], s21 offen offset:2048
    buffer_store_dwordx4 v[4:7], v1, s[8:11], s21 offen offset:3072
    s_add_u32 s21, s21, 4096
    buffer_store_dwordx4 v[4:7], v1, s[8:11], s21 offen offset:0
    buffer_store_dwordx4 v[4:7], v1, s[8:11], s21 offen offset:1024
    buffer_store_dwordx4 v[4:7], v1, s[8:11], s21 offen offset:2048
    buffer_store_dwordx4 v[4:7], v1, s[8:11], s21 offen offset:3072
    s_add_u32 s21, s21, 4096
    s_sub_u32 s22, 0, s4
    s_and_b32 s22, s22, 0x1fffff
    s_getreg_b32 s23, hwreg(HW_REG_XCC_ID)
    s_bfe_u32 s23, s23, 0x10002
    s_mov_b64 exec, 1
    v_mov_b32 v1, 0
    s_mul_i32 s24, s13, 2097152
    s_add_u32 s22, s22, s24
    s_add_u32 s22, s22, 2086912
    s_mov_b32 s30, -1
    s_mov_b32 s31, -1
    s_mov_b32 s25, 5
prep_kernel_cal:
    s_add_u32 s24, s22, 0
    s_memrealtime s[26:27]
    s_waitcnt lgkmcnt(0)
    buffer_store_dword v1, v1, s[8:11], s24 offen sc1
    s_waitcnt vmcnt(0)
    buffer_load_dword v2, v1, s[8:11], s24 offen sc1
    s_waitcnt vmcnt(0)
    s_memrealtime s[28:29]
    s_waitcnt lgkmcnt(0)
    s_sub_u32 s26, s28, s26
    s_min_u32 s30, s30, s26
    s_add_u32 s24, s22, 8192
    s_memrealtime s[26:27]
    s_waitcnt lgkmcnt(0)
    buffer_store_dword v1, v1, s[8:11], s24 offen sc1
    s_waitcnt vmcnt(0)
    buffer_load_dword v2, v1, s[8:11], s24 offen sc1
    s_waitcnt vmcnt(0)
    s_memrealtime s[28:29]
    s_waitcnt lgkmcnt(0)
    s_sub_u32 s26, s28, s26
    s_min_u32 s31, s31, s26
    s_sub_u32 s25, s25, 1
    s_cmp_lg_u32 s25, 0
    s_cbranch_scc1 prep_kernel_cal
    s_cmp_lt_u32 s31, s30
    s_cselect_b32 s24, 1, 0
    s_xor_b32 s24, s24, s23
    s_lshl_b32 s24, s24, 13
    v_mov_b32 v3, s24
    s_lshl_b32 s25, s13, 2
    s_add_u32 s25, s25, 10551296
    buffer_store_dword v3, v1, s[8:11], s25 offen
    s_lshl_b32 s26, s30, 16
    s_or_b32 s26, s26, s31
    v_mov_b32 v3, s26
    buffer_store_dword v3, v1, s[8:11], s25 offen offset:64
    s_branch prep_kernel_end
prep_kernel_r_wvo:
    s_lshl_b32 s20, s20, 2
    s_add_u32 s20, s20, s13
    s_load_dwordx2 s[24:25], s[0:1], 56
    s_load_dwordx2 s[26:27], s[0:1], 64
    s_and_b32 s21, s20, 1
    s_lshr_b32 s22, s20, 1
    s_mul_i32 s23, s22, 205
    s_lshr_b32 s23, s23, 11
    s_mul_i32 s28, s23, 10
    s_sub_u32 s22, s22, s28
    s_waitcnt lgkmcnt(0)
    s_mov_b32 s32, s24
    s_mov_b32 s33, s25
    s_mov_b32 s34, 7864320
    s_mov_b32 s35, 0x00020000
    s_mov_b32 s36, s26
    s_mov_b32 s37, s27
    s_mov_b32 s38, 7864320
    s_mov_b32 s39, 0x00020000
    v_and_b32 v1, 31, v0
    v_lshrrev_b32 v2, 5, v0
    v_mul_u32_u24 v3, 10240, v2
    v_lshl_add_u32 v3, v1, 2, v3
    s_mul_i32 s28, s23, 245760
    s_lshl_b32 s29, s22, 7
    s_add_u32 s28, s28, s29
    s_add_u32 s29, s28, 0
    buffer_load_dword v112, v3, s[36:39], s29 offen
    s_add_u32 s29, s28, 1280
    buffer_load_dword v113, v3, s[36:39], s29 offen
    s_add_u32 s29, s28, 2560
    buffer_load_dword v114, v3, s[36:39], s29 offen
    s_add_u32 s29, s28, 3840
    buffer_load_dword v115, v3, s[36:39], s29 offen
    s_add_u32 s29, s28, 5120
    buffer_load_dword v116, v3, s[36:39], s29 offen
    s_add_u32 s29, s28, 6400
    buffer_load_dword v117, v3, s[36:39], s29 offen
    s_add_u32 s29, s28, 7680
    buffer_load_dword v118, v3, s[36:39], s29 offen
    s_add_u32 s29, s28, 8960
    buffer_load_dword v119, v3, s[36:39], s29 offen
    s_add_u32 s29, s28, 20480
    buffer_load_dword v120, v3, s[36:39], s29 offen
    s_add_u32 s29, s28, 21760
    buffer_load_dword v121, v3, s[36:39], s29 offen
    s_add_u32 s29, s28, 23040
    buffer_load_dword v122, v3, s[36:39], s29 offen
    s_add_u32 s29, s28, 24320
    buffer_load_dword v123, v3, s[36:39], s29 offen
    s_add_u32 s29, s28, 25600
    buffer_load_dword v124, v3, s[36:39], s29 offen
    s_add_u32 s29, s28, 26880
    buffer_load_dword v125, v3, s[36:39], s29 offen
    s_add_u32 s29, s28, 28160
    buffer_load_dword v126, v3, s[36:39], s29 offen
    s_add_u32 s29, s28, 29440
    buffer_load_dword v127, v3, s[36:39], s29 offen
    s_add_u32 s29, s28, 40960
    buffer_load_dword v128, v3, s[36:39], s29 offen
    s_add_u32 s29, s28, 42240
    buffer_load_dword v129, v3, s[36:39], s29 offen
    s_add_u32 s29, s28, 43520
    buffer_load_dword v130, v3, s[36:39], s29 offen
    s_add_u32 s29, s28, 44800
    buffer_load_dword v131, v3, s[36:39], s29 offen
    s_add_u32 s29, s28, 46080
    buffer_load_dword v132, v3, s[36:39], s29 offen
    s_add_u32 s29, s28, 47360
    buffer_load_dword v133, v3, s[36:39], s29 offen
    s_add_u32 s29, s28, 48640
    buffer_load_dword v134, v3, s[36:39], s29 offen
    s_add_u32 s29, s28, 49920
    buffer_load_dword v135, v3, s[36:39], s29 offen
    s_add_u32 s29, s28, 61440
    buffer_load_dword v136, v3, s[36:39], s29 offen
    s_add_u32 s29, s28, 62720
    buffer_load_dword v137, v3, s[36:39], s29 offen
    s_add_u32 s29, s28, 64000
    buffer_load_dword v138, v3, s[36:39], s29 offen
    s_add_u32 s29, s28, 65280
    buffer_load_dword v139, v3, s[36:39], s29 offen
    s_add_u32 s29, s28, 66560
    buffer_load_dword v140, v3, s[36:39], s29 offen
    s_add_u32 s29, s28, 67840
    buffer_load_dword v141, v3, s[36:39], s29 offen
    s_add_u32 s29, s28, 69120
    buffer_load_dword v142, v3, s[36:39], s29 offen
    s_add_u32 s29, s28, 70400
    buffer_load_dword v143, v3, s[36:39], s29 offen
    s_add_u32 s29, s28, 81920
    buffer_load_dword v144, v3, s[36:39], s29 offen
    s_add_u32 s29, s28, 83200
    buffer_load_dword v145, v3, s[36:39], s29 offen
    s_add_u32 s29, s28, 84480
    buffer_load_dword v146, v3, s[36:39], s29 offen
    s_add_u32 s29, s28, 85760
    buffer_load_dword v147, v3, s[36:39], s29 offen
    s_add_u32 s29, s28, 87040
    buffer_load_dword v148, v3, s[36:39], s29 offen
    s_add_u32 s29, s28, 88320
    buffer_load_dword v149, v3, s[36:39], s29 offen
    s_add_u32 s29, s28, 89600
    buffer_load_dword v150, v3, s[36:39], s29 offen
    s_add_u32 s29, s28, 90880
    buffer_load_dword v151, v3, s[36:39], s29 offen
    s_add_u32 s29, s28, 102400
    buffer_load_dword v152, v3, s[36:39], s29 offen
    s_add_u32 s29, s28, 103680
    buffer_load_dword v153, v3, s[36:39], s29 offen
    s_add_u32 s29, s28, 104960
    buffer_load_dword v154, v3, s[36:39], s29 offen
    s_add_u32 s29, s28, 106240
    buffer_load_dword v155, v3, s[36:39], s29 offen
    s_add_u32 s29, s28, 107520
    buffer_load_dword v156, v3, s[36:39], s29 offen
    s_add_u32 s29, s28, 108800
    buffer_load_dword v157, v3, s[36:39], s29 offen
    s_add_u32 s29, s28, 110080
    buffer_load_dword v158, v3, s[36:39], s29 offen
    s_add_u32 s29, s28, 111360
    buffer_load_dword v159, v3, s[36:39], s29 offen
    v_mov_b32 v4, 0x05040100
    v_mov_b32 v5, 0x07060302
    s_waitcnt vmcnt(0)
    v_perm_b32 v16, v113, v112, v4
    v_perm_b32 v64, v113, v112, v5
    v_perm_b32 v17, v115, v114, v4
    v_perm_b32 v65, v115, v114, v5
    v_perm_b32 v18, v117, v116, v4
    v_perm_b32 v66, v117, v116, v5
    v_perm_b32 v19, v119, v118, v4
    v_perm_b32 v67, v119, v118, v5
    v_perm_b32 v20, v121, v120, v4
    v_perm_b32 v68, v121, v120, v5
    v_perm_b32 v21, v123, v122, v4
    v_perm_b32 v69, v123, v122, v5
    v_perm_b32 v22, v125, v124, v4
    v_perm_b32 v70, v125, v124, v5
    v_perm_b32 v23, v127, v126, v4
    v_perm_b32 v71, v127, v126, v5
    v_perm_b32 v24, v129, v128, v4
    v_perm_b32 v72, v129, v128, v5
    v_perm_b32 v25, v131, v130, v4
    v_perm_b32 v73, v131, v130, v5
    v_perm_b32 v26, v133, v132, v4
    v_perm_b32 v74, v133, v132, v5
    v_perm_b32 v27, v135, v134, v4
    v_perm_b32 v75, v135, v134, v5
    v_perm_b32 v28, v137, v136, v4
    v_perm_b32 v76, v137, v136, v5
    v_perm_b32 v29, v139, v138, v4
    v_perm_b32 v77, v139, v138, v5
    v_perm_b32 v30, v141, v140, v4
    v_perm_b32 v78, v141, v140, v5
    v_perm_b32 v31, v143, v142, v4
    v_perm_b32 v79, v143, v142, v5
    v_perm_b32 v32, v145, v144, v4
    v_perm_b32 v80, v145, v144, v5
    v_perm_b32 v33, v147, v146, v4
    v_perm_b32 v81, v147, v146, v5
    v_perm_b32 v34, v149, v148, v4
    v_perm_b32 v82, v149, v148, v5
    v_perm_b32 v35, v151, v150, v4
    v_perm_b32 v83, v151, v150, v5
    v_perm_b32 v36, v153, v152, v4
    v_perm_b32 v84, v153, v152, v5
    v_perm_b32 v37, v155, v154, v4
    v_perm_b32 v85, v155, v154, v5
    v_perm_b32 v38, v157, v156, v4
    v_perm_b32 v86, v157, v156, v5
    v_perm_b32 v39, v159, v158, v4
    v_perm_b32 v87, v159, v158, v5
    s_add_u32 s29, s28, 122880
    buffer_load_dword v112, v3, s[36:39], s29 offen
    s_add_u32 s29, s28, 124160
    buffer_load_dword v113, v3, s[36:39], s29 offen
    s_add_u32 s29, s28, 125440
    buffer_load_dword v114, v3, s[36:39], s29 offen
    s_add_u32 s29, s28, 126720
    buffer_load_dword v115, v3, s[36:39], s29 offen
    s_add_u32 s29, s28, 128000
    buffer_load_dword v116, v3, s[36:39], s29 offen
    s_add_u32 s29, s28, 129280
    buffer_load_dword v117, v3, s[36:39], s29 offen
    s_add_u32 s29, s28, 130560
    buffer_load_dword v118, v3, s[36:39], s29 offen
    s_add_u32 s29, s28, 131840
    buffer_load_dword v119, v3, s[36:39], s29 offen
    s_add_u32 s29, s28, 143360
    buffer_load_dword v120, v3, s[36:39], s29 offen
    s_add_u32 s29, s28, 144640
    buffer_load_dword v121, v3, s[36:39], s29 offen
    s_add_u32 s29, s28, 145920
    buffer_load_dword v122, v3, s[36:39], s29 offen
    s_add_u32 s29, s28, 147200
    buffer_load_dword v123, v3, s[36:39], s29 offen
    s_add_u32 s29, s28, 148480
    buffer_load_dword v124, v3, s[36:39], s29 offen
    s_add_u32 s29, s28, 149760
    buffer_load_dword v125, v3, s[36:39], s29 offen
    s_add_u32 s29, s28, 151040
    buffer_load_dword v126, v3, s[36:39], s29 offen
    s_add_u32 s29, s28, 152320
    buffer_load_dword v127, v3, s[36:39], s29 offen
    s_add_u32 s29, s28, 163840
    buffer_load_dword v128, v3, s[36:39], s29 offen
    s_add_u32 s29, s28, 165120
    buffer_load_dword v129, v3, s[36:39], s29 offen
    s_add_u32 s29, s28, 166400
    buffer_load_dword v130, v3, s[36:39], s29 offen
    s_add_u32 s29, s28, 167680
    buffer_load_dword v131, v3, s[36:39], s29 offen
    s_add_u32 s29, s28, 168960
    buffer_load_dword v132, v3, s[36:39], s29 offen
    s_add_u32 s29, s28, 170240
    buffer_load_dword v133, v3, s[36:39], s29 offen
    s_add_u32 s29, s28, 171520
    buffer_load_dword v134, v3, s[36:39], s29 offen
    s_add_u32 s29, s28, 172800
    buffer_load_dword v135, v3, s[36:39], s29 offen
    s_add_u32 s29, s28, 184320
    buffer_load_dword v136, v3, s[36:39], s29 offen
    s_add_u32 s29, s28, 185600
    buffer_load_dword v137, v3, s[36:39], s29 offen
    s_add_u32 s29, s28, 186880
    buffer_load_dword v138, v3, s[36:39], s29 offen
    s_add_u32 s29, s28, 188160
    buffer_load_dword v139, v3, s[36:39], s29 offen
    s_add_u32 s29, s28, 189440
    buffer_load_dword v140, v3, s[36:39], s29 offen
    s_add_u32 s29, s28, 190720
    buffer_load_dword v141, v3, s[36:39], s29 offen
    s_add_u32 s29, s28, 192000
    buffer_load_dword v142, v3, s[36:39], s29 offen
    s_add_u32 s29, s28, 193280
    buffer_load_dword v143, v3, s[36:39], s29 offen
    s_add_u32 s29, s28, 204800
    buffer_load_dword v144, v3, s[36:39], s29 offen
    s_add_u32 s29, s28, 206080
    buffer_load_dword v145, v3, s[36:39], s29 offen
    s_add_u32 s29, s28, 207360
    buffer_load_dword v146, v3, s[36:39], s29 offen
    s_add_u32 s29, s28, 208640
    buffer_load_dword v147, v3, s[36:39], s29 offen
    s_add_u32 s29, s28, 209920
    buffer_load_dword v148, v3, s[36:39], s29 offen
    s_add_u32 s29, s28, 211200
    buffer_load_dword v149, v3, s[36:39], s29 offen
    s_add_u32 s29, s28, 212480
    buffer_load_dword v150, v3, s[36:39], s29 offen
    s_add_u32 s29, s28, 213760
    buffer_load_dword v151, v3, s[36:39], s29 offen
    s_add_u32 s29, s28, 225280
    buffer_load_dword v152, v3, s[36:39], s29 offen
    s_add_u32 s29, s28, 226560
    buffer_load_dword v153, v3, s[36:39], s29 offen
    s_add_u32 s29, s28, 227840
    buffer_load_dword v154, v3, s[36:39], s29 offen
    s_add_u32 s29, s28, 229120
    buffer_load_dword v155, v3, s[36:39], s29 offen
    s_add_u32 s29, s28, 230400
    buffer_load_dword v156, v3, s[36:39], s29 offen
    s_add_u32 s29, s28, 231680
    buffer_load_dword v157, v3, s[36:39], s29 offen
    s_add_u32 s29, s28, 232960
    buffer_load_dword v158, v3, s[36:39], s29 offen
    s_add_u32 s29, s28, 234240
    buffer_load_dword v159, v3, s[36:39], s29 offen
    v_mov_b32 v4, 0x05040100
    v_mov_b32 v5, 0x07060302
    s_waitcnt vmcnt(0)
    v_perm_b32 v40, v113, v112, v4
    v_perm_b32 v88, v113, v112, v5
    v_perm_b32 v41, v115, v114, v4
    v_perm_b32 v89, v115, v114, v5
    v_perm_b32 v42, v117, v116, v4
    v_perm_b32 v90, v117, v116, v5
    v_perm_b32 v43, v119, v118, v4
    v_perm_b32 v91, v119, v118, v5
    v_perm_b32 v44, v121, v120, v4
    v_perm_b32 v92, v121, v120, v5
    v_perm_b32 v45, v123, v122, v4
    v_perm_b32 v93, v123, v122, v5
    v_perm_b32 v46, v125, v124, v4
    v_perm_b32 v94, v125, v124, v5
    v_perm_b32 v47, v127, v126, v4
    v_perm_b32 v95, v127, v126, v5
    v_perm_b32 v48, v129, v128, v4
    v_perm_b32 v96, v129, v128, v5
    v_perm_b32 v49, v131, v130, v4
    v_perm_b32 v97, v131, v130, v5
    v_perm_b32 v50, v133, v132, v4
    v_perm_b32 v98, v133, v132, v5
    v_perm_b32 v51, v135, v134, v4
    v_perm_b32 v99, v135, v134, v5
    v_perm_b32 v52, v137, v136, v4
    v_perm_b32 v100, v137, v136, v5
    v_perm_b32 v53, v139, v138, v4
    v_perm_b32 v101, v139, v138, v5
    v_perm_b32 v54, v141, v140, v4
    v_perm_b32 v102, v141, v140, v5
    v_perm_b32 v55, v143, v142, v4
    v_perm_b32 v103, v143, v142, v5
    v_perm_b32 v56, v145, v144, v4
    v_perm_b32 v104, v145, v144, v5
    v_perm_b32 v57, v147, v146, v4
    v_perm_b32 v105, v147, v146, v5
    v_perm_b32 v58, v149, v148, v4
    v_perm_b32 v106, v149, v148, v5
    v_perm_b32 v59, v151, v150, v4
    v_perm_b32 v107, v151, v150, v5
    v_perm_b32 v60, v153, v152, v4
    v_perm_b32 v108, v153, v152, v5
    v_perm_b32 v61, v155, v154, v4
    v_perm_b32 v109, v155, v154, v5
    v_perm_b32 v62, v157, v156, v4
    v_perm_b32 v110, v157, v156, v5
    v_perm_b32 v63, v159, v158, v4
    v_perm_b32 v111, v159, v158, v5
    v_lshrrev_b32 v6, 3, v1
    v_lshrrev_b32 v7, 2, v6
    v_lshlrev_b32 v7, 5, v7
    v_and_b32 v8, 2, v6
    v_lshl_add_u32 v7, v8, 3, v7
    v_and_b32 v8, 1, v6
    v_lshl_add_u32 v7, v8, 2, v7
    v_and_b32 v8, 7, v1
    v_and_b32 v9, 1, v8
    v_add_u32 v7, v7, v9
    v_and_b32 v9, 2, v8
    v_lshl_add_u32 v7, v9, 2, v7
    v_lshrrev_b32 v9, 2, v8
    v_lshl_add_u32 v7, v9, 1, v7
    v_mul_u32_u24 v7, 12288, v7
    v_lshl_add_u32 v7, v2, 4, v7
    s_mul_i32 s28, s23, 384
    s_mul_i32 s29, s21, 3932160
    s_add_u32 s28, s28, s29
    v_lshrrev_b32 v10, 2, v1
    v_mul_u32_u24 v10, 20480, v10
    v_lshlrev_b32 v10, 4, v10
    v_and_b32 v11, 3, v1
    v_lshl_add_u32 v10, v11, 5, v10
    v_lshl_add_u32 v10, v2, 8, v10
    s_mul_i32 s30, s22, 2621440
    s_lshr_b32 s31, s23, 3
    s_mul_i32 s31, s31, 81920
    s_add_u32 s30, s30, s31
    s_and_b32 s31, s23, 3
    s_mul_i32 s31, s31, 20480
    s_add_u32 s30, s30, s31
    s_bfe_u32 s31, s23, 0x10002
    s_lshl_b32 s31, s31, 7
    s_add_u32 s30, s30, s31
    s_mul_i32 s31, s21, 10240
    s_add_u32 s30, s30, s31
    s_add_u32 s30, s30, 27262976
    buffer_load_dwordx4 v[112:115], v7, s[32:35], s28 offen offset:0
    buffer_load_dwordx4 v[116:119], v7, s[32:35], s28 offen offset:32
    buffer_load_dwordx4 v[120:123], v7, s[32:35], s28 offen offset:64
    buffer_load_dwordx4 v[124:127], v7, s[32:35], s28 offen offset:96
    buffer_load_dwordx4 v[128:131], v7, s[32:35], s28 offen offset:128
    buffer_load_dwordx4 v[132:135], v7, s[32:35], s28 offen offset:160
    buffer_load_dwordx4 v[136:139], v7, s[32:35], s28 offen offset:192
    buffer_load_dwordx4 v[140:143], v7, s[32:35], s28 offen offset:224
    buffer_load_dwordx4 v[144:147], v7, s[32:35], s28 offen offset:256
    buffer_load_dwordx4 v[148:151], v7, s[32:35], s28 offen offset:288
    buffer_load_dwordx4 v[152:155], v7, s[32:35], s28 offen offset:320
    buffer_load_dwordx4 v[156:159], v7, s[32:35], s28 offen offset:352
    s_add_u32 s28, s28, 393216
    s_mov_b32 s31, 5
prep_kernel_wvo_loop:
    buffer_load_dwordx4 v[160:163], v7, s[32:35], s28 offen offset:0
    buffer_load_dwordx4 v[164:167], v7, s[32:35], s28 offen offset:32
    buffer_load_dwordx4 v[168:171], v7, s[32:35], s28 offen offset:64
    buffer_load_dwordx4 v[172:175], v7, s[32:35], s28 offen offset:96
    buffer_load_dwordx4 v[176:179], v7, s[32:35], s28 offen offset:128
    buffer_load_dwordx4 v[180:183], v7, s[32:35], s28 offen offset:160
    buffer_load_dwordx4 v[184:187], v7, s[32:35], s28 offen offset:192
    buffer_load_dwordx4 v[188:191], v7, s[32:35], s28 offen offset:224
    buffer_load_dwordx4 v[192:195], v7, s[32:35], s28 offen offset:256
    buffer_load_dwordx4 v[196:199], v7, s[32:35], s28 offen offset:288
    buffer_load_dwordx4 v[200:203], v7, s[32:35], s28 offen offset:320
    buffer_load_dwordx4 v[204:207], v7, s[32:35], s28 offen offset:352
    s_add_u32 s28, s28, 393216
    s_waitcnt vmcnt(12)
    v_mfma_f32_32x32x16_bf16 v[208:223], v[112:115], v[16:19], 0
    v_mfma_f32_32x32x16_bf16 v[224:239], v[112:115], v[64:67], 0
    v_mfma_f32_32x32x16_bf16 v[208:223], v[116:119], v[20:23], v[208:223]
    v_mfma_f32_32x32x16_bf16 v[224:239], v[116:119], v[68:71], v[224:239]
    v_mfma_f32_32x32x16_bf16 v[208:223], v[120:123], v[24:27], v[208:223]
    v_mfma_f32_32x32x16_bf16 v[224:239], v[120:123], v[72:75], v[224:239]
    v_mfma_f32_32x32x16_bf16 v[208:223], v[124:127], v[28:31], v[208:223]
    v_mfma_f32_32x32x16_bf16 v[224:239], v[124:127], v[76:79], v[224:239]
    v_mfma_f32_32x32x16_bf16 v[208:223], v[128:131], v[32:35], v[208:223]
    v_mfma_f32_32x32x16_bf16 v[224:239], v[128:131], v[80:83], v[224:239]
    v_mfma_f32_32x32x16_bf16 v[208:223], v[132:135], v[36:39], v[208:223]
    v_mfma_f32_32x32x16_bf16 v[224:239], v[132:135], v[84:87], v[224:239]
    v_mfma_f32_32x32x16_bf16 v[208:223], v[136:139], v[40:43], v[208:223]
    v_mfma_f32_32x32x16_bf16 v[224:239], v[136:139], v[88:91], v[224:239]
    v_mfma_f32_32x32x16_bf16 v[208:223], v[140:143], v[44:47], v[208:223]
    v_mfma_f32_32x32x16_bf16 v[224:239], v[140:143], v[92:95], v[224:239]
    v_mfma_f32_32x32x16_bf16 v[208:223], v[144:147], v[48:51], v[208:223]
    v_mfma_f32_32x32x16_bf16 v[224:239], v[144:147], v[96:99], v[224:239]
    v_mfma_f32_32x32x16_bf16 v[208:223], v[148:151], v[52:55], v[208:223]
    v_mfma_f32_32x32x16_bf16 v[224:239], v[148:151], v[100:103], v[224:239]
    v_mfma_f32_32x32x16_bf16 v[208:223], v[152:155], v[56:59], v[208:223]
    v_mfma_f32_32x32x16_bf16 v[224:239], v[152:155], v[104:107], v[224:239]
    v_mfma_f32_32x32x16_bf16 v[208:223], v[156:159], v[60:63], v[208:223]
    v_mfma_f32_32x32x16_bf16 v[224:239], v[156:159], v[108:111], v[224:239]
    s_nop 7
    s_nop 7
    v_cvt_pk_bf16_f32 v240, v208, v209
    v_cvt_pk_bf16_f32 v241, v210, v211
    v_cvt_pk_bf16_f32 v242, v212, v213
    v_cvt_pk_bf16_f32 v243, v214, v215
    s_nop 1
    v_permlane32_swap_b32 v240, v242
    v_permlane32_swap_b32 v241, v243
    buffer_store_dwordx4 v[240:243], v10, s[8:11], s30 offen offset:0
    v_cvt_pk_bf16_f32 v244, v216, v217
    v_cvt_pk_bf16_f32 v245, v218, v219
    v_cvt_pk_bf16_f32 v246, v220, v221
    v_cvt_pk_bf16_f32 v247, v222, v223
    s_nop 1
    v_permlane32_swap_b32 v244, v246
    v_permlane32_swap_b32 v245, v247
    buffer_store_dwordx4 v[244:247], v10, s[8:11], s30 offen offset:512
    s_nop 1
    v_cvt_pk_bf16_f32 v240, v224, v225
    v_cvt_pk_bf16_f32 v241, v226, v227
    v_cvt_pk_bf16_f32 v242, v228, v229
    v_cvt_pk_bf16_f32 v243, v230, v231
    s_nop 1
    v_permlane32_swap_b32 v240, v242
    v_permlane32_swap_b32 v241, v243
    buffer_store_dwordx4 v[240:243], v10, s[8:11], s30 offen offset:16
    v_cvt_pk_bf16_f32 v244, v232, v233
    v_cvt_pk_bf16_f32 v245, v234, v235
    v_cvt_pk_bf16_f32 v246, v236, v237
    v_cvt_pk_bf16_f32 v247, v238, v239
    s_nop 1
    v_permlane32_swap_b32 v244, v246
    v_permlane32_swap_b32 v245, v247
    buffer_store_dwordx4 v[244:247], v10, s[8:11], s30 offen offset:528
    s_nop 1
    s_add_u32 s30, s30, 1024
    s_cmp_eq_u32 s31, 1
    s_cbranch_scc1 prep_kernel_wvo_last
    buffer_load_dwordx4 v[112:115], v7, s[32:35], s28 offen offset:0
    buffer_load_dwordx4 v[116:119], v7, s[32:35], s28 offen offset:32
    buffer_load_dwordx4 v[120:123], v7, s[32:35], s28 offen offset:64
    buffer_load_dwordx4 v[124:127], v7, s[32:35], s28 offen offset:96
    buffer_load_dwordx4 v[128:131], v7, s[32:35], s28 offen offset:128
    buffer_load_dwordx4 v[132:135], v7, s[32:35], s28 offen offset:160
    buffer_load_dwordx4 v[136:139], v7, s[32:35], s28 offen offset:192
    buffer_load_dwordx4 v[140:143], v7, s[32:35], s28 offen offset:224
    buffer_load_dwordx4 v[144:147], v7, s[32:35], s28 offen offset:256
    buffer_load_dwordx4 v[148:151], v7, s[32:35], s28 offen offset:288
    buffer_load_dwordx4 v[152:155], v7, s[32:35], s28 offen offset:320
    buffer_load_dwordx4 v[156:159], v7, s[32:35], s28 offen offset:352
    s_add_u32 s28, s28, 393216
    s_waitcnt vmcnt(12)
    v_mfma_f32_32x32x16_bf16 v[208:223], v[160:163], v[16:19], 0
    v_mfma_f32_32x32x16_bf16 v[224:239], v[160:163], v[64:67], 0
    v_mfma_f32_32x32x16_bf16 v[208:223], v[164:167], v[20:23], v[208:223]
    v_mfma_f32_32x32x16_bf16 v[224:239], v[164:167], v[68:71], v[224:239]
    v_mfma_f32_32x32x16_bf16 v[208:223], v[168:171], v[24:27], v[208:223]
    v_mfma_f32_32x32x16_bf16 v[224:239], v[168:171], v[72:75], v[224:239]
    v_mfma_f32_32x32x16_bf16 v[208:223], v[172:175], v[28:31], v[208:223]
    v_mfma_f32_32x32x16_bf16 v[224:239], v[172:175], v[76:79], v[224:239]
    v_mfma_f32_32x32x16_bf16 v[208:223], v[176:179], v[32:35], v[208:223]
    v_mfma_f32_32x32x16_bf16 v[224:239], v[176:179], v[80:83], v[224:239]
    v_mfma_f32_32x32x16_bf16 v[208:223], v[180:183], v[36:39], v[208:223]
    v_mfma_f32_32x32x16_bf16 v[224:239], v[180:183], v[84:87], v[224:239]
    v_mfma_f32_32x32x16_bf16 v[208:223], v[184:187], v[40:43], v[208:223]
    v_mfma_f32_32x32x16_bf16 v[224:239], v[184:187], v[88:91], v[224:239]
    v_mfma_f32_32x32x16_bf16 v[208:223], v[188:191], v[44:47], v[208:223]
    v_mfma_f32_32x32x16_bf16 v[224:239], v[188:191], v[92:95], v[224:239]
    v_mfma_f32_32x32x16_bf16 v[208:223], v[192:195], v[48:51], v[208:223]
    v_mfma_f32_32x32x16_bf16 v[224:239], v[192:195], v[96:99], v[224:239]
    v_mfma_f32_32x32x16_bf16 v[208:223], v[196:199], v[52:55], v[208:223]
    v_mfma_f32_32x32x16_bf16 v[224:239], v[196:199], v[100:103], v[224:239]
    v_mfma_f32_32x32x16_bf16 v[208:223], v[200:203], v[56:59], v[208:223]
    v_mfma_f32_32x32x16_bf16 v[224:239], v[200:203], v[104:107], v[224:239]
    v_mfma_f32_32x32x16_bf16 v[208:223], v[204:207], v[60:63], v[208:223]
    v_mfma_f32_32x32x16_bf16 v[224:239], v[204:207], v[108:111], v[224:239]
    s_nop 7
    s_nop 7
    v_cvt_pk_bf16_f32 v240, v208, v209
    v_cvt_pk_bf16_f32 v241, v210, v211
    v_cvt_pk_bf16_f32 v242, v212, v213
    v_cvt_pk_bf16_f32 v243, v214, v215
    s_nop 1
    v_permlane32_swap_b32 v240, v242
    v_permlane32_swap_b32 v241, v243
    buffer_store_dwordx4 v[240:243], v10, s[8:11], s30 offen offset:0
    v_cvt_pk_bf16_f32 v244, v216, v217
    v_cvt_pk_bf16_f32 v245, v218, v219
    v_cvt_pk_bf16_f32 v246, v220, v221
    v_cvt_pk_bf16_f32 v247, v222, v223
    s_nop 1
    v_permlane32_swap_b32 v244, v246
    v_permlane32_swap_b32 v245, v247
    buffer_store_dwordx4 v[244:247], v10, s[8:11], s30 offen offset:512
    s_nop 1
    v_cvt_pk_bf16_f32 v240, v224, v225
    v_cvt_pk_bf16_f32 v241, v226, v227
    v_cvt_pk_bf16_f32 v242, v228, v229
    v_cvt_pk_bf16_f32 v243, v230, v231
    s_nop 1
    v_permlane32_swap_b32 v240, v242
    v_permlane32_swap_b32 v241, v243
    buffer_store_dwordx4 v[240:243], v10, s[8:11], s30 offen offset:16
    v_cvt_pk_bf16_f32 v244, v232, v233
    v_cvt_pk_bf16_f32 v245, v234, v235
    v_cvt_pk_bf16_f32 v246, v236, v237
    v_cvt_pk_bf16_f32 v247, v238, v239
    s_nop 1
    v_permlane32_swap_b32 v244, v246
    v_permlane32_swap_b32 v245, v247
    buffer_store_dwordx4 v[244:247], v10, s[8:11], s30 offen offset:528
    s_nop 1
    s_add_u32 s30, s30, 1024
    s_sub_u32 s31, s31, 1
    s_branch prep_kernel_wvo_loop
prep_kernel_wvo_last:
    s_waitcnt vmcnt(0)
    v_mfma_f32_32x32x16_bf16 v[208:223], v[160:163], v[16:19], 0
    v_mfma_f32_32x32x16_bf16 v[224:239], v[160:163], v[64:67], 0
    v_mfma_f32_32x32x16_bf16 v[208:223], v[164:167], v[20:23], v[208:223]
    v_mfma_f32_32x32x16_bf16 v[224:239], v[164:167], v[68:71], v[224:239]
    v_mfma_f32_32x32x16_bf16 v[208:223], v[168:171], v[24:27], v[208:223]
    v_mfma_f32_32x32x16_bf16 v[224:239], v[168:171], v[72:75], v[224:239]
    v_mfma_f32_32x32x16_bf16 v[208:223], v[172:175], v[28:31], v[208:223]
    v_mfma_f32_32x32x16_bf16 v[224:239], v[172:175], v[76:79], v[224:239]
    v_mfma_f32_32x32x16_bf16 v[208:223], v[176:179], v[32:35], v[208:223]
    v_mfma_f32_32x32x16_bf16 v[224:239], v[176:179], v[80:83], v[224:239]
    v_mfma_f32_32x32x16_bf16 v[208:223], v[180:183], v[36:39], v[208:223]
    v_mfma_f32_32x32x16_bf16 v[224:239], v[180:183], v[84:87], v[224:239]
    v_mfma_f32_32x32x16_bf16 v[208:223], v[184:187], v[40:43], v[208:223]
    v_mfma_f32_32x32x16_bf16 v[224:239], v[184:187], v[88:91], v[224:239]
    v_mfma_f32_32x32x16_bf16 v[208:223], v[188:191], v[44:47], v[208:223]
    v_mfma_f32_32x32x16_bf16 v[224:239], v[188:191], v[92:95], v[224:239]
    v_mfma_f32_32x32x16_bf16 v[208:223], v[192:195], v[48:51], v[208:223]
    v_mfma_f32_32x32x16_bf16 v[224:239], v[192:195], v[96:99], v[224:239]
    v_mfma_f32_32x32x16_bf16 v[208:223], v[196:199], v[52:55], v[208:223]
    v_mfma_f32_32x32x16_bf16 v[224:239], v[196:199], v[100:103], v[224:239]
    v_mfma_f32_32x32x16_bf16 v[208:223], v[200:203], v[56:59], v[208:223]
    v_mfma_f32_32x32x16_bf16 v[224:239], v[200:203], v[104:107], v[224:239]
    v_mfma_f32_32x32x16_bf16 v[208:223], v[204:207], v[60:63], v[208:223]
    v_mfma_f32_32x32x16_bf16 v[224:239], v[204:207], v[108:111], v[224:239]
    s_nop 7
    s_nop 7
    v_cvt_pk_bf16_f32 v240, v208, v209
    v_cvt_pk_bf16_f32 v241, v210, v211
    v_cvt_pk_bf16_f32 v242, v212, v213
    v_cvt_pk_bf16_f32 v243, v214, v215
    s_nop 1
    v_permlane32_swap_b32 v240, v242
    v_permlane32_swap_b32 v241, v243
    buffer_store_dwordx4 v[240:243], v10, s[8:11], s30 offen offset:0
    v_cvt_pk_bf16_f32 v244, v216, v217
    v_cvt_pk_bf16_f32 v245, v218, v219
    v_cvt_pk_bf16_f32 v246, v220, v221
    v_cvt_pk_bf16_f32 v247, v222, v223
    s_nop 1
    v_permlane32_swap_b32 v244, v246
    v_permlane32_swap_b32 v245, v247
    buffer_store_dwordx4 v[244:247], v10, s[8:11], s30 offen offset:512
    s_nop 1
    v_cvt_pk_bf16_f32 v240, v224, v225
    v_cvt_pk_bf16_f32 v241, v226, v227
    v_cvt_pk_bf16_f32 v242, v228, v229
    v_cvt_pk_bf16_f32 v243, v230, v231
    s_nop 1
    v_permlane32_swap_b32 v240, v242
    v_permlane32_swap_b32 v241, v243
    buffer_store_dwordx4 v[240:243], v10, s[8:11], s30 offen offset:16
    v_cvt_pk_bf16_f32 v244, v232, v233
    v_cvt_pk_bf16_f32 v245, v234, v235
    v_cvt_pk_bf16_f32 v246, v236, v237
    v_cvt_pk_bf16_f32 v247, v238, v239
    s_nop 1
    v_permlane32_swap_b32 v244, v246
    v_permlane32_swap_b32 v245, v247
    buffer_store_dwordx4 v[244:247], v10, s[8:11], s30 offen offset:528
    s_nop 1
    s_add_u32 s30, s30, 1024
    s_branch prep_kernel_end
prep_kernel_r_pwp:
    s_lshl_b32 s20, s20, 2
    s_add_u32 s20, s20, s13
    s_mul_i32 s21, s20, 13108
    s_lshr_b32 s21, s21, 16
    s_mul_i32 s22, s21, 5
    s_sub_u32 s22, s20, s22
    s_mul_i32 s23, s21, 21846
    s_lshr_b32 s23, s23, 16
    s_mul_i32 s28, s23, 3
    s_sub_u32 s21, s21, s28
    s_lshr_b32 s29, s23, 5
    s_and_b32 s23, s23, 31
    s_cmp_eq_u32 s29, 0
    s_cbranch_scc0 prep_kernel_pwp_k
    s_load_dwordx2 s[24:25], s[0:1], 40
    s_branch prep_kernel_pwp_go
prep_kernel_pwp_k:
    s_load_dwordx2 s[24:25], s[0:1], 48
prep_kernel_pwp_go:
    v_and_b32 v1, 31, v0
    v_lshrrev_b32 v2, 5, v0
    s_lshl_b32 s28, s21, 6
    v_lshlrev_b32 v3, 1, v1
    v_add_u32 v3, s28, v3
    v_and_b32 v4, 0xc1, v3
    v_and_b32 v5, 8, v3
    v_lshl_or_b32 v4, v5, 2, v4
    v_and_b32 v5, 32, v3
    v_lshrrev_b32 v5, 1, v5
    v_or_b32 v4, v4, v5
    v_and_b32 v5, 2, v3
    v_lshl_or_b32 v4, v5, 2, v4
    v_and_b32 v5, 16, v3
    v_lshrrev_b32 v5, 2, v5
    v_or_b32 v4, v4, v5
    v_and_b32 v5, 4, v3
    v_lshrrev_b32 v5, 1, v5
    v_or_b32 v4, v4, v5
    s_cmp_eq_u32 s29, 0
    s_cselect_b64 vcc, -1, 0
    s_nop 1
    v_cndmask_b32 v4, v4, v3, vcc
    v_lshrrev_b32 v5, 4, v3
    v_mul_u32_u24 v6, 11, v5
    v_lshrrev_b32 v6, 5, v6
    v_mul_u32_u24 v6, 3, v6
    v_add_u32 v5, v5, v6
    v_mul_u32_u24 v5, 20480, v5
    v_and_b32 v6, 15, v3
    v_lshl_add_u32 v7, v6, 4, v5
    s_mul_i32 s30, s29, 61440
    s_mul_i32 s31, s23, 491520
    s_add_u32 s30, s30, s31
    s_add_u32 s30, s30, 11534336
    s_lshl_b32 s31, s22, 4
    v_add_u32 v8, s31, v2
    s_waitcnt lgkmcnt(0)
    s_mov_b32 s32, s24
    s_mov_b32 s33, s25
    s_mov_b32 s34, 7864320
    s_mov_b32 s35, 0x00020000
    s_mul_i32 s28, s23, 384
    v_add_u32 v9, 0, v8
    v_lshrrev_b32 v10, 2, v9
    v_lshlrev_b32 v10, 5, v10
    v_and_b32 v11, 2, v9
    v_lshl_add_u32 v10, v11, 3, v10
    v_and_b32 v11, 1, v9
    v_lshl_add_u32 v10, v11, 2, v10
    v_mul_u32_u24 v10, 12288, v10
    v_lshl_add_u32 v10, v4, 1, v10
    s_add_u32 s31, s28, 0
    buffer_load_dword v16, v10, s[32:35], s31 offen
    s_add_u32 s31, s28, 12288
    buffer_load_dword v17, v10, s[32:35], s31 offen
    s_add_u32 s31, s28, 98304
    buffer_load_dword v18, v10, s[32:35], s31 offen
    s_add_u32 s31, s28, 110592
    buffer_load_dword v19, v10, s[32:35], s31 offen
    s_add_u32 s31, s28, 24576
    buffer_load_dword v20, v10, s[32:35], s31 offen
    s_add_u32 s31, s28, 36864
    buffer_load_dword v21, v10, s[32:35], s31 offen
    s_add_u32 s31, s28, 122880
    buffer_load_dword v22, v10, s[32:35], s31 offen
    s_add_u32 s31, s28, 135168
    buffer_load_dword v23, v10, s[32:35], s31 offen
    v_add_u32 v9, 2, v8
    v_lshrrev_b32 v10, 2, v9
    v_lshlrev_b32 v10, 5, v10
    v_and_b32 v11, 2, v9
    v_lshl_add_u32 v10, v11, 3, v10
    v_and_b32 v11, 1, v9
    v_lshl_add_u32 v10, v11, 2, v10
    v_mul_u32_u24 v10, 12288, v10
    v_lshl_add_u32 v10, v4, 1, v10
    s_add_u32 s31, s28, 0
    buffer_load_dword v24, v10, s[32:35], s31 offen
    s_add_u32 s31, s28, 12288
    buffer_load_dword v25, v10, s[32:35], s31 offen
    s_add_u32 s31, s28, 98304
    buffer_load_dword v26, v10, s[32:35], s31 offen
    s_add_u32 s31, s28, 110592
    buffer_load_dword v27, v10, s[32:35], s31 offen
    s_add_u32 s31, s28, 24576
    buffer_load_dword v28, v10, s[32:35], s31 offen
    s_add_u32 s31, s28, 36864
    buffer_load_dword v29, v10, s[32:35], s31 offen
    s_add_u32 s31, s28, 122880
    buffer_load_dword v30, v10, s[32:35], s31 offen
    s_add_u32 s31, s28, 135168
    buffer_load_dword v31, v10, s[32:35], s31 offen
    v_add_u32 v9, 4, v8
    v_lshrrev_b32 v10, 2, v9
    v_lshlrev_b32 v10, 5, v10
    v_and_b32 v11, 2, v9
    v_lshl_add_u32 v10, v11, 3, v10
    v_and_b32 v11, 1, v9
    v_lshl_add_u32 v10, v11, 2, v10
    v_mul_u32_u24 v10, 12288, v10
    v_lshl_add_u32 v10, v4, 1, v10
    s_add_u32 s31, s28, 0
    buffer_load_dword v32, v10, s[32:35], s31 offen
    s_add_u32 s31, s28, 12288
    buffer_load_dword v33, v10, s[32:35], s31 offen
    s_add_u32 s31, s28, 98304
    buffer_load_dword v34, v10, s[32:35], s31 offen
    s_add_u32 s31, s28, 110592
    buffer_load_dword v35, v10, s[32:35], s31 offen
    s_add_u32 s31, s28, 24576
    buffer_load_dword v36, v10, s[32:35], s31 offen
    s_add_u32 s31, s28, 36864
    buffer_load_dword v37, v10, s[32:35], s31 offen
    s_add_u32 s31, s28, 122880
    buffer_load_dword v38, v10, s[32:35], s31 offen
    s_add_u32 s31, s28, 135168
    buffer_load_dword v39, v10, s[32:35], s31 offen
    v_add_u32 v9, 6, v8
    v_lshrrev_b32 v10, 2, v9
    v_lshlrev_b32 v10, 5, v10
    v_and_b32 v11, 2, v9
    v_lshl_add_u32 v10, v11, 3, v10
    v_and_b32 v11, 1, v9
    v_lshl_add_u32 v10, v11, 2, v10
    v_mul_u32_u24 v10, 12288, v10
    v_lshl_add_u32 v10, v4, 1, v10
    s_add_u32 s31, s28, 0
    buffer_load_dword v40, v10, s[32:35], s31 offen
    s_add_u32 s31, s28, 12288
    buffer_load_dword v41, v10, s[32:35], s31 offen
    s_add_u32 s31, s28, 98304
    buffer_load_dword v42, v10, s[32:35], s31 offen
    s_add_u32 s31, s28, 110592
    buffer_load_dword v43, v10, s[32:35], s31 offen
    s_add_u32 s31, s28, 24576
    buffer_load_dword v44, v10, s[32:35], s31 offen
    s_add_u32 s31, s28, 36864
    buffer_load_dword v45, v10, s[32:35], s31 offen
    s_add_u32 s31, s28, 122880
    buffer_load_dword v46, v10, s[32:35], s31 offen
    s_add_u32 s31, s28, 135168
    buffer_load_dword v47, v10, s[32:35], s31 offen
    v_add_u32 v9, 8, v8
    v_lshrrev_b32 v10, 2, v9
    v_lshlrev_b32 v10, 5, v10
    v_and_b32 v11, 2, v9
    v_lshl_add_u32 v10, v11, 3, v10
    v_and_b32 v11, 1, v9
    v_lshl_add_u32 v10, v11, 2, v10
    v_mul_u32_u24 v10, 12288, v10
    v_lshl_add_u32 v10, v4, 1, v10
    s_add_u32 s31, s28, 0
    buffer_load_dword v48, v10, s[32:35], s31 offen
    s_add_u32 s31, s28, 12288
    buffer_load_dword v49, v10, s[32:35], s31 offen
    s_add_u32 s31, s28, 98304
    buffer_load_dword v50, v10, s[32:35], s31 offen
    s_add_u32 s31, s28, 110592
    buffer_load_dword v51, v10, s[32:35], s31 offen
    s_add_u32 s31, s28, 24576
    buffer_load_dword v52, v10, s[32:35], s31 offen
    s_add_u32 s31, s28, 36864
    buffer_load_dword v53, v10, s[32:35], s31 offen
    s_add_u32 s31, s28, 122880
    buffer_load_dword v54, v10, s[32:35], s31 offen
    s_add_u32 s31, s28, 135168
    buffer_load_dword v55, v10, s[32:35], s31 offen
    v_add_u32 v9, 10, v8
    v_lshrrev_b32 v10, 2, v9
    v_lshlrev_b32 v10, 5, v10
    v_and_b32 v11, 2, v9
    v_lshl_add_u32 v10, v11, 3, v10
    v_and_b32 v11, 1, v9
    v_lshl_add_u32 v10, v11, 2, v10
    v_mul_u32_u24 v10, 12288, v10
    v_lshl_add_u32 v10, v4, 1, v10
    s_add_u32 s31, s28, 0
    buffer_load_dword v56, v10, s[32:35], s31 offen
    s_add_u32 s31, s28, 12288
    buffer_load_dword v57, v10, s[32:35], s31 offen
    s_add_u32 s31, s28, 98304
    buffer_load_dword v58, v10, s[32:35], s31 offen
    s_add_u32 s31, s28, 110592
    buffer_load_dword v59, v10, s[32:35], s31 offen
    s_add_u32 s31, s28, 24576
    buffer_load_dword v60, v10, s[32:35], s31 offen
    s_add_u32 s31, s28, 36864
    buffer_load_dword v61, v10, s[32:35], s31 offen
    s_add_u32 s31, s28, 122880
    buffer_load_dword v62, v10, s[32:35], s31 offen
    s_add_u32 s31, s28, 135168
    buffer_load_dword v63, v10, s[32:35], s31 offen
    v_add_u32 v9, 12, v8
    v_lshrrev_b32 v10, 2, v9
    v_lshlrev_b32 v10, 5, v10
    v_and_b32 v11, 2, v9
    v_lshl_add_u32 v10, v11, 3, v10
    v_and_b32 v11, 1, v9
    v_lshl_add_u32 v10, v11, 2, v10
    v_mul_u32_u24 v10, 12288, v10
    v_lshl_add_u32 v10, v4, 1, v10
    s_add_u32 s31, s28, 0
    buffer_load_dword v64, v10, s[32:35], s31 offen
    s_add_u32 s31, s28, 12288
    buffer_load_dword v65, v10, s[32:35], s31 offen
    s_add_u32 s31, s28, 98304
    buffer_load_dword v66, v10, s[32:35], s31 offen
    s_add_u32 s31, s28, 110592
    buffer_load_dword v67, v10, s[32:35], s31 offen
    s_add_u32 s31, s28, 24576
    buffer_load_dword v68, v10, s[32:35], s31 offen
    s_add_u32 s31, s28, 36864
    buffer_load_dword v69, v10, s[32:35], s31 offen
    s_add_u32 s31, s28, 122880
    buffer_load_dword v70, v10, s[32:35], s31 offen
    s_add_u32 s31, s28, 135168
    buffer_load_dword v71, v10, s[32:35], s31 offen
    v_add_u32 v9, 14, v8
    v_lshrrev_b32 v10, 2, v9
    v_lshlrev_b32 v10, 5, v10
    v_and_b32 v11, 2, v9
    v_lshl_add_u32 v10, v11, 3, v10
    v_and_b32 v11, 1, v9
    v_lshl_add_u32 v10, v11, 2, v10
    v_mul_u32_u24 v10, 12288, v10
    v_lshl_add_u32 v10, v4, 1, v10
    s_add_u32 s31, s28, 0
    buffer_load_dword v72, v10, s[32:35], s31 offen
    s_add_u32 s31, s28, 12288
    buffer_load_dword v73, v10, s[32:35], s31 offen
    s_add_u32 s31, s28, 98304
    buffer_load_dword v74, v10, s[32:35], s31 offen
    s_add_u32 s31, s28, 110592
    buffer_load_dword v75, v10, s[32:35], s31 offen
    s_add_u32 s31, s28, 24576
    buffer_load_dword v76, v10, s[32:35], s31 offen
    s_add_u32 s31, s28, 36864
    buffer_load_dword v77, v10, s[32:35], s31 offen
    s_add_u32 s31, s28, 122880
    buffer_load_dword v78, v10, s[32:35], s31 offen
    s_add_u32 s31, s28, 135168
    buffer_load_dword v79, v10, s[32:35], s31 offen
    v_lshl_add_u32 v7, v8, 8, v7
    v_mov_b32 v4, 0x05040100
    v_mov_b32 v5, 0x07060302
    s_waitcnt vmcnt(56)
    v_perm_b32 v80, v17, v16, v4
    v_perm_b32 v84, v17, v16, v5
    v_perm_b32 v81, v19, v18, v4
    v_perm_b32 v85, v19, v18, v5
    v_perm_b32 v82, v21, v20, v4
    v_perm_b32 v86, v21, v20, v5
    v_perm_b32 v83, v23, v22, v4
    v_perm_b32 v87, v23, v22, v5
    buffer_store_dwordx4 v[80:83], v7, s[8:11], s30 offen offset:0
    buffer_store_dwordx4 v[84:87], v7, s[8:11], s30 offen offset:16
    s_waitcnt vmcnt(48)
    v_perm_b32 v88, v25, v24, v4
    v_perm_b32 v92, v25, v24, v5
    v_perm_b32 v89, v27, v26, v4
    v_perm_b32 v93, v27, v26, v5
    v_perm_b32 v90, v29, v28, v4
    v_perm_b32 v94, v29, v28, v5
    v_perm_b32 v91, v31, v30, v4
    v_perm_b32 v95, v31, v30, v5
    buffer_store_dwordx4 v[88:91], v7, s[8:11], s30 offen offset:512
    buffer_store_dwordx4 v[92:95], v7, s[8:11], s30 offen offset:528
    s_nop 0
    s_waitcnt vmcnt(40)
    v_perm_b32 v80, v33, v32, v4
    v_perm_b32 v84, v33, v32, v5
    v_perm_b32 v81, v35, v34, v4
    v_perm_b32 v85, v35, v34, v5
    v_perm_b32 v82, v37, v36, v4
    v_perm_b32 v86, v37, v36, v5
    v_perm_b32 v83, v39, v38, v4
    v_perm_b32 v87, v39, v38, v5
    buffer_store_dwordx4 v[80:83], v7, s[8:11], s30 offen offset:1024
    buffer_store_dwordx4 v[84:87], v7, s[8:11], s30 offen offset:1040
    s_nop 0
    s_waitcnt vmcnt(32)
    v_perm_b32 v88, v41, v40, v4
    v_perm_b32 v92, v41, v40, v5
    v_perm_b32 v89, v43, v42, v4
    v_perm_b32 v93, v43, v42, v5
    v_perm_b32 v90, v45, v44, v4
    v_perm_b32 v94, v45, v44, v5
    v_perm_b32 v91, v47, v46, v4
    v_perm_b32 v95, v47, v46, v5
    buffer_store_dwordx4 v[88:91], v7, s[8:11], s30 offen offset:1536
    buffer_store_dwordx4 v[92:95], v7, s[8:11], s30 offen offset:1552
    s_nop 0
    s_waitcnt vmcnt(24)
    v_perm_b32 v80, v49, v48, v4
    v_perm_b32 v84, v49, v48, v5
    v_perm_b32 v81, v51, v50, v4
    v_perm_b32 v85, v51, v50, v5
    v_perm_b32 v82, v53, v52, v4
    v_perm_b32 v86, v53, v52, v5
    v_perm_b32 v83, v55, v54, v4
    v_perm_b32 v87, v55, v54, v5
    buffer_store_dwordx4 v[80:83], v7, s[8:11], s30 offen offset:2048
    buffer_store_dwordx4 v[84:87], v7, s[8:11], s30 offen offset:2064
    s_nop 0
    s_waitcnt vmcnt(16)
    v_perm_b32 v88, v57, v56, v4
    v_perm_b32 v92, v57, v56, v5
    v_perm_b32 v89, v59, v58, v4
    v_perm_b32 v93, v59, v58, v5
    v_perm_b32 v90, v61, v60, v4
    v_perm_b32 v94, v61, v60, v5
    v_perm_b32 v91, v63, v62, v4
    v_perm_b32 v95, v63, v62, v5
    buffer_store_dwordx4 v[88:91], v7, s[8:11], s30 offen offset:2560
    buffer_store_dwordx4 v[92:95], v7, s[8:11], s30 offen offset:2576
    s_nop 0
    s_waitcnt vmcnt(8)
    v_perm_b32 v80, v65, v64, v4
    v_perm_b32 v84, v65, v64, v5
    v_perm_b32 v81, v67, v66, v4
    v_perm_b32 v85, v67, v66, v5
    v_perm_b32 v82, v69, v68, v4
    v_perm_b32 v86, v69, v68, v5
    v_perm_b32 v83, v71, v70, v4
    v_perm_b32 v87, v71, v70, v5
    buffer_store_dwordx4 v[80:83], v7, s[8:11], s30 offen offset:3072
    buffer_store_dwordx4 v[84:87], v7, s[8:11], s30 offen offset:3088
    s_nop 0
    s_waitcnt vmcnt(0)
    v_perm_b32 v88, v73, v72, v4
    v_perm_b32 v92, v73, v72, v5
    v_perm_b32 v89, v75, v74, v4
    v_perm_b32 v93, v75, v74, v5
    v_perm_b32 v90, v77, v76, v4
    v_perm_b32 v94, v77, v76, v5
    v_perm_b32 v91, v79, v78, v4
    v_perm_b32 v95, v79, v78, v5
    buffer_store_dwordx4 v[88:91], v7, s[8:11], s30 offen offset:3584
    buffer_store_dwordx4 v[92:95], v7, s[8:11], s30 offen offset:3600
    s_nop 0
    s_branch prep_kernel_end
prep_kernel_end:
    s_endpgm
.section .rodata,"a"
.p2align 6
.amdhsa_kernel prep_kernel
  .amdhsa_next_free_vgpr 248
  .amdhsa_next_free_sgpr 64
  .amdhsa_accum_offset 248
  .amdhsa_group_segment_fixed_size 0
  .amdhsa_kernarg_size 104
  .amdhsa_user_sgpr_count 2
  .amdhsa_user_sgpr_kernarg_segment_ptr 1
  .amdhsa_system_sgpr_workgroup_id_x 1
.end_amdhsa_kernel
.text
.globl ln_a1_kernel
.p2align 8
.type ln_a1_kernel,@function
ln_a1_kernel:
    v_lshrrev_b32 v1, 6, v0
    v_and_b32 v2, 63, v0
    s_nop 0
    v_readfirstlane_b32 s3, v1
    s_lshl_b32 s4, s2, 2
    s_add_u32 s4, s4, s3
    s_cmp_ge_u32 s4, 2048
    s_cbranch_scc1 ln_a1_kernel_end
    s_load_dwordx2 s[6:7], s[0:1], 0
    s_load_dwordx2 s[12:13], s[0:1], 96
    s_waitcnt lgkmcnt(0)
    s_mov_b32 s8, s6
    s_mov_b32 s9, s7
    s_mov_b32 s10, 2621440
    s_mov_b32 s11, 0x00020000
    s_add_u32 s16, s12, 223346688
    s_addc_u32 s17, s13, 0
    s_mov_b32 s18, 2621440
    s_mov_b32 s19, 0x00020000
    s_mul_i32 s5, s4, 1280
    v_lshlrev_b32 v3, 2, v2
    v_add_u32 v3, s5, v3
    buffer_load_dword v4, v3, s[8:11], 0 offen offset:0
    buffer_load_dword v5, v3, s[8:11], 0 offen offset:256
    buffer_load_dword v6, v3, s[8:11], 0 offen offset:512
    buffer_load_dword v7, v3, s[8:11], 0 offen offset:768
    buffer_load_dword v8, v3, s[8:11], 0 offen offset:1024
    s_waitcnt vmcnt(0)
    v_lshlrev_b32 v10, 16, v4
    v_and_b32 v11, 0xffff0000, v4
    v_lshlrev_b32 v12, 16, v5
    v_and_b32 v13, 0xffff0000, v5
    v_lshlrev_b32 v14, 16, v6
    v_and_b32 v15, 0xffff0000, v6
    v_lshlrev_b32 v16, 16, v7
    v_and_b32 v17, 0xffff0000, v7
    v_lshlrev_b32 v18, 16, v8
    v_and_b32 v19, 0xffff0000, v8
    v_add_f32 v20, v10, v11
    v_add_f32 v20, v20, v12
    v_add_f32 v20, v20, v13
    v_add_f32 v20, v20, v14
    v_add_f32 v20, v20, v15
    v_add_f32 v20, v20, v16
    v_add_f32 v20, v20, v17
    v_add_f32 v20, v20, v18
    v_add_f32 v20, v20, v19
    s_nop 1
    v_add_f32 v21, v20, v20 quad_perm:[1,0,3,2] row_mask:0xf bank_mask:0xf
    s_nop 1
    v_add_f32 v21, v21, v21 quad_perm:[2,3,0,1] row_mask:0xf bank_mask:0xf
    s_nop 1
    v_add_f32 v21, v21, v21 row_half_mirror row_mask:0xf bank_mask:0xf
    s_nop 1
    v_add_f32 v21, v21, v21 row_mirror row_mask:0xf bank_mask:0xf
    s_nop 1
    v_readlane_b32 s24, v21, 0
    v_readlane_b32 s25, v21, 16
    v_readlane_b32 s26, v21, 32
    v_readlane_b32 s27, v21, 48
    s_nop 1
    v_mov_b32 v20, s24
    v_add_f32 v20, s25, v20
    v_add_f32 v20, s26, v20
    v_add_f32 v20, s27, v20
    v_mul_f32 v20, 0.0015625, v20
    v_sub_f32 v10, v10, v20
    v_sub_f32 v11, v11, v20
    v_sub_f32 v12, v12, v20
    v_sub_f32 v13, v13, v20
    v_sub_f32 v14, v14, v20
    v_sub_f32 v15, v15, v20
    v_sub_f32 v16, v16, v20
    v_sub_f32 v17, v17, v20
    v_sub_f32 v18, v18, v20
    v_sub_f32 v19, v19, v20
    v_mul_f32 v21, v10, v10
    v_fmac_f32 v21, v11, v11
    v_fmac_f32 v21, v12, v12
    v_fmac_f32 v21, v13, v13
    v_fmac_f32 v21, v14, v14
    v_fmac_f32 v21, v15, v15
    v_fmac_f32 v21, v16, v16
    v_fmac_f32 v21, v17, v17
    v_fmac_f32 v21, v18, v18
    v_fmac_f32 v21, v19, v19
    s_nop 1
    v_add_f32 v22, v21, v21 quad_perm:[1,0,3,2] row_mask:0xf bank_mask:0xf
    s_nop 1
    v_add_f32 v22, v22, v22 quad_perm:[2,3,0,1] row_mask:0xf bank_mask:0xf
    s_nop 1
    v_add_f32 v22, v22, v22 row_half_mirror row_mask:0xf bank_mask:0xf
    s_nop 1
    v_add_f32 v22, v22, v22 row_mirror row_mask:0xf bank_mask:0xf
    s_nop 1
    v_readlane_b32 s24, v22, 0
    v_readlane_b32 s25, v22, 16
    v_readlane_b32 s26, v22, 32
    v_readlane_b32 s27, v22, 48
    s_nop 1
    v_mov_b32 v21, s24
    v_add_f32 v21, s25, v21
    v_add_f32 v21, s26, v21
    v_add_f32 v21, s27, v21
    v_mov_b32 v22, 0x3727c5ac
    v_fmac_f32 v22, 0.0015625, v21
    v_rsq_f32 v22, v22
    s_nop 0
    v_mul_f32 v10, v10, v22
    v_mul_f32 v11, v11, v22
    v_mul_f32 v12, v12, v22
    v_mul_f32 v13, v13, v22
    v_mul_f32 v14, v14, v22
    v_mul_f32 v15, v15, v22
    v_mul_f32 v16, v16, v22
    v_mul_f32 v17, v17, v22
    v_mul_f32 v18, v18, v22
    v_mul_f32 v19, v19, v22
    v_cvt_pk_bf16_f32 v4, v10, v11
    v_cvt_pk_bf16_f32 v5, v12, v13
    v_cvt_pk_bf16_f32 v6, v14, v15
    v_cvt_pk_bf16_f32 v7, v16, v17
    v_cvt_pk_bf16_f32 v8, v18, v19
    buffer_store_dword v4, v3, s[16:19], 0 offen offset:0
    buffer_store_dword v5, v3, s[16:19], 0 offen offset:256
    buffer_store_dword v6, v3, s[16:19], 0 offen offset:512
    buffer_store_dword v7, v3, s[16:19], 0 offen offset:768
    buffer_store_dword v8, v3, s[16:19], 0 offen offset:1024
ln_a1_kernel_end:
    s_endpgm
.section .rodata,"a"
.p2align 6
.amdhsa_kernel ln_a1_kernel
  .amdhsa_next_free_vgpr 32
  .amdhsa_next_free_sgpr 40
  .amdhsa_accum_offset 32
  .amdhsa_group_segment_fixed_size 0
  .amdhsa_kernarg_size 104
  .amdhsa_user_sgpr_count 2
  .amdhsa_user_sgpr_kernarg_segment_ptr 1
  .amdhsa_system_sgpr_workgroup_id_x 1
.end_amdhsa_kernel
.text
.globl qkv_a_kernel
.p2align 8
.type qkv_a_kernel,@function
qkv_a_kernel:
    v_lshrrev_b32 v1, 6, v0
    v_and_b32 v2, 63, v0
    s_nop 0
    v_readfirstlane_b32 s3, v1
    s_cmp_ge_u32 s2, 192
    s_cbranch_scc1 qkv_a_kernel_end
    s_load_dwordx2 s[4:5], s[0:1], 96
    s_load_dwordx2 s[6:7], s[0:1], 80
    s_mul_i32 s20, s2, 171
    s_lshr_b32 s20, s20, 12
    s_mul_i32 s21, s20, 24
    s_sub_u32 s21, s2, s21
    s_lshl_b32 s20, s20, 2
    s_add_u32 s20, s20, s3
    s_mul_i32 s22, s20, 64
    s_mul_i32 s23, s21, 80
    s_waitcnt lgkmcnt(0)
    s_mov_b32 s8, s4
    s_mov_b32 s9, s5
    s_mov_b32 s10, 268435456
    s_mov_b32 s11, 0x00020000
    v_and_b32 v3, 15, v2
    v_lshrrev_b32 v4, 4, v2
    s_mov_b32 s24, 1280
    v_add_u32 v5, s22, v3
    v_mul_lo_u32 v5, v5, s24
    v_lshlrev_b32 v6, 4, v4
    v_add_u32 v5, v5, v6
    v_add_u32 v5, 223346688, v5
    v_mov_b32 v8, v5
    v_add_u32 v9, 20480, v5
    v_add_u32 v10, 40960, v5
    v_add_u32 v11, 61440, v5
    v_lshlrev_b32 v7, 4, v2
    s_mov_b32 s25, 0
    s_mov_b32 s26, 0
    s_mul_i32 s27, s21, 102400
    s_add_u32 s27, s27, s26
    s_add_u32 s27, s27, 243269632
    s_add_u32 s32, s27, 0
    s_add_u32 s33, s27, 20480
    s_add_u32 s34, s27, 40960
    s_add_u32 s35, s27, 61440
    s_add_u32 s36, s27, 81920
    v_accvgpr_write_b32 a0, 0
    v_accvgpr_write_b32 a1, 0
    v_accvgpr_write_b32 a2, 0
    v_accvgpr_write_b32 a3, 0
    v_accvgpr_write_b32 a4, 0
    v_accvgpr_write_b32 a5, 0
    v_accvgpr_write_b32 a6, 0
    v_accvgpr_write_b32 a7, 0
    v_accvgpr_write_b32 a8, 0
    v_accvgpr_write_b32 a9, 0
    v_accvgpr_write_b32 a10, 0
    v_accvgpr_write_b32 a11, 0
    v_accvgpr_write_b32 a12, 0
    v_accvgpr_write_b32 a13, 0
    v_accvgpr_write_b32 a14, 0
    v_accvgpr_write_b32 a15, 0
    v_accvgpr_write_b32 a16, 0
    v_accvgpr_write_b32 a17, 0
    v_accvgpr_write_b32 a18, 0
    v_accvgpr_write_b32 a19, 0
    v_accvgpr_write_b32 a20, 0
    v_accvgpr_write_b32 a21, 0
    v_accvgpr_write_b32 a22, 0
    v_accvgpr_write_b32 a23, 0
    v_accvgpr_write_b32 a24, 0
    v_accvgpr_write_b32 a25, 0
    v_accvgpr_write_b32 a26, 0
    v_accvgpr_write_b32 a27, 0
    v_accvgpr_write_b32 a28, 0
    v_accvgpr_write_b32 a29, 0
    v_accvgpr_write_b32 a30, 0
    v_accvgpr_write_b32 a31, 0
    v_accvgpr_write_b32 a32, 0
    v_accvgpr_write_b32 a33, 0
    v_accvgpr_write_b32 a34, 0
    v_accvgpr_write_b32 a35, 0
    v_accvgpr_write_b32 a36, 0
    v_accvgpr_write_b32 a37, 0
    v_accvgpr_write_b32 a38, 0
    v_accvgpr_write_b32 a39, 0
    v_accvgpr_write_b32 a40, 0
    v_accvgpr_write_b32 a41, 0
    v_accvgpr_write_b32 a42, 0
    v_accvgpr_write_b32 a43, 0
    v_accvgpr_write_b32 a44, 0
    v_accvgpr_write_b32 a45, 0
    v_accvgpr_write_b32 a46, 0
    v_accvgpr_write_b32 a47, 0
    v_accvgpr_write_b32 a48, 0
    v_accvgpr_write_b32 a49, 0
    v_accvgpr_write_b32 a50, 0
    v_accvgpr_write_b32 a51, 0
    v_accvgpr_write_b32 a52, 0
    v_accvgpr_write_b32 a53, 0
    v_accvgpr_write_b32 a54, 0
    v_accvgpr_write_b32 a55, 0
    v_accvgpr_write_b32 a56, 0
    v_accvgpr_write_b32 a57, 0
    v_accvgpr_write_b32 a58, 0
    v_accvgpr_write_b32 a59, 0
    v_accvgpr_write_b32 a60, 0
    v_accvgpr_write_b32 a61, 0
    v_accvgpr_write_b32 a62, 0
    v_accvgpr_write_b32 a63, 0
    v_accvgpr_write_b32 a64, 0
    v_accvgpr_write_b32 a65, 0
    v_accvgpr_write_b32 a66, 0
    v_accvgpr_write_b32 a67, 0
    v_accvgpr_write_b32 a68, 0
    v_accvgpr_write_b32 a69, 0
    v_accvgpr_write_b32 a70, 0
    v_accvgpr_write_b32 a71, 0
    v_accvgpr_write_b32 a72, 0
    v_accvgpr_write_b32 a73, 0
    v_accvgpr_write_b32 a74, 0
    v_accvgpr_write_b32 a75, 0
    v_accvgpr_write_b32 a76, 0
    v_accvgpr_write_b32 a77, 0
    v_accvgpr_write_b32 a78, 0
    v_accvgpr_write_b32 a79, 0
    s_cmp_ge_u32 s23, 640
    s_cbranch_scc1 qkv_a_kernel_nrm
    buffer_load_dwordx4 v[16:19], v8, s[8:11], s25 offen
    buffer_load_dwordx4 v[20:23], v9, s[8:11], s25 offen
    buffer_load_dwordx4 v[24:27], v10, s[8:11], s25 offen
    buffer_load_dwordx4 v[28:31], v11, s[8:11], s25 offen
    buffer_load_dwordx4 v[32:35], v7, s[8:11], s32 offen
    buffer_load_dwordx4 v[36:39], v7, s[8:11], s33 offen
    buffer_load_dwordx4 v[40:43], v7, s[8:11], s34 offen
    buffer_load_dwordx4 v[44:47], v7, s[8:11], s35 offen
    buffer_load_dwordx4 v[48:51], v7, s[8:11], s36 offen
    s_mov_b32 s28, 10
qkv_a_kernel_loop0:
    s_add_u32 s25, s25, 64
    s_add_u32 s32, s32, 1024
    s_add_u32 s33, s33, 1024
    s_add_u32 s34, s34, 1024
    s_add_u32 s35, s35, 1024
    s_add_u32 s36, s36, 1024
    buffer_load_dwordx4 v[52:55], v8, s[8:11], s25 offen
    buffer_load_dwordx4 v[56:59], v9, s[8:11], s25 offen
    buffer_load_dwordx4 v[60:63], v10, s[8:11], s25 offen
    buffer_load_dwordx4 v[64:67], v11, s[8:11], s25 offen
    buffer_load_dwordx4 v[68:71], v7, s[8:11], s32 offen
    buffer_load_dwordx4 v[72:75], v7, s[8:11], s33 offen
    buffer_load_dwordx4 v[76:79], v7, s[8:11], s34 offen
    buffer_load_dwordx4 v[80:83], v7, s[8:11], s35 offen
    buffer_load_dwordx4 v[84:87], v7, s[8:11], s36 offen
    s_waitcnt vmcnt(9)
    v_mfma_f32_16x16x32_bf16 a[0:3], v[32:35], v[16:19], a[0:3]
    v_mfma_f32_16x16x32_bf16 a[20:23], v[32:35], v[20:23], a[20:23]
    v_mfma_f32_16x16x32_bf16 a[40:43], v[32:35], v[24:27], a[40:43]
    v_mfma_f32_16x16x32_bf16 a[60:63], v[32:35], v[28:31], a[60:63]
    v_mfma_f32_16x16x32_bf16 a[4:7], v[36:39], v[16:19], a[4:7]
    v_mfma_f32_16x16x32_bf16 a[24:27], v[36:39], v[20:23], a[24:27]
    v_mfma_f32_16x16x32_bf16 a[44:47], v[36:39], v[24:27], a[44:47]
    v_mfma_f32_16x16x32_bf16 a[64:67], v[36:39], v[28:31], a[64:67]
    v_mfma_f32_16x16x32_bf16 a[8:11], v[40:43], v[16:19], a[8:11]
    v_mfma_f32_16x16x32_bf16 a[28:31], v[40:43], v[20:23], a[28:31]
    v_mfma_f32_16x16x32_bf16 a[48:51], v[40:43], v[24:27], a[48:51]
    v_mfma_f32_16x16x32_bf16 a[68:71], v[40:43], v[28:31], a[68:71]
    v_mfma_f32_16x16x32_bf16 a[12:15], v[44:47], v[16:19], a[12:15]
    v_mfma_f32_16x16x32_bf16 a[32:35], v[44:47], v[20:23], a[32:35]
    v_mfma_f32_16x16x32_bf16 a[52:55], v[44:47], v[24:27], a[52:55]
    v_mfma_f32_16x16x32_bf16 a[72:75], v[44:47], v[28:31], a[72:75]
    v_mfma_f32_16x16x32_bf16 a[16:19], v[48:51], v[16:19], a[16:19]
    v_mfma_f32_16x16x32_bf16 a[36:39], v[48:51], v[20:23], a[36:39]
    v_mfma_f32_16x16x32_bf16 a[56:59], v[48:51], v[24:27], a[56:59]
    v_mfma_f32_16x16x32_bf16 a[76:79], v[48:51], v[28:31], a[76:79]
    s_sub_u32 s28, s28, 1
    s_cmp_eq_u32 s28, 0
    s_cbranch_scc1 qkv_a_kernel_loop0_last
    s_add_u32 s25, s25, 64
    s_add_u32 s32, s32, 1024
    s_add_u32 s33, s33, 1024
    s_add_u32 s34, s34, 1024
    s_add_u32 s35, s35, 1024
    s_add_u32 s36, s36, 1024
    buffer_load_dwordx4 v[16:19], v8, s[8:11], s25 offen
    buffer_load_dwordx4 v[20:23], v9, s[8:11], s25 offen
    buffer_load_dwordx4 v[24:27], v10, s[8:11], s25 offen
    buffer_load_dwordx4 v[28:31], v11, s[8:11], s25 offen
    buffer_load_dwordx4 v[32:35], v7, s[8:11], s32 offen
    buffer_load_dwordx4 v[36:39], v7, s[8:11], s33 offen
    buffer_load_dwordx4 v[40:43], v7, s[8:11], s34 offen
    buffer_load_dwordx4 v[44:47], v7, s[8:11], s35 offen
    buffer_load_dwordx4 v[48:51], v7, s[8:11], s36 offen
    s_waitcnt vmcnt(9)
    v_mfma_f32_16x16x32_bf16 a[0:3], v[68:71], v[52:55], a[0:3]
    v_mfma_f32_16x16x32_bf16 a[20:23], v[68:71], v[56:59], a[20:23]
    v_mfma_f32_16x16x32_bf16 a[40:43], v[68:71], v[60:63], a[40:43]
    v_mfma_f32_16x16x32_bf16 a[60:63], v[68:71], v[64:67], a[60:63]
    v_mfma_f32_16x16x32_bf16 a[4:7], v[72:75], v[52:55], a[4:7]
    v_mfma_f32_16x16x32_bf16 a[24:27], v[72:75], v[56:59], a[24:27]
    v_mfma_f32_16x16x32_bf16 a[44:47], v[72:75], v[60:63], a[44:47]
    v_mfma_f32_16x16x32_bf16 a[64:67], v[72:75], v[64:67], a[64:67]
    v_mfma_f32_16x16x32_bf16 a[8:11], v[76:79], v[52:55], a[8:11]
    v_mfma_f32_16x16x32_bf16 a[28:31], v[76:79], v[56:59], a[28:31]
    v_mfma_f32_16x16x32_bf16 a[48:51], v[76:79], v[60:63], a[48:51]
    v_mfma_f32_16x16x32_bf16 a[68:71], v[76:79], v[64:67], a[68:71]
    v_mfma_f32_16x16x32_bf16 a[12:15], v[80:83], v[52:55], a[12:15]
    v_mfma_f32_16x16x32_bf16 a[32:35], v[80:83], v[56:59], a[32:35]
    v_mfma_f32_16x16x32_bf16 a[52:55], v[80:83], v[60:63], a[52:55]
    v_mfma_f32_16x16x32_bf16 a[72:75], v[80:83], v[64:67], a[72:75]
    v_mfma_f32_16x16x32_bf16 a[16:19], v[84:87], v[52:55], a[16:19]
    v_mfma_f32_16x16x32_bf16 a[36:39], v[84:87], v[56:59], a[36:39]
    v_mfma_f32_16x16x32_bf16 a[56:59], v[84:87], v[60:63], a[56:59]
    v_mfma_f32_16x16x32_bf16 a[76:79], v[84:87], v[64:67], a[76:79]
    s_branch qkv_a_kernel_loop0
qkv_a_kernel_loop0_last:
    s_waitcnt vmcnt(0)
    v_mfma_f32_16x16x32_bf16 a[0:3], v[68:71], v[52:55], a[0:3]
    v_mfma_f32_16x16x32_bf16 a[20:23], v[68:71], v[56:59], a[20:23]
    v_mfma_f32_16x16x32_bf16 a[40:43], v[68:71], v[60:63], a[40:43]
    v_mfma_f32_16x16x32_bf16 a[60:63], v[68:71], v[64:67], a[60:63]
    v_mfma_f32_16x16x32_bf16 a[4:7], v[72:75], v[52:55], a[4:7]
    v_mfma_f32_16x16x32_bf16 a[24:27], v[72:75], v[56:59], a[24:27]
    v_mfma_f32_16x16x32_bf16 a[44:47], v[72:75], v[60:63], a[44:47]
    v_mfma_f32_16x16x32_bf16 a[64:67], v[72:75], v[64:67], a[64:67]
    v_mfma_f32_16x16x32_bf16 a[8:11], v[76:79], v[52:55], a[8:11]
    v_mfma_f32_16x16x32_bf16 a[28:31], v[76:79], v[56:59], a[28:31]
    v_mfma_f32_16x16x32_bf16 a[48:51], v[76:79], v[60:63], a[48:51]
    v_mfma_f32_16x16x32_bf16 a[68:71], v[76:79], v[64:67], a[68:71]
    v_mfma_f32_16x16x32_bf16 a[12:15], v[80:83], v[52:55], a[12:15]
    v_mfma_f32_16x16x32_bf16 a[32:35], v[80:83], v[56:59], a[32:35]
    v_mfma_f32_16x16x32_bf16 a[52:55], v[80:83], v[60:63], a[52:55]
    v_mfma_f32_16x16x32_bf16 a[72:75], v[80:83], v[64:67], a[72:75]
    v_mfma_f32_16x16x32_bf16 a[16:19], v[84:87], v[52:55], a[16:19]
    v_mfma_f32_16x16x32_bf16 a[36:39], v[84:87], v[56:59], a[36:39]
    v_mfma_f32_16x16x32_bf16 a[56:59], v[84:87], v[60:63], a[56:59]
    v_mfma_f32_16x16x32_bf16 a[76:79], v[84:87], v[64:67], a[76:79]
    s_nop 7
    s_nop 7
    s_mov_b32 s24, 1280
    s_lshl_b32 s29, s23, 1
    s_add_u32 s29, s29, 229638144
    v_add_u32 v5, s22, v3
    v_mul_lo_u32 v5, v5, s24
    v_lshlrev_b32 v6, 3, v4
    v_add3_u32 v5, v5, v6, s29
    v_accvgpr_read_b32 v92, a0
    v_accvgpr_read_b32 v93, a1
    v_accvgpr_read_b32 v94, a2
    v_accvgpr_read_b32 v95, a3
    v_cvt_pk_bf16_f32 v96, v92, v93
    v_cvt_pk_bf16_f32 v97, v94, v95
    v_add_u32 v6, 0, v5
    buffer_store_dwordx2 v[96:97], v6, s[8:11], 0 offen
    v_accvgpr_read_b32 v92, a4
    v_accvgpr_read_b32 v93, a5
    v_accvgpr_read_b32 v94, a6
    v_accvgpr_read_b32 v95, a7
    v_cvt_pk_bf16_f32 v96, v92, v93
    v_cvt_pk_bf16_f32 v97, v94, v95
    v_add_u32 v6, 32, v5
    buffer_store_dwordx2 v[96:97], v6, s[8:11], 0 offen
    v_accvgpr_read_b32 v92, a8
    v_accvgpr_read_b32 v93, a9
    v_accvgpr_read_b32 v94, a10
    v_accvgpr_read_b32 v95, a11
    v_cvt_pk_bf16_f32 v96, v92, v93
    v_cvt_pk_bf16_f32 v97, v94, v95
    v_add_u32 v6, 64, v5
    buffer_store_dwordx2 v[96:97], v6, s[8:11], 0 offen
    v_accvgpr_read_b32 v92, a12
    v_accvgpr_read_b32 v93, a13
    v_accvgpr_read_b32 v94, a14
    v_accvgpr_read_b32 v95, a15
    v_cvt_pk_bf16_f32 v96, v92, v93
    v_cvt_pk_bf16_f32 v97, v94, v95
    v_add_u32 v6, 96, v5
    buffer_store_dwordx2 v[96:97], v6, s[8:11], 0 offen
    v_accvgpr_read_b32 v92, a16
    v_accvgpr_read_b32 v93, a17
    v_accvgpr_read_b32 v94, a18
    v_accvgpr_read_b32 v95, a19
    v_cvt_pk_bf16_f32 v96, v92, v93
    v_cvt_pk_bf16_f32 v97, v94, v95
    v_add_u32 v6, 128, v5
    buffer_store_dwordx2 v[96:97], v6, s[8:11], 0 offen
    v_accvgpr_read_b32 v92, a20
    v_accvgpr_read_b32 v93, a21
    v_accvgpr_read_b32 v94, a22
    v_accvgpr_read_b32 v95, a23
    v_cvt_pk_bf16_f32 v96, v92, v93
    v_cvt_pk_bf16_f32 v97, v94, v95
    v_add_u32 v6, 20480, v5
    buffer_store_dwordx2 v[96:97], v6, s[8:11], 0 offen
    v_accvgpr_read_b32 v92, a24
    v_accvgpr_read_b32 v93, a25
    v_accvgpr_read_b32 v94, a26
    v_accvgpr_read_b32 v95, a27
    v_cvt_pk_bf16_f32 v96, v92, v93
    v_cvt_pk_bf16_f32 v97, v94, v95
    v_add_u32 v6, 20512, v5
    buffer_store_dwordx2 v[96:97], v6, s[8:11], 0 offen
    v_accvgpr_read_b32 v92, a28
    v_accvgpr_read_b32 v93, a29
    v_accvgpr_read_b32 v94, a30
    v_accvgpr_read_b32 v95, a31
    v_cvt_pk_bf16_f32 v96, v92, v93
    v_cvt_pk_bf16_f32 v97, v94, v95
    v_add_u32 v6, 20544, v5
    buffer_store_dwordx2 v[96:97], v6, s[8:11], 0 offen
    v_accvgpr_read_b32 v92, a32
    v_accvgpr_read_b32 v93, a33
    v_accvgpr_read_b32 v94, a34
    v_accvgpr_read_b32 v95, a35
    v_cvt_pk_bf16_f32 v96, v92, v93
    v_cvt_pk_bf16_f32 v97, v94, v95
    v_add_u32 v6, 20576, v5
    buffer_store_dwordx2 v[96:97], v6, s[8:11], 0 offen
    v_accvgpr_read_b32 v92, a36
    v_accvgpr_read_b32 v93, a37
    v_accvgpr_read_b32 v94, a38
    v_accvgpr_read_b32 v95, a39
    v_cvt_pk_bf16_f32 v96, v92, v93
    v_cvt_pk_bf16_f32 v97, v94, v95
    v_add_u32 v6, 20608, v5
    buffer_store_dwordx2 v[96:97], v6, s[8:11], 0 offen
    v_accvgpr_read_b32 v92, a40
    v_accvgpr_read_b32 v93, a41
    v_accvgpr_read_b32 v94, a42
    v_accvgpr_read_b32 v95, a43
    v_cvt_pk_bf16_f32 v96, v92, v93
    v_cvt_pk_bf16_f32 v97, v94, v95
    v_add_u32 v6, 40960, v5
    buffer_store_dwordx2 v[96:97], v6, s[8:11], 0 offen
    v_accvgpr_read_b32 v92, a44
    v_accvgpr_read_b32 v93, a45
    v_accvgpr_read_b32 v94, a46
    v_accvgpr_read_b32 v95, a47
    v_cvt_pk_bf16_f32 v96, v92, v93
    v_cvt_pk_bf16_f32 v97, v94, v95
    v_add_u32 v6, 40992, v5
    buffer_store_dwordx2 v[96:97], v6, s[8:11], 0 offen
    v_accvgpr_read_b32 v92, a48
    v_accvgpr_read_b32 v93, a49
    v_accvgpr_read_b32 v94, a50
    v_accvgpr_read_b32 v95, a51
    v_cvt_pk_bf16_f32 v96, v92, v93
    v_cvt_pk_bf16_f32 v97, v94, v95
    v_add_u32 v6, 41024, v5
    buffer_store_dwordx2 v[96:97], v6, s[8:11], 0 offen
    v_accvgpr_read_b32 v92, a52
    v_accvgpr_read_b32 v93, a53
    v_accvgpr_read_b32 v94, a54
    v_accvgpr_read_b32 v95, a55
    v_cvt_pk_bf16_f32 v96, v92, v93
    v_cvt_pk_bf16_f32 v97, v94, v95
    v_add_u32 v6, 41056, v5
    buffer_store_dwordx2 v[96:97], v6, s[8:11], 0 offen
    v_accvgpr_read_b32 v92, a56
    v_accvgpr_read_b32 v93, a57
    v_accvgpr_read_b32 v94, a58
    v_accvgpr_read_b32 v95, a59
    v_cvt_pk_bf16_f32 v96, v92, v93
    v_cvt_pk_bf16_f32 v97, v94, v95
    v_add_u32 v6, 41088, v5
    buffer_store_dwordx2 v[96:97], v6, s[8:11], 0 offen
    v_accvgpr_read_b32 v92, a60
    v_accvgpr_read_b32 v93, a61
    v_accvgpr_read_b32 v94, a62
    v_accvgpr_read_b32 v95, a63
    v_cvt_pk_bf16_f32 v96, v92, v93
    v_cvt_pk_bf16_f32 v97, v94, v95
    v_add_u32 v6, 61440, v5
    buffer_store_dwordx2 v[96:97], v6, s[8:11], 0 offen
    v_accvgpr_read_b32 v92, a64
    v_accvgpr_read_b32 v93, a65
    v_accvgpr_read_b32 v94, a66
    v_accvgpr_read_b32 v95, a67
    v_cvt_pk_bf16_f32 v96, v92, v93
    v_cvt_pk_bf16_f32 v97, v94, v95
    v_add_u32 v6, 61472, v5
    buffer_store_dwordx2 v[96:97], v6, s[8:11], 0 offen
    v_accvgpr_read_b32 v92, a68
    v_accvgpr_read_b32 v93, a69
    v_accvgpr_read_b32 v94, a70
    v_accvgpr_read_b32 v95, a71
    v_cvt_pk_bf16_f32 v96, v92, v93
    v_cvt_pk_bf16_f32 v97, v94, v95
    v_add_u32 v6, 61504, v5
    buffer_store_dwordx2 v[96:97], v6, s[8:11], 0 offen
    v_accvgpr_read_b32 v92, a72
    v_accvgpr_read_b32 v93, a73
    v_accvgpr_read_b32 v94, a74
    v_accvgpr_read_b32 v95, a75
    v_cvt_pk_bf16_f32 v96, v92, v93
    v_cvt_pk_bf16_f32 v97, v94, v95
    v_add_u32 v6, 61536, v5
    buffer_store_dwordx2 v[96:97], v6, s[8:11], 0 offen
    v_accvgpr_read_b32 v92, a76
    v_accvgpr_read_b32 v93, a77
    v_accvgpr_read_b32 v94, a78
    v_accvgpr_read_b32 v95, a79
    v_cvt_pk_bf16_f32 v96, v92, v93
    v_cvt_pk_bf16_f32 v97, v94, v95
    v_add_u32 v6, 61568, v5
    buffer_store_dwordx2 v[96:97], v6, s[8:11], 0 offen
    s_branch qkv_a_kernel_end
qkv_a_kernel_nrm:
    buffer_load_dwordx4 v[16:19], v8, s[8:11], s25 offen
    buffer_load_dwordx4 v[20:23], v9, s[8:11], s25 offen
    buffer_load_dwordx4 v[24:27], v10, s[8:11], s25 offen
    buffer_load_dwordx4 v[28:31], v11, s[8:11], s25 offen
    buffer_load_dwordx4 v[32:35], v7, s[8:11], s32 offen
    buffer_load_dwordx4 v[36:39], v7, s[8:11], s33 offen
    buffer_load_dwordx4 v[40:43], v7, s[8:11], s34 offen
    buffer_load_dwordx4 v[44:47], v7, s[8:11], s35 offen
    buffer_load_dwordx4 v[48:51], v7, s[8:11], s36 offen
    s_mov_b32 s28, 10
qkv_a_kernel_loop1:
    s_add_u32 s25, s25, 64
    s_add_u32 s32, s32, 1024
    s_add_u32 s33, s33, 1024
    s_add_u32 s34, s34, 1024
    s_add_u32 s35, s35, 1024
    s_add_u32 s36, s36, 1024
    buffer_load_dwordx4 v[52:55], v8, s[8:11], s25 offen
    buffer_load_dwordx4 v[56:59], v9, s[8:11], s25 offen
    buffer_load_dwordx4 v[60:63], v10, s[8:11], s25 offen
    buffer_load_dwordx4 v[64:67], v11, s[8:11], s25 offen
    buffer_load_dwordx4 v[68:71], v7, s[8:11], s32 offen
    buffer_load_dwordx4 v[72:75], v7, s[8:11], s33 offen
    buffer_load_dwordx4 v[76:79], v7, s[8:11], s34 offen
    buffer_load_dwordx4 v[80:83], v7, s[8:11], s35 offen
    buffer_load_dwordx4 v[84:87], v7, s[8:11], s36 offen
    s_waitcnt vmcnt(9)
    v_mfma_f32_16x16x32_bf16 a[0:3], v[16:19], v[32:35], a[0:3]
    v_mfma_f32_16x16x32_bf16 a[20:23], v[20:23], v[32:35], a[20:23]
    v_mfma_f32_16x16x32_bf16 a[40:43], v[24:27], v[32:35], a[40:43]
    v_mfma_f32_16x16x32_bf16 a[60:63], v[28:31], v[32:35], a[60:63]
    v_mfma_f32_16x16x32_bf16 a[4:7], v[16:19], v[36:39], a[4:7]
    v_mfma_f32_16x16x32_bf16 a[24:27], v[20:23], v[36:39], a[24:27]
    v_mfma_f32_16x16x32_bf16 a[44:47], v[24:27], v[36:39], a[44:47]
    v_mfma_f32_16x16x32_bf16 a[64:67], v[28:31], v[36:39], a[64:67]
    v_mfma_f32_16x16x32_bf16 a[8:11], v[16:19], v[40:43], a[8:11]
    v_mfma_f32_16x16x32_bf16 a[28:31], v[20:23], v[40:43], a[28:31]
    v_mfma_f32_16x16x32_bf16 a[48:51], v[24:27], v[40:43], a[48:51]
    v_mfma_f32_16x16x32_bf16 a[68:71], v[28:31], v[40:43], a[68:71]
    v_mfma_f32_16x16x32_bf16 a[12:15], v[16:19], v[44:47], a[12:15]
    v_mfma_f32_16x16x32_bf16 a[32:35], v[20:23], v[44:47], a[32:35]
    v_mfma_f32_16x16x32_bf16 a[52:55], v[24:27], v[44:47], a[52:55]
    v_mfma_f32_16x16x32_bf16 a[72:75], v[28:31], v[44:47], a[72:75]
    v_mfma_f32_16x16x32_bf16 a[16:19], v[16:19], v[48:51], a[16:19]
    v_mfma_f32_16x16x32_bf16 a[36:39], v[20:23], v[48:51], a[36:39]
    v_mfma_f32_16x16x32_bf16 a[56:59], v[24:27], v[48:51], a[56:59]
    v_mfma_f32_16x16x32_bf16 a[76:79], v[28:31], v[48:51], a[76:79]
    s_sub_u32 s28, s28, 1
    s_cmp_eq_u32 s28, 0
    s_cbranch_scc1 qkv_a_kernel_loop1_last
    s_add_u32 s25, s25, 64
    s_add_u32 s32, s32, 1024
    s_add_u32 s33, s33, 1024
    s_add_u32 s34, s34, 1024
    s_add_u32 s35, s35, 1024
    s_add_u32 s36, s36, 1024
    buffer_load_dwordx4 v[16:19], v8, s[8:11], s25 offen
    buffer_load_dwordx4 v[20:23], v9, s[8:11], s25 offen
    buffer_load_dwordx4 v[24:27], v10, s[8:11], s25 offen
    buffer_load_dwordx4 v[28:31], v11, s[8:11], s25 offen
    buffer_load_dwordx4 v[32:35], v7, s[8:11], s32 offen
    buffer_load_dwordx4 v[36:39], v7, s[8:11], s33 offen
    buffer_load_dwordx4 v[40:43], v7, s[8:11], s34 offen
    buffer_load_dwordx4 v[44:47], v7, s[8:11], s35 offen
    buffer_load_dwordx4 v[48:51], v7, s[8:11], s36 offen
    s_waitcnt vmcnt(9)
    v_mfma_f32_16x16x32_bf16 a[0:3], v[52:55], v[68:71], a[0:3]
    v_mfma_f32_16x16x32_bf16 a[20:23], v[56:59], v[68:71], a[20:23]
    v_mfma_f32_16x16x32_bf16 a[40:43], v[60:63], v[68:71], a[40:43]
    v_mfma_f32_16x16x32_bf16 a[60:63], v[64:67], v[68:71], a[60:63]
    v_mfma_f32_16x16x32_bf16 a[4:7], v[52:55], v[72:75], a[4:7]
    v_mfma_f32_16x16x32_bf16 a[24:27], v[56:59], v[72:75], a[24:27]
    v_mfma_f32_16x16x32_bf16 a[44:47], v[60:63], v[72:75], a[44:47]
    v_mfma_f32_16x16x32_bf16 a[64:67], v[64:67], v[72:75], a[64:67]
    v_mfma_f32_16x16x32_bf16 a[8:11], v[52:55], v[76:79], a[8:11]
    v_mfma_f32_16x16x32_bf16 a[28:31], v[56:59], v[76:79], a[28:31]
    v_mfma_f32_16x16x32_bf16 a[48:51], v[60:63], v[76:79], a[48:51]
    v_mfma_f32_16x16x32_bf16 a[68:71], v[64:67], v[76:79], a[68:71]
    v_mfma_f32_16x16x32_bf16 a[12:15], v[52:55], v[80:83], a[12:15]
    v_mfma_f32_16x16x32_bf16 a[32:35], v[56:59], v[80:83], a[32:35]
    v_mfma_f32_16x16x32_bf16 a[52:55], v[60:63], v[80:83], a[52:55]
    v_mfma_f32_16x16x32_bf16 a[72:75], v[64:67], v[80:83], a[72:75]
    v_mfma_f32_16x16x32_bf16 a[16:19], v[52:55], v[84:87], a[16:19]
    v_mfma_f32_16x16x32_bf16 a[36:39], v[56:59], v[84:87], a[36:39]
    v_mfma_f32_16x16x32_bf16 a[56:59], v[60:63], v[84:87], a[56:59]
    v_mfma_f32_16x16x32_bf16 a[76:79], v[64:67], v[84:87], a[76:79]
    s_branch qkv_a_kernel_loop1
qkv_a_kernel_loop1_last:
    s_waitcnt vmcnt(0)
    v_mfma_f32_16x16x32_bf16 a[0:3], v[52:55], v[68:71], a[0:3]
    v_mfma_f32_16x16x32_bf16 a[20:23], v[56:59], v[68:71], a[20:23]
    v_mfma_f32_16x16x32_bf16 a[40:43], v[60:63], v[68:71], a[40:43]
    v_mfma_f32_16x16x32_bf16 a[60:63], v[64:67], v[68:71], a[60:63]
    v_mfma_f32_16x16x32_bf16 a[4:7], v[52:55], v[72:75], a[4:7]
    v_mfma_f32_16x16x32_bf16 a[24:27], v[56:59], v[72:75], a[24:27]
    v_mfma_f32_16x16x32_bf16 a[44:47], v[60:63], v[72:75], a[44:47]
    v_mfma_f32_16x16x32_bf16 a[64:67], v[64:67], v[72:75], a[64:67]
    v_mfma_f32_16x16x32_bf16 a[8:11], v[52:55], v[76:79], a[8:11]
    v_mfma_f32_16x16x32_bf16 a[28:31], v[56:59], v[76:79], a[28:31]
    v_mfma_f32_16x16x32_bf16 a[48:51], v[60:63], v[76:79], a[48:51]
    v_mfma_f32_16x16x32_bf16 a[68:71], v[64:67], v[76:79], a[68:71]
    v_mfma_f32_16x16x32_bf16 a[12:15], v[52:55], v[80:83], a[12:15]
    v_mfma_f32_16x16x32_bf16 a[32:35], v[56:59], v[80:83], a[32:35]
    v_mfma_f32_16x16x32_bf16 a[52:55], v[60:63], v[80:83], a[52:55]
    v_mfma_f32_16x16x32_bf16 a[72:75], v[64:67], v[80:83], a[72:75]
    v_mfma_f32_16x16x32_bf16 a[16:19], v[52:55], v[84:87], a[16:19]
    v_mfma_f32_16x16x32_bf16 a[36:39], v[56:59], v[84:87], a[36:39]
    v_mfma_f32_16x16x32_bf16 a[56:59], v[60:63], v[84:87], a[56:59]
    v_mfma_f32_16x16x32_bf16 a[76:79], v[64:67], v[84:87], a[76:79]
    s_nop 7
    s_nop 7
    s_sub_u32 s29, s23, 640
    v_add_u32 v5, s29, v3
    v_lshlrev_b32 v5, 11, v5
    v_lshlrev_b32 v6, 2, v4
    v_add3_u32 v5, v5, v6, s22
    v_lshlrev_b32 v5, 1, v5
    v_add_u32 v5, 232783872, v5
    v_accvgpr_read_b32 v92, a0
    v_accvgpr_read_b32 v93, a1
    v_accvgpr_read_b32 v94, a2
    v_accvgpr_read_b32 v95, a3
    v_cvt_pk_bf16_f32 v96, v92, v93
    v_cvt_pk_bf16_f32 v97, v94, v95
    v_add_u32 v6, 0, v5
    buffer_store_dwordx2 v[96:97], v6, s[8:11], 0 offen
    v_accvgpr_read_b32 v92, a4
    v_accvgpr_read_b32 v93, a5
    v_accvgpr_read_b32 v94, a6
    v_accvgpr_read_b32 v95, a7
    v_cvt_pk_bf16_f32 v96, v92, v93
    v_cvt_pk_bf16_f32 v97, v94, v95
    v_add_u32 v6, 65536, v5
    buffer_store_dwordx2 v[96:97], v6, s[8:11], 0 offen
    v_accvgpr_read_b32 v92, a8
    v_accvgpr_read_b32 v93, a9
    v_accvgpr_read_b32 v94, a10
    v_accvgpr_read_b32 v95, a11
    v_cvt_pk_bf16_f32 v96, v92, v93
    v_cvt_pk_bf16_f32 v97, v94, v95
    v_add_u32 v6, 131072, v5
    buffer_store_dwordx2 v[96:97], v6, s[8:11], 0 offen
    v_accvgpr_read_b32 v92, a12
    v_accvgpr_read_b32 v93, a13
    v_accvgpr_read_b32 v94, a14
    v_accvgpr_read_b32 v95, a15
    v_cvt_pk_bf16_f32 v96, v92, v93
    v_cvt_pk_bf16_f32 v97, v94, v95
    v_add_u32 v6, 196608, v5
    buffer_store_dwordx2 v[96:97], v6, s[8:11], 0 offen
    v_accvgpr_read_b32 v92, a16
    v_accvgpr_read_b32 v93, a17
    v_accvgpr_read_b32 v94, a18
    v_accvgpr_read_b32 v95, a19
    v_cvt_pk_bf16_f32 v96, v92, v93
    v_cvt_pk_bf16_f32 v97, v94, v95
    v_add_u32 v6, 262144, v5
    buffer_store_dwordx2 v[96:97], v6, s[8:11], 0 offen
    v_accvgpr_read_b32 v92, a20
    v_accvgpr_read_b32 v93, a21
    v_accvgpr_read_b32 v94, a22
    v_accvgpr_read_b32 v95, a23
    v_cvt_pk_bf16_f32 v96, v92, v93
    v_cvt_pk_bf16_f32 v97, v94, v95
    v_add_u32 v6, 32, v5
    buffer_store_dwordx2 v[96:97], v6, s[8:11], 0 offen
    v_accvgpr_read_b32 v92, a24
    v_accvgpr_read_b32 v93, a25
    v_accvgpr_read_b32 v94, a26
    v_accvgpr_read_b32 v95, a27
    v_cvt_pk_bf16_f32 v96, v92, v93
    v_cvt_pk_bf16_f32 v97, v94, v95
    v_add_u32 v6, 65568, v5
    buffer_store_dwordx2 v[96:97], v6, s[8:11], 0 offen
    v_accvgpr_read_b32 v92, a28
    v_accvgpr_read_b32 v93, a29
    v_accvgpr_read_b32 v94, a30
    v_accvgpr_read_b32 v95, a31
    v_cvt_pk_bf16_f32 v96, v92, v93
    v_cvt_pk_bf16_f32 v97, v94, v95
    v_add_u32 v6, 131104, v5
    buffer_store_dwordx2 v[96:97], v6, s[8:11], 0 offen
    v_accvgpr_read_b32 v92, a32
    v_accvgpr_read_b32 v93, a33
    v_accvgpr_read_b32 v94, a34
    v_accvgpr_read_b32 v95, a35
    v_cvt_pk_bf16_f32 v96, v92, v93
    v_cvt_pk_bf16_f32 v97, v94, v95
    v_add_u32 v6, 196640, v5
    buffer_store_dwordx2 v[96:97], v6, s[8:11], 0 offen
    v_accvgpr_read_b32 v92, a36
    v_accvgpr_read_b32 v93, a37
    v_accvgpr_read_b32 v94, a38
    v_accvgpr_read_b32 v95, a39
    v_cvt_pk_bf16_f32 v96, v92, v93
    v_cvt_pk_bf16_f32 v97, v94, v95
    v_add_u32 v6, 262176, v5
    buffer_store_dwordx2 v[96:97], v6, s[8:11], 0 offen
    v_accvgpr_read_b32 v92, a40
    v_accvgpr_read_b32 v93, a41
    v_accvgpr_read_b32 v94, a42
    v_accvgpr_read_b32 v95, a43
    v_cvt_pk_bf16_f32 v96, v92, v93
    v_cvt_pk_bf16_f32 v97, v94, v95
    v_add_u32 v6, 64, v5
    buffer_store_dwordx2 v[96:97], v6, s[8:11], 0 offen
    v_accvgpr_read_b32 v92, a44
    v_accvgpr_read_b32 v93, a45
    v_accvgpr_read_b32 v94, a46
    v_accvgpr_read_b32 v95, a47
    v_cvt_pk_bf16_f32 v96, v92, v93
    v_cvt_pk_bf16_f32 v97, v94, v95
    v_add_u32 v6, 65600, v5
    buffer_store_dwordx2 v[96:97], v6, s[8:11], 0 offen
    v_accvgpr_read_b32 v92, a48
    v_accvgpr_read_b32 v93, a49
    v_accvgpr_read_b32 v94, a50
    v_accvgpr_read_b32 v95, a51
    v_cvt_pk_bf16_f32 v96, v92, v93
    v_cvt_pk_bf16_f32 v97, v94, v95
    v_add_u32 v6, 131136, v5
    buffer_store_dwordx2 v[96:97], v6, s[8:11], 0 offen
    v_accvgpr_read_b32 v92, a52
    v_accvgpr_read_b32 v93, a53
    v_accvgpr_read_b32 v94, a54
    v_accvgpr_read_b32 v95, a55
    v_cvt_pk_bf16_f32 v96, v92, v93
    v_cvt_pk_bf16_f32 v97, v94, v95
    v_add_u32 v6, 196672, v5
    buffer_store_dwordx2 v[96:97], v6, s[8:11], 0 offen
    v_accvgpr_read_b32 v92, a56
    v_accvgpr_read_b32 v93, a57
    v_accvgpr_read_b32 v94, a58
    v_accvgpr_read_b32 v95, a59
    v_cvt_pk_bf16_f32 v96, v92, v93
    v_cvt_pk_bf16_f32 v97, v94, v95
    v_add_u32 v6, 262208, v5
    buffer_store_dwordx2 v[96:97], v6, s[8:11], 0 offen
    v_accvgpr_read_b32 v92, a60
    v_accvgpr_read_b32 v93, a61
    v_accvgpr_read_b32 v94, a62
    v_accvgpr_read_b32 v95, a63
    v_cvt_pk_bf16_f32 v96, v92, v93
    v_cvt_pk_bf16_f32 v97, v94, v95
    v_add_u32 v6, 96, v5
    buffer_store_dwordx2 v[96:97], v6, s[8:11], 0 offen
    v_accvgpr_read_b32 v92, a64
    v_accvgpr_read_b32 v93, a65
    v_accvgpr_read_b32 v94, a66
    v_accvgpr_read_b32 v95, a67
    v_cvt_pk_bf16_f32 v96, v92, v93
    v_cvt_pk_bf16_f32 v97, v94, v95
    v_add_u32 v6, 65632, v5
    buffer_store_dwordx2 v[96:97], v6, s[8:11], 0 offen
    v_accvgpr_read_b32 v92, a68
    v_accvgpr_read_b32 v93, a69
    v_accvgpr_read_b32 v94, a70
    v_accvgpr_read_b32 v95, a71
    v_cvt_pk_bf16_f32 v96, v92, v93
    v_cvt_pk_bf16_f32 v97, v94, v95
    v_add_u32 v6, 131168, v5
    buffer_store_dwordx2 v[96:97], v6, s[8:11], 0 offen
    v_accvgpr_read_b32 v92, a72
    v_accvgpr_read_b32 v93, a73
    v_accvgpr_read_b32 v94, a74
    v_accvgpr_read_b32 v95, a75
    v_cvt_pk_bf16_f32 v96, v92, v93
    v_cvt_pk_bf16_f32 v97, v94, v95
    v_add_u32 v6, 196704, v5
    buffer_store_dwordx2 v[96:97], v6, s[8:11], 0 offen
    v_accvgpr_read_b32 v92, a76
    v_accvgpr_read_b32 v93, a77
    v_accvgpr_read_b32 v94, a78
    v_accvgpr_read_b32 v95, a79
    v_cvt_pk_bf16_f32 v96, v92, v93
    v_cvt_pk_bf16_f32 v97, v94, v95
    v_add_u32 v6, 262240, v5
    buffer_store_dwordx2 v[96:97], v6, s[8:11], 0 offen
qkv_a_kernel_end:
    s_endpgm
.section .rodata,"a"
.p2align 6
.amdhsa_kernel qkv_a_kernel
  .amdhsa_next_free_vgpr 192
  .amdhsa_next_free_sgpr 64
  .amdhsa_accum_offset 112
  .amdhsa_group_segment_fixed_size 0
  .amdhsa_kernarg_size 104
  .amdhsa_user_sgpr_count 2
  .amdhsa_user_sgpr_kernarg_segment_ptr 1
  .amdhsa_system_sgpr_workgroup_id_x 1
.end_amdhsa_kernel
.text
.globl kvz_a1_kernel
.p2align 8
.type kvz_a1_kernel,@function
kvz_a1_kernel:
    v_lshrrev_b32 v1, 6, v0
    v_and_b32 v2, 63, v0
    s_nop 0
    v_readfirstlane_b32 s3, v1
    s_lshl_b32 s4, s2, 2
    s_add_u32 s4, s4, s3
    s_cmp_ge_u32 s4, 512
    s_cbranch_scc1 kvz_a1_kernel_end
    s_load_dwordx2 s[6:7], s[0:1], 96
    s_waitcnt lgkmcnt(0)
    s_mov_b32 s8, s6
    s_mov_b32 s9, s7
    s_mov_b32 s10, 268435456
    s_mov_b32 s11, 0x00020000
    s_lshr_b32 s5, s4, 4
    s_and_b32 s12, s4, 15
    s_mul_i32 s13, s5, 20
    v_and_b32 v3, 15, v2
    v_lshrrev_b32 v4, 4, v2
    s_lshl_b32 s14, s12, 7
    v_lshlrev_b32 v5, 3, v4
    v_add_u32 v5, s14, v5
    v_add_u32 v6, 0, v3
    v_min_u32 v8, 19, v6
    v_add_u32 v8, s13, v8
    v_lshlrev_b32 v8, 11, v8
    v_add_u32 v8, v8, v5
    v_lshlrev_b32 v8, 1, v8
    v_add_u32 v8, 232783872, v8
    v_add_u32 v10, 2621440, v8
    v_add_u32 v7, 16, v3
    v_min_u32 v9, 19, v7
    v_add_u32 v9, s13, v9
    v_lshlrev_b32 v9, 11, v9
    v_add_u32 v9, v9, v5
    v_lshlrev_b32 v9, 1, v9
    v_add_u32 v9, 232783872, v9
    v_add_u32 v11, 2621440, v9
    v_accvgpr_write_b32 a0, 0
    v_accvgpr_write_b32 a1, 0
    v_accvgpr_write_b32 a2, 0
    v_accvgpr_write_b32 a3, 0
    v_accvgpr_write_b32 a4, 0
    v_accvgpr_write_b32 a5, 0
    v_accvgpr_write_b32 a6, 0
    v_accvgpr_write_b32 a7, 0
    v_accvgpr_write_b32 a8, 0
    v_accvgpr_write_b32 a9, 0
    v_accvgpr_write_b32 a10, 0
    v_accvgpr_write_b32 a11, 0
    v_accvgpr_write_b32 a12, 0
    v_accvgpr_write_b32 a13, 0
    v_accvgpr_write_b32 a14, 0
    v_accvgpr_write_b32 a15, 0
    v_cmp_gt_u32 s[16:17], 20, v7
    v_cmp_eq_u32 s[18:19], 20, v7
    buffer_load_dwordx4 v[16:19], v8, s[8:11], 0 offen offset:0
    buffer_load_dwordx4 v[24:27], v10, s[8:11], 0 offen offset:0
    buffer_load_dwordx4 v[20:23], v9, s[8:11], 0 offen offset:0
    buffer_load_dwordx4 v[28:31], v11, s[8:11], 0 offen offset:0
    s_waitcnt vmcnt(0)
    v_lshlrev_b32 v32, 16, v16
    v_and_b32 v33, 0xffff0000, v16
    v_mul_f32 v36, 1.4426950408889634, v32
    v_exp_f32 v36, v36
    v_add_f32 v34, 1.0, v32
    v_cmp_lt_f32 vcc, 0, v32
    s_nop 1
    v_cndmask_b32 v34, v36, v34, vcc
    v_add_f32 v34, 0x358637bd, v34
    v_mul_f32 v36, 1.4426950408889634, v33
    v_exp_f32 v36, v36
    v_add_f32 v35, 1.0, v33
    v_cmp_lt_f32 vcc, 0, v33
    s_nop 1
    v_cndmask_b32 v35, v36, v35, vcc
    v_add_f32 v35, 0x358637bd, v35
    v_cvt_pk_bf16_f32 v16, v34, v35
    v_lshlrev_b32 v32, 16, v17
    v_and_b32 v33, 0xffff0000, v17
    v_mul_f32 v36, 1.4426950408889634, v32
    v_exp_f32 v36, v36
    v_add_f32 v34, 1.0, v32
    v_cmp_lt_f32 vcc, 0, v32
    s_nop 1
    v_cndmask_b32 v34, v36, v34, vcc
    v_add_f32 v34, 0x358637bd, v34
    v_mul_f32 v36, 1.4426950408889634, v33
    v_exp_f32 v36, v36
    v_add_f32 v35, 1.0, v33
    v_cmp_lt_f32 vcc, 0, v33
    s_nop 1
    v_cndmask_b32 v35, v36, v35, vcc
    v_add_f32 v35, 0x358637bd, v35
    v_cvt_pk_bf16_f32 v17, v34, v35
    v_lshlrev_b32 v32, 16, v18
    v_and_b32 v33, 0xffff0000, v18
    v_mul_f32 v36, 1.4426950408889634, v32
    v_exp_f32 v36, v36
    v_add_f32 v34, 1.0, v32
    v_cmp_lt_f32 vcc, 0, v32
    s_nop 1
    v_cndmask_b32 v34, v36, v34, vcc
    v_add_f32 v34, 0x358637bd, v34
    v_mul_f32 v36, 1.4426950408889634, v33
    v_exp_f32 v36, v36
    v_add_f32 v35, 1.0, v33
    v_cmp_lt_f32 vcc, 0, v33
    s_nop 1
    v_cndmask_b32 v35, v36, v35, vcc
    v_add_f32 v35, 0x358637bd, v35
    v_cvt_pk_bf16_f32 v18, v34, v35
    v_lshlrev_b32 v32, 16, v19
    v_and_b32 v33, 0xffff0000, v19
    v_mul_f32 v36, 1.4426950408889634, v32
    v_exp_f32 v36, v36
    v_add_f32 v34, 1.0, v32
    v_cmp_lt_f32 vcc, 0, v32
    s_nop 1
    v_cndmask_b32 v34, v36, v34, vcc
    v_add_f32 v34, 0x358637bd, v34
    v_mul_f32 v36, 1.4426950408889634, v33
    v_exp_f32 v36, v36
    v_add_f32 v35, 1.0, v33
    v_cmp_lt_f32 vcc, 0, v33
    s_nop 1
    v_cndmask_b32 v35, v36, v35, vcc
    v_add_f32 v35, 0x358637bd, v35
    v_cvt_pk_bf16_f32 v19, v34, v35
    v_lshlrev_b32 v32, 16, v20
    v_and_b32 v33, 0xffff0000, v20
    v_mul_f32 v36, 1.4426950408889634, v32
    v_exp_f32 v36, v36
    v_add_f32 v34, 1.0, v32
    v_cmp_lt_f32 vcc, 0, v32
    s_nop 1
    v_cndmask_b32 v34, v36, v34, vcc
    v_add_f32 v34, 0x358637bd, v34
    v_mul_f32 v36, 1.4426950408889634, v33
    v_exp_f32 v36, v36
    v_add_f32 v35, 1.0, v33
    v_cmp_lt_f32 vcc, 0, v33
    s_nop 1
    v_cndmask_b32 v35, v36, v35, vcc
    v_add_f32 v35, 0x358637bd, v35
    v_cvt_pk_bf16_f32 v20, v34, v35
    v_lshlrev_b32 v32, 16, v21
    v_and_b32 v33, 0xffff0000, v21
    v_mul_f32 v36, 1.4426950408889634, v32
    v_exp_f32 v36, v36
    v_add_f32 v34, 1.0, v32
    v_cmp_lt_f32 vcc, 0, v32
    s_nop 1
    v_cndmask_b32 v34, v36, v34, vcc
    v_add_f32 v34, 0x358637bd, v34
    v_mul_f32 v36, 1.4426950408889634, v33
    v_exp_f32 v36, v36
    v_add_f32 v35, 1.0, v33
    v_cmp_lt_f32 vcc, 0, v33
    s_nop 1
    v_cndmask_b32 v35, v36, v35, vcc
    v_add_f32 v35, 0x358637bd, v35
    v_cvt_pk_bf16_f32 v21, v34, v35
    v_lshlrev_b32 v32, 16, v22
    v_and_b32 v33, 0xffff0000, v22
    v_mul_f32 v36, 1.4426950408889634, v32
    v_exp_f32 v36, v36
    v_add_f32 v34, 1.0, v32
    v_cmp_lt_f32 vcc, 0, v32
    s_nop 1
    v_cndmask_b32 v34, v36, v34, vcc
    v_add_f32 v34, 0x358637bd, v34
    v_mul_f32 v36, 1.4426950408889634, v33
    v_exp_f32 v36, v36
    v_add_f32 v35, 1.0, v33
    v_cmp_lt_f32 vcc, 0, v33
    s_nop 1
    v_cndmask_b32 v35, v36, v35, vcc
    v_add_f32 v35, 0x358637bd, v35
    v_cvt_pk_bf16_f32 v22, v34, v35
    v_lshlrev_b32 v32, 16, v23
    v_and_b32 v33, 0xffff0000, v23
    v_mul_f32 v36, 1.4426950408889634, v32
    v_exp_f32 v36, v36
    v_add_f32 v34, 1.0, v32
    v_cmp_lt_f32 vcc, 0, v32
    s_nop 1
    v_cndmask_b32 v34, v36, v34, vcc
    v_add_f32 v34, 0x358637bd, v34
    v_mul_f32 v36, 1.4426950408889634, v33
    v_exp_f32 v36, v36
    v_add_f32 v35, 1.0, v33
    v_cmp_lt_f32 vcc, 0, v33
    s_nop 1
    v_cndmask_b32 v35, v36, v35, vcc
    v_add_f32 v35, 0x358637bd, v35
    v_cvt_pk_bf16_f32 v23, v34, v35
    v_mov_b32 v37, 0x3f803f80
    v_cndmask_b32 v20, 0, v20, s[16:17]
    v_cndmask_b32 v28, 0, v28, s[16:17]
    v_cndmask_b32 v28, v28, v37, s[18:19]
    v_cndmask_b32 v21, 0, v21, s[16:17]
    v_cndmask_b32 v29, 0, v29, s[16:17]
    v_cndmask_b32 v29, v29, v37, s[18:19]
    v_cndmask_b32 v22, 0, v22, s[16:17]
    v_cndmask_b32 v30, 0, v30, s[16:17]
    v_cndmask_b32 v30, v30, v37, s[18:19]
    v_cndmask_b32 v23, 0, v23, s[16:17]
    v_cndmask_b32 v31, 0, v31, s[16:17]
    v_cndmask_b32 v31, v31, v37, s[18:19]
    s_nop 1
    v_mfma_f32_16x16x32_bf16 a[0:3], v[24:27], v[16:19], a[0:3]
    v_mfma_f32_16x16x32_bf16 a[4:7], v[24:27], v[20:23], a[4:7]
    v_mfma_f32_16x16x32_bf16 a[8:11], v[28:31], v[16:19], a[8:11]
    v_mfma_f32_16x16x32_bf16 a[12:15], v[28:31], v[20:23], a[12:15]
    buffer_load_dwordx4 v[16:19], v8, s[8:11], 0 offen offset:64
    buffer_load_dwordx4 v[24:27], v10, s[8:11], 0 offen offset:64
    buffer_load_dwordx4 v[20:23], v9, s[8:11], 0 offen offset:64
    buffer_load_dwordx4 v[28:31], v11, s[8:11], 0 offen offset:64
    s_waitcnt vmcnt(0)
    v_lshlrev_b32 v32, 16, v16
    v_and_b32 v33, 0xffff0000, v16
    v_mul_f32 v36, 1.4426950408889634, v32
    v_exp_f32 v36, v36
    v_add_f32 v34, 1.0, v32
    v_cmp_lt_f32 vcc, 0, v32
    s_nop 1
    v_cndmask_b32 v34, v36, v34, vcc
    v_add_f32 v34, 0x358637bd, v34
    v_mul_f32 v36, 1.4426950408889634, v33
    v_exp_f32 v36, v36
    v_add_f32 v35, 1.0, v33
    v_cmp_lt_f32 vcc, 0, v33
    s_nop 1
    v_cndmask_b32 v35, v36, v35, vcc
    v_add_f32 v35, 0x358637bd, v35
    v_cvt_pk_bf16_f32 v16, v34, v35
    v_lshlrev_b32 v32, 16, v17
    v_and_b32 v33, 0xffff0000, v17
    v_mul_f32 v36, 1.4426950408889634, v32
    v_exp_f32 v36, v36
    v_add_f32 v34, 1.0, v32
    v_cmp_lt_f32 vcc, 0, v32
    s_nop 1
    v_cndmask_b32 v34, v36, v34, vcc
    v_add_f32 v34, 0x358637bd, v34
    v_mul_f32 v36, 1.4426950408889634, v33
    v_exp_f32 v36, v36
    v_add_f32 v35, 1.0, v33
    v_cmp_lt_f32 vcc, 0, v33
    s_nop 1
    v_cndmask_b32 v35, v36, v35, vcc
    v_add_f32 v35, 0x358637bd, v35
    v_cvt_pk_bf16_f32 v17, v34, v35
    v_lshlrev_b32 v32, 16, v18
    v_and_b32 v33, 0xffff0000, v18
    v_mul_f32 v36, 1.4426950408889634, v32
    v_exp_f32 v36, v36
    v_add_f32 v34, 1.0, v32
    v_cmp_lt_f32 vcc, 0, v32
    s_nop 1
    v_cndmask_b32 v34, v36, v34, vcc
    v_add_f32 v34, 0x358637bd, v34
    v_mul_f32 v36, 1.4426950408889634, v33
    v_exp_f32 v36, v36
    v_add_f32 v35, 1.0, v33
    v_cmp_lt_f32 vcc, 0, v33
    s_nop 1
    v_cndmask_b32 v35, v36, v35, vcc
    v_add_f32 v35, 0x358637bd, v35
    v_cvt_pk_bf16_f32 v18, v34, v35
    v_lshlrev_b32 v32, 16, v19
    v_and_b32 v33, 0xffff0000, v19
    v_mul_f32 v36, 1.4426950408889634, v32
    v_exp_f32 v36, v36
    v_add_f32 v34, 1.0, v32
    v_cmp_lt_f32 vcc, 0, v32
    s_nop 1
    v_cndmask_b32 v34, v36, v34, vcc
    v_add_f32 v34, 0x358637bd, v34
    v_mul_f32 v36, 1.4426950408889634, v33
    v_exp_f32 v36, v36
    v_add_f32 v35, 1.0, v33
    v_cmp_lt_f32 vcc, 0, v33
    s_nop 1
    v_cndmask_b32 v35, v36, v35, vcc
    v_add_f32 v35, 0x358637bd, v35
    v_cvt_pk_bf16_f32 v19, v34, v35
    v_lshlrev_b32 v32, 16, v20
    v_and_b32 v33, 0xffff0000, v20
    v_mul_f32 v36, 1.4426950408889634, v32
    v_exp_f32 v36, v36
    v_add_f32 v34, 1.0, v32
    v_cmp_lt_f32 vcc, 0, v32
    s_nop 1
    v_cndmask_b32 v34, v36, v34, vcc
    v_add_f32 v34, 0x358637bd, v34
    v_mul_f32 v36, 1.4426950408889634, v33
    v_exp_f32 v36, v36
    v_add_f32 v35, 1.0, v33
    v_cmp_lt_f32 vcc, 0, v33
    s_nop 1
    v_cndmask_b32 v35, v36, v35, vcc
    v_add_f32 v35, 0x358637bd, v35
    v_cvt_pk_bf16_f32 v20, v34, v35
    v_lshlrev_b32 v32, 16, v21
    v_and_b32 v33, 0xffff0000, v21
    v_mul_f32 v36, 1.4426950408889634, v32
    v_exp_f32 v36, v36
    v_add_f32 v34, 1.0, v32
    v_cmp_lt_f32 vcc, 0, v32
    s_nop 1
    v_cndmask_b32 v34, v36, v34, vcc
    v_add_f32 v34, 0x358637bd, v34
    v_mul_f32 v36, 1.4426950408889634, v33
    v_exp_f32 v36, v36
    v_add_f32 v35, 1.0, v33
    v_cmp_lt_f32 vcc, 0, v33
    s_nop 1
    v_cndmask_b32 v35, v36, v35, vcc
    v_add_f32 v35, 0x358637bd, v35
    v_cvt_pk_bf16_f32 v21, v34, v35
    v_lshlrev_b32 v32, 16, v22
    v_and_b32 v33, 0xffff0000, v22
    v_mul_f32 v36, 1.4426950408889634, v32
    v_exp_f32 v36, v36
    v_add_f32 v34, 1.0, v32
    v_cmp_lt_f32 vcc, 0, v32
    s_nop 1
    v_cndmask_b32 v34, v36, v34, vcc
    v_add_f32 v34, 0x358637bd, v34
    v_mul_f32 v36, 1.4426950408889634, v33
    v_exp_f32 v36, v36
    v_add_f32 v35, 1.0, v33
    v_cmp_lt_f32 vcc, 0, v33
    s_nop 1
    v_cndmask_b32 v35, v36, v35, vcc
    v_add_f32 v35, 0x358637bd, v35
    v_cvt_pk_bf16_f32 v22, v34, v35
    v_lshlrev_b32 v32, 16, v23
    v_and_b32 v33, 0xffff0000, v23
    v_mul_f32 v36, 1.4426950408889634, v32
    v_exp_f32 v36, v36
    v_add_f32 v34, 1.0, v32
    v_cmp_lt_f32 vcc, 0, v32
    s_nop 1
    v_cndmask_b32 v34, v36, v34, vcc
    v_add_f32 v34, 0x358637bd, v34
    v_mul_f32 v36, 1.4426950408889634, v33
    v_exp_f32 v36, v36
    v_add_f32 v35, 1.0, v33
    v_cmp_lt_f32 vcc, 0, v33
    s_nop 1
    v_cndmask_b32 v35, v36, v35, vcc
    v_add_f32 v35, 0x358637bd, v35
    v_cvt_pk_bf16_f32 v23, v34, v35
    v_mov_b32 v37, 0x3f803f80
    v_cndmask_b32 v20, 0, v20, s[16:17]
    v_cndmask_b32 v28, 0, v28, s[16:17]
    v_cndmask_b32 v28, v28, v37, s[18:19]
    v_cndmask_b32 v21, 0, v21, s[16:17]
    v_cndmask_b32 v29, 0, v29, s[16:17]
    v_cndmask_b32 v29, v29, v37, s[18:19]
    v_cndmask_b32 v22, 0, v22, s[16:17]
    v_cndmask_b32 v30, 0, v30, s[16:17]
    v_cndmask_b32 v30, v30, v37, s[18:19]
    v_cndmask_b32 v23, 0, v23, s[16:17]
    v_cndmask_b32 v31, 0, v31, s[16:17]
    v_cndmask_b32 v31, v31, v37, s[18:19]
    s_nop 1
    v_mfma_f32_16x16x32_bf16 a[0:3], v[24:27], v[16:19], a[0:3]
    v_mfma_f32_16x16x32_bf16 a[4:7], v[24:27], v[20:23], a[4:7]
    v_mfma_f32_16x16x32_bf16 a[8:11], v[28:31], v[16:19], a[8:11]
    v_mfma_f32_16x16x32_bf16 a[12:15], v[28:31], v[20:23], a[12:15]
    buffer_load_dwordx4 v[16:19], v8, s[8:11], 0 offen offset:128
    buffer_load_dwordx4 v[24:27], v10, s[8:11], 0 offen offset:128
    buffer_load_dwordx4 v[20:23], v9, s[8:11], 0 offen offset:128
    buffer_load_dwordx4 v[28:31], v11, s[8:11], 0 offen offset:128
    s_waitcnt vmcnt(0)
    v_lshlrev_b32 v32, 16, v16
    v_and_b32 v33, 0xffff0000, v16
    v_mul_f32 v36, 1.4426950408889634, v32
    v_exp_f32 v36, v36
    v_add_f32 v34, 1.0, v32
    v_cmp_lt_f32 vcc, 0, v32
    s_nop 1
    v_cndmask_b32 v34, v36, v34, vcc
    v_add_f32 v34, 0x358637bd, v34
    v_mul_f32 v36, 1.4426950408889634, v33
    v_exp_f32 v36, v36
    v_add_f32 v35, 1.0, v33
    v_cmp_lt_f32 vcc, 0, v33
    s_nop 1
    v_cndmask_b32 v35, v36, v35, vcc
    v_add_f32 v35, 0x358637bd, v35
    v_cvt_pk_bf16_f32 v16, v34, v35
    v_lshlrev_b32 v32, 16, v17
    v_and_b32 v33, 0xffff0000, v17
    v_mul_f32 v36, 1.4426950408889634, v32
    v_exp_f32 v36, v36
    v_add_f32 v34, 1.0, v32
    v_cmp_lt_f32 vcc, 0, v32
    s_nop 1
    v_cndmask_b32 v34, v36, v34, vcc
    v_add_f32 v34, 0x358637bd, v34
    v_mul_f32 v36, 1.4426950408889634, v33
    v_exp_f32 v36, v36
    v_add_f32 v35, 1.0, v33
    v_cmp_lt_f32 vcc, 0, v33
    s_nop 1
    v_cndmask_b32 v35, v36, v35, vcc
    v_add_f32 v35, 0x358637bd, v35
    v_cvt_pk_bf16_f32 v17, v34, v35
    v_lshlrev_b32 v32, 16, v18
    v_and_b32 v33, 0xffff0000, v18
    v_mul_f32 v36, 1.4426950408889634, v32
    v_exp_f32 v36, v36
    v_add_f32 v34, 1.0, v32
    v_cmp_lt_f32 vcc, 0, v32
    s_nop 1
    v_cndmask_b32 v34, v36, v34, vcc
    v_add_f32 v34, 0x358637bd, v34
    v_mul_f32 v36, 1.4426950408889634, v33
    v_exp_f32 v36, v36
    v_add_f32 v35, 1.0, v33
    v_cmp_lt_f32 vcc, 0, v33
    s_nop 1
    v_cndmask_b32 v35, v36, v35, vcc
    v_add_f32 v35, 0x358637bd, v35
    v_cvt_pk_bf16_f32 v18, v34, v35
    v_lshlrev_b32 v32, 16, v19
    v_and_b32 v33, 0xffff0000, v19
    v_mul_f32 v36, 1.4426950408889634, v32
    v_exp_f32 v36, v36
    v_add_f32 v34, 1.0, v32
    v_cmp_lt_f32 vcc, 0, v32
    s_nop 1
    v_cndmask_b32 v34, v36, v34, vcc
    v_add_f32 v34, 0x358637bd, v34
    v_mul_f32 v36, 1.4426950408889634, v33
    v_exp_f32 v36, v36
    v_add_f32 v35, 1.0, v33
    v_cmp_lt_f32 vcc, 0, v33
    s_nop 1
    v_cndmask_b32 v35, v36, v35, vcc
    v_add_f32 v35, 0x358637bd, v35
    v_cvt_pk_bf16_f32 v19, v34, v35
    v_lshlrev_b32 v32, 16, v20
    v_and_b32 v33, 0xffff0000, v20
    v_mul_f32 v36, 1.4426950408889634, v32
    v_exp_f32 v36, v36
    v_add_f32 v34, 1.0, v32
    v_cmp_lt_f32 vcc, 0, v32
    s_nop 1
    v_cndmask_b32 v34, v36, v34, vcc
    v_add_f32 v34, 0x358637bd, v34
    v_mul_f32 v36, 1.4426950408889634, v33
    v_exp_f32 v36, v36
    v_add_f32 v35, 1.0, v33
    v_cmp_lt_f32 vcc, 0, v33
    s_nop 1
    v_cndmask_b32 v35, v36, v35, vcc
    v_add_f32 v35, 0x358637bd, v35
    v_cvt_pk_bf16_f32 v20, v34, v35
    v_lshlrev_b32 v32, 16, v21
    v_and_b32 v33, 0xffff0000, v21
    v_mul_f32 v36, 1.4426950408889634, v32
    v_exp_f32 v36, v36
    v_add_f32 v34, 1.0, v32
    v_cmp_lt_f32 vcc, 0, v32
    s_nop 1
    v_cndmask_b32 v34, v36, v34, vcc
    v_add_f32 v34, 0x358637bd, v34
    v_mul_f32 v36, 1.4426950408889634, v33
    v_exp_f32 v36, v36
    v_add_f32 v35, 1.0, v33
    v_cmp_lt_f32 vcc, 0, v33
    s_nop 1
    v_cndmask_b32 v35, v36, v35, vcc
    v_add_f32 v35, 0x358637bd, v35
    v_cvt_pk_bf16_f32 v21, v34, v35
    v_lshlrev_b32 v32, 16, v22
    v_and_b32 v33, 0xffff0000, v22
    v_mul_f32 v36, 1.4426950408889634, v32
    v_exp_f32 v36, v36
    v_add_f32 v34, 1.0, v32
    v_cmp_lt_f32 vcc, 0, v32
    s_nop 1
    v_cndmask_b32 v34, v36, v34, vcc
    v_add_f32 v34, 0x358637bd, v34
    v_mul_f32 v36, 1.4426950408889634, v33
    v_exp_f32 v36, v36
    v_add_f32 v35, 1.0, v33
    v_cmp_lt_f32 vcc, 0, v33
    s_nop 1
    v_cndmask_b32 v35, v36, v35, vcc
    v_add_f32 v35, 0x358637bd, v35
    v_cvt_pk_bf16_f32 v22, v34, v35
    v_lshlrev_b32 v32, 16, v23
    v_and_b32 v33, 0xffff0000, v23
    v_mul_f32 v36, 1.4426950408889634, v32
    v_exp_f32 v36, v36
    v_add_f32 v34, 1.0, v32
    v_cmp_lt_f32 vcc, 0, v32
    s_nop 1
    v_cndmask_b32 v34, v36, v34, vcc
    v_add_f32 v34, 0x358637bd, v34
    v_mul_f32 v36, 1.4426950408889634, v33
    v_exp_f32 v36, v36
    v_add_f32 v35, 1.0, v33
    v_cmp_lt_f32 vcc, 0, v33
    s_nop 1
    v_cndmask_b32 v35, v36, v35, vcc
    v_add_f32 v35, 0x358637bd, v35
    v_cvt_pk_bf16_f32 v23, v34, v35
    v_mov_b32 v37, 0x3f803f80
    v_cndmask_b32 v20, 0, v20, s[16:17]
    v_cndmask_b32 v28, 0, v28, s[16:17]
    v_cndmask_b32 v28, v28, v37, s[18:19]
    v_cndmask_b32 v21, 0, v21, s[16:17]
    v_cndmask_b32 v29, 0, v29, s[16:17]
    v_cndmask_b32 v29, v29, v37, s[18:19]
    v_cndmask_b32 v22, 0, v22, s[16:17]
    v_cndmask_b32 v30, 0, v30, s[16:17]
    v_cndmask_b32 v30, v30, v37, s[18:19]
    v_cndmask_b32 v23, 0, v23, s[16:17]
    v_cndmask_b32 v31, 0, v31, s[16:17]
    v_cndmask_b32 v31, v31, v37, s[18:19]
    s_nop 1
    v_mfma_f32_16x16x32_bf16 a[0:3], v[24:27], v[16:19], a[0:3]
    v_mfma_f32_16x16x32_bf16 a[4:7], v[24:27], v[20:23], a[4:7]
    v_mfma_f32_16x16x32_bf16 a[8:11], v[28:31], v[16:19], a[8:11]
    v_mfma_f32_16x16x32_bf16 a[12:15], v[28:31], v[20:23], a[12:15]
    buffer_load_dwordx4 v[16:19], v8, s[8:11], 0 offen offset:192
    buffer_load_dwordx4 v[24:27], v10, s[8:11], 0 offen offset:192
    buffer_load_dwordx4 v[20:23], v9, s[8:11], 0 offen offset:192
    buffer_load_dwordx4 v[28:31], v11, s[8:11], 0 offen offset:192
    s_waitcnt vmcnt(0)
    v_lshlrev_b32 v32, 16, v16
    v_and_b32 v33, 0xffff0000, v16
    v_mul_f32 v36, 1.4426950408889634, v32
    v_exp_f32 v36, v36
    v_add_f32 v34, 1.0, v32
    v_cmp_lt_f32 vcc, 0, v32
    s_nop 1
    v_cndmask_b32 v34, v36, v34, vcc
    v_add_f32 v34, 0x358637bd, v34
    v_mul_f32 v36, 1.4426950408889634, v33
    v_exp_f32 v36, v36
    v_add_f32 v35, 1.0, v33
    v_cmp_lt_f32 vcc, 0, v33
    s_nop 1
    v_cndmask_b32 v35, v36, v35, vcc
    v_add_f32 v35, 0x358637bd, v35
    v_cvt_pk_bf16_f32 v16, v34, v35
    v_lshlrev_b32 v32, 16, v17
    v_and_b32 v33, 0xffff0000, v17
    v_mul_f32 v36, 1.4426950408889634, v32
    v_exp_f32 v36, v36
    v_add_f32 v34, 1.0, v32
    v_cmp_lt_f32 vcc, 0, v32
    s_nop 1
    v_cndmask_b32 v34, v36, v34, vcc
    v_add_f32 v34, 0x358637bd, v34
    v_mul_f32 v36, 1.4426950408889634, v33
    v_exp_f32 v36, v36
    v_add_f32 v35, 1.0, v33
    v_cmp_lt_f32 vcc, 0, v33
    s_nop 1
    v_cndmask_b32 v35, v36, v35, vcc
    v_add_f32 v35, 0x358637bd, v35
    v_cvt_pk_bf16_f32 v17, v34, v35
    v_lshlrev_b32 v32, 16, v18
    v_and_b32 v33, 0xffff0000, v18
    v_mul_f32 v36, 1.4426950408889634, v32
    v_exp_f32 v36, v36
    v_add_f32 v34, 1.0, v32
    v_cmp_lt_f32 vcc, 0, v32
    s_nop 1
    v_cndmask_b32 v34, v36, v34, vcc
    v_add_f32 v34, 0x358637bd, v34
    v_mul_f32 v36, 1.4426950408889634, v33
    v_exp_f32 v36, v36
    v_add_f32 v35, 1.0, v33
    v_cmp_lt_f32 vcc, 0, v33
    s_nop 1
    v_cndmask_b32 v35, v36, v35, vcc
    v_add_f32 v35, 0x358637bd, v35
    v_cvt_pk_bf16_f32 v18, v34, v35
    v_lshlrev_b32 v32, 16, v19
    v_and_b32 v33, 0xffff0000, v19
    v_mul_f32 v36, 1.4426950408889634, v32
    v_exp_f32 v36, v36
    v_add_f32 v34, 1.0, v32
    v_cmp_lt_f32 vcc, 0, v32
    s_nop 1
    v_cndmask_b32 v34, v36, v34, vcc
    v_add_f32 v34, 0x358637bd, v34
    v_mul_f32 v36, 1.4426950408889634, v33
    v_exp_f32 v36, v36
    v_add_f32 v35, 1.0, v33
    v_cmp_lt_f32 vcc, 0, v33
    s_nop 1
    v_cndmask_b32 v35, v36, v35, vcc
    v_add_f32 v35, 0x358637bd, v35
    v_cvt_pk_bf16_f32 v19, v34, v35
    v_lshlrev_b32 v32, 16, v20
    v_and_b32 v33, 0xffff0000, v20
    v_mul_f32 v36, 1.4426950408889634, v32
    v_exp_f32 v36, v36
    v_add_f32 v34, 1.0, v32
    v_cmp_lt_f32 vcc, 0, v32
    s_nop 1
    v_cndmask_b32 v34, v36, v34, vcc
    v_add_f32 v34, 0x358637bd, v34
    v_mul_f32 v36, 1.4426950408889634, v33
    v_exp_f32 v36, v36
    v_add_f32 v35, 1.0, v33
    v_cmp_lt_f32 vcc, 0, v33
    s_nop 1
    v_cndmask_b32 v35, v36, v35, vcc
    v_add_f32 v35, 0x358637bd, v35
    v_cvt_pk_bf16_f32 v20, v34, v35
    v_lshlrev_b32 v32, 16, v21
    v_and_b32 v33, 0xffff0000, v21
    v_mul_f32 v36, 1.4426950408889634, v32
    v_exp_f32 v36, v36
    v_add_f32 v34, 1.0, v32
    v_cmp_lt_f32 vcc, 0, v32
    s_nop 1
    v_cndmask_b32 v34, v36, v34, vcc
    v_add_f32 v34, 0x358637bd, v34
    v_mul_f32 v36, 1.4426950408889634, v33
    v_exp_f32 v36, v36
    v_add_f32 v35, 1.0, v33
    v_cmp_lt_f32 vcc, 0, v33
    s_nop 1
    v_cndmask_b32 v35, v36, v35, vcc
    v_add_f32 v35, 0x358637bd, v35
    v_cvt_pk_bf16_f32 v21, v34, v35
    v_lshlrev_b32 v32, 16, v22
    v_and_b32 v33, 0xffff0000, v22
    v_mul_f32 v36, 1.4426950408889634, v32
    v_exp_f32 v36, v36
    v_add_f32 v34, 1.0, v32
    v_cmp_lt_f32 vcc, 0, v32
    s_nop 1
    v_cndmask_b32 v34, v36, v34, vcc
    v_add_f32 v34, 0x358637bd, v34
    v_mul_f32 v36, 1.4426950408889634, v33
    v_exp_f32 v36, v36
    v_add_f32 v35, 1.0, v33
    v_cmp_lt_f32 vcc, 0, v33
    s_nop 1
    v_cndmask_b32 v35, v36, v35, vcc
    v_add_f32 v35, 0x358637bd, v35
    v_cvt_pk_bf16_f32 v22, v34, v35
    v_lshlrev_b32 v32, 16, v23
    v_and_b32 v33, 0xffff0000, v23
    v_mul_f32 v36, 1.4426950408889634, v32
    v_exp_f32 v36, v36
    v_add_f32 v34, 1.0, v32
    v_cmp_lt_f32 vcc, 0, v32
    s_nop 1
    v_cndmask_b32 v34, v36, v34, vcc
    v_add_f32 v34, 0x358637bd, v34
    v_mul_f32 v36, 1.4426950408889634, v33
    v_exp_f32 v36, v36
    v_add_f32 v35, 1.0, v33
    v_cmp_lt_f32 vcc, 0, v33
    s_nop 1
    v_cndmask_b32 v35, v36, v35, vcc
    v_add_f32 v35, 0x358637bd, v35
    v_cvt_pk_bf16_f32 v23, v34, v35
    v_mov_b32 v37, 0x3f803f80
    v_cndmask_b32 v20, 0, v20, s[16:17]
    v_cndmask_b32 v28, 0, v28, s[16:17]
    v_cndmask_b32 v28, v28, v37, s[18:19]
    v_cndmask_b32 v21, 0, v21, s[16:17]
    v_cndmask_b32 v29, 0, v29, s[16:17]
    v_cndmask_b32 v29, v29, v37, s[18:19]
    v_cndmask_b32 v22, 0, v22, s[16:17]
    v_cndmask_b32 v30, 0, v30, s[16:17]
    v_cndmask_b32 v30, v30, v37, s[18:19]
    v_cndmask_b32 v23, 0, v23, s[16:17]
    v_cndmask_b32 v31, 0, v31, s[16:17]
    v_cndmask_b32 v31, v31, v37, s[18:19]
    s_nop 1
    v_mfma_f32_16x16x32_bf16 a[0:3], v[24:27], v[16:19], a[0:3]
    v_mfma_f32_16x16x32_bf16 a[4:7], v[24:27], v[20:23], a[4:7]
    v_mfma_f32_16x16x32_bf16 a[8:11], v[28:31], v[16:19], a[8:11]
    v_mfma_f32_16x16x32_bf16 a[12:15], v[28:31], v[20:23], a[12:15]
    s_nop 7
    s_nop 7
    v_lshlrev_b32 v5, 2, v4
    v_lshlrev_b32 v5, 5, v5
    v_add_u32 v5, v5, v3
    v_lshlrev_b32 v5, 2, v5
    s_lshl_b32 s14, s5, 12
    s_add_u32 s14, s14, 242221056
    v_add_u32 v5, s14, v5
    v_accvgpr_read_b32 v40, a0
    v_accvgpr_read_b32 v41, a1
    v_accvgpr_read_b32 v42, a2
    v_accvgpr_read_b32 v43, a3
    buffer_atomic_add_f32 v40, v5, s[8:11], 0 offen offset:0
    buffer_atomic_add_f32 v41, v5, s[8:11], 0 offen offset:128
    buffer_atomic_add_f32 v42, v5, s[8:11], 0 offen offset:256
    buffer_atomic_add_f32 v43, v5, s[8:11], 0 offen offset:384
    v_accvgpr_read_b32 v40, a4
    v_accvgpr_read_b32 v41, a5
    v_accvgpr_read_b32 v42, a6
    v_accvgpr_read_b32 v43, a7
    buffer_atomic_add_f32 v40, v5, s[8:11], 0 offen offset:64
    buffer_atomic_add_f32 v41, v5, s[8:11], 0 offen offset:192
    buffer_atomic_add_f32 v42, v5, s[8:11], 0 offen offset:320
    buffer_atomic_add_f32 v43, v5, s[8:11], 0 offen offset:448
    v_accvgpr_read_b32 v40, a8
    v_accvgpr_read_b32 v41, a9
    v_accvgpr_read_b32 v42, a10
    v_accvgpr_read_b32 v43, a11
    buffer_atomic_add_f32 v40, v5, s[8:11], 0 offen offset:2048
    buffer_atomic_add_f32 v41, v5, s[8:11], 0 offen offset:2176
    buffer_atomic_add_f32 v42, v5, s[8:11], 0 offen offset:2304
    buffer_atomic_add_f32 v43, v5, s[8:11], 0 offen offset:2432
    v_accvgpr_read_b32 v40, a12
    v_accvgpr_read_b32 v41, a13
    v_accvgpr_read_b32 v42, a14
    v_accvgpr_read_b32 v43, a15
    buffer_atomic_add_f32 v40, v5, s[8:11], 0 offen offset:2112
    buffer_atomic_add_f32 v41, v5, s[8:11], 0 offen offset:2240
    buffer_atomic_add_f32 v42, v5, s[8:11], 0 offen offset:2368
    buffer_atomic_add_f32 v43, v5, s[8:11], 0 offen offset:2496
kvz_a1_kernel_end:
    s_endpgm
.section .rodata,"a"
.p2align 6
.amdhsa_kernel kvz_a1_kernel
  .amdhsa_next_free_vgpr 80
  .amdhsa_next_free_sgpr 40
  .amdhsa_accum_offset 64
  .amdhsa_group_segment_fixed_size 0
  .amdhsa_kernarg_size 104
  .amdhsa_user_sgpr_count 2
  .amdhsa_user_sgpr_kernarg_segment_ptr 1
  .amdhsa_system_sgpr_workgroup_id_x 1
.end_amdhsa_kernel
.text
.globl attn_a1_kernel
.p2align 8
.type attn_a1_kernel,@function
attn_a1_kernel:
    s_cmp_ge_u32 s2, 256
    s_cbranch_scc1 attn_a1_kernel_end
    s_load_dwordx2 s[6:7], s[0:1], 96
    s_waitcnt lgkmcnt(0)
    s_mov_b32 s8, s6
    s_mov_b32 s9, s7
    s_mov_b32 s10, 268435456
    s_mov_b32 s11, 0x00020000
    v_mov_b32 v1, v0
    v_add_u32 v2, 0, v1
    s_mov_b32 s12, 3121
    v_mul_lo_u32 v3, v2, s12
    v_lshrrev_b32 v3, 19, v3
    v_mul_u32_u24 v4, 168, v3
    v_sub_u32 v4, v2, v4
    v_lshlrev_b32 v5, 12, v3
    v_lshlrev_b32 v6, 4, v4
    v_add_u32 v5, v5, v6
    v_add_u32 v5, 242221056, v5
    buffer_load_dwordx4 v[8:11], v5, s[8:11], 0 offen
    v_mul_u32_u24 v7, 2688, v3
    v_add_u32 v7, v7, v6
    s_waitcnt vmcnt(0)
    ds_write_b128 v7, v[8:11]
    v_add_u32 v2, 256, v1
    s_mov_b32 s12, 3121
    v_mul_lo_u32 v3, v2, s12
    v_lshrrev_b32 v3, 19, v3
    v_mul_u32_u24 v4, 168, v3
    v_sub_u32 v4, v2, v4
    v_lshlrev_b32 v5, 12, v3
    v_lshlrev_b32 v6, 4, v4
    v_add_u32 v5, v5, v6
    v_add_u32 v5, 242221056, v5
    buffer_load_dwordx4 v[8:11], v5, s[8:11], 0 offen
    v_mul_u32_u24 v7, 2688, v3
    v_add_u32 v7, v7, v6
    s_waitcnt vmcnt(0)
    ds_write_b128 v7, v[8:11]
    v_add_u32 v2, 512, v1
    s_mov_b32 s12, 3121
    v_mul_lo_u32 v3, v2, s12
    v_lshrrev_b32 v3, 19, v3
    v_mul_u32_u24 v4, 168, v3
    v_sub_u32 v4, v2, v4
    v_lshlrev_b32 v5, 12, v3
    v_lshlrev_b32 v6, 4, v4
    v_add_u32 v5, v5, v6
    v_add_u32 v5, 242221056, v5
    buffer_load_dwordx4 v[8:11], v5, s[8:11], 0 offen
    v_mul_u32_u24 v7, 2688, v3
    v_add_u32 v7, v7, v6
    s_waitcnt vmcnt(0)
    ds_write_b128 v7, v[8:11]
    v_add_u32 v2, 768, v1
    s_mov_b32 s12, 3121
    v_mul_lo_u32 v3, v2, s12
    v_lshrrev_b32 v3, 19, v3
    v_mul_u32_u24 v4, 168, v3
    v_sub_u32 v4, v2, v4
    v_lshlrev_b32 v5, 12, v3
    v_lshlrev_b32 v6, 4, v4
    v_add_u32 v5, v5, v6
    v_add_u32 v5, 242221056, v5
    buffer_load_dwordx4 v[8:11], v5, s[8:11], 0 offen
    v_mul_u32_u24 v7, 2688, v3
    v_add_u32 v7, v7, v6
    s_waitcnt vmcnt(0)
    ds_write_b128 v7, v[8:11]
    v_add_u32 v2, 1024, v1
    s_mov_b32 s12, 3121
    v_mul_lo_u32 v3, v2, s12
    v_lshrrev_b32 v3, 19, v3
    v_mul_u32_u24 v4, 168, v3
    v_sub_u32 v4, v2, v4
    v_lshlrev_b32 v5, 12, v3
    v_lshlrev_b32 v6, 4, v4
    v_add_u32 v5, v5, v6
    v_add_u32 v5, 242221056, v5
    buffer_load_dwordx4 v[8:11], v5, s[8:11], 0 offen
    v_mul_u32_u24 v7, 2688, v3
    v_add_u32 v7, v7, v6
    s_waitcnt vmcnt(0)
    ds_write_b128 v7, v[8:11]
    v_add_u32 v2, 1280, v1
    s_mov_b32 s12, 3121
    v_mul_lo_u32 v3, v2, s12
    v_lshrrev_b32 v3, 19, v3
    v_mul_u32_u24 v4, 168, v3
    v_sub_u32 v4, v2, v4
    v_lshlrev_b32 v5, 12, v3
    v_lshlrev_b32 v6, 4, v4
    v_add_u32 v5, v5, v6
    v_add_u32 v5, 242221056, v5
    buffer_load_dwordx4 v[8:11], v5, s[8:11], 0 offen
    v_mul_u32_u24 v7, 2688, v3
    v_add_u32 v7, v7, v6
    s_waitcnt vmcnt(0)
    ds_write_b128 v7, v[8:11]
    v_add_u32 v2, 1536, v1
    s_mov_b32 s12, 3121
    v_mul_lo_u32 v3, v2, s12
    v_lshrrev_b32 v3, 19, v3
    v_mul_u32_u24 v4, 168, v3
    v_sub_u32 v4, v2, v4
    v_lshlrev_b32 v5, 12, v3
    v_lshlrev_b32 v6, 4, v4
    v_add_u32 v5, v5, v6
    v_add_u32 v5, 242221056, v5
    buffer_load_dwordx4 v[8:11], v5, s[8:11], 0 offen
    v_mul_u32_u24 v7, 2688, v3
    v_add_u32 v7, v7, v6
    s_waitcnt vmcnt(0)
    ds_write_b128 v7, v[8:11]
    v_add_u32 v2, 1792, v1
    s_mov_b32 s12, 3121
    v_mul_lo_u32 v3, v2, s12
    v_lshrrev_b32 v3, 19, v3
    v_mul_u32_u24 v4, 168, v3
    v_sub_u32 v4, v2, v4
    v_lshlrev_b32 v5, 12, v3
    v_lshlrev_b32 v6, 4, v4
    v_add_u32 v5, v5, v6
    v_add_u32 v5, 242221056, v5
    buffer_load_dwordx4 v[8:11], v5, s[8:11], 0 offen
    v_mul_u32_u24 v7, 2688, v3
    v_add_u32 v7, v7, v6
    s_waitcnt vmcnt(0)
    ds_write_b128 v7, v[8:11]
    v_add_u32 v2, 2048, v1
    s_mov_b32 s12, 3121
    v_mul_lo_u32 v3, v2, s12
    v_lshrrev_b32 v3, 19, v3
    v_mul_u32_u24 v4, 168, v3
    v_sub_u32 v4, v2, v4
    v_lshlrev_b32 v5, 12, v3
    v_lshlrev_b32 v6, 4, v4
    v_add_u32 v5, v5, v6
    v_add_u32 v5, 242221056, v5
    buffer_load_dwordx4 v[8:11], v5, s[8:11], 0 offen
    v_mul_u32_u24 v7, 2688, v3
    v_add_u32 v7, v7, v6
    s_waitcnt vmcnt(0)
    ds_write_b128 v7, v[8:11]
    v_add_u32 v2, 2304, v1
    s_mov_b32 s12, 3121
    v_mul_lo_u32 v3, v2, s12
    v_lshrrev_b32 v3, 19, v3
    v_mul_u32_u24 v4, 168, v3
    v_sub_u32 v4, v2, v4
    v_lshlrev_b32 v5, 12, v3
    v_lshlrev_b32 v6, 4, v4
    v_add_u32 v5, v5, v6
    v_add_u32 v5, 242221056, v5
    buffer_load_dwordx4 v[8:11], v5, s[8:11], 0 offen
    v_mul_u32_u24 v7, 2688, v3
    v_add_u32 v7, v7, v6
    s_waitcnt vmcnt(0)
    ds_write_b128 v7, v[8:11]
    v_add_u32 v2, 2560, v1
    s_mov_b32 s12, 3121
    v_mul_lo_u32 v3, v2, s12
    v_lshrrev_b32 v3, 19, v3
    v_mul_u32_u24 v4, 168, v3
    v_sub_u32 v4, v2, v4
    v_lshlrev_b32 v5, 12, v3
    v_lshlrev_b32 v6, 4, v4
    v_add_u32 v5, v5, v6
    v_add_u32 v5, 242221056, v5
    buffer_load_dwordx4 v[8:11], v5, s[8:11], 0 offen
    v_mul_u32_u24 v7, 2688, v3
    v_add_u32 v7, v7, v6
    s_waitcnt vmcnt(0)
    ds_write_b128 v7, v[8:11]
    v_add_u32 v2, 2816, v1
    s_mov_b32 s12, 3121
    v_mul_lo_u32 v3, v2, s12
    v_lshrrev_b32 v3, 19, v3
    v_mul_u32_u24 v4, 168, v3
    v_sub_u32 v4, v2, v4
    v_lshlrev_b32 v5, 12, v3
    v_lshlrev_b32 v6, 4, v4
    v_add_u32 v5, v5, v6
    v_add_u32 v5, 242221056, v5
    buffer_load_dwordx4 v[8:11], v5, s[8:11], 0 offen
    v_mul_u32_u24 v7, 2688, v3
    v_add_u32 v7, v7, v6
    s_waitcnt vmcnt(0)
    ds_write_b128 v7, v[8:11]
    v_add_u32 v2, 3072, v1
    s_mov_b32 s12, 3121
    v_mul_lo_u32 v3, v2, s12
    v_lshrrev_b32 v3, 19, v3
    v_mul_u32_u24 v4, 168, v3
    v_sub_u32 v4, v2, v4
    v_lshlrev_b32 v5, 12, v3
    v_lshlrev_b32 v6, 4, v4
    v_add_u32 v5, v5, v6
    v_add_u32 v5, 242221056, v5
    buffer_load_dwordx4 v[8:11], v5, s[8:11], 0 offen
    v_mul_u32_u24 v7, 2688, v3
    v_add_u32 v7, v7, v6
    s_waitcnt vmcnt(0)
    ds_write_b128 v7, v[8:11]
    v_add_u32 v2, 3328, v1
    s_mov_b32 s12, 3121
    v_mul_lo_u32 v3, v2, s12
    v_lshrrev_b32 v3, 19, v3
    v_mul_u32_u24 v4, 168, v3
    v_sub_u32 v4, v2, v4
    v_lshlrev_b32 v5, 12, v3
    v_lshlrev_b32 v6, 4, v4
    v_add_u32 v5, v5, v6
    v_add_u32 v5, 242221056, v5
    buffer_load_dwordx4 v[8:11], v5, s[8:11], 0 offen
    v_mul_u32_u24 v7, 2688, v3
    v_add_u32 v7, v7, v6
    s_waitcnt vmcnt(0)
    ds_write_b128 v7, v[8:11]
    v_add_u32 v2, 3584, v1
    s_mov_b32 s12, 3121
    v_mul_lo_u32 v3, v2, s12
    v_lshrrev_b32 v3, 19, v3
    v_mul_u32_u24 v4, 168, v3
    v_sub_u32 v4, v2, v4
    v_lshlrev_b32 v5, 12, v3
    v_lshlrev_b32 v6, 4, v4
    v_add_u32 v5, v5, v6
    v_add_u32 v5, 242221056, v5
    buffer_load_dwordx4 v[8:11], v5, s[8:11], 0 offen
    v_mul_u32_u24 v7, 2688, v3
    v_add_u32 v7, v7, v6
    s_waitcnt vmcnt(0)
    ds_write_b128 v7, v[8:11]
    v_add_u32 v2, 3840, v1
    s_mov_b32 s12, 3121
    v_mul_lo_u32 v3, v2, s12
    v_lshrrev_b32 v3, 19, v3
    v_mul_u32_u24 v4, 168, v3
    v_sub_u32 v4, v2, v4
    v_lshlrev_b32 v5, 12, v3
    v_lshlrev_b32 v6, 4, v4
    v_add_u32 v5, v5, v6
    v_add_u32 v5, 242221056, v5
    buffer_load_dwordx4 v[8:11], v5, s[8:11], 0 offen
    v_mul_u32_u24 v7, 2688, v3
    v_add_u32 v7, v7, v6
    s_waitcnt vmcnt(0)
    ds_write_b128 v7, v[8:11]
    v_add_u32 v2, 4096, v1
    s_mov_b32 s12, 3121
    v_mul_lo_u32 v3, v2, s12
    v_lshrrev_b32 v3, 19, v3
    v_mul_u32_u24 v4, 168, v3
    v_sub_u32 v4, v2, v4
    v_lshlrev_b32 v5, 12, v3
    v_lshlrev_b32 v6, 4, v4
    v_add_u32 v5, v5, v6
    v_add_u32 v5, 242221056, v5
    buffer_load_dwordx4 v[8:11], v5, s[8:11], 0 offen
    v_mul_u32_u24 v7, 2688, v3
    v_add_u32 v7, v7, v6
    s_waitcnt vmcnt(0)
    ds_write_b128 v7, v[8:11]
    v_add_u32 v2, 4352, v1
    s_mov_b32 s12, 3121
    v_mul_lo_u32 v3, v2, s12
    v_lshrrev_b32 v3, 19, v3
    v_mul_u32_u24 v4, 168, v3
    v_sub_u32 v4, v2, v4
    v_lshlrev_b32 v5, 12, v3
    v_lshlrev_b32 v6, 4, v4
    v_add_u32 v5, v5, v6
    v_add_u32 v5, 242221056, v5
    buffer_load_dwordx4 v[8:11], v5, s[8:11], 0 offen
    v_mul_u32_u24 v7, 2688, v3
    v_add_u32 v7, v7, v6
    s_waitcnt vmcnt(0)
    ds_write_b128 v7, v[8:11]
    v_add_u32 v2, 4608, v1
    s_mov_b32 s12, 3121
    v_mul_lo_u32 v3, v2, s12
    v_lshrrev_b32 v3, 19, v3
    v_mul_u32_u24 v4, 168, v3
    v_sub_u32 v4, v2, v4
    v_lshlrev_b32 v5, 12, v3
    v_lshlrev_b32 v6, 4, v4
    v_add_u32 v5, v5, v6
    v_add_u32 v5, 242221056, v5
    buffer_load_dwordx4 v[8:11], v5, s[8:11], 0 offen
    v_mul_u32_u24 v7, 2688, v3
    v_add_u32 v7, v7, v6
    s_waitcnt vmcnt(0)
    ds_write_b128 v7, v[8:11]
    v_add_u32 v2, 4864, v1
    s_mov_b32 s12, 3121
    v_mul_lo_u32 v3, v2, s12
    v_lshrrev_b32 v3, 19, v3
    v_mul_u32_u24 v4, 168, v3
    v_sub_u32 v4, v2, v4
    v_lshlrev_b32 v5, 12, v3
    v_lshlrev_b32 v6, 4, v4
    v_add_u32 v5, v5, v6
    v_add_u32 v5, 242221056, v5
    buffer_load_dwordx4 v[8:11], v5, s[8:11], 0 offen
    v_mul_u32_u24 v7, 2688, v3
    v_add_u32 v7, v7, v6
    s_waitcnt vmcnt(0)
    ds_write_b128 v7, v[8:11]
    v_add_u32 v2, 5120, v1
    s_mov_b32 s12, 3121
    v_mul_lo_u32 v3, v2, s12
    v_lshrrev_b32 v3, 19, v3
    v_mul_u32_u24 v4, 168, v3
    v_sub_u32 v4, v2, v4
    v_lshlrev_b32 v5, 12, v3
    v_lshlrev_b32 v6, 4, v4
    v_add_u32 v5, v5, v6
    v_add_u32 v5, 242221056, v5
    buffer_load_dwordx4 v[8:11], v5, s[8:11], 0 offen
    v_mul_u32_u24 v7, 2688, v3
    v_add_u32 v7, v7, v6
    s_waitcnt vmcnt(0)
    ds_write_b128 v7, v[8:11]
    s_waitcnt lgkmcnt(0)
    s_barrier
    v_and_b32 v2, 31, v0
    v_lshrrev_b32 v3, 5, v0
    s_lshl_b32 s12, s2, 3
    v_add_u32 v3, s12, v3
    v_mul_u32_u24 v4, 1280, v3
    v_mul_u32_u24 v5, 40, v2
    v_add_u32 v4, v4, v5
    v_add_u32 v6, 229638144, v4
    buffer_load_dwordx2 v[8:9], v6, s[8:11], 0 offen offset:0
    buffer_load_dwordx2 v[10:11], v6, s[8:11], 0 offen offset:8
    buffer_load_dwordx2 v[12:13], v6, s[8:11], 0 offen offset:16
    buffer_load_dwordx2 v[14:15], v6, s[8:11], 0 offen offset:24
    buffer_load_dwordx2 v[16:17], v6, s[8:11], 0 offen offset:32
    s_waitcnt vmcnt(0)
    v_lshlrev_b32 v40, 16, v8
    v_and_b32 v41, 0xffff0000, v8
    v_mul_f32 v44, 1.4426950408889634, v40
    v_exp_f32 v44, v44
    v_add_f32 v42, 1.0, v40
    v_cmp_lt_f32 vcc, 0, v40
    s_nop 1
    v_cndmask_b32 v42, v44, v42, vcc
    v_add_f32 v42, 0x358637bd, v42
    v_mul_f32 v44, 1.4426950408889634, v41
    v_exp_f32 v44, v44
    v_add_f32 v43, 1.0, v41
    v_cmp_lt_f32 vcc, 0, v41
    s_nop 1
    v_cndmask_b32 v43, v44, v43, vcc
    v_add_f32 v43, 0x358637bd, v43
    v_cvt_pk_bf16_f32 v45, v42, v43
    v_lshlrev_b32 v20, 16, v45
    v_and_b32 v21, 0xffff0000, v45
    v_lshlrev_b32 v40, 16, v9
    v_and_b32 v41, 0xffff0000, v9
    v_mul_f32 v44, 1.4426950408889634, v40
    v_exp_f32 v44, v44
    v_add_f32 v42, 1.0, v40
    v_cmp_lt_f32 vcc, 0, v40
    s_nop 1
    v_cndmask_b32 v42, v44, v42, vcc
    v_add_f32 v42, 0x358637bd, v42
    v_mul_f32 v44, 1.4426950408889634, v41
    v_exp_f32 v44, v44
    v_add_f32 v43, 1.0, v41
    v_cmp_lt_f32 vcc, 0, v41
    s_nop 1
    v_cndmask_b32 v43, v44, v43, vcc
    v_add_f32 v43, 0x358637bd, v43
    v_cvt_pk_bf16_f32 v45, v42, v43
    v_lshlrev_b32 v22, 16, v45
    v_and_b32 v23, 0xffff0000, v45
    v_lshlrev_b32 v40, 16, v10
    v_and_b32 v41, 0xffff0000, v10
    v_mul_f32 v44, 1.4426950408889634, v40
    v_exp_f32 v44, v44
    v_add_f32 v42, 1.0, v40
    v_cmp_lt_f32 vcc, 0, v40
    s_nop 1
    v_cndmask_b32 v42, v44, v42, vcc
    v_add_f32 v42, 0x358637bd, v42
    v_mul_f32 v44, 1.4426950408889634, v41
    v_exp_f32 v44, v44
    v_add_f32 v43, 1.0, v41
    v_cmp_lt_f32 vcc, 0, v41
    s_nop 1
    v_cndmask_b32 v43, v44, v43, vcc
    v_add_f32 v43, 0x358637bd, v43
    v_cvt_pk_bf16_f32 v45, v42, v43
    v_lshlrev_b32 v24, 16, v45
    v_and_b32 v25, 0xffff0000, v45
    v_lshlrev_b32 v40, 16, v11
    v_and_b32 v41, 0xffff0000, v11
    v_mul_f32 v44, 1.4426950408889634, v40
    v_exp_f32 v44, v44
    v_add_f32 v42, 1.0, v40
    v_cmp_lt_f32 vcc, 0, v40
    s_nop 1
    v_cndmask_b32 v42, v44, v42, vcc
    v_add_f32 v42, 0x358637bd, v42
    v_mul_f32 v44, 1.4426950408889634, v41
    v_exp_f32 v44, v44
    v_add_f32 v43, 1.0, v41
    v_cmp_lt_f32 vcc, 0, v41
    s_nop 1
    v_cndmask_b32 v43, v44, v43, vcc
    v_add_f32 v43, 0x358637bd, v43
    v_cvt_pk_bf16_f32 v45, v42, v43
    v_lshlrev_b32 v26, 16, v45
    v_and_b32 v27, 0xffff0000, v45
    v_lshlrev_b32 v40, 16, v12
    v_and_b32 v41, 0xffff0000, v12
    v_mul_f32 v44, 1.4426950408889634, v40
    v_exp_f32 v44, v44
    v_add_f32 v42, 1.0, v40
    v_cmp_lt_f32 vcc, 0, v40
    s_nop 1
    v_cndmask_b32 v42, v44, v42, vcc
    v_add_f32 v42, 0x358637bd, v42
    v_mul_f32 v44, 1.4426950408889634, v41
    v_exp_f32 v44, v44
    v_add_f32 v43, 1.0, v41
    v_cmp_lt_f32 vcc, 0, v41
    s_nop 1
    v_cndmask_b32 v43, v44, v43, vcc
    v_add_f32 v43, 0x358637bd, v43
    v_cvt_pk_bf16_f32 v45, v42, v43
    v_lshlrev_b32 v28, 16, v45
    v_and_b32 v29, 0xffff0000, v45
    v_lshlrev_b32 v40, 16, v13
    v_and_b32 v41, 0xffff0000, v13
    v_mul_f32 v44, 1.4426950408889634, v40
    v_exp_f32 v44, v44
    v_add_f32 v42, 1.0, v40
    v_cmp_lt_f32 vcc, 0, v40
    s_nop 1
    v_cndmask_b32 v42, v44, v42, vcc
    v_add_f32 v42, 0x358637bd, v42
    v_mul_f32 v44, 1.4426950408889634, v41
    v_exp_f32 v44, v44
    v_add_f32 v43, 1.0, v41
    v_cmp_lt_f32 vcc, 0, v41
    s_nop 1
    v_cndmask_b32 v43, v44, v43, vcc
    v_add_f32 v43, 0x358637bd, v43
    v_cvt_pk_bf16_f32 v45, v42, v43
    v_lshlrev_b32 v30, 16, v45
    v_and_b32 v31, 0xffff0000, v45
    v_lshlrev_b32 v40, 16, v14
    v_and_b32 v41, 0xffff0000, v14
    v_mul_f32 v44, 1.4426950408889634, v40
    v_exp_f32 v44, v44
    v_add_f32 v42, 1.0, v40
    v_cmp_lt_f32 vcc, 0, v40
    s_nop 1
    v_cndmask_b32 v42, v44, v42, vcc
    v_add_f32 v42, 0x358637bd, v42
    v_mul_f32 v44, 1.4426950408889634, v41
    v_exp_f32 v44, v44
    v_add_f32 v43, 1.0, v41
    v_cmp_lt_f32 vcc, 0, v41
    s_nop 1
    v_cndmask_b32 v43, v44, v43, vcc
    v_add_f32 v43, 0x358637bd, v43
    v_cvt_pk_bf16_f32 v45, v42, v43
    v_lshlrev_b32 v32, 16, v45
    v_and_b32 v33, 0xffff0000, v45
    v_lshlrev_b32 v40, 16, v15
    v_and_b32 v41, 0xffff0000, v15
    v_mul_f32 v44, 1.4426950408889634, v40
    v_exp_f32 v44, v44
    v_add_f32 v42, 1.0, v40
    v_cmp_lt_f32 vcc, 0, v40
    s_nop 1
    v_cndmask_b32 v42, v44, v42, vcc
    v_add_f32 v42, 0x358637bd, v42
    v_mul_f32 v44, 1.4426950408889634, v41
    v_exp_f32 v44, v44
    v_add_f32 v43, 1.0, v41
    v_cmp_lt_f32 vcc, 0, v41
    s_nop 1
    v_cndmask_b32 v43, v44, v43, vcc
    v_add_f32 v43, 0x358637bd, v43
    v_cvt_pk_bf16_f32 v45, v42, v43
    v_lshlrev_b32 v34, 16, v45
    v_and_b32 v35, 0xffff0000, v45
    v_lshlrev_b32 v40, 16, v16
    v_and_b32 v41, 0xffff0000, v16
    v_mul_f32 v44, 1.4426950408889634, v40
    v_exp_f32 v44, v44
    v_add_f32 v42, 1.0, v40
    v_cmp_lt_f32 vcc, 0, v40
    s_nop 1
    v_cndmask_b32 v42, v44, v42, vcc
    v_add_f32 v42, 0x358637bd, v42
    v_mul_f32 v44, 1.4426950408889634, v41
    v_exp_f32 v44, v44
    v_add_f32 v43, 1.0, v41
    v_cmp_lt_f32 vcc, 0, v41
    s_nop 1
    v_cndmask_b32 v43, v44, v43, vcc
    v_add_f32 v43, 0x358637bd, v43
    v_cvt_pk_bf16_f32 v45, v42, v43
    v_lshlrev_b32 v36, 16, v45
    v_and_b32 v37, 0xffff0000, v45
    v_lshlrev_b32 v40, 16, v17
    v_and_b32 v41, 0xffff0000, v17
    v_mul_f32 v44, 1.4426950408889634, v40
    v_exp_f32 v44, v44
    v_add_f32 v42, 1.0, v40
    v_cmp_lt_f32 vcc, 0, v40
    s_nop 1
    v_cndmask_b32 v42, v44, v42, vcc
    v_add_f32 v42, 0x358637bd, v42
    v_mul_f32 v44, 1.4426950408889634, v41
    v_exp_f32 v44, v44
    v_add_f32 v43, 1.0, v41
    v_cmp_lt_f32 vcc, 0, v41
    s_nop 1
    v_cndmask_b32 v43, v44, v43, vcc
    v_add_f32 v43, 0x358637bd, v43
    v_cvt_pk_bf16_f32 v45, v42, v43
    v_lshlrev_b32 v38, 16, v45
    v_and_b32 v39, 0xffff0000, v45
    v_mul_u32_u24 v7, 2688, v2
    ds_read_b128 v[72:75], v7 offset:0
    ds_read_b128 v[76:79], v7 offset:16
    ds_read_b128 v[80:83], v7 offset:32
    ds_read_b128 v[84:87], v7 offset:48
    ds_read_b128 v[88:91], v7 offset:64
    s_waitcnt lgkmcnt(0)
    v_mul_f32 v50, v20, v72
    v_fmac_f32 v50, v21, v73
    v_fmac_f32 v50, v22, v74
    v_fmac_f32 v50, v23, v75
    v_fmac_f32 v50, v24, v76
    v_fmac_f32 v50, v25, v77
    v_fmac_f32 v50, v26, v78
    v_fmac_f32 v50, v27, v79
    v_fmac_f32 v50, v28, v80
    v_fmac_f32 v50, v29, v81
    v_fmac_f32 v50, v30, v82
    v_fmac_f32 v50, v31, v83
    v_fmac_f32 v50, v32, v84
    v_fmac_f32 v50, v33, v85
    v_fmac_f32 v50, v34, v86
    v_fmac_f32 v50, v35, v87
    v_fmac_f32 v50, v36, v88
    v_fmac_f32 v50, v37, v89
    v_fmac_f32 v50, v38, v90
    v_fmac_f32 v50, v39, v91
    ds_read_b128 v[72:75], v7 offset:128
    ds_read_b128 v[76:79], v7 offset:144
    ds_read_b128 v[80:83], v7 offset:160
    ds_read_b128 v[84:87], v7 offset:176
    ds_read_b128 v[88:91], v7 offset:192
    s_waitcnt lgkmcnt(0)
    v_mul_f32 v51, v20, v72
    v_fmac_f32 v51, v21, v73
    v_fmac_f32 v51, v22, v74
    v_fmac_f32 v51, v23, v75
    v_fmac_f32 v51, v24, v76
    v_fmac_f32 v51, v25, v77
    v_fmac_f32 v51, v26, v78
    v_fmac_f32 v51, v27, v79
    v_fmac_f32 v51, v28, v80
    v_fmac_f32 v51, v29, v81
    v_fmac_f32 v51, v30, v82
    v_fmac_f32 v51, v31, v83
    v_fmac_f32 v51, v32, v84
    v_fmac_f32 v51, v33, v85
    v_fmac_f32 v51, v34, v86
    v_fmac_f32 v51, v35, v87
    v_fmac_f32 v51, v36, v88
    v_fmac_f32 v51, v37, v89
    v_fmac_f32 v51, v38, v90
    v_fmac_f32 v51, v39, v91
    ds_read_b128 v[72:75], v7 offset:256
    ds_read_b128 v[76:79], v7 offset:272
    ds_read_b128 v[80:83], v7 offset:288
    ds_read_b128 v[84:87], v7 offset:304
    ds_read_b128 v[88:91], v7 offset:320
    s_waitcnt lgkmcnt(0)
    v_mul_f32 v52, v20, v72
    v_fmac_f32 v52, v21, v73
    v_fmac_f32 v52, v22, v74
    v_fmac_f32 v52, v23, v75
    v_fmac_f32 v52, v24, v76
    v_fmac_f32 v52, v25, v77
    v_fmac_f32 v52, v26, v78
    v_fmac_f32 v52, v27, v79
    v_fmac_f32 v52, v28, v80
    v_fmac_f32 v52, v29, v81
    v_fmac_f32 v52, v30, v82
    v_fmac_f32 v52, v31, v83
    v_fmac_f32 v52, v32, v84
    v_fmac_f32 v52, v33, v85
    v_fmac_f32 v52, v34, v86
    v_fmac_f32 v52, v35, v87
    v_fmac_f32 v52, v36, v88
    v_fmac_f32 v52, v37, v89
    v_fmac_f32 v52, v38, v90
    v_fmac_f32 v52, v39, v91
    ds_read_b128 v[72:75], v7 offset:384
    ds_read_b128 v[76:79], v7 offset:400
    ds_read_b128 v[80:83], v7 offset:416
    ds_read_b128 v[84:87], v7 offset:432
    ds_read_b128 v[88:91], v7 offset:448
    s_waitcnt lgkmcnt(0)
    v_mul_f32 v53, v20, v72
    v_fmac_f32 v53, v21, v73
    v_fmac_f32 v53, v22, v74
    v_fmac_f32 v53, v23, v75
    v_fmac_f32 v53, v24, v76
    v_fmac_f32 v53, v25, v77
    v_fmac_f32 v53, v26, v78
    v_fmac_f32 v53, v27, v79
    v_fmac_f32 v53, v28, v80
    v_fmac_f32 v53, v29, v81
    v_fmac_f32 v53, v30, v82
    v_fmac_f32 v53, v31, v83
    v_fmac_f32 v53, v32, v84
    v_fmac_f32 v53, v33, v85
    v_fmac_f32 v53, v34, v86
    v_fmac_f32 v53, v35, v87
    v_fmac_f32 v53, v36, v88
    v_fmac_f32 v53, v37, v89
    v_fmac_f32 v53, v38, v90
    v_fmac_f32 v53, v39, v91
    ds_read_b128 v[72:75], v7 offset:512
    ds_read_b128 v[76:79], v7 offset:528
    ds_read_b128 v[80:83], v7 offset:544
    ds_read_b128 v[84:87], v7 offset:560
    ds_read_b128 v[88:91], v7 offset:576
    s_waitcnt lgkmcnt(0)
    v_mul_f32 v54, v20, v72
    v_fmac_f32 v54, v21, v73
    v_fmac_f32 v54, v22, v74
    v_fmac_f32 v54, v23, v75
    v_fmac_f32 v54, v24, v76
    v_fmac_f32 v54, v25, v77
    v_fmac_f32 v54, v26, v78
    v_fmac_f32 v54, v27, v79
    v_fmac_f32 v54, v28, v80
    v_fmac_f32 v54, v29, v81
    v_fmac_f32 v54, v30, v82
    v_fmac_f32 v54, v31, v83
    v_fmac_f32 v54, v32, v84
    v_fmac_f32 v54, v33, v85
    v_fmac_f32 v54, v34, v86
    v_fmac_f32 v54, v35, v87
    v_fmac_f32 v54, v36, v88
    v_fmac_f32 v54, v37, v89
    v_fmac_f32 v54, v38, v90
    v_fmac_f32 v54, v39, v91
    ds_read_b128 v[72:75], v7 offset:640
    ds_read_b128 v[76:79], v7 offset:656
    ds_read_b128 v[80:83], v7 offset:672
    ds_read_b128 v[84:87], v7 offset:688
    ds_read_b128 v[88:91], v7 offset:704
    s_waitcnt lgkmcnt(0)
    v_mul_f32 v55, v20, v72
    v_fmac_f32 v55, v21, v73
    v_fmac_f32 v55, v22, v74
    v_fmac_f32 v55, v23, v75
    v_fmac_f32 v55, v24, v76
    v_fmac_f32 v55, v25, v77
    v_fmac_f32 v55, v26, v78
    v_fmac_f32 v55, v27, v79
    v_fmac_f32 v55, v28, v80
    v_fmac_f32 v55, v29, v81
    v_fmac_f32 v55, v30, v82
    v_fmac_f32 v55, v31, v83
    v_fmac_f32 v55, v32, v84
    v_fmac_f32 v55, v33, v85
    v_fmac_f32 v55, v34, v86
    v_fmac_f32 v55, v35, v87
    v_fmac_f32 v55, v36, v88
    v_fmac_f32 v55, v37, v89
    v_fmac_f32 v55, v38, v90
    v_fmac_f32 v55, v39, v91
    ds_read_b128 v[72:75], v7 offset:768
    ds_read_b128 v[76:79], v7 offset:784
    ds_read_b128 v[80:83], v7 offset:800
    ds_read_b128 v[84:87], v7 offset:816
    ds_read_b128 v[88:91], v7 offset:832
    s_waitcnt lgkmcnt(0)
    v_mul_f32 v56, v20, v72
    v_fmac_f32 v56, v21, v73
    v_fmac_f32 v56, v22, v74
    v_fmac_f32 v56, v23, v75
    v_fmac_f32 v56, v24, v76
    v_fmac_f32 v56, v25, v77
    v_fmac_f32 v56, v26, v78
    v_fmac_f32 v56, v27, v79
    v_fmac_f32 v56, v28, v80
    v_fmac_f32 v56, v29, v81
    v_fmac_f32 v56, v30, v82
    v_fmac_f32 v56, v31, v83
    v_fmac_f32 v56, v32, v84
    v_fmac_f32 v56, v33, v85
    v_fmac_f32 v56, v34, v86
    v_fmac_f32 v56, v35, v87
    v_fmac_f32 v56, v36, v88
    v_fmac_f32 v56, v37, v89
    v_fmac_f32 v56, v38, v90
    v_fmac_f32 v56, v39, v91
    ds_read_b128 v[72:75], v7 offset:896
    ds_read_b128 v[76:79], v7 offset:912
    ds_read_b128 v[80:83], v7 offset:928
    ds_read_b128 v[84:87], v7 offset:944
    ds_read_b128 v[88:91], v7 offset:960
    s_waitcnt lgkmcnt(0)
    v_mul_f32 v57, v20, v72
    v_fmac_f32 v57, v21, v73
    v_fmac_f32 v57, v22, v74
    v_fmac_f32 v57, v23, v75
    v_fmac_f32 v57, v24, v76
    v_fmac_f32 v57, v25, v77
    v_fmac_f32 v57, v26, v78
    v_fmac_f32 v57, v27, v79
    v_fmac_f32 v57, v28, v80
    v_fmac_f32 v57, v29, v81
    v_fmac_f32 v57, v30, v82
    v_fmac_f32 v57, v31, v83
    v_fmac_f32 v57, v32, v84
    v_fmac_f32 v57, v33, v85
    v_fmac_f32 v57, v34, v86
    v_fmac_f32 v57, v35, v87
    v_fmac_f32 v57, v36, v88
    v_fmac_f32 v57, v37, v89
    v_fmac_f32 v57, v38, v90
    v_fmac_f32 v57, v39, v91
    ds_read_b128 v[72:75], v7 offset:1024
    ds_read_b128 v[76:79], v7 offset:1040
    ds_read_b128 v[80:83], v7 offset:1056
    ds_read_b128 v[84:87], v7 offset:1072
    ds_read_b128 v[88:91], v7 offset:1088
    s_waitcnt lgkmcnt(0)
    v_mul_f32 v58, v20, v72
    v_fmac_f32 v58, v21, v73
    v_fmac_f32 v58, v22, v74
    v_fmac_f32 v58, v23, v75
    v_fmac_f32 v58, v24, v76
    v_fmac_f32 v58, v25, v77
    v_fmac_f32 v58, v26, v78
    v_fmac_f32 v58, v27, v79
    v_fmac_f32 v58, v28, v80
    v_fmac_f32 v58, v29, v81
    v_fmac_f32 v58, v30, v82
    v_fmac_f32 v58, v31, v83
    v_fmac_f32 v58, v32, v84
    v_fmac_f32 v58, v33, v85
    v_fmac_f32 v58, v34, v86
    v_fmac_f32 v58, v35, v87
    v_fmac_f32 v58, v36, v88
    v_fmac_f32 v58, v37, v89
    v_fmac_f32 v58, v38, v90
    v_fmac_f32 v58, v39, v91
    ds_read_b128 v[72:75], v7 offset:1152
    ds_read_b128 v[76:79], v7 offset:1168
    ds_read_b128 v[80:83], v7 offset:1184
    ds_read_b128 v[84:87], v7 offset:1200
    ds_read_b128 v[88:91], v7 offset:1216
    s_waitcnt lgkmcnt(0)
    v_mul_f32 v59, v20, v72
    v_fmac_f32 v59, v21, v73
    v_fmac_f32 v59, v22, v74
    v_fmac_f32 v59, v23, v75
    v_fmac_f32 v59, v24, v76
    v_fmac_f32 v59, v25, v77
    v_fmac_f32 v59, v26, v78
    v_fmac_f32 v59, v27, v79
    v_fmac_f32 v59, v28, v80
    v_fmac_f32 v59, v29, v81
    v_fmac_f32 v59, v30, v82
    v_fmac_f32 v59, v31, v83
    v_fmac_f32 v59, v32, v84
    v_fmac_f32 v59, v33, v85
    v_fmac_f32 v59, v34, v86
    v_fmac_f32 v59, v35, v87
    v_fmac_f32 v59, v36, v88
    v_fmac_f32 v59, v37, v89
    v_fmac_f32 v59, v38, v90
    v_fmac_f32 v59, v39, v91
    ds_read_b128 v[72:75], v7 offset:1280
    ds_read_b128 v[76:79], v7 offset:1296
    ds_read_b128 v[80:83], v7 offset:1312
    ds_read_b128 v[84:87], v7 offset:1328
    ds_read_b128 v[88:91], v7 offset:1344
    s_waitcnt lgkmcnt(0)
    v_mul_f32 v60, v20, v72
    v_fmac_f32 v60, v21, v73
    v_fmac_f32 v60, v22, v74
    v_fmac_f32 v60, v23, v75
    v_fmac_f32 v60, v24, v76
    v_fmac_f32 v60, v25, v77
    v_fmac_f32 v60, v26, v78
    v_fmac_f32 v60, v27, v79
    v_fmac_f32 v60, v28, v80
    v_fmac_f32 v60, v29, v81
    v_fmac_f32 v60, v30, v82
    v_fmac_f32 v60, v31, v83
    v_fmac_f32 v60, v32, v84
    v_fmac_f32 v60, v33, v85
    v_fmac_f32 v60, v34, v86
    v_fmac_f32 v60, v35, v87
    v_fmac_f32 v60, v36, v88
    v_fmac_f32 v60, v37, v89
    v_fmac_f32 v60, v38, v90
    v_fmac_f32 v60, v39, v91
    ds_read_b128 v[72:75], v7 offset:1408
    ds_read_b128 v[76:79], v7 offset:1424
    ds_read_b128 v[80:83], v7 offset:1440
    ds_read_b128 v[84:87], v7 offset:1456
    ds_read_b128 v[88:91], v7 offset:1472
    s_waitcnt lgkmcnt(0)
    v_mul_f32 v61, v20, v72
    v_fmac_f32 v61, v21, v73
    v_fmac_f32 v61, v22, v74
    v_fmac_f32 v61, v23, v75
    v_fmac_f32 v61, v24, v76
    v_fmac_f32 v61, v25, v77
    v_fmac_f32 v61, v26, v78
    v_fmac_f32 v61, v27, v79
    v_fmac_f32 v61, v28, v80
    v_fmac_f32 v61, v29, v81
    v_fmac_f32 v61, v30, v82
    v_fmac_f32 v61, v31, v83
    v_fmac_f32 v61, v32, v84
    v_fmac_f32 v61, v33, v85
    v_fmac_f32 v61, v34, v86
    v_fmac_f32 v61, v35, v87
    v_fmac_f32 v61, v36, v88
    v_fmac_f32 v61, v37, v89
    v_fmac_f32 v61, v38, v90
    v_fmac_f32 v61, v39, v91
    ds_read_b128 v[72:75], v7 offset:1536
    ds_read_b128 v[76:79], v7 offset:1552
    ds_read_b128 v[80:83], v7 offset:1568
    ds_read_b128 v[84:87], v7 offset:1584
    ds_read_b128 v[88:91], v7 offset:1600
    s_waitcnt lgkmcnt(0)
    v_mul_f32 v62, v20, v72
    v_fmac_f32 v62, v21, v73
    v_fmac_f32 v62, v22, v74
    v_fmac_f32 v62, v23, v75
    v_fmac_f32 v62, v24, v76
    v_fmac_f32 v62, v25, v77
    v_fmac_f32 v62, v26, v78
    v_fmac_f32 v62, v27, v79
    v_fmac_f32 v62, v28, v80
    v_fmac_f32 v62, v29, v81
    v_fmac_f32 v62, v30, v82
    v_fmac_f32 v62, v31, v83
    v_fmac_f32 v62, v32, v84
    v_fmac_f32 v62, v33, v85
    v_fmac_f32 v62, v34, v86
    v_fmac_f32 v62, v35, v87
    v_fmac_f32 v62, v36, v88
    v_fmac_f32 v62, v37, v89
    v_fmac_f32 v62, v38, v90
    v_fmac_f32 v62, v39, v91
    ds_read_b128 v[72:75], v7 offset:1664
    ds_read_b128 v[76:79], v7 offset:1680
    ds_read_b128 v[80:83], v7 offset:1696
    ds_read_b128 v[84:87], v7 offset:1712
    ds_read_b128 v[88:91], v7 offset:1728
    s_waitcnt lgkmcnt(0)
    v_mul_f32 v63, v20, v72
    v_fmac_f32 v63, v21, v73
    v_fmac_f32 v63, v22, v74
    v_fmac_f32 v63, v23, v75
    v_fmac_f32 v63, v24, v76
    v_fmac_f32 v63, v25, v77
    v_fmac_f32 v63, v26, v78
    v_fmac_f32 v63, v27, v79
    v_fmac_f32 v63, v28, v80
    v_fmac_f32 v63, v29, v81
    v_fmac_f32 v63, v30, v82
    v_fmac_f32 v63, v31, v83
    v_fmac_f32 v63, v32, v84
    v_fmac_f32 v63, v33, v85
    v_fmac_f32 v63, v34, v86
    v_fmac_f32 v63, v35, v87
    v_fmac_f32 v63, v36, v88
    v_fmac_f32 v63, v37, v89
    v_fmac_f32 v63, v38, v90
    v_fmac_f32 v63, v39, v91
    ds_read_b128 v[72:75], v7 offset:1792
    ds_read_b128 v[76:79], v7 offset:1808
    ds_read_b128 v[80:83], v7 offset:1824
    ds_read_b128 v[84:87], v7 offset:1840
    ds_read_b128 v[88:91], v7 offset:1856
    s_waitcnt lgkmcnt(0)
    v_mul_f32 v64, v20, v72
    v_fmac_f32 v64, v21, v73
    v_fmac_f32 v64, v22, v74
    v_fmac_f32 v64, v23, v75
    v_fmac_f32 v64, v24, v76
    v_fmac_f32 v64, v25, v77
    v_fmac_f32 v64, v26, v78
    v_fmac_f32 v64, v27, v79
    v_fmac_f32 v64, v28, v80
    v_fmac_f32 v64, v29, v81
    v_fmac_f32 v64, v30, v82
    v_fmac_f32 v64, v31, v83
    v_fmac_f32 v64, v32, v84
    v_fmac_f32 v64, v33, v85
    v_fmac_f32 v64, v34, v86
    v_fmac_f32 v64, v35, v87
    v_fmac_f32 v64, v36, v88
    v_fmac_f32 v64, v37, v89
    v_fmac_f32 v64, v38, v90
    v_fmac_f32 v64, v39, v91
    ds_read_b128 v[72:75], v7 offset:1920
    ds_read_b128 v[76:79], v7 offset:1936
    ds_read_b128 v[80:83], v7 offset:1952
    ds_read_b128 v[84:87], v7 offset:1968
    ds_read_b128 v[88:91], v7 offset:1984
    s_waitcnt lgkmcnt(0)
    v_mul_f32 v65, v20, v72
    v_fmac_f32 v65, v21, v73
    v_fmac_f32 v65, v22, v74
    v_fmac_f32 v65, v23, v75
    v_fmac_f32 v65, v24, v76
    v_fmac_f32 v65, v25, v77
    v_fmac_f32 v65, v26, v78
    v_fmac_f32 v65, v27, v79
    v_fmac_f32 v65, v28, v80
    v_fmac_f32 v65, v29, v81
    v_fmac_f32 v65, v30, v82
    v_fmac_f32 v65, v31, v83
    v_fmac_f32 v65, v32, v84
    v_fmac_f32 v65, v33, v85
    v_fmac_f32 v65, v34, v86
    v_fmac_f32 v65, v35, v87
    v_fmac_f32 v65, v36, v88
    v_fmac_f32 v65, v37, v89
    v_fmac_f32 v65, v38, v90
    v_fmac_f32 v65, v39, v91
    ds_read_b128 v[72:75], v7 offset:2048
    ds_read_b128 v[76:79], v7 offset:2064
    ds_read_b128 v[80:83], v7 offset:2080
    ds_read_b128 v[84:87], v7 offset:2096
    ds_read_b128 v[88:91], v7 offset:2112
    s_waitcnt lgkmcnt(0)
    v_mul_f32 v66, v20, v72
    v_fmac_f32 v66, v21, v73
    v_fmac_f32 v66, v22, v74
    v_fmac_f32 v66, v23, v75
    v_fmac_f32 v66, v24, v76
    v_fmac_f32 v66, v25, v77
    v_fmac_f32 v66, v26, v78
    v_fmac_f32 v66, v27, v79
    v_fmac_f32 v66, v28, v80
    v_fmac_f32 v66, v29, v81
    v_fmac_f32 v66, v30, v82
    v_fmac_f32 v66, v31, v83
    v_fmac_f32 v66, v32, v84
    v_fmac_f32 v66, v33, v85
    v_fmac_f32 v66, v34, v86
    v_fmac_f32 v66, v35, v87
    v_fmac_f32 v66, v36, v88
    v_fmac_f32 v66, v37, v89
    v_fmac_f32 v66, v38, v90
    v_fmac_f32 v66, v39, v91
    ds_read_b128 v[72:75], v7 offset:2176
    ds_read_b128 v[76:79], v7 offset:2192
    ds_read_b128 v[80:83], v7 offset:2208
    ds_read_b128 v[84:87], v7 offset:2224
    ds_read_b128 v[88:91], v7 offset:2240
    s_waitcnt lgkmcnt(0)
    v_mul_f32 v67, v20, v72
    v_fmac_f32 v67, v21, v73
    v_fmac_f32 v67, v22, v74
    v_fmac_f32 v67, v23, v75
    v_fmac_f32 v67, v24, v76
    v_fmac_f32 v67, v25, v77
    v_fmac_f32 v67, v26, v78
    v_fmac_f32 v67, v27, v79
    v_fmac_f32 v67, v28, v80
    v_fmac_f32 v67, v29, v81
    v_fmac_f32 v67, v30, v82
    v_fmac_f32 v67, v31, v83
    v_fmac_f32 v67, v32, v84
    v_fmac_f32 v67, v33, v85
    v_fmac_f32 v67, v34, v86
    v_fmac_f32 v67, v35, v87
    v_fmac_f32 v67, v36, v88
    v_fmac_f32 v67, v37, v89
    v_fmac_f32 v67, v38, v90
    v_fmac_f32 v67, v39, v91
    ds_read_b128 v[72:75], v7 offset:2304
    ds_read_b128 v[76:79], v7 offset:2320
    ds_read_b128 v[80:83], v7 offset:2336
    ds_read_b128 v[84:87], v7 offset:2352
    ds_read_b128 v[88:91], v7 offset:2368
    s_waitcnt lgkmcnt(0)
    v_mul_f32 v68, v20, v72
    v_fmac_f32 v68, v21, v73
    v_fmac_f32 v68, v22, v74
    v_fmac_f32 v68, v23, v75
    v_fmac_f32 v68, v24, v76
    v_fmac_f32 v68, v25, v77
    v_fmac_f32 v68, v26, v78
    v_fmac_f32 v68, v27, v79
    v_fmac_f32 v68, v28, v80
    v_fmac_f32 v68, v29, v81
    v_fmac_f32 v68, v30, v82
    v_fmac_f32 v68, v31, v83
    v_fmac_f32 v68, v32, v84
    v_fmac_f32 v68, v33, v85
    v_fmac_f32 v68, v34, v86
    v_fmac_f32 v68, v35, v87
    v_fmac_f32 v68, v36, v88
    v_fmac_f32 v68, v37, v89
    v_fmac_f32 v68, v38, v90
    v_fmac_f32 v68, v39, v91
    ds_read_b128 v[72:75], v7 offset:2432
    ds_read_b128 v[76:79], v7 offset:2448
    ds_read_b128 v[80:83], v7 offset:2464
    ds_read_b128 v[84:87], v7 offset:2480
    ds_read_b128 v[88:91], v7 offset:2496
    s_waitcnt lgkmcnt(0)
    v_mul_f32 v69, v20, v72
    v_fmac_f32 v69, v21, v73
    v_fmac_f32 v69, v22, v74
    v_fmac_f32 v69, v23, v75
    v_fmac_f32 v69, v24, v76
    v_fmac_f32 v69, v25, v77
    v_fmac_f32 v69, v26, v78
    v_fmac_f32 v69, v27, v79
    v_fmac_f32 v69, v28, v80
    v_fmac_f32 v69, v29, v81
    v_fmac_f32 v69, v30, v82
    v_fmac_f32 v69, v31, v83
    v_fmac_f32 v69, v32, v84
    v_fmac_f32 v69, v33, v85
    v_fmac_f32 v69, v34, v86
    v_fmac_f32 v69, v35, v87
    v_fmac_f32 v69, v36, v88
    v_fmac_f32 v69, v37, v89
    v_fmac_f32 v69, v38, v90
    v_fmac_f32 v69, v39, v91
    ds_read_b128 v[72:75], v7 offset:2560
    ds_read_b128 v[76:79], v7 offset:2576
    ds_read_b128 v[80:83], v7 offset:2592
    ds_read_b128 v[84:87], v7 offset:2608
    ds_read_b128 v[88:91], v7 offset:2624
    s_waitcnt lgkmcnt(0)
    v_mul_f32 v70, v20, v72
    v_fmac_f32 v70, v21, v73
    v_fmac_f32 v70, v22, v74
    v_fmac_f32 v70, v23, v75
    v_fmac_f32 v70, v24, v76
    v_fmac_f32 v70, v25, v77
    v_fmac_f32 v70, v26, v78
    v_fmac_f32 v70, v27, v79
    v_fmac_f32 v70, v28, v80
    v_fmac_f32 v70, v29, v81
    v_fmac_f32 v70, v30, v82
    v_fmac_f32 v70, v31, v83
    v_fmac_f32 v70, v32, v84
    v_fmac_f32 v70, v33, v85
    v_fmac_f32 v70, v34, v86
    v_fmac_f32 v70, v35, v87
    v_fmac_f32 v70, v36, v88
    v_fmac_f32 v70, v37, v89
    v_fmac_f32 v70, v38, v90
    v_fmac_f32 v70, v39, v91
    v_add_f32 v70, 0x358637bd, v70
    v_rcp_f32 v70, v70
    s_nop 0
    v_mul_f32 v50, v50, v70
    v_mul_f32 v51, v51, v70
    v_mul_f32 v52, v52, v70
    v_mul_f32 v53, v53, v70
    v_mul_f32 v54, v54, v70
    v_mul_f32 v55, v55, v70
    v_mul_f32 v56, v56, v70
    v_mul_f32 v57, v57, v70
    v_mul_f32 v58, v58, v70
    v_mul_f32 v59, v59, v70
    v_mul_f32 v60, v60, v70
    v_mul_f32 v61, v61, v70
    v_mul_f32 v62, v62, v70
    v_mul_f32 v63, v63, v70
    v_mul_f32 v64, v64, v70
    v_mul_f32 v65, v65, v70
    v_mul_f32 v66, v66, v70
    v_mul_f32 v67, v67, v70
    v_mul_f32 v68, v68, v70
    v_mul_f32 v69, v69, v70
    v_cvt_pk_bf16_f32 v8, v50, v51
    v_cvt_pk_bf16_f32 v9, v52, v53
    v_cvt_pk_bf16_f32 v10, v54, v55
    v_cvt_pk_bf16_f32 v11, v56, v57
    v_cvt_pk_bf16_f32 v12, v58, v59
    v_cvt_pk_bf16_f32 v13, v60, v61
    v_cvt_pk_bf16_f32 v14, v62, v63
    v_cvt_pk_bf16_f32 v15, v64, v65
    v_cvt_pk_bf16_f32 v16, v66, v67
    v_cvt_pk_bf16_f32 v17, v68, v69
    v_add_u32 v6, 239075328, v4
    buffer_store_dwordx2 v[8:9], v6, s[8:11], 0 offen offset:0
    buffer_store_dwordx2 v[10:11], v6, s[8:11], 0 offen offset:8
    buffer_store_dwordx2 v[12:13], v6, s[8:11], 0 offen offset:16
    buffer_store_dwordx2 v[14:15], v6, s[8:11], 0 offen offset:24
    buffer_store_dwordx2 v[16:17], v6, s[8:11], 0 offen offset:32
attn_a1_kernel_end:
    s_endpgm
.section .rodata,"a"
.p2align 6
.amdhsa_kernel attn_a1_kernel
  .amdhsa_next_free_vgpr 96
  .amdhsa_next_free_sgpr 40
  .amdhsa_accum_offset 96
  .amdhsa_group_segment_fixed_size 0
  .amdhsa_kernarg_size 104
  .amdhsa_user_sgpr_count 2
  .amdhsa_user_sgpr_kernarg_segment_ptr 1
  .amdhsa_system_sgpr_workgroup_id_x 1
.end_amdhsa_kernel
.text
.globl wo_a1_kernel
.p2align 8
.type wo_a1_kernel,@function
wo_a1_kernel:
    v_lshrrev_b32 v1, 6, v0
    v_and_b32 v2, 63, v0
    s_nop 0
    v_readfirstlane_b32 s3, v1
    s_cmp_ge_u32 s2, 128
    s_cbranch_scc1 wo_a1_kernel_end
    s_load_dwordx2 s[4:5], s[0:1], 96
    s_load_dwordx2 s[6:7], s[0:1], 80
    s_load_dwordx2 s[42:43], s[0:1], 0
    s_mul_i32 s20, s2, 1
    s_lshr_b32 s20, s20, 3
    s_mul_i32 s21, s20, 8
    s_sub_u32 s21, s2, s21
    s_lshl_b32 s20, s20, 2
    s_add_u32 s20, s20, s3
    s_mul_i32 s22, s20, 32
    s_mul_i32 s23, s21, 80
    s_waitcnt lgkmcnt(0)
    s_mov_b32 s8, s4
    s_mov_b32 s9, s5
    s_mov_b32 s10, 268435456
    s_mov_b32 s11, 0x00020000
    v_and_b32 v3, 15, v2
    v_lshrrev_b32 v4, 4, v2
    s_mov_b32 s24, 1280
    v_add_u32 v5, s22, v3
    v_mul_lo_u32 v5, v5, s24
    v_lshlrev_b32 v6, 4, v4
    v_add_u32 v5, v5, v6
    v_add_u32 v5, 239075328, v5
    v_mov_b32 v8, v5
    v_add_u32 v9, 20480, v5
    v_lshlrev_b32 v7, 4, v2
    s_mov_b32 s25, 0
    s_mov_b32 s26, 0
    s_mul_i32 s27, s21, 102400
    s_add_u32 s27, s27, s26
    s_add_u32 s27, s27, 246415360
    s_add_u32 s32, s27, 0
    s_add_u32 s33, s27, 20480
    s_add_u32 s34, s27, 40960
    s_add_u32 s35, s27, 61440
    s_add_u32 s36, s27, 81920
    v_accvgpr_write_b32 a0, 0
    v_accvgpr_write_b32 a1, 0
    v_accvgpr_write_b32 a2, 0
    v_accvgpr_write_b32 a3, 0
    v_accvgpr_write_b32 a4, 0
    v_accvgpr_write_b32 a5, 0
    v_accvgpr_write_b32 a6, 0
    v_accvgpr_write_b32 a7, 0
    v_accvgpr_write_b32 a8, 0
    v_accvgpr_write_b32 a9, 0
    v_accvgpr_write_b32 a10, 0
    v_accvgpr_write_b32 a11, 0
    v_accvgpr_write_b32 a12, 0
    v_accvgpr_write_b32 a13, 0
    v_accvgpr_write_b32 a14, 0
    v_accvgpr_write_b32 a15, 0
    v_accvgpr_write_b32 a16, 0
    v_accvgpr_write_b32 a17, 0
    v_accvgpr_write_b32 a18, 0
    v_accvgpr_write_b32 a19, 0
    v_accvgpr_write_b32 a20, 0
    v_accvgpr_write_b32 a21, 0
    v_accvgpr_write_b32 a22, 0
    v_accvgpr_write_b32 a23, 0
    v_accvgpr_write_b32 a24, 0
    v_accvgpr_write_b32 a25, 0
    v_accvgpr_write_b32 a26, 0
    v_accvgpr_write_b32 a27, 0
    v_accvgpr_write_b32 a28, 0
    v_accvgpr_write_b32 a29, 0
    v_accvgpr_write_b32 a30, 0
    v_accvgpr_write_b32 a31, 0
    v_accvgpr_write_b32 a32, 0
    v_accvgpr_write_b32 a33, 0
    v_accvgpr_write_b32 a34, 0
    v_accvgpr_write_b32 a35, 0
    v_accvgpr_write_b32 a36, 0
    v_accvgpr_write_b32 a37, 0
    v_accvgpr_write_b32 a38, 0
    v_accvgpr_write_b32 a39, 0
    buffer_load_dwordx4 v[16:19], v8, s[8:11], s25 offen
    buffer_load_dwordx4 v[20:23], v9, s[8:11], s25 offen
    buffer_load_dwordx4 v[24:27], v7, s[8:11], s32 offen
    buffer_load_dwordx4 v[28:31], v7, s[8:11], s33 offen
    buffer_load_dwordx4 v[32:35], v7, s[8:11], s34 offen
    buffer_load_dwordx4 v[36:39], v7, s[8:11], s35 offen
    buffer_load_dwordx4 v[40:43], v7, s[8:11], s36 offen
    s_mov_b32 s28, 10
wo_a1_kernel_loop0:
    s_add_u32 s25, s25, 64
    s_add_u32 s32, s32, 1024
    s_add_u32 s33, s33, 1024
    s_add_u32 s34, s34, 1024
    s_add_u32 s35, s35, 1024
    s_add_u32 s36, s36, 1024
    buffer_load_dwordx4 v[44:47], v8, s[8:11], s25 offen
    buffer_load_dwordx4 v[48:51], v9, s[8:11], s25 offen
    buffer_load_dwordx4 v[52:55], v7, s[8:11], s32 offen
    buffer_load_dwordx4 v[56:59], v7, s[8:11], s33 offen
    buffer_load_dwordx4 v[60:63], v7, s[8:11], s34 offen
    buffer_load_dwordx4 v[64:67], v7, s[8:11], s35 offen
    buffer_load_dwordx4 v[68:71], v7, s[8:11], s36 offen
    s_waitcnt vmcnt(7)
    v_mfma_f32_16x16x32_bf16 a[0:3], v[24:27], v[16:19], a[0:3]
    v_mfma_f32_16x16x32_bf16 a[20:23], v[24:27], v[20:23], a[20:23]
    v_mfma_f32_16x16x32_bf16 a[4:7], v[28:31], v[16:19], a[4:7]
    v_mfma_f32_16x16x32_bf16 a[24:27], v[28:31], v[20:23], a[24:27]
    v_mfma_f32_16x16x32_bf16 a[8:11], v[32:35], v[16:19], a[8:11]
    v_mfma_f32_16x16x32_bf16 a[28:31], v[32:35], v[20:23], a[28:31]
    v_mfma_f32_16x16x32_bf16 a[12:15], v[36:39], v[16:19], a[12:15]
    v_mfma_f32_16x16x32_bf16 a[32:35], v[36:39], v[20:23], a[32:35]
    v_mfma_f32_16x16x32_bf16 a[16:19], v[40:43], v[16:19], a[16:19]
    v_mfma_f32_16x16x32_bf16 a[36:39], v[40:43], v[20:23], a[36:39]
    s_sub_u32 s28, s28, 1
    s_cmp_eq_u32 s28, 0
    s_cbranch_scc1 wo_a1_kernel_loop0_last
    s_add_u32 s25, s25, 64
    s_add_u32 s32, s32, 1024
    s_add_u32 s33, s33, 1024
    s_add_u32 s34, s34, 1024
    s_add_u32 s35, s35, 1024
    s_add_u32 s36, s36, 1024
    buffer_load_dwordx4 v[16:19], v8, s[8:11], s25 offen
    buffer_load_dwordx4 v[20:23], v9, s[8:11], s25 offen
    buffer_load_dwordx4 v[24:27], v7, s[8:11], s32 offen
    buffer_load_dwordx4 v[28:31], v7, s[8:11], s33 offen
    buffer_load_dwordx4 v[32:35], v7, s[8:11], s34 offen
    buffer_load_dwordx4 v[36:39], v7, s[8:11], s35 offen
    buffer_load_dwordx4 v[40:43], v7, s[8:11], s36 offen
    s_waitcnt vmcnt(7)
    v_mfma_f32_16x16x32_bf16 a[0:3], v[52:55], v[44:47], a[0:3]
    v_mfma_f32_16x16x32_bf16 a[20:23], v[52:55], v[48:51], a[20:23]
    v_mfma_f32_16x16x32_bf16 a[4:7], v[56:59], v[44:47], a[4:7]
    v_mfma_f32_16x16x32_bf16 a[24:27], v[56:59], v[48:51], a[24:27]
    v_mfma_f32_16x16x32_bf16 a[8:11], v[60:63], v[44:47], a[8:11]
    v_mfma_f32_16x16x32_bf16 a[28:31], v[60:63], v[48:51], a[28:31]
    v_mfma_f32_16x16x32_bf16 a[12:15], v[64:67], v[44:47], a[12:15]
    v_mfma_f32_16x16x32_bf16 a[32:35], v[64:67], v[48:51], a[32:35]
    v_mfma_f32_16x16x32_bf16 a[16:19], v[68:71], v[44:47], a[16:19]
    v_mfma_f32_16x16x32_bf16 a[36:39], v[68:71], v[48:51], a[36:39]
    s_branch wo_a1_kernel_loop0
wo_a1_kernel_loop0_last:
    s_waitcnt vmcnt(0)
    v_mfma_f32_16x16x32_bf16 a[0:3], v[52:55], v[44:47], a[0:3]
    v_mfma_f32_16x16x32_bf16 a[20:23], v[52:55], v[48:51], a[20:23]
    v_mfma_f32_16x16x32_bf16 a[4:7], v[56:59], v[44:47], a[4:7]
    v_mfma_f32_16x16x32_bf16 a[24:27], v[56:59], v[48:51], a[24:27]
    v_mfma_f32_16x16x32_bf16 a[8:11], v[60:63], v[44:47], a[8:11]
    v_mfma_f32_16x16x32_bf16 a[28:31], v[60:63], v[48:51], a[28:31]
    v_mfma_f32_16x16x32_bf16 a[12:15], v[64:67], v[44:47], a[12:15]
    v_mfma_f32_16x16x32_bf16 a[32:35], v[64:67], v[48:51], a[32:35]
    v_mfma_f32_16x16x32_bf16 a[16:19], v[68:71], v[44:47], a[16:19]
    v_mfma_f32_16x16x32_bf16 a[36:39], v[68:71], v[48:51], a[36:39]
    s_nop 7
    s_nop 7
    s_mov_b32 s44, s42
    s_mov_b32 s45, s43
    s_mov_b32 s46, 2621440
    s_mov_b32 s47, 0x00020000
    s_mov_b32 s24, 1280
    v_add_u32 v5, s22, v3
    v_mul_lo_u32 v5, v5, s24
    v_lshlrev_b32 v6, 3, v4
    s_lshl_b32 s29, s23, 1
    v_add3_u32 v5, v5, v6, s29
    v_add_u32 v6, 0, v5
    buffer_load_dwordx2 v[72:73], v6, s[44:47], 0 offen
    v_accvgpr_read_b32 v76, a0
    v_accvgpr_read_b32 v77, a1
    v_accvgpr_read_b32 v78, a2
    v_accvgpr_read_b32 v79, a3
    v_cvt_pk_bf16_f32 v80, v76, v77
    v_cvt_pk_bf16_f32 v81, v78, v79
    s_waitcnt vmcnt(0)
    v_lshlrev_b32 v76, 16, v80
    v_and_b32 v77, 0xffff0000, v80
    v_lshlrev_b32 v82, 16, v72
    v_and_b32 v83, 0xffff0000, v72
    v_add_f32 v76, v76, v82
    v_add_f32 v77, v77, v83
    v_lshlrev_b32 v78, 16, v81
    v_and_b32 v79, 0xffff0000, v81
    v_lshlrev_b32 v82, 16, v73
    v_and_b32 v83, 0xffff0000, v73
    v_add_f32 v78, v78, v82
    v_add_f32 v79, v79, v83
    v_cvt_pk_bf16_f32 v80, v76, v77
    v_cvt_pk_bf16_f32 v81, v78, v79
    v_add_u32 v6, 226492416, v5
    buffer_store_dwordx2 v[80:81], v6, s[8:11], 0 offen
    v_add_u32 v6, 32, v5
    buffer_load_dwordx2 v[72:73], v6, s[44:47], 0 offen
    v_accvgpr_read_b32 v76, a4
    v_accvgpr_read_b32 v77, a5
    v_accvgpr_read_b32 v78, a6
    v_accvgpr_read_b32 v79, a7
    v_cvt_pk_bf16_f32 v80, v76, v77
    v_cvt_pk_bf16_f32 v81, v78, v79
    s_waitcnt vmcnt(0)
    v_lshlrev_b32 v76, 16, v80
    v_and_b32 v77, 0xffff0000, v80
    v_lshlrev_b32 v82, 16, v72
    v_and_b32 v83, 0xffff0000, v72
    v_add_f32 v76, v76, v82
    v_add_f32 v77, v77, v83
    v_lshlrev_b32 v78, 16, v81
    v_and_b32 v79, 0xffff0000, v81
    v_lshlrev_b32 v82, 16, v73
    v_and_b32 v83, 0xffff0000, v73
    v_add_f32 v78, v78, v82
    v_add_f32 v79, v79, v83
    v_cvt_pk_bf16_f32 v80, v76, v77
    v_cvt_pk_bf16_f32 v81, v78, v79
    v_add_u32 v6, 226492448, v5
    buffer_store_dwordx2 v[80:81], v6, s[8:11], 0 offen
    v_add_u32 v6, 64, v5
    buffer_load_dwordx2 v[72:73], v6, s[44:47], 0 offen
    v_accvgpr_read_b32 v76, a8
    v_accvgpr_read_b32 v77, a9
    v_accvgpr_read_b32 v78, a10
    v_accvgpr_read_b32 v79, a11
    v_cvt_pk_bf16_f32 v80, v76, v77
    v_cvt_pk_bf16_f32 v81, v78, v79
    s_waitcnt vmcnt(0)
    v_lshlrev_b32 v76, 16, v80
    v_and_b32 v77, 0xffff0000, v80
    v_lshlrev_b32 v82, 16, v72
    v_and_b32 v83, 0xffff0000, v72
    v_add_f32 v76, v76, v82
    v_add_f32 v77, v77, v83
    v_lshlrev_b32 v78, 16, v81
    v_and_b32 v79, 0xffff0000, v81
    v_lshlrev_b32 v82, 16, v73
    v_and_b32 v83, 0xffff0000, v73
    v_add_f32 v78, v78, v82
    v_add_f32 v79, v79, v83
    v_cvt_pk_bf16_f32 v80, v76, v77
    v_cvt_pk_bf16_f32 v81, v78, v79
    v_add_u32 v6, 226492480, v5
    buffer_store_dwordx2 v[80:81], v6, s[8:11], 0 offen
    v_add_u32 v6, 96, v5
    buffer_load_dwordx2 v[72:73], v6, s[44:47], 0 offen
    v_accvgpr_read_b32 v76, a12
    v_accvgpr_read_b32 v77, a13
    v_accvgpr_read_b32 v78, a14
    v_accvgpr_read_b32 v79, a15
    v_cvt_pk_bf16_f32 v80, v76, v77
    v_cvt_pk_bf16_f32 v81, v78, v79
    s_waitcnt vmcnt(0)
    v_lshlrev_b32 v76, 16, v80
    v_and_b32 v77, 0xffff0000, v80
    v_lshlrev_b32 v82, 16, v72
    v_and_b32 v83, 0xffff0000, v72
    v_add_f32 v76, v76, v82
    v_add_f32 v77, v77, v83
    v_lshlrev_b32 v78, 16, v81
    v_and_b32 v79, 0xffff0000, v81
    v_lshlrev_b32 v82, 16, v73
    v_and_b32 v83, 0xffff0000, v73
    v_add_f32 v78, v78, v82
    v_add_f32 v79, v79, v83
    v_cvt_pk_bf16_f32 v80, v76, v77
    v_cvt_pk_bf16_f32 v81, v78, v79
    v_add_u32 v6, 226492512, v5
    buffer_store_dwordx2 v[80:81], v6, s[8:11], 0 offen
    v_add_u32 v6, 128, v5
    buffer_load_dwordx2 v[72:73], v6, s[44:47], 0 offen
    v_accvgpr_read_b32 v76, a16
    v_accvgpr_read_b32 v77, a17
    v_accvgpr_read_b32 v78, a18
    v_accvgpr_read_b32 v79, a19
    v_cvt_pk_bf16_f32 v80, v76, v77
    v_cvt_pk_bf16_f32 v81, v78, v79
    s_waitcnt vmcnt(0)
    v_lshlrev_b32 v76, 16, v80
    v_and_b32 v77, 0xffff0000, v80
    v_lshlrev_b32 v82, 16, v72
    v_and_b32 v83, 0xffff0000, v72
    v_add_f32 v76, v76, v82
    v_add_f32 v77, v77, v83
    v_lshlrev_b32 v78, 16, v81
    v_and_b32 v79, 0xffff0000, v81
    v_lshlrev_b32 v82, 16, v73
    v_and_b32 v83, 0xffff0000, v73
    v_add_f32 v78, v78, v82
    v_add_f32 v79, v79, v83
    v_cvt_pk_bf16_f32 v80, v76, v77
    v_cvt_pk_bf16_f32 v81, v78, v79
    v_add_u32 v6, 226492544, v5
    buffer_store_dwordx2 v[80:81], v6, s[8:11], 0 offen
    v_add_u32 v6, 20480, v5
    buffer_load_dwordx2 v[72:73], v6, s[44:47], 0 offen
    v_accvgpr_read_b32 v76, a20
    v_accvgpr_read_b32 v77, a21
    v_accvgpr_read_b32 v78, a22
    v_accvgpr_read_b32 v79, a23
    v_cvt_pk_bf16_f32 v80, v76, v77
    v_cvt_pk_bf16_f32 v81, v78, v79
    s_waitcnt vmcnt(0)
    v_lshlrev_b32 v76, 16, v80
    v_and_b32 v77, 0xffff0000, v80
    v_lshlrev_b32 v82, 16, v72
    v_and_b32 v83, 0xffff0000, v72
    v_add_f32 v76, v76, v82
    v_add_f32 v77, v77, v83
    v_lshlrev_b32 v78, 16, v81
    v_and_b32 v79, 0xffff0000, v81
    v_lshlrev_b32 v82, 16, v73
    v_and_b32 v83, 0xffff0000, v73
    v_add_f32 v78, v78, v82
    v_add_f32 v79, v79, v83
    v_cvt_pk_bf16_f32 v80, v76, v77
    v_cvt_pk_bf16_f32 v81, v78, v79
    v_add_u32 v6, 226512896, v5
    buffer_store_dwordx2 v[80:81], v6, s[8:11], 0 offen
    v_add_u32 v6, 20512, v5
    buffer_load_dwordx2 v[72:73], v6, s[44:47], 0 offen
    v_accvgpr_read_b32 v76, a24
    v_accvgpr_read_b32 v77, a25
    v_accvgpr_read_b32 v78, a26
    v_accvgpr_read_b32 v79, a27
    v_cvt_pk_bf16_f32 v80, v76, v77
    v_cvt_pk_bf16_f32 v81, v78, v79
    s_waitcnt vmcnt(0)
    v_lshlrev_b32 v76, 16, v80
    v_and_b32 v77, 0xffff0000, v80
    v_lshlrev_b32 v82, 16, v72
    v_and_b32 v83, 0xffff0000, v72
    v_add_f32 v76, v76, v82
    v_add_f32 v77, v77, v83
    v_lshlrev_b32 v78, 16, v81
    v_and_b32 v79, 0xffff0000, v81
    v_lshlrev_b32 v82, 16, v73
    v_and_b32 v83, 0xffff0000, v73
    v_add_f32 v78, v78, v82
    v_add_f32 v79, v79, v83
    v_cvt_pk_bf16_f32 v80, v76, v77
    v_cvt_pk_bf16_f32 v81, v78, v79
    v_add_u32 v6, 226512928, v5
    buffer_store_dwordx2 v[80:81], v6, s[8:11], 0 offen
    v_add_u32 v6, 20544, v5
    buffer_load_dwordx2 v[72:73], v6, s[44:47], 0 offen
    v_accvgpr_read_b32 v76, a28
    v_accvgpr_read_b32 v77, a29
    v_accvgpr_read_b32 v78, a30
    v_accvgpr_read_b32 v79, a31
    v_cvt_pk_bf16_f32 v80, v76, v77
    v_cvt_pk_bf16_f32 v81, v78, v79
    s_waitcnt vmcnt(0)
    v_lshlrev_b32 v76, 16, v80
    v_and_b32 v77, 0xffff0000, v80
    v_lshlrev_b32 v82, 16, v72
    v_and_b32 v83, 0xffff0000, v72
    v_add_f32 v76, v76, v82
    v_add_f32 v77, v77, v83
    v_lshlrev_b32 v78, 16, v81
    v_and_b32 v79, 0xffff0000, v81
    v_lshlrev_b32 v82, 16, v73
    v_and_b32 v83, 0xffff0000, v73
    v_add_f32 v78, v78, v82
    v_add_f32 v79, v79, v83
    v_cvt_pk_bf16_f32 v80, v76, v77
    v_cvt_pk_bf16_f32 v81, v78, v79
    v_add_u32 v6, 226512960, v5
    buffer_store_dwordx2 v[80:81], v6, s[8:11], 0 offen
    v_add_u32 v6, 20576, v5
    buffer_load_dwordx2 v[72:73], v6, s[44:47], 0 offen
    v_accvgpr_read_b32 v76, a32
    v_accvgpr_read_b32 v77, a33
    v_accvgpr_read_b32 v78, a34
    v_accvgpr_read_b32 v79, a35
    v_cvt_pk_bf16_f32 v80, v76, v77
    v_cvt_pk_bf16_f32 v81, v78, v79
    s_waitcnt vmcnt(0)
    v_lshlrev_b32 v76, 16, v80
    v_and_b32 v77, 0xffff0000, v80
    v_lshlrev_b32 v82, 16, v72
    v_and_b32 v83, 0xffff0000, v72
    v_add_f32 v76, v76, v82
    v_add_f32 v77, v77, v83
    v_lshlrev_b32 v78, 16, v81
    v_and_b32 v79, 0xffff0000, v81
    v_lshlrev_b32 v82, 16, v73
    v_and_b32 v83, 0xffff0000, v73
    v_add_f32 v78, v78, v82
    v_add_f32 v79, v79, v83
    v_cvt_pk_bf16_f32 v80, v76, v77
    v_cvt_pk_bf16_f32 v81, v78, v79
    v_add_u32 v6, 226512992, v5
    buffer_store_dwordx2 v[80:81], v6, s[8:11], 0 offen
    v_add_u32 v6, 20608, v5
    buffer_load_dwordx2 v[72:73], v6, s[44:47], 0 offen
    v_accvgpr_read_b32 v76, a36
    v_accvgpr_read_b32 v77, a37
    v_accvgpr_read_b32 v78, a38
    v_accvgpr_read_b32 v79, a39
    v_cvt_pk_bf16_f32 v80, v76, v77
    v_cvt_pk_bf16_f32 v81, v78, v79
    s_waitcnt vmcnt(0)
    v_lshlrev_b32 v76, 16, v80
    v_and_b32 v77, 0xffff0000, v80
    v_lshlrev_b32 v82, 16, v72
    v_and_b32 v83, 0xffff0000, v72
    v_add_f32 v76, v76, v82
    v_add_f32 v77, v77, v83
    v_lshlrev_b32 v78, 16, v81
    v_and_b32 v79, 0xffff0000, v81
    v_lshlrev_b32 v82, 16, v73
    v_and_b32 v83, 0xffff0000, v73
    v_add_f32 v78, v78, v82
    v_add_f32 v79, v79, v83
    v_cvt_pk_bf16_f32 v80, v76, v77
    v_cvt_pk_bf16_f32 v81, v78, v79
    v_add_u32 v6, 226513024, v5
    buffer_store_dwordx2 v[80:81], v6, s[8:11], 0 offen
wo_a1_kernel_end:
    s_endpgm
.section .rodata,"a"
.p2align 6
.amdhsa_kernel wo_a1_kernel
  .amdhsa_next_free_vgpr 136
  .amdhsa_next_free_sgpr 64
  .amdhsa_accum_offset 96
  .amdhsa_group_segment_fixed_size 0
  .amdhsa_kernarg_size 104
  .amdhsa_user_sgpr_count 2
  .amdhsa_user_sgpr_kernarg_segment_ptr 1
  .amdhsa_system_sgpr_workgroup_id_x 1
.end_amdhsa_kernel
.text
.globl ln_b1_kernel
.p2align 8
.type ln_b1_kernel,@function
ln_b1_kernel:
    s_cmp_gt_u32 s2, 512
    s_cbranch_scc1 ln_b1_kernel_end
    s_load_dwordx2 s[4:5], s[0:1], 96
    s_load_dwordx2 s[6:7], s[0:1], 32
    v_lshrrev_b32 v1, 6, v0
    v_and_b32 v0, 63, v0
    s_nop 0
    v_readfirstlane_b32 s13, v1
    s_waitcnt lgkmcnt(0)
    s_mov_b32 s8, s4
    s_mov_b32 s9, s5
    s_mov_b32 s10, 268435456
    s_mov_b32 s11, 0x00020000
    s_cmp_eq_u32 s2, 512
    s_cbranch_scc1 ln_b1_kernel_mem0
    s_lshl_b32 s20, s2, 2
    s_add_u32 s20, s20, s13
    s_mul_i32 s21, s20, 1280
    s_add_u32 s21, s21, 226492416
    v_lshlrev_b32 v3, 2, v0
    buffer_load_dword v4, v3, s[8:11], s21 offen offset:0
    buffer_load_dword v5, v3, s[8:11], s21 offen offset:256
    buffer_load_dword v6, v3, s[8:11], s21 offen offset:512
    buffer_load_dword v7, v3, s[8:11], s21 offen offset:768
    buffer_load_dword v8, v3, s[8:11], s21 offen offset:1024
    v_lshrrev_b32 v20, 4, v0
    v_lshlrev_b32 v20, 2, v20
    v_bfe_u32 v21, v0, 3, 1
    v_lshl_add_u32 v20, v21, 1, v20
    v_bfe_u32 v21, v0, 1, 1
    v_add_u32 v20, v20, v21
    v_lshlrev_b32 v20, 9, v20
    v_and_b32 v21, 1, v0
    v_lshl_add_u32 v20, v21, 3, v20
    v_bfe_u32 v21, v0, 2, 1
    v_lshl_add_u32 v23, v21, 2, v20
    s_lshr_b32 s22, s20, 5
    s_mul_i32 s22, s22, 40960
    s_and_b32 s23, s20, 31
    s_lshl_b32 s23, s23, 4
    s_add_u32 s22, s22, s23
    s_add_u32 s22, s22, 220200960
    s_waitcnt vmcnt(0)
    v_lshlrev_b32 v10, 16, v4
    v_and_b32 v11, 0xffff0000, v4
    v_lshlrev_b32 v12, 16, v5
    v_and_b32 v13, 0xffff0000, v5
    v_lshlrev_b32 v14, 16, v6
    v_and_b32 v15, 0xffff0000, v6
    v_lshlrev_b32 v16, 16, v7
    v_and_b32 v17, 0xffff0000, v7
    v_lshlrev_b32 v18, 16, v8
    v_and_b32 v19, 0xffff0000, v8
    v_add_f32 v20, v10, v11
    v_add_f32 v20, v20, v12
    v_add_f32 v20, v20, v13
    v_add_f32 v20, v20, v14
    v_add_f32 v20, v20, v15
    v_add_f32 v20, v20, v16
    v_add_f32 v20, v20, v17
    v_add_f32 v20, v20, v18
    v_add_f32 v20, v20, v19
    s_nop 1
    v_add_f32 v21, v20, v20 quad_perm:[1,0,3,2] row_mask:0xf bank_mask:0xf
    s_nop 1
    v_add_f32 v21, v21, v21 quad_perm:[2,3,0,1] row_mask:0xf bank_mask:0xf
    s_nop 1
    v_add_f32 v21, v21, v21 row_half_mirror row_mask:0xf bank_mask:0xf
    s_nop 1
    v_add_f32 v21, v21, v21 row_mirror row_mask:0xf bank_mask:0xf
    s_nop 1
    v_readlane_b32 s24, v21, 0
    v_readlane_b32 s25, v21, 16
    v_readlane_b32 s26, v21, 32
    v_readlane_b32 s27, v21, 48
    s_nop 1
    v_mov_b32 v20, s24
    v_add_f32 v20, s25, v20
    v_add_f32 v20, s26, v20
    v_add_f32 v20, s27, v20
    v_mul_f32 v20, 0x3acccccd, v20
    v_sub_f32 v10, v10, v20
    v_sub_f32 v11, v11, v20
    v_sub_f32 v12, v12, v20
    v_sub_f32 v13, v13, v20
    v_sub_f32 v14, v14, v20
    v_sub_f32 v15, v15, v20
    v_sub_f32 v16, v16, v20
    v_sub_f32 v17, v17, v20
    v_sub_f32 v18, v18, v20
    v_sub_f32 v19, v19, v20
    v_mul_f32 v21, v10, v10
    v_fmac_f32 v21, v11, v11
    v_fmac_f32 v21, v12, v12
    v_fmac_f32 v21, v13, v13
    v_fmac_f32 v21, v14, v14
    v_fmac_f32 v21, v15, v15
    v_fmac_f32 v21, v16, v16
    v_fmac_f32 v21, v17, v17
    v_fmac_f32 v21, v18, v18
    v_fmac_f32 v21, v19, v19
    s_nop 1
    v_add_f32 v22, v21, v21 quad_perm:[1,0,3,2] row_mask:0xf bank_mask:0xf
    s_nop 1
    v_add_f32 v22, v22, v22 quad_perm:[2,3,0,1] row_mask:0xf bank_mask:0xf
    s_nop 1
    v_add_f32 v22, v22, v22 row_half_mirror row_mask:0xf bank_mask:0xf
    s_nop 1
    v_add_f32 v22, v22, v22 row_mirror row_mask:0xf bank_mask:0xf
    s_nop 1
    v_readlane_b32 s24, v22, 0
    v_readlane_b32 s25, v22, 16
    v_readlane_b32 s26, v22, 32
    v_readlane_b32 s27, v22, 48
    s_nop 1
    v_mov_b32 v21, s24
    v_add_f32 v21, s25, v21
    v_add_f32 v21, s26, v21
    v_add_f32 v21, s27, v21
    v_mov_b32 v22, 0x3727c5ac
    v_fmac_f32 v22, 0x3acccccd, v21
    v_rsq_f32 v22, v22
    s_nop 0
    v_mul_f32 v10, v10, v22
    v_mul_f32 v11, v11, v22
    v_mul_f32 v12, v12, v22
    v_mul_f32 v13, v13, v22
    v_mul_f32 v14, v14, v22
    v_mul_f32 v15, v15, v22
    v_mul_f32 v16, v16, v22
    v_mul_f32 v17, v17, v22
    v_mul_f32 v18, v18, v22
    v_mul_f32 v19, v19, v22
    v_cvt_pk_bf16_f32 v4, v10, v11
    v_cvt_pk_bf16_f32 v5, v12, v13
    v_cvt_pk_bf16_f32 v6, v14, v15
    v_cvt_pk_bf16_f32 v7, v16, v17
    v_cvt_pk_bf16_f32 v8, v18, v19
    s_add_u32 s23, s22, 0
    buffer_store_dword v4, v23, s[8:11], s23 offen
    s_add_u32 s23, s22, 8192
    buffer_store_dword v5, v23, s[8:11], s23 offen
    s_add_u32 s23, s22, 16384
    buffer_store_dword v6, v23, s[8:11], s23 offen
    s_add_u32 s23, s22, 24576
    buffer_store_dword v7, v23, s[8:11], s23 offen
    s_add_u32 s23, s22, 32768
    buffer_store_dword v8, v23, s[8:11], s23 offen
    s_branch ln_b1_kernel_end
ln_b1_kernel_mem0:
    s_mov_b32 s16, s6
    s_mov_b32 s17, s7
    s_mov_b32 s18, 10240
    s_mov_b32 s19, 0x00020000
    s_sub_u32 s22, 0, s4
    s_and_b32 s22, s22, 0x1fffff
    s_mov_b32 s23, 10551296
    s_buffer_load_dword s24, s[8:11], s23
    s_waitcnt lgkmcnt(0)
    s_and_b32 s24, s24, 8192
    s_add_u32 s22, s22, 0
    s_xor_b32 s25, s24, 8192
    s_add_u32 s26, s22, s25
    s_add_u32 s22, s22, s24
    s_lshl_b32 s25, s13, 6
    v_add_u32 v1, s25, v0
    v_add_u32 v2, 0, v1
    v_and_b32 v3, 7, v2
    v_mul_u32_u24 v3, 1280, v3
    v_lshrrev_b32 v4, 3, v2
    v_lshl_add_u32 v3, v4, 4, v3
    v_lshlrev_b32 v5, 4, v2
    v_add_u32 v5, 20480, v5
    v_lshrrev_b32 v6, 13, v5
    v_lshlrev_b32 v6, 14, v6
    v_and_b32 v5, 8191, v5
    v_add_u32 v5, v5, v6
    v_cmp_gt_u32 vcc, 640, v2
    s_and_saveexec_b64 s[30:31], vcc
    s_cbranch_execz ln_b1_kernel_m0s0
    buffer_load_dwordx4 v[8:11], v3, s[16:19], 0 offen
    s_waitcnt vmcnt(0)
    buffer_store_dwordx4 v[8:11], v5, s[8:11], s22 offen
    buffer_store_dwordx4 v[8:11], v5, s[8:11], s26 offen
ln_b1_kernel_m0s0:
    s_mov_b64 exec, s[30:31]
    v_add_u32 v2, 256, v1
    v_and_b32 v3, 7, v2
    v_mul_u32_u24 v3, 1280, v3
    v_lshrrev_b32 v4, 3, v2
    v_lshl_add_u32 v3, v4, 4, v3
    v_lshlrev_b32 v5, 4, v2
    v_add_u32 v5, 20480, v5
    v_lshrrev_b32 v6, 13, v5
    v_lshlrev_b32 v6, 14, v6
    v_and_b32 v5, 8191, v5
    v_add_u32 v5, v5, v6
    v_cmp_gt_u32 vcc, 640, v2
    s_and_saveexec_b64 s[30:31], vcc
    s_cbranch_execz ln_b1_kernel_m0s1
    buffer_load_dwordx4 v[8:11], v3, s[16:19], 0 offen
    s_waitcnt vmcnt(0)
    buffer_store_dwordx4 v[8:11], v5, s[8:11], s22 offen
    buffer_store_dwordx4 v[8:11], v5, s[8:11], s26 offen
ln_b1_kernel_m0s1:
    s_mov_b64 exec, s[30:31]
    v_add_u32 v2, 512, v1
    v_and_b32 v3, 7, v2
    v_mul_u32_u24 v3, 1280, v3
    v_lshrrev_b32 v4, 3, v2
    v_lshl_add_u32 v3, v4, 4, v3
    v_lshlrev_b32 v5, 4, v2
    v_add_u32 v5, 20480, v5
    v_lshrrev_b32 v6, 13, v5
    v_lshlrev_b32 v6, 14, v6
    v_and_b32 v5, 8191, v5
    v_add_u32 v5, v5, v6
    v_cmp_gt_u32 vcc, 640, v2
    s_and_saveexec_b64 s[30:31], vcc
    s_cbranch_execz ln_b1_kernel_m0s2
    buffer_load_dwordx4 v[8:11], v3, s[16:19], 0 offen
    s_waitcnt vmcnt(0)
    buffer_store_dwordx4 v[8:11], v5, s[8:11], s22 offen
    buffer_store_dwordx4 v[8:11], v5, s[8:11], s26 offen
ln_b1_kernel_m0s2:
    s_mov_b64 exec, s[30:31]
ln_b1_kernel_end:
    s_endpgm
.section .rodata,"a"
.p2align 6
.amdhsa_kernel ln_b1_kernel
  .amdhsa_next_free_vgpr 32
  .amdhsa_next_free_sgpr 48
  .amdhsa_accum_offset 32
  .amdhsa_group_segment_fixed_size 0
  .amdhsa_kernarg_size 104
  .amdhsa_user_sgpr_count 2
  .amdhsa_user_sgpr_kernarg_segment_ptr 1
  .amdhsa_system_sgpr_workgroup_id_x 1
.end_amdhsa_kernel
.text
.globl layerb2_kernel
.p2align 8
.type layerb2_kernel,@function
layerb2_kernel:
    s_mov_b32 s49, 1
    s_branch layerb1_kernel_body
    s_endpgm
.section .rodata,"a"
.p2align 6
.amdhsa_kernel layerb2_kernel
  .amdhsa_next_free_vgpr 512
  .amdhsa_next_free_sgpr 100
  .amdhsa_accum_offset 256
  .amdhsa_group_segment_fixed_size 0
  .amdhsa_kernarg_size 104
  .amdhsa_user_sgpr_count 2
  .amdhsa_user_sgpr_kernarg_segment_ptr 1
  .amdhsa_system_sgpr_workgroup_id_x 1
.end_amdhsa_kernel
.text
.globl layerb1_kernel
.p2align 8
.type layerb1_kernel,@function
layerb1_kernel:
    s_mov_b32 s49, 0
layerb1_kernel_body:
    s_cmp_ge_u32 s2, 256
    s_cbranch_scc1 layerb1_kernel_end0
    s_load_dwordx2 s[4:5], s[0:1], 96
    s_load_dwordx2 s[6:7], s[0:1], 80
    v_lshrrev_b32 v1, 6, v0
    v_and_b32 v0, 63, v0
    s_nop 0
    v_readfirstlane_b32 s13, v1
    s_mov_b32 s15, 400000
    s_waitcnt lgkmcnt(0)
    s_mov_b32 s8, s4
    s_mov_b32 s9, s5
    s_mov_b32 s10, 268435456
    s_mov_b32 s11, 0x00020000
    s_add_u32 s22, s4, 247463936
    s_addc_u32 s23, s5, 0
    s_cmp_eq_u32 s49, 0
    s_cselect_b32 s84, s22, s6
    s_cselect_b32 s85, s23, s7
    s_mov_b32 s86, 2621440
    s_mov_b32 s87, 0x00020000
    s_mul_i32 s48, s49, 32768
    s_add_u32 s48, s48, 10616832
    s_lshl_b32 s19, s49, 11
    s_add_u32 s19, s19, 10485760
    s_getreg_b32 s20, hwreg(HW_REG_XCC_ID)
    s_and_b32 s20, s20, 7
    s_cmp_lg_u32 s13, 0
    s_cbranch_scc1 layerb1_kernel_tk_wait
    s_lshl_b32 s22, s20, 8
    s_add_u32 s22, s22, s19
    s_mov_b64 exec, 1
    v_mov_b32 v2, 0
    v_mov_b32 v3, 1
    buffer_atomic_add v3, v2, s[8:11], s22 offen sc0 sc1
    s_waitcnt vmcnt(0)
    s_mov_b64 exec, -1
    s_nop 0
    v_readfirstlane_b32 s21, v3
    s_cmp_lt_u32 s21, 32
    s_cbranch_scc1 layerb1_kernel_tk_pub
    v_lshlrev_b32 v2, 8, v0
    v_and_b32 v2, 0x7ff, v2
    s_mov_b32 s22, s19
layerb1_kernel_tk_poll:
    buffer_load_dword v3, v2, s[8:11], s22 offen sc1
    s_waitcnt vmcnt(0)
    s_mov_b32 s23, 0
    v_readlane_b32 s24, v3, 0
    s_nop 0
    s_add_u32 s23, s23, s24
    v_readlane_b32 s25, v3, 1
    s_nop 0
    s_add_u32 s23, s23, s25
    v_readlane_b32 s26, v3, 2
    s_nop 0
    s_add_u32 s23, s23, s26
    v_readlane_b32 s27, v3, 3
    s_nop 0
    s_add_u32 s23, s23, s27
    v_readlane_b32 s28, v3, 4
    s_nop 0
    s_add_u32 s23, s23, s28
    v_readlane_b32 s29, v3, 5
    s_nop 0
    s_add_u32 s23, s23, s29
    v_readlane_b32 s30, v3, 6
    s_nop 0
    s_add_u32 s23, s23, s30
    v_readlane_b32 s31, v3, 7
    s_nop 0
    s_add_u32 s23, s23, s31
    s_sub_u32 s15, s15, 1
    s_cbranch_scc1 layerb1_kernel_bail
    s_cmp_lt_u32 s23, 256
    s_cbranch_scc1 layerb1_kernel_tk_poll
    s_sub_u32 s21, s21, 32
    s_max_u32 s23, s24, 32
    s_sub_u32 s23, s23, 32
    s_cmp_gt_u32 s20, 0
    s_cselect_b32 s23, s23, 0
    s_add_u32 s21, s21, s23
    s_max_u32 s23, s25, 32
    s_sub_u32 s23, s23, 32
    s_cmp_gt_u32 s20, 1
    s_cselect_b32 s23, s23, 0
    s_add_u32 s21, s21, s23
    s_max_u32 s23, s26, 32
    s_sub_u32 s23, s23, 32
    s_cmp_gt_u32 s20, 2
    s_cselect_b32 s23, s23, 0
    s_add_u32 s21, s21, s23
    s_max_u32 s23, s27, 32
    s_sub_u32 s23, s23, 32
    s_cmp_gt_u32 s20, 3
    s_cselect_b32 s23, s23, 0
    s_add_u32 s21, s21, s23
    s_max_u32 s23, s28, 32
    s_sub_u32 s23, s23, 32
    s_cmp_gt_u32 s20, 4
    s_cselect_b32 s23, s23, 0
    s_add_u32 s21, s21, s23
    s_max_u32 s23, s29, 32
    s_sub_u32 s23, s23, 32
    s_cmp_gt_u32 s20, 5
    s_cselect_b32 s23, s23, 0
    s_add_u32 s21, s21, s23
    s_max_u32 s23, s30, 32
    s_sub_u32 s23, s23, 32
    s_cmp_gt_u32 s20, 6
    s_cselect_b32 s23, s23, 0
    s_add_u32 s21, s21, s23
    s_min_u32 s23, s24, 32
    s_sub_u32 s22, 32, s23
    s_cmp_lt_u32 s21, s22
    s_cbranch_scc0 layerb1_kernel_tk_n0
    s_mov_b32 s20, 0
    s_add_u32 s21, s21, s23
    s_branch layerb1_kernel_tk_pub
layerb1_kernel_tk_n0:
    s_sub_u32 s21, s21, s22
    s_min_u32 s23, s25, 32
    s_sub_u32 s22, 32, s23
    s_cmp_lt_u32 s21, s22
    s_cbranch_scc0 layerb1_kernel_tk_n1
    s_mov_b32 s20, 1
    s_add_u32 s21, s21, s23
    s_branch layerb1_kernel_tk_pub
layerb1_kernel_tk_n1:
    s_sub_u32 s21, s21, s22
    s_min_u32 s23, s26, 32
    s_sub_u32 s22, 32, s23
    s_cmp_lt_u32 s21, s22
    s_cbranch_scc0 layerb1_kernel_tk_n2
    s_mov_b32 s20, 2
    s_add_u32 s21, s21, s23
    s_branch layerb1_kernel_tk_pub
layerb1_kernel_tk_n2:
    s_sub_u32 s21, s21, s22
    s_min_u32 s23, s27, 32
    s_sub_u32 s22, 32, s23
    s_cmp_lt_u32 s21, s22
    s_cbranch_scc0 layerb1_kernel_tk_n3
    s_mov_b32 s20, 3
    s_add_u32 s21, s21, s23
    s_branch layerb1_kernel_tk_pub
layerb1_kernel_tk_n3:
    s_sub_u32 s21, s21, s22
    s_min_u32 s23, s28, 32
    s_sub_u32 s22, 32, s23
    s_cmp_lt_u32 s21, s22
    s_cbranch_scc0 layerb1_kernel_tk_n4
    s_mov_b32 s20, 4
    s_add_u32 s21, s21, s23
    s_branch layerb1_kernel_tk_pub
layerb1_kernel_tk_n4:
    s_sub_u32 s21, s21, s22
    s_min_u32 s23, s29, 32
    s_sub_u32 s22, 32, s23
    s_cmp_lt_u32 s21, s22
    s_cbranch_scc0 layerb1_kernel_tk_n5
    s_mov_b32 s20, 5
    s_add_u32 s21, s21, s23
    s_branch layerb1_kernel_tk_pub
layerb1_kernel_tk_n5:
    s_sub_u32 s21, s21, s22
    s_min_u32 s23, s30, 32
    s_sub_u32 s22, 32, s23
    s_cmp_lt_u32 s21, s22
    s_cbranch_scc0 layerb1_kernel_tk_n6
    s_mov_b32 s20, 6
    s_add_u32 s21, s21, s23
    s_branch layerb1_kernel_tk_pub
layerb1_kernel_tk_n6:
    s_sub_u32 s21, s21, s22
    s_min_u32 s23, s31, 32
    s_sub_u32 s22, 32, s23
    s_cmp_lt_u32 s21, s22
    s_cbranch_scc0 layerb1_kernel_tk_n7
    s_mov_b32 s20, 7
    s_add_u32 s21, s21, s23
    s_branch layerb1_kernel_tk_pub
layerb1_kernel_tk_n7:
    s_sub_u32 s21, s21, s22
    s_branch layerb1_kernel_bail
layerb1_kernel_tk_pub:
    s_lshl_b32 s22, s20, 8
    s_or_b32 s22, s22, s21
    v_mov_b32 v2, 0
    v_mov_b32 v3, s22
    ds_write_b32 v2, v3
    s_waitcnt lgkmcnt(0)
layerb1_kernel_tk_wait:
    s_barrier
    v_mov_b32 v2, 0
    ds_read_b32 v3, v2
    s_waitcnt lgkmcnt(0)
    v_readfirstlane_b32 s22, v3
    s_barrier
    s_lshr_b32 s20, s22, 8
    s_and_b32 s21, s22, 255
    s_sub_u32 s22, 0, s4
    s_and_b32 s22, s22, 0x1fffff
    s_lshl_b32 s23, s49, 3
    s_add_u32 s23, s23, 10551296
    s_buffer_load_dwordx2 s[24:25], s[8:11], s23
    s_waitcnt lgkmcnt(0)
    s_and_b32 s24, s24, 8192
    s_and_b32 s25, s25, 8192
    s_lshl_b32 s82, s24, 1
    s_sub_u32 s82, 8192, s82
    s_lshl_b32 s83, s25, 1
    s_sub_u32 s83, 8192, s83
    s_mul_i32 s23, s49, 4194304
    s_add_u32 s22, s22, s23
    s_add_u32 s16, s22, s24
    s_add_u32 s17, s22, s25
    s_add_u32 s17, s17, 2097152
    s_mov_b32 s40, 0x01010101
    s_mov_b32 s41, 0x01010101
    s_mov_b32 s42, 0x00010001
    s_mov_b32 s43, 0
    v_lshlrev_b32 v1, 4, v0
    v_and_b32 v16, 8, v0
    v_cmp_eq_u32 vcc, 0, v16
    v_mov_b32 v17, 0xeeeeeeee
    v_mov_b32 v18, 0x44444444
    v_cndmask_b32 v2, v17, v18, vcc
    s_cmp_eq_u32 s20, 0
    s_cbranch_scc0 layerb1_kernel_notp
    s_mov_b32 s12, s21
    s_cmp_eq_u32 s13, 0
    s_cbranch_scc1 layerb1_kernel_p0_start
    s_cmp_eq_u32 s13, 1
    s_cbranch_scc1 layerb1_kernel_p1_start
    s_cmp_eq_u32 s13, 2
    s_cbranch_scc1 layerb1_kernel_p2_start
    s_cmp_eq_u32 s13, 3
    s_cbranch_scc1 layerb1_kernel_p3_start
layerb1_kernel_notp:
    s_cmp_ge_u32 s20, 4
    s_cbranch_scc1 layerb1_kernel_proj
    s_cmp_ge_u32 s21, 27
    s_cbranch_scc1 layerb1_kernel_w3
    s_sub_u32 s22, s20, 1
    s_mul_i32 s22, s22, 27
    s_add_u32 s12, s22, s21
    s_cmp_ge_u32 s12, 80
    s_cbranch_scc1 layerb1_kernel_w3
    s_cmp_eq_u32 s13, 0
    s_cbranch_scc1 layerb1_kernel_y0_start
    s_cmp_eq_u32 s13, 1
    s_cbranch_scc1 layerb1_kernel_y1_start
    s_cmp_eq_u32 s13, 2
    s_cbranch_scc1 layerb1_kernel_y2_start
    s_cmp_eq_u32 s13, 3
    s_cbranch_scc1 layerb1_kernel_y3_start
    s_branch layerb1_kernel_end
layerb1_kernel_p0_start:
    v_lshrrev_b32 v16, 4, v0
    v_and_b32 v17, 15, v0
    v_and_b32 v18, 1, v16
    v_lshlrev_b32 v18, 2, v18
    v_lshrrev_b32 v19, 1, v16
    v_lshl_add_u32 v18, v19, 1, v18
    v_mul_u32_u24 v18, 400, v18
    v_lshl_add_u32 v18, v17, 1, v18
    v_add_u32 v3, 133120, v18
    v_and_b32 v18, 7, v0
    v_mul_u32_u24 v18, 400, v18
    v_lshrrev_b32 v19, 3, v0
    v_lshl_add_u32 v18, v19, 4, v18
    v_add_u32 v4, 133120, v18
    v_and_b32 v18, 7, v0
    v_mul_u32_u24 v18, 400, v18
    v_lshl_add_u32 v18, v16, 5, v18
    v_add_u32 v5, 136320, v18
    v_lshrrev_b32 v18, 1, v16
    v_lshlrev_b32 v18, 10, v18
    v_and_b32 v19, 31, v0
    v_lshl_add_u32 v18, v19, 4, v18
    v_add_u32 v6, 139520, v18
    v_add_u32 v15, 139520, v1
    v_lshrrev_b32 v18, 1, v16
    v_lshlrev_b32 v18, 1, v18
    v_lshrrev_b32 v19, 3, v17
    v_add3_u32 v18, v18, v19, 1
    v_lshrrev_b32 v19, 1, v18
    v_lshlrev_b32 v19, 14, v19
    v_and_b32 v18, 1, v18
    v_lshl_add_u32 v18, v18, 12, v19
    v_and_b32 v19, 1, v16
    v_lshlrev_b32 v19, 4, v19
    v_add_u32 v19, 0, v19
    s_lshl_b32 s20, s12, 7
    v_add_u32 v8, s20, v19
    v_add_u32 v7, v8, v18
    v_lshlrev_b32 v18, 4, v17
    v_lshl_add_u32 v18, v16, 10, v18
    v_add_u32 v9, 0, v18
    v_add_u32 v18, 0, v0
    v_mul_u32_u24 v19, 2731, v18
    v_lshrrev_b32 v19, 16, v19
    v_mul_u32_u24 v20, 24, v19
    v_sub_u32 v20, v18, v20
    v_mul_u32_u24 v21, 400, v19
    v_lshl_add_u32 v21, v20, 4, v21
    v_add_u32 v10, 136320, v21
    v_lshlrev_b32 v21, 4, v19
    v_lshl_add_u32 v11, v20, 7, v21
    v_and_b32 v18, 0x28, v0
    v_cmp_eq_u32 vcc, 0, v18
    v_mov_b32 v18, 1.0
    v_mov_b32 v19, 0
    v_cndmask_b32 v12, v19, v18, vcc
    v_add_u32 v13, 0, v1
    v_add_u32 v14, 122880, v1
    s_mul_i32 s44, s12, 12288
    s_add_u32 s44, s44, 53477376
    s_mul_i32 s45, s12, 3072
    s_add_u32 s45, s45, 208666624
    s_mul_i32 s20, s12, 6
    s_add_u32 s21, s20, 5
    s_lshr_b32 s20, s20, 3
    s_lshr_b32 s21, s21, 3
    s_add_u32 s20, s20, 80
    s_add_u32 s21, s21, 80
    s_lshl_b32 s20, s20, 7
    s_lshl_b32 s21, s21, 7
    v_mov_b32 v255, s21
    v_mov_b32 v253, s20
    v_cmp_eq_u32 vcc, 0, v0
    s_nop 1
    v_cndmask_b32 v255, v255, v253, vcc
    s_mov_b32 s47, 0
    s_mul_i32 s20, s12, 491520
    s_add_u32 s20, s20, 11534336
    s_add_u32 s21, s20, 6144
    buffer_load_dwordx4 v[16:19], v1, s[8:11], s21 offen offset:0
    buffer_load_dwordx4 v[20:23], v1, s[8:11], s21 offen offset:1024
    s_add_u32 s21, s20, 47104
    buffer_load_dwordx4 v[24:27], v1, s[8:11], s21 offen offset:0
    buffer_load_dwordx4 v[28:31], v1, s[8:11], s21 offen offset:1024
    s_add_u32 s21, s20, 28672
    buffer_load_dwordx4 v[32:35], v1, s[8:11], s21 offen offset:0
    buffer_load_dwordx4 v[36:39], v1, s[8:11], s21 offen offset:1024
    s_add_u32 s21, s20, 10240
    buffer_load_dwordx4 v[40:43], v1, s[8:11], s21 offen offset:0
    buffer_load_dwordx4 v[44:47], v1, s[8:11], s21 offen offset:1024
    s_add_u32 s21, s20, 51200
    buffer_load_dwordx4 v[48:51], v1, s[8:11], s21 offen offset:0
    buffer_load_dwordx4 v[52:55], v1, s[8:11], s21 offen offset:1024
    s_add_u32 s21, s20, 32768
    buffer_load_dwordx4 v[56:59], v1, s[8:11], s21 offen offset:0
    buffer_load_dwordx4 v[60:63], v1, s[8:11], s21 offen offset:1024
    s_add_u32 s21, s20, 14336
    buffer_load_dwordx4 v[64:67], v1, s[8:11], s21 offen offset:0
    buffer_load_dwordx4 v[68:71], v1, s[8:11], s21 offen offset:1024
    s_add_u32 s21, s20, 55296
    buffer_load_dwordx4 v[72:75], v1, s[8:11], s21 offen offset:0
    buffer_load_dwordx4 v[76:79], v1, s[8:11], s21 offen offset:1024
    s_add_u32 s21, s20, 36864
    buffer_load_dwordx4 v[80:83], v1, s[8:11], s21 offen offset:0
    buffer_load_dwordx4 v[84:87], v1, s[8:11], s21 offen offset:1024
    s_add_u32 s21, s20, 18432
    buffer_load_dwordx4 v[88:91], v1, s[8:11], s21 offen offset:0
    buffer_load_dwordx4 v[92:95], v1, s[8:11], s21 offen offset:1024
    s_add_u32 s21, s20, 59392
    buffer_load_dwordx4 v[96:99], v1, s[8:11], s21 offen offset:0
    buffer_load_dwordx4 v[100:103], v1, s[8:11], s21 offen offset:1024
    s_add_u32 s21, s20, 90112
    buffer_load_dwordx4 v[104:107], v1, s[8:11], s21 offen offset:0
    buffer_load_dwordx4 v[108:111], v1, s[8:11], s21 offen offset:1024
    s_add_u32 s21, s20, 98304
    buffer_load_dwordx4 v[112:115], v1, s[8:11], s21 offen offset:0
    buffer_load_dwordx4 v[116:119], v1, s[8:11], s21 offen offset:1024
    s_add_u32 s21, s20, 106496
    buffer_load_dwordx4 v[120:123], v1, s[8:11], s21 offen offset:0
    buffer_load_dwordx4 v[124:127], v1, s[8:11], s21 offen offset:1024
    s_add_u32 s21, s20, 114688
    buffer_load_dwordx4 v[128:131], v1, s[8:11], s21 offen offset:0
    buffer_load_dwordx4 v[132:135], v1, s[8:11], s21 offen offset:1024
    s_add_u32 s21, s20, 0
    buffer_load_dwordx4 a[0:3], v1, s[8:11], s21 offen offset:0
    buffer_load_dwordx4 a[4:7], v1, s[8:11], s21 offen offset:1024
    s_add_u32 s21, s20, 20480
    buffer_load_dwordx4 a[8:11], v1, s[8:11], s21 offen offset:0
    buffer_load_dwordx4 a[12:15], v1, s[8:11], s21 offen offset:1024
    s_add_u32 s21, s20, 40960
    buffer_load_dwordx4 a[16:19], v1, s[8:11], s21 offen offset:0
    buffer_load_dwordx4 a[20:23], v1, s[8:11], s21 offen offset:1024
    s_add_u32 s21, s20, 2048
    buffer_load_dwordx4 a[24:27], v1, s[8:11], s21 offen offset:0
    buffer_load_dwordx4 a[28:31], v1, s[8:11], s21 offen offset:1024
    s_add_u32 s21, s20, 22528
    buffer_load_dwordx4 a[32:35], v1, s[8:11], s21 offen offset:0
    buffer_load_dwordx4 a[36:39], v1, s[8:11], s21 offen offset:1024
    s_add_u32 s21, s20, 43008
    buffer_load_dwordx4 a[40:43], v1, s[8:11], s21 offen offset:0
    buffer_load_dwordx4 a[44:47], v1, s[8:11], s21 offen offset:1024
    s_add_u32 s21, s20, 4096
    buffer_load_dwordx4 a[48:51], v1, s[8:11], s21 offen offset:0
    buffer_load_dwordx4 a[52:55], v1, s[8:11], s21 offen offset:1024
    s_add_u32 s21, s20, 24576
    buffer_load_dwordx4 a[56:59], v1, s[8:11], s21 offen offset:0
    buffer_load_dwordx4 a[60:63], v1, s[8:11], s21 offen offset:1024
    s_add_u32 s21, s20, 45056
    buffer_load_dwordx4 a[64:67], v1, s[8:11], s21 offen offset:0
    buffer_load_dwordx4 a[68:71], v1, s[8:11], s21 offen offset:1024
    s_add_u32 s21, s20, 26624
    buffer_load_dwordx4 a[72:75], v1, s[8:11], s21 offen offset:0
    buffer_load_dwordx4 a[76:79], v1, s[8:11], s21 offen offset:1024
    s_add_u32 s21, s20, 8192
    buffer_load_dwordx4 a[80:83], v1, s[8:11], s21 offen offset:0
    buffer_load_dwordx4 a[84:87], v1, s[8:11], s21 offen offset:1024
    s_add_u32 s21, s20, 49152
    buffer_load_dwordx4 a[88:91], v1, s[8:11], s21 offen offset:0
    buffer_load_dwordx4 a[92:95], v1, s[8:11], s21 offen offset:1024
    s_add_u32 s21, s20, 30720
    buffer_load_dwordx4 a[96:99], v1, s[8:11], s21 offen offset:0
    buffer_load_dwordx4 a[100:103], v1, s[8:11], s21 offen offset:1024
    s_add_u32 s21, s20, 12288
    buffer_load_dwordx4 a[104:107], v1, s[8:11], s21 offen offset:0
    buffer_load_dwordx4 a[108:111], v1, s[8:11], s21 offen offset:1024
    s_add_u32 s21, s20, 53248
    buffer_load_dwordx4 a[112:115], v1, s[8:11], s21 offen offset:0
    buffer_load_dwordx4 a[116:119], v1, s[8:11], s21 offen offset:1024
    s_add_u32 s21, s20, 34816
    buffer_load_dwordx4 a[120:123], v1, s[8:11], s21 offen offset:0
    buffer_load_dwordx4 a[124:127], v1, s[8:11], s21 offen offset:1024
    s_waitcnt vmcnt(32)
    ds_write_b128 v13, v[16:19] offset:0
    ds_write_b128 v13, v[20:23] offset:1024
    ds_write_b128 v13, v[24:27] offset:2048
    ds_write_b128 v13, v[28:31] offset:3072
    ds_write_b128 v13, v[32:35] offset:4096
    ds_write_b128 v13, v[36:39] offset:5120
    ds_write_b128 v13, v[40:43] offset:6144
    ds_write_b128 v13, v[44:47] offset:7168
    ds_write_b128 v13, v[48:51] offset:8192
    ds_write_b128 v13, v[52:55] offset:9216
    ds_write_b128 v13, v[56:59] offset:10240
    ds_write_b128 v13, v[60:63] offset:11264
    ds_write_b128 v13, v[64:67] offset:12288
    ds_write_b128 v13, v[68:71] offset:13312
    ds_write_b128 v13, v[72:75] offset:14336
    ds_write_b128 v13, v[76:79] offset:15360
    ds_write_b128 v13, v[80:83] offset:16384
    ds_write_b128 v13, v[84:87] offset:17408
    ds_write_b128 v13, v[88:91] offset:18432
    ds_write_b128 v13, v[92:95] offset:19456
    ds_write_b128 v13, v[96:99] offset:20480
    ds_write_b128 v13, v[100:103] offset:21504
    ds_write_b128 v13, v[104:107] offset:22528
    ds_write_b128 v13, v[108:111] offset:23552
    ds_write_b128 v13, v[112:115] offset:24576
    ds_write_b128 v13, v[116:119] offset:25600
    ds_write_b128 v13, v[120:123] offset:26624
    ds_write_b128 v13, v[124:127] offset:27648
    ds_write_b128 v13, v[128:131] offset:28672
    ds_write_b128 v13, v[132:135] offset:29696
    s_add_u32 s21, s20, 16384
    buffer_load_dwordx4 a[128:131], v1, s[8:11], s21 offen offset:0
    buffer_load_dwordx4 a[132:135], v1, s[8:11], s21 offen offset:1024
    s_add_u32 s21, s20, 57344
    buffer_load_dwordx4 a[136:139], v1, s[8:11], s21 offen offset:0
    buffer_load_dwordx4 a[140:143], v1, s[8:11], s21 offen offset:1024
    s_add_u32 s21, s20, 38912
    buffer_load_dwordx4 a[144:147], v1, s[8:11], s21 offen offset:0
    buffer_load_dwordx4 a[148:151], v1, s[8:11], s21 offen offset:1024
    s_add_u32 s21, s20, 61440
    buffer_load_dwordx4 a[152:155], v1, s[8:11], s21 offen offset:0
    buffer_load_dwordx4 a[156:159], v1, s[8:11], s21 offen offset:1024
    s_add_u32 s21, s20, 63488
    buffer_load_dwordx4 a[160:163], v1, s[8:11], s21 offen offset:0
    buffer_load_dwordx4 a[164:167], v1, s[8:11], s21 offen offset:1024
    s_add_u32 s21, s20, 65536
    buffer_load_dwordx4 a[168:171], v1, s[8:11], s21 offen offset:0
    buffer_load_dwordx4 a[172:175], v1, s[8:11], s21 offen offset:1024
    s_add_u32 s21, s20, 67584
    buffer_load_dwordx4 a[176:179], v1, s[8:11], s21 offen offset:0
    buffer_load_dwordx4 a[180:183], v1, s[8:11], s21 offen offset:1024
    s_add_u32 s21, s20, 69632
    buffer_load_dwordx4 a[184:187], v1, s[8:11], s21 offen offset:0
    buffer_load_dwordx4 a[188:191], v1, s[8:11], s21 offen offset:1024
    s_add_u32 s21, s20, 71680
    buffer_load_dwordx4 a[192:195], v1, s[8:11], s21 offen offset:0
    buffer_load_dwordx4 a[196:199], v1, s[8:11], s21 offen offset:1024
    s_add_u32 s21, s20, 73728
    buffer_load_dwordx4 a[200:203], v1, s[8:11], s21 offen offset:0
    buffer_load_dwordx4 a[204:207], v1, s[8:11], s21 offen offset:1024
    s_add_u32 s21, s20, 75776
    buffer_load_dwordx4 a[208:211], v1, s[8:11], s21 offen offset:0
    buffer_load_dwordx4 a[212:215], v1, s[8:11], s21 offen offset:1024
    s_add_u32 s21, s20, 77824
    buffer_load_dwordx4 a[216:219], v1, s[8:11], s21 offen offset:0
    buffer_load_dwordx4 a[220:223], v1, s[8:11], s21 offen offset:1024
    s_add_u32 s21, s20, 79872
    buffer_load_dwordx4 a[224:227], v1, s[8:11], s21 offen offset:0
    buffer_load_dwordx4 a[228:231], v1, s[8:11], s21 offen offset:1024
    s_add_u32 s21, s20, 81920
    buffer_load_dwordx4 a[232:235], v1, s[8:11], s21 offen offset:0
    buffer_load_dwordx4 a[236:239], v1, s[8:11], s21 offen offset:1024
    s_add_u32 s21, s20, 83968
    buffer_load_dwordx4 a[240:243], v1, s[8:11], s21 offen offset:0
    buffer_load_dwordx4 a[244:247], v1, s[8:11], s21 offen offset:1024
    s_add_u32 s21, s20, 86016
    buffer_load_dwordx4 a[248:251], v1, s[8:11], s21 offen offset:0
    buffer_load_dwordx4 a[252:255], v1, s[8:11], s21 offen offset:1024
    s_add_u32 s21, s20, 88064
    buffer_load_dwordx4 v[148:151], v1, s[8:11], s21 offen offset:0
    buffer_load_dwordx4 v[152:155], v1, s[8:11], s21 offen offset:1024
    s_add_u32 s21, s20, 92160
    buffer_load_dwordx4 v[156:159], v1, s[8:11], s21 offen offset:0
    buffer_load_dwordx4 v[160:163], v1, s[8:11], s21 offen offset:1024
    s_add_u32 s21, s20, 94208
    buffer_load_dwordx4 v[164:167], v1, s[8:11], s21 offen offset:0
    buffer_load_dwordx4 v[168:171], v1, s[8:11], s21 offen offset:1024
    s_add_u32 s21, s20, 96256
    buffer_load_dwordx4 v[172:175], v1, s[8:11], s21 offen offset:0
    buffer_load_dwordx4 v[176:179], v1, s[8:11], s21 offen offset:1024
    s_add_u32 s21, s20, 100352
    buffer_load_dwordx4 v[180:183], v1, s[8:11], s21 offen offset:0
    buffer_load_dwordx4 v[184:187], v1, s[8:11], s21 offen offset:1024
    s_add_u32 s21, s20, 102400
    buffer_load_dwordx4 v[188:191], v1, s[8:11], s21 offen offset:0
    buffer_load_dwordx4 v[192:195], v1, s[8:11], s21 offen offset:1024
    s_add_u32 s21, s20, 104448
    buffer_load_dwordx4 v[196:199], v1, s[8:11], s21 offen offset:0
    buffer_load_dwordx4 v[200:203], v1, s[8:11], s21 offen offset:1024
    s_add_u32 s21, s20, 108544
    buffer_load_dwordx4 v[204:207], v1, s[8:11], s21 offen offset:0
    buffer_load_dwordx4 v[208:211], v1, s[8:11], s21 offen offset:1024
    s_add_u32 s21, s20, 110592
    buffer_load_dwordx4 v[212:215], v1, s[8:11], s21 offen offset:0
    buffer_load_dwordx4 v[216:219], v1, s[8:11], s21 offen offset:1024
    s_add_u32 s21, s20, 112640
    buffer_load_dwordx4 v[220:223], v1, s[8:11], s21 offen offset:0
    buffer_load_dwordx4 v[224:227], v1, s[8:11], s21 offen offset:1024
    s_add_u32 s21, s20, 116736
    buffer_load_dwordx4 v[228:231], v1, s[8:11], s21 offen offset:0
    buffer_load_dwordx4 v[232:235], v1, s[8:11], s21 offen offset:1024
    s_add_u32 s21, s20, 118784
    buffer_load_dwordx4 v[236:239], v1, s[8:11], s21 offen offset:0
    buffer_load_dwordx4 v[240:243], v1, s[8:11], s21 offen offset:1024
    s_add_u32 s21, s20, 120832
    buffer_load_dwordx4 v[244:247], v1, s[8:11], s21 offen offset:0
    buffer_load_dwordx4 v[248:251], v1, s[8:11], s21 offen offset:1024
    s_waitcnt lgkmcnt(0)
    s_mov_b32 s14, 0
    s_cmp_gt_u32 s47, s14
    s_cbranch_scc1 layerb1_kernel_p0_gw1_ok
layerb1_kernel_p0_gw1_lp:
    buffer_load_dword v253, v255, s[8:11], s48 offen sc1
    s_waitcnt vmcnt(0)
    v_readlane_b32 s47, v253, 0
    v_readlane_b32 s29, v253, 1
    s_nop 0
    s_min_u32 s47, s47, s29
    s_sub_u32 s15, s15, 1
    s_cbranch_scc1 layerb1_kernel_bail
    s_cmp_gt_u32 s47, s14
    s_cbranch_scc0 layerb1_kernel_p0_gw1_lp
layerb1_kernel_p0_gw1_ok:
    s_mul_i32 s20, s14, 393216
    s_add_u32 s20, s20, s44
    s_add_u32 s21, s20, 0
    buffer_load_dwordx4 v[100:103], v9, s[8:11], s21 offen offset:0 sc1
    buffer_load_dwordx4 v[104:107], v9, s[8:11], s21 offen offset:512 sc1
    s_add_u32 s21, s20, 4096
    buffer_load_dwordx4 v[108:111], v9, s[8:11], s21 offen offset:0 sc1
    buffer_load_dwordx4 v[112:115], v9, s[8:11], s21 offen offset:512 sc1
    v_mov_b32 v56, 0
    v_mov_b32 v57, 0
    v_mov_b32 v58, 0
    v_mov_b32 v59, 0
    v_mov_b32 v60, 0
    v_mov_b32 v61, 0
    v_mov_b32 v62, 0
    v_mov_b32 v63, 0
    v_mov_b32 v64, 0
    v_mov_b32 v65, 0
    v_mov_b32 v66, 0
    v_mov_b32 v67, 0
    v_mov_b32 v68, 0
    v_mov_b32 v69, 0
    v_mov_b32 v70, 0
    v_mov_b32 v71, 0
    v_mov_b32 v72, 0
    v_mov_b32 v73, 0
    v_mov_b32 v74, 0
    v_mov_b32 v75, 0
    v_mov_b32 v76, 0
    v_mov_b32 v77, 0
    v_mov_b32 v78, 0
    v_mov_b32 v79, 0
    v_mov_b32 v80, 0
    v_mov_b32 v81, 0
    v_mov_b32 v82, 0
    v_mov_b32 v83, 0
    v_mov_b32 v84, 0
    v_mov_b32 v85, 0
    v_mov_b32 v86, 0
    v_mov_b32 v87, 0
    ds_read_b128 v[116:119], v13 offset:0
    ds_read_b128 v[120:123], v13 offset:1024
    ds_read_b128 v[124:127], v13 offset:2048
    ds_read_b128 v[128:131], v13 offset:3072
    ds_read_b128 v[132:135], v13 offset:4096
    ds_read_b128 v[136:139], v13 offset:5120
    ds_read_b128 v[140:143], v13 offset:6144
    ds_read_b128 v[144:147], v13 offset:7168
    s_waitcnt lgkmcnt(0)
layerb1_kernel_p0_step:
    s_cmp_lt_u32 s14, 32
    s_cselect_b32 s18, s16, s17
    s_and_b32 s20, s14, 31
    s_lshl_b32 s20, s20, 16
    s_add_u32 s18, s18, s20
    s_add_u32 s22, s18, 36864
    s_add_u32 s23, s18, 37888
    s_add_u32 s24, s18, 38912
layerb1_kernel_p0_poll:
    buffer_load_dwordx4 v[16:19], v1, s[8:11], s22 offen sc1
    buffer_load_dwordx4 v[20:23], v1, s[8:11], s23 offen sc1
    buffer_load_dwordx4 v[24:27], v1, s[8:11], s24 offen sc1
    s_waitcnt vmcnt(0)
    ds_write_b128 v14, v[16:19] offset:0
    ds_write_b128 v14, v[20:23] offset:1024
    ds_write_b128 v14, v[24:27] offset:2048
    v_max3_u32 v88, v16, v17, v18
    v_max3_u32 v88, v88, v19, v20
    v_max3_u32 v88, v88, v21, v22
    v_max3_u32 v88, v88, v23, v24
    v_max3_u32 v88, v88, v25, v26
    v_max_u32 v88, v88, v27
    v_cmp_eq_u32 vcc, -1, v88
    s_sub_u32 s15, s15, 1
    s_cbranch_scc1 layerb1_kernel_bail
    s_cbranch_vccnz layerb1_kernel_p0_poll
    s_waitcnt lgkmcnt(0)
    s_barrier
    ds_read_b128 v[28:31], v14 offset:3072
    ds_read_b128 v[32:35], v14 offset:4096
    ds_read_b128 v[36:39], v14 offset:5120
    ds_read_b128 v[40:43], v14 offset:6144
    ds_read_b128 v[44:47], v14 offset:7168
    ds_read_b128 v[48:51], v14 offset:8192
    ds_read_b128 v[52:55], v14 offset:9216
    v_smfmac_f32_16x16x64_bf16 v[56:59], v[16:19], a[0:7], v2
    v_smfmac_f32_16x16x64_bf16 v[60:63], v[16:19], a[8:15], v2
    v_smfmac_f32_16x16x64_bf16 v[64:67], v[16:19], a[16:23], v2
    v_smfmac_f32_16x16x64_bf16 v[56:59], v[20:23], a[24:31], v2
    v_smfmac_f32_16x16x64_bf16 v[60:63], v[20:23], a[32:39], v2
    v_smfmac_f32_16x16x64_bf16 v[64:67], v[20:23], a[40:47], v2
    v_smfmac_f32_16x16x64_bf16 v[56:59], v[24:27], a[48:55], v2
    v_smfmac_f32_16x16x64_bf16 v[60:63], v[24:27], a[56:63], v2
    v_smfmac_f32_16x16x64_bf16 v[64:67], v[24:27], a[64:71], v2
    s_waitcnt lgkmcnt(6)
    v_smfmac_f32_16x16x64_bf16 v[56:59], v[28:31], v[116:123], v2
    ds_read_b128 v[116:119], v13 offset:8192
    ds_read_b128 v[120:123], v13 offset:9216
    v_smfmac_f32_16x16x64_bf16 v[60:63], v[28:31], a[72:79], v2
    v_smfmac_f32_16x16x64_bf16 v[64:67], v[28:31], v[124:131], v2
    ds_read_b128 v[124:127], v13 offset:10240
    ds_read_b128 v[128:131], v13 offset:11264
    s_waitcnt lgkmcnt(9)
    v_smfmac_f32_16x16x64_bf16 v[56:59], v[32:35], a[80:87], v2
    v_smfmac_f32_16x16x64_bf16 v[60:63], v[32:35], v[132:139], v2
    ds_read_b128 v[132:135], v13 offset:12288
    ds_read_b128 v[136:139], v13 offset:13312
    v_smfmac_f32_16x16x64_bf16 v[64:67], v[32:35], a[88:95], v2
    s_waitcnt lgkmcnt(10)
    v_smfmac_f32_16x16x64_bf16 v[56:59], v[36:39], v[140:147], v2
    ds_read_b128 v[140:143], v13 offset:14336
    ds_read_b128 v[144:147], v13 offset:15360
    v_smfmac_f32_16x16x64_bf16 v[60:63], v[36:39], a[96:103], v2
    s_waitcnt lgkmcnt(6)
    v_smfmac_f32_16x16x64_bf16 v[64:67], v[36:39], v[116:123], v2
    ds_read_b128 v[116:119], v13 offset:16384
    ds_read_b128 v[120:123], v13 offset:17408
    v_smfmac_f32_16x16x64_bf16 v[56:59], v[40:43], a[104:111], v2
    s_waitcnt lgkmcnt(6)
    v_smfmac_f32_16x16x64_bf16 v[60:63], v[40:43], v[124:131], v2
    ds_read_b128 v[124:127], v13 offset:18432
    ds_read_b128 v[128:131], v13 offset:19456
    v_smfmac_f32_16x16x64_bf16 v[64:67], v[40:43], a[112:119], v2
    s_waitcnt lgkmcnt(6)
    v_smfmac_f32_16x16x64_bf16 v[56:59], v[44:47], v[132:139], v2
    ds_read_b128 v[132:135], v13 offset:20480
    ds_read_b128 v[136:139], v13 offset:21504
    v_smfmac_f32_16x16x64_bf16 v[60:63], v[44:47], a[120:127], v2
    s_waitcnt lgkmcnt(6)
    v_smfmac_f32_16x16x64_bf16 v[64:67], v[44:47], v[140:147], v2
    ds_read_b128 v[140:143], v13 offset:22528
    ds_read_b128 v[144:147], v13 offset:23552
    v_smfmac_f32_16x16x64_bf16 v[56:59], v[48:51], a[128:135], v2
    s_waitcnt lgkmcnt(6)
    v_smfmac_f32_16x16x64_bf16 v[60:63], v[48:51], v[116:123], v2
    ds_read_b128 v[116:119], v13 offset:24576
    ds_read_b128 v[120:123], v13 offset:25600
    v_smfmac_f32_16x16x64_bf16 v[64:67], v[48:51], a[136:143], v2
    s_waitcnt lgkmcnt(6)
    v_smfmac_f32_16x16x64_bf16 v[56:59], v[52:55], v[124:131], v2
    ds_read_b128 v[124:127], v13 offset:26624
    ds_read_b128 v[128:131], v13 offset:27648
    v_smfmac_f32_16x16x64_bf16 v[60:63], v[52:55], a[144:151], v2
    s_waitcnt lgkmcnt(6)
    v_smfmac_f32_16x16x64_bf16 v[64:67], v[52:55], v[132:139], v2
    ds_read_b128 v[132:135], v13 offset:28672
    ds_read_b128 v[136:139], v13 offset:29696
    v_smfmac_f32_16x16x64_bf16 v[68:71], v[16:19], a[152:159], v2
    v_smfmac_f32_16x16x64_bf16 v[68:71], v[20:23], a[160:167], v2
    v_permlane32_swap_b32 v56, v58
    v_permlane32_swap_b32 v57, v59
    v_smfmac_f32_16x16x64_bf16 v[68:71], v[24:27], a[168:175], v2
    v_add_f32 v56, v56, v58
    v_add_f32 v57, v57, v59
    v_smfmac_f32_16x16x64_bf16 v[68:71], v[28:31], a[176:183], v2
    v_cvt_pk_bf16_f32 v56, v56, v57
    ds_write_b16 v3, v56 offset:0
    v_smfmac_f32_16x16x64_bf16 v[68:71], v[32:35], a[184:191], v2
    ds_write_b16_d16_hi v3, v56 offset:400
    v_permlane32_swap_b32 v60, v62
    v_smfmac_f32_16x16x64_bf16 v[68:71], v[36:39], a[192:199], v2
    v_permlane32_swap_b32 v61, v63
    v_add_f32 v60, v60, v62
    v_smfmac_f32_16x16x64_bf16 v[68:71], v[40:43], a[200:207], v2
    v_add_f32 v61, v61, v63
    v_cvt_pk_bf16_f32 v60, v60, v61
    v_smfmac_f32_16x16x64_bf16 v[68:71], v[44:47], a[208:215], v2
    ds_write_b16 v3, v60 offset:32
    ds_write_b16_d16_hi v3, v60 offset:432
    v_smfmac_f32_16x16x64_bf16 v[68:71], v[48:51], a[216:223], v2
    v_permlane32_swap_b32 v64, v66
    v_permlane32_swap_b32 v65, v67
    v_smfmac_f32_16x16x64_bf16 v[68:71], v[52:55], a[224:231], v2
    v_add_f32 v64, v64, v66
    v_add_f32 v65, v65, v67
    v_smfmac_f32_16x16x64_bf16 v[72:75], v[16:19], a[232:239], v2
    v_cvt_pk_bf16_f32 v64, v64, v65
    ds_write_b16 v3, v64 offset:64
    v_smfmac_f32_16x16x64_bf16 v[72:75], v[20:23], a[240:247], v2
    ds_write_b16_d16_hi v3, v64 offset:464
    v_smfmac_f32_16x16x64_bf16 v[72:75], v[24:27], a[248:255], v2
    v_smfmac_f32_16x16x64_bf16 v[72:75], v[28:31], v[148:155], v2
    s_waitcnt lgkmcnt(0)
    s_barrier
    ds_read_b128 v[88:91], v4 offset:0
    v_smfmac_f32_16x16x64_bf16 v[72:75], v[32:35], v[140:147], v2
    ds_read_b128 v[92:95], v4 offset:128
    ds_read_b128 v[96:99], v4 offset:256
    v_smfmac_f32_16x16x64_bf16 v[72:75], v[36:39], v[156:163], v2
    v_permlane32_swap_b32 v68, v70
    v_permlane32_swap_b32 v69, v71
    v_smfmac_f32_16x16x64_bf16 v[72:75], v[40:43], v[164:171], v2
    v_add_f32 v68, v68, v70
    v_add_f32 v69, v69, v71
    v_smfmac_f32_16x16x64_bf16 v[72:75], v[44:47], v[172:179], v2
    v_cvt_pk_bf16_f32 v68, v68, v69
    ds_write_b16 v3, v68 offset:3200
    v_smfmac_f32_16x16x64_bf16 v[72:75], v[48:51], v[116:123], v2
    ds_write_b16_d16_hi v3, v68 offset:3600
    v_smfmac_f32_16x16x64_bf16 v[72:75], v[52:55], v[180:187], v2
    s_waitcnt lgkmcnt(2)
    v_smfmac_f32_16x16x64_bf16 v[80:83], v[88:91], v[100:107], v2
    v_smfmac_f32_16x16x64_bf16 v[80:83], v[92:95], v[108:115], v2
    v_smfmac_f32_16x16x64_bf16 v[76:79], v[16:19], v[188:195], v2
    v_smfmac_f32_16x16x64_bf16 v[76:79], v[20:23], v[196:203], v2
    v_smfmac_f32_16x16x64_bf16 v[76:79], v[24:27], v[124:131], v2
    v_permlane32_swap_b32 v72, v74
    v_permlane32_swap_b32 v73, v75
    v_smfmac_f32_16x16x64_bf16 v[76:79], v[28:31], v[204:211], v2
    v_add_f32 v72, v72, v74
    v_add_f32 v73, v73, v75
    ds_write_b128 v15, v[80:83]
    v_smfmac_f32_16x16x64_bf16 v[76:79], v[32:35], v[212:219], v2
    v_cvt_pk_bf16_f32 v72, v72, v73
    ds_write_b16 v3, v72 offset:3232
    v_smfmac_f32_16x16x64_bf16 v[76:79], v[36:39], v[220:227], v2
    ds_write_b16_d16_hi v3, v72 offset:3632
    v_smfmac_f32_16x16x64_bf16 v[76:79], v[40:43], v[132:139], v2
    v_smfmac_f32_16x16x64_bf16 v[76:79], v[44:47], v[228:235], v2
    v_smfmac_f32_16x16x64_bf16 v[76:79], v[48:51], v[236:243], v2
    v_smfmac_f32_16x16x64_bf16 v[76:79], v[52:55], v[244:251], v2
    s_nop 7
    v_permlane32_swap_b32 v76, v78
    v_permlane32_swap_b32 v77, v79
    v_add_f32 v76, v76, v78
    v_add_f32 v77, v77, v79
    v_cvt_pk_bf16_f32 v76, v76, v77
    ds_write_b16 v3, v76 offset:3264
    ds_write_b16_d16_hi v3, v76 offset:3664
    s_waitcnt lgkmcnt(0)
    s_barrier
    ds_read2st64_b32 v[40:41], v6 offset0:0 offset1:2
    ds_read2st64_b32 v[42:43], v6 offset0:8 offset1:10
    ds_read_b128 v[16:19], v5 offset:0
    ds_read_b128 v[20:23], v5 offset:16
    ds_read_b128 v[24:27], v5 offset:128
    ds_read_b128 v[28:31], v5 offset:144
    ds_read_b128 v[32:35], v5 offset:256
    ds_read_b128 v[36:39], v5 offset:272
    s_waitcnt lgkmcnt(6)
    v_add_f32 v40, v40, v41
    v_add_f32 v42, v42, v43
    v_add_f32 v44, v40, v42
    v_mul_f32 v44, 0x3dd53b95, v44
    s_waitcnt lgkmcnt(4)
    v_smfmac_f32_16x16x64_bf16 v[84:87], v[88:91], v[16:23], v2
    s_waitcnt lgkmcnt(2)
    v_smfmac_f32_16x16x64_bf16 v[84:87], v[92:95], v[24:31], v2
    s_waitcnt lgkmcnt(0)
    v_smfmac_f32_16x16x64_bf16 v[84:87], v[96:99], v[32:39], v2
    v_max_f32_dpp v45, v44, v44 row_ror:8 row_mask:0xf bank_mask:0xf
    s_nop 1
    v_max_f32_dpp v45, v45, v45 row_ror:4 row_mask:0xf bank_mask:0xf
    s_nop 1
    v_max_f32_dpp v45, v45, v45 row_ror:2 row_mask:0xf bank_mask:0xf
    s_nop 1
    v_max_f32_dpp v45, v45, v45 row_ror:1 row_mask:0xf bank_mask:0xf
    v_mov_b32 v47, v45
    s_nop 1
    v_permlane32_swap_b32 v45, v47
    v_max_f32 v45, v45, v47
    v_mov_b32 v47, v84
    s_nop 1
    v_permlane32_swap_b32 v84, v47
    v_add_f32 v48, v84, v47
    v_mul_f32 v48, 0x3dd53b95, v48
    s_nop 1
    v_max_f32_dpp v46, v48, v48 row_ror:4 row_mask:0xf bank_mask:0xf
    s_nop 1
    v_max_f32_dpp v46, v46, v46 row_ror:2 row_mask:0xf bank_mask:0xf
    s_nop 1
    v_max_f32_dpp v46, v46, v46 row_ror:1 row_mask:0xf bank_mask:0xf
    v_max_f32 v45, v45, v46
    v_sub_f32 v49, v44, v45
    v_sub_f32 v50, v48, v45
    v_exp_f32 v49, v49
    v_exp_f32 v50, v50
    s_nop 0
    v_fma_f32 v51, v50, v12, v49
    s_nop 1
    v_add_f32_dpp v51, v51, v51 row_ror:8 row_mask:0xf bank_mask:0xf
    s_nop 1
    v_add_f32_dpp v51, v51, v51 row_ror:4 row_mask:0xf bank_mask:0xf
    s_nop 1
    v_add_f32_dpp v51, v51, v51 row_ror:2 row_mask:0xf bank_mask:0xf
    s_nop 1
    v_add_f32_dpp v51, v51, v51 row_ror:1 row_mask:0xf bank_mask:0xf
    v_mov_b32 v47, v51
    s_nop 1
    v_permlane32_swap_b32 v51, v47
    v_add_f32 v51, v51, v47
    v_rcp_f32 v51, v51
    s_nop 0
    v_mul_f32 v49, v49, v51
    v_mul_f32 v50, v50, v51
    s_nop 0
    v_mov_b32_dpp v46, v49 quad_perm:[1,0,3,2] row_mask:0xf bank_mask:0xf
    v_mov_b32_dpp v47, v50 quad_perm:[1,0,3,2] row_mask:0xf bank_mask:0xf
    v_cvt_pk_bf16_f32 v16, v49, v46
    v_cvt_pk_bf16_f32 v20, v50, v47
    s_nop 0
    v_mov_b32_dpp v17, v16 row_shl:2 row_mask:0xf bank_mask:0xf
    v_mov_b32_dpp v18, v16 row_shl:4 row_mask:0xf bank_mask:0xf
    v_mov_b32_dpp v19, v16 row_shl:6 row_mask:0xf bank_mask:0xf
    v_mov_b32_dpp v21, v20 row_shl:2 row_mask:0xf bank_mask:0xf
    v_mov_b32_dpp v22, v20 row_shl:4 row_mask:0xf bank_mask:0xf
    v_mov_b32_dpp v23, v20 row_shl:6 row_mask:0xf bank_mask:0xf
    s_mov_b64 exec, s[40:41]
    buffer_store_dwordx4 v[16:19], v7, s[8:11], s18 offen sc1
    s_mov_b64 exec, s[42:43]
    buffer_store_dwordx4 v[20:23], v8, s[8:11], s18 offen sc1
    s_mov_b64 exec, -1
    ds_read_b128 v[40:43], v10
    s_add_u32 s28, s14, 1
    s_min_u32 s28, s28, 63
    s_cmp_gt_u32 s47, s28
    s_cbranch_scc1 layerb1_kernel_p0_gw2_ok
layerb1_kernel_p0_gw2_lp:
    buffer_load_dword v253, v255, s[8:11], s48 offen sc1
    s_waitcnt vmcnt(0)
    v_readlane_b32 s47, v253, 0
    v_readlane_b32 s29, v253, 1
    s_nop 0
    s_min_u32 s47, s47, s29
    s_sub_u32 s15, s15, 1
    s_cbranch_scc1 layerb1_kernel_bail
    s_cmp_gt_u32 s47, s28
    s_cbranch_scc0 layerb1_kernel_p0_gw2_lp
layerb1_kernel_p0_gw2_ok:
    s_mul_i32 s20, s28, 393216
    s_add_u32 s20, s20, s44
    s_add_u32 s21, s20, 0
    buffer_load_dwordx4 v[100:103], v9, s[8:11], s21 offen offset:0 sc1
    buffer_load_dwordx4 v[104:107], v9, s[8:11], s21 offen offset:512 sc1
    s_add_u32 s21, s20, 4096
    buffer_load_dwordx4 v[108:111], v9, s[8:11], s21 offen offset:0 sc1
    buffer_load_dwordx4 v[112:115], v9, s[8:11], s21 offen offset:512 sc1
    v_mov_b32 v56, 0
    v_mov_b32 v57, 0
    v_mov_b32 v58, 0
    v_mov_b32 v59, 0
    v_mov_b32 v60, 0
    v_mov_b32 v61, 0
    v_mov_b32 v62, 0
    v_mov_b32 v63, 0
    v_mov_b32 v64, 0
    v_mov_b32 v65, 0
    v_mov_b32 v66, 0
    v_mov_b32 v67, 0
    v_mov_b32 v68, 0
    v_mov_b32 v69, 0
    v_mov_b32 v70, 0
    v_mov_b32 v71, 0
    v_mov_b32 v72, 0
    v_mov_b32 v73, 0
    v_mov_b32 v74, 0
    v_mov_b32 v75, 0
    v_mov_b32 v76, 0
    v_mov_b32 v77, 0
    v_mov_b32 v78, 0
    v_mov_b32 v79, 0
    v_mov_b32 v80, 0
    v_mov_b32 v81, 0
    v_mov_b32 v82, 0
    v_mov_b32 v83, 0
    v_mov_b32 v84, 0
    v_mov_b32 v85, 0
    v_mov_b32 v86, 0
    v_mov_b32 v87, 0
    s_waitcnt lgkmcnt(0)
    s_mul_i32 s20, s14, 98304
    s_add_u32 s20, s20, s45
    buffer_store_dwordx4 v[40:43], v11, s[8:11], s20 offen sc1
    ds_read_b128 v[116:119], v13 offset:0
    ds_read_b128 v[120:123], v13 offset:1024
    ds_read_b128 v[124:127], v13 offset:2048
    ds_read_b128 v[128:131], v13 offset:3072
    ds_read_b128 v[132:135], v13 offset:4096
    ds_read_b128 v[136:139], v13 offset:5120
    ds_read_b128 v[140:143], v13 offset:6144
    ds_read_b128 v[144:147], v13 offset:7168
    s_waitcnt lgkmcnt(0)
    s_add_u32 s14, s14, 1
    s_cmp_lt_u32 s14, 64
    s_cbranch_scc1 layerb1_kernel_p0_step
    s_waitcnt vmcnt(0)
    s_barrier
    s_branch layerb1_kernel_end
layerb1_kernel_p1_start:
    v_lshrrev_b32 v16, 4, v0
    v_and_b32 v17, 15, v0
    v_and_b32 v18, 1, v16
    v_lshlrev_b32 v18, 2, v18
    v_lshrrev_b32 v19, 1, v16
    v_lshl_add_u32 v18, v19, 1, v18
    v_mul_u32_u24 v18, 400, v18
    v_lshl_add_u32 v18, v17, 1, v18
    v_add_u32 v3, 133216, v18
    v_and_b32 v18, 7, v0
    v_mul_u32_u24 v18, 400, v18
    v_lshrrev_b32 v19, 3, v0
    v_lshl_add_u32 v18, v19, 4, v18
    v_add_u32 v4, 133120, v18
    v_and_b32 v18, 7, v0
    v_mul_u32_u24 v18, 400, v18
    v_lshl_add_u32 v18, v16, 5, v18
    v_add_u32 v5, 136320, v18
    v_lshrrev_b32 v18, 1, v16
    v_lshlrev_b32 v18, 10, v18
    v_and_b32 v19, 31, v0
    v_lshl_add_u32 v18, v19, 4, v18
    v_add_u32 v6, 139524, v18
    v_add_u32 v15, 140544, v1
    v_lshrrev_b32 v18, 1, v16
    v_lshlrev_b32 v18, 1, v18
    v_lshrrev_b32 v19, 3, v17
    v_add3_u32 v18, v18, v19, 1
    v_lshrrev_b32 v19, 1, v18
    v_lshlrev_b32 v19, 14, v19
    v_and_b32 v18, 1, v18
    v_lshl_add_u32 v18, v18, 12, v19
    v_and_b32 v19, 1, v16
    v_lshlrev_b32 v19, 4, v19
    v_add_u32 v19, 32, v19
    s_lshl_b32 s20, s12, 7
    v_add_u32 v8, s20, v19
    v_add_u32 v7, v8, v18
    v_lshlrev_b32 v18, 4, v17
    v_lshl_add_u32 v18, v16, 10, v18
    v_add_u32 v9, 256, v18
    v_add_u32 v18, 64, v0
    v_mul_u32_u24 v19, 2731, v18
    v_lshrrev_b32 v19, 16, v19
    v_mul_u32_u24 v20, 24, v19
    v_sub_u32 v20, v18, v20
    v_mul_u32_u24 v21, 400, v19
    v_lshl_add_u32 v21, v20, 4, v21
    v_add_u32 v10, 136320, v21
    v_lshlrev_b32 v21, 4, v19
    v_lshl_add_u32 v11, v20, 7, v21
    v_and_b32 v18, 0x28, v0
    v_cmp_eq_u32 vcc, 0, v18
    v_mov_b32 v18, 1.0
    v_mov_b32 v19, 0
    v_cndmask_b32 v12, v19, v18, vcc
    v_add_u32 v13, 30720, v1
    v_add_u32 v14, 122880, v1
    s_mul_i32 s44, s12, 12288
    s_add_u32 s44, s44, 53477376
    s_mul_i32 s45, s12, 3072
    s_add_u32 s45, s45, 208666624
    s_mul_i32 s20, s12, 6
    s_add_u32 s21, s20, 5
    s_lshr_b32 s20, s20, 3
    s_lshr_b32 s21, s21, 3
    s_add_u32 s20, s20, 80
    s_add_u32 s21, s21, 80
    s_lshl_b32 s20, s20, 7
    s_lshl_b32 s21, s21, 7
    v_mov_b32 v255, s21
    v_mov_b32 v253, s20
    v_cmp_eq_u32 vcc, 0, v0
    s_nop 1
    v_cndmask_b32 v255, v255, v253, vcc
    s_mov_b32 s47, 0
    s_mul_i32 s20, s12, 491520
    s_add_u32 s20, s20, 11657216
    s_add_u32 s21, s20, 0
    buffer_load_dwordx4 v[16:19], v1, s[8:11], s21 offen offset:0
    buffer_load_dwordx4 v[20:23], v1, s[8:11], s21 offen offset:1024
    s_add_u32 s21, s20, 40960
    buffer_load_dwordx4 v[24:27], v1, s[8:11], s21 offen offset:0
    buffer_load_dwordx4 v[28:31], v1, s[8:11], s21 offen offset:1024
    s_add_u32 s21, s20, 22528
    buffer_load_dwordx4 v[32:35], v1, s[8:11], s21 offen offset:0
    buffer_load_dwordx4 v[36:39], v1, s[8:11], s21 offen offset:1024
    s_add_u32 s21, s20, 4096
    buffer_load_dwordx4 v[40:43], v1, s[8:11], s21 offen offset:0
    buffer_load_dwordx4 v[44:47], v1, s[8:11], s21 offen offset:1024
    s_add_u32 s21, s20, 45056
    buffer_load_dwordx4 v[48:51], v1, s[8:11], s21 offen offset:0
    buffer_load_dwordx4 v[52:55], v1, s[8:11], s21 offen offset:1024
    s_add_u32 s21, s20, 32768
    buffer_load_dwordx4 v[56:59], v1, s[8:11], s21 offen offset:0
    buffer_load_dwordx4 v[60:63], v1, s[8:11], s21 offen offset:1024
    s_add_u32 s21, s20, 14336
    buffer_load_dwordx4 v[64:67], v1, s[8:11], s21 offen offset:0
    buffer_load_dwordx4 v[68:71], v1, s[8:11], s21 offen offset:1024
    s_add_u32 s21, s20, 55296
    buffer_load_dwordx4 v[72:75], v1, s[8:11], s21 offen offset:0
    buffer_load_dwordx4 v[76:79], v1, s[8:11], s21 offen offset:1024
    s_add_u32 s21, s20, 36864
    buffer_load_dwordx4 v[80:83], v1, s[8:11], s21 offen offset:0
    buffer_load_dwordx4 v[84:87], v1, s[8:11], s21 offen offset:1024
    s_add_u32 s21, s20, 18432
    buffer_load_dwordx4 v[88:91], v1, s[8:11], s21 offen offset:0
    buffer_load_dwordx4 v[92:95], v1, s[8:11], s21 offen offset:1024
    s_add_u32 s21, s20, 59392
    buffer_load_dwordx4 v[96:99], v1, s[8:11], s21 offen offset:0
    buffer_load_dwordx4 v[100:103], v1, s[8:11], s21 offen offset:1024
    s_add_u32 s21, s20, 90112
    buffer_load_dwordx4 v[104:107], v1, s[8:11], s21 offen offset:0
    buffer_load_dwordx4 v[108:111], v1, s[8:11], s21 offen offset:1024
    s_add_u32 s21, s20, 98304
    buffer_load_dwordx4 v[112:115], v1, s[8:11], s21 offen offset:0
    buffer_load_dwordx4 v[116:119], v1, s[8:11], s21 offen offset:1024
    s_add_u32 s21, s20, 106496
    buffer_load_dwordx4 v[120:123], v1, s[8:11], s21 offen offset:0
    buffer_load_dwordx4 v[124:127], v1, s[8:11], s21 offen offset:1024
    s_add_u32 s21, s20, 114688
    buffer_load_dwordx4 v[128:131], v1, s[8:11], s21 offen offset:0
    buffer_load_dwordx4 v[132:135], v1, s[8:11], s21 offen offset:1024
    s_add_u32 s21, s20, 6144
    buffer_load_dwordx4 a[0:3], v1, s[8:11], s21 offen offset:0
    buffer_load_dwordx4 a[4:7], v1, s[8:11], s21 offen offset:1024
    s_add_u32 s21, s20, 26624
    buffer_load_dwordx4 a[8:11], v1, s[8:11], s21 offen offset:0
    buffer_load_dwordx4 a[12:15], v1, s[8:11], s21 offen offset:1024
    s_add_u32 s21, s20, 47104
    buffer_load_dwordx4 a[16:19], v1, s[8:11], s21 offen offset:0
    buffer_load_dwordx4 a[20:23], v1, s[8:11], s21 offen offset:1024
    s_add_u32 s21, s20, 8192
    buffer_load_dwordx4 a[24:27], v1, s[8:11], s21 offen offset:0
    buffer_load_dwordx4 a[28:31], v1, s[8:11], s21 offen offset:1024
    s_add_u32 s21, s20, 28672
    buffer_load_dwordx4 a[32:35], v1, s[8:11], s21 offen offset:0
    buffer_load_dwordx4 a[36:39], v1, s[8:11], s21 offen offset:1024
    s_add_u32 s21, s20, 49152
    buffer_load_dwordx4 a[40:43], v1, s[8:11], s21 offen offset:0
    buffer_load_dwordx4 a[44:47], v1, s[8:11], s21 offen offset:1024
    s_add_u32 s21, s20, 10240
    buffer_load_dwordx4 a[48:51], v1, s[8:11], s21 offen offset:0
    buffer_load_dwordx4 a[52:55], v1, s[8:11], s21 offen offset:1024
    s_add_u32 s21, s20, 30720
    buffer_load_dwordx4 a[56:59], v1, s[8:11], s21 offen offset:0
    buffer_load_dwordx4 a[60:63], v1, s[8:11], s21 offen offset:1024
    s_add_u32 s21, s20, 51200
    buffer_load_dwordx4 a[64:67], v1, s[8:11], s21 offen offset:0
    buffer_load_dwordx4 a[68:71], v1, s[8:11], s21 offen offset:1024
    s_add_u32 s21, s20, 20480
    buffer_load_dwordx4 a[72:75], v1, s[8:11], s21 offen offset:0
    buffer_load_dwordx4 a[76:79], v1, s[8:11], s21 offen offset:1024
    s_add_u32 s21, s20, 2048
    buffer_load_dwordx4 a[80:83], v1, s[8:11], s21 offen offset:0
    buffer_load_dwordx4 a[84:87], v1, s[8:11], s21 offen offset:1024
    s_add_u32 s21, s20, 43008
    buffer_load_dwordx4 a[88:91], v1, s[8:11], s21 offen offset:0
    buffer_load_dwordx4 a[92:95], v1, s[8:11], s21 offen offset:1024
    s_add_u32 s21, s20, 24576
    buffer_load_dwordx4 a[96:99], v1, s[8:11], s21 offen offset:0
    buffer_load_dwordx4 a[100:103], v1, s[8:11], s21 offen offset:1024
    s_add_u32 s21, s20, 12288
    buffer_load_dwordx4 a[104:107], v1, s[8:11], s21 offen offset:0
    buffer_load_dwordx4 a[108:111], v1, s[8:11], s21 offen offset:1024
    s_add_u32 s21, s20, 53248
    buffer_load_dwordx4 a[112:115], v1, s[8:11], s21 offen offset:0
    buffer_load_dwordx4 a[116:119], v1, s[8:11], s21 offen offset:1024
    s_add_u32 s21, s20, 34816
    buffer_load_dwordx4 a[120:123], v1, s[8:11], s21 offen offset:0
    buffer_load_dwordx4 a[124:127], v1, s[8:11], s21 offen offset:1024
    s_waitcnt vmcnt(32)
    ds_write_b128 v13, v[16:19] offset:0
    ds_write_b128 v13, v[20:23] offset:1024
    ds_write_b128 v13, v[24:27] offset:2048
    ds_write_b128 v13, v[28:31] offset:3072
    ds_write_b128 v13, v[32:35] offset:4096
    ds_write_b128 v13, v[36:39] offset:5120
    ds_write_b128 v13, v[40:43] offset:6144
    ds_write_b128 v13, v[44:47] offset:7168
    ds_write_b128 v13, v[48:51] offset:8192
    ds_write_b128 v13, v[52:55] offset:9216
    ds_write_b128 v13, v[56:59] offset:10240
    ds_write_b128 v13, v[60:63] offset:11264
    ds_write_b128 v13, v[64:67] offset:12288
    ds_write_b128 v13, v[68:71] offset:13312
    ds_write_b128 v13, v[72:75] offset:14336
    ds_write_b128 v13, v[76:79] offset:15360
    ds_write_b128 v13, v[80:83] offset:16384
    ds_write_b128 v13, v[84:87] offset:17408
    ds_write_b128 v13, v[88:91] offset:18432
    ds_write_b128 v13, v[92:95] offset:19456
    ds_write_b128 v13, v[96:99] offset:20480
    ds_write_b128 v13, v[100:103] offset:21504
    ds_write_b128 v13, v[104:107] offset:22528
    ds_write_b128 v13, v[108:111] offset:23552
    ds_write_b128 v13, v[112:115] offset:24576
    ds_write_b128 v13, v[116:119] offset:25600
    ds_write_b128 v13, v[120:123] offset:26624
    ds_write_b128 v13, v[124:127] offset:27648
    ds_write_b128 v13, v[128:131] offset:28672
    ds_write_b128 v13, v[132:135] offset:29696
    s_add_u32 s21, s20, 16384
    buffer_load_dwordx4 a[128:131], v1, s[8:11], s21 offen offset:0
    buffer_load_dwordx4 a[132:135], v1, s[8:11], s21 offen offset:1024
    s_add_u32 s21, s20, 57344
    buffer_load_dwordx4 a[136:139], v1, s[8:11], s21 offen offset:0
    buffer_load_dwordx4 a[140:143], v1, s[8:11], s21 offen offset:1024
    s_add_u32 s21, s20, 38912
    buffer_load_dwordx4 a[144:147], v1, s[8:11], s21 offen offset:0
    buffer_load_dwordx4 a[148:151], v1, s[8:11], s21 offen offset:1024
    s_add_u32 s21, s20, 61440
    buffer_load_dwordx4 a[152:155], v1, s[8:11], s21 offen offset:0
    buffer_load_dwordx4 a[156:159], v1, s[8:11], s21 offen offset:1024
    s_add_u32 s21, s20, 63488
    buffer_load_dwordx4 a[160:163], v1, s[8:11], s21 offen offset:0
    buffer_load_dwordx4 a[164:167], v1, s[8:11], s21 offen offset:1024
    s_add_u32 s21, s20, 65536
    buffer_load_dwordx4 a[168:171], v1, s[8:11], s21 offen offset:0
    buffer_load_dwordx4 a[172:175], v1, s[8:11], s21 offen offset:1024
    s_add_u32 s21, s20, 67584
    buffer_load_dwordx4 a[176:179], v1, s[8:11], s21 offen offset:0
    buffer_load_dwordx4 a[180:183], v1, s[8:11], s21 offen offset:1024
    s_add_u32 s21, s20, 69632
    buffer_load_dwordx4 a[184:187], v1, s[8:11], s21 offen offset:0
    buffer_load_dwordx4 a[188:191], v1, s[8:11], s21 offen offset:1024
    s_add_u32 s21, s20, 71680
    buffer_load_dwordx4 a[192:195], v1, s[8:11], s21 offen offset:0
    buffer_load_dwordx4 a[196:199], v1, s[8:11], s21 offen offset:1024
    s_add_u32 s21, s20, 73728
    buffer_load_dwordx4 a[200:203], v1, s[8:11], s21 offen offset:0
    buffer_load_dwordx4 a[204:207], v1, s[8:11], s21 offen offset:1024
    s_add_u32 s21, s20, 75776
    buffer_load_dwordx4 a[208:211], v1, s[8:11], s21 offen offset:0
    buffer_load_dwordx4 a[212:215], v1, s[8:11], s21 offen offset:1024
    s_add_u32 s21, s20, 77824
    buffer_load_dwordx4 a[216:219], v1, s[8:11], s21 offen offset:0
    buffer_load_dwordx4 a[220:223], v1, s[8:11], s21 offen offset:1024
    s_add_u32 s21, s20, 79872
    buffer_load_dwordx4 a[224:227], v1, s[8:11], s21 offen offset:0
    buffer_load_dwordx4 a[228:231], v1, s[8:11], s21 offen offset:1024
    s_add_u32 s21, s20, 81920
    buffer_load_dwordx4 a[232:235], v1, s[8:11], s21 offen offset:0
    buffer_load_dwordx4 a[236:239], v1, s[8:11], s21 offen offset:1024
    s_add_u32 s21, s20, 83968
    buffer_load_dwordx4 a[240:243], v1, s[8:11], s21 offen offset:0
    buffer_load_dwordx4 a[244:247], v1, s[8:11], s21 offen offset:1024
    s_add_u32 s21, s20, 86016
    buffer_load_dwordx4 a[248:251], v1, s[8:11], s21 offen offset:0
    buffer_load_dwordx4 a[252:255], v1, s[8:11], s21 offen offset:1024
    s_add_u32 s21, s20, 88064
    buffer_load_dwordx4 v[148:151], v1, s[8:11], s21 offen offset:0
    buffer_load_dwordx4 v[152:155], v1, s[8:11], s21 offen offset:1024
    s_add_u32 s21, s20, 92160
    buffer_load_dwordx4 v[156:159], v1, s[8:11], s21 offen offset:0
    buffer_load_dwordx4 v[160:163], v1, s[8:11], s21 offen offset:1024
    s_add_u32 s21, s20, 94208
    buffer_load_dwordx4 v[164:167], v1, s[8:11], s21 offen offset:0
    buffer_load_dwordx4 v[168:171], v1, s[8:11], s21 offen offset:1024
    s_add_u32 s21, s20, 96256
    buffer_load_dwordx4 v[172:175], v1, s[8:11], s21 offen offset:0
    buffer_load_dwordx4 v[176:179], v1, s[8:11], s21 offen offset:1024
    s_add_u32 s21, s20, 100352
    buffer_load_dwordx4 v[180:183], v1, s[8:11], s21 offen offset:0
    buffer_load_dwordx4 v[184:187], v1, s[8:11], s21 offen offset:1024
    s_add_u32 s21, s20, 102400
    buffer_load_dwordx4 v[188:191], v1, s[8:11], s21 offen offset:0
    buffer_load_dwordx4 v[192:195], v1, s[8:11], s21 offen offset:1024
    s_add_u32 s21, s20, 104448
    buffer_load_dwordx4 v[196:199], v1, s[8:11], s21 offen offset:0
    buffer_load_dwordx4 v[200:203], v1, s[8:11], s21 offen offset:1024
    s_add_u32 s21, s20, 108544
    buffer_load_dwordx4 v[204:207], v1, s[8:11], s21 offen offset:0
    buffer_load_dwordx4 v[208:211], v1, s[8:11], s21 offen offset:1024
    s_add_u32 s21, s20, 110592
    buffer_load_dwordx4 v[212:215], v1, s[8:11], s21 offen offset:0
    buffer_load_dwordx4 v[216:219], v1, s[8:11], s21 offen offset:1024
    s_add_u32 s21, s20, 112640
    buffer_load_dwordx4 v[220:223], v1, s[8:11], s21 offen offset:0
    buffer_load_dwordx4 v[224:227], v1, s[8:11], s21 offen offset:1024
    s_add_u32 s21, s20, 116736
    buffer_load_dwordx4 v[228:231], v1, s[8:11], s21 offen offset:0
    buffer_load_dwordx4 v[232:235], v1, s[8:11], s21 offen offset:1024
    s_add_u32 s21, s20, 118784
    buffer_load_dwordx4 v[236:239], v1, s[8:11], s21 offen offset:0
    buffer_load_dwordx4 v[240:243], v1, s[8:11], s21 offen offset:1024
    s_add_u32 s21, s20, 120832
    buffer_load_dwordx4 v[244:247], v1, s[8:11], s21 offen offset:0
    buffer_load_dwordx4 v[248:251], v1, s[8:11], s21 offen offset:1024
    s_waitcnt lgkmcnt(0)
    s_mov_b32 s14, 0
    s_cmp_gt_u32 s47, s14
    s_cbranch_scc1 layerb1_kernel_p1_gw1_ok
layerb1_kernel_p1_gw1_lp:
    buffer_load_dword v253, v255, s[8:11], s48 offen sc1
    s_waitcnt vmcnt(0)
    v_readlane_b32 s47, v253, 0
    v_readlane_b32 s29, v253, 1
    s_nop 0
    s_min_u32 s47, s47, s29
    s_sub_u32 s15, s15, 1
    s_cbranch_scc1 layerb1_kernel_bail
    s_cmp_gt_u32 s47, s14
    s_cbranch_scc0 layerb1_kernel_p1_gw1_lp
layerb1_kernel_p1_gw1_ok:
    s_mul_i32 s20, s14, 393216
    s_add_u32 s20, s20, s44
    s_add_u32 s21, s20, 0
    buffer_load_dwordx4 v[100:103], v9, s[8:11], s21 offen offset:0 sc1
    buffer_load_dwordx4 v[104:107], v9, s[8:11], s21 offen offset:512 sc1
    s_add_u32 s21, s20, 4096
    buffer_load_dwordx4 v[108:111], v9, s[8:11], s21 offen offset:0 sc1
    buffer_load_dwordx4 v[112:115], v9, s[8:11], s21 offen offset:512 sc1
    v_mov_b32 v56, 0
    v_mov_b32 v57, 0
    v_mov_b32 v58, 0
    v_mov_b32 v59, 0
    v_mov_b32 v60, 0
    v_mov_b32 v61, 0
    v_mov_b32 v62, 0
    v_mov_b32 v63, 0
    v_mov_b32 v64, 0
    v_mov_b32 v65, 0
    v_mov_b32 v66, 0
    v_mov_b32 v67, 0
    v_mov_b32 v68, 0
    v_mov_b32 v69, 0
    v_mov_b32 v70, 0
    v_mov_b32 v71, 0
    v_mov_b32 v72, 0
    v_mov_b32 v73, 0
    v_mov_b32 v74, 0
    v_mov_b32 v75, 0
    v_mov_b32 v76, 0
    v_mov_b32 v77, 0
    v_mov_b32 v78, 0
    v_mov_b32 v79, 0
    v_mov_b32 v80, 0
    v_mov_b32 v81, 0
    v_mov_b32 v82, 0
    v_mov_b32 v83, 0
    v_mov_b32 v84, 0
    v_mov_b32 v85, 0
    v_mov_b32 v86, 0
    v_mov_b32 v87, 0
    ds_read_b128 v[116:119], v13 offset:0
    ds_read_b128 v[120:123], v13 offset:1024
    ds_read_b128 v[124:127], v13 offset:2048
    ds_read_b128 v[128:131], v13 offset:3072
    ds_read_b128 v[132:135], v13 offset:4096
    ds_read_b128 v[136:139], v13 offset:5120
    ds_read_b128 v[140:143], v13 offset:6144
    ds_read_b128 v[144:147], v13 offset:7168
    s_waitcnt lgkmcnt(0)
layerb1_kernel_p1_step:
    s_cmp_lt_u32 s14, 32
    s_cselect_b32 s18, s16, s17
    s_and_b32 s20, s14, 31
    s_lshl_b32 s20, s20, 16
    s_add_u32 s18, s18, s20
    s_add_u32 s22, s18, 39936
    s_add_u32 s23, s18, 49152
    s_add_u32 s24, s18, 50176
layerb1_kernel_p1_poll:
    buffer_load_dwordx4 v[28:31], v1, s[8:11], s22 offen sc1
    buffer_load_dwordx4 v[32:35], v1, s[8:11], s23 offen sc1
    buffer_load_dwordx4 v[36:39], v1, s[8:11], s24 offen sc1
    s_waitcnt vmcnt(0)
    ds_write_b128 v14, v[28:31] offset:3072
    ds_write_b128 v14, v[32:35] offset:4096
    ds_write_b128 v14, v[36:39] offset:5120
    v_max3_u32 v88, v28, v29, v30
    v_max3_u32 v88, v88, v31, v32
    v_max3_u32 v88, v88, v33, v34
    v_max3_u32 v88, v88, v35, v36
    v_max3_u32 v88, v88, v37, v38
    v_max_u32 v88, v88, v39
    v_cmp_eq_u32 vcc, -1, v88
    s_sub_u32 s15, s15, 1
    s_cbranch_scc1 layerb1_kernel_bail
    s_cbranch_vccnz layerb1_kernel_p1_poll
    s_waitcnt lgkmcnt(0)
    s_barrier
    ds_read_b128 v[16:19], v14 offset:0
    ds_read_b128 v[20:23], v14 offset:1024
    ds_read_b128 v[24:27], v14 offset:2048
    ds_read_b128 v[40:43], v14 offset:6144
    ds_read_b128 v[44:47], v14 offset:7168
    ds_read_b128 v[48:51], v14 offset:8192
    ds_read_b128 v[52:55], v14 offset:9216
    v_smfmac_f32_16x16x64_bf16 v[56:59], v[28:31], a[0:7], v2
    v_smfmac_f32_16x16x64_bf16 v[60:63], v[28:31], a[8:15], v2
    v_smfmac_f32_16x16x64_bf16 v[64:67], v[28:31], a[16:23], v2
    v_smfmac_f32_16x16x64_bf16 v[56:59], v[32:35], a[24:31], v2
    v_smfmac_f32_16x16x64_bf16 v[60:63], v[32:35], a[32:39], v2
    v_smfmac_f32_16x16x64_bf16 v[64:67], v[32:35], a[40:47], v2
    v_smfmac_f32_16x16x64_bf16 v[56:59], v[36:39], a[48:55], v2
    v_smfmac_f32_16x16x64_bf16 v[60:63], v[36:39], a[56:63], v2
    v_smfmac_f32_16x16x64_bf16 v[64:67], v[36:39], a[64:71], v2
    s_waitcnt lgkmcnt(6)
    v_smfmac_f32_16x16x64_bf16 v[56:59], v[16:19], v[116:123], v2
    ds_read_b128 v[116:119], v13 offset:8192
    ds_read_b128 v[120:123], v13 offset:9216
    v_smfmac_f32_16x16x64_bf16 v[60:63], v[16:19], a[72:79], v2
    v_smfmac_f32_16x16x64_bf16 v[64:67], v[16:19], v[124:131], v2
    ds_read_b128 v[124:127], v13 offset:10240
    ds_read_b128 v[128:131], v13 offset:11264
    s_waitcnt lgkmcnt(9)
    v_smfmac_f32_16x16x64_bf16 v[56:59], v[20:23], a[80:87], v2
    v_smfmac_f32_16x16x64_bf16 v[60:63], v[20:23], v[132:139], v2
    ds_read_b128 v[132:135], v13 offset:12288
    ds_read_b128 v[136:139], v13 offset:13312
    v_smfmac_f32_16x16x64_bf16 v[64:67], v[20:23], a[88:95], v2
    s_waitcnt lgkmcnt(10)
    v_smfmac_f32_16x16x64_bf16 v[56:59], v[24:27], v[140:147], v2
    ds_read_b128 v[140:143], v13 offset:14336
    ds_read_b128 v[144:147], v13 offset:15360
    v_smfmac_f32_16x16x64_bf16 v[60:63], v[24:27], a[96:103], v2
    s_waitcnt lgkmcnt(6)
    v_smfmac_f32_16x16x64_bf16 v[64:67], v[24:27], v[116:123], v2
    ds_read_b128 v[116:119], v13 offset:16384
    ds_read_b128 v[120:123], v13 offset:17408
    v_smfmac_f32_16x16x64_bf16 v[56:59], v[40:43], a[104:111], v2
    s_waitcnt lgkmcnt(6)
    v_smfmac_f32_16x16x64_bf16 v[60:63], v[40:43], v[124:131], v2
    ds_read_b128 v[124:127], v13 offset:18432
    ds_read_b128 v[128:131], v13 offset:19456
    v_smfmac_f32_16x16x64_bf16 v[64:67], v[40:43], a[112:119], v2
    s_waitcnt lgkmcnt(6)
    v_smfmac_f32_16x16x64_bf16 v[56:59], v[44:47], v[132:139], v2
    ds_read_b128 v[132:135], v13 offset:20480
    ds_read_b128 v[136:139], v13 offset:21504
    v_smfmac_f32_16x16x64_bf16 v[60:63], v[44:47], a[120:127], v2
    s_waitcnt lgkmcnt(6)
    v_smfmac_f32_16x16x64_bf16 v[64:67], v[44:47], v[140:147], v2
    ds_read_b128 v[140:143], v13 offset:22528
    ds_read_b128 v[144:147], v13 offset:23552
    v_smfmac_f32_16x16x64_bf16 v[56:59], v[48:51], a[128:135], v2
    s_waitcnt lgkmcnt(6)
    v_smfmac_f32_16x16x64_bf16 v[60:63], v[48:51], v[116:123], v2
    ds_read_b128 v[116:119], v13 offset:24576
    ds_read_b128 v[120:123], v13 offset:25600
    v_smfmac_f32_16x16x64_bf16 v[64:67], v[48:51], a[136:143], v2
    s_waitcnt lgkmcnt(6)
    v_smfmac_f32_16x16x64_bf16 v[56:59], v[52:55], v[124:131], v2
    ds_read_b128 v[124:127], v13 offset:26624
    ds_read_b128 v[128:131], v13 offset:27648
    v_smfmac_f32_16x16x64_bf16 v[60:63], v[52:55], a[144:151], v2
    s_waitcnt lgkmcnt(6)
    v_smfmac_f32_16x16x64_bf16 v[64:67], v[52:55], v[132:139], v2
    ds_read_b128 v[132:135], v13 offset:28672
    ds_read_b128 v[136:139], v13 offset:29696
    v_smfmac_f32_16x16x64_bf16 v[68:71], v[16:19], a[152:159], v2
    v_smfmac_f32_16x16x64_bf16 v[68:71], v[20:23], a[160:167], v2
    v_permlane32_swap_b32 v56, v58
    v_permlane32_swap_b32 v57, v59
    v_smfmac_f32_16x16x64_bf16 v[68:71], v[24:27], a[168:175], v2
    v_add_f32 v56, v56, v58
    v_add_f32 v57, v57, v59
    v_smfmac_f32_16x16x64_bf16 v[68:71], v[28:31], a[176:183], v2
    v_cvt_pk_bf16_f32 v56, v56, v57
    ds_write_b16 v3, v56 offset:0
    v_smfmac_f32_16x16x64_bf16 v[68:71], v[32:35], a[184:191], v2
    ds_write_b16_d16_hi v3, v56 offset:400
    v_permlane32_swap_b32 v60, v62
    v_smfmac_f32_16x16x64_bf16 v[68:71], v[36:39], a[192:199], v2
    v_permlane32_swap_b32 v61, v63
    v_add_f32 v60, v60, v62
    v_smfmac_f32_16x16x64_bf16 v[68:71], v[40:43], a[200:207], v2
    v_add_f32 v61, v61, v63
    v_cvt_pk_bf16_f32 v60, v60, v61
    v_smfmac_f32_16x16x64_bf16 v[68:71], v[44:47], a[208:215], v2
    ds_write_b16 v3, v60 offset:32
    ds_write_b16_d16_hi v3, v60 offset:432
    v_smfmac_f32_16x16x64_bf16 v[68:71], v[48:51], a[216:223], v2
    v_permlane32_swap_b32 v64, v66
    v_permlane32_swap_b32 v65, v67
    v_smfmac_f32_16x16x64_bf16 v[68:71], v[52:55], a[224:231], v2
    v_add_f32 v64, v64, v66
    v_add_f32 v65, v65, v67
    v_smfmac_f32_16x16x64_bf16 v[72:75], v[16:19], a[232:239], v2
    v_cvt_pk_bf16_f32 v64, v64, v65
    ds_write_b16 v3, v64 offset:64
    v_smfmac_f32_16x16x64_bf16 v[72:75], v[20:23], a[240:247], v2
    ds_write_b16_d16_hi v3, v64 offset:464
    v_smfmac_f32_16x16x64_bf16 v[72:75], v[24:27], a[248:255], v2
    v_smfmac_f32_16x16x64_bf16 v[72:75], v[28:31], v[148:155], v2
    s_waitcnt lgkmcnt(0)
    s_barrier
    ds_read_b128 v[88:91], v4 offset:0
    v_smfmac_f32_16x16x64_bf16 v[72:75], v[32:35], v[140:147], v2
    ds_read_b128 v[92:95], v4 offset:128
    ds_read_b128 v[96:99], v4 offset:256
    v_smfmac_f32_16x16x64_bf16 v[72:75], v[36:39], v[156:163], v2
    v_permlane32_swap_b32 v68, v70
    v_permlane32_swap_b32 v69, v71
    v_smfmac_f32_16x16x64_bf16 v[72:75], v[40:43], v[164:171], v2
    v_add_f32 v68, v68, v70
    v_add_f32 v69, v69, v71
    v_smfmac_f32_16x16x64_bf16 v[72:75], v[44:47], v[172:179], v2
    v_cvt_pk_bf16_f32 v68, v68, v69
    ds_write_b16 v3, v68 offset:3200
    v_smfmac_f32_16x16x64_bf16 v[72:75], v[48:51], v[116:123], v2
    ds_write_b16_d16_hi v3, v68 offset:3600
    v_smfmac_f32_16x16x64_bf16 v[72:75], v[52:55], v[180:187], v2
    s_waitcnt lgkmcnt(2)
    v_smfmac_f32_16x16x64_bf16 v[80:83], v[88:91], v[100:107], v2
    v_smfmac_f32_16x16x64_bf16 v[80:83], v[92:95], v[108:115], v2
    v_smfmac_f32_16x16x64_bf16 v[76:79], v[16:19], v[188:195], v2
    v_smfmac_f32_16x16x64_bf16 v[76:79], v[20:23], v[196:203], v2
    v_smfmac_f32_16x16x64_bf16 v[76:79], v[24:27], v[124:131], v2
    v_permlane32_swap_b32 v72, v74
    v_permlane32_swap_b32 v73, v75
    v_smfmac_f32_16x16x64_bf16 v[76:79], v[28:31], v[204:211], v2
    v_add_f32 v72, v72, v74
    v_add_f32 v73, v73, v75
    ds_write_b128 v15, v[80:83]
    v_smfmac_f32_16x16x64_bf16 v[76:79], v[32:35], v[212:219], v2
    v_cvt_pk_bf16_f32 v72, v72, v73
    ds_write_b16 v3, v72 offset:3232
    v_smfmac_f32_16x16x64_bf16 v[76:79], v[36:39], v[220:227], v2
    ds_write_b16_d16_hi v3, v72 offset:3632
    v_smfmac_f32_16x16x64_bf16 v[76:79], v[40:43], v[132:139], v2
    v_smfmac_f32_16x16x64_bf16 v[76:79], v[44:47], v[228:235], v2
    v_smfmac_f32_16x16x64_bf16 v[76:79], v[48:51], v[236:243], v2
    v_smfmac_f32_16x16x64_bf16 v[76:79], v[52:55], v[244:251], v2
    s_nop 7
    v_permlane32_swap_b32 v76, v78
    v_permlane32_swap_b32 v77, v79
    v_add_f32 v76, v76, v78
    v_add_f32 v77, v77, v79
    v_cvt_pk_bf16_f32 v76, v76, v77
    ds_write_b16 v3, v76 offset:3264
    ds_write_b16_d16_hi v3, v76 offset:3664
    s_waitcnt lgkmcnt(0)
    s_barrier
    ds_read2st64_b32 v[40:41], v6 offset0:0 offset1:2
    ds_read2st64_b32 v[42:43], v6 offset0:8 offset1:10
    ds_read_b128 v[16:19], v5 offset:0
    ds_read_b128 v[20:23], v5 offset:16
    ds_read_b128 v[24:27], v5 offset:128
    ds_read_b128 v[28:31], v5 offset:144
    ds_read_b128 v[32:35], v5 offset:256
    ds_read_b128 v[36:39], v5 offset:272
    s_waitcnt lgkmcnt(6)
    v_add_f32 v40, v40, v41
    v_add_f32 v42, v42, v43
    v_add_f32 v44, v40, v42
    v_mul_f32 v44, 0x3dd53b95, v44
    s_waitcnt lgkmcnt(4)
    v_smfmac_f32_16x16x64_bf16 v[84:87], v[88:91], v[16:23], v2
    s_waitcnt lgkmcnt(2)
    v_smfmac_f32_16x16x64_bf16 v[84:87], v[92:95], v[24:31], v2
    s_waitcnt lgkmcnt(0)
    v_smfmac_f32_16x16x64_bf16 v[84:87], v[96:99], v[32:39], v2
    v_max_f32_dpp v45, v44, v44 row_ror:8 row_mask:0xf bank_mask:0xf
    s_nop 1
    v_max_f32_dpp v45, v45, v45 row_ror:4 row_mask:0xf bank_mask:0xf
    s_nop 1
    v_max_f32_dpp v45, v45, v45 row_ror:2 row_mask:0xf bank_mask:0xf
    s_nop 1
    v_max_f32_dpp v45, v45, v45 row_ror:1 row_mask:0xf bank_mask:0xf
    v_mov_b32 v47, v45
    s_nop 1
    v_permlane32_swap_b32 v45, v47
    v_max_f32 v45, v45, v47
    v_mov_b32 v47, v85
    s_nop 1
    v_permlane32_swap_b32 v85, v47
    v_add_f32 v48, v85, v47
    v_mul_f32 v48, 0x3dd53b95, v48
    s_nop 1
    v_max_f32_dpp v46, v48, v48 row_ror:4 row_mask:0xf bank_mask:0xf
    s_nop 1
    v_max_f32_dpp v46, v46, v46 row_ror:2 row_mask:0xf bank_mask:0xf
    s_nop 1
    v_max_f32_dpp v46, v46, v46 row_ror:1 row_mask:0xf bank_mask:0xf
    v_max_f32 v45, v45, v46
    v_sub_f32 v49, v44, v45
    v_sub_f32 v50, v48, v45
    v_exp_f32 v49, v49
    v_exp_f32 v50, v50
    s_nop 0
    v_fma_f32 v51, v50, v12, v49
    s_nop 1
    v_add_f32_dpp v51, v51, v51 row_ror:8 row_mask:0xf bank_mask:0xf
    s_nop 1
    v_add_f32_dpp v51, v51, v51 row_ror:4 row_mask:0xf bank_mask:0xf
    s_nop 1
    v_add_f32_dpp v51, v51, v51 row_ror:2 row_mask:0xf bank_mask:0xf
    s_nop 1
    v_add_f32_dpp v51, v51, v51 row_ror:1 row_mask:0xf bank_mask:0xf
    v_mov_b32 v47, v51
    s_nop 1
    v_permlane32_swap_b32 v51, v47
    v_add_f32 v51, v51, v47
    v_rcp_f32 v51, v51
    s_nop 0
    v_mul_f32 v49, v49, v51
    v_mul_f32 v50, v50, v51
    s_nop 0
    v_mov_b32_dpp v46, v49 quad_perm:[1,0,3,2] row_mask:0xf bank_mask:0xf
    v_mov_b32_dpp v47, v50 quad_perm:[1,0,3,2] row_mask:0xf bank_mask:0xf
    v_cvt_pk_bf16_f32 v16, v49, v46
    v_cvt_pk_bf16_f32 v20, v50, v47
    s_nop 0
    v_mov_b32_dpp v17, v16 row_shl:2 row_mask:0xf bank_mask:0xf
    v_mov_b32_dpp v18, v16 row_shl:4 row_mask:0xf bank_mask:0xf
    v_mov_b32_dpp v19, v16 row_shl:6 row_mask:0xf bank_mask:0xf
    v_mov_b32_dpp v21, v20 row_shl:2 row_mask:0xf bank_mask:0xf
    v_mov_b32_dpp v22, v20 row_shl:4 row_mask:0xf bank_mask:0xf
    v_mov_b32_dpp v23, v20 row_shl:6 row_mask:0xf bank_mask:0xf
    s_mov_b64 exec, s[40:41]
    buffer_store_dwordx4 v[16:19], v7, s[8:11], s18 offen sc1
    s_mov_b64 exec, s[42:43]
    buffer_store_dwordx4 v[20:23], v8, s[8:11], s18 offen sc1
    s_mov_b64 exec, -1
    ds_read_b128 v[40:43], v10
    s_add_u32 s28, s14, 1
    s_min_u32 s28, s28, 63
    s_cmp_gt_u32 s47, s28
    s_cbranch_scc1 layerb1_kernel_p1_gw2_ok
layerb1_kernel_p1_gw2_lp:
    buffer_load_dword v253, v255, s[8:11], s48 offen sc1
    s_waitcnt vmcnt(0)
    v_readlane_b32 s47, v253, 0
    v_readlane_b32 s29, v253, 1
    s_nop 0
    s_min_u32 s47, s47, s29
    s_sub_u32 s15, s15, 1
    s_cbranch_scc1 layerb1_kernel_bail
    s_cmp_gt_u32 s47, s28
    s_cbranch_scc0 layerb1_kernel_p1_gw2_lp
layerb1_kernel_p1_gw2_ok:
    s_mul_i32 s20, s28, 393216
    s_add_u32 s20, s20, s44
    s_add_u32 s21, s20, 0
    buffer_load_dwordx4 v[100:103], v9, s[8:11], s21 offen offset:0 sc1
    buffer_load_dwordx4 v[104:107], v9, s[8:11], s21 offen offset:512 sc1
    s_add_u32 s21, s20, 4096
    buffer_load_dwordx4 v[108:111], v9, s[8:11], s21 offen offset:0 sc1
    buffer_load_dwordx4 v[112:115], v9, s[8:11], s21 offen offset:512 sc1
    v_mov_b32 v56, 0
    v_mov_b32 v57, 0
    v_mov_b32 v58, 0
    v_mov_b32 v59, 0
    v_mov_b32 v60, 0
    v_mov_b32 v61, 0
    v_mov_b32 v62, 0
    v_mov_b32 v63, 0
    v_mov_b32 v64, 0
    v_mov_b32 v65, 0
    v_mov_b32 v66, 0
    v_mov_b32 v67, 0
    v_mov_b32 v68, 0
    v_mov_b32 v69, 0
    v_mov_b32 v70, 0
    v_mov_b32 v71, 0
    v_mov_b32 v72, 0
    v_mov_b32 v73, 0
    v_mov_b32 v74, 0
    v_mov_b32 v75, 0
    v_mov_b32 v76, 0
    v_mov_b32 v77, 0
    v_mov_b32 v78, 0
    v_mov_b32 v79, 0
    v_mov_b32 v80, 0
    v_mov_b32 v81, 0
    v_mov_b32 v82, 0
    v_mov_b32 v83, 0
    v_mov_b32 v84, 0
    v_mov_b32 v85, 0
    v_mov_b32 v86, 0
    v_mov_b32 v87, 0
    s_waitcnt lgkmcnt(0)
    s_mul_i32 s20, s14, 98304
    s_add_u32 s20, s20, s45
    buffer_store_dwordx4 v[40:43], v11, s[8:11], s20 offen sc1
    ds_read_b128 v[116:119], v13 offset:0
    ds_read_b128 v[120:123], v13 offset:1024
    ds_read_b128 v[124:127], v13 offset:2048
    ds_read_b128 v[128:131], v13 offset:3072
    ds_read_b128 v[132:135], v13 offset:4096
    ds_read_b128 v[136:139], v13 offset:5120
    ds_read_b128 v[140:143], v13 offset:6144
    ds_read_b128 v[144:147], v13 offset:7168
    s_waitcnt lgkmcnt(0)
    s_add_u32 s14, s14, 1
    s_cmp_lt_u32 s14, 64
    s_cbranch_scc1 layerb1_kernel_p1_step
    s_waitcnt vmcnt(0)
    s_barrier
    s_branch layerb1_kernel_end
layerb1_kernel_p2_start:
    v_lshrrev_b32 v16, 4, v0
    v_and_b32 v17, 15, v0
    v_and_b32 v18, 1, v16
    v_lshlrev_b32 v18, 2, v18
    v_lshrrev_b32 v19, 1, v16
    v_lshl_add_u32 v18, v19, 1, v18
    v_mul_u32_u24 v18, 400, v18
    v_lshl_add_u32 v18, v17, 1, v18
    v_add_u32 v3, 133312, v18
    v_and_b32 v18, 7, v0
    v_mul_u32_u24 v18, 400, v18
    v_lshrrev_b32 v19, 3, v0
    v_lshl_add_u32 v18, v19, 4, v18
    v_add_u32 v4, 133120, v18
    v_and_b32 v18, 7, v0
    v_mul_u32_u24 v18, 400, v18
    v_lshl_add_u32 v18, v16, 5, v18
    v_add_u32 v5, 136320, v18
    v_lshrrev_b32 v18, 1, v16
    v_lshlrev_b32 v18, 10, v18
    v_and_b32 v19, 31, v0
    v_lshl_add_u32 v18, v19, 4, v18
    v_add_u32 v6, 139528, v18
    v_add_u32 v15, 141568, v1
    v_lshrrev_b32 v18, 1, v16
    v_lshlrev_b32 v18, 1, v18
    v_lshrrev_b32 v19, 3, v17
    v_add3_u32 v18, v18, v19, 1
    v_lshrrev_b32 v19, 1, v18
    v_lshlrev_b32 v19, 14, v19
    v_and_b32 v18, 1, v18
    v_lshl_add_u32 v18, v18, 12, v19
    v_and_b32 v19, 1, v16
    v_lshlrev_b32 v19, 4, v19
    v_add_u32 v19, 64, v19
    s_lshl_b32 s20, s12, 7
    v_add_u32 v8, s20, v19
    v_add_u32 v7, v8, v18
    v_lshlrev_b32 v18, 4, v17
    v_lshl_add_u32 v18, v16, 10, v18
    v_add_u32 v9, 0, v18
    v_add_u32 v18, 128, v0
    v_mul_u32_u24 v19, 2731, v18
    v_lshrrev_b32 v19, 16, v19
    v_mul_u32_u24 v20, 24, v19
    v_sub_u32 v20, v18, v20
    v_mul_u32_u24 v21, 400, v19
    v_lshl_add_u32 v21, v20, 4, v21
    v_add_u32 v10, 136320, v21
    v_lshlrev_b32 v21, 4, v19
    v_lshl_add_u32 v11, v20, 7, v21
    v_and_b32 v18, 0x28, v0
    v_cmp_eq_u32 vcc, 0, v18
    v_mov_b32 v18, 1.0
    v_mov_b32 v19, 0
    v_cndmask_b32 v12, v19, v18, vcc
    v_add_u32 v13, 61440, v1
    v_add_u32 v14, 122880, v1
    s_mul_i32 s44, s12, 12288
    s_add_u32 s44, s44, 53477376
    s_mul_i32 s45, s12, 3072
    s_add_u32 s45, s45, 208666624
    s_mul_i32 s20, s12, 6
    s_add_u32 s21, s20, 5
    s_lshr_b32 s20, s20, 3
    s_lshr_b32 s21, s21, 3
    s_add_u32 s20, s20, 80
    s_add_u32 s21, s21, 80
    s_lshl_b32 s20, s20, 7
    s_lshl_b32 s21, s21, 7
    v_mov_b32 v255, s21
    v_mov_b32 v253, s20
    v_cmp_eq_u32 vcc, 0, v0
    s_nop 1
    v_cndmask_b32 v255, v255, v253, vcc
    s_mov_b32 s47, 0
    s_mul_i32 s20, s12, 491520
    s_add_u32 s20, s20, 11780096
    s_add_u32 s21, s20, 2048
    buffer_load_dwordx4 v[16:19], v1, s[8:11], s21 offen offset:0
    buffer_load_dwordx4 v[20:23], v1, s[8:11], s21 offen offset:1024
    s_add_u32 s21, s20, 43008
    buffer_load_dwordx4 v[24:27], v1, s[8:11], s21 offen offset:0
    buffer_load_dwordx4 v[28:31], v1, s[8:11], s21 offen offset:1024
    s_add_u32 s21, s20, 24576
    buffer_load_dwordx4 v[32:35], v1, s[8:11], s21 offen offset:0
    buffer_load_dwordx4 v[36:39], v1, s[8:11], s21 offen offset:1024
    s_add_u32 s21, s20, 6144
    buffer_load_dwordx4 v[40:43], v1, s[8:11], s21 offen offset:0
    buffer_load_dwordx4 v[44:47], v1, s[8:11], s21 offen offset:1024
    s_add_u32 s21, s20, 47104
    buffer_load_dwordx4 v[48:51], v1, s[8:11], s21 offen offset:0
    buffer_load_dwordx4 v[52:55], v1, s[8:11], s21 offen offset:1024
    s_add_u32 s21, s20, 28672
    buffer_load_dwordx4 v[56:59], v1, s[8:11], s21 offen offset:0
    buffer_load_dwordx4 v[60:63], v1, s[8:11], s21 offen offset:1024
    s_add_u32 s21, s20, 10240
    buffer_load_dwordx4 v[64:67], v1, s[8:11], s21 offen offset:0
    buffer_load_dwordx4 v[68:71], v1, s[8:11], s21 offen offset:1024
    s_add_u32 s21, s20, 51200
    buffer_load_dwordx4 v[72:75], v1, s[8:11], s21 offen offset:0
    buffer_load_dwordx4 v[76:79], v1, s[8:11], s21 offen offset:1024
    s_add_u32 s21, s20, 36864
    buffer_load_dwordx4 v[80:83], v1, s[8:11], s21 offen offset:0
    buffer_load_dwordx4 v[84:87], v1, s[8:11], s21 offen offset:1024
    s_add_u32 s21, s20, 18432
    buffer_load_dwordx4 v[88:91], v1, s[8:11], s21 offen offset:0
    buffer_load_dwordx4 v[92:95], v1, s[8:11], s21 offen offset:1024
    s_add_u32 s21, s20, 59392
    buffer_load_dwordx4 v[96:99], v1, s[8:11], s21 offen offset:0
    buffer_load_dwordx4 v[100:103], v1, s[8:11], s21 offen offset:1024
    s_add_u32 s21, s20, 90112
    buffer_load_dwordx4 v[104:107], v1, s[8:11], s21 offen offset:0
    buffer_load_dwordx4 v[108:111], v1, s[8:11], s21 offen offset:1024
    s_add_u32 s21, s20, 98304
    buffer_load_dwordx4 v[112:115], v1, s[8:11], s21 offen offset:0
    buffer_load_dwordx4 v[116:119], v1, s[8:11], s21 offen offset:1024
    s_add_u32 s21, s20, 106496
    buffer_load_dwordx4 v[120:123], v1, s[8:11], s21 offen offset:0
    buffer_load_dwordx4 v[124:127], v1, s[8:11], s21 offen offset:1024
    s_add_u32 s21, s20, 114688
    buffer_load_dwordx4 v[128:131], v1, s[8:11], s21 offen offset:0
    buffer_load_dwordx4 v[132:135], v1, s[8:11], s21 offen offset:1024
    s_add_u32 s21, s20, 12288
    buffer_load_dwordx4 a[0:3], v1, s[8:11], s21 offen offset:0
    buffer_load_dwordx4 a[4:7], v1, s[8:11], s21 offen offset:1024
    s_add_u32 s21, s20, 32768
    buffer_load_dwordx4 a[8:11], v1, s[8:11], s21 offen offset:0
    buffer_load_dwordx4 a[12:15], v1, s[8:11], s21 offen offset:1024
    s_add_u32 s21, s20, 53248
    buffer_load_dwordx4 a[16:19], v1, s[8:11], s21 offen offset:0
    buffer_load_dwordx4 a[20:23], v1, s[8:11], s21 offen offset:1024
    s_add_u32 s21, s20, 14336
    buffer_load_dwordx4 a[24:27], v1, s[8:11], s21 offen offset:0
    buffer_load_dwordx4 a[28:31], v1, s[8:11], s21 offen offset:1024
    s_add_u32 s21, s20, 34816
    buffer_load_dwordx4 a[32:35], v1, s[8:11], s21 offen offset:0
    buffer_load_dwordx4 a[36:39], v1, s[8:11], s21 offen offset:1024
    s_add_u32 s21, s20, 55296
    buffer_load_dwordx4 a[40:43], v1, s[8:11], s21 offen offset:0
    buffer_load_dwordx4 a[44:47], v1, s[8:11], s21 offen offset:1024
    s_add_u32 s21, s20, 0
    buffer_load_dwordx4 a[48:51], v1, s[8:11], s21 offen offset:0
    buffer_load_dwordx4 a[52:55], v1, s[8:11], s21 offen offset:1024
    s_add_u32 s21, s20, 20480
    buffer_load_dwordx4 a[56:59], v1, s[8:11], s21 offen offset:0
    buffer_load_dwordx4 a[60:63], v1, s[8:11], s21 offen offset:1024
    s_add_u32 s21, s20, 40960
    buffer_load_dwordx4 a[64:67], v1, s[8:11], s21 offen offset:0
    buffer_load_dwordx4 a[68:71], v1, s[8:11], s21 offen offset:1024
    s_add_u32 s21, s20, 22528
    buffer_load_dwordx4 a[72:75], v1, s[8:11], s21 offen offset:0
    buffer_load_dwordx4 a[76:79], v1, s[8:11], s21 offen offset:1024
    s_add_u32 s21, s20, 4096
    buffer_load_dwordx4 a[80:83], v1, s[8:11], s21 offen offset:0
    buffer_load_dwordx4 a[84:87], v1, s[8:11], s21 offen offset:1024
    s_add_u32 s21, s20, 45056
    buffer_load_dwordx4 a[88:91], v1, s[8:11], s21 offen offset:0
    buffer_load_dwordx4 a[92:95], v1, s[8:11], s21 offen offset:1024
    s_add_u32 s21, s20, 26624
    buffer_load_dwordx4 a[96:99], v1, s[8:11], s21 offen offset:0
    buffer_load_dwordx4 a[100:103], v1, s[8:11], s21 offen offset:1024
    s_add_u32 s21, s20, 8192
    buffer_load_dwordx4 a[104:107], v1, s[8:11], s21 offen offset:0
    buffer_load_dwordx4 a[108:111], v1, s[8:11], s21 offen offset:1024
    s_add_u32 s21, s20, 49152
    buffer_load_dwordx4 a[112:115], v1, s[8:11], s21 offen offset:0
    buffer_load_dwordx4 a[116:119], v1, s[8:11], s21 offen offset:1024
    s_add_u32 s21, s20, 30720
    buffer_load_dwordx4 a[120:123], v1, s[8:11], s21 offen offset:0
    buffer_load_dwordx4 a[124:127], v1, s[8:11], s21 offen offset:1024
    s_waitcnt vmcnt(32)
    ds_write_b128 v13, v[16:19] offset:0
    ds_write_b128 v13, v[20:23] offset:1024
    ds_write_b128 v13, v[24:27] offset:2048
    ds_write_b128 v13, v[28:31] offset:3072
    ds_write_b128 v13, v[32:35] offset:4096
    ds_write_b128 v13, v[36:39] offset:5120
    ds_write_b128 v13, v[40:43] offset:6144
    ds_write_b128 v13, v[44:47] offset:7168
    ds_write_b128 v13, v[48:51] offset:8192
    ds_write_b128 v13, v[52:55] offset:9216
    ds_write_b128 v13, v[56:59] offset:10240
    ds_write_b128 v13, v[60:63] offset:11264
    ds_write_b128 v13, v[64:67] offset:12288
    ds_write_b128 v13, v[68:71] offset:13312
    ds_write_b128 v13, v[72:75] offset:14336
    ds_write_b128 v13, v[76:79] offset:15360
    ds_write_b128 v13, v[80:83] offset:16384
    ds_write_b128 v13, v[84:87] offset:17408
    ds_write_b128 v13, v[88:91] offset:18432
    ds_write_b128 v13, v[92:95] offset:19456
    ds_write_b128 v13, v[96:99] offset:20480
    ds_write_b128 v13, v[100:103] offset:21504
    ds_write_b128 v13, v[104:107] offset:22528
    ds_write_b128 v13, v[108:111] offset:23552
    ds_write_b128 v13, v[112:115] offset:24576
    ds_write_b128 v13, v[116:119] offset:25600
    ds_write_b128 v13, v[120:123] offset:26624
    ds_write_b128 v13, v[124:127] offset:27648
    ds_write_b128 v13, v[128:131] offset:28672
    ds_write_b128 v13, v[132:135] offset:29696
    s_add_u32 s21, s20, 16384
    buffer_load_dwordx4 a[128:131], v1, s[8:11], s21 offen offset:0
    buffer_load_dwordx4 a[132:135], v1, s[8:11], s21 offen offset:1024
    s_add_u32 s21, s20, 57344
    buffer_load_dwordx4 a[136:139], v1, s[8:11], s21 offen offset:0
    buffer_load_dwordx4 a[140:143], v1, s[8:11], s21 offen offset:1024
    s_add_u32 s21, s20, 38912
    buffer_load_dwordx4 a[144:147], v1, s[8:11], s21 offen offset:0
    buffer_load_dwordx4 a[148:151], v1, s[8:11], s21 offen offset:1024
    s_add_u32 s21, s20, 61440
    buffer_load_dwordx4 a[152:155], v1, s[8:11], s21 offen offset:0
    buffer_load_dwordx4 a[156:159], v1, s[8:11], s21 offen offset:1024
    s_add_u32 s21, s20, 63488
    buffer_load_dwordx4 a[160:163], v1, s[8:11], s21 offen offset:0
    buffer_load_dwordx4 a[164:167], v1, s[8:11], s21 offen offset:1024
    s_add_u32 s21, s20, 65536
    buffer_load_dwordx4 a[168:171], v1, s[8:11], s21 offen offset:0
    buffer_load_dwordx4 a[172:175], v1, s[8:11], s21 offen offset:1024
    s_add_u32 s21, s20, 67584
    buffer_load_dwordx4 a[176:179], v1, s[8:11], s21 offen offset:0
    buffer_load_dwordx4 a[180:183], v1, s[8:11], s21 offen offset:1024
    s_add_u32 s21, s20, 69632
    buffer_load_dwordx4 a[184:187], v1, s[8:11], s21 offen offset:0
    buffer_load_dwordx4 a[188:191], v1, s[8:11], s21 offen offset:1024
    s_add_u32 s21, s20, 71680
    buffer_load_dwordx4 a[192:195], v1, s[8:11], s21 offen offset:0
    buffer_load_dwordx4 a[196:199], v1, s[8:11], s21 offen offset:1024
    s_add_u32 s21, s20, 73728
    buffer_load_dwordx4 a[200:203], v1, s[8:11], s21 offen offset:0
    buffer_load_dwordx4 a[204:207], v1, s[8:11], s21 offen offset:1024
    s_add_u32 s21, s20, 75776
    buffer_load_dwordx4 a[208:211], v1, s[8:11], s21 offen offset:0
    buffer_load_dwordx4 a[212:215], v1, s[8:11], s21 offen offset:1024
    s_add_u32 s21, s20, 77824
    buffer_load_dwordx4 a[216:219], v1, s[8:11], s21 offen offset:0
    buffer_load_dwordx4 a[220:223], v1, s[8:11], s21 offen offset:1024
    s_add_u32 s21, s20, 79872
    buffer_load_dwordx4 a[224:227], v1, s[8:11], s21 offen offset:0
    buffer_load_dwordx4 a[228:231], v1, s[8:11], s21 offen offset:1024
    s_add_u32 s21, s20, 81920
    buffer_load_dwordx4 a[232:235], v1, s[8:11], s21 offen offset:0
    buffer_load_dwordx4 a[236:239], v1, s[8:11], s21 offen offset:1024
    s_add_u32 s21, s20, 83968
    buffer_load_dwordx4 a[240:243], v1, s[8:11], s21 offen offset:0
    buffer_load_dwordx4 a[244:247], v1, s[8:11], s21 offen offset:1024
    s_add_u32 s21, s20, 86016
    buffer_load_dwordx4 a[248:251], v1, s[8:11], s21 offen offset:0
    buffer_load_dwordx4 a[252:255], v1, s[8:11], s21 offen offset:1024
    s_add_u32 s21, s20, 88064
    buffer_load_dwordx4 v[148:151], v1, s[8:11], s21 offen offset:0
    buffer_load_dwordx4 v[152:155], v1, s[8:11], s21 offen offset:1024
    s_add_u32 s21, s20, 92160
    buffer_load_dwordx4 v[156:159], v1, s[8:11], s21 offen offset:0
    buffer_load_dwordx4 v[160:163], v1, s[8:11], s21 offen offset:1024
    s_add_u32 s21, s20, 94208
    buffer_load_dwordx4 v[164:167], v1, s[8:11], s21 offen offset:0
    buffer_load_dwordx4 v[168:171], v1, s[8:11], s21 offen offset:1024
    s_add_u32 s21, s20, 96256
    buffer_load_dwordx4 v[172:175], v1, s[8:11], s21 offen offset:0
    buffer_load_dwordx4 v[176:179], v1, s[8:11], s21 offen offset:1024
    s_add_u32 s21, s20, 100352
    buffer_load_dwordx4 v[180:183], v1, s[8:11], s21 offen offset:0
    buffer_load_dwordx4 v[184:187], v1, s[8:11], s21 offen offset:1024
    s_add_u32 s21, s20, 102400
    buffer_load_dwordx4 v[188:191], v1, s[8:11], s21 offen offset:0
    buffer_load_dwordx4 v[192:195], v1, s[8:11], s21 offen offset:1024
    s_add_u32 s21, s20, 104448
    buffer_load_dwordx4 v[196:199], v1, s[8:11], s21 offen offset:0
    buffer_load_dwordx4 v[200:203], v1, s[8:11], s21 offen offset:1024
    s_add_u32 s21, s20, 108544
    buffer_load_dwordx4 v[204:207], v1, s[8:11], s21 offen offset:0
    buffer_load_dwordx4 v[208:211], v1, s[8:11], s21 offen offset:1024
    s_add_u32 s21, s20, 110592
    buffer_load_dwordx4 v[212:215], v1, s[8:11], s21 offen offset:0
    buffer_load_dwordx4 v[216:219], v1, s[8:11], s21 offen offset:1024
    s_add_u32 s21, s20, 112640
    buffer_load_dwordx4 v[220:223], v1, s[8:11], s21 offen offset:0
    buffer_load_dwordx4 v[224:227], v1, s[8:11], s21 offen offset:1024
    s_add_u32 s21, s20, 116736
    buffer_load_dwordx4 v[228:231], v1, s[8:11], s21 offen offset:0
    buffer_load_dwordx4 v[232:235], v1, s[8:11], s21 offen offset:1024
    s_add_u32 s21, s20, 118784
    buffer_load_dwordx4 v[236:239], v1, s[8:11], s21 offen offset:0
    buffer_load_dwordx4 v[240:243], v1, s[8:11], s21 offen offset:1024
    s_add_u32 s21, s20, 120832
    buffer_load_dwordx4 v[244:247], v1, s[8:11], s21 offen offset:0
    buffer_load_dwordx4 v[248:251], v1, s[8:11], s21 offen offset:1024
    s_waitcnt lgkmcnt(0)
    s_mov_b32 s14, 0
    s_cmp_gt_u32 s47, s14
    s_cbranch_scc1 layerb1_kernel_p2_gw1_ok
layerb1_kernel_p2_gw1_lp:
    buffer_load_dword v253, v255, s[8:11], s48 offen sc1
    s_waitcnt vmcnt(0)
    v_readlane_b32 s47, v253, 0
    v_readlane_b32 s29, v253, 1
    s_nop 0
    s_min_u32 s47, s47, s29
    s_sub_u32 s15, s15, 1
    s_cbranch_scc1 layerb1_kernel_bail
    s_cmp_gt_u32 s47, s14
    s_cbranch_scc0 layerb1_kernel_p2_gw1_lp
layerb1_kernel_p2_gw1_ok:
    s_mul_i32 s20, s14, 393216
    s_add_u32 s20, s20, s44
    s_add_u32 s21, s20, 8192
    buffer_load_dwordx4 v[100:103], v9, s[8:11], s21 offen offset:0 sc1
    buffer_load_dwordx4 v[104:107], v9, s[8:11], s21 offen offset:512 sc1
    v_mov_b32 v56, 0
    v_mov_b32 v57, 0
    v_mov_b32 v58, 0
    v_mov_b32 v59, 0
    v_mov_b32 v60, 0
    v_mov_b32 v61, 0
    v_mov_b32 v62, 0
    v_mov_b32 v63, 0
    v_mov_b32 v64, 0
    v_mov_b32 v65, 0
    v_mov_b32 v66, 0
    v_mov_b32 v67, 0
    v_mov_b32 v68, 0
    v_mov_b32 v69, 0
    v_mov_b32 v70, 0
    v_mov_b32 v71, 0
    v_mov_b32 v72, 0
    v_mov_b32 v73, 0
    v_mov_b32 v74, 0
    v_mov_b32 v75, 0
    v_mov_b32 v76, 0
    v_mov_b32 v77, 0
    v_mov_b32 v78, 0
    v_mov_b32 v79, 0
    v_mov_b32 v80, 0
    v_mov_b32 v81, 0
    v_mov_b32 v82, 0
    v_mov_b32 v83, 0
    v_mov_b32 v84, 0
    v_mov_b32 v85, 0
    v_mov_b32 v86, 0
    v_mov_b32 v87, 0
    ds_read_b128 v[116:119], v13 offset:0
    ds_read_b128 v[120:123], v13 offset:1024
    ds_read_b128 v[124:127], v13 offset:2048
    ds_read_b128 v[128:131], v13 offset:3072
    ds_read_b128 v[132:135], v13 offset:4096
    ds_read_b128 v[136:139], v13 offset:5120
    ds_read_b128 v[140:143], v13 offset:6144
    ds_read_b128 v[144:147], v13 offset:7168
    s_waitcnt lgkmcnt(0)
layerb1_kernel_p2_step:
    s_cmp_lt_u32 s14, 32
    s_cselect_b32 s18, s16, s17
    s_and_b32 s20, s14, 31
    s_lshl_b32 s20, s20, 16
    s_add_u32 s18, s18, s20
    s_add_u32 s22, s18, 51200
    s_add_u32 s23, s18, 52224
layerb1_kernel_p2_poll:
    buffer_load_dwordx4 v[40:43], v1, s[8:11], s22 offen sc1
    buffer_load_dwordx4 v[44:47], v1, s[8:11], s23 offen sc1
    s_waitcnt vmcnt(0)
    ds_write_b128 v14, v[40:43] offset:6144
    ds_write_b128 v14, v[44:47] offset:7168
    v_max3_u32 v88, v40, v41, v42
    v_max3_u32 v88, v88, v43, v44
    v_max3_u32 v88, v88, v45, v46
    v_max_u32 v88, v88, v47
    v_cmp_eq_u32 vcc, -1, v88
    s_sub_u32 s15, s15, 1
    s_cbranch_scc1 layerb1_kernel_bail
    s_cbranch_vccnz layerb1_kernel_p2_poll
    s_waitcnt lgkmcnt(0)
    s_barrier
    ds_read_b128 v[16:19], v14 offset:0
    ds_read_b128 v[20:23], v14 offset:1024
    ds_read_b128 v[24:27], v14 offset:2048
    ds_read_b128 v[28:31], v14 offset:3072
    ds_read_b128 v[32:35], v14 offset:4096
    ds_read_b128 v[36:39], v14 offset:5120
    ds_read_b128 v[48:51], v14 offset:8192
    ds_read_b128 v[52:55], v14 offset:9216
    v_smfmac_f32_16x16x64_bf16 v[56:59], v[40:43], a[0:7], v2
    v_smfmac_f32_16x16x64_bf16 v[60:63], v[40:43], a[8:15], v2
    v_smfmac_f32_16x16x64_bf16 v[64:67], v[40:43], a[16:23], v2
    v_smfmac_f32_16x16x64_bf16 v[56:59], v[44:47], a[24:31], v2
    v_smfmac_f32_16x16x64_bf16 v[60:63], v[44:47], a[32:39], v2
    v_smfmac_f32_16x16x64_bf16 v[64:67], v[44:47], a[40:47], v2
    s_waitcnt lgkmcnt(7)
    v_smfmac_f32_16x16x64_bf16 v[56:59], v[16:19], a[48:55], v2
    v_smfmac_f32_16x16x64_bf16 v[60:63], v[16:19], a[56:63], v2
    v_smfmac_f32_16x16x64_bf16 v[64:67], v[16:19], a[64:71], v2
    s_waitcnt lgkmcnt(6)
    v_smfmac_f32_16x16x64_bf16 v[56:59], v[20:23], v[116:123], v2
    ds_read_b128 v[116:119], v13 offset:8192
    ds_read_b128 v[120:123], v13 offset:9216
    v_smfmac_f32_16x16x64_bf16 v[60:63], v[20:23], a[72:79], v2
    v_smfmac_f32_16x16x64_bf16 v[64:67], v[20:23], v[124:131], v2
    ds_read_b128 v[124:127], v13 offset:10240
    ds_read_b128 v[128:131], v13 offset:11264
    s_waitcnt lgkmcnt(9)
    v_smfmac_f32_16x16x64_bf16 v[56:59], v[24:27], a[80:87], v2
    v_smfmac_f32_16x16x64_bf16 v[60:63], v[24:27], v[132:139], v2
    ds_read_b128 v[132:135], v13 offset:12288
    ds_read_b128 v[136:139], v13 offset:13312
    v_smfmac_f32_16x16x64_bf16 v[64:67], v[24:27], a[88:95], v2
    s_waitcnt lgkmcnt(10)
    v_smfmac_f32_16x16x64_bf16 v[56:59], v[28:31], v[140:147], v2
    ds_read_b128 v[140:143], v13 offset:14336
    ds_read_b128 v[144:147], v13 offset:15360
    v_smfmac_f32_16x16x64_bf16 v[60:63], v[28:31], a[96:103], v2
    s_waitcnt lgkmcnt(6)
    v_smfmac_f32_16x16x64_bf16 v[64:67], v[28:31], v[116:123], v2
    ds_read_b128 v[116:119], v13 offset:16384
    ds_read_b128 v[120:123], v13 offset:17408
    v_smfmac_f32_16x16x64_bf16 v[56:59], v[32:35], a[104:111], v2
    s_waitcnt lgkmcnt(6)
    v_smfmac_f32_16x16x64_bf16 v[60:63], v[32:35], v[124:131], v2
    ds_read_b128 v[124:127], v13 offset:18432
    ds_read_b128 v[128:131], v13 offset:19456
    v_smfmac_f32_16x16x64_bf16 v[64:67], v[32:35], a[112:119], v2
    s_waitcnt lgkmcnt(6)
    v_smfmac_f32_16x16x64_bf16 v[56:59], v[36:39], v[132:139], v2
    ds_read_b128 v[132:135], v13 offset:20480
    ds_read_b128 v[136:139], v13 offset:21504
    v_smfmac_f32_16x16x64_bf16 v[60:63], v[36:39], a[120:127], v2
    s_waitcnt lgkmcnt(6)
    v_smfmac_f32_16x16x64_bf16 v[64:67], v[36:39], v[140:147], v2
    ds_read_b128 v[140:143], v13 offset:22528
    ds_read_b128 v[144:147], v13 offset:23552
    v_smfmac_f32_16x16x64_bf16 v[56:59], v[48:51], a[128:135], v2
    s_waitcnt lgkmcnt(6)
    v_smfmac_f32_16x16x64_bf16 v[60:63], v[48:51], v[116:123], v2
    ds_read_b128 v[116:119], v13 offset:24576
    ds_read_b128 v[120:123], v13 offset:25600
    v_smfmac_f32_16x16x64_bf16 v[64:67], v[48:51], a[136:143], v2
    s_waitcnt lgkmcnt(6)
    v_smfmac_f32_16x16x64_bf16 v[56:59], v[52:55], v[124:131], v2
    ds_read_b128 v[124:127], v13 offset:26624
    ds_read_b128 v[128:131], v13 offset:27648
    v_smfmac_f32_16x16x64_bf16 v[60:63], v[52:55], a[144:151], v2
    s_waitcnt lgkmcnt(6)
    v_smfmac_f32_16x16x64_bf16 v[64:67], v[52:55], v[132:139], v2
    ds_read_b128 v[132:135], v13 offset:28672
    ds_read_b128 v[136:139], v13 offset:29696
    v_smfmac_f32_16x16x64_bf16 v[68:71], v[16:19], a[152:159], v2
    v_smfmac_f32_16x16x64_bf16 v[68:71], v[20:23], a[160:167], v2
    v_permlane32_swap_b32 v56, v58
    v_permlane32_swap_b32 v57, v59
    v_smfmac_f32_16x16x64_bf16 v[68:71], v[24:27], a[168:175], v2
    v_add_f32 v56, v56, v58
    v_add_f32 v57, v57, v59
    v_smfmac_f32_16x16x64_bf16 v[68:71], v[28:31], a[176:183], v2
    v_cvt_pk_bf16_f32 v56, v56, v57
    ds_write_b16 v3, v56 offset:0
    v_smfmac_f32_16x16x64_bf16 v[68:71], v[32:35], a[184:191], v2
    ds_write_b16_d16_hi v3, v56 offset:400
    v_permlane32_swap_b32 v60, v62
    v_smfmac_f32_16x16x64_bf16 v[68:71], v[36:39], a[192:199], v2
    v_permlane32_swap_b32 v61, v63
    v_add_f32 v60, v60, v62
    v_smfmac_f32_16x16x64_bf16 v[68:71], v[40:43], a[200:207], v2
    v_add_f32 v61, v61, v63
    v_cvt_pk_bf16_f32 v60, v60, v61
    v_smfmac_f32_16x16x64_bf16 v[68:71], v[44:47], a[208:215], v2
    ds_write_b16 v3, v60 offset:32
    ds_write_b16_d16_hi v3, v60 offset:432
    v_smfmac_f32_16x16x64_bf16 v[68:71], v[48:51], a[216:223], v2
    v_permlane32_swap_b32 v64, v66
    v_permlane32_swap_b32 v65, v67
    v_smfmac_f32_16x16x64_bf16 v[68:71], v[52:55], a[224:231], v2
    v_add_f32 v64, v64, v66
    v_add_f32 v65, v65, v67
    v_smfmac_f32_16x16x64_bf16 v[72:75], v[16:19], a[232:239], v2
    v_cvt_pk_bf16_f32 v64, v64, v65
    ds_write_b16 v3, v64 offset:64
    v_smfmac_f32_16x16x64_bf16 v[72:75], v[20:23], a[240:247], v2
    ds_write_b16_d16_hi v3, v64 offset:464
    v_smfmac_f32_16x16x64_bf16 v[72:75], v[24:27], a[248:255], v2
    v_smfmac_f32_16x16x64_bf16 v[72:75], v[28:31], v[148:155], v2
    s_waitcnt lgkmcnt(0)
    s_barrier
    ds_read_b128 v[88:91], v4 offset:0
    v_smfmac_f32_16x16x64_bf16 v[72:75], v[32:35], v[140:147], v2
    ds_read_b128 v[92:95], v4 offset:128
    ds_read_b128 v[96:99], v4 offset:256
    v_smfmac_f32_16x16x64_bf16 v[72:75], v[36:39], v[156:163], v2
    v_permlane32_swap_b32 v68, v70
    v_permlane32_swap_b32 v69, v71
    v_smfmac_f32_16x16x64_bf16 v[72:75], v[40:43], v[164:171], v2
    v_add_f32 v68, v68, v70
    v_add_f32 v69, v69, v71
    v_smfmac_f32_16x16x64_bf16 v[72:75], v[44:47], v[172:179], v2
    v_cvt_pk_bf16_f32 v68, v68, v69
    ds_write_b16 v3, v68 offset:3200
    v_smfmac_f32_16x16x64_bf16 v[72:75], v[48:51], v[116:123], v2
    ds_write_b16_d16_hi v3, v68 offset:3600
    v_smfmac_f32_16x16x64_bf16 v[72:75], v[52:55], v[180:187], v2
    s_waitcnt lgkmcnt(2)
    v_smfmac_f32_16x16x64_bf16 v[80:83], v[96:99], v[100:107], v2
    v_smfmac_f32_16x16x64_bf16 v[76:79], v[16:19], v[188:195], v2
    v_smfmac_f32_16x16x64_bf16 v[76:79], v[20:23], v[196:203], v2
    v_smfmac_f32_16x16x64_bf16 v[76:79], v[24:27], v[124:131], v2
    v_permlane32_swap_b32 v72, v74
    v_permlane32_swap_b32 v73, v75
    v_smfmac_f32_16x16x64_bf16 v[76:79], v[28:31], v[204:211], v2
    v_add_f32 v72, v72, v74
    v_add_f32 v73, v73, v75
    ds_write_b128 v15, v[80:83]
    v_smfmac_f32_16x16x64_bf16 v[76:79], v[32:35], v[212:219], v2
    v_cvt_pk_bf16_f32 v72, v72, v73
    ds_write_b16 v3, v72 offset:3232
    v_smfmac_f32_16x16x64_bf16 v[76:79], v[36:39], v[220:227], v2
    ds_write_b16_d16_hi v3, v72 offset:3632
    v_smfmac_f32_16x16x64_bf16 v[76:79], v[40:43], v[132:139], v2
    v_smfmac_f32_16x16x64_bf16 v[76:79], v[44:47], v[228:235], v2
    v_smfmac_f32_16x16x64_bf16 v[76:79], v[48:51], v[236:243], v2
    v_smfmac_f32_16x16x64_bf16 v[76:79], v[52:55], v[244:251], v2
    s_nop 7
    v_permlane32_swap_b32 v76, v78
    v_permlane32_swap_b32 v77, v79
    v_add_f32 v76, v76, v78
    v_add_f32 v77, v77, v79
    v_cvt_pk_bf16_f32 v76, v76, v77
    ds_write_b16 v3, v76 offset:3264
    ds_write_b16_d16_hi v3, v76 offset:3664
    s_waitcnt lgkmcnt(0)
    s_barrier
    ds_read2st64_b32 v[40:41], v6 offset0:0 offset1:2
    ds_read2st64_b32 v[42:43], v6 offset0:8 offset1:10
    ds_read_b128 v[16:19], v5 offset:0
    ds_read_b128 v[20:23], v5 offset:16
    ds_read_b128 v[24:27], v5 offset:128
    ds_read_b128 v[28:31], v5 offset:144
    ds_read_b128 v[32:35], v5 offset:256
    ds_read_b128 v[36:39], v5 offset:272
    s_waitcnt lgkmcnt(6)
    v_add_f32 v40, v40, v41
    v_add_f32 v42, v42, v43
    v_add_f32 v44, v40, v42
    v_mul_f32 v44, 0x3dd53b95, v44
    s_waitcnt lgkmcnt(4)
    v_smfmac_f32_16x16x64_bf16 v[84:87], v[88:91], v[16:23], v2
    s_waitcnt lgkmcnt(2)
    v_smfmac_f32_16x16x64_bf16 v[84:87], v[92:95], v[24:31], v2
    s_waitcnt lgkmcnt(0)
    v_smfmac_f32_16x16x64_bf16 v[84:87], v[96:99], v[32:39], v2
    v_max_f32_dpp v45, v44, v44 row_ror:8 row_mask:0xf bank_mask:0xf
    s_nop 1
    v_max_f32_dpp v45, v45, v45 row_ror:4 row_mask:0xf bank_mask:0xf
    s_nop 1
    v_max_f32_dpp v45, v45, v45 row_ror:2 row_mask:0xf bank_mask:0xf
    s_nop 1
    v_max_f32_dpp v45, v45, v45 row_ror:1 row_mask:0xf bank_mask:0xf
    v_mov_b32 v47, v45
    s_nop 1
    v_permlane32_swap_b32 v45, v47
    v_max_f32 v45, v45, v47
    v_mov_b32 v47, v86
    s_nop 1
    v_permlane32_swap_b32 v86, v47
    v_add_f32 v48, v86, v47
    v_mul_f32 v48, 0x3dd53b95, v48
    s_nop 1
    v_max_f32_dpp v46, v48, v48 row_ror:4 row_mask:0xf bank_mask:0xf
    s_nop 1
    v_max_f32_dpp v46, v46, v46 row_ror:2 row_mask:0xf bank_mask:0xf
    s_nop 1
    v_max_f32_dpp v46, v46, v46 row_ror:1 row_mask:0xf bank_mask:0xf
    v_max_f32 v45, v45, v46
    v_sub_f32 v49, v44, v45
    v_sub_f32 v50, v48, v45
    v_exp_f32 v49, v49
    v_exp_f32 v50, v50
    s_nop 0
    v_fma_f32 v51, v50, v12, v49
    s_nop 1
    v_add_f32_dpp v51, v51, v51 row_ror:8 row_mask:0xf bank_mask:0xf
    s_nop 1
    v_add_f32_dpp v51, v51, v51 row_ror:4 row_mask:0xf bank_mask:0xf
    s_nop 1
    v_add_f32_dpp v51, v51, v51 row_ror:2 row_mask:0xf bank_mask:0xf
    s_nop 1
    v_add_f32_dpp v51, v51, v51 row_ror:1 row_mask:0xf bank_mask:0xf
    v_mov_b32 v47, v51
    s_nop 1
    v_permlane32_swap_b32 v51, v47
    v_add_f32 v51, v51, v47
    v_rcp_f32 v51, v51
    s_nop 0
    v_mul_f32 v49, v49, v51
    v_mul_f32 v50, v50, v51
    s_nop 0
    v_mov_b32_dpp v46, v49 quad_perm:[1,0,3,2] row_mask:0xf bank_mask:0xf
    v_mov_b32_dpp v47, v50 quad_perm:[1,0,3,2] row_mask:0xf bank_mask:0xf
    v_cvt_pk_bf16_f32 v16, v49, v46
    v_cvt_pk_bf16_f32 v20, v50, v47
    s_nop 0
    v_mov_b32_dpp v17, v16 row_shl:2 row_mask:0xf bank_mask:0xf
    v_mov_b32_dpp v18, v16 row_shl:4 row_mask:0xf bank_mask:0xf
    v_mov_b32_dpp v19, v16 row_shl:6 row_mask:0xf bank_mask:0xf
    v_mov_b32_dpp v21, v20 row_shl:2 row_mask:0xf bank_mask:0xf
    v_mov_b32_dpp v22, v20 row_shl:4 row_mask:0xf bank_mask:0xf
    v_mov_b32_dpp v23, v20 row_shl:6 row_mask:0xf bank_mask:0xf
    s_mov_b64 exec, s[40:41]
    buffer_store_dwordx4 v[16:19], v7, s[8:11], s18 offen sc1
    s_mov_b64 exec, s[42:43]
    buffer_store_dwordx4 v[20:23], v8, s[8:11], s18 offen sc1
    s_mov_b64 exec, -1
    ds_read_b128 v[40:43], v10
    s_add_u32 s28, s14, 1
    s_min_u32 s28, s28, 63
    s_cmp_gt_u32 s47, s28
    s_cbranch_scc1 layerb1_kernel_p2_gw2_ok
layerb1_kernel_p2_gw2_lp:
    buffer_load_dword v253, v255, s[8:11], s48 offen sc1
    s_waitcnt vmcnt(0)
    v_readlane_b32 s47, v253, 0
    v_readlane_b32 s29, v253, 1
    s_nop 0
    s_min_u32 s47, s47, s29
    s_sub_u32 s15, s15, 1
    s_cbranch_scc1 layerb1_kernel_bail
    s_cmp_gt_u32 s47, s28
    s_cbranch_scc0 layerb1_kernel_p2_gw2_lp
layerb1_kernel_p2_gw2_ok:
    s_mul_i32 s20, s28, 393216
    s_add_u32 s20, s20, s44
    s_add_u32 s21, s20, 8192
    buffer_load_dwordx4 v[100:103], v9, s[8:11], s21 offen offset:0 sc1
    buffer_load_dwordx4 v[104:107], v9, s[8:11], s21 offen offset:512 sc1
    v_mov_b32 v56, 0
    v_mov_b32 v57, 0
    v_mov_b32 v58, 0
    v_mov_b32 v59, 0
    v_mov_b32 v60, 0
    v_mov_b32 v61, 0
    v_mov_b32 v62, 0
    v_mov_b32 v63, 0
    v_mov_b32 v64, 0
    v_mov_b32 v65, 0
    v_mov_b32 v66, 0
    v_mov_b32 v67, 0
    v_mov_b32 v68, 0
    v_mov_b32 v69, 0
    v_mov_b32 v70, 0
    v_mov_b32 v71, 0
    v_mov_b32 v72, 0
    v_mov_b32 v73, 0
    v_mov_b32 v74, 0
    v_mov_b32 v75, 0
    v_mov_b32 v76, 0
    v_mov_b32 v77, 0
    v_mov_b32 v78, 0
    v_mov_b32 v79, 0
    v_mov_b32 v80, 0
    v_mov_b32 v81, 0
    v_mov_b32 v82, 0
    v_mov_b32 v83, 0
    v_mov_b32 v84, 0
    v_mov_b32 v85, 0
    v_mov_b32 v86, 0
    v_mov_b32 v87, 0
    s_waitcnt lgkmcnt(0)
    s_mul_i32 s20, s14, 98304
    s_add_u32 s20, s20, s45
    buffer_store_dwordx4 v[40:43], v11, s[8:11], s20 offen sc1
    ds_read_b128 v[116:119], v13 offset:0
    ds_read_b128 v[120:123], v13 offset:1024
    ds_read_b128 v[124:127], v13 offset:2048
    ds_read_b128 v[128:131], v13 offset:3072
    ds_read_b128 v[132:135], v13 offset:4096
    ds_read_b128 v[136:139], v13 offset:5120
    ds_read_b128 v[140:143], v13 offset:6144
    ds_read_b128 v[144:147], v13 offset:7168
    s_waitcnt lgkmcnt(0)
    s_add_u32 s14, s14, 1
    s_cmp_lt_u32 s14, 64
    s_cbranch_scc1 layerb1_kernel_p2_step
    s_waitcnt vmcnt(0)
    s_barrier
    s_branch layerb1_kernel_end
layerb1_kernel_p3_start:
    v_lshrrev_b32 v16, 4, v0
    v_and_b32 v17, 15, v0
    v_and_b32 v18, 1, v16
    v_lshlrev_b32 v18, 2, v18
    v_lshrrev_b32 v19, 1, v16
    v_lshl_add_u32 v18, v19, 1, v18
    v_mul_u32_u24 v18, 400, v18
    v_lshl_add_u32 v18, v17, 1, v18
    v_add_u32 v3, 133408, v18
    v_and_b32 v18, 7, v0
    v_mul_u32_u24 v18, 400, v18
    v_lshrrev_b32 v19, 3, v0
    v_lshl_add_u32 v18, v19, 4, v18
    v_add_u32 v4, 133120, v18
    v_and_b32 v18, 7, v0
    v_mul_u32_u24 v18, 400, v18
    v_lshl_add_u32 v18, v16, 5, v18
    v_add_u32 v5, 136320, v18
    v_lshrrev_b32 v18, 1, v16
    v_lshlrev_b32 v18, 10, v18
    v_and_b32 v19, 31, v0
    v_lshl_add_u32 v18, v19, 4, v18
    v_add_u32 v6, 139532, v18
    v_add_u32 v15, 142592, v1
    v_lshrrev_b32 v18, 1, v16
    v_lshlrev_b32 v18, 1, v18
    v_lshrrev_b32 v19, 3, v17
    v_add3_u32 v18, v18, v19, 1
    v_lshrrev_b32 v19, 1, v18
    v_lshlrev_b32 v19, 14, v19
    v_and_b32 v18, 1, v18
    v_lshl_add_u32 v18, v18, 12, v19
    v_and_b32 v19, 1, v16
    v_lshlrev_b32 v19, 4, v19
    v_add_u32 v19, 96, v19
    s_lshl_b32 s20, s12, 7
    v_add_u32 v8, s20, v19
    v_add_u32 v7, v8, v18
    v_lshlrev_b32 v18, 4, v17
    v_lshl_add_u32 v18, v16, 10, v18
    v_add_u32 v9, 256, v18
    v_add_u32 v18, 192, v0
    v_mul_u32_u24 v19, 2731, v18
    v_lshrrev_b32 v19, 16, v19
    v_mul_u32_u24 v20, 24, v19
    v_sub_u32 v20, v18, v20
    v_mul_u32_u24 v21, 400, v19
    v_lshl_add_u32 v21, v20, 4, v21
    v_add_u32 v10, 136320, v21
    v_lshlrev_b32 v21, 4, v19
    v_lshl_add_u32 v11, v20, 7, v21
    v_and_b32 v18, 0x28, v0
    v_cmp_eq_u32 vcc, 0, v18
    v_mov_b32 v18, 1.0
    v_mov_b32 v19, 0
    v_cndmask_b32 v12, v19, v18, vcc
    v_add_u32 v13, 92160, v1
    v_add_u32 v14, 122880, v1
    s_mul_i32 s44, s12, 12288
    s_add_u32 s44, s44, 53477376
    s_mul_i32 s45, s12, 3072
    s_add_u32 s45, s45, 208666624
    s_mul_i32 s20, s12, 6
    s_add_u32 s21, s20, 5
    s_lshr_b32 s20, s20, 3
    s_lshr_b32 s21, s21, 3
    s_add_u32 s20, s20, 80
    s_add_u32 s21, s21, 80
    s_lshl_b32 s20, s20, 7
    s_lshl_b32 s21, s21, 7
    v_mov_b32 v255, s21
    v_mov_b32 v253, s20
    v_cmp_eq_u32 vcc, 0, v0
    s_nop 1
    v_cndmask_b32 v255, v255, v253, vcc
    s_mov_b32 s47, 0
    s_mul_i32 s20, s12, 491520
    s_add_u32 s20, s20, 11902976
    s_add_u32 s21, s20, 2048
    buffer_load_dwordx4 v[16:19], v1, s[8:11], s21 offen offset:0
    buffer_load_dwordx4 v[20:23], v1, s[8:11], s21 offen offset:1024
    s_add_u32 s21, s20, 43008
    buffer_load_dwordx4 v[24:27], v1, s[8:11], s21 offen offset:0
    buffer_load_dwordx4 v[28:31], v1, s[8:11], s21 offen offset:1024
    s_add_u32 s21, s20, 24576
    buffer_load_dwordx4 v[32:35], v1, s[8:11], s21 offen offset:0
    buffer_load_dwordx4 v[36:39], v1, s[8:11], s21 offen offset:1024
    s_add_u32 s21, s20, 6144
    buffer_load_dwordx4 v[40:43], v1, s[8:11], s21 offen offset:0
    buffer_load_dwordx4 v[44:47], v1, s[8:11], s21 offen offset:1024
    s_add_u32 s21, s20, 47104
    buffer_load_dwordx4 v[48:51], v1, s[8:11], s21 offen offset:0
    buffer_load_dwordx4 v[52:55], v1, s[8:11], s21 offen offset:1024
    s_add_u32 s21, s20, 28672
    buffer_load_dwordx4 v[56:59], v1, s[8:11], s21 offen offset:0
    buffer_load_dwordx4 v[60:63], v1, s[8:11], s21 offen offset:1024
    s_add_u32 s21, s20, 10240
    buffer_load_dwordx4 v[64:67], v1, s[8:11], s21 offen offset:0
    buffer_load_dwordx4 v[68:71], v1, s[8:11], s21 offen offset:1024
    s_add_u32 s21, s20, 51200
    buffer_load_dwordx4 v[72:75], v1, s[8:11], s21 offen offset:0
    buffer_load_dwordx4 v[76:79], v1, s[8:11], s21 offen offset:1024
    s_add_u32 s21, s20, 32768
    buffer_load_dwordx4 v[80:83], v1, s[8:11], s21 offen offset:0
    buffer_load_dwordx4 v[84:87], v1, s[8:11], s21 offen offset:1024
    s_add_u32 s21, s20, 14336
    buffer_load_dwordx4 v[88:91], v1, s[8:11], s21 offen offset:0
    buffer_load_dwordx4 v[92:95], v1, s[8:11], s21 offen offset:1024
    s_add_u32 s21, s20, 55296
    buffer_load_dwordx4 v[96:99], v1, s[8:11], s21 offen offset:0
    buffer_load_dwordx4 v[100:103], v1, s[8:11], s21 offen offset:1024
    s_add_u32 s21, s20, 90112
    buffer_load_dwordx4 v[104:107], v1, s[8:11], s21 offen offset:0
    buffer_load_dwordx4 v[108:111], v1, s[8:11], s21 offen offset:1024
    s_add_u32 s21, s20, 98304
    buffer_load_dwordx4 v[112:115], v1, s[8:11], s21 offen offset:0
    buffer_load_dwordx4 v[116:119], v1, s[8:11], s21 offen offset:1024
    s_add_u32 s21, s20, 106496
    buffer_load_dwordx4 v[120:123], v1, s[8:11], s21 offen offset:0
    buffer_load_dwordx4 v[124:127], v1, s[8:11], s21 offen offset:1024
    s_add_u32 s21, s20, 114688
    buffer_load_dwordx4 v[128:131], v1, s[8:11], s21 offen offset:0
    buffer_load_dwordx4 v[132:135], v1, s[8:11], s21 offen offset:1024
    s_add_u32 s21, s20, 16384
    buffer_load_dwordx4 a[0:3], v1, s[8:11], s21 offen offset:0
    buffer_load_dwordx4 a[4:7], v1, s[8:11], s21 offen offset:1024
    s_add_u32 s21, s20, 36864
    buffer_load_dwordx4 a[8:11], v1, s[8:11], s21 offen offset:0
    buffer_load_dwordx4 a[12:15], v1, s[8:11], s21 offen offset:1024
    s_add_u32 s21, s20, 57344
    buffer_load_dwordx4 a[16:19], v1, s[8:11], s21 offen offset:0
    buffer_load_dwordx4 a[20:23], v1, s[8:11], s21 offen offset:1024
    s_add_u32 s21, s20, 18432
    buffer_load_dwordx4 a[24:27], v1, s[8:11], s21 offen offset:0
    buffer_load_dwordx4 a[28:31], v1, s[8:11], s21 offen offset:1024
    s_add_u32 s21, s20, 38912
    buffer_load_dwordx4 a[32:35], v1, s[8:11], s21 offen offset:0
    buffer_load_dwordx4 a[36:39], v1, s[8:11], s21 offen offset:1024
    s_add_u32 s21, s20, 59392
    buffer_load_dwordx4 a[40:43], v1, s[8:11], s21 offen offset:0
    buffer_load_dwordx4 a[44:47], v1, s[8:11], s21 offen offset:1024
    s_add_u32 s21, s20, 0
    buffer_load_dwordx4 a[48:51], v1, s[8:11], s21 offen offset:0
    buffer_load_dwordx4 a[52:55], v1, s[8:11], s21 offen offset:1024
    s_add_u32 s21, s20, 20480
    buffer_load_dwordx4 a[56:59], v1, s[8:11], s21 offen offset:0
    buffer_load_dwordx4 a[60:63], v1, s[8:11], s21 offen offset:1024
    s_add_u32 s21, s20, 40960
    buffer_load_dwordx4 a[64:67], v1, s[8:11], s21 offen offset:0
    buffer_load_dwordx4 a[68:71], v1, s[8:11], s21 offen offset:1024
    s_add_u32 s21, s20, 22528
    buffer_load_dwordx4 a[72:75], v1, s[8:11], s21 offen offset:0
    buffer_load_dwordx4 a[76:79], v1, s[8:11], s21 offen offset:1024
    s_add_u32 s21, s20, 4096
    buffer_load_dwordx4 a[80:83], v1, s[8:11], s21 offen offset:0
    buffer_load_dwordx4 a[84:87], v1, s[8:11], s21 offen offset:1024
    s_add_u32 s21, s20, 45056
    buffer_load_dwordx4 a[88:91], v1, s[8:11], s21 offen offset:0
    buffer_load_dwordx4 a[92:95], v1, s[8:11], s21 offen offset:1024
    s_add_u32 s21, s20, 26624
    buffer_load_dwordx4 a[96:99], v1, s[8:11], s21 offen offset:0
    buffer_load_dwordx4 a[100:103], v1, s[8:11], s21 offen offset:1024
    s_add_u32 s21, s20, 8192
    buffer_load_dwordx4 a[104:107], v1, s[8:11], s21 offen offset:0
    buffer_load_dwordx4 a[108:111], v1, s[8:11], s21 offen offset:1024
    s_add_u32 s21, s20, 49152
    buffer_load_dwordx4 a[112:115], v1, s[8:11], s21 offen offset:0
    buffer_load_dwordx4 a[116:119], v1, s[8:11], s21 offen offset:1024
    s_add_u32 s21, s20, 30720
    buffer_load_dwordx4 a[120:123], v1, s[8:11], s21 offen offset:0
    buffer_load_dwordx4 a[124:127], v1, s[8:11], s21 offen offset:1024
    s_waitcnt vmcnt(32)
    ds_write_b128 v13, v[16:19] offset:0
    ds_write_b128 v13, v[20:23] offset:1024
    ds_write_b128 v13, v[24:27] offset:2048
    ds_write_b128 v13, v[28:31] offset:3072
    ds_write_b128 v13, v[32:35] offset:4096
    ds_write_b128 v13, v[36:39] offset:5120
    ds_write_b128 v13, v[40:43] offset:6144
    ds_write_b128 v13, v[44:47] offset:7168
    ds_write_b128 v13, v[48:51] offset:8192
    ds_write_b128 v13, v[52:55] offset:9216
    ds_write_b128 v13, v[56:59] offset:10240
    ds_write_b128 v13, v[60:63] offset:11264
    ds_write_b128 v13, v[64:67] offset:12288
    ds_write_b128 v13, v[68:71] offset:13312
    ds_write_b128 v13, v[72:75] offset:14336
    ds_write_b128 v13, v[76:79] offset:15360
    ds_write_b128 v13, v[80:83] offset:16384
    ds_write_b128 v13, v[84:87] offset:17408
    ds_write_b128 v13, v[88:91] offset:18432
    ds_write_b128 v13, v[92:95] offset:19456
    ds_write_b128 v13, v[96:99] offset:20480
    ds_write_b128 v13, v[100:103] offset:21504
    ds_write_b128 v13, v[104:107] offset:22528
    ds_write_b128 v13, v[108:111] offset:23552
    ds_write_b128 v13, v[112:115] offset:24576
    ds_write_b128 v13, v[116:119] offset:25600
    ds_write_b128 v13, v[120:123] offset:26624
    ds_write_b128 v13, v[124:127] offset:27648
    ds_write_b128 v13, v[128:131] offset:28672
    ds_write_b128 v13, v[132:135] offset:29696
    s_add_u32 s21, s20, 12288
    buffer_load_dwordx4 a[128:131], v1, s[8:11], s21 offen offset:0
    buffer_load_dwordx4 a[132:135], v1, s[8:11], s21 offen offset:1024
    s_add_u32 s21, s20, 53248
    buffer_load_dwordx4 a[136:139], v1, s[8:11], s21 offen offset:0
    buffer_load_dwordx4 a[140:143], v1, s[8:11], s21 offen offset:1024
    s_add_u32 s21, s20, 34816
    buffer_load_dwordx4 a[144:147], v1, s[8:11], s21 offen offset:0
    buffer_load_dwordx4 a[148:151], v1, s[8:11], s21 offen offset:1024
    s_add_u32 s21, s20, 61440
    buffer_load_dwordx4 a[152:155], v1, s[8:11], s21 offen offset:0
    buffer_load_dwordx4 a[156:159], v1, s[8:11], s21 offen offset:1024
    s_add_u32 s21, s20, 63488
    buffer_load_dwordx4 a[160:163], v1, s[8:11], s21 offen offset:0
    buffer_load_dwordx4 a[164:167], v1, s[8:11], s21 offen offset:1024
    s_add_u32 s21, s20, 65536
    buffer_load_dwordx4 a[168:171], v1, s[8:11], s21 offen offset:0
    buffer_load_dwordx4 a[172:175], v1, s[8:11], s21 offen offset:1024
    s_add_u32 s21, s20, 67584
    buffer_load_dwordx4 a[176:179], v1, s[8:11], s21 offen offset:0
    buffer_load_dwordx4 a[180:183], v1, s[8:11], s21 offen offset:1024
    s_add_u32 s21, s20, 69632
    buffer_load_dwordx4 a[184:187], v1, s[8:11], s21 offen offset:0
    buffer_load_dwordx4 a[188:191], v1, s[8:11], s21 offen offset:1024
    s_add_u32 s21, s20, 71680
    buffer_load_dwordx4 a[192:195], v1, s[8:11], s21 offen offset:0
    buffer_load_dwordx4 a[196:199], v1, s[8:11], s21 offen offset:1024
    s_add_u32 s21, s20, 73728
    buffer_load_dwordx4 a[200:203], v1, s[8:11], s21 offen offset:0
    buffer_load_dwordx4 a[204:207], v1, s[8:11], s21 offen offset:1024
    s_add_u32 s21, s20, 75776
    buffer_load_dwordx4 a[208:211], v1, s[8:11], s21 offen offset:0
    buffer_load_dwordx4 a[212:215], v1, s[8:11], s21 offen offset:1024
    s_add_u32 s21, s20, 77824
    buffer_load_dwordx4 a[216:219], v1, s[8:11], s21 offen offset:0
    buffer_load_dwordx4 a[220:223], v1, s[8:11], s21 offen offset:1024
    s_add_u32 s21, s20, 79872
    buffer_load_dwordx4 a[224:227], v1, s[8:11], s21 offen offset:0
    buffer_load_dwordx4 a[228:231], v1, s[8:11], s21 offen offset:1024
    s_add_u32 s21, s20, 81920
    buffer_load_dwordx4 a[232:235], v1, s[8:11], s21 offen offset:0
    buffer_load_dwordx4 a[236:239], v1, s[8:11], s21 offen offset:1024
    s_add_u32 s21, s20, 83968
    buffer_load_dwordx4 a[240:243], v1, s[8:11], s21 offen offset:0
    buffer_load_dwordx4 a[244:247], v1, s[8:11], s21 offen offset:1024
    s_add_u32 s21, s20, 86016
    buffer_load_dwordx4 a[248:251], v1, s[8:11], s21 offen offset:0
    buffer_load_dwordx4 a[252:255], v1, s[8:11], s21 offen offset:1024
    s_add_u32 s21, s20, 88064
    buffer_load_dwordx4 v[148:151], v1, s[8:11], s21 offen offset:0
    buffer_load_dwordx4 v[152:155], v1, s[8:11], s21 offen offset:1024
    s_add_u32 s21, s20, 92160
    buffer_load_dwordx4 v[156:159], v1, s[8:11], s21 offen offset:0
    buffer_load_dwordx4 v[160:163], v1, s[8:11], s21 offen offset:1024
    s_add_u32 s21, s20, 94208
    buffer_load_dwordx4 v[164:167], v1, s[8:11], s21 offen offset:0
    buffer_load_dwordx4 v[168:171], v1, s[8:11], s21 offen offset:1024
    s_add_u32 s21, s20, 96256
    buffer_load_dwordx4 v[172:175], v1, s[8:11], s21 offen offset:0
    buffer_load_dwordx4 v[176:179], v1, s[8:11], s21 offen offset:1024
    s_add_u32 s21, s20, 100352
    buffer_load_dwordx4 v[180:183], v1, s[8:11], s21 offen offset:0
    buffer_load_dwordx4 v[184:187], v1, s[8:11], s21 offen offset:1024
    s_add_u32 s21, s20, 102400
    buffer_load_dwordx4 v[188:191], v1, s[8:11], s21 offen offset:0
    buffer_load_dwordx4 v[192:195], v1, s[8:11], s21 offen offset:1024
    s_add_u32 s21, s20, 104448
    buffer_load_dwordx4 v[196:199], v1, s[8:11], s21 offen offset:0
    buffer_load_dwordx4 v[200:203], v1, s[8:11], s21 offen offset:1024
    s_add_u32 s21, s20, 108544
    buffer_load_dwordx4 v[204:207], v1, s[8:11], s21 offen offset:0
    buffer_load_dwordx4 v[208:211], v1, s[8:11], s21 offen offset:1024
    s_add_u32 s21, s20, 110592
    buffer_load_dwordx4 v[212:215], v1, s[8:11], s21 offen offset:0
    buffer_load_dwordx4 v[216:219], v1, s[8:11], s21 offen offset:1024
    s_add_u32 s21, s20, 112640
    buffer_load_dwordx4 v[220:223], v1, s[8:11], s21 offen offset:0
    buffer_load_dwordx4 v[224:227], v1, s[8:11], s21 offen offset:1024
    s_add_u32 s21, s20, 116736
    buffer_load_dwordx4 v[228:231], v1, s[8:11], s21 offen offset:0
    buffer_load_dwordx4 v[232:235], v1, s[8:11], s21 offen offset:1024
    s_add_u32 s21, s20, 118784
    buffer_load_dwordx4 v[236:239], v1, s[8:11], s21 offen offset:0
    buffer_load_dwordx4 v[240:243], v1, s[8:11], s21 offen offset:1024
    s_add_u32 s21, s20, 120832
    buffer_load_dwordx4 v[244:247], v1, s[8:11], s21 offen offset:0
    buffer_load_dwordx4 v[248:251], v1, s[8:11], s21 offen offset:1024
    s_waitcnt lgkmcnt(0)
    s_mov_b32 s14, 0
    s_cmp_gt_u32 s47, s14
    s_cbranch_scc1 layerb1_kernel_p3_gw1_ok
layerb1_kernel_p3_gw1_lp:
    buffer_load_dword v253, v255, s[8:11], s48 offen sc1
    s_waitcnt vmcnt(0)
    v_readlane_b32 s47, v253, 0
    v_readlane_b32 s29, v253, 1
    s_nop 0
    s_min_u32 s47, s47, s29
    s_sub_u32 s15, s15, 1
    s_cbranch_scc1 layerb1_kernel_bail
    s_cmp_gt_u32 s47, s14
    s_cbranch_scc0 layerb1_kernel_p3_gw1_lp
layerb1_kernel_p3_gw1_ok:
    s_mul_i32 s20, s14, 393216
    s_add_u32 s20, s20, s44
    s_add_u32 s21, s20, 8192
    buffer_load_dwordx4 v[100:103], v9, s[8:11], s21 offen offset:0 sc1
    buffer_load_dwordx4 v[104:107], v9, s[8:11], s21 offen offset:512 sc1
    v_mov_b32 v56, 0
    v_mov_b32 v57, 0
    v_mov_b32 v58, 0
    v_mov_b32 v59, 0
    v_mov_b32 v60, 0
    v_mov_b32 v61, 0
    v_mov_b32 v62, 0
    v_mov_b32 v63, 0
    v_mov_b32 v64, 0
    v_mov_b32 v65, 0
    v_mov_b32 v66, 0
    v_mov_b32 v67, 0
    v_mov_b32 v68, 0
    v_mov_b32 v69, 0
    v_mov_b32 v70, 0
    v_mov_b32 v71, 0
    v_mov_b32 v72, 0
    v_mov_b32 v73, 0
    v_mov_b32 v74, 0
    v_mov_b32 v75, 0
    v_mov_b32 v76, 0
    v_mov_b32 v77, 0
    v_mov_b32 v78, 0
    v_mov_b32 v79, 0
    v_mov_b32 v80, 0
    v_mov_b32 v81, 0
    v_mov_b32 v82, 0
    v_mov_b32 v83, 0
    v_mov_b32 v84, 0
    v_mov_b32 v85, 0
    v_mov_b32 v86, 0
    v_mov_b32 v87, 0
    ds_read_b128 v[116:119], v13 offset:0
    ds_read_b128 v[120:123], v13 offset:1024
    ds_read_b128 v[124:127], v13 offset:2048
    ds_read_b128 v[128:131], v13 offset:3072
    ds_read_b128 v[132:135], v13 offset:4096
    ds_read_b128 v[136:139], v13 offset:5120
    ds_read_b128 v[140:143], v13 offset:6144
    ds_read_b128 v[144:147], v13 offset:7168
    s_waitcnt lgkmcnt(0)
layerb1_kernel_p3_step:
    s_cmp_lt_u32 s14, 32
    s_cselect_b32 s18, s16, s17
    s_and_b32 s20, s14, 31
    s_lshl_b32 s20, s20, 16
    s_add_u32 s18, s18, s20
    s_add_u32 s22, s18, 53248
    s_add_u32 s23, s18, 54272
layerb1_kernel_p3_poll:
    buffer_load_dwordx4 v[48:51], v1, s[8:11], s22 offen sc1
    buffer_load_dwordx4 v[52:55], v1, s[8:11], s23 offen sc1
    s_waitcnt vmcnt(0)
    ds_write_b128 v14, v[48:51] offset:8192
    ds_write_b128 v14, v[52:55] offset:9216
    v_max3_u32 v88, v48, v49, v50
    v_max3_u32 v88, v88, v51, v52
    v_max3_u32 v88, v88, v53, v54
    v_max_u32 v88, v88, v55
    v_cmp_eq_u32 vcc, -1, v88
    s_sub_u32 s15, s15, 1
    s_cbranch_scc1 layerb1_kernel_bail
    s_cbranch_vccnz layerb1_kernel_p3_poll
    s_waitcnt lgkmcnt(0)
    s_barrier
    ds_read_b128 v[16:19], v14 offset:0
    ds_read_b128 v[20:23], v14 offset:1024
    ds_read_b128 v[24:27], v14 offset:2048
    ds_read_b128 v[28:31], v14 offset:3072
    ds_read_b128 v[32:35], v14 offset:4096
    ds_read_b128 v[36:39], v14 offset:5120
    ds_read_b128 v[40:43], v14 offset:6144
    ds_read_b128 v[44:47], v14 offset:7168
    v_smfmac_f32_16x16x64_bf16 v[56:59], v[48:51], a[0:7], v2
    v_smfmac_f32_16x16x64_bf16 v[60:63], v[48:51], a[8:15], v2
    v_smfmac_f32_16x16x64_bf16 v[64:67], v[48:51], a[16:23], v2
    v_smfmac_f32_16x16x64_bf16 v[56:59], v[52:55], a[24:31], v2
    v_smfmac_f32_16x16x64_bf16 v[60:63], v[52:55], a[32:39], v2
    v_smfmac_f32_16x16x64_bf16 v[64:67], v[52:55], a[40:47], v2
    s_waitcnt lgkmcnt(7)
    v_smfmac_f32_16x16x64_bf16 v[56:59], v[16:19], a[48:55], v2
    v_smfmac_f32_16x16x64_bf16 v[60:63], v[16:19], a[56:63], v2
    v_smfmac_f32_16x16x64_bf16 v[64:67], v[16:19], a[64:71], v2
    s_waitcnt lgkmcnt(6)
    v_smfmac_f32_16x16x64_bf16 v[56:59], v[20:23], v[116:123], v2
    ds_read_b128 v[116:119], v13 offset:8192
    ds_read_b128 v[120:123], v13 offset:9216
    v_smfmac_f32_16x16x64_bf16 v[60:63], v[20:23], a[72:79], v2
    v_smfmac_f32_16x16x64_bf16 v[64:67], v[20:23], v[124:131], v2
    ds_read_b128 v[124:127], v13 offset:10240
    ds_read_b128 v[128:131], v13 offset:11264
    s_waitcnt lgkmcnt(9)
    v_smfmac_f32_16x16x64_bf16 v[56:59], v[24:27], a[80:87], v2
    v_smfmac_f32_16x16x64_bf16 v[60:63], v[24:27], v[132:139], v2
    ds_read_b128 v[132:135], v13 offset:12288
    ds_read_b128 v[136:139], v13 offset:13312
    v_smfmac_f32_16x16x64_bf16 v[64:67], v[24:27], a[88:95], v2
    s_waitcnt lgkmcnt(10)
    v_smfmac_f32_16x16x64_bf16 v[56:59], v[28:31], v[140:147], v2
    ds_read_b128 v[140:143], v13 offset:14336
    ds_read_b128 v[144:147], v13 offset:15360
    v_smfmac_f32_16x16x64_bf16 v[60:63], v[28:31], a[96:103], v2
    s_waitcnt lgkmcnt(6)
    v_smfmac_f32_16x16x64_bf16 v[64:67], v[28:31], v[116:123], v2
    ds_read_b128 v[116:119], v13 offset:16384
    ds_read_b128 v[120:123], v13 offset:17408
    v_smfmac_f32_16x16x64_bf16 v[56:59], v[32:35], a[104:111], v2
    s_waitcnt lgkmcnt(6)
    v_smfmac_f32_16x16x64_bf16 v[60:63], v[32:35], v[124:131], v2
    ds_read_b128 v[124:127], v13 offset:18432
    ds_read_b128 v[128:131], v13 offset:19456
    v_smfmac_f32_16x16x64_bf16 v[64:67], v[32:35], a[112:119], v2
    s_waitcnt lgkmcnt(6)
    v_smfmac_f32_16x16x64_bf16 v[56:59], v[36:39], v[132:139], v2
    ds_read_b128 v[132:135], v13 offset:20480
    ds_read_b128 v[136:139], v13 offset:21504
    v_smfmac_f32_16x16x64_bf16 v[60:63], v[36:39], a[120:127], v2
    s_waitcnt lgkmcnt(6)
    v_smfmac_f32_16x16x64_bf16 v[64:67], v[36:39], v[140:147], v2
    ds_read_b128 v[140:143], v13 offset:22528
    ds_read_b128 v[144:147], v13 offset:23552
    v_smfmac_f32_16x16x64_bf16 v[56:59], v[40:43], a[128:135], v2
    s_waitcnt lgkmcnt(6)
    v_smfmac_f32_16x16x64_bf16 v[60:63], v[40:43], v[116:123], v2
    ds_read_b128 v[116:119], v13 offset:24576
    ds_read_b128 v[120:123], v13 offset:25600
    v_smfmac_f32_16x16x64_bf16 v[64:67], v[40:43], a[136:143], v2
    s_waitcnt lgkmcnt(6)
    v_smfmac_f32_16x16x64_bf16 v[56:59], v[44:47], v[124:131], v2
    ds_read_b128 v[124:127], v13 offset:26624
    ds_read_b128 v[128:131], v13 offset:27648
    v_smfmac_f32_16x16x64_bf16 v[60:63], v[44:47], a[144:151], v2
    s_waitcnt lgkmcnt(6)
    v_smfmac_f32_16x16x64_bf16 v[64:67], v[44:47], v[132:139], v2
    ds_read_b128 v[132:135], v13 offset:28672
    ds_read_b128 v[136:139], v13 offset:29696
    v_smfmac_f32_16x16x64_bf16 v[68:71], v[16:19], a[152:159], v2
    v_smfmac_f32_16x16x64_bf16 v[68:71], v[20:23], a[160:167], v2
    v_permlane32_swap_b32 v56, v58
    v_permlane32_swap_b32 v57, v59
    v_smfmac_f32_16x16x64_bf16 v[68:71], v[24:27], a[168:175], v2
    v_add_f32 v56, v56, v58
    v_add_f32 v57, v57, v59
    v_smfmac_f32_16x16x64_bf16 v[68:71], v[28:31], a[176:183], v2
    v_cvt_pk_bf16_f32 v56, v56, v57
    ds_write_b16 v3, v56 offset:0
    v_smfmac_f32_16x16x64_bf16 v[68:71], v[32:35], a[184:191], v2
    ds_write_b16_d16_hi v3, v56 offset:400
    v_permlane32_swap_b32 v60, v62
    v_smfmac_f32_16x16x64_bf16 v[68:71], v[36:39], a[192:199], v2
    v_permlane32_swap_b32 v61, v63
    v_add_f32 v60, v60, v62
    v_smfmac_f32_16x16x64_bf16 v[68:71], v[40:43], a[200:207], v2
    v_add_f32 v61, v61, v63
    v_cvt_pk_bf16_f32 v60, v60, v61
    v_smfmac_f32_16x16x64_bf16 v[68:71], v[44:47], a[208:215], v2
    ds_write_b16 v3, v60 offset:32
    ds_write_b16_d16_hi v3, v60 offset:432
    v_smfmac_f32_16x16x64_bf16 v[68:71], v[48:51], a[216:223], v2
    v_permlane32_swap_b32 v64, v66
    v_permlane32_swap_b32 v65, v67
    v_smfmac_f32_16x16x64_bf16 v[68:71], v[52:55], a[224:231], v2
    v_add_f32 v64, v64, v66
    v_add_f32 v65, v65, v67
    v_smfmac_f32_16x16x64_bf16 v[72:75], v[16:19], a[232:239], v2
    v_cvt_pk_bf16_f32 v64, v64, v65
    ds_write_b16 v3, v64 offset:64
    v_smfmac_f32_16x16x64_bf16 v[72:75], v[20:23], a[240:247], v2
    ds_write_b16_d16_hi v3, v64 offset:464
    v_smfmac_f32_16x16x64_bf16 v[72:75], v[24:27], a[248:255], v2
    v_smfmac_f32_16x16x64_bf16 v[72:75], v[28:31], v[148:155], v2
    s_waitcnt lgkmcnt(0)
    s_barrier
    ds_read_b128 v[88:91], v4 offset:0
    v_smfmac_f32_16x16x64_bf16 v[72:75], v[32:35], v[140:147], v2
    ds_read_b128 v[92:95], v4 offset:128
    ds_read_b128 v[96:99], v4 offset:256
    v_smfmac_f32_16x16x64_bf16 v[72:75], v[36:39], v[156:163], v2
    v_permlane32_swap_b32 v68, v70
    v_permlane32_swap_b32 v69, v71
    v_smfmac_f32_16x16x64_bf16 v[72:75], v[40:43], v[164:171], v2
    v_add_f32 v68, v68, v70
    v_add_f32 v69, v69, v71
    v_smfmac_f32_16x16x64_bf16 v[72:75], v[44:47], v[172:179], v2
    v_cvt_pk_bf16_f32 v68, v68, v69
    ds_write_b16 v3, v68 offset:3200
    v_smfmac_f32_16x16x64_bf16 v[72:75], v[48:51], v[116:123], v2
    ds_write_b16_d16_hi v3, v68 offset:3600
    v_smfmac_f32_16x16x64_bf16 v[72:75], v[52:55], v[180:187], v2
    s_waitcnt lgkmcnt(2)
    v_smfmac_f32_16x16x64_bf16 v[80:83], v[96:99], v[100:107], v2
    v_smfmac_f32_16x16x64_bf16 v[76:79], v[16:19], v[188:195], v2
    v_smfmac_f32_16x16x64_bf16 v[76:79], v[20:23], v[196:203], v2
    v_smfmac_f32_16x16x64_bf16 v[76:79], v[24:27], v[124:131], v2
    v_permlane32_swap_b32 v72, v74
    v_permlane32_swap_b32 v73, v75
    v_smfmac_f32_16x16x64_bf16 v[76:79], v[28:31], v[204:211], v2
    v_add_f32 v72, v72, v74
    v_add_f32 v73, v73, v75
    ds_write_b128 v15, v[80:83]
    v_smfmac_f32_16x16x64_bf16 v[76:79], v[32:35], v[212:219], v2
    v_cvt_pk_bf16_f32 v72, v72, v73
    ds_write_b16 v3, v72 offset:3232
    v_smfmac_f32_16x16x64_bf16 v[76:79], v[36:39], v[220:227], v2
    ds_write_b16_d16_hi v3, v72 offset:3632
    v_smfmac_f32_16x16x64_bf16 v[76:79], v[40:43], v[132:139], v2
    v_smfmac_f32_16x16x64_bf16 v[76:79], v[44:47], v[228:235], v2
    v_smfmac_f32_16x16x64_bf16 v[76:79], v[48:51], v[236:243], v2
    v_smfmac_f32_16x16x64_bf16 v[76:79], v[52:55], v[244:251], v2
    s_nop 7
    v_permlane32_swap_b32 v76, v78
    v_permlane32_swap_b32 v77, v79
    v_add_f32 v76, v76, v78
    v_add_f32 v77, v77, v79
    v_cvt_pk_bf16_f32 v76, v76, v77
    ds_write_b16 v3, v76 offset:3264
    ds_write_b16_d16_hi v3, v76 offset:3664
    s_waitcnt lgkmcnt(0)
    s_barrier
    ds_read2st64_b32 v[40:41], v6 offset0:0 offset1:2
    ds_read2st64_b32 v[42:43], v6 offset0:8 offset1:10
    ds_read_b128 v[16:19], v5 offset:0
    ds_read_b128 v[20:23], v5 offset:16
    ds_read_b128 v[24:27], v5 offset:128
    ds_read_b128 v[28:31], v5 offset:144
    ds_read_b128 v[32:35], v5 offset:256
    ds_read_b128 v[36:39], v5 offset:272
    s_waitcnt lgkmcnt(6)
    v_add_f32 v40, v40, v41
    v_add_f32 v42, v42, v43
    v_add_f32 v44, v40, v42
    v_mul_f32 v44, 0x3dd53b95, v44
    s_waitcnt lgkmcnt(4)
    v_smfmac_f32_16x16x64_bf16 v[84:87], v[88:91], v[16:23], v2
    s_waitcnt lgkmcnt(2)
    v_smfmac_f32_16x16x64_bf16 v[84:87], v[92:95], v[24:31], v2
    s_waitcnt lgkmcnt(0)
    v_smfmac_f32_16x16x64_bf16 v[84:87], v[96:99], v[32:39], v2
    v_max_f32_dpp v45, v44, v44 row_ror:8 row_mask:0xf bank_mask:0xf
    s_nop 1
    v_max_f32_dpp v45, v45, v45 row_ror:4 row_mask:0xf bank_mask:0xf
    s_nop 1
    v_max_f32_dpp v45, v45, v45 row_ror:2 row_mask:0xf bank_mask:0xf
    s_nop 1
    v_max_f32_dpp v45, v45, v45 row_ror:1 row_mask:0xf bank_mask:0xf
    v_mov_b32 v47, v45
    s_nop 1
    v_permlane32_swap_b32 v45, v47
    v_max_f32 v45, v45, v47
    v_mov_b32 v47, v87
    s_nop 1
    v_permlane32_swap_b32 v87, v47
    v_add_f32 v48, v87, v47
    v_mul_f32 v48, 0x3dd53b95, v48
    s_nop 1
    v_max_f32_dpp v46, v48, v48 row_ror:4 row_mask:0xf bank_mask:0xf
    s_nop 1
    v_max_f32_dpp v46, v46, v46 row_ror:2 row_mask:0xf bank_mask:0xf
    s_nop 1
    v_max_f32_dpp v46, v46, v46 row_ror:1 row_mask:0xf bank_mask:0xf
    v_max_f32 v45, v45, v46
    v_sub_f32 v49, v44, v45
    v_sub_f32 v50, v48, v45
    v_exp_f32 v49, v49
    v_exp_f32 v50, v50
    s_nop 0
    v_fma_f32 v51, v50, v12, v49
    s_nop 1
    v_add_f32_dpp v51, v51, v51 row_ror:8 row_mask:0xf bank_mask:0xf
    s_nop 1
    v_add_f32_dpp v51, v51, v51 row_ror:4 row_mask:0xf bank_mask:0xf
    s_nop 1
    v_add_f32_dpp v51, v51, v51 row_ror:2 row_mask:0xf bank_mask:0xf
    s_nop 1
    v_add_f32_dpp v51, v51, v51 row_ror:1 row_mask:0xf bank_mask:0xf
    v_mov_b32 v47, v51
    s_nop 1
    v_permlane32_swap_b32 v51, v47
    v_add_f32 v51, v51, v47
    v_rcp_f32 v51, v51
    s_nop 0
    v_mul_f32 v49, v49, v51
    v_mul_f32 v50, v50, v51
    s_nop 0
    v_mov_b32_dpp v46, v49 quad_perm:[1,0,3,2] row_mask:0xf bank_mask:0xf
    v_mov_b32_dpp v47, v50 quad_perm:[1,0,3,2] row_mask:0xf bank_mask:0xf
    v_cvt_pk_bf16_f32 v16, v49, v46
    v_cvt_pk_bf16_f32 v20, v50, v47
    s_nop 0
    v_mov_b32_dpp v17, v16 row_shl:2 row_mask:0xf bank_mask:0xf
    v_mov_b32_dpp v18, v16 row_shl:4 row_mask:0xf bank_mask:0xf
    v_mov_b32_dpp v19, v16 row_shl:6 row_mask:0xf bank_mask:0xf
    v_mov_b32_dpp v21, v20 row_shl:2 row_mask:0xf bank_mask:0xf
    v_mov_b32_dpp v22, v20 row_shl:4 row_mask:0xf bank_mask:0xf
    v_mov_b32_dpp v23, v20 row_shl:6 row_mask:0xf bank_mask:0xf
    s_mov_b64 exec, s[40:41]
    buffer_store_dwordx4 v[16:19], v7, s[8:11], s18 offen sc1
    s_mov_b64 exec, s[42:43]
    buffer_store_dwordx4 v[20:23], v8, s[8:11], s18 offen sc1
    s_mov_b64 exec, -1
    s_add_u32 s28, s14, 1
    s_min_u32 s28, s28, 63
    s_cmp_gt_u32 s47, s28
    s_cbranch_scc1 layerb1_kernel_p3_gw2_ok
layerb1_kernel_p3_gw2_lp:
    buffer_load_dword v253, v255, s[8:11], s48 offen sc1
    s_waitcnt vmcnt(0)
    v_readlane_b32 s47, v253, 0
    v_readlane_b32 s29, v253, 1
    s_nop 0
    s_min_u32 s47, s47, s29
    s_sub_u32 s15, s15, 1
    s_cbranch_scc1 layerb1_kernel_bail
    s_cmp_gt_u32 s47, s28
    s_cbranch_scc0 layerb1_kernel_p3_gw2_lp
layerb1_kernel_p3_gw2_ok:
    s_mul_i32 s20, s28, 393216
    s_add_u32 s20, s20, s44
    s_add_u32 s21, s20, 8192
    buffer_load_dwordx4 v[100:103], v9, s[8:11], s21 offen offset:0 sc1
    buffer_load_dwordx4 v[104:107], v9, s[8:11], s21 offen offset:512 sc1
    v_mov_b32 v56, 0
    v_mov_b32 v57, 0
    v_mov_b32 v58, 0
    v_mov_b32 v59, 0
    v_mov_b32 v60, 0
    v_mov_b32 v61, 0
    v_mov_b32 v62, 0
    v_mov_b32 v63, 0
    v_mov_b32 v64, 0
    v_mov_b32 v65, 0
    v_mov_b32 v66, 0
    v_mov_b32 v67, 0
    v_mov_b32 v68, 0
    v_mov_b32 v69, 0
    v_mov_b32 v70, 0
    v_mov_b32 v71, 0
    v_mov_b32 v72, 0
    v_mov_b32 v73, 0
    v_mov_b32 v74, 0
    v_mov_b32 v75, 0
    v_mov_b32 v76, 0
    v_mov_b32 v77, 0
    v_mov_b32 v78, 0
    v_mov_b32 v79, 0
    v_mov_b32 v80, 0
    v_mov_b32 v81, 0
    v_mov_b32 v82, 0
    v_mov_b32 v83, 0
    v_mov_b32 v84, 0
    v_mov_b32 v85, 0
    v_mov_b32 v86, 0
    v_mov_b32 v87, 0
    s_lshl_b32 s20, s12, 7
    s_add_u32 s20, s20, 16384
    s_mov_b64 exec, 1
    v_mov_b32 v253, s20
    v_mov_b32 v254, s14
    buffer_store_dword v254, v253, s[8:11], s48 offen sc1
    s_mov_b64 exec, -1
    ds_read_b128 v[116:119], v13 offset:0
    ds_read_b128 v[120:123], v13 offset:1024
    ds_read_b128 v[124:127], v13 offset:2048
    ds_read_b128 v[128:131], v13 offset:3072
    ds_read_b128 v[132:135], v13 offset:4096
    ds_read_b128 v[136:139], v13 offset:5120
    ds_read_b128 v[140:143], v13 offset:6144
    ds_read_b128 v[144:147], v13 offset:7168
    s_waitcnt lgkmcnt(0)
    s_add_u32 s14, s14, 1
    s_cmp_lt_u32 s14, 64
    s_cbranch_scc1 layerb1_kernel_p3_step
    s_waitcnt vmcnt(0)
    s_barrier
    s_lshl_b32 s20, s12, 7
    s_add_u32 s20, s20, 16384
    s_mov_b64 exec, 1
    v_mov_b32 v253, s20
    v_mov_b32 v254, s14
    buffer_store_dword v254, v253, s[8:11], s48 offen sc1
    s_mov_b64 exec, -1
    s_branch layerb1_kernel_end
layerb1_kernel_y0_start:
    v_lshrrev_b32 v16, 4, v0
    v_and_b32 v17, 7, v0
    v_lshrrev_b32 v18, 3, v0
    v_and_b32 v18, 1, v18
    v_lshl_add_u32 v19, v18, 2, v16
    v_add_u32 v19, 0, v19
    v_mul_u32_u24 v20, 640, v19
    v_lshl_add_u32 v4, v17, 4, v20
    v_and_b32 v20, 3, v17
    v_lshlrev_b32 v20, 1, v20
    v_lshrrev_b32 v21, 2, v17
    v_add_u32 v20, v20, v21
    v_lshlrev_b32 v20, 4, v20
    v_lshl_add_u32 v5, v19, 7, v20
    v_add_u32 v3, 0, v1
    v_lshlrev_b32 v20, 8, v18
    v_lshl_add_u32 v20, v17, 5, v20
    v_and_b32 v21, 1, v16
    v_lshl_add_u32 v20, v21, 4, v20
    v_add_u32 v20, 10240, v20
    v_add_u32 v21, 12288, v1
    v_lshrrev_b32 v22, 1, v16
    v_cmp_eq_u32 vcc, v22, v18
    s_nop 1
    v_cndmask_b32 v6, v21, v20, vcc
    v_lshrrev_b32 v20, 3, v0
    v_lshlrev_b32 v20, 2, v20
    v_lshl_add_u32 v20, v17, 5, v20
    v_add_u32 v7, 10240, v20
    s_lshl_b32 s20, s12, 7
    s_add_u32 s20, s20, 20480
    s_lshr_b32 s21, s20, 13
    s_lshl_b32 s21, s21, 14
    s_and_b32 s20, s20, 8191
    s_add_u32 s20, s20, s21
    v_lshrrev_b32 v20, 3, v0
    v_lshlrev_b32 v20, 4, v20
    v_add_u32 v8, s20, v20
    s_mul_i32 s46, s12, 20480
    s_add_u32 s46, s46, 103809024
    s_mul_i32 s20, s12, 327680
    s_add_u32 s20, s20, 27262976
    s_add_u32 s21, s20, 0
    buffer_load_dwordx4 a[0:3], v1, s[8:11], s21 offen offset:0
    buffer_load_dwordx4 a[4:7], v1, s[8:11], s21 offen offset:1024
    s_add_u32 s21, s20, 2048
    buffer_load_dwordx4 a[8:11], v1, s[8:11], s21 offen offset:0
    buffer_load_dwordx4 a[12:15], v1, s[8:11], s21 offen offset:1024
    s_add_u32 s21, s20, 4096
    buffer_load_dwordx4 a[16:19], v1, s[8:11], s21 offen offset:0
    buffer_load_dwordx4 a[20:23], v1, s[8:11], s21 offen offset:1024
    s_add_u32 s21, s20, 6144
    buffer_load_dwordx4 a[24:27], v1, s[8:11], s21 offen offset:0
    buffer_load_dwordx4 a[28:31], v1, s[8:11], s21 offen offset:1024
    s_add_u32 s21, s20, 8192
    buffer_load_dwordx4 a[32:35], v1, s[8:11], s21 offen offset:0
    buffer_load_dwordx4 a[36:39], v1, s[8:11], s21 offen offset:1024
    s_add_u32 s21, s20, 10240
    buffer_load_dwordx4 a[40:43], v1, s[8:11], s21 offen offset:0
    buffer_load_dwordx4 a[44:47], v1, s[8:11], s21 offen offset:1024
    s_add_u32 s21, s20, 12288
    buffer_load_dwordx4 a[48:51], v1, s[8:11], s21 offen offset:0
    buffer_load_dwordx4 a[52:55], v1, s[8:11], s21 offen offset:1024
    s_add_u32 s21, s20, 14336
    buffer_load_dwordx4 a[56:59], v1, s[8:11], s21 offen offset:0
    buffer_load_dwordx4 a[60:63], v1, s[8:11], s21 offen offset:1024
    s_add_u32 s21, s20, 16384
    buffer_load_dwordx4 a[64:67], v1, s[8:11], s21 offen offset:0
    buffer_load_dwordx4 a[68:71], v1, s[8:11], s21 offen offset:1024
    s_add_u32 s21, s20, 18432
    buffer_load_dwordx4 a[72:75], v1, s[8:11], s21 offen offset:0
    buffer_load_dwordx4 a[76:79], v1, s[8:11], s21 offen offset:1024
    s_add_u32 s21, s20, 20480
    buffer_load_dwordx4 a[80:83], v1, s[8:11], s21 offen offset:0
    buffer_load_dwordx4 a[84:87], v1, s[8:11], s21 offen offset:1024
    s_add_u32 s21, s20, 22528
    buffer_load_dwordx4 a[88:91], v1, s[8:11], s21 offen offset:0
    buffer_load_dwordx4 a[92:95], v1, s[8:11], s21 offen offset:1024
    s_add_u32 s21, s20, 24576
    buffer_load_dwordx4 a[96:99], v1, s[8:11], s21 offen offset:0
    buffer_load_dwordx4 a[100:103], v1, s[8:11], s21 offen offset:1024
    s_add_u32 s21, s20, 26624
    buffer_load_dwordx4 a[104:107], v1, s[8:11], s21 offen offset:0
    buffer_load_dwordx4 a[108:111], v1, s[8:11], s21 offen offset:1024
    s_add_u32 s21, s20, 28672
    buffer_load_dwordx4 a[112:115], v1, s[8:11], s21 offen offset:0
    buffer_load_dwordx4 a[116:119], v1, s[8:11], s21 offen offset:1024
    s_add_u32 s21, s20, 30720
    buffer_load_dwordx4 a[120:123], v1, s[8:11], s21 offen offset:0
    buffer_load_dwordx4 a[124:127], v1, s[8:11], s21 offen offset:1024
    s_add_u32 s21, s20, 32768
    buffer_load_dwordx4 a[128:131], v1, s[8:11], s21 offen offset:0
    buffer_load_dwordx4 a[132:135], v1, s[8:11], s21 offen offset:1024
    s_add_u32 s21, s20, 34816
    buffer_load_dwordx4 a[136:139], v1, s[8:11], s21 offen offset:0
    buffer_load_dwordx4 a[140:143], v1, s[8:11], s21 offen offset:1024
    s_add_u32 s21, s20, 36864
    buffer_load_dwordx4 a[144:147], v1, s[8:11], s21 offen offset:0
    buffer_load_dwordx4 a[148:151], v1, s[8:11], s21 offen offset:1024
    s_add_u32 s21, s20, 38912
    buffer_load_dwordx4 a[152:155], v1, s[8:11], s21 offen offset:0
    buffer_load_dwordx4 a[156:159], v1, s[8:11], s21 offen offset:1024
    s_add_u32 s21, s20, 40960
    buffer_load_dwordx4 a[160:163], v1, s[8:11], s21 offen offset:0
    buffer_load_dwordx4 a[164:167], v1, s[8:11], s21 offen offset:1024
    s_add_u32 s21, s20, 43008
    buffer_load_dwordx4 a[168:171], v1, s[8:11], s21 offen offset:0
    buffer_load_dwordx4 a[172:175], v1, s[8:11], s21 offen offset:1024
    s_add_u32 s21, s20, 45056
    buffer_load_dwordx4 a[176:179], v1, s[8:11], s21 offen offset:0
    buffer_load_dwordx4 a[180:183], v1, s[8:11], s21 offen offset:1024
    s_add_u32 s21, s20, 47104
    buffer_load_dwordx4 a[184:187], v1, s[8:11], s21 offen offset:0
    buffer_load_dwordx4 a[188:191], v1, s[8:11], s21 offen offset:1024
    s_add_u32 s21, s20, 49152
    buffer_load_dwordx4 a[192:195], v1, s[8:11], s21 offen offset:0
    buffer_load_dwordx4 a[196:199], v1, s[8:11], s21 offen offset:1024
    s_add_u32 s21, s20, 51200
    buffer_load_dwordx4 a[200:203], v1, s[8:11], s21 offen offset:0
    buffer_load_dwordx4 a[204:207], v1, s[8:11], s21 offen offset:1024
    s_add_u32 s21, s20, 53248
    buffer_load_dwordx4 a[208:211], v1, s[8:11], s21 offen offset:0
    buffer_load_dwordx4 a[212:215], v1, s[8:11], s21 offen offset:1024
    s_add_u32 s21, s20, 55296
    buffer_load_dwordx4 a[216:219], v1, s[8:11], s21 offen offset:0
    buffer_load_dwordx4 a[220:223], v1, s[8:11], s21 offen offset:1024
    s_add_u32 s21, s20, 57344
    buffer_load_dwordx4 a[224:227], v1, s[8:11], s21 offen offset:0
    buffer_load_dwordx4 a[228:231], v1, s[8:11], s21 offen offset:1024
    s_add_u32 s21, s20, 59392
    buffer_load_dwordx4 a[232:235], v1, s[8:11], s21 offen offset:0
    buffer_load_dwordx4 a[236:239], v1, s[8:11], s21 offen offset:1024
    s_add_u32 s21, s20, 61440
    buffer_load_dwordx4 a[240:243], v1, s[8:11], s21 offen offset:0
    buffer_load_dwordx4 a[244:247], v1, s[8:11], s21 offen offset:1024
    s_add_u32 s21, s20, 63488
    buffer_load_dwordx4 a[248:251], v1, s[8:11], s21 offen offset:0
    buffer_load_dwordx4 a[252:255], v1, s[8:11], s21 offen offset:1024
    s_add_u32 s21, s20, 65536
    buffer_load_dwordx4 v[176:179], v1, s[8:11], s21 offen offset:0
    buffer_load_dwordx4 v[180:183], v1, s[8:11], s21 offen offset:1024
    s_add_u32 s21, s20, 67584
    buffer_load_dwordx4 v[184:187], v1, s[8:11], s21 offen offset:0
    buffer_load_dwordx4 v[188:191], v1, s[8:11], s21 offen offset:1024
    s_add_u32 s21, s20, 69632
    buffer_load_dwordx4 v[192:195], v1, s[8:11], s21 offen offset:0
    buffer_load_dwordx4 v[196:199], v1, s[8:11], s21 offen offset:1024
    s_add_u32 s21, s20, 71680
    buffer_load_dwordx4 v[200:203], v1, s[8:11], s21 offen offset:0
    buffer_load_dwordx4 v[204:207], v1, s[8:11], s21 offen offset:1024
    s_add_u32 s21, s20, 73728
    buffer_load_dwordx4 v[208:211], v1, s[8:11], s21 offen offset:0
    buffer_load_dwordx4 v[212:215], v1, s[8:11], s21 offen offset:1024
    s_add_u32 s21, s20, 75776
    buffer_load_dwordx4 v[216:219], v1, s[8:11], s21 offen offset:0
    buffer_load_dwordx4 v[220:223], v1, s[8:11], s21 offen offset:1024
    s_add_u32 s21, s20, 77824
    buffer_load_dwordx4 v[224:227], v1, s[8:11], s21 offen offset:0
    buffer_load_dwordx4 v[228:231], v1, s[8:11], s21 offen offset:1024
    s_add_u32 s21, s20, 79872
    buffer_load_dwordx4 v[232:235], v1, s[8:11], s21 offen offset:0
    buffer_load_dwordx4 v[236:239], v1, s[8:11], s21 offen offset:1024
    s_mov_b32 s14, 0
    s_lshl_b32 s20, s12, 7
    v_mov_b32 v9, s20
    s_mov_b32 s47, 0
layerb1_kernel_y0_step:
    s_cmp_lt_u32 s14, 32
    s_cselect_b32 s18, s16, s17
    s_and_b32 s20, s14, 31
    s_lshl_b32 s20, s20, 16
    s_add_u32 s18, s18, s20
    s_mul_i32 s28, s14, 1638400
    s_add_u32 s28, s28, s46
    v_mov_b32 v56, 0
    v_mov_b32 v57, 0
    v_mov_b32 v58, 0
    v_mov_b32 v59, 0
    v_mov_b32 v60, 0
    v_mov_b32 v61, 0
    v_mov_b32 v62, 0
    v_mov_b32 v63, 0
    v_mov_b32 v64, 0
    v_mov_b32 v65, 0
    v_mov_b32 v66, 0
    v_mov_b32 v67, 0
    v_mov_b32 v68, 0
    v_mov_b32 v69, 0
    v_mov_b32 v70, 0
    v_mov_b32 v71, 0
    s_add_u32 s22, s18, 36864
    s_add_u32 s23, s18, 37888
    s_add_u32 s24, s18, 38912
layerb1_kernel_y0_poll:
    buffer_load_dwordx4 v[16:19], v1, s[8:11], s22 offen sc1
    buffer_load_dwordx4 v[20:23], v1, s[8:11], s23 offen sc1
    buffer_load_dwordx4 v[24:27], v1, s[8:11], s24 offen sc1
    s_waitcnt vmcnt(0)
    ds_write_b128 v3, v[16:19] offset:0
    ds_write_b128 v3, v[20:23] offset:1024
    ds_write_b128 v3, v[24:27] offset:2048
    v_max3_u32 v116, v16, v17, v18
    v_max3_u32 v116, v116, v19, v20
    v_max3_u32 v116, v116, v21, v22
    v_max3_u32 v116, v116, v23, v24
    v_max3_u32 v116, v116, v25, v26
    v_max_u32 v116, v116, v27
    v_cmp_eq_u32 vcc, -1, v116
    s_sub_u32 s15, s15, 1
    s_cbranch_scc1 layerb1_kernel_bail
    s_cbranch_vccnz layerb1_kernel_y0_poll
    s_waitcnt lgkmcnt(0)
    s_barrier
    ds_read_b128 v[28:31], v3 offset:3072
    ds_read_b128 v[32:35], v3 offset:4096
    ds_read_b128 v[36:39], v3 offset:5120
    ds_read_b128 v[40:43], v3 offset:6144
    ds_read_b128 v[44:47], v3 offset:7168
    ds_read_b128 v[48:51], v3 offset:8192
    ds_read_b128 v[52:55], v3 offset:9216
    s_cmp_gt_u32 s47, s14
    s_cbranch_scc1 layerb1_kernel_y0_gw_ok
layerb1_kernel_y0_gw_lp:
    buffer_load_dword v116, v9, s[8:11], s48 offen sc1
    s_waitcnt vmcnt(0)
    v_readlane_b32 s47, v116, 0
    s_nop 0
    s_sub_u32 s15, s15, 1
    s_cbranch_scc1 layerb1_kernel_bail
    s_cmp_gt_u32 s47, s14
    s_cbranch_scc0 layerb1_kernel_y0_gw_lp
layerb1_kernel_y0_gw_ok:
    buffer_load_dwordx4 v[76:79], v4, s[8:11], s28 offen offset:128 sc1
    buffer_load_dwordx4 v[80:83], v4, s[8:11], s28 offen offset:256 sc1
    buffer_load_dwordx4 v[84:87], v4, s[8:11], s28 offen offset:384 sc1
    buffer_load_dwordx4 v[88:91], v4, s[8:11], s28 offen offset:512 sc1
    v_smfmac_f32_16x16x64_bf16 v[56:59], v[16:19], a[0:7], v2
    v_smfmac_f32_16x16x64_bf16 v[60:63], v[16:19], a[80:87], v2
    v_smfmac_f32_16x16x64_bf16 v[64:67], v[16:19], a[160:167], v2
    v_smfmac_f32_16x16x64_bf16 v[68:71], v[16:19], a[240:247], v2
    v_smfmac_f32_16x16x64_bf16 v[56:59], v[20:23], a[8:15], v2
    v_smfmac_f32_16x16x64_bf16 v[60:63], v[20:23], a[88:95], v2
    v_smfmac_f32_16x16x64_bf16 v[64:67], v[20:23], a[168:175], v2
    v_smfmac_f32_16x16x64_bf16 v[68:71], v[20:23], a[248:255], v2
    v_smfmac_f32_16x16x64_bf16 v[56:59], v[24:27], a[16:23], v2
    v_smfmac_f32_16x16x64_bf16 v[60:63], v[24:27], a[96:103], v2
    v_smfmac_f32_16x16x64_bf16 v[64:67], v[24:27], a[176:183], v2
    v_smfmac_f32_16x16x64_bf16 v[68:71], v[24:27], v[176:183], v2
    s_waitcnt lgkmcnt(6)
    v_smfmac_f32_16x16x64_bf16 v[56:59], v[28:31], a[24:31], v2
    v_smfmac_f32_16x16x64_bf16 v[60:63], v[28:31], a[104:111], v2
    v_smfmac_f32_16x16x64_bf16 v[64:67], v[28:31], a[184:191], v2
    v_smfmac_f32_16x16x64_bf16 v[68:71], v[28:31], v[184:191], v2
    s_waitcnt lgkmcnt(5)
    v_smfmac_f32_16x16x64_bf16 v[56:59], v[32:35], a[32:39], v2
    v_smfmac_f32_16x16x64_bf16 v[60:63], v[32:35], a[112:119], v2
    v_smfmac_f32_16x16x64_bf16 v[64:67], v[32:35], a[192:199], v2
    v_smfmac_f32_16x16x64_bf16 v[68:71], v[32:35], v[192:199], v2
    s_waitcnt lgkmcnt(4)
    v_smfmac_f32_16x16x64_bf16 v[56:59], v[36:39], a[40:47], v2
    v_smfmac_f32_16x16x64_bf16 v[60:63], v[36:39], a[120:127], v2
    v_smfmac_f32_16x16x64_bf16 v[64:67], v[36:39], a[200:207], v2
    v_smfmac_f32_16x16x64_bf16 v[68:71], v[36:39], v[200:207], v2
    s_waitcnt lgkmcnt(3)
    v_smfmac_f32_16x16x64_bf16 v[56:59], v[40:43], a[48:55], v2
    v_smfmac_f32_16x16x64_bf16 v[60:63], v[40:43], a[128:135], v2
    v_smfmac_f32_16x16x64_bf16 v[64:67], v[40:43], a[208:215], v2
    v_smfmac_f32_16x16x64_bf16 v[68:71], v[40:43], v[208:215], v2
    s_waitcnt lgkmcnt(2)
    v_smfmac_f32_16x16x64_bf16 v[56:59], v[44:47], a[56:63], v2
    v_smfmac_f32_16x16x64_bf16 v[60:63], v[44:47], a[136:143], v2
    v_smfmac_f32_16x16x64_bf16 v[64:67], v[44:47], a[216:223], v2
    v_smfmac_f32_16x16x64_bf16 v[68:71], v[44:47], v[216:223], v2
    s_waitcnt lgkmcnt(1)
    v_smfmac_f32_16x16x64_bf16 v[56:59], v[48:51], a[64:71], v2
    v_smfmac_f32_16x16x64_bf16 v[60:63], v[48:51], a[144:151], v2
    v_smfmac_f32_16x16x64_bf16 v[64:67], v[48:51], a[224:231], v2
    v_smfmac_f32_16x16x64_bf16 v[68:71], v[48:51], v[224:231], v2
    s_waitcnt lgkmcnt(0)
    v_smfmac_f32_16x16x64_bf16 v[56:59], v[52:55], a[72:79], v2
    v_smfmac_f32_16x16x64_bf16 v[60:63], v[52:55], a[152:159], v2
    v_smfmac_f32_16x16x64_bf16 v[64:67], v[52:55], a[232:239], v2
    v_smfmac_f32_16x16x64_bf16 v[68:71], v[52:55], v[232:239], v2
    s_nop 7
    v_permlane32_swap_b32 v56, v64
    v_permlane32_swap_b32 v60, v68
    v_permlane32_swap_b32 v57, v65
    v_permlane32_swap_b32 v61, v69
    v_permlane32_swap_b32 v58, v66
    v_permlane32_swap_b32 v62, v70
    v_permlane32_swap_b32 v59, v67
    v_permlane32_swap_b32 v63, v71
    v_add_f32 v56, v56, v64
    v_add_f32 v60, v60, v68
    v_add_f32 v57, v57, v65
    v_add_f32 v61, v61, v69
    v_add_f32 v58, v58, v66
    v_add_f32 v62, v62, v70
    v_add_f32 v59, v59, v67
    v_add_f32 v63, v63, v71
    s_nop 1
    v_permlane16_swap_b32 v56, v60
    v_permlane16_swap_b32 v57, v61
    v_permlane16_swap_b32 v58, v62
    v_permlane16_swap_b32 v59, v63
    s_nop 1
    v_cvt_pk_bf16_f32 v72, v56, v57
    v_cvt_pk_bf16_f32 v73, v58, v59
    v_cvt_pk_bf16_f32 v74, v60, v61
    v_cvt_pk_bf16_f32 v75, v62, v63
    buffer_store_dwordx4 v[72:75], v4, s[8:11], s28 offen sc1
    s_cmp_eq_u32 s14, 63
    s_cbranch_scc1 layerb1_kernel_y0_last
    s_add_u32 s30, s18, 0
    s_add_u32 s31, s18, 4096
    s_add_u32 s32, s18, 16384
    s_add_u32 s33, s18, 20480
    s_add_u32 s34, s18, 32768
    s_add_u32 s29, s14, 1
    s_cmp_lt_u32 s29, 32
    s_cselect_b32 s19, s16, s17
    s_and_b32 s20, s29, 31
    s_lshl_b32 s20, s20, 16
    s_add_u32 s19, s19, s20
layerb1_kernel_y0_ppoll:
    buffer_load_dwordx4 v[92:95], v5, s[8:11], s30 offen sc1
    buffer_load_dwordx4 v[96:99], v5, s[8:11], s31 offen sc1
    buffer_load_dwordx4 v[100:103], v5, s[8:11], s32 offen sc1
    buffer_load_dwordx4 v[104:107], v5, s[8:11], s33 offen sc1
    buffer_load_dwordx4 v[108:111], v5, s[8:11], s34 offen sc1
    s_waitcnt vmcnt(0)
    v_mfma_f32_16x16x32_bf16 v[112:115], v[92:95], v[72:75], 0
    v_mfma_f32_16x16x32_bf16 v[112:115], v[96:99], v[76:79], v[112:115]
    v_mfma_f32_16x16x32_bf16 v[112:115], v[100:103], v[80:83], v[112:115]
    v_mfma_f32_16x16x32_bf16 v[112:115], v[104:107], v[84:87], v[112:115]
    v_mfma_f32_16x16x32_bf16 v[112:115], v[108:111], v[88:91], v[112:115]
    v_max3_u32 v116, v92, v93, v94
    v_max3_u32 v116, v116, v95, v96
    v_max3_u32 v116, v116, v97, v98
    v_max3_u32 v116, v116, v99, v100
    v_max3_u32 v116, v116, v101, v102
    v_max3_u32 v116, v116, v103, v104
    v_max3_u32 v116, v116, v105, v106
    v_max3_u32 v116, v116, v107, v108
    v_max3_u32 v116, v116, v109, v110
    v_max_u32 v116, v116, v111
    v_cmp_eq_u32 vcc, -1, v116
    s_sub_u32 s15, s15, 1
    s_cbranch_scc1 layerb1_kernel_bail
    s_cbranch_vccnz layerb1_kernel_y0_ppoll
    ds_write_b128 v6, v[112:115]
    s_waitcnt lgkmcnt(0)
    s_barrier
    ds_read2st64_b32 v[116:117], v7 offset0:0 offset1:1
    ds_read2st64_b32 v[118:119], v7 offset0:2 offset1:3
    ds_read2st64_b32 v[120:121], v7 offset0:4 offset1:5
    ds_read2st64_b32 v[122:123], v7 offset0:6 offset1:7
    s_waitcnt lgkmcnt(2)
    v_add_f32 v116, v116, v117
    v_add_f32 v118, v118, v119
    s_waitcnt lgkmcnt(0)
    v_add_f32 v120, v120, v121
    v_add_f32 v122, v122, v123
    v_add_f32 v116, v116, v118
    v_add_f32 v120, v120, v122
    v_add_f32 v116, v116, v120
    s_nop 1
    v_mov_b32_dpp v117, v116 quad_perm:[1,0,3,2] row_mask:0xf bank_mask:0xf
    v_cvt_pk_bf16_f32 v124, v116, v117
    s_nop 1
    v_mov_b32_dpp v125, v124 row_shl:2 row_mask:0xf bank_mask:0xf
    v_mov_b32_dpp v126, v124 row_shl:4 row_mask:0xf bank_mask:0xf
    v_mov_b32_dpp v127, v124 row_shl:6 row_mask:0xf bank_mask:0xf
    s_mov_b64 exec, s[40:41]
    buffer_store_dwordx4 v[124:127], v8, s[8:11], s19 offen sc1
    s_mov_b64 exec, -1
    s_lshl_b32 s20, s12, 7
    s_add_u32 s20, s20, 20480
    s_mov_b64 exec, 1
    v_mov_b32 v116, s20
    v_mov_b32 v117, s29
    buffer_store_dword v117, v116, s[8:11], s48 offen sc1
    s_mov_b64 exec, -1
    s_waitcnt vmcnt(0)
    s_barrier
    s_add_u32 s14, s14, 1
    s_branch layerb1_kernel_y0_step
layerb1_kernel_y0_last:
    s_waitcnt vmcnt(0)
    s_barrier
    s_lshl_b32 s20, s12, 7
    s_add_u32 s20, s20, 20480
    s_mov_b32 s29, 64
    s_mov_b64 exec, 1
    v_mov_b32 v116, s20
    v_mov_b32 v117, s29
    buffer_store_dword v117, v116, s[8:11], s48 offen sc1
    s_mov_b64 exec, -1
    s_branch layerb1_kernel_end
layerb1_kernel_y1_start:
    v_lshrrev_b32 v16, 4, v0
    v_and_b32 v17, 7, v0
    v_lshrrev_b32 v18, 3, v0
    v_and_b32 v18, 1, v18
    v_lshl_add_u32 v19, v18, 2, v16
    v_add_u32 v19, 8, v19
    v_mul_u32_u24 v20, 640, v19
    v_lshl_add_u32 v4, v17, 4, v20
    v_and_b32 v20, 3, v17
    v_lshlrev_b32 v20, 1, v20
    v_lshrrev_b32 v21, 2, v17
    v_add_u32 v20, v20, v21
    v_lshlrev_b32 v20, 4, v20
    v_lshl_add_u32 v5, v19, 7, v20
    v_add_u32 v3, 0, v1
    v_lshlrev_b32 v20, 8, v18
    v_lshl_add_u32 v20, v17, 5, v20
    v_and_b32 v21, 1, v16
    v_lshl_add_u32 v20, v21, 4, v20
    v_add_u32 v20, 10752, v20
    v_add_u32 v21, 12288, v1
    v_lshrrev_b32 v22, 1, v16
    v_cmp_eq_u32 vcc, v22, v18
    s_nop 1
    v_cndmask_b32 v6, v21, v20, vcc
    v_lshrrev_b32 v20, 3, v0
    v_lshlrev_b32 v20, 2, v20
    v_lshl_add_u32 v20, v17, 5, v20
    v_add_u32 v7, 10240, v20
    s_lshl_b32 s20, s12, 7
    s_add_u32 s20, s20, 20480
    s_lshr_b32 s21, s20, 13
    s_lshl_b32 s21, s21, 14
    s_and_b32 s20, s20, 8191
    s_add_u32 s20, s20, s21
    v_lshrrev_b32 v20, 3, v0
    v_lshlrev_b32 v20, 4, v20
    v_add_u32 v8, s20, v20
    s_mul_i32 s46, s12, 20480
    s_add_u32 s46, s46, 103809024
    s_mul_i32 s20, s12, 327680
    s_add_u32 s20, s20, 27344896
    s_add_u32 s21, s20, 0
    buffer_load_dwordx4 a[0:3], v1, s[8:11], s21 offen offset:0
    buffer_load_dwordx4 a[4:7], v1, s[8:11], s21 offen offset:1024
    s_add_u32 s21, s20, 2048
    buffer_load_dwordx4 a[8:11], v1, s[8:11], s21 offen offset:0
    buffer_load_dwordx4 a[12:15], v1, s[8:11], s21 offen offset:1024
    s_add_u32 s21, s20, 4096
    buffer_load_dwordx4 a[16:19], v1, s[8:11], s21 offen offset:0
    buffer_load_dwordx4 a[20:23], v1, s[8:11], s21 offen offset:1024
    s_add_u32 s21, s20, 6144
    buffer_load_dwordx4 a[24:27], v1, s[8:11], s21 offen offset:0
    buffer_load_dwordx4 a[28:31], v1, s[8:11], s21 offen offset:1024
    s_add_u32 s21, s20, 8192
    buffer_load_dwordx4 a[32:35], v1, s[8:11], s21 offen offset:0
    buffer_load_dwordx4 a[36:39], v1, s[8:11], s21 offen offset:1024
    s_add_u32 s21, s20, 10240
    buffer_load_dwordx4 a[40:43], v1, s[8:11], s21 offen offset:0
    buffer_load_dwordx4 a[44:47], v1, s[8:11], s21 offen offset:1024
    s_add_u32 s21, s20, 12288
    buffer_load_dwordx4 a[48:51], v1, s[8:11], s21 offen offset:0
    buffer_load_dwordx4 a[52:55], v1, s[8:11], s21 offen offset:1024
    s_add_u32 s21, s20, 14336
    buffer_load_dwordx4 a[56:59], v1, s[8:11], s21 offen offset:0
    buffer_load_dwordx4 a[60:63], v1, s[8:11], s21 offen offset:1024
    s_add_u32 s21, s20, 16384
    buffer_load_dwordx4 a[64:67], v1, s[8:11], s21 offen offset:0
    buffer_load_dwordx4 a[68:71], v1, s[8:11], s21 offen offset:1024
    s_add_u32 s21, s20, 18432
    buffer_load_dwordx4 a[72:75], v1, s[8:11], s21 offen offset:0
    buffer_load_dwordx4 a[76:79], v1, s[8:11], s21 offen offset:1024
    s_add_u32 s21, s20, 20480
    buffer_load_dwordx4 a[80:83], v1, s[8:11], s21 offen offset:0
    buffer_load_dwordx4 a[84:87], v1, s[8:11], s21 offen offset:1024
    s_add_u32 s21, s20, 22528
    buffer_load_dwordx4 a[88:91], v1, s[8:11], s21 offen offset:0
    buffer_load_dwordx4 a[92:95], v1, s[8:11], s21 offen offset:1024
    s_add_u32 s21, s20, 24576
    buffer_load_dwordx4 a[96:99], v1, s[8:11], s21 offen offset:0
    buffer_load_dwordx4 a[100:103], v1, s[8:11], s21 offen offset:1024
    s_add_u32 s21, s20, 26624
    buffer_load_dwordx4 a[104:107], v1, s[8:11], s21 offen offset:0
    buffer_load_dwordx4 a[108:111], v1, s[8:11], s21 offen offset:1024
    s_add_u32 s21, s20, 28672
    buffer_load_dwordx4 a[112:115], v1, s[8:11], s21 offen offset:0
    buffer_load_dwordx4 a[116:119], v1, s[8:11], s21 offen offset:1024
    s_add_u32 s21, s20, 30720
    buffer_load_dwordx4 a[120:123], v1, s[8:11], s21 offen offset:0
    buffer_load_dwordx4 a[124:127], v1, s[8:11], s21 offen offset:1024
    s_add_u32 s21, s20, 32768
    buffer_load_dwordx4 a[128:131], v1, s[8:11], s21 offen offset:0
    buffer_load_dwordx4 a[132:135], v1, s[8:11], s21 offen offset:1024
    s_add_u32 s21, s20, 34816
    buffer_load_dwordx4 a[136:139], v1, s[8:11], s21 offen offset:0
    buffer_load_dwordx4 a[140:143], v1, s[8:11], s21 offen offset:1024
    s_add_u32 s21, s20, 36864
    buffer_load_dwordx4 a[144:147], v1, s[8:11], s21 offen offset:0
    buffer_load_dwordx4 a[148:151], v1, s[8:11], s21 offen offset:1024
    s_add_u32 s21, s20, 38912
    buffer_load_dwordx4 a[152:155], v1, s[8:11], s21 offen offset:0
    buffer_load_dwordx4 a[156:159], v1, s[8:11], s21 offen offset:1024
    s_add_u32 s21, s20, 40960
    buffer_load_dwordx4 a[160:163], v1, s[8:11], s21 offen offset:0
    buffer_load_dwordx4 a[164:167], v1, s[8:11], s21 offen offset:1024
    s_add_u32 s21, s20, 43008
    buffer_load_dwordx4 a[168:171], v1, s[8:11], s21 offen offset:0
    buffer_load_dwordx4 a[172:175], v1, s[8:11], s21 offen offset:1024
    s_add_u32 s21, s20, 45056
    buffer_load_dwordx4 a[176:179], v1, s[8:11], s21 offen offset:0
    buffer_load_dwordx4 a[180:183], v1, s[8:11], s21 offen offset:1024
    s_add_u32 s21, s20, 47104
    buffer_load_dwordx4 a[184:187], v1, s[8:11], s21 offen offset:0
    buffer_load_dwordx4 a[188:191], v1, s[8:11], s21 offen offset:1024
    s_add_u32 s21, s20, 49152
    buffer_load_dwordx4 a[192:195], v1, s[8:11], s21 offen offset:0
    buffer_load_dwordx4 a[196:199], v1, s[8:11], s21 offen offset:1024
    s_add_u32 s21, s20, 51200
    buffer_load_dwordx4 a[200:203], v1, s[8:11], s21 offen offset:0
    buffer_load_dwordx4 a[204:207], v1, s[8:11], s21 offen offset:1024
    s_add_u32 s21, s20, 53248
    buffer_load_dwordx4 a[208:211], v1, s[8:11], s21 offen offset:0
    buffer_load_dwordx4 a[212:215], v1, s[8:11], s21 offen offset:1024
    s_add_u32 s21, s20, 55296
    buffer_load_dwordx4 a[216:219], v1, s[8:11], s21 offen offset:0
    buffer_load_dwordx4 a[220:223], v1, s[8:11], s21 offen offset:1024
    s_add_u32 s21, s20, 57344
    buffer_load_dwordx4 a[224:227], v1, s[8:11], s21 offen offset:0
    buffer_load_dwordx4 a[228:231], v1, s[8:11], s21 offen offset:1024
    s_add_u32 s21, s20, 59392
    buffer_load_dwordx4 a[232:235], v1, s[8:11], s21 offen offset:0
    buffer_load_dwordx4 a[236:239], v1, s[8:11], s21 offen offset:1024
    s_add_u32 s21, s20, 61440
    buffer_load_dwordx4 a[240:243], v1, s[8:11], s21 offen offset:0
    buffer_load_dwordx4 a[244:247], v1, s[8:11], s21 offen offset:1024
    s_add_u32 s21, s20, 63488
    buffer_load_dwordx4 a[248:251], v1, s[8:11], s21 offen offset:0
    buffer_load_dwordx4 a[252:255], v1, s[8:11], s21 offen offset:1024
    s_add_u32 s21, s20, 65536
    buffer_load_dwordx4 v[176:179], v1, s[8:11], s21 offen offset:0
    buffer_load_dwordx4 v[180:183], v1, s[8:11], s21 offen offset:1024
    s_add_u32 s21, s20, 67584
    buffer_load_dwordx4 v[184:187], v1, s[8:11], s21 offen offset:0
    buffer_load_dwordx4 v[188:191], v1, s[8:11], s21 offen offset:1024
    s_add_u32 s21, s20, 69632
    buffer_load_dwordx4 v[192:195], v1, s[8:11], s21 offen offset:0
    buffer_load_dwordx4 v[196:199], v1, s[8:11], s21 offen offset:1024
    s_add_u32 s21, s20, 71680
    buffer_load_dwordx4 v[200:203], v1, s[8:11], s21 offen offset:0
    buffer_load_dwordx4 v[204:207], v1, s[8:11], s21 offen offset:1024
    s_add_u32 s21, s20, 73728
    buffer_load_dwordx4 v[208:211], v1, s[8:11], s21 offen offset:0
    buffer_load_dwordx4 v[212:215], v1, s[8:11], s21 offen offset:1024
    s_add_u32 s21, s20, 75776
    buffer_load_dwordx4 v[216:219], v1, s[8:11], s21 offen offset:0
    buffer_load_dwordx4 v[220:223], v1, s[8:11], s21 offen offset:1024
    s_add_u32 s21, s20, 77824
    buffer_load_dwordx4 v[224:227], v1, s[8:11], s21 offen offset:0
    buffer_load_dwordx4 v[228:231], v1, s[8:11], s21 offen offset:1024
    s_add_u32 s21, s20, 79872
    buffer_load_dwordx4 v[232:235], v1, s[8:11], s21 offen offset:0
    buffer_load_dwordx4 v[236:239], v1, s[8:11], s21 offen offset:1024
    s_mov_b32 s14, 0
    s_lshl_b32 s20, s12, 7
    v_mov_b32 v9, s20
    s_mov_b32 s47, 0
layerb1_kernel_y1_step:
    s_cmp_lt_u32 s14, 32
    s_cselect_b32 s18, s16, s17
    s_and_b32 s20, s14, 31
    s_lshl_b32 s20, s20, 16
    s_add_u32 s18, s18, s20
    s_mul_i32 s28, s14, 1638400
    s_add_u32 s28, s28, s46
    v_mov_b32 v56, 0
    v_mov_b32 v57, 0
    v_mov_b32 v58, 0
    v_mov_b32 v59, 0
    v_mov_b32 v60, 0
    v_mov_b32 v61, 0
    v_mov_b32 v62, 0
    v_mov_b32 v63, 0
    v_mov_b32 v64, 0
    v_mov_b32 v65, 0
    v_mov_b32 v66, 0
    v_mov_b32 v67, 0
    v_mov_b32 v68, 0
    v_mov_b32 v69, 0
    v_mov_b32 v70, 0
    v_mov_b32 v71, 0
    s_add_u32 s22, s18, 39936
    s_add_u32 s23, s18, 49152
    s_add_u32 s24, s18, 50176
layerb1_kernel_y1_poll:
    buffer_load_dwordx4 v[28:31], v1, s[8:11], s22 offen sc1
    buffer_load_dwordx4 v[32:35], v1, s[8:11], s23 offen sc1
    buffer_load_dwordx4 v[36:39], v1, s[8:11], s24 offen sc1
    s_waitcnt vmcnt(0)
    ds_write_b128 v3, v[28:31] offset:3072
    ds_write_b128 v3, v[32:35] offset:4096
    ds_write_b128 v3, v[36:39] offset:5120
    v_max3_u32 v116, v28, v29, v30
    v_max3_u32 v116, v116, v31, v32
    v_max3_u32 v116, v116, v33, v34
    v_max3_u32 v116, v116, v35, v36
    v_max3_u32 v116, v116, v37, v38
    v_max_u32 v116, v116, v39
    v_cmp_eq_u32 vcc, -1, v116
    s_sub_u32 s15, s15, 1
    s_cbranch_scc1 layerb1_kernel_bail
    s_cbranch_vccnz layerb1_kernel_y1_poll
    s_waitcnt lgkmcnt(0)
    s_barrier
    ds_read_b128 v[16:19], v3 offset:0
    ds_read_b128 v[20:23], v3 offset:1024
    ds_read_b128 v[24:27], v3 offset:2048
    ds_read_b128 v[40:43], v3 offset:6144
    ds_read_b128 v[44:47], v3 offset:7168
    ds_read_b128 v[48:51], v3 offset:8192
    ds_read_b128 v[52:55], v3 offset:9216
    s_cmp_gt_u32 s47, s14
    s_cbranch_scc1 layerb1_kernel_y1_gw_ok
layerb1_kernel_y1_gw_lp:
    buffer_load_dword v116, v9, s[8:11], s48 offen sc1
    s_waitcnt vmcnt(0)
    v_readlane_b32 s47, v116, 0
    s_nop 0
    s_sub_u32 s15, s15, 1
    s_cbranch_scc1 layerb1_kernel_bail
    s_cmp_gt_u32 s47, s14
    s_cbranch_scc0 layerb1_kernel_y1_gw_lp
layerb1_kernel_y1_gw_ok:
    buffer_load_dwordx4 v[76:79], v4, s[8:11], s28 offen offset:128 sc1
    buffer_load_dwordx4 v[80:83], v4, s[8:11], s28 offen offset:256 sc1
    buffer_load_dwordx4 v[84:87], v4, s[8:11], s28 offen offset:384 sc1
    buffer_load_dwordx4 v[88:91], v4, s[8:11], s28 offen offset:512 sc1
    v_smfmac_f32_16x16x64_bf16 v[56:59], v[28:31], a[24:31], v2
    v_smfmac_f32_16x16x64_bf16 v[60:63], v[28:31], a[104:111], v2
    v_smfmac_f32_16x16x64_bf16 v[64:67], v[28:31], a[184:191], v2
    v_smfmac_f32_16x16x64_bf16 v[68:71], v[28:31], v[184:191], v2
    v_smfmac_f32_16x16x64_bf16 v[56:59], v[32:35], a[32:39], v2
    v_smfmac_f32_16x16x64_bf16 v[60:63], v[32:35], a[112:119], v2
    v_smfmac_f32_16x16x64_bf16 v[64:67], v[32:35], a[192:199], v2
    v_smfmac_f32_16x16x64_bf16 v[68:71], v[32:35], v[192:199], v2
    v_smfmac_f32_16x16x64_bf16 v[56:59], v[36:39], a[40:47], v2
    v_smfmac_f32_16x16x64_bf16 v[60:63], v[36:39], a[120:127], v2
    v_smfmac_f32_16x16x64_bf16 v[64:67], v[36:39], a[200:207], v2
    v_smfmac_f32_16x16x64_bf16 v[68:71], v[36:39], v[200:207], v2
    s_waitcnt lgkmcnt(6)
    v_smfmac_f32_16x16x64_bf16 v[56:59], v[16:19], a[0:7], v2
    v_smfmac_f32_16x16x64_bf16 v[60:63], v[16:19], a[80:87], v2
    v_smfmac_f32_16x16x64_bf16 v[64:67], v[16:19], a[160:167], v2
    v_smfmac_f32_16x16x64_bf16 v[68:71], v[16:19], a[240:247], v2
    s_waitcnt lgkmcnt(5)
    v_smfmac_f32_16x16x64_bf16 v[56:59], v[20:23], a[8:15], v2
    v_smfmac_f32_16x16x64_bf16 v[60:63], v[20:23], a[88:95], v2
    v_smfmac_f32_16x16x64_bf16 v[64:67], v[20:23], a[168:175], v2
    v_smfmac_f32_16x16x64_bf16 v[68:71], v[20:23], a[248:255], v2
    s_waitcnt lgkmcnt(4)
    v_smfmac_f32_16x16x64_bf16 v[56:59], v[24:27], a[16:23], v2
    v_smfmac_f32_16x16x64_bf16 v[60:63], v[24:27], a[96:103], v2
    v_smfmac_f32_16x16x64_bf16 v[64:67], v[24:27], a[176:183], v2
    v_smfmac_f32_16x16x64_bf16 v[68:71], v[24:27], v[176:183], v2
    s_waitcnt lgkmcnt(3)
    v_smfmac_f32_16x16x64_bf16 v[56:59], v[40:43], a[48:55], v2
    v_smfmac_f32_16x16x64_bf16 v[60:63], v[40:43], a[128:135], v2
    v_smfmac_f32_16x16x64_bf16 v[64:67], v[40:43], a[208:215], v2
    v_smfmac_f32_16x16x64_bf16 v[68:71], v[40:43], v[208:215], v2
    s_waitcnt lgkmcnt(2)
    v_smfmac_f32_16x16x64_bf16 v[56:59], v[44:47], a[56:63], v2
    v_smfmac_f32_16x16x64_bf16 v[60:63], v[44:47], a[136:143], v2
    v_smfmac_f32_16x16x64_bf16 v[64:67], v[44:47], a[216:223], v2
    v_smfmac_f32_16x16x64_bf16 v[68:71], v[44:47], v[216:223], v2
    s_waitcnt lgkmcnt(1)
    v_smfmac_f32_16x16x64_bf16 v[56:59], v[48:51], a[64:71], v2
    v_smfmac_f32_16x16x64_bf16 v[60:63], v[48:51], a[144:151], v2
    v_smfmac_f32_16x16x64_bf16 v[64:67], v[48:51], a[224:231], v2
    v_smfmac_f32_16x16x64_bf16 v[68:71], v[48:51], v[224:231], v2
    s_waitcnt lgkmcnt(0)
    v_smfmac_f32_16x16x64_bf16 v[56:59], v[52:55], a[72:79], v2
    v_smfmac_f32_16x16x64_bf16 v[60:63], v[52:55], a[152:159], v2
    v_smfmac_f32_16x16x64_bf16 v[64:67], v[52:55], a[232:239], v2
    v_smfmac_f32_16x16x64_bf16 v[68:71], v[52:55], v[232:239], v2
    s_nop 7
    v_permlane32_swap_b32 v56, v64
    v_permlane32_swap_b32 v60, v68
    v_permlane32_swap_b32 v57, v65
    v_permlane32_swap_b32 v61, v69
    v_permlane32_swap_b32 v58, v66
    v_permlane32_swap_b32 v62, v70
    v_permlane32_swap_b32 v59, v67
    v_permlane32_swap_b32 v63, v71
    v_add_f32 v56, v56, v64
    v_add_f32 v60, v60, v68
    v_add_f32 v57, v57, v65
    v_add_f32 v61, v61, v69
    v_add_f32 v58, v58, v66
    v_add_f32 v62, v62, v70
    v_add_f32 v59, v59, v67
    v_add_f32 v63, v63, v71
    s_nop 1
    v_permlane16_swap_b32 v56, v60
    v_permlane16_swap_b32 v57, v61
    v_permlane16_swap_b32 v58, v62
    v_permlane16_swap_b32 v59, v63
    s_nop 1
    v_cvt_pk_bf16_f32 v72, v56, v57
    v_cvt_pk_bf16_f32 v73, v58, v59
    v_cvt_pk_bf16_f32 v74, v60, v61
    v_cvt_pk_bf16_f32 v75, v62, v63
    buffer_store_dwordx4 v[72:75], v4, s[8:11], s28 offen sc1
    s_cmp_eq_u32 s14, 63
    s_cbranch_scc1 layerb1_kernel_y1_last
    s_add_u32 s30, s18, 0
    s_add_u32 s31, s18, 4096
    s_add_u32 s32, s18, 16384
    s_add_u32 s33, s18, 20480
    s_add_u32 s34, s18, 32768
    s_add_u32 s29, s14, 1
    s_cmp_lt_u32 s29, 32
    s_cselect_b32 s19, s16, s17
    s_and_b32 s20, s29, 31
    s_lshl_b32 s20, s20, 16
    s_add_u32 s19, s19, s20
layerb1_kernel_y1_ppoll:
    buffer_load_dwordx4 v[92:95], v5, s[8:11], s30 offen sc1
    buffer_load_dwordx4 v[96:99], v5, s[8:11], s31 offen sc1
    buffer_load_dwordx4 v[100:103], v5, s[8:11], s32 offen sc1
    buffer_load_dwordx4 v[104:107], v5, s[8:11], s33 offen sc1
    buffer_load_dwordx4 v[108:111], v5, s[8:11], s34 offen sc1
    s_waitcnt vmcnt(0)
    v_mfma_f32_16x16x32_bf16 v[112:115], v[92:95], v[72:75], 0
    v_mfma_f32_16x16x32_bf16 v[112:115], v[96:99], v[76:79], v[112:115]
    v_mfma_f32_16x16x32_bf16 v[112:115], v[100:103], v[80:83], v[112:115]
    v_mfma_f32_16x16x32_bf16 v[112:115], v[104:107], v[84:87], v[112:115]
    v_mfma_f32_16x16x32_bf16 v[112:115], v[108:111], v[88:91], v[112:115]
    v_max3_u32 v116, v92, v93, v94
    v_max3_u32 v116, v116, v95, v96
    v_max3_u32 v116, v116, v97, v98
    v_max3_u32 v116, v116, v99, v100
    v_max3_u32 v116, v116, v101, v102
    v_max3_u32 v116, v116, v103, v104
    v_max3_u32 v116, v116, v105, v106
    v_max3_u32 v116, v116, v107, v108
    v_max3_u32 v116, v116, v109, v110
    v_max_u32 v116, v116, v111
    v_cmp_eq_u32 vcc, -1, v116
    s_sub_u32 s15, s15, 1
    s_cbranch_scc1 layerb1_kernel_bail
    s_cbranch_vccnz layerb1_kernel_y1_ppoll
    ds_write_b128 v6, v[112:115]
    s_waitcnt lgkmcnt(0)
    s_barrier
    s_barrier
    s_add_u32 s14, s14, 1
    s_branch layerb1_kernel_y1_step
layerb1_kernel_y1_last:
    s_waitcnt vmcnt(0)
    s_barrier
    s_branch layerb1_kernel_end
layerb1_kernel_y2_start:
    v_lshrrev_b32 v16, 4, v0
    v_and_b32 v17, 7, v0
    v_lshrrev_b32 v18, 3, v0
    v_and_b32 v18, 1, v18
    v_lshl_add_u32 v19, v18, 2, v16
    v_add_u32 v19, 16, v19
    v_mul_u32_u24 v20, 640, v19
    v_lshl_add_u32 v4, v17, 4, v20
    v_and_b32 v20, 3, v17
    v_lshlrev_b32 v20, 1, v20
    v_lshrrev_b32 v21, 2, v17
    v_add_u32 v20, v20, v21
    v_lshlrev_b32 v20, 4, v20
    v_lshl_add_u32 v5, v19, 7, v20
    v_add_u32 v3, 0, v1
    v_lshlrev_b32 v20, 8, v18
    v_lshl_add_u32 v20, v17, 5, v20
    v_and_b32 v21, 1, v16
    v_lshl_add_u32 v20, v21, 4, v20
    v_add_u32 v20, 11264, v20
    v_add_u32 v21, 12288, v1
    v_lshrrev_b32 v22, 1, v16
    v_cmp_eq_u32 vcc, v22, v18
    s_nop 1
    v_cndmask_b32 v6, v21, v20, vcc
    v_lshrrev_b32 v20, 3, v0
    v_lshlrev_b32 v20, 2, v20
    v_lshl_add_u32 v20, v17, 5, v20
    v_add_u32 v7, 10240, v20
    s_lshl_b32 s20, s12, 7
    s_add_u32 s20, s20, 20480
    s_lshr_b32 s21, s20, 13
    s_lshl_b32 s21, s21, 14
    s_and_b32 s20, s20, 8191
    s_add_u32 s20, s20, s21
    v_lshrrev_b32 v20, 3, v0
    v_lshlrev_b32 v20, 4, v20
    v_add_u32 v8, s20, v20
    s_mul_i32 s46, s12, 20480
    s_add_u32 s46, s46, 103809024
    s_mul_i32 s20, s12, 327680
    s_add_u32 s20, s20, 27426816
    s_add_u32 s21, s20, 0
    buffer_load_dwordx4 a[0:3], v1, s[8:11], s21 offen offset:0
    buffer_load_dwordx4 a[4:7], v1, s[8:11], s21 offen offset:1024
    s_add_u32 s21, s20, 2048
    buffer_load_dwordx4 a[8:11], v1, s[8:11], s21 offen offset:0
    buffer_load_dwordx4 a[12:15], v1, s[8:11], s21 offen offset:1024
    s_add_u32 s21, s20, 4096
    buffer_load_dwordx4 a[16:19], v1, s[8:11], s21 offen offset:0
    buffer_load_dwordx4 a[20:23], v1, s[8:11], s21 offen offset:1024
    s_add_u32 s21, s20, 6144
    buffer_load_dwordx4 a[24:27], v1, s[8:11], s21 offen offset:0
    buffer_load_dwordx4 a[28:31], v1, s[8:11], s21 offen offset:1024
    s_add_u32 s21, s20, 8192
    buffer_load_dwordx4 a[32:35], v1, s[8:11], s21 offen offset:0
    buffer_load_dwordx4 a[36:39], v1, s[8:11], s21 offen offset:1024
    s_add_u32 s21, s20, 10240
    buffer_load_dwordx4 a[40:43], v1, s[8:11], s21 offen offset:0
    buffer_load_dwordx4 a[44:47], v1, s[8:11], s21 offen offset:1024
    s_add_u32 s21, s20, 12288
    buffer_load_dwordx4 a[48:51], v1, s[8:11], s21 offen offset:0
    buffer_load_dwordx4 a[52:55], v1, s[8:11], s21 offen offset:1024
    s_add_u32 s21, s20, 14336
    buffer_load_dwordx4 a[56:59], v1, s[8:11], s21 offen offset:0
    buffer_load_dwordx4 a[60:63], v1, s[8:11], s21 offen offset:1024
    s_add_u32 s21, s20, 16384
    buffer_load_dwordx4 a[64:67], v1, s[8:11], s21 offen offset:0
    buffer_load_dwordx4 a[68:71], v1, s[8:11], s21 offen offset:1024
    s_add_u32 s21, s20, 18432
    buffer_load_dwordx4 a[72:75], v1, s[8:11], s21 offen offset:0
    buffer_load_dwordx4 a[76:79], v1, s[8:11], s21 offen offset:1024
    s_add_u32 s21, s20, 20480
    buffer_load_dwordx4 a[80:83], v1, s[8:11], s21 offen offset:0
    buffer_load_dwordx4 a[84:87], v1, s[8:11], s21 offen offset:1024
    s_add_u32 s21, s20, 22528
    buffer_load_dwordx4 a[88:91], v1, s[8:11], s21 offen offset:0
    buffer_load_dwordx4 a[92:95], v1, s[8:11], s21 offen offset:1024
    s_add_u32 s21, s20, 24576
    buffer_load_dwordx4 a[96:99], v1, s[8:11], s21 offen offset:0
    buffer_load_dwordx4 a[100:103], v1, s[8:11], s21 offen offset:1024
    s_add_u32 s21, s20, 26624
    buffer_load_dwordx4 a[104:107], v1, s[8:11], s21 offen offset:0
    buffer_load_dwordx4 a[108:111], v1, s[8:11], s21 offen offset:1024
    s_add_u32 s21, s20, 28672
    buffer_load_dwordx4 a[112:115], v1, s[8:11], s21 offen offset:0
    buffer_load_dwordx4 a[116:119], v1, s[8:11], s21 offen offset:1024
    s_add_u32 s21, s20, 30720
    buffer_load_dwordx4 a[120:123], v1, s[8:11], s21 offen offset:0
    buffer_load_dwordx4 a[124:127], v1, s[8:11], s21 offen offset:1024
    s_add_u32 s21, s20, 32768
    buffer_load_dwordx4 a[128:131], v1, s[8:11], s21 offen offset:0
    buffer_load_dwordx4 a[132:135], v1, s[8:11], s21 offen offset:1024
    s_add_u32 s21, s20, 34816
    buffer_load_dwordx4 a[136:139], v1, s[8:11], s21 offen offset:0
    buffer_load_dwordx4 a[140:143], v1, s[8:11], s21 offen offset:1024
    s_add_u32 s21, s20, 36864
    buffer_load_dwordx4 a[144:147], v1, s[8:11], s21 offen offset:0
    buffer_load_dwordx4 a[148:151], v1, s[8:11], s21 offen offset:1024
    s_add_u32 s21, s20, 38912
    buffer_load_dwordx4 a[152:155], v1, s[8:11], s21 offen offset:0
    buffer_load_dwordx4 a[156:159], v1, s[8:11], s21 offen offset:1024
    s_add_u32 s21, s20, 40960
    buffer_load_dwordx4 a[160:163], v1, s[8:11], s21 offen offset:0
    buffer_load_dwordx4 a[164:167], v1, s[8:11], s21 offen offset:1024
    s_add_u32 s21, s20, 43008
    buffer_load_dwordx4 a[168:171], v1, s[8:11], s21 offen offset:0
    buffer_load_dwordx4 a[172:175], v1, s[8:11], s21 offen offset:1024
    s_add_u32 s21, s20, 45056
    buffer_load_dwordx4 a[176:179], v1, s[8:11], s21 offen offset:0
    buffer_load_dwordx4 a[180:183], v1, s[8:11], s21 offen offset:1024
    s_add_u32 s21, s20, 47104
    buffer_load_dwordx4 a[184:187], v1, s[8:11], s21 offen offset:0
    buffer_load_dwordx4 a[188:191], v1, s[8:11], s21 offen offset:1024
    s_add_u32 s21, s20, 49152
    buffer_load_dwordx4 a[192:195], v1, s[8:11], s21 offen offset:0
    buffer_load_dwordx4 a[196:199], v1, s[8:11], s21 offen offset:1024
    s_add_u32 s21, s20, 51200
    buffer_load_dwordx4 a[200:203], v1, s[8:11], s21 offen offset:0
    buffer_load_dwordx4 a[204:207], v1, s[8:11], s21 offen offset:1024
    s_add_u32 s21, s20, 53248
    buffer_load_dwordx4 a[208:211], v1, s[8:11], s21 offen offset:0
    buffer_load_dwordx4 a[212:215], v1, s[8:11], s21 offen offset:1024
    s_add_u32 s21, s20, 55296
    buffer_load_dwordx4 a[216:219], v1, s[8:11], s21 offen offset:0
    buffer_load_dwordx4 a[220:223], v1, s[8:11], s21 offen offset:1024
    s_add_u32 s21, s20, 57344
    buffer_load_dwordx4 a[224:227], v1, s[8:11], s21 offen offset:0
    buffer_load_dwordx4 a[228:231], v1, s[8:11], s21 offen offset:1024
    s_add_u32 s21, s20, 59392
    buffer_load_dwordx4 a[232:235], v1, s[8:11], s21 offen offset:0
    buffer_load_dwordx4 a[236:239], v1, s[8:11], s21 offen offset:1024
    s_add_u32 s21, s20, 61440
    buffer_load_dwordx4 a[240:243], v1, s[8:11], s21 offen offset:0
    buffer_load_dwordx4 a[244:247], v1, s[8:11], s21 offen offset:1024
    s_add_u32 s21, s20, 63488
    buffer_load_dwordx4 a[248:251], v1, s[8:11], s21 offen offset:0
    buffer_load_dwordx4 a[252:255], v1, s[8:11], s21 offen offset:1024
    s_add_u32 s21, s20, 65536
    buffer_load_dwordx4 v[176:179], v1, s[8:11], s21 offen offset:0
    buffer_load_dwordx4 v[180:183], v1, s[8:11], s21 offen offset:1024
    s_add_u32 s21, s20, 67584
    buffer_load_dwordx4 v[184:187], v1, s[8:11], s21 offen offset:0
    buffer_load_dwordx4 v[188:191], v1, s[8:11], s21 offen offset:1024
    s_add_u32 s21, s20, 69632
    buffer_load_dwordx4 v[192:195], v1, s[8:11], s21 offen offset:0
    buffer_load_dwordx4 v[196:199], v1, s[8:11], s21 offen offset:1024
    s_add_u32 s21, s20, 71680
    buffer_load_dwordx4 v[200:203], v1, s[8:11], s21 offen offset:0
    buffer_load_dwordx4 v[204:207], v1, s[8:11], s21 offen offset:1024
    s_add_u32 s21, s20, 73728
    buffer_load_dwordx4 v[208:211], v1, s[8:11], s21 offen offset:0
    buffer_load_dwordx4 v[212:215], v1, s[8:11], s21 offen offset:1024
    s_add_u32 s21, s20, 75776
    buffer_load_dwordx4 v[216:219], v1, s[8:11], s21 offen offset:0
    buffer_load_dwordx4 v[220:223], v1, s[8:11], s21 offen offset:1024
    s_add_u32 s21, s20, 77824
    buffer_load_dwordx4 v[224:227], v1, s[8:11], s21 offen offset:0
    buffer_load_dwordx4 v[228:231], v1, s[8:11], s21 offen offset:1024
    s_add_u32 s21, s20, 79872
    buffer_load_dwordx4 v[232:235], v1, s[8:11], s21 offen offset:0
    buffer_load_dwordx4 v[236:239], v1, s[8:11], s21 offen offset:1024
    s_mov_b32 s14, 0
    s_lshl_b32 s20, s12, 7
    v_mov_b32 v9, s20
    s_mov_b32 s47, 0
layerb1_kernel_y2_step:
    s_cmp_lt_u32 s14, 32
    s_cselect_b32 s18, s16, s17
    s_and_b32 s20, s14, 31
    s_lshl_b32 s20, s20, 16
    s_add_u32 s18, s18, s20
    s_mul_i32 s28, s14, 1638400
    s_add_u32 s28, s28, s46
    v_mov_b32 v56, 0
    v_mov_b32 v57, 0
    v_mov_b32 v58, 0
    v_mov_b32 v59, 0
    v_mov_b32 v60, 0
    v_mov_b32 v61, 0
    v_mov_b32 v62, 0
    v_mov_b32 v63, 0
    v_mov_b32 v64, 0
    v_mov_b32 v65, 0
    v_mov_b32 v66, 0
    v_mov_b32 v67, 0
    v_mov_b32 v68, 0
    v_mov_b32 v69, 0
    v_mov_b32 v70, 0
    v_mov_b32 v71, 0
    s_add_u32 s22, s18, 51200
    s_add_u32 s23, s18, 52224
layerb1_kernel_y2_poll:
    buffer_load_dwordx4 v[40:43], v1, s[8:11], s22 offen sc1
    buffer_load_dwordx4 v[44:47], v1, s[8:11], s23 offen sc1
    s_waitcnt vmcnt(0)
    ds_write_b128 v3, v[40:43] offset:6144
    ds_write_b128 v3, v[44:47] offset:7168
    v_max3_u32 v116, v40, v41, v42
    v_max3_u32 v116, v116, v43, v44
    v_max3_u32 v116, v116, v45, v46
    v_max_u32 v116, v116, v47
    v_cmp_eq_u32 vcc, -1, v116
    s_sub_u32 s15, s15, 1
    s_cbranch_scc1 layerb1_kernel_bail
    s_cbranch_vccnz layerb1_kernel_y2_poll
    s_waitcnt lgkmcnt(0)
    s_barrier
    ds_read_b128 v[16:19], v3 offset:0
    ds_read_b128 v[20:23], v3 offset:1024
    ds_read_b128 v[24:27], v3 offset:2048
    ds_read_b128 v[28:31], v3 offset:3072
    ds_read_b128 v[32:35], v3 offset:4096
    ds_read_b128 v[36:39], v3 offset:5120
    ds_read_b128 v[48:51], v3 offset:8192
    ds_read_b128 v[52:55], v3 offset:9216
    s_cmp_gt_u32 s47, s14
    s_cbranch_scc1 layerb1_kernel_y2_gw_ok
layerb1_kernel_y2_gw_lp:
    buffer_load_dword v116, v9, s[8:11], s48 offen sc1
    s_waitcnt vmcnt(0)
    v_readlane_b32 s47, v116, 0
    s_nop 0
    s_sub_u32 s15, s15, 1
    s_cbranch_scc1 layerb1_kernel_bail
    s_cmp_gt_u32 s47, s14
    s_cbranch_scc0 layerb1_kernel_y2_gw_lp
layerb1_kernel_y2_gw_ok:
    buffer_load_dwordx4 v[76:79], v4, s[8:11], s28 offen offset:128 sc1
    buffer_load_dwordx4 v[80:83], v4, s[8:11], s28 offen offset:256 sc1
    buffer_load_dwordx4 v[84:87], v4, s[8:11], s28 offen offset:384 sc1
    buffer_load_dwordx4 v[88:91], v4, s[8:11], s28 offen offset:512 sc1
    v_smfmac_f32_16x16x64_bf16 v[56:59], v[40:43], a[48:55], v2
    v_smfmac_f32_16x16x64_bf16 v[60:63], v[40:43], a[128:135], v2
    v_smfmac_f32_16x16x64_bf16 v[64:67], v[40:43], a[208:215], v2
    v_smfmac_f32_16x16x64_bf16 v[68:71], v[40:43], v[208:215], v2
    v_smfmac_f32_16x16x64_bf16 v[56:59], v[44:47], a[56:63], v2
    v_smfmac_f32_16x16x64_bf16 v[60:63], v[44:47], a[136:143], v2
    v_smfmac_f32_16x16x64_bf16 v[64:67], v[44:47], a[216:223], v2
    v_smfmac_f32_16x16x64_bf16 v[68:71], v[44:47], v[216:223], v2
    s_waitcnt lgkmcnt(7)
    v_smfmac_f32_16x16x64_bf16 v[56:59], v[16:19], a[0:7], v2
    v_smfmac_f32_16x16x64_bf16 v[60:63], v[16:19], a[80:87], v2
    v_smfmac_f32_16x16x64_bf16 v[64:67], v[16:19], a[160:167], v2
    v_smfmac_f32_16x16x64_bf16 v[68:71], v[16:19], a[240:247], v2
    s_waitcnt lgkmcnt(6)
    v_smfmac_f32_16x16x64_bf16 v[56:59], v[20:23], a[8:15], v2
    v_smfmac_f32_16x16x64_bf16 v[60:63], v[20:23], a[88:95], v2
    v_smfmac_f32_16x16x64_bf16 v[64:67], v[20:23], a[168:175], v2
    v_smfmac_f32_16x16x64_bf16 v[68:71], v[20:23], a[248:255], v2
    s_waitcnt lgkmcnt(5)
    v_smfmac_f32_16x16x64_bf16 v[56:59], v[24:27], a[16:23], v2
    v_smfmac_f32_16x16x64_bf16 v[60:63], v[24:27], a[96:103], v2
    v_smfmac_f32_16x16x64_bf16 v[64:67], v[24:27], a[176:183], v2
    v_smfmac_f32_16x16x64_bf16 v[68:71], v[24:27], v[176:183], v2
    s_waitcnt lgkmcnt(4)
    v_smfmac_f32_16x16x64_bf16 v[56:59], v[28:31], a[24:31], v2
    v_smfmac_f32_16x16x64_bf16 v[60:63], v[28:31], a[104:111], v2
    v_smfmac_f32_16x16x64_bf16 v[64:67], v[28:31], a[184:191], v2
    v_smfmac_f32_16x16x64_bf16 v[68:71], v[28:31], v[184:191], v2
    s_waitcnt lgkmcnt(3)
    v_smfmac_f32_16x16x64_bf16 v[56:59], v[32:35], a[32:39], v2
    v_smfmac_f32_16x16x64_bf16 v[60:63], v[32:35], a[112:119], v2
    v_smfmac_f32_16x16x64_bf16 v[64:67], v[32:35], a[192:199], v2
    v_smfmac_f32_16x16x64_bf16 v[68:71], v[32:35], v[192:199], v2
    s_waitcnt lgkmcnt(2)
    v_smfmac_f32_16x16x64_bf16 v[56:59], v[36:39], a[40:47], v2
    v_smfmac_f32_16x16x64_bf16 v[60:63], v[36:39], a[120:127], v2
    v_smfmac_f32_16x16x64_bf16 v[64:67], v[36:39], a[200:207], v2
    v_smfmac_f32_16x16x64_bf16 v[68:71], v[36:39], v[200:207], v2
    s_waitcnt lgkmcnt(1)
    v_smfmac_f32_16x16x64_bf16 v[56:59], v[48:51], a[64:71], v2
    v_smfmac_f32_16x16x64_bf16 v[60:63], v[48:51], a[144:151], v2
    v_smfmac_f32_16x16x64_bf16 v[64:67], v[48:51], a[224:231], v2
    v_smfmac_f32_16x16x64_bf16 v[68:71], v[48:51], v[224:231], v2
    s_waitcnt lgkmcnt(0)
    v_smfmac_f32_16x16x64_bf16 v[56:59], v[52:55], a[72:79], v2
    v_smfmac_f32_16x16x64_bf16 v[60:63], v[52:55], a[152:159], v2
    v_smfmac_f32_16x16x64_bf16 v[64:67], v[52:55], a[232:239], v2
    v_smfmac_f32_16x16x64_bf16 v[68:71], v[52:55], v[232:239], v2
    s_nop 7
    v_permlane32_swap_b32 v56, v64
    v_permlane32_swap_b32 v60, v68
    v_permlane32_swap_b32 v57, v65
    v_permlane32_swap_b32 v61, v69
    v_permlane32_swap_b32 v58, v66
    v_permlane32_swap_b32 v62, v70
    v_permlane32_swap_b32 v59, v67
    v_permlane32_swap_b32 v63, v71
    v_add_f32 v56, v56, v64
    v_add_f32 v60, v60, v68
    v_add_f32 v57, v57, v65
    v_add_f32 v61, v61, v69
    v_add_f32 v58, v58, v66
    v_add_f32 v62, v62, v70
    v_add_f32 v59, v59, v67
    v_add_f32 v63, v63, v71
    s_nop 1
    v_permlane16_swap_b32 v56, v60
    v_permlane16_swap_b32 v57, v61
    v_permlane16_swap_b32 v58, v62
    v_permlane16_swap_b32 v59, v63
    s_nop 1
    v_cvt_pk_bf16_f32 v72, v56, v57
    v_cvt_pk_bf16_f32 v73, v58, v59
    v_cvt_pk_bf16_f32 v74, v60, v61
    v_cvt_pk_bf16_f32 v75, v62, v63
    buffer_store_dwordx4 v[72:75], v4, s[8:11], s28 offen sc1
    s_cmp_eq_u32 s14, 63
    s_cbranch_scc1 layerb1_kernel_y2_last
    s_add_u32 s30, s18, 0
    s_add_u32 s31, s18, 4096
    s_add_u32 s32, s18, 16384
    s_add_u32 s33, s18, 20480
    s_add_u32 s34, s18, 32768
    s_add_u32 s29, s14, 1
    s_cmp_lt_u32 s29, 32
    s_cselect_b32 s19, s16, s17
    s_and_b32 s20, s29, 31
    s_lshl_b32 s20, s20, 16
    s_add_u32 s19, s19, s20
layerb1_kernel_y2_ppoll:
    buffer_load_dwordx4 v[92:95], v5, s[8:11], s30 offen sc1
    buffer_load_dwordx4 v[96:99], v5, s[8:11], s31 offen sc1
    buffer_load_dwordx4 v[100:103], v5, s[8:11], s32 offen sc1
    buffer_load_dwordx4 v[104:107], v5, s[8:11], s33 offen sc1
    buffer_load_dwordx4 v[108:111], v5, s[8:11], s34 offen sc1
    s_waitcnt vmcnt(0)
    v_mfma_f32_16x16x32_bf16 v[112:115], v[92:95], v[72:75], 0
    v_mfma_f32_16x16x32_bf16 v[112:115], v[96:99], v[76:79], v[112:115]
    v_mfma_f32_16x16x32_bf16 v[112:115], v[100:103], v[80:83], v[112:115]
    v_mfma_f32_16x16x32_bf16 v[112:115], v[104:107], v[84:87], v[112:115]
    v_mfma_f32_16x16x32_bf16 v[112:115], v[108:111], v[88:91], v[112:115]
    v_max3_u32 v116, v92, v93, v94
    v_max3_u32 v116, v116, v95, v96
    v_max3_u32 v116, v116, v97, v98
    v_max3_u32 v116, v116, v99, v100
    v_max3_u32 v116, v116, v101, v102
    v_max3_u32 v116, v116, v103, v104
    v_max3_u32 v116, v116, v105, v106
    v_max3_u32 v116, v116, v107, v108
    v_max3_u32 v116, v116, v109, v110
    v_max_u32 v116, v116, v111
    v_cmp_eq_u32 vcc, -1, v116
    s_sub_u32 s15, s15, 1
    s_cbranch_scc1 layerb1_kernel_bail
    s_cbranch_vccnz layerb1_kernel_y2_ppoll
    ds_write_b128 v6, v[112:115]
    s_waitcnt lgkmcnt(0)
    s_barrier
    s_barrier
    s_add_u32 s14, s14, 1
    s_branch layerb1_kernel_y2_step
layerb1_kernel_y2_last:
    s_waitcnt vmcnt(0)
    s_barrier
    s_branch layerb1_kernel_end
layerb1_kernel_y3_start:
    v_lshrrev_b32 v16, 4, v0
    v_and_b32 v17, 7, v0
    v_lshrrev_b32 v18, 3, v0
    v_and_b32 v18, 1, v18
    v_lshl_add_u32 v19, v18, 2, v16
    v_add_u32 v19, 24, v19
    v_mul_u32_u24 v20, 640, v19
    v_lshl_add_u32 v4, v17, 4, v20
    v_and_b32 v20, 3, v17
    v_lshlrev_b32 v20, 1, v20
    v_lshrrev_b32 v21, 2, v17
    v_add_u32 v20, v20, v21
    v_lshlrev_b32 v20, 4, v20
    v_lshl_add_u32 v5, v19, 7, v20
    v_add_u32 v3, 0, v1
    v_lshlrev_b32 v20, 8, v18
    v_lshl_add_u32 v20, v17, 5, v20
    v_and_b32 v21, 1, v16
    v_lshl_add_u32 v20, v21, 4, v20
    v_add_u32 v20, 11776, v20
    v_add_u32 v21, 12288, v1
    v_lshrrev_b32 v22, 1, v16
    v_cmp_eq_u32 vcc, v22, v18
    s_nop 1
    v_cndmask_b32 v6, v21, v20, vcc
    v_lshrrev_b32 v20, 3, v0
    v_lshlrev_b32 v20, 2, v20
    v_lshl_add_u32 v20, v17, 5, v20
    v_add_u32 v7, 10240, v20
    s_lshl_b32 s20, s12, 7
    s_add_u32 s20, s20, 20480
    s_lshr_b32 s21, s20, 13
    s_lshl_b32 s21, s21, 14
    s_and_b32 s20, s20, 8191
    s_add_u32 s20, s20, s21
    v_lshrrev_b32 v20, 3, v0
    v_lshlrev_b32 v20, 4, v20
    v_add_u32 v8, s20, v20
    s_mul_i32 s46, s12, 20480
    s_add_u32 s46, s46, 103809024
    s_mul_i32 s20, s12, 327680
    s_add_u32 s20, s20, 27508736
    s_add_u32 s21, s20, 0
    buffer_load_dwordx4 a[0:3], v1, s[8:11], s21 offen offset:0
    buffer_load_dwordx4 a[4:7], v1, s[8:11], s21 offen offset:1024
    s_add_u32 s21, s20, 2048
    buffer_load_dwordx4 a[8:11], v1, s[8:11], s21 offen offset:0
    buffer_load_dwordx4 a[12:15], v1, s[8:11], s21 offen offset:1024
    s_add_u32 s21, s20, 4096
    buffer_load_dwordx4 a[16:19], v1, s[8:11], s21 offen offset:0
    buffer_load_dwordx4 a[20:23], v1, s[8:11], s21 offen offset:1024
    s_add_u32 s21, s20, 6144
    buffer_load_dwordx4 a[24:27], v1, s[8:11], s21 offen offset:0
    buffer_load_dwordx4 a[28:31], v1, s[8:11], s21 offen offset:1024
    s_add_u32 s21, s20, 8192
    buffer_load_dwordx4 a[32:35], v1, s[8:11], s21 offen offset:0
    buffer_load_dwordx4 a[36:39], v1, s[8:11], s21 offen offset:1024
    s_add_u32 s21, s20, 10240
    buffer_load_dwordx4 a[40:43], v1, s[8:11], s21 offen offset:0
    buffer_load_dwordx4 a[44:47], v1, s[8:11], s21 offen offset:1024
    s_add_u32 s21, s20, 12288
    buffer_load_dwordx4 a[48:51], v1, s[8:11], s21 offen offset:0
    buffer_load_dwordx4 a[52:55], v1, s[8:11], s21 offen offset:1024
    s_add_u32 s21, s20, 14336
    buffer_load_dwordx4 a[56:59], v1, s[8:11], s21 offen offset:0
    buffer_load_dwordx4 a[60:63], v1, s[8:11], s21 offen offset:1024
    s_add_u32 s21, s20, 16384
    buffer_load_dwordx4 a[64:67], v1, s[8:11], s21 offen offset:0
    buffer_load_dwordx4 a[68:71], v1, s[8:11], s21 offen offset:1024
    s_add_u32 s21, s20, 18432
    buffer_load_dwordx4 a[72:75], v1, s[8:11], s21 offen offset:0
    buffer_load_dwordx4 a[76:79], v1, s[8:11], s21 offen offset:1024
    s_add_u32 s21, s20, 20480
    buffer_load_dwordx4 a[80:83], v1, s[8:11], s21 offen offset:0
    buffer_load_dwordx4 a[84:87], v1, s[8:11], s21 offen offset:1024
    s_add_u32 s21, s20, 22528
    buffer_load_dwordx4 a[88:91], v1, s[8:11], s21 offen offset:0
    buffer_load_dwordx4 a[92:95], v1, s[8:11], s21 offen offset:1024
    s_add_u32 s21, s20, 24576
    buffer_load_dwordx4 a[96:99], v1, s[8:11], s21 offen offset:0
    buffer_load_dwordx4 a[100:103], v1, s[8:11], s21 offen offset:1024
    s_add_u32 s21, s20, 26624
    buffer_load_dwordx4 a[104:107], v1, s[8:11], s21 offen offset:0
    buffer_load_dwordx4 a[108:111], v1, s[8:11], s21 offen offset:1024
    s_add_u32 s21, s20, 28672
    buffer_load_dwordx4 a[112:115], v1, s[8:11], s21 offen offset:0
    buffer_load_dwordx4 a[116:119], v1, s[8:11], s21 offen offset:1024
    s_add_u32 s21, s20, 30720
    buffer_load_dwordx4 a[120:123], v1, s[8:11], s21 offen offset:0
    buffer_load_dwordx4 a[124:127], v1, s[8:11], s21 offen offset:1024
    s_add_u32 s21, s20, 32768
    buffer_load_dwordx4 a[128:131], v1, s[8:11], s21 offen offset:0
    buffer_load_dwordx4 a[132:135], v1, s[8:11], s21 offen offset:1024
    s_add_u32 s21, s20, 34816
    buffer_load_dwordx4 a[136:139], v1, s[8:11], s21 offen offset:0
    buffer_load_dwordx4 a[140:143], v1, s[8:11], s21 offen offset:1024
    s_add_u32 s21, s20, 36864
    buffer_load_dwordx4 a[144:147], v1, s[8:11], s21 offen offset:0
    buffer_load_dwordx4 a[148:151], v1, s[8:11], s21 offen offset:1024
    s_add_u32 s21, s20, 38912
    buffer_load_dwordx4 a[152:155], v1, s[8:11], s21 offen offset:0
    buffer_load_dwordx4 a[156:159], v1, s[8:11], s21 offen offset:1024
    s_add_u32 s21, s20, 40960
    buffer_load_dwordx4 a[160:163], v1, s[8:11], s21 offen offset:0
    buffer_load_dwordx4 a[164:167], v1, s[8:11], s21 offen offset:1024
    s_add_u32 s21, s20, 43008
    buffer_load_dwordx4 a[168:171], v1, s[8:11], s21 offen offset:0
    buffer_load_dwordx4 a[172:175], v1, s[8:11], s21 offen offset:1024
    s_add_u32 s21, s20, 45056
    buffer_load_dwordx4 a[176:179], v1, s[8:11], s21 offen offset:0
    buffer_load_dwordx4 a[180:183], v1, s[8:11], s21 offen offset:1024
    s_add_u32 s21, s20, 47104
    buffer_load_dwordx4 a[184:187], v1, s[8:11], s21 offen offset:0
    buffer_load_dwordx4 a[188:191], v1, s[8:11], s21 offen offset:1024
    s_add_u32 s21, s20, 49152
    buffer_load_dwordx4 a[192:195], v1, s[8:11], s21 offen offset:0
    buffer_load_dwordx4 a[196:199], v1, s[8:11], s21 offen offset:1024
    s_add_u32 s21, s20, 51200
    buffer_load_dwordx4 a[200:203], v1, s[8:11], s21 offen offset:0
    buffer_load_dwordx4 a[204:207], v1, s[8:11], s21 offen offset:1024
    s_add_u32 s21, s20, 53248
    buffer_load_dwordx4 a[208:211], v1, s[8:11], s21 offen offset:0
    buffer_load_dwordx4 a[212:215], v1, s[8:11], s21 offen offset:1024
    s_add_u32 s21, s20, 55296
    buffer_load_dwordx4 a[216:219], v1, s[8:11], s21 offen offset:0
    buffer_load_dwordx4 a[220:223], v1, s[8:11], s21 offen offset:1024
    s_add_u32 s21, s20, 57344
    buffer_load_dwordx4 a[224:227], v1, s[8:11], s21 offen offset:0
    buffer_load_dwordx4 a[228:231], v1, s[8:11], s21 offen offset:1024
    s_add_u32 s21, s20, 59392
    buffer_load_dwordx4 a[232:235], v1, s[8:11], s21 offen offset:0
    buffer_load_dwordx4 a[236:239], v1, s[8:11], s21 offen offset:1024
    s_add_u32 s21, s20, 61440
    buffer_load_dwordx4 a[240:243], v1, s[8:11], s21 offen offset:0
    buffer_load_dwordx4 a[244:247], v1, s[8:11], s21 offen offset:1024
    s_add_u32 s21, s20, 63488
    buffer_load_dwordx4 a[248:251], v1, s[8:11], s21 offen offset:0
    buffer_load_dwordx4 a[252:255], v1, s[8:11], s21 offen offset:1024
    s_add_u32 s21, s20, 65536
    buffer_load_dwordx4 v[176:179], v1, s[8:11], s21 offen offset:0
    buffer_load_dwordx4 v[180:183], v1, s[8:11], s21 offen offset:1024
    s_add_u32 s21, s20, 67584
    buffer_load_dwordx4 v[184:187], v1, s[8:11], s21 offen offset:0
    buffer_load_dwordx4 v[188:191], v1, s[8:11], s21 offen offset:1024
    s_add_u32 s21, s20, 69632
    buffer_load_dwordx4 v[192:195], v1, s[8:11], s21 offen offset:0
    buffer_load_dwordx4 v[196:199], v1, s[8:11], s21 offen offset:1024
    s_add_u32 s21, s20, 71680
    buffer_load_dwordx4 v[200:203], v1, s[8:11], s21 offen offset:0
    buffer_load_dwordx4 v[204:207], v1, s[8:11], s21 offen offset:1024
    s_add_u32 s21, s20, 73728
    buffer_load_dwordx4 v[208:211], v1, s[8:11], s21 offen offset:0
    buffer_load_dwordx4 v[212:215], v1, s[8:11], s21 offen offset:1024
    s_add_u32 s21, s20, 75776
    buffer_load_dwordx4 v[216:219], v1, s[8:11], s21 offen offset:0
    buffer_load_dwordx4 v[220:223], v1, s[8:11], s21 offen offset:1024
    s_add_u32 s21, s20, 77824
    buffer_load_dwordx4 v[224:227], v1, s[8:11], s21 offen offset:0
    buffer_load_dwordx4 v[228:231], v1, s[8:11], s21 offen offset:1024
    s_add_u32 s21, s20, 79872
    buffer_load_dwordx4 v[232:235], v1, s[8:11], s21 offen offset:0
    buffer_load_dwordx4 v[236:239], v1, s[8:11], s21 offen offset:1024
    s_mov_b32 s14, 0
    s_lshl_b32 s20, s12, 7
    v_mov_b32 v9, s20
    s_mov_b32 s47, 0
layerb1_kernel_y3_step:
    s_cmp_lt_u32 s14, 32
    s_cselect_b32 s18, s16, s17
    s_and_b32 s20, s14, 31
    s_lshl_b32 s20, s20, 16
    s_add_u32 s18, s18, s20
    s_mul_i32 s28, s14, 1638400
    s_add_u32 s28, s28, s46
    v_mov_b32 v56, 0
    v_mov_b32 v57, 0
    v_mov_b32 v58, 0
    v_mov_b32 v59, 0
    v_mov_b32 v60, 0
    v_mov_b32 v61, 0
    v_mov_b32 v62, 0
    v_mov_b32 v63, 0
    v_mov_b32 v64, 0
    v_mov_b32 v65, 0
    v_mov_b32 v66, 0
    v_mov_b32 v67, 0
    v_mov_b32 v68, 0
    v_mov_b32 v69, 0
    v_mov_b32 v70, 0
    v_mov_b32 v71, 0
    s_add_u32 s22, s18, 53248
    s_add_u32 s23, s18, 54272
layerb1_kernel_y3_poll:
    buffer_load_dwordx4 v[48:51], v1, s[8:11], s22 offen sc1
    buffer_load_dwordx4 v[52:55], v1, s[8:11], s23 offen sc1
    s_waitcnt vmcnt(0)
    ds_write_b128 v3, v[48:51] offset:8192
    ds_write_b128 v3, v[52:55] offset:9216
    v_max3_u32 v116, v48, v49, v50
    v_max3_u32 v116, v116, v51, v52
    v_max3_u32 v116, v116, v53, v54
    v_max_u32 v116, v116, v55
    v_cmp_eq_u32 vcc, -1, v116
    s_sub_u32 s15, s15, 1
    s_cbranch_scc1 layerb1_kernel_bail
    s_cbranch_vccnz layerb1_kernel_y3_poll
    s_waitcnt lgkmcnt(0)
    s_barrier
    ds_read_b128 v[16:19], v3 offset:0
    ds_read_b128 v[20:23], v3 offset:1024
    ds_read_b128 v[24:27], v3 offset:2048
    ds_read_b128 v[28:31], v3 offset:3072
    ds_read_b128 v[32:35], v3 offset:4096
    ds_read_b128 v[36:39], v3 offset:5120
    ds_read_b128 v[40:43], v3 offset:6144
    ds_read_b128 v[44:47], v3 offset:7168
    s_cmp_gt_u32 s47, s14
    s_cbranch_scc1 layerb1_kernel_y3_gw_ok
layerb1_kernel_y3_gw_lp:
    buffer_load_dword v116, v9, s[8:11], s48 offen sc1
    s_waitcnt vmcnt(0)
    v_readlane_b32 s47, v116, 0
    s_nop 0
    s_sub_u32 s15, s15, 1
    s_cbranch_scc1 layerb1_kernel_bail
    s_cmp_gt_u32 s47, s14
    s_cbranch_scc0 layerb1_kernel_y3_gw_lp
layerb1_kernel_y3_gw_ok:
    buffer_load_dwordx4 v[76:79], v4, s[8:11], s28 offen offset:128 sc1
    buffer_load_dwordx4 v[80:83], v4, s[8:11], s28 offen offset:256 sc1
    buffer_load_dwordx4 v[84:87], v4, s[8:11], s28 offen offset:384 sc1
    buffer_load_dwordx4 v[88:91], v4, s[8:11], s28 offen offset:512 sc1
    v_smfmac_f32_16x16x64_bf16 v[56:59], v[48:51], a[64:71], v2
    v_smfmac_f32_16x16x64_bf16 v[60:63], v[48:51], a[144:151], v2
    v_smfmac_f32_16x16x64_bf16 v[64:67], v[48:51], a[224:231], v2
    v_smfmac_f32_16x16x64_bf16 v[68:71], v[48:51], v[224:231], v2
    v_smfmac_f32_16x16x64_bf16 v[56:59], v[52:55], a[72:79], v2
    v_smfmac_f32_16x16x64_bf16 v[60:63], v[52:55], a[152:159], v2
    v_smfmac_f32_16x16x64_bf16 v[64:67], v[52:55], a[232:239], v2
    v_smfmac_f32_16x16x64_bf16 v[68:71], v[52:55], v[232:239], v2
    s_waitcnt lgkmcnt(7)
    v_smfmac_f32_16x16x64_bf16 v[56:59], v[16:19], a[0:7], v2
    v_smfmac_f32_16x16x64_bf16 v[60:63], v[16:19], a[80:87], v2
    v_smfmac_f32_16x16x64_bf16 v[64:67], v[16:19], a[160:167], v2
    v_smfmac_f32_16x16x64_bf16 v[68:71], v[16:19], a[240:247], v2
    s_waitcnt lgkmcnt(6)
    v_smfmac_f32_16x16x64_bf16 v[56:59], v[20:23], a[8:15], v2
    v_smfmac_f32_16x16x64_bf16 v[60:63], v[20:23], a[88:95], v2
    v_smfmac_f32_16x16x64_bf16 v[64:67], v[20:23], a[168:175], v2
    v_smfmac_f32_16x16x64_bf16 v[68:71], v[20:23], a[248:255], v2
    s_waitcnt lgkmcnt(5)
    v_smfmac_f32_16x16x64_bf16 v[56:59], v[24:27], a[16:23], v2
    v_smfmac_f32_16x16x64_bf16 v[60:63], v[24:27], a[96:103], v2
    v_smfmac_f32_16x16x64_bf16 v[64:67], v[24:27], a[176:183], v2
    v_smfmac_f32_16x16x64_bf16 v[68:71], v[24:27], v[176:183], v2
    s_waitcnt lgkmcnt(4)
    v_smfmac_f32_16x16x64_bf16 v[56:59], v[28:31], a[24:31], v2
    v_smfmac_f32_16x16x64_bf16 v[60:63], v[28:31], a[104:111], v2
    v_smfmac_f32_16x16x64_bf16 v[64:67], v[28:31], a[184:191], v2
    v_smfmac_f32_16x16x64_bf16 v[68:71], v[28:31], v[184:191], v2
    s_waitcnt lgkmcnt(3)
    v_smfmac_f32_16x16x64_bf16 v[56:59], v[32:35], a[32:39], v2
    v_smfmac_f32_16x16x64_bf16 v[60:63], v[32:35], a[112:119], v2
    v_smfmac_f32_16x16x64_bf16 v[64:67], v[32:35], a[192:199], v2
    v_smfmac_f32_16x16x64_bf16 v[68:71], v[32:35], v[192:199], v2
    s_waitcnt lgkmcnt(2)
    v_smfmac_f32_16x16x64_bf16 v[56:59], v[36:39], a[40:47], v2
    v_smfmac_f32_16x16x64_bf16 v[60:63], v[36:39], a[120:127], v2
    v_smfmac_f32_16x16x64_bf16 v[64:67], v[36:39], a[200:207], v2
    v_smfmac_f32_16x16x64_bf16 v[68:71], v[36:39], v[200:207], v2
    s_waitcnt lgkmcnt(1)
    v_smfmac_f32_16x16x64_bf16 v[56:59], v[40:43], a[48:55], v2
    v_smfmac_f32_16x16x64_bf16 v[60:63], v[40:43], a[128:135], v2
    v_smfmac_f32_16x16x64_bf16 v[64:67], v[40:43], a[208:215], v2
    v_smfmac_f32_16x16x64_bf16 v[68:71], v[40:43], v[208:215], v2
    s_waitcnt lgkmcnt(0)
    v_smfmac_f32_16x16x64_bf16 v[56:59], v[44:47], a[56:63], v2
    v_smfmac_f32_16x16x64_bf16 v[60:63], v[44:47], a[136:143], v2
    v_smfmac_f32_16x16x64_bf16 v[64:67], v[44:47], a[216:223], v2
    v_smfmac_f32_16x16x64_bf16 v[68:71], v[44:47], v[216:223], v2
    s_nop 7
    v_permlane32_swap_b32 v56, v64
    v_permlane32_swap_b32 v60, v68
    v_permlane32_swap_b32 v57, v65
    v_permlane32_swap_b32 v61, v69
    v_permlane32_swap_b32 v58, v66
    v_permlane32_swap_b32 v62, v70
    v_permlane32_swap_b32 v59, v67
    v_permlane32_swap_b32 v63, v71
    v_add_f32 v56, v56, v64
    v_add_f32 v60, v60, v68
    v_add_f32 v57, v57, v65
    v_add_f32 v61, v61, v69
    v_add_f32 v58, v58, v66
    v_add_f32 v62, v62, v70
    v_add_f32 v59, v59, v67
    v_add_f32 v63, v63, v71
    s_nop 1
    v_permlane16_swap_b32 v56, v60
    v_permlane16_swap_b32 v57, v61
    v_permlane16_swap_b32 v58, v62
    v_permlane16_swap_b32 v59, v63
    s_nop 1
    v_cvt_pk_bf16_f32 v72, v56, v57
    v_cvt_pk_bf16_f32 v73, v58, v59
    v_cvt_pk_bf16_f32 v74, v60, v61
    v_cvt_pk_bf16_f32 v75, v62, v63
    buffer_store_dwordx4 v[72:75], v4, s[8:11], s28 offen sc1
    s_cmp_eq_u32 s14, 63
    s_cbranch_scc1 layerb1_kernel_y3_last
    s_add_u32 s30, s18, 0
    s_add_u32 s31, s18, 4096
    s_add_u32 s32, s18, 16384
    s_add_u32 s33, s18, 20480
    s_add_u32 s34, s18, 32768
    s_add_u32 s29, s14, 1
    s_cmp_lt_u32 s29, 32
    s_cselect_b32 s19, s16, s17
    s_and_b32 s20, s29, 31
    s_lshl_b32 s20, s20, 16
    s_add_u32 s19, s19, s20
layerb1_kernel_y3_ppoll:
    buffer_load_dwordx4 v[92:95], v5, s[8:11], s30 offen sc1
    buffer_load_dwordx4 v[96:99], v5, s[8:11], s31 offen sc1
    buffer_load_dwordx4 v[100:103], v5, s[8:11], s32 offen sc1
    buffer_load_dwordx4 v[104:107], v5, s[8:11], s33 offen sc1
    buffer_load_dwordx4 v[108:111], v5, s[8:11], s34 offen sc1
    s_waitcnt vmcnt(0)
    v_mfma_f32_16x16x32_bf16 v[112:115], v[92:95], v[72:75], 0
    v_mfma_f32_16x16x32_bf16 v[112:115], v[96:99], v[76:79], v[112:115]
    v_mfma_f32_16x16x32_bf16 v[112:115], v[100:103], v[80:83], v[112:115]
    v_mfma_f32_16x16x32_bf16 v[112:115], v[104:107], v[84:87], v[112:115]
    v_mfma_f32_16x16x32_bf16 v[112:115], v[108:111], v[88:91], v[112:115]
    v_max3_u32 v116, v92, v93, v94
    v_max3_u32 v116, v116, v95, v96
    v_max3_u32 v116, v116, v97, v98
    v_max3_u32 v116, v116, v99, v100
    v_max3_u32 v116, v116, v101, v102
    v_max3_u32 v116, v116, v103, v104
    v_max3_u32 v116, v116, v105, v106
    v_max3_u32 v116, v116, v107, v108
    v_max3_u32 v116, v116, v109, v110
    v_max_u32 v116, v116, v111
    v_cmp_eq_u32 vcc, -1, v116
    s_sub_u32 s15, s15, 1
    s_cbranch_scc1 layerb1_kernel_bail
    s_cbranch_vccnz layerb1_kernel_y3_ppoll
    ds_write_b128 v6, v[112:115]
    s_waitcnt lgkmcnt(0)
    s_barrier
    s_barrier
    s_add_u32 s14, s14, 1
    s_branch layerb1_kernel_y3_step
layerb1_kernel_y3_last:
    s_waitcnt vmcnt(0)
    s_barrier
    s_branch layerb1_kernel_end
layerb1_kernel_proj:
    s_sub_u32 s22, s20, 4
    s_lshl_b32 s22, s22, 5
    s_add_u32 s12, s22, s21
    s_mov_b32 s14, 0
    s_mov_b32 s15, 64
    v_lshlrev_b32 v1, 4, v0
    v_and_b32 v8, 31, v0
    v_lshrrev_b32 v9, 5, v0
    s_cmp_ge_u32 s12, 80
    s_cbranch_scc1 layerb1_kernel_g_qk
    v_lshrrev_b32 v10, 3, v8
    v_and_b32 v11, 7, v8
    v_mul_u32_u24 v12, 20480, v10
    v_lshl_add_u32 v12, v11, 4, v12
    v_lshl_add_u32 v4, v9, 8, v12
    s_mul_i32 s24, s12, 327680
    s_mul_i32 s25, s13, 81920
    s_add_u32 s24, s24, s25
    s_add_u32 s24, s24, 27262976
    buffer_load_dwordx4 a[0:3], v4, s[8:11], s24 offen offset:0
    buffer_load_dwordx4 a[4:7], v4, s[8:11], s24 offen offset:128
    buffer_load_dwordx4 a[8:11], v4, s[8:11], s24 offen offset:512
    buffer_load_dwordx4 a[12:15], v4, s[8:11], s24 offen offset:640
    buffer_load_dwordx4 a[16:19], v4, s[8:11], s24 offen offset:1024
    buffer_load_dwordx4 a[20:23], v4, s[8:11], s24 offen offset:1152
    buffer_load_dwordx4 a[24:27], v4, s[8:11], s24 offen offset:1536
    buffer_load_dwordx4 a[28:31], v4, s[8:11], s24 offen offset:1664
    buffer_load_dwordx4 a[32:35], v4, s[8:11], s24 offen offset:2048
    buffer_load_dwordx4 a[36:39], v4, s[8:11], s24 offen offset:2176
    buffer_load_dwordx4 a[40:43], v4, s[8:11], s24 offen offset:2560
    buffer_load_dwordx4 a[44:47], v4, s[8:11], s24 offen offset:2688
    buffer_load_dwordx4 a[48:51], v4, s[8:11], s24 offen offset:3072
    buffer_load_dwordx4 a[52:55], v4, s[8:11], s24 offen offset:3200
    s_add_u32 s24, s24, 3584
    buffer_load_dwordx4 a[56:59], v4, s[8:11], s24 offen offset:0
    buffer_load_dwordx4 a[60:63], v4, s[8:11], s24 offen offset:128
    buffer_load_dwordx4 a[64:67], v4, s[8:11], s24 offen offset:512
    buffer_load_dwordx4 a[68:71], v4, s[8:11], s24 offen offset:640
    buffer_load_dwordx4 a[72:75], v4, s[8:11], s24 offen offset:1024
    buffer_load_dwordx4 a[76:79], v4, s[8:11], s24 offen offset:1152
    buffer_load_dwordx4 a[80:83], v4, s[8:11], s24 offen offset:1536
    buffer_load_dwordx4 a[84:87], v4, s[8:11], s24 offen offset:1664
    buffer_load_dwordx4 a[88:91], v4, s[8:11], s24 offen offset:2048
    buffer_load_dwordx4 a[92:95], v4, s[8:11], s24 offen offset:2176
    buffer_load_dwordx4 a[96:99], v4, s[8:11], s24 offen offset:2560
    buffer_load_dwordx4 a[100:103], v4, s[8:11], s24 offen offset:2688
    buffer_load_dwordx4 a[104:107], v4, s[8:11], s24 offen offset:3072
    buffer_load_dwordx4 a[108:111], v4, s[8:11], s24 offen offset:3200
    s_add_u32 s24, s24, 3584
    buffer_load_dwordx4 a[112:115], v4, s[8:11], s24 offen offset:0
    buffer_load_dwordx4 a[116:119], v4, s[8:11], s24 offen offset:128
    buffer_load_dwordx4 a[120:123], v4, s[8:11], s24 offen offset:512
    buffer_load_dwordx4 a[124:127], v4, s[8:11], s24 offen offset:640
    buffer_load_dwordx4 a[128:131], v4, s[8:11], s24 offen offset:1024
    buffer_load_dwordx4 a[132:135], v4, s[8:11], s24 offen offset:1152
    buffer_load_dwordx4 a[136:139], v4, s[8:11], s24 offen offset:1536
    buffer_load_dwordx4 a[140:143], v4, s[8:11], s24 offen offset:1664
    buffer_load_dwordx4 a[144:147], v4, s[8:11], s24 offen offset:2048
    buffer_load_dwordx4 a[148:151], v4, s[8:11], s24 offen offset:2176
    buffer_load_dwordx4 a[152:155], v4, s[8:11], s24 offen offset:2560
    buffer_load_dwordx4 a[156:159], v4, s[8:11], s24 offen offset:2688
    buffer_load_dwordx4 a[160:163], v4, s[8:11], s24 offen offset:3072
    buffer_load_dwordx4 a[164:167], v4, s[8:11], s24 offen offset:3200
    s_add_u32 s24, s24, 3584
    buffer_load_dwordx4 a[168:171], v4, s[8:11], s24 offen offset:0
    buffer_load_dwordx4 a[172:175], v4, s[8:11], s24 offen offset:128
    buffer_load_dwordx4 a[176:179], v4, s[8:11], s24 offen offset:512
    buffer_load_dwordx4 a[180:183], v4, s[8:11], s24 offen offset:640
    buffer_load_dwordx4 a[184:187], v4, s[8:11], s24 offen offset:1024
    buffer_load_dwordx4 a[188:191], v4, s[8:11], s24 offen offset:1152
    buffer_load_dwordx4 a[192:195], v4, s[8:11], s24 offen offset:1536
    buffer_load_dwordx4 a[196:199], v4, s[8:11], s24 offen offset:1664
    buffer_load_dwordx4 a[200:203], v4, s[8:11], s24 offen offset:2048
    buffer_load_dwordx4 a[204:207], v4, s[8:11], s24 offen offset:2176
    buffer_load_dwordx4 a[208:211], v4, s[8:11], s24 offen offset:2560
    buffer_load_dwordx4 a[212:215], v4, s[8:11], s24 offen offset:2688
    buffer_load_dwordx4 a[216:219], v4, s[8:11], s24 offen offset:3072
    buffer_load_dwordx4 a[220:223], v4, s[8:11], s24 offen offset:3200
    s_add_u32 s24, s24, 3584
    buffer_load_dwordx4 a[224:227], v4, s[8:11], s24 offen offset:0
    buffer_load_dwordx4 a[228:231], v4, s[8:11], s24 offen offset:128
    buffer_load_dwordx4 a[232:235], v4, s[8:11], s24 offen offset:512
    buffer_load_dwordx4 a[236:239], v4, s[8:11], s24 offen offset:640
    buffer_load_dwordx4 a[240:243], v4, s[8:11], s24 offen offset:1024
    buffer_load_dwordx4 a[244:247], v4, s[8:11], s24 offen offset:1152
    buffer_load_dwordx4 a[248:251], v4, s[8:11], s24 offen offset:1536
    buffer_load_dwordx4 a[252:255], v4, s[8:11], s24 offen offset:1664
    buffer_load_dwordx4 v[192:195], v4, s[8:11], s24 offen offset:2048
    buffer_load_dwordx4 v[196:199], v4, s[8:11], s24 offen offset:2176
    buffer_load_dwordx4 v[200:203], v4, s[8:11], s24 offen offset:2560
    buffer_load_dwordx4 v[204:207], v4, s[8:11], s24 offen offset:2688
    buffer_load_dwordx4 v[208:211], v4, s[8:11], s24 offen offset:3072
    buffer_load_dwordx4 v[212:215], v4, s[8:11], s24 offen offset:3200
    s_add_u32 s24, s24, 3584
    buffer_load_dwordx4 v[216:219], v4, s[8:11], s24 offen offset:0
    buffer_load_dwordx4 v[220:223], v4, s[8:11], s24 offen offset:128
    buffer_load_dwordx4 v[224:227], v4, s[8:11], s24 offen offset:512
    buffer_load_dwordx4 v[228:231], v4, s[8:11], s24 offen offset:640
    buffer_load_dwordx4 v[232:235], v4, s[8:11], s24 offen offset:1024
    buffer_load_dwordx4 v[236:239], v4, s[8:11], s24 offen offset:1152
    buffer_load_dwordx4 v[240:243], v4, s[8:11], s24 offen offset:1536
    buffer_load_dwordx4 v[244:247], v4, s[8:11], s24 offen offset:1664
    buffer_load_dwordx4 v[248:251], v4, s[8:11], s24 offen offset:2048
    buffer_load_dwordx4 v[252:255], v4, s[8:11], s24 offen offset:2176
    s_lshl_b32 s25, s13, 3
    v_add_u32 v10, s25, v10
    v_mul_u32_u24 v10, 640, v10
    v_lshl_add_u32 v10, v9, 7, v10
    v_lshl_add_u32 v10, v11, 4, v10
    v_add_u32 v3, 128, v10
    s_mul_i32 s17, s12, 20480
    s_mul_i32 s25, s14, 1638400
    s_add_u32 s17, s17, s25
    s_add_u32 s17, s17, 103809024
    s_mov_b32 s20, 1638400
    s_mul_i32 s19, s13, 10240
    s_add_u32 s19, s19, 220200960
    s_mov_b32 s22, 0
    s_min_u32 s24, s14, 63
    s_mul_i32 s24, s24, 40960
    s_add_u32 s24, s24, s19
    s_mul_i32 s25, s13, 10240
    s_add_u32 s25, s25, s22
    s_mov_b32 m0, s25
    s_nop 0
    buffer_load_dwordx4 v1, s[8:11], s24 offen offset:0 lds
    buffer_load_dwordx4 v1, s[8:11], s24 offen offset:1024 lds
    buffer_load_dwordx4 v1, s[8:11], s24 offen offset:2048 lds
    buffer_load_dwordx4 v1, s[8:11], s24 offen offset:3072 lds
    s_add_u32 s24, s24, 4096
    s_add_u32 s25, s25, 4096
    s_mov_b32 m0, s25
    s_nop 0
    buffer_load_dwordx4 v1, s[8:11], s24 offen offset:0 lds
    buffer_load_dwordx4 v1, s[8:11], s24 offen offset:1024 lds
    buffer_load_dwordx4 v1, s[8:11], s24 offen offset:2048 lds
    buffer_load_dwordx4 v1, s[8:11], s24 offen offset:3072 lds
    s_add_u32 s24, s24, 4096
    s_add_u32 s25, s25, 4096
    s_mov_b32 m0, s25
    s_nop 0
    buffer_load_dwordx4 v1, s[8:11], s24 offen offset:0 lds
    buffer_load_dwordx4 v1, s[8:11], s24 offen offset:1024 lds
    s_mov_b32 s22, 40960
    s_add_u32 s23, s14, 1
    s_min_u32 s24, s23, 63
    s_mul_i32 s24, s24, 40960
    s_add_u32 s24, s24, s19
    s_mul_i32 s25, s13, 10240
    s_add_u32 s25, s25, s22
    s_mov_b32 m0, s25
    s_nop 0
    buffer_load_dwordx4 v1, s[8:11], s24 offen offset:0 lds
    buffer_load_dwordx4 v1, s[8:11], s24 offen offset:1024 lds
    buffer_load_dwordx4 v1, s[8:11], s24 offen offset:2048 lds
    buffer_load_dwordx4 v1, s[8:11], s24 offen offset:3072 lds
    s_add_u32 s24, s24, 4096
    s_add_u32 s25, s25, 4096
    s_mov_b32 m0, s25
    s_nop 0
    buffer_load_dwordx4 v1, s[8:11], s24 offen offset:0 lds
    buffer_load_dwordx4 v1, s[8:11], s24 offen offset:1024 lds
    buffer_load_dwordx4 v1, s[8:11], s24 offen offset:2048 lds
    buffer_load_dwordx4 v1, s[8:11], s24 offen offset:3072 lds
    s_add_u32 s24, s24, 4096
    s_add_u32 s25, s25, 4096
    s_mov_b32 m0, s25
    s_nop 0
    buffer_load_dwordx4 v1, s[8:11], s24 offen offset:0 lds
    buffer_load_dwordx4 v1, s[8:11], s24 offen offset:1024 lds
    s_mov_b32 s22, 81920
    s_mov_b32 s16, 0
    s_waitcnt vmcnt(10)
    s_barrier
    v_mov_b32 v2, v1
    ds_read_b128 v[8:11], v2 offset:0
    ds_read_b128 v[12:15], v2 offset:1024
    ds_read_b128 v[16:19], v2 offset:2048
    ds_read_b128 v[20:23], v2 offset:3072
    ds_read_b128 v[24:27], v2 offset:4096
    ds_read_b128 v[28:31], v2 offset:5120
    ds_read_b128 v[32:35], v2 offset:6144
    s_waitcnt lgkmcnt(6)
    v_mfma_f32_32x32x16_bf16 v[40:55], v[8:11], a[0:3], 0
    v_mfma_f32_32x32x16_bf16 v[56:71], v[8:11], a[4:7], 0
    ds_read_b128 v[36:39], v2 offset:7168
    s_waitcnt lgkmcnt(6)
    v_mfma_f32_32x32x16_bf16 v[40:55], v[12:15], a[8:11], v[40:55]
    v_mfma_f32_32x32x16_bf16 v[56:71], v[12:15], a[12:15], v[56:71]
    ds_read_b128 v[8:11], v2 offset:8192
    s_waitcnt lgkmcnt(6)
    v_mfma_f32_32x32x16_bf16 v[40:55], v[16:19], a[16:19], v[40:55]
    v_mfma_f32_32x32x16_bf16 v[56:71], v[16:19], a[20:23], v[56:71]
    ds_read_b128 v[12:15], v2 offset:9216
    s_waitcnt lgkmcnt(6)
    v_mfma_f32_32x32x16_bf16 v[40:55], v[20:23], a[24:27], v[40:55]
    v_mfma_f32_32x32x16_bf16 v[56:71], v[20:23], a[28:31], v[56:71]
    ds_read_b128 v[16:19], v2 offset:10240
    s_waitcnt lgkmcnt(6)
    v_mfma_f32_32x32x16_bf16 v[40:55], v[24:27], a[32:35], v[40:55]
    v_mfma_f32_32x32x16_bf16 v[56:71], v[24:27], a[36:39], v[56:71]
    ds_read_b128 v[20:23], v2 offset:11264
    s_waitcnt lgkmcnt(6)
    v_mfma_f32_32x32x16_bf16 v[40:55], v[28:31], a[40:43], v[40:55]
    v_mfma_f32_32x32x16_bf16 v[56:71], v[28:31], a[44:47], v[56:71]
    ds_read_b128 v[24:27], v2 offset:12288
    s_waitcnt lgkmcnt(6)
    v_mfma_f32_32x32x16_bf16 v[40:55], v[32:35], a[48:51], v[40:55]
    v_mfma_f32_32x32x16_bf16 v[56:71], v[32:35], a[52:55], v[56:71]
    ds_read_b128 v[28:31], v2 offset:13312
    s_waitcnt lgkmcnt(6)
    v_mfma_f32_32x32x16_bf16 v[40:55], v[36:39], a[56:59], v[40:55]
    v_mfma_f32_32x32x16_bf16 v[56:71], v[36:39], a[60:63], v[56:71]
    ds_read_b128 v[32:35], v2 offset:14336
    s_waitcnt lgkmcnt(6)
    v_mfma_f32_32x32x16_bf16 v[40:55], v[8:11], a[64:67], v[40:55]
    v_mfma_f32_32x32x16_bf16 v[56:71], v[8:11], a[68:71], v[56:71]
    ds_read_b128 v[36:39], v2 offset:15360
    s_waitcnt lgkmcnt(6)
    v_mfma_f32_32x32x16_bf16 v[40:55], v[12:15], a[72:75], v[40:55]
    v_mfma_f32_32x32x16_bf16 v[56:71], v[12:15], a[76:79], v[56:71]
    ds_read_b128 v[8:11], v2 offset:16384
    s_waitcnt lgkmcnt(6)
    v_mfma_f32_32x32x16_bf16 v[40:55], v[16:19], a[80:83], v[40:55]
    v_mfma_f32_32x32x16_bf16 v[56:71], v[16:19], a[84:87], v[56:71]
    ds_read_b128 v[12:15], v2 offset:17408
    s_waitcnt lgkmcnt(6)
    v_mfma_f32_32x32x16_bf16 v[40:55], v[20:23], a[88:91], v[40:55]
    v_mfma_f32_32x32x16_bf16 v[56:71], v[20:23], a[92:95], v[56:71]
    ds_read_b128 v[16:19], v2 offset:18432
    s_waitcnt lgkmcnt(6)
    v_mfma_f32_32x32x16_bf16 v[40:55], v[24:27], a[96:99], v[40:55]
    v_mfma_f32_32x32x16_bf16 v[56:71], v[24:27], a[100:103], v[56:71]
    ds_read_b128 v[20:23], v2 offset:19456
    s_waitcnt lgkmcnt(6)
    v_mfma_f32_32x32x16_bf16 v[40:55], v[28:31], a[104:107], v[40:55]
    v_mfma_f32_32x32x16_bf16 v[56:71], v[28:31], a[108:111], v[56:71]
    ds_read_b128 v[24:27], v2 offset:20480
    s_waitcnt lgkmcnt(6)
    v_mfma_f32_32x32x16_bf16 v[40:55], v[32:35], a[112:115], v[40:55]
    v_mfma_f32_32x32x16_bf16 v[56:71], v[32:35], a[116:119], v[56:71]
    ds_read_b128 v[28:31], v2 offset:21504
    s_waitcnt lgkmcnt(6)
    v_mfma_f32_32x32x16_bf16 v[40:55], v[36:39], a[120:123], v[40:55]
    v_mfma_f32_32x32x16_bf16 v[56:71], v[36:39], a[124:127], v[56:71]
    ds_read_b128 v[32:35], v2 offset:22528
    s_waitcnt lgkmcnt(6)
    v_mfma_f32_32x32x16_bf16 v[40:55], v[8:11], a[128:131], v[40:55]
    v_mfma_f32_32x32x16_bf16 v[56:71], v[8:11], a[132:135], v[56:71]
    ds_read_b128 v[36:39], v2 offset:23552
    s_waitcnt lgkmcnt(6)
    v_mfma_f32_32x32x16_bf16 v[40:55], v[12:15], a[136:139], v[40:55]
    v_mfma_f32_32x32x16_bf16 v[56:71], v[12:15], a[140:143], v[56:71]
    ds_read_b128 v[8:11], v2 offset:24576
    s_waitcnt lgkmcnt(6)
    v_mfma_f32_32x32x16_bf16 v[40:55], v[16:19], a[144:147], v[40:55]
    v_mfma_f32_32x32x16_bf16 v[56:71], v[16:19], a[148:151], v[56:71]
    ds_read_b128 v[12:15], v2 offset:25600
    s_waitcnt lgkmcnt(6)
    v_mfma_f32_32x32x16_bf16 v[40:55], v[20:23], a[152:155], v[40:55]
    v_mfma_f32_32x32x16_bf16 v[56:71], v[20:23], a[156:159], v[56:71]
    ds_read_b128 v[16:19], v2 offset:26624
    s_waitcnt lgkmcnt(6)
    v_mfma_f32_32x32x16_bf16 v[40:55], v[24:27], a[160:163], v[40:55]
    v_mfma_f32_32x32x16_bf16 v[56:71], v[24:27], a[164:167], v[56:71]
    ds_read_b128 v[20:23], v2 offset:27648
    s_waitcnt lgkmcnt(6)
    v_mfma_f32_32x32x16_bf16 v[40:55], v[28:31], a[168:171], v[40:55]
    v_mfma_f32_32x32x16_bf16 v[56:71], v[28:31], a[172:175], v[56:71]
    ds_read_b128 v[24:27], v2 offset:28672
    s_waitcnt lgkmcnt(6)
    v_mfma_f32_32x32x16_bf16 v[40:55], v[32:35], a[176:179], v[40:55]
    v_mfma_f32_32x32x16_bf16 v[56:71], v[32:35], a[180:183], v[56:71]
    ds_read_b128 v[28:31], v2 offset:29696
    s_waitcnt lgkmcnt(6)
    v_mfma_f32_32x32x16_bf16 v[40:55], v[36:39], a[184:187], v[40:55]
    v_mfma_f32_32x32x16_bf16 v[56:71], v[36:39], a[188:191], v[56:71]
    ds_read_b128 v[32:35], v2 offset:30720
    s_waitcnt lgkmcnt(6)
    v_mfma_f32_32x32x16_bf16 v[40:55], v[8:11], a[192:195], v[40:55]
    v_mfma_f32_32x32x16_bf16 v[56:71], v[8:11], a[196:199], v[56:71]
    ds_read_b128 v[36:39], v2 offset:31744
    s_waitcnt lgkmcnt(6)
    v_mfma_f32_32x32x16_bf16 v[40:55], v[12:15], a[200:203], v[40:55]
    v_mfma_f32_32x32x16_bf16 v[56:71], v[12:15], a[204:207], v[56:71]
    ds_read_b128 v[8:11], v2 offset:32768
    s_waitcnt lgkmcnt(6)
    v_mfma_f32_32x32x16_bf16 v[40:55], v[16:19], a[208:211], v[40:55]
    v_mfma_f32_32x32x16_bf16 v[56:71], v[16:19], a[212:215], v[56:71]
    ds_read_b128 v[12:15], v2 offset:33792
    s_waitcnt lgkmcnt(6)
    v_mfma_f32_32x32x16_bf16 v[40:55], v[20:23], a[216:219], v[40:55]
    v_mfma_f32_32x32x16_bf16 v[56:71], v[20:23], a[220:223], v[56:71]
    ds_read_b128 v[16:19], v2 offset:34816
    s_waitcnt lgkmcnt(6)
    v_mfma_f32_32x32x16_bf16 v[40:55], v[24:27], a[224:227], v[40:55]
    v_mfma_f32_32x32x16_bf16 v[56:71], v[24:27], a[228:231], v[56:71]
    s_waitcnt vmcnt(0)
    s_barrier
    s_add_u32 s21, s16, 40960
    s_cmp_eq_u32 s21, 122880
    s_cselect_b32 s21, 0, s21
    s_add_u32 s23, s14, 2
    s_min_u32 s24, s23, 63
    s_mul_i32 s24, s24, 40960
    s_add_u32 s24, s24, s19
    s_mul_i32 s25, s13, 10240
    s_add_u32 s25, s25, s22
    s_mov_b32 m0, s25
    s_nop 0
    buffer_load_dwordx4 v1, s[8:11], s24 offen offset:0 lds
    buffer_load_dwordx4 v1, s[8:11], s24 offen offset:1024 lds
    buffer_load_dwordx4 v1, s[8:11], s24 offen offset:2048 lds
    buffer_load_dwordx4 v1, s[8:11], s24 offen offset:3072 lds
    s_add_u32 s24, s24, 4096
    s_add_u32 s25, s25, 4096
    s_mov_b32 m0, s25
    s_nop 0
    buffer_load_dwordx4 v1, s[8:11], s24 offen offset:0 lds
    buffer_load_dwordx4 v1, s[8:11], s24 offen offset:1024 lds
    buffer_load_dwordx4 v1, s[8:11], s24 offen offset:2048 lds
    buffer_load_dwordx4 v1, s[8:11], s24 offen offset:3072 lds
    s_add_u32 s24, s24, 4096
    s_add_u32 s25, s25, 4096
    s_mov_b32 m0, s25
    s_nop 0
    buffer_load_dwordx4 v1, s[8:11], s24 offen offset:0 lds
    buffer_load_dwordx4 v1, s[8:11], s24 offen offset:1024 lds
    s_add_u32 s22, s22, 40960
    s_cmp_eq_u32 s22, 122880
    s_cselect_b32 s22, 0, s22
    ds_read_b128 v[20:23], v2 offset:35840
    s_waitcnt lgkmcnt(6)
    v_mfma_f32_32x32x16_bf16 v[40:55], v[28:31], a[232:235], v[40:55]
    v_mfma_f32_32x32x16_bf16 v[56:71], v[28:31], a[236:239], v[56:71]
    ds_read_b128 v[24:27], v2 offset:36864
    s_waitcnt lgkmcnt(6)
    v_mfma_f32_32x32x16_bf16 v[40:55], v[32:35], a[240:243], v[40:55]
    v_mfma_f32_32x32x16_bf16 v[56:71], v[32:35], a[244:247], v[56:71]
    ds_read_b128 v[28:31], v2 offset:37888
    s_waitcnt lgkmcnt(6)
    v_mfma_f32_32x32x16_bf16 v[40:55], v[36:39], a[248:251], v[40:55]
    v_mfma_f32_32x32x16_bf16 v[56:71], v[36:39], a[252:255], v[56:71]
    ds_read_b128 v[32:35], v2 offset:38912
    s_waitcnt lgkmcnt(6)
    v_mfma_f32_32x32x16_bf16 v[40:55], v[8:11], v[192:195], v[40:55]
    v_mfma_f32_32x32x16_bf16 v[56:71], v[8:11], v[196:199], v[56:71]
    ds_read_b128 v[36:39], v2 offset:39936
    s_waitcnt lgkmcnt(6)
    v_mfma_f32_32x32x16_bf16 v[40:55], v[12:15], v[200:203], v[40:55]
    v_mfma_f32_32x32x16_bf16 v[56:71], v[12:15], v[204:207], v[56:71]
    v_add_u32 v6, s21, v1
    ds_read_b128 v[8:11], v6 offset:0
    s_waitcnt lgkmcnt(6)
    v_mfma_f32_32x32x16_bf16 v[40:55], v[16:19], v[208:211], v[40:55]
    v_mfma_f32_32x32x16_bf16 v[56:71], v[16:19], v[212:215], v[56:71]
    ds_read_b128 v[12:15], v6 offset:1024
    s_waitcnt lgkmcnt(6)
    v_mfma_f32_32x32x16_bf16 v[40:55], v[20:23], v[216:219], v[40:55]
    v_mfma_f32_32x32x16_bf16 v[56:71], v[20:23], v[220:223], v[56:71]
    ds_read_b128 v[16:19], v6 offset:2048
    s_waitcnt lgkmcnt(6)
    v_mfma_f32_32x32x16_bf16 v[40:55], v[24:27], v[224:227], v[40:55]
    v_mfma_f32_32x32x16_bf16 v[56:71], v[24:27], v[228:231], v[56:71]
    ds_read_b128 v[20:23], v6 offset:3072
    s_waitcnt lgkmcnt(6)
    v_mfma_f32_32x32x16_bf16 v[40:55], v[28:31], v[232:235], v[40:55]
    v_mfma_f32_32x32x16_bf16 v[56:71], v[28:31], v[236:239], v[56:71]
    ds_read_b128 v[24:27], v6 offset:4096
    s_waitcnt lgkmcnt(6)
    v_mfma_f32_32x32x16_bf16 v[40:55], v[32:35], v[240:243], v[40:55]
    v_mfma_f32_32x32x16_bf16 v[56:71], v[32:35], v[244:247], v[56:71]
    ds_read_b128 v[28:31], v6 offset:5120
    s_waitcnt lgkmcnt(6)
    v_mfma_f32_32x32x16_bf16 v[40:55], v[36:39], v[248:251], v[40:55]
    v_mfma_f32_32x32x16_bf16 v[56:71], v[36:39], v[252:255], v[56:71]
    v_mov_b32 v2, v6
    s_mov_b32 s16, s21
    s_add_u32 s14, s14, 1
    s_cmp_ge_u32 s14, s15
    s_cbranch_scc1 layerb1_kernel_gu_fin0
layerb1_kernel_gu_loop:
    ds_read_b128 v[32:35], v2 offset:6144
    s_waitcnt lgkmcnt(6)
    v_mfma_f32_32x32x16_bf16 v[72:87], v[8:11], a[0:3], 0
    v_mfma_f32_32x32x16_bf16 v[88:103], v[8:11], a[4:7], 0
    ds_read_b128 v[36:39], v2 offset:7168
    s_waitcnt lgkmcnt(6)
    v_mfma_f32_32x32x16_bf16 v[72:87], v[12:15], a[8:11], v[72:87]
    v_mfma_f32_32x32x16_bf16 v[88:103], v[12:15], a[12:15], v[88:103]
    ds_read_b128 v[8:11], v2 offset:8192
    s_waitcnt lgkmcnt(6)
    v_mfma_f32_32x32x16_bf16 v[72:87], v[16:19], a[16:19], v[72:87]
    v_cvt_pk_bf16_f32 v104, v40, v41
    v_mfma_f32_32x32x16_bf16 v[88:103], v[16:19], a[20:23], v[88:103]
    v_cvt_pk_bf16_f32 v105, v42, v43
    ds_read_b128 v[12:15], v2 offset:9216
    s_waitcnt lgkmcnt(6)
    v_mfma_f32_32x32x16_bf16 v[72:87], v[20:23], a[24:27], v[72:87]
    v_cvt_pk_bf16_f32 v106, v44, v45
    v_mfma_f32_32x32x16_bf16 v[88:103], v[20:23], a[28:31], v[88:103]
    v_cvt_pk_bf16_f32 v107, v46, v47
    ds_read_b128 v[16:19], v2 offset:10240
    s_waitcnt lgkmcnt(6)
    v_mfma_f32_32x32x16_bf16 v[72:87], v[24:27], a[32:35], v[72:87]
    s_nop 1
    v_mfma_f32_32x32x16_bf16 v[88:103], v[24:27], a[36:39], v[88:103]
    v_permlane32_swap_b32 v104, v106
    ds_read_b128 v[20:23], v2 offset:11264
    s_waitcnt lgkmcnt(6)
    v_mfma_f32_32x32x16_bf16 v[72:87], v[28:31], a[40:43], v[72:87]
    v_permlane32_swap_b32 v105, v107
    v_mfma_f32_32x32x16_bf16 v[88:103], v[28:31], a[44:47], v[88:103]
    buffer_store_dwordx4 v[104:107], v3, s[8:11], s17 offen offset:0 sc1
    ds_read_b128 v[24:27], v2 offset:12288
    s_waitcnt lgkmcnt(6)
    v_mfma_f32_32x32x16_bf16 v[72:87], v[32:35], a[48:51], v[72:87]
    v_cvt_pk_bf16_f32 v108, v48, v49
    v_mfma_f32_32x32x16_bf16 v[88:103], v[32:35], a[52:55], v[88:103]
    v_cvt_pk_bf16_f32 v109, v50, v51
    ds_read_b128 v[28:31], v2 offset:13312
    s_waitcnt lgkmcnt(6)
    v_mfma_f32_32x32x16_bf16 v[72:87], v[36:39], a[56:59], v[72:87]
    v_cvt_pk_bf16_f32 v110, v52, v53
    v_mfma_f32_32x32x16_bf16 v[88:103], v[36:39], a[60:63], v[88:103]
    v_cvt_pk_bf16_f32 v111, v54, v55
    ds_read_b128 v[32:35], v2 offset:14336
    s_waitcnt lgkmcnt(6)
    v_mfma_f32_32x32x16_bf16 v[72:87], v[8:11], a[64:67], v[72:87]
    s_nop 1
    v_mfma_f32_32x32x16_bf16 v[88:103], v[8:11], a[68:71], v[88:103]
    v_permlane32_swap_b32 v108, v110
    ds_read_b128 v[36:39], v2 offset:15360
    s_waitcnt lgkmcnt(6)
    v_mfma_f32_32x32x16_bf16 v[72:87], v[12:15], a[72:75], v[72:87]
    v_permlane32_swap_b32 v109, v111
    v_mfma_f32_32x32x16_bf16 v[88:103], v[12:15], a[76:79], v[88:103]
    buffer_store_dwordx4 v[108:111], v3, s[8:11], s17 offen offset:256 sc1
    ds_read_b128 v[8:11], v2 offset:16384
    s_waitcnt lgkmcnt(6)
    v_mfma_f32_32x32x16_bf16 v[72:87], v[16:19], a[80:83], v[72:87]
    v_cvt_pk_bf16_f32 v112, v56, v57
    v_mfma_f32_32x32x16_bf16 v[88:103], v[16:19], a[84:87], v[88:103]
    v_cvt_pk_bf16_f32 v113, v58, v59
    ds_read_b128 v[12:15], v2 offset:17408
    s_waitcnt lgkmcnt(6)
    v_mfma_f32_32x32x16_bf16 v[72:87], v[20:23], a[88:91], v[72:87]
    v_cvt_pk_bf16_f32 v114, v60, v61
    v_mfma_f32_32x32x16_bf16 v[88:103], v[20:23], a[92:95], v[88:103]
    v_cvt_pk_bf16_f32 v115, v62, v63
    ds_read_b128 v[16:19], v2 offset:18432
    s_waitcnt lgkmcnt(6)
    v_mfma_f32_32x32x16_bf16 v[72:87], v[24:27], a[96:99], v[72:87]
    s_nop 1
    v_mfma_f32_32x32x16_bf16 v[88:103], v[24:27], a[100:103], v[88:103]
    v_permlane32_swap_b32 v112, v114
    ds_read_b128 v[20:23], v2 offset:19456
    s_waitcnt lgkmcnt(6)
    v_mfma_f32_32x32x16_bf16 v[72:87], v[28:31], a[104:107], v[72:87]
    v_permlane32_swap_b32 v113, v115
    v_mfma_f32_32x32x16_bf16 v[88:103], v[28:31], a[108:111], v[88:103]
    buffer_store_dwordx4 v[112:115], v3, s[8:11], s17 offen offset:2560 sc1
    ds_read_b128 v[24:27], v2 offset:20480
    s_waitcnt lgkmcnt(6)
    v_mfma_f32_32x32x16_bf16 v[72:87], v[32:35], a[112:115], v[72:87]
    v_cvt_pk_bf16_f32 v116, v64, v65
    v_mfma_f32_32x32x16_bf16 v[88:103], v[32:35], a[116:119], v[88:103]
    v_cvt_pk_bf16_f32 v117, v66, v67
    ds_read_b128 v[28:31], v2 offset:21504
    s_waitcnt lgkmcnt(6)
    v_mfma_f32_32x32x16_bf16 v[72:87], v[36:39], a[120:123], v[72:87]
    v_cvt_pk_bf16_f32 v118, v68, v69
    v_mfma_f32_32x32x16_bf16 v[88:103], v[36:39], a[124:127], v[88:103]
    v_cvt_pk_bf16_f32 v119, v70, v71
    ds_read_b128 v[32:35], v2 offset:22528
    s_waitcnt lgkmcnt(6)
    v_mfma_f32_32x32x16_bf16 v[72:87], v[8:11], a[128:131], v[72:87]
    s_nop 1
    v_mfma_f32_32x32x16_bf16 v[88:103], v[8:11], a[132:135], v[88:103]
    v_permlane32_swap_b32 v116, v118
    ds_read_b128 v[36:39], v2 offset:23552
    s_waitcnt lgkmcnt(6)
    v_mfma_f32_32x32x16_bf16 v[72:87], v[12:15], a[136:139], v[72:87]
    v_permlane32_swap_b32 v117, v119
    v_mfma_f32_32x32x16_bf16 v[88:103], v[12:15], a[140:143], v[88:103]
    buffer_store_dwordx4 v[116:119], v3, s[8:11], s17 offen offset:2816 sc1
    ds_read_b128 v[8:11], v2 offset:24576
    s_waitcnt lgkmcnt(6)
    v_mfma_f32_32x32x16_bf16 v[72:87], v[16:19], a[144:147], v[72:87]
    s_add_u32 s17, s17, s20
    v_mfma_f32_32x32x16_bf16 v[88:103], v[16:19], a[148:151], v[88:103]
    s_add_u32 s18, s18, s20
    ds_read_b128 v[12:15], v2 offset:25600
    s_waitcnt lgkmcnt(6)
    v_mfma_f32_32x32x16_bf16 v[72:87], v[20:23], a[152:155], v[72:87]
    v_mfma_f32_32x32x16_bf16 v[88:103], v[20:23], a[156:159], v[88:103]
    ds_read_b128 v[16:19], v2 offset:26624
    s_waitcnt lgkmcnt(6)
    v_mfma_f32_32x32x16_bf16 v[72:87], v[24:27], a[160:163], v[72:87]
    v_mfma_f32_32x32x16_bf16 v[88:103], v[24:27], a[164:167], v[88:103]
    ds_read_b128 v[20:23], v2 offset:27648
    s_waitcnt lgkmcnt(6)
    v_mfma_f32_32x32x16_bf16 v[72:87], v[28:31], a[168:171], v[72:87]
    v_mfma_f32_32x32x16_bf16 v[88:103], v[28:31], a[172:175], v[88:103]
    ds_read_b128 v[24:27], v2 offset:28672
    s_waitcnt lgkmcnt(6)
    v_mfma_f32_32x32x16_bf16 v[72:87], v[32:35], a[176:179], v[72:87]
    v_mfma_f32_32x32x16_bf16 v[88:103], v[32:35], a[180:183], v[88:103]
    ds_read_b128 v[28:31], v2 offset:29696
    s_waitcnt lgkmcnt(6)
    v_mfma_f32_32x32x16_bf16 v[72:87], v[36:39], a[184:187], v[72:87]
    v_mfma_f32_32x32x16_bf16 v[88:103], v[36:39], a[188:191], v[88:103]
    ds_read_b128 v[32:35], v2 offset:30720
    s_waitcnt lgkmcnt(6)
    v_mfma_f32_32x32x16_bf16 v[72:87], v[8:11], a[192:195], v[72:87]
    v_mfma_f32_32x32x16_bf16 v[88:103], v[8:11], a[196:199], v[88:103]
    ds_read_b128 v[36:39], v2 offset:31744
    s_waitcnt lgkmcnt(6)
    v_mfma_f32_32x32x16_bf16 v[72:87], v[12:15], a[200:203], v[72:87]
    v_mfma_f32_32x32x16_bf16 v[88:103], v[12:15], a[204:207], v[88:103]
    ds_read_b128 v[8:11], v2 offset:32768
    s_waitcnt lgkmcnt(6)
    v_mfma_f32_32x32x16_bf16 v[72:87], v[16:19], a[208:211], v[72:87]
    v_mfma_f32_32x32x16_bf16 v[88:103], v[16:19], a[212:215], v[88:103]
    ds_read_b128 v[12:15], v2 offset:33792
    s_waitcnt lgkmcnt(6)
    v_mfma_f32_32x32x16_bf16 v[72:87], v[20:23], a[216:219], v[72:87]
    v_mfma_f32_32x32x16_bf16 v[88:103], v[20:23], a[220:223], v[88:103]
    ds_read_b128 v[16:19], v2 offset:34816
    s_waitcnt lgkmcnt(6)
    v_mfma_f32_32x32x16_bf16 v[72:87], v[24:27], a[224:227], v[72:87]
    v_mfma_f32_32x32x16_bf16 v[88:103], v[24:27], a[228:231], v[88:103]
    s_cmp_gt_u32 s14, 2
    s_cbranch_scc1 layerb1_kernel_gu_dr1
    s_waitcnt vmcnt(0)
    s_mov_b32 s27, s14
    s_branch layerb1_kernel_gu_dq1
layerb1_kernel_gu_dr1:
    s_waitcnt vmcnt(4)
    s_sub_u32 s27, s14, 1
layerb1_kernel_gu_dq1:
    s_barrier
    s_cmp_lg_u32 s13, 0
    s_cbranch_scc1 layerb1_kernel_gu_fl2
    s_mov_b64 exec, 1
    s_lshl_b32 s26, s12, 7
    v_mov_b32 v7, s26
    v_mov_b32 v120, s27
    buffer_store_dword v120, v7, s[8:11], s48 offen sc1
    s_mov_b64 exec, -1
layerb1_kernel_gu_fl2:
    s_add_u32 s21, s16, 40960
    s_cmp_eq_u32 s21, 122880
    s_cselect_b32 s21, 0, s21
    s_add_u32 s23, s14, 2
    s_min_u32 s24, s23, 63
    s_mul_i32 s24, s24, 40960
    s_add_u32 s24, s24, s19
    s_mul_i32 s25, s13, 10240
    s_add_u32 s25, s25, s22
    s_mov_b32 m0, s25
    s_nop 0
    buffer_load_dwordx4 v1, s[8:11], s24 offen offset:0 lds
    buffer_load_dwordx4 v1, s[8:11], s24 offen offset:1024 lds
    buffer_load_dwordx4 v1, s[8:11], s24 offen offset:2048 lds
    buffer_load_dwordx4 v1, s[8:11], s24 offen offset:3072 lds
    s_add_u32 s24, s24, 4096
    s_add_u32 s25, s25, 4096
    s_mov_b32 m0, s25
    s_nop 0
    buffer_load_dwordx4 v1, s[8:11], s24 offen offset:0 lds
    buffer_load_dwordx4 v1, s[8:11], s24 offen offset:1024 lds
    buffer_load_dwordx4 v1, s[8:11], s24 offen offset:2048 lds
    buffer_load_dwordx4 v1, s[8:11], s24 offen offset:3072 lds
    s_add_u32 s24, s24, 4096
    s_add_u32 s25, s25, 4096
    s_mov_b32 m0, s25
    s_nop 0
    buffer_load_dwordx4 v1, s[8:11], s24 offen offset:0 lds
    buffer_load_dwordx4 v1, s[8:11], s24 offen offset:1024 lds
    s_add_u32 s22, s22, 40960
    s_cmp_eq_u32 s22, 122880
    s_cselect_b32 s22, 0, s22
    ds_read_b128 v[20:23], v2 offset:35840
    s_waitcnt lgkmcnt(6)
    v_mfma_f32_32x32x16_bf16 v[72:87], v[28:31], a[232:235], v[72:87]
    v_mfma_f32_32x32x16_bf16 v[88:103], v[28:31], a[236:239], v[88:103]
    ds_read_b128 v[24:27], v2 offset:36864
    s_waitcnt lgkmcnt(6)
    v_mfma_f32_32x32x16_bf16 v[72:87], v[32:35], a[240:243], v[72:87]
    v_mfma_f32_32x32x16_bf16 v[88:103], v[32:35], a[244:247], v[88:103]
    ds_read_b128 v[28:31], v2 offset:37888
    s_waitcnt lgkmcnt(6)
    v_mfma_f32_32x32x16_bf16 v[72:87], v[36:39], a[248:251], v[72:87]
    v_mfma_f32_32x32x16_bf16 v[88:103], v[36:39], a[252:255], v[88:103]
    ds_read_b128 v[32:35], v2 offset:38912
    s_waitcnt lgkmcnt(6)
    v_mfma_f32_32x32x16_bf16 v[72:87], v[8:11], v[192:195], v[72:87]
    v_mfma_f32_32x32x16_bf16 v[88:103], v[8:11], v[196:199], v[88:103]
    ds_read_b128 v[36:39], v2 offset:39936
    s_waitcnt lgkmcnt(6)
    v_mfma_f32_32x32x16_bf16 v[72:87], v[12:15], v[200:203], v[72:87]
    v_mfma_f32_32x32x16_bf16 v[88:103], v[12:15], v[204:207], v[88:103]
    v_add_u32 v6, s21, v1
    ds_read_b128 v[8:11], v6 offset:0
    s_waitcnt lgkmcnt(6)
    v_mfma_f32_32x32x16_bf16 v[72:87], v[16:19], v[208:211], v[72:87]
    v_mfma_f32_32x32x16_bf16 v[88:103], v[16:19], v[212:215], v[88:103]
    ds_read_b128 v[12:15], v6 offset:1024
    s_waitcnt lgkmcnt(6)
    v_mfma_f32_32x32x16_bf16 v[72:87], v[20:23], v[216:219], v[72:87]
    v_mfma_f32_32x32x16_bf16 v[88:103], v[20:23], v[220:223], v[88:103]
    ds_read_b128 v[16:19], v6 offset:2048
    s_waitcnt lgkmcnt(6)
    v_mfma_f32_32x32x16_bf16 v[72:87], v[24:27], v[224:227], v[72:87]
    v_mfma_f32_32x32x16_bf16 v[88:103], v[24:27], v[228:231], v[88:103]
    ds_read_b128 v[20:23], v6 offset:3072
    s_waitcnt lgkmcnt(6)
    v_mfma_f32_32x32x16_bf16 v[72:87], v[28:31], v[232:235], v[72:87]
    v_mfma_f32_32x32x16_bf16 v[88:103], v[28:31], v[236:239], v[88:103]
    ds_read_b128 v[24:27], v6 offset:4096
    s_waitcnt lgkmcnt(6)
    v_mfma_f32_32x32x16_bf16 v[72:87], v[32:35], v[240:243], v[72:87]
    v_mfma_f32_32x32x16_bf16 v[88:103], v[32:35], v[244:247], v[88:103]
    ds_read_b128 v[28:31], v6 offset:5120
    s_waitcnt lgkmcnt(6)
    v_mfma_f32_32x32x16_bf16 v[72:87], v[36:39], v[248:251], v[72:87]
    v_mfma_f32_32x32x16_bf16 v[88:103], v[36:39], v[252:255], v[88:103]
    v_mov_b32 v2, v6
    s_mov_b32 s16, s21
    s_add_u32 s14, s14, 1
    s_cmp_ge_u32 s14, s15
    s_cbranch_scc1 layerb1_kernel_gu_fin1
    ds_read_b128 v[32:35], v2 offset:6144
    s_waitcnt lgkmcnt(6)
    v_mfma_f32_32x32x16_bf16 v[40:55], v[8:11], a[0:3], 0
    v_mfma_f32_32x32x16_bf16 v[56:71], v[8:11], a[4:7], 0
    ds_read_b128 v[36:39], v2 offset:7168
    s_waitcnt lgkmcnt(6)
    v_mfma_f32_32x32x16_bf16 v[40:55], v[12:15], a[8:11], v[40:55]
    v_mfma_f32_32x32x16_bf16 v[56:71], v[12:15], a[12:15], v[56:71]
    ds_read_b128 v[8:11], v2 offset:8192
    s_waitcnt lgkmcnt(6)
    v_mfma_f32_32x32x16_bf16 v[40:55], v[16:19], a[16:19], v[40:55]
    v_cvt_pk_bf16_f32 v104, v72, v73
    v_mfma_f32_32x32x16_bf16 v[56:71], v[16:19], a[20:23], v[56:71]
    v_cvt_pk_bf16_f32 v105, v74, v75
    ds_read_b128 v[12:15], v2 offset:9216
    s_waitcnt lgkmcnt(6)
    v_mfma_f32_32x32x16_bf16 v[40:55], v[20:23], a[24:27], v[40:55]
    v_cvt_pk_bf16_f32 v106, v76, v77
    v_mfma_f32_32x32x16_bf16 v[56:71], v[20:23], a[28:31], v[56:71]
    v_cvt_pk_bf16_f32 v107, v78, v79
    ds_read_b128 v[16:19], v2 offset:10240
    s_waitcnt lgkmcnt(6)
    v_mfma_f32_32x32x16_bf16 v[40:55], v[24:27], a[32:35], v[40:55]
    s_nop 1
    v_mfma_f32_32x32x16_bf16 v[56:71], v[24:27], a[36:39], v[56:71]
    v_permlane32_swap_b32 v104, v106
    ds_read_b128 v[20:23], v2 offset:11264
    s_waitcnt lgkmcnt(6)
    v_mfma_f32_32x32x16_bf16 v[40:55], v[28:31], a[40:43], v[40:55]
    v_permlane32_swap_b32 v105, v107
    v_mfma_f32_32x32x16_bf16 v[56:71], v[28:31], a[44:47], v[56:71]
    buffer_store_dwordx4 v[104:107], v3, s[8:11], s17 offen offset:0 sc1
    ds_read_b128 v[24:27], v2 offset:12288
    s_waitcnt lgkmcnt(6)
    v_mfma_f32_32x32x16_bf16 v[40:55], v[32:35], a[48:51], v[40:55]
    v_cvt_pk_bf16_f32 v108, v80, v81
    v_mfma_f32_32x32x16_bf16 v[56:71], v[32:35], a[52:55], v[56:71]
    v_cvt_pk_bf16_f32 v109, v82, v83
    ds_read_b128 v[28:31], v2 offset:13312
    s_waitcnt lgkmcnt(6)
    v_mfma_f32_32x32x16_bf16 v[40:55], v[36:39], a[56:59], v[40:55]
    v_cvt_pk_bf16_f32 v110, v84, v85
    v_mfma_f32_32x32x16_bf16 v[56:71], v[36:39], a[60:63], v[56:71]
    v_cvt_pk_bf16_f32 v111, v86, v87
    ds_read_b128 v[32:35], v2 offset:14336
    s_waitcnt lgkmcnt(6)
    v_mfma_f32_32x32x16_bf16 v[40:55], v[8:11], a[64:67], v[40:55]
    s_nop 1
    v_mfma_f32_32x32x16_bf16 v[56:71], v[8:11], a[68:71], v[56:71]
    v_permlane32_swap_b32 v108, v110
    ds_read_b128 v[36:39], v2 offset:15360
    s_waitcnt lgkmcnt(6)
    v_mfma_f32_32x32x16_bf16 v[40:55], v[12:15], a[72:75], v[40:55]
    v_permlane32_swap_b32 v109, v111
    v_mfma_f32_32x32x16_bf16 v[56:71], v[12:15], a[76:79], v[56:71]
    buffer_store_dwordx4 v[108:111], v3, s[8:11], s17 offen offset:256 sc1
    ds_read_b128 v[8:11], v2 offset:16384
    s_waitcnt lgkmcnt(6)
    v_mfma_f32_32x32x16_bf16 v[40:55], v[16:19], a[80:83], v[40:55]
    v_cvt_pk_bf16_f32 v112, v88, v89
    v_mfma_f32_32x32x16_bf16 v[56:71], v[16:19], a[84:87], v[56:71]
    v_cvt_pk_bf16_f32 v113, v90, v91
    ds_read_b128 v[12:15], v2 offset:17408
    s_waitcnt lgkmcnt(6)
    v_mfma_f32_32x32x16_bf16 v[40:55], v[20:23], a[88:91], v[40:55]
    v_cvt_pk_bf16_f32 v114, v92, v93
    v_mfma_f32_32x32x16_bf16 v[56:71], v[20:23], a[92:95], v[56:71]
    v_cvt_pk_bf16_f32 v115, v94, v95
    ds_read_b128 v[16:19], v2 offset:18432
    s_waitcnt lgkmcnt(6)
    v_mfma_f32_32x32x16_bf16 v[40:55], v[24:27], a[96:99], v[40:55]
    s_nop 1
    v_mfma_f32_32x32x16_bf16 v[56:71], v[24:27], a[100:103], v[56:71]
    v_permlane32_swap_b32 v112, v114
    ds_read_b128 v[20:23], v2 offset:19456
    s_waitcnt lgkmcnt(6)
    v_mfma_f32_32x32x16_bf16 v[40:55], v[28:31], a[104:107], v[40:55]
    v_permlane32_swap_b32 v113, v115
    v_mfma_f32_32x32x16_bf16 v[56:71], v[28:31], a[108:111], v[56:71]
    buffer_store_dwordx4 v[112:115], v3, s[8:11], s17 offen offset:2560 sc1
    ds_read_b128 v[24:27], v2 offset:20480
    s_waitcnt lgkmcnt(6)
    v_mfma_f32_32x32x16_bf16 v[40:55], v[32:35], a[112:115], v[40:55]
    v_cvt_pk_bf16_f32 v116, v96, v97
    v_mfma_f32_32x32x16_bf16 v[56:71], v[32:35], a[116:119], v[56:71]
    v_cvt_pk_bf16_f32 v117, v98, v99
    ds_read_b128 v[28:31], v2 offset:21504
    s_waitcnt lgkmcnt(6)
    v_mfma_f32_32x32x16_bf16 v[40:55], v[36:39], a[120:123], v[40:55]
    v_cvt_pk_bf16_f32 v118, v100, v101
    v_mfma_f32_32x32x16_bf16 v[56:71], v[36:39], a[124:127], v[56:71]
    v_cvt_pk_bf16_f32 v119, v102, v103
    ds_read_b128 v[32:35], v2 offset:22528
    s_waitcnt lgkmcnt(6)
    v_mfma_f32_32x32x16_bf16 v[40:55], v[8:11], a[128:131], v[40:55]
    s_nop 1
    v_mfma_f32_32x32x16_bf16 v[56:71], v[8:11], a[132:135], v[56:71]
    v_permlane32_swap_b32 v116, v118
    ds_read_b128 v[36:39], v2 offset:23552
    s_waitcnt lgkmcnt(6)
    v_mfma_f32_32x32x16_bf16 v[40:55], v[12:15], a[136:139], v[40:55]
    v_permlane32_swap_b32 v117, v119
    v_mfma_f32_32x32x16_bf16 v[56:71], v[12:15], a[140:143], v[56:71]
    buffer_store_dwordx4 v[116:119], v3, s[8:11], s17 offen offset:2816 sc1
    ds_read_b128 v[8:11], v2 offset:24576
    s_waitcnt lgkmcnt(6)
    v_mfma_f32_32x32x16_bf16 v[40:55], v[16:19], a[144:147], v[40:55]
    s_add_u32 s17, s17, s20
    v_mfma_f32_32x32x16_bf16 v[56:71], v[16:19], a[148:151], v[56:71]
    s_add_u32 s18, s18, s20
    ds_read_b128 v[12:15], v2 offset:25600
    s_waitcnt lgkmcnt(6)
    v_mfma_f32_32x32x16_bf16 v[40:55], v[20:23], a[152:155], v[40:55]
    v_mfma_f32_32x32x16_bf16 v[56:71], v[20:23], a[156:159], v[56:71]
    ds_read_b128 v[16:19], v2 offset:26624
    s_waitcnt lgkmcnt(6)
    v_mfma_f32_32x32x16_bf16 v[40:55], v[24:27], a[160:163], v[40:55]
    v_mfma_f32_32x32x16_bf16 v[56:71], v[24:27], a[164:167], v[56:71]
    ds_read_b128 v[20:23], v2 offset:27648
    s_waitcnt lgkmcnt(6)
    v_mfma_f32_32x32x16_bf16 v[40:55], v[28:31], a[168:171], v[40:55]
    v_mfma_f32_32x32x16_bf16 v[56:71], v[28:31], a[172:175], v[56:71]
    ds_read_b128 v[24:27], v2 offset:28672
    s_waitcnt lgkmcnt(6)
    v_mfma_f32_32x32x16_bf16 v[40:55], v[32:35], a[176:179], v[40:55]
    v_mfma_f32_32x32x16_bf16 v[56:71], v[32:35], a[180:183], v[56:71]
    ds_read_b128 v[28:31], v2 offset:29696
    s_waitcnt lgkmcnt(6)
    v_mfma_f32_32x32x16_bf16 v[40:55], v[36:39], a[184:187], v[40:55]
    v_mfma_f32_32x32x16_bf16 v[56:71], v[36:39], a[188:191], v[56:71]
    ds_read_b128 v[32:35], v2 offset:30720
    s_waitcnt lgkmcnt(6)
    v_mfma_f32_32x32x16_bf16 v[40:55], v[8:11], a[192:195], v[40:55]
    v_mfma_f32_32x32x16_bf16 v[56:71], v[8:11], a[196:199], v[56:71]
    ds_read_b128 v[36:39], v2 offset:31744
    s_waitcnt lgkmcnt(6)
    v_mfma_f32_32x32x16_bf16 v[40:55], v[12:15], a[200:203], v[40:55]
    v_mfma_f32_32x32x16_bf16 v[56:71], v[12:15], a[204:207], v[56:71]
    ds_read_b128 v[8:11], v2 offset:32768
    s_waitcnt lgkmcnt(6)
    v_mfma_f32_32x32x16_bf16 v[40:55], v[16:19], a[208:211], v[40:55]
    v_mfma_f32_32x32x16_bf16 v[56:71], v[16:19], a[212:215], v[56:71]
    ds_read_b128 v[12:15], v2 offset:33792
    s_waitcnt lgkmcnt(6)
    v_mfma_f32_32x32x16_bf16 v[40:55], v[20:23], a[216:219], v[40:55]
    v_mfma_f32_32x32x16_bf16 v[56:71], v[20:23], a[220:223], v[56:71]
    ds_read_b128 v[16:19], v2 offset:34816
    s_waitcnt lgkmcnt(6)
    v_mfma_f32_32x32x16_bf16 v[40:55], v[24:27], a[224:227], v[40:55]
    v_mfma_f32_32x32x16_bf16 v[56:71], v[24:27], a[228:231], v[56:71]
    s_cmp_gt_u32 s14, 2
    s_cbranch_scc1 layerb1_kernel_gu_dr3
    s_waitcnt vmcnt(0)
    s_mov_b32 s27, s14
    s_branch layerb1_kernel_gu_dq3
layerb1_kernel_gu_dr3:
    s_waitcnt vmcnt(4)
    s_sub_u32 s27, s14, 1
layerb1_kernel_gu_dq3:
    s_barrier
    s_cmp_lg_u32 s13, 0
    s_cbranch_scc1 layerb1_kernel_gu_fl4
    s_mov_b64 exec, 1
    s_lshl_b32 s26, s12, 7
    v_mov_b32 v7, s26
    v_mov_b32 v120, s27
    buffer_store_dword v120, v7, s[8:11], s48 offen sc1
    s_mov_b64 exec, -1
layerb1_kernel_gu_fl4:
    s_add_u32 s21, s16, 40960
    s_cmp_eq_u32 s21, 122880
    s_cselect_b32 s21, 0, s21
    s_add_u32 s23, s14, 2
    s_min_u32 s24, s23, 63
    s_mul_i32 s24, s24, 40960
    s_add_u32 s24, s24, s19
    s_mul_i32 s25, s13, 10240
    s_add_u32 s25, s25, s22
    s_mov_b32 m0, s25
    s_nop 0
    buffer_load_dwordx4 v1, s[8:11], s24 offen offset:0 lds
    buffer_load_dwordx4 v1, s[8:11], s24 offen offset:1024 lds
    buffer_load_dwordx4 v1, s[8:11], s24 offen offset:2048 lds
    buffer_load_dwordx4 v1, s[8:11], s24 offen offset:3072 lds
    s_add_u32 s24, s24, 4096
    s_add_u32 s25, s25, 4096
    s_mov_b32 m0, s25
    s_nop 0
    buffer_load_dwordx4 v1, s[8:11], s24 offen offset:0 lds
    buffer_load_dwordx4 v1, s[8:11], s24 offen offset:1024 lds
    buffer_load_dwordx4 v1, s[8:11], s24 offen offset:2048 lds
    buffer_load_dwordx4 v1, s[8:11], s24 offen offset:3072 lds
    s_add_u32 s24, s24, 4096
    s_add_u32 s25, s25, 4096
    s_mov_b32 m0, s25
    s_nop 0
    buffer_load_dwordx4 v1, s[8:11], s24 offen offset:0 lds
    buffer_load_dwordx4 v1, s[8:11], s24 offen offset:1024 lds
    s_add_u32 s22, s22, 40960
    s_cmp_eq_u32 s22, 122880
    s_cselect_b32 s22, 0, s22
    ds_read_b128 v[20:23], v2 offset:35840
    s_waitcnt lgkmcnt(6)
    v_mfma_f32_32x32x16_bf16 v[40:55], v[28:31], a[232:235], v[40:55]
    v_mfma_f32_32x32x16_bf16 v[56:71], v[28:31], a[236:239], v[56:71]
    ds_read_b128 v[24:27], v2 offset:36864
    s_waitcnt lgkmcnt(6)
    v_mfma_f32_32x32x16_bf16 v[40:55], v[32:35], a[240:243], v[40:55]
    v_mfma_f32_32x32x16_bf16 v[56:71], v[32:35], a[244:247], v[56:71]
    ds_read_b128 v[28:31], v2 offset:37888
    s_waitcnt lgkmcnt(6)
    v_mfma_f32_32x32x16_bf16 v[40:55], v[36:39], a[248:251], v[40:55]
    v_mfma_f32_32x32x16_bf16 v[56:71], v[36:39], a[252:255], v[56:71]
    ds_read_b128 v[32:35], v2 offset:38912
    s_waitcnt lgkmcnt(6)
    v_mfma_f32_32x32x16_bf16 v[40:55], v[8:11], v[192:195], v[40:55]
    v_mfma_f32_32x32x16_bf16 v[56:71], v[8:11], v[196:199], v[56:71]
    ds_read_b128 v[36:39], v2 offset:39936
    s_waitcnt lgkmcnt(6)
    v_mfma_f32_32x32x16_bf16 v[40:55], v[12:15], v[200:203], v[40:55]
    v_mfma_f32_32x32x16_bf16 v[56:71], v[12:15], v[204:207], v[56:71]
    v_add_u32 v6, s21, v1
    ds_read_b128 v[8:11], v6 offset:0
    s_waitcnt lgkmcnt(6)
    v_mfma_f32_32x32x16_bf16 v[40:55], v[16:19], v[208:211], v[40:55]
    v_mfma_f32_32x32x16_bf16 v[56:71], v[16:19], v[212:215], v[56:71]
    ds_read_b128 v[12:15], v6 offset:1024
    s_waitcnt lgkmcnt(6)
    v_mfma_f32_32x32x16_bf16 v[40:55], v[20:23], v[216:219], v[40:55]
    v_mfma_f32_32x32x16_bf16 v[56:71], v[20:23], v[220:223], v[56:71]
    ds_read_b128 v[16:19], v6 offset:2048
    s_waitcnt lgkmcnt(6)
    v_mfma_f32_32x32x16_bf16 v[40:55], v[24:27], v[224:227], v[40:55]
    v_mfma_f32_32x32x16_bf16 v[56:71], v[24:27], v[228:231], v[56:71]
    ds_read_b128 v[20:23], v6 offset:3072
    s_waitcnt lgkmcnt(6)
    v_mfma_f32_32x32x16_bf16 v[40:55], v[28:31], v[232:235], v[40:55]
    v_mfma_f32_32x32x16_bf16 v[56:71], v[28:31], v[236:239], v[56:71]
    ds_read_b128 v[24:27], v6 offset:4096
    s_waitcnt lgkmcnt(6)
    v_mfma_f32_32x32x16_bf16 v[40:55], v[32:35], v[240:243], v[40:55]
    v_mfma_f32_32x32x16_bf16 v[56:71], v[32:35], v[244:247], v[56:71]
    ds_read_b128 v[28:31], v6 offset:5120
    s_waitcnt lgkmcnt(6)
    v_mfma_f32_32x32x16_bf16 v[40:55], v[36:39], v[248:251], v[40:55]
    v_mfma_f32_32x32x16_bf16 v[56:71], v[36:39], v[252:255], v[56:71]
    v_mov_b32 v2, v6
    s_mov_b32 s16, s21
    s_add_u32 s14, s14, 1
    s_cmp_lt_u32 s14, s15
    s_cbranch_scc1 layerb1_kernel_gu_loop
layerb1_kernel_gu_fin0:
    s_nop 7
    s_nop 7
    v_cvt_pk_bf16_f32 v104, v40, v41
    v_cvt_pk_bf16_f32 v105, v42, v43
    v_cvt_pk_bf16_f32 v106, v44, v45
    v_cvt_pk_bf16_f32 v107, v46, v47
    s_nop 1
    v_permlane32_swap_b32 v104, v106
    v_permlane32_swap_b32 v105, v107
    buffer_store_dwordx4 v[104:107], v3, s[8:11], s17 offen offset:0 sc1
    v_cvt_pk_bf16_f32 v108, v48, v49
    v_cvt_pk_bf16_f32 v109, v50, v51
    v_cvt_pk_bf16_f32 v110, v52, v53
    v_cvt_pk_bf16_f32 v111, v54, v55
    s_nop 1
    v_permlane32_swap_b32 v108, v110
    v_permlane32_swap_b32 v109, v111
    buffer_store_dwordx4 v[108:111], v3, s[8:11], s17 offen offset:256 sc1
    v_cvt_pk_bf16_f32 v112, v56, v57
    v_cvt_pk_bf16_f32 v113, v58, v59
    v_cvt_pk_bf16_f32 v114, v60, v61
    v_cvt_pk_bf16_f32 v115, v62, v63
    s_nop 1
    v_permlane32_swap_b32 v112, v114
    v_permlane32_swap_b32 v113, v115
    buffer_store_dwordx4 v[112:115], v3, s[8:11], s17 offen offset:2560 sc1
    v_cvt_pk_bf16_f32 v116, v64, v65
    v_cvt_pk_bf16_f32 v117, v66, v67
    v_cvt_pk_bf16_f32 v118, v68, v69
    v_cvt_pk_bf16_f32 v119, v70, v71
    s_nop 1
    v_permlane32_swap_b32 v116, v118
    v_permlane32_swap_b32 v117, v119
    buffer_store_dwordx4 v[116:119], v3, s[8:11], s17 offen offset:2816 sc1
    s_add_u32 s17, s17, s20
    s_add_u32 s18, s18, s20
    s_branch layerb1_kernel_gu_done
layerb1_kernel_gu_fin1:
    s_nop 7
    s_nop 7
    v_cvt_pk_bf16_f32 v104, v72, v73
    v_cvt_pk_bf16_f32 v105, v74, v75
    v_cvt_pk_bf16_f32 v106, v76, v77
    v_cvt_pk_bf16_f32 v107, v78, v79
    s_nop 1
    v_permlane32_swap_b32 v104, v106
    v_permlane32_swap_b32 v105, v107
    buffer_store_dwordx4 v[104:107], v3, s[8:11], s17 offen offset:0 sc1
    v_cvt_pk_bf16_f32 v108, v80, v81
    v_cvt_pk_bf16_f32 v109, v82, v83
    v_cvt_pk_bf16_f32 v110, v84, v85
    v_cvt_pk_bf16_f32 v111, v86, v87
    s_nop 1
    v_permlane32_swap_b32 v108, v110
    v_permlane32_swap_b32 v109, v111
    buffer_store_dwordx4 v[108:111], v3, s[8:11], s17 offen offset:256 sc1
    v_cvt_pk_bf16_f32 v112, v88, v89
    v_cvt_pk_bf16_f32 v113, v90, v91
    v_cvt_pk_bf16_f32 v114, v92, v93
    v_cvt_pk_bf16_f32 v115, v94, v95
    s_nop 1
    v_permlane32_swap_b32 v112, v114
    v_permlane32_swap_b32 v113, v115
    buffer_store_dwordx4 v[112:115], v3, s[8:11], s17 offen offset:2560 sc1
    v_cvt_pk_bf16_f32 v116, v96, v97
    v_cvt_pk_bf16_f32 v117, v98, v99
    v_cvt_pk_bf16_f32 v118, v100, v101
    v_cvt_pk_bf16_f32 v119, v102, v103
    s_nop 1
    v_permlane32_swap_b32 v116, v118
    v_permlane32_swap_b32 v117, v119
    buffer_store_dwordx4 v[116:119], v3, s[8:11], s17 offen offset:2816 sc1
    s_add_u32 s17, s17, s20
    s_add_u32 s18, s18, s20
layerb1_kernel_gu_done:
    s_waitcnt vmcnt(0) lgkmcnt(0)
    s_barrier
    s_cmp_lg_u32 s13, 0
    s_cbranch_scc1 layerb1_kernel_gu_fl5
    s_mov_b64 exec, 1
    s_lshl_b32 s26, s12, 7
    v_mov_b32 v7, s26
    v_mov_b32 v120, s14
    buffer_store_dword v120, v7, s[8:11], s48 offen sc1
    s_mov_b64 exec, -1
layerb1_kernel_gu_fl5:
    s_branch layerb1_kernel_g_done
layerb1_kernel_g_qk:
    s_sub_u32 s26, s12, 80
    s_cmp_ge_u32 s26, 24
    s_cselect_b32 s27, 1, 0
    s_cselect_b32 s28, 24, 0
    s_sub_u32 s26, s26, s28
    s_lshl_b32 s26, s26, 3
    s_lshl_b32 s28, s13, 1
    s_add_u32 s26, s26, s28
    s_add_u32 s28, s26, 0
    s_mul_i32 s29, s28, 171
    s_lshr_b32 s29, s29, 10
    s_mul_i32 s30, s29, 6
    s_sub_u32 s30, s28, s30
    s_mul_i32 s31, s29, 12288
    s_lshl_b32 s32, s30, 11
    s_add_u32 s31, s31, s32
    s_mul_i32 s32, s14, 393216
    s_add_u32 s31, s31, s32
    s_mul_i32 s32, s27, 25165824
    s_add_u32 s31, s31, s32
    s_add_u32 s17, s31, 53477376
    s_lshl_b32 s30, s30, 5
    v_add_u32 v10, s30, v8
    v_and_b32 v11, 0xc1, v10
    v_and_b32 v12, 8, v10
    v_lshl_or_b32 v11, v12, 2, v11
    v_and_b32 v12, 32, v10
    v_lshrrev_b32 v12, 1, v12
    v_or_b32 v11, v11, v12
    v_and_b32 v12, 2, v10
    v_lshl_or_b32 v11, v12, 2, v11
    v_and_b32 v12, 16, v10
    v_lshrrev_b32 v12, 2, v12
    v_or_b32 v11, v11, v12
    v_and_b32 v12, 4, v10
    v_lshrrev_b32 v12, 1, v12
    v_or_b32 v11, v11, v12
    s_cmp_eq_u32 s27, 1
    s_cselect_b64 vcc, -1, 0
    s_nop 1
    v_cndmask_b32 v10, v10, v11, vcc
    v_lshrrev_b32 v12, 4, v10
    v_mul_u32_u24 v13, 11, v12
    v_lshrrev_b32 v13, 5, v13
    v_mul_u32_u24 v13, 3, v13
    v_add_u32 v12, v12, v13
    v_mul_u32_u24 v12, 20480, v12
    v_and_b32 v13, 15, v10
    v_lshl_add_u32 v11, v13, 4, v12
    v_lshl_add_u32 v4, v9, 8, v11
    s_xor_b32 s30, s27, 1
    s_mul_i32 s30, s30, 61440
    s_mul_i32 s31, s29, 491520
    s_add_u32 s30, s30, s31
    s_add_u32 s34, s30, 11534336
    s_add_u32 s28, s26, 1
    s_mul_i32 s29, s28, 171
    s_lshr_b32 s29, s29, 10
    s_mul_i32 s30, s29, 6
    s_sub_u32 s30, s28, s30
    s_mul_i32 s31, s29, 12288
    s_lshl_b32 s32, s30, 11
    s_add_u32 s31, s31, s32
    s_mul_i32 s32, s14, 393216
    s_add_u32 s31, s31, s32
    s_mul_i32 s32, s27, 25165824
    s_add_u32 s31, s31, s32
    s_add_u32 s18, s31, 53477376
    s_lshl_b32 s30, s30, 5
    v_add_u32 v10, s30, v8
    v_and_b32 v11, 0xc1, v10
    v_and_b32 v12, 8, v10
    v_lshl_or_b32 v11, v12, 2, v11
    v_and_b32 v12, 32, v10
    v_lshrrev_b32 v12, 1, v12
    v_or_b32 v11, v11, v12
    v_and_b32 v12, 2, v10
    v_lshl_or_b32 v11, v12, 2, v11
    v_and_b32 v12, 16, v10
    v_lshrrev_b32 v12, 2, v12
    v_or_b32 v11, v11, v12
    v_and_b32 v12, 4, v10
    v_lshrrev_b32 v12, 1, v12
    v_or_b32 v11, v11, v12
    s_cmp_eq_u32 s27, 1
    s_cselect_b64 vcc, -1, 0
    s_nop 1
    v_cndmask_b32 v10, v10, v11, vcc
    v_lshrrev_b32 v12, 4, v10
    v_mul_u32_u24 v13, 11, v12
    v_lshrrev_b32 v13, 5, v13
    v_mul_u32_u24 v13, 3, v13
    v_add_u32 v12, v12, v13
    v_mul_u32_u24 v12, 20480, v12
    v_and_b32 v13, 15, v10
    v_lshl_add_u32 v11, v13, 4, v12
    v_lshl_add_u32 v5, v9, 8, v11
    s_xor_b32 s30, s27, 1
    s_mul_i32 s30, s30, 61440
    s_mul_i32 s31, s29, 491520
    s_add_u32 s30, s30, s31
    s_add_u32 s35, s30, 11534336
    buffer_load_dwordx4 a[0:3], v4, s[8:11], s34 offen offset:0
    buffer_load_dwordx4 a[4:7], v5, s[8:11], s35 offen offset:0
    buffer_load_dwordx4 a[8:11], v4, s[8:11], s34 offen offset:512
    buffer_load_dwordx4 a[12:15], v5, s[8:11], s35 offen offset:512
    buffer_load_dwordx4 a[16:19], v4, s[8:11], s34 offen offset:1024
    buffer_load_dwordx4 a[20:23], v5, s[8:11], s35 offen offset:1024
    buffer_load_dwordx4 a[24:27], v4, s[8:11], s34 offen offset:1536
    buffer_load_dwordx4 a[28:31], v5, s[8:11], s35 offen offset:1536
    buffer_load_dwordx4 a[32:35], v4, s[8:11], s34 offen offset:2048
    buffer_load_dwordx4 a[36:39], v5, s[8:11], s35 offen offset:2048
    buffer_load_dwordx4 a[40:43], v4, s[8:11], s34 offen offset:2560
    buffer_load_dwordx4 a[44:47], v5, s[8:11], s35 offen offset:2560
    buffer_load_dwordx4 a[48:51], v4, s[8:11], s34 offen offset:3072
    buffer_load_dwordx4 a[52:55], v5, s[8:11], s35 offen offset:3072
    buffer_load_dwordx4 a[56:59], v4, s[8:11], s34 offen offset:3584
    buffer_load_dwordx4 a[60:63], v5, s[8:11], s35 offen offset:3584
    s_add_u32 s34, s34, 4096
    s_add_u32 s35, s35, 4096
    buffer_load_dwordx4 a[64:67], v4, s[8:11], s34 offen offset:0
    buffer_load_dwordx4 a[68:71], v5, s[8:11], s35 offen offset:0
    buffer_load_dwordx4 a[72:75], v4, s[8:11], s34 offen offset:512
    buffer_load_dwordx4 a[76:79], v5, s[8:11], s35 offen offset:512
    buffer_load_dwordx4 a[80:83], v4, s[8:11], s34 offen offset:1024
    buffer_load_dwordx4 a[84:87], v5, s[8:11], s35 offen offset:1024
    buffer_load_dwordx4 a[88:91], v4, s[8:11], s34 offen offset:1536
    buffer_load_dwordx4 a[92:95], v5, s[8:11], s35 offen offset:1536
    buffer_load_dwordx4 a[96:99], v4, s[8:11], s34 offen offset:2048
    buffer_load_dwordx4 a[100:103], v5, s[8:11], s35 offen offset:2048
    buffer_load_dwordx4 a[104:107], v4, s[8:11], s34 offen offset:2560
    buffer_load_dwordx4 a[108:111], v5, s[8:11], s35 offen offset:2560
    buffer_load_dwordx4 a[112:115], v4, s[8:11], s34 offen offset:3072
    buffer_load_dwordx4 a[116:119], v5, s[8:11], s35 offen offset:3072
    buffer_load_dwordx4 a[120:123], v4, s[8:11], s34 offen offset:3584
    buffer_load_dwordx4 a[124:127], v5, s[8:11], s35 offen offset:3584
    s_add_u32 s34, s34, 4096
    s_add_u32 s35, s35, 4096
    buffer_load_dwordx4 a[128:131], v4, s[8:11], s34 offen offset:0
    buffer_load_dwordx4 a[132:135], v5, s[8:11], s35 offen offset:0
    buffer_load_dwordx4 a[136:139], v4, s[8:11], s34 offen offset:512
    buffer_load_dwordx4 a[140:143], v5, s[8:11], s35 offen offset:512
    buffer_load_dwordx4 a[144:147], v4, s[8:11], s34 offen offset:1024
    buffer_load_dwordx4 a[148:151], v5, s[8:11], s35 offen offset:1024
    buffer_load_dwordx4 a[152:155], v4, s[8:11], s34 offen offset:1536
    buffer_load_dwordx4 a[156:159], v5, s[8:11], s35 offen offset:1536
    buffer_load_dwordx4 a[160:163], v4, s[8:11], s34 offen offset:2048
    buffer_load_dwordx4 a[164:167], v5, s[8:11], s35 offen offset:2048
    buffer_load_dwordx4 a[168:171], v4, s[8:11], s34 offen offset:2560
    buffer_load_dwordx4 a[172:175], v5, s[8:11], s35 offen offset:2560
    buffer_load_dwordx4 a[176:179], v4, s[8:11], s34 offen offset:3072
    buffer_load_dwordx4 a[180:183], v5, s[8:11], s35 offen offset:3072
    buffer_load_dwordx4 a[184:187], v4, s[8:11], s34 offen offset:3584
    buffer_load_dwordx4 a[188:191], v5, s[8:11], s35 offen offset:3584
    s_add_u32 s34, s34, 4096
    s_add_u32 s35, s35, 4096
    buffer_load_dwordx4 a[192:195], v4, s[8:11], s34 offen offset:0
    buffer_load_dwordx4 a[196:199], v5, s[8:11], s35 offen offset:0
    buffer_load_dwordx4 a[200:203], v4, s[8:11], s34 offen offset:512
    buffer_load_dwordx4 a[204:207], v5, s[8:11], s35 offen offset:512
    buffer_load_dwordx4 a[208:211], v4, s[8:11], s34 offen offset:1024
    buffer_load_dwordx4 a[212:215], v5, s[8:11], s35 offen offset:1024
    buffer_load_dwordx4 a[216:219], v4, s[8:11], s34 offen offset:1536
    buffer_load_dwordx4 a[220:223], v5, s[8:11], s35 offen offset:1536
    buffer_load_dwordx4 a[224:227], v4, s[8:11], s34 offen offset:2048
    buffer_load_dwordx4 a[228:231], v5, s[8:11], s35 offen offset:2048
    buffer_load_dwordx4 a[232:235], v4, s[8:11], s34 offen offset:2560
    buffer_load_dwordx4 a[236:239], v5, s[8:11], s35 offen offset:2560
    buffer_load_dwordx4 a[240:243], v4, s[8:11], s34 offen offset:3072
    buffer_load_dwordx4 a[244:247], v5, s[8:11], s35 offen offset:3072
    buffer_load_dwordx4 a[248:251], v4, s[8:11], s34 offen offset:3584
    buffer_load_dwordx4 a[252:255], v5, s[8:11], s35 offen offset:3584
    s_add_u32 s34, s34, 4096
    s_add_u32 s35, s35, 4096
    buffer_load_dwordx4 v[192:195], v4, s[8:11], s34 offen offset:0
    buffer_load_dwordx4 v[196:199], v5, s[8:11], s35 offen offset:0
    buffer_load_dwordx4 v[200:203], v4, s[8:11], s34 offen offset:512
    buffer_load_dwordx4 v[204:207], v5, s[8:11], s35 offen offset:512
    buffer_load_dwordx4 v[208:211], v4, s[8:11], s34 offen offset:1024
    buffer_load_dwordx4 v[212:215], v5, s[8:11], s35 offen offset:1024
    buffer_load_dwordx4 v[216:219], v4, s[8:11], s34 offen offset:1536
    buffer_load_dwordx4 v[220:223], v5, s[8:11], s35 offen offset:1536
    buffer_load_dwordx4 v[224:227], v4, s[8:11], s34 offen offset:2048
    buffer_load_dwordx4 v[228:231], v5, s[8:11], s35 offen offset:2048
    buffer_load_dwordx4 v[232:235], v4, s[8:11], s34 offen offset:2560
    buffer_load_dwordx4 v[236:239], v5, s[8:11], s35 offen offset:2560
    buffer_load_dwordx4 v[240:243], v4, s[8:11], s34 offen offset:3072
    buffer_load_dwordx4 v[244:247], v5, s[8:11], s35 offen offset:3072
    buffer_load_dwordx4 v[248:251], v4, s[8:11], s34 offen offset:3584
    buffer_load_dwordx4 v[252:255], v5, s[8:11], s35 offen offset:3584
    v_mov_b32 v3, v1
    s_mov_b32 s20, 393216
    s_mul_i32 s19, s13, 10240
    s_add_u32 s19, s19, 220200960
    s_mov_b32 s22, 0
    s_min_u32 s24, s14, 63
    s_mul_i32 s24, s24, 40960
    s_add_u32 s24, s24, s19
    s_mul_i32 s25, s13, 10240
    s_add_u32 s25, s25, s22
    s_mov_b32 m0, s25
    s_nop 0
    buffer_load_dwordx4 v1, s[8:11], s24 offen offset:0 lds
    buffer_load_dwordx4 v1, s[8:11], s24 offen offset:1024 lds
    buffer_load_dwordx4 v1, s[8:11], s24 offen offset:2048 lds
    buffer_load_dwordx4 v1, s[8:11], s24 offen offset:3072 lds
    s_add_u32 s24, s24, 4096
    s_add_u32 s25, s25, 4096
    s_mov_b32 m0, s25
    s_nop 0
    buffer_load_dwordx4 v1, s[8:11], s24 offen offset:0 lds
    buffer_load_dwordx4 v1, s[8:11], s24 offen offset:1024 lds
    buffer_load_dwordx4 v1, s[8:11], s24 offen offset:2048 lds
    buffer_load_dwordx4 v1, s[8:11], s24 offen offset:3072 lds
    s_add_u32 s24, s24, 4096
    s_add_u32 s25, s25, 4096
    s_mov_b32 m0, s25
    s_nop 0
    buffer_load_dwordx4 v1, s[8:11], s24 offen offset:0 lds
    buffer_load_dwordx4 v1, s[8:11], s24 offen offset:1024 lds
    s_mov_b32 s22, 40960
    s_add_u32 s23, s14, 1
    s_min_u32 s24, s23, 63
    s_mul_i32 s24, s24, 40960
    s_add_u32 s24, s24, s19
    s_mul_i32 s25, s13, 10240
    s_add_u32 s25, s25, s22
    s_mov_b32 m0, s25
    s_nop 0
    buffer_load_dwordx4 v1, s[8:11], s24 offen offset:0 lds
    buffer_load_dwordx4 v1, s[8:11], s24 offen offset:1024 lds
    buffer_load_dwordx4 v1, s[8:11], s24 offen offset:2048 lds
    buffer_load_dwordx4 v1, s[8:11], s24 offen offset:3072 lds
    s_add_u32 s24, s24, 4096
    s_add_u32 s25, s25, 4096
    s_mov_b32 m0, s25
    s_nop 0
    buffer_load_dwordx4 v1, s[8:11], s24 offen offset:0 lds
    buffer_load_dwordx4 v1, s[8:11], s24 offen offset:1024 lds
    buffer_load_dwordx4 v1, s[8:11], s24 offen offset:2048 lds
    buffer_load_dwordx4 v1, s[8:11], s24 offen offset:3072 lds
    s_add_u32 s24, s24, 4096
    s_add_u32 s25, s25, 4096
    s_mov_b32 m0, s25
    s_nop 0
    buffer_load_dwordx4 v1, s[8:11], s24 offen offset:0 lds
    buffer_load_dwordx4 v1, s[8:11], s24 offen offset:1024 lds
    s_mov_b32 s22, 81920
    s_mov_b32 s16, 0
    s_waitcnt vmcnt(10)
    s_barrier
    v_mov_b32 v2, v1
    ds_read_b128 v[8:11], v2 offset:0
    ds_read_b128 v[12:15], v2 offset:1024
    ds_read_b128 v[16:19], v2 offset:2048
    ds_read_b128 v[20:23], v2 offset:3072
    ds_read_b128 v[24:27], v2 offset:4096
    ds_read_b128 v[28:31], v2 offset:5120
    ds_read_b128 v[32:35], v2 offset:6144
    s_waitcnt lgkmcnt(6)
    v_mfma_f32_32x32x16_bf16 v[40:55], a[0:3], v[8:11], 0
    v_mfma_f32_32x32x16_bf16 v[56:71], a[4:7], v[8:11], 0
    ds_read_b128 v[36:39], v2 offset:7168
    s_waitcnt lgkmcnt(6)
    v_mfma_f32_32x32x16_bf16 v[40:55], a[8:11], v[12:15], v[40:55]
    v_mfma_f32_32x32x16_bf16 v[56:71], a[12:15], v[12:15], v[56:71]
    ds_read_b128 v[8:11], v2 offset:8192
    s_waitcnt lgkmcnt(6)
    v_mfma_f32_32x32x16_bf16 v[40:55], a[16:19], v[16:19], v[40:55]
    v_mfma_f32_32x32x16_bf16 v[56:71], a[20:23], v[16:19], v[56:71]
    ds_read_b128 v[12:15], v2 offset:9216
    s_waitcnt lgkmcnt(6)
    v_mfma_f32_32x32x16_bf16 v[40:55], a[24:27], v[20:23], v[40:55]
    v_mfma_f32_32x32x16_bf16 v[56:71], a[28:31], v[20:23], v[56:71]
    ds_read_b128 v[16:19], v2 offset:10240
    s_waitcnt lgkmcnt(6)
    v_mfma_f32_32x32x16_bf16 v[40:55], a[32:35], v[24:27], v[40:55]
    v_mfma_f32_32x32x16_bf16 v[56:71], a[36:39], v[24:27], v[56:71]
    ds_read_b128 v[20:23], v2 offset:11264
    s_waitcnt lgkmcnt(6)
    v_mfma_f32_32x32x16_bf16 v[40:55], a[40:43], v[28:31], v[40:55]
    v_mfma_f32_32x32x16_bf16 v[56:71], a[44:47], v[28:31], v[56:71]
    ds_read_b128 v[24:27], v2 offset:12288
    s_waitcnt lgkmcnt(6)
    v_mfma_f32_32x32x16_bf16 v[40:55], a[48:51], v[32:35], v[40:55]
    v_mfma_f32_32x32x16_bf16 v[56:71], a[52:55], v[32:35], v[56:71]
    ds_read_b128 v[28:31], v2 offset:13312
    s_waitcnt lgkmcnt(6)
    v_mfma_f32_32x32x16_bf16 v[40:55], a[56:59], v[36:39], v[40:55]
    v_mfma_f32_32x32x16_bf16 v[56:71], a[60:63], v[36:39], v[56:71]
    ds_read_b128 v[32:35], v2 offset:14336
    s_waitcnt lgkmcnt(6)
    v_mfma_f32_32x32x16_bf16 v[40:55], a[64:67], v[8:11], v[40:55]
    v_mfma_f32_32x32x16_bf16 v[56:71], a[68:71], v[8:11], v[56:71]
    ds_read_b128 v[36:39], v2 offset:15360
    s_waitcnt lgkmcnt(6)
    v_mfma_f32_32x32x16_bf16 v[40:55], a[72:75], v[12:15], v[40:55]
    v_mfma_f32_32x32x16_bf16 v[56:71], a[76:79], v[12:15], v[56:71]
    ds_read_b128 v[8:11], v2 offset:16384
    s_waitcnt lgkmcnt(6)
    v_mfma_f32_32x32x16_bf16 v[40:55], a[80:83], v[16:19], v[40:55]
    v_mfma_f32_32x32x16_bf16 v[56:71], a[84:87], v[16:19], v[56:71]
    ds_read_b128 v[12:15], v2 offset:17408
    s_waitcnt lgkmcnt(6)
    v_mfma_f32_32x32x16_bf16 v[40:55], a[88:91], v[20:23], v[40:55]
    v_mfma_f32_32x32x16_bf16 v[56:71], a[92:95], v[20:23], v[56:71]
    ds_read_b128 v[16:19], v2 offset:18432
    s_waitcnt lgkmcnt(6)
    v_mfma_f32_32x32x16_bf16 v[40:55], a[96:99], v[24:27], v[40:55]
    v_mfma_f32_32x32x16_bf16 v[56:71], a[100:103], v[24:27], v[56:71]
    ds_read_b128 v[20:23], v2 offset:19456
    s_waitcnt lgkmcnt(6)
    v_mfma_f32_32x32x16_bf16 v[40:55], a[104:107], v[28:31], v[40:55]
    v_mfma_f32_32x32x16_bf16 v[56:71], a[108:111], v[28:31], v[56:71]
    ds_read_b128 v[24:27], v2 offset:20480
    s_waitcnt lgkmcnt(6)
    v_mfma_f32_32x32x16_bf16 v[40:55], a[112:115], v[32:35], v[40:55]
    v_mfma_f32_32x32x16_bf16 v[56:71], a[116:119], v[32:35], v[56:71]
    ds_read_b128 v[28:31], v2 offset:21504
    s_waitcnt lgkmcnt(6)
    v_mfma_f32_32x32x16_bf16 v[40:55], a[120:123], v[36:39], v[40:55]
    v_mfma_f32_32x32x16_bf16 v[56:71], a[124:127], v[36:39], v[56:71]
    ds_read_b128 v[32:35], v2 offset:22528
    s_waitcnt lgkmcnt(6)
    v_mfma_f32_32x32x16_bf16 v[40:55], a[128:131], v[8:11], v[40:55]
    v_mfma_f32_32x32x16_bf16 v[56:71], a[132:135], v[8:11], v[56:71]
    ds_read_b128 v[36:39], v2 offset:23552
    s_waitcnt lgkmcnt(6)
    v_mfma_f32_32x32x16_bf16 v[40:55], a[136:139], v[12:15], v[40:55]
    v_mfma_f32_32x32x16_bf16 v[56:71], a[140:143], v[12:15], v[56:71]
    ds_read_b128 v[8:11], v2 offset:24576
    s_waitcnt lgkmcnt(6)
    v_mfma_f32_32x32x16_bf16 v[40:55], a[144:147], v[16:19], v[40:55]
    v_mfma_f32_32x32x16_bf16 v[56:71], a[148:151], v[16:19], v[56:71]
    ds_read_b128 v[12:15], v2 offset:25600
    s_waitcnt lgkmcnt(6)
    v_mfma_f32_32x32x16_bf16 v[40:55], a[152:155], v[20:23], v[40:55]
    v_mfma_f32_32x32x16_bf16 v[56:71], a[156:159], v[20:23], v[56:71]
    ds_read_b128 v[16:19], v2 offset:26624
    s_waitcnt lgkmcnt(6)
    v_mfma_f32_32x32x16_bf16 v[40:55], a[160:163], v[24:27], v[40:55]
    v_mfma_f32_32x32x16_bf16 v[56:71], a[164:167], v[24:27], v[56:71]
    ds_read_b128 v[20:23], v2 offset:27648
    s_waitcnt lgkmcnt(6)
    v_mfma_f32_32x32x16_bf16 v[40:55], a[168:171], v[28:31], v[40:55]
    v_mfma_f32_32x32x16_bf16 v[56:71], a[172:175], v[28:31], v[56:71]
    ds_read_b128 v[24:27], v2 offset:28672
    s_waitcnt lgkmcnt(6)
    v_mfma_f32_32x32x16_bf16 v[40:55], a[176:179], v[32:35], v[40:55]
    v_mfma_f32_32x32x16_bf16 v[56:71], a[180:183], v[32:35], v[56:71]
    ds_read_b128 v[28:31], v2 offset:29696
    s_waitcnt lgkmcnt(6)
    v_mfma_f32_32x32x16_bf16 v[40:55], a[184:187], v[36:39], v[40:55]
    v_mfma_f32_32x32x16_bf16 v[56:71], a[188:191], v[36:39], v[56:71]
    ds_read_b128 v[32:35], v2 offset:30720
    s_waitcnt lgkmcnt(6)
    v_mfma_f32_32x32x16_bf16 v[40:55], a[192:195], v[8:11], v[40:55]
    v_mfma_f32_32x32x16_bf16 v[56:71], a[196:199], v[8:11], v[56:71]
    ds_read_b128 v[36:39], v2 offset:31744
    s_waitcnt lgkmcnt(6)
    v_mfma_f32_32x32x16_bf16 v[40:55], a[200:203], v[12:15], v[40:55]
    v_mfma_f32_32x32x16_bf16 v[56:71], a[204:207], v[12:15], v[56:71]
    ds_read_b128 v[8:11], v2 offset:32768
    s_waitcnt lgkmcnt(6)
    v_mfma_f32_32x32x16_bf16 v[40:55], a[208:211], v[16:19], v[40:55]
    v_mfma_f32_32x32x16_bf16 v[56:71], a[212:215], v[16:19], v[56:71]
    ds_read_b128 v[12:15], v2 offset:33792
    s_waitcnt lgkmcnt(6)
    v_mfma_f32_32x32x16_bf16 v[40:55], a[216:219], v[20:23], v[40:55]
    v_mfma_f32_32x32x16_bf16 v[56:71], a[220:223], v[20:23], v[56:71]
    ds_read_b128 v[16:19], v2 offset:34816
    s_waitcnt lgkmcnt(6)
    v_mfma_f32_32x32x16_bf16 v[40:55], a[224:227], v[24:27], v[40:55]
    v_mfma_f32_32x32x16_bf16 v[56:71], a[228:231], v[24:27], v[56:71]
    s_waitcnt vmcnt(0)
    s_barrier
    s_add_u32 s21, s16, 40960
    s_cmp_eq_u32 s21, 122880
    s_cselect_b32 s21, 0, s21
    s_add_u32 s23, s14, 2
    s_min_u32 s24, s23, 63
    s_mul_i32 s24, s24, 40960
    s_add_u32 s24, s24, s19
    s_mul_i32 s25, s13, 10240
    s_add_u32 s25, s25, s22
    s_mov_b32 m0, s25
    s_nop 0
    buffer_load_dwordx4 v1, s[8:11], s24 offen offset:0 lds
    buffer_load_dwordx4 v1, s[8:11], s24 offen offset:1024 lds
    buffer_load_dwordx4 v1, s[8:11], s24 offen offset:2048 lds
    buffer_load_dwordx4 v1, s[8:11], s24 offen offset:3072 lds
    s_add_u32 s24, s24, 4096
    s_add_u32 s25, s25, 4096
    s_mov_b32 m0, s25
    s_nop 0
    buffer_load_dwordx4 v1, s[8:11], s24 offen offset:0 lds
    buffer_load_dwordx4 v1, s[8:11], s24 offen offset:1024 lds
    buffer_load_dwordx4 v1, s[8:11], s24 offen offset:2048 lds
    buffer_load_dwordx4 v1, s[8:11], s24 offen offset:3072 lds
    s_add_u32 s24, s24, 4096
    s_add_u32 s25, s25, 4096
    s_mov_b32 m0, s25
    s_nop 0
    buffer_load_dwordx4 v1, s[8:11], s24 offen offset:0 lds
    buffer_load_dwordx4 v1, s[8:11], s24 offen offset:1024 lds
    s_add_u32 s22, s22, 40960
    s_cmp_eq_u32 s22, 122880
    s_cselect_b32 s22, 0, s22
    ds_read_b128 v[20:23], v2 offset:35840
    s_waitcnt lgkmcnt(6)
    v_mfma_f32_32x32x16_bf16 v[40:55], a[232:235], v[28:31], v[40:55]
    v_mfma_f32_32x32x16_bf16 v[56:71], a[236:239], v[28:31], v[56:71]
    ds_read_b128 v[24:27], v2 offset:36864
    s_waitcnt lgkmcnt(6)
    v_mfma_f32_32x32x16_bf16 v[40:55], a[240:243], v[32:35], v[40:55]
    v_mfma_f32_32x32x16_bf16 v[56:71], a[244:247], v[32:35], v[56:71]
    ds_read_b128 v[28:31], v2 offset:37888
    s_waitcnt lgkmcnt(6)
    v_mfma_f32_32x32x16_bf16 v[40:55], a[248:251], v[36:39], v[40:55]
    v_mfma_f32_32x32x16_bf16 v[56:71], a[252:255], v[36:39], v[56:71]
    ds_read_b128 v[32:35], v2 offset:38912
    s_waitcnt lgkmcnt(6)
    v_mfma_f32_32x32x16_bf16 v[40:55], v[192:195], v[8:11], v[40:55]
    v_mfma_f32_32x32x16_bf16 v[56:71], v[196:199], v[8:11], v[56:71]
    ds_read_b128 v[36:39], v2 offset:39936
    s_waitcnt lgkmcnt(6)
    v_mfma_f32_32x32x16_bf16 v[40:55], v[200:203], v[12:15], v[40:55]
    v_mfma_f32_32x32x16_bf16 v[56:71], v[204:207], v[12:15], v[56:71]
    v_add_u32 v6, s21, v1
    ds_read_b128 v[8:11], v6 offset:0
    s_waitcnt lgkmcnt(6)
    v_mfma_f32_32x32x16_bf16 v[40:55], v[208:211], v[16:19], v[40:55]
    v_mfma_f32_32x32x16_bf16 v[56:71], v[212:215], v[16:19], v[56:71]
    ds_read_b128 v[12:15], v6 offset:1024
    s_waitcnt lgkmcnt(6)
    v_mfma_f32_32x32x16_bf16 v[40:55], v[216:219], v[20:23], v[40:55]
    v_mfma_f32_32x32x16_bf16 v[56:71], v[220:223], v[20:23], v[56:71]
    ds_read_b128 v[16:19], v6 offset:2048
    s_waitcnt lgkmcnt(6)
    v_mfma_f32_32x32x16_bf16 v[40:55], v[224:227], v[24:27], v[40:55]
    v_mfma_f32_32x32x16_bf16 v[56:71], v[228:231], v[24:27], v[56:71]
    ds_read_b128 v[20:23], v6 offset:3072
    s_waitcnt lgkmcnt(6)
    v_mfma_f32_32x32x16_bf16 v[40:55], v[232:235], v[28:31], v[40:55]
    v_mfma_f32_32x32x16_bf16 v[56:71], v[236:239], v[28:31], v[56:71]
    ds_read_b128 v[24:27], v6 offset:4096
    s_waitcnt lgkmcnt(6)
    v_mfma_f32_32x32x16_bf16 v[40:55], v[240:243], v[32:35], v[40:55]
    v_mfma_f32_32x32x16_bf16 v[56:71], v[244:247], v[32:35], v[56:71]
    ds_read_b128 v[28:31], v6 offset:5120
    s_waitcnt lgkmcnt(6)
    v_mfma_f32_32x32x16_bf16 v[40:55], v[248:251], v[36:39], v[40:55]
    v_mfma_f32_32x32x16_bf16 v[56:71], v[252:255], v[36:39], v[56:71]
    v_mov_b32 v2, v6
    s_mov_b32 s16, s21
    s_add_u32 s14, s14, 1
    s_cmp_ge_u32 s14, s15
    s_cbranch_scc1 layerb1_kernel_gk_fin0
layerb1_kernel_gk_loop:
    ds_read_b128 v[32:35], v2 offset:6144
    s_waitcnt lgkmcnt(6)
    v_mfma_f32_32x32x16_bf16 v[72:87], a[0:3], v[8:11], 0
    v_mfma_f32_32x32x16_bf16 v[88:103], a[4:7], v[8:11], 0
    ds_read_b128 v[36:39], v2 offset:7168
    s_waitcnt lgkmcnt(6)
    v_mfma_f32_32x32x16_bf16 v[72:87], a[8:11], v[12:15], v[72:87]
    v_mfma_f32_32x32x16_bf16 v[88:103], a[12:15], v[12:15], v[88:103]
    ds_read_b128 v[8:11], v2 offset:8192
    s_waitcnt lgkmcnt(6)
    v_mfma_f32_32x32x16_bf16 v[72:87], a[16:19], v[16:19], v[72:87]
    v_cvt_pk_bf16_f32 v104, v40, v41
    v_mfma_f32_32x32x16_bf16 v[88:103], a[20:23], v[16:19], v[88:103]
    v_cvt_pk_bf16_f32 v105, v42, v43
    ds_read_b128 v[12:15], v2 offset:9216
    s_waitcnt lgkmcnt(6)
    v_mfma_f32_32x32x16_bf16 v[72:87], a[24:27], v[20:23], v[72:87]
    v_cvt_pk_bf16_f32 v106, v44, v45
    v_mfma_f32_32x32x16_bf16 v[88:103], a[28:31], v[20:23], v[88:103]
    v_cvt_pk_bf16_f32 v107, v46, v47
    ds_read_b128 v[16:19], v2 offset:10240
    s_waitcnt lgkmcnt(6)
    v_mfma_f32_32x32x16_bf16 v[72:87], a[32:35], v[24:27], v[72:87]
    s_nop 1
    v_mfma_f32_32x32x16_bf16 v[88:103], a[36:39], v[24:27], v[88:103]
    v_permlane32_swap_b32 v104, v106
    ds_read_b128 v[20:23], v2 offset:11264
    s_waitcnt lgkmcnt(6)
    v_mfma_f32_32x32x16_bf16 v[72:87], a[40:43], v[28:31], v[72:87]
    v_permlane32_swap_b32 v105, v107
    v_mfma_f32_32x32x16_bf16 v[88:103], a[44:47], v[28:31], v[88:103]
    buffer_store_dwordx4 v[104:107], v3, s[8:11], s17 offen offset:0 sc1
    ds_read_b128 v[24:27], v2 offset:12288
    s_waitcnt lgkmcnt(6)
    v_mfma_f32_32x32x16_bf16 v[72:87], a[48:51], v[32:35], v[72:87]
    v_cvt_pk_bf16_f32 v108, v48, v49
    v_mfma_f32_32x32x16_bf16 v[88:103], a[52:55], v[32:35], v[88:103]
    v_cvt_pk_bf16_f32 v109, v50, v51
    ds_read_b128 v[28:31], v2 offset:13312
    s_waitcnt lgkmcnt(6)
    v_mfma_f32_32x32x16_bf16 v[72:87], a[56:59], v[36:39], v[72:87]
    v_cvt_pk_bf16_f32 v110, v52, v53
    v_mfma_f32_32x32x16_bf16 v[88:103], a[60:63], v[36:39], v[88:103]
    v_cvt_pk_bf16_f32 v111, v54, v55
    ds_read_b128 v[32:35], v2 offset:14336
    s_waitcnt lgkmcnt(6)
    v_mfma_f32_32x32x16_bf16 v[72:87], a[64:67], v[8:11], v[72:87]
    s_nop 1
    v_mfma_f32_32x32x16_bf16 v[88:103], a[68:71], v[8:11], v[88:103]
    v_permlane32_swap_b32 v108, v110
    ds_read_b128 v[36:39], v2 offset:15360
    s_waitcnt lgkmcnt(6)
    v_mfma_f32_32x32x16_bf16 v[72:87], a[72:75], v[12:15], v[72:87]
    v_permlane32_swap_b32 v109, v111
    v_mfma_f32_32x32x16_bf16 v[88:103], a[76:79], v[12:15], v[88:103]
    buffer_store_dwordx4 v[108:111], v3, s[8:11], s17 offen offset:1024 sc1
    ds_read_b128 v[8:11], v2 offset:16384
    s_waitcnt lgkmcnt(6)
    v_mfma_f32_32x32x16_bf16 v[72:87], a[80:83], v[16:19], v[72:87]
    v_cvt_pk_bf16_f32 v112, v56, v57
    v_mfma_f32_32x32x16_bf16 v[88:103], a[84:87], v[16:19], v[88:103]
    v_cvt_pk_bf16_f32 v113, v58, v59
    ds_read_b128 v[12:15], v2 offset:17408
    s_waitcnt lgkmcnt(6)
    v_mfma_f32_32x32x16_bf16 v[72:87], a[88:91], v[20:23], v[72:87]
    v_cvt_pk_bf16_f32 v114, v60, v61
    v_mfma_f32_32x32x16_bf16 v[88:103], a[92:95], v[20:23], v[88:103]
    v_cvt_pk_bf16_f32 v115, v62, v63
    ds_read_b128 v[16:19], v2 offset:18432
    s_waitcnt lgkmcnt(6)
    v_mfma_f32_32x32x16_bf16 v[72:87], a[96:99], v[24:27], v[72:87]
    s_nop 1
    v_mfma_f32_32x32x16_bf16 v[88:103], a[100:103], v[24:27], v[88:103]
    v_permlane32_swap_b32 v112, v114
    ds_read_b128 v[20:23], v2 offset:19456
    s_waitcnt lgkmcnt(6)
    v_mfma_f32_32x32x16_bf16 v[72:87], a[104:107], v[28:31], v[72:87]
    v_permlane32_swap_b32 v113, v115
    v_mfma_f32_32x32x16_bf16 v[88:103], a[108:111], v[28:31], v[88:103]
    buffer_store_dwordx4 v[112:115], v3, s[8:11], s18 offen offset:0 sc1
    ds_read_b128 v[24:27], v2 offset:20480
    s_waitcnt lgkmcnt(6)
    v_mfma_f32_32x32x16_bf16 v[72:87], a[112:115], v[32:35], v[72:87]
    v_cvt_pk_bf16_f32 v116, v64, v65
    v_mfma_f32_32x32x16_bf16 v[88:103], a[116:119], v[32:35], v[88:103]
    v_cvt_pk_bf16_f32 v117, v66, v67
    ds_read_b128 v[28:31], v2 offset:21504
    s_waitcnt lgkmcnt(6)
    v_mfma_f32_32x32x16_bf16 v[72:87], a[120:123], v[36:39], v[72:87]
    v_cvt_pk_bf16_f32 v118, v68, v69
    v_mfma_f32_32x32x16_bf16 v[88:103], a[124:127], v[36:39], v[88:103]
    v_cvt_pk_bf16_f32 v119, v70, v71
    ds_read_b128 v[32:35], v2 offset:22528
    s_waitcnt lgkmcnt(6)
    v_mfma_f32_32x32x16_bf16 v[72:87], a[128:131], v[8:11], v[72:87]
    s_nop 1
    v_mfma_f32_32x32x16_bf16 v[88:103], a[132:135], v[8:11], v[88:103]
    v_permlane32_swap_b32 v116, v118
    ds_read_b128 v[36:39], v2 offset:23552
    s_waitcnt lgkmcnt(6)
    v_mfma_f32_32x32x16_bf16 v[72:87], a[136:139], v[12:15], v[72:87]
    v_permlane32_swap_b32 v117, v119
    v_mfma_f32_32x32x16_bf16 v[88:103], a[140:143], v[12:15], v[88:103]
    buffer_store_dwordx4 v[116:119], v3, s[8:11], s18 offen offset:1024 sc1
    ds_read_b128 v[8:11], v2 offset:24576
    s_waitcnt lgkmcnt(6)
    v_mfma_f32_32x32x16_bf16 v[72:87], a[144:147], v[16:19], v[72:87]
    s_add_u32 s17, s17, s20
    v_mfma_f32_32x32x16_bf16 v[88:103], a[148:151], v[16:19], v[88:103]
    s_add_u32 s18, s18, s20
    ds_read_b128 v[12:15], v2 offset:25600
    s_waitcnt lgkmcnt(6)
    v_mfma_f32_32x32x16_bf16 v[72:87], a[152:155], v[20:23], v[72:87]
    v_mfma_f32_32x32x16_bf16 v[88:103], a[156:159], v[20:23], v[88:103]
    ds_read_b128 v[16:19], v2 offset:26624
    s_waitcnt lgkmcnt(6)
    v_mfma_f32_32x32x16_bf16 v[72:87], a[160:163], v[24:27], v[72:87]
    v_mfma_f32_32x32x16_bf16 v[88:103], a[164:167], v[24:27], v[88:103]
    ds_read_b128 v[20:23], v2 offset:27648
    s_waitcnt lgkmcnt(6)
    v_mfma_f32_32x32x16_bf16 v[72:87], a[168:171], v[28:31], v[72:87]
    v_mfma_f32_32x32x16_bf16 v[88:103], a[172:175], v[28:31], v[88:103]
    ds_read_b128 v[24:27], v2 offset:28672
    s_waitcnt lgkmcnt(6)
    v_mfma_f32_32x32x16_bf16 v[72:87], a[176:179], v[32:35], v[72:87]
    v_mfma_f32_32x32x16_bf16 v[88:103], a[180:183], v[32:35], v[88:103]
    ds_read_b128 v[28:31], v2 offset:29696
    s_waitcnt lgkmcnt(6)
    v_mfma_f32_32x32x16_bf16 v[72:87], a[184:187], v[36:39], v[72:87]
    v_mfma_f32_32x32x16_bf16 v[88:103], a[188:191], v[36:39], v[88:103]
    ds_read_b128 v[32:35], v2 offset:30720
    s_waitcnt lgkmcnt(6)
    v_mfma_f32_32x32x16_bf16 v[72:87], a[192:195], v[8:11], v[72:87]
    v_mfma_f32_32x32x16_bf16 v[88:103], a[196:199], v[8:11], v[88:103]
    ds_read_b128 v[36:39], v2 offset:31744
    s_waitcnt lgkmcnt(6)
    v_mfma_f32_32x32x16_bf16 v[72:87], a[200:203], v[12:15], v[72:87]
    v_mfma_f32_32x32x16_bf16 v[88:103], a[204:207], v[12:15], v[88:103]
    ds_read_b128 v[8:11], v2 offset:32768
    s_waitcnt lgkmcnt(6)
    v_mfma_f32_32x32x16_bf16 v[72:87], a[208:211], v[16:19], v[72:87]
    v_mfma_f32_32x32x16_bf16 v[88:103], a[212:215], v[16:19], v[88:103]
    ds_read_b128 v[12:15], v2 offset:33792
    s_waitcnt lgkmcnt(6)
    v_mfma_f32_32x32x16_bf16 v[72:87], a[216:219], v[20:23], v[72:87]
    v_mfma_f32_32x32x16_bf16 v[88:103], a[220:223], v[20:23], v[88:103]
    ds_read_b128 v[16:19], v2 offset:34816
    s_waitcnt lgkmcnt(6)
    v_mfma_f32_32x32x16_bf16 v[72:87], a[224:227], v[24:27], v[72:87]
    v_mfma_f32_32x32x16_bf16 v[88:103], a[228:231], v[24:27], v[88:103]
    s_cmp_gt_u32 s14, 2
    s_cbranch_scc1 layerb1_kernel_gk_dr1
    s_waitcnt vmcnt(0)
    s_mov_b32 s27, s14
    s_branch layerb1_kernel_gk_dq1
layerb1_kernel_gk_dr1:
    s_waitcnt vmcnt(4)
    s_sub_u32 s27, s14, 1
layerb1_kernel_gk_dq1:
    s_barrier
    s_cmp_lg_u32 s13, 0
    s_cbranch_scc1 layerb1_kernel_gk_fl2
    s_mov_b64 exec, 1
    s_lshl_b32 s26, s12, 7
    v_mov_b32 v7, s26
    v_mov_b32 v120, s27
    buffer_store_dword v120, v7, s[8:11], s48 offen sc1
    s_mov_b64 exec, -1
layerb1_kernel_gk_fl2:
    s_add_u32 s21, s16, 40960
    s_cmp_eq_u32 s21, 122880
    s_cselect_b32 s21, 0, s21
    s_add_u32 s23, s14, 2
    s_min_u32 s24, s23, 63
    s_mul_i32 s24, s24, 40960
    s_add_u32 s24, s24, s19
    s_mul_i32 s25, s13, 10240
    s_add_u32 s25, s25, s22
    s_mov_b32 m0, s25
    s_nop 0
    buffer_load_dwordx4 v1, s[8:11], s24 offen offset:0 lds
    buffer_load_dwordx4 v1, s[8:11], s24 offen offset:1024 lds
    buffer_load_dwordx4 v1, s[8:11], s24 offen offset:2048 lds
    buffer_load_dwordx4 v1, s[8:11], s24 offen offset:3072 lds
    s_add_u32 s24, s24, 4096
    s_add_u32 s25, s25, 4096
    s_mov_b32 m0, s25
    s_nop 0
    buffer_load_dwordx4 v1, s[8:11], s24 offen offset:0 lds
    buffer_load_dwordx4 v1, s[8:11], s24 offen offset:1024 lds
    buffer_load_dwordx4 v1, s[8:11], s24 offen offset:2048 lds
    buffer_load_dwordx4 v1, s[8:11], s24 offen offset:3072 lds
    s_add_u32 s24, s24, 4096
    s_add_u32 s25, s25, 4096
    s_mov_b32 m0, s25
    s_nop 0
    buffer_load_dwordx4 v1, s[8:11], s24 offen offset:0 lds
    buffer_load_dwordx4 v1, s[8:11], s24 offen offset:1024 lds
    s_add_u32 s22, s22, 40960
    s_cmp_eq_u32 s22, 122880
    s_cselect_b32 s22, 0, s22
    ds_read_b128 v[20:23], v2 offset:35840
    s_waitcnt lgkmcnt(6)
    v_mfma_f32_32x32x16_bf16 v[72:87], a[232:235], v[28:31], v[72:87]
    v_mfma_f32_32x32x16_bf16 v[88:103], a[236:239], v[28:31], v[88:103]
    ds_read_b128 v[24:27], v2 offset:36864
    s_waitcnt lgkmcnt(6)
    v_mfma_f32_32x32x16_bf16 v[72:87], a[240:243], v[32:35], v[72:87]
    v_mfma_f32_32x32x16_bf16 v[88:103], a[244:247], v[32:35], v[88:103]
    ds_read_b128 v[28:31], v2 offset:37888
    s_waitcnt lgkmcnt(6)
    v_mfma_f32_32x32x16_bf16 v[72:87], a[248:251], v[36:39], v[72:87]
    v_mfma_f32_32x32x16_bf16 v[88:103], a[252:255], v[36:39], v[88:103]
    ds_read_b128 v[32:35], v2 offset:38912
    s_waitcnt lgkmcnt(6)
    v_mfma_f32_32x32x16_bf16 v[72:87], v[192:195], v[8:11], v[72:87]
    v_mfma_f32_32x32x16_bf16 v[88:103], v[196:199], v[8:11], v[88:103]
    ds_read_b128 v[36:39], v2 offset:39936
    s_waitcnt lgkmcnt(6)
    v_mfma_f32_32x32x16_bf16 v[72:87], v[200:203], v[12:15], v[72:87]
    v_mfma_f32_32x32x16_bf16 v[88:103], v[204:207], v[12:15], v[88:103]
    v_add_u32 v6, s21, v1
    ds_read_b128 v[8:11], v6 offset:0
    s_waitcnt lgkmcnt(6)
    v_mfma_f32_32x32x16_bf16 v[72:87], v[208:211], v[16:19], v[72:87]
    v_mfma_f32_32x32x16_bf16 v[88:103], v[212:215], v[16:19], v[88:103]
    ds_read_b128 v[12:15], v6 offset:1024
    s_waitcnt lgkmcnt(6)
    v_mfma_f32_32x32x16_bf16 v[72:87], v[216:219], v[20:23], v[72:87]
    v_mfma_f32_32x32x16_bf16 v[88:103], v[220:223], v[20:23], v[88:103]
    ds_read_b128 v[16:19], v6 offset:2048
    s_waitcnt lgkmcnt(6)
    v_mfma_f32_32x32x16_bf16 v[72:87], v[224:227], v[24:27], v[72:87]
    v_mfma_f32_32x32x16_bf16 v[88:103], v[228:231], v[24:27], v[88:103]
    ds_read_b128 v[20:23], v6 offset:3072
    s_waitcnt lgkmcnt(6)
    v_mfma_f32_32x32x16_bf16 v[72:87], v[232:235], v[28:31], v[72:87]
    v_mfma_f32_32x32x16_bf16 v[88:103], v[236:239], v[28:31], v[88:103]
    ds_read_b128 v[24:27], v6 offset:4096
    s_waitcnt lgkmcnt(6)
    v_mfma_f32_32x32x16_bf16 v[72:87], v[240:243], v[32:35], v[72:87]
    v_mfma_f32_32x32x16_bf16 v[88:103], v[244:247], v[32:35], v[88:103]
    ds_read_b128 v[28:31], v6 offset:5120
    s_waitcnt lgkmcnt(6)
    v_mfma_f32_32x32x16_bf16 v[72:87], v[248:251], v[36:39], v[72:87]
    v_mfma_f32_32x32x16_bf16 v[88:103], v[252:255], v[36:39], v[88:103]
    v_mov_b32 v2, v6
    s_mov_b32 s16, s21
    s_add_u32 s14, s14, 1
    s_cmp_ge_u32 s14, s15
    s_cbranch_scc1 layerb1_kernel_gk_fin1
    ds_read_b128 v[32:35], v2 offset:6144
    s_waitcnt lgkmcnt(6)
    v_mfma_f32_32x32x16_bf16 v[40:55], a[0:3], v[8:11], 0
    v_mfma_f32_32x32x16_bf16 v[56:71], a[4:7], v[8:11], 0
    ds_read_b128 v[36:39], v2 offset:7168
    s_waitcnt lgkmcnt(6)
    v_mfma_f32_32x32x16_bf16 v[40:55], a[8:11], v[12:15], v[40:55]
    v_mfma_f32_32x32x16_bf16 v[56:71], a[12:15], v[12:15], v[56:71]
    ds_read_b128 v[8:11], v2 offset:8192
    s_waitcnt lgkmcnt(6)
    v_mfma_f32_32x32x16_bf16 v[40:55], a[16:19], v[16:19], v[40:55]
    v_cvt_pk_bf16_f32 v104, v72, v73
    v_mfma_f32_32x32x16_bf16 v[56:71], a[20:23], v[16:19], v[56:71]
    v_cvt_pk_bf16_f32 v105, v74, v75
    ds_read_b128 v[12:15], v2 offset:9216
    s_waitcnt lgkmcnt(6)
    v_mfma_f32_32x32x16_bf16 v[40:55], a[24:27], v[20:23], v[40:55]
    v_cvt_pk_bf16_f32 v106, v76, v77
    v_mfma_f32_32x32x16_bf16 v[56:71], a[28:31], v[20:23], v[56:71]
    v_cvt_pk_bf16_f32 v107, v78, v79
    ds_read_b128 v[16:19], v2 offset:10240
    s_waitcnt lgkmcnt(6)
    v_mfma_f32_32x32x16_bf16 v[40:55], a[32:35], v[24:27], v[40:55]
    s_nop 1
    v_mfma_f32_32x32x16_bf16 v[56:71], a[36:39], v[24:27], v[56:71]
    v_permlane32_swap_b32 v104, v106
    ds_read_b128 v[20:23], v2 offset:11264
    s_waitcnt lgkmcnt(6)
    v_mfma_f32_32x32x16_bf16 v[40:55], a[40:43], v[28:31], v[40:55]
    v_permlane32_swap_b32 v105, v107
    v_mfma_f32_32x32x16_bf16 v[56:71], a[44:47], v[28:31], v[56:71]
    buffer_store_dwordx4 v[104:107], v3, s[8:11], s17 offen offset:0 sc1
    ds_read_b128 v[24:27], v2 offset:12288
    s_waitcnt lgkmcnt(6)
    v_mfma_f32_32x32x16_bf16 v[40:55], a[48:51], v[32:35], v[40:55]
    v_cvt_pk_bf16_f32 v108, v80, v81
    v_mfma_f32_32x32x16_bf16 v[56:71], a[52:55], v[32:35], v[56:71]
    v_cvt_pk_bf16_f32 v109, v82, v83
    ds_read_b128 v[28:31], v2 offset:13312
    s_waitcnt lgkmcnt(6)
    v_mfma_f32_32x32x16_bf16 v[40:55], a[56:59], v[36:39], v[40:55]
    v_cvt_pk_bf16_f32 v110, v84, v85
    v_mfma_f32_32x32x16_bf16 v[56:71], a[60:63], v[36:39], v[56:71]
    v_cvt_pk_bf16_f32 v111, v86, v87
    ds_read_b128 v[32:35], v2 offset:14336
    s_waitcnt lgkmcnt(6)
    v_mfma_f32_32x32x16_bf16 v[40:55], a[64:67], v[8:11], v[40:55]
    s_nop 1
    v_mfma_f32_32x32x16_bf16 v[56:71], a[68:71], v[8:11], v[56:71]
    v_permlane32_swap_b32 v108, v110
    ds_read_b128 v[36:39], v2 offset:15360
    s_waitcnt lgkmcnt(6)
    v_mfma_f32_32x32x16_bf16 v[40:55], a[72:75], v[12:15], v[40:55]
    v_permlane32_swap_b32 v109, v111
    v_mfma_f32_32x32x16_bf16 v[56:71], a[76:79], v[12:15], v[56:71]
    buffer_store_dwordx4 v[108:111], v3, s[8:11], s17 offen offset:1024 sc1
    ds_read_b128 v[8:11], v2 offset:16384
    s_waitcnt lgkmcnt(6)
    v_mfma_f32_32x32x16_bf16 v[40:55], a[80:83], v[16:19], v[40:55]
    v_cvt_pk_bf16_f32 v112, v88, v89
    v_mfma_f32_32x32x16_bf16 v[56:71], a[84:87], v[16:19], v[56:71]
    v_cvt_pk_bf16_f32 v113, v90, v91
    ds_read_b128 v[12:15], v2 offset:17408
    s_waitcnt lgkmcnt(6)
    v_mfma_f32_32x32x16_bf16 v[40:55], a[88:91], v[20:23], v[40:55]
    v_cvt_pk_bf16_f32 v114, v92, v93
    v_mfma_f32_32x32x16_bf16 v[56:71], a[92:95], v[20:23], v[56:71]
    v_cvt_pk_bf16_f32 v115, v94, v95
    ds_read_b128 v[16:19], v2 offset:18432
    s_waitcnt lgkmcnt(6)
    v_mfma_f32_32x32x16_bf16 v[40:55], a[96:99], v[24:27], v[40:55]
    s_nop 1
    v_mfma_f32_32x32x16_bf16 v[56:71], a[100:103], v[24:27], v[56:71]
    v_permlane32_swap_b32 v112, v114
    ds_read_b128 v[20:23], v2 offset:19456
    s_waitcnt lgkmcnt(6)
    v_mfma_f32_32x32x16_bf16 v[40:55], a[104:107], v[28:31], v[40:55]
    v_permlane32_swap_b32 v113, v115
    v_mfma_f32_32x32x16_bf16 v[56:71], a[108:111], v[28:31], v[56:71]
    buffer_store_dwordx4 v[112:115], v3, s[8:11], s18 offen offset:0 sc1
    ds_read_b128 v[24:27], v2 offset:20480
    s_waitcnt lgkmcnt(6)
    v_mfma_f32_32x32x16_bf16 v[40:55], a[112:115], v[32:35], v[40:55]
    v_cvt_pk_bf16_f32 v116, v96, v97
    v_mfma_f32_32x32x16_bf16 v[56:71], a[116:119], v[32:35], v[56:71]
    v_cvt_pk_bf16_f32 v117, v98, v99
    ds_read_b128 v[28:31], v2 offset:21504
    s_waitcnt lgkmcnt(6)
    v_mfma_f32_32x32x16_bf16 v[40:55], a[120:123], v[36:39], v[40:55]
    v_cvt_pk_bf16_f32 v118, v100, v101
    v_mfma_f32_32x32x16_bf16 v[56:71], a[124:127], v[36:39], v[56:71]
    v_cvt_pk_bf16_f32 v119, v102, v103
    ds_read_b128 v[32:35], v2 offset:22528
    s_waitcnt lgkmcnt(6)
    v_mfma_f32_32x32x16_bf16 v[40:55], a[128:131], v[8:11], v[40:55]
    s_nop 1
    v_mfma_f32_32x32x16_bf16 v[56:71], a[132:135], v[8:11], v[56:71]
    v_permlane32_swap_b32 v116, v118
    ds_read_b128 v[36:39], v2 offset:23552
    s_waitcnt lgkmcnt(6)
    v_mfma_f32_32x32x16_bf16 v[40:55], a[136:139], v[12:15], v[40:55]
    v_permlane32_swap_b32 v117, v119
    v_mfma_f32_32x32x16_bf16 v[56:71], a[140:143], v[12:15], v[56:71]
    buffer_store_dwordx4 v[116:119], v3, s[8:11], s18 offen offset:1024 sc1
    ds_read_b128 v[8:11], v2 offset:24576
    s_waitcnt lgkmcnt(6)
    v_mfma_f32_32x32x16_bf16 v[40:55], a[144:147], v[16:19], v[40:55]
    s_add_u32 s17, s17, s20
    v_mfma_f32_32x32x16_bf16 v[56:71], a[148:151], v[16:19], v[56:71]
    s_add_u32 s18, s18, s20
    ds_read_b128 v[12:15], v2 offset:25600
    s_waitcnt lgkmcnt(6)
    v_mfma_f32_32x32x16_bf16 v[40:55], a[152:155], v[20:23], v[40:55]
    v_mfma_f32_32x32x16_bf16 v[56:71], a[156:159], v[20:23], v[56:71]
    ds_read_b128 v[16:19], v2 offset:26624
    s_waitcnt lgkmcnt(6)
    v_mfma_f32_32x32x16_bf16 v[40:55], a[160:163], v[24:27], v[40:55]
    v_mfma_f32_32x32x16_bf16 v[56:71], a[164:167], v[24:27], v[56:71]
    ds_read_b128 v[20:23], v2 offset:27648
    s_waitcnt lgkmcnt(6)
    v_mfma_f32_32x32x16_bf16 v[40:55], a[168:171], v[28:31], v[40:55]
    v_mfma_f32_32x32x16_bf16 v[56:71], a[172:175], v[28:31], v[56:71]
    ds_read_b128 v[24:27], v2 offset:28672
    s_waitcnt lgkmcnt(6)
    v_mfma_f32_32x32x16_bf16 v[40:55], a[176:179], v[32:35], v[40:55]
    v_mfma_f32_32x32x16_bf16 v[56:71], a[180:183], v[32:35], v[56:71]
    ds_read_b128 v[28:31], v2 offset:29696
    s_waitcnt lgkmcnt(6)
    v_mfma_f32_32x32x16_bf16 v[40:55], a[184:187], v[36:39], v[40:55]
    v_mfma_f32_32x32x16_bf16 v[56:71], a[188:191], v[36:39], v[56:71]
    ds_read_b128 v[32:35], v2 offset:30720
    s_waitcnt lgkmcnt(6)
    v_mfma_f32_32x32x16_bf16 v[40:55], a[192:195], v[8:11], v[40:55]
    v_mfma_f32_32x32x16_bf16 v[56:71], a[196:199], v[8:11], v[56:71]
    ds_read_b128 v[36:39], v2 offset:31744
    s_waitcnt lgkmcnt(6)
    v_mfma_f32_32x32x16_bf16 v[40:55], a[200:203], v[12:15], v[40:55]
    v_mfma_f32_32x32x16_bf16 v[56:71], a[204:207], v[12:15], v[56:71]
    ds_read_b128 v[8:11], v2 offset:32768
    s_waitcnt lgkmcnt(6)
    v_mfma_f32_32x32x16_bf16 v[40:55], a[208:211], v[16:19], v[40:55]
    v_mfma_f32_32x32x16_bf16 v[56:71], a[212:215], v[16:19], v[56:71]
    ds_read_b128 v[12:15], v2 offset:33792
    s_waitcnt lgkmcnt(6)
    v_mfma_f32_32x32x16_bf16 v[40:55], a[216:219], v[20:23], v[40:55]
    v_mfma_f32_32x32x16_bf16 v[56:71], a[220:223], v[20:23], v[56:71]
    ds_read_b128 v[16:19], v2 offset:34816
    s_waitcnt lgkmcnt(6)
    v_mfma_f32_32x32x16_bf16 v[40:55], a[224:227], v[24:27], v[40:55]
    v_mfma_f32_32x32x16_bf16 v[56:71], a[228:231], v[24:27], v[56:71]
    s_cmp_gt_u32 s14, 2
    s_cbranch_scc1 layerb1_kernel_gk_dr3
    s_waitcnt vmcnt(0)
    s_mov_b32 s27, s14
    s_branch layerb1_kernel_gk_dq3
layerb1_kernel_gk_dr3:
    s_waitcnt vmcnt(4)
    s_sub_u32 s27, s14, 1
layerb1_kernel_gk_dq3:
    s_barrier
    s_cmp_lg_u32 s13, 0
    s_cbranch_scc1 layerb1_kernel_gk_fl4
    s_mov_b64 exec, 1
    s_lshl_b32 s26, s12, 7
    v_mov_b32 v7, s26
    v_mov_b32 v120, s27
    buffer_store_dword v120, v7, s[8:11], s48 offen sc1
    s_mov_b64 exec, -1
layerb1_kernel_gk_fl4:
    s_add_u32 s21, s16, 40960
    s_cmp_eq_u32 s21, 122880
    s_cselect_b32 s21, 0, s21
    s_add_u32 s23, s14, 2
    s_min_u32 s24, s23, 63
    s_mul_i32 s24, s24, 40960
    s_add_u32 s24, s24, s19
    s_mul_i32 s25, s13, 10240
    s_add_u32 s25, s25, s22
    s_mov_b32 m0, s25
    s_nop 0
    buffer_load_dwordx4 v1, s[8:11], s24 offen offset:0 lds
    buffer_load_dwordx4 v1, s[8:11], s24 offen offset:1024 lds
    buffer_load_dwordx4 v1, s[8:11], s24 offen offset:2048 lds
    buffer_load_dwordx4 v1, s[8:11], s24 offen offset:3072 lds
    s_add_u32 s24, s24, 4096
    s_add_u32 s25, s25, 4096
    s_mov_b32 m0, s25
    s_nop 0
    buffer_load_dwordx4 v1, s[8:11], s24 offen offset:0 lds
    buffer_load_dwordx4 v1, s[8:11], s24 offen offset:1024 lds
    buffer_load_dwordx4 v1, s[8:11], s24 offen offset:2048 lds
    buffer_load_dwordx4 v1, s[8:11], s24 offen offset:3072 lds
    s_add_u32 s24, s24, 4096
    s_add_u32 s25, s25, 4096
    s_mov_b32 m0, s25
    s_nop 0
    buffer_load_dwordx4 v1, s[8:11], s24 offen offset:0 lds
    buffer_load_dwordx4 v1, s[8:11], s24 offen offset:1024 lds
    s_add_u32 s22, s22, 40960
    s_cmp_eq_u32 s22, 122880
    s_cselect_b32 s22, 0, s22
    ds_read_b128 v[20:23], v2 offset:35840
    s_waitcnt lgkmcnt(6)
    v_mfma_f32_32x32x16_bf16 v[40:55], a[232:235], v[28:31], v[40:55]
    v_mfma_f32_32x32x16_bf16 v[56:71], a[236:239], v[28:31], v[56:71]
    ds_read_b128 v[24:27], v2 offset:36864
    s_waitcnt lgkmcnt(6)
    v_mfma_f32_32x32x16_bf16 v[40:55], a[240:243], v[32:35], v[40:55]
    v_mfma_f32_32x32x16_bf16 v[56:71], a[244:247], v[32:35], v[56:71]
    ds_read_b128 v[28:31], v2 offset:37888
    s_waitcnt lgkmcnt(6)
    v_mfma_f32_32x32x16_bf16 v[40:55], a[248:251], v[36:39], v[40:55]
    v_mfma_f32_32x32x16_bf16 v[56:71], a[252:255], v[36:39], v[56:71]
    ds_read_b128 v[32:35], v2 offset:38912
    s_waitcnt lgkmcnt(6)
    v_mfma_f32_32x32x16_bf16 v[40:55], v[192:195], v[8:11], v[40:55]
    v_mfma_f32_32x32x16_bf16 v[56:71], v[196:199], v[8:11], v[56:71]
    ds_read_b128 v[36:39], v2 offset:39936
    s_waitcnt lgkmcnt(6)
    v_mfma_f32_32x32x16_bf16 v[40:55], v[200:203], v[12:15], v[40:55]
    v_mfma_f32_32x32x16_bf16 v[56:71], v[204:207], v[12:15], v[56:71]
    v_add_u32 v6, s21, v1
    ds_read_b128 v[8:11], v6 offset:0
    s_waitcnt lgkmcnt(6)
    v_mfma_f32_32x32x16_bf16 v[40:55], v[208:211], v[16:19], v[40:55]
    v_mfma_f32_32x32x16_bf16 v[56:71], v[212:215], v[16:19], v[56:71]
    ds_read_b128 v[12:15], v6 offset:1024
    s_waitcnt lgkmcnt(6)
    v_mfma_f32_32x32x16_bf16 v[40:55], v[216:219], v[20:23], v[40:55]
    v_mfma_f32_32x32x16_bf16 v[56:71], v[220:223], v[20:23], v[56:71]
    ds_read_b128 v[16:19], v6 offset:2048
    s_waitcnt lgkmcnt(6)
    v_mfma_f32_32x32x16_bf16 v[40:55], v[224:227], v[24:27], v[40:55]
    v_mfma_f32_32x32x16_bf16 v[56:71], v[228:231], v[24:27], v[56:71]
    ds_read_b128 v[20:23], v6 offset:3072
    s_waitcnt lgkmcnt(6)
    v_mfma_f32_32x32x16_bf16 v[40:55], v[232:235], v[28:31], v[40:55]
    v_mfma_f32_32x32x16_bf16 v[56:71], v[236:239], v[28:31], v[56:71]
    ds_read_b128 v[24:27], v6 offset:4096
    s_waitcnt lgkmcnt(6)
    v_mfma_f32_32x32x16_bf16 v[40:55], v[240:243], v[32:35], v[40:55]
    v_mfma_f32_32x32x16_bf16 v[56:71], v[244:247], v[32:35], v[56:71]
    ds_read_b128 v[28:31], v6 offset:5120
    s_waitcnt lgkmcnt(6)
    v_mfma_f32_32x32x16_bf16 v[40:55], v[248:251], v[36:39], v[40:55]
    v_mfma_f32_32x32x16_bf16 v[56:71], v[252:255], v[36:39], v[56:71]
    v_mov_b32 v2, v6
    s_mov_b32 s16, s21
    s_add_u32 s14, s14, 1
    s_cmp_lt_u32 s14, s15
    s_cbranch_scc1 layerb1_kernel_gk_loop
layerb1_kernel_gk_fin0:
    s_nop 7
    s_nop 7
    v_cvt_pk_bf16_f32 v104, v40, v41
    v_cvt_pk_bf16_f32 v105, v42, v43
    v_cvt_pk_bf16_f32 v106, v44, v45
    v_cvt_pk_bf16_f32 v107, v46, v47
    s_nop 1
    v_permlane32_swap_b32 v104, v106
    v_permlane32_swap_b32 v105, v107
    buffer_store_dwordx4 v[104:107], v3, s[8:11], s17 offen offset:0 sc1
    v_cvt_pk_bf16_f32 v108, v48, v49
    v_cvt_pk_bf16_f32 v109, v50, v51
    v_cvt_pk_bf16_f32 v110, v52, v53
    v_cvt_pk_bf16_f32 v111, v54, v55
    s_nop 1
    v_permlane32_swap_b32 v108, v110
    v_permlane32_swap_b32 v109, v111
    buffer_store_dwordx4 v[108:111], v3, s[8:11], s17 offen offset:1024 sc1
    v_cvt_pk_bf16_f32 v112, v56, v57
    v_cvt_pk_bf16_f32 v113, v58, v59
    v_cvt_pk_bf16_f32 v114, v60, v61
    v_cvt_pk_bf16_f32 v115, v62, v63
    s_nop 1
    v_permlane32_swap_b32 v112, v114
    v_permlane32_swap_b32 v113, v115
    buffer_store_dwordx4 v[112:115], v3, s[8:11], s18 offen offset:0 sc1
    v_cvt_pk_bf16_f32 v116, v64, v65
    v_cvt_pk_bf16_f32 v117, v66, v67
    v_cvt_pk_bf16_f32 v118, v68, v69
    v_cvt_pk_bf16_f32 v119, v70, v71
    s_nop 1
    v_permlane32_swap_b32 v116, v118
    v_permlane32_swap_b32 v117, v119
    buffer_store_dwordx4 v[116:119], v3, s[8:11], s18 offen offset:1024 sc1
    s_add_u32 s17, s17, s20
    s_add_u32 s18, s18, s20
    s_branch layerb1_kernel_gk_done
layerb1_kernel_gk_fin1:
    s_nop 7
    s_nop 7
    v_cvt_pk_bf16_f32 v104, v72, v73
    v_cvt_pk_bf16_f32 v105, v74, v75
    v_cvt_pk_bf16_f32 v106, v76, v77
    v_cvt_pk_bf16_f32 v107, v78, v79
    s_nop 1
    v_permlane32_swap_b32 v104, v106
    v_permlane32_swap_b32 v105, v107
    buffer_store_dwordx4 v[104:107], v3, s[8:11], s17 offen offset:0 sc1
    v_cvt_pk_bf16_f32 v108, v80, v81
    v_cvt_pk_bf16_f32 v109, v82, v83
    v_cvt_pk_bf16_f32 v110, v84, v85
    v_cvt_pk_bf16_f32 v111, v86, v87
    s_nop 1
    v_permlane32_swap_b32 v108, v110
    v_permlane32_swap_b32 v109, v111
    buffer_store_dwordx4 v[108:111], v3, s[8:11], s17 offen offset:1024 sc1
    v_cvt_pk_bf16_f32 v112, v88, v89
    v_cvt_pk_bf16_f32 v113, v90, v91
    v_cvt_pk_bf16_f32 v114, v92, v93
    v_cvt_pk_bf16_f32 v115, v94, v95
    s_nop 1
    v_permlane32_swap_b32 v112, v114
    v_permlane32_swap_b32 v113, v115
    buffer_store_dwordx4 v[112:115], v3, s[8:11], s18 offen offset:0 sc1
    v_cvt_pk_bf16_f32 v116, v96, v97
    v_cvt_pk_bf16_f32 v117, v98, v99
    v_cvt_pk_bf16_f32 v118, v100, v101
    v_cvt_pk_bf16_f32 v119, v102, v103
    s_nop 1
    v_permlane32_swap_b32 v116, v118
    v_permlane32_swap_b32 v117, v119
    buffer_store_dwordx4 v[116:119], v3, s[8:11], s18 offen offset:1024 sc1
    s_add_u32 s17, s17, s20
    s_add_u32 s18, s18, s20
layerb1_kernel_gk_done:
    s_waitcnt vmcnt(0) lgkmcnt(0)
    s_barrier
    s_cmp_lg_u32 s13, 0
    s_cbranch_scc1 layerb1_kernel_gk_fl5
    s_mov_b64 exec, 1
    s_lshl_b32 s26, s12, 7
    v_mov_b32 v7, s26
    v_mov_b32 v120, s14
    buffer_store_dword v120, v7, s[8:11], s48 offen sc1
    s_mov_b64 exec, -1
layerb1_kernel_gk_fl5:
layerb1_kernel_g_done:
layerb1_kernel_w3:
    s_mov_b32 s15, 400000
layerb1_kernel_j_next:
    s_cmp_lg_u32 s13, 0
    s_cbranch_scc1 layerb1_kernel_j_rel
    s_mov_b64 exec, 1
    v_mov_b32 v2, 31744
    v_mov_b32 v3, 1
    buffer_atomic_add v3, v2, s[8:11], s48 offen sc0 sc1
    s_waitcnt vmcnt(0)
    s_mov_b64 exec, -1
    s_nop 0
    v_readfirstlane_b32 s38, v3
    s_cmp_ge_u32 s38, 1152
    s_cbranch_scc1 layerb1_kernel_j_pub
    s_mul_i32 s39, s38, 58255
    s_lshr_b32 s40, s39, 20
    s_mul_i32 s39, s40, 18
    s_sub_u32 s41, s38, s39
    s_add_u32 s42, s40, 1
    v_mov_b32 v4, s42
    s_cmp_ge_u32 s41, 8
    s_cbranch_scc1 layerb1_kernel_j_dep_b
    s_lshl_b32 s24, s41, 9
    s_add_u32 s24, s24, 16384
    v_lshlrev_b32 v2, 7, v0
    v_add_u32 v2, s24, v2
    s_mul_i32 s25, s41, 3
    s_add_u32 s25, s25, 104
    s_lshl_b32 s25, s25, 7
    v_writelane_b32 v2, s25, 4
    s_add_u32 s25, s25, 128
    v_writelane_b32 v2, s25, 5
    s_add_u32 s25, s25, 128
    v_writelane_b32 v2, s25, 6
    s_mov_b64 exec, 0x7f
    s_branch layerb1_kernel_j_poll
layerb1_kernel_j_dep_b:
    s_sub_u32 s24, s41, 8
    s_lshl_b32 s24, s24, 10
    s_add_u32 s24, s24, 20480
    v_lshlrev_b32 v2, 7, v0
    v_add_u32 v2, s24, v2
    s_lshl_b32 s25, s40, 4
    s_add_u32 s25, s25, 30720
    v_writelane_b32 v2, s25, 8
    s_mov_b32 s26, 8
    v_writelane_b32 v4, s26, 8
    s_mov_b64 exec, 0x1ff
layerb1_kernel_j_poll:
    buffer_load_dword v3, v2, s[8:11], s48 offen sc1
    s_waitcnt vmcnt(0)
    v_cmp_gt_u32 vcc, v4, v3
    s_sub_u32 s15, s15, 1
    s_cbranch_scc1 layerb1_kernel_j_giveup
    s_cbranch_vccnz layerb1_kernel_j_poll
    s_mov_b64 exec, -1
layerb1_kernel_j_pub:
    v_mov_b32 v2, 0
    v_mov_b32 v3, s38
    ds_write_b32 v2, v3 offset:32768
    s_waitcnt lgkmcnt(0)
layerb1_kernel_j_rel:
    s_barrier
    v_mov_b32 v2, 0
    ds_read_b32 v3, v2 offset:32768
    s_waitcnt lgkmcnt(0)
    v_readfirstlane_b32 s38, v3
    s_cmp_ge_u32 s38, 1152
    s_cbranch_scc1 layerb1_kernel_j_done
    s_mul_i32 s39, s38, 58255
    s_lshr_b32 s40, s39, 20
    s_mul_i32 s39, s40, 18
    s_sub_u32 s41, s38, s39
    s_cmp_ge_u32 s41, 8
    s_cbranch_scc1 layerb1_kernel_j_b
    s_lshl_b32 s41, s41, 2
    s_add_u32 s41, s41, s13
    v_lshlrev_b32 v1, 4, v0
    v_and_b32 v2, 31, v0
    v_lshrrev_b32 v3, 5, v0
    s_lshl_b32 s24, s40, 5
    s_add_u32 s24, s24, s41
    s_mul_i32 s25, s24, 12288
    s_add_u32 s26, s25, 78643200
    s_add_u32 s27, s25, 53477376
    s_mul_i32 s28, s24, 3072
    s_add_u32 s28, s28, 208666624
    v_and_b32 v4, 7, v0
    v_lshlrev_b32 v4, 4, v4
    v_lshl_add_u32 v4, v3, 7, v4
    buffer_load_dwordx4 v[16:19], v1, s[8:11], s26 offen offset:0 sc1
    buffer_load_dwordx4 v[64:67], v1, s[8:11], s27 offen offset:0 sc1
    buffer_load_dwordx4 v[112:115], v4, s[8:11], s28 offen offset:0 sc1
    buffer_load_dwordx4 v[20:23], v1, s[8:11], s26 offen offset:1024 sc1
    buffer_load_dwordx4 v[68:71], v1, s[8:11], s27 offen offset:1024 sc1
    buffer_load_dwordx4 v[116:119], v4, s[8:11], s28 offen offset:256 sc1
    buffer_load_dwordx4 v[24:27], v1, s[8:11], s26 offen offset:2048 sc1
    buffer_load_dwordx4 v[72:75], v1, s[8:11], s27 offen offset:2048 sc1
    buffer_load_dwordx4 v[120:123], v4, s[8:11], s28 offen offset:512 sc1
    buffer_load_dwordx4 v[28:31], v1, s[8:11], s26 offen offset:3072 sc1
    buffer_load_dwordx4 v[76:79], v1, s[8:11], s27 offen offset:3072 sc1
    buffer_load_dwordx4 v[124:127], v4, s[8:11], s28 offen offset:768 sc1
    s_add_u32 s26, s26, 4096
    s_add_u32 s27, s27, 4096
    buffer_load_dwordx4 v[32:35], v1, s[8:11], s26 offen offset:0 sc1
    buffer_load_dwordx4 v[80:83], v1, s[8:11], s27 offen offset:0 sc1
    buffer_load_dwordx4 v[128:131], v4, s[8:11], s28 offen offset:1024 sc1
    buffer_load_dwordx4 v[36:39], v1, s[8:11], s26 offen offset:1024 sc1
    buffer_load_dwordx4 v[84:87], v1, s[8:11], s27 offen offset:1024 sc1
    buffer_load_dwordx4 v[132:135], v4, s[8:11], s28 offen offset:1280 sc1
    buffer_load_dwordx4 v[40:43], v1, s[8:11], s26 offen offset:2048 sc1
    buffer_load_dwordx4 v[88:91], v1, s[8:11], s27 offen offset:2048 sc1
    buffer_load_dwordx4 v[136:139], v4, s[8:11], s28 offen offset:1536 sc1
    buffer_load_dwordx4 v[44:47], v1, s[8:11], s26 offen offset:3072 sc1
    buffer_load_dwordx4 v[92:95], v1, s[8:11], s27 offen offset:3072 sc1
    buffer_load_dwordx4 v[140:143], v4, s[8:11], s28 offen offset:1792 sc1
    s_add_u32 s26, s26, 4096
    s_add_u32 s27, s27, 4096
    buffer_load_dwordx4 v[48:51], v1, s[8:11], s26 offen offset:0 sc1
    buffer_load_dwordx4 v[96:99], v1, s[8:11], s27 offen offset:0 sc1
    buffer_load_dwordx4 v[144:147], v4, s[8:11], s28 offen offset:2048 sc1
    buffer_load_dwordx4 v[52:55], v1, s[8:11], s26 offen offset:1024 sc1
    buffer_load_dwordx4 v[100:103], v1, s[8:11], s27 offen offset:1024 sc1
    buffer_load_dwordx4 v[148:151], v4, s[8:11], s28 offen offset:2304 sc1
    buffer_load_dwordx4 v[56:59], v1, s[8:11], s26 offen offset:2048 sc1
    buffer_load_dwordx4 v[104:107], v1, s[8:11], s27 offen offset:2048 sc1
    buffer_load_dwordx4 v[152:155], v4, s[8:11], s28 offen offset:2560 sc1
    buffer_load_dwordx4 v[60:63], v1, s[8:11], s26 offen offset:3072 sc1
    buffer_load_dwordx4 v[108:111], v1, s[8:11], s27 offen offset:3072 sc1
    buffer_load_dwordx4 v[156:159], v4, s[8:11], s28 offen offset:2816 sc1
    v_lshlrev_b32 v5, 2, v3
    v_sub_u32 v5, v2, v5
    v_mov_b32 v6, 0xf149f2ca
    v_cmp_gt_i32 vcc, 0, v5
    s_nop 1
    v_cndmask_b32 v192, 0, v6, vcc
    v_cmp_gt_i32 vcc, 1, v5
    s_nop 1
    v_cndmask_b32 v193, 0, v6, vcc
    v_cmp_gt_i32 vcc, 2, v5
    s_nop 1
    v_cndmask_b32 v194, 0, v6, vcc
    v_cmp_gt_i32 vcc, 3, v5
    s_nop 1
    v_cndmask_b32 v195, 0, v6, vcc
    v_cmp_gt_i32 vcc, 8, v5
    s_nop 1
    v_cndmask_b32 v196, 0, v6, vcc
    v_cmp_gt_i32 vcc, 9, v5
    s_nop 1
    v_cndmask_b32 v197, 0, v6, vcc
    v_cmp_gt_i32 vcc, 10, v5
    s_nop 1
    v_cndmask_b32 v198, 0, v6, vcc
    v_cmp_gt_i32 vcc, 11, v5
    s_nop 1
    v_cndmask_b32 v199, 0, v6, vcc
    v_cmp_gt_i32 vcc, 16, v5
    s_nop 1
    v_cndmask_b32 v200, 0, v6, vcc
    v_cmp_gt_i32 vcc, 17, v5
    s_nop 1
    v_cndmask_b32 v201, 0, v6, vcc
    v_cmp_gt_i32 vcc, 18, v5
    s_nop 1
    v_cndmask_b32 v202, 0, v6, vcc
    v_cmp_gt_i32 vcc, 19, v5
    s_nop 1
    v_cndmask_b32 v203, 0, v6, vcc
    v_cmp_gt_i32 vcc, 24, v5
    s_nop 1
    v_cndmask_b32 v204, 0, v6, vcc
    v_cmp_gt_i32 vcc, 25, v5
    s_nop 1
    v_cndmask_b32 v205, 0, v6, vcc
    v_cmp_gt_i32 vcc, 26, v5
    s_nop 1
    v_cndmask_b32 v206, 0, v6, vcc
    v_cmp_gt_i32 vcc, 27, v5
    s_nop 1
    v_cndmask_b32 v207, 0, v6, vcc
    s_waitcnt vmcnt(33)
    v_mfma_f32_32x32x16_bf16 v[160:175], v[64:67], v[16:19], 0
    v_mfma_f32_32x32x16_bf16 v[176:191], v[112:115], v[16:19], 0
    s_waitcnt vmcnt(30)
    v_mfma_f32_32x32x16_bf16 v[160:175], v[68:71], v[20:23], v[160:175]
    v_mfma_f32_32x32x16_bf16 v[176:191], v[116:119], v[20:23], v[176:191]
    s_waitcnt vmcnt(27)
    v_mfma_f32_32x32x16_bf16 v[160:175], v[72:75], v[24:27], v[160:175]
    v_mfma_f32_32x32x16_bf16 v[176:191], v[120:123], v[24:27], v[176:191]
    s_waitcnt vmcnt(24)
    v_mfma_f32_32x32x16_bf16 v[160:175], v[76:79], v[28:31], v[160:175]
    v_mfma_f32_32x32x16_bf16 v[176:191], v[124:127], v[28:31], v[176:191]
    s_waitcnt vmcnt(21)
    v_mfma_f32_32x32x16_bf16 v[160:175], v[80:83], v[32:35], v[160:175]
    v_mfma_f32_32x32x16_bf16 v[176:191], v[128:131], v[32:35], v[176:191]
    s_waitcnt vmcnt(18)
    v_mfma_f32_32x32x16_bf16 v[160:175], v[84:87], v[36:39], v[160:175]
    v_mfma_f32_32x32x16_bf16 v[176:191], v[132:135], v[36:39], v[176:191]
    s_waitcnt vmcnt(15)
    v_mfma_f32_32x32x16_bf16 v[160:175], v[88:91], v[40:43], v[160:175]
    v_mfma_f32_32x32x16_bf16 v[176:191], v[136:139], v[40:43], v[176:191]
    s_waitcnt vmcnt(12)
    v_mfma_f32_32x32x16_bf16 v[160:175], v[92:95], v[44:47], v[160:175]
    v_mfma_f32_32x32x16_bf16 v[176:191], v[140:143], v[44:47], v[176:191]
    s_waitcnt vmcnt(9)
    v_mfma_f32_32x32x16_bf16 v[160:175], v[96:99], v[48:51], v[160:175]
    v_mfma_f32_32x32x16_bf16 v[176:191], v[144:147], v[48:51], v[176:191]
    s_waitcnt vmcnt(6)
    v_mfma_f32_32x32x16_bf16 v[160:175], v[100:103], v[52:55], v[160:175]
    v_mfma_f32_32x32x16_bf16 v[176:191], v[148:151], v[52:55], v[176:191]
    s_waitcnt vmcnt(3)
    v_mfma_f32_32x32x16_bf16 v[160:175], v[104:107], v[56:59], v[160:175]
    v_mfma_f32_32x32x16_bf16 v[176:191], v[152:155], v[56:59], v[176:191]
    s_waitcnt vmcnt(0)
    v_mfma_f32_32x32x16_bf16 v[160:175], v[108:111], v[60:63], v[160:175]
    v_mfma_f32_32x32x16_bf16 v[176:191], v[156:159], v[60:63], v[176:191]
    s_nop 7
    s_nop 7
    v_mov_b32 v7, 0x3dd53b95
    v_fma_f32 v160, v160, v7, v192
    v_fma_f32 v161, v161, v7, v193
    v_fma_f32 v162, v162, v7, v194
    v_fma_f32 v163, v163, v7, v195
    v_fma_f32 v164, v164, v7, v196
    v_fma_f32 v165, v165, v7, v197
    v_fma_f32 v166, v166, v7, v198
    v_fma_f32 v167, v167, v7, v199
    v_fma_f32 v168, v168, v7, v200
    v_fma_f32 v169, v169, v7, v201
    v_fma_f32 v170, v170, v7, v202
    v_fma_f32 v171, v171, v7, v203
    v_fma_f32 v172, v172, v7, v204
    v_fma_f32 v173, v173, v7, v205
    v_fma_f32 v174, v174, v7, v206
    v_fma_f32 v175, v175, v7, v207
    v_mul_f32 v176, v176, v7
    v_mul_f32 v177, v177, v7
    v_mul_f32 v178, v178, v7
    v_mul_f32 v179, v179, v7
    v_max3_f32 v208, v160, v161, v162
    v_max3_f32 v208, v208, v163, v164
    v_max3_f32 v208, v208, v165, v166
    v_max3_f32 v208, v208, v167, v168
    v_max3_f32 v208, v208, v169, v170
    v_max3_f32 v208, v208, v171, v172
    v_max3_f32 v208, v208, v173, v174
    v_max3_f32 v208, v208, v175, v176
    v_max3_f32 v208, v208, v177, v178
    v_max_f32 v208, v208, v179
    v_mov_b32 v209, v208
    s_nop 1
    v_permlane32_swap_b32 v208, v209
    v_max_f32 v208, v208, v209
    v_sub_f32 v160, v160, v208
    v_sub_f32 v161, v161, v208
    v_sub_f32 v162, v162, v208
    v_sub_f32 v163, v163, v208
    v_sub_f32 v164, v164, v208
    v_sub_f32 v165, v165, v208
    v_sub_f32 v166, v166, v208
    v_sub_f32 v167, v167, v208
    v_sub_f32 v168, v168, v208
    v_sub_f32 v169, v169, v208
    v_sub_f32 v170, v170, v208
    v_sub_f32 v171, v171, v208
    v_sub_f32 v172, v172, v208
    v_sub_f32 v173, v173, v208
    v_sub_f32 v174, v174, v208
    v_sub_f32 v175, v175, v208
    v_sub_f32 v176, v176, v208
    v_sub_f32 v177, v177, v208
    v_sub_f32 v178, v178, v208
    v_sub_f32 v179, v179, v208
    v_exp_f32 v160, v160
    v_exp_f32 v161, v161
    v_exp_f32 v162, v162
    v_exp_f32 v163, v163
    v_exp_f32 v164, v164
    v_exp_f32 v165, v165
    v_exp_f32 v166, v166
    v_exp_f32 v167, v167
    v_exp_f32 v168, v168
    v_exp_f32 v169, v169
    v_exp_f32 v170, v170
    v_exp_f32 v171, v171
    v_exp_f32 v172, v172
    v_exp_f32 v173, v173
    v_exp_f32 v174, v174
    v_exp_f32 v175, v175
    v_exp_f32 v176, v176
    v_exp_f32 v177, v177
    v_exp_f32 v178, v178
    v_exp_f32 v179, v179
    s_nop 0
    v_add_f32 v210, v160, v161
    v_add_f32 v210, v210, v162
    v_add_f32 v210, v210, v163
    v_add_f32 v210, v210, v164
    v_add_f32 v210, v210, v165
    v_add_f32 v210, v210, v166
    v_add_f32 v210, v210, v167
    v_add_f32 v210, v210, v168
    v_add_f32 v210, v210, v169
    v_add_f32 v210, v210, v170
    v_add_f32 v210, v210, v171
    v_add_f32 v210, v210, v172
    v_add_f32 v210, v210, v173
    v_add_f32 v210, v210, v174
    v_add_f32 v210, v210, v175
    v_add_f32 v210, v210, v176
    v_add_f32 v210, v210, v177
    v_add_f32 v210, v210, v178
    v_add_f32 v210, v210, v179
    v_mov_b32 v209, v210
    s_nop 1
    v_permlane32_swap_b32 v210, v209
    v_add_f32 v210, v210, v209
    v_rcp_f32 v210, v210
    s_nop 0
    v_mul_f32 v160, v160, v210
    v_mul_f32 v161, v161, v210
    v_mul_f32 v162, v162, v210
    v_mul_f32 v163, v163, v210
    v_mul_f32 v164, v164, v210
    v_mul_f32 v165, v165, v210
    v_mul_f32 v166, v166, v210
    v_mul_f32 v167, v167, v210
    v_mul_f32 v168, v168, v210
    v_mul_f32 v169, v169, v210
    v_mul_f32 v170, v170, v210
    v_mul_f32 v171, v171, v210
    v_mul_f32 v172, v172, v210
    v_mul_f32 v173, v173, v210
    v_mul_f32 v174, v174, v210
    v_mul_f32 v175, v175, v210
    v_mul_f32 v176, v176, v210
    v_mul_f32 v177, v177, v210
    v_mul_f32 v178, v178, v210
    v_mul_f32 v179, v179, v210
    s_mul_i32 s25, s40, 81920
    s_mul_i32 s26, s41, 2560
    s_add_u32 s25, s25, s26
    s_add_u32 s25, s25, 214958080
    v_cvt_pk_bf16_f32 v16, v160, v161
    v_cvt_pk_bf16_f32 v17, v162, v163
    v_cvt_pk_bf16_f32 v18, v164, v165
    v_cvt_pk_bf16_f32 v19, v166, v167
    s_nop 1
    v_permlane32_swap_b32 v16, v18
    v_permlane32_swap_b32 v17, v19
    buffer_store_dwordx4 v[16:19], v1, s[8:11], s25 offen offset:512 sc1
    v_cvt_pk_bf16_f32 v20, v168, v169
    v_cvt_pk_bf16_f32 v21, v170, v171
    v_cvt_pk_bf16_f32 v22, v172, v173
    v_cvt_pk_bf16_f32 v23, v174, v175
    s_nop 1
    v_permlane32_swap_b32 v20, v22
    v_permlane32_swap_b32 v21, v23
    buffer_store_dwordx4 v[20:23], v1, s[8:11], s25 offen offset:1536 sc1
    v_cvt_pk_bf16_f32 v24, v176, v177
    v_cvt_pk_bf16_f32 v25, v178, v179
    v_lshlrev_b32 v4, 4, v2
    v_lshl_add_u32 v4, v3, 3, v4
    buffer_store_dwordx2 v[24:25], v4, s[8:11], s25 offen sc1
    s_waitcnt vmcnt(0)
    s_barrier
    s_cmp_lg_u32 s13, 0
    s_cbranch_scc1 layerb1_kernel_j_next
    s_mov_b64 exec, 1
    s_lshl_b32 s24, s40, 4
    s_add_u32 s24, s24, 30720
    v_mov_b32 v2, s24
    v_mov_b32 v3, 1
    buffer_atomic_add v3, v2, s[8:11], s48 offen sc1
    s_mov_b64 exec, -1
    s_branch layerb1_kernel_j_next
layerb1_kernel_j_b:
    s_sub_u32 s41, s41, 8
    v_lshlrev_b32 v1, 4, v0
    v_and_b32 v2, 31, v0
    v_lshrrev_b32 v3, 5, v0
    v_lshrrev_b32 v4, 3, v2
    v_mul_u32_u24 v4, 20480, v4
    v_and_b32 v5, 7, v2
    v_lshl_add_u32 v4, v5, 4, v4
    v_lshl_add_u32 v4, v3, 7, v4
    s_mul_i32 s24, s40, 1638400
    s_mul_i32 s25, s41, 163840
    s_add_u32 s24, s24, s25
    s_mul_i32 s25, s13, 5120
    s_add_u32 s24, s24, s25
    s_add_u32 s24, s24, 103809024
    s_add_u32 s28, s24, 81920
    s_mul_i32 s25, s40, 81920
    s_mul_i32 s26, s13, 20480
    s_add_u32 s25, s25, s26
    s_add_u32 s25, s25, 214958080
    v_mul_u32_u24 v6, 1280, v2
    v_lshl_add_u32 v6, v3, 4, v6
    s_mul_i32 s26, s40, 40960
    s_lshl_b32 s27, s41, 7
    s_add_u32 s26, s26, s27
    s_lshl_b32 s27, s13, 5
    s_add_u32 s26, s26, s27
    s_add_u32 s27, s26, 226492416
    buffer_load_dwordx4 v[8:11], v6, s[8:11], s27 offen
    buffer_load_dwordx4 a[160:163], v1, s[8:11], s25 offen offset:0 sc1
    buffer_load_dwordx4 a[0:3], v4, s[8:11], s24 offen offset:0 sc1
    buffer_load_dwordx4 a[80:83], v4, s[8:11], s28 offen offset:0 sc1
    buffer_load_dwordx4 a[164:167], v1, s[8:11], s25 offen offset:1024 sc1
    buffer_load_dwordx4 a[4:7], v4, s[8:11], s24 offen offset:256 sc1
    buffer_load_dwordx4 a[84:87], v4, s[8:11], s28 offen offset:256 sc1
    buffer_load_dwordx4 a[168:171], v1, s[8:11], s25 offen offset:2048 sc1
    buffer_load_dwordx4 a[8:11], v4, s[8:11], s24 offen offset:512 sc1
    buffer_load_dwordx4 a[88:91], v4, s[8:11], s28 offen offset:512 sc1
    buffer_load_dwordx4 a[172:175], v1, s[8:11], s25 offen offset:3072 sc1
    buffer_load_dwordx4 a[12:15], v4, s[8:11], s24 offen offset:768 sc1
    buffer_load_dwordx4 a[92:95], v4, s[8:11], s28 offen offset:768 sc1
    s_add_u32 s25, s25, 4096
    buffer_load_dwordx4 a[176:179], v1, s[8:11], s25 offen offset:0 sc1
    buffer_load_dwordx4 a[16:19], v4, s[8:11], s24 offen offset:1024 sc1
    buffer_load_dwordx4 a[96:99], v4, s[8:11], s28 offen offset:1024 sc1
    buffer_load_dwordx4 a[180:183], v1, s[8:11], s25 offen offset:1024 sc1
    buffer_load_dwordx4 a[20:23], v4, s[8:11], s24 offen offset:1280 sc1
    buffer_load_dwordx4 a[100:103], v4, s[8:11], s28 offen offset:1280 sc1
    buffer_load_dwordx4 a[184:187], v1, s[8:11], s25 offen offset:2048 sc1
    buffer_load_dwordx4 a[24:27], v4, s[8:11], s24 offen offset:1536 sc1
    buffer_load_dwordx4 a[104:107], v4, s[8:11], s28 offen offset:1536 sc1
    buffer_load_dwordx4 a[188:191], v1, s[8:11], s25 offen offset:3072 sc1
    buffer_load_dwordx4 a[28:31], v4, s[8:11], s24 offen offset:1792 sc1
    buffer_load_dwordx4 a[108:111], v4, s[8:11], s28 offen offset:1792 sc1
    s_add_u32 s25, s25, 4096
    buffer_load_dwordx4 a[192:195], v1, s[8:11], s25 offen offset:0 sc1
    buffer_load_dwordx4 a[32:35], v4, s[8:11], s24 offen offset:2048 sc1
    buffer_load_dwordx4 a[112:115], v4, s[8:11], s28 offen offset:2048 sc1
    buffer_load_dwordx4 a[196:199], v1, s[8:11], s25 offen offset:1024 sc1
    buffer_load_dwordx4 a[36:39], v4, s[8:11], s24 offen offset:2304 sc1
    buffer_load_dwordx4 a[116:119], v4, s[8:11], s28 offen offset:2304 sc1
    buffer_load_dwordx4 a[200:203], v1, s[8:11], s25 offen offset:2048 sc1
    buffer_load_dwordx4 a[40:43], v4, s[8:11], s24 offen offset:2560 sc1
    buffer_load_dwordx4 a[120:123], v4, s[8:11], s28 offen offset:2560 sc1
    buffer_load_dwordx4 a[204:207], v1, s[8:11], s25 offen offset:3072 sc1
    buffer_load_dwordx4 a[44:47], v4, s[8:11], s24 offen offset:2816 sc1
    buffer_load_dwordx4 a[124:127], v4, s[8:11], s28 offen offset:2816 sc1
    s_add_u32 s25, s25, 4096
    buffer_load_dwordx4 a[208:211], v1, s[8:11], s25 offen offset:0 sc1
    buffer_load_dwordx4 a[48:51], v4, s[8:11], s24 offen offset:3072 sc1
    buffer_load_dwordx4 a[128:131], v4, s[8:11], s28 offen offset:3072 sc1
    buffer_load_dwordx4 a[212:215], v1, s[8:11], s25 offen offset:1024 sc1
    buffer_load_dwordx4 a[52:55], v4, s[8:11], s24 offen offset:3328 sc1
    buffer_load_dwordx4 a[132:135], v4, s[8:11], s28 offen offset:3328 sc1
    buffer_load_dwordx4 a[216:219], v1, s[8:11], s25 offen offset:2048 sc1
    buffer_load_dwordx4 a[56:59], v4, s[8:11], s24 offen offset:3584 sc1
    buffer_load_dwordx4 a[136:139], v4, s[8:11], s28 offen offset:3584 sc1
    buffer_load_dwordx4 a[220:223], v1, s[8:11], s25 offen offset:3072 sc1
    buffer_load_dwordx4 a[60:63], v4, s[8:11], s24 offen offset:3840 sc1
    buffer_load_dwordx4 a[140:143], v4, s[8:11], s28 offen offset:3840 sc1
    s_add_u32 s25, s25, 4096
    s_add_u32 s24, s24, 4096
    s_add_u32 s28, s28, 4096
    buffer_load_dwordx4 a[224:227], v1, s[8:11], s25 offen offset:0 sc1
    buffer_load_dwordx4 a[64:67], v4, s[8:11], s24 offen offset:0 sc1
    buffer_load_dwordx4 a[144:147], v4, s[8:11], s28 offen offset:0 sc1
    buffer_load_dwordx4 a[228:231], v1, s[8:11], s25 offen offset:1024 sc1
    buffer_load_dwordx4 a[68:71], v4, s[8:11], s24 offen offset:256 sc1
    buffer_load_dwordx4 a[148:151], v4, s[8:11], s28 offen offset:256 sc1
    buffer_load_dwordx4 a[232:235], v1, s[8:11], s25 offen offset:2048 sc1
    buffer_load_dwordx4 a[72:75], v4, s[8:11], s24 offen offset:512 sc1
    buffer_load_dwordx4 a[152:155], v4, s[8:11], s28 offen offset:512 sc1
    buffer_load_dwordx4 a[236:239], v1, s[8:11], s25 offen offset:3072 sc1
    buffer_load_dwordx4 a[76:79], v4, s[8:11], s24 offen offset:768 sc1
    buffer_load_dwordx4 a[156:159], v4, s[8:11], s28 offen offset:768 sc1
    s_waitcnt vmcnt(57)
    v_mfma_f32_32x32x16_bf16 v[16:31], a[0:3], a[160:163], 0
    v_mfma_f32_32x32x16_bf16 v[32:47], a[80:83], a[160:163], 0
    s_waitcnt vmcnt(54)
    v_mfma_f32_32x32x16_bf16 v[16:31], a[4:7], a[164:167], v[16:31]
    v_mfma_f32_32x32x16_bf16 v[32:47], a[84:87], a[164:167], v[32:47]
    s_waitcnt vmcnt(51)
    v_mfma_f32_32x32x16_bf16 v[16:31], a[8:11], a[168:171], v[16:31]
    v_mfma_f32_32x32x16_bf16 v[32:47], a[88:91], a[168:171], v[32:47]
    s_waitcnt vmcnt(48)
    v_mfma_f32_32x32x16_bf16 v[16:31], a[12:15], a[172:175], v[16:31]
    v_mfma_f32_32x32x16_bf16 v[32:47], a[92:95], a[172:175], v[32:47]
    s_waitcnt vmcnt(45)
    v_mfma_f32_32x32x16_bf16 v[16:31], a[16:19], a[176:179], v[16:31]
    v_mfma_f32_32x32x16_bf16 v[32:47], a[96:99], a[176:179], v[32:47]
    s_waitcnt vmcnt(42)
    v_mfma_f32_32x32x16_bf16 v[16:31], a[20:23], a[180:183], v[16:31]
    v_mfma_f32_32x32x16_bf16 v[32:47], a[100:103], a[180:183], v[32:47]
    s_waitcnt vmcnt(39)
    v_mfma_f32_32x32x16_bf16 v[16:31], a[24:27], a[184:187], v[16:31]
    v_mfma_f32_32x32x16_bf16 v[32:47], a[104:107], a[184:187], v[32:47]
    s_waitcnt vmcnt(36)
    v_mfma_f32_32x32x16_bf16 v[16:31], a[28:31], a[188:191], v[16:31]
    v_mfma_f32_32x32x16_bf16 v[32:47], a[108:111], a[188:191], v[32:47]
    s_waitcnt vmcnt(33)
    v_mfma_f32_32x32x16_bf16 v[16:31], a[32:35], a[192:195], v[16:31]
    v_mfma_f32_32x32x16_bf16 v[32:47], a[112:115], a[192:195], v[32:47]
    s_waitcnt vmcnt(30)
    v_mfma_f32_32x32x16_bf16 v[16:31], a[36:39], a[196:199], v[16:31]
    v_mfma_f32_32x32x16_bf16 v[32:47], a[116:119], a[196:199], v[32:47]
    s_waitcnt vmcnt(27)
    v_mfma_f32_32x32x16_bf16 v[16:31], a[40:43], a[200:203], v[16:31]
    v_mfma_f32_32x32x16_bf16 v[32:47], a[120:123], a[200:203], v[32:47]
    s_waitcnt vmcnt(24)
    v_mfma_f32_32x32x16_bf16 v[16:31], a[44:47], a[204:207], v[16:31]
    v_mfma_f32_32x32x16_bf16 v[32:47], a[124:127], a[204:207], v[32:47]
    s_waitcnt vmcnt(21)
    v_mfma_f32_32x32x16_bf16 v[16:31], a[48:51], a[208:211], v[16:31]
    v_mfma_f32_32x32x16_bf16 v[32:47], a[128:131], a[208:211], v[32:47]
    s_waitcnt vmcnt(18)
    v_mfma_f32_32x32x16_bf16 v[16:31], a[52:55], a[212:215], v[16:31]
    v_mfma_f32_32x32x16_bf16 v[32:47], a[132:135], a[212:215], v[32:47]
    s_waitcnt vmcnt(15)
    v_mfma_f32_32x32x16_bf16 v[16:31], a[56:59], a[216:219], v[16:31]
    v_mfma_f32_32x32x16_bf16 v[32:47], a[136:139], a[216:219], v[32:47]
    s_waitcnt vmcnt(12)
    v_mfma_f32_32x32x16_bf16 v[16:31], a[60:63], a[220:223], v[16:31]
    v_mfma_f32_32x32x16_bf16 v[32:47], a[140:143], a[220:223], v[32:47]
    s_waitcnt vmcnt(9)
    v_mfma_f32_32x32x16_bf16 v[16:31], a[64:67], a[224:227], v[16:31]
    v_mfma_f32_32x32x16_bf16 v[32:47], a[144:147], a[224:227], v[32:47]
    s_waitcnt vmcnt(6)
    v_mfma_f32_32x32x16_bf16 v[16:31], a[68:71], a[228:231], v[16:31]
    v_mfma_f32_32x32x16_bf16 v[32:47], a[148:151], a[228:231], v[32:47]
    s_waitcnt vmcnt(3)
    v_mfma_f32_32x32x16_bf16 v[16:31], a[72:75], a[232:235], v[16:31]
    v_mfma_f32_32x32x16_bf16 v[32:47], a[152:155], a[232:235], v[32:47]
    s_waitcnt vmcnt(0)
    v_mfma_f32_32x32x16_bf16 v[16:31], a[76:79], a[236:239], v[16:31]
    v_mfma_f32_32x32x16_bf16 v[32:47], a[156:159], a[236:239], v[32:47]
    s_lshl_b32 s27, s13, 11
    v_add_u32 v7, s27, v1
    s_nop 7
    s_nop 7
    ds_write_b128 v7, v[16:19] offset:0
    ds_write_b128 v7, v[20:23] offset:1024
    ds_write_b128 v7, v[24:27] offset:8192
    ds_write_b128 v7, v[28:31] offset:9216
    ds_write_b128 v7, v[32:35] offset:16384
    ds_write_b128 v7, v[36:39] offset:17408
    ds_write_b128 v7, v[40:43] offset:24576
    ds_write_b128 v7, v[44:47] offset:25600
    s_waitcnt lgkmcnt(0)
    s_barrier
    s_lshl_b32 s27, s13, 13
    v_add_u32 v7, s27, v1
    ds_read_b128 v[48:51], v7 offset:0
    ds_read_b128 v[52:55], v7 offset:1024
    ds_read_b128 v[56:59], v7 offset:2048
    ds_read_b128 v[60:63], v7 offset:3072
    ds_read_b128 v[64:67], v7 offset:4096
    ds_read_b128 v[68:71], v7 offset:5120
    ds_read_b128 v[72:75], v7 offset:6144
    ds_read_b128 v[76:79], v7 offset:7168
    s_waitcnt lgkmcnt(4)
    v_add_f32 v48, v48, v56
    v_add_f32 v49, v49, v57
    v_add_f32 v50, v50, v58
    v_add_f32 v51, v51, v59
    v_add_f32 v52, v52, v60
    v_add_f32 v53, v53, v61
    v_add_f32 v54, v54, v62
    v_add_f32 v55, v55, v63
    s_waitcnt lgkmcnt(0)
    v_add_f32 v64, v64, v72
    v_add_f32 v65, v65, v73
    v_add_f32 v66, v66, v74
    v_add_f32 v67, v67, v75
    v_add_f32 v68, v68, v76
    v_add_f32 v69, v69, v77
    v_add_f32 v70, v70, v78
    v_add_f32 v71, v71, v79
    v_add_f32 v48, v48, v64
    v_add_f32 v49, v49, v65
    v_add_f32 v50, v50, v66
    v_add_f32 v51, v51, v67
    v_add_f32 v52, v52, v68
    v_add_f32 v53, v53, v69
    v_add_f32 v54, v54, v70
    v_add_f32 v55, v55, v71
    v_cvt_pk_bf16_f32 v16, v48, v49
    v_cvt_pk_bf16_f32 v17, v50, v51
    v_cvt_pk_bf16_f32 v18, v52, v53
    v_cvt_pk_bf16_f32 v19, v54, v55
    s_nop 1
    v_permlane32_swap_b32 v16, v18
    v_permlane32_swap_b32 v17, v19
    s_nop 1
    v_lshlrev_b32 v48, 16, v16
    v_and_b32 v49, 0xffff0000, v16
    v_lshlrev_b32 v50, 16, v8
    v_and_b32 v51, 0xffff0000, v8
    v_add_f32 v48, v48, v50
    v_add_f32 v49, v49, v51
    v_cvt_pk_bf16_f32 v16, v48, v49
    v_lshlrev_b32 v48, 16, v17
    v_and_b32 v49, 0xffff0000, v17
    v_lshlrev_b32 v50, 16, v9
    v_and_b32 v51, 0xffff0000, v9
    v_add_f32 v48, v48, v50
    v_add_f32 v49, v49, v51
    v_cvt_pk_bf16_f32 v17, v48, v49
    v_lshlrev_b32 v48, 16, v18
    v_and_b32 v49, 0xffff0000, v18
    v_lshlrev_b32 v50, 16, v10
    v_and_b32 v51, 0xffff0000, v10
    v_add_f32 v48, v48, v50
    v_add_f32 v49, v49, v51
    v_cvt_pk_bf16_f32 v18, v48, v49
    v_lshlrev_b32 v48, 16, v19
    v_and_b32 v49, 0xffff0000, v19
    v_lshlrev_b32 v50, 16, v11
    v_and_b32 v51, 0xffff0000, v11
    v_add_f32 v48, v48, v50
    v_add_f32 v49, v49, v51
    v_cvt_pk_bf16_f32 v19, v48, v49
    buffer_store_dwordx4 v[16:19], v6, s[84:87], s26 offen
    s_branch layerb1_kernel_j_next
layerb1_kernel_j_giveup:
    s_mov_b64 exec, -1
    v_mov_b32 v2, 0
    v_mov_b32 v3, -1
    ds_write_b32 v2, v3 offset:32768
    s_waitcnt lgkmcnt(0)
    s_barrier
    s_branch layerb1_kernel_bail
layerb1_kernel_j_done:
    s_branch layerb1_kernel_end
layerb1_kernel_bail:
    s_mov_b64 exec, 1
    s_load_dwordx2 s[6:7], s[0:1], 88
    s_waitcnt lgkmcnt(0)
    s_mov_b32 s24, s6
    s_mov_b32 s25, s7
    s_mov_b32 s26, 256
    s_mov_b32 s27, 0x00020000
    v_mov_b32 v1, 0xdead
    v_mov_b32 v2, s14
    v_mov_b32 v3, 0
    buffer_store_dword v1, v3, s[24:27], 0 offen
    buffer_store_dword v2, v3, s[24:27], 0 offen offset:4
layerb1_kernel_end:
layerb1_kernel_end0:
    s_endpgm
.section .rodata,"a"
.p2align 6
.amdhsa_kernel layerb1_kernel
  .amdhsa_next_free_vgpr 512
  .amdhsa_next_free_sgpr 100
  .amdhsa_accum_offset 256
  .amdhsa_group_segment_fixed_size 0
  .amdhsa_kernarg_size 104
  .amdhsa_user_sgpr_count 2
  .amdhsa_user_sgpr_kernarg_segment_ptr 1
  .amdhsa_system_sgpr_workgroup_id_x 1
.end_amdhsa_kernel
.text
.globl ln_a2_kernel
.p2align 8
.type ln_a2_kernel,@function
ln_a2_kernel:
    v_lshrrev_b32 v1, 6, v0
    v_and_b32 v2, 63, v0
    s_nop 0
    v_readfirstlane_b32 s3, v1
    s_lshl_b32 s4, s2, 2
    s_add_u32 s4, s4, s3
    s_cmp_ge_u32 s4, 2048
    s_cbranch_scc1 ln_a2_kernel_end
    s_load_dwordx2 s[6:7], s[0:1], 96
    s_load_dwordx2 s[12:13], s[0:1], 96
    s_waitcnt lgkmcnt(0)
    s_add_u32 s8, s6, 247463936
    s_addc_u32 s9, s7, 0
    s_mov_b32 s10, 2621440
    s_mov_b32 s11, 0x00020000
    s_add_u32 s16, s12, 223346688
    s_addc_u32 s17, s13, 0
    s_mov_b32 s18, 2621440
    s_mov_b32 s19, 0x00020000
    s_mul_i32 s5, s4, 1280
    v_lshlrev_b32 v3, 2, v2
    v_add_u32 v3, s5, v3
    buffer_load_dword v4, v3, s[8:11], 0 offen offset:0
    buffer_load_dword v5, v3, s[8:11], 0 offen offset:256
    buffer_load_dword v6, v3, s[8:11], 0 offen offset:512
    buffer_load_dword v7, v3, s[8:11], 0 offen offset:768
    buffer_load_dword v8, v3, s[8:11], 0 offen offset:1024
    s_waitcnt vmcnt(0)
    v_lshlrev_b32 v10, 16, v4
    v_and_b32 v11, 0xffff0000, v4
    v_lshlrev_b32 v12, 16, v5
    v_and_b32 v13, 0xffff0000, v5
    v_lshlrev_b32 v14, 16, v6
    v_and_b32 v15, 0xffff0000, v6
    v_lshlrev_b32 v16, 16, v7
    v_and_b32 v17, 0xffff0000, v7
    v_lshlrev_b32 v18, 16, v8
    v_and_b32 v19, 0xffff0000, v8
    v_add_f32 v20, v10, v11
    v_add_f32 v20, v20, v12
    v_add_f32 v20, v20, v13
    v_add_f32 v20, v20, v14
    v_add_f32 v20, v20, v15
    v_add_f32 v20, v20, v16
    v_add_f32 v20, v20, v17
    v_add_f32 v20, v20, v18
    v_add_f32 v20, v20, v19
    s_nop 1
    v_add_f32 v21, v20, v20 quad_perm:[1,0,3,2] row_mask:0xf bank_mask:0xf
    s_nop 1
    v_add_f32 v21, v21, v21 quad_perm:[2,3,0,1] row_mask:0xf bank_mask:0xf
    s_nop 1
    v_add_f32 v21, v21, v21 row_half_mirror row_mask:0xf bank_mask:0xf
    s_nop 1
    v_add_f32 v21, v21, v21 row_mirror row_mask:0xf bank_mask:0xf
    s_nop 1
    v_readlane_b32 s24, v21, 0
    v_readlane_b32 s25, v21, 16
    v_readlane_b32 s26, v21, 32
    v_readlane_b32 s27, v21, 48
    s_nop 1
    v_mov_b32 v20, s24
    v_add_f32 v20, s25, v20
    v_add_f32 v20, s26, v20
    v_add_f32 v20, s27, v20
    v_mul_f32 v20, 0.0015625, v20
    v_sub_f32 v10, v10, v20
    v_sub_f32 v11, v11, v20
    v_sub_f32 v12, v12, v20
    v_sub_f32 v13, v13, v20
    v_sub_f32 v14, v14, v20
    v_sub_f32 v15, v15, v20
    v_sub_f32 v16, v16, v20
    v_sub_f32 v17, v17, v20
    v_sub_f32 v18, v18, v20
    v_sub_f32 v19, v19, v20
    v_mul_f32 v21, v10, v10
    v_fmac_f32 v21, v11, v11
    v_fmac_f32 v21, v12, v12
    v_fmac_f32 v21, v13, v13
    v_fmac_f32 v21, v14, v14
    v_fmac_f32 v21, v15, v15
    v_fmac_f32 v21, v16, v16
    v_fmac_f32 v21, v17, v17
    v_fmac_f32 v21, v18, v18
    v_fmac_f32 v21, v19, v19
    s_nop 1
    v_add_f32 v22, v21, v21 quad_perm:[1,0,3,2] row_mask:0xf bank_mask:0xf
    s_nop 1
    v_add_f32 v22, v22, v22 quad_perm:[2,3,0,1] row_mask:0xf bank_mask:0xf
    s_nop 1
    v_add_f32 v22, v22, v22 row_half_mirror row_mask:0xf bank_mask:0xf
    s_nop 1
    v_add_f32 v22, v22, v22 row_mirror row_mask:0xf bank_mask:0xf
    s_nop 1
    v_readlane_b32 s24, v22, 0
    v_readlane_b32 s25, v22, 16
    v_readlane_b32 s26, v22, 32
    v_readlane_b32 s27, v22, 48
    s_nop 1
    v_mov_b32 v21, s24
    v_add_f32 v21, s25, v21
    v_add_f32 v21, s26, v21
    v_add_f32 v21, s27, v21
    v_mov_b32 v22, 0x3727c5ac
    v_fmac_f32 v22, 0.0015625, v21
    v_rsq_f32 v22, v22
    s_nop 0
    v_mul_f32 v10, v10, v22
    v_mul_f32 v11, v11, v22
    v_mul_f32 v12, v12, v22
    v_mul_f32 v13, v13, v22
    v_mul_f32 v14, v14, v22
    v_mul_f32 v15, v15, v22
    v_mul_f32 v16, v16, v22
    v_mul_f32 v17, v17, v22
    v_mul_f32 v18, v18, v22
    v_mul_f32 v19, v19, v22
    v_cvt_pk_bf16_f32 v4, v10, v11
    v_cvt_pk_bf16_f32 v5, v12, v13
    v_cvt_pk_bf16_f32 v6, v14, v15
    v_cvt_pk_bf16_f32 v7, v16, v17
    v_cvt_pk_bf16_f32 v8, v18, v19
    buffer_store_dword v4, v3, s[16:19], 0 offen offset:0
    buffer_store_dword v5, v3, s[16:19], 0 offen offset:256
    buffer_store_dword v6, v3, s[16:19], 0 offen offset:512
    buffer_store_dword v7, v3, s[16:19], 0 offen offset:768
    buffer_store_dword v8, v3, s[16:19], 0 offen offset:1024
ln_a2_kernel_end:
    s_endpgm
.section .rodata,"a"
.p2align 6
.amdhsa_kernel ln_a2_kernel
  .amdhsa_next_free_vgpr 32
  .amdhsa_next_free_sgpr 40
  .amdhsa_accum_offset 32
  .amdhsa_group_segment_fixed_size 0
  .amdhsa_kernarg_size 104
  .amdhsa_user_sgpr_count 2
  .amdhsa_user_sgpr_kernarg_segment_ptr 1
  .amdhsa_system_sgpr_workgroup_id_x 1
.end_amdhsa_kernel
.text
.globl kvz_a2_kernel
.p2align 8
.type kvz_a2_kernel,@function
kvz_a2_kernel:
    v_lshrrev_b32 v1, 6, v0
    v_and_b32 v2, 63, v0
    s_nop 0
    v_readfirstlane_b32 s3, v1
    s_lshl_b32 s4, s2, 2
    s_add_u32 s4, s4, s3
    s_cmp_ge_u32 s4, 512
    s_cbranch_scc1 kvz_a2_kernel_end
    s_load_dwordx2 s[6:7], s[0:1], 96
    s_waitcnt lgkmcnt(0)
    s_mov_b32 s8, s6
    s_mov_b32 s9, s7
    s_mov_b32 s10, 268435456
    s_mov_b32 s11, 0x00020000
    s_lshr_b32 s5, s4, 4
    s_and_b32 s12, s4, 15
    s_mul_i32 s13, s5, 20
    v_and_b32 v3, 15, v2
    v_lshrrev_b32 v4, 4, v2
    s_lshl_b32 s14, s12, 7
    v_lshlrev_b32 v5, 3, v4
    v_add_u32 v5, s14, v5
    v_add_u32 v6, 0, v3
    v_min_u32 v8, 19, v6
    v_add_u32 v8, s13, v8
    v_lshlrev_b32 v8, 11, v8
    v_add_u32 v8, v8, v5
    v_lshlrev_b32 v8, 1, v8
    v_add_u32 v8, 232783872, v8
    v_add_u32 v10, 2621440, v8
    v_add_u32 v7, 16, v3
    v_min_u32 v9, 19, v7
    v_add_u32 v9, s13, v9
    v_lshlrev_b32 v9, 11, v9
    v_add_u32 v9, v9, v5
    v_lshlrev_b32 v9, 1, v9
    v_add_u32 v9, 232783872, v9
    v_add_u32 v11, 2621440, v9
    v_accvgpr_write_b32 a0, 0
    v_accvgpr_write_b32 a1, 0
    v_accvgpr_write_b32 a2, 0
    v_accvgpr_write_b32 a3, 0
    v_accvgpr_write_b32 a4, 0
    v_accvgpr_write_b32 a5, 0
    v_accvgpr_write_b32 a6, 0
    v_accvgpr_write_b32 a7, 0
    v_accvgpr_write_b32 a8, 0
    v_accvgpr_write_b32 a9, 0
    v_accvgpr_write_b32 a10, 0
    v_accvgpr_write_b32 a11, 0
    v_accvgpr_write_b32 a12, 0
    v_accvgpr_write_b32 a13, 0
    v_accvgpr_write_b32 a14, 0
    v_accvgpr_write_b32 a15, 0
    v_cmp_gt_u32 s[16:17], 20, v7
    v_cmp_eq_u32 s[18:19], 20, v7
    buffer_load_dwordx4 v[16:19], v8, s[8:11], 0 offen offset:0
    buffer_load_dwordx4 v[24:27], v10, s[8:11], 0 offen offset:0
    buffer_load_dwordx4 v[20:23], v9, s[8:11], 0 offen offset:0
    buffer_load_dwordx4 v[28:31], v11, s[8:11], 0 offen offset:0
    s_waitcnt vmcnt(0)
    v_lshlrev_b32 v32, 16, v16
    v_and_b32 v33, 0xffff0000, v16
    v_mul_f32 v36, 1.4426950408889634, v32
    v_exp_f32 v36, v36
    v_add_f32 v34, 1.0, v32
    v_cmp_lt_f32 vcc, 0, v32
    s_nop 1
    v_cndmask_b32 v34, v36, v34, vcc
    v_add_f32 v34, 0x358637bd, v34
    v_mul_f32 v36, 1.4426950408889634, v33
    v_exp_f32 v36, v36
    v_add_f32 v35, 1.0, v33
    v_cmp_lt_f32 vcc, 0, v33
    s_nop 1
    v_cndmask_b32 v35, v36, v35, vcc
    v_add_f32 v35, 0x358637bd, v35
    v_cvt_pk_bf16_f32 v16, v34, v35
    v_lshlrev_b32 v32, 16, v17
    v_and_b32 v33, 0xffff0000, v17
    v_mul_f32 v36, 1.4426950408889634, v32
    v_exp_f32 v36, v36
    v_add_f32 v34, 1.0, v32
    v_cmp_lt_f32 vcc, 0, v32
    s_nop 1
    v_cndmask_b32 v34, v36, v34, vcc
    v_add_f32 v34, 0x358637bd, v34
    v_mul_f32 v36, 1.4426950408889634, v33
    v_exp_f32 v36, v36
    v_add_f32 v35, 1.0, v33
    v_cmp_lt_f32 vcc, 0, v33
    s_nop 1
    v_cndmask_b32 v35, v36, v35, vcc
    v_add_f32 v35, 0x358637bd, v35
    v_cvt_pk_bf16_f32 v17, v34, v35
    v_lshlrev_b32 v32, 16, v18
    v_and_b32 v33, 0xffff0000, v18
    v_mul_f32 v36, 1.4426950408889634, v32
    v_exp_f32 v36, v36
    v_add_f32 v34, 1.0, v32
    v_cmp_lt_f32 vcc, 0, v32
    s_nop 1
    v_cndmask_b32 v34, v36, v34, vcc
    v_add_f32 v34, 0x358637bd, v34
    v_mul_f32 v36, 1.4426950408889634, v33
    v_exp_f32 v36, v36
    v_add_f32 v35, 1.0, v33
    v_cmp_lt_f32 vcc, 0, v33
    s_nop 1
    v_cndmask_b32 v35, v36, v35, vcc
    v_add_f32 v35, 0x358637bd, v35
    v_cvt_pk_bf16_f32 v18, v34, v35
    v_lshlrev_b32 v32, 16, v19
    v_and_b32 v33, 0xffff0000, v19
    v_mul_f32 v36, 1.4426950408889634, v32
    v_exp_f32 v36, v36
    v_add_f32 v34, 1.0, v32
    v_cmp_lt_f32 vcc, 0, v32
    s_nop 1
    v_cndmask_b32 v34, v36, v34, vcc
    v_add_f32 v34, 0x358637bd, v34
    v_mul_f32 v36, 1.4426950408889634, v33
    v_exp_f32 v36, v36
    v_add_f32 v35, 1.0, v33
    v_cmp_lt_f32 vcc, 0, v33
    s_nop 1
    v_cndmask_b32 v35, v36, v35, vcc
    v_add_f32 v35, 0x358637bd, v35
    v_cvt_pk_bf16_f32 v19, v34, v35
    v_lshlrev_b32 v32, 16, v20
    v_and_b32 v33, 0xffff0000, v20
    v_mul_f32 v36, 1.4426950408889634, v32
    v_exp_f32 v36, v36
    v_add_f32 v34, 1.0, v32
    v_cmp_lt_f32 vcc, 0, v32
    s_nop 1
    v_cndmask_b32 v34, v36, v34, vcc
    v_add_f32 v34, 0x358637bd, v34
    v_mul_f32 v36, 1.4426950408889634, v33
    v_exp_f32 v36, v36
    v_add_f32 v35, 1.0, v33
    v_cmp_lt_f32 vcc, 0, v33
    s_nop 1
    v_cndmask_b32 v35, v36, v35, vcc
    v_add_f32 v35, 0x358637bd, v35
    v_cvt_pk_bf16_f32 v20, v34, v35
    v_lshlrev_b32 v32, 16, v21
    v_and_b32 v33, 0xffff0000, v21
    v_mul_f32 v36, 1.4426950408889634, v32
    v_exp_f32 v36, v36
    v_add_f32 v34, 1.0, v32
    v_cmp_lt_f32 vcc, 0, v32
    s_nop 1
    v_cndmask_b32 v34, v36, v34, vcc
    v_add_f32 v34, 0x358637bd, v34
    v_mul_f32 v36, 1.4426950408889634, v33
    v_exp_f32 v36, v36
    v_add_f32 v35, 1.0, v33
    v_cmp_lt_f32 vcc, 0, v33
    s_nop 1
    v_cndmask_b32 v35, v36, v35, vcc
    v_add_f32 v35, 0x358637bd, v35
    v_cvt_pk_bf16_f32 v21, v34, v35
    v_lshlrev_b32 v32, 16, v22
    v_and_b32 v33, 0xffff0000, v22
    v_mul_f32 v36, 1.4426950408889634, v32
    v_exp_f32 v36, v36
    v_add_f32 v34, 1.0, v32
    v_cmp_lt_f32 vcc, 0, v32
    s_nop 1
    v_cndmask_b32 v34, v36, v34, vcc
    v_add_f32 v34, 0x358637bd, v34
    v_mul_f32 v36, 1.4426950408889634, v33
    v_exp_f32 v36, v36
    v_add_f32 v35, 1.0, v33
    v_cmp_lt_f32 vcc, 0, v33
    s_nop 1
    v_cndmask_b32 v35, v36, v35, vcc
    v_add_f32 v35, 0x358637bd, v35
    v_cvt_pk_bf16_f32 v22, v34, v35
    v_lshlrev_b32 v32, 16, v23
    v_and_b32 v33, 0xffff0000, v23
    v_mul_f32 v36, 1.4426950408889634, v32
    v_exp_f32 v36, v36
    v_add_f32 v34, 1.0, v32
    v_cmp_lt_f32 vcc, 0, v32
    s_nop 1
    v_cndmask_b32 v34, v36, v34, vcc
    v_add_f32 v34, 0x358637bd, v34
    v_mul_f32 v36, 1.4426950408889634, v33
    v_exp_f32 v36, v36
    v_add_f32 v35, 1.0, v33
    v_cmp_lt_f32 vcc, 0, v33
    s_nop 1
    v_cndmask_b32 v35, v36, v35, vcc
    v_add_f32 v35, 0x358637bd, v35
    v_cvt_pk_bf16_f32 v23, v34, v35
    v_mov_b32 v37, 0x3f803f80
    v_cndmask_b32 v20, 0, v20, s[16:17]
    v_cndmask_b32 v28, 0, v28, s[16:17]
    v_cndmask_b32 v28, v28, v37, s[18:19]
    v_cndmask_b32 v21, 0, v21, s[16:17]
    v_cndmask_b32 v29, 0, v29, s[16:17]
    v_cndmask_b32 v29, v29, v37, s[18:19]
    v_cndmask_b32 v22, 0, v22, s[16:17]
    v_cndmask_b32 v30, 0, v30, s[16:17]
    v_cndmask_b32 v30, v30, v37, s[18:19]
    v_cndmask_b32 v23, 0, v23, s[16:17]
    v_cndmask_b32 v31, 0, v31, s[16:17]
    v_cndmask_b32 v31, v31, v37, s[18:19]
    s_nop 1
    v_mfma_f32_16x16x32_bf16 a[0:3], v[24:27], v[16:19], a[0:3]
    v_mfma_f32_16x16x32_bf16 a[4:7], v[24:27], v[20:23], a[4:7]
    v_mfma_f32_16x16x32_bf16 a[8:11], v[28:31], v[16:19], a[8:11]
    v_mfma_f32_16x16x32_bf16 a[12:15], v[28:31], v[20:23], a[12:15]
    buffer_load_dwordx4 v[16:19], v8, s[8:11], 0 offen offset:64
    buffer_load_dwordx4 v[24:27], v10, s[8:11], 0 offen offset:64
    buffer_load_dwordx4 v[20:23], v9, s[8:11], 0 offen offset:64
    buffer_load_dwordx4 v[28:31], v11, s[8:11], 0 offen offset:64
    s_waitcnt vmcnt(0)
    v_lshlrev_b32 v32, 16, v16
    v_and_b32 v33, 0xffff0000, v16
    v_mul_f32 v36, 1.4426950408889634, v32
    v_exp_f32 v36, v36
    v_add_f32 v34, 1.0, v32
    v_cmp_lt_f32 vcc, 0, v32
    s_nop 1
    v_cndmask_b32 v34, v36, v34, vcc
    v_add_f32 v34, 0x358637bd, v34
    v_mul_f32 v36, 1.4426950408889634, v33
    v_exp_f32 v36, v36
    v_add_f32 v35, 1.0, v33
    v_cmp_lt_f32 vcc, 0, v33
    s_nop 1
    v_cndmask_b32 v35, v36, v35, vcc
    v_add_f32 v35, 0x358637bd, v35
    v_cvt_pk_bf16_f32 v16, v34, v35
    v_lshlrev_b32 v32, 16, v17
    v_and_b32 v33, 0xffff0000, v17
    v_mul_f32 v36, 1.4426950408889634, v32
    v_exp_f32 v36, v36
    v_add_f32 v34, 1.0, v32
    v_cmp_lt_f32 vcc, 0, v32
    s_nop 1
    v_cndmask_b32 v34, v36, v34, vcc
    v_add_f32 v34, 0x358637bd, v34
    v_mul_f32 v36, 1.4426950408889634, v33
    v_exp_f32 v36, v36
    v_add_f32 v35, 1.0, v33
    v_cmp_lt_f32 vcc, 0, v33
    s_nop 1
    v_cndmask_b32 v35, v36, v35, vcc
    v_add_f32 v35, 0x358637bd, v35
    v_cvt_pk_bf16_f32 v17, v34, v35
    v_lshlrev_b32 v32, 16, v18
    v_and_b32 v33, 0xffff0000, v18
    v_mul_f32 v36, 1.4426950408889634, v32
    v_exp_f32 v36, v36
    v_add_f32 v34, 1.0, v32
    v_cmp_lt_f32 vcc, 0, v32
    s_nop 1
    v_cndmask_b32 v34, v36, v34, vcc
    v_add_f32 v34, 0x358637bd, v34
    v_mul_f32 v36, 1.4426950408889634, v33
    v_exp_f32 v36, v36
    v_add_f32 v35, 1.0, v33
    v_cmp_lt_f32 vcc, 0, v33
    s_nop 1
    v_cndmask_b32 v35, v36, v35, vcc
    v_add_f32 v35, 0x358637bd, v35
    v_cvt_pk_bf16_f32 v18, v34, v35
    v_lshlrev_b32 v32, 16, v19
    v_and_b32 v33, 0xffff0000, v19
    v_mul_f32 v36, 1.4426950408889634, v32
    v_exp_f32 v36, v36
    v_add_f32 v34, 1.0, v32
    v_cmp_lt_f32 vcc, 0, v32
    s_nop 1
    v_cndmask_b32 v34, v36, v34, vcc
    v_add_f32 v34, 0x358637bd, v34
    v_mul_f32 v36, 1.4426950408889634, v33
    v_exp_f32 v36, v36
    v_add_f32 v35, 1.0, v33
    v_cmp_lt_f32 vcc, 0, v33
    s_nop 1
    v_cndmask_b32 v35, v36, v35, vcc
    v_add_f32 v35, 0x358637bd, v35
    v_cvt_pk_bf16_f32 v19, v34, v35
    v_lshlrev_b32 v32, 16, v20
    v_and_b32 v33, 0xffff0000, v20
    v_mul_f32 v36, 1.4426950408889634, v32
    v_exp_f32 v36, v36
    v_add_f32 v34, 1.0, v32
    v_cmp_lt_f32 vcc, 0, v32
    s_nop 1
    v_cndmask_b32 v34, v36, v34, vcc
    v_add_f32 v34, 0x358637bd, v34
    v_mul_f32 v36, 1.4426950408889634, v33
    v_exp_f32 v36, v36
    v_add_f32 v35, 1.0, v33
    v_cmp_lt_f32 vcc, 0, v33
    s_nop 1
    v_cndmask_b32 v35, v36, v35, vcc
    v_add_f32 v35, 0x358637bd, v35
    v_cvt_pk_bf16_f32 v20, v34, v35
    v_lshlrev_b32 v32, 16, v21
    v_and_b32 v33, 0xffff0000, v21
    v_mul_f32 v36, 1.4426950408889634, v32
    v_exp_f32 v36, v36
    v_add_f32 v34, 1.0, v32
    v_cmp_lt_f32 vcc, 0, v32
    s_nop 1
    v_cndmask_b32 v34, v36, v34, vcc
    v_add_f32 v34, 0x358637bd, v34
    v_mul_f32 v36, 1.4426950408889634, v33
    v_exp_f32 v36, v36
    v_add_f32 v35, 1.0, v33
    v_cmp_lt_f32 vcc, 0, v33
    s_nop 1
    v_cndmask_b32 v35, v36, v35, vcc
    v_add_f32 v35, 0x358637bd, v35
    v_cvt_pk_bf16_f32 v21, v34, v35
    v_lshlrev_b32 v32, 16, v22
    v_and_b32 v33, 0xffff0000, v22
    v_mul_f32 v36, 1.4426950408889634, v32
    v_exp_f32 v36, v36
    v_add_f32 v34, 1.0, v32
    v_cmp_lt_f32 vcc, 0, v32
    s_nop 1
    v_cndmask_b32 v34, v36, v34, vcc
    v_add_f32 v34, 0x358637bd, v34
    v_mul_f32 v36, 1.4426950408889634, v33
    v_exp_f32 v36, v36
    v_add_f32 v35, 1.0, v33
    v_cmp_lt_f32 vcc, 0, v33
    s_nop 1
    v_cndmask_b32 v35, v36, v35, vcc
    v_add_f32 v35, 0x358637bd, v35
    v_cvt_pk_bf16_f32 v22, v34, v35
    v_lshlrev_b32 v32, 16, v23
    v_and_b32 v33, 0xffff0000, v23
    v_mul_f32 v36, 1.4426950408889634, v32
    v_exp_f32 v36, v36
    v_add_f32 v34, 1.0, v32
    v_cmp_lt_f32 vcc, 0, v32
    s_nop 1
    v_cndmask_b32 v34, v36, v34, vcc
    v_add_f32 v34, 0x358637bd, v34
    v_mul_f32 v36, 1.4426950408889634, v33
    v_exp_f32 v36, v36
    v_add_f32 v35, 1.0, v33
    v_cmp_lt_f32 vcc, 0, v33
    s_nop 1
    v_cndmask_b32 v35, v36, v35, vcc
    v_add_f32 v35, 0x358637bd, v35
    v_cvt_pk_bf16_f32 v23, v34, v35
    v_mov_b32 v37, 0x3f803f80
    v_cndmask_b32 v20, 0, v20, s[16:17]
    v_cndmask_b32 v28, 0, v28, s[16:17]
    v_cndmask_b32 v28, v28, v37, s[18:19]
    v_cndmask_b32 v21, 0, v21, s[16:17]
    v_cndmask_b32 v29, 0, v29, s[16:17]
    v_cndmask_b32 v29, v29, v37, s[18:19]
    v_cndmask_b32 v22, 0, v22, s[16:17]
    v_cndmask_b32 v30, 0, v30, s[16:17]
    v_cndmask_b32 v30, v30, v37, s[18:19]
    v_cndmask_b32 v23, 0, v23, s[16:17]
    v_cndmask_b32 v31, 0, v31, s[16:17]
    v_cndmask_b32 v31, v31, v37, s[18:19]
    s_nop 1
    v_mfma_f32_16x16x32_bf16 a[0:3], v[24:27], v[16:19], a[0:3]
    v_mfma_f32_16x16x32_bf16 a[4:7], v[24:27], v[20:23], a[4:7]
    v_mfma_f32_16x16x32_bf16 a[8:11], v[28:31], v[16:19], a[8:11]
    v_mfma_f32_16x16x32_bf16 a[12:15], v[28:31], v[20:23], a[12:15]
    buffer_load_dwordx4 v[16:19], v8, s[8:11], 0 offen offset:128
    buffer_load_dwordx4 v[24:27], v10, s[8:11], 0 offen offset:128
    buffer_load_dwordx4 v[20:23], v9, s[8:11], 0 offen offset:128
    buffer_load_dwordx4 v[28:31], v11, s[8:11], 0 offen offset:128
    s_waitcnt vmcnt(0)
    v_lshlrev_b32 v32, 16, v16
    v_and_b32 v33, 0xffff0000, v16
    v_mul_f32 v36, 1.4426950408889634, v32
    v_exp_f32 v36, v36
    v_add_f32 v34, 1.0, v32
    v_cmp_lt_f32 vcc, 0, v32
    s_nop 1
    v_cndmask_b32 v34, v36, v34, vcc
    v_add_f32 v34, 0x358637bd, v34
    v_mul_f32 v36, 1.4426950408889634, v33
    v_exp_f32 v36, v36
    v_add_f32 v35, 1.0, v33
    v_cmp_lt_f32 vcc, 0, v33
    s_nop 1
    v_cndmask_b32 v35, v36, v35, vcc
    v_add_f32 v35, 0x358637bd, v35
    v_cvt_pk_bf16_f32 v16, v34, v35
    v_lshlrev_b32 v32, 16, v17
    v_and_b32 v33, 0xffff0000, v17
    v_mul_f32 v36, 1.4426950408889634, v32
    v_exp_f32 v36, v36
    v_add_f32 v34, 1.0, v32
    v_cmp_lt_f32 vcc, 0, v32
    s_nop 1
    v_cndmask_b32 v34, v36, v34, vcc
    v_add_f32 v34, 0x358637bd, v34
    v_mul_f32 v36, 1.4426950408889634, v33
    v_exp_f32 v36, v36
    v_add_f32 v35, 1.0, v33
    v_cmp_lt_f32 vcc, 0, v33
    s_nop 1
    v_cndmask_b32 v35, v36, v35, vcc
    v_add_f32 v35, 0x358637bd, v35
    v_cvt_pk_bf16_f32 v17, v34, v35
    v_lshlrev_b32 v32, 16, v18
    v_and_b32 v33, 0xffff0000, v18
    v_mul_f32 v36, 1.4426950408889634, v32
    v_exp_f32 v36, v36
    v_add_f32 v34, 1.0, v32
    v_cmp_lt_f32 vcc, 0, v32
    s_nop 1
    v_cndmask_b32 v34, v36, v34, vcc
    v_add_f32 v34, 0x358637bd, v34
    v_mul_f32 v36, 1.4426950408889634, v33
    v_exp_f32 v36, v36
    v_add_f32 v35, 1.0, v33
    v_cmp_lt_f32 vcc, 0, v33
    s_nop 1
    v_cndmask_b32 v35, v36, v35, vcc
    v_add_f32 v35, 0x358637bd, v35
    v_cvt_pk_bf16_f32 v18, v34, v35
    v_lshlrev_b32 v32, 16, v19
    v_and_b32 v33, 0xffff0000, v19
    v_mul_f32 v36, 1.4426950408889634, v32
    v_exp_f32 v36, v36
    v_add_f32 v34, 1.0, v32
    v_cmp_lt_f32 vcc, 0, v32
    s_nop 1
    v_cndmask_b32 v34, v36, v34, vcc
    v_add_f32 v34, 0x358637bd, v34
    v_mul_f32 v36, 1.4426950408889634, v33
    v_exp_f32 v36, v36
    v_add_f32 v35, 1.0, v33
    v_cmp_lt_f32 vcc, 0, v33
    s_nop 1
    v_cndmask_b32 v35, v36, v35, vcc
    v_add_f32 v35, 0x358637bd, v35
    v_cvt_pk_bf16_f32 v19, v34, v35
    v_lshlrev_b32 v32, 16, v20
    v_and_b32 v33, 0xffff0000, v20
    v_mul_f32 v36, 1.4426950408889634, v32
    v_exp_f32 v36, v36
    v_add_f32 v34, 1.0, v32
    v_cmp_lt_f32 vcc, 0, v32
    s_nop 1
    v_cndmask_b32 v34, v36, v34, vcc
    v_add_f32 v34, 0x358637bd, v34
    v_mul_f32 v36, 1.4426950408889634, v33
    v_exp_f32 v36, v36
    v_add_f32 v35, 1.0, v33
    v_cmp_lt_f32 vcc, 0, v33
    s_nop 1
    v_cndmask_b32 v35, v36, v35, vcc
    v_add_f32 v35, 0x358637bd, v35
    v_cvt_pk_bf16_f32 v20, v34, v35
    v_lshlrev_b32 v32, 16, v21
    v_and_b32 v33, 0xffff0000, v21
    v_mul_f32 v36, 1.4426950408889634, v32
    v_exp_f32 v36, v36
    v_add_f32 v34, 1.0, v32
    v_cmp_lt_f32 vcc, 0, v32
    s_nop 1
    v_cndmask_b32 v34, v36, v34, vcc
    v_add_f32 v34, 0x358637bd, v34
    v_mul_f32 v36, 1.4426950408889634, v33
    v_exp_f32 v36, v36
    v_add_f32 v35, 1.0, v33
    v_cmp_lt_f32 vcc, 0, v33
    s_nop 1
    v_cndmask_b32 v35, v36, v35, vcc
    v_add_f32 v35, 0x358637bd, v35
    v_cvt_pk_bf16_f32 v21, v34, v35
    v_lshlrev_b32 v32, 16, v22
    v_and_b32 v33, 0xffff0000, v22
    v_mul_f32 v36, 1.4426950408889634, v32
    v_exp_f32 v36, v36
    v_add_f32 v34, 1.0, v32
    v_cmp_lt_f32 vcc, 0, v32
    s_nop 1
    v_cndmask_b32 v34, v36, v34, vcc
    v_add_f32 v34, 0x358637bd, v34
    v_mul_f32 v36, 1.4426950408889634, v33
    v_exp_f32 v36, v36
    v_add_f32 v35, 1.0, v33
    v_cmp_lt_f32 vcc, 0, v33
    s_nop 1
    v_cndmask_b32 v35, v36, v35, vcc
    v_add_f32 v35, 0x358637bd, v35
    v_cvt_pk_bf16_f32 v22, v34, v35
    v_lshlrev_b32 v32, 16, v23
    v_and_b32 v33, 0xffff0000, v23
    v_mul_f32 v36, 1.4426950408889634, v32
    v_exp_f32 v36, v36
    v_add_f32 v34, 1.0, v32
    v_cmp_lt_f32 vcc, 0, v32
    s_nop 1
    v_cndmask_b32 v34, v36, v34, vcc
    v_add_f32 v34, 0x358637bd, v34
    v_mul_f32 v36, 1.4426950408889634, v33
    v_exp_f32 v36, v36
    v_add_f32 v35, 1.0, v33
    v_cmp_lt_f32 vcc, 0, v33
    s_nop 1
    v_cndmask_b32 v35, v36, v35, vcc
    v_add_f32 v35, 0x358637bd, v35
    v_cvt_pk_bf16_f32 v23, v34, v35
    v_mov_b32 v37, 0x3f803f80
    v_cndmask_b32 v20, 0, v20, s[16:17]
    v_cndmask_b32 v28, 0, v28, s[16:17]
    v_cndmask_b32 v28, v28, v37, s[18:19]
    v_cndmask_b32 v21, 0, v21, s[16:17]
    v_cndmask_b32 v29, 0, v29, s[16:17]
    v_cndmask_b32 v29, v29, v37, s[18:19]
    v_cndmask_b32 v22, 0, v22, s[16:17]
    v_cndmask_b32 v30, 0, v30, s[16:17]
    v_cndmask_b32 v30, v30, v37, s[18:19]
    v_cndmask_b32 v23, 0, v23, s[16:17]
    v_cndmask_b32 v31, 0, v31, s[16:17]
    v_cndmask_b32 v31, v31, v37, s[18:19]
    s_nop 1
    v_mfma_f32_16x16x32_bf16 a[0:3], v[24:27], v[16:19], a[0:3]
    v_mfma_f32_16x16x32_bf16 a[4:7], v[24:27], v[20:23], a[4:7]
    v_mfma_f32_16x16x32_bf16 a[8:11], v[28:31], v[16:19], a[8:11]
    v_mfma_f32_16x16x32_bf16 a[12:15], v[28:31], v[20:23], a[12:15]
    buffer_load_dwordx4 v[16:19], v8, s[8:11], 0 offen offset:192
    buffer_load_dwordx4 v[24:27], v10, s[8:11], 0 offen offset:192
    buffer_load_dwordx4 v[20:23], v9, s[8:11], 0 offen offset:192
    buffer_load_dwordx4 v[28:31], v11, s[8:11], 0 offen offset:192
    s_waitcnt vmcnt(0)
    v_lshlrev_b32 v32, 16, v16
    v_and_b32 v33, 0xffff0000, v16
    v_mul_f32 v36, 1.4426950408889634, v32
    v_exp_f32 v36, v36
    v_add_f32 v34, 1.0, v32
    v_cmp_lt_f32 vcc, 0, v32
    s_nop 1
    v_cndmask_b32 v34, v36, v34, vcc
    v_add_f32 v34, 0x358637bd, v34
    v_mul_f32 v36, 1.4426950408889634, v33
    v_exp_f32 v36, v36
    v_add_f32 v35, 1.0, v33
    v_cmp_lt_f32 vcc, 0, v33
    s_nop 1
    v_cndmask_b32 v35, v36, v35, vcc
    v_add_f32 v35, 0x358637bd, v35
    v_cvt_pk_bf16_f32 v16, v34, v35
    v_lshlrev_b32 v32, 16, v17
    v_and_b32 v33, 0xffff0000, v17
    v_mul_f32 v36, 1.4426950408889634, v32
    v_exp_f32 v36, v36
    v_add_f32 v34, 1.0, v32
    v_cmp_lt_f32 vcc, 0, v32
    s_nop 1
    v_cndmask_b32 v34, v36, v34, vcc
    v_add_f32 v34, 0x358637bd, v34
    v_mul_f32 v36, 1.4426950408889634, v33
    v_exp_f32 v36, v36
    v_add_f32 v35, 1.0, v33
    v_cmp_lt_f32 vcc, 0, v33
    s_nop 1
    v_cndmask_b32 v35, v36, v35, vcc
    v_add_f32 v35, 0x358637bd, v35
    v_cvt_pk_bf16_f32 v17, v34, v35
    v_lshlrev_b32 v32, 16, v18
    v_and_b32 v33, 0xffff0000, v18
    v_mul_f32 v36, 1.4426950408889634, v32
    v_exp_f32 v36, v36
    v_add_f32 v34, 1.0, v32
    v_cmp_lt_f32 vcc, 0, v32
    s_nop 1
    v_cndmask_b32 v34, v36, v34, vcc
    v_add_f32 v34, 0x358637bd, v34
    v_mul_f32 v36, 1.4426950408889634, v33
    v_exp_f32 v36, v36
    v_add_f32 v35, 1.0, v33
    v_cmp_lt_f32 vcc, 0, v33
    s_nop 1
    v_cndmask_b32 v35, v36, v35, vcc
    v_add_f32 v35, 0x358637bd, v35
    v_cvt_pk_bf16_f32 v18, v34, v35
    v_lshlrev_b32 v32, 16, v19
    v_and_b32 v33, 0xffff0000, v19
    v_mul_f32 v36, 1.4426950408889634, v32
    v_exp_f32 v36, v36
    v_add_f32 v34, 1.0, v32
    v_cmp_lt_f32 vcc, 0, v32
    s_nop 1
    v_cndmask_b32 v34, v36, v34, vcc
    v_add_f32 v34, 0x358637bd, v34
    v_mul_f32 v36, 1.4426950408889634, v33
    v_exp_f32 v36, v36
    v_add_f32 v35, 1.0, v33
    v_cmp_lt_f32 vcc, 0, v33
    s_nop 1
    v_cndmask_b32 v35, v36, v35, vcc
    v_add_f32 v35, 0x358637bd, v35
    v_cvt_pk_bf16_f32 v19, v34, v35
    v_lshlrev_b32 v32, 16, v20
    v_and_b32 v33, 0xffff0000, v20
    v_mul_f32 v36, 1.4426950408889634, v32
    v_exp_f32 v36, v36
    v_add_f32 v34, 1.0, v32
    v_cmp_lt_f32 vcc, 0, v32
    s_nop 1
    v_cndmask_b32 v34, v36, v34, vcc
    v_add_f32 v34, 0x358637bd, v34
    v_mul_f32 v36, 1.4426950408889634, v33
    v_exp_f32 v36, v36
    v_add_f32 v35, 1.0, v33
    v_cmp_lt_f32 vcc, 0, v33
    s_nop 1
    v_cndmask_b32 v35, v36, v35, vcc
    v_add_f32 v35, 0x358637bd, v35
    v_cvt_pk_bf16_f32 v20, v34, v35
    v_lshlrev_b32 v32, 16, v21
    v_and_b32 v33, 0xffff0000, v21
    v_mul_f32 v36, 1.4426950408889634, v32
    v_exp_f32 v36, v36
    v_add_f32 v34, 1.0, v32
    v_cmp_lt_f32 vcc, 0, v32
    s_nop 1
    v_cndmask_b32 v34, v36, v34, vcc
    v_add_f32 v34, 0x358637bd, v34
    v_mul_f32 v36, 1.4426950408889634, v33
    v_exp_f32 v36, v36
    v_add_f32 v35, 1.0, v33
    v_cmp_lt_f32 vcc, 0, v33
    s_nop 1
    v_cndmask_b32 v35, v36, v35, vcc
    v_add_f32 v35, 0x358637bd, v35
    v_cvt_pk_bf16_f32 v21, v34, v35
    v_lshlrev_b32 v32, 16, v22
    v_and_b32 v33, 0xffff0000, v22
    v_mul_f32 v36, 1.4426950408889634, v32
    v_exp_f32 v36, v36
    v_add_f32 v34, 1.0, v32
    v_cmp_lt_f32 vcc, 0, v32
    s_nop 1
    v_cndmask_b32 v34, v36, v34, vcc
    v_add_f32 v34, 0x358637bd, v34
    v_mul_f32 v36, 1.4426950408889634, v33
    v_exp_f32 v36, v36
    v_add_f32 v35, 1.0, v33
    v_cmp_lt_f32 vcc, 0, v33
    s_nop 1
    v_cndmask_b32 v35, v36, v35, vcc
    v_add_f32 v35, 0x358637bd, v35
    v_cvt_pk_bf16_f32 v22, v34, v35
    v_lshlrev_b32 v32, 16, v23
    v_and_b32 v33, 0xffff0000, v23
    v_mul_f32 v36, 1.4426950408889634, v32
    v_exp_f32 v36, v36
    v_add_f32 v34, 1.0, v32
    v_cmp_lt_f32 vcc, 0, v32
    s_nop 1
    v_cndmask_b32 v34, v36, v34, vcc
    v_add_f32 v34, 0x358637bd, v34
    v_mul_f32 v36, 1.4426950408889634, v33
    v_exp_f32 v36, v36
    v_add_f32 v35, 1.0, v33
    v_cmp_lt_f32 vcc, 0, v33
    s_nop 1
    v_cndmask_b32 v35, v36, v35, vcc
    v_add_f32 v35, 0x358637bd, v35
    v_cvt_pk_bf16_f32 v23, v34, v35
    v_mov_b32 v37, 0x3f803f80
    v_cndmask_b32 v20, 0, v20, s[16:17]
    v_cndmask_b32 v28, 0, v28, s[16:17]
    v_cndmask_b32 v28, v28, v37, s[18:19]
    v_cndmask_b32 v21, 0, v21, s[16:17]
    v_cndmask_b32 v29, 0, v29, s[16:17]
    v_cndmask_b32 v29, v29, v37, s[18:19]
    v_cndmask_b32 v22, 0, v22, s[16:17]
    v_cndmask_b32 v30, 0, v30, s[16:17]
    v_cndmask_b32 v30, v30, v37, s[18:19]
    v_cndmask_b32 v23, 0, v23, s[16:17]
    v_cndmask_b32 v31, 0, v31, s[16:17]
    v_cndmask_b32 v31, v31, v37, s[18:19]
    s_nop 1
    v_mfma_f32_16x16x32_bf16 a[0:3], v[24:27], v[16:19], a[0:3]
    v_mfma_f32_16x16x32_bf16 a[4:7], v[24:27], v[20:23], a[4:7]
    v_mfma_f32_16x16x32_bf16 a[8:11], v[28:31], v[16:19], a[8:11]
    v_mfma_f32_16x16x32_bf16 a[12:15], v[28:31], v[20:23], a[12:15]
    s_nop 7
    s_nop 7
    v_lshlrev_b32 v5, 2, v4
    v_lshlrev_b32 v5, 5, v5
    v_add_u32 v5, v5, v3
    v_lshlrev_b32 v5, 2, v5
    s_lshl_b32 s14, s5, 12
    s_add_u32 s14, s14, 242352128
    v_add_u32 v5, s14, v5
    v_accvgpr_read_b32 v40, a0
    v_accvgpr_read_b32 v41, a1
    v_accvgpr_read_b32 v42, a2
    v_accvgpr_read_b32 v43, a3
    buffer_atomic_add_f32 v40, v5, s[8:11], 0 offen offset:0
    buffer_atomic_add_f32 v41, v5, s[8:11], 0 offen offset:128
    buffer_atomic_add_f32 v42, v5, s[8:11], 0 offen offset:256
    buffer_atomic_add_f32 v43, v5, s[8:11], 0 offen offset:384
    v_accvgpr_read_b32 v40, a4
    v_accvgpr_read_b32 v41, a5
    v_accvgpr_read_b32 v42, a6
    v_accvgpr_read_b32 v43, a7
    buffer_atomic_add_f32 v40, v5, s[8:11], 0 offen offset:64
    buffer_atomic_add_f32 v41, v5, s[8:11], 0 offen offset:192
    buffer_atomic_add_f32 v42, v5, s[8:11], 0 offen offset:320
    buffer_atomic_add_f32 v43, v5, s[8:11], 0 offen offset:448
    v_accvgpr_read_b32 v40, a8
    v_accvgpr_read_b32 v41, a9
    v_accvgpr_read_b32 v42, a10
    v_accvgpr_read_b32 v43, a11
    buffer_atomic_add_f32 v40, v5, s[8:11], 0 offen offset:2048
    buffer_atomic_add_f32 v41, v5, s[8:11], 0 offen offset:2176
    buffer_atomic_add_f32 v42, v5, s[8:11], 0 offen offset:2304
    buffer_atomic_add_f32 v43, v5, s[8:11], 0 offen offset:2432
    v_accvgpr_read_b32 v40, a12
    v_accvgpr_read_b32 v41, a13
    v_accvgpr_read_b32 v42, a14
    v_accvgpr_read_b32 v43, a15
    buffer_atomic_add_f32 v40, v5, s[8:11], 0 offen offset:2112
    buffer_atomic_add_f32 v41, v5, s[8:11], 0 offen offset:2240
    buffer_atomic_add_f32 v42, v5, s[8:11], 0 offen offset:2368
    buffer_atomic_add_f32 v43, v5, s[8:11], 0 offen offset:2496
kvz_a2_kernel_end:
    s_endpgm
.section .rodata,"a"
.p2align 6
.amdhsa_kernel kvz_a2_kernel
  .amdhsa_next_free_vgpr 80
  .amdhsa_next_free_sgpr 40
  .amdhsa_accum_offset 64
  .amdhsa_group_segment_fixed_size 0
  .amdhsa_kernarg_size 104
  .amdhsa_user_sgpr_count 2
  .amdhsa_user_sgpr_kernarg_segment_ptr 1
  .amdhsa_system_sgpr_workgroup_id_x 1
.end_amdhsa_kernel
.text
.globl attn_a2_kernel
.p2align 8
.type attn_a2_kernel,@function
attn_a2_kernel:
    s_cmp_ge_u32 s2, 256
    s_cbranch_scc1 attn_a2_kernel_end
    s_load_dwordx2 s[6:7], s[0:1], 96
    s_waitcnt lgkmcnt(0)
    s_mov_b32 s8, s6
    s_mov_b32 s9, s7
    s_mov_b32 s10, 268435456
    s_mov_b32 s11, 0x00020000
    v_mov_b32 v1, v0
    v_add_u32 v2, 0, v1
    s_mov_b32 s12, 3121
    v_mul_lo_u32 v3, v2, s12
    v_lshrrev_b32 v3, 19, v3
    v_mul_u32_u24 v4, 168, v3
    v_sub_u32 v4, v2, v4
    v_lshlrev_b32 v5, 12, v3
    v_lshlrev_b32 v6, 4, v4
    v_add_u32 v5, v5, v6
    v_add_u32 v5, 242352128, v5
    buffer_load_dwordx4 v[8:11], v5, s[8:11], 0 offen
    v_mul_u32_u24 v7, 2688, v3
    v_add_u32 v7, v7, v6
    s_waitcnt vmcnt(0)
    ds_write_b128 v7, v[8:11]
    v_add_u32 v2, 256, v1
    s_mov_b32 s12, 3121
    v_mul_lo_u32 v3, v2, s12
    v_lshrrev_b32 v3, 19, v3
    v_mul_u32_u24 v4, 168, v3
    v_sub_u32 v4, v2, v4
    v_lshlrev_b32 v5, 12, v3
    v_lshlrev_b32 v6, 4, v4
    v_add_u32 v5, v5, v6
    v_add_u32 v5, 242352128, v5
    buffer_load_dwordx4 v[8:11], v5, s[8:11], 0 offen
    v_mul_u32_u24 v7, 2688, v3
    v_add_u32 v7, v7, v6
    s_waitcnt vmcnt(0)
    ds_write_b128 v7, v[8:11]
    v_add_u32 v2, 512, v1
    s_mov_b32 s12, 3121
    v_mul_lo_u32 v3, v2, s12
    v_lshrrev_b32 v3, 19, v3
    v_mul_u32_u24 v4, 168, v3
    v_sub_u32 v4, v2, v4
    v_lshlrev_b32 v5, 12, v3
    v_lshlrev_b32 v6, 4, v4
    v_add_u32 v5, v5, v6
    v_add_u32 v5, 242352128, v5
    buffer_load_dwordx4 v[8:11], v5, s[8:11], 0 offen
    v_mul_u32_u24 v7, 2688, v3
    v_add_u32 v7, v7, v6
    s_waitcnt vmcnt(0)
    ds_write_b128 v7, v[8:11]
    v_add_u32 v2, 768, v1
    s_mov_b32 s12, 3121
    v_mul_lo_u32 v3, v2, s12
    v_lshrrev_b32 v3, 19, v3
    v_mul_u32_u24 v4, 168, v3
    v_sub_u32 v4, v2, v4
    v_lshlrev_b32 v5, 12, v3
    v_lshlrev_b32 v6, 4, v4
    v_add_u32 v5, v5, v6
    v_add_u32 v5, 242352128, v5
    buffer_load_dwordx4 v[8:11], v5, s[8:11], 0 offen
    v_mul_u32_u24 v7, 2688, v3
    v_add_u32 v7, v7, v6
    s_waitcnt vmcnt(0)
    ds_write_b128 v7, v[8:11]
    v_add_u32 v2, 1024, v1
    s_mov_b32 s12, 3121
    v_mul_lo_u32 v3, v2, s12
    v_lshrrev_b32 v3, 19, v3
    v_mul_u32_u24 v4, 168, v3
    v_sub_u32 v4, v2, v4
    v_lshlrev_b32 v5, 12, v3
    v_lshlrev_b32 v6, 4, v4
    v_add_u32 v5, v5, v6
    v_add_u32 v5, 242352128, v5
    buffer_load_dwordx4 v[8:11], v5, s[8:11], 0 offen
    v_mul_u32_u24 v7, 2688, v3
    v_add_u32 v7, v7, v6
    s_waitcnt vmcnt(0)
    ds_write_b128 v7, v[8:11]
    v_add_u32 v2, 1280, v1
    s_mov_b32 s12, 3121
    v_mul_lo_u32 v3, v2, s12
    v_lshrrev_b32 v3, 19, v3
    v_mul_u32_u24 v4, 168, v3
    v_sub_u32 v4, v2, v4
    v_lshlrev_b32 v5, 12, v3
    v_lshlrev_b32 v6, 4, v4
    v_add_u32 v5, v5, v6
    v_add_u32 v5, 242352128, v5
    buffer_load_dwordx4 v[8:11], v5, s[8:11], 0 offen
    v_mul_u32_u24 v7, 2688, v3
    v_add_u32 v7, v7, v6
    s_waitcnt vmcnt(0)
    ds_write_b128 v7, v[8:11]
    v_add_u32 v2, 1536, v1
    s_mov_b32 s12, 3121
    v_mul_lo_u32 v3, v2, s12
    v_lshrrev_b32 v3, 19, v3
    v_mul_u32_u24 v4, 168, v3
    v_sub_u32 v4, v2, v4
    v_lshlrev_b32 v5, 12, v3
    v_lshlrev_b32 v6, 4, v4
    v_add_u32 v5, v5, v6
    v_add_u32 v5, 242352128, v5
    buffer_load_dwordx4 v[8:11], v5, s[8:11], 0 offen
    v_mul_u32_u24 v7, 2688, v3
    v_add_u32 v7, v7, v6
    s_waitcnt vmcnt(0)
    ds_write_b128 v7, v[8:11]
    v_add_u32 v2, 1792, v1
    s_mov_b32 s12, 3121
    v_mul_lo_u32 v3, v2, s12
    v_lshrrev_b32 v3, 19, v3
    v_mul_u32_u24 v4, 168, v3
    v_sub_u32 v4, v2, v4
    v_lshlrev_b32 v5, 12, v3
    v_lshlrev_b32 v6, 4, v4
    v_add_u32 v5, v5, v6
    v_add_u32 v5, 242352128, v5
    buffer_load_dwordx4 v[8:11], v5, s[8:11], 0 offen
    v_mul_u32_u24 v7, 2688, v3
    v_add_u32 v7, v7, v6
    s_waitcnt vmcnt(0)
    ds_write_b128 v7, v[8:11]
    v_add_u32 v2, 2048, v1
    s_mov_b32 s12, 3121
    v_mul_lo_u32 v3, v2, s12
    v_lshrrev_b32 v3, 19, v3
    v_mul_u32_u24 v4, 168, v3
    v_sub_u32 v4, v2, v4
    v_lshlrev_b32 v5, 12, v3
    v_lshlrev_b32 v6, 4, v4
    v_add_u32 v5, v5, v6
    v_add_u32 v5, 242352128, v5
    buffer_load_dwordx4 v[8:11], v5, s[8:11], 0 offen
    v_mul_u32_u24 v7, 2688, v3
    v_add_u32 v7, v7, v6
    s_waitcnt vmcnt(0)
    ds_write_b128 v7, v[8:11]
    v_add_u32 v2, 2304, v1
    s_mov_b32 s12, 3121
    v_mul_lo_u32 v3, v2, s12
    v_lshrrev_b32 v3, 19, v3
    v_mul_u32_u24 v4, 168, v3
    v_sub_u32 v4, v2, v4
    v_lshlrev_b32 v5, 12, v3
    v_lshlrev_b32 v6, 4, v4
    v_add_u32 v5, v5, v6
    v_add_u32 v5, 242352128, v5
    buffer_load_dwordx4 v[8:11], v5, s[8:11], 0 offen
    v_mul_u32_u24 v7, 2688, v3
    v_add_u32 v7, v7, v6
    s_waitcnt vmcnt(0)
    ds_write_b128 v7, v[8:11]
    v_add_u32 v2, 2560, v1
    s_mov_b32 s12, 3121
    v_mul_lo_u32 v3, v2, s12
    v_lshrrev_b32 v3, 19, v3
    v_mul_u32_u24 v4, 168, v3
    v_sub_u32 v4, v2, v4
    v_lshlrev_b32 v5, 12, v3
    v_lshlrev_b32 v6, 4, v4
    v_add_u32 v5, v5, v6
    v_add_u32 v5, 242352128, v5
    buffer_load_dwordx4 v[8:11], v5, s[8:11], 0 offen
    v_mul_u32_u24 v7, 2688, v3
    v_add_u32 v7, v7, v6
    s_waitcnt vmcnt(0)
    ds_write_b128 v7, v[8:11]
    v_add_u32 v2, 2816, v1
    s_mov_b32 s12, 3121
    v_mul_lo_u32 v3, v2, s12
    v_lshrrev_b32 v3, 19, v3
    v_mul_u32_u24 v4, 168, v3
    v_sub_u32 v4, v2, v4
    v_lshlrev_b32 v5, 12, v3
    v_lshlrev_b32 v6, 4, v4
    v_add_u32 v5, v5, v6
    v_add_u32 v5, 242352128, v5
    buffer_load_dwordx4 v[8:11], v5, s[8:11], 0 offen
    v_mul_u32_u24 v7, 2688, v3
    v_add_u32 v7, v7, v6
    s_waitcnt vmcnt(0)
    ds_write_b128 v7, v[8:11]
    v_add_u32 v2, 3072, v1
    s_mov_b32 s12, 3121
    v_mul_lo_u32 v3, v2, s12
    v_lshrrev_b32 v3, 19, v3
    v_mul_u32_u24 v4, 168, v3
    v_sub_u32 v4, v2, v4
    v_lshlrev_b32 v5, 12, v3
    v_lshlrev_b32 v6, 4, v4
    v_add_u32 v5, v5, v6
    v_add_u32 v5, 242352128, v5
    buffer_load_dwordx4 v[8:11], v5, s[8:11], 0 offen
    v_mul_u32_u24 v7, 2688, v3
    v_add_u32 v7, v7, v6
    s_waitcnt vmcnt(0)
    ds_write_b128 v7, v[8:11]
    v_add_u32 v2, 3328, v1
    s_mov_b32 s12, 3121
    v_mul_lo_u32 v3, v2, s12
    v_lshrrev_b32 v3, 19, v3
    v_mul_u32_u24 v4, 168, v3
    v_sub_u32 v4, v2, v4
    v_lshlrev_b32 v5, 12, v3
    v_lshlrev_b32 v6, 4, v4
    v_add_u32 v5, v5, v6
    v_add_u32 v5, 242352128, v5
    buffer_load_dwordx4 v[8:11], v5, s[8:11], 0 offen
    v_mul_u32_u24 v7, 2688, v3
    v_add_u32 v7, v7, v6
    s_waitcnt vmcnt(0)
    ds_write_b128 v7, v[8:11]
    v_add_u32 v2, 3584, v1
    s_mov_b32 s12, 3121
    v_mul_lo_u32 v3, v2, s12
    v_lshrrev_b32 v3, 19, v3
    v_mul_u32_u24 v4, 168, v3
    v_sub_u32 v4, v2, v4
    v_lshlrev_b32 v5, 12, v3
    v_lshlrev_b32 v6, 4, v4
    v_add_u32 v5, v5, v6
    v_add_u32 v5, 242352128, v5
    buffer_load_dwordx4 v[8:11], v5, s[8:11], 0 offen
    v_mul_u32_u24 v7, 2688, v3
    v_add_u32 v7, v7, v6
    s_waitcnt vmcnt(0)
    ds_write_b128 v7, v[8:11]
    v_add_u32 v2, 3840, v1
    s_mov_b32 s12, 3121
    v_mul_lo_u32 v3, v2, s12
    v_lshrrev_b32 v3, 19, v3
    v_mul_u32_u24 v4, 168, v3
    v_sub_u32 v4, v2, v4
    v_lshlrev_b32 v5, 12, v3
    v_lshlrev_b32 v6, 4, v4
    v_add_u32 v5, v5, v6
    v_add_u32 v5, 242352128, v5
    buffer_load_dwordx4 v[8:11], v5, s[8:11], 0 offen
    v_mul_u32_u24 v7, 2688, v3
    v_add_u32 v7, v7, v6
    s_waitcnt vmcnt(0)
    ds_write_b128 v7, v[8:11]
    v_add_u32 v2, 4096, v1
    s_mov_b32 s12, 3121
    v_mul_lo_u32 v3, v2, s12
    v_lshrrev_b32 v3, 19, v3
    v_mul_u32_u24 v4, 168, v3
    v_sub_u32 v4, v2, v4
    v_lshlrev_b32 v5, 12, v3
    v_lshlrev_b32 v6, 4, v4
    v_add_u32 v5, v5, v6
    v_add_u32 v5, 242352128, v5
    buffer_load_dwordx4 v[8:11], v5, s[8:11], 0 offen
    v_mul_u32_u24 v7, 2688, v3
    v_add_u32 v7, v7, v6
    s_waitcnt vmcnt(0)
    ds_write_b128 v7, v[8:11]
    v_add_u32 v2, 4352, v1
    s_mov_b32 s12, 3121
    v_mul_lo_u32 v3, v2, s12
    v_lshrrev_b32 v3, 19, v3
    v_mul_u32_u24 v4, 168, v3
    v_sub_u32 v4, v2, v4
    v_lshlrev_b32 v5, 12, v3
    v_lshlrev_b32 v6, 4, v4
    v_add_u32 v5, v5, v6
    v_add_u32 v5, 242352128, v5
    buffer_load_dwordx4 v[8:11], v5, s[8:11], 0 offen
    v_mul_u32_u24 v7, 2688, v3
    v_add_u32 v7, v7, v6
    s_waitcnt vmcnt(0)
    ds_write_b128 v7, v[8:11]
    v_add_u32 v2, 4608, v1
    s_mov_b32 s12, 3121
    v_mul_lo_u32 v3, v2, s12
    v_lshrrev_b32 v3, 19, v3
    v_mul_u32_u24 v4, 168, v3
    v_sub_u32 v4, v2, v4
    v_lshlrev_b32 v5, 12, v3
    v_lshlrev_b32 v6, 4, v4
    v_add_u32 v5, v5, v6
    v_add_u32 v5, 242352128, v5
    buffer_load_dwordx4 v[8:11], v5, s[8:11], 0 offen
    v_mul_u32_u24 v7, 2688, v3
    v_add_u32 v7, v7, v6
    s_waitcnt vmcnt(0)
    ds_write_b128 v7, v[8:11]
    v_add_u32 v2, 4864, v1
    s_mov_b32 s12, 3121
    v_mul_lo_u32 v3, v2, s12
    v_lshrrev_b32 v3, 19, v3
    v_mul_u32_u24 v4, 168, v3
    v_sub_u32 v4, v2, v4
    v_lshlrev_b32 v5, 12, v3
    v_lshlrev_b32 v6, 4, v4
    v_add_u32 v5, v5, v6
    v_add_u32 v5, 242352128, v5
    buffer_load_dwordx4 v[8:11], v5, s[8:11], 0 offen
    v_mul_u32_u24 v7, 2688, v3
    v_add_u32 v7, v7, v6
    s_waitcnt vmcnt(0)
    ds_write_b128 v7, v[8:11]
    v_add_u32 v2, 5120, v1
    s_mov_b32 s12, 3121
    v_mul_lo_u32 v3, v2, s12
    v_lshrrev_b32 v3, 19, v3
    v_mul_u32_u24 v4, 168, v3
    v_sub_u32 v4, v2, v4
    v_lshlrev_b32 v5, 12, v3
    v_lshlrev_b32 v6, 4, v4
    v_add_u32 v5, v5, v6
    v_add_u32 v5, 242352128, v5
    buffer_load_dwordx4 v[8:11], v5, s[8:11], 0 offen
    v_mul_u32_u24 v7, 2688, v3
    v_add_u32 v7, v7, v6
    s_waitcnt vmcnt(0)
    ds_write_b128 v7, v[8:11]
    s_waitcnt lgkmcnt(0)
    s_barrier
    v_and_b32 v2, 31, v0
    v_lshrrev_b32 v3, 5, v0
    s_lshl_b32 s12, s2, 3
    v_add_u32 v3, s12, v3
    v_mul_u32_u24 v4, 1280, v3
    v_mul_u32_u24 v5, 40, v2
    v_add_u32 v4, v4, v5
    v_add_u32 v6, 229638144, v4
    buffer_load_dwordx2 v[8:9], v6, s[8:11], 0 offen offset:0
    buffer_load_dwordx2 v[10:11], v6, s[8:11], 0 offen offset:8
    buffer_load_dwordx2 v[12:13], v6, s[8:11], 0 offen offset:16
    buffer_load_dwordx2 v[14:15], v6, s[8:11], 0 offen offset:24
    buffer_load_dwordx2 v[16:17], v6, s[8:11], 0 offen offset:32
    s_waitcnt vmcnt(0)
    v_lshlrev_b32 v40, 16, v8
    v_and_b32 v41, 0xffff0000, v8
    v_mul_f32 v44, 1.4426950408889634, v40
    v_exp_f32 v44, v44
    v_add_f32 v42, 1.0, v40
    v_cmp_lt_f32 vcc, 0, v40
    s_nop 1
    v_cndmask_b32 v42, v44, v42, vcc
    v_add_f32 v42, 0x358637bd, v42
    v_mul_f32 v44, 1.4426950408889634, v41
    v_exp_f32 v44, v44
    v_add_f32 v43, 1.0, v41
    v_cmp_lt_f32 vcc, 0, v41
    s_nop 1
    v_cndmask_b32 v43, v44, v43, vcc
    v_add_f32 v43, 0x358637bd, v43
    v_cvt_pk_bf16_f32 v45, v42, v43
    v_lshlrev_b32 v20, 16, v45
    v_and_b32 v21, 0xffff0000, v45
    v_lshlrev_b32 v40, 16, v9
    v_and_b32 v41, 0xffff0000, v9
    v_mul_f32 v44, 1.4426950408889634, v40
    v_exp_f32 v44, v44
    v_add_f32 v42, 1.0, v40
    v_cmp_lt_f32 vcc, 0, v40
    s_nop 1
    v_cndmask_b32 v42, v44, v42, vcc
    v_add_f32 v42, 0x358637bd, v42
    v_mul_f32 v44, 1.4426950408889634, v41
    v_exp_f32 v44, v44
    v_add_f32 v43, 1.0, v41
    v_cmp_lt_f32 vcc, 0, v41
    s_nop 1
    v_cndmask_b32 v43, v44, v43, vcc
    v_add_f32 v43, 0x358637bd, v43
    v_cvt_pk_bf16_f32 v45, v42, v43
    v_lshlrev_b32 v22, 16, v45
    v_and_b32 v23, 0xffff0000, v45
    v_lshlrev_b32 v40, 16, v10
    v_and_b32 v41, 0xffff0000, v10
    v_mul_f32 v44, 1.4426950408889634, v40
    v_exp_f32 v44, v44
    v_add_f32 v42, 1.0, v40
    v_cmp_lt_f32 vcc, 0, v40
    s_nop 1
    v_cndmask_b32 v42, v44, v42, vcc
    v_add_f32 v42, 0x358637bd, v42
    v_mul_f32 v44, 1.4426950408889634, v41
    v_exp_f32 v44, v44
    v_add_f32 v43, 1.0, v41
    v_cmp_lt_f32 vcc, 0, v41
    s_nop 1
    v_cndmask_b32 v43, v44, v43, vcc
    v_add_f32 v43, 0x358637bd, v43
    v_cvt_pk_bf16_f32 v45, v42, v43
    v_lshlrev_b32 v24, 16, v45
    v_and_b32 v25, 0xffff0000, v45
    v_lshlrev_b32 v40, 16, v11
    v_and_b32 v41, 0xffff0000, v11
    v_mul_f32 v44, 1.4426950408889634, v40
    v_exp_f32 v44, v44
    v_add_f32 v42, 1.0, v40
    v_cmp_lt_f32 vcc, 0, v40
    s_nop 1
    v_cndmask_b32 v42, v44, v42, vcc
    v_add_f32 v42, 0x358637bd, v42
    v_mul_f32 v44, 1.4426950408889634, v41
    v_exp_f32 v44, v44
    v_add_f32 v43, 1.0, v41
    v_cmp_lt_f32 vcc, 0, v41
    s_nop 1
    v_cndmask_b32 v43, v44, v43, vcc
    v_add_f32 v43, 0x358637bd, v43
    v_cvt_pk_bf16_f32 v45, v42, v43
    v_lshlrev_b32 v26, 16, v45
    v_and_b32 v27, 0xffff0000, v45
    v_lshlrev_b32 v40, 16, v12
    v_and_b32 v41, 0xffff0000, v12
    v_mul_f32 v44, 1.4426950408889634, v40
    v_exp_f32 v44, v44
    v_add_f32 v42, 1.0, v40
    v_cmp_lt_f32 vcc, 0, v40
    s_nop 1
    v_cndmask_b32 v42, v44, v42, vcc
    v_add_f32 v42, 0x358637bd, v42
    v_mul_f32 v44, 1.4426950408889634, v41
    v_exp_f32 v44, v44
    v_add_f32 v43, 1.0, v41
    v_cmp_lt_f32 vcc, 0, v41
    s_nop 1
    v_cndmask_b32 v43, v44, v43, vcc
    v_add_f32 v43, 0x358637bd, v43
    v_cvt_pk_bf16_f32 v45, v42, v43
    v_lshlrev_b32 v28, 16, v45
    v_and_b32 v29, 0xffff0000, v45
    v_lshlrev_b32 v40, 16, v13
    v_and_b32 v41, 0xffff0000, v13
    v_mul_f32 v44, 1.4426950408889634, v40
    v_exp_f32 v44, v44
    v_add_f32 v42, 1.0, v40
    v_cmp_lt_f32 vcc, 0, v40
    s_nop 1
    v_cndmask_b32 v42, v44, v42, vcc
    v_add_f32 v42, 0x358637bd, v42
    v_mul_f32 v44, 1.4426950408889634, v41
    v_exp_f32 v44, v44
    v_add_f32 v43, 1.0, v41
    v_cmp_lt_f32 vcc, 0, v41
    s_nop 1
    v_cndmask_b32 v43, v44, v43, vcc
    v_add_f32 v43, 0x358637bd, v43
    v_cvt_pk_bf16_f32 v45, v42, v43
    v_lshlrev_b32 v30, 16, v45
    v_and_b32 v31, 0xffff0000, v45
    v_lshlrev_b32 v40, 16, v14
    v_and_b32 v41, 0xffff0000, v14
    v_mul_f32 v44, 1.4426950408889634, v40
    v_exp_f32 v44, v44
    v_add_f32 v42, 1.0, v40
    v_cmp_lt_f32 vcc, 0, v40
    s_nop 1
    v_cndmask_b32 v42, v44, v42, vcc
    v_add_f32 v42, 0x358637bd, v42
    v_mul_f32 v44, 1.4426950408889634, v41
    v_exp_f32 v44, v44
    v_add_f32 v43, 1.0, v41
    v_cmp_lt_f32 vcc, 0, v41
    s_nop 1
    v_cndmask_b32 v43, v44, v43, vcc
    v_add_f32 v43, 0x358637bd, v43
    v_cvt_pk_bf16_f32 v45, v42, v43
    v_lshlrev_b32 v32, 16, v45
    v_and_b32 v33, 0xffff0000, v45
    v_lshlrev_b32 v40, 16, v15
    v_and_b32 v41, 0xffff0000, v15
    v_mul_f32 v44, 1.4426950408889634, v40
    v_exp_f32 v44, v44
    v_add_f32 v42, 1.0, v40
    v_cmp_lt_f32 vcc, 0, v40
    s_nop 1
    v_cndmask_b32 v42, v44, v42, vcc
    v_add_f32 v42, 0x358637bd, v42
    v_mul_f32 v44, 1.4426950408889634, v41
    v_exp_f32 v44, v44
    v_add_f32 v43, 1.0, v41
    v_cmp_lt_f32 vcc, 0, v41
    s_nop 1
    v_cndmask_b32 v43, v44, v43, vcc
    v_add_f32 v43, 0x358637bd, v43
    v_cvt_pk_bf16_f32 v45, v42, v43
    v_lshlrev_b32 v34, 16, v45
    v_and_b32 v35, 0xffff0000, v45
    v_lshlrev_b32 v40, 16, v16
    v_and_b32 v41, 0xffff0000, v16
    v_mul_f32 v44, 1.4426950408889634, v40
    v_exp_f32 v44, v44
    v_add_f32 v42, 1.0, v40
    v_cmp_lt_f32 vcc, 0, v40
    s_nop 1
    v_cndmask_b32 v42, v44, v42, vcc
    v_add_f32 v42, 0x358637bd, v42
    v_mul_f32 v44, 1.4426950408889634, v41
    v_exp_f32 v44, v44
    v_add_f32 v43, 1.0, v41
    v_cmp_lt_f32 vcc, 0, v41
    s_nop 1
    v_cndmask_b32 v43, v44, v43, vcc
    v_add_f32 v43, 0x358637bd, v43
    v_cvt_pk_bf16_f32 v45, v42, v43
    v_lshlrev_b32 v36, 16, v45
    v_and_b32 v37, 0xffff0000, v45
    v_lshlrev_b32 v40, 16, v17
    v_and_b32 v41, 0xffff0000, v17
    v_mul_f32 v44, 1.4426950408889634, v40
    v_exp_f32 v44, v44
    v_add_f32 v42, 1.0, v40
    v_cmp_lt_f32 vcc, 0, v40
    s_nop 1
    v_cndmask_b32 v42, v44, v42, vcc
    v_add_f32 v42, 0x358637bd, v42
    v_mul_f32 v44, 1.4426950408889634, v41
    v_exp_f32 v44, v44
    v_add_f32 v43, 1.0, v41
    v_cmp_lt_f32 vcc, 0, v41
    s_nop 1
    v_cndmask_b32 v43, v44, v43, vcc
    v_add_f32 v43, 0x358637bd, v43
    v_cvt_pk_bf16_f32 v45, v42, v43
    v_lshlrev_b32 v38, 16, v45
    v_and_b32 v39, 0xffff0000, v45
    v_mul_u32_u24 v7, 2688, v2
    ds_read_b128 v[72:75], v7 offset:0
    ds_read_b128 v[76:79], v7 offset:16
    ds_read_b128 v[80:83], v7 offset:32
    ds_read_b128 v[84:87], v7 offset:48
    ds_read_b128 v[88:91], v7 offset:64
    s_waitcnt lgkmcnt(0)
    v_mul_f32 v50, v20, v72
    v_fmac_f32 v50, v21, v73
    v_fmac_f32 v50, v22, v74
    v_fmac_f32 v50, v23, v75
    v_fmac_f32 v50, v24, v76
    v_fmac_f32 v50, v25, v77
    v_fmac_f32 v50, v26, v78
    v_fmac_f32 v50, v27, v79
    v_fmac_f32 v50, v28, v80
    v_fmac_f32 v50, v29, v81
    v_fmac_f32 v50, v30, v82
    v_fmac_f32 v50, v31, v83
    v_fmac_f32 v50, v32, v84
    v_fmac_f32 v50, v33, v85
    v_fmac_f32 v50, v34, v86
    v_fmac_f32 v50, v35, v87
    v_fmac_f32 v50, v36, v88
    v_fmac_f32 v50, v37, v89
    v_fmac_f32 v50, v38, v90
    v_fmac_f32 v50, v39, v91
    ds_read_b128 v[72:75], v7 offset:128
    ds_read_b128 v[76:79], v7 offset:144
    ds_read_b128 v[80:83], v7 offset:160
    ds_read_b128 v[84:87], v7 offset:176
    ds_read_b128 v[88:91], v7 offset:192
    s_waitcnt lgkmcnt(0)
    v_mul_f32 v51, v20, v72
    v_fmac_f32 v51, v21, v73
    v_fmac_f32 v51, v22, v74
    v_fmac_f32 v51, v23, v75
    v_fmac_f32 v51, v24, v76
    v_fmac_f32 v51, v25, v77
    v_fmac_f32 v51, v26, v78
    v_fmac_f32 v51, v27, v79
    v_fmac_f32 v51, v28, v80
    v_fmac_f32 v51, v29, v81
    v_fmac_f32 v51, v30, v82
    v_fmac_f32 v51, v31, v83
    v_fmac_f32 v51, v32, v84
    v_fmac_f32 v51, v33, v85
    v_fmac_f32 v51, v34, v86
    v_fmac_f32 v51, v35, v87
    v_fmac_f32 v51, v36, v88
    v_fmac_f32 v51, v37, v89
    v_fmac_f32 v51, v38, v90
    v_fmac_f32 v51, v39, v91
    ds_read_b128 v[72:75], v7 offset:256
    ds_read_b128 v[76:79], v7 offset:272
    ds_read_b128 v[80:83], v7 offset:288
    ds_read_b128 v[84:87], v7 offset:304
    ds_read_b128 v[88:91], v7 offset:320
    s_waitcnt lgkmcnt(0)
    v_mul_f32 v52, v20, v72
    v_fmac_f32 v52, v21, v73
    v_fmac_f32 v52, v22, v74
    v_fmac_f32 v52, v23, v75
    v_fmac_f32 v52, v24, v76
    v_fmac_f32 v52, v25, v77
    v_fmac_f32 v52, v26, v78
    v_fmac_f32 v52, v27, v79
    v_fmac_f32 v52, v28, v80
    v_fmac_f32 v52, v29, v81
    v_fmac_f32 v52, v30, v82
    v_fmac_f32 v52, v31, v83
    v_fmac_f32 v52, v32, v84
    v_fmac_f32 v52, v33, v85
    v_fmac_f32 v52, v34, v86
    v_fmac_f32 v52, v35, v87
    v_fmac_f32 v52, v36, v88
    v_fmac_f32 v52, v37, v89
    v_fmac_f32 v52, v38, v90
    v_fmac_f32 v52, v39, v91
    ds_read_b128 v[72:75], v7 offset:384
    ds_read_b128 v[76:79], v7 offset:400
    ds_read_b128 v[80:83], v7 offset:416
    ds_read_b128 v[84:87], v7 offset:432
    ds_read_b128 v[88:91], v7 offset:448
    s_waitcnt lgkmcnt(0)
    v_mul_f32 v53, v20, v72
    v_fmac_f32 v53, v21, v73
    v_fmac_f32 v53, v22, v74
    v_fmac_f32 v53, v23, v75
    v_fmac_f32 v53, v24, v76
    v_fmac_f32 v53, v25, v77
    v_fmac_f32 v53, v26, v78
    v_fmac_f32 v53, v27, v79
    v_fmac_f32 v53, v28, v80
    v_fmac_f32 v53, v29, v81
    v_fmac_f32 v53, v30, v82
    v_fmac_f32 v53, v31, v83
    v_fmac_f32 v53, v32, v84
    v_fmac_f32 v53, v33, v85
    v_fmac_f32 v53, v34, v86
    v_fmac_f32 v53, v35, v87
    v_fmac_f32 v53, v36, v88
    v_fmac_f32 v53, v37, v89
    v_fmac_f32 v53, v38, v90
    v_fmac_f32 v53, v39, v91
    ds_read_b128 v[72:75], v7 offset:512
    ds_read_b128 v[76:79], v7 offset:528
    ds_read_b128 v[80:83], v7 offset:544
    ds_read_b128 v[84:87], v7 offset:560
    ds_read_b128 v[88:91], v7 offset:576
    s_waitcnt lgkmcnt(0)
    v_mul_f32 v54, v20, v72
    v_fmac_f32 v54, v21, v73
    v_fmac_f32 v54, v22, v74
    v_fmac_f32 v54, v23, v75
    v_fmac_f32 v54, v24, v76
    v_fmac_f32 v54, v25, v77
    v_fmac_f32 v54, v26, v78
    v_fmac_f32 v54, v27, v79
    v_fmac_f32 v54, v28, v80
    v_fmac_f32 v54, v29, v81
    v_fmac_f32 v54, v30, v82
    v_fmac_f32 v54, v31, v83
    v_fmac_f32 v54, v32, v84
    v_fmac_f32 v54, v33, v85
    v_fmac_f32 v54, v34, v86
    v_fmac_f32 v54, v35, v87
    v_fmac_f32 v54, v36, v88
    v_fmac_f32 v54, v37, v89
    v_fmac_f32 v54, v38, v90
    v_fmac_f32 v54, v39, v91
    ds_read_b128 v[72:75], v7 offset:640
    ds_read_b128 v[76:79], v7 offset:656
    ds_read_b128 v[80:83], v7 offset:672
    ds_read_b128 v[84:87], v7 offset:688
    ds_read_b128 v[88:91], v7 offset:704
    s_waitcnt lgkmcnt(0)
    v_mul_f32 v55, v20, v72
    v_fmac_f32 v55, v21, v73
    v_fmac_f32 v55, v22, v74
    v_fmac_f32 v55, v23, v75
    v_fmac_f32 v55, v24, v76
    v_fmac_f32 v55, v25, v77
    v_fmac_f32 v55, v26, v78
    v_fmac_f32 v55, v27, v79
    v_fmac_f32 v55, v28, v80
    v_fmac_f32 v55, v29, v81
    v_fmac_f32 v55, v30, v82
    v_fmac_f32 v55, v31, v83
    v_fmac_f32 v55, v32, v84
    v_fmac_f32 v55, v33, v85
    v_fmac_f32 v55, v34, v86
    v_fmac_f32 v55, v35, v87
    v_fmac_f32 v55, v36, v88
    v_fmac_f32 v55, v37, v89
    v_fmac_f32 v55, v38, v90
    v_fmac_f32 v55, v39, v91
    ds_read_b128 v[72:75], v7 offset:768
    ds_read_b128 v[76:79], v7 offset:784
    ds_read_b128 v[80:83], v7 offset:800
    ds_read_b128 v[84:87], v7 offset:816
    ds_read_b128 v[88:91], v7 offset:832
    s_waitcnt lgkmcnt(0)
    v_mul_f32 v56, v20, v72
    v_fmac_f32 v56, v21, v73
    v_fmac_f32 v56, v22, v74
    v_fmac_f32 v56, v23, v75
    v_fmac_f32 v56, v24, v76
    v_fmac_f32 v56, v25, v77
    v_fmac_f32 v56, v26, v78
    v_fmac_f32 v56, v27, v79
    v_fmac_f32 v56, v28, v80
    v_fmac_f32 v56, v29, v81
    v_fmac_f32 v56, v30, v82
    v_fmac_f32 v56, v31, v83
    v_fmac_f32 v56, v32, v84
    v_fmac_f32 v56, v33, v85
    v_fmac_f32 v56, v34, v86
    v_fmac_f32 v56, v35, v87
    v_fmac_f32 v56, v36, v88
    v_fmac_f32 v56, v37, v89
    v_fmac_f32 v56, v38, v90
    v_fmac_f32 v56, v39, v91
    ds_read_b128 v[72:75], v7 offset:896
    ds_read_b128 v[76:79], v7 offset:912
    ds_read_b128 v[80:83], v7 offset:928
    ds_read_b128 v[84:87], v7 offset:944
    ds_read_b128 v[88:91], v7 offset:960
    s_waitcnt lgkmcnt(0)
    v_mul_f32 v57, v20, v72
    v_fmac_f32 v57, v21, v73
    v_fmac_f32 v57, v22, v74
    v_fmac_f32 v57, v23, v75
    v_fmac_f32 v57, v24, v76
    v_fmac_f32 v57, v25, v77
    v_fmac_f32 v57, v26, v78
    v_fmac_f32 v57, v27, v79
    v_fmac_f32 v57, v28, v80
    v_fmac_f32 v57, v29, v81
    v_fmac_f32 v57, v30, v82
    v_fmac_f32 v57, v31, v83
    v_fmac_f32 v57, v32, v84
    v_fmac_f32 v57, v33, v85
    v_fmac_f32 v57, v34, v86
    v_fmac_f32 v57, v35, v87
    v_fmac_f32 v57, v36, v88
    v_fmac_f32 v57, v37, v89
    v_fmac_f32 v57, v38, v90
    v_fmac_f32 v57, v39, v91
    ds_read_b128 v[72:75], v7 offset:1024
    ds_read_b128 v[76:79], v7 offset:1040
    ds_read_b128 v[80:83], v7 offset:1056
    ds_read_b128 v[84:87], v7 offset:1072
    ds_read_b128 v[88:91], v7 offset:1088
    s_waitcnt lgkmcnt(0)
    v_mul_f32 v58, v20, v72
    v_fmac_f32 v58, v21, v73
    v_fmac_f32 v58, v22, v74
    v_fmac_f32 v58, v23, v75
    v_fmac_f32 v58, v24, v76
    v_fmac_f32 v58, v25, v77
    v_fmac_f32 v58, v26, v78
    v_fmac_f32 v58, v27, v79
    v_fmac_f32 v58, v28, v80
    v_fmac_f32 v58, v29, v81
    v_fmac_f32 v58, v30, v82
    v_fmac_f32 v58, v31, v83
    v_fmac_f32 v58, v32, v84
    v_fmac_f32 v58, v33, v85
    v_fmac_f32 v58, v34, v86
    v_fmac_f32 v58, v35, v87
    v_fmac_f32 v58, v36, v88
    v_fmac_f32 v58, v37, v89
    v_fmac_f32 v58, v38, v90
    v_fmac_f32 v58, v39, v91
    ds_read_b128 v[72:75], v7 offset:1152
    ds_read_b128 v[76:79], v7 offset:1168
    ds_read_b128 v[80:83], v7 offset:1184
    ds_read_b128 v[84:87], v7 offset:1200
    ds_read_b128 v[88:91], v7 offset:1216
    s_waitcnt lgkmcnt(0)
    v_mul_f32 v59, v20, v72
    v_fmac_f32 v59, v21, v73
    v_fmac_f32 v59, v22, v74
    v_fmac_f32 v59, v23, v75
    v_fmac_f32 v59, v24, v76
    v_fmac_f32 v59, v25, v77
    v_fmac_f32 v59, v26, v78
    v_fmac_f32 v59, v27, v79
    v_fmac_f32 v59, v28, v80
    v_fmac_f32 v59, v29, v81
    v_fmac_f32 v59, v30, v82
    v_fmac_f32 v59, v31, v83
    v_fmac_f32 v59, v32, v84
    v_fmac_f32 v59, v33, v85
    v_fmac_f32 v59, v34, v86
    v_fmac_f32 v59, v35, v87
    v_fmac_f32 v59, v36, v88
    v_fmac_f32 v59, v37, v89
    v_fmac_f32 v59, v38, v90
    v_fmac_f32 v59, v39, v91
    ds_read_b128 v[72:75], v7 offset:1280
    ds_read_b128 v[76:79], v7 offset:1296
    ds_read_b128 v[80:83], v7 offset:1312
    ds_read_b128 v[84:87], v7 offset:1328
    ds_read_b128 v[88:91], v7 offset:1344
    s_waitcnt lgkmcnt(0)
    v_mul_f32 v60, v20, v72
    v_fmac_f32 v60, v21, v73
    v_fmac_f32 v60, v22, v74
    v_fmac_f32 v60, v23, v75
    v_fmac_f32 v60, v24, v76
    v_fmac_f32 v60, v25, v77
    v_fmac_f32 v60, v26, v78
    v_fmac_f32 v60, v27, v79
    v_fmac_f32 v60, v28, v80
    v_fmac_f32 v60, v29, v81
    v_fmac_f32 v60, v30, v82
    v_fmac_f32 v60, v31, v83
    v_fmac_f32 v60, v32, v84
    v_fmac_f32 v60, v33, v85
    v_fmac_f32 v60, v34, v86
    v_fmac_f32 v60, v35, v87
    v_fmac_f32 v60, v36, v88
    v_fmac_f32 v60, v37, v89
    v_fmac_f32 v60, v38, v90
    v_fmac_f32 v60, v39, v91
    ds_read_b128 v[72:75], v7 offset:1408
    ds_read_b128 v[76:79], v7 offset:1424
    ds_read_b128 v[80:83], v7 offset:1440
    ds_read_b128 v[84:87], v7 offset:1456
    ds_read_b128 v[88:91], v7 offset:1472
    s_waitcnt lgkmcnt(0)
    v_mul_f32 v61, v20, v72
    v_fmac_f32 v61, v21, v73
    v_fmac_f32 v61, v22, v74
    v_fmac_f32 v61, v23, v75
    v_fmac_f32 v61, v24, v76
    v_fmac_f32 v61, v25, v77
    v_fmac_f32 v61, v26, v78
    v_fmac_f32 v61, v27, v79
    v_fmac_f32 v61, v28, v80
    v_fmac_f32 v61, v29, v81
    v_fmac_f32 v61, v30, v82
    v_fmac_f32 v61, v31, v83
    v_fmac_f32 v61, v32, v84
    v_fmac_f32 v61, v33, v85
    v_fmac_f32 v61, v34, v86
    v_fmac_f32 v61, v35, v87
    v_fmac_f32 v61, v36, v88
    v_fmac_f32 v61, v37, v89
    v_fmac_f32 v61, v38, v90
    v_fmac_f32 v61, v39, v91
    ds_read_b128 v[72:75], v7 offset:1536
    ds_read_b128 v[76:79], v7 offset:1552
    ds_read_b128 v[80:83], v7 offset:1568
    ds_read_b128 v[84:87], v7 offset:1584
    ds_read_b128 v[88:91], v7 offset:1600
    s_waitcnt lgkmcnt(0)
    v_mul_f32 v62, v20, v72
    v_fmac_f32 v62, v21, v73
    v_fmac_f32 v62, v22, v74
    v_fmac_f32 v62, v23, v75
    v_fmac_f32 v62, v24, v76
    v_fmac_f32 v62, v25, v77
    v_fmac_f32 v62, v26, v78
    v_fmac_f32 v62, v27, v79
    v_fmac_f32 v62, v28, v80
    v_fmac_f32 v62, v29, v81
    v_fmac_f32 v62, v30, v82
    v_fmac_f32 v62, v31, v83
    v_fmac_f32 v62, v32, v84
    v_fmac_f32 v62, v33, v85
    v_fmac_f32 v62, v34, v86
    v_fmac_f32 v62, v35, v87
    v_fmac_f32 v62, v36, v88
    v_fmac_f32 v62, v37, v89
    v_fmac_f32 v62, v38, v90
    v_fmac_f32 v62, v39, v91
    ds_read_b128 v[72:75], v7 offset:1664
    ds_read_b128 v[76:79], v7 offset:1680
    ds_read_b128 v[80:83], v7 offset:1696
    ds_read_b128 v[84:87], v7 offset:1712
    ds_read_b128 v[88:91], v7 offset:1728
    s_waitcnt lgkmcnt(0)
    v_mul_f32 v63, v20, v72
    v_fmac_f32 v63, v21, v73
    v_fmac_f32 v63, v22, v74
    v_fmac_f32 v63, v23, v75
    v_fmac_f32 v63, v24, v76
    v_fmac_f32 v63, v25, v77
    v_fmac_f32 v63, v26, v78
    v_fmac_f32 v63, v27, v79
    v_fmac_f32 v63, v28, v80
    v_fmac_f32 v63, v29, v81
    v_fmac_f32 v63, v30, v82
    v_fmac_f32 v63, v31, v83
    v_fmac_f32 v63, v32, v84
    v_fmac_f32 v63, v33, v85
    v_fmac_f32 v63, v34, v86
    v_fmac_f32 v63, v35, v87
    v_fmac_f32 v63, v36, v88
    v_fmac_f32 v63, v37, v89
    v_fmac_f32 v63, v38, v90
    v_fmac_f32 v63, v39, v91
    ds_read_b128 v[72:75], v7 offset:1792
    ds_read_b128 v[76:79], v7 offset:1808
    ds_read_b128 v[80:83], v7 offset:1824
    ds_read_b128 v[84:87], v7 offset:1840
    ds_read_b128 v[88:91], v7 offset:1856
    s_waitcnt lgkmcnt(0)
    v_mul_f32 v64, v20, v72
    v_fmac_f32 v64, v21, v73
    v_fmac_f32 v64, v22, v74
    v_fmac_f32 v64, v23, v75
    v_fmac_f32 v64, v24, v76
    v_fmac_f32 v64, v25, v77
    v_fmac_f32 v64, v26, v78
    v_fmac_f32 v64, v27, v79
    v_fmac_f32 v64, v28, v80
    v_fmac_f32 v64, v29, v81
    v_fmac_f32 v64, v30, v82
    v_fmac_f32 v64, v31, v83
    v_fmac_f32 v64, v32, v84
    v_fmac_f32 v64, v33, v85
    v_fmac_f32 v64, v34, v86
    v_fmac_f32 v64, v35, v87
    v_fmac_f32 v64, v36, v88
    v_fmac_f32 v64, v37, v89
    v_fmac_f32 v64, v38, v90
    v_fmac_f32 v64, v39, v91
    ds_read_b128 v[72:75], v7 offset:1920
    ds_read_b128 v[76:79], v7 offset:1936
    ds_read_b128 v[80:83], v7 offset:1952
    ds_read_b128 v[84:87], v7 offset:1968
    ds_read_b128 v[88:91], v7 offset:1984
    s_waitcnt lgkmcnt(0)
    v_mul_f32 v65, v20, v72
    v_fmac_f32 v65, v21, v73
    v_fmac_f32 v65, v22, v74
    v_fmac_f32 v65, v23, v75
    v_fmac_f32 v65, v24, v76
    v_fmac_f32 v65, v25, v77
    v_fmac_f32 v65, v26, v78
    v_fmac_f32 v65, v27, v79
    v_fmac_f32 v65, v28, v80
    v_fmac_f32 v65, v29, v81
    v_fmac_f32 v65, v30, v82
    v_fmac_f32 v65, v31, v83
    v_fmac_f32 v65, v32, v84
    v_fmac_f32 v65, v33, v85
    v_fmac_f32 v65, v34, v86
    v_fmac_f32 v65, v35, v87
    v_fmac_f32 v65, v36, v88
    v_fmac_f32 v65, v37, v89
    v_fmac_f32 v65, v38, v90
    v_fmac_f32 v65, v39, v91
    ds_read_b128 v[72:75], v7 offset:2048
    ds_read_b128 v[76:79], v7 offset:2064
    ds_read_b128 v[80:83], v7 offset:2080
    ds_read_b128 v[84:87], v7 offset:2096
    ds_read_b128 v[88:91], v7 offset:2112
    s_waitcnt lgkmcnt(0)
    v_mul_f32 v66, v20, v72
    v_fmac_f32 v66, v21, v73
    v_fmac_f32 v66, v22, v74
    v_fmac_f32 v66, v23, v75
    v_fmac_f32 v66, v24, v76
    v_fmac_f32 v66, v25, v77
    v_fmac_f32 v66, v26, v78
    v_fmac_f32 v66, v27, v79
    v_fmac_f32 v66, v28, v80
    v_fmac_f32 v66, v29, v81
    v_fmac_f32 v66, v30, v82
    v_fmac_f32 v66, v31, v83
    v_fmac_f32 v66, v32, v84
    v_fmac_f32 v66, v33, v85
    v_fmac_f32 v66, v34, v86
    v_fmac_f32 v66, v35, v87
    v_fmac_f32 v66, v36, v88
    v_fmac_f32 v66, v37, v89
    v_fmac_f32 v66, v38, v90
    v_fmac_f32 v66, v39, v91
    ds_read_b128 v[72:75], v7 offset:2176
    ds_read_b128 v[76:79], v7 offset:2192
    ds_read_b128 v[80:83], v7 offset:2208
    ds_read_b128 v[84:87], v7 offset:2224
    ds_read_b128 v[88:91], v7 offset:2240
    s_waitcnt lgkmcnt(0)
    v_mul_f32 v67, v20, v72
    v_fmac_f32 v67, v21, v73
    v_fmac_f32 v67, v22, v74
    v_fmac_f32 v67, v23, v75
    v_fmac_f32 v67, v24, v76
    v_fmac_f32 v67, v25, v77
    v_fmac_f32 v67, v26, v78
    v_fmac_f32 v67, v27, v79
    v_fmac_f32 v67, v28, v80
    v_fmac_f32 v67, v29, v81
    v_fmac_f32 v67, v30, v82
    v_fmac_f32 v67, v31, v83
    v_fmac_f32 v67, v32, v84
    v_fmac_f32 v67, v33, v85
    v_fmac_f32 v67, v34, v86
    v_fmac_f32 v67, v35, v87
    v_fmac_f32 v67, v36, v88
    v_fmac_f32 v67, v37, v89
    v_fmac_f32 v67, v38, v90
    v_fmac_f32 v67, v39, v91
    ds_read_b128 v[72:75], v7 offset:2304
    ds_read_b128 v[76:79], v7 offset:2320
    ds_read_b128 v[80:83], v7 offset:2336
    ds_read_b128 v[84:87], v7 offset:2352
    ds_read_b128 v[88:91], v7 offset:2368
    s_waitcnt lgkmcnt(0)
    v_mul_f32 v68, v20, v72
    v_fmac_f32 v68, v21, v73
    v_fmac_f32 v68, v22, v74
    v_fmac_f32 v68, v23, v75
    v_fmac_f32 v68, v24, v76
    v_fmac_f32 v68, v25, v77
    v_fmac_f32 v68, v26, v78
    v_fmac_f32 v68, v27, v79
    v_fmac_f32 v68, v28, v80
    v_fmac_f32 v68, v29, v81
    v_fmac_f32 v68, v30, v82
    v_fmac_f32 v68, v31, v83
    v_fmac_f32 v68, v32, v84
    v_fmac_f32 v68, v33, v85
    v_fmac_f32 v68, v34, v86
    v_fmac_f32 v68, v35, v87
    v_fmac_f32 v68, v36, v88
    v_fmac_f32 v68, v37, v89
    v_fmac_f32 v68, v38, v90
    v_fmac_f32 v68, v39, v91
    ds_read_b128 v[72:75], v7 offset:2432
    ds_read_b128 v[76:79], v7 offset:2448
    ds_read_b128 v[80:83], v7 offset:2464
    ds_read_b128 v[84:87], v7 offset:2480
    ds_read_b128 v[88:91], v7 offset:2496
    s_waitcnt lgkmcnt(0)
    v_mul_f32 v69, v20, v72
    v_fmac_f32 v69, v21, v73
    v_fmac_f32 v69, v22, v74
    v_fmac_f32 v69, v23, v75
    v_fmac_f32 v69, v24, v76
    v_fmac_f32 v69, v25, v77
    v_fmac_f32 v69, v26, v78
    v_fmac_f32 v69, v27, v79
    v_fmac_f32 v69, v28, v80
    v_fmac_f32 v69, v29, v81
    v_fmac_f32 v69, v30, v82
    v_fmac_f32 v69, v31, v83
    v_fmac_f32 v69, v32, v84
    v_fmac_f32 v69, v33, v85
    v_fmac_f32 v69, v34, v86
    v_fmac_f32 v69, v35, v87
    v_fmac_f32 v69, v36, v88
    v_fmac_f32 v69, v37, v89
    v_fmac_f32 v69, v38, v90
    v_fmac_f32 v69, v39, v91
    ds_read_b128 v[72:75], v7 offset:2560
    ds_read_b128 v[76:79], v7 offset:2576
    ds_read_b128 v[80:83], v7 offset:2592
    ds_read_b128 v[84:87], v7 offset:2608
    ds_read_b128 v[88:91], v7 offset:2624
    s_waitcnt lgkmcnt(0)
    v_mul_f32 v70, v20, v72
    v_fmac_f32 v70, v21, v73
    v_fmac_f32 v70, v22, v74
    v_fmac_f32 v70, v23, v75
    v_fmac_f32 v70, v24, v76
    v_fmac_f32 v70, v25, v77
    v_fmac_f32 v70, v26, v78
    v_fmac_f32 v70, v27, v79
    v_fmac_f32 v70, v28, v80
    v_fmac_f32 v70, v29, v81
    v_fmac_f32 v70, v30, v82
    v_fmac_f32 v70, v31, v83
    v_fmac_f32 v70, v32, v84
    v_fmac_f32 v70, v33, v85
    v_fmac_f32 v70, v34, v86
    v_fmac_f32 v70, v35, v87
    v_fmac_f32 v70, v36, v88
    v_fmac_f32 v70, v37, v89
    v_fmac_f32 v70, v38, v90
    v_fmac_f32 v70, v39, v91
    v_add_f32 v70, 0x358637bd, v70
    v_rcp_f32 v70, v70
    s_nop 0
    v_mul_f32 v50, v50, v70
    v_mul_f32 v51, v51, v70
    v_mul_f32 v52, v52, v70
    v_mul_f32 v53, v53, v70
    v_mul_f32 v54, v54, v70
    v_mul_f32 v55, v55, v70
    v_mul_f32 v56, v56, v70
    v_mul_f32 v57, v57, v70
    v_mul_f32 v58, v58, v70
    v_mul_f32 v59, v59, v70
    v_mul_f32 v60, v60, v70
    v_mul_f32 v61, v61, v70
    v_mul_f32 v62, v62, v70
    v_mul_f32 v63, v63, v70
    v_mul_f32 v64, v64, v70
    v_mul_f32 v65, v65, v70
    v_mul_f32 v66, v66, v70
    v_mul_f32 v67, v67, v70
    v_mul_f32 v68, v68, v70
    v_mul_f32 v69, v69, v70
    v_cvt_pk_bf16_f32 v8, v50, v51
    v_cvt_pk_bf16_f32 v9, v52, v53
    v_cvt_pk_bf16_f32 v10, v54, v55
    v_cvt_pk_bf16_f32 v11, v56, v57
    v_cvt_pk_bf16_f32 v12, v58, v59
    v_cvt_pk_bf16_f32 v13, v60, v61
    v_cvt_pk_bf16_f32 v14, v62, v63
    v_cvt_pk_bf16_f32 v15, v64, v65
    v_cvt_pk_bf16_f32 v16, v66, v67
    v_cvt_pk_bf16_f32 v17, v68, v69
    v_add_u32 v6, 239075328, v4
    buffer_store_dwordx2 v[8:9], v6, s[8:11], 0 offen offset:0
    buffer_store_dwordx2 v[10:11], v6, s[8:11], 0 offen offset:8
    buffer_store_dwordx2 v[12:13], v6, s[8:11], 0 offen offset:16
    buffer_store_dwordx2 v[14:15], v6, s[8:11], 0 offen offset:24
    buffer_store_dwordx2 v[16:17], v6, s[8:11], 0 offen offset:32
attn_a2_kernel_end:
    s_endpgm
.section .rodata,"a"
.p2align 6
.amdhsa_kernel attn_a2_kernel
  .amdhsa_next_free_vgpr 96
  .amdhsa_next_free_sgpr 40
  .amdhsa_accum_offset 96
  .amdhsa_group_segment_fixed_size 0
  .amdhsa_kernarg_size 104
  .amdhsa_user_sgpr_count 2
  .amdhsa_user_sgpr_kernarg_segment_ptr 1
  .amdhsa_system_sgpr_workgroup_id_x 1
.end_amdhsa_kernel
.text
.globl wo_a2_kernel
.p2align 8
.type wo_a2_kernel,@function
wo_a2_kernel:
    v_lshrrev_b32 v1, 6, v0
    v_and_b32 v2, 63, v0
    s_nop 0
    v_readfirstlane_b32 s3, v1
    s_cmp_ge_u32 s2, 128
    s_cbranch_scc1 wo_a2_kernel_end
    s_load_dwordx2 s[4:5], s[0:1], 96
    s_load_dwordx2 s[6:7], s[0:1], 80
    s_mul_i32 s20, s2, 1
    s_lshr_b32 s20, s20, 3
    s_mul_i32 s21, s20, 8
    s_sub_u32 s21, s2, s21
    s_lshl_b32 s20, s20, 2
    s_add_u32 s20, s20, s3
    s_mul_i32 s22, s20, 32
    s_mul_i32 s23, s21, 80
    s_waitcnt lgkmcnt(0)
    s_mov_b32 s8, s4
    s_mov_b32 s9, s5
    s_mov_b32 s10, 268435456
    s_mov_b32 s11, 0x00020000
    v_and_b32 v3, 15, v2
    v_lshrrev_b32 v4, 4, v2
    s_mov_b32 s24, 1280
    v_add_u32 v5, s22, v3
    v_mul_lo_u32 v5, v5, s24
    v_lshlrev_b32 v6, 4, v4
    v_add_u32 v5, v5, v6
    v_add_u32 v5, 239075328, v5
    v_mov_b32 v8, v5
    v_add_u32 v9, 20480, v5
    v_lshlrev_b32 v7, 4, v2
    s_mov_b32 s25, 0
    s_mov_b32 s26, 0
    s_mul_i32 s27, s21, 102400
    s_add_u32 s27, s27, s26
    s_add_u32 s27, s27, 246415360
    s_add_u32 s32, s27, 0
    s_add_u32 s33, s27, 20480
    s_add_u32 s34, s27, 40960
    s_add_u32 s35, s27, 61440
    s_add_u32 s36, s27, 81920
    v_accvgpr_write_b32 a0, 0
    v_accvgpr_write_b32 a1, 0
    v_accvgpr_write_b32 a2, 0
    v_accvgpr_write_b32 a3, 0
    v_accvgpr_write_b32 a4, 0
    v_accvgpr_write_b32 a5, 0
    v_accvgpr_write_b32 a6, 0
    v_accvgpr_write_b32 a7, 0
    v_accvgpr_write_b32 a8, 0
    v_accvgpr_write_b32 a9, 0
    v_accvgpr_write_b32 a10, 0
    v_accvgpr_write_b32 a11, 0
    v_accvgpr_write_b32 a12, 0
    v_accvgpr_write_b32 a13, 0
    v_accvgpr_write_b32 a14, 0
    v_accvgpr_write_b32 a15, 0
    v_accvgpr_write_b32 a16, 0
    v_accvgpr_write_b32 a17, 0
    v_accvgpr_write_b32 a18, 0
    v_accvgpr_write_b32 a19, 0
    v_accvgpr_write_b32 a20, 0
    v_accvgpr_write_b32 a21, 0
    v_accvgpr_write_b32 a22, 0
    v_accvgpr_write_b32 a23, 0
    v_accvgpr_write_b32 a24, 0
    v_accvgpr_write_b32 a25, 0
    v_accvgpr_write_b32 a26, 0
    v_accvgpr_write_b32 a27, 0
    v_accvgpr_write_b32 a28, 0
    v_accvgpr_write_b32 a29, 0
    v_accvgpr_write_b32 a30, 0
    v_accvgpr_write_b32 a31, 0
    v_accvgpr_write_b32 a32, 0
    v_accvgpr_write_b32 a33, 0
    v_accvgpr_write_b32 a34, 0
    v_accvgpr_write_b32 a35, 0
    v_accvgpr_write_b32 a36, 0
    v_accvgpr_write_b32 a37, 0
    v_accvgpr_write_b32 a38, 0
    v_accvgpr_write_b32 a39, 0
    buffer_load_dwordx4 v[16:19], v8, s[8:11], s25 offen
    buffer_load_dwordx4 v[20:23], v9, s[8:11], s25 offen
    buffer_load_dwordx4 v[24:27], v7, s[8:11], s32 offen
    buffer_load_dwordx4 v[28:31], v7, s[8:11], s33 offen
    buffer_load_dwordx4 v[32:35], v7, s[8:11], s34 offen
    buffer_load_dwordx4 v[36:39], v7, s[8:11], s35 offen
    buffer_load_dwordx4 v[40:43], v7, s[8:11], s36 offen
    s_mov_b32 s28, 10
wo_a2_kernel_loop0:
    s_add_u32 s25, s25, 64
    s_add_u32 s32, s32, 1024
    s_add_u32 s33, s33, 1024
    s_add_u32 s34, s34, 1024
    s_add_u32 s35, s35, 1024
    s_add_u32 s36, s36, 1024
    buffer_load_dwordx4 v[44:47], v8, s[8:11], s25 offen
    buffer_load_dwordx4 v[48:51], v9, s[8:11], s25 offen
    buffer_load_dwordx4 v[52:55], v7, s[8:11], s32 offen
    buffer_load_dwordx4 v[56:59], v7, s[8:11], s33 offen
    buffer_load_dwordx4 v[60:63], v7, s[8:11], s34 offen
    buffer_load_dwordx4 v[64:67], v7, s[8:11], s35 offen
    buffer_load_dwordx4 v[68:71], v7, s[8:11], s36 offen
    s_waitcnt vmcnt(7)
    v_mfma_f32_16x16x32_bf16 a[0:3], v[24:27], v[16:19], a[0:3]
    v_mfma_f32_16x16x32_bf16 a[20:23], v[24:27], v[20:23], a[20:23]
    v_mfma_f32_16x16x32_bf16 a[4:7], v[28:31], v[16:19], a[4:7]
    v_mfma_f32_16x16x32_bf16 a[24:27], v[28:31], v[20:23], a[24:27]
    v_mfma_f32_16x16x32_bf16 a[8:11], v[32:35], v[16:19], a[8:11]
    v_mfma_f32_16x16x32_bf16 a[28:31], v[32:35], v[20:23], a[28:31]
    v_mfma_f32_16x16x32_bf16 a[12:15], v[36:39], v[16:19], a[12:15]
    v_mfma_f32_16x16x32_bf16 a[32:35], v[36:39], v[20:23], a[32:35]
    v_mfma_f32_16x16x32_bf16 a[16:19], v[40:43], v[16:19], a[16:19]
    v_mfma_f32_16x16x32_bf16 a[36:39], v[40:43], v[20:23], a[36:39]
    s_sub_u32 s28, s28, 1
    s_cmp_eq_u32 s28, 0
    s_cbranch_scc1 wo_a2_kernel_loop0_last
    s_add_u32 s25, s25, 64
    s_add_u32 s32, s32, 1024
    s_add_u32 s33, s33, 1024
    s_add_u32 s34, s34, 1024
    s_add_u32 s35, s35, 1024
    s_add_u32 s36, s36, 1024
    buffer_load_dwordx4 v[16:19], v8, s[8:11], s25 offen
    buffer_load_dwordx4 v[20:23], v9, s[8:11], s25 offen
    buffer_load_dwordx4 v[24:27], v7, s[8:11], s32 offen
    buffer_load_dwordx4 v[28:31], v7, s[8:11], s33 offen
    buffer_load_dwordx4 v[32:35], v7, s[8:11], s34 offen
    buffer_load_dwordx4 v[36:39], v7, s[8:11], s35 offen
    buffer_load_dwordx4 v[40:43], v7, s[8:11], s36 offen
    s_waitcnt vmcnt(7)
    v_mfma_f32_16x16x32_bf16 a[0:3], v[52:55], v[44:47], a[0:3]
    v_mfma_f32_16x16x32_bf16 a[20:23], v[52:55], v[48:51], a[20:23]
    v_mfma_f32_16x16x32_bf16 a[4:7], v[56:59], v[44:47], a[4:7]
    v_mfma_f32_16x16x32_bf16 a[24:27], v[56:59], v[48:51], a[24:27]
    v_mfma_f32_16x16x32_bf16 a[8:11], v[60:63], v[44:47], a[8:11]
    v_mfma_f32_16x16x32_bf16 a[28:31], v[60:63], v[48:51], a[28:31]
    v_mfma_f32_16x16x32_bf16 a[12:15], v[64:67], v[44:47], a[12:15]
    v_mfma_f32_16x16x32_bf16 a[32:35], v[64:67], v[48:51], a[32:35]
    v_mfma_f32_16x16x32_bf16 a[16:19], v[68:71], v[44:47], a[16:19]
    v_mfma_f32_16x16x32_bf16 a[36:39], v[68:71], v[48:51], a[36:39]
    s_branch wo_a2_kernel_loop0
wo_a2_kernel_loop0_last:
    s_waitcnt vmcnt(0)
    v_mfma_f32_16x16x32_bf16 a[0:3], v[52:55], v[44:47], a[0:3]
    v_mfma_f32_16x16x32_bf16 a[20:23], v[52:55], v[48:51], a[20:23]
    v_mfma_f32_16x16x32_bf16 a[4:7], v[56:59], v[44:47], a[4:7]
    v_mfma_f32_16x16x32_bf16 a[24:27], v[56:59], v[48:51], a[24:27]
    v_mfma_f32_16x16x32_bf16 a[8:11], v[60:63], v[44:47], a[8:11]
    v_mfma_f32_16x16x32_bf16 a[28:31], v[60:63], v[48:51], a[28:31]
    v_mfma_f32_16x16x32_bf16 a[12:15], v[64:67], v[44:47], a[12:15]
    v_mfma_f32_16x16x32_bf16 a[32:35], v[64:67], v[48:51], a[32:35]
    v_mfma_f32_16x16x32_bf16 a[16:19], v[68:71], v[44:47], a[16:19]
    v_mfma_f32_16x16x32_bf16 a[36:39], v[68:71], v[48:51], a[36:39]
    s_nop 7
    s_nop 7
    s_mov_b32 s24, 1280
    v_add_u32 v5, s22, v3
    v_mul_lo_u32 v5, v5, s24
    v_lshlrev_b32 v6, 3, v4
    s_lshl_b32 s29, s23, 1
    v_add3_u32 v5, v5, v6, s29
    v_add_u32 v6, 247463936, v5
    buffer_load_dwordx2 v[72:73], v6, s[8:11], 0 offen
    v_accvgpr_read_b32 v76, a0
    v_accvgpr_read_b32 v77, a1
    v_accvgpr_read_b32 v78, a2
    v_accvgpr_read_b32 v79, a3
    v_cvt_pk_bf16_f32 v80, v76, v77
    v_cvt_pk_bf16_f32 v81, v78, v79
    s_waitcnt vmcnt(0)
    v_lshlrev_b32 v76, 16, v80
    v_and_b32 v77, 0xffff0000, v80
    v_lshlrev_b32 v82, 16, v72
    v_and_b32 v83, 0xffff0000, v72
    v_add_f32 v76, v76, v82
    v_add_f32 v77, v77, v83
    v_lshlrev_b32 v78, 16, v81
    v_and_b32 v79, 0xffff0000, v81
    v_lshlrev_b32 v82, 16, v73
    v_and_b32 v83, 0xffff0000, v73
    v_add_f32 v78, v78, v82
    v_add_f32 v79, v79, v83
    v_cvt_pk_bf16_f32 v80, v76, v77
    v_cvt_pk_bf16_f32 v81, v78, v79
    v_add_u32 v6, 226492416, v5
    buffer_store_dwordx2 v[80:81], v6, s[8:11], 0 offen
    v_add_u32 v6, 247463968, v5
    buffer_load_dwordx2 v[72:73], v6, s[8:11], 0 offen
    v_accvgpr_read_b32 v76, a4
    v_accvgpr_read_b32 v77, a5
    v_accvgpr_read_b32 v78, a6
    v_accvgpr_read_b32 v79, a7
    v_cvt_pk_bf16_f32 v80, v76, v77
    v_cvt_pk_bf16_f32 v81, v78, v79
    s_waitcnt vmcnt(0)
    v_lshlrev_b32 v76, 16, v80
    v_and_b32 v77, 0xffff0000, v80
    v_lshlrev_b32 v82, 16, v72
    v_and_b32 v83, 0xffff0000, v72
    v_add_f32 v76, v76, v82
    v_add_f32 v77, v77, v83
    v_lshlrev_b32 v78, 16, v81
    v_and_b32 v79, 0xffff0000, v81
    v_lshlrev_b32 v82, 16, v73
    v_and_b32 v83, 0xffff0000, v73
    v_add_f32 v78, v78, v82
    v_add_f32 v79, v79, v83
    v_cvt_pk_bf16_f32 v80, v76, v77
    v_cvt_pk_bf16_f32 v81, v78, v79
    v_add_u32 v6, 226492448, v5
    buffer_store_dwordx2 v[80:81], v6, s[8:11], 0 offen
    v_add_u32 v6, 247464000, v5
    buffer_load_dwordx2 v[72:73], v6, s[8:11], 0 offen
    v_accvgpr_read_b32 v76, a8
    v_accvgpr_read_b32 v77, a9
    v_accvgpr_read_b32 v78, a10
    v_accvgpr_read_b32 v79, a11
    v_cvt_pk_bf16_f32 v80, v76, v77
    v_cvt_pk_bf16_f32 v81, v78, v79
    s_waitcnt vmcnt(0)
    v_lshlrev_b32 v76, 16, v80
    v_and_b32 v77, 0xffff0000, v80
    v_lshlrev_b32 v82, 16, v72
    v_and_b32 v83, 0xffff0000, v72
    v_add_f32 v76, v76, v82
    v_add_f32 v77, v77, v83
    v_lshlrev_b32 v78, 16, v81
    v_and_b32 v79, 0xffff0000, v81
    v_lshlrev_b32 v82, 16, v73
    v_and_b32 v83, 0xffff0000, v73
    v_add_f32 v78, v78, v82
    v_add_f32 v79, v79, v83
    v_cvt_pk_bf16_f32 v80, v76, v77
    v_cvt_pk_bf16_f32 v81, v78, v79
    v_add_u32 v6, 226492480, v5
    buffer_store_dwordx2 v[80:81], v6, s[8:11], 0 offen
    v_add_u32 v6, 247464032, v5
    buffer_load_dwordx2 v[72:73], v6, s[8:11], 0 offen
    v_accvgpr_read_b32 v76, a12
    v_accvgpr_read_b32 v77, a13
    v_accvgpr_read_b32 v78, a14
    v_accvgpr_read_b32 v79, a15
    v_cvt_pk_bf16_f32 v80, v76, v77
    v_cvt_pk_bf16_f32 v81, v78, v79
    s_waitcnt vmcnt(0)
    v_lshlrev_b32 v76, 16, v80
    v_and_b32 v77, 0xffff0000, v80
    v_lshlrev_b32 v82, 16, v72
    v_and_b32 v83, 0xffff0000, v72
    v_add_f32 v76, v76, v82
    v_add_f32 v77, v77, v83
    v_lshlrev_b32 v78, 16, v81
    v_and_b32 v79, 0xffff0000, v81
    v_lshlrev_b32 v82, 16, v73
    v_and_b32 v83, 0xffff0000, v73
    v_add_f32 v78, v78, v82
    v_add_f32 v79, v79, v83
    v_cvt_pk_bf16_f32 v80, v76, v77
    v_cvt_pk_bf16_f32 v81, v78, v79
    v_add_u32 v6, 226492512, v5
    buffer_store_dwordx2 v[80:81], v6, s[8:11], 0 offen
    v_add_u32 v6, 247464064, v5
    buffer_load_dwordx2 v[72:73], v6, s[8:11], 0 offen
    v_accvgpr_read_b32 v76, a16
    v_accvgpr_read_b32 v77, a17
    v_accvgpr_read_b32 v78, a18
    v_accvgpr_read_b32 v79, a19
    v_cvt_pk_bf16_f32 v80, v76, v77
    v_cvt_pk_bf16_f32 v81, v78, v79
    s_waitcnt vmcnt(0)
    v_lshlrev_b32 v76, 16, v80
    v_and_b32 v77, 0xffff0000, v80
    v_lshlrev_b32 v82, 16, v72
    v_and_b32 v83, 0xffff0000, v72
    v_add_f32 v76, v76, v82
    v_add_f32 v77, v77, v83
    v_lshlrev_b32 v78, 16, v81
    v_and_b32 v79, 0xffff0000, v81
    v_lshlrev_b32 v82, 16, v73
    v_and_b32 v83, 0xffff0000, v73
    v_add_f32 v78, v78, v82
    v_add_f32 v79, v79, v83
    v_cvt_pk_bf16_f32 v80, v76, v77
    v_cvt_pk_bf16_f32 v81, v78, v79
    v_add_u32 v6, 226492544, v5
    buffer_store_dwordx2 v[80:81], v6, s[8:11], 0 offen
    v_add_u32 v6, 247484416, v5
    buffer_load_dwordx2 v[72:73], v6, s[8:11], 0 offen
    v_accvgpr_read_b32 v76, a20
    v_accvgpr_read_b32 v77, a21
    v_accvgpr_read_b32 v78, a22
    v_accvgpr_read_b32 v79, a23
    v_cvt_pk_bf16_f32 v80, v76, v77
    v_cvt_pk_bf16_f32 v81, v78, v79
    s_waitcnt vmcnt(0)
    v_lshlrev_b32 v76, 16, v80
    v_and_b32 v77, 0xffff0000, v80
    v_lshlrev_b32 v82, 16, v72
    v_and_b32 v83, 0xffff0000, v72
    v_add_f32 v76, v76, v82
    v_add_f32 v77, v77, v83
    v_lshlrev_b32 v78, 16, v81
    v_and_b32 v79, 0xffff0000, v81
    v_lshlrev_b32 v82, 16, v73
    v_and_b32 v83, 0xffff0000, v73
    v_add_f32 v78, v78, v82
    v_add_f32 v79, v79, v83
    v_cvt_pk_bf16_f32 v80, v76, v77
    v_cvt_pk_bf16_f32 v81, v78, v79
    v_add_u32 v6, 226512896, v5
    buffer_store_dwordx2 v[80:81], v6, s[8:11], 0 offen
    v_add_u32 v6, 247484448, v5
    buffer_load_dwordx2 v[72:73], v6, s[8:11], 0 offen
    v_accvgpr_read_b32 v76, a24
    v_accvgpr_read_b32 v77, a25
    v_accvgpr_read_b32 v78, a26
    v_accvgpr_read_b32 v79, a27
    v_cvt_pk_bf16_f32 v80, v76, v77
    v_cvt_pk_bf16_f32 v81, v78, v79
    s_waitcnt vmcnt(0)
    v_lshlrev_b32 v76, 16, v80
    v_and_b32 v77, 0xffff0000, v80
    v_lshlrev_b32 v82, 16, v72
    v_and_b32 v83, 0xffff0000, v72
    v_add_f32 v76, v76, v82
    v_add_f32 v77, v77, v83
    v_lshlrev_b32 v78, 16, v81
    v_and_b32 v79, 0xffff0000, v81
    v_lshlrev_b32 v82, 16, v73
    v_and_b32 v83, 0xffff0000, v73
    v_add_f32 v78, v78, v82
    v_add_f32 v79, v79, v83
    v_cvt_pk_bf16_f32 v80, v76, v77
    v_cvt_pk_bf16_f32 v81, v78, v79
    v_add_u32 v6, 226512928, v5
    buffer_store_dwordx2 v[80:81], v6, s[8:11], 0 offen
    v_add_u32 v6, 247484480, v5
    buffer_load_dwordx2 v[72:73], v6, s[8:11], 0 offen
    v_accvgpr_read_b32 v76, a28
    v_accvgpr_read_b32 v77, a29
    v_accvgpr_read_b32 v78, a30
    v_accvgpr_read_b32 v79, a31
    v_cvt_pk_bf16_f32 v80, v76, v77
    v_cvt_pk_bf16_f32 v81, v78, v79
    s_waitcnt vmcnt(0)
    v_lshlrev_b32 v76, 16, v80
    v_and_b32 v77, 0xffff0000, v80
    v_lshlrev_b32 v82, 16, v72
    v_and_b32 v83, 0xffff0000, v72
    v_add_f32 v76, v76, v82
    v_add_f32 v77, v77, v83
    v_lshlrev_b32 v78, 16, v81
    v_and_b32 v79, 0xffff0000, v81
    v_lshlrev_b32 v82, 16, v73
    v_and_b32 v83, 0xffff0000, v73
    v_add_f32 v78, v78, v82
    v_add_f32 v79, v79, v83
    v_cvt_pk_bf16_f32 v80, v76, v77
    v_cvt_pk_bf16_f32 v81, v78, v79
    v_add_u32 v6, 226512960, v5
    buffer_store_dwordx2 v[80:81], v6, s[8:11], 0 offen
    v_add_u32 v6, 247484512, v5
    buffer_load_dwordx2 v[72:73], v6, s[8:11], 0 offen
    v_accvgpr_read_b32 v76, a32
    v_accvgpr_read_b32 v77, a33
    v_accvgpr_read_b32 v78, a34
    v_accvgpr_read_b32 v79, a35
    v_cvt_pk_bf16_f32 v80, v76, v77
    v_cvt_pk_bf16_f32 v81, v78, v79
    s_waitcnt vmcnt(0)
    v_lshlrev_b32 v76, 16, v80
    v_and_b32 v77, 0xffff0000, v80
    v_lshlrev_b32 v82, 16, v72
    v_and_b32 v83, 0xffff0000, v72
    v_add_f32 v76, v76, v82
    v_add_f32 v77, v77, v83
    v_lshlrev_b32 v78, 16, v81
    v_and_b32 v79, 0xffff0000, v81
    v_lshlrev_b32 v82, 16, v73
    v_and_b32 v83, 0xffff0000, v73
    v_add_f32 v78, v78, v82
    v_add_f32 v79, v79, v83
    v_cvt_pk_bf16_f32 v80, v76, v77
    v_cvt_pk_bf16_f32 v81, v78, v79
    v_add_u32 v6, 226512992, v5
    buffer_store_dwordx2 v[80:81], v6, s[8:11], 0 offen
    v_add_u32 v6, 247484544, v5
    buffer_load_dwordx2 v[72:73], v6, s[8:11], 0 offen
    v_accvgpr_read_b32 v76, a36
    v_accvgpr_read_b32 v77, a37
    v_accvgpr_read_b32 v78, a38
    v_accvgpr_read_b32 v79, a39
    v_cvt_pk_bf16_f32 v80, v76, v77
    v_cvt_pk_bf16_f32 v81, v78, v79
    s_waitcnt vmcnt(0)
    v_lshlrev_b32 v76, 16, v80
    v_and_b32 v77, 0xffff0000, v80
    v_lshlrev_b32 v82, 16, v72
    v_and_b32 v83, 0xffff0000, v72
    v_add_f32 v76, v76, v82
    v_add_f32 v77, v77, v83
    v_lshlrev_b32 v78, 16, v81
    v_and_b32 v79, 0xffff0000, v81
    v_lshlrev_b32 v82, 16, v73
    v_and_b32 v83, 0xffff0000, v73
    v_add_f32 v78, v78, v82
    v_add_f32 v79, v79, v83
    v_cvt_pk_bf16_f32 v80, v76, v77
    v_cvt_pk_bf16_f32 v81, v78, v79
    v_add_u32 v6, 226513024, v5
    buffer_store_dwordx2 v[80:81], v6, s[8:11], 0 offen
wo_a2_kernel_end:
    s_endpgm
.section .rodata,"a"
.p2align 6
.amdhsa_kernel wo_a2_kernel
  .amdhsa_next_free_vgpr 136
  .amdhsa_next_free_sgpr 64
  .amdhsa_accum_offset 96
  .amdhsa_group_segment_fixed_size 0
  .amdhsa_kernarg_size 104
  .amdhsa_user_sgpr_count 2
  .amdhsa_user_sgpr_kernarg_segment_ptr 1
  .amdhsa_system_sgpr_workgroup_id_x 1
.end_amdhsa_kernel
.text
.globl ln_b2_kernel
.p2align 8
.type ln_b2_kernel,@function
ln_b2_kernel:
    s_cmp_gt_u32 s2, 512
    s_cbranch_scc1 ln_b2_kernel_end
    s_load_dwordx2 s[4:5], s[0:1], 96
    s_load_dwordx2 s[6:7], s[0:1], 32
    v_lshrrev_b32 v1, 6, v0
    v_and_b32 v0, 63, v0
    s_nop 0
    v_readfirstlane_b32 s13, v1
    s_waitcnt lgkmcnt(0)
    s_mov_b32 s8, s4
    s_mov_b32 s9, s5
    s_mov_b32 s10, 268435456
    s_mov_b32 s11, 0x00020000
    s_cmp_eq_u32 s2, 512
    s_cbranch_scc1 ln_b2_kernel_mem0
    s_lshl_b32 s20, s2, 2
    s_add_u32 s20, s20, s13
    s_mul_i32 s21, s20, 1280
    s_add_u32 s21, s21, 226492416
    v_lshlrev_b32 v3, 2, v0
    buffer_load_dword v4, v3, s[8:11], s21 offen offset:0
    buffer_load_dword v5, v3, s[8:11], s21 offen offset:256
    buffer_load_dword v6, v3, s[8:11], s21 offen offset:512
    buffer_load_dword v7, v3, s[8:11], s21 offen offset:768
    buffer_load_dword v8, v3, s[8:11], s21 offen offset:1024
    v_lshrrev_b32 v20, 4, v0
    v_lshlrev_b32 v20, 2, v20
    v_bfe_u32 v21, v0, 3, 1
    v_lshl_add_u32 v20, v21, 1, v20
    v_bfe_u32 v21, v0, 1, 1
    v_add_u32 v20, v20, v21
    v_lshlrev_b32 v20, 9, v20
    v_and_b32 v21, 1, v0
    v_lshl_add_u32 v20, v21, 3, v20
    v_bfe_u32 v21, v0, 2, 1
    v_lshl_add_u32 v23, v21, 2, v20
    s_lshr_b32 s22, s20, 5
    s_mul_i32 s22, s22, 40960
    s_and_b32 s23, s20, 31
    s_lshl_b32 s23, s23, 4
    s_add_u32 s22, s22, s23
    s_add_u32 s22, s22, 220200960
    s_waitcnt vmcnt(0)
    v_lshlrev_b32 v10, 16, v4
    v_and_b32 v11, 0xffff0000, v4
    v_lshlrev_b32 v12, 16, v5
    v_and_b32 v13, 0xffff0000, v5
    v_lshlrev_b32 v14, 16, v6
    v_and_b32 v15, 0xffff0000, v6
    v_lshlrev_b32 v16, 16, v7
    v_and_b32 v17, 0xffff0000, v7
    v_lshlrev_b32 v18, 16, v8
    v_and_b32 v19, 0xffff0000, v8
    v_add_f32 v20, v10, v11
    v_add_f32 v20, v20, v12
    v_add_f32 v20, v20, v13
    v_add_f32 v20, v20, v14
    v_add_f32 v20, v20, v15
    v_add_f32 v20, v20, v16
    v_add_f32 v20, v20, v17
    v_add_f32 v20, v20, v18
    v_add_f32 v20, v20, v19
    s_nop 1
    v_add_f32 v21, v20, v20 quad_perm:[1,0,3,2] row_mask:0xf bank_mask:0xf
    s_nop 1
    v_add_f32 v21, v21, v21 quad_perm:[2,3,0,1] row_mask:0xf bank_mask:0xf
    s_nop 1
    v_add_f32 v21, v21, v21 row_half_mirror row_mask:0xf bank_mask:0xf
    s_nop 1
    v_add_f32 v21, v21, v21 row_mirror row_mask:0xf bank_mask:0xf
    s_nop 1
    v_readlane_b32 s24, v21, 0
    v_readlane_b32 s25, v21, 16
    v_readlane_b32 s26, v21, 32
    v_readlane_b32 s27, v21, 48
    s_nop 1
    v_mov_b32 v20, s24
    v_add_f32 v20, s25, v20
    v_add_f32 v20, s26, v20
    v_add_f32 v20, s27, v20
    v_mul_f32 v20, 0x3acccccd, v20
    v_sub_f32 v10, v10, v20
    v_sub_f32 v11, v11, v20
    v_sub_f32 v12, v12, v20
    v_sub_f32 v13, v13, v20
    v_sub_f32 v14, v14, v20
    v_sub_f32 v15, v15, v20
    v_sub_f32 v16, v16, v20
    v_sub_f32 v17, v17, v20
    v_sub_f32 v18, v18, v20
    v_sub_f32 v19, v19, v20
    v_mul_f32 v21, v10, v10
    v_fmac_f32 v21, v11, v11
    v_fmac_f32 v21, v12, v12
    v_fmac_f32 v21, v13, v13
    v_fmac_f32 v21, v14, v14
    v_fmac_f32 v21, v15, v15
    v_fmac_f32 v21, v16, v16
    v_fmac_f32 v21, v17, v17
    v_fmac_f32 v21, v18, v18
    v_fmac_f32 v21, v19, v19
    s_nop 1
    v_add_f32 v22, v21, v21 quad_perm:[1,0,3,2] row_mask:0xf bank_mask:0xf
    s_nop 1
    v_add_f32 v22, v22, v22 quad_perm:[2,3,0,1] row_mask:0xf bank_mask:0xf
    s_nop 1
    v_add_f32 v22, v22, v22 row_half_mirror row_mask:0xf bank_mask:0xf
    s_nop 1
    v_add_f32 v22, v22, v22 row_mirror row_mask:0xf bank_mask:0xf
    s_nop 1
    v_readlane_b32 s24, v22, 0
    v_readlane_b32 s25, v22, 16
    v_readlane_b32 s26, v22, 32
    v_readlane_b32 s27, v22, 48
    s_nop 1
    v_mov_b32 v21, s24
    v_add_f32 v21, s25, v21
    v_add_f32 v21, s26, v21
    v_add_f32 v21, s27, v21
    v_mov_b32 v22, 0x3727c5ac
    v_fmac_f32 v22, 0x3acccccd, v21
    v_rsq_f32 v22, v22
    s_nop 0
    v_mul_f32 v10, v10, v22
    v_mul_f32 v11, v11, v22
    v_mul_f32 v12, v12, v22
    v_mul_f32 v13, v13, v22
    v_mul_f32 v14, v14, v22
    v_mul_f32 v15, v15, v22
    v_mul_f32 v16, v16, v22
    v_mul_f32 v17, v17, v22
    v_mul_f32 v18, v18, v22
    v_mul_f32 v19, v19, v22
    v_cvt_pk_bf16_f32 v4, v10, v11
    v_cvt_pk_bf16_f32 v5, v12, v13
    v_cvt_pk_bf16_f32 v6, v14, v15
    v_cvt_pk_bf16_f32 v7, v16, v17
    v_cvt_pk_bf16_f32 v8, v18, v19
    s_add_u32 s23, s22, 0
    buffer_store_dword v4, v23, s[8:11], s23 offen
    s_add_u32 s23, s22, 8192
    buffer_store_dword v5, v23, s[8:11], s23 offen
    s_add_u32 s23, s22, 16384
    buffer_store_dword v6, v23, s[8:11], s23 offen
    s_add_u32 s23, s22, 24576
    buffer_store_dword v7, v23, s[8:11], s23 offen
    s_add_u32 s23, s22, 32768
    buffer_store_dword v8, v23, s[8:11], s23 offen
    s_branch ln_b2_kernel_end
ln_b2_kernel_mem0:
    s_mov_b32 s16, s6
    s_mov_b32 s17, s7
    s_mov_b32 s18, 10240
    s_mov_b32 s19, 0x00020000
    s_sub_u32 s22, 0, s4
    s_and_b32 s22, s22, 0x1fffff
    s_mov_b32 s23, 10551304
    s_buffer_load_dword s24, s[8:11], s23
    s_waitcnt lgkmcnt(0)
    s_and_b32 s24, s24, 8192
    s_add_u32 s22, s22, 4194304
    s_xor_b32 s25, s24, 8192
    s_add_u32 s26, s22, s25
    s_add_u32 s22, s22, s24
    s_lshl_b32 s25, s13, 6
    v_add_u32 v1, s25, v0
    v_add_u32 v2, 0, v1
    v_and_b32 v3, 7, v2
    v_mul_u32_u24 v3, 1280, v3
    v_lshrrev_b32 v4, 3, v2
    v_lshl_add_u32 v3, v4, 4, v3
    v_lshlrev_b32 v5, 4, v2
    v_add_u32 v5, 20480, v5
    v_lshrrev_b32 v6, 13, v5
    v_lshlrev_b32 v6, 14, v6
    v_and_b32 v5, 8191, v5
    v_add_u32 v5, v5, v6
    v_cmp_gt_u32 vcc, 640, v2
    s_and_saveexec_b64 s[30:31], vcc
    s_cbranch_execz ln_b2_kernel_m0s0
    buffer_load_dwordx4 v[8:11], v3, s[16:19], 0 offen
    s_waitcnt vmcnt(0)
    buffer_store_dwordx4 v[8:11], v5, s[8:11], s22 offen
    buffer_store_dwordx4 v[8:11], v5, s[8:11], s26 offen
ln_b2_kernel_m0s0:
    s_mov_b64 exec, s[30:31]
    v_add_u32 v2, 256, v1
    v_and_b32 v3, 7, v2
    v_mul_u32_u24 v3, 1280, v3
    v_lshrrev_b32 v4, 3, v2
    v_lshl_add_u32 v3, v4, 4, v3
    v_lshlrev_b32 v5, 4, v2
    v_add_u32 v5, 20480, v5
    v_lshrrev_b32 v6, 13, v5
    v_lshlrev_b32 v6, 14, v6
    v_and_b32 v5, 8191, v5
    v_add_u32 v5, v5, v6
    v_cmp_gt_u32 vcc, 640, v2
    s_and_saveexec_b64 s[30:31], vcc
    s_cbranch_execz ln_b2_kernel_m0s1
    buffer_load_dwordx4 v[8:11], v3, s[16:19], 0 offen
    s_waitcnt vmcnt(0)
    buffer_store_dwordx4 v[8:11], v5, s[8:11], s22 offen
    buffer_store_dwordx4 v[8:11], v5, s[8:11], s26 offen
ln_b2_kernel_m0s1:
    s_mov_b64 exec, s[30:31]
    v_add_u32 v2, 512, v1
    v_and_b32 v3, 7, v2
    v_mul_u32_u24 v3, 1280, v3
    v_lshrrev_b32 v4, 3, v2
    v_lshl_add_u32 v3, v4, 4, v3
    v_lshlrev_b32 v5, 4, v2
    v_add_u32 v5, 20480, v5
    v_lshrrev_b32 v6, 13, v5
    v_lshlrev_b32 v6, 14, v6
    v_and_b32 v5, 8191, v5
    v_add_u32 v5, v5, v6
    v_cmp_gt_u32 vcc, 640, v2
    s_and_saveexec_b64 s[30:31], vcc
    s_cbranch_execz ln_b2_kernel_m0s2
    buffer_load_dwordx4 v[8:11], v3, s[16:19], 0 offen
    s_waitcnt vmcnt(0)
    buffer_store_dwordx4 v[8:11], v5, s[8:11], s22 offen
    buffer_store_dwordx4 v[8:11], v5, s[8:11], s26 offen
ln_b2_kernel_m0s2:
    s_mov_b64 exec, s[30:31]
ln_b2_kernel_end:
    s_endpgm
.section .rodata,"a"
.p2align 6
.amdhsa_kernel ln_b2_kernel
  .amdhsa_next_free_vgpr 32
  .amdhsa_next_free_sgpr 48
  .amdhsa_accum_offset 32
  .amdhsa_group_segment_fixed_size 0
  .amdhsa_kernarg_size 104
  .amdhsa_user_sgpr_count 2
  .amdhsa_user_sgpr_kernarg_segment_ptr 1
  .amdhsa_system_sgpr_workgroup_id_x 1
.end_amdhsa_kernel
```

```asm
; @launch kernel=prep_kernel grid=(569,1,1) block=(256,1,1) lds=1024
; @launch kernel=afront1_kernel grid=(256,1,1) block=(256,1,1) lds=131072
; @launch kernel=aback1_kernel grid=(160,1,1) block=(256,1,1) lds=122880
; @launch kernel=ln_b1_kernel grid=(513,1,1) block=(256,1,1) lds=0
; @launch kernel=layerb1_kernel grid=(256,1,1) block=(256,1,1) lds=143616
; @launch kernel=afront2_kernel grid=(256,1,1) block=(256,1,1) lds=131072
; @launch kernel=aback2_kernel grid=(160,1,1) block=(256,1,1) lds=122880
; @launch kernel=ln_b2_kernel grid=(513,1,1) block=(256,1,1) lds=0
; @launch kernel=layerb2_kernel grid=(256,1,1) block=(256,1,1) lds=143616
.amdgcn_target "amdgcn-amd-amdhsa--gfx950"
.text
.globl prep_kernel
.p2align 8
.type prep_kernel,@function
prep_kernel:
    s_cmp_ge_u32 s2, 569
    s_cbranch_scc1 prep_kernel_end
    s_load_dwordx2 s[4:5], s[0:1], 96
    v_lshrrev_b32 v1, 6, v0
    v_and_b32 v0, 63, v0
    s_nop 0
    v_readfirstlane_b32 s13, v1
    s_waitcnt lgkmcnt(0)
    s_mov_b32 s8, s4
    s_mov_b32 s9, s5
    s_mov_b32 s10, 268435456
    s_mov_b32 s11, 0x00020000
    s_cmp_eq_u32 s2, 0
    s_cbranch_scc1 prep_kernel_r_ctl
    s_sub_u32 s20, s2, 1
    s_cmp_lt_u32 s20, 64
    s_cbranch_scc1 prep_kernel_r_pwa
    s_sub_u32 s20, s20, 64
    s_cmp_lt_u32 s20, 40
    s_cbranch_scc1 prep_kernel_r_pwo
    s_sub_u32 s20, s20, 40
    s_cmp_lt_u32 s20, 160
    s_cbranch_scc1 prep_kernel_r_wvo
    s_sub_u32 s20, s20, 160
    s_cmp_lt_u32 s20, 240
    s_cbranch_scc1 prep_kernel_r_pwp
    s_sub_u32 s20, s20, 240
    s_sub_u32 s21, 0, s4
    s_and_b32 s21, s21, 0x1fffff
    s_mul_i32 s22, s20, 131072
    s_add_u32 s21, s21, s22
    s_lshl_b32 s22, s13, 10
    s_add_u32 s21, s21, s22
    v_lshlrev_b32 v1, 4, v0
    v_mov_b32 v4, -1
    v_mov_b32 v5, -1
    v_mov_b32 v6, -1
    v_mov_b32 v7, -1
    s_mov_b32 s22, 32
prep_kernel_clr_loop:
    buffer_store_dwordx4 v[4:7], v1, s[8:11], s21 offen
    s_add_u32 s21, s21, 4096
    s_sub_u32 s22, s22, 1
    s_cmp_lg_u32 s22, 0
    s_cbranch_scc1 prep_kernel_clr_loop
    s_branch prep_kernel_end
prep_kernel_r_ctl:
    v_lshlrev_b32 v1, 4, v0
    v_mov_b32 v4, 0
    v_mov_b32 v5, 0
    v_mov_b32 v6, 0
    v_mov_b32 v7, 0
    s_lshl_b32 s21, s13, 10
    s_add_u32 s21, s21, 10485760
    buffer_store_dwordx4 v[4:7], v1, s[8:11], s21 offen
    s_lshl_b32 s21, s13, 15
    s_add_u32 s21, s21, 10616832
    buffer_store_dwordx4 v[4:7], v1, s[8:11], s21 offen offset:0
    buffer_store_dwordx4 v[4:7], v1, s[8:11], s21 offen offset:1024
    buffer_store_dwordx4 v[4:7], v1, s[8:11], s21 offen offset:2048
    buffer_store_dwordx4 v[4:7], v1, s[8:11], s21 offen offset:3072
    s_add_u32 s21, s21, 4096
    buffer_store_dwordx4 v[4:7], v1, s[8:11], s21 offen offset:0
    buffer_store_dwordx4 v[4:7], v1, s[8:11], s21 offen offset:1024
    buffer_store_dwordx4 v[4:7], v1, s[8:11], s21 offen offset:2048
    buffer_store_dwordx4 v[4:7], v1, s[8:11], s21 offen offset:3072
    s_add_u32 s21, s21, 4096
    buffer_store_dwordx4 v[4:7], v1, s[8:11], s21 offen offset:0
    buffer_store_dwordx4 v[4:7], v1, s[8:11], s21 offen offset:1024
    buffer_store_dwordx4 v[4:7], v1, s[8:11], s21 offen offset:2048
    buffer_store_dwordx4 v[4:7], v1, s[8:11], s21 offen offset:3072
    s_add_u32 s21, s21, 4096
    buffer_store_dwordx4 v[4:7], v1, s[8:11], s21 offen offset:0
    buffer_store_dwordx4 v[4:7], v1, s[8:11], s21 offen offset:1024
    buffer_store_dwordx4 v[4:7], v1, s[8:11], s21 offen offset:2048
    buffer_store_dwordx4 v[4:7], v1, s[8:11], s21 offen offset:3072
    s_add_u32 s21, s21, 4096
    buffer_store_dwordx4 v[4:7], v1, s[8:11], s21 offen offset:0
    buffer_store_dwordx4 v[4:7], v1, s[8:11], s21 offen offset:1024
    buffer_store_dwordx4 v[4:7], v1, s[8:11], s21 offen offset:2048
    buffer_store_dwordx4 v[4:7], v1, s[8:11], s21 offen offset:3072
    s_add_u32 s21, s21, 4096
    buffer_store_dwordx4 v[4:7], v1, s[8:11], s21 offen offset:0
    buffer_store_dwordx4 v[4:7], v1, s[8:11], s21 offen offset:1024
    buffer_store_dwordx4 v[4:7], v1, s[8:11], s21 offen offset:2048
    buffer_store_dwordx4 v[4:7], v1, s[8:11], s21 offen offset:3072
    s_add_u32 s21, s21, 4096
    buffer_store_dwordx4 v[4:7], v1, s[8:11], s21 offen offset:0
    buffer_store_dwordx4 v[4:7], v1, s[8:11], s21 offen offset:1024
    buffer_store_dwordx4 v[4:7], v1, s[8:11], s21 offen offset:2048
    buffer_store_dwordx4 v[4:7], v1, s[8:11], s21 offen offset:3072
    s_add_u32 s21, s21, 4096
    buffer_store_dwordx4 v[4:7], v1, s[8:11], s21 offen offset:0
    buffer_store_dwordx4 v[4:7], v1, s[8:11], s21 offen offset:1024
    buffer_store_dwordx4 v[4:7], v1, s[8:11], s21 offen offset:2048
    buffer_store_dwordx4 v[4:7], v1, s[8:11], s21 offen offset:3072
    s_add_u32 s21, s21, 4096
    s_sub_u32 s22, 0, s4
    s_and_b32 s22, s22, 0x1fffff
    s_getreg_b32 s23, hwreg(HW_REG_XCC_ID)
    s_bfe_u32 s23, s23, 0x10002
    s_mov_b64 exec, 1
    v_mov_b32 v1, 0
    s_mul_i32 s24, s13, 2097152
    s_add_u32 s22, s22, s24
    s_add_u32 s22, s22, 2086912
    s_mov_b32 s30, -1
    s_mov_b32 s31, -1
    s_mov_b32 s25, 5
prep_kernel_cal:
    s_add_u32 s24, s22, 0
    s_memrealtime s[26:27]
    s_waitcnt lgkmcnt(0)
    buffer_store_dword v1, v1, s[8:11], s24 offen sc1
    s_waitcnt vmcnt(0)
    buffer_load_dword v2, v1, s[8:11], s24 offen sc1
    s_waitcnt vmcnt(0)
    s_memrealtime s[28:29]
    s_waitcnt lgkmcnt(0)
    s_sub_u32 s26, s28, s26
    s_min_u32 s30, s30, s26
    s_add_u32 s24, s22, 8192
    s_memrealtime s[26:27]
    s_waitcnt lgkmcnt(0)
    buffer_store_dword v1, v1, s[8:11], s24 offen sc1
    s_waitcnt vmcnt(0)
    buffer_load_dword v2, v1, s[8:11], s24 offen sc1
    s_waitcnt vmcnt(0)
    s_memrealtime s[28:29]
    s_waitcnt lgkmcnt(0)
    s_sub_u32 s26, s28, s26
    s_min_u32 s31, s31, s26
    s_sub_u32 s25, s25, 1
    s_cmp_lg_u32 s25, 0
    s_cbranch_scc1 prep_kernel_cal
    s_cmp_lt_u32 s31, s30
    s_cselect_b32 s24, 1, 0
    s_xor_b32 s24, s24, s23
    s_lshl_b32 s24, s24, 13
    v_mov_b32 v3, s24
    s_lshl_b32 s25, s13, 2
    s_add_u32 s25, s25, 10551296
    buffer_store_dword v3, v1, s[8:11], s25 offen
    s_lshl_b32 s26, s30, 16
    s_or_b32 s26, s26, s31
    v_mov_b32 v3, s26
    buffer_store_dword v3, v1, s[8:11], s25 offen offset:64
    s_branch prep_kernel_end
prep_kernel_r_wvo:
    s_lshl_b32 s20, s20, 2
    s_add_u32 s20, s20, s13
    s_load_dwordx2 s[24:25], s[0:1], 56
    s_load_dwordx2 s[26:27], s[0:1], 64
    s_and_b32 s21, s20, 1
    s_lshr_b32 s22, s20, 1
    s_mul_i32 s23, s22, 205
    s_lshr_b32 s23, s23, 11
    s_mul_i32 s28, s23, 10
    s_sub_u32 s22, s22, s28
    s_waitcnt lgkmcnt(0)
    s_mov_b32 s32, s24
    s_mov_b32 s33, s25
    s_mov_b32 s34, 7864320
    s_mov_b32 s35, 0x00020000
    s_mov_b32 s36, s26
    s_mov_b32 s37, s27
    s_mov_b32 s38, 7864320
    s_mov_b32 s39, 0x00020000
    v_and_b32 v1, 31, v0
    v_lshrrev_b32 v2, 5, v0
    v_mul_u32_u24 v3, 10240, v2
    v_lshl_add_u32 v3, v1, 2, v3
    s_mul_i32 s28, s23, 245760
    s_lshl_b32 s29, s22, 7
    s_add_u32 s28, s28, s29
    s_add_u32 s29, s28, 0
    buffer_load_dword v112, v3, s[36:39], s29 offen
    s_add_u32 s29, s28, 1280
    buffer_load_dword v113, v3, s[36:39], s29 offen
    s_add_u32 s29, s28, 2560
    buffer_load_dword v114, v3, s[36:39], s29 offen
    s_add_u32 s29, s28, 3840
    buffer_load_dword v115, v3, s[36:39], s29 offen
    s_add_u32 s29, s28, 5120
    buffer_load_dword v116, v3, s[36:39], s29 offen
    s_add_u32 s29, s28, 6400
    buffer_load_dword v117, v3, s[36:39], s29 offen
    s_add_u32 s29, s28, 7680
    buffer_load_dword v118, v3, s[36:39], s29 offen
    s_add_u32 s29, s28, 8960
    buffer_load_dword v119, v3, s[36:39], s29 offen
    s_add_u32 s29, s28, 20480
    buffer_load_dword v120, v3, s[36:39], s29 offen
    s_add_u32 s29, s28, 21760
    buffer_load_dword v121, v3, s[36:39], s29 offen
    s_add_u32 s29, s28, 23040
    buffer_load_dword v122, v3, s[36:39], s29 offen
    s_add_u32 s29, s28, 24320
    buffer_load_dword v123, v3, s[36:39], s29 offen
    s_add_u32 s29, s28, 25600
    buffer_load_dword v124, v3, s[36:39], s29 offen
    s_add_u32 s29, s28, 26880
    buffer_load_dword v125, v3, s[36:39], s29 offen
    s_add_u32 s29, s28, 28160
    buffer_load_dword v126, v3, s[36:39], s29 offen
    s_add_u32 s29, s28, 29440
    buffer_load_dword v127, v3, s[36:39], s29 offen
    s_add_u32 s29, s28, 40960
    buffer_load_dword v128, v3, s[36:39], s29 offen
    s_add_u32 s29, s28, 42240
    buffer_load_dword v129, v3, s[36:39], s29 offen
    s_add_u32 s29, s28, 43520
    buffer_load_dword v130, v3, s[36:39], s29 offen
    s_add_u32 s29, s28, 44800
    buffer_load_dword v131, v3, s[36:39], s29 offen
    s_add_u32 s29, s28, 46080
    buffer_load_dword v132, v3, s[36:39], s29 offen
    s_add_u32 s29, s28, 47360
    buffer_load_dword v133, v3, s[36:39], s29 offen
    s_add_u32 s29, s28, 48640
    buffer_load_dword v134, v3, s[36:39], s29 offen
    s_add_u32 s29, s28, 49920
    buffer_load_dword v135, v3, s[36:39], s29 offen
    s_add_u32 s29, s28, 61440
    buffer_load_dword v136, v3, s[36:39], s29 offen
    s_add_u32 s29, s28, 62720
    buffer_load_dword v137, v3, s[36:39], s29 offen
    s_add_u32 s29, s28, 64000
    buffer_load_dword v138, v3, s[36:39], s29 offen
    s_add_u32 s29, s28, 65280
    buffer_load_dword v139, v3, s[36:39], s29 offen
    s_add_u32 s29, s28, 66560
    buffer_load_dword v140, v3, s[36:39], s29 offen
    s_add_u32 s29, s28, 67840
    buffer_load_dword v141, v3, s[36:39], s29 offen
    s_add_u32 s29, s28, 69120
    buffer_load_dword v142, v3, s[36:39], s29 offen
    s_add_u32 s29, s28, 70400
    buffer_load_dword v143, v3, s[36:39], s29 offen
    s_add_u32 s29, s28, 81920
    buffer_load_dword v144, v3, s[36:39], s29 offen
    s_add_u32 s29, s28, 83200
    buffer_load_dword v145, v3, s[36:39], s29 offen
    s_add_u32 s29, s28, 84480
    buffer_load_dword v146, v3, s[36:39], s29 offen
    s_add_u32 s29, s28, 85760
    buffer_load_dword v147, v3, s[36:39], s29 offen
    s_add_u32 s29, s28, 87040
    buffer_load_dword v148, v3, s[36:39], s29 offen
    s_add_u32 s29, s28, 88320
    buffer_load_dword v149, v3, s[36:39], s29 offen
    s_add_u32 s29, s28, 89600
    buffer_load_dword v150, v3, s[36:39], s29 offen
    s_add_u32 s29, s28, 90880
    buffer_load_dword v151, v3, s[36:39], s29 offen
    s_add_u32 s29, s28, 102400
    buffer_load_dword v152, v3, s[36:39], s29 offen
    s_add_u32 s29, s28, 103680
    buffer_load_dword v153, v3, s[36:39], s29 offen
    s_add_u32 s29, s28, 104960
    buffer_load_dword v154, v3, s[36:39], s29 offen
    s_add_u32 s29, s28, 106240
    buffer_load_dword v155, v3, s[36:39], s29 offen
    s_add_u32 s29, s28, 107520
    buffer_load_dword v156, v3, s[36:39], s29 offen
    s_add_u32 s29, s28, 108800
    buffer_load_dword v157, v3, s[36:39], s29 offen
    s_add_u32 s29, s28, 110080
    buffer_load_dword v158, v3, s[36:39], s29 offen
    s_add_u32 s29, s28, 111360
    buffer_load_dword v159, v3, s[36:39], s29 offen
    v_mov_b32 v4, 0x05040100
    v_mov_b32 v5, 0x07060302
    s_waitcnt vmcnt(0)
    v_perm_b32 v16, v113, v112, v4
    v_perm_b32 v64, v113, v112, v5
    v_perm_b32 v17, v115, v114, v4
    v_perm_b32 v65, v115, v114, v5
    v_perm_b32 v18, v117, v116, v4
    v_perm_b32 v66, v117, v116, v5
    v_perm_b32 v19, v119, v118, v4
    v_perm_b32 v67, v119, v118, v5
    v_perm_b32 v20, v121, v120, v4
    v_perm_b32 v68, v121, v120, v5
    v_perm_b32 v21, v123, v122, v4
    v_perm_b32 v69, v123, v122, v5
    v_perm_b32 v22, v125, v124, v4
    v_perm_b32 v70, v125, v124, v5
    v_perm_b32 v23, v127, v126, v4
    v_perm_b32 v71, v127, v126, v5
    v_perm_b32 v24, v129, v128, v4
    v_perm_b32 v72, v129, v128, v5
    v_perm_b32 v25, v131, v130, v4
    v_perm_b32 v73, v131, v130, v5
    v_perm_b32 v26, v133, v132, v4
    v_perm_b32 v74, v133, v132, v5
    v_perm_b32 v27, v135, v134, v4
    v_perm_b32 v75, v135, v134, v5
    v_perm_b32 v28, v137, v136, v4
    v_perm_b32 v76, v137, v136, v5
    v_perm_b32 v29, v139, v138, v4
    v_perm_b32 v77, v139, v138, v5
    v_perm_b32 v30, v141, v140, v4
    v_perm_b32 v78, v141, v140, v5
    v_perm_b32 v31, v143, v142, v4
    v_perm_b32 v79, v143, v142, v5
    v_perm_b32 v32, v145, v144, v4
    v_perm_b32 v80, v145, v144, v5
    v_perm_b32 v33, v147, v146, v4
    v_perm_b32 v81, v147, v146, v5
    v_perm_b32 v34, v149, v148, v4
    v_perm_b32 v82, v149, v148, v5
    v_perm_b32 v35, v151, v150, v4
    v_perm_b32 v83, v151, v150, v5
    v_perm_b32 v36, v153, v152, v4
    v_perm_b32 v84, v153, v152, v5
    v_perm_b32 v37, v155, v154, v4
    v_perm_b32 v85, v155, v154, v5
    v_perm_b32 v38, v157, v156, v4
    v_perm_b32 v86, v157, v156, v5
    v_perm_b32 v39, v159, v158, v4
    v_perm_b32 v87, v159, v158, v5
    s_add_u32 s29, s28, 122880
    buffer_load_dword v112, v3, s[36:39], s29 offen
    s_add_u32 s29, s28, 124160
    buffer_load_dword v113, v3, s[36:39], s29 offen
    s_add_u32 s29, s28, 125440
    buffer_load_dword v114, v3, s[36:39], s29 offen
    s_add_u32 s29, s28, 126720
    buffer_load_dword v115, v3, s[36:39], s29 offen
    s_add_u32 s29, s28, 128000
    buffer_load_dword v116, v3, s[36:39], s29 offen
    s_add_u32 s29, s28, 129280
    buffer_load_dword v117, v3, s[36:39], s29 offen
    s_add_u32 s29, s28, 130560
    buffer_load_dword v118, v3, s[36:39], s29 offen
    s_add_u32 s29, s28, 131840
    buffer_load_dword v119, v3, s[36:39], s29 offen
    s_add_u32 s29, s28, 143360
    buffer_load_dword v120, v3, s[36:39], s29 offen
    s_add_u32 s29, s28, 144640
    buffer_load_dword v121, v3, s[36:39], s29 offen
    s_add_u32 s29, s28, 145920
    buffer_load_dword v122, v3, s[36:39], s29 offen
    s_add_u32 s29, s28, 147200
    buffer_load_dword v123, v3, s[36:39], s29 offen
    s_add_u32 s29, s28, 148480
    buffer_load_dword v124, v3, s[36:39], s29 offen
    s_add_u32 s29, s28, 149760
    buffer_load_dword v125, v3, s[36:39], s29 offen
    s_add_u32 s29, s28, 151040
    buffer_load_dword v126, v3, s[36:39], s29 offen
    s_add_u32 s29, s28, 152320
    buffer_load_dword v127, v3, s[36:39], s29 offen
    s_add_u32 s29, s28, 163840
    buffer_load_dword v128, v3, s[36:39], s29 offen
    s_add_u32 s29, s28, 165120
    buffer_load_dword v129, v3, s[36:39], s29 offen
    s_add_u32 s29, s28, 166400
    buffer_load_dword v130, v3, s[36:39], s29 offen
    s_add_u32 s29, s28, 167680
    buffer_load_dword v131, v3, s[36:39], s29 offen
    s_add_u32 s29, s28, 168960
    buffer_load_dword v132, v3, s[36:39], s29 offen
    s_add_u32 s29, s28, 170240
    buffer_load_dword v133, v3, s[36:39], s29 offen
    s_add_u32 s29, s28, 171520
    buffer_load_dword v134, v3, s[36:39], s29 offen
    s_add_u32 s29, s28, 172800
    buffer_load_dword v135, v3, s[36:39], s29 offen
    s_add_u32 s29, s28, 184320
    buffer_load_dword v136, v3, s[36:39], s29 offen
    s_add_u32 s29, s28, 185600
    buffer_load_dword v137, v3, s[36:39], s29 offen
    s_add_u32 s29, s28, 186880
    buffer_load_dword v138, v3, s[36:39], s29 offen
    s_add_u32 s29, s28, 188160
    buffer_load_dword v139, v3, s[36:39], s29 offen
    s_add_u32 s29, s28, 189440
    buffer_load_dword v140, v3, s[36:39], s29 offen
    s_add_u32 s29, s28, 190720
    buffer_load_dword v141, v3, s[36:39], s29 offen
    s_add_u32 s29, s28, 192000
    buffer_load_dword v142, v3, s[36:39], s29 offen
    s_add_u32 s29, s28, 193280
    buffer_load_dword v143, v3, s[36:39], s29 offen
    s_add_u32 s29, s28, 204800
    buffer_load_dword v144, v3, s[36:39], s29 offen
    s_add_u32 s29, s28, 206080
    buffer_load_dword v145, v3, s[36:39], s29 offen
    s_add_u32 s29, s28, 207360
    buffer_load_dword v146, v3, s[36:39], s29 offen
    s_add_u32 s29, s28, 208640
    buffer_load_dword v147, v3, s[36:39], s29 offen
    s_add_u32 s29, s28, 209920
    buffer_load_dword v148, v3, s[36:39], s29 offen
    s_add_u32 s29, s28, 211200
    buffer_load_dword v149, v3, s[36:39], s29 offen
    s_add_u32 s29, s28, 212480
    buffer_load_dword v150, v3, s[36:39], s29 offen
    s_add_u32 s29, s28, 213760
    buffer_load_dword v151, v3, s[36:39], s29 offen
    s_add_u32 s29, s28, 225280
    buffer_load_dword v152, v3, s[36:39], s29 offen
    s_add_u32 s29, s28, 226560
    buffer_load_dword v153, v3, s[36:39], s29 offen
    s_add_u32 s29, s28, 227840
    buffer_load_dword v154, v3, s[36:39], s29 offen
    s_add_u32 s29, s28, 229120
    buffer_load_dword v155, v3, s[36:39], s29 offen
    s_add_u32 s29, s28, 230400
    buffer_load_dword v156, v3, s[36:39], s29 offen
    s_add_u32 s29, s28, 231680
    buffer_load_dword v157, v3, s[36:39], s29 offen
    s_add_u32 s29, s28, 232960
    buffer_load_dword v158, v3, s[36:39], s29 offen
    s_add_u32 s29, s28, 234240
    buffer_load_dword v159, v3, s[36:39], s29 offen
    v_mov_b32 v4, 0x05040100
    v_mov_b32 v5, 0x07060302
    s_waitcnt vmcnt(0)
    v_perm_b32 v40, v113, v112, v4
    v_perm_b32 v88, v113, v112, v5
    v_perm_b32 v41, v115, v114, v4
    v_perm_b32 v89, v115, v114, v5
    v_perm_b32 v42, v117, v116, v4
    v_perm_b32 v90, v117, v116, v5
    v_perm_b32 v43, v119, v118, v4
    v_perm_b32 v91, v119, v118, v5
    v_perm_b32 v44, v121, v120, v4
    v_perm_b32 v92, v121, v120, v5
    v_perm_b32 v45, v123, v122, v4
    v_perm_b32 v93, v123, v122, v5
    v_perm_b32 v46, v125, v124, v4
    v_perm_b32 v94, v125, v124, v5
    v_perm_b32 v47, v127, v126, v4
    v_perm_b32 v95, v127, v126, v5
    v_perm_b32 v48, v129, v128, v4
    v_perm_b32 v96, v129, v128, v5
    v_perm_b32 v49, v131, v130, v4
    v_perm_b32 v97, v131, v130, v5
    v_perm_b32 v50, v133, v132, v4
    v_perm_b32 v98, v133, v132, v5
    v_perm_b32 v51, v135, v134, v4
    v_perm_b32 v99, v135, v134, v5
    v_perm_b32 v52, v137, v136, v4
    v_perm_b32 v100, v137, v136, v5
    v_perm_b32 v53, v139, v138, v4
    v_perm_b32 v101, v139, v138, v5
    v_perm_b32 v54, v141, v140, v4
    v_perm_b32 v102, v141, v140, v5
    v_perm_b32 v55, v143, v142, v4
    v_perm_b32 v103, v143, v142, v5
    v_perm_b32 v56, v145, v144, v4
    v_perm_b32 v104, v145, v144, v5
    v_perm_b32 v57, v147, v146, v4
    v_perm_b32 v105, v147, v146, v5
    v_perm_b32 v58, v149, v148, v4
    v_perm_b32 v106, v149, v148, v5
    v_perm_b32 v59, v151, v150, v4
    v_perm_b32 v107, v151, v150, v5
    v_perm_b32 v60, v153, v152, v4
    v_perm_b32 v108, v153, v152, v5
    v_perm_b32 v61, v155, v154, v4
    v_perm_b32 v109, v155, v154, v5
    v_perm_b32 v62, v157, v156, v4
    v_perm_b32 v110, v157, v156, v5
    v_perm_b32 v63, v159, v158, v4
    v_perm_b32 v111, v159, v158, v5
    v_lshrrev_b32 v6, 3, v1
    v_lshrrev_b32 v7, 2, v6
    v_lshlrev_b32 v7, 5, v7
    v_and_b32 v8, 2, v6
    v_lshl_add_u32 v7, v8, 3, v7
    v_and_b32 v8, 1, v6
    v_lshl_add_u32 v7, v8, 2, v7
    v_and_b32 v8, 7, v1
    v_and_b32 v9, 1, v8
    v_add_u32 v7, v7, v9
    v_and_b32 v9, 2, v8
    v_lshl_add_u32 v7, v9, 2, v7
    v_lshrrev_b32 v9, 2, v8
    v_lshl_add_u32 v7, v9, 1, v7
    v_mul_u32_u24 v7, 12288, v7
    v_lshl_add_u32 v7, v2, 4, v7
    s_mul_i32 s28, s23, 384
    s_mul_i32 s29, s21, 3932160
    s_add_u32 s28, s28, s29
    v_lshrrev_b32 v10, 2, v1
    v_mul_u32_u24 v10, 20480, v10
    v_lshlrev_b32 v10, 4, v10
    v_and_b32 v11, 3, v1
    v_lshl_add_u32 v10, v11, 5, v10
    v_lshl_add_u32 v10, v2, 8, v10
    s_mul_i32 s30, s22, 2621440
    s_lshr_b32 s31, s23, 3
    s_mul_i32 s31, s31, 81920
    s_add_u32 s30, s30, s31
    s_and_b32 s31, s23, 3
    s_mul_i32 s31, s31, 20480
    s_add_u32 s30, s30, s31
    s_bfe_u32 s31, s23, 0x10002
    s_lshl_b32 s31, s31, 7
    s_add_u32 s30, s30, s31
    s_mul_i32 s31, s21, 10240
    s_add_u32 s30, s30, s31
    s_add_u32 s30, s30, 27262976
    buffer_load_dwordx4 v[112:115], v7, s[32:35], s28 offen offset:0
    buffer_load_dwordx4 v[116:119], v7, s[32:35], s28 offen offset:32
    buffer_load_dwordx4 v[120:123], v7, s[32:35], s28 offen offset:64
    buffer_load_dwordx4 v[124:127], v7, s[32:35], s28 offen offset:96
    buffer_load_dwordx4 v[128:131], v7, s[32:35], s28 offen offset:128
    buffer_load_dwordx4 v[132:135], v7, s[32:35], s28 offen offset:160
    buffer_load_dwordx4 v[136:139], v7, s[32:35], s28 offen offset:192
    buffer_load_dwordx4 v[140:143], v7, s[32:35], s28 offen offset:224
    buffer_load_dwordx4 v[144:147], v7, s[32:35], s28 offen offset:256
    buffer_load_dwordx4 v[148:151], v7, s[32:35], s28 offen offset:288
    buffer_load_dwordx4 v[152:155], v7, s[32:35], s28 offen offset:320
    buffer_load_dwordx4 v[156:159], v7, s[32:35], s28 offen offset:352
    s_add_u32 s28, s28, 393216
    s_mov_b32 s31, 5
prep_kernel_wvo_loop:
    buffer_load_dwordx4 v[160:163], v7, s[32:35], s28 offen offset:0
    buffer_load_dwordx4 v[164:167], v7, s[32:35], s28 offen offset:32
    buffer_load_dwordx4 v[168:171], v7, s[32:35], s28 offen offset:64
    buffer_load_dwordx4 v[172:175], v7, s[32:35], s28 offen offset:96
    buffer_load_dwordx4 v[176:179], v7, s[32:35], s28 offen offset:128
    buffer_load_dwordx4 v[180:183], v7, s[32:35], s28 offen offset:160
    buffer_load_dwordx4 v[184:187], v7, s[32:35], s28 offen offset:192
    buffer_load_dwordx4 v[188:191], v7, s[32:35], s28 offen offset:224
    buffer_load_dwordx4 v[192:195], v7, s[32:35], s28 offen offset:256
    buffer_load_dwordx4 v[196:199], v7, s[32:35], s28 offen offset:288
    buffer_load_dwordx4 v[200:203], v7, s[32:35], s28 offen offset:320
    buffer_load_dwordx4 v[204:207], v7, s[32:35], s28 offen offset:352
    s_add_u32 s28, s28, 393216
    s_waitcnt vmcnt(12)
    v_mfma_f32_32x32x16_bf16 v[208:223], v[112:115], v[16:19], 0
    v_mfma_f32_32x32x16_bf16 v[224:239], v[112:115], v[64:67], 0
    v_mfma_f32_32x32x16_bf16 v[208:223], v[116:119], v[20:23], v[208:223]
    v_mfma_f32_32x32x16_bf16 v[224:239], v[116:119], v[68:71], v[224:239]
    v_mfma_f32_32x32x16_bf16 v[208:223], v[120:123], v[24:27], v[208:223]
    v_mfma_f32_32x32x16_bf16 v[224:239], v[120:123], v[72:75], v[224:239]
    v_mfma_f32_32x32x16_bf16 v[208:223], v[124:127], v[28:31], v[208:223]
    v_mfma_f32_32x32x16_bf16 v[224:239], v[124:127], v[76:79], v[224:239]
    v_mfma_f32_32x32x16_bf16 v[208:223], v[128:131], v[32:35], v[208:223]
    v_mfma_f32_32x32x16_bf16 v[224:239], v[128:131], v[80:83], v[224:239]
    v_mfma_f32_32x32x16_bf16 v[208:223], v[132:135], v[36:39], v[208:223]
    v_mfma_f32_32x32x16_bf16 v[224:239], v[132:135], v[84:87], v[224:239]
    v_mfma_f32_32x32x16_bf16 v[208:223], v[136:139], v[40:43], v[208:223]
    v_mfma_f32_32x32x16_bf16 v[224:239], v[136:139], v[88:91], v[224:239]
    v_mfma_f32_32x32x16_bf16 v[208:223], v[140:143], v[44:47], v[208:223]
    v_mfma_f32_32x32x16_bf16 v[224:239], v[140:143], v[92:95], v[224:239]
    v_mfma_f32_32x32x16_bf16 v[208:223], v[144:147], v[48:51], v[208:223]
    v_mfma_f32_32x32x16_bf16 v[224:239], v[144:147], v[96:99], v[224:239]
    v_mfma_f32_32x32x16_bf16 v[208:223], v[148:151], v[52:55], v[208:223]
    v_mfma_f32_32x32x16_bf16 v[224:239], v[148:151], v[100:103], v[224:239]
    v_mfma_f32_32x32x16_bf16 v[208:223], v[152:155], v[56:59], v[208:223]
    v_mfma_f32_32x32x16_bf16 v[224:239], v[152:155], v[104:107], v[224:239]
    v_mfma_f32_32x32x16_bf16 v[208:223], v[156:159], v[60:63], v[208:223]
    v_mfma_f32_32x32x16_bf16 v[224:239], v[156:159], v[108:111], v[224:239]
    s_nop 7
    s_nop 7
    v_cvt_pk_bf16_f32 v240, v208, v209
    v_cvt_pk_bf16_f32 v241, v210, v211
    v_cvt_pk_bf16_f32 v242, v212, v213
    v_cvt_pk_bf16_f32 v243, v214, v215
    s_nop 1
    v_permlane32_swap_b32 v240, v242
    v_permlane32_swap_b32 v241, v243
    buffer_store_dwordx4 v[240:243], v10, s[8:11], s30 offen offset:0
    v_cvt_pk_bf16_f32 v244, v216, v217
    v_cvt_pk_bf16_f32 v245, v218, v219
    v_cvt_pk_bf16_f32 v246, v220, v221
    v_cvt_pk_bf16_f32 v247, v222, v223
    s_nop 1
    v_permlane32_swap_b32 v244, v246
    v_permlane32_swap_b32 v245, v247
    buffer_store_dwordx4 v[244:247], v10, s[8:11], s30 offen offset:512
    s_nop 1
    v_cvt_pk_bf16_f32 v240, v224, v225
    v_cvt_pk_bf16_f32 v241, v226, v227
    v_cvt_pk_bf16_f32 v242, v228, v229
    v_cvt_pk_bf16_f32 v243, v230, v231
    s_nop 1
    v_permlane32_swap_b32 v240, v242
    v_permlane32_swap_b32 v241, v243
    buffer_store_dwordx4 v[240:243], v10, s[8:11], s30 offen offset:16
    v_cvt_pk_bf16_f32 v244, v232, v233
    v_cvt_pk_bf16_f32 v245, v234, v235
    v_cvt_pk_bf16_f32 v246, v236, v237
    v_cvt_pk_bf16_f32 v247, v238, v239
    s_nop 1
    v_permlane32_swap_b32 v244, v246
    v_permlane32_swap_b32 v245, v247
    buffer_store_dwordx4 v[244:247], v10, s[8:11], s30 offen offset:528
    s_nop 1
    s_add_u32 s30, s30, 1024
    s_cmp_eq_u32 s31, 1
    s_cbranch_scc1 prep_kernel_wvo_last
    buffer_load_dwordx4 v[112:115], v7, s[32:35], s28 offen offset:0
    buffer_load_dwordx4 v[116:119], v7, s[32:35], s28 offen offset:32
    buffer_load_dwordx4 v[120:123], v7, s[32:35], s28 offen offset:64
    buffer_load_dwordx4 v[124:127], v7, s[32:35], s28 offen offset:96
    buffer_load_dwordx4 v[128:131], v7, s[32:35], s28 offen offset:128
    buffer_load_dwordx4 v[132:135], v7, s[32:35], s28 offen offset:160
    buffer_load_dwordx4 v[136:139], v7, s[32:35], s28 offen offset:192
    buffer_load_dwordx4 v[140:143], v7, s[32:35], s28 offen offset:224
    buffer_load_dwordx4 v[144:147], v7, s[32:35], s28 offen offset:256
    buffer_load_dwordx4 v[148:151], v7, s[32:35], s28 offen offset:288
    buffer_load_dwordx4 v[152:155], v7, s[32:35], s28 offen offset:320
    buffer_load_dwordx4 v[156:159], v7, s[32:35], s28 offen offset:352
    s_add_u32 s28, s28, 393216
    s_waitcnt vmcnt(12)
    v_mfma_f32_32x32x16_bf16 v[208:223], v[160:163], v[16:19], 0
    v_mfma_f32_32x32x16_bf16 v[224:239], v[160:163], v[64:67], 0
    v_mfma_f32_32x32x16_bf16 v[208:223], v[164:167], v[20:23], v[208:223]
    v_mfma_f32_32x32x16_bf16 v[224:239], v[164:167], v[68:71], v[224:239]
    v_mfma_f32_32x32x16_bf16 v[208:223], v[168:171], v[24:27], v[208:223]
    v_mfma_f32_32x32x16_bf16 v[224:239], v[168:171], v[72:75], v[224:239]
    v_mfma_f32_32x32x16_bf16 v[208:223], v[172:175], v[28:31], v[208:223]
    v_mfma_f32_32x32x16_bf16 v[224:239], v[172:175], v[76:79], v[224:239]
    v_mfma_f32_32x32x16_bf16 v[208:223], v[176:179], v[32:35], v[208:223]
    v_mfma_f32_32x32x16_bf16 v[224:239], v[176:179], v[80:83], v[224:239]
    v_mfma_f32_32x32x16_bf16 v[208:223], v[180:183], v[36:39], v[208:223]
    v_mfma_f32_32x32x16_bf16 v[224:239], v[180:183], v[84:87], v[224:239]
    v_mfma_f32_32x32x16_bf16 v[208:223], v[184:187], v[40:43], v[208:223]
    v_mfma_f32_32x32x16_bf16 v[224:239], v[184:187], v[88:91], v[224:239]
    v_mfma_f32_32x32x16_bf16 v[208:223], v[188:191], v[44:47], v[208:223]
    v_mfma_f32_32x32x16_bf16 v[224:239], v[188:191], v[92:95], v[224:239]
    v_mfma_f32_32x32x16_bf16 v[208:223], v[192:195], v[48:51], v[208:223]
    v_mfma_f32_32x32x16_bf16 v[224:239], v[192:195], v[96:99], v[224:239]
    v_mfma_f32_32x32x16_bf16 v[208:223], v[196:199], v[52:55], v[208:223]
    v_mfma_f32_32x32x16_bf16 v[224:239], v[196:199], v[100:103], v[224:239]
    v_mfma_f32_32x32x16_bf16 v[208:223], v[200:203], v[56:59], v[208:223]
    v_mfma_f32_32x32x16_bf16 v[224:239], v[200:203], v[104:107], v[224:239]
    v_mfma_f32_32x32x16_bf16 v[208:223], v[204:207], v[60:63], v[208:223]
    v_mfma_f32_32x32x16_bf16 v[224:239], v[204:207], v[108:111], v[224:239]
    s_nop 7
    s_nop 7
    v_cvt_pk_bf16_f32 v240, v208, v209
    v_cvt_pk_bf16_f32 v241, v210, v211
    v_cvt_pk_bf16_f32 v242, v212, v213
    v_cvt_pk_bf16_f32 v243, v214, v215
    s_nop 1
    v_permlane32_swap_b32 v240, v242
    v_permlane32_swap_b32 v241, v243
    buffer_store_dwordx4 v[240:243], v10, s[8:11], s30 offen offset:0
    v_cvt_pk_bf16_f32 v244, v216, v217
    v_cvt_pk_bf16_f32 v245, v218, v219
    v_cvt_pk_bf16_f32 v246, v220, v221
    v_cvt_pk_bf16_f32 v247, v222, v223
    s_nop 1
    v_permlane32_swap_b32 v244, v246
    v_permlane32_swap_b32 v245, v247
    buffer_store_dwordx4 v[244:247], v10, s[8:11], s30 offen offset:512
    s_nop 1
    v_cvt_pk_bf16_f32 v240, v224, v225
    v_cvt_pk_bf16_f32 v241, v226, v227
    v_cvt_pk_bf16_f32 v242, v228, v229
    v_cvt_pk_bf16_f32 v243, v230, v231
    s_nop 1
    v_permlane32_swap_b32 v240, v242
    v_permlane32_swap_b32 v241, v243
    buffer_store_dwordx4 v[240:243], v10, s[8:11], s30 offen offset:16
    v_cvt_pk_bf16_f32 v244, v232, v233
    v_cvt_pk_bf16_f32 v245, v234, v235
    v_cvt_pk_bf16_f32 v246, v236, v237
    v_cvt_pk_bf16_f32 v247, v238, v239
    s_nop 1
    v_permlane32_swap_b32 v244, v246
    v_permlane32_swap_b32 v245, v247
    buffer_store_dwordx4 v[244:247], v10, s[8:11], s30 offen offset:528
    s_nop 1
    s_add_u32 s30, s30, 1024
    s_sub_u32 s31, s31, 1
    s_branch prep_kernel_wvo_loop
prep_kernel_wvo_last:
    s_waitcnt vmcnt(0)
    v_mfma_f32_32x32x16_bf16 v[208:223], v[160:163], v[16:19], 0
    v_mfma_f32_32x32x16_bf16 v[224:239], v[160:163], v[64:67], 0
    v_mfma_f32_32x32x16_bf16 v[208:223], v[164:167], v[20:23], v[208:223]
    v_mfma_f32_32x32x16_bf16 v[224:239], v[164:167], v[68:71], v[224:239]
    v_mfma_f32_32x32x16_bf16 v[208:223], v[168:171], v[24:27], v[208:223]
    v_mfma_f32_32x32x16_bf16 v[224:239], v[168:171], v[72:75], v[224:239]
    v_mfma_f32_32x32x16_bf16 v[208:223], v[172:175], v[28:31], v[208:223]
    v_mfma_f32_32x32x16_bf16 v[224:239], v[172:175], v[76:79], v[224:239]
    v_mfma_f32_32x32x16_bf16 v[208:223], v[176:179], v[32:35], v[208:223]
    v_mfma_f32_32x32x16_bf16 v[224:239], v[176:179], v[80:83], v[224:239]
    v_mfma_f32_32x32x16_bf16 v[208:223], v[180:183], v[36:39], v[208:223]
    v_mfma_f32_32x32x16_bf16 v[224:239], v[180:183], v[84:87], v[224:239]
    v_mfma_f32_32x32x16_bf16 v[208:223], v[184:187], v[40:43], v[208:223]
    v_mfma_f32_32x32x16_bf16 v[224:239], v[184:187], v[88:91], v[224:239]
    v_mfma_f32_32x32x16_bf16 v[208:223], v[188:191], v[44:47], v[208:223]
    v_mfma_f32_32x32x16_bf16 v[224:239], v[188:191], v[92:95], v[224:239]
    v_mfma_f32_32x32x16_bf16 v[208:223], v[192:195], v[48:51], v[208:223]
    v_mfma_f32_32x32x16_bf16 v[224:239], v[192:195], v[96:99], v[224:239]
    v_mfma_f32_32x32x16_bf16 v[208:223], v[196:199], v[52:55], v[208:223]
    v_mfma_f32_32x32x16_bf16 v[224:239], v[196:199], v[100:103], v[224:239]
    v_mfma_f32_32x32x16_bf16 v[208:223], v[200:203], v[56:59], v[208:223]
    v_mfma_f32_32x32x16_bf16 v[224:239], v[200:203], v[104:107], v[224:239]
    v_mfma_f32_32x32x16_bf16 v[208:223], v[204:207], v[60:63], v[208:223]
    v_mfma_f32_32x32x16_bf16 v[224:239], v[204:207], v[108:111], v[224:239]
    s_nop 7
    s_nop 7
    v_cvt_pk_bf16_f32 v240, v208, v209
    v_cvt_pk_bf16_f32 v241, v210, v211
    v_cvt_pk_bf16_f32 v242, v212, v213
    v_cvt_pk_bf16_f32 v243, v214, v215
    s_nop 1
    v_permlane32_swap_b32 v240, v242
    v_permlane32_swap_b32 v241, v243
    buffer_store_dwordx4 v[240:243], v10, s[8:11], s30 offen offset:0
    v_cvt_pk_bf16_f32 v244, v216, v217
    v_cvt_pk_bf16_f32 v245, v218, v219
    v_cvt_pk_bf16_f32 v246, v220, v221
    v_cvt_pk_bf16_f32 v247, v222, v223
    s_nop 1
    v_permlane32_swap_b32 v244, v246
    v_permlane32_swap_b32 v245, v247
    buffer_store_dwordx4 v[244:247], v10, s[8:11], s30 offen offset:512
    s_nop 1
    v_cvt_pk_bf16_f32 v240, v224, v225
    v_cvt_pk_bf16_f32 v241, v226, v227
    v_cvt_pk_bf16_f32 v242, v228, v229
    v_cvt_pk_bf16_f32 v243, v230, v231
    s_nop 1
    v_permlane32_swap_b32 v240, v242
    v_permlane32_swap_b32 v241, v243
    buffer_store_dwordx4 v[240:243], v10, s[8:11], s30 offen offset:16
    v_cvt_pk_bf16_f32 v244, v232, v233
    v_cvt_pk_bf16_f32 v245, v234, v235
    v_cvt_pk_bf16_f32 v246, v236, v237
    v_cvt_pk_bf16_f32 v247, v238, v239
    s_nop 1
    v_permlane32_swap_b32 v244, v246
    v_permlane32_swap_b32 v245, v247
    buffer_store_dwordx4 v[244:247], v10, s[8:11], s30 offen offset:528
    s_nop 1
    s_add_u32 s30, s30, 1024
    s_branch prep_kernel_end
prep_kernel_r_pwp:
    s_lshl_b32 s20, s20, 2
    s_add_u32 s20, s20, s13
    s_mul_i32 s21, s20, 13108
    s_lshr_b32 s21, s21, 16
    s_mul_i32 s22, s21, 5
    s_sub_u32 s22, s20, s22
    s_mul_i32 s23, s21, 21846
    s_lshr_b32 s23, s23, 16
    s_mul_i32 s28, s23, 3
    s_sub_u32 s21, s21, s28
    s_lshr_b32 s29, s23, 5
    s_and_b32 s23, s23, 31
    s_cmp_eq_u32 s29, 0
    s_cbranch_scc0 prep_kernel_pwp_k
    s_load_dwordx2 s[24:25], s[0:1], 40
    s_branch prep_kernel_pwp_go
prep_kernel_pwp_k:
    s_load_dwordx2 s[24:25], s[0:1], 48
prep_kernel_pwp_go:
    v_and_b32 v1, 31, v0
    v_lshrrev_b32 v2, 5, v0
    s_lshl_b32 s28, s21, 6
    v_lshlrev_b32 v3, 1, v1
    v_add_u32 v3, s28, v3
    v_and_b32 v4, 0xc1, v3
    v_and_b32 v5, 8, v3
    v_lshl_or_b32 v4, v5, 2, v4
    v_and_b32 v5, 32, v3
    v_lshrrev_b32 v5, 1, v5
    v_or_b32 v4, v4, v5
    v_and_b32 v5, 2, v3
    v_lshl_or_b32 v4, v5, 2, v4
    v_and_b32 v5, 16, v3
    v_lshrrev_b32 v5, 2, v5
    v_or_b32 v4, v4, v5
    v_and_b32 v5, 4, v3
    v_lshrrev_b32 v5, 1, v5
    v_or_b32 v4, v4, v5
    s_cmp_eq_u32 s29, 0
    s_cselect_b64 vcc, -1, 0
    s_nop 1
    v_cndmask_b32 v4, v4, v3, vcc
    v_lshrrev_b32 v5, 4, v3
    v_mul_u32_u24 v6, 11, v5
    v_lshrrev_b32 v6, 5, v6
    v_mul_u32_u24 v6, 3, v6
    v_add_u32 v5, v5, v6
    v_mul_u32_u24 v5, 20480, v5
    v_and_b32 v6, 15, v3
    v_lshl_add_u32 v7, v6, 4, v5
    s_mul_i32 s30, s29, 61440
    s_mul_i32 s31, s23, 491520
    s_add_u32 s30, s30, s31
    s_add_u32 s30, s30, 11534336
    s_lshl_b32 s31, s22, 4
    v_add_u32 v8, s31, v2
    s_waitcnt lgkmcnt(0)
    s_mov_b32 s32, s24
    s_mov_b32 s33, s25
    s_mov_b32 s34, 7864320
    s_mov_b32 s35, 0x00020000
    s_mul_i32 s28, s23, 384
    v_add_u32 v9, 0, v8
    v_lshrrev_b32 v10, 2, v9
    v_lshlrev_b32 v10, 5, v10
    v_and_b32 v11, 2, v9
    v_lshl_add_u32 v10, v11, 3, v10
    v_and_b32 v11, 1, v9
    v_lshl_add_u32 v10, v11, 2, v10
    v_mul_u32_u24 v10, 12288, v10
    v_lshl_add_u32 v10, v4, 1, v10
    s_add_u32 s31, s28, 0
    buffer_load_dword v16, v10, s[32:35], s31 offen
    s_add_u32 s31, s28, 12288
    buffer_load_dword v17, v10, s[32:35], s31 offen
    s_add_u32 s31, s28, 98304
    buffer_load_dword v18, v10, s[32:35], s31 offen
    s_add_u32 s31, s28, 110592
    buffer_load_dword v19, v10, s[32:35], s31 offen
    s_add_u32 s31, s28, 24576
    buffer_load_dword v20, v10, s[32:35], s31 offen
    s_add_u32 s31, s28, 36864
    buffer_load_dword v21, v10, s[32:35], s31 offen
    s_add_u32 s31, s28, 122880
    buffer_load_dword v22, v10, s[32:35], s31 offen
    s_add_u32 s31, s28, 135168
    buffer_load_dword v23, v10, s[32:35], s31 offen
    v_add_u32 v9, 2, v8
    v_lshrrev_b32 v10, 2, v9
    v_lshlrev_b32 v10, 5, v10
    v_and_b32 v11, 2, v9
    v_lshl_add_u32 v10, v11, 3, v10
    v_and_b32 v11, 1, v9
    v_lshl_add_u32 v10, v11, 2, v10
    v_mul_u32_u24 v10, 12288, v10
    v_lshl_add_u32 v10, v4, 1, v10
    s_add_u32 s31, s28, 0
    buffer_load_dword v24, v10, s[32:35], s31 offen
    s_add_u32 s31, s28, 12288
    buffer_load_dword v25, v10, s[32:35], s31 offen
    s_add_u32 s31, s28, 98304
    buffer_load_dword v26, v10, s[32:35], s31 offen
    s_add_u32 s31, s28, 110592
    buffer_load_dword v27, v10, s[32:35], s31 offen
    s_add_u32 s31, s28, 24576
    buffer_load_dword v28, v10, s[32:35], s31 offen
    s_add_u32 s31, s28, 36864
    buffer_load_dword v29, v10, s[32:35], s31 offen
    s_add_u32 s31, s28, 122880
    buffer_load_dword v30, v10, s[32:35], s31 offen
    s_add_u32 s31, s28, 135168
    buffer_load_dword v31, v10, s[32:35], s31 offen
    v_add_u32 v9, 4, v8
    v_lshrrev_b32 v10, 2, v9
    v_lshlrev_b32 v10, 5, v10
    v_and_b32 v11, 2, v9
    v_lshl_add_u32 v10, v11, 3, v10
    v_and_b32 v11, 1, v9
    v_lshl_add_u32 v10, v11, 2, v10
    v_mul_u32_u24 v10, 12288, v10
    v_lshl_add_u32 v10, v4, 1, v10
    s_add_u32 s31, s28, 0
    buffer_load_dword v32, v10, s[32:35], s31 offen
    s_add_u32 s31, s28, 12288
    buffer_load_dword v33, v10, s[32:35], s31 offen
    s_add_u32 s31, s28, 98304
    buffer_load_dword v34, v10, s[32:35], s31 offen
    s_add_u32 s31, s28, 110592
    buffer_load_dword v35, v10, s[32:35], s31 offen
    s_add_u32 s31, s28, 24576
    buffer_load_dword v36, v10, s[32:35], s31 offen
    s_add_u32 s31, s28, 36864
    buffer_load_dword v37, v10, s[32:35], s31 offen
    s_add_u32 s31, s28, 122880
    buffer_load_dword v38, v10, s[32:35], s31 offen
    s_add_u32 s31, s28, 135168
    buffer_load_dword v39, v10, s[32:35], s31 offen
    v_add_u32 v9, 6, v8
    v_lshrrev_b32 v10, 2, v9
    v_lshlrev_b32 v10, 5, v10
    v_and_b32 v11, 2, v9
    v_lshl_add_u32 v10, v11, 3, v10
    v_and_b32 v11, 1, v9
    v_lshl_add_u32 v10, v11, 2, v10
    v_mul_u32_u24 v10, 12288, v10
    v_lshl_add_u32 v10, v4, 1, v10
    s_add_u32 s31, s28, 0
    buffer_load_dword v40, v10, s[32:35], s31 offen
    s_add_u32 s31, s28, 12288
    buffer_load_dword v41, v10, s[32:35], s31 offen
    s_add_u32 s31, s28, 98304
    buffer_load_dword v42, v10, s[32:35], s31 offen
    s_add_u32 s31, s28, 110592
    buffer_load_dword v43, v10, s[32:35], s31 offen
    s_add_u32 s31, s28, 24576
    buffer_load_dword v44, v10, s[32:35], s31 offen
    s_add_u32 s31, s28, 36864
    buffer_load_dword v45, v10, s[32:35], s31 offen
    s_add_u32 s31, s28, 122880
    buffer_load_dword v46, v10, s[32:35], s31 offen
    s_add_u32 s31, s28, 135168
    buffer_load_dword v47, v10, s[32:35], s31 offen
    v_add_u32 v9, 8, v8
    v_lshrrev_b32 v10, 2, v9
    v_lshlrev_b32 v10, 5, v10
    v_and_b32 v11, 2, v9
    v_lshl_add_u32 v10, v11, 3, v10
    v_and_b32 v11, 1, v9
    v_lshl_add_u32 v10, v11, 2, v10
    v_mul_u32_u24 v10, 12288, v10
    v_lshl_add_u32 v10, v4, 1, v10
    s_add_u32 s31, s28, 0
    buffer_load_dword v48, v10, s[32:35], s31 offen
    s_add_u32 s31, s28, 12288
    buffer_load_dword v49, v10, s[32:35], s31 offen
    s_add_u32 s31, s28, 98304
    buffer_load_dword v50, v10, s[32:35], s31 offen
    s_add_u32 s31, s28, 110592
    buffer_load_dword v51, v10, s[32:35], s31 offen
    s_add_u32 s31, s28, 24576
    buffer_load_dword v52, v10, s[32:35], s31 offen
    s_add_u32 s31, s28, 36864
    buffer_load_dword v53, v10, s[32:35], s31 offen
    s_add_u32 s31, s28, 122880
    buffer_load_dword v54, v10, s[32:35], s31 offen
    s_add_u32 s31, s28, 135168
    buffer_load_dword v55, v10, s[32:35], s31 offen
    v_add_u32 v9, 10, v8
    v_lshrrev_b32 v10, 2, v9
    v_lshlrev_b32 v10, 5, v10
    v_and_b32 v11, 2, v9
    v_lshl_add_u32 v10, v11, 3, v10
    v_and_b32 v11, 1, v9
    v_lshl_add_u32 v10, v11, 2, v10
    v_mul_u32_u24 v10, 12288, v10
    v_lshl_add_u32 v10, v4, 1, v10
    s_add_u32 s31, s28, 0
    buffer_load_dword v56, v10, s[32:35], s31 offen
    s_add_u32 s31, s28, 12288
    buffer_load_dword v57, v10, s[32:35], s31 offen
    s_add_u32 s31, s28, 98304
    buffer_load_dword v58, v10, s[32:35], s31 offen
    s_add_u32 s31, s28, 110592
    buffer_load_dword v59, v10, s[32:35], s31 offen
    s_add_u32 s31, s28, 24576
    buffer_load_dword v60, v10, s[32:35], s31 offen
    s_add_u32 s31, s28, 36864
    buffer_load_dword v61, v10, s[32:35], s31 offen
    s_add_u32 s31, s28, 122880
    buffer_load_dword v62, v10, s[32:35], s31 offen
    s_add_u32 s31, s28, 135168
    buffer_load_dword v63, v10, s[32:35], s31 offen
    v_add_u32 v9, 12, v8
    v_lshrrev_b32 v10, 2, v9
    v_lshlrev_b32 v10, 5, v10
    v_and_b32 v11, 2, v9
    v_lshl_add_u32 v10, v11, 3, v10
    v_and_b32 v11, 1, v9
    v_lshl_add_u32 v10, v11, 2, v10
    v_mul_u32_u24 v10, 12288, v10
    v_lshl_add_u32 v10, v4, 1, v10
    s_add_u32 s31, s28, 0
    buffer_load_dword v64, v10, s[32:35], s31 offen
    s_add_u32 s31, s28, 12288
    buffer_load_dword v65, v10, s[32:35], s31 offen
    s_add_u32 s31, s28, 98304
    buffer_load_dword v66, v10, s[32:35], s31 offen
    s_add_u32 s31, s28, 110592
    buffer_load_dword v67, v10, s[32:35], s31 offen
    s_add_u32 s31, s28, 24576
    buffer_load_dword v68, v10, s[32:35], s31 offen
    s_add_u32 s31, s28, 36864
    buffer_load_dword v69, v10, s[32:35], s31 offen
    s_add_u32 s31, s28, 122880
    buffer_load_dword v70, v10, s[32:35], s31 offen
    s_add_u32 s31, s28, 135168
    buffer_load_dword v71, v10, s[32:35], s31 offen
    v_add_u32 v9, 14, v8
    v_lshrrev_b32 v10, 2, v9
    v_lshlrev_b32 v10, 5, v10
    v_and_b32 v11, 2, v9
    v_lshl_add_u32 v10, v11, 3, v10
    v_and_b32 v11, 1, v9
    v_lshl_add_u32 v10, v11, 2, v10
    v_mul_u32_u24 v10, 12288, v10
    v_lshl_add_u32 v10, v4, 1, v10
    s_add_u32 s31, s28, 0
    buffer_load_dword v72, v10, s[32:35], s31 offen
    s_add_u32 s31, s28, 12288
    buffer_load_dword v73, v10, s[32:35], s31 offen
    s_add_u32 s31, s28, 98304
    buffer_load_dword v74, v10, s[32:35], s31 offen
    s_add_u32 s31, s28, 110592
    buffer_load_dword v75, v10, s[32:35], s31 offen
    s_add_u32 s31, s28, 24576
    buffer_load_dword v76, v10, s[32:35], s31 offen
    s_add_u32 s31, s28, 36864
    buffer_load_dword v77, v10, s[32:35], s31 offen
    s_add_u32 s31, s28, 122880
    buffer_load_dword v78, v10, s[32:35], s31 offen
    s_add_u32 s31, s28, 135168
    buffer_load_dword v79, v10, s[32:35], s31 offen
    v_lshl_add_u32 v7, v8, 8, v7
    v_mov_b32 v4, 0x05040100
    v_mov_b32 v5, 0x07060302
    s_waitcnt vmcnt(56)
    v_perm_b32 v80, v17, v16, v4
    v_perm_b32 v84, v17, v16, v5
    v_perm_b32 v81, v19, v18, v4
    v_perm_b32 v85, v19, v18, v5
    v_perm_b32 v82, v21, v20, v4
    v_perm_b32 v86, v21, v20, v5
    v_perm_b32 v83, v23, v22, v4
    v_perm_b32 v87, v23, v22, v5
    buffer_store_dwordx4 v[80:83], v7, s[8:11], s30 offen offset:0
    buffer_store_dwordx4 v[84:87], v7, s[8:11], s30 offen offset:16
    s_waitcnt vmcnt(48)
    v_perm_b32 v88, v25, v24, v4
    v_perm_b32 v92, v25, v24, v5
    v_perm_b32 v89, v27, v26, v4
    v_perm_b32 v93, v27, v26, v5
    v_perm_b32 v90, v29, v28, v4
    v_perm_b32 v94, v29, v28, v5
    v_perm_b32 v91, v31, v30, v4
    v_perm_b32 v95, v31, v30, v5
    buffer_store_dwordx4 v[88:91], v7, s[8:11], s30 offen offset:512
    buffer_store_dwordx4 v[92:95], v7, s[8:11], s30 offen offset:528
    s_nop 0
    s_waitcnt vmcnt(40)
    v_perm_b32 v80, v33, v32, v4
    v_perm_b32 v84, v33, v32, v5
    v_perm_b32 v81, v35, v34, v4
    v_perm_b32 v85, v35, v34, v5
    v_perm_b32 v82, v37, v36, v4
    v_perm_b32 v86, v37, v36, v5
    v_perm_b32 v83, v39, v38, v4
    v_perm_b32 v87, v39, v38, v5
    buffer_store_dwordx4 v[80:83], v7, s[8:11], s30 offen offset:1024
    buffer_store_dwordx4 v[84:87], v7, s[8:11], s30 offen offset:1040
    s_nop 0
    s_waitcnt vmcnt(32)
    v_perm_b32 v88, v41, v40, v4
    v_perm_b32 v92, v41, v40, v5
    v_perm_b32 v89, v43, v42, v4
    v_perm_b32 v93, v43, v42, v5
    v_perm_b32 v90, v45, v44, v4
    v_perm_b32 v94, v45, v44, v5
    v_perm_b32 v91, v47, v46, v4
    v_perm_b32 v95, v47, v46, v5
    buffer_store_dwordx4 v[88:91], v7, s[8:11], s30 offen offset:1536
    buffer_store_dwordx4 v[92:95], v7, s[8:11], s30 offen offset:1552
    s_nop 0
    s_waitcnt vmcnt(24)
    v_perm_b32 v80, v49, v48, v4
    v_perm_b32 v84, v49, v48, v5
    v_perm_b32 v81, v51, v50, v4
    v_perm_b32 v85, v51, v50, v5
    v_perm_b32 v82, v53, v52, v4
    v_perm_b32 v86, v53, v52, v5
    v_perm_b32 v83, v55, v54, v4
    v_perm_b32 v87, v55, v54, v5
    buffer_store_dwordx4 v[80:83], v7, s[8:11], s30 offen offset:2048
    buffer_store_dwordx4 v[84:87], v7, s[8:11], s30 offen offset:2064
    s_nop 0
    s_waitcnt vmcnt(16)
    v_perm_b32 v88, v57, v56, v4
    v_perm_b32 v92, v57, v56, v5
    v_perm_b32 v89, v59, v58, v4
    v_perm_b32 v93, v59, v58, v5
    v_perm_b32 v90, v61, v60, v4
    v_perm_b32 v94, v61, v60, v5
    v_perm_b32 v91, v63, v62, v4
    v_perm_b32 v95, v63, v62, v5
    buffer_store_dwordx4 v[88:91], v7, s[8:11], s30 offen offset:2560
    buffer_store_dwordx4 v[92:95], v7, s[8:11], s30 offen offset:2576
    s_nop 0
    s_waitcnt vmcnt(8)
    v_perm_b32 v80, v65, v64, v4
    v_perm_b32 v84, v65, v64, v5
    v_perm_b32 v81, v67, v66, v4
    v_perm_b32 v85, v67, v66, v5
    v_perm_b32 v82, v69, v68, v4
    v_perm_b32 v86, v69, v68, v5
    v_perm_b32 v83, v71, v70, v4
    v_perm_b32 v87, v71, v70, v5
    buffer_store_dwordx4 v[80:83], v7, s[8:11], s30 offen offset:3072
    buffer_store_dwordx4 v[84:87], v7, s[8:11], s30 offen offset:3088
    s_nop 0
    s_waitcnt vmcnt(0)
    v_perm_b32 v88, v73, v72, v4
    v_perm_b32 v92, v73, v72, v5
    v_perm_b32 v89, v75, v74, v4
    v_perm_b32 v93, v75, v74, v5
    v_perm_b32 v90, v77, v76, v4
    v_perm_b32 v94, v77, v76, v5
    v_perm_b32 v91, v79, v78, v4
    v_perm_b32 v95, v79, v78, v5
    buffer_store_dwordx4 v[88:91], v7, s[8:11], s30 offen offset:3584
    buffer_store_dwordx4 v[92:95], v7, s[8:11], s30 offen offset:3600
    s_nop 0
    s_branch prep_kernel_end
prep_kernel_r_pwa:
    s_load_dwordx2 s[24:25], s[0:1], 8
    s_lshr_b32 s21, s20, 1
    s_and_b32 s22, s20, 1
    v_and_b32 v1, 31, v0
    v_lshrrev_b32 v2, 5, v0
    s_mul_i32 s23, s21, 20
    v_add_u32 v3, 640, v1
    v_add_u32 v4, 1260, v1
    v_cmp_gt_u32 vcc, 20, v1
    s_nop 1
    v_cndmask_b32 v3, v4, v3, vcc
    v_add_u32 v4, 1292, v1
    v_subrev_u32 v5, 12, v1
    v_cmp_gt_u32 vcc, 8, v1
    s_nop 1
    v_cndmask_b32 v4, v5, v4, vcc
    s_cmp_eq_u32 s22, 0
    s_cselect_b64 vcc, -1, 0
    s_nop 1
    v_cndmask_b32 v3, v4, v3, vcc
    v_add_u32 v3, s23, v3
    v_lshlrev_b32 v3, 1, v3
    v_mul_u32_u24 v4, 30720, v2
    v_add_u32 v3, v3, v4
    s_mov_b32 s26, 0xfffff0ff
    s_cmp_eq_u32 s22, 0
    s_cselect_b32 s26, -1, s26
    s_mov_b32 s27, s26
    v_mov_b32 v16, 0
    v_mov_b32 v17, 0
    v_mov_b32 v18, 0
    v_mov_b32 v19, 0
    v_mov_b32 v20, 0
    v_mov_b32 v21, 0
    v_mov_b32 v22, 0
    v_mov_b32 v23, 0
    v_mov_b32 v24, 0
    v_mov_b32 v25, 0
    v_mov_b32 v26, 0
    v_mov_b32 v27, 0
    v_mov_b32 v28, 0
    v_mov_b32 v29, 0
    v_mov_b32 v30, 0
    v_mov_b32 v31, 0
    v_mov_b32 v32, 0
    v_mov_b32 v33, 0
    v_mov_b32 v34, 0
    v_mov_b32 v35, 0
    v_mov_b32 v36, 0
    v_mov_b32 v37, 0
    v_mov_b32 v38, 0
    v_mov_b32 v39, 0
    v_mov_b32 v40, 0
    v_mov_b32 v41, 0
    v_mov_b32 v42, 0
    v_mov_b32 v43, 0
    v_mov_b32 v44, 0
    v_mov_b32 v45, 0
    v_mov_b32 v46, 0
    v_mov_b32 v47, 0
    v_mov_b32 v48, 0
    v_mov_b32 v49, 0
    v_mov_b32 v50, 0
    v_mov_b32 v51, 0
    v_mov_b32 v52, 0
    v_mov_b32 v53, 0
    v_mov_b32 v54, 0
    v_mov_b32 v55, 0
    v_mov_b32 v56, 0
    v_mov_b32 v57, 0
    v_mov_b32 v58, 0
    v_mov_b32 v59, 0
    v_mov_b32 v60, 0
    v_mov_b32 v61, 0
    v_mov_b32 v62, 0
    v_mov_b32 v63, 0
    v_mov_b32 v64, 0
    v_mov_b32 v65, 0
    v_mov_b32 v66, 0
    v_mov_b32 v67, 0
    v_mov_b32 v68, 0
    v_mov_b32 v69, 0
    v_mov_b32 v70, 0
    v_mov_b32 v71, 0
    v_mov_b32 v72, 0
    v_mov_b32 v73, 0
    v_mov_b32 v74, 0
    v_mov_b32 v75, 0
    v_mov_b32 v76, 0
    v_mov_b32 v77, 0
    v_mov_b32 v78, 0
    v_mov_b32 v79, 0
    v_mov_b32 v80, 0
    v_mov_b32 v81, 0
    v_mov_b32 v82, 0
    v_mov_b32 v83, 0
    v_mov_b32 v84, 0
    v_mov_b32 v85, 0
    v_mov_b32 v86, 0
    v_mov_b32 v87, 0
    v_mov_b32 v88, 0
    v_mov_b32 v89, 0
    v_mov_b32 v90, 0
    v_mov_b32 v91, 0
    v_mov_b32 v92, 0
    v_mov_b32 v93, 0
    v_mov_b32 v94, 0
    v_mov_b32 v95, 0
    s_waitcnt lgkmcnt(0)
    s_mov_b32 s32, s24
    s_mov_b32 s33, s25
    s_mov_b32 s34, 2457600
    s_mov_b32 s35, 0x00020000
    s_mul_i32 s28, s13, 614400
    s_mov_b64 exec, s[26:27]
    s_add_u32 s29, s28, 0
    buffer_load_short_d16_hi v16, v3, s[32:35], s29 offen
    s_add_u32 s29, s28, 3840
    buffer_load_short_d16_hi v17, v3, s[32:35], s29 offen
    s_add_u32 s29, s28, 7680
    buffer_load_short_d16_hi v18, v3, s[32:35], s29 offen
    s_add_u32 s29, s28, 11520
    buffer_load_short_d16_hi v19, v3, s[32:35], s29 offen
    s_add_u32 s29, s28, 15360
    buffer_load_short_d16_hi v20, v3, s[32:35], s29 offen
    s_add_u32 s29, s28, 19200
    buffer_load_short_d16_hi v21, v3, s[32:35], s29 offen
    s_add_u32 s29, s28, 23040
    buffer_load_short_d16_hi v22, v3, s[32:35], s29 offen
    s_add_u32 s29, s28, 26880
    buffer_load_short_d16_hi v23, v3, s[32:35], s29 offen
    s_add_u32 s29, s28, 61440
    buffer_load_short_d16_hi v24, v3, s[32:35], s29 offen
    s_add_u32 s29, s28, 65280
    buffer_load_short_d16_hi v25, v3, s[32:35], s29 offen
    s_add_u32 s29, s28, 69120
    buffer_load_short_d16_hi v26, v3, s[32:35], s29 offen
    s_add_u32 s29, s28, 72960
    buffer_load_short_d16_hi v27, v3, s[32:35], s29 offen
    s_add_u32 s29, s28, 76800
    buffer_load_short_d16_hi v28, v3, s[32:35], s29 offen
    s_add_u32 s29, s28, 80640
    buffer_load_short_d16_hi v29, v3, s[32:35], s29 offen
    s_add_u32 s29, s28, 84480
    buffer_load_short_d16_hi v30, v3, s[32:35], s29 offen
    s_add_u32 s29, s28, 88320
    buffer_load_short_d16_hi v31, v3, s[32:35], s29 offen
    s_add_u32 s29, s28, 122880
    buffer_load_short_d16_hi v32, v3, s[32:35], s29 offen
    s_add_u32 s29, s28, 126720
    buffer_load_short_d16_hi v33, v3, s[32:35], s29 offen
    s_add_u32 s29, s28, 130560
    buffer_load_short_d16_hi v34, v3, s[32:35], s29 offen
    s_add_u32 s29, s28, 134400
    buffer_load_short_d16_hi v35, v3, s[32:35], s29 offen
    s_add_u32 s29, s28, 138240
    buffer_load_short_d16_hi v36, v3, s[32:35], s29 offen
    s_add_u32 s29, s28, 142080
    buffer_load_short_d16_hi v37, v3, s[32:35], s29 offen
    s_add_u32 s29, s28, 145920
    buffer_load_short_d16_hi v38, v3, s[32:35], s29 offen
    s_add_u32 s29, s28, 149760
    buffer_load_short_d16_hi v39, v3, s[32:35], s29 offen
    s_add_u32 s29, s28, 184320
    buffer_load_short_d16_hi v40, v3, s[32:35], s29 offen
    s_add_u32 s29, s28, 188160
    buffer_load_short_d16_hi v41, v3, s[32:35], s29 offen
    s_add_u32 s29, s28, 192000
    buffer_load_short_d16_hi v42, v3, s[32:35], s29 offen
    s_add_u32 s29, s28, 195840
    buffer_load_short_d16_hi v43, v3, s[32:35], s29 offen
    s_add_u32 s29, s28, 199680
    buffer_load_short_d16_hi v44, v3, s[32:35], s29 offen
    s_add_u32 s29, s28, 203520
    buffer_load_short_d16_hi v45, v3, s[32:35], s29 offen
    s_add_u32 s29, s28, 207360
    buffer_load_short_d16_hi v46, v3, s[32:35], s29 offen
    s_add_u32 s29, s28, 211200
    buffer_load_short_d16_hi v47, v3, s[32:35], s29 offen
    s_add_u32 s29, s28, 245760
    buffer_load_short_d16_hi v48, v3, s[32:35], s29 offen
    s_add_u32 s29, s28, 249600
    buffer_load_short_d16_hi v49, v3, s[32:35], s29 offen
    s_add_u32 s29, s28, 253440
    buffer_load_short_d16_hi v50, v3, s[32:35], s29 offen
    s_add_u32 s29, s28, 257280
    buffer_load_short_d16_hi v51, v3, s[32:35], s29 offen
    s_add_u32 s29, s28, 261120
    buffer_load_short_d16_hi v52, v3, s[32:35], s29 offen
    s_add_u32 s29, s28, 264960
    buffer_load_short_d16_hi v53, v3, s[32:35], s29 offen
    s_add_u32 s29, s28, 268800
    buffer_load_short_d16_hi v54, v3, s[32:35], s29 offen
    s_add_u32 s29, s28, 272640
    buffer_load_short_d16_hi v55, v3, s[32:35], s29 offen
    s_add_u32 s29, s28, 307200
    buffer_load_short_d16_hi v56, v3, s[32:35], s29 offen
    s_add_u32 s29, s28, 311040
    buffer_load_short_d16_hi v57, v3, s[32:35], s29 offen
    s_add_u32 s29, s28, 314880
    buffer_load_short_d16_hi v58, v3, s[32:35], s29 offen
    s_add_u32 s29, s28, 318720
    buffer_load_short_d16_hi v59, v3, s[32:35], s29 offen
    s_add_u32 s29, s28, 322560
    buffer_load_short_d16_hi v60, v3, s[32:35], s29 offen
    s_add_u32 s29, s28, 326400
    buffer_load_short_d16_hi v61, v3, s[32:35], s29 offen
    s_add_u32 s29, s28, 330240
    buffer_load_short_d16_hi v62, v3, s[32:35], s29 offen
    s_add_u32 s29, s28, 334080
    buffer_load_short_d16_hi v63, v3, s[32:35], s29 offen
    s_add_u32 s29, s28, 368640
    buffer_load_short_d16_hi v64, v3, s[32:35], s29 offen
    s_add_u32 s29, s28, 372480
    buffer_load_short_d16_hi v65, v3, s[32:35], s29 offen
    s_add_u32 s29, s28, 376320
    buffer_load_short_d16_hi v66, v3, s[32:35], s29 offen
    s_add_u32 s29, s28, 380160
    buffer_load_short_d16_hi v67, v3, s[32:35], s29 offen
    s_add_u32 s29, s28, 384000
    buffer_load_short_d16_hi v68, v3, s[32:35], s29 offen
    s_add_u32 s29, s28, 387840
    buffer_load_short_d16_hi v69, v3, s[32:35], s29 offen
    s_add_u32 s29, s28, 391680
    buffer_load_short_d16_hi v70, v3, s[32:35], s29 offen
    s_add_u32 s29, s28, 395520
    buffer_load_short_d16_hi v71, v3, s[32:35], s29 offen
    s_add_u32 s29, s28, 430080
    buffer_load_short_d16_hi v72, v3, s[32:35], s29 offen
    s_add_u32 s29, s28, 433920
    buffer_load_short_d16_hi v73, v3, s[32:35], s29 offen
    s_add_u32 s29, s28, 437760
    buffer_load_short_d16_hi v74, v3, s[32:35], s29 offen
    s_add_u32 s29, s28, 441600
    buffer_load_short_d16_hi v75, v3, s[32:35], s29 offen
    s_add_u32 s29, s28, 445440
    buffer_load_short_d16_hi v76, v3, s[32:35], s29 offen
    s_add_u32 s29, s28, 449280
    buffer_load_short_d16_hi v77, v3, s[32:35], s29 offen
    s_add_u32 s29, s28, 453120
    buffer_load_short_d16_hi v78, v3, s[32:35], s29 offen
    s_add_u32 s29, s28, 456960
    buffer_load_short_d16_hi v79, v3, s[32:35], s29 offen
    s_add_u32 s29, s28, 491520
    buffer_load_short_d16_hi v80, v3, s[32:35], s29 offen
    s_add_u32 s29, s28, 495360
    buffer_load_short_d16_hi v81, v3, s[32:35], s29 offen
    s_add_u32 s29, s28, 499200
    buffer_load_short_d16_hi v82, v3, s[32:35], s29 offen
    s_add_u32 s29, s28, 503040
    buffer_load_short_d16_hi v83, v3, s[32:35], s29 offen
    s_add_u32 s29, s28, 506880
    buffer_load_short_d16_hi v84, v3, s[32:35], s29 offen
    s_add_u32 s29, s28, 510720
    buffer_load_short_d16_hi v85, v3, s[32:35], s29 offen
    s_add_u32 s29, s28, 514560
    buffer_load_short_d16_hi v86, v3, s[32:35], s29 offen
    s_add_u32 s29, s28, 518400
    buffer_load_short_d16_hi v87, v3, s[32:35], s29 offen
    s_add_u32 s29, s28, 552960
    buffer_load_short_d16_hi v88, v3, s[32:35], s29 offen
    s_add_u32 s29, s28, 556800
    buffer_load_short_d16_hi v89, v3, s[32:35], s29 offen
    s_add_u32 s29, s28, 560640
    buffer_load_short_d16_hi v90, v3, s[32:35], s29 offen
    s_add_u32 s29, s28, 564480
    buffer_load_short_d16_hi v91, v3, s[32:35], s29 offen
    s_add_u32 s29, s28, 568320
    buffer_load_short_d16_hi v92, v3, s[32:35], s29 offen
    s_add_u32 s29, s28, 572160
    buffer_load_short_d16_hi v93, v3, s[32:35], s29 offen
    s_add_u32 s29, s28, 576000
    buffer_load_short_d16_hi v94, v3, s[32:35], s29 offen
    s_add_u32 s29, s28, 579840
    buffer_load_short_d16_hi v95, v3, s[32:35], s29 offen
    s_mov_b64 exec, -1
    s_waitcnt vmcnt(0)
    v_add_f32 v5, v16, v17
    v_add_f32 v5, v5, v18
    v_add_f32 v5, v5, v19
    v_add_f32 v5, v5, v20
    v_add_f32 v5, v5, v21
    v_add_f32 v5, v5, v22
    v_add_f32 v5, v5, v23
    v_add_f32 v5, v5, v24
    v_add_f32 v5, v5, v25
    v_add_f32 v5, v5, v26
    v_add_f32 v5, v5, v27
    v_add_f32 v5, v5, v28
    v_add_f32 v5, v5, v29
    v_add_f32 v5, v5, v30
    v_add_f32 v5, v5, v31
    v_add_f32 v5, v5, v32
    v_add_f32 v5, v5, v33
    v_add_f32 v5, v5, v34
    v_add_f32 v5, v5, v35
    v_add_f32 v5, v5, v36
    v_add_f32 v5, v5, v37
    v_add_f32 v5, v5, v38
    v_add_f32 v5, v5, v39
    v_add_f32 v5, v5, v40
    v_add_f32 v5, v5, v41
    v_add_f32 v5, v5, v42
    v_add_f32 v5, v5, v43
    v_add_f32 v5, v5, v44
    v_add_f32 v5, v5, v45
    v_add_f32 v5, v5, v46
    v_add_f32 v5, v5, v47
    v_add_f32 v5, v5, v48
    v_add_f32 v5, v5, v49
    v_add_f32 v5, v5, v50
    v_add_f32 v5, v5, v51
    v_add_f32 v5, v5, v52
    v_add_f32 v5, v5, v53
    v_add_f32 v5, v5, v54
    v_add_f32 v5, v5, v55
    v_add_f32 v5, v5, v56
    v_add_f32 v5, v5, v57
    v_add_f32 v5, v5, v58
    v_add_f32 v5, v5, v59
    v_add_f32 v5, v5, v60
    v_add_f32 v5, v5, v61
    v_add_f32 v5, v5, v62
    v_add_f32 v5, v5, v63
    v_add_f32 v5, v5, v64
    v_add_f32 v5, v5, v65
    v_add_f32 v5, v5, v66
    v_add_f32 v5, v5, v67
    v_add_f32 v5, v5, v68
    v_add_f32 v5, v5, v69
    v_add_f32 v5, v5, v70
    v_add_f32 v5, v5, v71
    v_add_f32 v5, v5, v72
    v_add_f32 v5, v5, v73
    v_add_f32 v5, v5, v74
    v_add_f32 v5, v5, v75
    v_add_f32 v5, v5, v76
    v_add_f32 v5, v5, v77
    v_add_f32 v5, v5, v78
    v_add_f32 v5, v5, v79
    v_add_f32 v5, v5, v80
    v_add_f32 v5, v5, v81
    v_add_f32 v5, v5, v82
    v_add_f32 v5, v5, v83
    v_add_f32 v5, v5, v84
    v_add_f32 v5, v5, v85
    v_add_f32 v5, v5, v86
    v_add_f32 v5, v5, v87
    v_add_f32 v5, v5, v88
    v_add_f32 v5, v5, v89
    v_add_f32 v5, v5, v90
    v_add_f32 v5, v5, v91
    v_add_f32 v5, v5, v92
    v_add_f32 v5, v5, v93
    v_add_f32 v5, v5, v94
    v_add_f32 v5, v5, v95
    v_mov_b32 v6, v5
    s_nop 1
    v_permlane32_swap_b32 v5, v6
    v_add_f32 v5, v5, v6
    s_lshl_b32 s29, s13, 8
    v_lshlrev_b32 v7, 2, v0
    v_add_u32 v8, s29, v7
    ds_write_b32 v8, v5
    s_waitcnt lgkmcnt(0)
    s_barrier
    ds_read_b32 v8, v7 offset:0
    ds_read_b32 v9, v7 offset:256
    ds_read_b32 v10, v7 offset:512
    ds_read_b32 v11, v7 offset:768
    s_waitcnt lgkmcnt(0)
    v_add_f32 v8, v8, v9
    v_add_f32 v10, v10, v11
    v_add_f32 v8, v8, v10
    v_mul_f32 v8, 0x3acccccd, v8
    v_sub_f32 v16, v16, v8
    v_sub_f32 v17, v17, v8
    v_sub_f32 v18, v18, v8
    v_sub_f32 v19, v19, v8
    v_sub_f32 v20, v20, v8
    v_sub_f32 v21, v21, v8
    v_sub_f32 v22, v22, v8
    v_sub_f32 v23, v23, v8
    v_sub_f32 v24, v24, v8
    v_sub_f32 v25, v25, v8
    v_sub_f32 v26, v26, v8
    v_sub_f32 v27, v27, v8
    v_sub_f32 v28, v28, v8
    v_sub_f32 v29, v29, v8
    v_sub_f32 v30, v30, v8
    v_sub_f32 v31, v31, v8
    v_sub_f32 v32, v32, v8
    v_sub_f32 v33, v33, v8
    v_sub_f32 v34, v34, v8
    v_sub_f32 v35, v35, v8
    v_sub_f32 v36, v36, v8
    v_sub_f32 v37, v37, v8
    v_sub_f32 v38, v38, v8
    v_sub_f32 v39, v39, v8
    v_sub_f32 v40, v40, v8
    v_sub_f32 v41, v41, v8
    v_sub_f32 v42, v42, v8
    v_sub_f32 v43, v43, v8
    v_sub_f32 v44, v44, v8
    v_sub_f32 v45, v45, v8
    v_sub_f32 v46, v46, v8
    v_sub_f32 v47, v47, v8
    v_sub_f32 v48, v48, v8
    v_sub_f32 v49, v49, v8
    v_sub_f32 v50, v50, v8
    v_sub_f32 v51, v51, v8
    v_sub_f32 v52, v52, v8
    v_sub_f32 v53, v53, v8
    v_sub_f32 v54, v54, v8
    v_sub_f32 v55, v55, v8
    v_sub_f32 v56, v56, v8
    v_sub_f32 v57, v57, v8
    v_sub_f32 v58, v58, v8
    v_sub_f32 v59, v59, v8
    v_sub_f32 v60, v60, v8
    v_sub_f32 v61, v61, v8
    v_sub_f32 v62, v62, v8
    v_sub_f32 v63, v63, v8
    v_sub_f32 v64, v64, v8
    v_sub_f32 v65, v65, v8
    v_sub_f32 v66, v66, v8
    v_sub_f32 v67, v67, v8
    v_sub_f32 v68, v68, v8
    v_sub_f32 v69, v69, v8
    v_sub_f32 v70, v70, v8
    v_sub_f32 v71, v71, v8
    v_sub_f32 v72, v72, v8
    v_sub_f32 v73, v73, v8
    v_sub_f32 v74, v74, v8
    v_sub_f32 v75, v75, v8
    v_sub_f32 v76, v76, v8
    v_sub_f32 v77, v77, v8
    v_sub_f32 v78, v78, v8
    v_sub_f32 v79, v79, v8
    v_sub_f32 v80, v80, v8
    v_sub_f32 v81, v81, v8
    v_sub_f32 v82, v82, v8
    v_sub_f32 v83, v83, v8
    v_sub_f32 v84, v84, v8
    v_sub_f32 v85, v85, v8
    v_sub_f32 v86, v86, v8
    v_sub_f32 v87, v87, v8
    v_sub_f32 v88, v88, v8
    v_sub_f32 v89, v89, v8
    v_sub_f32 v90, v90, v8
    v_sub_f32 v91, v91, v8
    v_sub_f32 v92, v92, v8
    v_sub_f32 v93, v93, v8
    v_sub_f32 v94, v94, v8
    v_sub_f32 v95, v95, v8
    s_mul_i32 s29, s21, 81920
    s_lshl_b32 s30, s22, 10
    s_add_u32 s29, s29, s30
    s_mul_i32 s30, s13, 20480
    s_add_u32 s29, s29, s30
    s_add_u32 s29, s29, 243269632
    v_lshlrev_b32 v7, 4, v0
    v_cvt_pk_bf16_f32 v100, v16, v17
    v_cvt_pk_bf16_f32 v101, v18, v19
    v_cvt_pk_bf16_f32 v102, v20, v21
    v_cvt_pk_bf16_f32 v103, v22, v23
    buffer_store_dwordx4 v[100:103], v7, s[8:11], s29 offen
    s_add_u32 s29, s29, 2048
    v_cvt_pk_bf16_f32 v104, v24, v25
    v_cvt_pk_bf16_f32 v105, v26, v27
    v_cvt_pk_bf16_f32 v106, v28, v29
    v_cvt_pk_bf16_f32 v107, v30, v31
    buffer_store_dwordx4 v[104:107], v7, s[8:11], s29 offen
    s_add_u32 s29, s29, 2048
    v_cvt_pk_bf16_f32 v100, v32, v33
    v_cvt_pk_bf16_f32 v101, v34, v35
    v_cvt_pk_bf16_f32 v102, v36, v37
    v_cvt_pk_bf16_f32 v103, v38, v39
    buffer_store_dwordx4 v[100:103], v7, s[8:11], s29 offen
    s_add_u32 s29, s29, 2048
    v_cvt_pk_bf16_f32 v104, v40, v41
    v_cvt_pk_bf16_f32 v105, v42, v43
    v_cvt_pk_bf16_f32 v106, v44, v45
    v_cvt_pk_bf16_f32 v107, v46, v47
    buffer_store_dwordx4 v[104:107], v7, s[8:11], s29 offen
    s_add_u32 s29, s29, 2048
    v_cvt_pk_bf16_f32 v100, v48, v49
    v_cvt_pk_bf16_f32 v101, v50, v51
    v_cvt_pk_bf16_f32 v102, v52, v53
    v_cvt_pk_bf16_f32 v103, v54, v55
    buffer_store_dwordx4 v[100:103], v7, s[8:11], s29 offen
    s_add_u32 s29, s29, 2048
    v_cvt_pk_bf16_f32 v104, v56, v57
    v_cvt_pk_bf16_f32 v105, v58, v59
    v_cvt_pk_bf16_f32 v106, v60, v61
    v_cvt_pk_bf16_f32 v107, v62, v63
    buffer_store_dwordx4 v[104:107], v7, s[8:11], s29 offen
    s_add_u32 s29, s29, 2048
    v_cvt_pk_bf16_f32 v100, v64, v65
    v_cvt_pk_bf16_f32 v101, v66, v67
    v_cvt_pk_bf16_f32 v102, v68, v69
    v_cvt_pk_bf16_f32 v103, v70, v71
    buffer_store_dwordx4 v[100:103], v7, s[8:11], s29 offen
    s_add_u32 s29, s29, 2048
    v_cvt_pk_bf16_f32 v104, v72, v73
    v_cvt_pk_bf16_f32 v105, v74, v75
    v_cvt_pk_bf16_f32 v106, v76, v77
    v_cvt_pk_bf16_f32 v107, v78, v79
    buffer_store_dwordx4 v[104:107], v7, s[8:11], s29 offen
    s_add_u32 s29, s29, 2048
    v_cvt_pk_bf16_f32 v100, v80, v81
    v_cvt_pk_bf16_f32 v101, v82, v83
    v_cvt_pk_bf16_f32 v102, v84, v85
    v_cvt_pk_bf16_f32 v103, v86, v87
    buffer_store_dwordx4 v[100:103], v7, s[8:11], s29 offen
    s_add_u32 s29, s29, 2048
    v_cvt_pk_bf16_f32 v104, v88, v89
    v_cvt_pk_bf16_f32 v105, v90, v91
    v_cvt_pk_bf16_f32 v106, v92, v93
    v_cvt_pk_bf16_f32 v107, v94, v95
    buffer_store_dwordx4 v[104:107], v7, s[8:11], s29 offen
    s_add_u32 s29, s29, 2048
    s_branch prep_kernel_end
prep_kernel_r_pwo:
    s_lshl_b32 s20, s20, 2
    s_add_u32 s20, s20, s13
    s_load_dwordx2 s[24:25], s[0:1], 16
    s_lshr_b32 s21, s20, 3
    s_and_b32 s22, s20, 7
    v_and_b32 v1, 31, v0
    v_lshrrev_b32 v2, 5, v0
    v_lshlrev_b32 v3, 1, v1
    v_mul_u32_u24 v4, 10240, v2
    v_add_u32 v3, v3, v4
    s_lshl_b32 s29, s21, 6
    s_mul_i32 s30, s22, 102400
    s_add_u32 s29, s29, s30
    s_waitcnt lgkmcnt(0)
    s_mov_b32 s32, s24
    s_mov_b32 s33, s25
    s_mov_b32 s34, 819200
    s_mov_b32 s35, 0x00020000
    s_add_u32 s30, s29, 0
    buffer_load_ushort v16, v3, s[32:35], s30 offen
    s_add_u32 s30, s29, 1280
    buffer_load_ushort v17, v3, s[32:35], s30 offen
    s_add_u32 s30, s29, 2560
    buffer_load_ushort v18, v3, s[32:35], s30 offen
    s_add_u32 s30, s29, 3840
    buffer_load_ushort v19, v3, s[32:35], s30 offen
    s_add_u32 s30, s29, 5120
    buffer_load_ushort v20, v3, s[32:35], s30 offen
    s_add_u32 s30, s29, 6400
    buffer_load_ushort v21, v3, s[32:35], s30 offen
    s_add_u32 s30, s29, 7680
    buffer_load_ushort v22, v3, s[32:35], s30 offen
    s_add_u32 s30, s29, 8960
    buffer_load_ushort v23, v3, s[32:35], s30 offen
    s_add_u32 s30, s29, 20480
    buffer_load_ushort v24, v3, s[32:35], s30 offen
    s_add_u32 s30, s29, 21760
    buffer_load_ushort v25, v3, s[32:35], s30 offen
    s_add_u32 s30, s29, 23040
    buffer_load_ushort v26, v3, s[32:35], s30 offen
    s_add_u32 s30, s29, 24320
    buffer_load_ushort v27, v3, s[32:35], s30 offen
    s_add_u32 s30, s29, 25600
    buffer_load_ushort v28, v3, s[32:35], s30 offen
    s_add_u32 s30, s29, 26880
    buffer_load_ushort v29, v3, s[32:35], s30 offen
    s_add_u32 s30, s29, 28160
    buffer_load_ushort v30, v3, s[32:35], s30 offen
    s_add_u32 s30, s29, 29440
    buffer_load_ushort v31, v3, s[32:35], s30 offen
    s_add_u32 s30, s29, 40960
    buffer_load_ushort v32, v3, s[32:35], s30 offen
    s_add_u32 s30, s29, 42240
    buffer_load_ushort v33, v3, s[32:35], s30 offen
    s_add_u32 s30, s29, 43520
    buffer_load_ushort v34, v3, s[32:35], s30 offen
    s_add_u32 s30, s29, 44800
    buffer_load_ushort v35, v3, s[32:35], s30 offen
    s_add_u32 s30, s29, 46080
    buffer_load_ushort v36, v3, s[32:35], s30 offen
    s_add_u32 s30, s29, 47360
    buffer_load_ushort v37, v3, s[32:35], s30 offen
    s_add_u32 s30, s29, 48640
    buffer_load_ushort v38, v3, s[32:35], s30 offen
    s_add_u32 s30, s29, 49920
    buffer_load_ushort v39, v3, s[32:35], s30 offen
    s_add_u32 s30, s29, 61440
    buffer_load_ushort v40, v3, s[32:35], s30 offen
    s_add_u32 s30, s29, 62720
    buffer_load_ushort v41, v3, s[32:35], s30 offen
    s_add_u32 s30, s29, 64000
    buffer_load_ushort v42, v3, s[32:35], s30 offen
    s_add_u32 s30, s29, 65280
    buffer_load_ushort v43, v3, s[32:35], s30 offen
    s_add_u32 s30, s29, 66560
    buffer_load_ushort v44, v3, s[32:35], s30 offen
    s_add_u32 s30, s29, 67840
    buffer_load_ushort v45, v3, s[32:35], s30 offen
    s_add_u32 s30, s29, 69120
    buffer_load_ushort v46, v3, s[32:35], s30 offen
    s_add_u32 s30, s29, 70400
    buffer_load_ushort v47, v3, s[32:35], s30 offen
    s_add_u32 s30, s29, 81920
    buffer_load_ushort v48, v3, s[32:35], s30 offen
    s_add_u32 s30, s29, 83200
    buffer_load_ushort v49, v3, s[32:35], s30 offen
    s_add_u32 s30, s29, 84480
    buffer_load_ushort v50, v3, s[32:35], s30 offen
    s_add_u32 s30, s29, 85760
    buffer_load_ushort v51, v3, s[32:35], s30 offen
    s_add_u32 s30, s29, 87040
    buffer_load_ushort v52, v3, s[32:35], s30 offen
    s_add_u32 s30, s29, 88320
    buffer_load_ushort v53, v3, s[32:35], s30 offen
    s_add_u32 s30, s29, 89600
    buffer_load_ushort v54, v3, s[32:35], s30 offen
    s_add_u32 s30, s29, 90880
    buffer_load_ushort v55, v3, s[32:35], s30 offen
    s_mul_i32 s29, s20, 5120
    s_add_u32 s29, s29, 246415360
    v_lshlrev_b32 v7, 4, v0
    s_waitcnt vmcnt(32)
    v_lshl_or_b32 v64, v17, 16, v16
    v_lshl_or_b32 v65, v19, 16, v18
    v_lshl_or_b32 v66, v21, 16, v20
    v_lshl_or_b32 v67, v23, 16, v22
    buffer_store_dwordx4 v[64:67], v7, s[8:11], s29 offen offset:0
    s_waitcnt vmcnt(25)
    v_lshl_or_b32 v68, v25, 16, v24
    v_lshl_or_b32 v69, v27, 16, v26
    v_lshl_or_b32 v70, v29, 16, v28
    v_lshl_or_b32 v71, v31, 16, v30
    buffer_store_dwordx4 v[68:71], v7, s[8:11], s29 offen offset:1024
    s_waitcnt vmcnt(18)
    v_lshl_or_b32 v72, v33, 16, v32
    v_lshl_or_b32 v73, v35, 16, v34
    v_lshl_or_b32 v74, v37, 16, v36
    v_lshl_or_b32 v75, v39, 16, v38
    buffer_store_dwordx4 v[72:75], v7, s[8:11], s29 offen offset:2048
    s_waitcnt vmcnt(11)
    v_lshl_or_b32 v76, v41, 16, v40
    v_lshl_or_b32 v77, v43, 16, v42
    v_lshl_or_b32 v78, v45, 16, v44
    v_lshl_or_b32 v79, v47, 16, v46
    buffer_store_dwordx4 v[76:79], v7, s[8:11], s29 offen offset:3072
    s_add_u32 s29, s29, 4096
    s_waitcnt vmcnt(4)
    v_lshl_or_b32 v80, v49, 16, v48
    v_lshl_or_b32 v81, v51, 16, v50
    v_lshl_or_b32 v82, v53, 16, v52
    v_lshl_or_b32 v83, v55, 16, v54
    buffer_store_dwordx4 v[80:83], v7, s[8:11], s29 offen offset:0
    s_branch prep_kernel_end
prep_kernel_end:
    s_endpgm
.section .rodata,"a"
.p2align 6
.amdhsa_kernel prep_kernel
  .amdhsa_next_free_vgpr 248
  .amdhsa_next_free_sgpr 64
  .amdhsa_accum_offset 248
  .amdhsa_group_segment_fixed_size 0
  .amdhsa_kernarg_size 104
  .amdhsa_user_sgpr_count 2
  .amdhsa_user_sgpr_kernarg_segment_ptr 1
  .amdhsa_system_sgpr_workgroup_id_x 1
.end_amdhsa_kernel
.text
.globl afront1_kernel
.p2align 8
.type afront1_kernel,@function
afront1_kernel:
    s_cmp_ge_u32 s2, 256
    s_cbranch_scc1 afront1_kernel_end
    s_load_dwordx2 s[4:5], s[0:1], 96
    s_load_dwordx2 s[6:7], s[0:1], 0
    v_lshrrev_b32 v1, 6, v0
    v_and_b32 v0, 63, v0
    s_nop 0
    v_readfirstlane_b32 s13, v1
    s_waitcnt lgkmcnt(0)
    s_mov_b32 s8, s4
    s_mov_b32 s9, s5
    s_mov_b32 s10, 268435456
    s_mov_b32 s11, 0x00020000
    s_mov_b32 s16, s6
    s_mov_b32 s17, s7
    s_mov_b32 s18, 2621440
    s_mov_b32 s19, 0x00020000
    s_and_b32 s28, s2, 7
    s_lshr_b32 s29, s2, 3
    s_and_b32 s30, s28, 3
    s_lshl_b32 s30, s30, 2
    s_and_b32 s31, s29, 3
    s_add_u32 s20, s30, s31
    s_lshr_b32 s30, s28, 2
    s_lshl_b32 s30, s30, 3
    s_lshr_b32 s31, s29, 2
    s_add_u32 s21, s30, s31
    s_lshr_b32 s22, s13, 1
    s_and_b32 s23, s13, 1
    s_lshl_b32 s26, s20, 1
    s_add_u32 s26, s26, s23
    s_mov_b32 s27, 0x3f803f80
    s_lshl_b32 s28, s21, 7
    s_lshl_b32 s29, s13, 5
    s_add_u32 s28, s28, s29
    s_mul_i32 s24, s28, 1280
    s_lshl_b32 s28, s20, 1
    s_add_u32 s28, s28, s22
    s_mul_i32 s25, s28, 81920
    s_lshl_b32 s29, s23, 12
    s_add_u32 s25, s25, s29
    s_add_u32 s25, s25, 243269632
    v_lshlrev_b32 v1, 4, v0
    v_lshrrev_b32 v16, 3, v0
    v_mul_u32_u24 v16, 1280, v16
    v_and_b32 v17, 7, v0
    v_lshrrev_b32 v18, 4, v0
    v_xor_b32 v19, v17, v18
    v_lshl_add_u32 v2, v19, 4, v16
    v_xor_b32 v19, 4, v19
    v_lshl_add_u32 v3, v19, 4, v16
    s_lshl_b32 s28, s13, 12
    s_mov_b32 m0, s28
    s_add_u32 s29, s24, 0
    buffer_load_dwordx4 v2, s[16:19], s29 offen offset:0 lds
    s_add_u32 s29, s29, 9216
    buffer_load_dwordx4 v3, s[16:19], s29 offen offset:1024 lds
    s_add_u32 s29, s29, 9216
    buffer_load_dwordx4 v2, s[16:19], s29 offen offset:2048 lds
    s_add_u32 s29, s29, 9216
    buffer_load_dwordx4 v3, s[16:19], s29 offen offset:3072 lds
    s_add_u32 s28, s28, 16384
    s_mov_b32 m0, s28
    s_add_u32 s29, s25, 0
    buffer_load_dwordx4 v1, s[8:11], s29 offen offset:0 lds
    buffer_load_dwordx4 v1, s[8:11], s29 offen offset:1024 lds
    buffer_load_dwordx4 v1, s[8:11], s29 offen offset:2048 lds
    buffer_load_dwordx4 v1, s[8:11], s29 offen offset:3072 lds
    s_lshl_b32 s28, s13, 12
    s_add_u32 s28, s28, 32768
    s_mov_b32 m0, s28
    s_add_u32 s29, s24, 128
    buffer_load_dwordx4 v2, s[16:19], s29 offen offset:0 lds
    s_add_u32 s29, s29, 9216
    buffer_load_dwordx4 v3, s[16:19], s29 offen offset:1024 lds
    s_add_u32 s29, s29, 9216
    buffer_load_dwordx4 v2, s[16:19], s29 offen offset:2048 lds
    s_add_u32 s29, s29, 9216
    buffer_load_dwordx4 v3, s[16:19], s29 offen offset:3072 lds
    s_add_u32 s28, s28, 16384
    s_mov_b32 m0, s28
    s_add_u32 s29, s25, 8192
    buffer_load_dwordx4 v1, s[8:11], s29 offen offset:0 lds
    buffer_load_dwordx4 v1, s[8:11], s29 offen offset:1024 lds
    buffer_load_dwordx4 v1, s[8:11], s29 offen offset:2048 lds
    buffer_load_dwordx4 v1, s[8:11], s29 offen offset:3072 lds
    s_lshl_b32 s28, s13, 12
    s_add_u32 s28, s28, 65536
    s_mov_b32 m0, s28
    s_add_u32 s29, s24, 256
    buffer_load_dwordx4 v2, s[16:19], s29 offen offset:0 lds
    s_add_u32 s29, s29, 9216
    buffer_load_dwordx4 v3, s[16:19], s29 offen offset:1024 lds
    s_add_u32 s29, s29, 9216
    buffer_load_dwordx4 v2, s[16:19], s29 offen offset:2048 lds
    s_add_u32 s29, s29, 9216
    buffer_load_dwordx4 v3, s[16:19], s29 offen offset:3072 lds
    s_add_u32 s28, s28, 16384
    s_mov_b32 m0, s28
    s_add_u32 s29, s25, 16384
    buffer_load_dwordx4 v1, s[8:11], s29 offen offset:0 lds
    buffer_load_dwordx4 v1, s[8:11], s29 offen offset:1024 lds
    buffer_load_dwordx4 v1, s[8:11], s29 offen offset:2048 lds
    buffer_load_dwordx4 v1, s[8:11], s29 offen offset:3072 lds
    v_and_b32 v16, 31, v0
    v_lshrrev_b32 v17, 5, v0
    v_lshrrev_b32 v18, 1, v16
    v_and_b32 v18, 7, v18
    v_xor_b32 v18, v18, v17
    v_lshlrev_b32 v18, 4, v18
    v_lshl_add_u32 v18, v16, 7, v18
    s_lshl_b32 s28, s22, 13
    v_add_u32 v18, s28, v18
    v_xor_b32 v6, 0, v18
    v_add_u32 v10, 65536, v6
    v_xor_b32 v7, 32, v18
    v_add_u32 v11, 65536, v7
    v_xor_b32 v8, 64, v18
    v_add_u32 v12, 65536, v8
    v_xor_b32 v9, 96, v18
    v_add_u32 v13, 65536, v9
    s_lshl_b32 s28, s23, 13
    s_add_u32 s28, s28, 16384
    v_add_u32 v4, s28, v1
    v_add_u32 v5, 65536, v4
    v_mov_b32 v20, 0
    v_mov_b32 v21, 0
    v_mov_b32 v22, 0
    v_mov_b32 v23, 0
    s_waitcnt vmcnt(16)
    s_barrier
    ds_read_b128 v[32:35], v6 offset:0
    ds_read_b128 v[36:39], v6 offset:4096
    ds_read_b128 v[40:43], v4 offset:0
    ds_read_b128 v[44:47], v4 offset:1024
    s_cmp_eq_u32 s23, 1
    s_cbranch_scc1 afront1_kernel_af_h1
    s_waitcnt lgkmcnt(0)
    v_mfma_f32_32x32x16_bf16 v[64:79], v[32:35], v[40:43], 0
    v_dot2c_f32_bf16 v20, s27, v32
    v_dot2c_f32_bf16 v22, v32, v32
    v_mfma_f32_32x32x16_bf16 v[96:111], v[32:35], v[44:47], 0
    ds_read_b128 v[48:51], v7 offset:0
    v_dot2c_f32_bf16 v21, s27, v33
    v_mfma_f32_32x32x16_bf16 v[128:143], v[44:47], v[32:35], 0
    ds_read_b128 v[52:55], v7 offset:4096
    v_dot2c_f32_bf16 v23, v33, v33
    v_mfma_f32_32x32x16_bf16 v[80:95], v[36:39], v[40:43], 0
    ds_read_b128 v[56:59], v4 offset:2048
    v_dot2c_f32_bf16 v20, s27, v34
    v_dot2c_f32_bf16 v22, v34, v34
    v_mfma_f32_32x32x16_bf16 v[112:127], v[36:39], v[44:47], 0
    ds_read_b128 v[60:63], v4 offset:3072
    v_dot2c_f32_bf16 v21, s27, v35
    v_mfma_f32_32x32x16_bf16 v[144:159], v[44:47], v[36:39], 0
    v_dot2c_f32_bf16 v23, v35, v35
    s_waitcnt lgkmcnt(0)
    v_mfma_f32_32x32x16_bf16 v[64:79], v[48:51], v[56:59], v[64:79]
    v_dot2c_f32_bf16 v20, s27, v48
    v_dot2c_f32_bf16 v22, v48, v48
    v_mfma_f32_32x32x16_bf16 v[96:111], v[48:51], v[60:63], v[96:111]
    ds_read_b128 v[32:35], v8 offset:0
    v_dot2c_f32_bf16 v21, s27, v49
    v_mfma_f32_32x32x16_bf16 v[128:143], v[60:63], v[48:51], v[128:143]
    ds_read_b128 v[36:39], v8 offset:4096
    v_dot2c_f32_bf16 v23, v49, v49
    v_mfma_f32_32x32x16_bf16 v[80:95], v[52:55], v[56:59], v[80:95]
    ds_read_b128 v[40:43], v4 offset:4096
    v_dot2c_f32_bf16 v20, s27, v50
    v_dot2c_f32_bf16 v22, v50, v50
    v_mfma_f32_32x32x16_bf16 v[112:127], v[52:55], v[60:63], v[112:127]
    ds_read_b128 v[44:47], v4 offset:5120
    v_dot2c_f32_bf16 v21, s27, v51
    v_mfma_f32_32x32x16_bf16 v[144:159], v[60:63], v[52:55], v[144:159]
    v_dot2c_f32_bf16 v23, v51, v51
    s_waitcnt lgkmcnt(0)
    v_mfma_f32_32x32x16_bf16 v[64:79], v[32:35], v[40:43], v[64:79]
    v_dot2c_f32_bf16 v20, s27, v32
    v_dot2c_f32_bf16 v22, v32, v32
    v_mfma_f32_32x32x16_bf16 v[96:111], v[32:35], v[44:47], v[96:111]
    ds_read_b128 v[48:51], v9 offset:0
    v_dot2c_f32_bf16 v21, s27, v33
    v_mfma_f32_32x32x16_bf16 v[128:143], v[44:47], v[32:35], v[128:143]
    ds_read_b128 v[52:55], v9 offset:4096
    v_dot2c_f32_bf16 v23, v33, v33
    v_mfma_f32_32x32x16_bf16 v[80:95], v[36:39], v[40:43], v[80:95]
    ds_read_b128 v[56:59], v4 offset:6144
    v_dot2c_f32_bf16 v20, s27, v34
    v_dot2c_f32_bf16 v22, v34, v34
    v_mfma_f32_32x32x16_bf16 v[112:127], v[36:39], v[44:47], v[112:127]
    ds_read_b128 v[60:63], v4 offset:7168
    v_dot2c_f32_bf16 v21, s27, v35
    v_mfma_f32_32x32x16_bf16 v[144:159], v[44:47], v[36:39], v[144:159]
    v_dot2c_f32_bf16 v23, v35, v35
    s_waitcnt vmcnt(8)
    s_barrier
    s_lshl_b32 s28, s13, 12
    s_add_u32 s28, s28, 98304
    s_mov_b32 m0, s28
    s_add_u32 s29, s24, 384
    buffer_load_dwordx4 v2, s[16:19], s29 offen offset:0 lds
    s_add_u32 s29, s29, 9216
    buffer_load_dwordx4 v3, s[16:19], s29 offen offset:1024 lds
    s_add_u32 s29, s29, 9216
    buffer_load_dwordx4 v2, s[16:19], s29 offen offset:2048 lds
    s_add_u32 s29, s29, 9216
    buffer_load_dwordx4 v3, s[16:19], s29 offen offset:3072 lds
    s_add_u32 s28, s28, 16384
    s_mov_b32 m0, s28
    s_add_u32 s29, s25, 24576
    buffer_load_dwordx4 v1, s[8:11], s29 offen offset:0 lds
    buffer_load_dwordx4 v1, s[8:11], s29 offen offset:1024 lds
    buffer_load_dwordx4 v1, s[8:11], s29 offen offset:2048 lds
    buffer_load_dwordx4 v1, s[8:11], s29 offen offset:3072 lds
    s_waitcnt lgkmcnt(0)
    v_mfma_f32_32x32x16_bf16 v[64:79], v[48:51], v[56:59], v[64:79]
    v_dot2c_f32_bf16 v20, s27, v48
    v_dot2c_f32_bf16 v22, v48, v48
    v_mfma_f32_32x32x16_bf16 v[96:111], v[48:51], v[60:63], v[96:111]
    ds_read_b128 v[32:35], v6 offset:32768
    v_dot2c_f32_bf16 v21, s27, v49
    v_mfma_f32_32x32x16_bf16 v[128:143], v[60:63], v[48:51], v[128:143]
    ds_read_b128 v[36:39], v6 offset:36864
    v_dot2c_f32_bf16 v23, v49, v49
    v_mfma_f32_32x32x16_bf16 v[80:95], v[52:55], v[56:59], v[80:95]
    ds_read_b128 v[40:43], v4 offset:32768
    v_dot2c_f32_bf16 v20, s27, v50
    v_dot2c_f32_bf16 v22, v50, v50
    v_mfma_f32_32x32x16_bf16 v[112:127], v[52:55], v[60:63], v[112:127]
    ds_read_b128 v[44:47], v4 offset:33792
    v_dot2c_f32_bf16 v21, s27, v51
    v_mfma_f32_32x32x16_bf16 v[144:159], v[60:63], v[52:55], v[144:159]
    v_dot2c_f32_bf16 v23, v51, v51
    s_waitcnt lgkmcnt(0)
    v_mfma_f32_32x32x16_bf16 v[64:79], v[32:35], v[40:43], v[64:79]
    v_dot2c_f32_bf16 v20, s27, v32
    v_dot2c_f32_bf16 v22, v32, v32
    v_mfma_f32_32x32x16_bf16 v[96:111], v[32:35], v[44:47], v[96:111]
    ds_read_b128 v[48:51], v7 offset:32768
    v_dot2c_f32_bf16 v21, s27, v33
    v_mfma_f32_32x32x16_bf16 v[128:143], v[44:47], v[32:35], v[128:143]
    ds_read_b128 v[52:55], v7 offset:36864
    v_dot2c_f32_bf16 v23, v33, v33
    v_mfma_f32_32x32x16_bf16 v[80:95], v[36:39], v[40:43], v[80:95]
    ds_read_b128 v[56:59], v4 offset:34816
    v_dot2c_f32_bf16 v20, s27, v34
    v_dot2c_f32_bf16 v22, v34, v34
    v_mfma_f32_32x32x16_bf16 v[112:127], v[36:39], v[44:47], v[112:127]
    ds_read_b128 v[60:63], v4 offset:35840
    v_dot2c_f32_bf16 v21, s27, v35
    v_mfma_f32_32x32x16_bf16 v[144:159], v[44:47], v[36:39], v[144:159]
    v_dot2c_f32_bf16 v23, v35, v35
    s_waitcnt lgkmcnt(0)
    v_mfma_f32_32x32x16_bf16 v[64:79], v[48:51], v[56:59], v[64:79]
    v_dot2c_f32_bf16 v20, s27, v48
    v_dot2c_f32_bf16 v22, v48, v48
    v_mfma_f32_32x32x16_bf16 v[96:111], v[48:51], v[60:63], v[96:111]
    ds_read_b128 v[32:35], v8 offset:32768
    v_dot2c_f32_bf16 v21, s27, v49
    v_mfma_f32_32x32x16_bf16 v[128:143], v[60:63], v[48:51], v[128:143]
    ds_read_b128 v[36:39], v8 offset:36864
    v_dot2c_f32_bf16 v23, v49, v49
    v_mfma_f32_32x32x16_bf16 v[80:95], v[52:55], v[56:59], v[80:95]
    ds_read_b128 v[40:43], v4 offset:36864
    v_dot2c_f32_bf16 v20, s27, v50
    v_dot2c_f32_bf16 v22, v50, v50
    v_mfma_f32_32x32x16_bf16 v[112:127], v[52:55], v[60:63], v[112:127]
    ds_read_b128 v[44:47], v4 offset:37888
    v_dot2c_f32_bf16 v21, s27, v51
    v_mfma_f32_32x32x16_bf16 v[144:159], v[60:63], v[52:55], v[144:159]
    v_dot2c_f32_bf16 v23, v51, v51
    s_waitcnt lgkmcnt(0)
    v_mfma_f32_32x32x16_bf16 v[64:79], v[32:35], v[40:43], v[64:79]
    v_dot2c_f32_bf16 v20, s27, v32
    v_dot2c_f32_bf16 v22, v32, v32
    v_mfma_f32_32x32x16_bf16 v[96:111], v[32:35], v[44:47], v[96:111]
    ds_read_b128 v[48:51], v9 offset:32768
    v_dot2c_f32_bf16 v21, s27, v33
    v_mfma_f32_32x32x16_bf16 v[128:143], v[44:47], v[32:35], v[128:143]
    ds_read_b128 v[52:55], v9 offset:36864
    v_dot2c_f32_bf16 v23, v33, v33
    v_mfma_f32_32x32x16_bf16 v[80:95], v[36:39], v[40:43], v[80:95]
    ds_read_b128 v[56:59], v4 offset:38912
    v_dot2c_f32_bf16 v20, s27, v34
    v_dot2c_f32_bf16 v22, v34, v34
    v_mfma_f32_32x32x16_bf16 v[112:127], v[36:39], v[44:47], v[112:127]
    ds_read_b128 v[60:63], v4 offset:39936
    v_dot2c_f32_bf16 v21, s27, v35
    v_mfma_f32_32x32x16_bf16 v[144:159], v[44:47], v[36:39], v[144:159]
    v_dot2c_f32_bf16 v23, v35, v35
    s_waitcnt vmcnt(8)
    s_barrier
    s_lshl_b32 s28, s13, 12
    s_mov_b32 m0, s28
    s_add_u32 s29, s24, 512
    buffer_load_dwordx4 v2, s[16:19], s29 offen offset:0 lds
    s_add_u32 s29, s29, 9216
    buffer_load_dwordx4 v3, s[16:19], s29 offen offset:1024 lds
    s_add_u32 s29, s29, 9216
    buffer_load_dwordx4 v2, s[16:19], s29 offen offset:2048 lds
    s_add_u32 s29, s29, 9216
    buffer_load_dwordx4 v3, s[16:19], s29 offen offset:3072 lds
    s_add_u32 s28, s28, 16384
    s_mov_b32 m0, s28
    s_add_u32 s29, s25, 32768
    buffer_load_dwordx4 v1, s[8:11], s29 offen offset:0 lds
    buffer_load_dwordx4 v1, s[8:11], s29 offen offset:1024 lds
    buffer_load_dwordx4 v1, s[8:11], s29 offen offset:2048 lds
    buffer_load_dwordx4 v1, s[8:11], s29 offen offset:3072 lds
    s_waitcnt lgkmcnt(0)
    v_mfma_f32_32x32x16_bf16 v[64:79], v[48:51], v[56:59], v[64:79]
    v_dot2c_f32_bf16 v20, s27, v48
    v_dot2c_f32_bf16 v22, v48, v48
    v_mfma_f32_32x32x16_bf16 v[96:111], v[48:51], v[60:63], v[96:111]
    ds_read_b128 v[32:35], v10 offset:0
    v_dot2c_f32_bf16 v21, s27, v49
    v_mfma_f32_32x32x16_bf16 v[128:143], v[60:63], v[48:51], v[128:143]
    ds_read_b128 v[36:39], v10 offset:4096
    v_dot2c_f32_bf16 v23, v49, v49
    v_mfma_f32_32x32x16_bf16 v[80:95], v[52:55], v[56:59], v[80:95]
    ds_read_b128 v[40:43], v5 offset:0
    v_dot2c_f32_bf16 v20, s27, v50
    v_dot2c_f32_bf16 v22, v50, v50
    v_mfma_f32_32x32x16_bf16 v[112:127], v[52:55], v[60:63], v[112:127]
    ds_read_b128 v[44:47], v5 offset:1024
    v_dot2c_f32_bf16 v21, s27, v51
    v_mfma_f32_32x32x16_bf16 v[144:159], v[60:63], v[52:55], v[144:159]
    v_dot2c_f32_bf16 v23, v51, v51
    s_waitcnt lgkmcnt(0)
    v_mfma_f32_32x32x16_bf16 v[64:79], v[32:35], v[40:43], v[64:79]
    v_dot2c_f32_bf16 v20, s27, v32
    v_dot2c_f32_bf16 v22, v32, v32
    v_mfma_f32_32x32x16_bf16 v[96:111], v[32:35], v[44:47], v[96:111]
    ds_read_b128 v[48:51], v11 offset:0
    v_dot2c_f32_bf16 v21, s27, v33
    v_mfma_f32_32x32x16_bf16 v[128:143], v[44:47], v[32:35], v[128:143]
    ds_read_b128 v[52:55], v11 offset:4096
    v_dot2c_f32_bf16 v23, v33, v33
    v_mfma_f32_32x32x16_bf16 v[80:95], v[36:39], v[40:43], v[80:95]
    ds_read_b128 v[56:59], v5 offset:2048
    v_dot2c_f32_bf16 v20, s27, v34
    v_dot2c_f32_bf16 v22, v34, v34
    v_mfma_f32_32x32x16_bf16 v[112:127], v[36:39], v[44:47], v[112:127]
    ds_read_b128 v[60:63], v5 offset:3072
    v_dot2c_f32_bf16 v21, s27, v35
    v_mfma_f32_32x32x16_bf16 v[144:159], v[44:47], v[36:39], v[144:159]
    v_dot2c_f32_bf16 v23, v35, v35
    s_waitcnt lgkmcnt(0)
    v_mfma_f32_32x32x16_bf16 v[64:79], v[48:51], v[56:59], v[64:79]
    v_dot2c_f32_bf16 v20, s27, v48
    v_dot2c_f32_bf16 v22, v48, v48
    v_mfma_f32_32x32x16_bf16 v[96:111], v[48:51], v[60:63], v[96:111]
    ds_read_b128 v[32:35], v12 offset:0
    v_dot2c_f32_bf16 v21, s27, v49
    v_mfma_f32_32x32x16_bf16 v[128:143], v[60:63], v[48:51], v[128:143]
    ds_read_b128 v[36:39], v12 offset:4096
    v_dot2c_f32_bf16 v23, v49, v49
    v_mfma_f32_32x32x16_bf16 v[80:95], v[52:55], v[56:59], v[80:95]
    ds_read_b128 v[40:43], v5 offset:4096
    v_dot2c_f32_bf16 v20, s27, v50
    v_dot2c_f32_bf16 v22, v50, v50
    v_mfma_f32_32x32x16_bf16 v[112:127], v[52:55], v[60:63], v[112:127]
    ds_read_b128 v[44:47], v5 offset:5120
    v_dot2c_f32_bf16 v21, s27, v51
    v_mfma_f32_32x32x16_bf16 v[144:159], v[60:63], v[52:55], v[144:159]
    v_dot2c_f32_bf16 v23, v51, v51
    s_waitcnt lgkmcnt(0)
    v_mfma_f32_32x32x16_bf16 v[64:79], v[32:35], v[40:43], v[64:79]
    v_dot2c_f32_bf16 v20, s27, v32
    v_dot2c_f32_bf16 v22, v32, v32
    v_mfma_f32_32x32x16_bf16 v[96:111], v[32:35], v[44:47], v[96:111]
    ds_read_b128 v[48:51], v13 offset:0
    v_dot2c_f32_bf16 v21, s27, v33
    v_mfma_f32_32x32x16_bf16 v[128:143], v[44:47], v[32:35], v[128:143]
    ds_read_b128 v[52:55], v13 offset:4096
    v_dot2c_f32_bf16 v23, v33, v33
    v_mfma_f32_32x32x16_bf16 v[80:95], v[36:39], v[40:43], v[80:95]
    ds_read_b128 v[56:59], v5 offset:6144
    v_dot2c_f32_bf16 v20, s27, v34
    v_dot2c_f32_bf16 v22, v34, v34
    v_mfma_f32_32x32x16_bf16 v[112:127], v[36:39], v[44:47], v[112:127]
    ds_read_b128 v[60:63], v5 offset:7168
    v_dot2c_f32_bf16 v21, s27, v35
    v_mfma_f32_32x32x16_bf16 v[144:159], v[44:47], v[36:39], v[144:159]
    v_dot2c_f32_bf16 v23, v35, v35
    s_waitcnt vmcnt(8)
    s_barrier
    s_lshl_b32 s28, s13, 12
    s_add_u32 s28, s28, 32768
    s_mov_b32 m0, s28
    s_add_u32 s29, s24, 640
    buffer_load_dwordx4 v2, s[16:19], s29 offen offset:0 lds
    s_add_u32 s29, s29, 9216
    buffer_load_dwordx4 v3, s[16:19], s29 offen offset:1024 lds
    s_add_u32 s29, s29, 9216
    buffer_load_dwordx4 v2, s[16:19], s29 offen offset:2048 lds
    s_add_u32 s29, s29, 9216
    buffer_load_dwordx4 v3, s[16:19], s29 offen offset:3072 lds
    s_add_u32 s28, s28, 16384
    s_mov_b32 m0, s28
    s_add_u32 s29, s25, 40960
    buffer_load_dwordx4 v1, s[8:11], s29 offen offset:0 lds
    buffer_load_dwordx4 v1, s[8:11], s29 offen offset:1024 lds
    buffer_load_dwordx4 v1, s[8:11], s29 offen offset:2048 lds
    buffer_load_dwordx4 v1, s[8:11], s29 offen offset:3072 lds
    s_waitcnt lgkmcnt(0)
    v_mfma_f32_32x32x16_bf16 v[64:79], v[48:51], v[56:59], v[64:79]
    v_dot2c_f32_bf16 v20, s27, v48
    v_dot2c_f32_bf16 v22, v48, v48
    v_mfma_f32_32x32x16_bf16 v[96:111], v[48:51], v[60:63], v[96:111]
    ds_read_b128 v[32:35], v10 offset:32768
    v_dot2c_f32_bf16 v21, s27, v49
    v_mfma_f32_32x32x16_bf16 v[128:143], v[60:63], v[48:51], v[128:143]
    ds_read_b128 v[36:39], v10 offset:36864
    v_dot2c_f32_bf16 v23, v49, v49
    v_mfma_f32_32x32x16_bf16 v[80:95], v[52:55], v[56:59], v[80:95]
    ds_read_b128 v[40:43], v5 offset:32768
    v_dot2c_f32_bf16 v20, s27, v50
    v_dot2c_f32_bf16 v22, v50, v50
    v_mfma_f32_32x32x16_bf16 v[112:127], v[52:55], v[60:63], v[112:127]
    ds_read_b128 v[44:47], v5 offset:33792
    v_dot2c_f32_bf16 v21, s27, v51
    v_mfma_f32_32x32x16_bf16 v[144:159], v[60:63], v[52:55], v[144:159]
    v_dot2c_f32_bf16 v23, v51, v51
    s_waitcnt lgkmcnt(0)
    v_mfma_f32_32x32x16_bf16 v[64:79], v[32:35], v[40:43], v[64:79]
    v_dot2c_f32_bf16 v20, s27, v32
    v_dot2c_f32_bf16 v22, v32, v32
    v_mfma_f32_32x32x16_bf16 v[96:111], v[32:35], v[44:47], v[96:111]
    ds_read_b128 v[48:51], v11 offset:32768
    v_dot2c_f32_bf16 v21, s27, v33
    v_mfma_f32_32x32x16_bf16 v[128:143], v[44:47], v[32:35], v[128:143]
    ds_read_b128 v[52:55], v11 offset:36864
    v_dot2c_f32_bf16 v23, v33, v33
    v_mfma_f32_32x32x16_bf16 v[80:95], v[36:39], v[40:43], v[80:95]
    ds_read_b128 v[56:59], v5 offset:34816
    v_dot2c_f32_bf16 v20, s27, v34
    v_dot2c_f32_bf16 v22, v34, v34
    v_mfma_f32_32x32x16_bf16 v[112:127], v[36:39], v[44:47], v[112:127]
    ds_read_b128 v[60:63], v5 offset:35840
    v_dot2c_f32_bf16 v21, s27, v35
    v_mfma_f32_32x32x16_bf16 v[144:159], v[44:47], v[36:39], v[144:159]
    v_dot2c_f32_bf16 v23, v35, v35
    s_waitcnt lgkmcnt(0)
    v_mfma_f32_32x32x16_bf16 v[64:79], v[48:51], v[56:59], v[64:79]
    v_dot2c_f32_bf16 v20, s27, v48
    v_dot2c_f32_bf16 v22, v48, v48
    v_mfma_f32_32x32x16_bf16 v[96:111], v[48:51], v[60:63], v[96:111]
    ds_read_b128 v[32:35], v12 offset:32768
    v_dot2c_f32_bf16 v21, s27, v49
    v_mfma_f32_32x32x16_bf16 v[128:143], v[60:63], v[48:51], v[128:143]
    ds_read_b128 v[36:39], v12 offset:36864
    v_dot2c_f32_bf16 v23, v49, v49
    v_mfma_f32_32x32x16_bf16 v[80:95], v[52:55], v[56:59], v[80:95]
    ds_read_b128 v[40:43], v5 offset:36864
    v_dot2c_f32_bf16 v20, s27, v50
    v_dot2c_f32_bf16 v22, v50, v50
    v_mfma_f32_32x32x16_bf16 v[112:127], v[52:55], v[60:63], v[112:127]
    ds_read_b128 v[44:47], v5 offset:37888
    v_dot2c_f32_bf16 v21, s27, v51
    v_mfma_f32_32x32x16_bf16 v[144:159], v[60:63], v[52:55], v[144:159]
    v_dot2c_f32_bf16 v23, v51, v51
    s_waitcnt lgkmcnt(0)
    v_mfma_f32_32x32x16_bf16 v[64:79], v[32:35], v[40:43], v[64:79]
    v_dot2c_f32_bf16 v20, s27, v32
    v_dot2c_f32_bf16 v22, v32, v32
    v_mfma_f32_32x32x16_bf16 v[96:111], v[32:35], v[44:47], v[96:111]
    ds_read_b128 v[48:51], v13 offset:32768
    v_dot2c_f32_bf16 v21, s27, v33
    v_mfma_f32_32x32x16_bf16 v[128:143], v[44:47], v[32:35], v[128:143]
    ds_read_b128 v[52:55], v13 offset:36864
    v_dot2c_f32_bf16 v23, v33, v33
    v_mfma_f32_32x32x16_bf16 v[80:95], v[36:39], v[40:43], v[80:95]
    ds_read_b128 v[56:59], v5 offset:38912
    v_dot2c_f32_bf16 v20, s27, v34
    v_dot2c_f32_bf16 v22, v34, v34
    v_mfma_f32_32x32x16_bf16 v[112:127], v[36:39], v[44:47], v[112:127]
    ds_read_b128 v[60:63], v5 offset:39936
    v_dot2c_f32_bf16 v21, s27, v35
    v_mfma_f32_32x32x16_bf16 v[144:159], v[44:47], v[36:39], v[144:159]
    v_dot2c_f32_bf16 v23, v35, v35
    s_waitcnt vmcnt(8)
    s_barrier
    s_lshl_b32 s28, s13, 12
    s_add_u32 s28, s28, 65536
    s_mov_b32 m0, s28
    s_add_u32 s29, s24, 768
    buffer_load_dwordx4 v2, s[16:19], s29 offen offset:0 lds
    s_add_u32 s29, s29, 9216
    buffer_load_dwordx4 v3, s[16:19], s29 offen offset:1024 lds
    s_add_u32 s29, s29, 9216
    buffer_load_dwordx4 v2, s[16:19], s29 offen offset:2048 lds
    s_add_u32 s29, s29, 9216
    buffer_load_dwordx4 v3, s[16:19], s29 offen offset:3072 lds
    s_add_u32 s28, s28, 16384
    s_mov_b32 m0, s28
    s_add_u32 s29, s25, 49152
    buffer_load_dwordx4 v1, s[8:11], s29 offen offset:0 lds
    buffer_load_dwordx4 v1, s[8:11], s29 offen offset:1024 lds
    buffer_load_dwordx4 v1, s[8:11], s29 offen offset:2048 lds
    buffer_load_dwordx4 v1, s[8:11], s29 offen offset:3072 lds
    s_waitcnt lgkmcnt(0)
    v_mfma_f32_32x32x16_bf16 v[64:79], v[48:51], v[56:59], v[64:79]
    v_dot2c_f32_bf16 v20, s27, v48
    v_dot2c_f32_bf16 v22, v48, v48
    v_mfma_f32_32x32x16_bf16 v[96:111], v[48:51], v[60:63], v[96:111]
    ds_read_b128 v[32:35], v6 offset:0
    v_dot2c_f32_bf16 v21, s27, v49
    v_mfma_f32_32x32x16_bf16 v[128:143], v[60:63], v[48:51], v[128:143]
    ds_read_b128 v[36:39], v6 offset:4096
    v_dot2c_f32_bf16 v23, v49, v49
    v_mfma_f32_32x32x16_bf16 v[80:95], v[52:55], v[56:59], v[80:95]
    ds_read_b128 v[40:43], v4 offset:0
    v_dot2c_f32_bf16 v20, s27, v50
    v_dot2c_f32_bf16 v22, v50, v50
    v_mfma_f32_32x32x16_bf16 v[112:127], v[52:55], v[60:63], v[112:127]
    ds_read_b128 v[44:47], v4 offset:1024
    v_dot2c_f32_bf16 v21, s27, v51
    v_mfma_f32_32x32x16_bf16 v[144:159], v[60:63], v[52:55], v[144:159]
    v_dot2c_f32_bf16 v23, v51, v51
    s_waitcnt lgkmcnt(0)
    v_mfma_f32_32x32x16_bf16 v[64:79], v[32:35], v[40:43], v[64:79]
    v_dot2c_f32_bf16 v20, s27, v32
    v_dot2c_f32_bf16 v22, v32, v32
    v_mfma_f32_32x32x16_bf16 v[96:111], v[32:35], v[44:47], v[96:111]
    ds_read_b128 v[48:51], v7 offset:0
    v_dot2c_f32_bf16 v21, s27, v33
    v_mfma_f32_32x32x16_bf16 v[128:143], v[44:47], v[32:35], v[128:143]
    ds_read_b128 v[52:55], v7 offset:4096
    v_dot2c_f32_bf16 v23, v33, v33
    v_mfma_f32_32x32x16_bf16 v[80:95], v[36:39], v[40:43], v[80:95]
    ds_read_b128 v[56:59], v4 offset:2048
    v_dot2c_f32_bf16 v20, s27, v34
    v_dot2c_f32_bf16 v22, v34, v34
    v_mfma_f32_32x32x16_bf16 v[112:127], v[36:39], v[44:47], v[112:127]
    ds_read_b128 v[60:63], v4 offset:3072
    v_dot2c_f32_bf16 v21, s27, v35
    v_mfma_f32_32x32x16_bf16 v[144:159], v[44:47], v[36:39], v[144:159]
    v_dot2c_f32_bf16 v23, v35, v35
    s_waitcnt lgkmcnt(0)
    v_mfma_f32_32x32x16_bf16 v[64:79], v[48:51], v[56:59], v[64:79]
    v_dot2c_f32_bf16 v20, s27, v48
    v_dot2c_f32_bf16 v22, v48, v48
    v_mfma_f32_32x32x16_bf16 v[96:111], v[48:51], v[60:63], v[96:111]
    ds_read_b128 v[32:35], v8 offset:0
    v_dot2c_f32_bf16 v21, s27, v49
    v_mfma_f32_32x32x16_bf16 v[128:143], v[60:63], v[48:51], v[128:143]
    ds_read_b128 v[36:39], v8 offset:4096
    v_dot2c_f32_bf16 v23, v49, v49
    v_mfma_f32_32x32x16_bf16 v[80:95], v[52:55], v[56:59], v[80:95]
    ds_read_b128 v[40:43], v4 offset:4096
    v_dot2c_f32_bf16 v20, s27, v50
    v_dot2c_f32_bf16 v22, v50, v50
    v_mfma_f32_32x32x16_bf16 v[112:127], v[52:55], v[60:63], v[112:127]
    ds_read_b128 v[44:47], v4 offset:5120
    v_dot2c_f32_bf16 v21, s27, v51
    v_mfma_f32_32x32x16_bf16 v[144:159], v[60:63], v[52:55], v[144:159]
    v_dot2c_f32_bf16 v23, v51, v51
    s_waitcnt lgkmcnt(0)
    v_mfma_f32_32x32x16_bf16 v[64:79], v[32:35], v[40:43], v[64:79]
    v_dot2c_f32_bf16 v20, s27, v32
    v_dot2c_f32_bf16 v22, v32, v32
    v_mfma_f32_32x32x16_bf16 v[96:111], v[32:35], v[44:47], v[96:111]
    ds_read_b128 v[48:51], v9 offset:0
    v_dot2c_f32_bf16 v21, s27, v33
    v_mfma_f32_32x32x16_bf16 v[128:143], v[44:47], v[32:35], v[128:143]
    ds_read_b128 v[52:55], v9 offset:4096
    v_dot2c_f32_bf16 v23, v33, v33
    v_mfma_f32_32x32x16_bf16 v[80:95], v[36:39], v[40:43], v[80:95]
    ds_read_b128 v[56:59], v4 offset:6144
    v_dot2c_f32_bf16 v20, s27, v34
    v_dot2c_f32_bf16 v22, v34, v34
    v_mfma_f32_32x32x16_bf16 v[112:127], v[36:39], v[44:47], v[112:127]
    ds_read_b128 v[60:63], v4 offset:7168
    v_dot2c_f32_bf16 v21, s27, v35
    v_mfma_f32_32x32x16_bf16 v[144:159], v[44:47], v[36:39], v[144:159]
    v_dot2c_f32_bf16 v23, v35, v35
    s_waitcnt vmcnt(8)
    s_barrier
    s_lshl_b32 s28, s13, 12
    s_add_u32 s28, s28, 98304
    s_mov_b32 m0, s28
    s_add_u32 s29, s24, 896
    buffer_load_dwordx4 v2, s[16:19], s29 offen offset:0 lds
    s_add_u32 s29, s29, 9216
    buffer_load_dwordx4 v3, s[16:19], s29 offen offset:1024 lds
    s_add_u32 s29, s29, 9216
    buffer_load_dwordx4 v2, s[16:19], s29 offen offset:2048 lds
    s_add_u32 s29, s29, 9216
    buffer_load_dwordx4 v3, s[16:19], s29 offen offset:3072 lds
    s_add_u32 s28, s28, 16384
    s_mov_b32 m0, s28
    s_add_u32 s29, s25, 57344
    buffer_load_dwordx4 v1, s[8:11], s29 offen offset:0 lds
    buffer_load_dwordx4 v1, s[8:11], s29 offen offset:1024 lds
    buffer_load_dwordx4 v1, s[8:11], s29 offen offset:2048 lds
    buffer_load_dwordx4 v1, s[8:11], s29 offen offset:3072 lds
    s_waitcnt lgkmcnt(0)
    v_mfma_f32_32x32x16_bf16 v[64:79], v[48:51], v[56:59], v[64:79]
    v_dot2c_f32_bf16 v20, s27, v48
    v_dot2c_f32_bf16 v22, v48, v48
    v_mfma_f32_32x32x16_bf16 v[96:111], v[48:51], v[60:63], v[96:111]
    ds_read_b128 v[32:35], v6 offset:32768
    v_dot2c_f32_bf16 v21, s27, v49
    v_mfma_f32_32x32x16_bf16 v[128:143], v[60:63], v[48:51], v[128:143]
    ds_read_b128 v[36:39], v6 offset:36864
    v_dot2c_f32_bf16 v23, v49, v49
    v_mfma_f32_32x32x16_bf16 v[80:95], v[52:55], v[56:59], v[80:95]
    ds_read_b128 v[40:43], v4 offset:32768
    v_dot2c_f32_bf16 v20, s27, v50
    v_dot2c_f32_bf16 v22, v50, v50
    v_mfma_f32_32x32x16_bf16 v[112:127], v[52:55], v[60:63], v[112:127]
    ds_read_b128 v[44:47], v4 offset:33792
    v_dot2c_f32_bf16 v21, s27, v51
    v_mfma_f32_32x32x16_bf16 v[144:159], v[60:63], v[52:55], v[144:159]
    v_dot2c_f32_bf16 v23, v51, v51
    s_waitcnt lgkmcnt(0)
    v_mfma_f32_32x32x16_bf16 v[64:79], v[32:35], v[40:43], v[64:79]
    v_dot2c_f32_bf16 v20, s27, v32
    v_dot2c_f32_bf16 v22, v32, v32
    v_mfma_f32_32x32x16_bf16 v[96:111], v[32:35], v[44:47], v[96:111]
    ds_read_b128 v[48:51], v7 offset:32768
    v_dot2c_f32_bf16 v21, s27, v33
    v_mfma_f32_32x32x16_bf16 v[128:143], v[44:47], v[32:35], v[128:143]
    ds_read_b128 v[52:55], v7 offset:36864
    v_dot2c_f32_bf16 v23, v33, v33
    v_mfma_f32_32x32x16_bf16 v[80:95], v[36:39], v[40:43], v[80:95]
    ds_read_b128 v[56:59], v4 offset:34816
    v_dot2c_f32_bf16 v20, s27, v34
    v_dot2c_f32_bf16 v22, v34, v34
    v_mfma_f32_32x32x16_bf16 v[112:127], v[36:39], v[44:47], v[112:127]
    ds_read_b128 v[60:63], v4 offset:35840
    v_dot2c_f32_bf16 v21, s27, v35
    v_mfma_f32_32x32x16_bf16 v[144:159], v[44:47], v[36:39], v[144:159]
    v_dot2c_f32_bf16 v23, v35, v35
    s_waitcnt lgkmcnt(0)
    v_mfma_f32_32x32x16_bf16 v[64:79], v[48:51], v[56:59], v[64:79]
    v_dot2c_f32_bf16 v20, s27, v48
    v_dot2c_f32_bf16 v22, v48, v48
    v_mfma_f32_32x32x16_bf16 v[96:111], v[48:51], v[60:63], v[96:111]
    ds_read_b128 v[32:35], v8 offset:32768
    v_dot2c_f32_bf16 v21, s27, v49
    v_mfma_f32_32x32x16_bf16 v[128:143], v[60:63], v[48:51], v[128:143]
    ds_read_b128 v[36:39], v8 offset:36864
    v_dot2c_f32_bf16 v23, v49, v49
    v_mfma_f32_32x32x16_bf16 v[80:95], v[52:55], v[56:59], v[80:95]
    ds_read_b128 v[40:43], v4 offset:36864
    v_dot2c_f32_bf16 v20, s27, v50
    v_dot2c_f32_bf16 v22, v50, v50
    v_mfma_f32_32x32x16_bf16 v[112:127], v[52:55], v[60:63], v[112:127]
    ds_read_b128 v[44:47], v4 offset:37888
    v_dot2c_f32_bf16 v21, s27, v51
    v_mfma_f32_32x32x16_bf16 v[144:159], v[60:63], v[52:55], v[144:159]
    v_dot2c_f32_bf16 v23, v51, v51
    s_waitcnt lgkmcnt(0)
    v_mfma_f32_32x32x16_bf16 v[64:79], v[32:35], v[40:43], v[64:79]
    v_dot2c_f32_bf16 v20, s27, v32
    v_dot2c_f32_bf16 v22, v32, v32
    v_mfma_f32_32x32x16_bf16 v[96:111], v[32:35], v[44:47], v[96:111]
    ds_read_b128 v[48:51], v9 offset:32768
    v_dot2c_f32_bf16 v21, s27, v33
    v_mfma_f32_32x32x16_bf16 v[128:143], v[44:47], v[32:35], v[128:143]
    ds_read_b128 v[52:55], v9 offset:36864
    v_dot2c_f32_bf16 v23, v33, v33
    v_mfma_f32_32x32x16_bf16 v[80:95], v[36:39], v[40:43], v[80:95]
    ds_read_b128 v[56:59], v4 offset:38912
    v_dot2c_f32_bf16 v20, s27, v34
    v_dot2c_f32_bf16 v22, v34, v34
    v_mfma_f32_32x32x16_bf16 v[112:127], v[36:39], v[44:47], v[112:127]
    ds_read_b128 v[60:63], v4 offset:39936
    v_dot2c_f32_bf16 v21, s27, v35
    v_mfma_f32_32x32x16_bf16 v[144:159], v[44:47], v[36:39], v[144:159]
    v_dot2c_f32_bf16 v23, v35, v35
    s_waitcnt vmcnt(8)
    s_barrier
    s_lshl_b32 s28, s13, 12
    s_mov_b32 m0, s28
    s_add_u32 s29, s24, 1024
    buffer_load_dwordx4 v2, s[16:19], s29 offen offset:0 lds
    s_add_u32 s29, s29, 9216
    buffer_load_dwordx4 v3, s[16:19], s29 offen offset:1024 lds
    s_add_u32 s29, s29, 9216
    buffer_load_dwordx4 v2, s[16:19], s29 offen offset:2048 lds
    s_add_u32 s29, s29, 9216
    buffer_load_dwordx4 v3, s[16:19], s29 offen offset:3072 lds
    s_add_u32 s28, s28, 16384
    s_mov_b32 m0, s28
    s_add_u32 s29, s25, 65536
    buffer_load_dwordx4 v1, s[8:11], s29 offen offset:0 lds
    buffer_load_dwordx4 v1, s[8:11], s29 offen offset:1024 lds
    buffer_load_dwordx4 v1, s[8:11], s29 offen offset:2048 lds
    buffer_load_dwordx4 v1, s[8:11], s29 offen offset:3072 lds
    s_waitcnt lgkmcnt(0)
    v_mfma_f32_32x32x16_bf16 v[64:79], v[48:51], v[56:59], v[64:79]
    v_dot2c_f32_bf16 v20, s27, v48
    v_dot2c_f32_bf16 v22, v48, v48
    v_mfma_f32_32x32x16_bf16 v[96:111], v[48:51], v[60:63], v[96:111]
    ds_read_b128 v[32:35], v10 offset:0
    v_dot2c_f32_bf16 v21, s27, v49
    v_mfma_f32_32x32x16_bf16 v[128:143], v[60:63], v[48:51], v[128:143]
    ds_read_b128 v[36:39], v10 offset:4096
    v_dot2c_f32_bf16 v23, v49, v49
    v_mfma_f32_32x32x16_bf16 v[80:95], v[52:55], v[56:59], v[80:95]
    ds_read_b128 v[40:43], v5 offset:0
    v_dot2c_f32_bf16 v20, s27, v50
    v_dot2c_f32_bf16 v22, v50, v50
    v_mfma_f32_32x32x16_bf16 v[112:127], v[52:55], v[60:63], v[112:127]
    ds_read_b128 v[44:47], v5 offset:1024
    v_dot2c_f32_bf16 v21, s27, v51
    v_mfma_f32_32x32x16_bf16 v[144:159], v[60:63], v[52:55], v[144:159]
    v_dot2c_f32_bf16 v23, v51, v51
    s_waitcnt lgkmcnt(0)
    v_mfma_f32_32x32x16_bf16 v[64:79], v[32:35], v[40:43], v[64:79]
    v_dot2c_f32_bf16 v20, s27, v32
    v_dot2c_f32_bf16 v22, v32, v32
    v_mfma_f32_32x32x16_bf16 v[96:111], v[32:35], v[44:47], v[96:111]
    ds_read_b128 v[48:51], v11 offset:0
    v_dot2c_f32_bf16 v21, s27, v33
    v_mfma_f32_32x32x16_bf16 v[128:143], v[44:47], v[32:35], v[128:143]
    ds_read_b128 v[52:55], v11 offset:4096
    v_dot2c_f32_bf16 v23, v33, v33
    v_mfma_f32_32x32x16_bf16 v[80:95], v[36:39], v[40:43], v[80:95]
    ds_read_b128 v[56:59], v5 offset:2048
    v_dot2c_f32_bf16 v20, s27, v34
    v_dot2c_f32_bf16 v22, v34, v34
    v_mfma_f32_32x32x16_bf16 v[112:127], v[36:39], v[44:47], v[112:127]
    ds_read_b128 v[60:63], v5 offset:3072
    v_dot2c_f32_bf16 v21, s27, v35
    v_mfma_f32_32x32x16_bf16 v[144:159], v[44:47], v[36:39], v[144:159]
    v_dot2c_f32_bf16 v23, v35, v35
    s_waitcnt lgkmcnt(0)
    v_mfma_f32_32x32x16_bf16 v[64:79], v[48:51], v[56:59], v[64:79]
    v_dot2c_f32_bf16 v20, s27, v48
    v_dot2c_f32_bf16 v22, v48, v48
    v_mfma_f32_32x32x16_bf16 v[96:111], v[48:51], v[60:63], v[96:111]
    ds_read_b128 v[32:35], v12 offset:0
    v_dot2c_f32_bf16 v21, s27, v49
    v_mfma_f32_32x32x16_bf16 v[128:143], v[60:63], v[48:51], v[128:143]
    ds_read_b128 v[36:39], v12 offset:4096
    v_dot2c_f32_bf16 v23, v49, v49
    v_mfma_f32_32x32x16_bf16 v[80:95], v[52:55], v[56:59], v[80:95]
    ds_read_b128 v[40:43], v5 offset:4096
    v_dot2c_f32_bf16 v20, s27, v50
    v_dot2c_f32_bf16 v22, v50, v50
    v_mfma_f32_32x32x16_bf16 v[112:127], v[52:55], v[60:63], v[112:127]
    ds_read_b128 v[44:47], v5 offset:5120
    v_dot2c_f32_bf16 v21, s27, v51
    v_mfma_f32_32x32x16_bf16 v[144:159], v[60:63], v[52:55], v[144:159]
    v_dot2c_f32_bf16 v23, v51, v51
    s_waitcnt lgkmcnt(0)
    v_mfma_f32_32x32x16_bf16 v[64:79], v[32:35], v[40:43], v[64:79]
    v_dot2c_f32_bf16 v20, s27, v32
    v_dot2c_f32_bf16 v22, v32, v32
    v_mfma_f32_32x32x16_bf16 v[96:111], v[32:35], v[44:47], v[96:111]
    ds_read_b128 v[48:51], v13 offset:0
    v_dot2c_f32_bf16 v21, s27, v33
    v_mfma_f32_32x32x16_bf16 v[128:143], v[44:47], v[32:35], v[128:143]
    ds_read_b128 v[52:55], v13 offset:4096
    v_dot2c_f32_bf16 v23, v33, v33
    v_mfma_f32_32x32x16_bf16 v[80:95], v[36:39], v[40:43], v[80:95]
    ds_read_b128 v[56:59], v5 offset:6144
    v_dot2c_f32_bf16 v20, s27, v34
    v_dot2c_f32_bf16 v22, v34, v34
    v_mfma_f32_32x32x16_bf16 v[112:127], v[36:39], v[44:47], v[112:127]
    ds_read_b128 v[60:63], v5 offset:7168
    v_dot2c_f32_bf16 v21, s27, v35
    v_mfma_f32_32x32x16_bf16 v[144:159], v[44:47], v[36:39], v[144:159]
    v_dot2c_f32_bf16 v23, v35, v35
    s_waitcnt vmcnt(8)
    s_barrier
    s_lshl_b32 s28, s13, 12
    s_add_u32 s28, s28, 32768
    s_mov_b32 m0, s28
    s_add_u32 s29, s24, 1152
    buffer_load_dwordx4 v2, s[16:19], s29 offen offset:0 lds
    s_add_u32 s29, s29, 9216
    buffer_load_dwordx4 v3, s[16:19], s29 offen offset:1024 lds
    s_add_u32 s29, s29, 9216
    buffer_load_dwordx4 v2, s[16:19], s29 offen offset:2048 lds
    s_add_u32 s29, s29, 9216
    buffer_load_dwordx4 v3, s[16:19], s29 offen offset:3072 lds
    s_add_u32 s28, s28, 16384
    s_mov_b32 m0, s28
    s_add_u32 s29, s25, 73728
    buffer_load_dwordx4 v1, s[8:11], s29 offen offset:0 lds
    buffer_load_dwordx4 v1, s[8:11], s29 offen offset:1024 lds
    buffer_load_dwordx4 v1, s[8:11], s29 offen offset:2048 lds
    buffer_load_dwordx4 v1, s[8:11], s29 offen offset:3072 lds
    s_waitcnt lgkmcnt(0)
    v_mfma_f32_32x32x16_bf16 v[64:79], v[48:51], v[56:59], v[64:79]
    v_dot2c_f32_bf16 v20, s27, v48
    v_dot2c_f32_bf16 v22, v48, v48
    v_mfma_f32_32x32x16_bf16 v[96:111], v[48:51], v[60:63], v[96:111]
    ds_read_b128 v[32:35], v10 offset:32768
    v_dot2c_f32_bf16 v21, s27, v49
    v_mfma_f32_32x32x16_bf16 v[128:143], v[60:63], v[48:51], v[128:143]
    ds_read_b128 v[36:39], v10 offset:36864
    v_dot2c_f32_bf16 v23, v49, v49
    v_mfma_f32_32x32x16_bf16 v[80:95], v[52:55], v[56:59], v[80:95]
    ds_read_b128 v[40:43], v5 offset:32768
    v_dot2c_f32_bf16 v20, s27, v50
    v_dot2c_f32_bf16 v22, v50, v50
    v_mfma_f32_32x32x16_bf16 v[112:127], v[52:55], v[60:63], v[112:127]
    ds_read_b128 v[44:47], v5 offset:33792
    v_dot2c_f32_bf16 v21, s27, v51
    v_mfma_f32_32x32x16_bf16 v[144:159], v[60:63], v[52:55], v[144:159]
    v_dot2c_f32_bf16 v23, v51, v51
    s_waitcnt lgkmcnt(0)
    v_mfma_f32_32x32x16_bf16 v[64:79], v[32:35], v[40:43], v[64:79]
    v_dot2c_f32_bf16 v20, s27, v32
    v_dot2c_f32_bf16 v22, v32, v32
    v_mfma_f32_32x32x16_bf16 v[96:111], v[32:35], v[44:47], v[96:111]
    ds_read_b128 v[48:51], v11 offset:32768
    v_dot2c_f32_bf16 v21, s27, v33
    v_mfma_f32_32x32x16_bf16 v[128:143], v[44:47], v[32:35], v[128:143]
    ds_read_b128 v[52:55], v11 offset:36864
    v_dot2c_f32_bf16 v23, v33, v33
    v_mfma_f32_32x32x16_bf16 v[80:95], v[36:39], v[40:43], v[80:95]
    ds_read_b128 v[56:59], v5 offset:34816
    v_dot2c_f32_bf16 v20, s27, v34
    v_dot2c_f32_bf16 v22, v34, v34
    v_mfma_f32_32x32x16_bf16 v[112:127], v[36:39], v[44:47], v[112:127]
    ds_read_b128 v[60:63], v5 offset:35840
    v_dot2c_f32_bf16 v21, s27, v35
    v_mfma_f32_32x32x16_bf16 v[144:159], v[44:47], v[36:39], v[144:159]
    v_dot2c_f32_bf16 v23, v35, v35
    s_waitcnt lgkmcnt(0)
    v_mfma_f32_32x32x16_bf16 v[64:79], v[48:51], v[56:59], v[64:79]
    v_dot2c_f32_bf16 v20, s27, v48
    v_dot2c_f32_bf16 v22, v48, v48
    v_mfma_f32_32x32x16_bf16 v[96:111], v[48:51], v[60:63], v[96:111]
    ds_read_b128 v[32:35], v12 offset:32768
    v_dot2c_f32_bf16 v21, s27, v49
    v_mfma_f32_32x32x16_bf16 v[128:143], v[60:63], v[48:51], v[128:143]
    ds_read_b128 v[36:39], v12 offset:36864
    v_dot2c_f32_bf16 v23, v49, v49
    v_mfma_f32_32x32x16_bf16 v[80:95], v[52:55], v[56:59], v[80:95]
    ds_read_b128 v[40:43], v5 offset:36864
    v_dot2c_f32_bf16 v20, s27, v50
    v_dot2c_f32_bf16 v22, v50, v50
    v_mfma_f32_32x32x16_bf16 v[112:127], v[52:55], v[60:63], v[112:127]
    ds_read_b128 v[44:47], v5 offset:37888
    v_dot2c_f32_bf16 v21, s27, v51
    v_mfma_f32_32x32x16_bf16 v[144:159], v[60:63], v[52:55], v[144:159]
    v_dot2c_f32_bf16 v23, v51, v51
    s_waitcnt lgkmcnt(0)
    v_mfma_f32_32x32x16_bf16 v[64:79], v[32:35], v[40:43], v[64:79]
    v_dot2c_f32_bf16 v20, s27, v32
    v_dot2c_f32_bf16 v22, v32, v32
    v_mfma_f32_32x32x16_bf16 v[96:111], v[32:35], v[44:47], v[96:111]
    ds_read_b128 v[48:51], v13 offset:32768
    v_dot2c_f32_bf16 v21, s27, v33
    v_mfma_f32_32x32x16_bf16 v[128:143], v[44:47], v[32:35], v[128:143]
    ds_read_b128 v[52:55], v13 offset:36864
    v_dot2c_f32_bf16 v23, v33, v33
    v_mfma_f32_32x32x16_bf16 v[80:95], v[36:39], v[40:43], v[80:95]
    ds_read_b128 v[56:59], v5 offset:38912
    v_dot2c_f32_bf16 v20, s27, v34
    v_dot2c_f32_bf16 v22, v34, v34
    v_mfma_f32_32x32x16_bf16 v[112:127], v[36:39], v[44:47], v[112:127]
    ds_read_b128 v[60:63], v5 offset:39936
    v_dot2c_f32_bf16 v21, s27, v35
    v_mfma_f32_32x32x16_bf16 v[144:159], v[44:47], v[36:39], v[144:159]
    v_dot2c_f32_bf16 v23, v35, v35
    s_waitcnt vmcnt(8)
    s_barrier
    s_waitcnt lgkmcnt(0)
    v_mfma_f32_32x32x16_bf16 v[64:79], v[48:51], v[56:59], v[64:79]
    v_dot2c_f32_bf16 v20, s27, v48
    v_dot2c_f32_bf16 v22, v48, v48
    v_mfma_f32_32x32x16_bf16 v[96:111], v[48:51], v[60:63], v[96:111]
    ds_read_b128 v[32:35], v6 offset:0
    v_dot2c_f32_bf16 v21, s27, v49
    v_mfma_f32_32x32x16_bf16 v[128:143], v[60:63], v[48:51], v[128:143]
    ds_read_b128 v[36:39], v6 offset:4096
    v_dot2c_f32_bf16 v23, v49, v49
    v_mfma_f32_32x32x16_bf16 v[80:95], v[52:55], v[56:59], v[80:95]
    ds_read_b128 v[40:43], v4 offset:0
    v_dot2c_f32_bf16 v20, s27, v50
    v_dot2c_f32_bf16 v22, v50, v50
    v_mfma_f32_32x32x16_bf16 v[112:127], v[52:55], v[60:63], v[112:127]
    ds_read_b128 v[44:47], v4 offset:1024
    v_dot2c_f32_bf16 v21, s27, v51
    v_mfma_f32_32x32x16_bf16 v[144:159], v[60:63], v[52:55], v[144:159]
    v_dot2c_f32_bf16 v23, v51, v51
    s_waitcnt lgkmcnt(0)
    v_mfma_f32_32x32x16_bf16 v[64:79], v[32:35], v[40:43], v[64:79]
    v_dot2c_f32_bf16 v20, s27, v32
    v_dot2c_f32_bf16 v22, v32, v32
    v_mfma_f32_32x32x16_bf16 v[96:111], v[32:35], v[44:47], v[96:111]
    ds_read_b128 v[48:51], v7 offset:0
    v_dot2c_f32_bf16 v21, s27, v33
    v_mfma_f32_32x32x16_bf16 v[128:143], v[44:47], v[32:35], v[128:143]
    ds_read_b128 v[52:55], v7 offset:4096
    v_dot2c_f32_bf16 v23, v33, v33
    v_mfma_f32_32x32x16_bf16 v[80:95], v[36:39], v[40:43], v[80:95]
    ds_read_b128 v[56:59], v4 offset:2048
    v_dot2c_f32_bf16 v20, s27, v34
    v_dot2c_f32_bf16 v22, v34, v34
    v_mfma_f32_32x32x16_bf16 v[112:127], v[36:39], v[44:47], v[112:127]
    ds_read_b128 v[60:63], v4 offset:3072
    v_dot2c_f32_bf16 v21, s27, v35
    v_mfma_f32_32x32x16_bf16 v[144:159], v[44:47], v[36:39], v[144:159]
    v_dot2c_f32_bf16 v23, v35, v35
    s_waitcnt lgkmcnt(0)
    v_mfma_f32_32x32x16_bf16 v[64:79], v[48:51], v[56:59], v[64:79]
    v_dot2c_f32_bf16 v20, s27, v48
    v_dot2c_f32_bf16 v22, v48, v48
    v_mfma_f32_32x32x16_bf16 v[96:111], v[48:51], v[60:63], v[96:111]
    ds_read_b128 v[32:35], v8 offset:0
    v_dot2c_f32_bf16 v21, s27, v49
    v_mfma_f32_32x32x16_bf16 v[128:143], v[60:63], v[48:51], v[128:143]
    ds_read_b128 v[36:39], v8 offset:4096
    v_dot2c_f32_bf16 v23, v49, v49
    v_mfma_f32_32x32x16_bf16 v[80:95], v[52:55], v[56:59], v[80:95]
    ds_read_b128 v[40:43], v4 offset:4096
    v_dot2c_f32_bf16 v20, s27, v50
    v_dot2c_f32_bf16 v22, v50, v50
    v_mfma_f32_32x32x16_bf16 v[112:127], v[52:55], v[60:63], v[112:127]
    ds_read_b128 v[44:47], v4 offset:5120
    v_dot2c_f32_bf16 v21, s27, v51
    v_mfma_f32_32x32x16_bf16 v[144:159], v[60:63], v[52:55], v[144:159]
    v_dot2c_f32_bf16 v23, v51, v51
    s_waitcnt lgkmcnt(0)
    v_mfma_f32_32x32x16_bf16 v[64:79], v[32:35], v[40:43], v[64:79]
    v_dot2c_f32_bf16 v20, s27, v32
    v_dot2c_f32_bf16 v22, v32, v32
    v_mfma_f32_32x32x16_bf16 v[96:111], v[32:35], v[44:47], v[96:111]
    ds_read_b128 v[48:51], v9 offset:0
    v_dot2c_f32_bf16 v21, s27, v33
    v_mfma_f32_32x32x16_bf16 v[128:143], v[44:47], v[32:35], v[128:143]
    ds_read_b128 v[52:55], v9 offset:4096
    v_dot2c_f32_bf16 v23, v33, v33
    v_mfma_f32_32x32x16_bf16 v[80:95], v[36:39], v[40:43], v[80:95]
    ds_read_b128 v[56:59], v4 offset:6144
    v_dot2c_f32_bf16 v20, s27, v34
    v_dot2c_f32_bf16 v22, v34, v34
    v_mfma_f32_32x32x16_bf16 v[112:127], v[36:39], v[44:47], v[112:127]
    ds_read_b128 v[60:63], v4 offset:7168
    v_dot2c_f32_bf16 v21, s27, v35
    v_mfma_f32_32x32x16_bf16 v[144:159], v[44:47], v[36:39], v[144:159]
    v_dot2c_f32_bf16 v23, v35, v35
    s_waitcnt vmcnt(0)
    s_barrier
    s_waitcnt lgkmcnt(0)
    v_mfma_f32_32x32x16_bf16 v[64:79], v[48:51], v[56:59], v[64:79]
    v_dot2c_f32_bf16 v20, s27, v48
    v_dot2c_f32_bf16 v22, v48, v48
    v_mfma_f32_32x32x16_bf16 v[96:111], v[48:51], v[60:63], v[96:111]
    ds_read_b128 v[32:35], v6 offset:32768
    v_dot2c_f32_bf16 v21, s27, v49
    v_mfma_f32_32x32x16_bf16 v[128:143], v[60:63], v[48:51], v[128:143]
    ds_read_b128 v[36:39], v6 offset:36864
    v_dot2c_f32_bf16 v23, v49, v49
    v_mfma_f32_32x32x16_bf16 v[80:95], v[52:55], v[56:59], v[80:95]
    ds_read_b128 v[40:43], v4 offset:32768
    v_dot2c_f32_bf16 v20, s27, v50
    v_dot2c_f32_bf16 v22, v50, v50
    v_mfma_f32_32x32x16_bf16 v[112:127], v[52:55], v[60:63], v[112:127]
    ds_read_b128 v[44:47], v4 offset:33792
    v_dot2c_f32_bf16 v21, s27, v51
    v_mfma_f32_32x32x16_bf16 v[144:159], v[60:63], v[52:55], v[144:159]
    v_dot2c_f32_bf16 v23, v51, v51
    s_waitcnt lgkmcnt(0)
    v_mfma_f32_32x32x16_bf16 v[64:79], v[32:35], v[40:43], v[64:79]
    v_dot2c_f32_bf16 v20, s27, v32
    v_dot2c_f32_bf16 v22, v32, v32
    v_mfma_f32_32x32x16_bf16 v[96:111], v[32:35], v[44:47], v[96:111]
    ds_read_b128 v[48:51], v7 offset:32768
    v_dot2c_f32_bf16 v21, s27, v33
    v_mfma_f32_32x32x16_bf16 v[128:143], v[44:47], v[32:35], v[128:143]
    ds_read_b128 v[52:55], v7 offset:36864
    v_dot2c_f32_bf16 v23, v33, v33
    v_mfma_f32_32x32x16_bf16 v[80:95], v[36:39], v[40:43], v[80:95]
    ds_read_b128 v[56:59], v4 offset:34816
    v_dot2c_f32_bf16 v20, s27, v34
    v_dot2c_f32_bf16 v22, v34, v34
    v_mfma_f32_32x32x16_bf16 v[112:127], v[36:39], v[44:47], v[112:127]
    ds_read_b128 v[60:63], v4 offset:35840
    v_dot2c_f32_bf16 v21, s27, v35
    v_mfma_f32_32x32x16_bf16 v[144:159], v[44:47], v[36:39], v[144:159]
    v_dot2c_f32_bf16 v23, v35, v35
    s_waitcnt lgkmcnt(0)
    v_mfma_f32_32x32x16_bf16 v[64:79], v[48:51], v[56:59], v[64:79]
    v_dot2c_f32_bf16 v20, s27, v48
    v_dot2c_f32_bf16 v22, v48, v48
    v_mfma_f32_32x32x16_bf16 v[96:111], v[48:51], v[60:63], v[96:111]
    ds_read_b128 v[32:35], v8 offset:32768
    v_dot2c_f32_bf16 v21, s27, v49
    v_mfma_f32_32x32x16_bf16 v[128:143], v[60:63], v[48:51], v[128:143]
    ds_read_b128 v[36:39], v8 offset:36864
    v_dot2c_f32_bf16 v23, v49, v49
    v_mfma_f32_32x32x16_bf16 v[80:95], v[52:55], v[56:59], v[80:95]
    ds_read_b128 v[40:43], v4 offset:36864
    v_dot2c_f32_bf16 v20, s27, v50
    v_dot2c_f32_bf16 v22, v50, v50
    v_mfma_f32_32x32x16_bf16 v[112:127], v[52:55], v[60:63], v[112:127]
    ds_read_b128 v[44:47], v4 offset:37888
    v_dot2c_f32_bf16 v21, s27, v51
    v_mfma_f32_32x32x16_bf16 v[144:159], v[60:63], v[52:55], v[144:159]
    v_dot2c_f32_bf16 v23, v51, v51
    s_waitcnt lgkmcnt(0)
    v_mfma_f32_32x32x16_bf16 v[64:79], v[32:35], v[40:43], v[64:79]
    v_dot2c_f32_bf16 v20, s27, v32
    v_dot2c_f32_bf16 v22, v32, v32
    v_mfma_f32_32x32x16_bf16 v[96:111], v[32:35], v[44:47], v[96:111]
    ds_read_b128 v[48:51], v9 offset:32768
    v_dot2c_f32_bf16 v21, s27, v33
    v_mfma_f32_32x32x16_bf16 v[128:143], v[44:47], v[32:35], v[128:143]
    ds_read_b128 v[52:55], v9 offset:36864
    v_dot2c_f32_bf16 v23, v33, v33
    v_mfma_f32_32x32x16_bf16 v[80:95], v[36:39], v[40:43], v[80:95]
    ds_read_b128 v[56:59], v4 offset:38912
    v_dot2c_f32_bf16 v20, s27, v34
    v_dot2c_f32_bf16 v22, v34, v34
    v_mfma_f32_32x32x16_bf16 v[112:127], v[36:39], v[44:47], v[112:127]
    ds_read_b128 v[60:63], v4 offset:39936
    v_dot2c_f32_bf16 v21, s27, v35
    v_mfma_f32_32x32x16_bf16 v[144:159], v[44:47], v[36:39], v[144:159]
    v_dot2c_f32_bf16 v23, v35, v35
    s_waitcnt lgkmcnt(0)
    v_mfma_f32_32x32x16_bf16 v[64:79], v[48:51], v[56:59], v[64:79]
    v_dot2c_f32_bf16 v20, s27, v48
    v_dot2c_f32_bf16 v22, v48, v48
    v_mfma_f32_32x32x16_bf16 v[96:111], v[48:51], v[60:63], v[96:111]
    v_dot2c_f32_bf16 v21, s27, v49
    v_mfma_f32_32x32x16_bf16 v[128:143], v[60:63], v[48:51], v[128:143]
    v_dot2c_f32_bf16 v23, v49, v49
    v_mfma_f32_32x32x16_bf16 v[80:95], v[52:55], v[56:59], v[80:95]
    v_dot2c_f32_bf16 v20, s27, v50
    v_dot2c_f32_bf16 v22, v50, v50
    v_mfma_f32_32x32x16_bf16 v[112:127], v[52:55], v[60:63], v[112:127]
    v_dot2c_f32_bf16 v21, s27, v51
    v_mfma_f32_32x32x16_bf16 v[144:159], v[60:63], v[52:55], v[144:159]
    v_dot2c_f32_bf16 v23, v51, v51
    s_branch afront1_kernel_af_epi
afront1_kernel_af_h1:
    s_waitcnt lgkmcnt(0)
    v_mfma_f32_32x32x16_bf16 v[64:79], v[32:35], v[40:43], 0
    v_dot2c_f32_bf16 v20, s27, v36
    v_dot2c_f32_bf16 v22, v36, v36
    v_mfma_f32_32x32x16_bf16 v[96:111], v[32:35], v[44:47], 0
    ds_read_b128 v[48:51], v7 offset:0
    v_dot2c_f32_bf16 v21, s27, v37
    v_mfma_f32_32x32x16_bf16 v[128:143], v[44:47], v[32:35], 0
    ds_read_b128 v[52:55], v7 offset:4096
    v_dot2c_f32_bf16 v23, v37, v37
    v_mfma_f32_32x32x16_bf16 v[80:95], v[36:39], v[40:43], 0
    ds_read_b128 v[56:59], v4 offset:2048
    v_dot2c_f32_bf16 v20, s27, v38
    v_dot2c_f32_bf16 v22, v38, v38
    v_mfma_f32_32x32x16_bf16 v[112:127], v[36:39], v[44:47], 0
    ds_read_b128 v[60:63], v4 offset:3072
    v_dot2c_f32_bf16 v21, s27, v39
    v_mfma_f32_32x32x16_bf16 v[144:159], v[44:47], v[36:39], 0
    v_dot2c_f32_bf16 v23, v39, v39
    s_waitcnt lgkmcnt(0)
    v_mfma_f32_32x32x16_bf16 v[64:79], v[48:51], v[56:59], v[64:79]
    v_dot2c_f32_bf16 v20, s27, v52
    v_dot2c_f32_bf16 v22, v52, v52
    v_mfma_f32_32x32x16_bf16 v[96:111], v[48:51], v[60:63], v[96:111]
    ds_read_b128 v[32:35], v8 offset:0
    v_dot2c_f32_bf16 v21, s27, v53
    v_mfma_f32_32x32x16_bf16 v[128:143], v[60:63], v[48:51], v[128:143]
    ds_read_b128 v[36:39], v8 offset:4096
    v_dot2c_f32_bf16 v23, v53, v53
    v_mfma_f32_32x32x16_bf16 v[80:95], v[52:55], v[56:59], v[80:95]
    ds_read_b128 v[40:43], v4 offset:4096
    v_dot2c_f32_bf16 v20, s27, v54
    v_dot2c_f32_bf16 v22, v54, v54
    v_mfma_f32_32x32x16_bf16 v[112:127], v[52:55], v[60:63], v[112:127]
    ds_read_b128 v[44:47], v4 offset:5120
    v_dot2c_f32_bf16 v21, s27, v55
    v_mfma_f32_32x32x16_bf16 v[144:159], v[60:63], v[52:55], v[144:159]
    v_dot2c_f32_bf16 v23, v55, v55
    s_waitcnt lgkmcnt(0)
    v_mfma_f32_32x32x16_bf16 v[64:79], v[32:35], v[40:43], v[64:79]
    v_dot2c_f32_bf16 v20, s27, v36
    v_dot2c_f32_bf16 v22, v36, v36
    v_mfma_f32_32x32x16_bf16 v[96:111], v[32:35], v[44:47], v[96:111]
    ds_read_b128 v[48:51], v9 offset:0
    v_dot2c_f32_bf16 v21, s27, v37
    v_mfma_f32_32x32x16_bf16 v[128:143], v[44:47], v[32:35], v[128:143]
    ds_read_b128 v[52:55], v9 offset:4096
    v_dot2c_f32_bf16 v23, v37, v37
    v_mfma_f32_32x32x16_bf16 v[80:95], v[36:39], v[40:43], v[80:95]
    ds_read_b128 v[56:59], v4 offset:6144
    v_dot2c_f32_bf16 v20, s27, v38
    v_dot2c_f32_bf16 v22, v38, v38
    v_mfma_f32_32x32x16_bf16 v[112:127], v[36:39], v[44:47], v[112:127]
    ds_read_b128 v[60:63], v4 offset:7168
    v_dot2c_f32_bf16 v21, s27, v39
    v_mfma_f32_32x32x16_bf16 v[144:159], v[44:47], v[36:39], v[144:159]
    v_dot2c_f32_bf16 v23, v39, v39
    s_waitcnt vmcnt(8)
    s_barrier
    s_lshl_b32 s28, s13, 12
    s_add_u32 s28, s28, 98304
    s_mov_b32 m0, s28
    s_add_u32 s29, s24, 384
    buffer_load_dwordx4 v2, s[16:19], s29 offen offset:0 lds
    s_add_u32 s29, s29, 9216
    buffer_load_dwordx4 v3, s[16:19], s29 offen offset:1024 lds
    s_add_u32 s29, s29, 9216
    buffer_load_dwordx4 v2, s[16:19], s29 offen offset:2048 lds
    s_add_u32 s29, s29, 9216
    buffer_load_dwordx4 v3, s[16:19], s29 offen offset:3072 lds
    s_add_u32 s28, s28, 16384
    s_mov_b32 m0, s28
    s_add_u32 s29, s25, 24576
    buffer_load_dwordx4 v1, s[8:11], s29 offen offset:0 lds
    buffer_load_dwordx4 v1, s[8:11], s29 offen offset:1024 lds
    buffer_load_dwordx4 v1, s[8:11], s29 offen offset:2048 lds
    buffer_load_dwordx4 v1, s[8:11], s29 offen offset:3072 lds
    s_waitcnt lgkmcnt(0)
    v_mfma_f32_32x32x16_bf16 v[64:79], v[48:51], v[56:59], v[64:79]
    v_dot2c_f32_bf16 v20, s27, v52
    v_dot2c_f32_bf16 v22, v52, v52
    v_mfma_f32_32x32x16_bf16 v[96:111], v[48:51], v[60:63], v[96:111]
    ds_read_b128 v[32:35], v6 offset:32768
    v_dot2c_f32_bf16 v21, s27, v53
    v_mfma_f32_32x32x16_bf16 v[128:143], v[60:63], v[48:51], v[128:143]
    ds_read_b128 v[36:39], v6 offset:36864
    v_dot2c_f32_bf16 v23, v53, v53
    v_mfma_f32_32x32x16_bf16 v[80:95], v[52:55], v[56:59], v[80:95]
    ds_read_b128 v[40:43], v4 offset:32768
    v_dot2c_f32_bf16 v20, s27, v54
    v_dot2c_f32_bf16 v22, v54, v54
    v_mfma_f32_32x32x16_bf16 v[112:127], v[52:55], v[60:63], v[112:127]
    ds_read_b128 v[44:47], v4 offset:33792
    v_dot2c_f32_bf16 v21, s27, v55
    v_mfma_f32_32x32x16_bf16 v[144:159], v[60:63], v[52:55], v[144:159]
    v_dot2c_f32_bf16 v23, v55, v55
    s_waitcnt lgkmcnt(0)
    v_mfma_f32_32x32x16_bf16 v[64:79], v[32:35], v[40:43], v[64:79]
    v_dot2c_f32_bf16 v20, s27, v36
    v_dot2c_f32_bf16 v22, v36, v36
    v_mfma_f32_32x32x16_bf16 v[96:111], v[32:35], v[44:47], v[96:111]
    ds_read_b128 v[48:51], v7 offset:32768
    v_dot2c_f32_bf16 v21, s27, v37
    v_mfma_f32_32x32x16_bf16 v[128:143], v[44:47], v[32:35], v[128:143]
    ds_read_b128 v[52:55], v7 offset:36864
    v_dot2c_f32_bf16 v23, v37, v37
    v_mfma_f32_32x32x16_bf16 v[80:95], v[36:39], v[40:43], v[80:95]
    ds_read_b128 v[56:59], v4 offset:34816
    v_dot2c_f32_bf16 v20, s27, v38
    v_dot2c_f32_bf16 v22, v38, v38
    v_mfma_f32_32x32x16_bf16 v[112:127], v[36:39], v[44:47], v[112:127]
    ds_read_b128 v[60:63], v4 offset:35840
    v_dot2c_f32_bf16 v21, s27, v39
    v_mfma_f32_32x32x16_bf16 v[144:159], v[44:47], v[36:39], v[144:159]
    v_dot2c_f32_bf16 v23, v39, v39
    s_waitcnt lgkmcnt(0)
    v_mfma_f32_32x32x16_bf16 v[64:79], v[48:51], v[56:59], v[64:79]
    v_dot2c_f32_bf16 v20, s27, v52
    v_dot2c_f32_bf16 v22, v52, v52
    v_mfma_f32_32x32x16_bf16 v[96:111], v[48:51], v[60:63], v[96:111]
    ds_read_b128 v[32:35], v8 offset:32768
    v_dot2c_f32_bf16 v21, s27, v53
    v_mfma_f32_32x32x16_bf16 v[128:143], v[60:63], v[48:51], v[128:143]
    ds_read_b128 v[36:39], v8 offset:36864
    v_dot2c_f32_bf16 v23, v53, v53
    v_mfma_f32_32x32x16_bf16 v[80:95], v[52:55], v[56:59], v[80:95]
    ds_read_b128 v[40:43], v4 offset:36864
    v_dot2c_f32_bf16 v20, s27, v54
    v_dot2c_f32_bf16 v22, v54, v54
    v_mfma_f32_32x32x16_bf16 v[112:127], v[52:55], v[60:63], v[112:127]
    ds_read_b128 v[44:47], v4 offset:37888
    v_dot2c_f32_bf16 v21, s27, v55
    v_mfma_f32_32x32x16_bf16 v[144:159], v[60:63], v[52:55], v[144:159]
    v_dot2c_f32_bf16 v23, v55, v55
    s_waitcnt lgkmcnt(0)
    v_mfma_f32_32x32x16_bf16 v[64:79], v[32:35], v[40:43], v[64:79]
    v_dot2c_f32_bf16 v20, s27, v36
    v_dot2c_f32_bf16 v22, v36, v36
    v_mfma_f32_32x32x16_bf16 v[96:111], v[32:35], v[44:47], v[96:111]
    ds_read_b128 v[48:51], v9 offset:32768
    v_dot2c_f32_bf16 v21, s27, v37
    v_mfma_f32_32x32x16_bf16 v[128:143], v[44:47], v[32:35], v[128:143]
    ds_read_b128 v[52:55], v9 offset:36864
    v_dot2c_f32_bf16 v23, v37, v37
    v_mfma_f32_32x32x16_bf16 v[80:95], v[36:39], v[40:43], v[80:95]
    ds_read_b128 v[56:59], v4 offset:38912
    v_dot2c_f32_bf16 v20, s27, v38
    v_dot2c_f32_bf16 v22, v38, v38
    v_mfma_f32_32x32x16_bf16 v[112:127], v[36:39], v[44:47], v[112:127]
    ds_read_b128 v[60:63], v4 offset:39936
    v_dot2c_f32_bf16 v21, s27, v39
    v_mfma_f32_32x32x16_bf16 v[144:159], v[44:47], v[36:39], v[144:159]
    v_dot2c_f32_bf16 v23, v39, v39
    s_waitcnt vmcnt(8)
    s_barrier
    s_lshl_b32 s28, s13, 12
    s_mov_b32 m0, s28
    s_add_u32 s29, s24, 512
    buffer_load_dwordx4 v2, s[16:19], s29 offen offset:0 lds
    s_add_u32 s29, s29, 9216
    buffer_load_dwordx4 v3, s[16:19], s29 offen offset:1024 lds
    s_add_u32 s29, s29, 9216
    buffer_load_dwordx4 v2, s[16:19], s29 offen offset:2048 lds
    s_add_u32 s29, s29, 9216
    buffer_load_dwordx4 v3, s[16:19], s29 offen offset:3072 lds
    s_add_u32 s28, s28, 16384
    s_mov_b32 m0, s28
    s_add_u32 s29, s25, 32768
    buffer_load_dwordx4 v1, s[8:11], s29 offen offset:0 lds
    buffer_load_dwordx4 v1, s[8:11], s29 offen offset:1024 lds
    buffer_load_dwordx4 v1, s[8:11], s29 offen offset:2048 lds
    buffer_load_dwordx4 v1, s[8:11], s29 offen offset:3072 lds
    s_waitcnt lgkmcnt(0)
    v_mfma_f32_32x32x16_bf16 v[64:79], v[48:51], v[56:59], v[64:79]
    v_dot2c_f32_bf16 v20, s27, v52
    v_dot2c_f32_bf16 v22, v52, v52
    v_mfma_f32_32x32x16_bf16 v[96:111], v[48:51], v[60:63], v[96:111]
    ds_read_b128 v[32:35], v10 offset:0
    v_dot2c_f32_bf16 v21, s27, v53
    v_mfma_f32_32x32x16_bf16 v[128:143], v[60:63], v[48:51], v[128:143]
    ds_read_b128 v[36:39], v10 offset:4096
    v_dot2c_f32_bf16 v23, v53, v53
    v_mfma_f32_32x32x16_bf16 v[80:95], v[52:55], v[56:59], v[80:95]
    ds_read_b128 v[40:43], v5 offset:0
    v_dot2c_f32_bf16 v20, s27, v54
    v_dot2c_f32_bf16 v22, v54, v54
    v_mfma_f32_32x32x16_bf16 v[112:127], v[52:55], v[60:63], v[112:127]
    ds_read_b128 v[44:47], v5 offset:1024
    v_dot2c_f32_bf16 v21, s27, v55
    v_mfma_f32_32x32x16_bf16 v[144:159], v[60:63], v[52:55], v[144:159]
    v_dot2c_f32_bf16 v23, v55, v55
    s_waitcnt lgkmcnt(0)
    v_mfma_f32_32x32x16_bf16 v[64:79], v[32:35], v[40:43], v[64:79]
    v_dot2c_f32_bf16 v20, s27, v36
    v_dot2c_f32_bf16 v22, v36, v36
    v_mfma_f32_32x32x16_bf16 v[96:111], v[32:35], v[44:47], v[96:111]
    ds_read_b128 v[48:51], v11 offset:0
    v_dot2c_f32_bf16 v21, s27, v37
    v_mfma_f32_32x32x16_bf16 v[128:143], v[44:47], v[32:35], v[128:143]
    ds_read_b128 v[52:55], v11 offset:4096
    v_dot2c_f32_bf16 v23, v37, v37
    v_mfma_f32_32x32x16_bf16 v[80:95], v[36:39], v[40:43], v[80:95]
    ds_read_b128 v[56:59], v5 offset:2048
    v_dot2c_f32_bf16 v20, s27, v38
    v_dot2c_f32_bf16 v22, v38, v38
    v_mfma_f32_32x32x16_bf16 v[112:127], v[36:39], v[44:47], v[112:127]
    ds_read_b128 v[60:63], v5 offset:3072
    v_dot2c_f32_bf16 v21, s27, v39
    v_mfma_f32_32x32x16_bf16 v[144:159], v[44:47], v[36:39], v[144:159]
    v_dot2c_f32_bf16 v23, v39, v39
    s_waitcnt lgkmcnt(0)
    v_mfma_f32_32x32x16_bf16 v[64:79], v[48:51], v[56:59], v[64:79]
    v_dot2c_f32_bf16 v20, s27, v52
    v_dot2c_f32_bf16 v22, v52, v52
    v_mfma_f32_32x32x16_bf16 v[96:111], v[48:51], v[60:63], v[96:111]
    ds_read_b128 v[32:35], v12 offset:0
    v_dot2c_f32_bf16 v21, s27, v53
    v_mfma_f32_32x32x16_bf16 v[128:143], v[60:63], v[48:51], v[128:143]
    ds_read_b128 v[36:39], v12 offset:4096
    v_dot2c_f32_bf16 v23, v53, v53
    v_mfma_f32_32x32x16_bf16 v[80:95], v[52:55], v[56:59], v[80:95]
    ds_read_b128 v[40:43], v5 offset:4096
    v_dot2c_f32_bf16 v20, s27, v54
    v_dot2c_f32_bf16 v22, v54, v54
    v_mfma_f32_32x32x16_bf16 v[112:127], v[52:55], v[60:63], v[112:127]
    ds_read_b128 v[44:47], v5 offset:5120
    v_dot2c_f32_bf16 v21, s27, v55
    v_mfma_f32_32x32x16_bf16 v[144:159], v[60:63], v[52:55], v[144:159]
    v_dot2c_f32_bf16 v23, v55, v55
    s_waitcnt lgkmcnt(0)
    v_mfma_f32_32x32x16_bf16 v[64:79], v[32:35], v[40:43], v[64:79]
    v_dot2c_f32_bf16 v20, s27, v36
    v_dot2c_f32_bf16 v22, v36, v36
    v_mfma_f32_32x32x16_bf16 v[96:111], v[32:35], v[44:47], v[96:111]
    ds_read_b128 v[48:51], v13 offset:0
    v_dot2c_f32_bf16 v21, s27, v37
    v_mfma_f32_32x32x16_bf16 v[128:143], v[44:47], v[32:35], v[128:143]
    ds_read_b128 v[52:55], v13 offset:4096
    v_dot2c_f32_bf16 v23, v37, v37
    v_mfma_f32_32x32x16_bf16 v[80:95], v[36:39], v[40:43], v[80:95]
    ds_read_b128 v[56:59], v5 offset:6144
    v_dot2c_f32_bf16 v20, s27, v38
    v_dot2c_f32_bf16 v22, v38, v38
    v_mfma_f32_32x32x16_bf16 v[112:127], v[36:39], v[44:47], v[112:127]
    ds_read_b128 v[60:63], v5 offset:7168
    v_dot2c_f32_bf16 v21, s27, v39
    v_mfma_f32_32x32x16_bf16 v[144:159], v[44:47], v[36:39], v[144:159]
    v_dot2c_f32_bf16 v23, v39, v39
    s_waitcnt vmcnt(8)
    s_barrier
    s_lshl_b32 s28, s13, 12
    s_add_u32 s28, s28, 32768
    s_mov_b32 m0, s28
    s_add_u32 s29, s24, 640
    buffer_load_dwordx4 v2, s[16:19], s29 offen offset:0 lds
    s_add_u32 s29, s29, 9216
    buffer_load_dwordx4 v3, s[16:19], s29 offen offset:1024 lds
    s_add_u32 s29, s29, 9216
    buffer_load_dwordx4 v2, s[16:19], s29 offen offset:2048 lds
    s_add_u32 s29, s29, 9216
    buffer_load_dwordx4 v3, s[16:19], s29 offen offset:3072 lds
    s_add_u32 s28, s28, 16384
    s_mov_b32 m0, s28
    s_add_u32 s29, s25, 40960
    buffer_load_dwordx4 v1, s[8:11], s29 offen offset:0 lds
    buffer_load_dwordx4 v1, s[8:11], s29 offen offset:1024 lds
    buffer_load_dwordx4 v1, s[8:11], s29 offen offset:2048 lds
    buffer_load_dwordx4 v1, s[8:11], s29 offen offset:3072 lds
    s_waitcnt lgkmcnt(0)
    v_mfma_f32_32x32x16_bf16 v[64:79], v[48:51], v[56:59], v[64:79]
    v_dot2c_f32_bf16 v20, s27, v52
    v_dot2c_f32_bf16 v22, v52, v52
    v_mfma_f32_32x32x16_bf16 v[96:111], v[48:51], v[60:63], v[96:111]
    ds_read_b128 v[32:35], v10 offset:32768
    v_dot2c_f32_bf16 v21, s27, v53
    v_mfma_f32_32x32x16_bf16 v[128:143], v[60:63], v[48:51], v[128:143]
    ds_read_b128 v[36:39], v10 offset:36864
    v_dot2c_f32_bf16 v23, v53, v53
    v_mfma_f32_32x32x16_bf16 v[80:95], v[52:55], v[56:59], v[80:95]
    ds_read_b128 v[40:43], v5 offset:32768
    v_dot2c_f32_bf16 v20, s27, v54
    v_dot2c_f32_bf16 v22, v54, v54
    v_mfma_f32_32x32x16_bf16 v[112:127], v[52:55], v[60:63], v[112:127]
    ds_read_b128 v[44:47], v5 offset:33792
    v_dot2c_f32_bf16 v21, s27, v55
    v_mfma_f32_32x32x16_bf16 v[144:159], v[60:63], v[52:55], v[144:159]
    v_dot2c_f32_bf16 v23, v55, v55
    s_waitcnt lgkmcnt(0)
    v_mfma_f32_32x32x16_bf16 v[64:79], v[32:35], v[40:43], v[64:79]
    v_dot2c_f32_bf16 v20, s27, v36
    v_dot2c_f32_bf16 v22, v36, v36
    v_mfma_f32_32x32x16_bf16 v[96:111], v[32:35], v[44:47], v[96:111]
    ds_read_b128 v[48:51], v11 offset:32768
    v_dot2c_f32_bf16 v21, s27, v37
    v_mfma_f32_32x32x16_bf16 v[128:143], v[44:47], v[32:35], v[128:143]
    ds_read_b128 v[52:55], v11 offset:36864
    v_dot2c_f32_bf16 v23, v37, v37
    v_mfma_f32_32x32x16_bf16 v[80:95], v[36:39], v[40:43], v[80:95]
    ds_read_b128 v[56:59], v5 offset:34816
    v_dot2c_f32_bf16 v20, s27, v38
    v_dot2c_f32_bf16 v22, v38, v38
    v_mfma_f32_32x32x16_bf16 v[112:127], v[36:39], v[44:47], v[112:127]
    ds_read_b128 v[60:63], v5 offset:35840
    v_dot2c_f32_bf16 v21, s27, v39
    v_mfma_f32_32x32x16_bf16 v[144:159], v[44:47], v[36:39], v[144:159]
    v_dot2c_f32_bf16 v23, v39, v39
    s_waitcnt lgkmcnt(0)
    v_mfma_f32_32x32x16_bf16 v[64:79], v[48:51], v[56:59], v[64:79]
    v_dot2c_f32_bf16 v20, s27, v52
    v_dot2c_f32_bf16 v22, v52, v52
    v_mfma_f32_32x32x16_bf16 v[96:111], v[48:51], v[60:63], v[96:111]
    ds_read_b128 v[32:35], v12 offset:32768
    v_dot2c_f32_bf16 v21, s27, v53
    v_mfma_f32_32x32x16_bf16 v[128:143], v[60:63], v[48:51], v[128:143]
    ds_read_b128 v[36:39], v12 offset:36864
    v_dot2c_f32_bf16 v23, v53, v53
    v_mfma_f32_32x32x16_bf16 v[80:95], v[52:55], v[56:59], v[80:95]
    ds_read_b128 v[40:43], v5 offset:36864
    v_dot2c_f32_bf16 v20, s27, v54
    v_dot2c_f32_bf16 v22, v54, v54
    v_mfma_f32_32x32x16_bf16 v[112:127], v[52:55], v[60:63], v[112:127]
    ds_read_b128 v[44:47], v5 offset:37888
    v_dot2c_f32_bf16 v21, s27, v55
    v_mfma_f32_32x32x16_bf16 v[144:159], v[60:63], v[52:55], v[144:159]
    v_dot2c_f32_bf16 v23, v55, v55
    s_waitcnt lgkmcnt(0)
    v_mfma_f32_32x32x16_bf16 v[64:79], v[32:35], v[40:43], v[64:79]
    v_dot2c_f32_bf16 v20, s27, v36
    v_dot2c_f32_bf16 v22, v36, v36
    v_mfma_f32_32x32x16_bf16 v[96:111], v[32:35], v[44:47], v[96:111]
    ds_read_b128 v[48:51], v13 offset:32768
    v_dot2c_f32_bf16 v21, s27, v37
    v_mfma_f32_32x32x16_bf16 v[128:143], v[44:47], v[32:35], v[128:143]
    ds_read_b128 v[52:55], v13 offset:36864
    v_dot2c_f32_bf16 v23, v37, v37
    v_mfma_f32_32x32x16_bf16 v[80:95], v[36:39], v[40:43], v[80:95]
    ds_read_b128 v[56:59], v5 offset:38912
    v_dot2c_f32_bf16 v20, s27, v38
    v_dot2c_f32_bf16 v22, v38, v38
    v_mfma_f32_32x32x16_bf16 v[112:127], v[36:39], v[44:47], v[112:127]
    ds_read_b128 v[60:63], v5 offset:39936
    v_dot2c_f32_bf16 v21, s27, v39
    v_mfma_f32_32x32x16_bf16 v[144:159], v[44:47], v[36:39], v[144:159]
    v_dot2c_f32_bf16 v23, v39, v39
    s_waitcnt vmcnt(8)
    s_barrier
    s_lshl_b32 s28, s13, 12
    s_add_u32 s28, s28, 65536
    s_mov_b32 m0, s28
    s_add_u32 s29, s24, 768
    buffer_load_dwordx4 v2, s[16:19], s29 offen offset:0 lds
    s_add_u32 s29, s29, 9216
    buffer_load_dwordx4 v3, s[16:19], s29 offen offset:1024 lds
    s_add_u32 s29, s29, 9216
    buffer_load_dwordx4 v2, s[16:19], s29 offen offset:2048 lds
    s_add_u32 s29, s29, 9216
    buffer_load_dwordx4 v3, s[16:19], s29 offen offset:3072 lds
    s_add_u32 s28, s28, 16384
    s_mov_b32 m0, s28
    s_add_u32 s29, s25, 49152
    buffer_load_dwordx4 v1, s[8:11], s29 offen offset:0 lds
    buffer_load_dwordx4 v1, s[8:11], s29 offen offset:1024 lds
    buffer_load_dwordx4 v1, s[8:11], s29 offen offset:2048 lds
    buffer_load_dwordx4 v1, s[8:11], s29 offen offset:3072 lds
    s_waitcnt lgkmcnt(0)
    v_mfma_f32_32x32x16_bf16 v[64:79], v[48:51], v[56:59], v[64:79]
    v_dot2c_f32_bf16 v20, s27, v52
    v_dot2c_f32_bf16 v22, v52, v52
    v_mfma_f32_32x32x16_bf16 v[96:111], v[48:51], v[60:63], v[96:111]
    ds_read_b128 v[32:35], v6 offset:0
    v_dot2c_f32_bf16 v21, s27, v53
    v_mfma_f32_32x32x16_bf16 v[128:143], v[60:63], v[48:51], v[128:143]
    ds_read_b128 v[36:39], v6 offset:4096
    v_dot2c_f32_bf16 v23, v53, v53
    v_mfma_f32_32x32x16_bf16 v[80:95], v[52:55], v[56:59], v[80:95]
    ds_read_b128 v[40:43], v4 offset:0
    v_dot2c_f32_bf16 v20, s27, v54
    v_dot2c_f32_bf16 v22, v54, v54
    v_mfma_f32_32x32x16_bf16 v[112:127], v[52:55], v[60:63], v[112:127]
    ds_read_b128 v[44:47], v4 offset:1024
    v_dot2c_f32_bf16 v21, s27, v55
    v_mfma_f32_32x32x16_bf16 v[144:159], v[60:63], v[52:55], v[144:159]
    v_dot2c_f32_bf16 v23, v55, v55
    s_waitcnt lgkmcnt(0)
    v_mfma_f32_32x32x16_bf16 v[64:79], v[32:35], v[40:43], v[64:79]
    v_dot2c_f32_bf16 v20, s27, v36
    v_dot2c_f32_bf16 v22, v36, v36
    v_mfma_f32_32x32x16_bf16 v[96:111], v[32:35], v[44:47], v[96:111]
    ds_read_b128 v[48:51], v7 offset:0
    v_dot2c_f32_bf16 v21, s27, v37
    v_mfma_f32_32x32x16_bf16 v[128:143], v[44:47], v[32:35], v[128:143]
    ds_read_b128 v[52:55], v7 offset:4096
    v_dot2c_f32_bf16 v23, v37, v37
    v_mfma_f32_32x32x16_bf16 v[80:95], v[36:39], v[40:43], v[80:95]
    ds_read_b128 v[56:59], v4 offset:2048
    v_dot2c_f32_bf16 v20, s27, v38
    v_dot2c_f32_bf16 v22, v38, v38
    v_mfma_f32_32x32x16_bf16 v[112:127], v[36:39], v[44:47], v[112:127]
    ds_read_b128 v[60:63], v4 offset:3072
    v_dot2c_f32_bf16 v21, s27, v39
    v_mfma_f32_32x32x16_bf16 v[144:159], v[44:47], v[36:39], v[144:159]
    v_dot2c_f32_bf16 v23, v39, v39
    s_waitcnt lgkmcnt(0)
    v_mfma_f32_32x32x16_bf16 v[64:79], v[48:51], v[56:59], v[64:79]
    v_dot2c_f32_bf16 v20, s27, v52
    v_dot2c_f32_bf16 v22, v52, v52
    v_mfma_f32_32x32x16_bf16 v[96:111], v[48:51], v[60:63], v[96:111]
    ds_read_b128 v[32:35], v8 offset:0
    v_dot2c_f32_bf16 v21, s27, v53
    v_mfma_f32_32x32x16_bf16 v[128:143], v[60:63], v[48:51], v[128:143]
    ds_read_b128 v[36:39], v8 offset:4096
    v_dot2c_f32_bf16 v23, v53, v53
    v_mfma_f32_32x32x16_bf16 v[80:95], v[52:55], v[56:59], v[80:95]
    ds_read_b128 v[40:43], v4 offset:4096
    v_dot2c_f32_bf16 v20, s27, v54
    v_dot2c_f32_bf16 v22, v54, v54
    v_mfma_f32_32x32x16_bf16 v[112:127], v[52:55], v[60:63], v[112:127]
    ds_read_b128 v[44:47], v4 offset:5120
    v_dot2c_f32_bf16 v21, s27, v55
    v_mfma_f32_32x32x16_bf16 v[144:159], v[60:63], v[52:55], v[144:159]
    v_dot2c_f32_bf16 v23, v55, v55
    s_waitcnt lgkmcnt(0)
    v_mfma_f32_32x32x16_bf16 v[64:79], v[32:35], v[40:43], v[64:79]
    v_dot2c_f32_bf16 v20, s27, v36
    v_dot2c_f32_bf16 v22, v36, v36
    v_mfma_f32_32x32x16_bf16 v[96:111], v[32:35], v[44:47], v[96:111]
    ds_read_b128 v[48:51], v9 offset:0
    v_dot2c_f32_bf16 v21, s27, v37
    v_mfma_f32_32x32x16_bf16 v[128:143], v[44:47], v[32:35], v[128:143]
    ds_read_b128 v[52:55], v9 offset:4096
    v_dot2c_f32_bf16 v23, v37, v37
    v_mfma_f32_32x32x16_bf16 v[80:95], v[36:39], v[40:43], v[80:95]
    ds_read_b128 v[56:59], v4 offset:6144
    v_dot2c_f32_bf16 v20, s27, v38
    v_dot2c_f32_bf16 v22, v38, v38
    v_mfma_f32_32x32x16_bf16 v[112:127], v[36:39], v[44:47], v[112:127]
    ds_read_b128 v[60:63], v4 offset:7168
    v_dot2c_f32_bf16 v21, s27, v39
    v_mfma_f32_32x32x16_bf16 v[144:159], v[44:47], v[36:39], v[144:159]
    v_dot2c_f32_bf16 v23, v39, v39
    s_waitcnt vmcnt(8)
    s_barrier
    s_lshl_b32 s28, s13, 12
    s_add_u32 s28, s28, 98304
    s_mov_b32 m0, s28
    s_add_u32 s29, s24, 896
    buffer_load_dwordx4 v2, s[16:19], s29 offen offset:0 lds
    s_add_u32 s29, s29, 9216
    buffer_load_dwordx4 v3, s[16:19], s29 offen offset:1024 lds
    s_add_u32 s29, s29, 9216
    buffer_load_dwordx4 v2, s[16:19], s29 offen offset:2048 lds
    s_add_u32 s29, s29, 9216
    buffer_load_dwordx4 v3, s[16:19], s29 offen offset:3072 lds
    s_add_u32 s28, s28, 16384
    s_mov_b32 m0, s28
    s_add_u32 s29, s25, 57344
    buffer_load_dwordx4 v1, s[8:11], s29 offen offset:0 lds
    buffer_load_dwordx4 v1, s[8:11], s29 offen offset:1024 lds
    buffer_load_dwordx4 v1, s[8:11], s29 offen offset:2048 lds
    buffer_load_dwordx4 v1, s[8:11], s29 offen offset:3072 lds
    s_waitcnt lgkmcnt(0)
    v_mfma_f32_32x32x16_bf16 v[64:79], v[48:51], v[56:59], v[64:79]
    v_dot2c_f32_bf16 v20, s27, v52
    v_dot2c_f32_bf16 v22, v52, v52
    v_mfma_f32_32x32x16_bf16 v[96:111], v[48:51], v[60:63], v[96:111]
    ds_read_b128 v[32:35], v6 offset:32768
    v_dot2c_f32_bf16 v21, s27, v53
    v_mfma_f32_32x32x16_bf16 v[128:143], v[60:63], v[48:51], v[128:143]
    ds_read_b128 v[36:39], v6 offset:36864
    v_dot2c_f32_bf16 v23, v53, v53
    v_mfma_f32_32x32x16_bf16 v[80:95], v[52:55], v[56:59], v[80:95]
    ds_read_b128 v[40:43], v4 offset:32768
    v_dot2c_f32_bf16 v20, s27, v54
    v_dot2c_f32_bf16 v22, v54, v54
    v_mfma_f32_32x32x16_bf16 v[112:127], v[52:55], v[60:63], v[112:127]
    ds_read_b128 v[44:47], v4 offset:33792
    v_dot2c_f32_bf16 v21, s27, v55
    v_mfma_f32_32x32x16_bf16 v[144:159], v[60:63], v[52:55], v[144:159]
    v_dot2c_f32_bf16 v23, v55, v55
    s_waitcnt lgkmcnt(0)
    v_mfma_f32_32x32x16_bf16 v[64:79], v[32:35], v[40:43], v[64:79]
    v_dot2c_f32_bf16 v20, s27, v36
    v_dot2c_f32_bf16 v22, v36, v36
    v_mfma_f32_32x32x16_bf16 v[96:111], v[32:35], v[44:47], v[96:111]
    ds_read_b128 v[48:51], v7 offset:32768
    v_dot2c_f32_bf16 v21, s27, v37
    v_mfma_f32_32x32x16_bf16 v[128:143], v[44:47], v[32:35], v[128:143]
    ds_read_b128 v[52:55], v7 offset:36864
    v_dot2c_f32_bf16 v23, v37, v37
    v_mfma_f32_32x32x16_bf16 v[80:95], v[36:39], v[40:43], v[80:95]
    ds_read_b128 v[56:59], v4 offset:34816
    v_dot2c_f32_bf16 v20, s27, v38
    v_dot2c_f32_bf16 v22, v38, v38
    v_mfma_f32_32x32x16_bf16 v[112:127], v[36:39], v[44:47], v[112:127]
    ds_read_b128 v[60:63], v4 offset:35840
    v_dot2c_f32_bf16 v21, s27, v39
    v_mfma_f32_32x32x16_bf16 v[144:159], v[44:47], v[36:39], v[144:159]
    v_dot2c_f32_bf16 v23, v39, v39
    s_waitcnt lgkmcnt(0)
    v_mfma_f32_32x32x16_bf16 v[64:79], v[48:51], v[56:59], v[64:79]
    v_dot2c_f32_bf16 v20, s27, v52
    v_dot2c_f32_bf16 v22, v52, v52
    v_mfma_f32_32x32x16_bf16 v[96:111], v[48:51], v[60:63], v[96:111]
    ds_read_b128 v[32:35], v8 offset:32768
    v_dot2c_f32_bf16 v21, s27, v53
    v_mfma_f32_32x32x16_bf16 v[128:143], v[60:63], v[48:51], v[128:143]
    ds_read_b128 v[36:39], v8 offset:36864
    v_dot2c_f32_bf16 v23, v53, v53
    v_mfma_f32_32x32x16_bf16 v[80:95], v[52:55], v[56:59], v[80:95]
    ds_read_b128 v[40:43], v4 offset:36864
    v_dot2c_f32_bf16 v20, s27, v54
    v_dot2c_f32_bf16 v22, v54, v54
    v_mfma_f32_32x32x16_bf16 v[112:127], v[52:55], v[60:63], v[112:127]
    ds_read_b128 v[44:47], v4 offset:37888
    v_dot2c_f32_bf16 v21, s27, v55
    v_mfma_f32_32x32x16_bf16 v[144:159], v[60:63], v[52:55], v[144:159]
    v_dot2c_f32_bf16 v23, v55, v55
    s_waitcnt lgkmcnt(0)
    v_mfma_f32_32x32x16_bf16 v[64:79], v[32:35], v[40:43], v[64:79]
    v_dot2c_f32_bf16 v20, s27, v36
    v_dot2c_f32_bf16 v22, v36, v36
    v_mfma_f32_32x32x16_bf16 v[96:111], v[32:35], v[44:47], v[96:111]
    ds_read_b128 v[48:51], v9 offset:32768
    v_dot2c_f32_bf16 v21, s27, v37
    v_mfma_f32_32x32x16_bf16 v[128:143], v[44:47], v[32:35], v[128:143]
    ds_read_b128 v[52:55], v9 offset:36864
    v_dot2c_f32_bf16 v23, v37, v37
    v_mfma_f32_32x32x16_bf16 v[80:95], v[36:39], v[40:43], v[80:95]
    ds_read_b128 v[56:59], v4 offset:38912
    v_dot2c_f32_bf16 v20, s27, v38
    v_dot2c_f32_bf16 v22, v38, v38
    v_mfma_f32_32x32x16_bf16 v[112:127], v[36:39], v[44:47], v[112:127]
    ds_read_b128 v[60:63], v4 offset:39936
    v_dot2c_f32_bf16 v21, s27, v39
    v_mfma_f32_32x32x16_bf16 v[144:159], v[44:47], v[36:39], v[144:159]
    v_dot2c_f32_bf16 v23, v39, v39
    s_waitcnt vmcnt(8)
    s_barrier
    s_lshl_b32 s28, s13, 12
    s_mov_b32 m0, s28
    s_add_u32 s29, s24, 1024
    buffer_load_dwordx4 v2, s[16:19], s29 offen offset:0 lds
    s_add_u32 s29, s29, 9216
    buffer_load_dwordx4 v3, s[16:19], s29 offen offset:1024 lds
    s_add_u32 s29, s29, 9216
    buffer_load_dwordx4 v2, s[16:19], s29 offen offset:2048 lds
    s_add_u32 s29, s29, 9216
    buffer_load_dwordx4 v3, s[16:19], s29 offen offset:3072 lds
    s_add_u32 s28, s28, 16384
    s_mov_b32 m0, s28
    s_add_u32 s29, s25, 65536
    buffer_load_dwordx4 v1, s[8:11], s29 offen offset:0 lds
    buffer_load_dwordx4 v1, s[8:11], s29 offen offset:1024 lds
    buffer_load_dwordx4 v1, s[8:11], s29 offen offset:2048 lds
    buffer_load_dwordx4 v1, s[8:11], s29 offen offset:3072 lds
    s_waitcnt lgkmcnt(0)
    v_mfma_f32_32x32x16_bf16 v[64:79], v[48:51], v[56:59], v[64:79]
    v_dot2c_f32_bf16 v20, s27, v52
    v_dot2c_f32_bf16 v22, v52, v52
    v_mfma_f32_32x32x16_bf16 v[96:111], v[48:51], v[60:63], v[96:111]
    ds_read_b128 v[32:35], v10 offset:0
    v_dot2c_f32_bf16 v21, s27, v53
    v_mfma_f32_32x32x16_bf16 v[128:143], v[60:63], v[48:51], v[128:143]
    ds_read_b128 v[36:39], v10 offset:4096
    v_dot2c_f32_bf16 v23, v53, v53
    v_mfma_f32_32x32x16_bf16 v[80:95], v[52:55], v[56:59], v[80:95]
    ds_read_b128 v[40:43], v5 offset:0
    v_dot2c_f32_bf16 v20, s27, v54
    v_dot2c_f32_bf16 v22, v54, v54
    v_mfma_f32_32x32x16_bf16 v[112:127], v[52:55], v[60:63], v[112:127]
    ds_read_b128 v[44:47], v5 offset:1024
    v_dot2c_f32_bf16 v21, s27, v55
    v_mfma_f32_32x32x16_bf16 v[144:159], v[60:63], v[52:55], v[144:159]
    v_dot2c_f32_bf16 v23, v55, v55
    s_waitcnt lgkmcnt(0)
    v_mfma_f32_32x32x16_bf16 v[64:79], v[32:35], v[40:43], v[64:79]
    v_dot2c_f32_bf16 v20, s27, v36
    v_dot2c_f32_bf16 v22, v36, v36
    v_mfma_f32_32x32x16_bf16 v[96:111], v[32:35], v[44:47], v[96:111]
    ds_read_b128 v[48:51], v11 offset:0
    v_dot2c_f32_bf16 v21, s27, v37
    v_mfma_f32_32x32x16_bf16 v[128:143], v[44:47], v[32:35], v[128:143]
    ds_read_b128 v[52:55], v11 offset:4096
    v_dot2c_f32_bf16 v23, v37, v37
    v_mfma_f32_32x32x16_bf16 v[80:95], v[36:39], v[40:43], v[80:95]
    ds_read_b128 v[56:59], v5 offset:2048
    v_dot2c_f32_bf16 v20, s27, v38
    v_dot2c_f32_bf16 v22, v38, v38
    v_mfma_f32_32x32x16_bf16 v[112:127], v[36:39], v[44:47], v[112:127]
    ds_read_b128 v[60:63], v5 offset:3072
    v_dot2c_f32_bf16 v21, s27, v39
    v_mfma_f32_32x32x16_bf16 v[144:159], v[44:47], v[36:39], v[144:159]
    v_dot2c_f32_bf16 v23, v39, v39
    s_waitcnt lgkmcnt(0)
    v_mfma_f32_32x32x16_bf16 v[64:79], v[48:51], v[56:59], v[64:79]
    v_dot2c_f32_bf16 v20, s27, v52
    v_dot2c_f32_bf16 v22, v52, v52
    v_mfma_f32_32x32x16_bf16 v[96:111], v[48:51], v[60:63], v[96:111]
    ds_read_b128 v[32:35], v12 offset:0
    v_dot2c_f32_bf16 v21, s27, v53
    v_mfma_f32_32x32x16_bf16 v[128:143], v[60:63], v[48:51], v[128:143]
    ds_read_b128 v[36:39], v12 offset:4096
    v_dot2c_f32_bf16 v23, v53, v53
    v_mfma_f32_32x32x16_bf16 v[80:95], v[52:55], v[56:59], v[80:95]
    ds_read_b128 v[40:43], v5 offset:4096
    v_dot2c_f32_bf16 v20, s27, v54
    v_dot2c_f32_bf16 v22, v54, v54
    v_mfma_f32_32x32x16_bf16 v[112:127], v[52:55], v[60:63], v[112:127]
    ds_read_b128 v[44:47], v5 offset:5120
    v_dot2c_f32_bf16 v21, s27, v55
    v_mfma_f32_32x32x16_bf16 v[144:159], v[60:63], v[52:55], v[144:159]
    v_dot2c_f32_bf16 v23, v55, v55
    s_waitcnt lgkmcnt(0)
    v_mfma_f32_32x32x16_bf16 v[64:79], v[32:35], v[40:43], v[64:79]
    v_dot2c_f32_bf16 v20, s27, v36
    v_dot2c_f32_bf16 v22, v36, v36
    v_mfma_f32_32x32x16_bf16 v[96:111], v[32:35], v[44:47], v[96:111]
    ds_read_b128 v[48:51], v13 offset:0
    v_dot2c_f32_bf16 v21, s27, v37
    v_mfma_f32_32x32x16_bf16 v[128:143], v[44:47], v[32:35], v[128:143]
    ds_read_b128 v[52:55], v13 offset:4096
    v_dot2c_f32_bf16 v23, v37, v37
    v_mfma_f32_32x32x16_bf16 v[80:95], v[36:39], v[40:43], v[80:95]
    ds_read_b128 v[56:59], v5 offset:6144
    v_dot2c_f32_bf16 v20, s27, v38
    v_dot2c_f32_bf16 v22, v38, v38
    v_mfma_f32_32x32x16_bf16 v[112:127], v[36:39], v[44:47], v[112:127]
    ds_read_b128 v[60:63], v5 offset:7168
    v_dot2c_f32_bf16 v21, s27, v39
    v_mfma_f32_32x32x16_bf16 v[144:159], v[44:47], v[36:39], v[144:159]
    v_dot2c_f32_bf16 v23, v39, v39
    s_waitcnt vmcnt(8)
    s_barrier
    s_lshl_b32 s28, s13, 12
    s_add_u32 s28, s28, 32768
    s_mov_b32 m0, s28
    s_add_u32 s29, s24, 1152
    buffer_load_dwordx4 v2, s[16:19], s29 offen offset:0 lds
    s_add_u32 s29, s29, 9216
    buffer_load_dwordx4 v3, s[16:19], s29 offen offset:1024 lds
    s_add_u32 s29, s29, 9216
    buffer_load_dwordx4 v2, s[16:19], s29 offen offset:2048 lds
    s_add_u32 s29, s29, 9216
    buffer_load_dwordx4 v3, s[16:19], s29 offen offset:3072 lds
    s_add_u32 s28, s28, 16384
    s_mov_b32 m0, s28
    s_add_u32 s29, s25, 73728
    buffer_load_dwordx4 v1, s[8:11], s29 offen offset:0 lds
    buffer_load_dwordx4 v1, s[8:11], s29 offen offset:1024 lds
    buffer_load_dwordx4 v1, s[8:11], s29 offen offset:2048 lds
    buffer_load_dwordx4 v1, s[8:11], s29 offen offset:3072 lds
    s_waitcnt lgkmcnt(0)
    v_mfma_f32_32x32x16_bf16 v[64:79], v[48:51], v[56:59], v[64:79]
    v_dot2c_f32_bf16 v20, s27, v52
    v_dot2c_f32_bf16 v22, v52, v52
    v_mfma_f32_32x32x16_bf16 v[96:111], v[48:51], v[60:63], v[96:111]
    ds_read_b128 v[32:35], v10 offset:32768
    v_dot2c_f32_bf16 v21, s27, v53
    v_mfma_f32_32x32x16_bf16 v[128:143], v[60:63], v[48:51], v[128:143]
    ds_read_b128 v[36:39], v10 offset:36864
    v_dot2c_f32_bf16 v23, v53, v53
    v_mfma_f32_32x32x16_bf16 v[80:95], v[52:55], v[56:59], v[80:95]
    ds_read_b128 v[40:43], v5 offset:32768
    v_dot2c_f32_bf16 v20, s27, v54
    v_dot2c_f32_bf16 v22, v54, v54
    v_mfma_f32_32x32x16_bf16 v[112:127], v[52:55], v[60:63], v[112:127]
    ds_read_b128 v[44:47], v5 offset:33792
    v_dot2c_f32_bf16 v21, s27, v55
    v_mfma_f32_32x32x16_bf16 v[144:159], v[60:63], v[52:55], v[144:159]
    v_dot2c_f32_bf16 v23, v55, v55
    s_waitcnt lgkmcnt(0)
    v_mfma_f32_32x32x16_bf16 v[64:79], v[32:35], v[40:43], v[64:79]
    v_dot2c_f32_bf16 v20, s27, v36
    v_dot2c_f32_bf16 v22, v36, v36
    v_mfma_f32_32x32x16_bf16 v[96:111], v[32:35], v[44:47], v[96:111]
    ds_read_b128 v[48:51], v11 offset:32768
    v_dot2c_f32_bf16 v21, s27, v37
    v_mfma_f32_32x32x16_bf16 v[128:143], v[44:47], v[32:35], v[128:143]
    ds_read_b128 v[52:55], v11 offset:36864
    v_dot2c_f32_bf16 v23, v37, v37
    v_mfma_f32_32x32x16_bf16 v[80:95], v[36:39], v[40:43], v[80:95]
    ds_read_b128 v[56:59], v5 offset:34816
    v_dot2c_f32_bf16 v20, s27, v38
    v_dot2c_f32_bf16 v22, v38, v38
    v_mfma_f32_32x32x16_bf16 v[112:127], v[36:39], v[44:47], v[112:127]
    ds_read_b128 v[60:63], v5 offset:35840
    v_dot2c_f32_bf16 v21, s27, v39
    v_mfma_f32_32x32x16_bf16 v[144:159], v[44:47], v[36:39], v[144:159]
    v_dot2c_f32_bf16 v23, v39, v39
    s_waitcnt lgkmcnt(0)
    v_mfma_f32_32x32x16_bf16 v[64:79], v[48:51], v[56:59], v[64:79]
    v_dot2c_f32_bf16 v20, s27, v52
    v_dot2c_f32_bf16 v22, v52, v52
    v_mfma_f32_32x32x16_bf16 v[96:111], v[48:51], v[60:63], v[96:111]
    ds_read_b128 v[32:35], v12 offset:32768
    v_dot2c_f32_bf16 v21, s27, v53
    v_mfma_f32_32x32x16_bf16 v[128:143], v[60:63], v[48:51], v[128:143]
    ds_read_b128 v[36:39], v12 offset:36864
    v_dot2c_f32_bf16 v23, v53, v53
    v_mfma_f32_32x32x16_bf16 v[80:95], v[52:55], v[56:59], v[80:95]
    ds_read_b128 v[40:43], v5 offset:36864
    v_dot2c_f32_bf16 v20, s27, v54
    v_dot2c_f32_bf16 v22, v54, v54
    v_mfma_f32_32x32x16_bf16 v[112:127], v[52:55], v[60:63], v[112:127]
    ds_read_b128 v[44:47], v5 offset:37888
    v_dot2c_f32_bf16 v21, s27, v55
    v_mfma_f32_32x32x16_bf16 v[144:159], v[60:63], v[52:55], v[144:159]
    v_dot2c_f32_bf16 v23, v55, v55
    s_waitcnt lgkmcnt(0)
    v_mfma_f32_32x32x16_bf16 v[64:79], v[32:35], v[40:43], v[64:79]
    v_dot2c_f32_bf16 v20, s27, v36
    v_dot2c_f32_bf16 v22, v36, v36
    v_mfma_f32_32x32x16_bf16 v[96:111], v[32:35], v[44:47], v[96:111]
    ds_read_b128 v[48:51], v13 offset:32768
    v_dot2c_f32_bf16 v21, s27, v37
    v_mfma_f32_32x32x16_bf16 v[128:143], v[44:47], v[32:35], v[128:143]
    ds_read_b128 v[52:55], v13 offset:36864
    v_dot2c_f32_bf16 v23, v37, v37
    v_mfma_f32_32x32x16_bf16 v[80:95], v[36:39], v[40:43], v[80:95]
    ds_read_b128 v[56:59], v5 offset:38912
    v_dot2c_f32_bf16 v20, s27, v38
    v_dot2c_f32_bf16 v22, v38, v38
    v_mfma_f32_32x32x16_bf16 v[112:127], v[36:39], v[44:47], v[112:127]
    ds_read_b128 v[60:63], v5 offset:39936
    v_dot2c_f32_bf16 v21, s27, v39
    v_mfma_f32_32x32x16_bf16 v[144:159], v[44:47], v[36:39], v[144:159]
    v_dot2c_f32_bf16 v23, v39, v39
    s_waitcnt vmcnt(8)
    s_barrier
    s_waitcnt lgkmcnt(0)
    v_mfma_f32_32x32x16_bf16 v[64:79], v[48:51], v[56:59], v[64:79]
    v_dot2c_f32_bf16 v20, s27, v52
    v_dot2c_f32_bf16 v22, v52, v52
    v_mfma_f32_32x32x16_bf16 v[96:111], v[48:51], v[60:63], v[96:111]
    ds_read_b128 v[32:35], v6 offset:0
    v_dot2c_f32_bf16 v21, s27, v53
    v_mfma_f32_32x32x16_bf16 v[128:143], v[60:63], v[48:51], v[128:143]
    ds_read_b128 v[36:39], v6 offset:4096
    v_dot2c_f32_bf16 v23, v53, v53
    v_mfma_f32_32x32x16_bf16 v[80:95], v[52:55], v[56:59], v[80:95]
    ds_read_b128 v[40:43], v4 offset:0
    v_dot2c_f32_bf16 v20, s27, v54
    v_dot2c_f32_bf16 v22, v54, v54
    v_mfma_f32_32x32x16_bf16 v[112:127], v[52:55], v[60:63], v[112:127]
    ds_read_b128 v[44:47], v4 offset:1024
    v_dot2c_f32_bf16 v21, s27, v55
    v_mfma_f32_32x32x16_bf16 v[144:159], v[60:63], v[52:55], v[144:159]
    v_dot2c_f32_bf16 v23, v55, v55
    s_waitcnt lgkmcnt(0)
    v_mfma_f32_32x32x16_bf16 v[64:79], v[32:35], v[40:43], v[64:79]
    v_dot2c_f32_bf16 v20, s27, v36
    v_dot2c_f32_bf16 v22, v36, v36
    v_mfma_f32_32x32x16_bf16 v[96:111], v[32:35], v[44:47], v[96:111]
    ds_read_b128 v[48:51], v7 offset:0
    v_dot2c_f32_bf16 v21, s27, v37
    v_mfma_f32_32x32x16_bf16 v[128:143], v[44:47], v[32:35], v[128:143]
    ds_read_b128 v[52:55], v7 offset:4096
    v_dot2c_f32_bf16 v23, v37, v37
    v_mfma_f32_32x32x16_bf16 v[80:95], v[36:39], v[40:43], v[80:95]
    ds_read_b128 v[56:59], v4 offset:2048
    v_dot2c_f32_bf16 v20, s27, v38
    v_dot2c_f32_bf16 v22, v38, v38
    v_mfma_f32_32x32x16_bf16 v[112:127], v[36:39], v[44:47], v[112:127]
    ds_read_b128 v[60:63], v4 offset:3072
    v_dot2c_f32_bf16 v21, s27, v39
    v_mfma_f32_32x32x16_bf16 v[144:159], v[44:47], v[36:39], v[144:159]
    v_dot2c_f32_bf16 v23, v39, v39
    s_waitcnt lgkmcnt(0)
    v_mfma_f32_32x32x16_bf16 v[64:79], v[48:51], v[56:59], v[64:79]
    v_dot2c_f32_bf16 v20, s27, v52
    v_dot2c_f32_bf16 v22, v52, v52
    v_mfma_f32_32x32x16_bf16 v[96:111], v[48:51], v[60:63], v[96:111]
    ds_read_b128 v[32:35], v8 offset:0
    v_dot2c_f32_bf16 v21, s27, v53
    v_mfma_f32_32x32x16_bf16 v[128:143], v[60:63], v[48:51], v[128:143]
    ds_read_b128 v[36:39], v8 offset:4096
    v_dot2c_f32_bf16 v23, v53, v53
    v_mfma_f32_32x32x16_bf16 v[80:95], v[52:55], v[56:59], v[80:95]
    ds_read_b128 v[40:43], v4 offset:4096
    v_dot2c_f32_bf16 v20, s27, v54
    v_dot2c_f32_bf16 v22, v54, v54
    v_mfma_f32_32x32x16_bf16 v[112:127], v[52:55], v[60:63], v[112:127]
    ds_read_b128 v[44:47], v4 offset:5120
    v_dot2c_f32_bf16 v21, s27, v55
    v_mfma_f32_32x32x16_bf16 v[144:159], v[60:63], v[52:55], v[144:159]
    v_dot2c_f32_bf16 v23, v55, v55
    s_waitcnt lgkmcnt(0)
    v_mfma_f32_32x32x16_bf16 v[64:79], v[32:35], v[40:43], v[64:79]
    v_dot2c_f32_bf16 v20, s27, v36
    v_dot2c_f32_bf16 v22, v36, v36
    v_mfma_f32_32x32x16_bf16 v[96:111], v[32:35], v[44:47], v[96:111]
    ds_read_b128 v[48:51], v9 offset:0
    v_dot2c_f32_bf16 v21, s27, v37
    v_mfma_f32_32x32x16_bf16 v[128:143], v[44:47], v[32:35], v[128:143]
    ds_read_b128 v[52:55], v9 offset:4096
    v_dot2c_f32_bf16 v23, v37, v37
    v_mfma_f32_32x32x16_bf16 v[80:95], v[36:39], v[40:43], v[80:95]
    ds_read_b128 v[56:59], v4 offset:6144
    v_dot2c_f32_bf16 v20, s27, v38
    v_dot2c_f32_bf16 v22, v38, v38
    v_mfma_f32_32x32x16_bf16 v[112:127], v[36:39], v[44:47], v[112:127]
    ds_read_b128 v[60:63], v4 offset:7168
    v_dot2c_f32_bf16 v21, s27, v39
    v_mfma_f32_32x32x16_bf16 v[144:159], v[44:47], v[36:39], v[144:159]
    v_dot2c_f32_bf16 v23, v39, v39
    s_waitcnt vmcnt(0)
    s_barrier
    s_waitcnt lgkmcnt(0)
    v_mfma_f32_32x32x16_bf16 v[64:79], v[48:51], v[56:59], v[64:79]
    v_dot2c_f32_bf16 v20, s27, v52
    v_dot2c_f32_bf16 v22, v52, v52
    v_mfma_f32_32x32x16_bf16 v[96:111], v[48:51], v[60:63], v[96:111]
    ds_read_b128 v[32:35], v6 offset:32768
    v_dot2c_f32_bf16 v21, s27, v53
    v_mfma_f32_32x32x16_bf16 v[128:143], v[60:63], v[48:51], v[128:143]
    ds_read_b128 v[36:39], v6 offset:36864
    v_dot2c_f32_bf16 v23, v53, v53
    v_mfma_f32_32x32x16_bf16 v[80:95], v[52:55], v[56:59], v[80:95]
    ds_read_b128 v[40:43], v4 offset:32768
    v_dot2c_f32_bf16 v20, s27, v54
    v_dot2c_f32_bf16 v22, v54, v54
    v_mfma_f32_32x32x16_bf16 v[112:127], v[52:55], v[60:63], v[112:127]
    ds_read_b128 v[44:47], v4 offset:33792
    v_dot2c_f32_bf16 v21, s27, v55
    v_mfma_f32_32x32x16_bf16 v[144:159], v[60:63], v[52:55], v[144:159]
    v_dot2c_f32_bf16 v23, v55, v55
    s_waitcnt lgkmcnt(0)
    v_mfma_f32_32x32x16_bf16 v[64:79], v[32:35], v[40:43], v[64:79]
    v_dot2c_f32_bf16 v20, s27, v36
    v_dot2c_f32_bf16 v22, v36, v36
    v_mfma_f32_32x32x16_bf16 v[96:111], v[32:35], v[44:47], v[96:111]
    ds_read_b128 v[48:51], v7 offset:32768
    v_dot2c_f32_bf16 v21, s27, v37
    v_mfma_f32_32x32x16_bf16 v[128:143], v[44:47], v[32:35], v[128:143]
    ds_read_b128 v[52:55], v7 offset:36864
    v_dot2c_f32_bf16 v23, v37, v37
    v_mfma_f32_32x32x16_bf16 v[80:95], v[36:39], v[40:43], v[80:95]
    ds_read_b128 v[56:59], v4 offset:34816
    v_dot2c_f32_bf16 v20, s27, v38
    v_dot2c_f32_bf16 v22, v38, v38
    v_mfma_f32_32x32x16_bf16 v[112:127], v[36:39], v[44:47], v[112:127]
    ds_read_b128 v[60:63], v4 offset:35840
    v_dot2c_f32_bf16 v21, s27, v39
    v_mfma_f32_32x32x16_bf16 v[144:159], v[44:47], v[36:39], v[144:159]
    v_dot2c_f32_bf16 v23, v39, v39
    s_waitcnt lgkmcnt(0)
    v_mfma_f32_32x32x16_bf16 v[64:79], v[48:51], v[56:59], v[64:79]
    v_dot2c_f32_bf16 v20, s27, v52
    v_dot2c_f32_bf16 v22, v52, v52
    v_mfma_f32_32x32x16_bf16 v[96:111], v[48:51], v[60:63], v[96:111]
    ds_read_b128 v[32:35], v8 offset:32768
    v_dot2c_f32_bf16 v21, s27, v53
    v_mfma_f32_32x32x16_bf16 v[128:143], v[60:63], v[48:51], v[128:143]
    ds_read_b128 v[36:39], v8 offset:36864
    v_dot2c_f32_bf16 v23, v53, v53
    v_mfma_f32_32x32x16_bf16 v[80:95], v[52:55], v[56:59], v[80:95]
    ds_read_b128 v[40:43], v4 offset:36864
    v_dot2c_f32_bf16 v20, s27, v54
    v_dot2c_f32_bf16 v22, v54, v54
    v_mfma_f32_32x32x16_bf16 v[112:127], v[52:55], v[60:63], v[112:127]
    ds_read_b128 v[44:47], v4 offset:37888
    v_dot2c_f32_bf16 v21, s27, v55
    v_mfma_f32_32x32x16_bf16 v[144:159], v[60:63], v[52:55], v[144:159]
    v_dot2c_f32_bf16 v23, v55, v55
    s_waitcnt lgkmcnt(0)
    v_mfma_f32_32x32x16_bf16 v[64:79], v[32:35], v[40:43], v[64:79]
    v_dot2c_f32_bf16 v20, s27, v36
    v_dot2c_f32_bf16 v22, v36, v36
    v_mfma_f32_32x32x16_bf16 v[96:111], v[32:35], v[44:47], v[96:111]
    ds_read_b128 v[48:51], v9 offset:32768
    v_dot2c_f32_bf16 v21, s27, v37
    v_mfma_f32_32x32x16_bf16 v[128:143], v[44:47], v[32:35], v[128:143]
    ds_read_b128 v[52:55], v9 offset:36864
    v_dot2c_f32_bf16 v23, v37, v37
    v_mfma_f32_32x32x16_bf16 v[80:95], v[36:39], v[40:43], v[80:95]
    ds_read_b128 v[56:59], v4 offset:38912
    v_dot2c_f32_bf16 v20, s27, v38
    v_dot2c_f32_bf16 v22, v38, v38
    v_mfma_f32_32x32x16_bf16 v[112:127], v[36:39], v[44:47], v[112:127]
    ds_read_b128 v[60:63], v4 offset:39936
    v_dot2c_f32_bf16 v21, s27, v39
    v_mfma_f32_32x32x16_bf16 v[144:159], v[44:47], v[36:39], v[144:159]
    v_dot2c_f32_bf16 v23, v39, v39
    s_waitcnt lgkmcnt(0)
    v_mfma_f32_32x32x16_bf16 v[64:79], v[48:51], v[56:59], v[64:79]
    v_dot2c_f32_bf16 v20, s27, v52
    v_dot2c_f32_bf16 v22, v52, v52
    v_mfma_f32_32x32x16_bf16 v[96:111], v[48:51], v[60:63], v[96:111]
    v_dot2c_f32_bf16 v21, s27, v53
    v_mfma_f32_32x32x16_bf16 v[128:143], v[60:63], v[48:51], v[128:143]
    v_dot2c_f32_bf16 v23, v53, v53
    v_mfma_f32_32x32x16_bf16 v[80:95], v[52:55], v[56:59], v[80:95]
    v_dot2c_f32_bf16 v20, s27, v54
    v_dot2c_f32_bf16 v22, v54, v54
    v_mfma_f32_32x32x16_bf16 v[112:127], v[52:55], v[60:63], v[112:127]
    v_dot2c_f32_bf16 v21, s27, v55
    v_mfma_f32_32x32x16_bf16 v[144:159], v[60:63], v[52:55], v[144:159]
    v_dot2c_f32_bf16 v23, v55, v55
afront1_kernel_af_epi:
    v_add_f32 v20, v20, v21
    v_add_f32 v22, v22, v23
    v_mov_b32 v21, v20
    v_mov_b32 v23, v22
    s_nop 1
    v_permlane32_swap_b32 v20, v21
    v_permlane32_swap_b32 v22, v23
    v_add_f32 v20, v20, v21
    v_add_f32 v22, v22, v23
    v_mul_f32 v20, 0x3acccccd, v20
    v_mul_f32 v21, v20, v20
    v_mul_f32 v22, 0x3acccccd, v22
    v_sub_f32 v22, v22, v21
    v_max_f32 v22, 0, v22
    v_add_f32 v22, 0x3727c5ac, v22
    v_rsq_f32 v22, v22
    v_and_b32 v16, 31, v0
    s_lshl_b32 s28, s13, 7
    s_add_u32 s28, s28, 65536
    v_lshl_add_u32 v17, v16, 2, s28
    ds_write_b32 v17, v22
    s_waitcnt lgkmcnt(0)
    s_barrier
    s_lshl_b32 s28, s22, 8
    s_add_u32 s28, s28, 65536
    v_lshl_add_u32 v17, v16, 2, s28
    v_lshrrev_b32 v18, 5, v0
    v_lshlrev_b32 v18, 4, v18
    v_add_u32 v18, s28, v18
    ds_read_b32 v224, v17 offset:0
    ds_read_b128 v[192:195], v18 offset:0
    ds_read_b128 v[196:199], v18 offset:32
    ds_read_b128 v[200:203], v18 offset:64
    ds_read_b128 v[204:207], v18 offset:96
    ds_read_b32 v225, v17 offset:128
    ds_read_b128 v[208:211], v18 offset:128
    ds_read_b128 v[212:215], v18 offset:160
    ds_read_b128 v[216:219], v18 offset:192
    ds_read_b128 v[220:223], v18 offset:224
    v_and_b32 v16, 31, v0
    v_mov_b32 v228, 0x358637bd
    v_cmp_gt_u32 vcc, 20, v16
    s_mov_b64 s[30:31], vcc
    s_nop 0
    v_cndmask_b32 v226, 0, v228, vcc
    v_cmp_eq_u32 vcc, 8, v16
    s_nop 1
    v_cndmask_b32 v227, 0, 1.0, vcc
    s_waitcnt lgkmcnt(0)
    v_fma_f32 v64, v64, v192, v226
    v_mul_f32 v48, 0x3fb8aa3b, v64
    v_exp_f32 v48, v48 clamp
    v_max_f32 v49, v64, v228
    v_fma_f32 v96, v96, v192, v227
    v_add_f32 v48, v48, v49
    v_cndmask_b32 v64, v64, v48, s[30:31]
    v_fma_f32 v65, v65, v193, v226
    v_mul_f32 v50, 0x3fb8aa3b, v65
    v_exp_f32 v50, v50 clamp
    v_max_f32 v51, v65, v228
    v_fma_f32 v97, v97, v193, v227
    v_add_f32 v50, v50, v51
    v_cndmask_b32 v65, v65, v50, s[30:31]
    v_fma_f32 v66, v66, v194, v226
    v_mul_f32 v52, 0x3fb8aa3b, v66
    v_exp_f32 v52, v52 clamp
    v_max_f32 v53, v66, v228
    v_fma_f32 v98, v98, v194, v227
    v_add_f32 v52, v52, v53
    v_cndmask_b32 v66, v66, v52, s[30:31]
    v_fma_f32 v67, v67, v195, v226
    v_mul_f32 v54, 0x3fb8aa3b, v67
    v_exp_f32 v54, v54 clamp
    v_max_f32 v55, v67, v228
    v_fma_f32 v99, v99, v195, v227
    v_add_f32 v54, v54, v55
    v_cndmask_b32 v67, v67, v54, s[30:31]
    v_fma_f32 v68, v68, v196, v226
    v_mul_f32 v48, 0x3fb8aa3b, v68
    v_exp_f32 v48, v48 clamp
    v_max_f32 v49, v68, v228
    v_fma_f32 v100, v100, v196, v227
    v_add_f32 v48, v48, v49
    v_cndmask_b32 v68, v68, v48, s[30:31]
    v_fma_f32 v69, v69, v197, v226
    v_mul_f32 v50, 0x3fb8aa3b, v69
    v_exp_f32 v50, v50 clamp
    v_max_f32 v51, v69, v228
    v_fma_f32 v101, v101, v197, v227
    v_add_f32 v50, v50, v51
    v_cndmask_b32 v69, v69, v50, s[30:31]
    v_fma_f32 v70, v70, v198, v226
    v_mul_f32 v52, 0x3fb8aa3b, v70
    v_exp_f32 v52, v52 clamp
    v_max_f32 v53, v70, v228
    v_fma_f32 v102, v102, v198, v227
    v_add_f32 v52, v52, v53
    v_cndmask_b32 v70, v70, v52, s[30:31]
    v_fma_f32 v71, v71, v199, v226
    v_mul_f32 v54, 0x3fb8aa3b, v71
    v_exp_f32 v54, v54 clamp
    v_max_f32 v55, v71, v228
    v_fma_f32 v103, v103, v199, v227
    v_add_f32 v54, v54, v55
    v_cndmask_b32 v71, v71, v54, s[30:31]
    v_fma_f32 v72, v72, v200, v226
    v_mul_f32 v48, 0x3fb8aa3b, v72
    v_exp_f32 v48, v48 clamp
    v_max_f32 v49, v72, v228
    v_fma_f32 v104, v104, v200, v227
    v_add_f32 v48, v48, v49
    v_cndmask_b32 v72, v72, v48, s[30:31]
    v_fma_f32 v73, v73, v201, v226
    v_mul_f32 v50, 0x3fb8aa3b, v73
    v_exp_f32 v50, v50 clamp
    v_max_f32 v51, v73, v228
    v_fma_f32 v105, v105, v201, v227
    v_add_f32 v50, v50, v51
    v_cndmask_b32 v73, v73, v50, s[30:31]
    v_fma_f32 v74, v74, v202, v226
    v_mul_f32 v52, 0x3fb8aa3b, v74
    v_exp_f32 v52, v52 clamp
    v_max_f32 v53, v74, v228
    v_fma_f32 v106, v106, v202, v227
    v_add_f32 v52, v52, v53
    v_cndmask_b32 v74, v74, v52, s[30:31]
    v_fma_f32 v75, v75, v203, v226
    v_mul_f32 v54, 0x3fb8aa3b, v75
    v_exp_f32 v54, v54 clamp
    v_max_f32 v55, v75, v228
    v_fma_f32 v107, v107, v203, v227
    v_add_f32 v54, v54, v55
    v_cndmask_b32 v75, v75, v54, s[30:31]
    v_fma_f32 v76, v76, v204, v226
    v_mul_f32 v48, 0x3fb8aa3b, v76
    v_exp_f32 v48, v48 clamp
    v_max_f32 v49, v76, v228
    v_fma_f32 v108, v108, v204, v227
    v_add_f32 v48, v48, v49
    v_cndmask_b32 v76, v76, v48, s[30:31]
    v_fma_f32 v77, v77, v205, v226
    v_mul_f32 v50, 0x3fb8aa3b, v77
    v_exp_f32 v50, v50 clamp
    v_max_f32 v51, v77, v228
    v_fma_f32 v109, v109, v205, v227
    v_add_f32 v50, v50, v51
    v_cndmask_b32 v77, v77, v50, s[30:31]
    v_fma_f32 v78, v78, v206, v226
    v_mul_f32 v52, 0x3fb8aa3b, v78
    v_exp_f32 v52, v52 clamp
    v_max_f32 v53, v78, v228
    v_fma_f32 v110, v110, v206, v227
    v_add_f32 v52, v52, v53
    v_cndmask_b32 v78, v78, v52, s[30:31]
    v_fma_f32 v79, v79, v207, v226
    v_mul_f32 v54, 0x3fb8aa3b, v79
    v_exp_f32 v54, v54 clamp
    v_max_f32 v55, v79, v228
    v_fma_f32 v111, v111, v207, v227
    v_add_f32 v54, v54, v55
    v_cndmask_b32 v79, v79, v54, s[30:31]
    v_cvt_pk_bf16_f32 v32, v64, v65
    v_cvt_pk_bf16_f32 v40, v96, v97
    v_cvt_pk_bf16_f32 v33, v66, v67
    v_cvt_pk_bf16_f32 v41, v98, v99
    v_cvt_pk_bf16_f32 v34, v68, v69
    v_cvt_pk_bf16_f32 v42, v100, v101
    v_cvt_pk_bf16_f32 v35, v70, v71
    v_cvt_pk_bf16_f32 v43, v102, v103
    v_cvt_pk_bf16_f32 v36, v72, v73
    v_cvt_pk_bf16_f32 v44, v104, v105
    v_cvt_pk_bf16_f32 v37, v74, v75
    v_cvt_pk_bf16_f32 v45, v106, v107
    v_cvt_pk_bf16_f32 v38, v76, v77
    v_cvt_pk_bf16_f32 v46, v108, v109
    v_cvt_pk_bf16_f32 v39, v78, v79
    v_cvt_pk_bf16_f32 v47, v110, v111
    s_nop 1
    v_mfma_f32_32x32x16_bf16 v[160:175], v[32:35], v[32:35], 0
    v_mfma_f32_32x32x16_bf16 v[176:191], v[40:43], v[32:35], 0
    v_mfma_f32_32x32x16_bf16 v[160:175], v[36:39], v[36:39], v[160:175]
    v_mfma_f32_32x32x16_bf16 v[176:191], v[44:47], v[36:39], v[176:191]
    v_fma_f32 v80, v80, v208, v226
    v_mul_f32 v48, 0x3fb8aa3b, v80
    v_exp_f32 v48, v48 clamp
    v_max_f32 v49, v80, v228
    v_fma_f32 v112, v112, v208, v227
    v_add_f32 v48, v48, v49
    v_cndmask_b32 v80, v80, v48, s[30:31]
    v_fma_f32 v81, v81, v209, v226
    v_mul_f32 v50, 0x3fb8aa3b, v81
    v_exp_f32 v50, v50 clamp
    v_max_f32 v51, v81, v228
    v_fma_f32 v113, v113, v209, v227
    v_add_f32 v50, v50, v51
    v_cndmask_b32 v81, v81, v50, s[30:31]
    v_fma_f32 v82, v82, v210, v226
    v_mul_f32 v52, 0x3fb8aa3b, v82
    v_exp_f32 v52, v52 clamp
    v_max_f32 v53, v82, v228
    v_fma_f32 v114, v114, v210, v227
    v_add_f32 v52, v52, v53
    v_cndmask_b32 v82, v82, v52, s[30:31]
    v_fma_f32 v83, v83, v211, v226
    v_mul_f32 v54, 0x3fb8aa3b, v83
    v_exp_f32 v54, v54 clamp
    v_max_f32 v55, v83, v228
    v_fma_f32 v115, v115, v211, v227
    v_add_f32 v54, v54, v55
    v_cndmask_b32 v83, v83, v54, s[30:31]
    v_fma_f32 v84, v84, v212, v226
    v_mul_f32 v48, 0x3fb8aa3b, v84
    v_exp_f32 v48, v48 clamp
    v_max_f32 v49, v84, v228
    v_fma_f32 v116, v116, v212, v227
    v_add_f32 v48, v48, v49
    v_cndmask_b32 v84, v84, v48, s[30:31]
    v_fma_f32 v85, v85, v213, v226
    v_mul_f32 v50, 0x3fb8aa3b, v85
    v_exp_f32 v50, v50 clamp
    v_max_f32 v51, v85, v228
    v_fma_f32 v117, v117, v213, v227
    v_add_f32 v50, v50, v51
    v_cndmask_b32 v85, v85, v50, s[30:31]
    v_fma_f32 v86, v86, v214, v226
    v_mul_f32 v52, 0x3fb8aa3b, v86
    v_exp_f32 v52, v52 clamp
    v_max_f32 v53, v86, v228
    v_fma_f32 v118, v118, v214, v227
    v_add_f32 v52, v52, v53
    v_cndmask_b32 v86, v86, v52, s[30:31]
    v_fma_f32 v87, v87, v215, v226
    v_mul_f32 v54, 0x3fb8aa3b, v87
    v_exp_f32 v54, v54 clamp
    v_max_f32 v55, v87, v228
    v_fma_f32 v119, v119, v215, v227
    v_add_f32 v54, v54, v55
    v_cndmask_b32 v87, v87, v54, s[30:31]
    v_fma_f32 v88, v88, v216, v226
    v_mul_f32 v48, 0x3fb8aa3b, v88
    v_exp_f32 v48, v48 clamp
    v_max_f32 v49, v88, v228
    v_fma_f32 v120, v120, v216, v227
    v_add_f32 v48, v48, v49
    v_cndmask_b32 v88, v88, v48, s[30:31]
    v_fma_f32 v89, v89, v217, v226
    v_mul_f32 v50, 0x3fb8aa3b, v89
    v_exp_f32 v50, v50 clamp
    v_max_f32 v51, v89, v228
    v_fma_f32 v121, v121, v217, v227
    v_add_f32 v50, v50, v51
    v_cndmask_b32 v89, v89, v50, s[30:31]
    v_fma_f32 v90, v90, v218, v226
    v_mul_f32 v52, 0x3fb8aa3b, v90
    v_exp_f32 v52, v52 clamp
    v_max_f32 v53, v90, v228
    v_fma_f32 v122, v122, v218, v227
    v_add_f32 v52, v52, v53
    v_cndmask_b32 v90, v90, v52, s[30:31]
    v_fma_f32 v91, v91, v219, v226
    v_mul_f32 v54, 0x3fb8aa3b, v91
    v_exp_f32 v54, v54 clamp
    v_max_f32 v55, v91, v228
    v_fma_f32 v123, v123, v219, v227
    v_add_f32 v54, v54, v55
    v_cndmask_b32 v91, v91, v54, s[30:31]
    v_fma_f32 v92, v92, v220, v226
    v_mul_f32 v48, 0x3fb8aa3b, v92
    v_exp_f32 v48, v48 clamp
    v_max_f32 v49, v92, v228
    v_fma_f32 v124, v124, v220, v227
    v_add_f32 v48, v48, v49
    v_cndmask_b32 v92, v92, v48, s[30:31]
    v_fma_f32 v93, v93, v221, v226
    v_mul_f32 v50, 0x3fb8aa3b, v93
    v_exp_f32 v50, v50 clamp
    v_max_f32 v51, v93, v228
    v_fma_f32 v125, v125, v221, v227
    v_add_f32 v50, v50, v51
    v_cndmask_b32 v93, v93, v50, s[30:31]
    v_fma_f32 v94, v94, v222, v226
    v_mul_f32 v52, 0x3fb8aa3b, v94
    v_exp_f32 v52, v52 clamp
    v_max_f32 v53, v94, v228
    v_fma_f32 v126, v126, v222, v227
    v_add_f32 v52, v52, v53
    v_cndmask_b32 v94, v94, v52, s[30:31]
    v_fma_f32 v95, v95, v223, v226
    v_mul_f32 v54, 0x3fb8aa3b, v95
    v_exp_f32 v54, v54 clamp
    v_max_f32 v55, v95, v228
    v_fma_f32 v127, v127, v223, v227
    v_add_f32 v54, v54, v55
    v_cndmask_b32 v95, v95, v54, s[30:31]
    v_cvt_pk_bf16_f32 v32, v80, v81
    v_cvt_pk_bf16_f32 v40, v112, v113
    v_cvt_pk_bf16_f32 v33, v82, v83
    v_cvt_pk_bf16_f32 v41, v114, v115
    v_cvt_pk_bf16_f32 v34, v84, v85
    v_cvt_pk_bf16_f32 v42, v116, v117
    v_cvt_pk_bf16_f32 v35, v86, v87
    v_cvt_pk_bf16_f32 v43, v118, v119
    v_cvt_pk_bf16_f32 v36, v88, v89
    v_cvt_pk_bf16_f32 v44, v120, v121
    v_cvt_pk_bf16_f32 v37, v90, v91
    v_cvt_pk_bf16_f32 v45, v122, v123
    v_cvt_pk_bf16_f32 v38, v92, v93
    v_cvt_pk_bf16_f32 v46, v124, v125
    v_cvt_pk_bf16_f32 v39, v94, v95
    v_cvt_pk_bf16_f32 v47, v126, v127
    s_nop 1
    v_mfma_f32_32x32x16_bf16 v[160:175], v[32:35], v[32:35], v[160:175]
    v_mfma_f32_32x32x16_bf16 v[176:191], v[40:43], v[32:35], v[176:191]
    v_mfma_f32_32x32x16_bf16 v[160:175], v[36:39], v[36:39], v[160:175]
    v_mfma_f32_32x32x16_bf16 v[176:191], v[44:47], v[36:39], v[176:191]
    v_fma_f32 v132, v132, v224, v228
    v_mul_f32 v48, 0x3fb8aa3b, v132
    v_exp_f32 v48, v48 clamp
    v_max_f32 v49, v132, v228
    v_add_f32 v132, v48, v49
    v_fma_f32 v133, v133, v224, v228
    v_mul_f32 v50, 0x3fb8aa3b, v133
    v_exp_f32 v50, v50 clamp
    v_max_f32 v51, v133, v228
    v_add_f32 v133, v50, v51
    v_fma_f32 v134, v134, v224, v228
    v_mul_f32 v52, 0x3fb8aa3b, v134
    v_exp_f32 v52, v52 clamp
    v_max_f32 v53, v134, v228
    v_add_f32 v134, v52, v53
    v_fma_f32 v135, v135, v224, v228
    v_mul_f32 v54, 0x3fb8aa3b, v135
    v_exp_f32 v54, v54 clamp
    v_max_f32 v55, v135, v228
    v_add_f32 v135, v54, v55
    v_fma_f32 v136, v136, v224, v228
    v_mul_f32 v48, 0x3fb8aa3b, v136
    v_exp_f32 v48, v48 clamp
    v_max_f32 v49, v136, v228
    v_add_f32 v136, v48, v49
    v_fma_f32 v137, v137, v224, v228
    v_mul_f32 v50, 0x3fb8aa3b, v137
    v_exp_f32 v50, v50 clamp
    v_max_f32 v51, v137, v228
    v_add_f32 v137, v50, v51
    v_fma_f32 v138, v138, v224, v228
    v_mul_f32 v52, 0x3fb8aa3b, v138
    v_exp_f32 v52, v52 clamp
    v_max_f32 v53, v138, v228
    v_add_f32 v138, v52, v53
    v_fma_f32 v139, v139, v224, v228
    v_mul_f32 v54, 0x3fb8aa3b, v139
    v_exp_f32 v54, v54 clamp
    v_max_f32 v55, v139, v228
    v_add_f32 v139, v54, v55
    v_fma_f32 v140, v140, v224, v228
    v_mul_f32 v48, 0x3fb8aa3b, v140
    v_exp_f32 v48, v48 clamp
    v_max_f32 v49, v140, v228
    v_add_f32 v140, v48, v49
    v_fma_f32 v141, v141, v224, v228
    v_mul_f32 v50, 0x3fb8aa3b, v141
    v_exp_f32 v50, v50 clamp
    v_max_f32 v51, v141, v228
    v_add_f32 v141, v50, v51
    v_fma_f32 v142, v142, v224, v228
    v_mul_f32 v52, 0x3fb8aa3b, v142
    v_exp_f32 v52, v52 clamp
    v_max_f32 v53, v142, v228
    v_add_f32 v142, v52, v53
    v_fma_f32 v143, v143, v224, v228
    v_mul_f32 v54, 0x3fb8aa3b, v143
    v_exp_f32 v54, v54 clamp
    v_max_f32 v55, v143, v228
    v_add_f32 v143, v54, v55
    v_cvt_pk_bf16_f32 v130, v132, v133
    v_cvt_pk_bf16_f32 v131, v134, v135
    v_cvt_pk_bf16_f32 v132, v136, v137
    v_cvt_pk_bf16_f32 v133, v138, v139
    v_cvt_pk_bf16_f32 v134, v140, v141
    v_cvt_pk_bf16_f32 v135, v142, v143
    v_mov_b32 v128, 0
    v_mov_b32 v129, 0
    s_lshl_b32 s28, s13, 13
    s_add_u32 s28, s28, 66560
    v_add_u32 v17, s28, v1
    ds_write_b128 v17, v[160:163] offset:0
    ds_write_b128 v17, v[164:167] offset:1024
    ds_write_b128 v17, v[168:171] offset:2048
    ds_write_b128 v17, v[172:175] offset:3072
    ds_write_b128 v17, v[176:179] offset:4096
    ds_write_b128 v17, v[180:183] offset:5120
    ds_write_b128 v17, v[184:187] offset:6144
    ds_write_b128 v17, v[188:191] offset:7168
    s_lshl_b32 s28, s13, 6
    v_add_u32 v32, s28, v0
    v_cmp_le_u32 vcc, 105, v32
    s_nop 1
    v_cndmask_b32 v33, 0, 1, vcc
    v_mul_u32_u24 v34, 105, v33
    v_sub_u32 v34, v32, v34
    v_mul_u32_u24 v35, 13108, v34
    v_lshrrev_b32 v35, 16, v35
    v_mul_u32_u24 v36, 5, v35
    v_sub_u32 v36, v34, v36
    v_add_u32 v37, 20, v35
    v_subrev_u32 v38, 12, v35
    v_cmp_gt_u32 vcc, 12, v35
    s_nop 1
    v_cndmask_b32 v37, v38, v37, vcc
    v_cndmask_b32 v38, 1, 0, vcc
    v_lshlrev_b32 v38, 12, v38
    v_lshl_add_u32 v38, v33, 13, v38
    v_lshrrev_b32 v39, 3, v37
    v_lshl_add_u32 v38, v39, 10, v38
    v_bfe_u32 v39, v37, 2, 1
    v_lshlrev_b32 v39, 5, v39
    v_lshl_add_u32 v39, v36, 2, v39
    v_lshl_add_u32 v38, v39, 4, v38
    v_and_b32 v39, 3, v37
    v_lshl_add_u32 v38, v39, 2, v38
    v_min_u32 v38, 16320, v38
    v_add_u32 v38, 66560, v38
    s_waitcnt lgkmcnt(0)
    s_barrier
    ds_read_b32 v40, v38 offset:0
    ds_read_b32 v41, v38 offset:16
    ds_read_b32 v42, v38 offset:32
    ds_read_b32 v43, v38 offset:48
    ds_read_b32 v44, v38 offset:16384
    ds_read_b32 v45, v38 offset:16400
    ds_read_b32 v46, v38 offset:16416
    ds_read_b32 v47, v38 offset:16432
    s_lshl_b32 s28, s20, 4
    s_add_u32 s28, s28, s21
    s_lshl_b32 s28, s28, 12
    s_add_u32 s28, s28, 232783872
    v_lshlrev_b32 v39, 4, v32
    v_cmp_gt_u32 vcc, 210, v32
    s_mov_b64 s[32:33], vcc
    s_waitcnt lgkmcnt(0)
    v_add_f32 v40, v40, v44
    v_add_f32 v41, v41, v45
    v_add_f32 v42, v42, v46
    v_add_f32 v43, v43, v47
    s_mov_b64 exec, s[32:33]
    buffer_store_dwordx4 v[40:43], v39, s[8:11], s28 offen sc1
    s_mov_b64 exec, -1
    v_fma_f32 v148, v148, v225, v228
    v_mul_f32 v48, 0x3fb8aa3b, v148
    v_exp_f32 v48, v48 clamp
    v_max_f32 v49, v148, v228
    v_add_f32 v148, v48, v49
    v_fma_f32 v149, v149, v225, v228
    v_mul_f32 v50, 0x3fb8aa3b, v149
    v_exp_f32 v50, v50 clamp
    v_max_f32 v51, v149, v228
    v_add_f32 v149, v50, v51
    v_fma_f32 v150, v150, v225, v228
    v_mul_f32 v52, 0x3fb8aa3b, v150
    v_exp_f32 v52, v52 clamp
    v_max_f32 v53, v150, v228
    v_add_f32 v150, v52, v53
    v_fma_f32 v151, v151, v225, v228
    v_mul_f32 v54, 0x3fb8aa3b, v151
    v_exp_f32 v54, v54 clamp
    v_max_f32 v55, v151, v228
    v_add_f32 v151, v54, v55
    v_fma_f32 v152, v152, v225, v228
    v_mul_f32 v48, 0x3fb8aa3b, v152
    v_exp_f32 v48, v48 clamp
    v_max_f32 v49, v152, v228
    v_add_f32 v152, v48, v49
    v_fma_f32 v153, v153, v225, v228
    v_mul_f32 v50, 0x3fb8aa3b, v153
    v_exp_f32 v50, v50 clamp
    v_max_f32 v51, v153, v228
    v_add_f32 v153, v50, v51
    v_fma_f32 v154, v154, v225, v228
    v_mul_f32 v52, 0x3fb8aa3b, v154
    v_exp_f32 v52, v52 clamp
    v_max_f32 v53, v154, v228
    v_add_f32 v154, v52, v53
    v_fma_f32 v155, v155, v225, v228
    v_mul_f32 v54, 0x3fb8aa3b, v155
    v_exp_f32 v54, v54 clamp
    v_max_f32 v55, v155, v228
    v_add_f32 v155, v54, v55
    v_fma_f32 v156, v156, v225, v228
    v_mul_f32 v48, 0x3fb8aa3b, v156
    v_exp_f32 v48, v48 clamp
    v_max_f32 v49, v156, v228
    v_add_f32 v156, v48, v49
    v_fma_f32 v157, v157, v225, v228
    v_mul_f32 v50, 0x3fb8aa3b, v157
    v_exp_f32 v50, v50 clamp
    v_max_f32 v51, v157, v228
    v_add_f32 v157, v50, v51
    v_fma_f32 v158, v158, v225, v228
    v_mul_f32 v52, 0x3fb8aa3b, v158
    v_exp_f32 v52, v52 clamp
    v_max_f32 v53, v158, v228
    v_add_f32 v158, v52, v53
    v_fma_f32 v159, v159, v225, v228
    v_mul_f32 v54, 0x3fb8aa3b, v159
    v_exp_f32 v54, v54 clamp
    v_max_f32 v55, v159, v228
    v_add_f32 v159, v54, v55
    v_cvt_pk_bf16_f32 v146, v148, v149
    v_cvt_pk_bf16_f32 v147, v150, v151
    v_cvt_pk_bf16_f32 v148, v152, v153
    v_cvt_pk_bf16_f32 v149, v154, v155
    v_cvt_pk_bf16_f32 v150, v156, v157
    v_cvt_pk_bf16_f32 v151, v158, v159
    v_mov_b32 v144, 0
    v_mov_b32 v145, 0
    s_mul_i32 s29, s26, 5
    v_lshrrev_b32 v17, 5, v0
    v_add_u32 v17, s29, v17
    v_lshrrev_b32 v18, 1, v17
    v_lshlrev_b32 v18, 9, v18
    v_and_b32 v17, 1, v17
    v_lshl_add_u32 v18, v17, 3, v18
    v_and_b32 v16, 31, v0
    v_lshl_add_u32 v14, v16, 4, v18
    v_mul_u32_u24 v15, 80, v16
    v_lshrrev_b32 v17, 5, v0
    v_lshl_add_u32 v15, v17, 4, v15
    s_mul_i32 s29, s23, 1680
    s_add_u32 s29, s29, 48
    v_add_u32 v15, s29, v15
    v_mov_b32 v48, 0
    v_mov_b32 v49, 0
    v_mov_b32 v50, 0
    v_mov_b32 v51, 0
    v_mov_b32 v52, 0
    v_mov_b32 v53, 0
    v_mov_b32 v54, 0
    v_mov_b32 v55, 0
    v_mov_b32 v56, 0
    v_mov_b32 v57, 0
    v_mov_b32 v58, 0
    v_mov_b32 v59, 0
    s_waitcnt vmcnt(0)
    s_barrier
    s_cmp_lg_u32 s13, 0
    s_cbranch_scc1 afront1_kernel_af_go
    s_lshl_b32 s29, s20, 7
    s_add_u32 s29, s29, 10649600
    s_lshl_b32 s30, s21, 2
    v_mov_b32 v16, s30
    v_mov_b32 v17, 1
    s_mov_b64 exec, 1
    buffer_store_dword v17, v16, s[8:11], s29 offen sc1
    s_mov_b64 exec, 0xffff
    v_lshlrev_b32 v16, 2, v0
    s_mov_b32 s31, 400000
afront1_kernel_af_poll:
    buffer_load_dword v17, v16, s[8:11], s29 offen sc1
    s_waitcnt vmcnt(0)
    v_cmp_eq_u32 vcc, 0, v17
    s_sub_u32 s31, s31, 1
    s_cbranch_scc1 afront1_kernel_af_fail
    s_cbranch_vccnz afront1_kernel_af_poll
    s_branch afront1_kernel_af_ok
afront1_kernel_af_fail:
    s_load_dwordx2 s[34:35], s[0:1], 88
    s_waitcnt lgkmcnt(0)
    s_mov_b32 s36, s34
    s_mov_b32 s37, s35
    s_mov_b32 s38, 256
    s_mov_b32 s39, 0x00020000
    s_mov_b64 exec, 1
    v_mov_b32 v16, 0
    v_mov_b32 v17, 0xdead
    buffer_store_dword v17, v16, s[36:39], 0 offen
afront1_kernel_af_ok:
    s_mov_b64 exec, -1
afront1_kernel_af_go:
    s_barrier
    s_lshl_b32 s28, s20, 16
    s_add_u32 s28, s28, 232783872
    s_mov_b64 exec, s[32:33]
    buffer_load_dwordx4 v[160:163], v39, s[8:11], s28 offen sc1
    s_add_u32 s28, s28, 4096
    buffer_load_dwordx4 v[164:167], v39, s[8:11], s28 offen sc1
    s_add_u32 s28, s28, 4096
    buffer_load_dwordx4 v[168:171], v39, s[8:11], s28 offen sc1
    s_add_u32 s28, s28, 4096
    buffer_load_dwordx4 v[172:175], v39, s[8:11], s28 offen sc1
    s_add_u32 s28, s28, 4096
    buffer_load_dwordx4 v[176:179], v39, s[8:11], s28 offen sc1
    s_add_u32 s28, s28, 4096
    buffer_load_dwordx4 v[180:183], v39, s[8:11], s28 offen sc1
    s_add_u32 s28, s28, 4096
    buffer_load_dwordx4 v[184:187], v39, s[8:11], s28 offen sc1
    s_add_u32 s28, s28, 4096
    buffer_load_dwordx4 v[188:191], v39, s[8:11], s28 offen sc1
    s_add_u32 s28, s28, 4096
    buffer_load_dwordx4 v[192:195], v39, s[8:11], s28 offen sc1
    s_add_u32 s28, s28, 4096
    buffer_load_dwordx4 v[196:199], v39, s[8:11], s28 offen sc1
    s_add_u32 s28, s28, 4096
    buffer_load_dwordx4 v[200:203], v39, s[8:11], s28 offen sc1
    s_add_u32 s28, s28, 4096
    buffer_load_dwordx4 v[204:207], v39, s[8:11], s28 offen sc1
    s_add_u32 s28, s28, 4096
    buffer_load_dwordx4 v[208:211], v39, s[8:11], s28 offen sc1
    s_add_u32 s28, s28, 4096
    buffer_load_dwordx4 v[212:215], v39, s[8:11], s28 offen sc1
    s_add_u32 s28, s28, 4096
    buffer_load_dwordx4 v[216:219], v39, s[8:11], s28 offen sc1
    s_add_u32 s28, s28, 4096
    buffer_load_dwordx4 v[220:223], v39, s[8:11], s28 offen sc1
    s_mov_b64 exec, -1
    s_waitcnt vmcnt(14)
    v_add_f32 v160, v160, v164
    v_add_f32 v161, v161, v165
    v_add_f32 v162, v162, v166
    v_add_f32 v163, v163, v167
    s_waitcnt vmcnt(12)
    v_add_f32 v168, v168, v172
    v_add_f32 v169, v169, v173
    v_add_f32 v170, v170, v174
    v_add_f32 v171, v171, v175
    s_waitcnt vmcnt(10)
    v_add_f32 v176, v176, v180
    v_add_f32 v177, v177, v181
    v_add_f32 v178, v178, v182
    v_add_f32 v179, v179, v183
    s_waitcnt vmcnt(8)
    v_add_f32 v184, v184, v188
    v_add_f32 v185, v185, v189
    v_add_f32 v186, v186, v190
    v_add_f32 v187, v187, v191
    s_waitcnt vmcnt(6)
    v_add_f32 v192, v192, v196
    v_add_f32 v193, v193, v197
    v_add_f32 v194, v194, v198
    v_add_f32 v195, v195, v199
    s_waitcnt vmcnt(4)
    v_add_f32 v200, v200, v204
    v_add_f32 v201, v201, v205
    v_add_f32 v202, v202, v206
    v_add_f32 v203, v203, v207
    s_waitcnt vmcnt(2)
    v_add_f32 v208, v208, v212
    v_add_f32 v209, v209, v213
    v_add_f32 v210, v210, v214
    v_add_f32 v211, v211, v215
    s_waitcnt vmcnt(0)
    v_add_f32 v216, v216, v220
    v_add_f32 v217, v217, v221
    v_add_f32 v218, v218, v222
    v_add_f32 v219, v219, v223
    v_add_f32 v160, v160, v168
    v_add_f32 v161, v161, v169
    v_add_f32 v162, v162, v170
    v_add_f32 v163, v163, v171
    v_add_f32 v176, v176, v184
    v_add_f32 v177, v177, v185
    v_add_f32 v178, v178, v186
    v_add_f32 v179, v179, v187
    v_add_f32 v192, v192, v200
    v_add_f32 v193, v193, v201
    v_add_f32 v194, v194, v202
    v_add_f32 v195, v195, v203
    v_add_f32 v208, v208, v216
    v_add_f32 v209, v209, v217
    v_add_f32 v210, v210, v218
    v_add_f32 v211, v211, v219
    v_add_f32 v160, v160, v176
    v_add_f32 v161, v161, v177
    v_add_f32 v162, v162, v178
    v_add_f32 v163, v163, v179
    v_add_f32 v192, v192, v208
    v_add_f32 v193, v193, v209
    v_add_f32 v194, v194, v210
    v_add_f32 v195, v195, v211
    v_add_f32 v160, v160, v192
    v_add_f32 v161, v161, v193
    v_add_f32 v162, v162, v194
    v_add_f32 v163, v163, v195
    v_add_u32 v39, 64, v39
    s_mov_b64 exec, s[32:33]
    ds_write_b128 v39, v[160:163]
    s_mov_b64 exec, -1
    s_waitcnt lgkmcnt(0)
    s_barrier
    s_mov_b32 exec_lo, 0x1fffff
    s_mov_b32 exec_hi, 0x1fffff
    ds_read_b128 v[52:55], v15 offset:32
    ds_read_b128 v[56:59], v15 offset:64
    s_mov_b32 exec_lo, 0
    ds_read_b128 v[48:51], v15
    s_mov_b64 exec, -1
    v_mov_b32 v32, 0
    v_mov_b32 v33, 0
    s_waitcnt lgkmcnt(0)
    v_cvt_pk_bf16_f32 v34, v48, v49
    v_cvt_pk_bf16_f32 v35, v50, v51
    v_cvt_pk_bf16_f32 v36, v52, v53
    v_cvt_pk_bf16_f32 v37, v54, v55
    v_cvt_pk_bf16_f32 v38, v56, v57
    v_cvt_pk_bf16_f32 v39, v58, v59
    s_nop 1
    v_mfma_f32_32x32x16_bf16 v[64:79], v[32:35], v[128:131], 0
    v_mfma_f32_32x32x16_bf16 v[64:79], v[36:39], v[132:135], v[64:79]
    v_mfma_f32_32x32x16_bf16 v[80:95], v[32:35], v[144:147], 0
    v_mfma_f32_32x32x16_bf16 v[80:95], v[36:39], v[148:151], v[80:95]
    s_lshl_b32 s28, s21, 2
    s_lshl_b32 s29, s22, 1
    s_add_u32 s28, s28, s29
    s_mul_i32 s28, s28, 40960
    s_add_u32 s28, s28, 229638144
    s_nop 7
    s_nop 3
    v_add_f32 v40, 0x358637bd, v72
    v_mov_b32 v41, v40
    s_nop 1
    v_permlane32_swap_b32 v40, v41
    v_rcp_f32 v41, v41
    s_nop 0
    v_mul_f32 v64, v64, v41
    v_mul_f32 v65, v65, v41
    v_mul_f32 v66, v66, v41
    v_mul_f32 v67, v67, v41
    v_mul_f32 v68, v68, v41
    v_mul_f32 v69, v69, v41
    v_mul_f32 v70, v70, v41
    v_mul_f32 v71, v71, v41
    v_mul_f32 v72, v72, v41
    v_mul_f32 v73, v73, v41
    v_mul_f32 v74, v74, v41
    v_mul_f32 v75, v75, v41
    v_cvt_pk_bf16_f32 v42, v64, v65
    v_cvt_pk_bf16_f32 v43, v66, v67
    v_cvt_pk_bf16_f32 v44, v68, v69
    v_cvt_pk_bf16_f32 v45, v70, v71
    v_cvt_pk_bf16_f32 v46, v72, v73
    v_cvt_pk_bf16_f32 v47, v74, v75
    buffer_store_dwordx2 v[42:43], v14, s[8:11], s28 offen offset:0
    buffer_store_dwordx2 v[44:45], v14, s[8:11], s28 offen offset:512
    s_mov_b32 exec_hi, 0
    buffer_store_dwordx2 v[46:47], v14, s[8:11], s28 offen offset:1024
    s_mov_b32 exec_hi, -1
    s_add_u32 s28, s28, 40960
    s_nop 7
    v_add_f32 v40, 0x358637bd, v88
    v_mov_b32 v41, v40
    s_nop 1
    v_permlane32_swap_b32 v40, v41
    v_rcp_f32 v41, v41
    s_nop 0
    v_mul_f32 v80, v80, v41
    v_mul_f32 v81, v81, v41
    v_mul_f32 v82, v82, v41
    v_mul_f32 v83, v83, v41
    v_mul_f32 v84, v84, v41
    v_mul_f32 v85, v85, v41
    v_mul_f32 v86, v86, v41
    v_mul_f32 v87, v87, v41
    v_mul_f32 v88, v88, v41
    v_mul_f32 v89, v89, v41
    v_mul_f32 v90, v90, v41
    v_mul_f32 v91, v91, v41
    v_cvt_pk_bf16_f32 v48, v80, v81
    v_cvt_pk_bf16_f32 v49, v82, v83
    v_cvt_pk_bf16_f32 v50, v84, v85
    v_cvt_pk_bf16_f32 v51, v86, v87
    v_cvt_pk_bf16_f32 v52, v88, v89
    v_cvt_pk_bf16_f32 v53, v90, v91
    buffer_store_dwordx2 v[48:49], v14, s[8:11], s28 offen offset:0
    buffer_store_dwordx2 v[50:51], v14, s[8:11], s28 offen offset:512
    s_mov_b32 exec_hi, 0
    buffer_store_dwordx2 v[52:53], v14, s[8:11], s28 offen offset:1024
    s_mov_b32 exec_hi, -1
afront1_kernel_end:
    s_endpgm
.section .rodata,"a"
.p2align 6
.amdhsa_kernel afront1_kernel
  .amdhsa_next_free_vgpr 256
  .amdhsa_next_free_sgpr 64
  .amdhsa_accum_offset 256
  .amdhsa_group_segment_fixed_size 0
  .amdhsa_kernarg_size 104
  .amdhsa_user_sgpr_count 2
  .amdhsa_user_sgpr_kernarg_segment_ptr 1
  .amdhsa_system_sgpr_workgroup_id_x 1
.end_amdhsa_kernel
.text
.globl aback1_kernel
.p2align 8
.type aback1_kernel,@function
aback1_kernel:
    s_cmp_ge_u32 s2, 160
    s_cbranch_scc1 aback1_kernel_end
    s_load_dwordx2 s[4:5], s[0:1], 96
    v_lshrrev_b32 v1, 6, v0
    v_and_b32 v0, 63, v0
    s_nop 0
    v_readfirstlane_b32 s13, v1
    s_waitcnt lgkmcnt(0)
    s_mov_b32 s8, s4
    s_mov_b32 s9, s5
    s_mov_b32 s10, 268435456
    s_mov_b32 s11, 0x00020000
    s_mov_b32 s49, 0
    s_mul_i32 s28, s2, 13108
    s_lshr_b32 s28, s28, 16
    s_mul_i32 s29, s28, 5
    s_sub_u32 s29, s2, s29
    s_lshl_b32 s14, s28, 1
    s_add_u32 s15, s14, 2
    s_load_dwordx2 s[52:53], s[0:1], 0
    v_lshlrev_b32 v1, 4, v0
    s_lshl_b32 s21, s29, 2
    s_add_u32 s21, s21, s13
    s_mul_i32 s24, s21, 40960
    s_add_u32 s24, s24, 246415360
    buffer_load_dwordx4 a[0:3], v1, s[8:11], s24 offen offset:0
    buffer_load_dwordx4 a[4:7], v1, s[8:11], s24 offen offset:1024
    buffer_load_dwordx4 a[8:11], v1, s[8:11], s24 offen offset:2048
    buffer_load_dwordx4 a[12:15], v1, s[8:11], s24 offen offset:3072
    s_add_u32 s24, s24, 4096
    buffer_load_dwordx4 a[16:19], v1, s[8:11], s24 offen offset:0
    buffer_load_dwordx4 a[20:23], v1, s[8:11], s24 offen offset:1024
    buffer_load_dwordx4 a[24:27], v1, s[8:11], s24 offen offset:2048
    buffer_load_dwordx4 a[28:31], v1, s[8:11], s24 offen offset:3072
    s_add_u32 s24, s24, 4096
    buffer_load_dwordx4 a[32:35], v1, s[8:11], s24 offen offset:0
    buffer_load_dwordx4 a[36:39], v1, s[8:11], s24 offen offset:1024
    buffer_load_dwordx4 a[40:43], v1, s[8:11], s24 offen offset:2048
    buffer_load_dwordx4 a[44:47], v1, s[8:11], s24 offen offset:3072
    s_add_u32 s24, s24, 4096
    buffer_load_dwordx4 a[48:51], v1, s[8:11], s24 offen offset:0
    buffer_load_dwordx4 a[52:55], v1, s[8:11], s24 offen offset:1024
    buffer_load_dwordx4 a[56:59], v1, s[8:11], s24 offen offset:2048
    buffer_load_dwordx4 a[60:63], v1, s[8:11], s24 offen offset:3072
    s_add_u32 s24, s24, 4096
    buffer_load_dwordx4 a[64:67], v1, s[8:11], s24 offen offset:0
    buffer_load_dwordx4 a[68:71], v1, s[8:11], s24 offen offset:1024
    buffer_load_dwordx4 a[72:75], v1, s[8:11], s24 offen offset:2048
    buffer_load_dwordx4 a[76:79], v1, s[8:11], s24 offen offset:3072
    s_add_u32 s24, s24, 4096
    buffer_load_dwordx4 a[80:83], v1, s[8:11], s24 offen offset:0
    buffer_load_dwordx4 a[84:87], v1, s[8:11], s24 offen offset:1024
    buffer_load_dwordx4 a[88:91], v1, s[8:11], s24 offen offset:2048
    buffer_load_dwordx4 a[92:95], v1, s[8:11], s24 offen offset:3072
    s_add_u32 s24, s24, 4096
    buffer_load_dwordx4 a[96:99], v1, s[8:11], s24 offen offset:0
    buffer_load_dwordx4 a[100:103], v1, s[8:11], s24 offen offset:1024
    buffer_load_dwordx4 a[104:107], v1, s[8:11], s24 offen offset:2048
    buffer_load_dwordx4 a[108:111], v1, s[8:11], s24 offen offset:3072
    s_add_u32 s24, s24, 4096
    buffer_load_dwordx4 a[112:115], v1, s[8:11], s24 offen offset:0
    buffer_load_dwordx4 a[116:119], v1, s[8:11], s24 offen offset:1024
    buffer_load_dwordx4 a[120:123], v1, s[8:11], s24 offen offset:2048
    buffer_load_dwordx4 a[124:127], v1, s[8:11], s24 offen offset:3072
    s_add_u32 s24, s24, 4096
    buffer_load_dwordx4 a[128:131], v1, s[8:11], s24 offen offset:0
    buffer_load_dwordx4 a[132:135], v1, s[8:11], s24 offen offset:1024
    buffer_load_dwordx4 a[136:139], v1, s[8:11], s24 offen offset:2048
    buffer_load_dwordx4 a[140:143], v1, s[8:11], s24 offen offset:3072
    s_add_u32 s24, s24, 4096
    buffer_load_dwordx4 a[144:147], v1, s[8:11], s24 offen offset:0
    buffer_load_dwordx4 a[148:151], v1, s[8:11], s24 offen offset:1024
    buffer_load_dwordx4 a[152:155], v1, s[8:11], s24 offen offset:2048
    buffer_load_dwordx4 a[156:159], v1, s[8:11], s24 offen offset:3072
    s_add_u32 s24, s4, 247463936
    s_addc_u32 s25, s5, 0
    s_waitcnt lgkmcnt(0)
    s_cmp_eq_u32 s49, 0
    s_cselect_b32 s52, s52, s24
    s_cselect_b32 s53, s53, s25
    s_mov_b32 s54, 2621440
    s_mov_b32 s55, 0x00020000
    v_and_b32 v6, 31, v0
    v_lshrrev_b32 v7, 5, v0
    v_mul_u32_u24 v6, 1280, v6
    v_lshl_add_u32 v3, v7, 4, v6
    s_mul_i32 s19, s14, 40960
    s_lshl_b32 s24, s21, 6
    s_add_u32 s19, s19, s24
    s_lshl_b32 s20, s14, 7
    s_lshl_b32 s24, s21, 2
    s_add_u32 s20, s20, s24
    s_add_u32 s20, s20, 36864
    v_mov_b32 v5, 1
    v_mov_b32 v4, 0
    s_mul_i32 s18, s13, 10240
    s_add_u32 s18, s18, 229638144
    s_mov_b32 s17, 0
    s_min_u32 s24, s14, 63
    s_mul_i32 s24, s24, 40960
    s_add_u32 s24, s24, s18
    s_mul_i32 s25, s13, 10240
    s_add_u32 s25, s25, s17
    s_mov_b32 m0, s25
    s_nop 0
    buffer_load_dwordx4 v1, s[8:11], s24 offen offset:0 lds
    buffer_load_dwordx4 v1, s[8:11], s24 offen offset:1024 lds
    buffer_load_dwordx4 v1, s[8:11], s24 offen offset:2048 lds
    buffer_load_dwordx4 v1, s[8:11], s24 offen offset:3072 lds
    s_add_u32 s24, s24, 4096
    s_add_u32 s25, s25, 4096
    s_mov_b32 m0, s25
    s_nop 0
    buffer_load_dwordx4 v1, s[8:11], s24 offen offset:0 lds
    buffer_load_dwordx4 v1, s[8:11], s24 offen offset:1024 lds
    buffer_load_dwordx4 v1, s[8:11], s24 offen offset:2048 lds
    buffer_load_dwordx4 v1, s[8:11], s24 offen offset:3072 lds
    s_add_u32 s24, s24, 4096
    s_add_u32 s25, s25, 4096
    s_mov_b32 m0, s25
    s_nop 0
    buffer_load_dwordx4 v1, s[8:11], s24 offen offset:0 lds
    buffer_load_dwordx4 v1, s[8:11], s24 offen offset:1024 lds
    s_mov_b32 s17, 40960
    s_add_u32 s23, s14, 1
    s_min_u32 s24, s23, 63
    s_mul_i32 s24, s24, 40960
    s_add_u32 s24, s24, s18
    s_mul_i32 s25, s13, 10240
    s_add_u32 s25, s25, s17
    s_mov_b32 m0, s25
    s_nop 0
    buffer_load_dwordx4 v1, s[8:11], s24 offen offset:0 lds
    buffer_load_dwordx4 v1, s[8:11], s24 offen offset:1024 lds
    buffer_load_dwordx4 v1, s[8:11], s24 offen offset:2048 lds
    buffer_load_dwordx4 v1, s[8:11], s24 offen offset:3072 lds
    s_add_u32 s24, s24, 4096
    s_add_u32 s25, s25, 4096
    s_mov_b32 m0, s25
    s_nop 0
    buffer_load_dwordx4 v1, s[8:11], s24 offen offset:0 lds
    buffer_load_dwordx4 v1, s[8:11], s24 offen offset:1024 lds
    buffer_load_dwordx4 v1, s[8:11], s24 offen offset:2048 lds
    buffer_load_dwordx4 v1, s[8:11], s24 offen offset:3072 lds
    s_add_u32 s24, s24, 4096
    s_add_u32 s25, s25, 4096
    s_mov_b32 m0, s25
    s_nop 0
    buffer_load_dwordx4 v1, s[8:11], s24 offen offset:0 lds
    buffer_load_dwordx4 v1, s[8:11], s24 offen offset:1024 lds
    s_mov_b32 s17, 81920
    s_mov_b32 s16, 0
    s_waitcnt vmcnt(10)
    s_barrier
    v_add_u32 v2, s16, v1
    buffer_load_dwordx4 v[8:11], v3, s[52:55], s19 offen offset:0
    buffer_load_dwordx4 v[12:15], v3, s[52:55], s19 offen offset:32
    s_add_u32 s23, s14, 2
    s_min_u32 s24, s23, 63
    s_mul_i32 s24, s24, 40960
    s_add_u32 s24, s24, s18
    s_mul_i32 s25, s13, 10240
    s_add_u32 s25, s25, s17
    s_mov_b32 m0, s25
    s_nop 0
    buffer_load_dwordx4 v1, s[8:11], s24 offen offset:0 lds
    buffer_load_dwordx4 v1, s[8:11], s24 offen offset:1024 lds
    buffer_load_dwordx4 v1, s[8:11], s24 offen offset:2048 lds
    buffer_load_dwordx4 v1, s[8:11], s24 offen offset:3072 lds
    s_add_u32 s24, s24, 4096
    s_add_u32 s25, s25, 4096
    s_mov_b32 m0, s25
    s_nop 0
    buffer_load_dwordx4 v1, s[8:11], s24 offen offset:0 lds
    buffer_load_dwordx4 v1, s[8:11], s24 offen offset:1024 lds
    buffer_load_dwordx4 v1, s[8:11], s24 offen offset:2048 lds
    buffer_load_dwordx4 v1, s[8:11], s24 offen offset:3072 lds
    s_add_u32 s24, s24, 4096
    s_add_u32 s25, s25, 4096
    s_mov_b32 m0, s25
    s_nop 0
    buffer_load_dwordx4 v1, s[8:11], s24 offen offset:0 lds
    buffer_load_dwordx4 v1, s[8:11], s24 offen offset:1024 lds
    s_add_u32 s17, s17, 40960
    s_cmp_eq_u32 s17, 122880
    s_cselect_b32 s17, 0, s17
    ds_read_b128 v[16:19], v2 offset:0
    ds_read_b128 v[20:23], v2 offset:1024
    ds_read_b128 v[24:27], v2 offset:2048
    ds_read_b128 v[28:31], v2 offset:3072
    ds_read_b128 v[32:35], v2 offset:4096
    ds_read_b128 v[36:39], v2 offset:5120
    ds_read_b128 v[40:43], v2 offset:6144
    s_waitcnt lgkmcnt(6)
    v_mfma_f32_32x32x16_bf16 v[48:63], a[0:3], v[16:19], 0
    ds_read_b128 v[44:47], v2 offset:7168
    s_waitcnt lgkmcnt(6)
    v_mfma_f32_32x32x16_bf16 v[64:79], a[4:7], v[20:23], 0
    ds_read_b128 v[16:19], v2 offset:8192
    s_waitcnt lgkmcnt(6)
    v_mfma_f32_32x32x16_bf16 v[48:63], a[8:11], v[24:27], v[48:63]
    ds_read_b128 v[20:23], v2 offset:9216
    s_waitcnt lgkmcnt(6)
    v_mfma_f32_32x32x16_bf16 v[64:79], a[12:15], v[28:31], v[64:79]
    ds_read_b128 v[24:27], v2 offset:10240
    s_waitcnt lgkmcnt(6)
    v_mfma_f32_32x32x16_bf16 v[48:63], a[16:19], v[32:35], v[48:63]
    ds_read_b128 v[28:31], v2 offset:11264
    s_waitcnt lgkmcnt(6)
    v_mfma_f32_32x32x16_bf16 v[64:79], a[20:23], v[36:39], v[64:79]
    ds_read_b128 v[32:35], v2 offset:12288
    s_waitcnt lgkmcnt(6)
    v_mfma_f32_32x32x16_bf16 v[48:63], a[24:27], v[40:43], v[48:63]
    ds_read_b128 v[36:39], v2 offset:13312
    s_waitcnt lgkmcnt(6)
    v_mfma_f32_32x32x16_bf16 v[64:79], a[28:31], v[44:47], v[64:79]
    ds_read_b128 v[40:43], v2 offset:14336
    s_waitcnt lgkmcnt(6)
    v_mfma_f32_32x32x16_bf16 v[48:63], a[32:35], v[16:19], v[48:63]
    ds_read_b128 v[44:47], v2 offset:15360
    s_waitcnt lgkmcnt(6)
    v_mfma_f32_32x32x16_bf16 v[64:79], a[36:39], v[20:23], v[64:79]
    ds_read_b128 v[16:19], v2 offset:16384
    s_waitcnt lgkmcnt(6)
    v_mfma_f32_32x32x16_bf16 v[48:63], a[40:43], v[24:27], v[48:63]
    ds_read_b128 v[20:23], v2 offset:17408
    s_waitcnt lgkmcnt(6)
    v_mfma_f32_32x32x16_bf16 v[64:79], a[44:47], v[28:31], v[64:79]
    ds_read_b128 v[24:27], v2 offset:18432
    s_waitcnt lgkmcnt(6)
    v_mfma_f32_32x32x16_bf16 v[48:63], a[48:51], v[32:35], v[48:63]
    ds_read_b128 v[28:31], v2 offset:19456
    s_waitcnt lgkmcnt(6)
    v_mfma_f32_32x32x16_bf16 v[64:79], a[52:55], v[36:39], v[64:79]
    ds_read_b128 v[32:35], v2 offset:20480
    s_waitcnt lgkmcnt(6)
    v_mfma_f32_32x32x16_bf16 v[48:63], a[56:59], v[40:43], v[48:63]
    ds_read_b128 v[36:39], v2 offset:21504
    s_waitcnt lgkmcnt(6)
    v_mfma_f32_32x32x16_bf16 v[64:79], a[60:63], v[44:47], v[64:79]
    ds_read_b128 v[40:43], v2 offset:22528
    s_waitcnt lgkmcnt(6)
    v_mfma_f32_32x32x16_bf16 v[48:63], a[64:67], v[16:19], v[48:63]
    ds_read_b128 v[44:47], v2 offset:23552
    s_waitcnt lgkmcnt(6)
    v_mfma_f32_32x32x16_bf16 v[64:79], a[68:71], v[20:23], v[64:79]
    ds_read_b128 v[16:19], v2 offset:24576
    s_waitcnt lgkmcnt(6)
    v_mfma_f32_32x32x16_bf16 v[48:63], a[72:75], v[24:27], v[48:63]
    ds_read_b128 v[20:23], v2 offset:25600
    s_waitcnt lgkmcnt(6)
    v_mfma_f32_32x32x16_bf16 v[64:79], a[76:79], v[28:31], v[64:79]
    ds_read_b128 v[24:27], v2 offset:26624
    s_waitcnt lgkmcnt(6)
    v_mfma_f32_32x32x16_bf16 v[48:63], a[80:83], v[32:35], v[48:63]
    ds_read_b128 v[28:31], v2 offset:27648
    s_waitcnt lgkmcnt(6)
    v_mfma_f32_32x32x16_bf16 v[64:79], a[84:87], v[36:39], v[64:79]
    ds_read_b128 v[32:35], v2 offset:28672
    s_waitcnt lgkmcnt(6)
    v_mfma_f32_32x32x16_bf16 v[48:63], a[88:91], v[40:43], v[48:63]
    ds_read_b128 v[36:39], v2 offset:29696
    s_waitcnt lgkmcnt(6)
    v_mfma_f32_32x32x16_bf16 v[64:79], a[92:95], v[44:47], v[64:79]
    ds_read_b128 v[40:43], v2 offset:30720
    s_waitcnt lgkmcnt(6)
    v_mfma_f32_32x32x16_bf16 v[48:63], a[96:99], v[16:19], v[48:63]
    ds_read_b128 v[44:47], v2 offset:31744
    s_waitcnt lgkmcnt(6)
    v_mfma_f32_32x32x16_bf16 v[64:79], a[100:103], v[20:23], v[64:79]
    ds_read_b128 v[16:19], v2 offset:32768
    s_waitcnt lgkmcnt(6)
    v_mfma_f32_32x32x16_bf16 v[48:63], a[104:107], v[24:27], v[48:63]
    ds_read_b128 v[20:23], v2 offset:33792
    s_waitcnt lgkmcnt(6)
    v_mfma_f32_32x32x16_bf16 v[64:79], a[108:111], v[28:31], v[64:79]
    ds_read_b128 v[24:27], v2 offset:34816
    s_waitcnt lgkmcnt(6)
    v_mfma_f32_32x32x16_bf16 v[48:63], a[112:115], v[32:35], v[48:63]
    ds_read_b128 v[28:31], v2 offset:35840
    s_waitcnt lgkmcnt(6)
    v_mfma_f32_32x32x16_bf16 v[64:79], a[116:119], v[36:39], v[64:79]
    ds_read_b128 v[32:35], v2 offset:36864
    s_waitcnt lgkmcnt(6)
    v_mfma_f32_32x32x16_bf16 v[48:63], a[120:123], v[40:43], v[48:63]
    ds_read_b128 v[36:39], v2 offset:37888
    s_waitcnt lgkmcnt(6)
    v_mfma_f32_32x32x16_bf16 v[64:79], a[124:127], v[44:47], v[64:79]
    ds_read_b128 v[40:43], v2 offset:38912
    s_waitcnt lgkmcnt(6)
    v_mfma_f32_32x32x16_bf16 v[48:63], a[128:131], v[16:19], v[48:63]
    ds_read_b128 v[44:47], v2 offset:39936
    s_waitcnt lgkmcnt(6)
    v_mfma_f32_32x32x16_bf16 v[64:79], a[132:135], v[20:23], v[64:79]
    s_waitcnt lgkmcnt(5)
    v_mfma_f32_32x32x16_bf16 v[48:63], a[136:139], v[24:27], v[48:63]
    s_waitcnt lgkmcnt(4)
    v_mfma_f32_32x32x16_bf16 v[64:79], a[140:143], v[28:31], v[64:79]
    s_waitcnt lgkmcnt(3)
    v_mfma_f32_32x32x16_bf16 v[48:63], a[144:147], v[32:35], v[48:63]
    s_waitcnt lgkmcnt(2)
    v_mfma_f32_32x32x16_bf16 v[64:79], a[148:151], v[36:39], v[64:79]
    s_waitcnt lgkmcnt(1)
    v_mfma_f32_32x32x16_bf16 v[48:63], a[152:155], v[40:43], v[48:63]
    s_waitcnt lgkmcnt(0)
    v_mfma_f32_32x32x16_bf16 v[64:79], a[156:159], v[44:47], v[64:79]
    s_waitcnt vmcnt(10)
    s_nop 7
    s_nop 3
    v_add_f32 v48, v48, v64
    v_add_f32 v49, v49, v65
    v_add_f32 v50, v50, v66
    v_add_f32 v51, v51, v67
    v_add_f32 v52, v52, v68
    v_add_f32 v53, v53, v69
    v_add_f32 v54, v54, v70
    v_add_f32 v55, v55, v71
    v_add_f32 v56, v56, v72
    v_add_f32 v57, v57, v73
    v_add_f32 v58, v58, v74
    v_add_f32 v59, v59, v75
    v_add_f32 v60, v60, v76
    v_add_f32 v61, v61, v77
    v_add_f32 v62, v62, v78
    v_add_f32 v63, v63, v79
    v_cvt_pk_bf16_f32 v80, v48, v49
    v_cvt_pk_bf16_f32 v81, v50, v51
    v_cvt_pk_bf16_f32 v82, v52, v53
    v_cvt_pk_bf16_f32 v83, v54, v55
    s_nop 1
    v_permlane32_swap_b32 v80, v82
    v_permlane32_swap_b32 v81, v83
    s_nop 1
    v_lshlrev_b32 v88, 16, v80
    v_and_b32 v89, 0xffff0000, v80
    v_lshlrev_b32 v90, 16, v8
    v_and_b32 v91, 0xffff0000, v8
    v_add_f32 v88, v88, v90
    v_add_f32 v89, v89, v91
    v_cvt_pk_bf16_f32 v80, v88, v89
    v_lshlrev_b32 v92, 16, v81
    v_and_b32 v93, 0xffff0000, v81
    v_lshlrev_b32 v94, 16, v9
    v_and_b32 v95, 0xffff0000, v9
    v_add_f32 v92, v92, v94
    v_add_f32 v93, v93, v95
    v_cvt_pk_bf16_f32 v81, v92, v93
    v_lshlrev_b32 v88, 16, v82
    v_and_b32 v89, 0xffff0000, v82
    v_lshlrev_b32 v90, 16, v10
    v_and_b32 v91, 0xffff0000, v10
    v_add_f32 v88, v88, v90
    v_add_f32 v89, v89, v91
    v_cvt_pk_bf16_f32 v82, v88, v89
    v_lshlrev_b32 v92, 16, v83
    v_and_b32 v93, 0xffff0000, v83
    v_lshlrev_b32 v94, 16, v11
    v_and_b32 v95, 0xffff0000, v11
    v_add_f32 v92, v92, v94
    v_add_f32 v93, v93, v95
    v_cvt_pk_bf16_f32 v83, v92, v93
    s_add_u32 s26, s19, 226492416
    buffer_store_dwordx4 v[80:83], v3, s[8:11], s26 offen offset:0
    v_cvt_pk_bf16_f32 v84, v56, v57
    v_cvt_pk_bf16_f32 v85, v58, v59
    v_cvt_pk_bf16_f32 v86, v60, v61
    v_cvt_pk_bf16_f32 v87, v62, v63
    s_nop 1
    v_permlane32_swap_b32 v84, v86
    v_permlane32_swap_b32 v85, v87
    s_nop 1
    v_lshlrev_b32 v88, 16, v84
    v_and_b32 v89, 0xffff0000, v84
    v_lshlrev_b32 v90, 16, v12
    v_and_b32 v91, 0xffff0000, v12
    v_add_f32 v88, v88, v90
    v_add_f32 v89, v89, v91
    v_cvt_pk_bf16_f32 v84, v88, v89
    v_lshlrev_b32 v92, 16, v85
    v_and_b32 v93, 0xffff0000, v85
    v_lshlrev_b32 v94, 16, v13
    v_and_b32 v95, 0xffff0000, v13
    v_add_f32 v92, v92, v94
    v_add_f32 v93, v93, v95
    v_cvt_pk_bf16_f32 v85, v92, v93
    v_lshlrev_b32 v88, 16, v86
    v_and_b32 v89, 0xffff0000, v86
    v_lshlrev_b32 v90, 16, v14
    v_and_b32 v91, 0xffff0000, v14
    v_add_f32 v88, v88, v90
    v_add_f32 v89, v89, v91
    v_cvt_pk_bf16_f32 v86, v88, v89
    v_lshlrev_b32 v92, 16, v87
    v_and_b32 v93, 0xffff0000, v87
    v_lshlrev_b32 v94, 16, v15
    v_and_b32 v95, 0xffff0000, v15
    v_add_f32 v92, v92, v94
    v_add_f32 v93, v93, v95
    v_cvt_pk_bf16_f32 v87, v92, v93
    s_add_u32 s26, s19, 226492416
    buffer_store_dwordx4 v[84:87], v3, s[8:11], s26 offen offset:32
    s_add_u32 s19, s19, 40960
    s_add_u32 s16, s16, 40960
    s_cmp_eq_u32 s16, 122880
    s_cselect_b32 s16, 0, s16
    s_add_u32 s14, s14, 1
    s_cmp_ge_u32 s14, s15
    s_cbranch_scc1 aback1_kernel_ab_fin
aback1_kernel_ab_loop:
    s_barrier
    v_add_u32 v2, s16, v1
    buffer_load_dwordx4 v[8:11], v3, s[52:55], s19 offen offset:0
    buffer_load_dwordx4 v[12:15], v3, s[52:55], s19 offen offset:32
    s_add_u32 s23, s14, 2
    s_min_u32 s24, s23, 63
    s_mul_i32 s24, s24, 40960
    s_add_u32 s24, s24, s18
    s_mul_i32 s25, s13, 10240
    s_add_u32 s25, s25, s17
    s_mov_b32 m0, s25
    s_nop 0
    buffer_load_dwordx4 v1, s[8:11], s24 offen offset:0 lds
    buffer_load_dwordx4 v1, s[8:11], s24 offen offset:1024 lds
    buffer_load_dwordx4 v1, s[8:11], s24 offen offset:2048 lds
    buffer_load_dwordx4 v1, s[8:11], s24 offen offset:3072 lds
    s_add_u32 s24, s24, 4096
    s_add_u32 s25, s25, 4096
    s_mov_b32 m0, s25
    s_nop 0
    buffer_load_dwordx4 v1, s[8:11], s24 offen offset:0 lds
    buffer_load_dwordx4 v1, s[8:11], s24 offen offset:1024 lds
    buffer_load_dwordx4 v1, s[8:11], s24 offen offset:2048 lds
    buffer_load_dwordx4 v1, s[8:11], s24 offen offset:3072 lds
    s_add_u32 s24, s24, 4096
    s_add_u32 s25, s25, 4096
    s_mov_b32 m0, s25
    s_nop 0
    buffer_load_dwordx4 v1, s[8:11], s24 offen offset:0 lds
    buffer_load_dwordx4 v1, s[8:11], s24 offen offset:1024 lds
    s_add_u32 s17, s17, 40960
    s_cmp_eq_u32 s17, 122880
    s_cselect_b32 s17, 0, s17
    ds_read_b128 v[16:19], v2 offset:0
    ds_read_b128 v[20:23], v2 offset:1024
    ds_read_b128 v[24:27], v2 offset:2048
    ds_read_b128 v[28:31], v2 offset:3072
    ds_read_b128 v[32:35], v2 offset:4096
    ds_read_b128 v[36:39], v2 offset:5120
    ds_read_b128 v[40:43], v2 offset:6144
    s_waitcnt lgkmcnt(6)
    v_mfma_f32_32x32x16_bf16 v[48:63], a[0:3], v[16:19], 0
    ds_read_b128 v[44:47], v2 offset:7168
    s_waitcnt lgkmcnt(6)
    v_mfma_f32_32x32x16_bf16 v[64:79], a[4:7], v[20:23], 0
    ds_read_b128 v[16:19], v2 offset:8192
    s_waitcnt lgkmcnt(6)
    v_mfma_f32_32x32x16_bf16 v[48:63], a[8:11], v[24:27], v[48:63]
    ds_read_b128 v[20:23], v2 offset:9216
    s_waitcnt lgkmcnt(6)
    v_mfma_f32_32x32x16_bf16 v[64:79], a[12:15], v[28:31], v[64:79]
    ds_read_b128 v[24:27], v2 offset:10240
    s_waitcnt lgkmcnt(6)
    v_mfma_f32_32x32x16_bf16 v[48:63], a[16:19], v[32:35], v[48:63]
    ds_read_b128 v[28:31], v2 offset:11264
    s_waitcnt lgkmcnt(6)
    v_mfma_f32_32x32x16_bf16 v[64:79], a[20:23], v[36:39], v[64:79]
    ds_read_b128 v[32:35], v2 offset:12288
    s_waitcnt lgkmcnt(6)
    v_mfma_f32_32x32x16_bf16 v[48:63], a[24:27], v[40:43], v[48:63]
    ds_read_b128 v[36:39], v2 offset:13312
    s_waitcnt lgkmcnt(6)
    v_mfma_f32_32x32x16_bf16 v[64:79], a[28:31], v[44:47], v[64:79]
    ds_read_b128 v[40:43], v2 offset:14336
    s_waitcnt lgkmcnt(6)
    v_mfma_f32_32x32x16_bf16 v[48:63], a[32:35], v[16:19], v[48:63]
    ds_read_b128 v[44:47], v2 offset:15360
    s_waitcnt lgkmcnt(6)
    v_mfma_f32_32x32x16_bf16 v[64:79], a[36:39], v[20:23], v[64:79]
    ds_read_b128 v[16:19], v2 offset:16384
    s_waitcnt lgkmcnt(6)
    v_mfma_f32_32x32x16_bf16 v[48:63], a[40:43], v[24:27], v[48:63]
    ds_read_b128 v[20:23], v2 offset:17408
    s_waitcnt lgkmcnt(6)
    v_mfma_f32_32x32x16_bf16 v[64:79], a[44:47], v[28:31], v[64:79]
    ds_read_b128 v[24:27], v2 offset:18432
    s_waitcnt lgkmcnt(6)
    v_mfma_f32_32x32x16_bf16 v[48:63], a[48:51], v[32:35], v[48:63]
    ds_read_b128 v[28:31], v2 offset:19456
    s_waitcnt lgkmcnt(6)
    v_mfma_f32_32x32x16_bf16 v[64:79], a[52:55], v[36:39], v[64:79]
    ds_read_b128 v[32:35], v2 offset:20480
    s_waitcnt lgkmcnt(6)
    v_mfma_f32_32x32x16_bf16 v[48:63], a[56:59], v[40:43], v[48:63]
    ds_read_b128 v[36:39], v2 offset:21504
    s_waitcnt lgkmcnt(6)
    v_mfma_f32_32x32x16_bf16 v[64:79], a[60:63], v[44:47], v[64:79]
    ds_read_b128 v[40:43], v2 offset:22528
    s_waitcnt lgkmcnt(6)
    v_mfma_f32_32x32x16_bf16 v[48:63], a[64:67], v[16:19], v[48:63]
    ds_read_b128 v[44:47], v2 offset:23552
    s_waitcnt lgkmcnt(6)
    v_mfma_f32_32x32x16_bf16 v[64:79], a[68:71], v[20:23], v[64:79]
    ds_read_b128 v[16:19], v2 offset:24576
    s_waitcnt lgkmcnt(6)
    v_mfma_f32_32x32x16_bf16 v[48:63], a[72:75], v[24:27], v[48:63]
    ds_read_b128 v[20:23], v2 offset:25600
    s_waitcnt lgkmcnt(6)
    v_mfma_f32_32x32x16_bf16 v[64:79], a[76:79], v[28:31], v[64:79]
    ds_read_b128 v[24:27], v2 offset:26624
    s_waitcnt lgkmcnt(6)
    v_mfma_f32_32x32x16_bf16 v[48:63], a[80:83], v[32:35], v[48:63]
    ds_read_b128 v[28:31], v2 offset:27648
    s_waitcnt lgkmcnt(6)
    v_mfma_f32_32x32x16_bf16 v[64:79], a[84:87], v[36:39], v[64:79]
    ds_read_b128 v[32:35], v2 offset:28672
    s_waitcnt lgkmcnt(6)
    v_mfma_f32_32x32x16_bf16 v[48:63], a[88:91], v[40:43], v[48:63]
    ds_read_b128 v[36:39], v2 offset:29696
    s_waitcnt lgkmcnt(6)
    v_mfma_f32_32x32x16_bf16 v[64:79], a[92:95], v[44:47], v[64:79]
    ds_read_b128 v[40:43], v2 offset:30720
    s_waitcnt lgkmcnt(6)
    v_mfma_f32_32x32x16_bf16 v[48:63], a[96:99], v[16:19], v[48:63]
    ds_read_b128 v[44:47], v2 offset:31744
    s_waitcnt lgkmcnt(6)
    v_mfma_f32_32x32x16_bf16 v[64:79], a[100:103], v[20:23], v[64:79]
    ds_read_b128 v[16:19], v2 offset:32768
    s_waitcnt lgkmcnt(6)
    v_mfma_f32_32x32x16_bf16 v[48:63], a[104:107], v[24:27], v[48:63]
    ds_read_b128 v[20:23], v2 offset:33792
    s_waitcnt lgkmcnt(6)
    v_mfma_f32_32x32x16_bf16 v[64:79], a[108:111], v[28:31], v[64:79]
    ds_read_b128 v[24:27], v2 offset:34816
    s_waitcnt lgkmcnt(6)
    v_mfma_f32_32x32x16_bf16 v[48:63], a[112:115], v[32:35], v[48:63]
    ds_read_b128 v[28:31], v2 offset:35840
    s_waitcnt lgkmcnt(6)
    v_mfma_f32_32x32x16_bf16 v[64:79], a[116:119], v[36:39], v[64:79]
    ds_read_b128 v[32:35], v2 offset:36864
    s_waitcnt lgkmcnt(6)
    v_mfma_f32_32x32x16_bf16 v[48:63], a[120:123], v[40:43], v[48:63]
    ds_read_b128 v[36:39], v2 offset:37888
    s_waitcnt lgkmcnt(6)
    v_mfma_f32_32x32x16_bf16 v[64:79], a[124:127], v[44:47], v[64:79]
    ds_read_b128 v[40:43], v2 offset:38912
    s_waitcnt lgkmcnt(6)
    v_mfma_f32_32x32x16_bf16 v[48:63], a[128:131], v[16:19], v[48:63]
    ds_read_b128 v[44:47], v2 offset:39936
    s_waitcnt lgkmcnt(6)
    v_mfma_f32_32x32x16_bf16 v[64:79], a[132:135], v[20:23], v[64:79]
    s_waitcnt lgkmcnt(5)
    v_mfma_f32_32x32x16_bf16 v[48:63], a[136:139], v[24:27], v[48:63]
    s_waitcnt lgkmcnt(4)
    v_mfma_f32_32x32x16_bf16 v[64:79], a[140:143], v[28:31], v[64:79]
    s_waitcnt lgkmcnt(3)
    v_mfma_f32_32x32x16_bf16 v[48:63], a[144:147], v[32:35], v[48:63]
    s_waitcnt lgkmcnt(2)
    v_mfma_f32_32x32x16_bf16 v[64:79], a[148:151], v[36:39], v[64:79]
    s_waitcnt lgkmcnt(1)
    v_mfma_f32_32x32x16_bf16 v[48:63], a[152:155], v[40:43], v[48:63]
    s_waitcnt lgkmcnt(0)
    v_mfma_f32_32x32x16_bf16 v[64:79], a[156:159], v[44:47], v[64:79]
    s_waitcnt vmcnt(10)
    s_nop 7
    s_nop 3
    v_add_f32 v48, v48, v64
    v_add_f32 v49, v49, v65
    v_add_f32 v50, v50, v66
    v_add_f32 v51, v51, v67
    v_add_f32 v52, v52, v68
    v_add_f32 v53, v53, v69
    v_add_f32 v54, v54, v70
    v_add_f32 v55, v55, v71
    v_add_f32 v56, v56, v72
    v_add_f32 v57, v57, v73
    v_add_f32 v58, v58, v74
    v_add_f32 v59, v59, v75
    v_add_f32 v60, v60, v76
    v_add_f32 v61, v61, v77
    v_add_f32 v62, v62, v78
    v_add_f32 v63, v63, v79
    v_cvt_pk_bf16_f32 v80, v48, v49
    v_cvt_pk_bf16_f32 v81, v50, v51
    v_cvt_pk_bf16_f32 v82, v52, v53
    v_cvt_pk_bf16_f32 v83, v54, v55
    s_nop 1
    v_permlane32_swap_b32 v80, v82
    v_permlane32_swap_b32 v81, v83
    s_nop 1
    v_lshlrev_b32 v88, 16, v80
    v_and_b32 v89, 0xffff0000, v80
    v_lshlrev_b32 v90, 16, v8
    v_and_b32 v91, 0xffff0000, v8
    v_add_f32 v88, v88, v90
    v_add_f32 v89, v89, v91
    v_cvt_pk_bf16_f32 v80, v88, v89
    v_lshlrev_b32 v92, 16, v81
    v_and_b32 v93, 0xffff0000, v81
    v_lshlrev_b32 v94, 16, v9
    v_and_b32 v95, 0xffff0000, v9
    v_add_f32 v92, v92, v94
    v_add_f32 v93, v93, v95
    v_cvt_pk_bf16_f32 v81, v92, v93
    v_lshlrev_b32 v88, 16, v82
    v_and_b32 v89, 0xffff0000, v82
    v_lshlrev_b32 v90, 16, v10
    v_and_b32 v91, 0xffff0000, v10
    v_add_f32 v88, v88, v90
    v_add_f32 v89, v89, v91
    v_cvt_pk_bf16_f32 v82, v88, v89
    v_lshlrev_b32 v92, 16, v83
    v_and_b32 v93, 0xffff0000, v83
    v_lshlrev_b32 v94, 16, v11
    v_and_b32 v95, 0xffff0000, v11
    v_add_f32 v92, v92, v94
    v_add_f32 v93, v93, v95
    v_cvt_pk_bf16_f32 v83, v92, v93
    s_add_u32 s26, s19, 226492416
    buffer_store_dwordx4 v[80:83], v3, s[8:11], s26 offen offset:0
    v_cvt_pk_bf16_f32 v84, v56, v57
    v_cvt_pk_bf16_f32 v85, v58, v59
    v_cvt_pk_bf16_f32 v86, v60, v61
    v_cvt_pk_bf16_f32 v87, v62, v63
    s_nop 1
    v_permlane32_swap_b32 v84, v86
    v_permlane32_swap_b32 v85, v87
    s_nop 1
    v_lshlrev_b32 v88, 16, v84
    v_and_b32 v89, 0xffff0000, v84
    v_lshlrev_b32 v90, 16, v12
    v_and_b32 v91, 0xffff0000, v12
    v_add_f32 v88, v88, v90
    v_add_f32 v89, v89, v91
    v_cvt_pk_bf16_f32 v84, v88, v89
    v_lshlrev_b32 v92, 16, v85
    v_and_b32 v93, 0xffff0000, v85
    v_lshlrev_b32 v94, 16, v13
    v_and_b32 v95, 0xffff0000, v13
    v_add_f32 v92, v92, v94
    v_add_f32 v93, v93, v95
    v_cvt_pk_bf16_f32 v85, v92, v93
    v_lshlrev_b32 v88, 16, v86
    v_and_b32 v89, 0xffff0000, v86
    v_lshlrev_b32 v90, 16, v14
    v_and_b32 v91, 0xffff0000, v14
    v_add_f32 v88, v88, v90
    v_add_f32 v89, v89, v91
    v_cvt_pk_bf16_f32 v86, v88, v89
    v_lshlrev_b32 v92, 16, v87
    v_and_b32 v93, 0xffff0000, v87
    v_lshlrev_b32 v94, 16, v15
    v_and_b32 v95, 0xffff0000, v15
    v_add_f32 v92, v92, v94
    v_add_f32 v93, v93, v95
    v_cvt_pk_bf16_f32 v87, v92, v93
    s_add_u32 s26, s19, 226492416
    buffer_store_dwordx4 v[84:87], v3, s[8:11], s26 offen offset:32
    s_add_u32 s19, s19, 40960
    s_add_u32 s16, s16, 40960
    s_cmp_eq_u32 s16, 122880
    s_cselect_b32 s16, 0, s16
    s_add_u32 s14, s14, 1
    s_cmp_lt_u32 s14, s15
    s_cbranch_scc1 aback1_kernel_ab_loop
aback1_kernel_ab_fin:
    s_waitcnt vmcnt(0) lgkmcnt(0)
    s_barrier
aback1_kernel_end:
    s_endpgm
.section .rodata,"a"
.p2align 6
.amdhsa_kernel aback1_kernel
  .amdhsa_next_free_vgpr 288
  .amdhsa_next_free_sgpr 64
  .amdhsa_accum_offset 128
  .amdhsa_group_segment_fixed_size 0
  .amdhsa_kernarg_size 104
  .amdhsa_user_sgpr_count 2
  .amdhsa_user_sgpr_kernarg_segment_ptr 1
  .amdhsa_system_sgpr_workgroup_id_x 1
.end_amdhsa_kernel
.text
.globl ln_b1_kernel
.p2align 8
.type ln_b1_kernel,@function
ln_b1_kernel:
    s_cmp_gt_u32 s2, 512
    s_cbranch_scc1 ln_b1_kernel_end
    s_load_dwordx2 s[4:5], s[0:1], 96
    s_load_dwordx2 s[6:7], s[0:1], 32
    v_lshrrev_b32 v1, 6, v0
    v_and_b32 v0, 63, v0
    s_nop 0
    v_readfirstlane_b32 s13, v1
    s_waitcnt lgkmcnt(0)
    s_mov_b32 s8, s4
    s_mov_b32 s9, s5
    s_mov_b32 s10, 268435456
    s_mov_b32 s11, 0x00020000
    s_cmp_eq_u32 s2, 512
    s_cbranch_scc1 ln_b1_kernel_mem0
    s_lshl_b32 s20, s2, 2
    s_add_u32 s20, s20, s13
    s_mul_i32 s21, s20, 1280
    s_add_u32 s21, s21, 226492416
    v_lshlrev_b32 v3, 2, v0
    buffer_load_dword v4, v3, s[8:11], s21 offen offset:0
    buffer_load_dword v5, v3, s[8:11], s21 offen offset:256
    buffer_load_dword v6, v3, s[8:11], s21 offen offset:512
    buffer_load_dword v7, v3, s[8:11], s21 offen offset:768
    buffer_load_dword v8, v3, s[8:11], s21 offen offset:1024
    v_lshrrev_b32 v20, 4, v0
    v_lshlrev_b32 v20, 2, v20
    v_bfe_u32 v21, v0, 3, 1
    v_lshl_add_u32 v20, v21, 1, v20
    v_bfe_u32 v21, v0, 1, 1
    v_add_u32 v20, v20, v21
    v_lshlrev_b32 v20, 9, v20
    v_and_b32 v21, 1, v0
    v_lshl_add_u32 v20, v21, 3, v20
    v_bfe_u32 v21, v0, 2, 1
    v_lshl_add_u32 v23, v21, 2, v20
    s_lshr_b32 s22, s20, 5
    s_mul_i32 s22, s22, 40960
    s_and_b32 s23, s20, 31
    s_lshl_b32 s23, s23, 4
    s_add_u32 s22, s22, s23
    s_add_u32 s22, s22, 220200960
    s_waitcnt vmcnt(0)
    v_lshlrev_b32 v10, 16, v4
    v_and_b32 v11, 0xffff0000, v4
    v_lshlrev_b32 v12, 16, v5
    v_and_b32 v13, 0xffff0000, v5
    v_lshlrev_b32 v14, 16, v6
    v_and_b32 v15, 0xffff0000, v6
    v_lshlrev_b32 v16, 16, v7
    v_and_b32 v17, 0xffff0000, v7
    v_lshlrev_b32 v18, 16, v8
    v_and_b32 v19, 0xffff0000, v8
    v_add_f32 v20, v10, v11
    v_add_f32 v20, v20, v12
    v_add_f32 v20, v20, v13
    v_add_f32 v20, v20, v14
    v_add_f32 v20, v20, v15
    v_add_f32 v20, v20, v16
    v_add_f32 v20, v20, v17
    v_add_f32 v20, v20, v18
    v_add_f32 v20, v20, v19
    s_nop 1
    v_add_f32 v21, v20, v20 quad_perm:[1,0,3,2] row_mask:0xf bank_mask:0xf
    s_nop 1
    v_add_f32 v21, v21, v21 quad_perm:[2,3,0,1] row_mask:0xf bank_mask:0xf
    s_nop 1
    v_add_f32 v21, v21, v21 row_half_mirror row_mask:0xf bank_mask:0xf
    s_nop 1
    v_add_f32 v21, v21, v21 row_mirror row_mask:0xf bank_mask:0xf
    s_nop 1
    v_readlane_b32 s24, v21, 0
    v_readlane_b32 s25, v21, 16
    v_readlane_b32 s26, v21, 32
    v_readlane_b32 s27, v21, 48
    s_nop 1
    v_mov_b32 v20, s24
    v_add_f32 v20, s25, v20
    v_add_f32 v20, s26, v20
    v_add_f32 v20, s27, v20
    v_mul_f32 v20, 0x3acccccd, v20
    v_sub_f32 v10, v10, v20
    v_sub_f32 v11, v11, v20
    v_sub_f32 v12, v12, v20
    v_sub_f32 v13, v13, v20
    v_sub_f32 v14, v14, v20
    v_sub_f32 v15, v15, v20
    v_sub_f32 v16, v16, v20
    v_sub_f32 v17, v17, v20
    v_sub_f32 v18, v18, v20
    v_sub_f32 v19, v19, v20
    v_mul_f32 v21, v10, v10
    v_fmac_f32 v21, v11, v11
    v_fmac_f32 v21, v12, v12
    v_fmac_f32 v21, v13, v13
    v_fmac_f32 v21, v14, v14
    v_fmac_f32 v21, v15, v15
    v_fmac_f32 v21, v16, v16
    v_fmac_f32 v21, v17, v17
    v_fmac_f32 v21, v18, v18
    v_fmac_f32 v21, v19, v19
    s_nop 1
    v_add_f32 v22, v21, v21 quad_perm:[1,0,3,2] row_mask:0xf bank_mask:0xf
    s_nop 1
    v_add_f32 v22, v22, v22 quad_perm:[2,3,0,1] row_mask:0xf bank_mask:0xf
    s_nop 1
    v_add_f32 v22, v22, v22 row_half_mirror row_mask:0xf bank_mask:0xf
    s_nop 1
    v_add_f32 v22, v22, v22 row_mirror row_mask:0xf bank_mask:0xf
    s_nop 1
    v_readlane_b32 s24, v22, 0
    v_readlane_b32 s25, v22, 16
    v_readlane_b32 s26, v22, 32
    v_readlane_b32 s27, v22, 48
    s_nop 1
    v_mov_b32 v21, s24
    v_add_f32 v21, s25, v21
    v_add_f32 v21, s26, v21
    v_add_f32 v21, s27, v21
    v_mov_b32 v22, 0x3727c5ac
    v_fmac_f32 v22, 0x3acccccd, v21
    v_rsq_f32 v22, v22
    s_nop 0
    v_mul_f32 v10, v10, v22
    v_mul_f32 v11, v11, v22
    v_mul_f32 v12, v12, v22
    v_mul_f32 v13, v13, v22
    v_mul_f32 v14, v14, v22
    v_mul_f32 v15, v15, v22
    v_mul_f32 v16, v16, v22
    v_mul_f32 v17, v17, v22
    v_mul_f32 v18, v18, v22
    v_mul_f32 v19, v19, v22
    v_cvt_pk_bf16_f32 v4, v10, v11
    v_cvt_pk_bf16_f32 v5, v12, v13
    v_cvt_pk_bf16_f32 v6, v14, v15
    v_cvt_pk_bf16_f32 v7, v16, v17
    v_cvt_pk_bf16_f32 v8, v18, v19
    s_add_u32 s23, s22, 0
    buffer_store_dword v4, v23, s[8:11], s23 offen
    s_add_u32 s23, s22, 8192
    buffer_store_dword v5, v23, s[8:11], s23 offen
    s_add_u32 s23, s22, 16384
    buffer_store_dword v6, v23, s[8:11], s23 offen
    s_add_u32 s23, s22, 24576
    buffer_store_dword v7, v23, s[8:11], s23 offen
    s_add_u32 s23, s22, 32768
    buffer_store_dword v8, v23, s[8:11], s23 offen
    s_branch ln_b1_kernel_end
ln_b1_kernel_mem0:
    s_mov_b32 s16, s6
    s_mov_b32 s17, s7
    s_mov_b32 s18, 10240
    s_mov_b32 s19, 0x00020000
    s_sub_u32 s22, 0, s4
    s_and_b32 s22, s22, 0x1fffff
    s_mov_b32 s23, 10551296
    s_buffer_load_dword s24, s[8:11], s23
    s_waitcnt lgkmcnt(0)
    s_and_b32 s24, s24, 8192
    s_add_u32 s22, s22, 0
    s_xor_b32 s25, s24, 8192
    s_add_u32 s26, s22, s25
    s_add_u32 s22, s22, s24
    s_lshl_b32 s25, s13, 6
    v_add_u32 v1, s25, v0
    v_add_u32 v2, 0, v1
    v_and_b32 v3, 7, v2
    v_mul_u32_u24 v3, 1280, v3
    v_lshrrev_b32 v4, 3, v2
    v_lshl_add_u32 v3, v4, 4, v3
    v_lshlrev_b32 v5, 4, v2
    v_add_u32 v5, 20480, v5
    v_lshrrev_b32 v6, 13, v5
    v_lshlrev_b32 v6, 14, v6
    v_and_b32 v5, 8191, v5
    v_add_u32 v5, v5, v6
    v_cmp_gt_u32 vcc, 640, v2
    s_and_saveexec_b64 s[30:31], vcc
    s_cbranch_execz ln_b1_kernel_m0s0
    buffer_load_dwordx4 v[8:11], v3, s[16:19], 0 offen
    s_waitcnt vmcnt(0)
    buffer_store_dwordx4 v[8:11], v5, s[8:11], s22 offen
    buffer_store_dwordx4 v[8:11], v5, s[8:11], s26 offen
ln_b1_kernel_m0s0:
    s_mov_b64 exec, s[30:31]
    v_add_u32 v2, 256, v1
    v_and_b32 v3, 7, v2
    v_mul_u32_u24 v3, 1280, v3
    v_lshrrev_b32 v4, 3, v2
    v_lshl_add_u32 v3, v4, 4, v3
    v_lshlrev_b32 v5, 4, v2
    v_add_u32 v5, 20480, v5
    v_lshrrev_b32 v6, 13, v5
    v_lshlrev_b32 v6, 14, v6
    v_and_b32 v5, 8191, v5
    v_add_u32 v5, v5, v6
    v_cmp_gt_u32 vcc, 640, v2
    s_and_saveexec_b64 s[30:31], vcc
    s_cbranch_execz ln_b1_kernel_m0s1
    buffer_load_dwordx4 v[8:11], v3, s[16:19], 0 offen
    s_waitcnt vmcnt(0)
    buffer_store_dwordx4 v[8:11], v5, s[8:11], s22 offen
    buffer_store_dwordx4 v[8:11], v5, s[8:11], s26 offen
ln_b1_kernel_m0s1:
    s_mov_b64 exec, s[30:31]
    v_add_u32 v2, 512, v1
    v_and_b32 v3, 7, v2
    v_mul_u32_u24 v3, 1280, v3
    v_lshrrev_b32 v4, 3, v2
    v_lshl_add_u32 v3, v4, 4, v3
    v_lshlrev_b32 v5, 4, v2
    v_add_u32 v5, 20480, v5
    v_lshrrev_b32 v6, 13, v5
    v_lshlrev_b32 v6, 14, v6
    v_and_b32 v5, 8191, v5
    v_add_u32 v5, v5, v6
    v_cmp_gt_u32 vcc, 640, v2
    s_and_saveexec_b64 s[30:31], vcc
    s_cbranch_execz ln_b1_kernel_m0s2
    buffer_load_dwordx4 v[8:11], v3, s[16:19], 0 offen
    s_waitcnt vmcnt(0)
    buffer_store_dwordx4 v[8:11], v5, s[8:11], s22 offen
    buffer_store_dwordx4 v[8:11], v5, s[8:11], s26 offen
ln_b1_kernel_m0s2:
    s_mov_b64 exec, s[30:31]
ln_b1_kernel_end:
    s_endpgm
.section .rodata,"a"
.p2align 6
.amdhsa_kernel ln_b1_kernel
  .amdhsa_next_free_vgpr 32
  .amdhsa_next_free_sgpr 48
  .amdhsa_accum_offset 32
  .amdhsa_group_segment_fixed_size 0
  .amdhsa_kernarg_size 104
  .amdhsa_user_sgpr_count 2
  .amdhsa_user_sgpr_kernarg_segment_ptr 1
  .amdhsa_system_sgpr_workgroup_id_x 1
.end_amdhsa_kernel
.text
.globl layerb2_kernel
.p2align 8
.type layerb2_kernel,@function
layerb2_kernel:
    s_mov_b32 s49, 1
    s_branch layerb1_kernel_body
    s_endpgm
.section .rodata,"a"
.p2align 6
.amdhsa_kernel layerb2_kernel
  .amdhsa_next_free_vgpr 512
  .amdhsa_next_free_sgpr 100
  .amdhsa_accum_offset 256
  .amdhsa_group_segment_fixed_size 0
  .amdhsa_kernarg_size 104
  .amdhsa_user_sgpr_count 2
  .amdhsa_user_sgpr_kernarg_segment_ptr 1
  .amdhsa_system_sgpr_workgroup_id_x 1
.end_amdhsa_kernel
.text
.globl layerb1_kernel
.p2align 8
.type layerb1_kernel,@function
layerb1_kernel:
    s_mov_b32 s49, 0
layerb1_kernel_body:
    s_cmp_ge_u32 s2, 256
    s_cbranch_scc1 layerb1_kernel_end0
    s_load_dwordx2 s[4:5], s[0:1], 96
    s_load_dwordx2 s[6:7], s[0:1], 80
    v_lshrrev_b32 v1, 6, v0
    v_and_b32 v0, 63, v0
    s_nop 0
    v_readfirstlane_b32 s13, v1
    s_mov_b32 s15, 400000
    s_waitcnt lgkmcnt(0)
    s_mov_b32 s8, s4
    s_mov_b32 s9, s5
    s_mov_b32 s10, 268435456
    s_mov_b32 s11, 0x00020000
    s_add_u32 s22, s4, 247463936
    s_addc_u32 s23, s5, 0
    s_cmp_eq_u32 s49, 0
    s_cselect_b32 s84, s22, s6
    s_cselect_b32 s85, s23, s7
    s_mov_b32 s86, 2621440
    s_mov_b32 s87, 0x00020000
    s_mul_i32 s48, s49, 65536
    s_add_u32 s48, s48, 10616832
    s_lshl_b32 s19, s49, 11
    s_add_u32 s19, s19, 10485760
    s_getreg_b32 s20, hwreg(HW_REG_XCC_ID)
    s_and_b32 s20, s20, 7
    s_cmp_lg_u32 s13, 0
    s_cbranch_scc1 layerb1_kernel_tk_wait
    s_lshl_b32 s22, s20, 8
    s_add_u32 s22, s22, s19
    s_mov_b64 exec, 1
    v_mov_b32 v2, 0
    v_mov_b32 v3, 1
    buffer_atomic_add v3, v2, s[8:11], s22 offen sc0 sc1
    s_waitcnt vmcnt(0)
    s_mov_b64 exec, -1
    s_nop 0
    v_readfirstlane_b32 s21, v3
    s_cmp_lt_u32 s21, 32
    s_cbranch_scc1 layerb1_kernel_tk_pub
    v_lshlrev_b32 v2, 8, v0
    v_and_b32 v2, 0x7ff, v2
    s_mov_b32 s22, s19
layerb1_kernel_tk_poll:
    buffer_load_dword v3, v2, s[8:11], s22 offen sc1
    s_waitcnt vmcnt(0)
    s_mov_b32 s23, 0
    v_readlane_b32 s24, v3, 0
    s_nop 0
    s_add_u32 s23, s23, s24
    v_readlane_b32 s25, v3, 1
    s_nop 0
    s_add_u32 s23, s23, s25
    v_readlane_b32 s26, v3, 2
    s_nop 0
    s_add_u32 s23, s23, s26
    v_readlane_b32 s27, v3, 3
    s_nop 0
    s_add_u32 s23, s23, s27
    v_readlane_b32 s28, v3, 4
    s_nop 0
    s_add_u32 s23, s23, s28
    v_readlane_b32 s29, v3, 5
    s_nop 0
    s_add_u32 s23, s23, s29
    v_readlane_b32 s30, v3, 6
    s_nop 0
    s_add_u32 s23, s23, s30
    v_readlane_b32 s31, v3, 7
    s_nop 0
    s_add_u32 s23, s23, s31
    s_sub_u32 s15, s15, 1
    s_cbranch_scc1 layerb1_kernel_bail
    s_cmp_lt_u32 s23, 256
    s_cbranch_scc1 layerb1_kernel_tk_poll
    s_sub_u32 s21, s21, 32
    s_max_u32 s23, s24, 32
    s_sub_u32 s23, s23, 32
    s_cmp_gt_u32 s20, 0
    s_cselect_b32 s23, s23, 0
    s_add_u32 s21, s21, s23
    s_max_u32 s23, s25, 32
    s_sub_u32 s23, s23, 32
    s_cmp_gt_u32 s20, 1
    s_cselect_b32 s23, s23, 0
    s_add_u32 s21, s21, s23
    s_max_u32 s23, s26, 32
    s_sub_u32 s23, s23, 32
    s_cmp_gt_u32 s20, 2
    s_cselect_b32 s23, s23, 0
    s_add_u32 s21, s21, s23
    s_max_u32 s23, s27, 32
    s_sub_u32 s23, s23, 32
    s_cmp_gt_u32 s20, 3
    s_cselect_b32 s23, s23, 0
    s_add_u32 s21, s21, s23
    s_max_u32 s23, s28, 32
    s_sub_u32 s23, s23, 32
    s_cmp_gt_u32 s20, 4
    s_cselect_b32 s23, s23, 0
    s_add_u32 s21, s21, s23
    s_max_u32 s23, s29, 32
    s_sub_u32 s23, s23, 32
    s_cmp_gt_u32 s20, 5
    s_cselect_b32 s23, s23, 0
    s_add_u32 s21, s21, s23
    s_max_u32 s23, s30, 32
    s_sub_u32 s23, s23, 32
    s_cmp_gt_u32 s20, 6
    s_cselect_b32 s23, s23, 0
    s_add_u32 s21, s21, s23
    s_min_u32 s23, s24, 32
    s_sub_u32 s22, 32, s23
    s_cmp_lt_u32 s21, s22
    s_cbranch_scc0 layerb1_kernel_tk_n0
    s_mov_b32 s20, 0
    s_add_u32 s21, s21, s23
    s_branch layerb1_kernel_tk_pub
layerb1_kernel_tk_n0:
    s_sub_u32 s21, s21, s22
    s_min_u32 s23, s25, 32
    s_sub_u32 s22, 32, s23
    s_cmp_lt_u32 s21, s22
    s_cbranch_scc0 layerb1_kernel_tk_n1
    s_mov_b32 s20, 1
    s_add_u32 s21, s21, s23
    s_branch layerb1_kernel_tk_pub
layerb1_kernel_tk_n1:
    s_sub_u32 s21, s21, s22
    s_min_u32 s23, s26, 32
    s_sub_u32 s22, 32, s23
    s_cmp_lt_u32 s21, s22
    s_cbranch_scc0 layerb1_kernel_tk_n2
    s_mov_b32 s20, 2
    s_add_u32 s21, s21, s23
    s_branch layerb1_kernel_tk_pub
layerb1_kernel_tk_n2:
    s_sub_u32 s21, s21, s22
    s_min_u32 s23, s27, 32
    s_sub_u32 s22, 32, s23
    s_cmp_lt_u32 s21, s22
    s_cbranch_scc0 layerb1_kernel_tk_n3
    s_mov_b32 s20, 3
    s_add_u32 s21, s21, s23
    s_branch layerb1_kernel_tk_pub
layerb1_kernel_tk_n3:
    s_sub_u32 s21, s21, s22
    s_min_u32 s23, s28, 32
    s_sub_u32 s22, 32, s23
    s_cmp_lt_u32 s21, s22
    s_cbranch_scc0 layerb1_kernel_tk_n4
    s_mov_b32 s20, 4
    s_add_u32 s21, s21, s23
    s_branch layerb1_kernel_tk_pub
layerb1_kernel_tk_n4:
    s_sub_u32 s21, s21, s22
    s_min_u32 s23, s29, 32
    s_sub_u32 s22, 32, s23
    s_cmp_lt_u32 s21, s22
    s_cbranch_scc0 layerb1_kernel_tk_n5
    s_mov_b32 s20, 5
    s_add_u32 s21, s21, s23
    s_branch layerb1_kernel_tk_pub
layerb1_kernel_tk_n5:
    s_sub_u32 s21, s21, s22
    s_min_u32 s23, s30, 32
    s_sub_u32 s22, 32, s23
    s_cmp_lt_u32 s21, s22
    s_cbranch_scc0 layerb1_kernel_tk_n6
    s_mov_b32 s20, 6
    s_add_u32 s21, s21, s23
    s_branch layerb1_kernel_tk_pub
layerb1_kernel_tk_n6:
    s_sub_u32 s21, s21, s22
    s_min_u32 s23, s31, 32
    s_sub_u32 s22, 32, s23
    s_cmp_lt_u32 s21, s22
    s_cbranch_scc0 layerb1_kernel_tk_n7
    s_mov_b32 s20, 7
    s_add_u32 s21, s21, s23
    s_branch layerb1_kernel_tk_pub
layerb1_kernel_tk_n7:
    s_sub_u32 s21, s21, s22
    s_branch layerb1_kernel_bail
layerb1_kernel_tk_pub:
    s_lshl_b32 s22, s20, 8
    s_or_b32 s22, s22, s21
    v_mov_b32 v2, 0
    v_mov_b32 v3, s22
    ds_write_b32 v2, v3
    s_waitcnt lgkmcnt(0)
layerb1_kernel_tk_wait:
    s_barrier
    v_mov_b32 v2, 0
    ds_read_b32 v3, v2
    s_waitcnt lgkmcnt(0)
    v_readfirstlane_b32 s22, v3
    s_barrier
    s_lshr_b32 s20, s22, 8
    s_and_b32 s21, s22, 255
    s_sub_u32 s22, 0, s4
    s_and_b32 s22, s22, 0x1fffff
    s_lshl_b32 s23, s49, 3
    s_add_u32 s23, s23, 10551296
    s_buffer_load_dwordx2 s[24:25], s[8:11], s23
    s_waitcnt lgkmcnt(0)
    s_and_b32 s24, s24, 8192
    s_and_b32 s25, s25, 8192
    s_lshl_b32 s82, s24, 1
    s_sub_u32 s82, 8192, s82
    s_lshl_b32 s83, s25, 1
    s_sub_u32 s83, 8192, s83
    s_mul_i32 s23, s49, 4194304
    s_add_u32 s22, s22, s23
    s_add_u32 s16, s22, s24
    s_add_u32 s17, s22, s25
    s_add_u32 s17, s17, 2097152
    s_mov_b32 s40, 0x01010101
    s_mov_b32 s41, 0x01010101
    s_mov_b32 s42, 0x00010001
    s_mov_b32 s43, 0
    v_lshlrev_b32 v1, 4, v0
    v_and_b32 v16, 8, v0
    v_cmp_eq_u32 vcc, 0, v16
    v_mov_b32 v17, 0xeeeeeeee
    v_mov_b32 v18, 0x44444444
    v_cndmask_b32 v2, v17, v18, vcc
    s_cmp_eq_u32 s20, 0
    s_cbranch_scc0 layerb1_kernel_notp
    s_mov_b32 s12, s21
    s_cmp_eq_u32 s13, 0
    s_cbranch_scc1 layerb1_kernel_p0_start
    s_cmp_eq_u32 s13, 1
    s_cbranch_scc1 layerb1_kernel_p1_start
    s_cmp_eq_u32 s13, 2
    s_cbranch_scc1 layerb1_kernel_p2_start
    s_cmp_eq_u32 s13, 3
    s_cbranch_scc1 layerb1_kernel_p3_start
layerb1_kernel_notp:
    s_cmp_ge_u32 s20, 4
    s_cbranch_scc1 layerb1_kernel_proj
    s_cmp_ge_u32 s21, 27
    s_cbranch_scc1 layerb1_kernel_w3
    s_sub_u32 s22, s20, 1
    s_mul_i32 s22, s22, 27
    s_add_u32 s12, s22, s21
    s_cmp_ge_u32 s12, 80
    s_cbranch_scc1 layerb1_kernel_w3
    s_cmp_eq_u32 s13, 0
    s_cbranch_scc1 layerb1_kernel_y0_start
    s_cmp_eq_u32 s13, 1
    s_cbranch_scc1 layerb1_kernel_y1_start
    s_cmp_eq_u32 s13, 2
    s_cbranch_scc1 layerb1_kernel_y2_start
    s_cmp_eq_u32 s13, 3
    s_cbranch_scc1 layerb1_kernel_y3_start
    s_branch layerb1_kernel_end
layerb1_kernel_p0_start:
    v_lshrrev_b32 v16, 4, v0
    v_and_b32 v17, 15, v0
    v_and_b32 v18, 1, v16
    v_lshlrev_b32 v18, 2, v18
    v_lshrrev_b32 v19, 1, v16
    v_lshl_add_u32 v18, v19, 1, v18
    v_mul_u32_u24 v18, 400, v18
    v_lshl_add_u32 v18, v17, 1, v18
    v_add_u32 v3, 133120, v18
    v_and_b32 v18, 7, v0
    v_mul_u32_u24 v18, 400, v18
    v_lshrrev_b32 v19, 3, v0
    v_lshl_add_u32 v18, v19, 4, v18
    v_add_u32 v4, 133120, v18
    v_and_b32 v18, 7, v0
    v_mul_u32_u24 v18, 400, v18
    v_lshl_add_u32 v18, v16, 5, v18
    v_add_u32 v5, 136320, v18
    v_lshrrev_b32 v18, 1, v16
    v_lshlrev_b32 v18, 10, v18
    v_and_b32 v19, 31, v0
    v_lshl_add_u32 v18, v19, 4, v18
    v_add_u32 v6, 139520, v18
    v_add_u32 v15, 139520, v1
    v_lshrrev_b32 v18, 1, v16
    v_lshlrev_b32 v18, 1, v18
    v_lshrrev_b32 v19, 3, v17
    v_add3_u32 v18, v18, v19, 1
    v_lshrrev_b32 v19, 1, v18
    v_lshlrev_b32 v19, 14, v19
    v_and_b32 v18, 1, v18
    v_lshl_add_u32 v18, v18, 12, v19
    v_and_b32 v19, 1, v16
    v_lshlrev_b32 v19, 4, v19
    v_add_u32 v19, 0, v19
    s_lshl_b32 s20, s12, 7
    v_add_u32 v8, s20, v19
    v_add_u32 v7, v8, v18
    v_lshlrev_b32 v18, 4, v17
    v_lshl_add_u32 v18, v16, 10, v18
    v_add_u32 v9, 0, v18
    v_add_u32 v18, 0, v0
    v_mul_u32_u24 v19, 2731, v18
    v_lshrrev_b32 v19, 16, v19
    v_mul_u32_u24 v20, 24, v19
    v_sub_u32 v20, v18, v20
    v_mul_u32_u24 v21, 400, v19
    v_lshl_add_u32 v21, v20, 4, v21
    v_add_u32 v10, 136320, v21
    v_lshlrev_b32 v21, 4, v19
    v_lshl_add_u32 v11, v20, 7, v21
    v_and_b32 v18, 0x28, v0
    v_cmp_eq_u32 vcc, 0, v18
    v_mov_b32 v18, 1.0
    v_mov_b32 v19, 0
    v_cndmask_b32 v12, v19, v18, vcc
    v_add_u32 v13, 0, v1
    v_add_u32 v14, 122880, v1
    s_mul_i32 s44, s12, 12288
    s_add_u32 s44, s44, 53477376
    s_mul_i32 s45, s12, 3072
    s_add_u32 s45, s45, 208666624
    s_mul_i32 s20, s12, 6
    s_add_u32 s21, s20, 5
    s_lshr_b32 s20, s20, 3
    s_lshr_b32 s21, s21, 3
    s_add_u32 s20, s20, 80
    s_add_u32 s21, s21, 80
    s_lshl_b32 s20, s20, 7
    s_lshl_b32 s21, s21, 7
    v_mov_b32 v255, s21
    v_mov_b32 v253, s20
    v_cmp_eq_u32 vcc, 0, v0
    s_nop 1
    v_cndmask_b32 v255, v255, v253, vcc
    s_mov_b32 s47, 0
    s_mul_i32 s20, s12, 491520
    s_add_u32 s20, s20, 11534336
    s_add_u32 s21, s20, 6144
    buffer_load_dwordx4 v[16:19], v1, s[8:11], s21 offen offset:0
    buffer_load_dwordx4 v[20:23], v1, s[8:11], s21 offen offset:1024
    s_add_u32 s21, s20, 47104
    buffer_load_dwordx4 v[24:27], v1, s[8:11], s21 offen offset:0
    buffer_load_dwordx4 v[28:31], v1, s[8:11], s21 offen offset:1024
    s_add_u32 s21, s20, 28672
    buffer_load_dwordx4 v[32:35], v1, s[8:11], s21 offen offset:0
    buffer_load_dwordx4 v[36:39], v1, s[8:11], s21 offen offset:1024
    s_add_u32 s21, s20, 10240
    buffer_load_dwordx4 v[40:43], v1, s[8:11], s21 offen offset:0
    buffer_load_dwordx4 v[44:47], v1, s[8:11], s21 offen offset:1024
    s_add_u32 s21, s20, 51200
    buffer_load_dwordx4 v[48:51], v1, s[8:11], s21 offen offset:0
    buffer_load_dwordx4 v[52:55], v1, s[8:11], s21 offen offset:1024
    s_add_u32 s21, s20, 32768
    buffer_load_dwordx4 v[56:59], v1, s[8:11], s21 offen offset:0
    buffer_load_dwordx4 v[60:63], v1, s[8:11], s21 offen offset:1024
    s_add_u32 s21, s20, 14336
    buffer_load_dwordx4 v[64:67], v1, s[8:11], s21 offen offset:0
    buffer_load_dwordx4 v[68:71], v1, s[8:11], s21 offen offset:1024
    s_add_u32 s21, s20, 55296
    buffer_load_dwordx4 v[72:75], v1, s[8:11], s21 offen offset:0
    buffer_load_dwordx4 v[76:79], v1, s[8:11], s21 offen offset:1024
    s_add_u32 s21, s20, 36864
    buffer_load_dwordx4 v[80:83], v1, s[8:11], s21 offen offset:0
    buffer_load_dwordx4 v[84:87], v1, s[8:11], s21 offen offset:1024
    s_add_u32 s21, s20, 18432
    buffer_load_dwordx4 v[88:91], v1, s[8:11], s21 offen offset:0
    buffer_load_dwordx4 v[92:95], v1, s[8:11], s21 offen offset:1024
    s_add_u32 s21, s20, 59392
    buffer_load_dwordx4 v[96:99], v1, s[8:11], s21 offen offset:0
    buffer_load_dwordx4 v[100:103], v1, s[8:11], s21 offen offset:1024
    s_add_u32 s21, s20, 90112
    buffer_load_dwordx4 v[104:107], v1, s[8:11], s21 offen offset:0
    buffer_load_dwordx4 v[108:111], v1, s[8:11], s21 offen offset:1024
    s_add_u32 s21, s20, 98304
    buffer_load_dwordx4 v[112:115], v1, s[8:11], s21 offen offset:0
    buffer_load_dwordx4 v[116:119], v1, s[8:11], s21 offen offset:1024
    s_add_u32 s21, s20, 106496
    buffer_load_dwordx4 v[120:123], v1, s[8:11], s21 offen offset:0
    buffer_load_dwordx4 v[124:127], v1, s[8:11], s21 offen offset:1024
    s_add_u32 s21, s20, 114688
    buffer_load_dwordx4 v[128:131], v1, s[8:11], s21 offen offset:0
    buffer_load_dwordx4 v[132:135], v1, s[8:11], s21 offen offset:1024
    s_add_u32 s21, s20, 0
    buffer_load_dwordx4 a[0:3], v1, s[8:11], s21 offen offset:0
    buffer_load_dwordx4 a[4:7], v1, s[8:11], s21 offen offset:1024
    s_add_u32 s21, s20, 20480
    buffer_load_dwordx4 a[8:11], v1, s[8:11], s21 offen offset:0
    buffer_load_dwordx4 a[12:15], v1, s[8:11], s21 offen offset:1024
    s_add_u32 s21, s20, 40960
    buffer_load_dwordx4 a[16:19], v1, s[8:11], s21 offen offset:0
    buffer_load_dwordx4 a[20:23], v1, s[8:11], s21 offen offset:1024
    s_add_u32 s21, s20, 2048
    buffer_load_dwordx4 a[24:27], v1, s[8:11], s21 offen offset:0
    buffer_load_dwordx4 a[28:31], v1, s[8:11], s21 offen offset:1024
    s_add_u32 s21, s20, 22528
    buffer_load_dwordx4 a[32:35], v1, s[8:11], s21 offen offset:0
    buffer_load_dwordx4 a[36:39], v1, s[8:11], s21 offen offset:1024
    s_add_u32 s21, s20, 43008
    buffer_load_dwordx4 a[40:43], v1, s[8:11], s21 offen offset:0
    buffer_load_dwordx4 a[44:47], v1, s[8:11], s21 offen offset:1024
    s_add_u32 s21, s20, 4096
    buffer_load_dwordx4 a[48:51], v1, s[8:11], s21 offen offset:0
    buffer_load_dwordx4 a[52:55], v1, s[8:11], s21 offen offset:1024
    s_add_u32 s21, s20, 24576
    buffer_load_dwordx4 a[56:59], v1, s[8:11], s21 offen offset:0
    buffer_load_dwordx4 a[60:63], v1, s[8:11], s21 offen offset:1024
    s_add_u32 s21, s20, 45056
    buffer_load_dwordx4 a[64:67], v1, s[8:11], s21 offen offset:0
    buffer_load_dwordx4 a[68:71], v1, s[8:11], s21 offen offset:1024
    s_add_u32 s21, s20, 26624
    buffer_load_dwordx4 a[72:75], v1, s[8:11], s21 offen offset:0
    buffer_load_dwordx4 a[76:79], v1, s[8:11], s21 offen offset:1024
    s_add_u32 s21, s20, 8192
    buffer_load_dwordx4 a[80:83], v1, s[8:11], s21 offen offset:0
    buffer_load_dwordx4 a[84:87], v1, s[8:11], s21 offen offset:1024
    s_add_u32 s21, s20, 49152
    buffer_load_dwordx4 a[88:91], v1, s[8:11], s21 offen offset:0
    buffer_load_dwordx4 a[92:95], v1, s[8:11], s21 offen offset:1024
    s_add_u32 s21, s20, 30720
    buffer_load_dwordx4 a[96:99], v1, s[8:11], s21 offen offset:0
    buffer_load_dwordx4 a[100:103], v1, s[8:11], s21 offen offset:1024
    s_add_u32 s21, s20, 12288
    buffer_load_dwordx4 a[104:107], v1, s[8:11], s21 offen offset:0
    buffer_load_dwordx4 a[108:111], v1, s[8:11], s21 offen offset:1024
    s_add_u32 s21, s20, 53248
    buffer_load_dwordx4 a[112:115], v1, s[8:11], s21 offen offset:0
    buffer_load_dwordx4 a[116:119], v1, s[8:11], s21 offen offset:1024
    s_add_u32 s21, s20, 34816
    buffer_load_dwordx4 a[120:123], v1, s[8:11], s21 offen offset:0
    buffer_load_dwordx4 a[124:127], v1, s[8:11], s21 offen offset:1024
    s_waitcnt vmcnt(32)
    ds_write_b128 v13, v[16:19] offset:0
    ds_write_b128 v13, v[20:23] offset:1024
    ds_write_b128 v13, v[24:27] offset:2048
    ds_write_b128 v13, v[28:31] offset:3072
    ds_write_b128 v13, v[32:35] offset:4096
    ds_write_b128 v13, v[36:39] offset:5120
    ds_write_b128 v13, v[40:43] offset:6144
    ds_write_b128 v13, v[44:47] offset:7168
    ds_write_b128 v13, v[48:51] offset:8192
    ds_write_b128 v13, v[52:55] offset:9216
    ds_write_b128 v13, v[56:59] offset:10240
    ds_write_b128 v13, v[60:63] offset:11264
    ds_write_b128 v13, v[64:67] offset:12288
    ds_write_b128 v13, v[68:71] offset:13312
    ds_write_b128 v13, v[72:75] offset:14336
    ds_write_b128 v13, v[76:79] offset:15360
    ds_write_b128 v13, v[80:83] offset:16384
    ds_write_b128 v13, v[84:87] offset:17408
    ds_write_b128 v13, v[88:91] offset:18432
    ds_write_b128 v13, v[92:95] offset:19456
    ds_write_b128 v13, v[96:99] offset:20480
    ds_write_b128 v13, v[100:103] offset:21504
    ds_write_b128 v13, v[104:107] offset:22528
    ds_write_b128 v13, v[108:111] offset:23552
    ds_write_b128 v13, v[112:115] offset:24576
    ds_write_b128 v13, v[116:119] offset:25600
    ds_write_b128 v13, v[120:123] offset:26624
    ds_write_b128 v13, v[124:127] offset:27648
    ds_write_b128 v13, v[128:131] offset:28672
    ds_write_b128 v13, v[132:135] offset:29696
    s_add_u32 s21, s20, 16384
    buffer_load_dwordx4 a[128:131], v1, s[8:11], s21 offen offset:0
    buffer_load_dwordx4 a[132:135], v1, s[8:11], s21 offen offset:1024
    s_add_u32 s21, s20, 57344
    buffer_load_dwordx4 a[136:139], v1, s[8:11], s21 offen offset:0
    buffer_load_dwordx4 a[140:143], v1, s[8:11], s21 offen offset:1024
    s_add_u32 s21, s20, 38912
    buffer_load_dwordx4 a[144:147], v1, s[8:11], s21 offen offset:0
    buffer_load_dwordx4 a[148:151], v1, s[8:11], s21 offen offset:1024
    s_add_u32 s21, s20, 61440
    buffer_load_dwordx4 a[152:155], v1, s[8:11], s21 offen offset:0
    buffer_load_dwordx4 a[156:159], v1, s[8:11], s21 offen offset:1024
    s_add_u32 s21, s20, 63488
    buffer_load_dwordx4 a[160:163], v1, s[8:11], s21 offen offset:0
    buffer_load_dwordx4 a[164:167], v1, s[8:11], s21 offen offset:1024
    s_add_u32 s21, s20, 65536
    buffer_load_dwordx4 a[168:171], v1, s[8:11], s21 offen offset:0
    buffer_load_dwordx4 a[172:175], v1, s[8:11], s21 offen offset:1024
    s_add_u32 s21, s20, 67584
    buffer_load_dwordx4 a[176:179], v1, s[8:11], s21 offen offset:0
    buffer_load_dwordx4 a[180:183], v1, s[8:11], s21 offen offset:1024
    s_add_u32 s21, s20, 69632
    buffer_load_dwordx4 a[184:187], v1, s[8:11], s21 offen offset:0
    buffer_load_dwordx4 a[188:191], v1, s[8:11], s21 offen offset:1024
    s_add_u32 s21, s20, 71680
    buffer_load_dwordx4 a[192:195], v1, s[8:11], s21 offen offset:0
    buffer_load_dwordx4 a[196:199], v1, s[8:11], s21 offen offset:1024
    s_add_u32 s21, s20, 73728
    buffer_load_dwordx4 a[200:203], v1, s[8:11], s21 offen offset:0
    buffer_load_dwordx4 a[204:207], v1, s[8:11], s21 offen offset:1024
    s_add_u32 s21, s20, 75776
    buffer_load_dwordx4 a[208:211], v1, s[8:11], s21 offen offset:0
    buffer_load_dwordx4 a[212:215], v1, s[8:11], s21 offen offset:1024
    s_add_u32 s21, s20, 77824
    buffer_load_dwordx4 a[216:219], v1, s[8:11], s21 offen offset:0
    buffer_load_dwordx4 a[220:223], v1, s[8:11], s21 offen offset:1024
    s_add_u32 s21, s20, 79872
    buffer_load_dwordx4 a[224:227], v1, s[8:11], s21 offen offset:0
    buffer_load_dwordx4 a[228:231], v1, s[8:11], s21 offen offset:1024
    s_add_u32 s21, s20, 81920
    buffer_load_dwordx4 a[232:235], v1, s[8:11], s21 offen offset:0
    buffer_load_dwordx4 a[236:239], v1, s[8:11], s21 offen offset:1024
    s_add_u32 s21, s20, 83968
    buffer_load_dwordx4 a[240:243], v1, s[8:11], s21 offen offset:0
    buffer_load_dwordx4 a[244:247], v1, s[8:11], s21 offen offset:1024
    s_add_u32 s21, s20, 86016
    buffer_load_dwordx4 a[248:251], v1, s[8:11], s21 offen offset:0
    buffer_load_dwordx4 a[252:255], v1, s[8:11], s21 offen offset:1024
    s_add_u32 s21, s20, 88064
    buffer_load_dwordx4 v[148:151], v1, s[8:11], s21 offen offset:0
    buffer_load_dwordx4 v[152:155], v1, s[8:11], s21 offen offset:1024
    s_add_u32 s21, s20, 92160
    buffer_load_dwordx4 v[156:159], v1, s[8:11], s21 offen offset:0
    buffer_load_dwordx4 v[160:163], v1, s[8:11], s21 offen offset:1024
    s_add_u32 s21, s20, 94208
    buffer_load_dwordx4 v[164:167], v1, s[8:11], s21 offen offset:0
    buffer_load_dwordx4 v[168:171], v1, s[8:11], s21 offen offset:1024
    s_add_u32 s21, s20, 96256
    buffer_load_dwordx4 v[172:175], v1, s[8:11], s21 offen offset:0
    buffer_load_dwordx4 v[176:179], v1, s[8:11], s21 offen offset:1024
    s_add_u32 s21, s20, 100352
    buffer_load_dwordx4 v[180:183], v1, s[8:11], s21 offen offset:0
    buffer_load_dwordx4 v[184:187], v1, s[8:11], s21 offen offset:1024
    s_add_u32 s21, s20, 102400
    buffer_load_dwordx4 v[188:191], v1, s[8:11], s21 offen offset:0
    buffer_load_dwordx4 v[192:195], v1, s[8:11], s21 offen offset:1024
    s_add_u32 s21, s20, 104448
    buffer_load_dwordx4 v[196:199], v1, s[8:11], s21 offen offset:0
    buffer_load_dwordx4 v[200:203], v1, s[8:11], s21 offen offset:1024
    s_add_u32 s21, s20, 108544
    buffer_load_dwordx4 v[204:207], v1, s[8:11], s21 offen offset:0
    buffer_load_dwordx4 v[208:211], v1, s[8:11], s21 offen offset:1024
    s_add_u32 s21, s20, 110592
    buffer_load_dwordx4 v[212:215], v1, s[8:11], s21 offen offset:0
    buffer_load_dwordx4 v[216:219], v1, s[8:11], s21 offen offset:1024
    s_add_u32 s21, s20, 112640
    buffer_load_dwordx4 v[220:223], v1, s[8:11], s21 offen offset:0
    buffer_load_dwordx4 v[224:227], v1, s[8:11], s21 offen offset:1024
    s_add_u32 s21, s20, 116736
    buffer_load_dwordx4 v[228:231], v1, s[8:11], s21 offen offset:0
    buffer_load_dwordx4 v[232:235], v1, s[8:11], s21 offen offset:1024
    s_add_u32 s21, s20, 118784
    buffer_load_dwordx4 v[236:239], v1, s[8:11], s21 offen offset:0
    buffer_load_dwordx4 v[240:243], v1, s[8:11], s21 offen offset:1024
    s_add_u32 s21, s20, 120832
    buffer_load_dwordx4 v[244:247], v1, s[8:11], s21 offen offset:0
    buffer_load_dwordx4 v[248:251], v1, s[8:11], s21 offen offset:1024
    s_waitcnt lgkmcnt(0)
    s_mov_b32 s14, 0
    s_cmp_gt_u32 s47, s14
    s_cbranch_scc1 layerb1_kernel_p0_gw1_ok
layerb1_kernel_p0_gw1_lp:
    buffer_load_dword v253, v255, s[8:11], s48 offen sc1
    s_waitcnt vmcnt(0)
    v_readlane_b32 s47, v253, 0
    v_readlane_b32 s29, v253, 1
    s_nop 0
    s_min_u32 s47, s47, s29
    s_sub_u32 s15, s15, 1
    s_cbranch_scc1 layerb1_kernel_bail
    s_cmp_gt_u32 s47, s14
    s_cbranch_scc0 layerb1_kernel_p0_gw1_lp
layerb1_kernel_p0_gw1_ok:
    s_mul_i32 s20, s14, 393216
    s_add_u32 s20, s20, s44
    s_add_u32 s21, s20, 0
    buffer_load_dwordx4 v[100:103], v9, s[8:11], s21 offen offset:0 sc1
    buffer_load_dwordx4 v[104:107], v9, s[8:11], s21 offen offset:512 sc1
    s_add_u32 s21, s20, 4096
    buffer_load_dwordx4 v[108:111], v9, s[8:11], s21 offen offset:0 sc1
    buffer_load_dwordx4 v[112:115], v9, s[8:11], s21 offen offset:512 sc1
    v_mov_b32 v56, 0
    v_mov_b32 v57, 0
    v_mov_b32 v58, 0
    v_mov_b32 v59, 0
    v_mov_b32 v60, 0
    v_mov_b32 v61, 0
    v_mov_b32 v62, 0
    v_mov_b32 v63, 0
    v_mov_b32 v64, 0
    v_mov_b32 v65, 0
    v_mov_b32 v66, 0
    v_mov_b32 v67, 0
    v_mov_b32 v68, 0
    v_mov_b32 v69, 0
    v_mov_b32 v70, 0
    v_mov_b32 v71, 0
    v_mov_b32 v72, 0
    v_mov_b32 v73, 0
    v_mov_b32 v74, 0
    v_mov_b32 v75, 0
    v_mov_b32 v76, 0
    v_mov_b32 v77, 0
    v_mov_b32 v78, 0
    v_mov_b32 v79, 0
    v_mov_b32 v80, 0
    v_mov_b32 v81, 0
    v_mov_b32 v82, 0
    v_mov_b32 v83, 0
    v_mov_b32 v84, 0
    v_mov_b32 v85, 0
    v_mov_b32 v86, 0
    v_mov_b32 v87, 0
    ds_read_b128 v[116:119], v13 offset:0
    ds_read_b128 v[120:123], v13 offset:1024
    ds_read_b128 v[124:127], v13 offset:2048
    ds_read_b128 v[128:131], v13 offset:3072
    ds_read_b128 v[132:135], v13 offset:4096
    ds_read_b128 v[136:139], v13 offset:5120
    ds_read_b128 v[140:143], v13 offset:6144
    ds_read_b128 v[144:147], v13 offset:7168
    s_waitcnt lgkmcnt(0)
layerb1_kernel_p0_step:
    s_cmp_lt_u32 s14, 32
    s_cselect_b32 s18, s16, s17
    s_and_b32 s20, s14, 31
    s_lshl_b32 s20, s20, 16
    s_add_u32 s18, s18, s20
    s_add_u32 s22, s18, 36864
    s_add_u32 s23, s18, 37888
    s_add_u32 s24, s18, 38912
layerb1_kernel_p0_poll:
    buffer_load_dwordx4 v[16:19], v1, s[8:11], s22 offen sc1
    buffer_load_dwordx4 v[20:23], v1, s[8:11], s23 offen sc1
    buffer_load_dwordx4 v[24:27], v1, s[8:11], s24 offen sc1
    s_waitcnt vmcnt(0)
    ds_write_b128 v14, v[16:19] offset:0
    ds_write_b128 v14, v[20:23] offset:1024
    ds_write_b128 v14, v[24:27] offset:2048
    v_max3_u32 v88, v16, v17, v18
    v_max3_u32 v88, v88, v19, v20
    v_max3_u32 v88, v88, v21, v22
    v_max3_u32 v88, v88, v23, v24
    v_max3_u32 v88, v88, v25, v26
    v_max_u32 v88, v88, v27
    v_cmp_eq_u32 vcc, -1, v88
    s_sub_u32 s15, s15, 1
    s_cbranch_scc1 layerb1_kernel_bail
    s_cbranch_vccnz layerb1_kernel_p0_poll
    s_waitcnt lgkmcnt(0)
    s_barrier
    ds_read_b128 v[28:31], v14 offset:3072
    ds_read_b128 v[32:35], v14 offset:4096
    ds_read_b128 v[36:39], v14 offset:5120
    ds_read_b128 v[40:43], v14 offset:6144
    ds_read_b128 v[44:47], v14 offset:7168
    ds_read_b128 v[48:51], v14 offset:8192
    ds_read_b128 v[52:55], v14 offset:9216
    v_smfmac_f32_16x16x64_bf16 v[56:59], v[16:19], a[0:7], v2
    v_smfmac_f32_16x16x64_bf16 v[60:63], v[16:19], a[8:15], v2
    v_smfmac_f32_16x16x64_bf16 v[64:67], v[16:19], a[16:23], v2
    v_smfmac_f32_16x16x64_bf16 v[56:59], v[20:23], a[24:31], v2
    v_smfmac_f32_16x16x64_bf16 v[60:63], v[20:23], a[32:39], v2
    v_smfmac_f32_16x16x64_bf16 v[64:67], v[20:23], a[40:47], v2
    v_smfmac_f32_16x16x64_bf16 v[56:59], v[24:27], a[48:55], v2
    v_smfmac_f32_16x16x64_bf16 v[60:63], v[24:27], a[56:63], v2
    v_smfmac_f32_16x16x64_bf16 v[64:67], v[24:27], a[64:71], v2
    s_waitcnt lgkmcnt(6)
    v_smfmac_f32_16x16x64_bf16 v[56:59], v[28:31], v[116:123], v2
    ds_read_b128 v[116:119], v13 offset:8192
    ds_read_b128 v[120:123], v13 offset:9216
    v_smfmac_f32_16x16x64_bf16 v[60:63], v[28:31], a[72:79], v2
    v_smfmac_f32_16x16x64_bf16 v[64:67], v[28:31], v[124:131], v2
    ds_read_b128 v[124:127], v13 offset:10240
    ds_read_b128 v[128:131], v13 offset:11264
    s_waitcnt lgkmcnt(9)
    v_smfmac_f32_16x16x64_bf16 v[56:59], v[32:35], a[80:87], v2
    v_smfmac_f32_16x16x64_bf16 v[60:63], v[32:35], v[132:139], v2
    ds_read_b128 v[132:135], v13 offset:12288
    ds_read_b128 v[136:139], v13 offset:13312
    v_smfmac_f32_16x16x64_bf16 v[64:67], v[32:35], a[88:95], v2
    s_waitcnt lgkmcnt(10)
    v_smfmac_f32_16x16x64_bf16 v[56:59], v[36:39], v[140:147], v2
    ds_read_b128 v[140:143], v13 offset:14336
    ds_read_b128 v[144:147], v13 offset:15360
    v_smfmac_f32_16x16x64_bf16 v[60:63], v[36:39], a[96:103], v2
    s_waitcnt lgkmcnt(6)
    v_smfmac_f32_16x16x64_bf16 v[64:67], v[36:39], v[116:123], v2
    ds_read_b128 v[116:119], v13 offset:16384
    ds_read_b128 v[120:123], v13 offset:17408
    v_smfmac_f32_16x16x64_bf16 v[56:59], v[40:43], a[104:111], v2
    s_waitcnt lgkmcnt(6)
    v_smfmac_f32_16x16x64_bf16 v[60:63], v[40:43], v[124:131], v2
    ds_read_b128 v[124:127], v13 offset:18432
    ds_read_b128 v[128:131], v13 offset:19456
    v_smfmac_f32_16x16x64_bf16 v[64:67], v[40:43], a[112:119], v2
    s_waitcnt lgkmcnt(6)
    v_smfmac_f32_16x16x64_bf16 v[56:59], v[44:47], v[132:139], v2
    ds_read_b128 v[132:135], v13 offset:20480
    ds_read_b128 v[136:139], v13 offset:21504
    v_smfmac_f32_16x16x64_bf16 v[60:63], v[44:47], a[120:127], v2
    s_waitcnt lgkmcnt(6)
    v_smfmac_f32_16x16x64_bf16 v[64:67], v[44:47], v[140:147], v2
    ds_read_b128 v[140:143], v13 offset:22528
    ds_read_b128 v[144:147], v13 offset:23552
    v_smfmac_f32_16x16x64_bf16 v[56:59], v[48:51], a[128:135], v2
    s_waitcnt lgkmcnt(6)
    v_smfmac_f32_16x16x64_bf16 v[60:63], v[48:51], v[116:123], v2
    ds_read_b128 v[116:119], v13 offset:24576
    ds_read_b128 v[120:123], v13 offset:25600
    v_smfmac_f32_16x16x64_bf16 v[64:67], v[48:51], a[136:143], v2
    s_waitcnt lgkmcnt(6)
    v_smfmac_f32_16x16x64_bf16 v[56:59], v[52:55], v[124:131], v2
    ds_read_b128 v[124:127], v13 offset:26624
    ds_read_b128 v[128:131], v13 offset:27648
    v_smfmac_f32_16x16x64_bf16 v[60:63], v[52:55], a[144:151], v2
    s_waitcnt lgkmcnt(6)
    v_smfmac_f32_16x16x64_bf16 v[64:67], v[52:55], v[132:139], v2
    ds_read_b128 v[132:135], v13 offset:28672
    ds_read_b128 v[136:139], v13 offset:29696
    v_smfmac_f32_16x16x64_bf16 v[68:71], v[16:19], a[152:159], v2
    v_smfmac_f32_16x16x64_bf16 v[68:71], v[20:23], a[160:167], v2
    v_permlane32_swap_b32 v56, v58
    v_permlane32_swap_b32 v57, v59
    v_smfmac_f32_16x16x64_bf16 v[68:71], v[24:27], a[168:175], v2
    v_add_f32 v56, v56, v58
    v_add_f32 v57, v57, v59
    v_smfmac_f32_16x16x64_bf16 v[68:71], v[28:31], a[176:183], v2
    v_cvt_pk_bf16_f32 v56, v56, v57
    ds_write_b16 v3, v56 offset:0
    v_smfmac_f32_16x16x64_bf16 v[68:71], v[32:35], a[184:191], v2
    ds_write_b16_d16_hi v3, v56 offset:400
    v_permlane32_swap_b32 v60, v62
    v_smfmac_f32_16x16x64_bf16 v[68:71], v[36:39], a[192:199], v2
    v_permlane32_swap_b32 v61, v63
    v_add_f32 v60, v60, v62
    v_smfmac_f32_16x16x64_bf16 v[68:71], v[40:43], a[200:207], v2
    v_add_f32 v61, v61, v63
    v_cvt_pk_bf16_f32 v60, v60, v61
    v_smfmac_f32_16x16x64_bf16 v[68:71], v[44:47], a[208:215], v2
    ds_write_b16 v3, v60 offset:32
    ds_write_b16_d16_hi v3, v60 offset:432
    v_smfmac_f32_16x16x64_bf16 v[68:71], v[48:51], a[216:223], v2
    v_permlane32_swap_b32 v64, v66
    v_permlane32_swap_b32 v65, v67
    v_smfmac_f32_16x16x64_bf16 v[68:71], v[52:55], a[224:231], v2
    v_add_f32 v64, v64, v66
    v_add_f32 v65, v65, v67
    v_smfmac_f32_16x16x64_bf16 v[72:75], v[16:19], a[232:239], v2
    v_cvt_pk_bf16_f32 v64, v64, v65
    ds_write_b16 v3, v64 offset:64
    v_smfmac_f32_16x16x64_bf16 v[72:75], v[20:23], a[240:247], v2
    ds_write_b16_d16_hi v3, v64 offset:464
    v_smfmac_f32_16x16x64_bf16 v[72:75], v[24:27], a[248:255], v2
    v_smfmac_f32_16x16x64_bf16 v[72:75], v[28:31], v[148:155], v2
    s_waitcnt lgkmcnt(0)
    s_barrier
    ds_read_b128 v[88:91], v4 offset:0
    v_smfmac_f32_16x16x64_bf16 v[72:75], v[32:35], v[140:147], v2
    ds_read_b128 v[92:95], v4 offset:128
    ds_read_b128 v[96:99], v4 offset:256
    v_smfmac_f32_16x16x64_bf16 v[72:75], v[36:39], v[156:163], v2
    v_permlane32_swap_b32 v68, v70
    v_permlane32_swap_b32 v69, v71
    v_smfmac_f32_16x16x64_bf16 v[72:75], v[40:43], v[164:171], v2
    v_add_f32 v68, v68, v70
    v_add_f32 v69, v69, v71
    v_smfmac_f32_16x16x64_bf16 v[72:75], v[44:47], v[172:179], v2
    v_cvt_pk_bf16_f32 v68, v68, v69
    ds_write_b16 v3, v68 offset:3200
    v_smfmac_f32_16x16x64_bf16 v[72:75], v[48:51], v[116:123], v2
    ds_write_b16_d16_hi v3, v68 offset:3600
    v_smfmac_f32_16x16x64_bf16 v[72:75], v[52:55], v[180:187], v2
    s_waitcnt lgkmcnt(2)
    v_smfmac_f32_16x16x64_bf16 v[80:83], v[88:91], v[100:107], v2
    v_smfmac_f32_16x16x64_bf16 v[80:83], v[92:95], v[108:115], v2
    v_smfmac_f32_16x16x64_bf16 v[76:79], v[16:19], v[188:195], v2
    v_smfmac_f32_16x16x64_bf16 v[76:79], v[20:23], v[196:203], v2
    v_smfmac_f32_16x16x64_bf16 v[76:79], v[24:27], v[124:131], v2
    v_permlane32_swap_b32 v72, v74
    v_permlane32_swap_b32 v73, v75
    v_smfmac_f32_16x16x64_bf16 v[76:79], v[28:31], v[204:211], v2
    v_add_f32 v72, v72, v74
    v_add_f32 v73, v73, v75
    ds_write_b128 v15, v[80:83]
    v_smfmac_f32_16x16x64_bf16 v[76:79], v[32:35], v[212:219], v2
    v_cvt_pk_bf16_f32 v72, v72, v73
    ds_write_b16 v3, v72 offset:3232
    v_smfmac_f32_16x16x64_bf16 v[76:79], v[36:39], v[220:227], v2
    ds_write_b16_d16_hi v3, v72 offset:3632
    v_smfmac_f32_16x16x64_bf16 v[76:79], v[40:43], v[132:139], v2
    v_smfmac_f32_16x16x64_bf16 v[76:79], v[44:47], v[228:235], v2
    v_smfmac_f32_16x16x64_bf16 v[76:79], v[48:51], v[236:243], v2
    v_smfmac_f32_16x16x64_bf16 v[76:79], v[52:55], v[244:251], v2
    s_nop 7
    v_permlane32_swap_b32 v76, v78
    v_permlane32_swap_b32 v77, v79
    v_add_f32 v76, v76, v78
    v_add_f32 v77, v77, v79
    v_cvt_pk_bf16_f32 v76, v76, v77
    ds_write_b16 v3, v76 offset:3264
    ds_write_b16_d16_hi v3, v76 offset:3664
    s_waitcnt lgkmcnt(0)
    s_barrier
    ds_read2st64_b32 v[40:41], v6 offset0:0 offset1:2
    ds_read2st64_b32 v[42:43], v6 offset0:8 offset1:10
    ds_read_b128 v[16:19], v5 offset:0
    ds_read_b128 v[20:23], v5 offset:16
    ds_read_b128 v[24:27], v5 offset:128
    ds_read_b128 v[28:31], v5 offset:144
    ds_read_b128 v[32:35], v5 offset:256
    ds_read_b128 v[36:39], v5 offset:272
    s_waitcnt lgkmcnt(6)
    v_add_f32 v40, v40, v41
    v_add_f32 v42, v42, v43
    v_add_f32 v44, v40, v42
    v_mul_f32 v44, 0x3dd53b95, v44
    s_waitcnt lgkmcnt(4)
    v_smfmac_f32_16x16x64_bf16 v[84:87], v[88:91], v[16:23], v2
    s_waitcnt lgkmcnt(2)
    v_smfmac_f32_16x16x64_bf16 v[84:87], v[92:95], v[24:31], v2
    s_waitcnt lgkmcnt(0)
    v_smfmac_f32_16x16x64_bf16 v[84:87], v[96:99], v[32:39], v2
    v_max_f32_dpp v45, v44, v44 row_ror:8 row_mask:0xf bank_mask:0xf
    s_nop 1
    v_max_f32_dpp v45, v45, v45 row_ror:4 row_mask:0xf bank_mask:0xf
    s_nop 1
    v_max_f32_dpp v45, v45, v45 row_ror:2 row_mask:0xf bank_mask:0xf
    s_nop 1
    v_max_f32_dpp v45, v45, v45 row_ror:1 row_mask:0xf bank_mask:0xf
    v_mov_b32 v47, v45
    s_nop 1
    v_permlane32_swap_b32 v45, v47
    v_max_f32 v45, v45, v47
    v_mov_b32 v47, v84
    s_nop 1
    v_permlane32_swap_b32 v84, v47
    v_add_f32 v48, v84, v47
    v_mul_f32 v48, 0x3dd53b95, v48
    s_nop 1
    v_max_f32_dpp v46, v48, v48 row_ror:4 row_mask:0xf bank_mask:0xf
    s_nop 1
    v_max_f32_dpp v46, v46, v46 row_ror:2 row_mask:0xf bank_mask:0xf
    s_nop 1
    v_max_f32_dpp v46, v46, v46 row_ror:1 row_mask:0xf bank_mask:0xf
    v_max_f32 v45, v45, v46
    v_sub_f32 v49, v44, v45
    v_sub_f32 v50, v48, v45
    v_exp_f32 v49, v49
    v_exp_f32 v50, v50
    s_nop 0
    v_fma_f32 v51, v50, v12, v49
    s_nop 1
    v_add_f32_dpp v51, v51, v51 row_ror:8 row_mask:0xf bank_mask:0xf
    s_nop 1
    v_add_f32_dpp v51, v51, v51 row_ror:4 row_mask:0xf bank_mask:0xf
    s_nop 1
    v_add_f32_dpp v51, v51, v51 row_ror:2 row_mask:0xf bank_mask:0xf
    s_nop 1
    v_add_f32_dpp v51, v51, v51 row_ror:1 row_mask:0xf bank_mask:0xf
    v_mov_b32 v47, v51
    s_nop 1
    v_permlane32_swap_b32 v51, v47
    v_add_f32 v51, v51, v47
    v_rcp_f32 v51, v51
    s_nop 0
    v_mul_f32 v49, v49, v51
    v_mul_f32 v50, v50, v51
    s_nop 0
    v_mov_b32_dpp v46, v49 quad_perm:[1,0,3,2] row_mask:0xf bank_mask:0xf
    v_mov_b32_dpp v47, v50 quad_perm:[1,0,3,2] row_mask:0xf bank_mask:0xf
    v_cvt_pk_bf16_f32 v16, v49, v46
    v_cvt_pk_bf16_f32 v20, v50, v47
    s_nop 0
    v_mov_b32_dpp v17, v16 row_shl:2 row_mask:0xf bank_mask:0xf
    v_mov_b32_dpp v18, v16 row_shl:4 row_mask:0xf bank_mask:0xf
    v_mov_b32_dpp v19, v16 row_shl:6 row_mask:0xf bank_mask:0xf
    v_mov_b32_dpp v21, v20 row_shl:2 row_mask:0xf bank_mask:0xf
    v_mov_b32_dpp v22, v20 row_shl:4 row_mask:0xf bank_mask:0xf
    v_mov_b32_dpp v23, v20 row_shl:6 row_mask:0xf bank_mask:0xf
    s_mov_b64 exec, s[40:41]
    buffer_store_dwordx4 v[16:19], v7, s[8:11], s18 offen sc1
    s_mov_b64 exec, s[42:43]
    buffer_store_dwordx4 v[20:23], v8, s[8:11], s18 offen sc1
    s_mov_b64 exec, -1
    ds_read_b128 v[40:43], v10
    s_add_u32 s28, s14, 1
    s_min_u32 s28, s28, 63
    s_cmp_gt_u32 s47, s28
    s_cbranch_scc1 layerb1_kernel_p0_gw2_ok
layerb1_kernel_p0_gw2_lp:
    buffer_load_dword v253, v255, s[8:11], s48 offen sc1
    s_waitcnt vmcnt(0)
    v_readlane_b32 s47, v253, 0
    v_readlane_b32 s29, v253, 1
    s_nop 0
    s_min_u32 s47, s47, s29
    s_sub_u32 s15, s15, 1
    s_cbranch_scc1 layerb1_kernel_bail
    s_cmp_gt_u32 s47, s28
    s_cbranch_scc0 layerb1_kernel_p0_gw2_lp
layerb1_kernel_p0_gw2_ok:
    s_mul_i32 s20, s28, 393216
    s_add_u32 s20, s20, s44
    s_add_u32 s21, s20, 0
    buffer_load_dwordx4 v[100:103], v9, s[8:11], s21 offen offset:0 sc1
    buffer_load_dwordx4 v[104:107], v9, s[8:11], s21 offen offset:512 sc1
    s_add_u32 s21, s20, 4096
    buffer_load_dwordx4 v[108:111], v9, s[8:11], s21 offen offset:0 sc1
    buffer_load_dwordx4 v[112:115], v9, s[8:11], s21 offen offset:512 sc1
    v_mov_b32 v56, 0
    v_mov_b32 v57, 0
    v_mov_b32 v58, 0
    v_mov_b32 v59, 0
    v_mov_b32 v60, 0
    v_mov_b32 v61, 0
    v_mov_b32 v62, 0
    v_mov_b32 v63, 0
    v_mov_b32 v64, 0
    v_mov_b32 v65, 0
    v_mov_b32 v66, 0
    v_mov_b32 v67, 0
    v_mov_b32 v68, 0
    v_mov_b32 v69, 0
    v_mov_b32 v70, 0
    v_mov_b32 v71, 0
    v_mov_b32 v72, 0
    v_mov_b32 v73, 0
    v_mov_b32 v74, 0
    v_mov_b32 v75, 0
    v_mov_b32 v76, 0
    v_mov_b32 v77, 0
    v_mov_b32 v78, 0
    v_mov_b32 v79, 0
    v_mov_b32 v80, 0
    v_mov_b32 v81, 0
    v_mov_b32 v82, 0
    v_mov_b32 v83, 0
    v_mov_b32 v84, 0
    v_mov_b32 v85, 0
    v_mov_b32 v86, 0
    v_mov_b32 v87, 0
    s_waitcnt lgkmcnt(0)
    s_mul_i32 s20, s14, 98304
    s_add_u32 s20, s20, s45
    buffer_store_dwordx4 v[40:43], v11, s[8:11], s20 offen sc1
    ds_read_b128 v[116:119], v13 offset:0
    ds_read_b128 v[120:123], v13 offset:1024
    ds_read_b128 v[124:127], v13 offset:2048
    ds_read_b128 v[128:131], v13 offset:3072
    ds_read_b128 v[132:135], v13 offset:4096
    ds_read_b128 v[136:139], v13 offset:5120
    ds_read_b128 v[140:143], v13 offset:6144
    ds_read_b128 v[144:147], v13 offset:7168
    s_waitcnt lgkmcnt(0)
    s_add_u32 s14, s14, 1
    s_cmp_lt_u32 s14, 64
    s_cbranch_scc1 layerb1_kernel_p0_step
    s_waitcnt vmcnt(0)
    s_barrier
    s_branch layerb1_kernel_end
layerb1_kernel_p1_start:
    v_lshrrev_b32 v16, 4, v0
    v_and_b32 v17, 15, v0
    v_and_b32 v18, 1, v16
    v_lshlrev_b32 v18, 2, v18
    v_lshrrev_b32 v19, 1, v16
    v_lshl_add_u32 v18, v19, 1, v18
    v_mul_u32_u24 v18, 400, v18
    v_lshl_add_u32 v18, v17, 1, v18
    v_add_u32 v3, 133216, v18
    v_and_b32 v18, 7, v0
    v_mul_u32_u24 v18, 400, v18
    v_lshrrev_b32 v19, 3, v0
    v_lshl_add_u32 v18, v19, 4, v18
    v_add_u32 v4, 133120, v18
    v_and_b32 v18, 7, v0
    v_mul_u32_u24 v18, 400, v18
    v_lshl_add_u32 v18, v16, 5, v18
    v_add_u32 v5, 136320, v18
    v_lshrrev_b32 v18, 1, v16
    v_lshlrev_b32 v18, 10, v18
    v_and_b32 v19, 31, v0
    v_lshl_add_u32 v18, v19, 4, v18
    v_add_u32 v6, 139524, v18
    v_add_u32 v15, 140544, v1
    v_lshrrev_b32 v18, 1, v16
    v_lshlrev_b32 v18, 1, v18
    v_lshrrev_b32 v19, 3, v17
    v_add3_u32 v18, v18, v19, 1
    v_lshrrev_b32 v19, 1, v18
    v_lshlrev_b32 v19, 14, v19
    v_and_b32 v18, 1, v18
    v_lshl_add_u32 v18, v18, 12, v19
    v_and_b32 v19, 1, v16
    v_lshlrev_b32 v19, 4, v19
    v_add_u32 v19, 32, v19
    s_lshl_b32 s20, s12, 7
    v_add_u32 v8, s20, v19
    v_add_u32 v7, v8, v18
    v_lshlrev_b32 v18, 4, v17
    v_lshl_add_u32 v18, v16, 10, v18
    v_add_u32 v9, 256, v18
    v_add_u32 v18, 64, v0
    v_mul_u32_u24 v19, 2731, v18
    v_lshrrev_b32 v19, 16, v19
    v_mul_u32_u24 v20, 24, v19
    v_sub_u32 v20, v18, v20
    v_mul_u32_u24 v21, 400, v19
    v_lshl_add_u32 v21, v20, 4, v21
    v_add_u32 v10, 136320, v21
    v_lshlrev_b32 v21, 4, v19
    v_lshl_add_u32 v11, v20, 7, v21
    v_and_b32 v18, 0x28, v0
    v_cmp_eq_u32 vcc, 0, v18
    v_mov_b32 v18, 1.0
    v_mov_b32 v19, 0
    v_cndmask_b32 v12, v19, v18, vcc
    v_add_u32 v13, 30720, v1
    v_add_u32 v14, 122880, v1
    s_mul_i32 s44, s12, 12288
    s_add_u32 s44, s44, 53477376
    s_mul_i32 s45, s12, 3072
    s_add_u32 s45, s45, 208666624
    s_mul_i32 s20, s12, 6
    s_add_u32 s21, s20, 5
    s_lshr_b32 s20, s20, 3
    s_lshr_b32 s21, s21, 3
    s_add_u32 s20, s20, 80
    s_add_u32 s21, s21, 80
    s_lshl_b32 s20, s20, 7
    s_lshl_b32 s21, s21, 7
    v_mov_b32 v255, s21
    v_mov_b32 v253, s20
    v_cmp_eq_u32 vcc, 0, v0
    s_nop 1
    v_cndmask_b32 v255, v255, v253, vcc
    s_mov_b32 s47, 0
    s_mul_i32 s20, s12, 491520
    s_add_u32 s20, s20, 11657216
    s_add_u32 s21, s20, 0
    buffer_load_dwordx4 v[16:19], v1, s[8:11], s21 offen offset:0
    buffer_load_dwordx4 v[20:23], v1, s[8:11], s21 offen offset:1024
    s_add_u32 s21, s20, 40960
    buffer_load_dwordx4 v[24:27], v1, s[8:11], s21 offen offset:0
    buffer_load_dwordx4 v[28:31], v1, s[8:11], s21 offen offset:1024
    s_add_u32 s21, s20, 22528
    buffer_load_dwordx4 v[32:35], v1, s[8:11], s21 offen offset:0
    buffer_load_dwordx4 v[36:39], v1, s[8:11], s21 offen offset:1024
    s_add_u32 s21, s20, 4096
    buffer_load_dwordx4 v[40:43], v1, s[8:11], s21 offen offset:0
    buffer_load_dwordx4 v[44:47], v1, s[8:11], s21 offen offset:1024
    s_add_u32 s21, s20, 45056
    buffer_load_dwordx4 v[48:51], v1, s[8:11], s21 offen offset:0
    buffer_load_dwordx4 v[52:55], v1, s[8:11], s21 offen offset:1024
    s_add_u32 s21, s20, 32768
    buffer_load_dwordx4 v[56:59], v1, s[8:11], s21 offen offset:0
    buffer_load_dwordx4 v[60:63], v1, s[8:11], s21 offen offset:1024
    s_add_u32 s21, s20, 14336
    buffer_load_dwordx4 v[64:67], v1, s[8:11], s21 offen offset:0
    buffer_load_dwordx4 v[68:71], v1, s[8:11], s21 offen offset:1024
    s_add_u32 s21, s20, 55296
    buffer_load_dwordx4 v[72:75], v1, s[8:11], s21 offen offset:0
    buffer_load_dwordx4 v[76:79], v1, s[8:11], s21 offen offset:1024
    s_add_u32 s21, s20, 36864
    buffer_load_dwordx4 v[80:83], v1, s[8:11], s21 offen offset:0
    buffer_load_dwordx4 v[84:87], v1, s[8:11], s21 offen offset:1024
    s_add_u32 s21, s20, 18432
    buffer_load_dwordx4 v[88:91], v1, s[8:11], s21 offen offset:0
    buffer_load_dwordx4 v[92:95], v1, s[8:11], s21 offen offset:1024
    s_add_u32 s21, s20, 59392
    buffer_load_dwordx4 v[96:99], v1, s[8:11], s21 offen offset:0
    buffer_load_dwordx4 v[100:103], v1, s[8:11], s21 offen offset:1024
    s_add_u32 s21, s20, 90112
    buffer_load_dwordx4 v[104:107], v1, s[8:11], s21 offen offset:0
    buffer_load_dwordx4 v[108:111], v1, s[8:11], s21 offen offset:1024
    s_add_u32 s21, s20, 98304
    buffer_load_dwordx4 v[112:115], v1, s[8:11], s21 offen offset:0
    buffer_load_dwordx4 v[116:119], v1, s[8:11], s21 offen offset:1024
    s_add_u32 s21, s20, 106496
    buffer_load_dwordx4 v[120:123], v1, s[8:11], s21 offen offset:0
    buffer_load_dwordx4 v[124:127], v1, s[8:11], s21 offen offset:1024
    s_add_u32 s21, s20, 114688
    buffer_load_dwordx4 v[128:131], v1, s[8:11], s21 offen offset:0
    buffer_load_dwordx4 v[132:135], v1, s[8:11], s21 offen offset:1024
    s_add_u32 s21, s20, 6144
    buffer_load_dwordx4 a[0:3], v1, s[8:11], s21 offen offset:0
    buffer_load_dwordx4 a[4:7], v1, s[8:11], s21 offen offset:1024
    s_add_u32 s21, s20, 26624
    buffer_load_dwordx4 a[8:11], v1, s[8:11], s21 offen offset:0
    buffer_load_dwordx4 a[12:15], v1, s[8:11], s21 offen offset:1024
    s_add_u32 s21, s20, 47104
    buffer_load_dwordx4 a[16:19], v1, s[8:11], s21 offen offset:0
    buffer_load_dwordx4 a[20:23], v1, s[8:11], s21 offen offset:1024
    s_add_u32 s21, s20, 8192
    buffer_load_dwordx4 a[24:27], v1, s[8:11], s21 offen offset:0
    buffer_load_dwordx4 a[28:31], v1, s[8:11], s21 offen offset:1024
    s_add_u32 s21, s20, 28672
    buffer_load_dwordx4 a[32:35], v1, s[8:11], s21 offen offset:0
    buffer_load_dwordx4 a[36:39], v1, s[8:11], s21 offen offset:1024
    s_add_u32 s21, s20, 49152
    buffer_load_dwordx4 a[40:43], v1, s[8:11], s21 offen offset:0
    buffer_load_dwordx4 a[44:47], v1, s[8:11], s21 offen offset:1024
    s_add_u32 s21, s20, 10240
    buffer_load_dwordx4 a[48:51], v1, s[8:11], s21 offen offset:0
    buffer_load_dwordx4 a[52:55], v1, s[8:11], s21 offen offset:1024
    s_add_u32 s21, s20, 30720
    buffer_load_dwordx4 a[56:59], v1, s[8:11], s21 offen offset:0
    buffer_load_dwordx4 a[60:63], v1, s[8:11], s21 offen offset:1024
    s_add_u32 s21, s20, 51200
    buffer_load_dwordx4 a[64:67], v1, s[8:11], s21 offen offset:0
    buffer_load_dwordx4 a[68:71], v1, s[8:11], s21 offen offset:1024
    s_add_u32 s21, s20, 20480
    buffer_load_dwordx4 a[72:75], v1, s[8:11], s21 offen offset:0
    buffer_load_dwordx4 a[76:79], v1, s[8:11], s21 offen offset:1024
    s_add_u32 s21, s20, 2048
    buffer_load_dwordx4 a[80:83], v1, s[8:11], s21 offen offset:0
    buffer_load_dwordx4 a[84:87], v1, s[8:11], s21 offen offset:1024
    s_add_u32 s21, s20, 43008
    buffer_load_dwordx4 a[88:91], v1, s[8:11], s21 offen offset:0
    buffer_load_dwordx4 a[92:95], v1, s[8:11], s21 offen offset:1024
    s_add_u32 s21, s20, 24576
    buffer_load_dwordx4 a[96:99], v1, s[8:11], s21 offen offset:0
    buffer_load_dwordx4 a[100:103], v1, s[8:11], s21 offen offset:1024
    s_add_u32 s21, s20, 12288
    buffer_load_dwordx4 a[104:107], v1, s[8:11], s21 offen offset:0
    buffer_load_dwordx4 a[108:111], v1, s[8:11], s21 offen offset:1024
    s_add_u32 s21, s20, 53248
    buffer_load_dwordx4 a[112:115], v1, s[8:11], s21 offen offset:0
    buffer_load_dwordx4 a[116:119], v1, s[8:11], s21 offen offset:1024
    s_add_u32 s21, s20, 34816
    buffer_load_dwordx4 a[120:123], v1, s[8:11], s21 offen offset:0
    buffer_load_dwordx4 a[124:127], v1, s[8:11], s21 offen offset:1024
    s_waitcnt vmcnt(32)
    ds_write_b128 v13, v[16:19] offset:0
    ds_write_b128 v13, v[20:23] offset:1024
    ds_write_b128 v13, v[24:27] offset:2048
    ds_write_b128 v13, v[28:31] offset:3072
    ds_write_b128 v13, v[32:35] offset:4096
    ds_write_b128 v13, v[36:39] offset:5120
    ds_write_b128 v13, v[40:43] offset:6144
    ds_write_b128 v13, v[44:47] offset:7168
    ds_write_b128 v13, v[48:51] offset:8192
    ds_write_b128 v13, v[52:55] offset:9216
    ds_write_b128 v13, v[56:59] offset:10240
    ds_write_b128 v13, v[60:63] offset:11264
    ds_write_b128 v13, v[64:67] offset:12288
    ds_write_b128 v13, v[68:71] offset:13312
    ds_write_b128 v13, v[72:75] offset:14336
    ds_write_b128 v13, v[76:79] offset:15360
    ds_write_b128 v13, v[80:83] offset:16384
    ds_write_b128 v13, v[84:87] offset:17408
    ds_write_b128 v13, v[88:91] offset:18432
    ds_write_b128 v13, v[92:95] offset:19456
    ds_write_b128 v13, v[96:99] offset:20480
    ds_write_b128 v13, v[100:103] offset:21504
    ds_write_b128 v13, v[104:107] offset:22528
    ds_write_b128 v13, v[108:111] offset:23552
    ds_write_b128 v13, v[112:115] offset:24576
    ds_write_b128 v13, v[116:119] offset:25600
    ds_write_b128 v13, v[120:123] offset:26624
    ds_write_b128 v13, v[124:127] offset:27648
    ds_write_b128 v13, v[128:131] offset:28672
    ds_write_b128 v13, v[132:135] offset:29696
    s_add_u32 s21, s20, 16384
    buffer_load_dwordx4 a[128:131], v1, s[8:11], s21 offen offset:0
    buffer_load_dwordx4 a[132:135], v1, s[8:11], s21 offen offset:1024
    s_add_u32 s21, s20, 57344
    buffer_load_dwordx4 a[136:139], v1, s[8:11], s21 offen offset:0
    buffer_load_dwordx4 a[140:143], v1, s[8:11], s21 offen offset:1024
    s_add_u32 s21, s20, 38912
    buffer_load_dwordx4 a[144:147], v1, s[8:11], s21 offen offset:0
    buffer_load_dwordx4 a[148:151], v1, s[8:11], s21 offen offset:1024
    s_add_u32 s21, s20, 61440
    buffer_load_dwordx4 a[152:155], v1, s[8:11], s21 offen offset:0
    buffer_load_dwordx4 a[156:159], v1, s[8:11], s21 offen offset:1024
    s_add_u32 s21, s20, 63488
    buffer_load_dwordx4 a[160:163], v1, s[8:11], s21 offen offset:0
    buffer_load_dwordx4 a[164:167], v1, s[8:11], s21 offen offset:1024
    s_add_u32 s21, s20, 65536
    buffer_load_dwordx4 a[168:171], v1, s[8:11], s21 offen offset:0
    buffer_load_dwordx4 a[172:175], v1, s[8:11], s21 offen offset:1024
    s_add_u32 s21, s20, 67584
    buffer_load_dwordx4 a[176:179], v1, s[8:11], s21 offen offset:0
    buffer_load_dwordx4 a[180:183], v1, s[8:11], s21 offen offset:1024
    s_add_u32 s21, s20, 69632
    buffer_load_dwordx4 a[184:187], v1, s[8:11], s21 offen offset:0
    buffer_load_dwordx4 a[188:191], v1, s[8:11], s21 offen offset:1024
    s_add_u32 s21, s20, 71680
    buffer_load_dwordx4 a[192:195], v1, s[8:11], s21 offen offset:0
    buffer_load_dwordx4 a[196:199], v1, s[8:11], s21 offen offset:1024
    s_add_u32 s21, s20, 73728
    buffer_load_dwordx4 a[200:203], v1, s[8:11], s21 offen offset:0
    buffer_load_dwordx4 a[204:207], v1, s[8:11], s21 offen offset:1024
    s_add_u32 s21, s20, 75776
    buffer_load_dwordx4 a[208:211], v1, s[8:11], s21 offen offset:0
    buffer_load_dwordx4 a[212:215], v1, s[8:11], s21 offen offset:1024
    s_add_u32 s21, s20, 77824
    buffer_load_dwordx4 a[216:219], v1, s[8:11], s21 offen offset:0
    buffer_load_dwordx4 a[220:223], v1, s[8:11], s21 offen offset:1024
    s_add_u32 s21, s20, 79872
    buffer_load_dwordx4 a[224:227], v1, s[8:11], s21 offen offset:0
    buffer_load_dwordx4 a[228:231], v1, s[8:11], s21 offen offset:1024
    s_add_u32 s21, s20, 81920
    buffer_load_dwordx4 a[232:235], v1, s[8:11], s21 offen offset:0
    buffer_load_dwordx4 a[236:239], v1, s[8:11], s21 offen offset:1024
    s_add_u32 s21, s20, 83968
    buffer_load_dwordx4 a[240:243], v1, s[8:11], s21 offen offset:0
    buffer_load_dwordx4 a[244:247], v1, s[8:11], s21 offen offset:1024
    s_add_u32 s21, s20, 86016
    buffer_load_dwordx4 a[248:251], v1, s[8:11], s21 offen offset:0
    buffer_load_dwordx4 a[252:255], v1, s[8:11], s21 offen offset:1024
    s_add_u32 s21, s20, 88064
    buffer_load_dwordx4 v[148:151], v1, s[8:11], s21 offen offset:0
    buffer_load_dwordx4 v[152:155], v1, s[8:11], s21 offen offset:1024
    s_add_u32 s21, s20, 92160
    buffer_load_dwordx4 v[156:159], v1, s[8:11], s21 offen offset:0
    buffer_load_dwordx4 v[160:163], v1, s[8:11], s21 offen offset:1024
    s_add_u32 s21, s20, 94208
    buffer_load_dwordx4 v[164:167], v1, s[8:11], s21 offen offset:0
    buffer_load_dwordx4 v[168:171], v1, s[8:11], s21 offen offset:1024
    s_add_u32 s21, s20, 96256
    buffer_load_dwordx4 v[172:175], v1, s[8:11], s21 offen offset:0
    buffer_load_dwordx4 v[176:179], v1, s[8:11], s21 offen offset:1024
    s_add_u32 s21, s20, 100352
    buffer_load_dwordx4 v[180:183], v1, s[8:11], s21 offen offset:0
    buffer_load_dwordx4 v[184:187], v1, s[8:11], s21 offen offset:1024
    s_add_u32 s21, s20, 102400
    buffer_load_dwordx4 v[188:191], v1, s[8:11], s21 offen offset:0
    buffer_load_dwordx4 v[192:195], v1, s[8:11], s21 offen offset:1024
    s_add_u32 s21, s20, 104448
    buffer_load_dwordx4 v[196:199], v1, s[8:11], s21 offen offset:0
    buffer_load_dwordx4 v[200:203], v1, s[8:11], s21 offen offset:1024
    s_add_u32 s21, s20, 108544
    buffer_load_dwordx4 v[204:207], v1, s[8:11], s21 offen offset:0
    buffer_load_dwordx4 v[208:211], v1, s[8:11], s21 offen offset:1024
    s_add_u32 s21, s20, 110592
    buffer_load_dwordx4 v[212:215], v1, s[8:11], s21 offen offset:0
    buffer_load_dwordx4 v[216:219], v1, s[8:11], s21 offen offset:1024
    s_add_u32 s21, s20, 112640
    buffer_load_dwordx4 v[220:223], v1, s[8:11], s21 offen offset:0
    buffer_load_dwordx4 v[224:227], v1, s[8:11], s21 offen offset:1024
    s_add_u32 s21, s20, 116736
    buffer_load_dwordx4 v[228:231], v1, s[8:11], s21 offen offset:0
    buffer_load_dwordx4 v[232:235], v1, s[8:11], s21 offen offset:1024
    s_add_u32 s21, s20, 118784
    buffer_load_dwordx4 v[236:239], v1, s[8:11], s21 offen offset:0
    buffer_load_dwordx4 v[240:243], v1, s[8:11], s21 offen offset:1024
    s_add_u32 s21, s20, 120832
    buffer_load_dwordx4 v[244:247], v1, s[8:11], s21 offen offset:0
    buffer_load_dwordx4 v[248:251], v1, s[8:11], s21 offen offset:1024
    s_waitcnt lgkmcnt(0)
    s_mov_b32 s14, 0
    s_cmp_gt_u32 s47, s14
    s_cbranch_scc1 layerb1_kernel_p1_gw1_ok
layerb1_kernel_p1_gw1_lp:
    buffer_load_dword v253, v255, s[8:11], s48 offen sc1
    s_waitcnt vmcnt(0)
    v_readlane_b32 s47, v253, 0
    v_readlane_b32 s29, v253, 1
    s_nop 0
    s_min_u32 s47, s47, s29
    s_sub_u32 s15, s15, 1
    s_cbranch_scc1 layerb1_kernel_bail
    s_cmp_gt_u32 s47, s14
    s_cbranch_scc0 layerb1_kernel_p1_gw1_lp
layerb1_kernel_p1_gw1_ok:
    s_mul_i32 s20, s14, 393216
    s_add_u32 s20, s20, s44
    s_add_u32 s21, s20, 0
    buffer_load_dwordx4 v[100:103], v9, s[8:11], s21 offen offset:0 sc1
    buffer_load_dwordx4 v[104:107], v9, s[8:11], s21 offen offset:512 sc1
    s_add_u32 s21, s20, 4096
    buffer_load_dwordx4 v[108:111], v9, s[8:11], s21 offen offset:0 sc1
    buffer_load_dwordx4 v[112:115], v9, s[8:11], s21 offen offset:512 sc1
    v_mov_b32 v56, 0
    v_mov_b32 v57, 0
    v_mov_b32 v58, 0
    v_mov_b32 v59, 0
    v_mov_b32 v60, 0
    v_mov_b32 v61, 0
    v_mov_b32 v62, 0
    v_mov_b32 v63, 0
    v_mov_b32 v64, 0
    v_mov_b32 v65, 0
    v_mov_b32 v66, 0
    v_mov_b32 v67, 0
    v_mov_b32 v68, 0
    v_mov_b32 v69, 0
    v_mov_b32 v70, 0
    v_mov_b32 v71, 0
    v_mov_b32 v72, 0
    v_mov_b32 v73, 0
    v_mov_b32 v74, 0
    v_mov_b32 v75, 0
    v_mov_b32 v76, 0
    v_mov_b32 v77, 0
    v_mov_b32 v78, 0
    v_mov_b32 v79, 0
    v_mov_b32 v80, 0
    v_mov_b32 v81, 0
    v_mov_b32 v82, 0
    v_mov_b32 v83, 0
    v_mov_b32 v84, 0
    v_mov_b32 v85, 0
    v_mov_b32 v86, 0
    v_mov_b32 v87, 0
    ds_read_b128 v[116:119], v13 offset:0
    ds_read_b128 v[120:123], v13 offset:1024
    ds_read_b128 v[124:127], v13 offset:2048
    ds_read_b128 v[128:131], v13 offset:3072
    ds_read_b128 v[132:135], v13 offset:4096
    ds_read_b128 v[136:139], v13 offset:5120
    ds_read_b128 v[140:143], v13 offset:6144
    ds_read_b128 v[144:147], v13 offset:7168
    s_waitcnt lgkmcnt(0)
layerb1_kernel_p1_step:
    s_cmp_lt_u32 s14, 32
    s_cselect_b32 s18, s16, s17
    s_and_b32 s20, s14, 31
    s_lshl_b32 s20, s20, 16
    s_add_u32 s18, s18, s20
    s_add_u32 s22, s18, 39936
    s_add_u32 s23, s18, 49152
    s_add_u32 s24, s18, 50176
layerb1_kernel_p1_poll:
    buffer_load_dwordx4 v[28:31], v1, s[8:11], s22 offen sc1
    buffer_load_dwordx4 v[32:35], v1, s[8:11], s23 offen sc1
    buffer_load_dwordx4 v[36:39], v1, s[8:11], s24 offen sc1
    s_waitcnt vmcnt(0)
    ds_write_b128 v14, v[28:31] offset:3072
    ds_write_b128 v14, v[32:35] offset:4096
    ds_write_b128 v14, v[36:39] offset:5120
    v_max3_u32 v88, v28, v29, v30
    v_max3_u32 v88, v88, v31, v32
    v_max3_u32 v88, v88, v33, v34
    v_max3_u32 v88, v88, v35, v36
    v_max3_u32 v88, v88, v37, v38
    v_max_u32 v88, v88, v39
    v_cmp_eq_u32 vcc, -1, v88
    s_sub_u32 s15, s15, 1
    s_cbranch_scc1 layerb1_kernel_bail
    s_cbranch_vccnz layerb1_kernel_p1_poll
    s_waitcnt lgkmcnt(0)
    s_barrier
    ds_read_b128 v[16:19], v14 offset:0
    ds_read_b128 v[20:23], v14 offset:1024
    ds_read_b128 v[24:27], v14 offset:2048
    ds_read_b128 v[40:43], v14 offset:6144
    ds_read_b128 v[44:47], v14 offset:7168
    ds_read_b128 v[48:51], v14 offset:8192
    ds_read_b128 v[52:55], v14 offset:9216
    v_smfmac_f32_16x16x64_bf16 v[56:59], v[28:31], a[0:7], v2
    v_smfmac_f32_16x16x64_bf16 v[60:63], v[28:31], a[8:15], v2
    v_smfmac_f32_16x16x64_bf16 v[64:67], v[28:31], a[16:23], v2
    v_smfmac_f32_16x16x64_bf16 v[56:59], v[32:35], a[24:31], v2
    v_smfmac_f32_16x16x64_bf16 v[60:63], v[32:35], a[32:39], v2
    v_smfmac_f32_16x16x64_bf16 v[64:67], v[32:35], a[40:47], v2
    v_smfmac_f32_16x16x64_bf16 v[56:59], v[36:39], a[48:55], v2
    v_smfmac_f32_16x16x64_bf16 v[60:63], v[36:39], a[56:63], v2
    v_smfmac_f32_16x16x64_bf16 v[64:67], v[36:39], a[64:71], v2
    s_waitcnt lgkmcnt(6)
    v_smfmac_f32_16x16x64_bf16 v[56:59], v[16:19], v[116:123], v2
    ds_read_b128 v[116:119], v13 offset:8192
    ds_read_b128 v[120:123], v13 offset:9216
    v_smfmac_f32_16x16x64_bf16 v[60:63], v[16:19], a[72:79], v2
    v_smfmac_f32_16x16x64_bf16 v[64:67], v[16:19], v[124:131], v2
    ds_read_b128 v[124:127], v13 offset:10240
    ds_read_b128 v[128:131], v13 offset:11264
    s_waitcnt lgkmcnt(9)
    v_smfmac_f32_16x16x64_bf16 v[56:59], v[20:23], a[80:87], v2
    v_smfmac_f32_16x16x64_bf16 v[60:63], v[20:23], v[132:139], v2
    ds_read_b128 v[132:135], v13 offset:12288
    ds_read_b128 v[136:139], v13 offset:13312
    v_smfmac_f32_16x16x64_bf16 v[64:67], v[20:23], a[88:95], v2
    s_waitcnt lgkmcnt(10)
    v_smfmac_f32_16x16x64_bf16 v[56:59], v[24:27], v[140:147], v2
    ds_read_b128 v[140:143], v13 offset:14336
    ds_read_b128 v[144:147], v13 offset:15360
    v_smfmac_f32_16x16x64_bf16 v[60:63], v[24:27], a[96:103], v2
    s_waitcnt lgkmcnt(6)
    v_smfmac_f32_16x16x64_bf16 v[64:67], v[24:27], v[116:123], v2
    ds_read_b128 v[116:119], v13 offset:16384
    ds_read_b128 v[120:123], v13 offset:17408
    v_smfmac_f32_16x16x64_bf16 v[56:59], v[40:43], a[104:111], v2
    s_waitcnt lgkmcnt(6)
    v_smfmac_f32_16x16x64_bf16 v[60:63], v[40:43], v[124:131], v2
    ds_read_b128 v[124:127], v13 offset:18432
    ds_read_b128 v[128:131], v13 offset:19456
    v_smfmac_f32_16x16x64_bf16 v[64:67], v[40:43], a[112:119], v2
    s_waitcnt lgkmcnt(6)
    v_smfmac_f32_16x16x64_bf16 v[56:59], v[44:47], v[132:139], v2
    ds_read_b128 v[132:135], v13 offset:20480
    ds_read_b128 v[136:139], v13 offset:21504
    v_smfmac_f32_16x16x64_bf16 v[60:63], v[44:47], a[120:127], v2
    s_waitcnt lgkmcnt(6)
    v_smfmac_f32_16x16x64_bf16 v[64:67], v[44:47], v[140:147], v2
    ds_read_b128 v[140:143], v13 offset:22528
    ds_read_b128 v[144:147], v13 offset:23552
    v_smfmac_f32_16x16x64_bf16 v[56:59], v[48:51], a[128:135], v2
    s_waitcnt lgkmcnt(6)
    v_smfmac_f32_16x16x64_bf16 v[60:63], v[48:51], v[116:123], v2
    ds_read_b128 v[116:119], v13 offset:24576
    ds_read_b128 v[120:123], v13 offset:25600
    v_smfmac_f32_16x16x64_bf16 v[64:67], v[48:51], a[136:143], v2
    s_waitcnt lgkmcnt(6)
    v_smfmac_f32_16x16x64_bf16 v[56:59], v[52:55], v[124:131], v2
    ds_read_b128 v[124:127], v13 offset:26624
    ds_read_b128 v[128:131], v13 offset:27648
    v_smfmac_f32_16x16x64_bf16 v[60:63], v[52:55], a[144:151], v2
    s_waitcnt lgkmcnt(6)
    v_smfmac_f32_16x16x64_bf16 v[64:67], v[52:55], v[132:139], v2
    ds_read_b128 v[132:135], v13 offset:28672
    ds_read_b128 v[136:139], v13 offset:29696
    v_smfmac_f32_16x16x64_bf16 v[68:71], v[16:19], a[152:159], v2
    v_smfmac_f32_16x16x64_bf16 v[68:71], v[20:23], a[160:167], v2
    v_permlane32_swap_b32 v56, v58
    v_permlane32_swap_b32 v57, v59
    v_smfmac_f32_16x16x64_bf16 v[68:71], v[24:27], a[168:175], v2
    v_add_f32 v56, v56, v58
    v_add_f32 v57, v57, v59
    v_smfmac_f32_16x16x64_bf16 v[68:71], v[28:31], a[176:183], v2
    v_cvt_pk_bf16_f32 v56, v56, v57
    ds_write_b16 v3, v56 offset:0
    v_smfmac_f32_16x16x64_bf16 v[68:71], v[32:35], a[184:191], v2
    ds_write_b16_d16_hi v3, v56 offset:400
    v_permlane32_swap_b32 v60, v62
    v_smfmac_f32_16x16x64_bf16 v[68:71], v[36:39], a[192:199], v2
    v_permlane32_swap_b32 v61, v63
    v_add_f32 v60, v60, v62
    v_smfmac_f32_16x16x64_bf16 v[68:71], v[40:43], a[200:207], v2
    v_add_f32 v61, v61, v63
    v_cvt_pk_bf16_f32 v60, v60, v61
    v_smfmac_f32_16x16x64_bf16 v[68:71], v[44:47], a[208:215], v2
    ds_write_b16 v3, v60 offset:32
    ds_write_b16_d16_hi v3, v60 offset:432
    v_smfmac_f32_16x16x64_bf16 v[68:71], v[48:51], a[216:223], v2
    v_permlane32_swap_b32 v64, v66
    v_permlane32_swap_b32 v65, v67
    v_smfmac_f32_16x16x64_bf16 v[68:71], v[52:55], a[224:231], v2
    v_add_f32 v64, v64, v66
    v_add_f32 v65, v65, v67
    v_smfmac_f32_16x16x64_bf16 v[72:75], v[16:19], a[232:239], v2
    v_cvt_pk_bf16_f32 v64, v64, v65
    ds_write_b16 v3, v64 offset:64
    v_smfmac_f32_16x16x64_bf16 v[72:75], v[20:23], a[240:247], v2
    ds_write_b16_d16_hi v3, v64 offset:464
    v_smfmac_f32_16x16x64_bf16 v[72:75], v[24:27], a[248:255], v2
    v_smfmac_f32_16x16x64_bf16 v[72:75], v[28:31], v[148:155], v2
    s_waitcnt lgkmcnt(0)
    s_barrier
    ds_read_b128 v[88:91], v4 offset:0
    v_smfmac_f32_16x16x64_bf16 v[72:75], v[32:35], v[140:147], v2
    ds_read_b128 v[92:95], v4 offset:128
    ds_read_b128 v[96:99], v4 offset:256
    v_smfmac_f32_16x16x64_bf16 v[72:75], v[36:39], v[156:163], v2
    v_permlane32_swap_b32 v68, v70
    v_permlane32_swap_b32 v69, v71
    v_smfmac_f32_16x16x64_bf16 v[72:75], v[40:43], v[164:171], v2
    v_add_f32 v68, v68, v70
    v_add_f32 v69, v69, v71
    v_smfmac_f32_16x16x64_bf16 v[72:75], v[44:47], v[172:179], v2
    v_cvt_pk_bf16_f32 v68, v68, v69
    ds_write_b16 v3, v68 offset:3200
    v_smfmac_f32_16x16x64_bf16 v[72:75], v[48:51], v[116:123], v2
    ds_write_b16_d16_hi v3, v68 offset:3600
    v_smfmac_f32_16x16x64_bf16 v[72:75], v[52:55], v[180:187], v2
    s_waitcnt lgkmcnt(2)
    v_smfmac_f32_16x16x64_bf16 v[80:83], v[88:91], v[100:107], v2
    v_smfmac_f32_16x16x64_bf16 v[80:83], v[92:95], v[108:115], v2
    v_smfmac_f32_16x16x64_bf16 v[76:79], v[16:19], v[188:195], v2
    v_smfmac_f32_16x16x64_bf16 v[76:79], v[20:23], v[196:203], v2
    v_smfmac_f32_16x16x64_bf16 v[76:79], v[24:27], v[124:131], v2
    v_permlane32_swap_b32 v72, v74
    v_permlane32_swap_b32 v73, v75
    v_smfmac_f32_16x16x64_bf16 v[76:79], v[28:31], v[204:211], v2
    v_add_f32 v72, v72, v74
    v_add_f32 v73, v73, v75
    ds_write_b128 v15, v[80:83]
    v_smfmac_f32_16x16x64_bf16 v[76:79], v[32:35], v[212:219], v2
    v_cvt_pk_bf16_f32 v72, v72, v73
    ds_write_b16 v3, v72 offset:3232
    v_smfmac_f32_16x16x64_bf16 v[76:79], v[36:39], v[220:227], v2
    ds_write_b16_d16_hi v3, v72 offset:3632
    v_smfmac_f32_16x16x64_bf16 v[76:79], v[40:43], v[132:139], v2
    v_smfmac_f32_16x16x64_bf16 v[76:79], v[44:47], v[228:235], v2
    v_smfmac_f32_16x16x64_bf16 v[76:79], v[48:51], v[236:243], v2
    v_smfmac_f32_16x16x64_bf16 v[76:79], v[52:55], v[244:251], v2
    s_nop 7
    v_permlane32_swap_b32 v76, v78
    v_permlane32_swap_b32 v77, v79
    v_add_f32 v76, v76, v78
    v_add_f32 v77, v77, v79
    v_cvt_pk_bf16_f32 v76, v76, v77
    ds_write_b16 v3, v76 offset:3264
    ds_write_b16_d16_hi v3, v76 offset:3664
    s_waitcnt lgkmcnt(0)
    s_barrier
    ds_read2st64_b32 v[40:41], v6 offset0:0 offset1:2
    ds_read2st64_b32 v[42:43], v6 offset0:8 offset1:10
    ds_read_b128 v[16:19], v5 offset:0
    ds_read_b128 v[20:23], v5 offset:16
    ds_read_b128 v[24:27], v5 offset:128
    ds_read_b128 v[28:31], v5 offset:144
    ds_read_b128 v[32:35], v5 offset:256
    ds_read_b128 v[36:39], v5 offset:272
    s_waitcnt lgkmcnt(6)
    v_add_f32 v40, v40, v41
    v_add_f32 v42, v42, v43
    v_add_f32 v44, v40, v42
    v_mul_f32 v44, 0x3dd53b95, v44
    s_waitcnt lgkmcnt(4)
    v_smfmac_f32_16x16x64_bf16 v[84:87], v[88:91], v[16:23], v2
    s_waitcnt lgkmcnt(2)
    v_smfmac_f32_16x16x64_bf16 v[84:87], v[92:95], v[24:31], v2
    s_waitcnt lgkmcnt(0)
    v_smfmac_f32_16x16x64_bf16 v[84:87], v[96:99], v[32:39], v2
    v_max_f32_dpp v45, v44, v44 row_ror:8 row_mask:0xf bank_mask:0xf
    s_nop 1
    v_max_f32_dpp v45, v45, v45 row_ror:4 row_mask:0xf bank_mask:0xf
    s_nop 1
    v_max_f32_dpp v45, v45, v45 row_ror:2 row_mask:0xf bank_mask:0xf
    s_nop 1
    v_max_f32_dpp v45, v45, v45 row_ror:1 row_mask:0xf bank_mask:0xf
    v_mov_b32 v47, v45
    s_nop 1
    v_permlane32_swap_b32 v45, v47
    v_max_f32 v45, v45, v47
    v_mov_b32 v47, v85
    s_nop 1
    v_permlane32_swap_b32 v85, v47
    v_add_f32 v48, v85, v47
    v_mul_f32 v48, 0x3dd53b95, v48
    s_nop 1
    v_max_f32_dpp v46, v48, v48 row_ror:4 row_mask:0xf bank_mask:0xf
    s_nop 1
    v_max_f32_dpp v46, v46, v46 row_ror:2 row_mask:0xf bank_mask:0xf
    s_nop 1
    v_max_f32_dpp v46, v46, v46 row_ror:1 row_mask:0xf bank_mask:0xf
    v_max_f32 v45, v45, v46
    v_sub_f32 v49, v44, v45
    v_sub_f32 v50, v48, v45
    v_exp_f32 v49, v49
    v_exp_f32 v50, v50
    s_nop 0
    v_fma_f32 v51, v50, v12, v49
    s_nop 1
    v_add_f32_dpp v51, v51, v51 row_ror:8 row_mask:0xf bank_mask:0xf
    s_nop 1
    v_add_f32_dpp v51, v51, v51 row_ror:4 row_mask:0xf bank_mask:0xf
    s_nop 1
    v_add_f32_dpp v51, v51, v51 row_ror:2 row_mask:0xf bank_mask:0xf
    s_nop 1
    v_add_f32_dpp v51, v51, v51 row_ror:1 row_mask:0xf bank_mask:0xf
    v_mov_b32 v47, v51
    s_nop 1
    v_permlane32_swap_b32 v51, v47
    v_add_f32 v51, v51, v47
    v_rcp_f32 v51, v51
    s_nop 0
    v_mul_f32 v49, v49, v51
    v_mul_f32 v50, v50, v51
    s_nop 0
    v_mov_b32_dpp v46, v49 quad_perm:[1,0,3,2] row_mask:0xf bank_mask:0xf
    v_mov_b32_dpp v47, v50 quad_perm:[1,0,3,2] row_mask:0xf bank_mask:0xf
    v_cvt_pk_bf16_f32 v16, v49, v46
    v_cvt_pk_bf16_f32 v20, v50, v47
    s_nop 0
    v_mov_b32_dpp v17, v16 row_shl:2 row_mask:0xf bank_mask:0xf
    v_mov_b32_dpp v18, v16 row_shl:4 row_mask:0xf bank_mask:0xf
    v_mov_b32_dpp v19, v16 row_shl:6 row_mask:0xf bank_mask:0xf
    v_mov_b32_dpp v21, v20 row_shl:2 row_mask:0xf bank_mask:0xf
    v_mov_b32_dpp v22, v20 row_shl:4 row_mask:0xf bank_mask:0xf
    v_mov_b32_dpp v23, v20 row_shl:6 row_mask:0xf bank_mask:0xf
    s_mov_b64 exec, s[40:41]
    buffer_store_dwordx4 v[16:19], v7, s[8:11], s18 offen sc1
    s_mov_b64 exec, s[42:43]
    buffer_store_dwordx4 v[20:23], v8, s[8:11], s18 offen sc1
    s_mov_b64 exec, -1
    ds_read_b128 v[40:43], v10
    s_add_u32 s28, s14, 1
    s_min_u32 s28, s28, 63
    s_cmp_gt_u32 s47, s28
    s_cbranch_scc1 layerb1_kernel_p1_gw2_ok
layerb1_kernel_p1_gw2_lp:
    buffer_load_dword v253, v255, s[8:11], s48 offen sc1
    s_waitcnt vmcnt(0)
    v_readlane_b32 s47, v253, 0
    v_readlane_b32 s29, v253, 1
    s_nop 0
    s_min_u32 s47, s47, s29
    s_sub_u32 s15, s15, 1
    s_cbranch_scc1 layerb1_kernel_bail
    s_cmp_gt_u32 s47, s28
    s_cbranch_scc0 layerb1_kernel_p1_gw2_lp
layerb1_kernel_p1_gw2_ok:
    s_mul_i32 s20, s28, 393216
    s_add_u32 s20, s20, s44
    s_add_u32 s21, s20, 0
    buffer_load_dwordx4 v[100:103], v9, s[8:11], s21 offen offset:0 sc1
    buffer_load_dwordx4 v[104:107], v9, s[8:11], s21 offen offset:512 sc1
    s_add_u32 s21, s20, 4096
    buffer_load_dwordx4 v[108:111], v9, s[8:11], s21 offen offset:0 sc1
    buffer_load_dwordx4 v[112:115], v9, s[8:11], s21 offen offset:512 sc1
    v_mov_b32 v56, 0
    v_mov_b32 v57, 0
    v_mov_b32 v58, 0
    v_mov_b32 v59, 0
    v_mov_b32 v60, 0
    v_mov_b32 v61, 0
    v_mov_b32 v62, 0
    v_mov_b32 v63, 0
    v_mov_b32 v64, 0
    v_mov_b32 v65, 0
    v_mov_b32 v66, 0
    v_mov_b32 v67, 0
    v_mov_b32 v68, 0
    v_mov_b32 v69, 0
    v_mov_b32 v70, 0
    v_mov_b32 v71, 0
    v_mov_b32 v72, 0
    v_mov_b32 v73, 0
    v_mov_b32 v74, 0
    v_mov_b32 v75, 0
    v_mov_b32 v76, 0
    v_mov_b32 v77, 0
    v_mov_b32 v78, 0
    v_mov_b32 v79, 0
    v_mov_b32 v80, 0
    v_mov_b32 v81, 0
    v_mov_b32 v82, 0
    v_mov_b32 v83, 0
    v_mov_b32 v84, 0
    v_mov_b32 v85, 0
    v_mov_b32 v86, 0
    v_mov_b32 v87, 0
    s_waitcnt lgkmcnt(0)
    s_mul_i32 s20, s14, 98304
    s_add_u32 s20, s20, s45
    buffer_store_dwordx4 v[40:43], v11, s[8:11], s20 offen sc1
    ds_read_b128 v[116:119], v13 offset:0
    ds_read_b128 v[120:123], v13 offset:1024
    ds_read_b128 v[124:127], v13 offset:2048
    ds_read_b128 v[128:131], v13 offset:3072
    ds_read_b128 v[132:135], v13 offset:4096
    ds_read_b128 v[136:139], v13 offset:5120
    ds_read_b128 v[140:143], v13 offset:6144
    ds_read_b128 v[144:147], v13 offset:7168
    s_waitcnt lgkmcnt(0)
    s_add_u32 s14, s14, 1
    s_cmp_lt_u32 s14, 64
    s_cbranch_scc1 layerb1_kernel_p1_step
    s_waitcnt vmcnt(0)
    s_barrier
    s_branch layerb1_kernel_end
layerb1_kernel_p2_start:
    v_lshrrev_b32 v16, 4, v0
    v_and_b32 v17, 15, v0
    v_and_b32 v18, 1, v16
    v_lshlrev_b32 v18, 2, v18
    v_lshrrev_b32 v19, 1, v16
    v_lshl_add_u32 v18, v19, 1, v18
    v_mul_u32_u24 v18, 400, v18
    v_lshl_add_u32 v18, v17, 1, v18
    v_add_u32 v3, 133312, v18
    v_and_b32 v18, 7, v0
    v_mul_u32_u24 v18, 400, v18
    v_lshrrev_b32 v19, 3, v0
    v_lshl_add_u32 v18, v19, 4, v18
    v_add_u32 v4, 133120, v18
    v_and_b32 v18, 7, v0
    v_mul_u32_u24 v18, 400, v18
    v_lshl_add_u32 v18, v16, 5, v18
    v_add_u32 v5, 136320, v18
    v_lshrrev_b32 v18, 1, v16
    v_lshlrev_b32 v18, 10, v18
    v_and_b32 v19, 31, v0
    v_lshl_add_u32 v18, v19, 4, v18
    v_add_u32 v6, 139528, v18
    v_add_u32 v15, 141568, v1
    v_lshrrev_b32 v18, 1, v16
    v_lshlrev_b32 v18, 1, v18
    v_lshrrev_b32 v19, 3, v17
    v_add3_u32 v18, v18, v19, 1
    v_lshrrev_b32 v19, 1, v18
    v_lshlrev_b32 v19, 14, v19
    v_and_b32 v18, 1, v18
    v_lshl_add_u32 v18, v18, 12, v19
    v_and_b32 v19, 1, v16
    v_lshlrev_b32 v19, 4, v19
    v_add_u32 v19, 64, v19
    s_lshl_b32 s20, s12, 7
    v_add_u32 v8, s20, v19
    v_add_u32 v7, v8, v18
    v_lshlrev_b32 v18, 4, v17
    v_lshl_add_u32 v18, v16, 10, v18
    v_add_u32 v9, 0, v18
    v_add_u32 v18, 128, v0
    v_mul_u32_u24 v19, 2731, v18
    v_lshrrev_b32 v19, 16, v19
    v_mul_u32_u24 v20, 24, v19
    v_sub_u32 v20, v18, v20
    v_mul_u32_u24 v21, 400, v19
    v_lshl_add_u32 v21, v20, 4, v21
    v_add_u32 v10, 136320, v21
    v_lshlrev_b32 v21, 4, v19
    v_lshl_add_u32 v11, v20, 7, v21
    v_and_b32 v18, 0x28, v0
    v_cmp_eq_u32 vcc, 0, v18
    v_mov_b32 v18, 1.0
    v_mov_b32 v19, 0
    v_cndmask_b32 v12, v19, v18, vcc
    v_add_u32 v13, 61440, v1
    v_add_u32 v14, 122880, v1
    s_mul_i32 s44, s12, 12288
    s_add_u32 s44, s44, 53477376
    s_mul_i32 s45, s12, 3072
    s_add_u32 s45, s45, 208666624
    s_mul_i32 s20, s12, 6
    s_add_u32 s21, s20, 5
    s_lshr_b32 s20, s20, 3
    s_lshr_b32 s21, s21, 3
    s_add_u32 s20, s20, 80
    s_add_u32 s21, s21, 80
    s_lshl_b32 s20, s20, 7
    s_lshl_b32 s21, s21, 7
    v_mov_b32 v255, s21
    v_mov_b32 v253, s20
    v_cmp_eq_u32 vcc, 0, v0
    s_nop 1
    v_cndmask_b32 v255, v255, v253, vcc
    s_mov_b32 s47, 0
    s_mul_i32 s20, s12, 491520
    s_add_u32 s20, s20, 11780096
    s_add_u32 s21, s20, 2048
    buffer_load_dwordx4 v[16:19], v1, s[8:11], s21 offen offset:0
    buffer_load_dwordx4 v[20:23], v1, s[8:11], s21 offen offset:1024
    s_add_u32 s21, s20, 43008
    buffer_load_dwordx4 v[24:27], v1, s[8:11], s21 offen offset:0
    buffer_load_dwordx4 v[28:31], v1, s[8:11], s21 offen offset:1024
    s_add_u32 s21, s20, 24576
    buffer_load_dwordx4 v[32:35], v1, s[8:11], s21 offen offset:0
    buffer_load_dwordx4 v[36:39], v1, s[8:11], s21 offen offset:1024
    s_add_u32 s21, s20, 6144
    buffer_load_dwordx4 v[40:43], v1, s[8:11], s21 offen offset:0
    buffer_load_dwordx4 v[44:47], v1, s[8:11], s21 offen offset:1024
    s_add_u32 s21, s20, 47104
    buffer_load_dwordx4 v[48:51], v1, s[8:11], s21 offen offset:0
    buffer_load_dwordx4 v[52:55], v1, s[8:11], s21 offen offset:1024
    s_add_u32 s21, s20, 28672
    buffer_load_dwordx4 v[56:59], v1, s[8:11], s21 offen offset:0
    buffer_load_dwordx4 v[60:63], v1, s[8:11], s21 offen offset:1024
    s_add_u32 s21, s20, 10240
    buffer_load_dwordx4 v[64:67], v1, s[8:11], s21 offen offset:0
    buffer_load_dwordx4 v[68:71], v1, s[8:11], s21 offen offset:1024
    s_add_u32 s21, s20, 51200
    buffer_load_dwordx4 v[72:75], v1, s[8:11], s21 offen offset:0
    buffer_load_dwordx4 v[76:79], v1, s[8:11], s21 offen offset:1024
    s_add_u32 s21, s20, 36864
    buffer_load_dwordx4 v[80:83], v1, s[8:11], s21 offen offset:0
    buffer_load_dwordx4 v[84:87], v1, s[8:11], s21 offen offset:1024
    s_add_u32 s21, s20, 18432
    buffer_load_dwordx4 v[88:91], v1, s[8:11], s21 offen offset:0
    buffer_load_dwordx4 v[92:95], v1, s[8:11], s21 offen offset:1024
    s_add_u32 s21, s20, 59392
    buffer_load_dwordx4 v[96:99], v1, s[8:11], s21 offen offset:0
    buffer_load_dwordx4 v[100:103], v1, s[8:11], s21 offen offset:1024
    s_add_u32 s21, s20, 90112
    buffer_load_dwordx4 v[104:107], v1, s[8:11], s21 offen offset:0
    buffer_load_dwordx4 v[108:111], v1, s[8:11], s21 offen offset:1024
    s_add_u32 s21, s20, 98304
    buffer_load_dwordx4 v[112:115], v1, s[8:11], s21 offen offset:0
    buffer_load_dwordx4 v[116:119], v1, s[8:11], s21 offen offset:1024
    s_add_u32 s21, s20, 106496
    buffer_load_dwordx4 v[120:123], v1, s[8:11], s21 offen offset:0
    buffer_load_dwordx4 v[124:127], v1, s[8:11], s21 offen offset:1024
    s_add_u32 s21, s20, 114688
    buffer_load_dwordx4 v[128:131], v1, s[8:11], s21 offen offset:0
    buffer_load_dwordx4 v[132:135], v1, s[8:11], s21 offen offset:1024
    s_add_u32 s21, s20, 12288
    buffer_load_dwordx4 a[0:3], v1, s[8:11], s21 offen offset:0
    buffer_load_dwordx4 a[4:7], v1, s[8:11], s21 offen offset:1024
    s_add_u32 s21, s20, 32768
    buffer_load_dwordx4 a[8:11], v1, s[8:11], s21 offen offset:0
    buffer_load_dwordx4 a[12:15], v1, s[8:11], s21 offen offset:1024
    s_add_u32 s21, s20, 53248
    buffer_load_dwordx4 a[16:19], v1, s[8:11], s21 offen offset:0
    buffer_load_dwordx4 a[20:23], v1, s[8:11], s21 offen offset:1024
    s_add_u32 s21, s20, 14336
    buffer_load_dwordx4 a[24:27], v1, s[8:11], s21 offen offset:0
    buffer_load_dwordx4 a[28:31], v1, s[8:11], s21 offen offset:1024
    s_add_u32 s21, s20, 34816
    buffer_load_dwordx4 a[32:35], v1, s[8:11], s21 offen offset:0
    buffer_load_dwordx4 a[36:39], v1, s[8:11], s21 offen offset:1024
    s_add_u32 s21, s20, 55296
    buffer_load_dwordx4 a[40:43], v1, s[8:11], s21 offen offset:0
    buffer_load_dwordx4 a[44:47], v1, s[8:11], s21 offen offset:1024
    s_add_u32 s21, s20, 0
    buffer_load_dwordx4 a[48:51], v1, s[8:11], s21 offen offset:0
    buffer_load_dwordx4 a[52:55], v1, s[8:11], s21 offen offset:1024
    s_add_u32 s21, s20, 20480
    buffer_load_dwordx4 a[56:59], v1, s[8:11], s21 offen offset:0
    buffer_load_dwordx4 a[60:63], v1, s[8:11], s21 offen offset:1024
    s_add_u32 s21, s20, 40960
    buffer_load_dwordx4 a[64:67], v1, s[8:11], s21 offen offset:0
    buffer_load_dwordx4 a[68:71], v1, s[8:11], s21 offen offset:1024
    s_add_u32 s21, s20, 22528
    buffer_load_dwordx4 a[72:75], v1, s[8:11], s21 offen offset:0
    buffer_load_dwordx4 a[76:79], v1, s[8:11], s21 offen offset:1024
    s_add_u32 s21, s20, 4096
    buffer_load_dwordx4 a[80:83], v1, s[8:11], s21 offen offset:0
    buffer_load_dwordx4 a[84:87], v1, s[8:11], s21 offen offset:1024
    s_add_u32 s21, s20, 45056
    buffer_load_dwordx4 a[88:91], v1, s[8:11], s21 offen offset:0
    buffer_load_dwordx4 a[92:95], v1, s[8:11], s21 offen offset:1024
    s_add_u32 s21, s20, 26624
    buffer_load_dwordx4 a[96:99], v1, s[8:11], s21 offen offset:0
    buffer_load_dwordx4 a[100:103], v1, s[8:11], s21 offen offset:1024
    s_add_u32 s21, s20, 8192
    buffer_load_dwordx4 a[104:107], v1, s[8:11], s21 offen offset:0
    buffer_load_dwordx4 a[108:111], v1, s[8:11], s21 offen offset:1024
    s_add_u32 s21, s20, 49152
    buffer_load_dwordx4 a[112:115], v1, s[8:11], s21 offen offset:0
    buffer_load_dwordx4 a[116:119], v1, s[8:11], s21 offen offset:1024
    s_add_u32 s21, s20, 30720
    buffer_load_dwordx4 a[120:123], v1, s[8:11], s21 offen offset:0
    buffer_load_dwordx4 a[124:127], v1, s[8:11], s21 offen offset:1024
    s_waitcnt vmcnt(32)
    ds_write_b128 v13, v[16:19] offset:0
    ds_write_b128 v13, v[20:23] offset:1024
    ds_write_b128 v13, v[24:27] offset:2048
    ds_write_b128 v13, v[28:31] offset:3072
    ds_write_b128 v13, v[32:35] offset:4096
    ds_write_b128 v13, v[36:39] offset:5120
    ds_write_b128 v13, v[40:43] offset:6144
    ds_write_b128 v13, v[44:47] offset:7168
    ds_write_b128 v13, v[48:51] offset:8192
    ds_write_b128 v13, v[52:55] offset:9216
    ds_write_b128 v13, v[56:59] offset:10240
    ds_write_b128 v13, v[60:63] offset:11264
    ds_write_b128 v13, v[64:67] offset:12288
    ds_write_b128 v13, v[68:71] offset:13312
    ds_write_b128 v13, v[72:75] offset:14336
    ds_write_b128 v13, v[76:79] offset:15360
    ds_write_b128 v13, v[80:83] offset:16384
    ds_write_b128 v13, v[84:87] offset:17408
    ds_write_b128 v13, v[88:91] offset:18432
    ds_write_b128 v13, v[92:95] offset:19456
    ds_write_b128 v13, v[96:99] offset:20480
    ds_write_b128 v13, v[100:103] offset:21504
    ds_write_b128 v13, v[104:107] offset:22528
    ds_write_b128 v13, v[108:111] offset:23552
    ds_write_b128 v13, v[112:115] offset:24576
    ds_write_b128 v13, v[116:119] offset:25600
    ds_write_b128 v13, v[120:123] offset:26624
    ds_write_b128 v13, v[124:127] offset:27648
    ds_write_b128 v13, v[128:131] offset:28672
    ds_write_b128 v13, v[132:135] offset:29696
    s_add_u32 s21, s20, 16384
    buffer_load_dwordx4 a[128:131], v1, s[8:11], s21 offen offset:0
    buffer_load_dwordx4 a[132:135], v1, s[8:11], s21 offen offset:1024
    s_add_u32 s21, s20, 57344
    buffer_load_dwordx4 a[136:139], v1, s[8:11], s21 offen offset:0
    buffer_load_dwordx4 a[140:143], v1, s[8:11], s21 offen offset:1024
    s_add_u32 s21, s20, 38912
    buffer_load_dwordx4 a[144:147], v1, s[8:11], s21 offen offset:0
    buffer_load_dwordx4 a[148:151], v1, s[8:11], s21 offen offset:1024
    s_add_u32 s21, s20, 61440
    buffer_load_dwordx4 a[152:155], v1, s[8:11], s21 offen offset:0
    buffer_load_dwordx4 a[156:159], v1, s[8:11], s21 offen offset:1024
    s_add_u32 s21, s20, 63488
    buffer_load_dwordx4 a[160:163], v1, s[8:11], s21 offen offset:0
    buffer_load_dwordx4 a[164:167], v1, s[8:11], s21 offen offset:1024
    s_add_u32 s21, s20, 65536
    buffer_load_dwordx4 a[168:171], v1, s[8:11], s21 offen offset:0
    buffer_load_dwordx4 a[172:175], v1, s[8:11], s21 offen offset:1024
    s_add_u32 s21, s20, 67584
    buffer_load_dwordx4 a[176:179], v1, s[8:11], s21 offen offset:0
    buffer_load_dwordx4 a[180:183], v1, s[8:11], s21 offen offset:1024
    s_add_u32 s21, s20, 69632
    buffer_load_dwordx4 a[184:187], v1, s[8:11], s21 offen offset:0
    buffer_load_dwordx4 a[188:191], v1, s[8:11], s21 offen offset:1024
    s_add_u32 s21, s20, 71680
    buffer_load_dwordx4 a[192:195], v1, s[8:11], s21 offen offset:0
    buffer_load_dwordx4 a[196:199], v1, s[8:11], s21 offen offset:1024
    s_add_u32 s21, s20, 73728
    buffer_load_dwordx4 a[200:203], v1, s[8:11], s21 offen offset:0
    buffer_load_dwordx4 a[204:207], v1, s[8:11], s21 offen offset:1024
    s_add_u32 s21, s20, 75776
    buffer_load_dwordx4 a[208:211], v1, s[8:11], s21 offen offset:0
    buffer_load_dwordx4 a[212:215], v1, s[8:11], s21 offen offset:1024
    s_add_u32 s21, s20, 77824
    buffer_load_dwordx4 a[216:219], v1, s[8:11], s21 offen offset:0
    buffer_load_dwordx4 a[220:223], v1, s[8:11], s21 offen offset:1024
    s_add_u32 s21, s20, 79872
    buffer_load_dwordx4 a[224:227], v1, s[8:11], s21 offen offset:0
    buffer_load_dwordx4 a[228:231], v1, s[8:11], s21 offen offset:1024
    s_add_u32 s21, s20, 81920
    buffer_load_dwordx4 a[232:235], v1, s[8:11], s21 offen offset:0
    buffer_load_dwordx4 a[236:239], v1, s[8:11], s21 offen offset:1024
    s_add_u32 s21, s20, 83968
    buffer_load_dwordx4 a[240:243], v1, s[8:11], s21 offen offset:0
    buffer_load_dwordx4 a[244:247], v1, s[8:11], s21 offen offset:1024
    s_add_u32 s21, s20, 86016
    buffer_load_dwordx4 a[248:251], v1, s[8:11], s21 offen offset:0
    buffer_load_dwordx4 a[252:255], v1, s[8:11], s21 offen offset:1024
    s_add_u32 s21, s20, 88064
    buffer_load_dwordx4 v[148:151], v1, s[8:11], s21 offen offset:0
    buffer_load_dwordx4 v[152:155], v1, s[8:11], s21 offen offset:1024
    s_add_u32 s21, s20, 92160
    buffer_load_dwordx4 v[156:159], v1, s[8:11], s21 offen offset:0
    buffer_load_dwordx4 v[160:163], v1, s[8:11], s21 offen offset:1024
    s_add_u32 s21, s20, 94208
    buffer_load_dwordx4 v[164:167], v1, s[8:11], s21 offen offset:0
    buffer_load_dwordx4 v[168:171], v1, s[8:11], s21 offen offset:1024
    s_add_u32 s21, s20, 96256
    buffer_load_dwordx4 v[172:175], v1, s[8:11], s21 offen offset:0
    buffer_load_dwordx4 v[176:179], v1, s[8:11], s21 offen offset:1024
    s_add_u32 s21, s20, 100352
    buffer_load_dwordx4 v[180:183], v1, s[8:11], s21 offen offset:0
    buffer_load_dwordx4 v[184:187], v1, s[8:11], s21 offen offset:1024
    s_add_u32 s21, s20, 102400
    buffer_load_dwordx4 v[188:191], v1, s[8:11], s21 offen offset:0
    buffer_load_dwordx4 v[192:195], v1, s[8:11], s21 offen offset:1024
    s_add_u32 s21, s20, 104448
    buffer_load_dwordx4 v[196:199], v1, s[8:11], s21 offen offset:0
    buffer_load_dwordx4 v[200:203], v1, s[8:11], s21 offen offset:1024
    s_add_u32 s21, s20, 108544
    buffer_load_dwordx4 v[204:207], v1, s[8:11], s21 offen offset:0
    buffer_load_dwordx4 v[208:211], v1, s[8:11], s21 offen offset:1024
    s_add_u32 s21, s20, 110592
    buffer_load_dwordx4 v[212:215], v1, s[8:11], s21 offen offset:0
    buffer_load_dwordx4 v[216:219], v1, s[8:11], s21 offen offset:1024
    s_add_u32 s21, s20, 112640
    buffer_load_dwordx4 v[220:223], v1, s[8:11], s21 offen offset:0
    buffer_load_dwordx4 v[224:227], v1, s[8:11], s21 offen offset:1024
    s_add_u32 s21, s20, 116736
    buffer_load_dwordx4 v[228:231], v1, s[8:11], s21 offen offset:0
    buffer_load_dwordx4 v[232:235], v1, s[8:11], s21 offen offset:1024
    s_add_u32 s21, s20, 118784
    buffer_load_dwordx4 v[236:239], v1, s[8:11], s21 offen offset:0
    buffer_load_dwordx4 v[240:243], v1, s[8:11], s21 offen offset:1024
    s_add_u32 s21, s20, 120832
    buffer_load_dwordx4 v[244:247], v1, s[8:11], s21 offen offset:0
    buffer_load_dwordx4 v[248:251], v1, s[8:11], s21 offen offset:1024
    s_waitcnt lgkmcnt(0)
    s_mov_b32 s14, 0
    s_cmp_gt_u32 s47, s14
    s_cbranch_scc1 layerb1_kernel_p2_gw1_ok
layerb1_kernel_p2_gw1_lp:
    buffer_load_dword v253, v255, s[8:11], s48 offen sc1
    s_waitcnt vmcnt(0)
    v_readlane_b32 s47, v253, 0
    v_readlane_b32 s29, v253, 1
    s_nop 0
    s_min_u32 s47, s47, s29
    s_sub_u32 s15, s15, 1
    s_cbranch_scc1 layerb1_kernel_bail
    s_cmp_gt_u32 s47, s14
    s_cbranch_scc0 layerb1_kernel_p2_gw1_lp
layerb1_kernel_p2_gw1_ok:
    s_mul_i32 s20, s14, 393216
    s_add_u32 s20, s20, s44
    s_add_u32 s21, s20, 8192
    buffer_load_dwordx4 v[100:103], v9, s[8:11], s21 offen offset:0 sc1
    buffer_load_dwordx4 v[104:107], v9, s[8:11], s21 offen offset:512 sc1
    v_mov_b32 v56, 0
    v_mov_b32 v57, 0
    v_mov_b32 v58, 0
    v_mov_b32 v59, 0
    v_mov_b32 v60, 0
    v_mov_b32 v61, 0
    v_mov_b32 v62, 0
    v_mov_b32 v63, 0
    v_mov_b32 v64, 0
    v_mov_b32 v65, 0
    v_mov_b32 v66, 0
    v_mov_b32 v67, 0
    v_mov_b32 v68, 0
    v_mov_b32 v69, 0
    v_mov_b32 v70, 0
    v_mov_b32 v71, 0
    v_mov_b32 v72, 0
    v_mov_b32 v73, 0
    v_mov_b32 v74, 0
    v_mov_b32 v75, 0
    v_mov_b32 v76, 0
    v_mov_b32 v77, 0
    v_mov_b32 v78, 0
    v_mov_b32 v79, 0
    v_mov_b32 v80, 0
    v_mov_b32 v81, 0
    v_mov_b32 v82, 0
    v_mov_b32 v83, 0
    v_mov_b32 v84, 0
    v_mov_b32 v85, 0
    v_mov_b32 v86, 0
    v_mov_b32 v87, 0
    ds_read_b128 v[116:119], v13 offset:0
    ds_read_b128 v[120:123], v13 offset:1024
    ds_read_b128 v[124:127], v13 offset:2048
    ds_read_b128 v[128:131], v13 offset:3072
    ds_read_b128 v[132:135], v13 offset:4096
    ds_read_b128 v[136:139], v13 offset:5120
    ds_read_b128 v[140:143], v13 offset:6144
    ds_read_b128 v[144:147], v13 offset:7168
    s_waitcnt lgkmcnt(0)
layerb1_kernel_p2_step:
    s_cmp_lt_u32 s14, 32
    s_cselect_b32 s18, s16, s17
    s_and_b32 s20, s14, 31
    s_lshl_b32 s20, s20, 16
    s_add_u32 s18, s18, s20
    s_add_u32 s22, s18, 51200
    s_add_u32 s23, s18, 52224
layerb1_kernel_p2_poll:
    buffer_load_dwordx4 v[40:43], v1, s[8:11], s22 offen sc1
    buffer_load_dwordx4 v[44:47], v1, s[8:11], s23 offen sc1
    s_waitcnt vmcnt(0)
    ds_write_b128 v14, v[40:43] offset:6144
    ds_write_b128 v14, v[44:47] offset:7168
    v_max3_u32 v88, v40, v41, v42
    v_max3_u32 v88, v88, v43, v44
    v_max3_u32 v88, v88, v45, v46
    v_max_u32 v88, v88, v47
    v_cmp_eq_u32 vcc, -1, v88
    s_sub_u32 s15, s15, 1
    s_cbranch_scc1 layerb1_kernel_bail
    s_cbranch_vccnz layerb1_kernel_p2_poll
    s_waitcnt lgkmcnt(0)
    s_barrier
    ds_read_b128 v[16:19], v14 offset:0
    ds_read_b128 v[20:23], v14 offset:1024
    ds_read_b128 v[24:27], v14 offset:2048
    ds_read_b128 v[28:31], v14 offset:3072
    ds_read_b128 v[32:35], v14 offset:4096
    ds_read_b128 v[36:39], v14 offset:5120
    ds_read_b128 v[48:51], v14 offset:8192
    ds_read_b128 v[52:55], v14 offset:9216
    v_smfmac_f32_16x16x64_bf16 v[56:59], v[40:43], a[0:7], v2
    v_smfmac_f32_16x16x64_bf16 v[60:63], v[40:43], a[8:15], v2
    v_smfmac_f32_16x16x64_bf16 v[64:67], v[40:43], a[16:23], v2
    v_smfmac_f32_16x16x64_bf16 v[56:59], v[44:47], a[24:31], v2
    v_smfmac_f32_16x16x64_bf16 v[60:63], v[44:47], a[32:39], v2
    v_smfmac_f32_16x16x64_bf16 v[64:67], v[44:47], a[40:47], v2
    s_waitcnt lgkmcnt(7)
    v_smfmac_f32_16x16x64_bf16 v[56:59], v[16:19], a[48:55], v2
    v_smfmac_f32_16x16x64_bf16 v[60:63], v[16:19], a[56:63], v2
    v_smfmac_f32_16x16x64_bf16 v[64:67], v[16:19], a[64:71], v2
    s_waitcnt lgkmcnt(6)
    v_smfmac_f32_16x16x64_bf16 v[56:59], v[20:23], v[116:123], v2
    ds_read_b128 v[116:119], v13 offset:8192
    ds_read_b128 v[120:123], v13 offset:9216
    v_smfmac_f32_16x16x64_bf16 v[60:63], v[20:23], a[72:79], v2
    v_smfmac_f32_16x16x64_bf16 v[64:67], v[20:23], v[124:131], v2
    ds_read_b128 v[124:127], v13 offset:10240
    ds_read_b128 v[128:131], v13 offset:11264
    s_waitcnt lgkmcnt(9)
    v_smfmac_f32_16x16x64_bf16 v[56:59], v[24:27], a[80:87], v2
    v_smfmac_f32_16x16x64_bf16 v[60:63], v[24:27], v[132:139], v2
    ds_read_b128 v[132:135], v13 offset:12288
    ds_read_b128 v[136:139], v13 offset:13312
    v_smfmac_f32_16x16x64_bf16 v[64:67], v[24:27], a[88:95], v2
    s_waitcnt lgkmcnt(10)
    v_smfmac_f32_16x16x64_bf16 v[56:59], v[28:31], v[140:147], v2
    ds_read_b128 v[140:143], v13 offset:14336
    ds_read_b128 v[144:147], v13 offset:15360
    v_smfmac_f32_16x16x64_bf16 v[60:63], v[28:31], a[96:103], v2
    s_waitcnt lgkmcnt(6)
    v_smfmac_f32_16x16x64_bf16 v[64:67], v[28:31], v[116:123], v2
    ds_read_b128 v[116:119], v13 offset:16384
    ds_read_b128 v[120:123], v13 offset:17408
    v_smfmac_f32_16x16x64_bf16 v[56:59], v[32:35], a[104:111], v2
    s_waitcnt lgkmcnt(6)
    v_smfmac_f32_16x16x64_bf16 v[60:63], v[32:35], v[124:131], v2
    ds_read_b128 v[124:127], v13 offset:18432
    ds_read_b128 v[128:131], v13 offset:19456
    v_smfmac_f32_16x16x64_bf16 v[64:67], v[32:35], a[112:119], v2
    s_waitcnt lgkmcnt(6)
    v_smfmac_f32_16x16x64_bf16 v[56:59], v[36:39], v[132:139], v2
    ds_read_b128 v[132:135], v13 offset:20480
    ds_read_b128 v[136:139], v13 offset:21504
    v_smfmac_f32_16x16x64_bf16 v[60:63], v[36:39], a[120:127], v2
    s_waitcnt lgkmcnt(6)
    v_smfmac_f32_16x16x64_bf16 v[64:67], v[36:39], v[140:147], v2
    ds_read_b128 v[140:143], v13 offset:22528
    ds_read_b128 v[144:147], v13 offset:23552
    v_smfmac_f32_16x16x64_bf16 v[56:59], v[48:51], a[128:135], v2
    s_waitcnt lgkmcnt(6)
    v_smfmac_f32_16x16x64_bf16 v[60:63], v[48:51], v[116:123], v2
    ds_read_b128 v[116:119], v13 offset:24576
    ds_read_b128 v[120:123], v13 offset:25600
    v_smfmac_f32_16x16x64_bf16 v[64:67], v[48:51], a[136:143], v2
    s_waitcnt lgkmcnt(6)
    v_smfmac_f32_16x16x64_bf16 v[56:59], v[52:55], v[124:131], v2
    ds_read_b128 v[124:127], v13 offset:26624
    ds_read_b128 v[128:131], v13 offset:27648
    v_smfmac_f32_16x16x64_bf16 v[60:63], v[52:55], a[144:151], v2
    s_waitcnt lgkmcnt(6)
    v_smfmac_f32_16x16x64_bf16 v[64:67], v[52:55], v[132:139], v2
    ds_read_b128 v[132:135], v13 offset:28672
    ds_read_b128 v[136:139], v13 offset:29696
    v_smfmac_f32_16x16x64_bf16 v[68:71], v[16:19], a[152:159], v2
    v_smfmac_f32_16x16x64_bf16 v[68:71], v[20:23], a[160:167], v2
    v_permlane32_swap_b32 v56, v58
    v_permlane32_swap_b32 v57, v59
    v_smfmac_f32_16x16x64_bf16 v[68:71], v[24:27], a[168:175], v2
    v_add_f32 v56, v56, v58
    v_add_f32 v57, v57, v59
    v_smfmac_f32_16x16x64_bf16 v[68:71], v[28:31], a[176:183], v2
    v_cvt_pk_bf16_f32 v56, v56, v57
    ds_write_b16 v3, v56 offset:0
    v_smfmac_f32_16x16x64_bf16 v[68:71], v[32:35], a[184:191], v2
    ds_write_b16_d16_hi v3, v56 offset:400
    v_permlane32_swap_b32 v60, v62
    v_smfmac_f32_16x16x64_bf16 v[68:71], v[36:39], a[192:199], v2
    v_permlane32_swap_b32 v61, v63
    v_add_f32 v60, v60, v62
    v_smfmac_f32_16x16x64_bf16 v[68:71], v[40:43], a[200:207], v2
    v_add_f32 v61, v61, v63
    v_cvt_pk_bf16_f32 v60, v60, v61
    v_smfmac_f32_16x16x64_bf16 v[68:71], v[44:47], a[208:215], v2
    ds_write_b16 v3, v60 offset:32
    ds_write_b16_d16_hi v3, v60 offset:432
    v_smfmac_f32_16x16x64_bf16 v[68:71], v[48:51], a[216:223], v2
    v_permlane32_swap_b32 v64, v66
    v_permlane32_swap_b32 v65, v67
    v_smfmac_f32_16x16x64_bf16 v[68:71], v[52:55], a[224:231], v2
    v_add_f32 v64, v64, v66
    v_add_f32 v65, v65, v67
    v_smfmac_f32_16x16x64_bf16 v[72:75], v[16:19], a[232:239], v2
    v_cvt_pk_bf16_f32 v64, v64, v65
    ds_write_b16 v3, v64 offset:64
    v_smfmac_f32_16x16x64_bf16 v[72:75], v[20:23], a[240:247], v2
    ds_write_b16_d16_hi v3, v64 offset:464
    v_smfmac_f32_16x16x64_bf16 v[72:75], v[24:27], a[248:255], v2
    v_smfmac_f32_16x16x64_bf16 v[72:75], v[28:31], v[148:155], v2
    s_waitcnt lgkmcnt(0)
    s_barrier
    ds_read_b128 v[88:91], v4 offset:0
    v_smfmac_f32_16x16x64_bf16 v[72:75], v[32:35], v[140:147], v2
    ds_read_b128 v[92:95], v4 offset:128
    ds_read_b128 v[96:99], v4 offset:256
    v_smfmac_f32_16x16x64_bf16 v[72:75], v[36:39], v[156:163], v2
    v_permlane32_swap_b32 v68, v70
    v_permlane32_swap_b32 v69, v71
    v_smfmac_f32_16x16x64_bf16 v[72:75], v[40:43], v[164:171], v2
    v_add_f32 v68, v68, v70
    v_add_f32 v69, v69, v71
    v_smfmac_f32_16x16x64_bf16 v[72:75], v[44:47], v[172:179], v2
    v_cvt_pk_bf16_f32 v68, v68, v69
    ds_write_b16 v3, v68 offset:3200
    v_smfmac_f32_16x16x64_bf16 v[72:75], v[48:51], v[116:123], v2
    ds_write_b16_d16_hi v3, v68 offset:3600
    v_smfmac_f32_16x16x64_bf16 v[72:75], v[52:55], v[180:187], v2
    s_waitcnt lgkmcnt(2)
    v_smfmac_f32_16x16x64_bf16 v[80:83], v[96:99], v[100:107], v2
    v_smfmac_f32_16x16x64_bf16 v[76:79], v[16:19], v[188:195], v2
    v_smfmac_f32_16x16x64_bf16 v[76:79], v[20:23], v[196:203], v2
    v_smfmac_f32_16x16x64_bf16 v[76:79], v[24:27], v[124:131], v2
    v_permlane32_swap_b32 v72, v74
    v_permlane32_swap_b32 v73, v75
    v_smfmac_f32_16x16x64_bf16 v[76:79], v[28:31], v[204:211], v2
    v_add_f32 v72, v72, v74
    v_add_f32 v73, v73, v75
    ds_write_b128 v15, v[80:83]
    v_smfmac_f32_16x16x64_bf16 v[76:79], v[32:35], v[212:219], v2
    v_cvt_pk_bf16_f32 v72, v72, v73
    ds_write_b16 v3, v72 offset:3232
    v_smfmac_f32_16x16x64_bf16 v[76:79], v[36:39], v[220:227], v2
    ds_write_b16_d16_hi v3, v72 offset:3632
    v_smfmac_f32_16x16x64_bf16 v[76:79], v[40:43], v[132:139], v2
    v_smfmac_f32_16x16x64_bf16 v[76:79], v[44:47], v[228:235], v2
    v_smfmac_f32_16x16x64_bf16 v[76:79], v[48:51], v[236:243], v2
    v_smfmac_f32_16x16x64_bf16 v[76:79], v[52:55], v[244:251], v2
    s_nop 7
    v_permlane32_swap_b32 v76, v78
    v_permlane32_swap_b32 v77, v79
    v_add_f32 v76, v76, v78
    v_add_f32 v77, v77, v79
    v_cvt_pk_bf16_f32 v76, v76, v77
    ds_write_b16 v3, v76 offset:3264
    ds_write_b16_d16_hi v3, v76 offset:3664
    s_waitcnt lgkmcnt(0)
    s_barrier
    ds_read2st64_b32 v[40:41], v6 offset0:0 offset1:2
    ds_read2st64_b32 v[42:43], v6 offset0:8 offset1:10
    ds_read_b128 v[16:19], v5 offset:0
    ds_read_b128 v[20:23], v5 offset:16
    ds_read_b128 v[24:27], v5 offset:128
    ds_read_b128 v[28:31], v5 offset:144
    ds_read_b128 v[32:35], v5 offset:256
    ds_read_b128 v[36:39], v5 offset:272
    s_waitcnt lgkmcnt(6)
    v_add_f32 v40, v40, v41
    v_add_f32 v42, v42, v43
    v_add_f32 v44, v40, v42
    v_mul_f32 v44, 0x3dd53b95, v44
    s_waitcnt lgkmcnt(4)
    v_smfmac_f32_16x16x64_bf16 v[84:87], v[88:91], v[16:23], v2
    s_waitcnt lgkmcnt(2)
    v_smfmac_f32_16x16x64_bf16 v[84:87], v[92:95], v[24:31], v2
    s_waitcnt lgkmcnt(0)
    v_smfmac_f32_16x16x64_bf16 v[84:87], v[96:99], v[32:39], v2
    v_max_f32_dpp v45, v44, v44 row_ror:8 row_mask:0xf bank_mask:0xf
    s_nop 1
    v_max_f32_dpp v45, v45, v45 row_ror:4 row_mask:0xf bank_mask:0xf
    s_nop 1
    v_max_f32_dpp v45, v45, v45 row_ror:2 row_mask:0xf bank_mask:0xf
    s_nop 1
    v_max_f32_dpp v45, v45, v45 row_ror:1 row_mask:0xf bank_mask:0xf
    v_mov_b32 v47, v45
    s_nop 1
    v_permlane32_swap_b32 v45, v47
    v_max_f32 v45, v45, v47
    v_mov_b32 v47, v86
    s_nop 1
    v_permlane32_swap_b32 v86, v47
    v_add_f32 v48, v86, v47
    v_mul_f32 v48, 0x3dd53b95, v48
    s_nop 1
    v_max_f32_dpp v46, v48, v48 row_ror:4 row_mask:0xf bank_mask:0xf
    s_nop 1
    v_max_f32_dpp v46, v46, v46 row_ror:2 row_mask:0xf bank_mask:0xf
    s_nop 1
    v_max_f32_dpp v46, v46, v46 row_ror:1 row_mask:0xf bank_mask:0xf
    v_max_f32 v45, v45, v46
    v_sub_f32 v49, v44, v45
    v_sub_f32 v50, v48, v45
    v_exp_f32 v49, v49
    v_exp_f32 v50, v50
    s_nop 0
    v_fma_f32 v51, v50, v12, v49
    s_nop 1
    v_add_f32_dpp v51, v51, v51 row_ror:8 row_mask:0xf bank_mask:0xf
    s_nop 1
    v_add_f32_dpp v51, v51, v51 row_ror:4 row_mask:0xf bank_mask:0xf
    s_nop 1
    v_add_f32_dpp v51, v51, v51 row_ror:2 row_mask:0xf bank_mask:0xf
    s_nop 1
    v_add_f32_dpp v51, v51, v51 row_ror:1 row_mask:0xf bank_mask:0xf
    v_mov_b32 v47, v51
    s_nop 1
    v_permlane32_swap_b32 v51, v47
    v_add_f32 v51, v51, v47
    v_rcp_f32 v51, v51
    s_nop 0
    v_mul_f32 v49, v49, v51
    v_mul_f32 v50, v50, v51
    s_nop 0
    v_mov_b32_dpp v46, v49 quad_perm:[1,0,3,2] row_mask:0xf bank_mask:0xf
    v_mov_b32_dpp v47, v50 quad_perm:[1,0,3,2] row_mask:0xf bank_mask:0xf
    v_cvt_pk_bf16_f32 v16, v49, v46
    v_cvt_pk_bf16_f32 v20, v50, v47
    s_nop 0
    v_mov_b32_dpp v17, v16 row_shl:2 row_mask:0xf bank_mask:0xf
    v_mov_b32_dpp v18, v16 row_shl:4 row_mask:0xf bank_mask:0xf
    v_mov_b32_dpp v19, v16 row_shl:6 row_mask:0xf bank_mask:0xf
    v_mov_b32_dpp v21, v20 row_shl:2 row_mask:0xf bank_mask:0xf
    v_mov_b32_dpp v22, v20 row_shl:4 row_mask:0xf bank_mask:0xf
    v_mov_b32_dpp v23, v20 row_shl:6 row_mask:0xf bank_mask:0xf
    s_mov_b64 exec, s[40:41]
    buffer_store_dwordx4 v[16:19], v7, s[8:11], s18 offen sc1
    s_mov_b64 exec, s[42:43]
    buffer_store_dwordx4 v[20:23], v8, s[8:11], s18 offen sc1
    s_mov_b64 exec, -1
    ds_read_b128 v[40:43], v10
    s_add_u32 s28, s14, 1
    s_min_u32 s28, s28, 63
    s_cmp_gt_u32 s47, s28
    s_cbranch_scc1 layerb1_kernel_p2_gw2_ok
layerb1_kernel_p2_gw2_lp:
    buffer_load_dword v253, v255, s[8:11], s48 offen sc1
    s_waitcnt vmcnt(0)
    v_readlane_b32 s47, v253, 0
    v_readlane_b32 s29, v253, 1
    s_nop 0
    s_min_u32 s47, s47, s29
    s_sub_u32 s15, s15, 1
    s_cbranch_scc1 layerb1_kernel_bail
    s_cmp_gt_u32 s47, s28
    s_cbranch_scc0 layerb1_kernel_p2_gw2_lp
layerb1_kernel_p2_gw2_ok:
    s_mul_i32 s20, s28, 393216
    s_add_u32 s20, s20, s44
    s_add_u32 s21, s20, 8192
    buffer_load_dwordx4 v[100:103], v9, s[8:11], s21 offen offset:0 sc1
    buffer_load_dwordx4 v[104:107], v9, s[8:11], s21 offen offset:512 sc1
    v_mov_b32 v56, 0
    v_mov_b32 v57, 0
    v_mov_b32 v58, 0
    v_mov_b32 v59, 0
    v_mov_b32 v60, 0
    v_mov_b32 v61, 0
    v_mov_b32 v62, 0
    v_mov_b32 v63, 0
    v_mov_b32 v64, 0
    v_mov_b32 v65, 0
    v_mov_b32 v66, 0
    v_mov_b32 v67, 0
    v_mov_b32 v68, 0
    v_mov_b32 v69, 0
    v_mov_b32 v70, 0
    v_mov_b32 v71, 0
    v_mov_b32 v72, 0
    v_mov_b32 v73, 0
    v_mov_b32 v74, 0
    v_mov_b32 v75, 0
    v_mov_b32 v76, 0
    v_mov_b32 v77, 0
    v_mov_b32 v78, 0
    v_mov_b32 v79, 0
    v_mov_b32 v80, 0
    v_mov_b32 v81, 0
    v_mov_b32 v82, 0
    v_mov_b32 v83, 0
    v_mov_b32 v84, 0
    v_mov_b32 v85, 0
    v_mov_b32 v86, 0
    v_mov_b32 v87, 0
    s_waitcnt lgkmcnt(0)
    s_mul_i32 s20, s14, 98304
    s_add_u32 s20, s20, s45
    buffer_store_dwordx4 v[40:43], v11, s[8:11], s20 offen sc1
    ds_read_b128 v[116:119], v13 offset:0
    ds_read_b128 v[120:123], v13 offset:1024
    ds_read_b128 v[124:127], v13 offset:2048
    ds_read_b128 v[128:131], v13 offset:3072
    ds_read_b128 v[132:135], v13 offset:4096
    ds_read_b128 v[136:139], v13 offset:5120
    ds_read_b128 v[140:143], v13 offset:6144
    ds_read_b128 v[144:147], v13 offset:7168
    s_waitcnt lgkmcnt(0)
    s_add_u32 s14, s14, 1
    s_cmp_lt_u32 s14, 64
    s_cbranch_scc1 layerb1_kernel_p2_step
    s_waitcnt vmcnt(0)
    s_barrier
    s_branch layerb1_kernel_end
layerb1_kernel_p3_start:
    v_lshrrev_b32 v16, 4, v0
    v_and_b32 v17, 15, v0
    v_and_b32 v18, 1, v16
    v_lshlrev_b32 v18, 2, v18
    v_lshrrev_b32 v19, 1, v16
    v_lshl_add_u32 v18, v19, 1, v18
    v_mul_u32_u24 v18, 400, v18
    v_lshl_add_u32 v18, v17, 1, v18
    v_add_u32 v3, 133408, v18
    v_and_b32 v18, 7, v0
    v_mul_u32_u24 v18, 400, v18
    v_lshrrev_b32 v19, 3, v0
    v_lshl_add_u32 v18, v19, 4, v18
    v_add_u32 v4, 133120, v18
    v_and_b32 v18, 7, v0
    v_mul_u32_u24 v18, 400, v18
    v_lshl_add_u32 v18, v16, 5, v18
    v_add_u32 v5, 136320, v18
    v_lshrrev_b32 v18, 1, v16
    v_lshlrev_b32 v18, 10, v18
    v_and_b32 v19, 31, v0
    v_lshl_add_u32 v18, v19, 4, v18
    v_add_u32 v6, 139532, v18
    v_add_u32 v15, 142592, v1
    v_lshrrev_b32 v18, 1, v16
    v_lshlrev_b32 v18, 1, v18
    v_lshrrev_b32 v19, 3, v17
    v_add3_u32 v18, v18, v19, 1
    v_lshrrev_b32 v19, 1, v18
    v_lshlrev_b32 v19, 14, v19
    v_and_b32 v18, 1, v18
    v_lshl_add_u32 v18, v18, 12, v19
    v_and_b32 v19, 1, v16
    v_lshlrev_b32 v19, 4, v19
    v_add_u32 v19, 96, v19
    s_lshl_b32 s20, s12, 7
    v_add_u32 v8, s20, v19
    v_add_u32 v7, v8, v18
    v_lshlrev_b32 v18, 4, v17
    v_lshl_add_u32 v18, v16, 10, v18
    v_add_u32 v9, 256, v18
    v_add_u32 v18, 192, v0
    v_mul_u32_u24 v19, 2731, v18
    v_lshrrev_b32 v19, 16, v19
    v_mul_u32_u24 v20, 24, v19
    v_sub_u32 v20, v18, v20
    v_mul_u32_u24 v21, 400, v19
    v_lshl_add_u32 v21, v20, 4, v21
    v_add_u32 v10, 136320, v21
    v_lshlrev_b32 v21, 4, v19
    v_lshl_add_u32 v11, v20, 7, v21
    v_and_b32 v18, 0x28, v0
    v_cmp_eq_u32 vcc, 0, v18
    v_mov_b32 v18, 1.0
    v_mov_b32 v19, 0
    v_cndmask_b32 v12, v19, v18, vcc
    v_add_u32 v13, 92160, v1
    v_add_u32 v14, 122880, v1
    s_mul_i32 s44, s12, 12288
    s_add_u32 s44, s44, 53477376
    s_mul_i32 s45, s12, 3072
    s_add_u32 s45, s45, 208666624
    s_mul_i32 s20, s12, 6
    s_add_u32 s21, s20, 5
    s_lshr_b32 s20, s20, 3
    s_lshr_b32 s21, s21, 3
    s_add_u32 s20, s20, 80
    s_add_u32 s21, s21, 80
    s_lshl_b32 s20, s20, 7
    s_lshl_b32 s21, s21, 7
    v_mov_b32 v255, s21
    v_mov_b32 v253, s20
    v_cmp_eq_u32 vcc, 0, v0
    s_nop 1
    v_cndmask_b32 v255, v255, v253, vcc
    s_mov_b32 s47, 0
    s_mul_i32 s20, s12, 491520
    s_add_u32 s20, s20, 11902976
    s_add_u32 s21, s20, 2048
    buffer_load_dwordx4 v[16:19], v1, s[8:11], s21 offen offset:0
    buffer_load_dwordx4 v[20:23], v1, s[8:11], s21 offen offset:1024
    s_add_u32 s21, s20, 43008
    buffer_load_dwordx4 v[24:27], v1, s[8:11], s21 offen offset:0
    buffer_load_dwordx4 v[28:31], v1, s[8:11], s21 offen offset:1024
    s_add_u32 s21, s20, 24576
    buffer_load_dwordx4 v[32:35], v1, s[8:11], s21 offen offset:0
    buffer_load_dwordx4 v[36:39], v1, s[8:11], s21 offen offset:1024
    s_add_u32 s21, s20, 6144
    buffer_load_dwordx4 v[40:43], v1, s[8:11], s21 offen offset:0
    buffer_load_dwordx4 v[44:47], v1, s[8:11], s21 offen offset:1024
    s_add_u32 s21, s20, 47104
    buffer_load_dwordx4 v[48:51], v1, s[8:11], s21 offen offset:0
    buffer_load_dwordx4 v[52:55], v1, s[8:11], s21 offen offset:1024
    s_add_u32 s21, s20, 28672
    buffer_load_dwordx4 v[56:59], v1, s[8:11], s21 offen offset:0
    buffer_load_dwordx4 v[60:63], v1, s[8:11], s21 offen offset:1024
    s_add_u32 s21, s20, 10240
    buffer_load_dwordx4 v[64:67], v1, s[8:11], s21 offen offset:0
    buffer_load_dwordx4 v[68:71], v1, s[8:11], s21 offen offset:1024
    s_add_u32 s21, s20, 51200
    buffer_load_dwordx4 v[72:75], v1, s[8:11], s21 offen offset:0
    buffer_load_dwordx4 v[76:79], v1, s[8:11], s21 offen offset:1024
    s_add_u32 s21, s20, 32768
    buffer_load_dwordx4 v[80:83], v1, s[8:11], s21 offen offset:0
    buffer_load_dwordx4 v[84:87], v1, s[8:11], s21 offen offset:1024
    s_add_u32 s21, s20, 14336
    buffer_load_dwordx4 v[88:91], v1, s[8:11], s21 offen offset:0
    buffer_load_dwordx4 v[92:95], v1, s[8:11], s21 offen offset:1024
    s_add_u32 s21, s20, 55296
    buffer_load_dwordx4 v[96:99], v1, s[8:11], s21 offen offset:0
    buffer_load_dwordx4 v[100:103], v1, s[8:11], s21 offen offset:1024
    s_add_u32 s21, s20, 90112
    buffer_load_dwordx4 v[104:107], v1, s[8:11], s21 offen offset:0
    buffer_load_dwordx4 v[108:111], v1, s[8:11], s21 offen offset:1024
    s_add_u32 s21, s20, 98304
    buffer_load_dwordx4 v[112:115], v1, s[8:11], s21 offen offset:0
    buffer_load_dwordx4 v[116:119], v1, s[8:11], s21 offen offset:1024
    s_add_u32 s21, s20, 106496
    buffer_load_dwordx4 v[120:123], v1, s[8:11], s21 offen offset:0
    buffer_load_dwordx4 v[124:127], v1, s[8:11], s21 offen offset:1024
    s_add_u32 s21, s20, 114688
    buffer_load_dwordx4 v[128:131], v1, s[8:11], s21 offen offset:0
    buffer_load_dwordx4 v[132:135], v1, s[8:11], s21 offen offset:1024
    s_add_u32 s21, s20, 16384
    buffer_load_dwordx4 a[0:3], v1, s[8:11], s21 offen offset:0
    buffer_load_dwordx4 a[4:7], v1, s[8:11], s21 offen offset:1024
    s_add_u32 s21, s20, 36864
    buffer_load_dwordx4 a[8:11], v1, s[8:11], s21 offen offset:0
    buffer_load_dwordx4 a[12:15], v1, s[8:11], s21 offen offset:1024
    s_add_u32 s21, s20, 57344
    buffer_load_dwordx4 a[16:19], v1, s[8:11], s21 offen offset:0
    buffer_load_dwordx4 a[20:23], v1, s[8:11], s21 offen offset:1024
    s_add_u32 s21, s20, 18432
    buffer_load_dwordx4 a[24:27], v1, s[8:11], s21 offen offset:0
    buffer_load_dwordx4 a[28:31], v1, s[8:11], s21 offen offset:1024
    s_add_u32 s21, s20, 38912
    buffer_load_dwordx4 a[32:35], v1, s[8:11], s21 offen offset:0
    buffer_load_dwordx4 a[36:39], v1, s[8:11], s21 offen offset:1024
    s_add_u32 s21, s20, 59392
    buffer_load_dwordx4 a[40:43], v1, s[8:11], s21 offen offset:0
    buffer_load_dwordx4 a[44:47], v1, s[8:11], s21 offen offset:1024
    s_add_u32 s21, s20, 0
    buffer_load_dwordx4 a[48:51], v1, s[8:11], s21 offen offset:0
    buffer_load_dwordx4 a[52:55], v1, s[8:11], s21 offen offset:1024
    s_add_u32 s21, s20, 20480
    buffer_load_dwordx4 a[56:59], v1, s[8:11], s21 offen offset:0
    buffer_load_dwordx4 a[60:63], v1, s[8:11], s21 offen offset:1024
    s_add_u32 s21, s20, 40960
    buffer_load_dwordx4 a[64:67], v1, s[8:11], s21 offen offset:0
    buffer_load_dwordx4 a[68:71], v1, s[8:11], s21 offen offset:1024
    s_add_u32 s21, s20, 22528
    buffer_load_dwordx4 a[72:75], v1, s[8:11], s21 offen offset:0
    buffer_load_dwordx4 a[76:79], v1, s[8:11], s21 offen offset:1024
    s_add_u32 s21, s20, 4096
    buffer_load_dwordx4 a[80:83], v1, s[8:11], s21 offen offset:0
    buffer_load_dwordx4 a[84:87], v1, s[8:11], s21 offen offset:1024
    s_add_u32 s21, s20, 45056
    buffer_load_dwordx4 a[88:91], v1, s[8:11], s21 offen offset:0
    buffer_load_dwordx4 a[92:95], v1, s[8:11], s21 offen offset:1024
    s_add_u32 s21, s20, 26624
    buffer_load_dwordx4 a[96:99], v1, s[8:11], s21 offen offset:0
    buffer_load_dwordx4 a[100:103], v1, s[8:11], s21 offen offset:1024
    s_add_u32 s21, s20, 8192
    buffer_load_dwordx4 a[104:107], v1, s[8:11], s21 offen offset:0
    buffer_load_dwordx4 a[108:111], v1, s[8:11], s21 offen offset:1024
    s_add_u32 s21, s20, 49152
    buffer_load_dwordx4 a[112:115], v1, s[8:11], s21 offen offset:0
    buffer_load_dwordx4 a[116:119], v1, s[8:11], s21 offen offset:1024
    s_add_u32 s21, s20, 30720
    buffer_load_dwordx4 a[120:123], v1, s[8:11], s21 offen offset:0
    buffer_load_dwordx4 a[124:127], v1, s[8:11], s21 offen offset:1024
    s_waitcnt vmcnt(32)
    ds_write_b128 v13, v[16:19] offset:0
    ds_write_b128 v13, v[20:23] offset:1024
    ds_write_b128 v13, v[24:27] offset:2048
    ds_write_b128 v13, v[28:31] offset:3072
    ds_write_b128 v13, v[32:35] offset:4096
    ds_write_b128 v13, v[36:39] offset:5120
    ds_write_b128 v13, v[40:43] offset:6144
    ds_write_b128 v13, v[44:47] offset:7168
    ds_write_b128 v13, v[48:51] offset:8192
    ds_write_b128 v13, v[52:55] offset:9216
    ds_write_b128 v13, v[56:59] offset:10240
    ds_write_b128 v13, v[60:63] offset:11264
    ds_write_b128 v13, v[64:67] offset:12288
    ds_write_b128 v13, v[68:71] offset:13312
    ds_write_b128 v13, v[72:75] offset:14336
    ds_write_b128 v13, v[76:79] offset:15360
    ds_write_b128 v13, v[80:83] offset:16384
    ds_write_b128 v13, v[84:87] offset:17408
    ds_write_b128 v13, v[88:91] offset:18432
    ds_write_b128 v13, v[92:95] offset:19456
    ds_write_b128 v13, v[96:99] offset:20480
    ds_write_b128 v13, v[100:103] offset:21504
    ds_write_b128 v13, v[104:107] offset:22528
    ds_write_b128 v13, v[108:111] offset:23552
    ds_write_b128 v13, v[112:115] offset:24576
    ds_write_b128 v13, v[116:119] offset:25600
    ds_write_b128 v13, v[120:123] offset:26624
    ds_write_b128 v13, v[124:127] offset:27648
    ds_write_b128 v13, v[128:131] offset:28672
    ds_write_b128 v13, v[132:135] offset:29696
    s_add_u32 s21, s20, 12288
    buffer_load_dwordx4 a[128:131], v1, s[8:11], s21 offen offset:0
    buffer_load_dwordx4 a[132:135], v1, s[8:11], s21 offen offset:1024
    s_add_u32 s21, s20, 53248
    buffer_load_dwordx4 a[136:139], v1, s[8:11], s21 offen offset:0
    buffer_load_dwordx4 a[140:143], v1, s[8:11], s21 offen offset:1024
    s_add_u32 s21, s20, 34816
    buffer_load_dwordx4 a[144:147], v1, s[8:11], s21 offen offset:0
    buffer_load_dwordx4 a[148:151], v1, s[8:11], s21 offen offset:1024
    s_add_u32 s21, s20, 61440
    buffer_load_dwordx4 a[152:155], v1, s[8:11], s21 offen offset:0
    buffer_load_dwordx4 a[156:159], v1, s[8:11], s21 offen offset:1024
    s_add_u32 s21, s20, 63488
    buffer_load_dwordx4 a[160:163], v1, s[8:11], s21 offen offset:0
    buffer_load_dwordx4 a[164:167], v1, s[8:11], s21 offen offset:1024
    s_add_u32 s21, s20, 65536
    buffer_load_dwordx4 a[168:171], v1, s[8:11], s21 offen offset:0
    buffer_load_dwordx4 a[172:175], v1, s[8:11], s21 offen offset:1024
    s_add_u32 s21, s20, 67584
    buffer_load_dwordx4 a[176:179], v1, s[8:11], s21 offen offset:0
    buffer_load_dwordx4 a[180:183], v1, s[8:11], s21 offen offset:1024
    s_add_u32 s21, s20, 69632
    buffer_load_dwordx4 a[184:187], v1, s[8:11], s21 offen offset:0
    buffer_load_dwordx4 a[188:191], v1, s[8:11], s21 offen offset:1024
    s_add_u32 s21, s20, 71680
    buffer_load_dwordx4 a[192:195], v1, s[8:11], s21 offen offset:0
    buffer_load_dwordx4 a[196:199], v1, s[8:11], s21 offen offset:1024
    s_add_u32 s21, s20, 73728
    buffer_load_dwordx4 a[200:203], v1, s[8:11], s21 offen offset:0
    buffer_load_dwordx4 a[204:207], v1, s[8:11], s21 offen offset:1024
    s_add_u32 s21, s20, 75776
    buffer_load_dwordx4 a[208:211], v1, s[8:11], s21 offen offset:0
    buffer_load_dwordx4 a[212:215], v1, s[8:11], s21 offen offset:1024
    s_add_u32 s21, s20, 77824
    buffer_load_dwordx4 a[216:219], v1, s[8:11], s21 offen offset:0
    buffer_load_dwordx4 a[220:223], v1, s[8:11], s21 offen offset:1024
    s_add_u32 s21, s20, 79872
    buffer_load_dwordx4 a[224:227], v1, s[8:11], s21 offen offset:0
    buffer_load_dwordx4 a[228:231], v1, s[8:11], s21 offen offset:1024
    s_add_u32 s21, s20, 81920
    buffer_load_dwordx4 a[232:235], v1, s[8:11], s21 offen offset:0
    buffer_load_dwordx4 a[236:239], v1, s[8:11], s21 offen offset:1024
    s_add_u32 s21, s20, 83968
    buffer_load_dwordx4 a[240:243], v1, s[8:11], s21 offen offset:0
    buffer_load_dwordx4 a[244:247], v1, s[8:11], s21 offen offset:1024
    s_add_u32 s21, s20, 86016
    buffer_load_dwordx4 a[248:251], v1, s[8:11], s21 offen offset:0
    buffer_load_dwordx4 a[252:255], v1, s[8:11], s21 offen offset:1024
    s_add_u32 s21, s20, 88064
    buffer_load_dwordx4 v[148:151], v1, s[8:11], s21 offen offset:0
    buffer_load_dwordx4 v[152:155], v1, s[8:11], s21 offen offset:1024
    s_add_u32 s21, s20, 92160
    buffer_load_dwordx4 v[156:159], v1, s[8:11], s21 offen offset:0
    buffer_load_dwordx4 v[160:163], v1, s[8:11], s21 offen offset:1024
    s_add_u32 s21, s20, 94208
    buffer_load_dwordx4 v[164:167], v1, s[8:11], s21 offen offset:0
    buffer_load_dwordx4 v[168:171], v1, s[8:11], s21 offen offset:1024
    s_add_u32 s21, s20, 96256
    buffer_load_dwordx4 v[172:175], v1, s[8:11], s21 offen offset:0
    buffer_load_dwordx4 v[176:179], v1, s[8:11], s21 offen offset:1024
    s_add_u32 s21, s20, 100352
    buffer_load_dwordx4 v[180:183], v1, s[8:11], s21 offen offset:0
    buffer_load_dwordx4 v[184:187], v1, s[8:11], s21 offen offset:1024
    s_add_u32 s21, s20, 102400
    buffer_load_dwordx4 v[188:191], v1, s[8:11], s21 offen offset:0
    buffer_load_dwordx4 v[192:195], v1, s[8:11], s21 offen offset:1024
    s_add_u32 s21, s20, 104448
    buffer_load_dwordx4 v[196:199], v1, s[8:11], s21 offen offset:0
    buffer_load_dwordx4 v[200:203], v1, s[8:11], s21 offen offset:1024
    s_add_u32 s21, s20, 108544
    buffer_load_dwordx4 v[204:207], v1, s[8:11], s21 offen offset:0
    buffer_load_dwordx4 v[208:211], v1, s[8:11], s21 offen offset:1024
    s_add_u32 s21, s20, 110592
    buffer_load_dwordx4 v[212:215], v1, s[8:11], s21 offen offset:0
    buffer_load_dwordx4 v[216:219], v1, s[8:11], s21 offen offset:1024
    s_add_u32 s21, s20, 112640
    buffer_load_dwordx4 v[220:223], v1, s[8:11], s21 offen offset:0
    buffer_load_dwordx4 v[224:227], v1, s[8:11], s21 offen offset:1024
    s_add_u32 s21, s20, 116736
    buffer_load_dwordx4 v[228:231], v1, s[8:11], s21 offen offset:0
    buffer_load_dwordx4 v[232:235], v1, s[8:11], s21 offen offset:1024
    s_add_u32 s21, s20, 118784
    buffer_load_dwordx4 v[236:239], v1, s[8:11], s21 offen offset:0
    buffer_load_dwordx4 v[240:243], v1, s[8:11], s21 offen offset:1024
    s_add_u32 s21, s20, 120832
    buffer_load_dwordx4 v[244:247], v1, s[8:11], s21 offen offset:0
    buffer_load_dwordx4 v[248:251], v1, s[8:11], s21 offen offset:1024
    s_waitcnt lgkmcnt(0)
    s_mov_b32 s14, 0
    s_cmp_gt_u32 s47, s14
    s_cbranch_scc1 layerb1_kernel_p3_gw1_ok
layerb1_kernel_p3_gw1_lp:
    buffer_load_dword v253, v255, s[8:11], s48 offen sc1
    s_waitcnt vmcnt(0)
    v_readlane_b32 s47, v253, 0
    v_readlane_b32 s29, v253, 1
    s_nop 0
    s_min_u32 s47, s47, s29
    s_sub_u32 s15, s15, 1
    s_cbranch_scc1 layerb1_kernel_bail
    s_cmp_gt_u32 s47, s14
    s_cbranch_scc0 layerb1_kernel_p3_gw1_lp
layerb1_kernel_p3_gw1_ok:
    s_mul_i32 s20, s14, 393216
    s_add_u32 s20, s20, s44
    s_add_u32 s21, s20, 8192
    buffer_load_dwordx4 v[100:103], v9, s[8:11], s21 offen offset:0 sc1
    buffer_load_dwordx4 v[104:107], v9, s[8:11], s21 offen offset:512 sc1
    v_mov_b32 v56, 0
    v_mov_b32 v57, 0
    v_mov_b32 v58, 0
    v_mov_b32 v59, 0
    v_mov_b32 v60, 0
    v_mov_b32 v61, 0
    v_mov_b32 v62, 0
    v_mov_b32 v63, 0
    v_mov_b32 v64, 0
    v_mov_b32 v65, 0
    v_mov_b32 v66, 0
    v_mov_b32 v67, 0
    v_mov_b32 v68, 0
    v_mov_b32 v69, 0
    v_mov_b32 v70, 0
    v_mov_b32 v71, 0
    v_mov_b32 v72, 0
    v_mov_b32 v73, 0
    v_mov_b32 v74, 0
    v_mov_b32 v75, 0
    v_mov_b32 v76, 0
    v_mov_b32 v77, 0
    v_mov_b32 v78, 0
    v_mov_b32 v79, 0
    v_mov_b32 v80, 0
    v_mov_b32 v81, 0
    v_mov_b32 v82, 0
    v_mov_b32 v83, 0
    v_mov_b32 v84, 0
    v_mov_b32 v85, 0
    v_mov_b32 v86, 0
    v_mov_b32 v87, 0
    ds_read_b128 v[116:119], v13 offset:0
    ds_read_b128 v[120:123], v13 offset:1024
    ds_read_b128 v[124:127], v13 offset:2048
    ds_read_b128 v[128:131], v13 offset:3072
    ds_read_b128 v[132:135], v13 offset:4096
    ds_read_b128 v[136:139], v13 offset:5120
    ds_read_b128 v[140:143], v13 offset:6144
    ds_read_b128 v[144:147], v13 offset:7168
    s_waitcnt lgkmcnt(0)
layerb1_kernel_p3_step:
    s_cmp_lt_u32 s14, 32
    s_cselect_b32 s18, s16, s17
    s_and_b32 s20, s14, 31
    s_lshl_b32 s20, s20, 16
    s_add_u32 s18, s18, s20
    s_add_u32 s22, s18, 53248
    s_add_u32 s23, s18, 54272
layerb1_kernel_p3_poll:
    buffer_load_dwordx4 v[48:51], v1, s[8:11], s22 offen sc1
    buffer_load_dwordx4 v[52:55], v1, s[8:11], s23 offen sc1
    s_waitcnt vmcnt(0)
    ds_write_b128 v14, v[48:51] offset:8192
    ds_write_b128 v14, v[52:55] offset:9216
    v_max3_u32 v88, v48, v49, v50
    v_max3_u32 v88, v88, v51, v52
    v_max3_u32 v88, v88, v53, v54
    v_max_u32 v88, v88, v55
    v_cmp_eq_u32 vcc, -1, v88
    s_sub_u32 s15, s15, 1
    s_cbranch_scc1 layerb1_kernel_bail
    s_cbranch_vccnz layerb1_kernel_p3_poll
    s_waitcnt lgkmcnt(0)
    s_barrier
    ds_read_b128 v[16:19], v14 offset:0
    ds_read_b128 v[20:23], v14 offset:1024
    ds_read_b128 v[24:27], v14 offset:2048
    ds_read_b128 v[28:31], v14 offset:3072
    ds_read_b128 v[32:35], v14 offset:4096
    ds_read_b128 v[36:39], v14 offset:5120
    ds_read_b128 v[40:43], v14 offset:6144
    ds_read_b128 v[44:47], v14 offset:7168
    v_smfmac_f32_16x16x64_bf16 v[56:59], v[48:51], a[0:7], v2
    v_smfmac_f32_16x16x64_bf16 v[60:63], v[48:51], a[8:15], v2
    v_smfmac_f32_16x16x64_bf16 v[64:67], v[48:51], a[16:23], v2
    v_smfmac_f32_16x16x64_bf16 v[56:59], v[52:55], a[24:31], v2
    v_smfmac_f32_16x16x64_bf16 v[60:63], v[52:55], a[32:39], v2
    v_smfmac_f32_16x16x64_bf16 v[64:67], v[52:55], a[40:47], v2
    s_waitcnt lgkmcnt(7)
    v_smfmac_f32_16x16x64_bf16 v[56:59], v[16:19], a[48:55], v2
    v_smfmac_f32_16x16x64_bf16 v[60:63], v[16:19], a[56:63], v2
    v_smfmac_f32_16x16x64_bf16 v[64:67], v[16:19], a[64:71], v2
    s_waitcnt lgkmcnt(6)
    v_smfmac_f32_16x16x64_bf16 v[56:59], v[20:23], v[116:123], v2
    ds_read_b128 v[116:119], v13 offset:8192
    ds_read_b128 v[120:123], v13 offset:9216
    v_smfmac_f32_16x16x64_bf16 v[60:63], v[20:23], a[72:79], v2
    v_smfmac_f32_16x16x64_bf16 v[64:67], v[20:23], v[124:131], v2
    ds_read_b128 v[124:127], v13 offset:10240
    ds_read_b128 v[128:131], v13 offset:11264
    s_waitcnt lgkmcnt(9)
    v_smfmac_f32_16x16x64_bf16 v[56:59], v[24:27], a[80:87], v2
    v_smfmac_f32_16x16x64_bf16 v[60:63], v[24:27], v[132:139], v2
    ds_read_b128 v[132:135], v13 offset:12288
    ds_read_b128 v[136:139], v13 offset:13312
    v_smfmac_f32_16x16x64_bf16 v[64:67], v[24:27], a[88:95], v2
    s_waitcnt lgkmcnt(10)
    v_smfmac_f32_16x16x64_bf16 v[56:59], v[28:31], v[140:147], v2
    ds_read_b128 v[140:143], v13 offset:14336
    ds_read_b128 v[144:147], v13 offset:15360
    v_smfmac_f32_16x16x64_bf16 v[60:63], v[28:31], a[96:103], v2
    s_waitcnt lgkmcnt(6)
    v_smfmac_f32_16x16x64_bf16 v[64:67], v[28:31], v[116:123], v2
    ds_read_b128 v[116:119], v13 offset:16384
    ds_read_b128 v[120:123], v13 offset:17408
    v_smfmac_f32_16x16x64_bf16 v[56:59], v[32:35], a[104:111], v2
    s_waitcnt lgkmcnt(6)
    v_smfmac_f32_16x16x64_bf16 v[60:63], v[32:35], v[124:131], v2
    ds_read_b128 v[124:127], v13 offset:18432
    ds_read_b128 v[128:131], v13 offset:19456
    v_smfmac_f32_16x16x64_bf16 v[64:67], v[32:35], a[112:119], v2
    s_waitcnt lgkmcnt(6)
    v_smfmac_f32_16x16x64_bf16 v[56:59], v[36:39], v[132:139], v2
    ds_read_b128 v[132:135], v13 offset:20480
    ds_read_b128 v[136:139], v13 offset:21504
    v_smfmac_f32_16x16x64_bf16 v[60:63], v[36:39], a[120:127], v2
    s_waitcnt lgkmcnt(6)
    v_smfmac_f32_16x16x64_bf16 v[64:67], v[36:39], v[140:147], v2
    ds_read_b128 v[140:143], v13 offset:22528
    ds_read_b128 v[144:147], v13 offset:23552
    v_smfmac_f32_16x16x64_bf16 v[56:59], v[40:43], a[128:135], v2
    s_waitcnt lgkmcnt(6)
    v_smfmac_f32_16x16x64_bf16 v[60:63], v[40:43], v[116:123], v2
    ds_read_b128 v[116:119], v13 offset:24576
    ds_read_b128 v[120:123], v13 offset:25600
    v_smfmac_f32_16x16x64_bf16 v[64:67], v[40:43], a[136:143], v2
    s_waitcnt lgkmcnt(6)
    v_smfmac_f32_16x16x64_bf16 v[56:59], v[44:47], v[124:131], v2
    ds_read_b128 v[124:127], v13 offset:26624
    ds_read_b128 v[128:131], v13 offset:27648
    v_smfmac_f32_16x16x64_bf16 v[60:63], v[44:47], a[144:151], v2
    s_waitcnt lgkmcnt(6)
    v_smfmac_f32_16x16x64_bf16 v[64:67], v[44:47], v[132:139], v2
    ds_read_b128 v[132:135], v13 offset:28672
    ds_read_b128 v[136:139], v13 offset:29696
    v_smfmac_f32_16x16x64_bf16 v[68:71], v[16:19], a[152:159], v2
    v_smfmac_f32_16x16x64_bf16 v[68:71], v[20:23], a[160:167], v2
    v_permlane32_swap_b32 v56, v58
    v_permlane32_swap_b32 v57, v59
    v_smfmac_f32_16x16x64_bf16 v[68:71], v[24:27], a[168:175], v2
    v_add_f32 v56, v56, v58
    v_add_f32 v57, v57, v59
    v_smfmac_f32_16x16x64_bf16 v[68:71], v[28:31], a[176:183], v2
    v_cvt_pk_bf16_f32 v56, v56, v57
    ds_write_b16 v3, v56 offset:0
    v_smfmac_f32_16x16x64_bf16 v[68:71], v[32:35], a[184:191], v2
    ds_write_b16_d16_hi v3, v56 offset:400
    v_permlane32_swap_b32 v60, v62
    v_smfmac_f32_16x16x64_bf16 v[68:71], v[36:39], a[192:199], v2
    v_permlane32_swap_b32 v61, v63
    v_add_f32 v60, v60, v62
    v_smfmac_f32_16x16x64_bf16 v[68:71], v[40:43], a[200:207], v2
    v_add_f32 v61, v61, v63
    v_cvt_pk_bf16_f32 v60, v60, v61
    v_smfmac_f32_16x16x64_bf16 v[68:71], v[44:47], a[208:215], v2
    ds_write_b16 v3, v60 offset:32
    ds_write_b16_d16_hi v3, v60 offset:432
    v_smfmac_f32_16x16x64_bf16 v[68:71], v[48:51], a[216:223], v2
    v_permlane32_swap_b32 v64, v66
    v_permlane32_swap_b32 v65, v67
    v_smfmac_f32_16x16x64_bf16 v[68:71], v[52:55], a[224:231], v2
    v_add_f32 v64, v64, v66
    v_add_f32 v65, v65, v67
    v_smfmac_f32_16x16x64_bf16 v[72:75], v[16:19], a[232:239], v2
    v_cvt_pk_bf16_f32 v64, v64, v65
    ds_write_b16 v3, v64 offset:64
    v_smfmac_f32_16x16x64_bf16 v[72:75], v[20:23], a[240:247], v2
    ds_write_b16_d16_hi v3, v64 offset:464
    v_smfmac_f32_16x16x64_bf16 v[72:75], v[24:27], a[248:255], v2
    v_smfmac_f32_16x16x64_bf16 v[72:75], v[28:31], v[148:155], v2
    s_waitcnt lgkmcnt(0)
    s_barrier
    ds_read_b128 v[88:91], v4 offset:0
    v_smfmac_f32_16x16x64_bf16 v[72:75], v[32:35], v[140:147], v2
    ds_read_b128 v[92:95], v4 offset:128
    ds_read_b128 v[96:99], v4 offset:256
    v_smfmac_f32_16x16x64_bf16 v[72:75], v[36:39], v[156:163], v2
    v_permlane32_swap_b32 v68, v70
    v_permlane32_swap_b32 v69, v71
    v_smfmac_f32_16x16x64_bf16 v[72:75], v[40:43], v[164:171], v2
    v_add_f32 v68, v68, v70
    v_add_f32 v69, v69, v71
    v_smfmac_f32_16x16x64_bf16 v[72:75], v[44:47], v[172:179], v2
    v_cvt_pk_bf16_f32 v68, v68, v69
    ds_write_b16 v3, v68 offset:3200
    v_smfmac_f32_16x16x64_bf16 v[72:75], v[48:51], v[116:123], v2
    ds_write_b16_d16_hi v3, v68 offset:3600
    v_smfmac_f32_16x16x64_bf16 v[72:75], v[52:55], v[180:187], v2
    s_waitcnt lgkmcnt(2)
    v_smfmac_f32_16x16x64_bf16 v[80:83], v[96:99], v[100:107], v2
    v_smfmac_f32_16x16x64_bf16 v[76:79], v[16:19], v[188:195], v2
    v_smfmac_f32_16x16x64_bf16 v[76:79], v[20:23], v[196:203], v2
    v_smfmac_f32_16x16x64_bf16 v[76:79], v[24:27], v[124:131], v2
    v_permlane32_swap_b32 v72, v74
    v_permlane32_swap_b32 v73, v75
    v_smfmac_f32_16x16x64_bf16 v[76:79], v[28:31], v[204:211], v2
    v_add_f32 v72, v72, v74
    v_add_f32 v73, v73, v75
    ds_write_b128 v15, v[80:83]
    v_smfmac_f32_16x16x64_bf16 v[76:79], v[32:35], v[212:219], v2
    v_cvt_pk_bf16_f32 v72, v72, v73
    ds_write_b16 v3, v72 offset:3232
    v_smfmac_f32_16x16x64_bf16 v[76:79], v[36:39], v[220:227], v2
    ds_write_b16_d16_hi v3, v72 offset:3632
    v_smfmac_f32_16x16x64_bf16 v[76:79], v[40:43], v[132:139], v2
    v_smfmac_f32_16x16x64_bf16 v[76:79], v[44:47], v[228:235], v2
    v_smfmac_f32_16x16x64_bf16 v[76:79], v[48:51], v[236:243], v2
    v_smfmac_f32_16x16x64_bf16 v[76:79], v[52:55], v[244:251], v2
    s_nop 7
    v_permlane32_swap_b32 v76, v78
    v_permlane32_swap_b32 v77, v79
    v_add_f32 v76, v76, v78
    v_add_f32 v77, v77, v79
    v_cvt_pk_bf16_f32 v76, v76, v77
    ds_write_b16 v3, v76 offset:3264
    ds_write_b16_d16_hi v3, v76 offset:3664
    s_waitcnt lgkmcnt(0)
    s_barrier
    ds_read2st64_b32 v[40:41], v6 offset0:0 offset1:2
    ds_read2st64_b32 v[42:43], v6 offset0:8 offset1:10
    ds_read_b128 v[16:19], v5 offset:0
    ds_read_b128 v[20:23], v5 offset:16
    ds_read_b128 v[24:27], v5 offset:128
    ds_read_b128 v[28:31], v5 offset:144
    ds_read_b128 v[32:35], v5 offset:256
    ds_read_b128 v[36:39], v5 offset:272
    s_waitcnt lgkmcnt(6)
    v_add_f32 v40, v40, v41
    v_add_f32 v42, v42, v43
    v_add_f32 v44, v40, v42
    v_mul_f32 v44, 0x3dd53b95, v44
    s_waitcnt lgkmcnt(4)
    v_smfmac_f32_16x16x64_bf16 v[84:87], v[88:91], v[16:23], v2
    s_waitcnt lgkmcnt(2)
    v_smfmac_f32_16x16x64_bf16 v[84:87], v[92:95], v[24:31], v2
    s_waitcnt lgkmcnt(0)
    v_smfmac_f32_16x16x64_bf16 v[84:87], v[96:99], v[32:39], v2
    v_max_f32_dpp v45, v44, v44 row_ror:8 row_mask:0xf bank_mask:0xf
    s_nop 1
    v_max_f32_dpp v45, v45, v45 row_ror:4 row_mask:0xf bank_mask:0xf
    s_nop 1
    v_max_f32_dpp v45, v45, v45 row_ror:2 row_mask:0xf bank_mask:0xf
    s_nop 1
    v_max_f32_dpp v45, v45, v45 row_ror:1 row_mask:0xf bank_mask:0xf
    v_mov_b32 v47, v45
    s_nop 1
    v_permlane32_swap_b32 v45, v47
    v_max_f32 v45, v45, v47
    v_mov_b32 v47, v87
    s_nop 1
    v_permlane32_swap_b32 v87, v47
    v_add_f32 v48, v87, v47
    v_mul_f32 v48, 0x3dd53b95, v48
    s_nop 1
    v_max_f32_dpp v46, v48, v48 row_ror:4 row_mask:0xf bank_mask:0xf
    s_nop 1
    v_max_f32_dpp v46, v46, v46 row_ror:2 row_mask:0xf bank_mask:0xf
    s_nop 1
    v_max_f32_dpp v46, v46, v46 row_ror:1 row_mask:0xf bank_mask:0xf
    v_max_f32 v45, v45, v46
    v_sub_f32 v49, v44, v45
    v_sub_f32 v50, v48, v45
    v_exp_f32 v49, v49
    v_exp_f32 v50, v50
    s_nop 0
    v_fma_f32 v51, v50, v12, v49
    s_nop 1
    v_add_f32_dpp v51, v51, v51 row_ror:8 row_mask:0xf bank_mask:0xf
    s_nop 1
    v_add_f32_dpp v51, v51, v51 row_ror:4 row_mask:0xf bank_mask:0xf
    s_nop 1
    v_add_f32_dpp v51, v51, v51 row_ror:2 row_mask:0xf bank_mask:0xf
    s_nop 1
    v_add_f32_dpp v51, v51, v51 row_ror:1 row_mask:0xf bank_mask:0xf
    v_mov_b32 v47, v51
    s_nop 1
    v_permlane32_swap_b32 v51, v47
    v_add_f32 v51, v51, v47
    v_rcp_f32 v51, v51
    s_nop 0
    v_mul_f32 v49, v49, v51
    v_mul_f32 v50, v50, v51
    s_nop 0
    v_mov_b32_dpp v46, v49 quad_perm:[1,0,3,2] row_mask:0xf bank_mask:0xf
    v_mov_b32_dpp v47, v50 quad_perm:[1,0,3,2] row_mask:0xf bank_mask:0xf
    v_cvt_pk_bf16_f32 v16, v49, v46
    v_cvt_pk_bf16_f32 v20, v50, v47
    s_nop 0
    v_mov_b32_dpp v17, v16 row_shl:2 row_mask:0xf bank_mask:0xf
    v_mov_b32_dpp v18, v16 row_shl:4 row_mask:0xf bank_mask:0xf
    v_mov_b32_dpp v19, v16 row_shl:6 row_mask:0xf bank_mask:0xf
    v_mov_b32_dpp v21, v20 row_shl:2 row_mask:0xf bank_mask:0xf
    v_mov_b32_dpp v22, v20 row_shl:4 row_mask:0xf bank_mask:0xf
    v_mov_b32_dpp v23, v20 row_shl:6 row_mask:0xf bank_mask:0xf
    s_mov_b64 exec, s[40:41]
    buffer_store_dwordx4 v[16:19], v7, s[8:11], s18 offen sc1
    s_mov_b64 exec, s[42:43]
    buffer_store_dwordx4 v[20:23], v8, s[8:11], s18 offen sc1
    s_mov_b64 exec, -1
    s_add_u32 s28, s14, 1
    s_min_u32 s28, s28, 63
    s_cmp_gt_u32 s47, s28
    s_cbranch_scc1 layerb1_kernel_p3_gw2_ok
layerb1_kernel_p3_gw2_lp:
    buffer_load_dword v253, v255, s[8:11], s48 offen sc1
    s_waitcnt vmcnt(0)
    v_readlane_b32 s47, v253, 0
    v_readlane_b32 s29, v253, 1
    s_nop 0
    s_min_u32 s47, s47, s29
    s_sub_u32 s15, s15, 1
    s_cbranch_scc1 layerb1_kernel_bail
    s_cmp_gt_u32 s47, s28
    s_cbranch_scc0 layerb1_kernel_p3_gw2_lp
layerb1_kernel_p3_gw2_ok:
    s_mul_i32 s20, s28, 393216
    s_add_u32 s20, s20, s44
    s_add_u32 s21, s20, 8192
    buffer_load_dwordx4 v[100:103], v9, s[8:11], s21 offen offset:0 sc1
    buffer_load_dwordx4 v[104:107], v9, s[8:11], s21 offen offset:512 sc1
    v_mov_b32 v56, 0
    v_mov_b32 v57, 0
    v_mov_b32 v58, 0
    v_mov_b32 v59, 0
    v_mov_b32 v60, 0
    v_mov_b32 v61, 0
    v_mov_b32 v62, 0
    v_mov_b32 v63, 0
    v_mov_b32 v64, 0
    v_mov_b32 v65, 0
    v_mov_b32 v66, 0
    v_mov_b32 v67, 0
    v_mov_b32 v68, 0
    v_mov_b32 v69, 0
    v_mov_b32 v70, 0
    v_mov_b32 v71, 0
    v_mov_b32 v72, 0
    v_mov_b32 v73, 0
    v_mov_b32 v74, 0
    v_mov_b32 v75, 0
    v_mov_b32 v76, 0
    v_mov_b32 v77, 0
    v_mov_b32 v78, 0
    v_mov_b32 v79, 0
    v_mov_b32 v80, 0
    v_mov_b32 v81, 0
    v_mov_b32 v82, 0
    v_mov_b32 v83, 0
    v_mov_b32 v84, 0
    v_mov_b32 v85, 0
    v_mov_b32 v86, 0
    v_mov_b32 v87, 0
    s_lshl_b32 s20, s12, 7
    s_add_u32 s20, s20, 16384
    s_mov_b64 exec, 1
    v_mov_b32 v253, s20
    v_mov_b32 v254, s14
    buffer_store_dword v254, v253, s[8:11], s48 offen sc1
    s_mov_b64 exec, -1
    ds_read_b128 v[116:119], v13 offset:0
    ds_read_b128 v[120:123], v13 offset:1024
    ds_read_b128 v[124:127], v13 offset:2048
    ds_read_b128 v[128:131], v13 offset:3072
    ds_read_b128 v[132:135], v13 offset:4096
    ds_read_b128 v[136:139], v13 offset:5120
    ds_read_b128 v[140:143], v13 offset:6144
    ds_read_b128 v[144:147], v13 offset:7168
    s_waitcnt lgkmcnt(0)
    s_add_u32 s14, s14, 1
    s_cmp_lt_u32 s14, 64
    s_cbranch_scc1 layerb1_kernel_p3_step
    s_waitcnt vmcnt(0)
    s_barrier
    s_lshl_b32 s20, s12, 7
    s_add_u32 s20, s20, 16384
    s_mov_b64 exec, 1
    v_mov_b32 v253, s20
    v_mov_b32 v254, s14
    buffer_store_dword v254, v253, s[8:11], s48 offen sc1
    s_mov_b64 exec, -1
    s_branch layerb1_kernel_end
layerb1_kernel_y0_start:
    v_lshrrev_b32 v16, 4, v0
    v_and_b32 v17, 7, v0
    v_lshrrev_b32 v18, 3, v0
    v_and_b32 v18, 1, v18
    v_lshl_add_u32 v19, v18, 2, v16
    v_add_u32 v19, 0, v19
    v_mul_u32_u24 v20, 640, v19
    v_lshl_add_u32 v4, v17, 4, v20
    v_and_b32 v20, 3, v17
    v_lshlrev_b32 v20, 1, v20
    v_lshrrev_b32 v21, 2, v17
    v_add_u32 v20, v20, v21
    v_lshlrev_b32 v20, 4, v20
    v_lshl_add_u32 v5, v19, 7, v20
    v_add_u32 v3, 0, v1
    v_lshrrev_b32 v20, 1, v17
    v_lshlrev_b32 v20, 7, v20
    v_and_b32 v21, 1, v17
    v_lshl_add_u32 v20, v21, 2, v20
    v_add_u32 v10, 0, v20
    v_lshlrev_b32 v20, 8, v18
    v_lshl_add_u32 v20, v17, 5, v20
    v_and_b32 v21, 1, v16
    v_lshl_add_u32 v20, v21, 4, v20
    v_add_u32 v20, 10240, v20
    v_add_u32 v21, 12288, v1
    v_lshrrev_b32 v22, 1, v16
    v_cmp_eq_u32 vcc, v22, v18
    s_nop 1
    v_cndmask_b32 v6, v21, v20, vcc
    v_lshrrev_b32 v20, 3, v0
    v_lshlrev_b32 v20, 2, v20
    v_lshl_add_u32 v20, v17, 5, v20
    v_add_u32 v7, 10240, v20
    s_lshl_b32 s20, s12, 7
    s_add_u32 s20, s20, 20480
    s_lshr_b32 s21, s20, 13
    s_lshl_b32 s21, s21, 14
    s_and_b32 s20, s20, 8191
    s_add_u32 s20, s20, s21
    v_lshrrev_b32 v20, 3, v0
    v_lshlrev_b32 v20, 4, v20
    v_add_u32 v8, s20, v20
    s_mul_i32 s46, s12, 20480
    s_add_u32 s46, s46, 103809024
    s_mul_i32 s20, s12, 327680
    s_add_u32 s20, s20, 27262976
    s_add_u32 s21, s20, 0
    buffer_load_dwordx4 a[0:3], v1, s[8:11], s21 offen offset:0
    buffer_load_dwordx4 a[4:7], v1, s[8:11], s21 offen offset:1024
    s_add_u32 s21, s20, 2048
    buffer_load_dwordx4 a[8:11], v1, s[8:11], s21 offen offset:0
    buffer_load_dwordx4 a[12:15], v1, s[8:11], s21 offen offset:1024
    s_add_u32 s21, s20, 4096
    buffer_load_dwordx4 a[16:19], v1, s[8:11], s21 offen offset:0
    buffer_load_dwordx4 a[20:23], v1, s[8:11], s21 offen offset:1024
    s_add_u32 s21, s20, 6144
    buffer_load_dwordx4 a[24:27], v1, s[8:11], s21 offen offset:0
    buffer_load_dwordx4 a[28:31], v1, s[8:11], s21 offen offset:1024
    s_add_u32 s21, s20, 8192
    buffer_load_dwordx4 a[32:35], v1, s[8:11], s21 offen offset:0
    buffer_load_dwordx4 a[36:39], v1, s[8:11], s21 offen offset:1024
    s_add_u32 s21, s20, 10240
    buffer_load_dwordx4 a[40:43], v1, s[8:11], s21 offen offset:0
    buffer_load_dwordx4 a[44:47], v1, s[8:11], s21 offen offset:1024
    s_add_u32 s21, s20, 12288
    buffer_load_dwordx4 a[48:51], v1, s[8:11], s21 offen offset:0
    buffer_load_dwordx4 a[52:55], v1, s[8:11], s21 offen offset:1024
    s_add_u32 s21, s20, 14336
    buffer_load_dwordx4 a[56:59], v1, s[8:11], s21 offen offset:0
    buffer_load_dwordx4 a[60:63], v1, s[8:11], s21 offen offset:1024
    s_add_u32 s21, s20, 16384
    buffer_load_dwordx4 a[64:67], v1, s[8:11], s21 offen offset:0
    buffer_load_dwordx4 a[68:71], v1, s[8:11], s21 offen offset:1024
    s_add_u32 s21, s20, 18432
    buffer_load_dwordx4 a[72:75], v1, s[8:11], s21 offen offset:0
    buffer_load_dwordx4 a[76:79], v1, s[8:11], s21 offen offset:1024
    s_add_u32 s21, s20, 20480
    buffer_load_dwordx4 a[80:83], v1, s[8:11], s21 offen offset:0
    buffer_load_dwordx4 a[84:87], v1, s[8:11], s21 offen offset:1024
    s_add_u32 s21, s20, 22528
    buffer_load_dwordx4 a[88:91], v1, s[8:11], s21 offen offset:0
    buffer_load_dwordx4 a[92:95], v1, s[8:11], s21 offen offset:1024
    s_add_u32 s21, s20, 24576
    buffer_load_dwordx4 a[96:99], v1, s[8:11], s21 offen offset:0
    buffer_load_dwordx4 a[100:103], v1, s[8:11], s21 offen offset:1024
    s_add_u32 s21, s20, 26624
    buffer_load_dwordx4 a[104:107], v1, s[8:11], s21 offen offset:0
    buffer_load_dwordx4 a[108:111], v1, s[8:11], s21 offen offset:1024
    s_add_u32 s21, s20, 28672
    buffer_load_dwordx4 a[112:115], v1, s[8:11], s21 offen offset:0
    buffer_load_dwordx4 a[116:119], v1, s[8:11], s21 offen offset:1024
    s_add_u32 s21, s20, 30720
    buffer_load_dwordx4 a[120:123], v1, s[8:11], s21 offen offset:0
    buffer_load_dwordx4 a[124:127], v1, s[8:11], s21 offen offset:1024
    s_add_u32 s21, s20, 32768
    buffer_load_dwordx4 a[128:131], v1, s[8:11], s21 offen offset:0
    buffer_load_dwordx4 a[132:135], v1, s[8:11], s21 offen offset:1024
    s_add_u32 s21, s20, 34816
    buffer_load_dwordx4 a[136:139], v1, s[8:11], s21 offen offset:0
    buffer_load_dwordx4 a[140:143], v1, s[8:11], s21 offen offset:1024
    s_add_u32 s21, s20, 36864
    buffer_load_dwordx4 a[144:147], v1, s[8:11], s21 offen offset:0
    buffer_load_dwordx4 a[148:151], v1, s[8:11], s21 offen offset:1024
    s_add_u32 s21, s20, 38912
    buffer_load_dwordx4 a[152:155], v1, s[8:11], s21 offen offset:0
    buffer_load_dwordx4 a[156:159], v1, s[8:11], s21 offen offset:1024
    s_add_u32 s21, s20, 40960
    buffer_load_dwordx4 a[160:163], v1, s[8:11], s21 offen offset:0
    buffer_load_dwordx4 a[164:167], v1, s[8:11], s21 offen offset:1024
    s_add_u32 s21, s20, 43008
    buffer_load_dwordx4 a[168:171], v1, s[8:11], s21 offen offset:0
    buffer_load_dwordx4 a[172:175], v1, s[8:11], s21 offen offset:1024
    s_add_u32 s21, s20, 45056
    buffer_load_dwordx4 a[176:179], v1, s[8:11], s21 offen offset:0
    buffer_load_dwordx4 a[180:183], v1, s[8:11], s21 offen offset:1024
    s_add_u32 s21, s20, 47104
    buffer_load_dwordx4 a[184:187], v1, s[8:11], s21 offen offset:0
    buffer_load_dwordx4 a[188:191], v1, s[8:11], s21 offen offset:1024
    s_add_u32 s21, s20, 49152
    buffer_load_dwordx4 a[192:195], v1, s[8:11], s21 offen offset:0
    buffer_load_dwordx4 a[196:199], v1, s[8:11], s21 offen offset:1024
    s_add_u32 s21, s20, 51200
    buffer_load_dwordx4 a[200:203], v1, s[8:11], s21 offen offset:0
    buffer_load_dwordx4 a[204:207], v1, s[8:11], s21 offen offset:1024
    s_add_u32 s21, s20, 53248
    buffer_load_dwordx4 a[208:211], v1, s[8:11], s21 offen offset:0
    buffer_load_dwordx4 a[212:215], v1, s[8:11], s21 offen offset:1024
    s_add_u32 s21, s20, 55296
    buffer_load_dwordx4 a[216:219], v1, s[8:11], s21 offen offset:0
    buffer_load_dwordx4 a[220:223], v1, s[8:11], s21 offen offset:1024
    s_add_u32 s21, s20, 57344
    buffer_load_dwordx4 a[224:227], v1, s[8:11], s21 offen offset:0
    buffer_load_dwordx4 a[228:231], v1, s[8:11], s21 offen offset:1024
    s_add_u32 s21, s20, 59392
    buffer_load_dwordx4 a[232:235], v1, s[8:11], s21 offen offset:0
    buffer_load_dwordx4 a[236:239], v1, s[8:11], s21 offen offset:1024
    s_add_u32 s21, s20, 61440
    buffer_load_dwordx4 a[240:243], v1, s[8:11], s21 offen offset:0
    buffer_load_dwordx4 a[244:247], v1, s[8:11], s21 offen offset:1024
    s_add_u32 s21, s20, 63488
    buffer_load_dwordx4 a[248:251], v1, s[8:11], s21 offen offset:0
    buffer_load_dwordx4 a[252:255], v1, s[8:11], s21 offen offset:1024
    s_add_u32 s21, s20, 65536
    buffer_load_dwordx4 v[176:179], v1, s[8:11], s21 offen offset:0
    buffer_load_dwordx4 v[180:183], v1, s[8:11], s21 offen offset:1024
    s_add_u32 s21, s20, 67584
    buffer_load_dwordx4 v[184:187], v1, s[8:11], s21 offen offset:0
    buffer_load_dwordx4 v[188:191], v1, s[8:11], s21 offen offset:1024
    s_add_u32 s21, s20, 69632
    buffer_load_dwordx4 v[192:195], v1, s[8:11], s21 offen offset:0
    buffer_load_dwordx4 v[196:199], v1, s[8:11], s21 offen offset:1024
    s_add_u32 s21, s20, 71680
    buffer_load_dwordx4 v[200:203], v1, s[8:11], s21 offen offset:0
    buffer_load_dwordx4 v[204:207], v1, s[8:11], s21 offen offset:1024
    s_add_u32 s21, s20, 73728
    buffer_load_dwordx4 v[208:211], v1, s[8:11], s21 offen offset:0
    buffer_load_dwordx4 v[212:215], v1, s[8:11], s21 offen offset:1024
    s_add_u32 s21, s20, 75776
    buffer_load_dwordx4 v[216:219], v1, s[8:11], s21 offen offset:0
    buffer_load_dwordx4 v[220:223], v1, s[8:11], s21 offen offset:1024
    s_add_u32 s21, s20, 77824
    buffer_load_dwordx4 v[224:227], v1, s[8:11], s21 offen offset:0
    buffer_load_dwordx4 v[228:231], v1, s[8:11], s21 offen offset:1024
    s_add_u32 s21, s20, 79872
    buffer_load_dwordx4 v[232:235], v1, s[8:11], s21 offen offset:0
    buffer_load_dwordx4 v[236:239], v1, s[8:11], s21 offen offset:1024
    s_mov_b32 s14, 0
    s_lshl_b32 s20, s12, 7
    v_mov_b32 v9, s20
    s_mov_b32 s47, 0
layerb1_kernel_y0_step:
    s_cmp_lt_u32 s14, 32
    s_cselect_b32 s18, s16, s17
    s_and_b32 s20, s14, 31
    s_lshl_b32 s20, s20, 16
    s_add_u32 s18, s18, s20
    s_mul_i32 s28, s14, 1638400
    s_add_u32 s28, s28, s46
    v_mov_b32 v56, 0
    v_mov_b32 v57, 0
    v_mov_b32 v58, 0
    v_mov_b32 v59, 0
    v_mov_b32 v60, 0
    v_mov_b32 v61, 0
    v_mov_b32 v62, 0
    v_mov_b32 v63, 0
    v_mov_b32 v64, 0
    v_mov_b32 v65, 0
    v_mov_b32 v66, 0
    v_mov_b32 v67, 0
    v_mov_b32 v68, 0
    v_mov_b32 v69, 0
    v_mov_b32 v70, 0
    v_mov_b32 v71, 0
    s_add_u32 s22, s18, 36864
    s_add_u32 s23, s18, 37888
    s_add_u32 s24, s18, 38912
layerb1_kernel_y0_poll:
    buffer_load_dwordx4 v[16:19], v1, s[8:11], s22 offen sc1
    buffer_load_dwordx4 v[20:23], v1, s[8:11], s23 offen sc1
    buffer_load_dwordx4 v[24:27], v1, s[8:11], s24 offen sc1
    s_waitcnt vmcnt(0)
    ds_write_b128 v3, v[16:19] offset:0
    ds_write_b128 v3, v[20:23] offset:1024
    ds_write_b128 v3, v[24:27] offset:2048
    v_max3_u32 v116, v16, v17, v18
    v_max3_u32 v116, v116, v19, v20
    v_max3_u32 v116, v116, v21, v22
    v_max3_u32 v116, v116, v23, v24
    v_max3_u32 v116, v116, v25, v26
    v_max_u32 v116, v116, v27
    v_cmp_eq_u32 vcc, -1, v116
    s_sub_u32 s15, s15, 1
    s_cbranch_scc1 layerb1_kernel_bail
    s_cbranch_vccnz layerb1_kernel_y0_poll
    s_waitcnt lgkmcnt(0)
    s_barrier
    ds_read_b128 v[28:31], v3 offset:3072
    ds_read_b128 v[32:35], v3 offset:4096
    ds_read_b128 v[36:39], v3 offset:5120
    ds_read_b128 v[40:43], v3 offset:6144
    ds_read_b128 v[44:47], v3 offset:7168
    ds_read_b128 v[48:51], v3 offset:8192
    ds_read_b128 v[52:55], v3 offset:9216
    s_cmp_gt_u32 s47, s14
    s_cbranch_scc1 layerb1_kernel_y0_gw_ok
layerb1_kernel_y0_gw_lp:
    buffer_load_dword v116, v9, s[8:11], s48 offen sc1
    s_waitcnt vmcnt(0)
    v_readlane_b32 s47, v116, 0
    s_nop 0
    s_sub_u32 s15, s15, 1
    s_cbranch_scc1 layerb1_kernel_bail
    s_cmp_gt_u32 s47, s14
    s_cbranch_scc0 layerb1_kernel_y0_gw_lp
layerb1_kernel_y0_gw_ok:
    buffer_load_dwordx4 v[76:79], v4, s[8:11], s28 offen offset:128 sc1
    buffer_load_dwordx4 v[80:83], v4, s[8:11], s28 offen offset:256 sc1
    buffer_load_dwordx4 v[84:87], v4, s[8:11], s28 offen offset:384 sc1
    buffer_load_dwordx4 v[88:91], v4, s[8:11], s28 offen offset:512 sc1
    v_smfmac_f32_16x16x64_bf16 v[56:59], v[16:19], a[0:7], v2
    v_smfmac_f32_16x16x64_bf16 v[60:63], v[16:19], a[80:87], v2
    v_smfmac_f32_16x16x64_bf16 v[64:67], v[16:19], a[160:167], v2
    v_smfmac_f32_16x16x64_bf16 v[68:71], v[16:19], a[240:247], v2
    v_smfmac_f32_16x16x64_bf16 v[56:59], v[20:23], a[8:15], v2
    v_smfmac_f32_16x16x64_bf16 v[60:63], v[20:23], a[88:95], v2
    v_smfmac_f32_16x16x64_bf16 v[64:67], v[20:23], a[168:175], v2
    v_smfmac_f32_16x16x64_bf16 v[68:71], v[20:23], a[248:255], v2
    v_smfmac_f32_16x16x64_bf16 v[56:59], v[24:27], a[16:23], v2
    v_smfmac_f32_16x16x64_bf16 v[60:63], v[24:27], a[96:103], v2
    v_smfmac_f32_16x16x64_bf16 v[64:67], v[24:27], a[176:183], v2
    v_smfmac_f32_16x16x64_bf16 v[68:71], v[24:27], v[176:183], v2
    s_waitcnt lgkmcnt(6)
    v_smfmac_f32_16x16x64_bf16 v[56:59], v[28:31], a[24:31], v2
    v_smfmac_f32_16x16x64_bf16 v[60:63], v[28:31], a[104:111], v2
    v_smfmac_f32_16x16x64_bf16 v[64:67], v[28:31], a[184:191], v2
    v_smfmac_f32_16x16x64_bf16 v[68:71], v[28:31], v[184:191], v2
    s_waitcnt lgkmcnt(5)
    v_smfmac_f32_16x16x64_bf16 v[56:59], v[32:35], a[32:39], v2
    v_smfmac_f32_16x16x64_bf16 v[60:63], v[32:35], a[112:119], v2
    v_smfmac_f32_16x16x64_bf16 v[64:67], v[32:35], a[192:199], v2
    v_smfmac_f32_16x16x64_bf16 v[68:71], v[32:35], v[192:199], v2
    s_waitcnt lgkmcnt(4)
    v_smfmac_f32_16x16x64_bf16 v[56:59], v[36:39], a[40:47], v2
    v_smfmac_f32_16x16x64_bf16 v[60:63], v[36:39], a[120:127], v2
    v_smfmac_f32_16x16x64_bf16 v[64:67], v[36:39], a[200:207], v2
    v_smfmac_f32_16x16x64_bf16 v[68:71], v[36:39], v[200:207], v2
    s_waitcnt lgkmcnt(3)
    v_smfmac_f32_16x16x64_bf16 v[56:59], v[40:43], a[48:55], v2
    v_smfmac_f32_16x16x64_bf16 v[60:63], v[40:43], a[128:135], v2
    v_smfmac_f32_16x16x64_bf16 v[64:67], v[40:43], a[208:215], v2
    v_smfmac_f32_16x16x64_bf16 v[68:71], v[40:43], v[208:215], v2
    s_waitcnt lgkmcnt(2)
    v_smfmac_f32_16x16x64_bf16 v[56:59], v[44:47], a[56:63], v2
    v_smfmac_f32_16x16x64_bf16 v[60:63], v[44:47], a[136:143], v2
    v_smfmac_f32_16x16x64_bf16 v[64:67], v[44:47], a[216:223], v2
    v_smfmac_f32_16x16x64_bf16 v[68:71], v[44:47], v[216:223], v2
    s_waitcnt lgkmcnt(1)
    v_smfmac_f32_16x16x64_bf16 v[56:59], v[48:51], a[64:71], v2
    v_smfmac_f32_16x16x64_bf16 v[60:63], v[48:51], a[144:151], v2
    v_smfmac_f32_16x16x64_bf16 v[64:67], v[48:51], a[224:231], v2
    v_smfmac_f32_16x16x64_bf16 v[68:71], v[48:51], v[224:231], v2
    s_waitcnt lgkmcnt(0)
    v_smfmac_f32_16x16x64_bf16 v[56:59], v[52:55], a[72:79], v2
    v_smfmac_f32_16x16x64_bf16 v[60:63], v[52:55], a[152:159], v2
    v_smfmac_f32_16x16x64_bf16 v[64:67], v[52:55], a[232:239], v2
    v_smfmac_f32_16x16x64_bf16 v[68:71], v[52:55], v[232:239], v2
    s_nop 7
    v_permlane32_swap_b32 v56, v64
    v_permlane32_swap_b32 v60, v68
    v_permlane32_swap_b32 v57, v65
    v_permlane32_swap_b32 v61, v69
    v_permlane32_swap_b32 v58, v66
    v_permlane32_swap_b32 v62, v70
    v_permlane32_swap_b32 v59, v67
    v_permlane32_swap_b32 v63, v71
    v_add_f32 v56, v56, v64
    v_add_f32 v60, v60, v68
    v_add_f32 v57, v57, v65
    v_add_f32 v61, v61, v69
    v_add_f32 v58, v58, v66
    v_add_f32 v62, v62, v70
    v_add_f32 v59, v59, v67
    v_add_f32 v63, v63, v71
    s_nop 1
    v_permlane16_swap_b32 v56, v60
    v_permlane16_swap_b32 v57, v61
    v_permlane16_swap_b32 v58, v62
    v_permlane16_swap_b32 v59, v63
    s_nop 1
    v_cvt_pk_bf16_f32 v72, v56, v57
    v_cvt_pk_bf16_f32 v73, v58, v59
    v_cvt_pk_bf16_f32 v74, v60, v61
    v_cvt_pk_bf16_f32 v75, v62, v63
    buffer_store_dwordx4 v[72:75], v4, s[8:11], s28 offen sc1
    s_cmp_eq_u32 s14, 63
    s_cbranch_scc1 layerb1_kernel_y0_last
    s_add_u32 s30, s18, 0
    s_add_u32 s31, s18, 4096
    s_add_u32 s32, s18, 16384
    s_add_u32 s33, s18, 20480
    s_add_u32 s34, s18, 32768
    s_add_u32 s29, s14, 1
    s_cmp_lt_u32 s29, 32
    s_cselect_b32 s19, s16, s17
    s_and_b32 s20, s29, 31
    s_lshl_b32 s20, s20, 16
    s_add_u32 s19, s19, s20
layerb1_kernel_y0_ppoll:
    buffer_load_dwordx4 v[92:95], v5, s[8:11], s30 offen sc1
    buffer_load_dwordx4 v[96:99], v5, s[8:11], s31 offen sc1
    buffer_load_dwordx4 v[100:103], v5, s[8:11], s32 offen sc1
    buffer_load_dwordx4 v[104:107], v5, s[8:11], s33 offen sc1
    buffer_load_dwordx4 v[108:111], v5, s[8:11], s34 offen sc1
    s_waitcnt vmcnt(0)
    v_mfma_f32_16x16x32_bf16 v[112:115], v[92:95], v[72:75], 0
    v_mfma_f32_16x16x32_bf16 v[112:115], v[96:99], v[76:79], v[112:115]
    v_mfma_f32_16x16x32_bf16 v[112:115], v[100:103], v[80:83], v[112:115]
    v_mfma_f32_16x16x32_bf16 v[112:115], v[104:107], v[84:87], v[112:115]
    v_mfma_f32_16x16x32_bf16 v[112:115], v[108:111], v[88:91], v[112:115]
    v_max3_u32 v116, v92, v93, v94
    v_max3_u32 v116, v116, v95, v96
    v_max3_u32 v116, v116, v97, v98
    v_max3_u32 v116, v116, v99, v100
    v_max3_u32 v116, v116, v101, v102
    v_max3_u32 v116, v116, v103, v104
    v_max3_u32 v116, v116, v105, v106
    v_max3_u32 v116, v116, v107, v108
    v_max3_u32 v116, v116, v109, v110
    v_max_u32 v116, v116, v111
    v_cmp_eq_u32 vcc, -1, v116
    s_sub_u32 s15, s15, 1
    s_cbranch_scc1 layerb1_kernel_bail
    s_cbranch_vccnz layerb1_kernel_y0_ppoll
    ds_write_b128 v6, v[112:115]
    s_waitcnt lgkmcnt(0)
    s_barrier
    ds_read2st64_b32 v[116:117], v7 offset0:0 offset1:1
    ds_read2st64_b32 v[118:119], v7 offset0:2 offset1:3
    ds_read2st64_b32 v[120:121], v7 offset0:4 offset1:5
    ds_read2st64_b32 v[122:123], v7 offset0:6 offset1:7
    s_waitcnt lgkmcnt(2)
    v_add_f32 v116, v116, v117
    v_add_f32 v118, v118, v119
    s_waitcnt lgkmcnt(0)
    v_add_f32 v120, v120, v121
    v_add_f32 v122, v122, v123
    v_add_f32 v116, v116, v118
    v_add_f32 v120, v120, v122
    v_add_f32 v116, v116, v120
    s_nop 1
    v_mov_b32_dpp v117, v116 quad_perm:[1,0,3,2] row_mask:0xf bank_mask:0xf
    v_cvt_pk_bf16_f32 v124, v116, v117
    s_nop 1
    v_mov_b32_dpp v125, v124 row_shl:2 row_mask:0xf bank_mask:0xf
    v_mov_b32_dpp v126, v124 row_shl:4 row_mask:0xf bank_mask:0xf
    v_mov_b32_dpp v127, v124 row_shl:6 row_mask:0xf bank_mask:0xf
    s_mov_b64 exec, s[40:41]
    buffer_store_dwordx4 v[124:127], v8, s[8:11], s19 offen sc1
    s_mov_b64 exec, -1
    s_lshl_b32 s20, s12, 7
    s_add_u32 s20, s20, 20480
    s_mov_b64 exec, 1
    v_mov_b32 v116, s20
    v_mov_b32 v117, s29
    buffer_store_dword v117, v116, s[8:11], s48 offen sc1
    s_mov_b64 exec, -1
    s_waitcnt vmcnt(0)
    s_barrier
    s_add_u32 s14, s14, 1
    s_branch layerb1_kernel_y0_step
layerb1_kernel_y0_last:
    s_waitcnt vmcnt(0)
    s_barrier
    s_lshl_b32 s20, s12, 7
    s_add_u32 s20, s20, 20480
    s_mov_b32 s29, 64
    s_mov_b64 exec, 1
    v_mov_b32 v116, s20
    v_mov_b32 v117, s29
    buffer_store_dword v117, v116, s[8:11], s48 offen sc1
    s_mov_b64 exec, -1
    s_branch layerb1_kernel_end
layerb1_kernel_y1_start:
    v_lshrrev_b32 v16, 4, v0
    v_and_b32 v17, 7, v0
    v_lshrrev_b32 v18, 3, v0
    v_and_b32 v18, 1, v18
    v_lshl_add_u32 v19, v18, 2, v16
    v_add_u32 v19, 8, v19
    v_mul_u32_u24 v20, 640, v19
    v_lshl_add_u32 v4, v17, 4, v20
    v_and_b32 v20, 3, v17
    v_lshlrev_b32 v20, 1, v20
    v_lshrrev_b32 v21, 2, v17
    v_add_u32 v20, v20, v21
    v_lshlrev_b32 v20, 4, v20
    v_lshl_add_u32 v5, v19, 7, v20
    v_add_u32 v3, 0, v1
    v_lshrrev_b32 v20, 1, v17
    v_lshlrev_b32 v20, 7, v20
    v_and_b32 v21, 1, v17
    v_lshl_add_u32 v20, v21, 2, v20
    v_add_u32 v10, 512, v20
    v_lshlrev_b32 v20, 8, v18
    v_lshl_add_u32 v20, v17, 5, v20
    v_and_b32 v21, 1, v16
    v_lshl_add_u32 v20, v21, 4, v20
    v_add_u32 v20, 10752, v20
    v_add_u32 v21, 12288, v1
    v_lshrrev_b32 v22, 1, v16
    v_cmp_eq_u32 vcc, v22, v18
    s_nop 1
    v_cndmask_b32 v6, v21, v20, vcc
    v_lshrrev_b32 v20, 3, v0
    v_lshlrev_b32 v20, 2, v20
    v_lshl_add_u32 v20, v17, 5, v20
    v_add_u32 v7, 10240, v20
    s_lshl_b32 s20, s12, 7
    s_add_u32 s20, s20, 20480
    s_lshr_b32 s21, s20, 13
    s_lshl_b32 s21, s21, 14
    s_and_b32 s20, s20, 8191
    s_add_u32 s20, s20, s21
    v_lshrrev_b32 v20, 3, v0
    v_lshlrev_b32 v20, 4, v20
    v_add_u32 v8, s20, v20
    s_mul_i32 s46, s12, 20480
    s_add_u32 s46, s46, 103809024
    s_mul_i32 s20, s12, 327680
    s_add_u32 s20, s20, 27344896
    s_add_u32 s21, s20, 0
    buffer_load_dwordx4 a[0:3], v1, s[8:11], s21 offen offset:0
    buffer_load_dwordx4 a[4:7], v1, s[8:11], s21 offen offset:1024
    s_add_u32 s21, s20, 2048
    buffer_load_dwordx4 a[8:11], v1, s[8:11], s21 offen offset:0
    buffer_load_dwordx4 a[12:15], v1, s[8:11], s21 offen offset:1024
    s_add_u32 s21, s20, 4096
    buffer_load_dwordx4 a[16:19], v1, s[8:11], s21 offen offset:0
    buffer_load_dwordx4 a[20:23], v1, s[8:11], s21 offen offset:1024
    s_add_u32 s21, s20, 6144
    buffer_load_dwordx4 a[24:27], v1, s[8:11], s21 offen offset:0
    buffer_load_dwordx4 a[28:31], v1, s[8:11], s21 offen offset:1024
    s_add_u32 s21, s20, 8192
    buffer_load_dwordx4 a[32:35], v1, s[8:11], s21 offen offset:0
    buffer_load_dwordx4 a[36:39], v1, s[8:11], s21 offen offset:1024
    s_add_u32 s21, s20, 10240
    buffer_load_dwordx4 a[40:43], v1, s[8:11], s21 offen offset:0
    buffer_load_dwordx4 a[44:47], v1, s[8:11], s21 offen offset:1024
    s_add_u32 s21, s20, 12288
    buffer_load_dwordx4 a[48:51], v1, s[8:11], s21 offen offset:0
    buffer_load_dwordx4 a[52:55], v1, s[8:11], s21 offen offset:1024
    s_add_u32 s21, s20, 14336
    buffer_load_dwordx4 a[56:59], v1, s[8:11], s21 offen offset:0
    buffer_load_dwordx4 a[60:63], v1, s[8:11], s21 offen offset:1024
    s_add_u32 s21, s20, 16384
    buffer_load_dwordx4 a[64:67], v1, s[8:11], s21 offen offset:0
    buffer_load_dwordx4 a[68:71], v1, s[8:11], s21 offen offset:1024
    s_add_u32 s21, s20, 18432
    buffer_load_dwordx4 a[72:75], v1, s[8:11], s21 offen offset:0
    buffer_load_dwordx4 a[76:79], v1, s[8:11], s21 offen offset:1024
    s_add_u32 s21, s20, 20480
    buffer_load_dwordx4 a[80:83], v1, s[8:11], s21 offen offset:0
    buffer_load_dwordx4 a[84:87], v1, s[8:11], s21 offen offset:1024
    s_add_u32 s21, s20, 22528
    buffer_load_dwordx4 a[88:91], v1, s[8:11], s21 offen offset:0
    buffer_load_dwordx4 a[92:95], v1, s[8:11], s21 offen offset:1024
    s_add_u32 s21, s20, 24576
    buffer_load_dwordx4 a[96:99], v1, s[8:11], s21 offen offset:0
    buffer_load_dwordx4 a[100:103], v1, s[8:11], s21 offen offset:1024
    s_add_u32 s21, s20, 26624
    buffer_load_dwordx4 a[104:107], v1, s[8:11], s21 offen offset:0
    buffer_load_dwordx4 a[108:111], v1, s[8:11], s21 offen offset:1024
    s_add_u32 s21, s20, 28672
    buffer_load_dwordx4 a[112:115], v1, s[8:11], s21 offen offset:0
    buffer_load_dwordx4 a[116:119], v1, s[8:11], s21 offen offset:1024
    s_add_u32 s21, s20, 30720
    buffer_load_dwordx4 a[120:123], v1, s[8:11], s21 offen offset:0
    buffer_load_dwordx4 a[124:127], v1, s[8:11], s21 offen offset:1024
    s_add_u32 s21, s20, 32768
    buffer_load_dwordx4 a[128:131], v1, s[8:11], s21 offen offset:0
    buffer_load_dwordx4 a[132:135], v1, s[8:11], s21 offen offset:1024
    s_add_u32 s21, s20, 34816
    buffer_load_dwordx4 a[136:139], v1, s[8:11], s21 offen offset:0
    buffer_load_dwordx4 a[140:143], v1, s[8:11], s21 offen offset:1024
    s_add_u32 s21, s20, 36864
    buffer_load_dwordx4 a[144:147], v1, s[8:11], s21 offen offset:0
    buffer_load_dwordx4 a[148:151], v1, s[8:11], s21 offen offset:1024
    s_add_u32 s21, s20, 38912
    buffer_load_dwordx4 a[152:155], v1, s[8:11], s21 offen offset:0
    buffer_load_dwordx4 a[156:159], v1, s[8:11], s21 offen offset:1024
    s_add_u32 s21, s20, 40960
    buffer_load_dwordx4 a[160:163], v1, s[8:11], s21 offen offset:0
    buffer_load_dwordx4 a[164:167], v1, s[8:11], s21 offen offset:1024
    s_add_u32 s21, s20, 43008
    buffer_load_dwordx4 a[168:171], v1, s[8:11], s21 offen offset:0
    buffer_load_dwordx4 a[172:175], v1, s[8:11], s21 offen offset:1024
    s_add_u32 s21, s20, 45056
    buffer_load_dwordx4 a[176:179], v1, s[8:11], s21 offen offset:0
    buffer_load_dwordx4 a[180:183], v1, s[8:11], s21 offen offset:1024
    s_add_u32 s21, s20, 47104
    buffer_load_dwordx4 a[184:187], v1, s[8:11], s21 offen offset:0
    buffer_load_dwordx4 a[188:191], v1, s[8:11], s21 offen offset:1024
    s_add_u32 s21, s20, 49152
    buffer_load_dwordx4 a[192:195], v1, s[8:11], s21 offen offset:0
    buffer_load_dwordx4 a[196:199], v1, s[8:11], s21 offen offset:1024
    s_add_u32 s21, s20, 51200
    buffer_load_dwordx4 a[200:203], v1, s[8:11], s21 offen offset:0
    buffer_load_dwordx4 a[204:207], v1, s[8:11], s21 offen offset:1024
    s_add_u32 s21, s20, 53248
    buffer_load_dwordx4 a[208:211], v1, s[8:11], s21 offen offset:0
    buffer_load_dwordx4 a[212:215], v1, s[8:11], s21 offen offset:1024
    s_add_u32 s21, s20, 55296
    buffer_load_dwordx4 a[216:219], v1, s[8:11], s21 offen offset:0
    buffer_load_dwordx4 a[220:223], v1, s[8:11], s21 offen offset:1024
    s_add_u32 s21, s20, 57344
    buffer_load_dwordx4 a[224:227], v1, s[8:11], s21 offen offset:0
    buffer_load_dwordx4 a[228:231], v1, s[8:11], s21 offen offset:1024
    s_add_u32 s21, s20, 59392
    buffer_load_dwordx4 a[232:235], v1, s[8:11], s21 offen offset:0
    buffer_load_dwordx4 a[236:239], v1, s[8:11], s21 offen offset:1024
    s_add_u32 s21, s20, 61440
    buffer_load_dwordx4 a[240:243], v1, s[8:11], s21 offen offset:0
    buffer_load_dwordx4 a[244:247], v1, s[8:11], s21 offen offset:1024
    s_add_u32 s21, s20, 63488
    buffer_load_dwordx4 a[248:251], v1, s[8:11], s21 offen offset:0
    buffer_load_dwordx4 a[252:255], v1, s[8:11], s21 offen offset:1024
    s_add_u32 s21, s20, 65536
    buffer_load_dwordx4 v[176:179], v1, s[8:11], s21 offen offset:0
    buffer_load_dwordx4 v[180:183], v1, s[8:11], s21 offen offset:1024
    s_add_u32 s21, s20, 67584
    buffer_load_dwordx4 v[184:187], v1, s[8:11], s21 offen offset:0
    buffer_load_dwordx4 v[188:191], v1, s[8:11], s21 offen offset:1024
    s_add_u32 s21, s20, 69632
    buffer_load_dwordx4 v[192:195], v1, s[8:11], s21 offen offset:0
    buffer_load_dwordx4 v[196:199], v1, s[8:11], s21 offen offset:1024
    s_add_u32 s21, s20, 71680
    buffer_load_dwordx4 v[200:203], v1, s[8:11], s21 offen offset:0
    buffer_load_dwordx4 v[204:207], v1, s[8:11], s21 offen offset:1024
    s_add_u32 s21, s20, 73728
    buffer_load_dwordx4 v[208:211], v1, s[8:11], s21 offen offset:0
    buffer_load_dwordx4 v[212:215], v1, s[8:11], s21 offen offset:1024
    s_add_u32 s21, s20, 75776
    buffer_load_dwordx4 v[216:219], v1, s[8:11], s21 offen offset:0
    buffer_load_dwordx4 v[220:223], v1, s[8:11], s21 offen offset:1024
    s_add_u32 s21, s20, 77824
    buffer_load_dwordx4 v[224:227], v1, s[8:11], s21 offen offset:0
    buffer_load_dwordx4 v[228:231], v1, s[8:11], s21 offen offset:1024
    s_add_u32 s21, s20, 79872
    buffer_load_dwordx4 v[232:235], v1, s[8:11], s21 offen offset:0
    buffer_load_dwordx4 v[236:239], v1, s[8:11], s21 offen offset:1024
    s_mov_b32 s14, 0
    s_lshl_b32 s20, s12, 7
    v_mov_b32 v9, s20
    s_mov_b32 s47, 0
layerb1_kernel_y1_step:
    s_cmp_lt_u32 s14, 32
    s_cselect_b32 s18, s16, s17
    s_and_b32 s20, s14, 31
    s_lshl_b32 s20, s20, 16
    s_add_u32 s18, s18, s20
    s_mul_i32 s28, s14, 1638400
    s_add_u32 s28, s28, s46
    v_mov_b32 v56, 0
    v_mov_b32 v57, 0
    v_mov_b32 v58, 0
    v_mov_b32 v59, 0
    v_mov_b32 v60, 0
    v_mov_b32 v61, 0
    v_mov_b32 v62, 0
    v_mov_b32 v63, 0
    v_mov_b32 v64, 0
    v_mov_b32 v65, 0
    v_mov_b32 v66, 0
    v_mov_b32 v67, 0
    v_mov_b32 v68, 0
    v_mov_b32 v69, 0
    v_mov_b32 v70, 0
    v_mov_b32 v71, 0
    s_add_u32 s22, s18, 39936
    s_add_u32 s23, s18, 49152
    s_add_u32 s24, s18, 50176
layerb1_kernel_y1_poll:
    buffer_load_dwordx4 v[28:31], v1, s[8:11], s22 offen sc1
    buffer_load_dwordx4 v[32:35], v1, s[8:11], s23 offen sc1
    buffer_load_dwordx4 v[36:39], v1, s[8:11], s24 offen sc1
    s_waitcnt vmcnt(0)
    ds_write_b128 v3, v[28:31] offset:3072
    ds_write_b128 v3, v[32:35] offset:4096
    ds_write_b128 v3, v[36:39] offset:5120
    v_max3_u32 v116, v28, v29, v30
    v_max3_u32 v116, v116, v31, v32
    v_max3_u32 v116, v116, v33, v34
    v_max3_u32 v116, v116, v35, v36
    v_max3_u32 v116, v116, v37, v38
    v_max_u32 v116, v116, v39
    v_cmp_eq_u32 vcc, -1, v116
    s_sub_u32 s15, s15, 1
    s_cbranch_scc1 layerb1_kernel_bail
    s_cbranch_vccnz layerb1_kernel_y1_poll
    s_waitcnt lgkmcnt(0)
    s_barrier
    ds_read_b128 v[16:19], v3 offset:0
    ds_read_b128 v[20:23], v3 offset:1024
    ds_read_b128 v[24:27], v3 offset:2048
    ds_read_b128 v[40:43], v3 offset:6144
    ds_read_b128 v[44:47], v3 offset:7168
    ds_read_b128 v[48:51], v3 offset:8192
    ds_read_b128 v[52:55], v3 offset:9216
    s_cmp_gt_u32 s47, s14
    s_cbranch_scc1 layerb1_kernel_y1_gw_ok
layerb1_kernel_y1_gw_lp:
    buffer_load_dword v116, v9, s[8:11], s48 offen sc1
    s_waitcnt vmcnt(0)
    v_readlane_b32 s47, v116, 0
    s_nop 0
    s_sub_u32 s15, s15, 1
    s_cbranch_scc1 layerb1_kernel_bail
    s_cmp_gt_u32 s47, s14
    s_cbranch_scc0 layerb1_kernel_y1_gw_lp
layerb1_kernel_y1_gw_ok:
    buffer_load_dwordx4 v[76:79], v4, s[8:11], s28 offen offset:128 sc1
    buffer_load_dwordx4 v[80:83], v4, s[8:11], s28 offen offset:256 sc1
    buffer_load_dwordx4 v[84:87], v4, s[8:11], s28 offen offset:384 sc1
    buffer_load_dwordx4 v[88:91], v4, s[8:11], s28 offen offset:512 sc1
    v_smfmac_f32_16x16x64_bf16 v[56:59], v[28:31], a[24:31], v2
    v_smfmac_f32_16x16x64_bf16 v[60:63], v[28:31], a[104:111], v2
    v_smfmac_f32_16x16x64_bf16 v[64:67], v[28:31], a[184:191], v2
    v_smfmac_f32_16x16x64_bf16 v[68:71], v[28:31], v[184:191], v2
    v_smfmac_f32_16x16x64_bf16 v[56:59], v[32:35], a[32:39], v2
    v_smfmac_f32_16x16x64_bf16 v[60:63], v[32:35], a[112:119], v2
    v_smfmac_f32_16x16x64_bf16 v[64:67], v[32:35], a[192:199], v2
    v_smfmac_f32_16x16x64_bf16 v[68:71], v[32:35], v[192:199], v2
    v_smfmac_f32_16x16x64_bf16 v[56:59], v[36:39], a[40:47], v2
    v_smfmac_f32_16x16x64_bf16 v[60:63], v[36:39], a[120:127], v2
    v_smfmac_f32_16x16x64_bf16 v[64:67], v[36:39], a[200:207], v2
    v_smfmac_f32_16x16x64_bf16 v[68:71], v[36:39], v[200:207], v2
    s_waitcnt lgkmcnt(6)
    v_smfmac_f32_16x16x64_bf16 v[56:59], v[16:19], a[0:7], v2
    v_smfmac_f32_16x16x64_bf16 v[60:63], v[16:19], a[80:87], v2
    v_smfmac_f32_16x16x64_bf16 v[64:67], v[16:19], a[160:167], v2
    v_smfmac_f32_16x16x64_bf16 v[68:71], v[16:19], a[240:247], v2
    s_waitcnt lgkmcnt(5)
    v_smfmac_f32_16x16x64_bf16 v[56:59], v[20:23], a[8:15], v2
    v_smfmac_f32_16x16x64_bf16 v[60:63], v[20:23], a[88:95], v2
    v_smfmac_f32_16x16x64_bf16 v[64:67], v[20:23], a[168:175], v2
    v_smfmac_f32_16x16x64_bf16 v[68:71], v[20:23], a[248:255], v2
    s_waitcnt lgkmcnt(4)
    v_smfmac_f32_16x16x64_bf16 v[56:59], v[24:27], a[16:23], v2
    v_smfmac_f32_16x16x64_bf16 v[60:63], v[24:27], a[96:103], v2
    v_smfmac_f32_16x16x64_bf16 v[64:67], v[24:27], a[176:183], v2
    v_smfmac_f32_16x16x64_bf16 v[68:71], v[24:27], v[176:183], v2
    s_waitcnt lgkmcnt(3)
    v_smfmac_f32_16x16x64_bf16 v[56:59], v[40:43], a[48:55], v2
    v_smfmac_f32_16x16x64_bf16 v[60:63], v[40:43], a[128:135], v2
    v_smfmac_f32_16x16x64_bf16 v[64:67], v[40:43], a[208:215], v2
    v_smfmac_f32_16x16x64_bf16 v[68:71], v[40:43], v[208:215], v2
    s_waitcnt lgkmcnt(2)
    v_smfmac_f32_16x16x64_bf16 v[56:59], v[44:47], a[56:63], v2
    v_smfmac_f32_16x16x64_bf16 v[60:63], v[44:47], a[136:143], v2
    v_smfmac_f32_16x16x64_bf16 v[64:67], v[44:47], a[216:223], v2
    v_smfmac_f32_16x16x64_bf16 v[68:71], v[44:47], v[216:223], v2
    s_waitcnt lgkmcnt(1)
    v_smfmac_f32_16x16x64_bf16 v[56:59], v[48:51], a[64:71], v2
    v_smfmac_f32_16x16x64_bf16 v[60:63], v[48:51], a[144:151], v2
    v_smfmac_f32_16x16x64_bf16 v[64:67], v[48:51], a[224:231], v2
    v_smfmac_f32_16x16x64_bf16 v[68:71], v[48:51], v[224:231], v2
    s_waitcnt lgkmcnt(0)
    v_smfmac_f32_16x16x64_bf16 v[56:59], v[52:55], a[72:79], v2
    v_smfmac_f32_16x16x64_bf16 v[60:63], v[52:55], a[152:159], v2
    v_smfmac_f32_16x16x64_bf16 v[64:67], v[52:55], a[232:239], v2
    v_smfmac_f32_16x16x64_bf16 v[68:71], v[52:55], v[232:239], v2
    s_nop 7
    v_permlane32_swap_b32 v56, v64
    v_permlane32_swap_b32 v60, v68
    v_permlane32_swap_b32 v57, v65
    v_permlane32_swap_b32 v61, v69
    v_permlane32_swap_b32 v58, v66
    v_permlane32_swap_b32 v62, v70
    v_permlane32_swap_b32 v59, v67
    v_permlane32_swap_b32 v63, v71
    v_add_f32 v56, v56, v64
    v_add_f32 v60, v60, v68
    v_add_f32 v57, v57, v65
    v_add_f32 v61, v61, v69
    v_add_f32 v58, v58, v66
    v_add_f32 v62, v62, v70
    v_add_f32 v59, v59, v67
    v_add_f32 v63, v63, v71
    s_nop 1
    v_permlane16_swap_b32 v56, v60
    v_permlane16_swap_b32 v57, v61
    v_permlane16_swap_b32 v58, v62
    v_permlane16_swap_b32 v59, v63
    s_nop 1
    v_cvt_pk_bf16_f32 v72, v56, v57
    v_cvt_pk_bf16_f32 v73, v58, v59
    v_cvt_pk_bf16_f32 v74, v60, v61
    v_cvt_pk_bf16_f32 v75, v62, v63
    buffer_store_dwordx4 v[72:75], v4, s[8:11], s28 offen sc1
    s_cmp_eq_u32 s14, 63
    s_cbranch_scc1 layerb1_kernel_y1_last
    s_add_u32 s30, s18, 0
    s_add_u32 s31, s18, 4096
    s_add_u32 s32, s18, 16384
    s_add_u32 s33, s18, 20480
    s_add_u32 s34, s18, 32768
    s_add_u32 s29, s14, 1
    s_cmp_lt_u32 s29, 32
    s_cselect_b32 s19, s16, s17
    s_and_b32 s20, s29, 31
    s_lshl_b32 s20, s20, 16
    s_add_u32 s19, s19, s20
layerb1_kernel_y1_ppoll:
    buffer_load_dwordx4 v[92:95], v5, s[8:11], s30 offen sc1
    buffer_load_dwordx4 v[96:99], v5, s[8:11], s31 offen sc1
    buffer_load_dwordx4 v[100:103], v5, s[8:11], s32 offen sc1
    buffer_load_dwordx4 v[104:107], v5, s[8:11], s33 offen sc1
    buffer_load_dwordx4 v[108:111], v5, s[8:11], s34 offen sc1
    s_waitcnt vmcnt(0)
    v_mfma_f32_16x16x32_bf16 v[112:115], v[92:95], v[72:75], 0
    v_mfma_f32_16x16x32_bf16 v[112:115], v[96:99], v[76:79], v[112:115]
    v_mfma_f32_16x16x32_bf16 v[112:115], v[100:103], v[80:83], v[112:115]
    v_mfma_f32_16x16x32_bf16 v[112:115], v[104:107], v[84:87], v[112:115]
    v_mfma_f32_16x16x32_bf16 v[112:115], v[108:111], v[88:91], v[112:115]
    v_max3_u32 v116, v92, v93, v94
    v_max3_u32 v116, v116, v95, v96
    v_max3_u32 v116, v116, v97, v98
    v_max3_u32 v116, v116, v99, v100
    v_max3_u32 v116, v116, v101, v102
    v_max3_u32 v116, v116, v103, v104
    v_max3_u32 v116, v116, v105, v106
    v_max3_u32 v116, v116, v107, v108
    v_max3_u32 v116, v116, v109, v110
    v_max_u32 v116, v116, v111
    v_cmp_eq_u32 vcc, -1, v116
    s_sub_u32 s15, s15, 1
    s_cbranch_scc1 layerb1_kernel_bail
    s_cbranch_vccnz layerb1_kernel_y1_ppoll
    ds_write_b128 v6, v[112:115]
    s_waitcnt lgkmcnt(0)
    s_barrier
    s_barrier
    s_add_u32 s14, s14, 1
    s_branch layerb1_kernel_y1_step
layerb1_kernel_y1_last:
    s_waitcnt vmcnt(0)
    s_barrier
    s_branch layerb1_kernel_end
layerb1_kernel_y2_start:
    v_lshrrev_b32 v16, 4, v0
    v_and_b32 v17, 7, v0
    v_lshrrev_b32 v18, 3, v0
    v_and_b32 v18, 1, v18
    v_lshl_add_u32 v19, v18, 2, v16
    v_add_u32 v19, 16, v19
    v_mul_u32_u24 v20, 640, v19
    v_lshl_add_u32 v4, v17, 4, v20
    v_and_b32 v20, 3, v17
    v_lshlrev_b32 v20, 1, v20
    v_lshrrev_b32 v21, 2, v17
    v_add_u32 v20, v20, v21
    v_lshlrev_b32 v20, 4, v20
    v_lshl_add_u32 v5, v19, 7, v20
    v_add_u32 v3, 0, v1
    v_lshrrev_b32 v20, 1, v17
    v_lshlrev_b32 v20, 7, v20
    v_and_b32 v21, 1, v17
    v_lshl_add_u32 v20, v21, 2, v20
    v_add_u32 v10, 1024, v20
    v_lshlrev_b32 v20, 8, v18
    v_lshl_add_u32 v20, v17, 5, v20
    v_and_b32 v21, 1, v16
    v_lshl_add_u32 v20, v21, 4, v20
    v_add_u32 v20, 11264, v20
    v_add_u32 v21, 12288, v1
    v_lshrrev_b32 v22, 1, v16
    v_cmp_eq_u32 vcc, v22, v18
    s_nop 1
    v_cndmask_b32 v6, v21, v20, vcc
    v_lshrrev_b32 v20, 3, v0
    v_lshlrev_b32 v20, 2, v20
    v_lshl_add_u32 v20, v17, 5, v20
    v_add_u32 v7, 10240, v20
    s_lshl_b32 s20, s12, 7
    s_add_u32 s20, s20, 20480
    s_lshr_b32 s21, s20, 13
    s_lshl_b32 s21, s21, 14
    s_and_b32 s20, s20, 8191
    s_add_u32 s20, s20, s21
    v_lshrrev_b32 v20, 3, v0
    v_lshlrev_b32 v20, 4, v20
    v_add_u32 v8, s20, v20
    s_mul_i32 s46, s12, 20480
    s_add_u32 s46, s46, 103809024
    s_mul_i32 s20, s12, 327680
    s_add_u32 s20, s20, 27426816
    s_add_u32 s21, s20, 0
    buffer_load_dwordx4 a[0:3], v1, s[8:11], s21 offen offset:0
    buffer_load_dwordx4 a[4:7], v1, s[8:11], s21 offen offset:1024
    s_add_u32 s21, s20, 2048
    buffer_load_dwordx4 a[8:11], v1, s[8:11], s21 offen offset:0
    buffer_load_dwordx4 a[12:15], v1, s[8:11], s21 offen offset:1024
    s_add_u32 s21, s20, 4096
    buffer_load_dwordx4 a[16:19], v1, s[8:11], s21 offen offset:0
    buffer_load_dwordx4 a[20:23], v1, s[8:11], s21 offen offset:1024
    s_add_u32 s21, s20, 6144
    buffer_load_dwordx4 a[24:27], v1, s[8:11], s21 offen offset:0
    buffer_load_dwordx4 a[28:31], v1, s[8:11], s21 offen offset:1024
    s_add_u32 s21, s20, 8192
    buffer_load_dwordx4 a[32:35], v1, s[8:11], s21 offen offset:0
    buffer_load_dwordx4 a[36:39], v1, s[8:11], s21 offen offset:1024
    s_add_u32 s21, s20, 10240
    buffer_load_dwordx4 a[40:43], v1, s[8:11], s21 offen offset:0
    buffer_load_dwordx4 a[44:47], v1, s[8:11], s21 offen offset:1024
    s_add_u32 s21, s20, 12288
    buffer_load_dwordx4 a[48:51], v1, s[8:11], s21 offen offset:0
    buffer_load_dwordx4 a[52:55], v1, s[8:11], s21 offen offset:1024
    s_add_u32 s21, s20, 14336
    buffer_load_dwordx4 a[56:59], v1, s[8:11], s21 offen offset:0
    buffer_load_dwordx4 a[60:63], v1, s[8:11], s21 offen offset:1024
    s_add_u32 s21, s20, 16384
    buffer_load_dwordx4 a[64:67], v1, s[8:11], s21 offen offset:0
    buffer_load_dwordx4 a[68:71], v1, s[8:11], s21 offen offset:1024
    s_add_u32 s21, s20, 18432
    buffer_load_dwordx4 a[72:75], v1, s[8:11], s21 offen offset:0
    buffer_load_dwordx4 a[76:79], v1, s[8:11], s21 offen offset:1024
    s_add_u32 s21, s20, 20480
    buffer_load_dwordx4 a[80:83], v1, s[8:11], s21 offen offset:0
    buffer_load_dwordx4 a[84:87], v1, s[8:11], s21 offen offset:1024
    s_add_u32 s21, s20, 22528
    buffer_load_dwordx4 a[88:91], v1, s[8:11], s21 offen offset:0
    buffer_load_dwordx4 a[92:95], v1, s[8:11], s21 offen offset:1024
    s_add_u32 s21, s20, 24576
    buffer_load_dwordx4 a[96:99], v1, s[8:11], s21 offen offset:0
    buffer_load_dwordx4 a[100:103], v1, s[8:11], s21 offen offset:1024
    s_add_u32 s21, s20, 26624
    buffer_load_dwordx4 a[104:107], v1, s[8:11], s21 offen offset:0
    buffer_load_dwordx4 a[108:111], v1, s[8:11], s21 offen offset:1024
    s_add_u32 s21, s20, 28672
    buffer_load_dwordx4 a[112:115], v1, s[8:11], s21 offen offset:0
    buffer_load_dwordx4 a[116:119], v1, s[8:11], s21 offen offset:1024
    s_add_u32 s21, s20, 30720
    buffer_load_dwordx4 a[120:123], v1, s[8:11], s21 offen offset:0
    buffer_load_dwordx4 a[124:127], v1, s[8:11], s21 offen offset:1024
    s_add_u32 s21, s20, 32768
    buffer_load_dwordx4 a[128:131], v1, s[8:11], s21 offen offset:0
    buffer_load_dwordx4 a[132:135], v1, s[8:11], s21 offen offset:1024
    s_add_u32 s21, s20, 34816
    buffer_load_dwordx4 a[136:139], v1, s[8:11], s21 offen offset:0
    buffer_load_dwordx4 a[140:143], v1, s[8:11], s21 offen offset:1024
    s_add_u32 s21, s20, 36864
    buffer_load_dwordx4 a[144:147], v1, s[8:11], s21 offen offset:0
    buffer_load_dwordx4 a[148:151], v1, s[8:11], s21 offen offset:1024
    s_add_u32 s21, s20, 38912
    buffer_load_dwordx4 a[152:155], v1, s[8:11], s21 offen offset:0
    buffer_load_dwordx4 a[156:159], v1, s[8:11], s21 offen offset:1024
    s_add_u32 s21, s20, 40960
    buffer_load_dwordx4 a[160:163], v1, s[8:11], s21 offen offset:0
    buffer_load_dwordx4 a[164:167], v1, s[8:11], s21 offen offset:1024
    s_add_u32 s21, s20, 43008
    buffer_load_dwordx4 a[168:171], v1, s[8:11], s21 offen offset:0
    buffer_load_dwordx4 a[172:175], v1, s[8:11], s21 offen offset:1024
    s_add_u32 s21, s20, 45056
    buffer_load_dwordx4 a[176:179], v1, s[8:11], s21 offen offset:0
    buffer_load_dwordx4 a[180:183], v1, s[8:11], s21 offen offset:1024
    s_add_u32 s21, s20, 47104
    buffer_load_dwordx4 a[184:187], v1, s[8:11], s21 offen offset:0
    buffer_load_dwordx4 a[188:191], v1, s[8:11], s21 offen offset:1024
    s_add_u32 s21, s20, 49152
    buffer_load_dwordx4 a[192:195], v1, s[8:11], s21 offen offset:0
    buffer_load_dwordx4 a[196:199], v1, s[8:11], s21 offen offset:1024
    s_add_u32 s21, s20, 51200
    buffer_load_dwordx4 a[200:203], v1, s[8:11], s21 offen offset:0
    buffer_load_dwordx4 a[204:207], v1, s[8:11], s21 offen offset:1024
    s_add_u32 s21, s20, 53248
    buffer_load_dwordx4 a[208:211], v1, s[8:11], s21 offen offset:0
    buffer_load_dwordx4 a[212:215], v1, s[8:11], s21 offen offset:1024
    s_add_u32 s21, s20, 55296
    buffer_load_dwordx4 a[216:219], v1, s[8:11], s21 offen offset:0
    buffer_load_dwordx4 a[220:223], v1, s[8:11], s21 offen offset:1024
    s_add_u32 s21, s20, 57344
    buffer_load_dwordx4 a[224:227], v1, s[8:11], s21 offen offset:0
    buffer_load_dwordx4 a[228:231], v1, s[8:11], s21 offen offset:1024
    s_add_u32 s21, s20, 59392
    buffer_load_dwordx4 a[232:235], v1, s[8:11], s21 offen offset:0
    buffer_load_dwordx4 a[236:239], v1, s[8:11], s21 offen offset:1024
    s_add_u32 s21, s20, 61440
    buffer_load_dwordx4 a[240:243], v1, s[8:11], s21 offen offset:0
    buffer_load_dwordx4 a[244:247], v1, s[8:11], s21 offen offset:1024
    s_add_u32 s21, s20, 63488
    buffer_load_dwordx4 a[248:251], v1, s[8:11], s21 offen offset:0
    buffer_load_dwordx4 a[252:255], v1, s[8:11], s21 offen offset:1024
    s_add_u32 s21, s20, 65536
    buffer_load_dwordx4 v[176:179], v1, s[8:11], s21 offen offset:0
    buffer_load_dwordx4 v[180:183], v1, s[8:11], s21 offen offset:1024
    s_add_u32 s21, s20, 67584
    buffer_load_dwordx4 v[184:187], v1, s[8:11], s21 offen offset:0
    buffer_load_dwordx4 v[188:191], v1, s[8:11], s21 offen offset:1024
    s_add_u32 s21, s20, 69632
    buffer_load_dwordx4 v[192:195], v1, s[8:11], s21 offen offset:0
    buffer_load_dwordx4 v[196:199], v1, s[8:11], s21 offen offset:1024
    s_add_u32 s21, s20, 71680
    buffer_load_dwordx4 v[200:203], v1, s[8:11], s21 offen offset:0
    buffer_load_dwordx4 v[204:207], v1, s[8:11], s21 offen offset:1024
    s_add_u32 s21, s20, 73728
    buffer_load_dwordx4 v[208:211], v1, s[8:11], s21 offen offset:0
    buffer_load_dwordx4 v[212:215], v1, s[8:11], s21 offen offset:1024
    s_add_u32 s21, s20, 75776
    buffer_load_dwordx4 v[216:219], v1, s[8:11], s21 offen offset:0
    buffer_load_dwordx4 v[220:223], v1, s[8:11], s21 offen offset:1024
    s_add_u32 s21, s20, 77824
    buffer_load_dwordx4 v[224:227], v1, s[8:11], s21 offen offset:0
    buffer_load_dwordx4 v[228:231], v1, s[8:11], s21 offen offset:1024
    s_add_u32 s21, s20, 79872
    buffer_load_dwordx4 v[232:235], v1, s[8:11], s21 offen offset:0
    buffer_load_dwordx4 v[236:239], v1, s[8:11], s21 offen offset:1024
    s_mov_b32 s14, 0
    s_lshl_b32 s20, s12, 7
    v_mov_b32 v9, s20
    s_mov_b32 s47, 0
layerb1_kernel_y2_step:
    s_cmp_lt_u32 s14, 32
    s_cselect_b32 s18, s16, s17
    s_and_b32 s20, s14, 31
    s_lshl_b32 s20, s20, 16
    s_add_u32 s18, s18, s20
    s_mul_i32 s28, s14, 1638400
    s_add_u32 s28, s28, s46
    v_mov_b32 v56, 0
    v_mov_b32 v57, 0
    v_mov_b32 v58, 0
    v_mov_b32 v59, 0
    v_mov_b32 v60, 0
    v_mov_b32 v61, 0
    v_mov_b32 v62, 0
    v_mov_b32 v63, 0
    v_mov_b32 v64, 0
    v_mov_b32 v65, 0
    v_mov_b32 v66, 0
    v_mov_b32 v67, 0
    v_mov_b32 v68, 0
    v_mov_b32 v69, 0
    v_mov_b32 v70, 0
    v_mov_b32 v71, 0
    s_add_u32 s22, s18, 51200
    s_add_u32 s23, s18, 52224
layerb1_kernel_y2_poll:
    buffer_load_dwordx4 v[40:43], v1, s[8:11], s22 offen sc1
    buffer_load_dwordx4 v[44:47], v1, s[8:11], s23 offen sc1
    s_waitcnt vmcnt(0)
    ds_write_b128 v3, v[40:43] offset:6144
    ds_write_b128 v3, v[44:47] offset:7168
    v_max3_u32 v116, v40, v41, v42
    v_max3_u32 v116, v116, v43, v44
    v_max3_u32 v116, v116, v45, v46
    v_max_u32 v116, v116, v47
    v_cmp_eq_u32 vcc, -1, v116
    s_sub_u32 s15, s15, 1
    s_cbranch_scc1 layerb1_kernel_bail
    s_cbranch_vccnz layerb1_kernel_y2_poll
    s_waitcnt lgkmcnt(0)
    s_barrier
    ds_read_b128 v[16:19], v3 offset:0
    ds_read_b128 v[20:23], v3 offset:1024
    ds_read_b128 v[24:27], v3 offset:2048
    ds_read_b128 v[28:31], v3 offset:3072
    ds_read_b128 v[32:35], v3 offset:4096
    ds_read_b128 v[36:39], v3 offset:5120
    ds_read_b128 v[48:51], v3 offset:8192
    ds_read_b128 v[52:55], v3 offset:9216
    s_cmp_gt_u32 s47, s14
    s_cbranch_scc1 layerb1_kernel_y2_gw_ok
layerb1_kernel_y2_gw_lp:
    buffer_load_dword v116, v9, s[8:11], s48 offen sc1
    s_waitcnt vmcnt(0)
    v_readlane_b32 s47, v116, 0
    s_nop 0
    s_sub_u32 s15, s15, 1
    s_cbranch_scc1 layerb1_kernel_bail
    s_cmp_gt_u32 s47, s14
    s_cbranch_scc0 layerb1_kernel_y2_gw_lp
layerb1_kernel_y2_gw_ok:
    buffer_load_dwordx4 v[76:79], v4, s[8:11], s28 offen offset:128 sc1
    buffer_load_dwordx4 v[80:83], v4, s[8:11], s28 offen offset:256 sc1
    buffer_load_dwordx4 v[84:87], v4, s[8:11], s28 offen offset:384 sc1
    buffer_load_dwordx4 v[88:91], v4, s[8:11], s28 offen offset:512 sc1
    v_smfmac_f32_16x16x64_bf16 v[56:59], v[40:43], a[48:55], v2
    v_smfmac_f32_16x16x64_bf16 v[60:63], v[40:43], a[128:135], v2
    v_smfmac_f32_16x16x64_bf16 v[64:67], v[40:43], a[208:215], v2
    v_smfmac_f32_16x16x64_bf16 v[68:71], v[40:43], v[208:215], v2
    v_smfmac_f32_16x16x64_bf16 v[56:59], v[44:47], a[56:63], v2
    v_smfmac_f32_16x16x64_bf16 v[60:63], v[44:47], a[136:143], v2
    v_smfmac_f32_16x16x64_bf16 v[64:67], v[44:47], a[216:223], v2
    v_smfmac_f32_16x16x64_bf16 v[68:71], v[44:47], v[216:223], v2
    s_waitcnt lgkmcnt(7)
    v_smfmac_f32_16x16x64_bf16 v[56:59], v[16:19], a[0:7], v2
    v_smfmac_f32_16x16x64_bf16 v[60:63], v[16:19], a[80:87], v2
    v_smfmac_f32_16x16x64_bf16 v[64:67], v[16:19], a[160:167], v2
    v_smfmac_f32_16x16x64_bf16 v[68:71], v[16:19], a[240:247], v2
    s_waitcnt lgkmcnt(6)
    v_smfmac_f32_16x16x64_bf16 v[56:59], v[20:23], a[8:15], v2
    v_smfmac_f32_16x16x64_bf16 v[60:63], v[20:23], a[88:95], v2
    v_smfmac_f32_16x16x64_bf16 v[64:67], v[20:23], a[168:175], v2
    v_smfmac_f32_16x16x64_bf16 v[68:71], v[20:23], a[248:255], v2
    s_waitcnt lgkmcnt(5)
    v_smfmac_f32_16x16x64_bf16 v[56:59], v[24:27], a[16:23], v2
    v_smfmac_f32_16x16x64_bf16 v[60:63], v[24:27], a[96:103], v2
    v_smfmac_f32_16x16x64_bf16 v[64:67], v[24:27], a[176:183], v2
    v_smfmac_f32_16x16x64_bf16 v[68:71], v[24:27], v[176:183], v2
    s_waitcnt lgkmcnt(4)
    v_smfmac_f32_16x16x64_bf16 v[56:59], v[28:31], a[24:31], v2
    v_smfmac_f32_16x16x64_bf16 v[60:63], v[28:31], a[104:111], v2
    v_smfmac_f32_16x16x64_bf16 v[64:67], v[28:31], a[184:191], v2
    v_smfmac_f32_16x16x64_bf16 v[68:71], v[28:31], v[184:191], v2
    s_waitcnt lgkmcnt(3)
    v_smfmac_f32_16x16x64_bf16 v[56:59], v[32:35], a[32:39], v2
    v_smfmac_f32_16x16x64_bf16 v[60:63], v[32:35], a[112:119], v2
    v_smfmac_f32_16x16x64_bf16 v[64:67], v[32:35], a[192:199], v2
    v_smfmac_f32_16x16x64_bf16 v[68:71], v[32:35], v[192:199], v2
    s_waitcnt lgkmcnt(2)
    v_smfmac_f32_16x16x64_bf16 v[56:59], v[36:39], a[40:47], v2
    v_smfmac_f32_16x16x64_bf16 v[60:63], v[36:39], a[120:127], v2
    v_smfmac_f32_16x16x64_bf16 v[64:67], v[36:39], a[200:207], v2
    v_smfmac_f32_16x16x64_bf16 v[68:71], v[36:39], v[200:207], v2
    s_waitcnt lgkmcnt(1)
    v_smfmac_f32_16x16x64_bf16 v[56:59], v[48:51], a[64:71], v2
    v_smfmac_f32_16x16x64_bf16 v[60:63], v[48:51], a[144:151], v2
    v_smfmac_f32_16x16x64_bf16 v[64:67], v[48:51], a[224:231], v2
    v_smfmac_f32_16x16x64_bf16 v[68:71], v[48:51], v[224:231], v2
    s_waitcnt lgkmcnt(0)
    v_smfmac_f32_16x16x64_bf16 v[56:59], v[52:55], a[72:79], v2
    v_smfmac_f32_16x16x64_bf16 v[60:63], v[52:55], a[152:159], v2
    v_smfmac_f32_16x16x64_bf16 v[64:67], v[52:55], a[232:239], v2
    v_smfmac_f32_16x16x64_bf16 v[68:71], v[52:55], v[232:239], v2
    s_nop 7
    v_permlane32_swap_b32 v56, v64
    v_permlane32_swap_b32 v60, v68
    v_permlane32_swap_b32 v57, v65
    v_permlane32_swap_b32 v61, v69
    v_permlane32_swap_b32 v58, v66
    v_permlane32_swap_b32 v62, v70
    v_permlane32_swap_b32 v59, v67
    v_permlane32_swap_b32 v63, v71
    v_add_f32 v56, v56, v64
    v_add_f32 v60, v60, v68
    v_add_f32 v57, v57, v65
    v_add_f32 v61, v61, v69
    v_add_f32 v58, v58, v66
    v_add_f32 v62, v62, v70
    v_add_f32 v59, v59, v67
    v_add_f32 v63, v63, v71
    s_nop 1
    v_permlane16_swap_b32 v56, v60
    v_permlane16_swap_b32 v57, v61
    v_permlane16_swap_b32 v58, v62
    v_permlane16_swap_b32 v59, v63
    s_nop 1
    v_cvt_pk_bf16_f32 v72, v56, v57
    v_cvt_pk_bf16_f32 v73, v58, v59
    v_cvt_pk_bf16_f32 v74, v60, v61
    v_cvt_pk_bf16_f32 v75, v62, v63
    buffer_store_dwordx4 v[72:75], v4, s[8:11], s28 offen sc1
    s_cmp_eq_u32 s14, 63
    s_cbranch_scc1 layerb1_kernel_y2_last
    s_add_u32 s30, s18, 0
    s_add_u32 s31, s18, 4096
    s_add_u32 s32, s18, 16384
    s_add_u32 s33, s18, 20480
    s_add_u32 s34, s18, 32768
    s_add_u32 s29, s14, 1
    s_cmp_lt_u32 s29, 32
    s_cselect_b32 s19, s16, s17
    s_and_b32 s20, s29, 31
    s_lshl_b32 s20, s20, 16
    s_add_u32 s19, s19, s20
layerb1_kernel_y2_ppoll:
    buffer_load_dwordx4 v[92:95], v5, s[8:11], s30 offen sc1
    buffer_load_dwordx4 v[96:99], v5, s[8:11], s31 offen sc1
    buffer_load_dwordx4 v[100:103], v5, s[8:11], s32 offen sc1
    buffer_load_dwordx4 v[104:107], v5, s[8:11], s33 offen sc1
    buffer_load_dwordx4 v[108:111], v5, s[8:11], s34 offen sc1
    s_waitcnt vmcnt(0)
    v_mfma_f32_16x16x32_bf16 v[112:115], v[92:95], v[72:75], 0
    v_mfma_f32_16x16x32_bf16 v[112:115], v[96:99], v[76:79], v[112:115]
    v_mfma_f32_16x16x32_bf16 v[112:115], v[100:103], v[80:83], v[112:115]
    v_mfma_f32_16x16x32_bf16 v[112:115], v[104:107], v[84:87], v[112:115]
    v_mfma_f32_16x16x32_bf16 v[112:115], v[108:111], v[88:91], v[112:115]
    v_max3_u32 v116, v92, v93, v94
    v_max3_u32 v116, v116, v95, v96
    v_max3_u32 v116, v116, v97, v98
    v_max3_u32 v116, v116, v99, v100
    v_max3_u32 v116, v116, v101, v102
    v_max3_u32 v116, v116, v103, v104
    v_max3_u32 v116, v116, v105, v106
    v_max3_u32 v116, v116, v107, v108
    v_max3_u32 v116, v116, v109, v110
    v_max_u32 v116, v116, v111
    v_cmp_eq_u32 vcc, -1, v116
    s_sub_u32 s15, s15, 1
    s_cbranch_scc1 layerb1_kernel_bail
    s_cbranch_vccnz layerb1_kernel_y2_ppoll
    ds_write_b128 v6, v[112:115]
    s_waitcnt lgkmcnt(0)
    s_barrier
    s_barrier
    s_add_u32 s14, s14, 1
    s_branch layerb1_kernel_y2_step
layerb1_kernel_y2_last:
    s_waitcnt vmcnt(0)
    s_barrier
    s_branch layerb1_kernel_end
layerb1_kernel_y3_start:
    v_lshrrev_b32 v16, 4, v0
    v_and_b32 v17, 7, v0
    v_lshrrev_b32 v18, 3, v0
    v_and_b32 v18, 1, v18
    v_lshl_add_u32 v19, v18, 2, v16
    v_add_u32 v19, 24, v19
    v_mul_u32_u24 v20, 640, v19
    v_lshl_add_u32 v4, v17, 4, v20
    v_and_b32 v20, 3, v17
    v_lshlrev_b32 v20, 1, v20
    v_lshrrev_b32 v21, 2, v17
    v_add_u32 v20, v20, v21
    v_lshlrev_b32 v20, 4, v20
    v_lshl_add_u32 v5, v19, 7, v20
    v_add_u32 v3, 0, v1
    v_lshrrev_b32 v20, 1, v17
    v_lshlrev_b32 v20, 7, v20
    v_and_b32 v21, 1, v17
    v_lshl_add_u32 v20, v21, 2, v20
    v_add_u32 v10, 1536, v20
    v_lshlrev_b32 v20, 8, v18
    v_lshl_add_u32 v20, v17, 5, v20
    v_and_b32 v21, 1, v16
    v_lshl_add_u32 v20, v21, 4, v20
    v_add_u32 v20, 11776, v20
    v_add_u32 v21, 12288, v1
    v_lshrrev_b32 v22, 1, v16
    v_cmp_eq_u32 vcc, v22, v18
    s_nop 1
    v_cndmask_b32 v6, v21, v20, vcc
    v_lshrrev_b32 v20, 3, v0
    v_lshlrev_b32 v20, 2, v20
    v_lshl_add_u32 v20, v17, 5, v20
    v_add_u32 v7, 10240, v20
    s_lshl_b32 s20, s12, 7
    s_add_u32 s20, s20, 20480
    s_lshr_b32 s21, s20, 13
    s_lshl_b32 s21, s21, 14
    s_and_b32 s20, s20, 8191
    s_add_u32 s20, s20, s21
    v_lshrrev_b32 v20, 3, v0
    v_lshlrev_b32 v20, 4, v20
    v_add_u32 v8, s20, v20
    s_mul_i32 s46, s12, 20480
    s_add_u32 s46, s46, 103809024
    s_mul_i32 s20, s12, 327680
    s_add_u32 s20, s20, 27508736
    s_add_u32 s21, s20, 0
    buffer_load_dwordx4 a[0:3], v1, s[8:11], s21 offen offset:0
    buffer_load_dwordx4 a[4:7], v1, s[8:11], s21 offen offset:1024
    s_add_u32 s21, s20, 2048
    buffer_load_dwordx4 a[8:11], v1, s[8:11], s21 offen offset:0
    buffer_load_dwordx4 a[12:15], v1, s[8:11], s21 offen offset:1024
    s_add_u32 s21, s20, 4096
    buffer_load_dwordx4 a[16:19], v1, s[8:11], s21 offen offset:0
    buffer_load_dwordx4 a[20:23], v1, s[8:11], s21 offen offset:1024
    s_add_u32 s21, s20, 6144
    buffer_load_dwordx4 a[24:27], v1, s[8:11], s21 offen offset:0
    buffer_load_dwordx4 a[28:31], v1, s[8:11], s21 offen offset:1024
    s_add_u32 s21, s20, 8192
    buffer_load_dwordx4 a[32:35], v1, s[8:11], s21 offen offset:0
    buffer_load_dwordx4 a[36:39], v1, s[8:11], s21 offen offset:1024
    s_add_u32 s21, s20, 10240
    buffer_load_dwordx4 a[40:43], v1, s[8:11], s21 offen offset:0
    buffer_load_dwordx4 a[44:47], v1, s[8:11], s21 offen offset:1024
    s_add_u32 s21, s20, 12288
    buffer_load_dwordx4 a[48:51], v1, s[8:11], s21 offen offset:0
    buffer_load_dwordx4 a[52:55], v1, s[8:11], s21 offen offset:1024
    s_add_u32 s21, s20, 14336
    buffer_load_dwordx4 a[56:59], v1, s[8:11], s21 offen offset:0
    buffer_load_dwordx4 a[60:63], v1, s[8:11], s21 offen offset:1024
    s_add_u32 s21, s20, 16384
    buffer_load_dwordx4 a[64:67], v1, s[8:11], s21 offen offset:0
    buffer_load_dwordx4 a[68:71], v1, s[8:11], s21 offen offset:1024
    s_add_u32 s21, s20, 18432
    buffer_load_dwordx4 a[72:75], v1, s[8:11], s21 offen offset:0
    buffer_load_dwordx4 a[76:79], v1, s[8:11], s21 offen offset:1024
    s_add_u32 s21, s20, 20480
    buffer_load_dwordx4 a[80:83], v1, s[8:11], s21 offen offset:0
    buffer_load_dwordx4 a[84:87], v1, s[8:11], s21 offen offset:1024
    s_add_u32 s21, s20, 22528
    buffer_load_dwordx4 a[88:91], v1, s[8:11], s21 offen offset:0
    buffer_load_dwordx4 a[92:95], v1, s[8:11], s21 offen offset:1024
    s_add_u32 s21, s20, 24576
    buffer_load_dwordx4 a[96:99], v1, s[8:11], s21 offen offset:0
    buffer_load_dwordx4 a[100:103], v1, s[8:11], s21 offen offset:1024
    s_add_u32 s21, s20, 26624
    buffer_load_dwordx4 a[104:107], v1, s[8:11], s21 offen offset:0
    buffer_load_dwordx4 a[108:111], v1, s[8:11], s21 offen offset:1024
    s_add_u32 s21, s20, 28672
    buffer_load_dwordx4 a[112:115], v1, s[8:11], s21 offen offset:0
    buffer_load_dwordx4 a[116:119], v1, s[8:11], s21 offen offset:1024
    s_add_u32 s21, s20, 30720
    buffer_load_dwordx4 a[120:123], v1, s[8:11], s21 offen offset:0
    buffer_load_dwordx4 a[124:127], v1, s[8:11], s21 offen offset:1024
    s_add_u32 s21, s20, 32768
    buffer_load_dwordx4 a[128:131], v1, s[8:11], s21 offen offset:0
    buffer_load_dwordx4 a[132:135], v1, s[8:11], s21 offen offset:1024
    s_add_u32 s21, s20, 34816
    buffer_load_dwordx4 a[136:139], v1, s[8:11], s21 offen offset:0
    buffer_load_dwordx4 a[140:143], v1, s[8:11], s21 offen offset:1024
    s_add_u32 s21, s20, 36864
    buffer_load_dwordx4 a[144:147], v1, s[8:11], s21 offen offset:0
    buffer_load_dwordx4 a[148:151], v1, s[8:11], s21 offen offset:1024
    s_add_u32 s21, s20, 38912
    buffer_load_dwordx4 a[152:155], v1, s[8:11], s21 offen offset:0
    buffer_load_dwordx4 a[156:159], v1, s[8:11], s21 offen offset:1024
    s_add_u32 s21, s20, 40960
    buffer_load_dwordx4 a[160:163], v1, s[8:11], s21 offen offset:0
    buffer_load_dwordx4 a[164:167], v1, s[8:11], s21 offen offset:1024
    s_add_u32 s21, s20, 43008
    buffer_load_dwordx4 a[168:171], v1, s[8:11], s21 offen offset:0
    buffer_load_dwordx4 a[172:175], v1, s[8:11], s21 offen offset:1024
    s_add_u32 s21, s20, 45056
    buffer_load_dwordx4 a[176:179], v1, s[8:11], s21 offen offset:0
    buffer_load_dwordx4 a[180:183], v1, s[8:11], s21 offen offset:1024
    s_add_u32 s21, s20, 47104
    buffer_load_dwordx4 a[184:187], v1, s[8:11], s21 offen offset:0
    buffer_load_dwordx4 a[188:191], v1, s[8:11], s21 offen offset:1024
    s_add_u32 s21, s20, 49152
    buffer_load_dwordx4 a[192:195], v1, s[8:11], s21 offen offset:0
    buffer_load_dwordx4 a[196:199], v1, s[8:11], s21 offen offset:1024
    s_add_u32 s21, s20, 51200
    buffer_load_dwordx4 a[200:203], v1, s[8:11], s21 offen offset:0
    buffer_load_dwordx4 a[204:207], v1, s[8:11], s21 offen offset:1024
    s_add_u32 s21, s20, 53248
    buffer_load_dwordx4 a[208:211], v1, s[8:11], s21 offen offset:0
    buffer_load_dwordx4 a[212:215], v1, s[8:11], s21 offen offset:1024
    s_add_u32 s21, s20, 55296
    buffer_load_dwordx4 a[216:219], v1, s[8:11], s21 offen offset:0
    buffer_load_dwordx4 a[220:223], v1, s[8:11], s21 offen offset:1024
    s_add_u32 s21, s20, 57344
    buffer_load_dwordx4 a[224:227], v1, s[8:11], s21 offen offset:0
    buffer_load_dwordx4 a[228:231], v1, s[8:11], s21 offen offset:1024
    s_add_u32 s21, s20, 59392
    buffer_load_dwordx4 a[232:235], v1, s[8:11], s21 offen offset:0
    buffer_load_dwordx4 a[236:239], v1, s[8:11], s21 offen offset:1024
    s_add_u32 s21, s20, 61440
    buffer_load_dwordx4 a[240:243], v1, s[8:11], s21 offen offset:0
    buffer_load_dwordx4 a[244:247], v1, s[8:11], s21 offen offset:1024
    s_add_u32 s21, s20, 63488
    buffer_load_dwordx4 a[248:251], v1, s[8:11], s21 offen offset:0
    buffer_load_dwordx4 a[252:255], v1, s[8:11], s21 offen offset:1024
    s_add_u32 s21, s20, 65536
    buffer_load_dwordx4 v[176:179], v1, s[8:11], s21 offen offset:0
    buffer_load_dwordx4 v[180:183], v1, s[8:11], s21 offen offset:1024
    s_add_u32 s21, s20, 67584
    buffer_load_dwordx4 v[184:187], v1, s[8:11], s21 offen offset:0
    buffer_load_dwordx4 v[188:191], v1, s[8:11], s21 offen offset:1024
    s_add_u32 s21, s20, 69632
    buffer_load_dwordx4 v[192:195], v1, s[8:11], s21 offen offset:0
    buffer_load_dwordx4 v[196:199], v1, s[8:11], s21 offen offset:1024
    s_add_u32 s21, s20, 71680
    buffer_load_dwordx4 v[200:203], v1, s[8:11], s21 offen offset:0
    buffer_load_dwordx4 v[204:207], v1, s[8:11], s21 offen offset:1024
    s_add_u32 s21, s20, 73728
    buffer_load_dwordx4 v[208:211], v1, s[8:11], s21 offen offset:0
    buffer_load_dwordx4 v[212:215], v1, s[8:11], s21 offen offset:1024
    s_add_u32 s21, s20, 75776
    buffer_load_dwordx4 v[216:219], v1, s[8:11], s21 offen offset:0
    buffer_load_dwordx4 v[220:223], v1, s[8:11], s21 offen offset:1024
    s_add_u32 s21, s20, 77824
    buffer_load_dwordx4 v[224:227], v1, s[8:11], s21 offen offset:0
    buffer_load_dwordx4 v[228:231], v1, s[8:11], s21 offen offset:1024
    s_add_u32 s21, s20, 79872
    buffer_load_dwordx4 v[232:235], v1, s[8:11], s21 offen offset:0
    buffer_load_dwordx4 v[236:239], v1, s[8:11], s21 offen offset:1024
    s_mov_b32 s14, 0
    s_lshl_b32 s20, s12, 7
    v_mov_b32 v9, s20
    s_mov_b32 s47, 0
layerb1_kernel_y3_step:
    s_cmp_lt_u32 s14, 32
    s_cselect_b32 s18, s16, s17
    s_and_b32 s20, s14, 31
    s_lshl_b32 s20, s20, 16
    s_add_u32 s18, s18, s20
    s_mul_i32 s28, s14, 1638400
    s_add_u32 s28, s28, s46
    v_mov_b32 v56, 0
    v_mov_b32 v57, 0
    v_mov_b32 v58, 0
    v_mov_b32 v59, 0
    v_mov_b32 v60, 0
    v_mov_b32 v61, 0
    v_mov_b32 v62, 0
    v_mov_b32 v63, 0
    v_mov_b32 v64, 0
    v_mov_b32 v65, 0
    v_mov_b32 v66, 0
    v_mov_b32 v67, 0
    v_mov_b32 v68, 0
    v_mov_b32 v69, 0
    v_mov_b32 v70, 0
    v_mov_b32 v71, 0
    s_add_u32 s22, s18, 53248
    s_add_u32 s23, s18, 54272
layerb1_kernel_y3_poll:
    buffer_load_dwordx4 v[48:51], v1, s[8:11], s22 offen sc1
    buffer_load_dwordx4 v[52:55], v1, s[8:11], s23 offen sc1
    s_waitcnt vmcnt(0)
    ds_write_b128 v3, v[48:51] offset:8192
    ds_write_b128 v3, v[52:55] offset:9216
    v_max3_u32 v116, v48, v49, v50
    v_max3_u32 v116, v116, v51, v52
    v_max3_u32 v116, v116, v53, v54
    v_max_u32 v116, v116, v55
    v_cmp_eq_u32 vcc, -1, v116
    s_sub_u32 s15, s15, 1
    s_cbranch_scc1 layerb1_kernel_bail
    s_cbranch_vccnz layerb1_kernel_y3_poll
    s_waitcnt lgkmcnt(0)
    s_barrier
    ds_read_b128 v[16:19], v3 offset:0
    ds_read_b128 v[20:23], v3 offset:1024
    ds_read_b128 v[24:27], v3 offset:2048
    ds_read_b128 v[28:31], v3 offset:3072
    ds_read_b128 v[32:35], v3 offset:4096
    ds_read_b128 v[36:39], v3 offset:5120
    ds_read_b128 v[40:43], v3 offset:6144
    ds_read_b128 v[44:47], v3 offset:7168
    s_cmp_gt_u32 s47, s14
    s_cbranch_scc1 layerb1_kernel_y3_gw_ok
layerb1_kernel_y3_gw_lp:
    buffer_load_dword v116, v9, s[8:11], s48 offen sc1
    s_waitcnt vmcnt(0)
    v_readlane_b32 s47, v116, 0
    s_nop 0
    s_sub_u32 s15, s15, 1
    s_cbranch_scc1 layerb1_kernel_bail
    s_cmp_gt_u32 s47, s14
    s_cbranch_scc0 layerb1_kernel_y3_gw_lp
layerb1_kernel_y3_gw_ok:
    buffer_load_dwordx4 v[76:79], v4, s[8:11], s28 offen offset:128 sc1
    buffer_load_dwordx4 v[80:83], v4, s[8:11], s28 offen offset:256 sc1
    buffer_load_dwordx4 v[84:87], v4, s[8:11], s28 offen offset:384 sc1
    buffer_load_dwordx4 v[88:91], v4, s[8:11], s28 offen offset:512 sc1
    v_smfmac_f32_16x16x64_bf16 v[56:59], v[48:51], a[64:71], v2
    v_smfmac_f32_16x16x64_bf16 v[60:63], v[48:51], a[144:151], v2
    v_smfmac_f32_16x16x64_bf16 v[64:67], v[48:51], a[224:231], v2
    v_smfmac_f32_16x16x64_bf16 v[68:71], v[48:51], v[224:231], v2
    v_smfmac_f32_16x16x64_bf16 v[56:59], v[52:55], a[72:79], v2
    v_smfmac_f32_16x16x64_bf16 v[60:63], v[52:55], a[152:159], v2
    v_smfmac_f32_16x16x64_bf16 v[64:67], v[52:55], a[232:239], v2
    v_smfmac_f32_16x16x64_bf16 v[68:71], v[52:55], v[232:239], v2
    s_waitcnt lgkmcnt(7)
    v_smfmac_f32_16x16x64_bf16 v[56:59], v[16:19], a[0:7], v2
    v_smfmac_f32_16x16x64_bf16 v[60:63], v[16:19], a[80:87], v2
    v_smfmac_f32_16x16x64_bf16 v[64:67], v[16:19], a[160:167], v2
    v_smfmac_f32_16x16x64_bf16 v[68:71], v[16:19], a[240:247], v2
    s_waitcnt lgkmcnt(6)
    v_smfmac_f32_16x16x64_bf16 v[56:59], v[20:23], a[8:15], v2
    v_smfmac_f32_16x16x64_bf16 v[60:63], v[20:23], a[88:95], v2
    v_smfmac_f32_16x16x64_bf16 v[64:67], v[20:23], a[168:175], v2
    v_smfmac_f32_16x16x64_bf16 v[68:71], v[20:23], a[248:255], v2
    s_waitcnt lgkmcnt(5)
    v_smfmac_f32_16x16x64_bf16 v[56:59], v[24:27], a[16:23], v2
    v_smfmac_f32_16x16x64_bf16 v[60:63], v[24:27], a[96:103], v2
    v_smfmac_f32_16x16x64_bf16 v[64:67], v[24:27], a[176:183], v2
    v_smfmac_f32_16x16x64_bf16 v[68:71], v[24:27], v[176:183], v2
    s_waitcnt lgkmcnt(4)
    v_smfmac_f32_16x16x64_bf16 v[56:59], v[28:31], a[24:31], v2
    v_smfmac_f32_16x16x64_bf16 v[60:63], v[28:31], a[104:111], v2
    v_smfmac_f32_16x16x64_bf16 v[64:67], v[28:31], a[184:191], v2
    v_smfmac_f32_16x16x64_bf16 v[68:71], v[28:31], v[184:191], v2
    s_waitcnt lgkmcnt(3)
    v_smfmac_f32_16x16x64_bf16 v[56:59], v[32:35], a[32:39], v2
    v_smfmac_f32_16x16x64_bf16 v[60:63], v[32:35], a[112:119], v2
    v_smfmac_f32_16x16x64_bf16 v[64:67], v[32:35], a[192:199], v2
    v_smfmac_f32_16x16x64_bf16 v[68:71], v[32:35], v[192:199], v2
    s_waitcnt lgkmcnt(2)
    v_smfmac_f32_16x16x64_bf16 v[56:59], v[36:39], a[40:47], v2
    v_smfmac_f32_16x16x64_bf16 v[60:63], v[36:39], a[120:127], v2
    v_smfmac_f32_16x16x64_bf16 v[64:67], v[36:39], a[200:207], v2
    v_smfmac_f32_16x16x64_bf16 v[68:71], v[36:39], v[200:207], v2
    s_waitcnt lgkmcnt(1)
    v_smfmac_f32_16x16x64_bf16 v[56:59], v[40:43], a[48:55], v2
    v_smfmac_f32_16x16x64_bf16 v[60:63], v[40:43], a[128:135], v2
    v_smfmac_f32_16x16x64_bf16 v[64:67], v[40:43], a[208:215], v2
    v_smfmac_f32_16x16x64_bf16 v[68:71], v[40:43], v[208:215], v2
    s_waitcnt lgkmcnt(0)
    v_smfmac_f32_16x16x64_bf16 v[56:59], v[44:47], a[56:63], v2
    v_smfmac_f32_16x16x64_bf16 v[60:63], v[44:47], a[136:143], v2
    v_smfmac_f32_16x16x64_bf16 v[64:67], v[44:47], a[216:223], v2
    v_smfmac_f32_16x16x64_bf16 v[68:71], v[44:47], v[216:223], v2
    s_nop 7
    v_permlane32_swap_b32 v56, v64
    v_permlane32_swap_b32 v60, v68
    v_permlane32_swap_b32 v57, v65
    v_permlane32_swap_b32 v61, v69
    v_permlane32_swap_b32 v58, v66
    v_permlane32_swap_b32 v62, v70
    v_permlane32_swap_b32 v59, v67
    v_permlane32_swap_b32 v63, v71
    v_add_f32 v56, v56, v64
    v_add_f32 v60, v60, v68
    v_add_f32 v57, v57, v65
    v_add_f32 v61, v61, v69
    v_add_f32 v58, v58, v66
    v_add_f32 v62, v62, v70
    v_add_f32 v59, v59, v67
    v_add_f32 v63, v63, v71
    s_nop 1
    v_permlane16_swap_b32 v56, v60
    v_permlane16_swap_b32 v57, v61
    v_permlane16_swap_b32 v58, v62
    v_permlane16_swap_b32 v59, v63
    s_nop 1
    v_cvt_pk_bf16_f32 v72, v56, v57
    v_cvt_pk_bf16_f32 v73, v58, v59
    v_cvt_pk_bf16_f32 v74, v60, v61
    v_cvt_pk_bf16_f32 v75, v62, v63
    buffer_store_dwordx4 v[72:75], v4, s[8:11], s28 offen sc1
    s_cmp_eq_u32 s14, 63
    s_cbranch_scc1 layerb1_kernel_y3_last
    s_add_u32 s30, s18, 0
    s_add_u32 s31, s18, 4096
    s_add_u32 s32, s18, 16384
    s_add_u32 s33, s18, 20480
    s_add_u32 s34, s18, 32768
    s_add_u32 s29, s14, 1
    s_cmp_lt_u32 s29, 32
    s_cselect_b32 s19, s16, s17
    s_and_b32 s20, s29, 31
    s_lshl_b32 s20, s20, 16
    s_add_u32 s19, s19, s20
layerb1_kernel_y3_ppoll:
    buffer_load_dwordx4 v[92:95], v5, s[8:11], s30 offen sc1
    buffer_load_dwordx4 v[96:99], v5, s[8:11], s31 offen sc1
    buffer_load_dwordx4 v[100:103], v5, s[8:11], s32 offen sc1
    buffer_load_dwordx4 v[104:107], v5, s[8:11], s33 offen sc1
    buffer_load_dwordx4 v[108:111], v5, s[8:11], s34 offen sc1
    s_waitcnt vmcnt(0)
    v_mfma_f32_16x16x32_bf16 v[112:115], v[92:95], v[72:75], 0
    v_mfma_f32_16x16x32_bf16 v[112:115], v[96:99], v[76:79], v[112:115]
    v_mfma_f32_16x16x32_bf16 v[112:115], v[100:103], v[80:83], v[112:115]
    v_mfma_f32_16x16x32_bf16 v[112:115], v[104:107], v[84:87], v[112:115]
    v_mfma_f32_16x16x32_bf16 v[112:115], v[108:111], v[88:91], v[112:115]
    v_max3_u32 v116, v92, v93, v94
    v_max3_u32 v116, v116, v95, v96
    v_max3_u32 v116, v116, v97, v98
    v_max3_u32 v116, v116, v99, v100
    v_max3_u32 v116, v116, v101, v102
    v_max3_u32 v116, v116, v103, v104
    v_max3_u32 v116, v116, v105, v106
    v_max3_u32 v116, v116, v107, v108
    v_max3_u32 v116, v116, v109, v110
    v_max_u32 v116, v116, v111
    v_cmp_eq_u32 vcc, -1, v116
    s_sub_u32 s15, s15, 1
    s_cbranch_scc1 layerb1_kernel_bail
    s_cbranch_vccnz layerb1_kernel_y3_ppoll
    ds_write_b128 v6, v[112:115]
    s_waitcnt lgkmcnt(0)
    s_barrier
    s_barrier
    s_add_u32 s14, s14, 1
    s_branch layerb1_kernel_y3_step
layerb1_kernel_y3_last:
    s_waitcnt vmcnt(0)
    s_barrier
    s_branch layerb1_kernel_end
layerb1_kernel_proj:
    s_sub_u32 s22, s20, 4
    s_lshl_b32 s22, s22, 5
    s_add_u32 s12, s22, s21
    s_mov_b32 s14, 0
    s_mov_b32 s15, 64
    v_lshlrev_b32 v1, 4, v0
    v_and_b32 v8, 31, v0
    v_lshrrev_b32 v9, 5, v0
    s_cmp_ge_u32 s12, 80
    s_cbranch_scc1 layerb1_kernel_g_qk
    v_lshrrev_b32 v10, 3, v8
    v_and_b32 v11, 7, v8
    v_mul_u32_u24 v12, 20480, v10
    v_lshl_add_u32 v12, v11, 4, v12
    v_lshl_add_u32 v4, v9, 8, v12
    s_mul_i32 s24, s12, 327680
    s_mul_i32 s25, s13, 81920
    s_add_u32 s24, s24, s25
    s_add_u32 s24, s24, 27262976
    buffer_load_dwordx4 a[0:3], v4, s[8:11], s24 offen offset:0
    buffer_load_dwordx4 a[4:7], v4, s[8:11], s24 offen offset:128
    buffer_load_dwordx4 a[8:11], v4, s[8:11], s24 offen offset:512
    buffer_load_dwordx4 a[12:15], v4, s[8:11], s24 offen offset:640
    buffer_load_dwordx4 a[16:19], v4, s[8:11], s24 offen offset:1024
    buffer_load_dwordx4 a[20:23], v4, s[8:11], s24 offen offset:1152
    buffer_load_dwordx4 a[24:27], v4, s[8:11], s24 offen offset:1536
    buffer_load_dwordx4 a[28:31], v4, s[8:11], s24 offen offset:1664
    buffer_load_dwordx4 a[32:35], v4, s[8:11], s24 offen offset:2048
    buffer_load_dwordx4 a[36:39], v4, s[8:11], s24 offen offset:2176
    buffer_load_dwordx4 a[40:43], v4, s[8:11], s24 offen offset:2560
    buffer_load_dwordx4 a[44:47], v4, s[8:11], s24 offen offset:2688
    buffer_load_dwordx4 a[48:51], v4, s[8:11], s24 offen offset:3072
    buffer_load_dwordx4 a[52:55], v4, s[8:11], s24 offen offset:3200
    s_add_u32 s24, s24, 3584
    buffer_load_dwordx4 a[56:59], v4, s[8:11], s24 offen offset:0
    buffer_load_dwordx4 a[60:63], v4, s[8:11], s24 offen offset:128
    buffer_load_dwordx4 a[64:67], v4, s[8:11], s24 offen offset:512
    buffer_load_dwordx4 a[68:71], v4, s[8:11], s24 offen offset:640
    buffer_load_dwordx4 a[72:75], v4, s[8:11], s24 offen offset:1024
    buffer_load_dwordx4 a[76:79], v4, s[8:11], s24 offen offset:1152
    buffer_load_dwordx4 a[80:83], v4, s[8:11], s24 offen offset:1536
    buffer_load_dwordx4 a[84:87], v4, s[8:11], s24 offen offset:1664
    buffer_load_dwordx4 a[88:91], v4, s[8:11], s24 offen offset:2048
    buffer_load_dwordx4 a[92:95], v4, s[8:11], s24 offen offset:2176
    buffer_load_dwordx4 a[96:99], v4, s[8:11], s24 offen offset:2560
    buffer_load_dwordx4 a[100:103], v4, s[8:11], s24 offen offset:2688
    buffer_load_dwordx4 a[104:107], v4, s[8:11], s24 offen offset:3072
    buffer_load_dwordx4 a[108:111], v4, s[8:11], s24 offen offset:3200
    s_add_u32 s24, s24, 3584
    buffer_load_dwordx4 a[112:115], v4, s[8:11], s24 offen offset:0
    buffer_load_dwordx4 a[116:119], v4, s[8:11], s24 offen offset:128
    buffer_load_dwordx4 a[120:123], v4, s[8:11], s24 offen offset:512
    buffer_load_dwordx4 a[124:127], v4, s[8:11], s24 offen offset:640
    buffer_load_dwordx4 a[128:131], v4, s[8:11], s24 offen offset:1024
    buffer_load_dwordx4 a[132:135], v4, s[8:11], s24 offen offset:1152
    buffer_load_dwordx4 a[136:139], v4, s[8:11], s24 offen offset:1536
    buffer_load_dwordx4 a[140:143], v4, s[8:11], s24 offen offset:1664
    buffer_load_dwordx4 a[144:147], v4, s[8:11], s24 offen offset:2048
    buffer_load_dwordx4 a[148:151], v4, s[8:11], s24 offen offset:2176
    buffer_load_dwordx4 a[152:155], v4, s[8:11], s24 offen offset:2560
    buffer_load_dwordx4 a[156:159], v4, s[8:11], s24 offen offset:2688
    buffer_load_dwordx4 a[160:163], v4, s[8:11], s24 offen offset:3072
    buffer_load_dwordx4 a[164:167], v4, s[8:11], s24 offen offset:3200
    s_add_u32 s24, s24, 3584
    buffer_load_dwordx4 a[168:171], v4, s[8:11], s24 offen offset:0
    buffer_load_dwordx4 a[172:175], v4, s[8:11], s24 offen offset:128
    buffer_load_dwordx4 a[176:179], v4, s[8:11], s24 offen offset:512
    buffer_load_dwordx4 a[180:183], v4, s[8:11], s24 offen offset:640
    buffer_load_dwordx4 a[184:187], v4, s[8:11], s24 offen offset:1024
    buffer_load_dwordx4 a[188:191], v4, s[8:11], s24 offen offset:1152
    buffer_load_dwordx4 a[192:195], v4, s[8:11], s24 offen offset:1536
    buffer_load_dwordx4 a[196:199], v4, s[8:11], s24 offen offset:1664
    buffer_load_dwordx4 a[200:203], v4, s[8:11], s24 offen offset:2048
    buffer_load_dwordx4 a[204:207], v4, s[8:11], s24 offen offset:2176
    buffer_load_dwordx4 a[208:211], v4, s[8:11], s24 offen offset:2560
    buffer_load_dwordx4 a[212:215], v4, s[8:11], s24 offen offset:2688
    buffer_load_dwordx4 a[216:219], v4, s[8:11], s24 offen offset:3072
    buffer_load_dwordx4 a[220:223], v4, s[8:11], s24 offen offset:3200
    s_add_u32 s24, s24, 3584
    buffer_load_dwordx4 a[224:227], v4, s[8:11], s24 offen offset:0
    buffer_load_dwordx4 a[228:231], v4, s[8:11], s24 offen offset:128
    buffer_load_dwordx4 a[232:235], v4, s[8:11], s24 offen offset:512
    buffer_load_dwordx4 a[236:239], v4, s[8:11], s24 offen offset:640
    buffer_load_dwordx4 a[240:243], v4, s[8:11], s24 offen offset:1024
    buffer_load_dwordx4 a[244:247], v4, s[8:11], s24 offen offset:1152
    buffer_load_dwordx4 a[248:251], v4, s[8:11], s24 offen offset:1536
    buffer_load_dwordx4 a[252:255], v4, s[8:11], s24 offen offset:1664
    buffer_load_dwordx4 v[192:195], v4, s[8:11], s24 offen offset:2048
    buffer_load_dwordx4 v[196:199], v4, s[8:11], s24 offen offset:2176
    buffer_load_dwordx4 v[200:203], v4, s[8:11], s24 offen offset:2560
    buffer_load_dwordx4 v[204:207], v4, s[8:11], s24 offen offset:2688
    buffer_load_dwordx4 v[208:211], v4, s[8:11], s24 offen offset:3072
    buffer_load_dwordx4 v[212:215], v4, s[8:11], s24 offen offset:3200
    s_add_u32 s24, s24, 3584
    buffer_load_dwordx4 v[216:219], v4, s[8:11], s24 offen offset:0
    buffer_load_dwordx4 v[220:223], v4, s[8:11], s24 offen offset:128
    buffer_load_dwordx4 v[224:227], v4, s[8:11], s24 offen offset:512
    buffer_load_dwordx4 v[228:231], v4, s[8:11], s24 offen offset:640
    buffer_load_dwordx4 v[232:235], v4, s[8:11], s24 offen offset:1024
    buffer_load_dwordx4 v[236:239], v4, s[8:11], s24 offen offset:1152
    buffer_load_dwordx4 v[240:243], v4, s[8:11], s24 offen offset:1536
    buffer_load_dwordx4 v[244:247], v4, s[8:11], s24 offen offset:1664
    buffer_load_dwordx4 v[248:251], v4, s[8:11], s24 offen offset:2048
    buffer_load_dwordx4 v[252:255], v4, s[8:11], s24 offen offset:2176
    s_lshl_b32 s25, s13, 3
    v_add_u32 v10, s25, v10
    v_mul_u32_u24 v10, 640, v10
    v_lshl_add_u32 v10, v9, 7, v10
    v_lshl_add_u32 v10, v11, 4, v10
    v_add_u32 v3, 128, v10
    s_mul_i32 s17, s12, 20480
    s_mul_i32 s25, s14, 1638400
    s_add_u32 s17, s17, s25
    s_add_u32 s17, s17, 103809024
    s_mov_b32 s20, 1638400
    s_mul_i32 s19, s13, 10240
    s_add_u32 s19, s19, 220200960
    s_mov_b32 s22, 0
    s_min_u32 s24, s14, 63
    s_mul_i32 s24, s24, 40960
    s_add_u32 s24, s24, s19
    s_mul_i32 s25, s13, 10240
    s_add_u32 s25, s25, s22
    s_mov_b32 m0, s25
    s_nop 0
    buffer_load_dwordx4 v1, s[8:11], s24 offen offset:0 lds
    buffer_load_dwordx4 v1, s[8:11], s24 offen offset:1024 lds
    buffer_load_dwordx4 v1, s[8:11], s24 offen offset:2048 lds
    buffer_load_dwordx4 v1, s[8:11], s24 offen offset:3072 lds
    s_add_u32 s24, s24, 4096
    s_add_u32 s25, s25, 4096
    s_mov_b32 m0, s25
    s_nop 0
    buffer_load_dwordx4 v1, s[8:11], s24 offen offset:0 lds
    buffer_load_dwordx4 v1, s[8:11], s24 offen offset:1024 lds
    buffer_load_dwordx4 v1, s[8:11], s24 offen offset:2048 lds
    buffer_load_dwordx4 v1, s[8:11], s24 offen offset:3072 lds
    s_add_u32 s24, s24, 4096
    s_add_u32 s25, s25, 4096
    s_mov_b32 m0, s25
    s_nop 0
    buffer_load_dwordx4 v1, s[8:11], s24 offen offset:0 lds
    buffer_load_dwordx4 v1, s[8:11], s24 offen offset:1024 lds
    s_mov_b32 s22, 40960
    s_add_u32 s23, s14, 1
    s_min_u32 s24, s23, 63
    s_mul_i32 s24, s24, 40960
    s_add_u32 s24, s24, s19
    s_mul_i32 s25, s13, 10240
    s_add_u32 s25, s25, s22
    s_mov_b32 m0, s25
    s_nop 0
    buffer_load_dwordx4 v1, s[8:11], s24 offen offset:0 lds
    buffer_load_dwordx4 v1, s[8:11], s24 offen offset:1024 lds
    buffer_load_dwordx4 v1, s[8:11], s24 offen offset:2048 lds
    buffer_load_dwordx4 v1, s[8:11], s24 offen offset:3072 lds
    s_add_u32 s24, s24, 4096
    s_add_u32 s25, s25, 4096
    s_mov_b32 m0, s25
    s_nop 0
    buffer_load_dwordx4 v1, s[8:11], s24 offen offset:0 lds
    buffer_load_dwordx4 v1, s[8:11], s24 offen offset:1024 lds
    buffer_load_dwordx4 v1, s[8:11], s24 offen offset:2048 lds
    buffer_load_dwordx4 v1, s[8:11], s24 offen offset:3072 lds
    s_add_u32 s24, s24, 4096
    s_add_u32 s25, s25, 4096
    s_mov_b32 m0, s25
    s_nop 0
    buffer_load_dwordx4 v1, s[8:11], s24 offen offset:0 lds
    buffer_load_dwordx4 v1, s[8:11], s24 offen offset:1024 lds
    s_mov_b32 s22, 81920
    s_mov_b32 s16, 0
    s_waitcnt vmcnt(10)
    s_barrier
    v_mov_b32 v2, v1
    ds_read_b128 v[8:11], v2 offset:0
    ds_read_b128 v[12:15], v2 offset:1024
    ds_read_b128 v[16:19], v2 offset:2048
    ds_read_b128 v[20:23], v2 offset:3072
    ds_read_b128 v[24:27], v2 offset:4096
    ds_read_b128 v[28:31], v2 offset:5120
    ds_read_b128 v[32:35], v2 offset:6144
    s_waitcnt lgkmcnt(6)
    v_mfma_f32_32x32x16_bf16 v[40:55], v[8:11], a[0:3], 0
    v_mfma_f32_32x32x16_bf16 v[56:71], v[8:11], a[4:7], 0
    ds_read_b128 v[36:39], v2 offset:7168
    s_waitcnt lgkmcnt(6)
    v_mfma_f32_32x32x16_bf16 v[40:55], v[12:15], a[8:11], v[40:55]
    v_mfma_f32_32x32x16_bf16 v[56:71], v[12:15], a[12:15], v[56:71]
    ds_read_b128 v[8:11], v2 offset:8192
    s_waitcnt lgkmcnt(6)
    v_mfma_f32_32x32x16_bf16 v[40:55], v[16:19], a[16:19], v[40:55]
    v_mfma_f32_32x32x16_bf16 v[56:71], v[16:19], a[20:23], v[56:71]
    ds_read_b128 v[12:15], v2 offset:9216
    s_waitcnt lgkmcnt(6)
    v_mfma_f32_32x32x16_bf16 v[40:55], v[20:23], a[24:27], v[40:55]
    v_mfma_f32_32x32x16_bf16 v[56:71], v[20:23], a[28:31], v[56:71]
    ds_read_b128 v[16:19], v2 offset:10240
    s_waitcnt lgkmcnt(6)
    v_mfma_f32_32x32x16_bf16 v[40:55], v[24:27], a[32:35], v[40:55]
    v_mfma_f32_32x32x16_bf16 v[56:71], v[24:27], a[36:39], v[56:71]
    ds_read_b128 v[20:23], v2 offset:11264
    s_waitcnt lgkmcnt(6)
    v_mfma_f32_32x32x16_bf16 v[40:55], v[28:31], a[40:43], v[40:55]
    v_mfma_f32_32x32x16_bf16 v[56:71], v[28:31], a[44:47], v[56:71]
    ds_read_b128 v[24:27], v2 offset:12288
    s_waitcnt lgkmcnt(6)
    v_mfma_f32_32x32x16_bf16 v[40:55], v[32:35], a[48:51], v[40:55]
    v_mfma_f32_32x32x16_bf16 v[56:71], v[32:35], a[52:55], v[56:71]
    ds_read_b128 v[28:31], v2 offset:13312
    s_waitcnt lgkmcnt(6)
    v_mfma_f32_32x32x16_bf16 v[40:55], v[36:39], a[56:59], v[40:55]
    v_mfma_f32_32x32x16_bf16 v[56:71], v[36:39], a[60:63], v[56:71]
    ds_read_b128 v[32:35], v2 offset:14336
    s_waitcnt lgkmcnt(6)
    v_mfma_f32_32x32x16_bf16 v[40:55], v[8:11], a[64:67], v[40:55]
    v_mfma_f32_32x32x16_bf16 v[56:71], v[8:11], a[68:71], v[56:71]
    ds_read_b128 v[36:39], v2 offset:15360
    s_waitcnt lgkmcnt(6)
    v_mfma_f32_32x32x16_bf16 v[40:55], v[12:15], a[72:75], v[40:55]
    v_mfma_f32_32x32x16_bf16 v[56:71], v[12:15], a[76:79], v[56:71]
    ds_read_b128 v[8:11], v2 offset:16384
    s_waitcnt lgkmcnt(6)
    v_mfma_f32_32x32x16_bf16 v[40:55], v[16:19], a[80:83], v[40:55]
    v_mfma_f32_32x32x16_bf16 v[56:71], v[16:19], a[84:87], v[56:71]
    ds_read_b128 v[12:15], v2 offset:17408
    s_waitcnt lgkmcnt(6)
    v_mfma_f32_32x32x16_bf16 v[40:55], v[20:23], a[88:91], v[40:55]
    v_mfma_f32_32x32x16_bf16 v[56:71], v[20:23], a[92:95], v[56:71]
    ds_read_b128 v[16:19], v2 offset:18432
    s_waitcnt lgkmcnt(6)
    v_mfma_f32_32x32x16_bf16 v[40:55], v[24:27], a[96:99], v[40:55]
    v_mfma_f32_32x32x16_bf16 v[56:71], v[24:27], a[100:103], v[56:71]
    ds_read_b128 v[20:23], v2 offset:19456
    s_waitcnt lgkmcnt(6)
    v_mfma_f32_32x32x16_bf16 v[40:55], v[28:31], a[104:107], v[40:55]
    v_mfma_f32_32x32x16_bf16 v[56:71], v[28:31], a[108:111], v[56:71]
    ds_read_b128 v[24:27], v2 offset:20480
    s_waitcnt lgkmcnt(6)
    v_mfma_f32_32x32x16_bf16 v[40:55], v[32:35], a[112:115], v[40:55]
    v_mfma_f32_32x32x16_bf16 v[56:71], v[32:35], a[116:119], v[56:71]
    ds_read_b128 v[28:31], v2 offset:21504
    s_waitcnt lgkmcnt(6)
    v_mfma_f32_32x32x16_bf16 v[40:55], v[36:39], a[120:123], v[40:55]
    v_mfma_f32_32x32x16_bf16 v[56:71], v[36:39], a[124:127], v[56:71]
    ds_read_b128 v[32:35], v2 offset:22528
    s_waitcnt lgkmcnt(6)
    v_mfma_f32_32x32x16_bf16 v[40:55], v[8:11], a[128:131], v[40:55]
    v_mfma_f32_32x32x16_bf16 v[56:71], v[8:11], a[132:135], v[56:71]
    ds_read_b128 v[36:39], v2 offset:23552
    s_waitcnt lgkmcnt(6)
    v_mfma_f32_32x32x16_bf16 v[40:55], v[12:15], a[136:139], v[40:55]
    v_mfma_f32_32x32x16_bf16 v[56:71], v[12:15], a[140:143], v[56:71]
    ds_read_b128 v[8:11], v2 offset:24576
    s_waitcnt lgkmcnt(6)
    v_mfma_f32_32x32x16_bf16 v[40:55], v[16:19], a[144:147], v[40:55]
    v_mfma_f32_32x32x16_bf16 v[56:71], v[16:19], a[148:151], v[56:71]
    ds_read_b128 v[12:15], v2 offset:25600
    s_waitcnt lgkmcnt(6)
    v_mfma_f32_32x32x16_bf16 v[40:55], v[20:23], a[152:155], v[40:55]
    v_mfma_f32_32x32x16_bf16 v[56:71], v[20:23], a[156:159], v[56:71]
    ds_read_b128 v[16:19], v2 offset:26624
    s_waitcnt lgkmcnt(6)
    v_mfma_f32_32x32x16_bf16 v[40:55], v[24:27], a[160:163], v[40:55]
    v_mfma_f32_32x32x16_bf16 v[56:71], v[24:27], a[164:167], v[56:71]
    ds_read_b128 v[20:23], v2 offset:27648
    s_waitcnt lgkmcnt(6)
    v_mfma_f32_32x32x16_bf16 v[40:55], v[28:31], a[168:171], v[40:55]
    v_mfma_f32_32x32x16_bf16 v[56:71], v[28:31], a[172:175], v[56:71]
    ds_read_b128 v[24:27], v2 offset:28672
    s_waitcnt lgkmcnt(6)
    v_mfma_f32_32x32x16_bf16 v[40:55], v[32:35], a[176:179], v[40:55]
    v_mfma_f32_32x32x16_bf16 v[56:71], v[32:35], a[180:183], v[56:71]
    ds_read_b128 v[28:31], v2 offset:29696
    s_waitcnt lgkmcnt(6)
    v_mfma_f32_32x32x16_bf16 v[40:55], v[36:39], a[184:187], v[40:55]
    v_mfma_f32_32x32x16_bf16 v[56:71], v[36:39], a[188:191], v[56:71]
    ds_read_b128 v[32:35], v2 offset:30720
    s_waitcnt lgkmcnt(6)
    v_mfma_f32_32x32x16_bf16 v[40:55], v[8:11], a[192:195], v[40:55]
    v_mfma_f32_32x32x16_bf16 v[56:71], v[8:11], a[196:199], v[56:71]
    ds_read_b128 v[36:39], v2 offset:31744
    s_waitcnt lgkmcnt(6)
    v_mfma_f32_32x32x16_bf16 v[40:55], v[12:15], a[200:203], v[40:55]
    v_mfma_f32_32x32x16_bf16 v[56:71], v[12:15], a[204:207], v[56:71]
    ds_read_b128 v[8:11], v2 offset:32768
    s_waitcnt lgkmcnt(6)
    v_mfma_f32_32x32x16_bf16 v[40:55], v[16:19], a[208:211], v[40:55]
    v_mfma_f32_32x32x16_bf16 v[56:71], v[16:19], a[212:215], v[56:71]
    ds_read_b128 v[12:15], v2 offset:33792
    s_waitcnt lgkmcnt(6)
    v_mfma_f32_32x32x16_bf16 v[40:55], v[20:23], a[216:219], v[40:55]
    v_mfma_f32_32x32x16_bf16 v[56:71], v[20:23], a[220:223], v[56:71]
    ds_read_b128 v[16:19], v2 offset:34816
    s_waitcnt lgkmcnt(6)
    v_mfma_f32_32x32x16_bf16 v[40:55], v[24:27], a[224:227], v[40:55]
    v_mfma_f32_32x32x16_bf16 v[56:71], v[24:27], a[228:231], v[56:71]
    s_waitcnt vmcnt(0)
    s_barrier
    s_add_u32 s21, s16, 40960
    s_cmp_eq_u32 s21, 122880
    s_cselect_b32 s21, 0, s21
    s_add_u32 s23, s14, 2
    s_min_u32 s24, s23, 63
    s_mul_i32 s24, s24, 40960
    s_add_u32 s24, s24, s19
    s_mul_i32 s25, s13, 10240
    s_add_u32 s25, s25, s22
    s_mov_b32 m0, s25
    s_nop 0
    buffer_load_dwordx4 v1, s[8:11], s24 offen offset:0 lds
    buffer_load_dwordx4 v1, s[8:11], s24 offen offset:1024 lds
    buffer_load_dwordx4 v1, s[8:11], s24 offen offset:2048 lds
    buffer_load_dwordx4 v1, s[8:11], s24 offen offset:3072 lds
    s_add_u32 s24, s24, 4096
    s_add_u32 s25, s25, 4096
    s_mov_b32 m0, s25
    s_nop 0
    buffer_load_dwordx4 v1, s[8:11], s24 offen offset:0 lds
    buffer_load_dwordx4 v1, s[8:11], s24 offen offset:1024 lds
    buffer_load_dwordx4 v1, s[8:11], s24 offen offset:2048 lds
    buffer_load_dwordx4 v1, s[8:11], s24 offen offset:3072 lds
    s_add_u32 s24, s24, 4096
    s_add_u32 s25, s25, 4096
    s_mov_b32 m0, s25
    s_nop 0
    buffer_load_dwordx4 v1, s[8:11], s24 offen offset:0 lds
    buffer_load_dwordx4 v1, s[8:11], s24 offen offset:1024 lds
    s_add_u32 s22, s22, 40960
    s_cmp_eq_u32 s22, 122880
    s_cselect_b32 s22, 0, s22
    ds_read_b128 v[20:23], v2 offset:35840
    s_waitcnt lgkmcnt(6)
    v_mfma_f32_32x32x16_bf16 v[40:55], v[28:31], a[232:235], v[40:55]
    v_mfma_f32_32x32x16_bf16 v[56:71], v[28:31], a[236:239], v[56:71]
    ds_read_b128 v[24:27], v2 offset:36864
    s_waitcnt lgkmcnt(6)
    v_mfma_f32_32x32x16_bf16 v[40:55], v[32:35], a[240:243], v[40:55]
    v_mfma_f32_32x32x16_bf16 v[56:71], v[32:35], a[244:247], v[56:71]
    ds_read_b128 v[28:31], v2 offset:37888
    s_waitcnt lgkmcnt(6)
    v_mfma_f32_32x32x16_bf16 v[40:55], v[36:39], a[248:251], v[40:55]
    v_mfma_f32_32x32x16_bf16 v[56:71], v[36:39], a[252:255], v[56:71]
    ds_read_b128 v[32:35], v2 offset:38912
    s_waitcnt lgkmcnt(6)
    v_mfma_f32_32x32x16_bf16 v[40:55], v[8:11], v[192:195], v[40:55]
    v_mfma_f32_32x32x16_bf16 v[56:71], v[8:11], v[196:199], v[56:71]
    ds_read_b128 v[36:39], v2 offset:39936
    s_waitcnt lgkmcnt(6)
    v_mfma_f32_32x32x16_bf16 v[40:55], v[12:15], v[200:203], v[40:55]
    v_mfma_f32_32x32x16_bf16 v[56:71], v[12:15], v[204:207], v[56:71]
    v_add_u32 v6, s21, v1
    ds_read_b128 v[8:11], v6 offset:0
    s_waitcnt lgkmcnt(6)
    v_mfma_f32_32x32x16_bf16 v[40:55], v[16:19], v[208:211], v[40:55]
    v_mfma_f32_32x32x16_bf16 v[56:71], v[16:19], v[212:215], v[56:71]
    ds_read_b128 v[12:15], v6 offset:1024
    s_waitcnt lgkmcnt(6)
    v_mfma_f32_32x32x16_bf16 v[40:55], v[20:23], v[216:219], v[40:55]
    v_mfma_f32_32x32x16_bf16 v[56:71], v[20:23], v[220:223], v[56:71]
    ds_read_b128 v[16:19], v6 offset:2048
    s_waitcnt lgkmcnt(6)
    v_mfma_f32_32x32x16_bf16 v[40:55], v[24:27], v[224:227], v[40:55]
    v_mfma_f32_32x32x16_bf16 v[56:71], v[24:27], v[228:231], v[56:71]
    ds_read_b128 v[20:23], v6 offset:3072
    s_waitcnt lgkmcnt(6)
    v_mfma_f32_32x32x16_bf16 v[40:55], v[28:31], v[232:235], v[40:55]
    v_mfma_f32_32x32x16_bf16 v[56:71], v[28:31], v[236:239], v[56:71]
    ds_read_b128 v[24:27], v6 offset:4096
    s_waitcnt lgkmcnt(6)
    v_mfma_f32_32x32x16_bf16 v[40:55], v[32:35], v[240:243], v[40:55]
    v_mfma_f32_32x32x16_bf16 v[56:71], v[32:35], v[244:247], v[56:71]
    ds_read_b128 v[28:31], v6 offset:5120
    s_waitcnt lgkmcnt(6)
    v_mfma_f32_32x32x16_bf16 v[40:55], v[36:39], v[248:251], v[40:55]
    v_mfma_f32_32x32x16_bf16 v[56:71], v[36:39], v[252:255], v[56:71]
    v_mov_b32 v2, v6
    s_mov_b32 s16, s21
    s_add_u32 s14, s14, 1
    s_cmp_ge_u32 s14, s15
    s_cbranch_scc1 layerb1_kernel_gu_fin0
layerb1_kernel_gu_loop:
    ds_read_b128 v[32:35], v2 offset:6144
    s_waitcnt lgkmcnt(6)
    v_mfma_f32_32x32x16_bf16 v[72:87], v[8:11], a[0:3], 0
    v_mfma_f32_32x32x16_bf16 v[88:103], v[8:11], a[4:7], 0
    ds_read_b128 v[36:39], v2 offset:7168
    s_waitcnt lgkmcnt(6)
    v_mfma_f32_32x32x16_bf16 v[72:87], v[12:15], a[8:11], v[72:87]
    v_mfma_f32_32x32x16_bf16 v[88:103], v[12:15], a[12:15], v[88:103]
    ds_read_b128 v[8:11], v2 offset:8192
    s_waitcnt lgkmcnt(6)
    v_mfma_f32_32x32x16_bf16 v[72:87], v[16:19], a[16:19], v[72:87]
    v_cvt_pk_bf16_f32 v104, v40, v41
    v_mfma_f32_32x32x16_bf16 v[88:103], v[16:19], a[20:23], v[88:103]
    v_cvt_pk_bf16_f32 v105, v42, v43
    ds_read_b128 v[12:15], v2 offset:9216
    s_waitcnt lgkmcnt(6)
    v_mfma_f32_32x32x16_bf16 v[72:87], v[20:23], a[24:27], v[72:87]
    v_cvt_pk_bf16_f32 v106, v44, v45
    v_mfma_f32_32x32x16_bf16 v[88:103], v[20:23], a[28:31], v[88:103]
    v_cvt_pk_bf16_f32 v107, v46, v47
    ds_read_b128 v[16:19], v2 offset:10240
    s_waitcnt lgkmcnt(6)
    v_mfma_f32_32x32x16_bf16 v[72:87], v[24:27], a[32:35], v[72:87]
    s_nop 1
    v_mfma_f32_32x32x16_bf16 v[88:103], v[24:27], a[36:39], v[88:103]
    v_permlane32_swap_b32 v104, v106
    ds_read_b128 v[20:23], v2 offset:11264
    s_waitcnt lgkmcnt(6)
    v_mfma_f32_32x32x16_bf16 v[72:87], v[28:31], a[40:43], v[72:87]
    v_permlane32_swap_b32 v105, v107
    v_mfma_f32_32x32x16_bf16 v[88:103], v[28:31], a[44:47], v[88:103]
    buffer_store_dwordx4 v[104:107], v3, s[8:11], s17 offen offset:0 sc1
    ds_read_b128 v[24:27], v2 offset:12288
    s_waitcnt lgkmcnt(6)
    v_mfma_f32_32x32x16_bf16 v[72:87], v[32:35], a[48:51], v[72:87]
    v_cvt_pk_bf16_f32 v108, v48, v49
    v_mfma_f32_32x32x16_bf16 v[88:103], v[32:35], a[52:55], v[88:103]
    v_cvt_pk_bf16_f32 v109, v50, v51
    ds_read_b128 v[28:31], v2 offset:13312
    s_waitcnt lgkmcnt(6)
    v_mfma_f32_32x32x16_bf16 v[72:87], v[36:39], a[56:59], v[72:87]
    v_cvt_pk_bf16_f32 v110, v52, v53
    v_mfma_f32_32x32x16_bf16 v[88:103], v[36:39], a[60:63], v[88:103]
    v_cvt_pk_bf16_f32 v111, v54, v55
    ds_read_b128 v[32:35], v2 offset:14336
    s_waitcnt lgkmcnt(6)
    v_mfma_f32_32x32x16_bf16 v[72:87], v[8:11], a[64:67], v[72:87]
    s_nop 1
    v_mfma_f32_32x32x16_bf16 v[88:103], v[8:11], a[68:71], v[88:103]
    v_permlane32_swap_b32 v108, v110
    ds_read_b128 v[36:39], v2 offset:15360
    s_waitcnt lgkmcnt(6)
    v_mfma_f32_32x32x16_bf16 v[72:87], v[12:15], a[72:75], v[72:87]
    v_permlane32_swap_b32 v109, v111
    v_mfma_f32_32x32x16_bf16 v[88:103], v[12:15], a[76:79], v[88:103]
    buffer_store_dwordx4 v[108:111], v3, s[8:11], s17 offen offset:256 sc1
    ds_read_b128 v[8:11], v2 offset:16384
    s_waitcnt lgkmcnt(6)
    v_mfma_f32_32x32x16_bf16 v[72:87], v[16:19], a[80:83], v[72:87]
    v_cvt_pk_bf16_f32 v112, v56, v57
    v_mfma_f32_32x32x16_bf16 v[88:103], v[16:19], a[84:87], v[88:103]
    v_cvt_pk_bf16_f32 v113, v58, v59
    ds_read_b128 v[12:15], v2 offset:17408
    s_waitcnt lgkmcnt(6)
    v_mfma_f32_32x32x16_bf16 v[72:87], v[20:23], a[88:91], v[72:87]
    v_cvt_pk_bf16_f32 v114, v60, v61
    v_mfma_f32_32x32x16_bf16 v[88:103], v[20:23], a[92:95], v[88:103]
    v_cvt_pk_bf16_f32 v115, v62, v63
    ds_read_b128 v[16:19], v2 offset:18432
    s_waitcnt lgkmcnt(6)
    v_mfma_f32_32x32x16_bf16 v[72:87], v[24:27], a[96:99], v[72:87]
    s_nop 1
    v_mfma_f32_32x32x16_bf16 v[88:103], v[24:27], a[100:103], v[88:103]
    v_permlane32_swap_b32 v112, v114
    ds_read_b128 v[20:23], v2 offset:19456
    s_waitcnt lgkmcnt(6)
    v_mfma_f32_32x32x16_bf16 v[72:87], v[28:31], a[104:107], v[72:87]
    v_permlane32_swap_b32 v113, v115
    v_mfma_f32_32x32x16_bf16 v[88:103], v[28:31], a[108:111], v[88:103]
    buffer_store_dwordx4 v[112:115], v3, s[8:11], s17 offen offset:2560 sc1
    ds_read_b128 v[24:27], v2 offset:20480
    s_waitcnt lgkmcnt(6)
    v_mfma_f32_32x32x16_bf16 v[72:87], v[32:35], a[112:115], v[72:87]
    v_cvt_pk_bf16_f32 v116, v64, v65
    v_mfma_f32_32x32x16_bf16 v[88:103], v[32:35], a[116:119], v[88:103]
    v_cvt_pk_bf16_f32 v117, v66, v67
    ds_read_b128 v[28:31], v2 offset:21504
    s_waitcnt lgkmcnt(6)
    v_mfma_f32_32x32x16_bf16 v[72:87], v[36:39], a[120:123], v[72:87]
    v_cvt_pk_bf16_f32 v118, v68, v69
    v_mfma_f32_32x32x16_bf16 v[88:103], v[36:39], a[124:127], v[88:103]
    v_cvt_pk_bf16_f32 v119, v70, v71
    ds_read_b128 v[32:35], v2 offset:22528
    s_waitcnt lgkmcnt(6)
    v_mfma_f32_32x32x16_bf16 v[72:87], v[8:11], a[128:131], v[72:87]
    s_nop 1
    v_mfma_f32_32x32x16_bf16 v[88:103], v[8:11], a[132:135], v[88:103]
    v_permlane32_swap_b32 v116, v118
    ds_read_b128 v[36:39], v2 offset:23552
    s_waitcnt lgkmcnt(6)
    v_mfma_f32_32x32x16_bf16 v[72:87], v[12:15], a[136:139], v[72:87]
    v_permlane32_swap_b32 v117, v119
    v_mfma_f32_32x32x16_bf16 v[88:103], v[12:15], a[140:143], v[88:103]
    buffer_store_dwordx4 v[116:119], v3, s[8:11], s17 offen offset:2816 sc1
    ds_read_b128 v[8:11], v2 offset:24576
    s_waitcnt lgkmcnt(6)
    v_mfma_f32_32x32x16_bf16 v[72:87], v[16:19], a[144:147], v[72:87]
    s_add_u32 s17, s17, s20
    v_mfma_f32_32x32x16_bf16 v[88:103], v[16:19], a[148:151], v[88:103]
    s_add_u32 s18, s18, s20
    ds_read_b128 v[12:15], v2 offset:25600
    s_waitcnt lgkmcnt(6)
    v_mfma_f32_32x32x16_bf16 v[72:87], v[20:23], a[152:155], v[72:87]
    v_mfma_f32_32x32x16_bf16 v[88:103], v[20:23], a[156:159], v[88:103]
    ds_read_b128 v[16:19], v2 offset:26624
    s_waitcnt lgkmcnt(6)
    v_mfma_f32_32x32x16_bf16 v[72:87], v[24:27], a[160:163], v[72:87]
    v_mfma_f32_32x32x16_bf16 v[88:103], v[24:27], a[164:167], v[88:103]
    ds_read_b128 v[20:23], v2 offset:27648
    s_waitcnt lgkmcnt(6)
    v_mfma_f32_32x32x16_bf16 v[72:87], v[28:31], a[168:171], v[72:87]
    v_mfma_f32_32x32x16_bf16 v[88:103], v[28:31], a[172:175], v[88:103]
    ds_read_b128 v[24:27], v2 offset:28672
    s_waitcnt lgkmcnt(6)
    v_mfma_f32_32x32x16_bf16 v[72:87], v[32:35], a[176:179], v[72:87]
    v_mfma_f32_32x32x16_bf16 v[88:103], v[32:35], a[180:183], v[88:103]
    ds_read_b128 v[28:31], v2 offset:29696
    s_waitcnt lgkmcnt(6)
    v_mfma_f32_32x32x16_bf16 v[72:87], v[36:39], a[184:187], v[72:87]
    v_mfma_f32_32x32x16_bf16 v[88:103], v[36:39], a[188:191], v[88:103]
    ds_read_b128 v[32:35], v2 offset:30720
    s_waitcnt lgkmcnt(6)
    v_mfma_f32_32x32x16_bf16 v[72:87], v[8:11], a[192:195], v[72:87]
    v_mfma_f32_32x32x16_bf16 v[88:103], v[8:11], a[196:199], v[88:103]
    ds_read_b128 v[36:39], v2 offset:31744
    s_waitcnt lgkmcnt(6)
    v_mfma_f32_32x32x16_bf16 v[72:87], v[12:15], a[200:203], v[72:87]
    v_mfma_f32_32x32x16_bf16 v[88:103], v[12:15], a[204:207], v[88:103]
    ds_read_b128 v[8:11], v2 offset:32768
    s_waitcnt lgkmcnt(6)
    v_mfma_f32_32x32x16_bf16 v[72:87], v[16:19], a[208:211], v[72:87]
    v_mfma_f32_32x32x16_bf16 v[88:103], v[16:19], a[212:215], v[88:103]
    ds_read_b128 v[12:15], v2 offset:33792
    s_waitcnt lgkmcnt(6)
    v_mfma_f32_32x32x16_bf16 v[72:87], v[20:23], a[216:219], v[72:87]
    v_mfma_f32_32x32x16_bf16 v[88:103], v[20:23], a[220:223], v[88:103]
    ds_read_b128 v[16:19], v2 offset:34816
    s_waitcnt lgkmcnt(6)
    v_mfma_f32_32x32x16_bf16 v[72:87], v[24:27], a[224:227], v[72:87]
    v_mfma_f32_32x32x16_bf16 v[88:103], v[24:27], a[228:231], v[88:103]
    s_cmp_gt_u32 s14, 2
    s_cbranch_scc1 layerb1_kernel_gu_dr1
    s_waitcnt vmcnt(0)
    s_mov_b32 s27, s14
    s_branch layerb1_kernel_gu_dq1
layerb1_kernel_gu_dr1:
    s_waitcnt vmcnt(4)
    s_sub_u32 s27, s14, 1
layerb1_kernel_gu_dq1:
    s_barrier
    s_cmp_lg_u32 s13, 0
    s_cbranch_scc1 layerb1_kernel_gu_fl2
    s_mov_b64 exec, 1
    s_lshl_b32 s26, s12, 7
    v_mov_b32 v7, s26
    v_mov_b32 v120, s27
    buffer_store_dword v120, v7, s[8:11], s48 offen sc1
    s_mov_b64 exec, -1
layerb1_kernel_gu_fl2:
    s_add_u32 s21, s16, 40960
    s_cmp_eq_u32 s21, 122880
    s_cselect_b32 s21, 0, s21
    s_add_u32 s23, s14, 2
    s_min_u32 s24, s23, 63
    s_mul_i32 s24, s24, 40960
    s_add_u32 s24, s24, s19
    s_mul_i32 s25, s13, 10240
    s_add_u32 s25, s25, s22
    s_mov_b32 m0, s25
    s_nop 0
    buffer_load_dwordx4 v1, s[8:11], s24 offen offset:0 lds
    buffer_load_dwordx4 v1, s[8:11], s24 offen offset:1024 lds
    buffer_load_dwordx4 v1, s[8:11], s24 offen offset:2048 lds
    buffer_load_dwordx4 v1, s[8:11], s24 offen offset:3072 lds
    s_add_u32 s24, s24, 4096
    s_add_u32 s25, s25, 4096
    s_mov_b32 m0, s25
    s_nop 0
    buffer_load_dwordx4 v1, s[8:11], s24 offen offset:0 lds
    buffer_load_dwordx4 v1, s[8:11], s24 offen offset:1024 lds
    buffer_load_dwordx4 v1, s[8:11], s24 offen offset:2048 lds
    buffer_load_dwordx4 v1, s[8:11], s24 offen offset:3072 lds
    s_add_u32 s24, s24, 4096
    s_add_u32 s25, s25, 4096
    s_mov_b32 m0, s25
    s_nop 0
    buffer_load_dwordx4 v1, s[8:11], s24 offen offset:0 lds
    buffer_load_dwordx4 v1, s[8:11], s24 offen offset:1024 lds
    s_add_u32 s22, s22, 40960
    s_cmp_eq_u32 s22, 122880
    s_cselect_b32 s22, 0, s22
    ds_read_b128 v[20:23], v2 offset:35840
    s_waitcnt lgkmcnt(6)
    v_mfma_f32_32x32x16_bf16 v[72:87], v[28:31], a[232:235], v[72:87]
    v_mfma_f32_32x32x16_bf16 v[88:103], v[28:31], a[236:239], v[88:103]
    ds_read_b128 v[24:27], v2 offset:36864
    s_waitcnt lgkmcnt(6)
    v_mfma_f32_32x32x16_bf16 v[72:87], v[32:35], a[240:243], v[72:87]
    v_mfma_f32_32x32x16_bf16 v[88:103], v[32:35], a[244:247], v[88:103]
    ds_read_b128 v[28:31], v2 offset:37888
    s_waitcnt lgkmcnt(6)
    v_mfma_f32_32x32x16_bf16 v[72:87], v[36:39], a[248:251], v[72:87]
    v_mfma_f32_32x32x16_bf16 v[88:103], v[36:39], a[252:255], v[88:103]
    ds_read_b128 v[32:35], v2 offset:38912
    s_waitcnt lgkmcnt(6)
    v_mfma_f32_32x32x16_bf16 v[72:87], v[8:11], v[192:195], v[72:87]
    v_mfma_f32_32x32x16_bf16 v[88:103], v[8:11], v[196:199], v[88:103]
    ds_read_b128 v[36:39], v2 offset:39936
    s_waitcnt lgkmcnt(6)
    v_mfma_f32_32x32x16_bf16 v[72:87], v[12:15], v[200:203], v[72:87]
    v_mfma_f32_32x32x16_bf16 v[88:103], v[12:15], v[204:207], v[88:103]
    v_add_u32 v6, s21, v1
    ds_read_b128 v[8:11], v6 offset:0
    s_waitcnt lgkmcnt(6)
    v_mfma_f32_32x32x16_bf16 v[72:87], v[16:19], v[208:211], v[72:87]
    v_mfma_f32_32x32x16_bf16 v[88:103], v[16:19], v[212:215], v[88:103]
    ds_read_b128 v[12:15], v6 offset:1024
    s_waitcnt lgkmcnt(6)
    v_mfma_f32_32x32x16_bf16 v[72:87], v[20:23], v[216:219], v[72:87]
    v_mfma_f32_32x32x16_bf16 v[88:103], v[20:23], v[220:223], v[88:103]
    ds_read_b128 v[16:19], v6 offset:2048
    s_waitcnt lgkmcnt(6)
    v_mfma_f32_32x32x16_bf16 v[72:87], v[24:27], v[224:227], v[72:87]
    v_mfma_f32_32x32x16_bf16 v[88:103], v[24:27], v[228:231], v[88:103]
    ds_read_b128 v[20:23], v6 offset:3072
    s_waitcnt lgkmcnt(6)
    v_mfma_f32_32x32x16_bf16 v[72:87], v[28:31], v[232:235], v[72:87]
    v_mfma_f32_32x32x16_bf16 v[88:103], v[28:31], v[236:239], v[88:103]
    ds_read_b128 v[24:27], v6 offset:4096
    s_waitcnt lgkmcnt(6)
    v_mfma_f32_32x32x16_bf16 v[72:87], v[32:35], v[240:243], v[72:87]
    v_mfma_f32_32x32x16_bf16 v[88:103], v[32:35], v[244:247], v[88:103]
    ds_read_b128 v[28:31], v6 offset:5120
    s_waitcnt lgkmcnt(6)
    v_mfma_f32_32x32x16_bf16 v[72:87], v[36:39], v[248:251], v[72:87]
    v_mfma_f32_32x32x16_bf16 v[88:103], v[36:39], v[252:255], v[88:103]
    v_mov_b32 v2, v6
    s_mov_b32 s16, s21
    s_add_u32 s14, s14, 1
    s_cmp_ge_u32 s14, s15
    s_cbranch_scc1 layerb1_kernel_gu_fin1
    ds_read_b128 v[32:35], v2 offset:6144
    s_waitcnt lgkmcnt(6)
    v_mfma_f32_32x32x16_bf16 v[40:55], v[8:11], a[0:3], 0
    v_mfma_f32_32x32x16_bf16 v[56:71], v[8:11], a[4:7], 0
    ds_read_b128 v[36:39], v2 offset:7168
    s_waitcnt lgkmcnt(6)
    v_mfma_f32_32x32x16_bf16 v[40:55], v[12:15], a[8:11], v[40:55]
    v_mfma_f32_32x32x16_bf16 v[56:71], v[12:15], a[12:15], v[56:71]
    ds_read_b128 v[8:11], v2 offset:8192
    s_waitcnt lgkmcnt(6)
    v_mfma_f32_32x32x16_bf16 v[40:55], v[16:19], a[16:19], v[40:55]
    v_cvt_pk_bf16_f32 v104, v72, v73
    v_mfma_f32_32x32x16_bf16 v[56:71], v[16:19], a[20:23], v[56:71]
    v_cvt_pk_bf16_f32 v105, v74, v75
    ds_read_b128 v[12:15], v2 offset:9216
    s_waitcnt lgkmcnt(6)
    v_mfma_f32_32x32x16_bf16 v[40:55], v[20:23], a[24:27], v[40:55]
    v_cvt_pk_bf16_f32 v106, v76, v77
    v_mfma_f32_32x32x16_bf16 v[56:71], v[20:23], a[28:31], v[56:71]
    v_cvt_pk_bf16_f32 v107, v78, v79
    ds_read_b128 v[16:19], v2 offset:10240
    s_waitcnt lgkmcnt(6)
    v_mfma_f32_32x32x16_bf16 v[40:55], v[24:27], a[32:35], v[40:55]
    s_nop 1
    v_mfma_f32_32x32x16_bf16 v[56:71], v[24:27], a[36:39], v[56:71]
    v_permlane32_swap_b32 v104, v106
    ds_read_b128 v[20:23], v2 offset:11264
    s_waitcnt lgkmcnt(6)
    v_mfma_f32_32x32x16_bf16 v[40:55], v[28:31], a[40:43], v[40:55]
    v_permlane32_swap_b32 v105, v107
    v_mfma_f32_32x32x16_bf16 v[56:71], v[28:31], a[44:47], v[56:71]
    buffer_store_dwordx4 v[104:107], v3, s[8:11], s17 offen offset:0 sc1
    ds_read_b128 v[24:27], v2 offset:12288
    s_waitcnt lgkmcnt(6)
    v_mfma_f32_32x32x16_bf16 v[40:55], v[32:35], a[48:51], v[40:55]
    v_cvt_pk_bf16_f32 v108, v80, v81
    v_mfma_f32_32x32x16_bf16 v[56:71], v[32:35], a[52:55], v[56:71]
    v_cvt_pk_bf16_f32 v109, v82, v83
    ds_read_b128 v[28:31], v2 offset:13312
    s_waitcnt lgkmcnt(6)
    v_mfma_f32_32x32x16_bf16 v[40:55], v[36:39], a[56:59], v[40:55]
    v_cvt_pk_bf16_f32 v110, v84, v85
    v_mfma_f32_32x32x16_bf16 v[56:71], v[36:39], a[60:63], v[56:71]
    v_cvt_pk_bf16_f32 v111, v86, v87
    ds_read_b128 v[32:35], v2 offset:14336
    s_waitcnt lgkmcnt(6)
    v_mfma_f32_32x32x16_bf16 v[40:55], v[8:11], a[64:67], v[40:55]
    s_nop 1
    v_mfma_f32_32x32x16_bf16 v[56:71], v[8:11], a[68:71], v[56:71]
    v_permlane32_swap_b32 v108, v110
    ds_read_b128 v[36:39], v2 offset:15360
    s_waitcnt lgkmcnt(6)
    v_mfma_f32_32x32x16_bf16 v[40:55], v[12:15], a[72:75], v[40:55]
    v_permlane32_swap_b32 v109, v111
    v_mfma_f32_32x32x16_bf16 v[56:71], v[12:15], a[76:79], v[56:71]
    buffer_store_dwordx4 v[108:111], v3, s[8:11], s17 offen offset:256 sc1
    ds_read_b128 v[8:11], v2 offset:16384
    s_waitcnt lgkmcnt(6)
    v_mfma_f32_32x32x16_bf16 v[40:55], v[16:19], a[80:83], v[40:55]
    v_cvt_pk_bf16_f32 v112, v88, v89
    v_mfma_f32_32x32x16_bf16 v[56:71], v[16:19], a[84:87], v[56:71]
    v_cvt_pk_bf16_f32 v113, v90, v91
    ds_read_b128 v[12:15], v2 offset:17408
    s_waitcnt lgkmcnt(6)
    v_mfma_f32_32x32x16_bf16 v[40:55], v[20:23], a[88:91], v[40:55]
    v_cvt_pk_bf16_f32 v114, v92, v93
    v_mfma_f32_32x32x16_bf16 v[56:71], v[20:23], a[92:95], v[56:71]
    v_cvt_pk_bf16_f32 v115, v94, v95
    ds_read_b128 v[16:19], v2 offset:18432
    s_waitcnt lgkmcnt(6)
    v_mfma_f32_32x32x16_bf16 v[40:55], v[24:27], a[96:99], v[40:55]
    s_nop 1
    v_mfma_f32_32x32x16_bf16 v[56:71], v[24:27], a[100:103], v[56:71]
    v_permlane32_swap_b32 v112, v114
    ds_read_b128 v[20:23], v2 offset:19456
    s_waitcnt lgkmcnt(6)
    v_mfma_f32_32x32x16_bf16 v[40:55], v[28:31], a[104:107], v[40:55]
    v_permlane32_swap_b32 v113, v115
    v_mfma_f32_32x32x16_bf16 v[56:71], v[28:31], a[108:111], v[56:71]
    buffer_store_dwordx4 v[112:115], v3, s[8:11], s17 offen offset:2560 sc1
    ds_read_b128 v[24:27], v2 offset:20480
    s_waitcnt lgkmcnt(6)
    v_mfma_f32_32x32x16_bf16 v[40:55], v[32:35], a[112:115], v[40:55]
    v_cvt_pk_bf16_f32 v116, v96, v97
    v_mfma_f32_32x32x16_bf16 v[56:71], v[32:35], a[116:119], v[56:71]
    v_cvt_pk_bf16_f32 v117, v98, v99
    ds_read_b128 v[28:31], v2 offset:21504
    s_waitcnt lgkmcnt(6)
    v_mfma_f32_32x32x16_bf16 v[40:55], v[36:39], a[120:123], v[40:55]
    v_cvt_pk_bf16_f32 v118, v100, v101
    v_mfma_f32_32x32x16_bf16 v[56:71], v[36:39], a[124:127], v[56:71]
    v_cvt_pk_bf16_f32 v119, v102, v103
    ds_read_b128 v[32:35], v2 offset:22528
    s_waitcnt lgkmcnt(6)
    v_mfma_f32_32x32x16_bf16 v[40:55], v[8:11], a[128:131], v[40:55]
    s_nop 1
    v_mfma_f32_32x32x16_bf16 v[56:71], v[8:11], a[132:135], v[56:71]
    v_permlane32_swap_b32 v116, v118
    ds_read_b128 v[36:39], v2 offset:23552
    s_waitcnt lgkmcnt(6)
    v_mfma_f32_32x32x16_bf16 v[40:55], v[12:15], a[136:139], v[40:55]
    v_permlane32_swap_b32 v117, v119
    v_mfma_f32_32x32x16_bf16 v[56:71], v[12:15], a[140:143], v[56:71]
    buffer_store_dwordx4 v[116:119], v3, s[8:11], s17 offen offset:2816 sc1
    ds_read_b128 v[8:11], v2 offset:24576
    s_waitcnt lgkmcnt(6)
    v_mfma_f32_32x32x16_bf16 v[40:55], v[16:19], a[144:147], v[40:55]
    s_add_u32 s17, s17, s20
    v_mfma_f32_32x32x16_bf16 v[56:71], v[16:19], a[148:151], v[56:71]
    s_add_u32 s18, s18, s20
    ds_read_b128 v[12:15], v2 offset:25600
    s_waitcnt lgkmcnt(6)
    v_mfma_f32_32x32x16_bf16 v[40:55], v[20:23], a[152:155], v[40:55]
    v_mfma_f32_32x32x16_bf16 v[56:71], v[20:23], a[156:159], v[56:71]
    ds_read_b128 v[16:19], v2 offset:26624
    s_waitcnt lgkmcnt(6)
    v_mfma_f32_32x32x16_bf16 v[40:55], v[24:27], a[160:163], v[40:55]
    v_mfma_f32_32x32x16_bf16 v[56:71], v[24:27], a[164:167], v[56:71]
    ds_read_b128 v[20:23], v2 offset:27648
    s_waitcnt lgkmcnt(6)
    v_mfma_f32_32x32x16_bf16 v[40:55], v[28:31], a[168:171], v[40:55]
    v_mfma_f32_32x32x16_bf16 v[56:71], v[28:31], a[172:175], v[56:71]
    ds_read_b128 v[24:27], v2 offset:28672
    s_waitcnt lgkmcnt(6)
    v_mfma_f32_32x32x16_bf16 v[40:55], v[32:35], a[176:179], v[40:55]
    v_mfma_f32_32x32x16_bf16 v[56:71], v[32:35], a[180:183], v[56:71]
    ds_read_b128 v[28:31], v2 offset:29696
    s_waitcnt lgkmcnt(6)
    v_mfma_f32_32x32x16_bf16 v[40:55], v[36:39], a[184:187], v[40:55]
    v_mfma_f32_32x32x16_bf16 v[56:71], v[36:39], a[188:191], v[56:71]
    ds_read_b128 v[32:35], v2 offset:30720
    s_waitcnt lgkmcnt(6)
    v_mfma_f32_32x32x16_bf16 v[40:55], v[8:11], a[192:195], v[40:55]
    v_mfma_f32_32x32x16_bf16 v[56:71], v[8:11], a[196:199], v[56:71]
    ds_read_b128 v[36:39], v2 offset:31744
    s_waitcnt lgkmcnt(6)
    v_mfma_f32_32x32x16_bf16 v[40:55], v[12:15], a[200:203], v[40:55]
    v_mfma_f32_32x32x16_bf16 v[56:71], v[12:15], a[204:207], v[56:71]
    ds_read_b128 v[8:11], v2 offset:32768
    s_waitcnt lgkmcnt(6)
    v_mfma_f32_32x32x16_bf16 v[40:55], v[16:19], a[208:211], v[40:55]
    v_mfma_f32_32x32x16_bf16 v[56:71], v[16:19], a[212:215], v[56:71]
    ds_read_b128 v[12:15], v2 offset:33792
    s_waitcnt lgkmcnt(6)
    v_mfma_f32_32x32x16_bf16 v[40:55], v[20:23], a[216:219], v[40:55]
    v_mfma_f32_32x32x16_bf16 v[56:71], v[20:23], a[220:223], v[56:71]
    ds_read_b128 v[16:19], v2 offset:34816
    s_waitcnt lgkmcnt(6)
    v_mfma_f32_32x32x16_bf16 v[40:55], v[24:27], a[224:227], v[40:55]
    v_mfma_f32_32x32x16_bf16 v[56:71], v[24:27], a[228:231], v[56:71]
    s_cmp_gt_u32 s14, 2
    s_cbranch_scc1 layerb1_kernel_gu_dr3
    s_waitcnt vmcnt(0)
    s_mov_b32 s27, s14
    s_branch layerb1_kernel_gu_dq3
layerb1_kernel_gu_dr3:
    s_waitcnt vmcnt(4)
    s_sub_u32 s27, s14, 1
layerb1_kernel_gu_dq3:
    s_barrier
    s_cmp_lg_u32 s13, 0
    s_cbranch_scc1 layerb1_kernel_gu_fl4
    s_mov_b64 exec, 1
    s_lshl_b32 s26, s12, 7
    v_mov_b32 v7, s26
    v_mov_b32 v120, s27
    buffer_store_dword v120, v7, s[8:11], s48 offen sc1
    s_mov_b64 exec, -1
layerb1_kernel_gu_fl4:
    s_add_u32 s21, s16, 40960
    s_cmp_eq_u32 s21, 122880
    s_cselect_b32 s21, 0, s21
    s_add_u32 s23, s14, 2
    s_min_u32 s24, s23, 63
    s_mul_i32 s24, s24, 40960
    s_add_u32 s24, s24, s19
    s_mul_i32 s25, s13, 10240
    s_add_u32 s25, s25, s22
    s_mov_b32 m0, s25
    s_nop 0
    buffer_load_dwordx4 v1, s[8:11], s24 offen offset:0 lds
    buffer_load_dwordx4 v1, s[8:11], s24 offen offset:1024 lds
    buffer_load_dwordx4 v1, s[8:11], s24 offen offset:2048 lds
    buffer_load_dwordx4 v1, s[8:11], s24 offen offset:3072 lds
    s_add_u32 s24, s24, 4096
    s_add_u32 s25, s25, 4096
    s_mov_b32 m0, s25
    s_nop 0
    buffer_load_dwordx4 v1, s[8:11], s24 offen offset:0 lds
    buffer_load_dwordx4 v1, s[8:11], s24 offen offset:1024 lds
    buffer_load_dwordx4 v1, s[8:11], s24 offen offset:2048 lds
    buffer_load_dwordx4 v1, s[8:11], s24 offen offset:3072 lds
    s_add_u32 s24, s24, 4096
    s_add_u32 s25, s25, 4096
    s_mov_b32 m0, s25
    s_nop 0
    buffer_load_dwordx4 v1, s[8:11], s24 offen offset:0 lds
    buffer_load_dwordx4 v1, s[8:11], s24 offen offset:1024 lds
    s_add_u32 s22, s22, 40960
    s_cmp_eq_u32 s22, 122880
    s_cselect_b32 s22, 0, s22
    ds_read_b128 v[20:23], v2 offset:35840
    s_waitcnt lgkmcnt(6)
    v_mfma_f32_32x32x16_bf16 v[40:55], v[28:31], a[232:235], v[40:55]
    v_mfma_f32_32x32x16_bf16 v[56:71], v[28:31], a[236:239], v[56:71]
    ds_read_b128 v[24:27], v2 offset:36864
    s_waitcnt lgkmcnt(6)
    v_mfma_f32_32x32x16_bf16 v[40:55], v[32:35], a[240:243], v[40:55]
    v_mfma_f32_32x32x16_bf16 v[56:71], v[32:35], a[244:247], v[56:71]
    ds_read_b128 v[28:31], v2 offset:37888
    s_waitcnt lgkmcnt(6)
    v_mfma_f32_32x32x16_bf16 v[40:55], v[36:39], a[248:251], v[40:55]
    v_mfma_f32_32x32x16_bf16 v[56:71], v[36:39], a[252:255], v[56:71]
    ds_read_b128 v[32:35], v2 offset:38912
    s_waitcnt lgkmcnt(6)
    v_mfma_f32_32x32x16_bf16 v[40:55], v[8:11], v[192:195], v[40:55]
    v_mfma_f32_32x32x16_bf16 v[56:71], v[8:11], v[196:199], v[56:71]
    ds_read_b128 v[36:39], v2 offset:39936
    s_waitcnt lgkmcnt(6)
    v_mfma_f32_32x32x16_bf16 v[40:55], v[12:15], v[200:203], v[40:55]
    v_mfma_f32_32x32x16_bf16 v[56:71], v[12:15], v[204:207], v[56:71]
    v_add_u32 v6, s21, v1
    ds_read_b128 v[8:11], v6 offset:0
    s_waitcnt lgkmcnt(6)
    v_mfma_f32_32x32x16_bf16 v[40:55], v[16:19], v[208:211], v[40:55]
    v_mfma_f32_32x32x16_bf16 v[56:71], v[16:19], v[212:215], v[56:71]
    ds_read_b128 v[12:15], v6 offset:1024
    s_waitcnt lgkmcnt(6)
    v_mfma_f32_32x32x16_bf16 v[40:55], v[20:23], v[216:219], v[40:55]
    v_mfma_f32_32x32x16_bf16 v[56:71], v[20:23], v[220:223], v[56:71]
    ds_read_b128 v[16:19], v6 offset:2048
    s_waitcnt lgkmcnt(6)
    v_mfma_f32_32x32x16_bf16 v[40:55], v[24:27], v[224:227], v[40:55]
    v_mfma_f32_32x32x16_bf16 v[56:71], v[24:27], v[228:231], v[56:71]
    ds_read_b128 v[20:23], v6 offset:3072
    s_waitcnt lgkmcnt(6)
    v_mfma_f32_32x32x16_bf16 v[40:55], v[28:31], v[232:235], v[40:55]
    v_mfma_f32_32x32x16_bf16 v[56:71], v[28:31], v[236:239], v[56:71]
    ds_read_b128 v[24:27], v6 offset:4096
    s_waitcnt lgkmcnt(6)
    v_mfma_f32_32x32x16_bf16 v[40:55], v[32:35], v[240:243], v[40:55]
    v_mfma_f32_32x32x16_bf16 v[56:71], v[32:35], v[244:247], v[56:71]
    ds_read_b128 v[28:31], v6 offset:5120
    s_waitcnt lgkmcnt(6)
    v_mfma_f32_32x32x16_bf16 v[40:55], v[36:39], v[248:251], v[40:55]
    v_mfma_f32_32x32x16_bf16 v[56:71], v[36:39], v[252:255], v[56:71]
    v_mov_b32 v2, v6
    s_mov_b32 s16, s21
    s_add_u32 s14, s14, 1
    s_cmp_lt_u32 s14, s15
    s_cbranch_scc1 layerb1_kernel_gu_loop
layerb1_kernel_gu_fin0:
    s_nop 7
    s_nop 7
    v_cvt_pk_bf16_f32 v104, v40, v41
    v_cvt_pk_bf16_f32 v105, v42, v43
    v_cvt_pk_bf16_f32 v106, v44, v45
    v_cvt_pk_bf16_f32 v107, v46, v47
    s_nop 1
    v_permlane32_swap_b32 v104, v106
    v_permlane32_swap_b32 v105, v107
    buffer_store_dwordx4 v[104:107], v3, s[8:11], s17 offen offset:0 sc1
    v_cvt_pk_bf16_f32 v108, v48, v49
    v_cvt_pk_bf16_f32 v109, v50, v51
    v_cvt_pk_bf16_f32 v110, v52, v53
    v_cvt_pk_bf16_f32 v111, v54, v55
    s_nop 1
    v_permlane32_swap_b32 v108, v110
    v_permlane32_swap_b32 v109, v111
    buffer_store_dwordx4 v[108:111], v3, s[8:11], s17 offen offset:256 sc1
    v_cvt_pk_bf16_f32 v112, v56, v57
    v_cvt_pk_bf16_f32 v113, v58, v59
    v_cvt_pk_bf16_f32 v114, v60, v61
    v_cvt_pk_bf16_f32 v115, v62, v63
    s_nop 1
    v_permlane32_swap_b32 v112, v114
    v_permlane32_swap_b32 v113, v115
    buffer_store_dwordx4 v[112:115], v3, s[8:11], s17 offen offset:2560 sc1
    v_cvt_pk_bf16_f32 v116, v64, v65
    v_cvt_pk_bf16_f32 v117, v66, v67
    v_cvt_pk_bf16_f32 v118, v68, v69
    v_cvt_pk_bf16_f32 v119, v70, v71
    s_nop 1
    v_permlane32_swap_b32 v116, v118
    v_permlane32_swap_b32 v117, v119
    buffer_store_dwordx4 v[116:119], v3, s[8:11], s17 offen offset:2816 sc1
    s_add_u32 s17, s17, s20
    s_add_u32 s18, s18, s20
    s_branch layerb1_kernel_gu_done
layerb1_kernel_gu_fin1:
    s_nop 7
    s_nop 7
    v_cvt_pk_bf16_f32 v104, v72, v73
    v_cvt_pk_bf16_f32 v105, v74, v75
    v_cvt_pk_bf16_f32 v106, v76, v77
    v_cvt_pk_bf16_f32 v107, v78, v79
    s_nop 1
    v_permlane32_swap_b32 v104, v106
    v_permlane32_swap_b32 v105, v107
    buffer_store_dwordx4 v[104:107], v3, s[8:11], s17 offen offset:0 sc1
    v_cvt_pk_bf16_f32 v108, v80, v81
    v_cvt_pk_bf16_f32 v109, v82, v83
    v_cvt_pk_bf16_f32 v110, v84, v85
    v_cvt_pk_bf16_f32 v111, v86, v87
    s_nop 1
    v_permlane32_swap_b32 v108, v110
    v_permlane32_swap_b32 v109, v111
    buffer_store_dwordx4 v[108:111], v3, s[8:11], s17 offen offset:256 sc1
    v_cvt_pk_bf16_f32 v112, v88, v89
    v_cvt_pk_bf16_f32 v113, v90, v91
    v_cvt_pk_bf16_f32 v114, v92, v93
    v_cvt_pk_bf16_f32 v115, v94, v95
    s_nop 1
    v_permlane32_swap_b32 v112, v114
    v_permlane32_swap_b32 v113, v115
    buffer_store_dwordx4 v[112:115], v3, s[8:11], s17 offen offset:2560 sc1
    v_cvt_pk_bf16_f32 v116, v96, v97
    v_cvt_pk_bf16_f32 v117, v98, v99
    v_cvt_pk_bf16_f32 v118, v100, v101
    v_cvt_pk_bf16_f32 v119, v102, v103
    s_nop 1
    v_permlane32_swap_b32 v116, v118
    v_permlane32_swap_b32 v117, v119
    buffer_store_dwordx4 v[116:119], v3, s[8:11], s17 offen offset:2816 sc1
    s_add_u32 s17, s17, s20
    s_add_u32 s18, s18, s20
layerb1_kernel_gu_done:
    s_waitcnt vmcnt(0) lgkmcnt(0)
    s_barrier
    s_cmp_lg_u32 s13, 0
    s_cbranch_scc1 layerb1_kernel_gu_fl5
    s_mov_b64 exec, 1
    s_lshl_b32 s26, s12, 7
    v_mov_b32 v7, s26
    v_mov_b32 v120, s14
    buffer_store_dword v120, v7, s[8:11], s48 offen sc1
    s_mov_b64 exec, -1
layerb1_kernel_gu_fl5:
    s_branch layerb1_kernel_g_done
layerb1_kernel_g_qk:
    s_sub_u32 s26, s12, 80
    s_cmp_ge_u32 s26, 24
    s_cselect_b32 s27, 1, 0
    s_cselect_b32 s28, 24, 0
    s_sub_u32 s26, s26, s28
    s_lshl_b32 s26, s26, 3
    s_lshl_b32 s28, s13, 1
    s_add_u32 s26, s26, s28
    s_add_u32 s28, s26, 0
    s_mul_i32 s29, s28, 171
    s_lshr_b32 s29, s29, 10
    s_mul_i32 s30, s29, 6
    s_sub_u32 s30, s28, s30
    s_mul_i32 s31, s29, 12288
    s_lshl_b32 s32, s30, 11
    s_add_u32 s31, s31, s32
    s_mul_i32 s32, s14, 393216
    s_add_u32 s31, s31, s32
    s_mul_i32 s32, s27, 25165824
    s_add_u32 s31, s31, s32
    s_add_u32 s17, s31, 53477376
    s_lshl_b32 s30, s30, 5
    v_add_u32 v10, s30, v8
    v_and_b32 v11, 0xc1, v10
    v_and_b32 v12, 8, v10
    v_lshl_or_b32 v11, v12, 2, v11
    v_and_b32 v12, 32, v10
    v_lshrrev_b32 v12, 1, v12
    v_or_b32 v11, v11, v12
    v_and_b32 v12, 2, v10
    v_lshl_or_b32 v11, v12, 2, v11
    v_and_b32 v12, 16, v10
    v_lshrrev_b32 v12, 2, v12
    v_or_b32 v11, v11, v12
    v_and_b32 v12, 4, v10
    v_lshrrev_b32 v12, 1, v12
    v_or_b32 v11, v11, v12
    s_cmp_eq_u32 s27, 1
    s_cselect_b64 vcc, -1, 0
    s_nop 1
    v_cndmask_b32 v10, v10, v11, vcc
    v_lshrrev_b32 v12, 4, v10
    v_mul_u32_u24 v13, 11, v12
    v_lshrrev_b32 v13, 5, v13
    v_mul_u32_u24 v13, 3, v13
    v_add_u32 v12, v12, v13
    v_mul_u32_u24 v12, 20480, v12
    v_and_b32 v13, 15, v10
    v_lshl_add_u32 v11, v13, 4, v12
    v_lshl_add_u32 v4, v9, 8, v11
    s_xor_b32 s30, s27, 1
    s_mul_i32 s30, s30, 61440
    s_mul_i32 s31, s29, 491520
    s_add_u32 s30, s30, s31
    s_add_u32 s34, s30, 11534336
    s_add_u32 s28, s26, 1
    s_mul_i32 s29, s28, 171
    s_lshr_b32 s29, s29, 10
    s_mul_i32 s30, s29, 6
    s_sub_u32 s30, s28, s30
    s_mul_i32 s31, s29, 12288
    s_lshl_b32 s32, s30, 11
    s_add_u32 s31, s31, s32
    s_mul_i32 s32, s14, 393216
    s_add_u32 s31, s31, s32
    s_mul_i32 s32, s27, 25165824
    s_add_u32 s31, s31, s32
    s_add_u32 s18, s31, 53477376
    s_lshl_b32 s30, s30, 5
    v_add_u32 v10, s30, v8
    v_and_b32 v11, 0xc1, v10
    v_and_b32 v12, 8, v10
    v_lshl_or_b32 v11, v12, 2, v11
    v_and_b32 v12, 32, v10
    v_lshrrev_b32 v12, 1, v12
    v_or_b32 v11, v11, v12
    v_and_b32 v12, 2, v10
    v_lshl_or_b32 v11, v12, 2, v11
    v_and_b32 v12, 16, v10
    v_lshrrev_b32 v12, 2, v12
    v_or_b32 v11, v11, v12
    v_and_b32 v12, 4, v10
    v_lshrrev_b32 v12, 1, v12
    v_or_b32 v11, v11, v12
    s_cmp_eq_u32 s27, 1
    s_cselect_b64 vcc, -1, 0
    s_nop 1
    v_cndmask_b32 v10, v10, v11, vcc
    v_lshrrev_b32 v12, 4, v10
    v_mul_u32_u24 v13, 11, v12
    v_lshrrev_b32 v13, 5, v13
    v_mul_u32_u24 v13, 3, v13
    v_add_u32 v12, v12, v13
    v_mul_u32_u24 v12, 20480, v12
    v_and_b32 v13, 15, v10
    v_lshl_add_u32 v11, v13, 4, v12
    v_lshl_add_u32 v5, v9, 8, v11
    s_xor_b32 s30, s27, 1
    s_mul_i32 s30, s30, 61440
    s_mul_i32 s31, s29, 491520
    s_add_u32 s30, s30, s31
    s_add_u32 s35, s30, 11534336
    buffer_load_dwordx4 a[0:3], v4, s[8:11], s34 offen offset:0
    buffer_load_dwordx4 a[4:7], v5, s[8:11], s35 offen offset:0
    buffer_load_dwordx4 a[8:11], v4, s[8:11], s34 offen offset:512
    buffer_load_dwordx4 a[12:15], v5, s[8:11], s35 offen offset:512
    buffer_load_dwordx4 a[16:19], v4, s[8:11], s34 offen offset:1024
    buffer_load_dwordx4 a[20:23], v5, s[8:11], s35 offen offset:1024
    buffer_load_dwordx4 a[24:27], v4, s[8:11], s34 offen offset:1536
    buffer_load_dwordx4 a[28:31], v5, s[8:11], s35 offen offset:1536
    buffer_load_dwordx4 a[32:35], v4, s[8:11], s34 offen offset:2048
    buffer_load_dwordx4 a[36:39], v5, s[8:11], s35 offen offset:2048
    buffer_load_dwordx4 a[40:43], v4, s[8:11], s34 offen offset:2560
    buffer_load_dwordx4 a[44:47], v5, s[8:11], s35 offen offset:2560
    buffer_load_dwordx4 a[48:51], v4, s[8:11], s34 offen offset:3072
    buffer_load_dwordx4 a[52:55], v5, s[8:11], s35 offen offset:3072
    buffer_load_dwordx4 a[56:59], v4, s[8:11], s34 offen offset:3584
    buffer_load_dwordx4 a[60:63], v5, s[8:11], s35 offen offset:3584
    s_add_u32 s34, s34, 4096
    s_add_u32 s35, s35, 4096
    buffer_load_dwordx4 a[64:67], v4, s[8:11], s34 offen offset:0
    buffer_load_dwordx4 a[68:71], v5, s[8:11], s35 offen offset:0
    buffer_load_dwordx4 a[72:75], v4, s[8:11], s34 offen offset:512
    buffer_load_dwordx4 a[76:79], v5, s[8:11], s35 offen offset:512
    buffer_load_dwordx4 a[80:83], v4, s[8:11], s34 offen offset:1024
    buffer_load_dwordx4 a[84:87], v5, s[8:11], s35 offen offset:1024
    buffer_load_dwordx4 a[88:91], v4, s[8:11], s34 offen offset:1536
    buffer_load_dwordx4 a[92:95], v5, s[8:11], s35 offen offset:1536
    buffer_load_dwordx4 a[96:99], v4, s[8:11], s34 offen offset:2048
    buffer_load_dwordx4 a[100:103], v5, s[8:11], s35 offen offset:2048
    buffer_load_dwordx4 a[104:107], v4, s[8:11], s34 offen offset:2560
    buffer_load_dwordx4 a[108:111], v5, s[8:11], s35 offen offset:2560
    buffer_load_dwordx4 a[112:115], v4, s[8:11], s34 offen offset:3072
    buffer_load_dwordx4 a[116:119], v5, s[8:11], s35 offen offset:3072
    buffer_load_dwordx4 a[120:123], v4, s[8:11], s34 offen offset:3584
    buffer_load_dwordx4 a[124:127], v5, s[8:11], s35 offen offset:3584
    s_add_u32 s34, s34, 4096
    s_add_u32 s35, s35, 4096
    buffer_load_dwordx4 a[128:131], v4, s[8:11], s34 offen offset:0
    buffer_load_dwordx4 a[132:135], v5, s[8:11], s35 offen offset:0
    buffer_load_dwordx4 a[136:139], v4, s[8:11], s34 offen offset:512
    buffer_load_dwordx4 a[140:143], v5, s[8:11], s35 offen offset:512
    buffer_load_dwordx4 a[144:147], v4, s[8:11], s34 offen offset:1024
    buffer_load_dwordx4 a[148:151], v5, s[8:11], s35 offen offset:1024
    buffer_load_dwordx4 a[152:155], v4, s[8:11], s34 offen offset:1536
    buffer_load_dwordx4 a[156:159], v5, s[8:11], s35 offen offset:1536
    buffer_load_dwordx4 a[160:163], v4, s[8:11], s34 offen offset:2048
    buffer_load_dwordx4 a[164:167], v5, s[8:11], s35 offen offset:2048
    buffer_load_dwordx4 a[168:171], v4, s[8:11], s34 offen offset:2560
    buffer_load_dwordx4 a[172:175], v5, s[8:11], s35 offen offset:2560
    buffer_load_dwordx4 a[176:179], v4, s[8:11], s34 offen offset:3072
    buffer_load_dwordx4 a[180:183], v5, s[8:11], s35 offen offset:3072
    buffer_load_dwordx4 a[184:187], v4, s[8:11], s34 offen offset:3584
    buffer_load_dwordx4 a[188:191], v5, s[8:11], s35 offen offset:3584
    s_add_u32 s34, s34, 4096
    s_add_u32 s35, s35, 4096
    buffer_load_dwordx4 a[192:195], v4, s[8:11], s34 offen offset:0
    buffer_load_dwordx4 a[196:199], v5, s[8:11], s35 offen offset:0
    buffer_load_dwordx4 a[200:203], v4, s[8:11], s34 offen offset:512
    buffer_load_dwordx4 a[204:207], v5, s[8:11], s35 offen offset:512
    buffer_load_dwordx4 a[208:211], v4, s[8:11], s34 offen offset:1024
    buffer_load_dwordx4 a[212:215], v5, s[8:11], s35 offen offset:1024
    buffer_load_dwordx4 a[216:219], v4, s[8:11], s34 offen offset:1536
    buffer_load_dwordx4 a[220:223], v5, s[8:11], s35 offen offset:1536
    buffer_load_dwordx4 a[224:227], v4, s[8:11], s34 offen offset:2048
    buffer_load_dwordx4 a[228:231], v5, s[8:11], s35 offen offset:2048
    buffer_load_dwordx4 a[232:235], v4, s[8:11], s34 offen offset:2560
    buffer_load_dwordx4 a[236:239], v5, s[8:11], s35 offen offset:2560
    buffer_load_dwordx4 a[240:243], v4, s[8:11], s34 offen offset:3072
    buffer_load_dwordx4 a[244:247], v5, s[8:11], s35 offen offset:3072
    buffer_load_dwordx4 a[248:251], v4, s[8:11], s34 offen offset:3584
    buffer_load_dwordx4 a[252:255], v5, s[8:11], s35 offen offset:3584
    s_add_u32 s34, s34, 4096
    s_add_u32 s35, s35, 4096
    buffer_load_dwordx4 v[192:195], v4, s[8:11], s34 offen offset:0
    buffer_load_dwordx4 v[196:199], v5, s[8:11], s35 offen offset:0
    buffer_load_dwordx4 v[200:203], v4, s[8:11], s34 offen offset:512
    buffer_load_dwordx4 v[204:207], v5, s[8:11], s35 offen offset:512
    buffer_load_dwordx4 v[208:211], v4, s[8:11], s34 offen offset:1024
    buffer_load_dwordx4 v[212:215], v5, s[8:11], s35 offen offset:1024
    buffer_load_dwordx4 v[216:219], v4, s[8:11], s34 offen offset:1536
    buffer_load_dwordx4 v[220:223], v5, s[8:11], s35 offen offset:1536
    buffer_load_dwordx4 v[224:227], v4, s[8:11], s34 offen offset:2048
    buffer_load_dwordx4 v[228:231], v5, s[8:11], s35 offen offset:2048
    buffer_load_dwordx4 v[232:235], v4, s[8:11], s34 offen offset:2560
    buffer_load_dwordx4 v[236:239], v5, s[8:11], s35 offen offset:2560
    buffer_load_dwordx4 v[240:243], v4, s[8:11], s34 offen offset:3072
    buffer_load_dwordx4 v[244:247], v5, s[8:11], s35 offen offset:3072
    buffer_load_dwordx4 v[248:251], v4, s[8:11], s34 offen offset:3584
    buffer_load_dwordx4 v[252:255], v5, s[8:11], s35 offen offset:3584
    v_mov_b32 v3, v1
    s_mov_b32 s20, 393216
    s_mul_i32 s19, s13, 10240
    s_add_u32 s19, s19, 220200960
    s_mov_b32 s22, 0
    s_min_u32 s24, s14, 63
    s_mul_i32 s24, s24, 40960
    s_add_u32 s24, s24, s19
    s_mul_i32 s25, s13, 10240
    s_add_u32 s25, s25, s22
    s_mov_b32 m0, s25
    s_nop 0
    buffer_load_dwordx4 v1, s[8:11], s24 offen offset:0 lds
    buffer_load_dwordx4 v1, s[8:11], s24 offen offset:1024 lds
    buffer_load_dwordx4 v1, s[8:11], s24 offen offset:2048 lds
    buffer_load_dwordx4 v1, s[8:11], s24 offen offset:3072 lds
    s_add_u32 s24, s24, 4096
    s_add_u32 s25, s25, 4096
    s_mov_b32 m0, s25
    s_nop 0
    buffer_load_dwordx4 v1, s[8:11], s24 offen offset:0 lds
    buffer_load_dwordx4 v1, s[8:11], s24 offen offset:1024 lds
    buffer_load_dwordx4 v1, s[8:11], s24 offen offset:2048 lds
    buffer_load_dwordx4 v1, s[8:11], s24 offen offset:3072 lds
    s_add_u32 s24, s24, 4096
    s_add_u32 s25, s25, 4096
    s_mov_b32 m0, s25
    s_nop 0
    buffer_load_dwordx4 v1, s[8:11], s24 offen offset:0 lds
    buffer_load_dwordx4 v1, s[8:11], s24 offen offset:1024 lds
    s_mov_b32 s22, 40960
    s_add_u32 s23, s14, 1
    s_min_u32 s24, s23, 63
    s_mul_i32 s24, s24, 40960
    s_add_u32 s24, s24, s19
    s_mul_i32 s25, s13, 10240
    s_add_u32 s25, s25, s22
    s_mov_b32 m0, s25
    s_nop 0
    buffer_load_dwordx4 v1, s[8:11], s24 offen offset:0 lds
    buffer_load_dwordx4 v1, s[8:11], s24 offen offset:1024 lds
    buffer_load_dwordx4 v1, s[8:11], s24 offen offset:2048 lds
    buffer_load_dwordx4 v1, s[8:11], s24 offen offset:3072 lds
    s_add_u32 s24, s24, 4096
    s_add_u32 s25, s25, 4096
    s_mov_b32 m0, s25
    s_nop 0
    buffer_load_dwordx4 v1, s[8:11], s24 offen offset:0 lds
    buffer_load_dwordx4 v1, s[8:11], s24 offen offset:1024 lds
    buffer_load_dwordx4 v1, s[8:11], s24 offen offset:2048 lds
    buffer_load_dwordx4 v1, s[8:11], s24 offen offset:3072 lds
    s_add_u32 s24, s24, 4096
    s_add_u32 s25, s25, 4096
    s_mov_b32 m0, s25
    s_nop 0
    buffer_load_dwordx4 v1, s[8:11], s24 offen offset:0 lds
    buffer_load_dwordx4 v1, s[8:11], s24 offen offset:1024 lds
    s_mov_b32 s22, 81920
    s_mov_b32 s16, 0
    s_waitcnt vmcnt(10)
    s_barrier
    v_mov_b32 v2, v1
    ds_read_b128 v[8:11], v2 offset:0
    ds_read_b128 v[12:15], v2 offset:1024
    ds_read_b128 v[16:19], v2 offset:2048
    ds_read_b128 v[20:23], v2 offset:3072
    ds_read_b128 v[24:27], v2 offset:4096
    ds_read_b128 v[28:31], v2 offset:5120
    ds_read_b128 v[32:35], v2 offset:6144
    s_waitcnt lgkmcnt(6)
    v_mfma_f32_32x32x16_bf16 v[40:55], a[0:3], v[8:11], 0
    v_mfma_f32_32x32x16_bf16 v[56:71], a[4:7], v[8:11], 0
    ds_read_b128 v[36:39], v2 offset:7168
    s_waitcnt lgkmcnt(6)
    v_mfma_f32_32x32x16_bf16 v[40:55], a[8:11], v[12:15], v[40:55]
    v_mfma_f32_32x32x16_bf16 v[56:71], a[12:15], v[12:15], v[56:71]
    ds_read_b128 v[8:11], v2 offset:8192
    s_waitcnt lgkmcnt(6)
    v_mfma_f32_32x32x16_bf16 v[40:55], a[16:19], v[16:19], v[40:55]
    v_mfma_f32_32x32x16_bf16 v[56:71], a[20:23], v[16:19], v[56:71]
    ds_read_b128 v[12:15], v2 offset:9216
    s_waitcnt lgkmcnt(6)
    v_mfma_f32_32x32x16_bf16 v[40:55], a[24:27], v[20:23], v[40:55]
    v_mfma_f32_32x32x16_bf16 v[56:71], a[28:31], v[20:23], v[56:71]
    ds_read_b128 v[16:19], v2 offset:10240
    s_waitcnt lgkmcnt(6)
    v_mfma_f32_32x32x16_bf16 v[40:55], a[32:35], v[24:27], v[40:55]
    v_mfma_f32_32x32x16_bf16 v[56:71], a[36:39], v[24:27], v[56:71]
    ds_read_b128 v[20:23], v2 offset:11264
    s_waitcnt lgkmcnt(6)
    v_mfma_f32_32x32x16_bf16 v[40:55], a[40:43], v[28:31], v[40:55]
    v_mfma_f32_32x32x16_bf16 v[56:71], a[44:47], v[28:31], v[56:71]
    ds_read_b128 v[24:27], v2 offset:12288
    s_waitcnt lgkmcnt(6)
    v_mfma_f32_32x32x16_bf16 v[40:55], a[48:51], v[32:35], v[40:55]
    v_mfma_f32_32x32x16_bf16 v[56:71], a[52:55], v[32:35], v[56:71]
    ds_read_b128 v[28:31], v2 offset:13312
    s_waitcnt lgkmcnt(6)
    v_mfma_f32_32x32x16_bf16 v[40:55], a[56:59], v[36:39], v[40:55]
    v_mfma_f32_32x32x16_bf16 v[56:71], a[60:63], v[36:39], v[56:71]
    ds_read_b128 v[32:35], v2 offset:14336
    s_waitcnt lgkmcnt(6)
    v_mfma_f32_32x32x16_bf16 v[40:55], a[64:67], v[8:11], v[40:55]
    v_mfma_f32_32x32x16_bf16 v[56:71], a[68:71], v[8:11], v[56:71]
    ds_read_b128 v[36:39], v2 offset:15360
    s_waitcnt lgkmcnt(6)
    v_mfma_f32_32x32x16_bf16 v[40:55], a[72:75], v[12:15], v[40:55]
    v_mfma_f32_32x32x16_bf16 v[56:71], a[76:79], v[12:15], v[56:71]
    ds_read_b128 v[8:11], v2 offset:16384
    s_waitcnt lgkmcnt(6)
    v_mfma_f32_32x32x16_bf16 v[40:55], a[80:83], v[16:19], v[40:55]
    v_mfma_f32_32x32x16_bf16 v[56:71], a[84:87], v[16:19], v[56:71]
    ds_read_b128 v[12:15], v2 offset:17408
    s_waitcnt lgkmcnt(6)
    v_mfma_f32_32x32x16_bf16 v[40:55], a[88:91], v[20:23], v[40:55]
    v_mfma_f32_32x32x16_bf16 v[56:71], a[92:95], v[20:23], v[56:71]
    ds_read_b128 v[16:19], v2 offset:18432
    s_waitcnt lgkmcnt(6)
    v_mfma_f32_32x32x16_bf16 v[40:55], a[96:99], v[24:27], v[40:55]
    v_mfma_f32_32x32x16_bf16 v[56:71], a[100:103], v[24:27], v[56:71]
    ds_read_b128 v[20:23], v2 offset:19456
    s_waitcnt lgkmcnt(6)
    v_mfma_f32_32x32x16_bf16 v[40:55], a[104:107], v[28:31], v[40:55]
    v_mfma_f32_32x32x16_bf16 v[56:71], a[108:111], v[28:31], v[56:71]
    ds_read_b128 v[24:27], v2 offset:20480
    s_waitcnt lgkmcnt(6)
    v_mfma_f32_32x32x16_bf16 v[40:55], a[112:115], v[32:35], v[40:55]
    v_mfma_f32_32x32x16_bf16 v[56:71], a[116:119], v[32:35], v[56:71]
    ds_read_b128 v[28:31], v2 offset:21504
    s_waitcnt lgkmcnt(6)
    v_mfma_f32_32x32x16_bf16 v[40:55], a[120:123], v[36:39], v[40:55]
    v_mfma_f32_32x32x16_bf16 v[56:71], a[124:127], v[36:39], v[56:71]
    ds_read_b128 v[32:35], v2 offset:22528
    s_waitcnt lgkmcnt(6)
    v_mfma_f32_32x32x16_bf16 v[40:55], a[128:131], v[8:11], v[40:55]
    v_mfma_f32_32x32x16_bf16 v[56:71], a[132:135], v[8:11], v[56:71]
    ds_read_b128 v[36:39], v2 offset:23552
    s_waitcnt lgkmcnt(6)
    v_mfma_f32_32x32x16_bf16 v[40:55], a[136:139], v[12:15], v[40:55]
    v_mfma_f32_32x32x16_bf16 v[56:71], a[140:143], v[12:15], v[56:71]
    ds_read_b128 v[8:11], v2 offset:24576
    s_waitcnt lgkmcnt(6)
    v_mfma_f32_32x32x16_bf16 v[40:55], a[144:147], v[16:19], v[40:55]
    v_mfma_f32_32x32x16_bf16 v[56:71], a[148:151], v[16:19], v[56:71]
    ds_read_b128 v[12:15], v2 offset:25600
    s_waitcnt lgkmcnt(6)
    v_mfma_f32_32x32x16_bf16 v[40:55], a[152:155], v[20:23], v[40:55]
    v_mfma_f32_32x32x16_bf16 v[56:71], a[156:159], v[20:23], v[56:71]
    ds_read_b128 v[16:19], v2 offset:26624
    s_waitcnt lgkmcnt(6)
    v_mfma_f32_32x32x16_bf16 v[40:55], a[160:163], v[24:27], v[40:55]
    v_mfma_f32_32x32x16_bf16 v[56:71], a[164:167], v[24:27], v[56:71]
    ds_read_b128 v[20:23], v2 offset:27648
    s_waitcnt lgkmcnt(6)
    v_mfma_f32_32x32x16_bf16 v[40:55], a[168:171], v[28:31], v[40:55]
    v_mfma_f32_32x32x16_bf16 v[56:71], a[172:175], v[28:31], v[56:71]
    ds_read_b128 v[24:27], v2 offset:28672
    s_waitcnt lgkmcnt(6)
    v_mfma_f32_32x32x16_bf16 v[40:55], a[176:179], v[32:35], v[40:55]
    v_mfma_f32_32x32x16_bf16 v[56:71], a[180:183], v[32:35], v[56:71]
    ds_read_b128 v[28:31], v2 offset:29696
    s_waitcnt lgkmcnt(6)
    v_mfma_f32_32x32x16_bf16 v[40:55], a[184:187], v[36:39], v[40:55]
    v_mfma_f32_32x32x16_bf16 v[56:71], a[188:191], v[36:39], v[56:71]
    ds_read_b128 v[32:35], v2 offset:30720
    s_waitcnt lgkmcnt(6)
    v_mfma_f32_32x32x16_bf16 v[40:55], a[192:195], v[8:11], v[40:55]
    v_mfma_f32_32x32x16_bf16 v[56:71], a[196:199], v[8:11], v[56:71]
    ds_read_b128 v[36:39], v2 offset:31744
    s_waitcnt lgkmcnt(6)
    v_mfma_f32_32x32x16_bf16 v[40:55], a[200:203], v[12:15], v[40:55]
    v_mfma_f32_32x32x16_bf16 v[56:71], a[204:207], v[12:15], v[56:71]
    ds_read_b128 v[8:11], v2 offset:32768
    s_waitcnt lgkmcnt(6)
    v_mfma_f32_32x32x16_bf16 v[40:55], a[208:211], v[16:19], v[40:55]
    v_mfma_f32_32x32x16_bf16 v[56:71], a[212:215], v[16:19], v[56:71]
    ds_read_b128 v[12:15], v2 offset:33792
    s_waitcnt lgkmcnt(6)
    v_mfma_f32_32x32x16_bf16 v[40:55], a[216:219], v[20:23], v[40:55]
    v_mfma_f32_32x32x16_bf16 v[56:71], a[220:223], v[20:23], v[56:71]
    ds_read_b128 v[16:19], v2 offset:34816
    s_waitcnt lgkmcnt(6)
    v_mfma_f32_32x32x16_bf16 v[40:55], a[224:227], v[24:27], v[40:55]
    v_mfma_f32_32x32x16_bf16 v[56:71], a[228:231], v[24:27], v[56:71]
    s_waitcnt vmcnt(0)
    s_barrier
    s_add_u32 s21, s16, 40960
    s_cmp_eq_u32 s21, 122880
    s_cselect_b32 s21, 0, s21
    s_add_u32 s23, s14, 2
    s_min_u32 s24, s23, 63
    s_mul_i32 s24, s24, 40960
    s_add_u32 s24, s24, s19
    s_mul_i32 s25, s13, 10240
    s_add_u32 s25, s25, s22
    s_mov_b32 m0, s25
    s_nop 0
    buffer_load_dwordx4 v1, s[8:11], s24 offen offset:0 lds
    buffer_load_dwordx4 v1, s[8:11], s24 offen offset:1024 lds
    buffer_load_dwordx4 v1, s[8:11], s24 offen offset:2048 lds
    buffer_load_dwordx4 v1, s[8:11], s24 offen offset:3072 lds
    s_add_u32 s24, s24, 4096
    s_add_u32 s25, s25, 4096
    s_mov_b32 m0, s25
    s_nop 0
    buffer_load_dwordx4 v1, s[8:11], s24 offen offset:0 lds
    buffer_load_dwordx4 v1, s[8:11], s24 offen offset:1024 lds
    buffer_load_dwordx4 v1, s[8:11], s24 offen offset:2048 lds
    buffer_load_dwordx4 v1, s[8:11], s24 offen offset:3072 lds
    s_add_u32 s24, s24, 4096
    s_add_u32 s25, s25, 4096
    s_mov_b32 m0, s25
    s_nop 0
    buffer_load_dwordx4 v1, s[8:11], s24 offen offset:0 lds
    buffer_load_dwordx4 v1, s[8:11], s24 offen offset:1024 lds
    s_add_u32 s22, s22, 40960
    s_cmp_eq_u32 s22, 122880
    s_cselect_b32 s22, 0, s22
    ds_read_b128 v[20:23], v2 offset:35840
    s_waitcnt lgkmcnt(6)
    v_mfma_f32_32x32x16_bf16 v[40:55], a[232:235], v[28:31], v[40:55]
    v_mfma_f32_32x32x16_bf16 v[56:71], a[236:239], v[28:31], v[56:71]
    ds_read_b128 v[24:27], v2 offset:36864
    s_waitcnt lgkmcnt(6)
    v_mfma_f32_32x32x16_bf16 v[40:55], a[240:243], v[32:35], v[40:55]
    v_mfma_f32_32x32x16_bf16 v[56:71], a[244:247], v[32:35], v[56:71]
    ds_read_b128 v[28:31], v2 offset:37888
    s_waitcnt lgkmcnt(6)
    v_mfma_f32_32x32x16_bf16 v[40:55], a[248:251], v[36:39], v[40:55]
    v_mfma_f32_32x32x16_bf16 v[56:71], a[252:255], v[36:39], v[56:71]
    ds_read_b128 v[32:35], v2 offset:38912
    s_waitcnt lgkmcnt(6)
    v_mfma_f32_32x32x16_bf16 v[40:55], v[192:195], v[8:11], v[40:55]
    v_mfma_f32_32x32x16_bf16 v[56:71], v[196:199], v[8:11], v[56:71]
    ds_read_b128 v[36:39], v2 offset:39936
    s_waitcnt lgkmcnt(6)
    v_mfma_f32_32x32x16_bf16 v[40:55], v[200:203], v[12:15], v[40:55]
    v_mfma_f32_32x32x16_bf16 v[56:71], v[204:207], v[12:15], v[56:71]
    v_add_u32 v6, s21, v1
    ds_read_b128 v[8:11], v6 offset:0
    s_waitcnt lgkmcnt(6)
    v_mfma_f32_32x32x16_bf16 v[40:55], v[208:211], v[16:19], v[40:55]
    v_mfma_f32_32x32x16_bf16 v[56:71], v[212:215], v[16:19], v[56:71]
    ds_read_b128 v[12:15], v6 offset:1024
    s_waitcnt lgkmcnt(6)
    v_mfma_f32_32x32x16_bf16 v[40:55], v[216:219], v[20:23], v[40:55]
    v_mfma_f32_32x32x16_bf16 v[56:71], v[220:223], v[20:23], v[56:71]
    ds_read_b128 v[16:19], v6 offset:2048
    s_waitcnt lgkmcnt(6)
    v_mfma_f32_32x32x16_bf16 v[40:55], v[224:227], v[24:27], v[40:55]
    v_mfma_f32_32x32x16_bf16 v[56:71], v[228:231], v[24:27], v[56:71]
    ds_read_b128 v[20:23], v6 offset:3072
    s_waitcnt lgkmcnt(6)
    v_mfma_f32_32x32x16_bf16 v[40:55], v[232:235], v[28:31], v[40:55]
    v_mfma_f32_32x32x16_bf16 v[56:71], v[236:239], v[28:31], v[56:71]
    ds_read_b128 v[24:27], v6 offset:4096
    s_waitcnt lgkmcnt(6)
    v_mfma_f32_32x32x16_bf16 v[40:55], v[240:243], v[32:35], v[40:55]
    v_mfma_f32_32x32x16_bf16 v[56:71], v[244:247], v[32:35], v[56:71]
    ds_read_b128 v[28:31], v6 offset:5120
    s_waitcnt lgkmcnt(6)
    v_mfma_f32_32x32x16_bf16 v[40:55], v[248:251], v[36:39], v[40:55]
    v_mfma_f32_32x32x16_bf16 v[56:71], v[252:255], v[36:39], v[56:71]
    v_mov_b32 v2, v6
    s_mov_b32 s16, s21
    s_add_u32 s14, s14, 1
    s_cmp_ge_u32 s14, s15
    s_cbranch_scc1 layerb1_kernel_gk_fin0
layerb1_kernel_gk_loop:
    ds_read_b128 v[32:35], v2 offset:6144
    s_waitcnt lgkmcnt(6)
    v_mfma_f32_32x32x16_bf16 v[72:87], a[0:3], v[8:11], 0
    v_mfma_f32_32x32x16_bf16 v[88:103], a[4:7], v[8:11], 0
    ds_read_b128 v[36:39], v2 offset:7168
    s_waitcnt lgkmcnt(6)
    v_mfma_f32_32x32x16_bf16 v[72:87], a[8:11], v[12:15], v[72:87]
    v_mfma_f32_32x32x16_bf16 v[88:103], a[12:15], v[12:15], v[88:103]
    ds_read_b128 v[8:11], v2 offset:8192
    s_waitcnt lgkmcnt(6)
    v_mfma_f32_32x32x16_bf16 v[72:87], a[16:19], v[16:19], v[72:87]
    v_cvt_pk_bf16_f32 v104, v40, v41
    v_mfma_f32_32x32x16_bf16 v[88:103], a[20:23], v[16:19], v[88:103]
    v_cvt_pk_bf16_f32 v105, v42, v43
    ds_read_b128 v[12:15], v2 offset:9216
    s_waitcnt lgkmcnt(6)
    v_mfma_f32_32x32x16_bf16 v[72:87], a[24:27], v[20:23], v[72:87]
    v_cvt_pk_bf16_f32 v106, v44, v45
    v_mfma_f32_32x32x16_bf16 v[88:103], a[28:31], v[20:23], v[88:103]
    v_cvt_pk_bf16_f32 v107, v46, v47
    ds_read_b128 v[16:19], v2 offset:10240
    s_waitcnt lgkmcnt(6)
    v_mfma_f32_32x32x16_bf16 v[72:87], a[32:35], v[24:27], v[72:87]
    s_nop 1
    v_mfma_f32_32x32x16_bf16 v[88:103], a[36:39], v[24:27], v[88:103]
    v_permlane32_swap_b32 v104, v106
    ds_read_b128 v[20:23], v2 offset:11264
    s_waitcnt lgkmcnt(6)
    v_mfma_f32_32x32x16_bf16 v[72:87], a[40:43], v[28:31], v[72:87]
    v_permlane32_swap_b32 v105, v107
    v_mfma_f32_32x32x16_bf16 v[88:103], a[44:47], v[28:31], v[88:103]
    buffer_store_dwordx4 v[104:107], v3, s[8:11], s17 offen offset:0 sc1
    ds_read_b128 v[24:27], v2 offset:12288
    s_waitcnt lgkmcnt(6)
    v_mfma_f32_32x32x16_bf16 v[72:87], a[48:51], v[32:35], v[72:87]
    v_cvt_pk_bf16_f32 v108, v48, v49
    v_mfma_f32_32x32x16_bf16 v[88:103], a[52:55], v[32:35], v[88:103]
    v_cvt_pk_bf16_f32 v109, v50, v51
    ds_read_b128 v[28:31], v2 offset:13312
    s_waitcnt lgkmcnt(6)
    v_mfma_f32_32x32x16_bf16 v[72:87], a[56:59], v[36:39], v[72:87]
    v_cvt_pk_bf16_f32 v110, v52, v53
    v_mfma_f32_32x32x16_bf16 v[88:103], a[60:63], v[36:39], v[88:103]
    v_cvt_pk_bf16_f32 v111, v54, v55
    ds_read_b128 v[32:35], v2 offset:14336
    s_waitcnt lgkmcnt(6)
    v_mfma_f32_32x32x16_bf16 v[72:87], a[64:67], v[8:11], v[72:87]
    s_nop 1
    v_mfma_f32_32x32x16_bf16 v[88:103], a[68:71], v[8:11], v[88:103]
    v_permlane32_swap_b32 v108, v110
    ds_read_b128 v[36:39], v2 offset:15360
    s_waitcnt lgkmcnt(6)
    v_mfma_f32_32x32x16_bf16 v[72:87], a[72:75], v[12:15], v[72:87]
    v_permlane32_swap_b32 v109, v111
    v_mfma_f32_32x32x16_bf16 v[88:103], a[76:79], v[12:15], v[88:103]
    buffer_store_dwordx4 v[108:111], v3, s[8:11], s17 offen offset:1024 sc1
    ds_read_b128 v[8:11], v2 offset:16384
    s_waitcnt lgkmcnt(6)
    v_mfma_f32_32x32x16_bf16 v[72:87], a[80:83], v[16:19], v[72:87]
    v_cvt_pk_bf16_f32 v112, v56, v57
    v_mfma_f32_32x32x16_bf16 v[88:103], a[84:87], v[16:19], v[88:103]
    v_cvt_pk_bf16_f32 v113, v58, v59
    ds_read_b128 v[12:15], v2 offset:17408
    s_waitcnt lgkmcnt(6)
    v_mfma_f32_32x32x16_bf16 v[72:87], a[88:91], v[20:23], v[72:87]
    v_cvt_pk_bf16_f32 v114, v60, v61
    v_mfma_f32_32x32x16_bf16 v[88:103], a[92:95], v[20:23], v[88:103]
    v_cvt_pk_bf16_f32 v115, v62, v63
    ds_read_b128 v[16:19], v2 offset:18432
    s_waitcnt lgkmcnt(6)
    v_mfma_f32_32x32x16_bf16 v[72:87], a[96:99], v[24:27], v[72:87]
    s_nop 1
    v_mfma_f32_32x32x16_bf16 v[88:103], a[100:103], v[24:27], v[88:103]
    v_permlane32_swap_b32 v112, v114
    ds_read_b128 v[20:23], v2 offset:19456
    s_waitcnt lgkmcnt(6)
    v_mfma_f32_32x32x16_bf16 v[72:87], a[104:107], v[28:31], v[72:87]
    v_permlane32_swap_b32 v113, v115
    v_mfma_f32_32x32x16_bf16 v[88:103], a[108:111], v[28:31], v[88:103]
    buffer_store_dwordx4 v[112:115], v3, s[8:11], s18 offen offset:0 sc1
    ds_read_b128 v[24:27], v2 offset:20480
    s_waitcnt lgkmcnt(6)
    v_mfma_f32_32x32x16_bf16 v[72:87], a[112:115], v[32:35], v[72:87]
    v_cvt_pk_bf16_f32 v116, v64, v65
    v_mfma_f32_32x32x16_bf16 v[88:103], a[116:119], v[32:35], v[88:103]
    v_cvt_pk_bf16_f32 v117, v66, v67
    ds_read_b128 v[28:31], v2 offset:21504
    s_waitcnt lgkmcnt(6)
    v_mfma_f32_32x32x16_bf16 v[72:87], a[120:123], v[36:39], v[72:87]
    v_cvt_pk_bf16_f32 v118, v68, v69
    v_mfma_f32_32x32x16_bf16 v[88:103], a[124:127], v[36:39], v[88:103]
    v_cvt_pk_bf16_f32 v119, v70, v71
    ds_read_b128 v[32:35], v2 offset:22528
    s_waitcnt lgkmcnt(6)
    v_mfma_f32_32x32x16_bf16 v[72:87], a[128:131], v[8:11], v[72:87]
    s_nop 1
    v_mfma_f32_32x32x16_bf16 v[88:103], a[132:135], v[8:11], v[88:103]
    v_permlane32_swap_b32 v116, v118
    ds_read_b128 v[36:39], v2 offset:23552
    s_waitcnt lgkmcnt(6)
    v_mfma_f32_32x32x16_bf16 v[72:87], a[136:139], v[12:15], v[72:87]
    v_permlane32_swap_b32 v117, v119
    v_mfma_f32_32x32x16_bf16 v[88:103], a[140:143], v[12:15], v[88:103]
    buffer_store_dwordx4 v[116:119], v3, s[8:11], s18 offen offset:1024 sc1
    ds_read_b128 v[8:11], v2 offset:24576
    s_waitcnt lgkmcnt(6)
    v_mfma_f32_32x32x16_bf16 v[72:87], a[144:147], v[16:19], v[72:87]
    s_add_u32 s17, s17, s20
    v_mfma_f32_32x32x16_bf16 v[88:103], a[148:151], v[16:19], v[88:103]
    s_add_u32 s18, s18, s20
    ds_read_b128 v[12:15], v2 offset:25600
    s_waitcnt lgkmcnt(6)
    v_mfma_f32_32x32x16_bf16 v[72:87], a[152:155], v[20:23], v[72:87]
    v_mfma_f32_32x32x16_bf16 v[88:103], a[156:159], v[20:23], v[88:103]
    ds_read_b128 v[16:19], v2 offset:26624
    s_waitcnt lgkmcnt(6)
    v_mfma_f32_32x32x16_bf16 v[72:87], a[160:163], v[24:27], v[72:87]
    v_mfma_f32_32x32x16_bf16 v[88:103], a[164:167], v[24:27], v[88:103]
    ds_read_b128 v[20:23], v2 offset:27648
    s_waitcnt lgkmcnt(6)
    v_mfma_f32_32x32x16_bf16 v[72:87], a[168:171], v[28:31], v[72:87]
    v_mfma_f32_32x32x16_bf16 v[88:103], a[172:175], v[28:31], v[88:103]
    ds_read_b128 v[24:27], v2 offset:28672
    s_waitcnt lgkmcnt(6)
    v_mfma_f32_32x32x16_bf16 v[72:87], a[176:179], v[32:35], v[72:87]
    v_mfma_f32_32x32x16_bf16 v[88:103], a[180:183], v[32:35], v[88:103]
    ds_read_b128 v[28:31], v2 offset:29696
    s_waitcnt lgkmcnt(6)
    v_mfma_f32_32x32x16_bf16 v[72:87], a[184:187], v[36:39], v[72:87]
    v_mfma_f32_32x32x16_bf16 v[88:103], a[188:191], v[36:39], v[88:103]
    ds_read_b128 v[32:35], v2 offset:30720
    s_waitcnt lgkmcnt(6)
    v_mfma_f32_32x32x16_bf16 v[72:87], a[192:195], v[8:11], v[72:87]
    v_mfma_f32_32x32x16_bf16 v[88:103], a[196:199], v[8:11], v[88:103]
    ds_read_b128 v[36:39], v2 offset:31744
    s_waitcnt lgkmcnt(6)
    v_mfma_f32_32x32x16_bf16 v[72:87], a[200:203], v[12:15], v[72:87]
    v_mfma_f32_32x32x16_bf16 v[88:103], a[204:207], v[12:15], v[88:103]
    ds_read_b128 v[8:11], v2 offset:32768
    s_waitcnt lgkmcnt(6)
    v_mfma_f32_32x32x16_bf16 v[72:87], a[208:211], v[16:19], v[72:87]
    v_mfma_f32_32x32x16_bf16 v[88:103], a[212:215], v[16:19], v[88:103]
    ds_read_b128 v[12:15], v2 offset:33792
    s_waitcnt lgkmcnt(6)
    v_mfma_f32_32x32x16_bf16 v[72:87], a[216:219], v[20:23], v[72:87]
    v_mfma_f32_32x32x16_bf16 v[88:103], a[220:223], v[20:23], v[88:103]
    ds_read_b128 v[16:19], v2 offset:34816
    s_waitcnt lgkmcnt(6)
    v_mfma_f32_32x32x16_bf16 v[72:87], a[224:227], v[24:27], v[72:87]
    v_mfma_f32_32x32x16_bf16 v[88:103], a[228:231], v[24:27], v[88:103]
    s_cmp_gt_u32 s14, 2
    s_cbranch_scc1 layerb1_kernel_gk_dr1
    s_waitcnt vmcnt(0)
    s_mov_b32 s27, s14
    s_branch layerb1_kernel_gk_dq1
layerb1_kernel_gk_dr1:
    s_waitcnt vmcnt(4)
    s_sub_u32 s27, s14, 1
layerb1_kernel_gk_dq1:
    s_barrier
    s_cmp_lg_u32 s13, 0
    s_cbranch_scc1 layerb1_kernel_gk_fl2
    s_mov_b64 exec, 1
    s_lshl_b32 s26, s12, 7
    v_mov_b32 v7, s26
    v_mov_b32 v120, s27
    buffer_store_dword v120, v7, s[8:11], s48 offen sc1
    s_mov_b64 exec, -1
layerb1_kernel_gk_fl2:
    s_add_u32 s21, s16, 40960
    s_cmp_eq_u32 s21, 122880
    s_cselect_b32 s21, 0, s21
    s_add_u32 s23, s14, 2
    s_min_u32 s24, s23, 63
    s_mul_i32 s24, s24, 40960
    s_add_u32 s24, s24, s19
    s_mul_i32 s25, s13, 10240
    s_add_u32 s25, s25, s22
    s_mov_b32 m0, s25
    s_nop 0
    buffer_load_dwordx4 v1, s[8:11], s24 offen offset:0 lds
    buffer_load_dwordx4 v1, s[8:11], s24 offen offset:1024 lds
    buffer_load_dwordx4 v1, s[8:11], s24 offen offset:2048 lds
    buffer_load_dwordx4 v1, s[8:11], s24 offen offset:3072 lds
    s_add_u32 s24, s24, 4096
    s_add_u32 s25, s25, 4096
    s_mov_b32 m0, s25
    s_nop 0
    buffer_load_dwordx4 v1, s[8:11], s24 offen offset:0 lds
    buffer_load_dwordx4 v1, s[8:11], s24 offen offset:1024 lds
    buffer_load_dwordx4 v1, s[8:11], s24 offen offset:2048 lds
    buffer_load_dwordx4 v1, s[8:11], s24 offen offset:3072 lds
    s_add_u32 s24, s24, 4096
    s_add_u32 s25, s25, 4096
    s_mov_b32 m0, s25
    s_nop 0
    buffer_load_dwordx4 v1, s[8:11], s24 offen offset:0 lds
    buffer_load_dwordx4 v1, s[8:11], s24 offen offset:1024 lds
    s_add_u32 s22, s22, 40960
    s_cmp_eq_u32 s22, 122880
    s_cselect_b32 s22, 0, s22
    ds_read_b128 v[20:23], v2 offset:35840
    s_waitcnt lgkmcnt(6)
    v_mfma_f32_32x32x16_bf16 v[72:87], a[232:235], v[28:31], v[72:87]
    v_mfma_f32_32x32x16_bf16 v[88:103], a[236:239], v[28:31], v[88:103]
    ds_read_b128 v[24:27], v2 offset:36864
    s_waitcnt lgkmcnt(6)
    v_mfma_f32_32x32x16_bf16 v[72:87], a[240:243], v[32:35], v[72:87]
    v_mfma_f32_32x32x16_bf16 v[88:103], a[244:247], v[32:35], v[88:103]
    ds_read_b128 v[28:31], v2 offset:37888
    s_waitcnt lgkmcnt(6)
    v_mfma_f32_32x32x16_bf16 v[72:87], a[248:251], v[36:39], v[72:87]
    v_mfma_f32_32x32x16_bf16 v[88:103], a[252:255], v[36:39], v[88:103]
    ds_read_b128 v[32:35], v2 offset:38912
    s_waitcnt lgkmcnt(6)
    v_mfma_f32_32x32x16_bf16 v[72:87], v[192:195], v[8:11], v[72:87]
    v_mfma_f32_32x32x16_bf16 v[88:103], v[196:199], v[8:11], v[88:103]
    ds_read_b128 v[36:39], v2 offset:39936
    s_waitcnt lgkmcnt(6)
    v_mfma_f32_32x32x16_bf16 v[72:87], v[200:203], v[12:15], v[72:87]
    v_mfma_f32_32x32x16_bf16 v[88:103], v[204:207], v[12:15], v[88:103]
    v_add_u32 v6, s21, v1
    ds_read_b128 v[8:11], v6 offset:0
    s_waitcnt lgkmcnt(6)
    v_mfma_f32_32x32x16_bf16 v[72:87], v[208:211], v[16:19], v[72:87]
    v_mfma_f32_32x32x16_bf16 v[88:103], v[212:215], v[16:19], v[88:103]
    ds_read_b128 v[12:15], v6 offset:1024
    s_waitcnt lgkmcnt(6)
    v_mfma_f32_32x32x16_bf16 v[72:87], v[216:219], v[20:23], v[72:87]
    v_mfma_f32_32x32x16_bf16 v[88:103], v[220:223], v[20:23], v[88:103]
    ds_read_b128 v[16:19], v6 offset:2048
    s_waitcnt lgkmcnt(6)
    v_mfma_f32_32x32x16_bf16 v[72:87], v[224:227], v[24:27], v[72:87]
    v_mfma_f32_32x32x16_bf16 v[88:103], v[228:231], v[24:27], v[88:103]
    ds_read_b128 v[20:23], v6 offset:3072
    s_waitcnt lgkmcnt(6)
    v_mfma_f32_32x32x16_bf16 v[72:87], v[232:235], v[28:31], v[72:87]
    v_mfma_f32_32x32x16_bf16 v[88:103], v[236:239], v[28:31], v[88:103]
    ds_read_b128 v[24:27], v6 offset:4096
    s_waitcnt lgkmcnt(6)
    v_mfma_f32_32x32x16_bf16 v[72:87], v[240:243], v[32:35], v[72:87]
    v_mfma_f32_32x32x16_bf16 v[88:103], v[244:247], v[32:35], v[88:103]
    ds_read_b128 v[28:31], v6 offset:5120
    s_waitcnt lgkmcnt(6)
    v_mfma_f32_32x32x16_bf16 v[72:87], v[248:251], v[36:39], v[72:87]
    v_mfma_f32_32x32x16_bf16 v[88:103], v[252:255], v[36:39], v[88:103]
    v_mov_b32 v2, v6
    s_mov_b32 s16, s21
    s_add_u32 s14, s14, 1
    s_cmp_ge_u32 s14, s15
    s_cbranch_scc1 layerb1_kernel_gk_fin1
    ds_read_b128 v[32:35], v2 offset:6144
    s_waitcnt lgkmcnt(6)
    v_mfma_f32_32x32x16_bf16 v[40:55], a[0:3], v[8:11], 0
    v_mfma_f32_32x32x16_bf16 v[56:71], a[4:7], v[8:11], 0
    ds_read_b128 v[36:39], v2 offset:7168
    s_waitcnt lgkmcnt(6)
    v_mfma_f32_32x32x16_bf16 v[40:55], a[8:11], v[12:15], v[40:55]
    v_mfma_f32_32x32x16_bf16 v[56:71], a[12:15], v[12:15], v[56:71]
    ds_read_b128 v[8:11], v2 offset:8192
    s_waitcnt lgkmcnt(6)
    v_mfma_f32_32x32x16_bf16 v[40:55], a[16:19], v[16:19], v[40:55]
    v_cvt_pk_bf16_f32 v104, v72, v73
    v_mfma_f32_32x32x16_bf16 v[56:71], a[20:23], v[16:19], v[56:71]
    v_cvt_pk_bf16_f32 v105, v74, v75
    ds_read_b128 v[12:15], v2 offset:9216
    s_waitcnt lgkmcnt(6)
    v_mfma_f32_32x32x16_bf16 v[40:55], a[24:27], v[20:23], v[40:55]
    v_cvt_pk_bf16_f32 v106, v76, v77
    v_mfma_f32_32x32x16_bf16 v[56:71], a[28:31], v[20:23], v[56:71]
    v_cvt_pk_bf16_f32 v107, v78, v79
    ds_read_b128 v[16:19], v2 offset:10240
    s_waitcnt lgkmcnt(6)
    v_mfma_f32_32x32x16_bf16 v[40:55], a[32:35], v[24:27], v[40:55]
    s_nop 1
    v_mfma_f32_32x32x16_bf16 v[56:71], a[36:39], v[24:27], v[56:71]
    v_permlane32_swap_b32 v104, v106
    ds_read_b128 v[20:23], v2 offset:11264
    s_waitcnt lgkmcnt(6)
    v_mfma_f32_32x32x16_bf16 v[40:55], a[40:43], v[28:31], v[40:55]
    v_permlane32_swap_b32 v105, v107
    v_mfma_f32_32x32x16_bf16 v[56:71], a[44:47], v[28:31], v[56:71]
    buffer_store_dwordx4 v[104:107], v3, s[8:11], s17 offen offset:0 sc1
    ds_read_b128 v[24:27], v2 offset:12288
    s_waitcnt lgkmcnt(6)
    v_mfma_f32_32x32x16_bf16 v[40:55], a[48:51], v[32:35], v[40:55]
    v_cvt_pk_bf16_f32 v108, v80, v81
    v_mfma_f32_32x32x16_bf16 v[56:71], a[52:55], v[32:35], v[56:71]
    v_cvt_pk_bf16_f32 v109, v82, v83
    ds_read_b128 v[28:31], v2 offset:13312
    s_waitcnt lgkmcnt(6)
    v_mfma_f32_32x32x16_bf16 v[40:55], a[56:59], v[36:39], v[40:55]
    v_cvt_pk_bf16_f32 v110, v84, v85
    v_mfma_f32_32x32x16_bf16 v[56:71], a[60:63], v[36:39], v[56:71]
    v_cvt_pk_bf16_f32 v111, v86, v87
    ds_read_b128 v[32:35], v2 offset:14336
    s_waitcnt lgkmcnt(6)
    v_mfma_f32_32x32x16_bf16 v[40:55], a[64:67], v[8:11], v[40:55]
    s_nop 1
    v_mfma_f32_32x32x16_bf16 v[56:71], a[68:71], v[8:11], v[56:71]
    v_permlane32_swap_b32 v108, v110
    ds_read_b128 v[36:39], v2 offset:15360
    s_waitcnt lgkmcnt(6)
    v_mfma_f32_32x32x16_bf16 v[40:55], a[72:75], v[12:15], v[40:55]
    v_permlane32_swap_b32 v109, v111
    v_mfma_f32_32x32x16_bf16 v[56:71], a[76:79], v[12:15], v[56:71]
    buffer_store_dwordx4 v[108:111], v3, s[8:11], s17 offen offset:1024 sc1
    ds_read_b128 v[8:11], v2 offset:16384
    s_waitcnt lgkmcnt(6)
    v_mfma_f32_32x32x16_bf16 v[40:55], a[80:83], v[16:19], v[40:55]
    v_cvt_pk_bf16_f32 v112, v88, v89
    v_mfma_f32_32x32x16_bf16 v[56:71], a[84:87], v[16:19], v[56:71]
    v_cvt_pk_bf16_f32 v113, v90, v91
    ds_read_b128 v[12:15], v2 offset:17408
    s_waitcnt lgkmcnt(6)
    v_mfma_f32_32x32x16_bf16 v[40:55], a[88:91], v[20:23], v[40:55]
    v_cvt_pk_bf16_f32 v114, v92, v93
    v_mfma_f32_32x32x16_bf16 v[56:71], a[92:95], v[20:23], v[56:71]
    v_cvt_pk_bf16_f32 v115, v94, v95
    ds_read_b128 v[16:19], v2 offset:18432
    s_waitcnt lgkmcnt(6)
    v_mfma_f32_32x32x16_bf16 v[40:55], a[96:99], v[24:27], v[40:55]
    s_nop 1
    v_mfma_f32_32x32x16_bf16 v[56:71], a[100:103], v[24:27], v[56:71]
    v_permlane32_swap_b32 v112, v114
    ds_read_b128 v[20:23], v2 offset:19456
    s_waitcnt lgkmcnt(6)
    v_mfma_f32_32x32x16_bf16 v[40:55], a[104:107], v[28:31], v[40:55]
    v_permlane32_swap_b32 v113, v115
    v_mfma_f32_32x32x16_bf16 v[56:71], a[108:111], v[28:31], v[56:71]
    buffer_store_dwordx4 v[112:115], v3, s[8:11], s18 offen offset:0 sc1
    ds_read_b128 v[24:27], v2 offset:20480
    s_waitcnt lgkmcnt(6)
    v_mfma_f32_32x32x16_bf16 v[40:55], a[112:115], v[32:35], v[40:55]
    v_cvt_pk_bf16_f32 v116, v96, v97
    v_mfma_f32_32x32x16_bf16 v[56:71], a[116:119], v[32:35], v[56:71]
    v_cvt_pk_bf16_f32 v117, v98, v99
    ds_read_b128 v[28:31], v2 offset:21504
    s_waitcnt lgkmcnt(6)
    v_mfma_f32_32x32x16_bf16 v[40:55], a[120:123], v[36:39], v[40:55]
    v_cvt_pk_bf16_f32 v118, v100, v101
    v_mfma_f32_32x32x16_bf16 v[56:71], a[124:127], v[36:39], v[56:71]
    v_cvt_pk_bf16_f32 v119, v102, v103
    ds_read_b128 v[32:35], v2 offset:22528
    s_waitcnt lgkmcnt(6)
    v_mfma_f32_32x32x16_bf16 v[40:55], a[128:131], v[8:11], v[40:55]
    s_nop 1
    v_mfma_f32_32x32x16_bf16 v[56:71], a[132:135], v[8:11], v[56:71]
    v_permlane32_swap_b32 v116, v118
    ds_read_b128 v[36:39], v2 offset:23552
    s_waitcnt lgkmcnt(6)
    v_mfma_f32_32x32x16_bf16 v[40:55], a[136:139], v[12:15], v[40:55]
    v_permlane32_swap_b32 v117, v119
    v_mfma_f32_32x32x16_bf16 v[56:71], a[140:143], v[12:15], v[56:71]
    buffer_store_dwordx4 v[116:119], v3, s[8:11], s18 offen offset:1024 sc1
    ds_read_b128 v[8:11], v2 offset:24576
    s_waitcnt lgkmcnt(6)
    v_mfma_f32_32x32x16_bf16 v[40:55], a[144:147], v[16:19], v[40:55]
    s_add_u32 s17, s17, s20
    v_mfma_f32_32x32x16_bf16 v[56:71], a[148:151], v[16:19], v[56:71]
    s_add_u32 s18, s18, s20
    ds_read_b128 v[12:15], v2 offset:25600
    s_waitcnt lgkmcnt(6)
    v_mfma_f32_32x32x16_bf16 v[40:55], a[152:155], v[20:23], v[40:55]
    v_mfma_f32_32x32x16_bf16 v[56:71], a[156:159], v[20:23], v[56:71]
    ds_read_b128 v[16:19], v2 offset:26624
    s_waitcnt lgkmcnt(6)
    v_mfma_f32_32x32x16_bf16 v[40:55], a[160:163], v[24:27], v[40:55]
    v_mfma_f32_32x32x16_bf16 v[56:71], a[164:167], v[24:27], v[56:71]
    ds_read_b128 v[20:23], v2 offset:27648
    s_waitcnt lgkmcnt(6)
    v_mfma_f32_32x32x16_bf16 v[40:55], a[168:171], v[28:31], v[40:55]
    v_mfma_f32_32x32x16_bf16 v[56:71], a[172:175], v[28:31], v[56:71]
    ds_read_b128 v[24:27], v2 offset:28672
    s_waitcnt lgkmcnt(6)
    v_mfma_f32_32x32x16_bf16 v[40:55], a[176:179], v[32:35], v[40:55]
    v_mfma_f32_32x32x16_bf16 v[56:71], a[180:183], v[32:35], v[56:71]
    ds_read_b128 v[28:31], v2 offset:29696
    s_waitcnt lgkmcnt(6)
    v_mfma_f32_32x32x16_bf16 v[40:55], a[184:187], v[36:39], v[40:55]
    v_mfma_f32_32x32x16_bf16 v[56:71], a[188:191], v[36:39], v[56:71]
    ds_read_b128 v[32:35], v2 offset:30720
    s_waitcnt lgkmcnt(6)
    v_mfma_f32_32x32x16_bf16 v[40:55], a[192:195], v[8:11], v[40:55]
    v_mfma_f32_32x32x16_bf16 v[56:71], a[196:199], v[8:11], v[56:71]
    ds_read_b128 v[36:39], v2 offset:31744
    s_waitcnt lgkmcnt(6)
    v_mfma_f32_32x32x16_bf16 v[40:55], a[200:203], v[12:15], v[40:55]
    v_mfma_f32_32x32x16_bf16 v[56:71], a[204:207], v[12:15], v[56:71]
    ds_read_b128 v[8:11], v2 offset:32768
    s_waitcnt lgkmcnt(6)
    v_mfma_f32_32x32x16_bf16 v[40:55], a[208:211], v[16:19], v[40:55]
    v_mfma_f32_32x32x16_bf16 v[56:71], a[212:215], v[16:19], v[56:71]
    ds_read_b128 v[12:15], v2 offset:33792
    s_waitcnt lgkmcnt(6)
    v_mfma_f32_32x32x16_bf16 v[40:55], a[216:219], v[20:23], v[40:55]
    v_mfma_f32_32x32x16_bf16 v[56:71], a[220:223], v[20:23], v[56:71]
    ds_read_b128 v[16:19], v2 offset:34816
    s_waitcnt lgkmcnt(6)
    v_mfma_f32_32x32x16_bf16 v[40:55], a[224:227], v[24:27], v[40:55]
    v_mfma_f32_32x32x16_bf16 v[56:71], a[228:231], v[24:27], v[56:71]
    s_cmp_gt_u32 s14, 2
    s_cbranch_scc1 layerb1_kernel_gk_dr3
    s_waitcnt vmcnt(0)
    s_mov_b32 s27, s14
    s_branch layerb1_kernel_gk_dq3
layerb1_kernel_gk_dr3:
    s_waitcnt vmcnt(4)
    s_sub_u32 s27, s14, 1
layerb1_kernel_gk_dq3:
    s_barrier
    s_cmp_lg_u32 s13, 0
    s_cbranch_scc1 layerb1_kernel_gk_fl4
    s_mov_b64 exec, 1
    s_lshl_b32 s26, s12, 7
    v_mov_b32 v7, s26
    v_mov_b32 v120, s27
    buffer_store_dword v120, v7, s[8:11], s48 offen sc1
    s_mov_b64 exec, -1
layerb1_kernel_gk_fl4:
    s_add_u32 s21, s16, 40960
    s_cmp_eq_u32 s21, 122880
    s_cselect_b32 s21, 0, s21
    s_add_u32 s23, s14, 2
    s_min_u32 s24, s23, 63
    s_mul_i32 s24, s24, 40960
    s_add_u32 s24, s24, s19
    s_mul_i32 s25, s13, 10240
    s_add_u32 s25, s25, s22
    s_mov_b32 m0, s25
    s_nop 0
    buffer_load_dwordx4 v1, s[8:11], s24 offen offset:0 lds
    buffer_load_dwordx4 v1, s[8:11], s24 offen offset:1024 lds
    buffer_load_dwordx4 v1, s[8:11], s24 offen offset:2048 lds
    buffer_load_dwordx4 v1, s[8:11], s24 offen offset:3072 lds
    s_add_u32 s24, s24, 4096
    s_add_u32 s25, s25, 4096
    s_mov_b32 m0, s25
    s_nop 0
    buffer_load_dwordx4 v1, s[8:11], s24 offen offset:0 lds
    buffer_load_dwordx4 v1, s[8:11], s24 offen offset:1024 lds
    buffer_load_dwordx4 v1, s[8:11], s24 offen offset:2048 lds
    buffer_load_dwordx4 v1, s[8:11], s24 offen offset:3072 lds
    s_add_u32 s24, s24, 4096
    s_add_u32 s25, s25, 4096
    s_mov_b32 m0, s25
    s_nop 0
    buffer_load_dwordx4 v1, s[8:11], s24 offen offset:0 lds
    buffer_load_dwordx4 v1, s[8:11], s24 offen offset:1024 lds
    s_add_u32 s22, s22, 40960
    s_cmp_eq_u32 s22, 122880
    s_cselect_b32 s22, 0, s22
    ds_read_b128 v[20:23], v2 offset:35840
    s_waitcnt lgkmcnt(6)
    v_mfma_f32_32x32x16_bf16 v[40:55], a[232:235], v[28:31], v[40:55]
    v_mfma_f32_32x32x16_bf16 v[56:71], a[236:239], v[28:31], v[56:71]
    ds_read_b128 v[24:27], v2 offset:36864
    s_waitcnt lgkmcnt(6)
    v_mfma_f32_32x32x16_bf16 v[40:55], a[240:243], v[32:35], v[40:55]
    v_mfma_f32_32x32x16_bf16 v[56:71], a[244:247], v[32:35], v[56:71]
    ds_read_b128 v[28:31], v2 offset:37888
    s_waitcnt lgkmcnt(6)
    v_mfma_f32_32x32x16_bf16 v[40:55], a[248:251], v[36:39], v[40:55]
    v_mfma_f32_32x32x16_bf16 v[56:71], a[252:255], v[36:39], v[56:71]
    ds_read_b128 v[32:35], v2 offset:38912
    s_waitcnt lgkmcnt(6)
    v_mfma_f32_32x32x16_bf16 v[40:55], v[192:195], v[8:11], v[40:55]
    v_mfma_f32_32x32x16_bf16 v[56:71], v[196:199], v[8:11], v[56:71]
    ds_read_b128 v[36:39], v2 offset:39936
    s_waitcnt lgkmcnt(6)
    v_mfma_f32_32x32x16_bf16 v[40:55], v[200:203], v[12:15], v[40:55]
    v_mfma_f32_32x32x16_bf16 v[56:71], v[204:207], v[12:15], v[56:71]
    v_add_u32 v6, s21, v1
    ds_read_b128 v[8:11], v6 offset:0
    s_waitcnt lgkmcnt(6)
    v_mfma_f32_32x32x16_bf16 v[40:55], v[208:211], v[16:19], v[40:55]
    v_mfma_f32_32x32x16_bf16 v[56:71], v[212:215], v[16:19], v[56:71]
    ds_read_b128 v[12:15], v6 offset:1024
    s_waitcnt lgkmcnt(6)
    v_mfma_f32_32x32x16_bf16 v[40:55], v[216:219], v[20:23], v[40:55]
    v_mfma_f32_32x32x16_bf16 v[56:71], v[220:223], v[20:23], v[56:71]
    ds_read_b128 v[16:19], v6 offset:2048
    s_waitcnt lgkmcnt(6)
    v_mfma_f32_32x32x16_bf16 v[40:55], v[224:227], v[24:27], v[40:55]
    v_mfma_f32_32x32x16_bf16 v[56:71], v[228:231], v[24:27], v[56:71]
    ds_read_b128 v[20:23], v6 offset:3072
    s_waitcnt lgkmcnt(6)
    v_mfma_f32_32x32x16_bf16 v[40:55], v[232:235], v[28:31], v[40:55]
    v_mfma_f32_32x32x16_bf16 v[56:71], v[236:239], v[28:31], v[56:71]
    ds_read_b128 v[24:27], v6 offset:4096
    s_waitcnt lgkmcnt(6)
    v_mfma_f32_32x32x16_bf16 v[40:55], v[240:243], v[32:35], v[40:55]
    v_mfma_f32_32x32x16_bf16 v[56:71], v[244:247], v[32:35], v[56:71]
    ds_read_b128 v[28:31], v6 offset:5120
    s_waitcnt lgkmcnt(6)
    v_mfma_f32_32x32x16_bf16 v[40:55], v[248:251], v[36:39], v[40:55]
    v_mfma_f32_32x32x16_bf16 v[56:71], v[252:255], v[36:39], v[56:71]
    v_mov_b32 v2, v6
    s_mov_b32 s16, s21
    s_add_u32 s14, s14, 1
    s_cmp_lt_u32 s14, s15
    s_cbranch_scc1 layerb1_kernel_gk_loop
layerb1_kernel_gk_fin0:
    s_nop 7
    s_nop 7
    v_cvt_pk_bf16_f32 v104, v40, v41
    v_cvt_pk_bf16_f32 v105, v42, v43
    v_cvt_pk_bf16_f32 v106, v44, v45
    v_cvt_pk_bf16_f32 v107, v46, v47
    s_nop 1
    v_permlane32_swap_b32 v104, v106
    v_permlane32_swap_b32 v105, v107
    buffer_store_dwordx4 v[104:107], v3, s[8:11], s17 offen offset:0 sc1
    v_cvt_pk_bf16_f32 v108, v48, v49
    v_cvt_pk_bf16_f32 v109, v50, v51
    v_cvt_pk_bf16_f32 v110, v52, v53
    v_cvt_pk_bf16_f32 v111, v54, v55
    s_nop 1
    v_permlane32_swap_b32 v108, v110
    v_permlane32_swap_b32 v109, v111
    buffer_store_dwordx4 v[108:111], v3, s[8:11], s17 offen offset:1024 sc1
    v_cvt_pk_bf16_f32 v112, v56, v57
    v_cvt_pk_bf16_f32 v113, v58, v59
    v_cvt_pk_bf16_f32 v114, v60, v61
    v_cvt_pk_bf16_f32 v115, v62, v63
    s_nop 1
    v_permlane32_swap_b32 v112, v114
    v_permlane32_swap_b32 v113, v115
    buffer_store_dwordx4 v[112:115], v3, s[8:11], s18 offen offset:0 sc1
    v_cvt_pk_bf16_f32 v116, v64, v65
    v_cvt_pk_bf16_f32 v117, v66, v67
    v_cvt_pk_bf16_f32 v118, v68, v69
    v_cvt_pk_bf16_f32 v119, v70, v71
    s_nop 1
    v_permlane32_swap_b32 v116, v118
    v_permlane32_swap_b32 v117, v119
    buffer_store_dwordx4 v[116:119], v3, s[8:11], s18 offen offset:1024 sc1
    s_add_u32 s17, s17, s20
    s_add_u32 s18, s18, s20
    s_branch layerb1_kernel_gk_done
layerb1_kernel_gk_fin1:
    s_nop 7
    s_nop 7
    v_cvt_pk_bf16_f32 v104, v72, v73
    v_cvt_pk_bf16_f32 v105, v74, v75
    v_cvt_pk_bf16_f32 v106, v76, v77
    v_cvt_pk_bf16_f32 v107, v78, v79
    s_nop 1
    v_permlane32_swap_b32 v104, v106
    v_permlane32_swap_b32 v105, v107
    buffer_store_dwordx4 v[104:107], v3, s[8:11], s17 offen offset:0 sc1
    v_cvt_pk_bf16_f32 v108, v80, v81
    v_cvt_pk_bf16_f32 v109, v82, v83
    v_cvt_pk_bf16_f32 v110, v84, v85
    v_cvt_pk_bf16_f32 v111, v86, v87
    s_nop 1
    v_permlane32_swap_b32 v108, v110
    v_permlane32_swap_b32 v109, v111
    buffer_store_dwordx4 v[108:111], v3, s[8:11], s17 offen offset:1024 sc1
    v_cvt_pk_bf16_f32 v112, v88, v89
    v_cvt_pk_bf16_f32 v113, v90, v91
    v_cvt_pk_bf16_f32 v114, v92, v93
    v_cvt_pk_bf16_f32 v115, v94, v95
    s_nop 1
    v_permlane32_swap_b32 v112, v114
    v_permlane32_swap_b32 v113, v115
    buffer_store_dwordx4 v[112:115], v3, s[8:11], s18 offen offset:0 sc1
    v_cvt_pk_bf16_f32 v116, v96, v97
    v_cvt_pk_bf16_f32 v117, v98, v99
    v_cvt_pk_bf16_f32 v118, v100, v101
    v_cvt_pk_bf16_f32 v119, v102, v103
    s_nop 1
    v_permlane32_swap_b32 v116, v118
    v_permlane32_swap_b32 v117, v119
    buffer_store_dwordx4 v[116:119], v3, s[8:11], s18 offen offset:1024 sc1
    s_add_u32 s17, s17, s20
    s_add_u32 s18, s18, s20
layerb1_kernel_gk_done:
    s_waitcnt vmcnt(0) lgkmcnt(0)
    s_barrier
    s_cmp_lg_u32 s13, 0
    s_cbranch_scc1 layerb1_kernel_gk_fl5
    s_mov_b64 exec, 1
    s_lshl_b32 s26, s12, 7
    v_mov_b32 v7, s26
    v_mov_b32 v120, s14
    buffer_store_dword v120, v7, s[8:11], s48 offen sc1
    s_mov_b64 exec, -1
layerb1_kernel_gk_fl5:
layerb1_kernel_g_done:
layerb1_kernel_w3:
    s_mov_b32 s15, 400000
layerb1_kernel_j_next:
    s_cmp_lg_u32 s13, 0
    s_cbranch_scc1 layerb1_kernel_j_rel
    s_mov_b64 exec, 1
    v_mov_b32 v2, 31744
    v_mov_b32 v3, 1
    buffer_atomic_add v3, v2, s[8:11], s48 offen sc0 sc1
    s_waitcnt vmcnt(0)
    s_mov_b64 exec, -1
    s_nop 0
    v_readfirstlane_b32 s38, v3
    s_cmp_ge_u32 s38, 1152
    s_cbranch_scc1 layerb1_kernel_j_pub
    s_mul_i32 s39, s38, 58255
    s_lshr_b32 s40, s39, 20
    s_mul_i32 s39, s40, 18
    s_sub_u32 s41, s38, s39
    s_add_u32 s42, s40, 1
    v_mov_b32 v4, s42
    s_cmp_ge_u32 s41, 8
    s_cbranch_scc1 layerb1_kernel_j_dep_b
    s_lshl_b32 s24, s41, 9
    s_add_u32 s24, s24, 16384
    v_lshlrev_b32 v2, 7, v0
    v_add_u32 v2, s24, v2
    s_mul_i32 s25, s41, 3
    s_add_u32 s25, s25, 104
    s_lshl_b32 s25, s25, 7
    v_writelane_b32 v2, s25, 4
    s_add_u32 s25, s25, 128
    v_writelane_b32 v2, s25, 5
    s_add_u32 s25, s25, 128
    v_writelane_b32 v2, s25, 6
    s_mov_b64 exec, 0x7f
    s_branch layerb1_kernel_j_poll
layerb1_kernel_j_dep_b:
    s_sub_u32 s24, s41, 8
    s_lshl_b32 s24, s24, 10
    s_add_u32 s24, s24, 20480
    v_lshlrev_b32 v2, 7, v0
    v_add_u32 v2, s24, v2
    s_lshl_b32 s25, s40, 4
    s_add_u32 s25, s25, 30720
    v_writelane_b32 v2, s25, 8
    s_mov_b32 s26, 8
    v_writelane_b32 v4, s26, 8
    s_mov_b64 exec, 0x1ff
layerb1_kernel_j_poll:
    buffer_load_dword v3, v2, s[8:11], s48 offen sc1
    s_waitcnt vmcnt(0)
    v_cmp_gt_u32 vcc, v4, v3
    s_sub_u32 s15, s15, 1
    s_cbranch_scc1 layerb1_kernel_j_giveup
    s_cbranch_vccnz layerb1_kernel_j_poll
    s_mov_b64 exec, -1
layerb1_kernel_j_pub:
    v_mov_b32 v2, 0
    v_mov_b32 v3, s38
    ds_write_b32 v2, v3 offset:32768
    s_waitcnt lgkmcnt(0)
layerb1_kernel_j_rel:
    s_barrier
    v_mov_b32 v2, 0
    ds_read_b32 v3, v2 offset:32768
    s_waitcnt lgkmcnt(0)
    v_readfirstlane_b32 s38, v3
    s_cmp_ge_u32 s38, 1152
    s_cbranch_scc1 layerb1_kernel_j_done
    s_mul_i32 s39, s38, 58255
    s_lshr_b32 s40, s39, 20
    s_mul_i32 s39, s40, 18
    s_sub_u32 s41, s38, s39
    s_cmp_ge_u32 s41, 8
    s_cbranch_scc1 layerb1_kernel_j_b
    s_lshl_b32 s41, s41, 2
    s_add_u32 s41, s41, s13
    v_lshlrev_b32 v1, 4, v0
    v_and_b32 v2, 31, v0
    v_lshrrev_b32 v3, 5, v0
    s_lshl_b32 s24, s40, 5
    s_add_u32 s24, s24, s41
    s_mul_i32 s25, s24, 12288
    s_add_u32 s26, s25, 78643200
    s_add_u32 s27, s25, 53477376
    s_mul_i32 s28, s24, 3072
    s_add_u32 s28, s28, 208666624
    v_and_b32 v4, 7, v0
    v_lshlrev_b32 v4, 4, v4
    v_lshl_add_u32 v4, v3, 7, v4
    buffer_load_dwordx4 v[16:19], v1, s[8:11], s26 offen offset:0 sc1
    buffer_load_dwordx4 v[64:67], v1, s[8:11], s27 offen offset:0 sc1
    buffer_load_dwordx4 v[112:115], v4, s[8:11], s28 offen offset:0 sc1
    buffer_load_dwordx4 v[20:23], v1, s[8:11], s26 offen offset:1024 sc1
    buffer_load_dwordx4 v[68:71], v1, s[8:11], s27 offen offset:1024 sc1
    buffer_load_dwordx4 v[116:119], v4, s[8:11], s28 offen offset:256 sc1
    buffer_load_dwordx4 v[24:27], v1, s[8:11], s26 offen offset:2048 sc1
    buffer_load_dwordx4 v[72:75], v1, s[8:11], s27 offen offset:2048 sc1
    buffer_load_dwordx4 v[120:123], v4, s[8:11], s28 offen offset:512 sc1
    buffer_load_dwordx4 v[28:31], v1, s[8:11], s26 offen offset:3072 sc1
    buffer_load_dwordx4 v[76:79], v1, s[8:11], s27 offen offset:3072 sc1
    buffer_load_dwordx4 v[124:127], v4, s[8:11], s28 offen offset:768 sc1
    s_add_u32 s26, s26, 4096
    s_add_u32 s27, s27, 4096
    buffer_load_dwordx4 v[32:35], v1, s[8:11], s26 offen offset:0 sc1
    buffer_load_dwordx4 v[80:83], v1, s[8:11], s27 offen offset:0 sc1
    buffer_load_dwordx4 v[128:131], v4, s[8:11], s28 offen offset:1024 sc1
    buffer_load_dwordx4 v[36:39], v1, s[8:11], s26 offen offset:1024 sc1
    buffer_load_dwordx4 v[84:87], v1, s[8:11], s27 offen offset:1024 sc1
    buffer_load_dwordx4 v[132:135], v4, s[8:11], s28 offen offset:1280 sc1
    buffer_load_dwordx4 v[40:43], v1, s[8:11], s26 offen offset:2048 sc1
    buffer_load_dwordx4 v[88:91], v1, s[8:11], s27 offen offset:2048 sc1
    buffer_load_dwordx4 v[136:139], v4, s[8:11], s28 offen offset:1536 sc1
    buffer_load_dwordx4 v[44:47], v1, s[8:11], s26 offen offset:3072 sc1
    buffer_load_dwordx4 v[92:95], v1, s[8:11], s27 offen offset:3072 sc1
    buffer_load_dwordx4 v[140:143], v4, s[8:11], s28 offen offset:1792 sc1
    s_add_u32 s26, s26, 4096
    s_add_u32 s27, s27, 4096
    buffer_load_dwordx4 v[48:51], v1, s[8:11], s26 offen offset:0 sc1
    buffer_load_dwordx4 v[96:99], v1, s[8:11], s27 offen offset:0 sc1
    buffer_load_dwordx4 v[144:147], v4, s[8:11], s28 offen offset:2048 sc1
    buffer_load_dwordx4 v[52:55], v1, s[8:11], s26 offen offset:1024 sc1
    buffer_load_dwordx4 v[100:103], v1, s[8:11], s27 offen offset:1024 sc1
    buffer_load_dwordx4 v[148:151], v4, s[8:11], s28 offen offset:2304 sc1
    buffer_load_dwordx4 v[56:59], v1, s[8:11], s26 offen offset:2048 sc1
    buffer_load_dwordx4 v[104:107], v1, s[8:11], s27 offen offset:2048 sc1
    buffer_load_dwordx4 v[152:155], v4, s[8:11], s28 offen offset:2560 sc1
    buffer_load_dwordx4 v[60:63], v1, s[8:11], s26 offen offset:3072 sc1
    buffer_load_dwordx4 v[108:111], v1, s[8:11], s27 offen offset:3072 sc1
    buffer_load_dwordx4 v[156:159], v4, s[8:11], s28 offen offset:2816 sc1
    v_lshlrev_b32 v5, 2, v3
    v_sub_u32 v5, v2, v5
    v_mov_b32 v6, 0xf149f2ca
    v_cmp_gt_i32 vcc, 0, v5
    s_nop 1
    v_cndmask_b32 v192, 0, v6, vcc
    v_cmp_gt_i32 vcc, 1, v5
    s_nop 1
    v_cndmask_b32 v193, 0, v6, vcc
    v_cmp_gt_i32 vcc, 2, v5
    s_nop 1
    v_cndmask_b32 v194, 0, v6, vcc
    v_cmp_gt_i32 vcc, 3, v5
    s_nop 1
    v_cndmask_b32 v195, 0, v6, vcc
    v_cmp_gt_i32 vcc, 8, v5
    s_nop 1
    v_cndmask_b32 v196, 0, v6, vcc
    v_cmp_gt_i32 vcc, 9, v5
    s_nop 1
    v_cndmask_b32 v197, 0, v6, vcc
    v_cmp_gt_i32 vcc, 10, v5
    s_nop 1
    v_cndmask_b32 v198, 0, v6, vcc
    v_cmp_gt_i32 vcc, 11, v5
    s_nop 1
    v_cndmask_b32 v199, 0, v6, vcc
    v_cmp_gt_i32 vcc, 16, v5
    s_nop 1
    v_cndmask_b32 v200, 0, v6, vcc
    v_cmp_gt_i32 vcc, 17, v5
    s_nop 1
    v_cndmask_b32 v201, 0, v6, vcc
    v_cmp_gt_i32 vcc, 18, v5
    s_nop 1
    v_cndmask_b32 v202, 0, v6, vcc
    v_cmp_gt_i32 vcc, 19, v5
    s_nop 1
    v_cndmask_b32 v203, 0, v6, vcc
    v_cmp_gt_i32 vcc, 24, v5
    s_nop 1
    v_cndmask_b32 v204, 0, v6, vcc
    v_cmp_gt_i32 vcc, 25, v5
    s_nop 1
    v_cndmask_b32 v205, 0, v6, vcc
    v_cmp_gt_i32 vcc, 26, v5
    s_nop 1
    v_cndmask_b32 v206, 0, v6, vcc
    v_cmp_gt_i32 vcc, 27, v5
    s_nop 1
    v_cndmask_b32 v207, 0, v6, vcc
    s_waitcnt vmcnt(33)
    v_mfma_f32_32x32x16_bf16 v[160:175], v[64:67], v[16:19], 0
    v_mfma_f32_32x32x16_bf16 v[176:191], v[112:115], v[16:19], 0
    s_waitcnt vmcnt(30)
    v_mfma_f32_32x32x16_bf16 v[160:175], v[68:71], v[20:23], v[160:175]
    v_mfma_f32_32x32x16_bf16 v[176:191], v[116:119], v[20:23], v[176:191]
    s_waitcnt vmcnt(27)
    v_mfma_f32_32x32x16_bf16 v[160:175], v[72:75], v[24:27], v[160:175]
    v_mfma_f32_32x32x16_bf16 v[176:191], v[120:123], v[24:27], v[176:191]
    s_waitcnt vmcnt(24)
    v_mfma_f32_32x32x16_bf16 v[160:175], v[76:79], v[28:31], v[160:175]
    v_mfma_f32_32x32x16_bf16 v[176:191], v[124:127], v[28:31], v[176:191]
    s_waitcnt vmcnt(21)
    v_mfma_f32_32x32x16_bf16 v[160:175], v[80:83], v[32:35], v[160:175]
    v_mfma_f32_32x32x16_bf16 v[176:191], v[128:131], v[32:35], v[176:191]
    s_waitcnt vmcnt(18)
    v_mfma_f32_32x32x16_bf16 v[160:175], v[84:87], v[36:39], v[160:175]
    v_mfma_f32_32x32x16_bf16 v[176:191], v[132:135], v[36:39], v[176:191]
    s_waitcnt vmcnt(15)
    v_mfma_f32_32x32x16_bf16 v[160:175], v[88:91], v[40:43], v[160:175]
    v_mfma_f32_32x32x16_bf16 v[176:191], v[136:139], v[40:43], v[176:191]
    s_waitcnt vmcnt(12)
    v_mfma_f32_32x32x16_bf16 v[160:175], v[92:95], v[44:47], v[160:175]
    v_mfma_f32_32x32x16_bf16 v[176:191], v[140:143], v[44:47], v[176:191]
    s_waitcnt vmcnt(9)
    v_mfma_f32_32x32x16_bf16 v[160:175], v[96:99], v[48:51], v[160:175]
    v_mfma_f32_32x32x16_bf16 v[176:191], v[144:147], v[48:51], v[176:191]
    s_waitcnt vmcnt(6)
    v_mfma_f32_32x32x16_bf16 v[160:175], v[100:103], v[52:55], v[160:175]
    v_mfma_f32_32x32x16_bf16 v[176:191], v[148:151], v[52:55], v[176:191]
    s_waitcnt vmcnt(3)
    v_mfma_f32_32x32x16_bf16 v[160:175], v[104:107], v[56:59], v[160:175]
    v_mfma_f32_32x32x16_bf16 v[176:191], v[152:155], v[56:59], v[176:191]
    s_waitcnt vmcnt(0)
    v_mfma_f32_32x32x16_bf16 v[160:175], v[108:111], v[60:63], v[160:175]
    v_mfma_f32_32x32x16_bf16 v[176:191], v[156:159], v[60:63], v[176:191]
    s_nop 7
    s_nop 7
    v_mov_b32 v7, 0x3dd53b95
    v_fma_f32 v160, v160, v7, v192
    v_fma_f32 v161, v161, v7, v193
    v_fma_f32 v162, v162, v7, v194
    v_fma_f32 v163, v163, v7, v195
    v_fma_f32 v164, v164, v7, v196
    v_fma_f32 v165, v165, v7, v197
    v_fma_f32 v166, v166, v7, v198
    v_fma_f32 v167, v167, v7, v199
    v_fma_f32 v168, v168, v7, v200
    v_fma_f32 v169, v169, v7, v201
    v_fma_f32 v170, v170, v7, v202
    v_fma_f32 v171, v171, v7, v203
    v_fma_f32 v172, v172, v7, v204
    v_fma_f32 v173, v173, v7, v205
    v_fma_f32 v174, v174, v7, v206
    v_fma_f32 v175, v175, v7, v207
    v_mul_f32 v176, v176, v7
    v_mul_f32 v177, v177, v7
    v_mul_f32 v178, v178, v7
    v_mul_f32 v179, v179, v7
    v_max3_f32 v208, v160, v161, v162
    v_max3_f32 v208, v208, v163, v164
    v_max3_f32 v208, v208, v165, v166
    v_max3_f32 v208, v208, v167, v168
    v_max3_f32 v208, v208, v169, v170
    v_max3_f32 v208, v208, v171, v172
    v_max3_f32 v208, v208, v173, v174
    v_max3_f32 v208, v208, v175, v176
    v_max3_f32 v208, v208, v177, v178
    v_max_f32 v208, v208, v179
    v_mov_b32 v209, v208
    s_nop 1
    v_permlane32_swap_b32 v208, v209
    v_max_f32 v208, v208, v209
    v_sub_f32 v160, v160, v208
    v_sub_f32 v161, v161, v208
    v_sub_f32 v162, v162, v208
    v_sub_f32 v163, v163, v208
    v_sub_f32 v164, v164, v208
    v_sub_f32 v165, v165, v208
    v_sub_f32 v166, v166, v208
    v_sub_f32 v167, v167, v208
    v_sub_f32 v168, v168, v208
    v_sub_f32 v169, v169, v208
    v_sub_f32 v170, v170, v208
    v_sub_f32 v171, v171, v208
    v_sub_f32 v172, v172, v208
    v_sub_f32 v173, v173, v208
    v_sub_f32 v174, v174, v208
    v_sub_f32 v175, v175, v208
    v_sub_f32 v176, v176, v208
    v_sub_f32 v177, v177, v208
    v_sub_f32 v178, v178, v208
    v_sub_f32 v179, v179, v208
    v_exp_f32 v160, v160
    v_exp_f32 v161, v161
    v_exp_f32 v162, v162
    v_exp_f32 v163, v163
    v_exp_f32 v164, v164
    v_exp_f32 v165, v165
    v_exp_f32 v166, v166
    v_exp_f32 v167, v167
    v_exp_f32 v168, v168
    v_exp_f32 v169, v169
    v_exp_f32 v170, v170
    v_exp_f32 v171, v171
    v_exp_f32 v172, v172
    v_exp_f32 v173, v173
    v_exp_f32 v174, v174
    v_exp_f32 v175, v175
    v_exp_f32 v176, v176
    v_exp_f32 v177, v177
    v_exp_f32 v178, v178
    v_exp_f32 v179, v179
    s_nop 0
    v_add_f32 v210, v160, v161
    v_add_f32 v210, v210, v162
    v_add_f32 v210, v210, v163
    v_add_f32 v210, v210, v164
    v_add_f32 v210, v210, v165
    v_add_f32 v210, v210, v166
    v_add_f32 v210, v210, v167
    v_add_f32 v210, v210, v168
    v_add_f32 v210, v210, v169
    v_add_f32 v210, v210, v170
    v_add_f32 v210, v210, v171
    v_add_f32 v210, v210, v172
    v_add_f32 v210, v210, v173
    v_add_f32 v210, v210, v174
    v_add_f32 v210, v210, v175
    v_add_f32 v210, v210, v176
    v_add_f32 v210, v210, v177
    v_add_f32 v210, v210, v178
    v_add_f32 v210, v210, v179
    v_mov_b32 v209, v210
    s_nop 1
    v_permlane32_swap_b32 v210, v209
    v_add_f32 v210, v210, v209
    v_rcp_f32 v210, v210
    s_nop 0
    v_mul_f32 v160, v160, v210
    v_mul_f32 v161, v161, v210
    v_mul_f32 v162, v162, v210
    v_mul_f32 v163, v163, v210
    v_mul_f32 v164, v164, v210
    v_mul_f32 v165, v165, v210
    v_mul_f32 v166, v166, v210
    v_mul_f32 v167, v167, v210
    v_mul_f32 v168, v168, v210
    v_mul_f32 v169, v169, v210
    v_mul_f32 v170, v170, v210
    v_mul_f32 v171, v171, v210
    v_mul_f32 v172, v172, v210
    v_mul_f32 v173, v173, v210
    v_mul_f32 v174, v174, v210
    v_mul_f32 v175, v175, v210
    v_mul_f32 v176, v176, v210
    v_mul_f32 v177, v177, v210
    v_mul_f32 v178, v178, v210
    v_mul_f32 v179, v179, v210
    s_mul_i32 s25, s40, 81920
    s_mul_i32 s26, s41, 2560
    s_add_u32 s25, s25, s26
    s_add_u32 s25, s25, 214958080
    v_cvt_pk_bf16_f32 v16, v160, v161
    v_cvt_pk_bf16_f32 v17, v162, v163
    v_cvt_pk_bf16_f32 v18, v164, v165
    v_cvt_pk_bf16_f32 v19, v166, v167
    s_nop 1
    v_permlane32_swap_b32 v16, v18
    v_permlane32_swap_b32 v17, v19
    buffer_store_dwordx4 v[16:19], v1, s[8:11], s25 offen offset:512 sc1
    v_cvt_pk_bf16_f32 v20, v168, v169
    v_cvt_pk_bf16_f32 v21, v170, v171
    v_cvt_pk_bf16_f32 v22, v172, v173
    v_cvt_pk_bf16_f32 v23, v174, v175
    s_nop 1
    v_permlane32_swap_b32 v20, v22
    v_permlane32_swap_b32 v21, v23
    buffer_store_dwordx4 v[20:23], v1, s[8:11], s25 offen offset:1536 sc1
    v_cvt_pk_bf16_f32 v24, v176, v177
    v_cvt_pk_bf16_f32 v25, v178, v179
    v_lshlrev_b32 v4, 4, v2
    v_lshl_add_u32 v4, v3, 3, v4
    buffer_store_dwordx2 v[24:25], v4, s[8:11], s25 offen sc1
    s_waitcnt vmcnt(0)
    s_barrier
    s_cmp_lg_u32 s13, 0
    s_cbranch_scc1 layerb1_kernel_j_next
    s_mov_b64 exec, 1
    s_lshl_b32 s24, s40, 4
    s_add_u32 s24, s24, 30720
    v_mov_b32 v2, s24
    v_mov_b32 v3, 1
    buffer_atomic_add v3, v2, s[8:11], s48 offen sc1
    s_mov_b64 exec, -1
    s_branch layerb1_kernel_j_next
layerb1_kernel_j_b:
    s_sub_u32 s41, s41, 8
    v_lshlrev_b32 v1, 4, v0
    v_and_b32 v2, 31, v0
    v_lshrrev_b32 v3, 5, v0
    v_lshrrev_b32 v4, 3, v2
    v_mul_u32_u24 v4, 20480, v4
    v_and_b32 v5, 7, v2
    v_lshl_add_u32 v4, v5, 4, v4
    v_lshl_add_u32 v4, v3, 7, v4
    s_mul_i32 s24, s40, 1638400
    s_mul_i32 s25, s41, 163840
    s_add_u32 s24, s24, s25
    s_mul_i32 s25, s13, 5120
    s_add_u32 s24, s24, s25
    s_add_u32 s24, s24, 103809024
    s_add_u32 s28, s24, 81920
    s_mul_i32 s25, s40, 81920
    s_mul_i32 s26, s13, 20480
    s_add_u32 s25, s25, s26
    s_add_u32 s25, s25, 214958080
    v_mul_u32_u24 v6, 1280, v2
    v_lshl_add_u32 v6, v3, 4, v6
    s_mul_i32 s26, s40, 40960
    s_lshl_b32 s27, s41, 7
    s_add_u32 s26, s26, s27
    s_lshl_b32 s27, s13, 5
    s_add_u32 s26, s26, s27
    s_add_u32 s27, s26, 226492416
    buffer_load_dwordx4 v[8:11], v6, s[8:11], s27 offen
    buffer_load_dwordx4 a[160:163], v1, s[8:11], s25 offen offset:0 sc1
    buffer_load_dwordx4 a[0:3], v4, s[8:11], s24 offen offset:0 sc1
    buffer_load_dwordx4 a[80:83], v4, s[8:11], s28 offen offset:0 sc1
    buffer_load_dwordx4 a[164:167], v1, s[8:11], s25 offen offset:1024 sc1
    buffer_load_dwordx4 a[4:7], v4, s[8:11], s24 offen offset:256 sc1
    buffer_load_dwordx4 a[84:87], v4, s[8:11], s28 offen offset:256 sc1
    buffer_load_dwordx4 a[168:171], v1, s[8:11], s25 offen offset:2048 sc1
    buffer_load_dwordx4 a[8:11], v4, s[8:11], s24 offen offset:512 sc1
    buffer_load_dwordx4 a[88:91], v4, s[8:11], s28 offen offset:512 sc1
    buffer_load_dwordx4 a[172:175], v1, s[8:11], s25 offen offset:3072 sc1
    buffer_load_dwordx4 a[12:15], v4, s[8:11], s24 offen offset:768 sc1
    buffer_load_dwordx4 a[92:95], v4, s[8:11], s28 offen offset:768 sc1
    s_add_u32 s25, s25, 4096
    buffer_load_dwordx4 a[176:179], v1, s[8:11], s25 offen offset:0 sc1
    buffer_load_dwordx4 a[16:19], v4, s[8:11], s24 offen offset:1024 sc1
    buffer_load_dwordx4 a[96:99], v4, s[8:11], s28 offen offset:1024 sc1
    buffer_load_dwordx4 a[180:183], v1, s[8:11], s25 offen offset:1024 sc1
    buffer_load_dwordx4 a[20:23], v4, s[8:11], s24 offen offset:1280 sc1
    buffer_load_dwordx4 a[100:103], v4, s[8:11], s28 offen offset:1280 sc1
    buffer_load_dwordx4 a[184:187], v1, s[8:11], s25 offen offset:2048 sc1
    buffer_load_dwordx4 a[24:27], v4, s[8:11], s24 offen offset:1536 sc1
    buffer_load_dwordx4 a[104:107], v4, s[8:11], s28 offen offset:1536 sc1
    buffer_load_dwordx4 a[188:191], v1, s[8:11], s25 offen offset:3072 sc1
    buffer_load_dwordx4 a[28:31], v4, s[8:11], s24 offen offset:1792 sc1
    buffer_load_dwordx4 a[108:111], v4, s[8:11], s28 offen offset:1792 sc1
    s_add_u32 s25, s25, 4096
    buffer_load_dwordx4 a[192:195], v1, s[8:11], s25 offen offset:0 sc1
    buffer_load_dwordx4 a[32:35], v4, s[8:11], s24 offen offset:2048 sc1
    buffer_load_dwordx4 a[112:115], v4, s[8:11], s28 offen offset:2048 sc1
    buffer_load_dwordx4 a[196:199], v1, s[8:11], s25 offen offset:1024 sc1
    buffer_load_dwordx4 a[36:39], v4, s[8:11], s24 offen offset:2304 sc1
    buffer_load_dwordx4 a[116:119], v4, s[8:11], s28 offen offset:2304 sc1
    buffer_load_dwordx4 a[200:203], v1, s[8:11], s25 offen offset:2048 sc1
    buffer_load_dwordx4 a[40:43], v4, s[8:11], s24 offen offset:2560 sc1
    buffer_load_dwordx4 a[120:123], v4, s[8:11], s28 offen offset:2560 sc1
    buffer_load_dwordx4 a[204:207], v1, s[8:11], s25 offen offset:3072 sc1
    buffer_load_dwordx4 a[44:47], v4, s[8:11], s24 offen offset:2816 sc1
    buffer_load_dwordx4 a[124:127], v4, s[8:11], s28 offen offset:2816 sc1
    s_add_u32 s25, s25, 4096
    buffer_load_dwordx4 a[208:211], v1, s[8:11], s25 offen offset:0 sc1
    buffer_load_dwordx4 a[48:51], v4, s[8:11], s24 offen offset:3072 sc1
    buffer_load_dwordx4 a[128:131], v4, s[8:11], s28 offen offset:3072 sc1
    buffer_load_dwordx4 a[212:215], v1, s[8:11], s25 offen offset:1024 sc1
    buffer_load_dwordx4 a[52:55], v4, s[8:11], s24 offen offset:3328 sc1
    buffer_load_dwordx4 a[132:135], v4, s[8:11], s28 offen offset:3328 sc1
    buffer_load_dwordx4 a[216:219], v1, s[8:11], s25 offen offset:2048 sc1
    buffer_load_dwordx4 a[56:59], v4, s[8:11], s24 offen offset:3584 sc1
    buffer_load_dwordx4 a[136:139], v4, s[8:11], s28 offen offset:3584 sc1
    buffer_load_dwordx4 a[220:223], v1, s[8:11], s25 offen offset:3072 sc1
    buffer_load_dwordx4 a[60:63], v4, s[8:11], s24 offen offset:3840 sc1
    buffer_load_dwordx4 a[140:143], v4, s[8:11], s28 offen offset:3840 sc1
    s_add_u32 s25, s25, 4096
    s_add_u32 s24, s24, 4096
    s_add_u32 s28, s28, 4096
    buffer_load_dwordx4 a[224:227], v1, s[8:11], s25 offen offset:0 sc1
    buffer_load_dwordx4 a[64:67], v4, s[8:11], s24 offen offset:0 sc1
    buffer_load_dwordx4 a[144:147], v4, s[8:11], s28 offen offset:0 sc1
    buffer_load_dwordx4 a[228:231], v1, s[8:11], s25 offen offset:1024 sc1
    buffer_load_dwordx4 a[68:71], v4, s[8:11], s24 offen offset:256 sc1
    buffer_load_dwordx4 a[148:151], v4, s[8:11], s28 offen offset:256 sc1
    buffer_load_dwordx4 a[232:235], v1, s[8:11], s25 offen offset:2048 sc1
    buffer_load_dwordx4 a[72:75], v4, s[8:11], s24 offen offset:512 sc1
    buffer_load_dwordx4 a[152:155], v4, s[8:11], s28 offen offset:512 sc1
    buffer_load_dwordx4 a[236:239], v1, s[8:11], s25 offen offset:3072 sc1
    buffer_load_dwordx4 a[76:79], v4, s[8:11], s24 offen offset:768 sc1
    buffer_load_dwordx4 a[156:159], v4, s[8:11], s28 offen offset:768 sc1
    s_waitcnt vmcnt(57)
    v_mfma_f32_32x32x16_bf16 v[16:31], a[0:3], a[160:163], 0
    v_mfma_f32_32x32x16_bf16 v[32:47], a[80:83], a[160:163], 0
    s_waitcnt vmcnt(54)
    v_mfma_f32_32x32x16_bf16 v[16:31], a[4:7], a[164:167], v[16:31]
    v_mfma_f32_32x32x16_bf16 v[32:47], a[84:87], a[164:167], v[32:47]
    s_waitcnt vmcnt(51)
    v_mfma_f32_32x32x16_bf16 v[16:31], a[8:11], a[168:171], v[16:31]
    v_mfma_f32_32x32x16_bf16 v[32:47], a[88:91], a[168:171], v[32:47]
    s_waitcnt vmcnt(48)
    v_mfma_f32_32x32x16_bf16 v[16:31], a[12:15], a[172:175], v[16:31]
    v_mfma_f32_32x32x16_bf16 v[32:47], a[92:95], a[172:175], v[32:47]
    s_waitcnt vmcnt(45)
    v_mfma_f32_32x32x16_bf16 v[16:31], a[16:19], a[176:179], v[16:31]
    v_mfma_f32_32x32x16_bf16 v[32:47], a[96:99], a[176:179], v[32:47]
    s_waitcnt vmcnt(42)
    v_mfma_f32_32x32x16_bf16 v[16:31], a[20:23], a[180:183], v[16:31]
    v_mfma_f32_32x32x16_bf16 v[32:47], a[100:103], a[180:183], v[32:47]
    s_waitcnt vmcnt(39)
    v_mfma_f32_32x32x16_bf16 v[16:31], a[24:27], a[184:187], v[16:31]
    v_mfma_f32_32x32x16_bf16 v[32:47], a[104:107], a[184:187], v[32:47]
    s_waitcnt vmcnt(36)
    v_mfma_f32_32x32x16_bf16 v[16:31], a[28:31], a[188:191], v[16:31]
    v_mfma_f32_32x32x16_bf16 v[32:47], a[108:111], a[188:191], v[32:47]
    s_waitcnt vmcnt(33)
    v_mfma_f32_32x32x16_bf16 v[16:31], a[32:35], a[192:195], v[16:31]
    v_mfma_f32_32x32x16_bf16 v[32:47], a[112:115], a[192:195], v[32:47]
    s_waitcnt vmcnt(30)
    v_mfma_f32_32x32x16_bf16 v[16:31], a[36:39], a[196:199], v[16:31]
    v_mfma_f32_32x32x16_bf16 v[32:47], a[116:119], a[196:199], v[32:47]
    s_waitcnt vmcnt(27)
    v_mfma_f32_32x32x16_bf16 v[16:31], a[40:43], a[200:203], v[16:31]
    v_mfma_f32_32x32x16_bf16 v[32:47], a[120:123], a[200:203], v[32:47]
    s_waitcnt vmcnt(24)
    v_mfma_f32_32x32x16_bf16 v[16:31], a[44:47], a[204:207], v[16:31]
    v_mfma_f32_32x32x16_bf16 v[32:47], a[124:127], a[204:207], v[32:47]
    s_waitcnt vmcnt(21)
    v_mfma_f32_32x32x16_bf16 v[16:31], a[48:51], a[208:211], v[16:31]
    v_mfma_f32_32x32x16_bf16 v[32:47], a[128:131], a[208:211], v[32:47]
    s_waitcnt vmcnt(18)
    v_mfma_f32_32x32x16_bf16 v[16:31], a[52:55], a[212:215], v[16:31]
    v_mfma_f32_32x32x16_bf16 v[32:47], a[132:135], a[212:215], v[32:47]
    s_waitcnt vmcnt(15)
    v_mfma_f32_32x32x16_bf16 v[16:31], a[56:59], a[216:219], v[16:31]
    v_mfma_f32_32x32x16_bf16 v[32:47], a[136:139], a[216:219], v[32:47]
    s_waitcnt vmcnt(12)
    v_mfma_f32_32x32x16_bf16 v[16:31], a[60:63], a[220:223], v[16:31]
    v_mfma_f32_32x32x16_bf16 v[32:47], a[140:143], a[220:223], v[32:47]
    s_waitcnt vmcnt(9)
    v_mfma_f32_32x32x16_bf16 v[16:31], a[64:67], a[224:227], v[16:31]
    v_mfma_f32_32x32x16_bf16 v[32:47], a[144:147], a[224:227], v[32:47]
    s_waitcnt vmcnt(6)
    v_mfma_f32_32x32x16_bf16 v[16:31], a[68:71], a[228:231], v[16:31]
    v_mfma_f32_32x32x16_bf16 v[32:47], a[148:151], a[228:231], v[32:47]
    s_waitcnt vmcnt(3)
    v_mfma_f32_32x32x16_bf16 v[16:31], a[72:75], a[232:235], v[16:31]
    v_mfma_f32_32x32x16_bf16 v[32:47], a[152:155], a[232:235], v[32:47]
    s_waitcnt vmcnt(0)
    v_mfma_f32_32x32x16_bf16 v[16:31], a[76:79], a[236:239], v[16:31]
    v_mfma_f32_32x32x16_bf16 v[32:47], a[156:159], a[236:239], v[32:47]
    s_lshl_b32 s27, s13, 11
    v_add_u32 v7, s27, v1
    s_nop 7
    s_nop 7
    ds_write_b128 v7, v[16:19] offset:0
    ds_write_b128 v7, v[20:23] offset:1024
    ds_write_b128 v7, v[24:27] offset:8192
    ds_write_b128 v7, v[28:31] offset:9216
    ds_write_b128 v7, v[32:35] offset:16384
    ds_write_b128 v7, v[36:39] offset:17408
    ds_write_b128 v7, v[40:43] offset:24576
    ds_write_b128 v7, v[44:47] offset:25600
    s_waitcnt lgkmcnt(0)
    s_barrier
    s_lshl_b32 s27, s13, 13
    v_add_u32 v7, s27, v1
    ds_read_b128 v[48:51], v7 offset:0
    ds_read_b128 v[52:55], v7 offset:1024
    ds_read_b128 v[56:59], v7 offset:2048
    ds_read_b128 v[60:63], v7 offset:3072
    ds_read_b128 v[64:67], v7 offset:4096
    ds_read_b128 v[68:71], v7 offset:5120
    ds_read_b128 v[72:75], v7 offset:6144
    ds_read_b128 v[76:79], v7 offset:7168
    s_waitcnt lgkmcnt(4)
    v_add_f32 v48, v48, v56
    v_add_f32 v49, v49, v57
    v_add_f32 v50, v50, v58
    v_add_f32 v51, v51, v59
    v_add_f32 v52, v52, v60
    v_add_f32 v53, v53, v61
    v_add_f32 v54, v54, v62
    v_add_f32 v55, v55, v63
    s_waitcnt lgkmcnt(0)
    v_add_f32 v64, v64, v72
    v_add_f32 v65, v65, v73
    v_add_f32 v66, v66, v74
    v_add_f32 v67, v67, v75
    v_add_f32 v68, v68, v76
    v_add_f32 v69, v69, v77
    v_add_f32 v70, v70, v78
    v_add_f32 v71, v71, v79
    v_add_f32 v48, v48, v64
    v_add_f32 v49, v49, v65
    v_add_f32 v50, v50, v66
    v_add_f32 v51, v51, v67
    v_add_f32 v52, v52, v68
    v_add_f32 v53, v53, v69
    v_add_f32 v54, v54, v70
    v_add_f32 v55, v55, v71
    v_cvt_pk_bf16_f32 v16, v48, v49
    v_cvt_pk_bf16_f32 v17, v50, v51
    v_cvt_pk_bf16_f32 v18, v52, v53
    v_cvt_pk_bf16_f32 v19, v54, v55
    s_nop 1
    v_permlane32_swap_b32 v16, v18
    v_permlane32_swap_b32 v17, v19
    s_nop 1
    v_lshlrev_b32 v48, 16, v16
    v_and_b32 v49, 0xffff0000, v16
    v_lshlrev_b32 v50, 16, v8
    v_and_b32 v51, 0xffff0000, v8
    v_add_f32 v48, v48, v50
    v_add_f32 v49, v49, v51
    v_cvt_pk_bf16_f32 v16, v48, v49
    v_lshlrev_b32 v48, 16, v17
    v_and_b32 v49, 0xffff0000, v17
    v_lshlrev_b32 v50, 16, v9
    v_and_b32 v51, 0xffff0000, v9
    v_add_f32 v48, v48, v50
    v_add_f32 v49, v49, v51
    v_cvt_pk_bf16_f32 v17, v48, v49
    v_lshlrev_b32 v48, 16, v18
    v_and_b32 v49, 0xffff0000, v18
    v_lshlrev_b32 v50, 16, v10
    v_and_b32 v51, 0xffff0000, v10
    v_add_f32 v48, v48, v50
    v_add_f32 v49, v49, v51
    v_cvt_pk_bf16_f32 v18, v48, v49
    v_lshlrev_b32 v48, 16, v19
    v_and_b32 v49, 0xffff0000, v19
    v_lshlrev_b32 v50, 16, v11
    v_and_b32 v51, 0xffff0000, v11
    v_add_f32 v48, v48, v50
    v_add_f32 v49, v49, v51
    v_cvt_pk_bf16_f32 v19, v48, v49
    buffer_store_dwordx4 v[16:19], v6, s[84:87], s26 offen
    s_branch layerb1_kernel_j_next
layerb1_kernel_j_giveup:
    s_mov_b64 exec, -1
    v_mov_b32 v2, 0
    v_mov_b32 v3, -1
    ds_write_b32 v2, v3 offset:32768
    s_waitcnt lgkmcnt(0)
    s_barrier
    s_branch layerb1_kernel_bail
layerb1_kernel_j_done:
    s_branch layerb1_kernel_end
layerb1_kernel_bail:
    s_mov_b64 exec, 1
    s_load_dwordx2 s[6:7], s[0:1], 88
    s_waitcnt lgkmcnt(0)
    s_mov_b32 s24, s6
    s_mov_b32 s25, s7
    s_mov_b32 s26, 256
    s_mov_b32 s27, 0x00020000
    v_mov_b32 v1, 0xdead
    v_mov_b32 v2, s14
    v_mov_b32 v3, 0
    buffer_store_dword v1, v3, s[24:27], 0 offen
    buffer_store_dword v2, v3, s[24:27], 0 offen offset:4
layerb1_kernel_end:
layerb1_kernel_end0:
    s_endpgm
.section .rodata,"a"
.p2align 6
.amdhsa_kernel layerb1_kernel
  .amdhsa_next_free_vgpr 512
  .amdhsa_next_free_sgpr 100
  .amdhsa_accum_offset 256
  .amdhsa_group_segment_fixed_size 0
  .amdhsa_kernarg_size 104
  .amdhsa_user_sgpr_count 2
  .amdhsa_user_sgpr_kernarg_segment_ptr 1
  .amdhsa_system_sgpr_workgroup_id_x 1
.end_amdhsa_kernel
.text
.globl afront2_kernel
.p2align 8
.type afront2_kernel,@function
afront2_kernel:
    s_cmp_ge_u32 s2, 256
    s_cbranch_scc1 afront2_kernel_end
    s_load_dwordx2 s[4:5], s[0:1], 96
    v_lshrrev_b32 v1, 6, v0
    v_and_b32 v0, 63, v0
    s_nop 0
    v_readfirstlane_b32 s13, v1
    s_waitcnt lgkmcnt(0)
    s_mov_b32 s8, s4
    s_mov_b32 s9, s5
    s_mov_b32 s10, 268435456
    s_mov_b32 s11, 0x00020000
    s_add_u32 s16, s4, 247463936
    s_addc_u32 s17, s5, 0
    s_mov_b32 s18, 2621440
    s_mov_b32 s19, 0x00020000
    s_and_b32 s28, s2, 7
    s_lshr_b32 s29, s2, 3
    s_and_b32 s30, s28, 3
    s_lshl_b32 s30, s30, 2
    s_and_b32 s31, s29, 3
    s_add_u32 s20, s30, s31
    s_lshr_b32 s30, s28, 2
    s_lshl_b32 s30, s30, 3
    s_lshr_b32 s31, s29, 2
    s_add_u32 s21, s30, s31
    s_lshr_b32 s22, s13, 1
    s_and_b32 s23, s13, 1
    s_lshl_b32 s26, s20, 1
    s_add_u32 s26, s26, s23
    s_mov_b32 s27, 0x3f803f80
    s_lshl_b32 s28, s21, 7
    s_lshl_b32 s29, s13, 5
    s_add_u32 s28, s28, s29
    s_mul_i32 s24, s28, 1280
    s_lshl_b32 s28, s20, 1
    s_add_u32 s28, s28, s22
    s_mul_i32 s25, s28, 81920
    s_lshl_b32 s29, s23, 12
    s_add_u32 s25, s25, s29
    s_add_u32 s25, s25, 243269632
    v_lshlrev_b32 v1, 4, v0
    v_lshrrev_b32 v16, 3, v0
    v_mul_u32_u24 v16, 1280, v16
    v_and_b32 v17, 7, v0
    v_lshrrev_b32 v18, 4, v0
    v_xor_b32 v19, v17, v18
    v_lshl_add_u32 v2, v19, 4, v16
    v_xor_b32 v19, 4, v19
    v_lshl_add_u32 v3, v19, 4, v16
    s_lshl_b32 s28, s13, 12
    s_mov_b32 m0, s28
    s_add_u32 s29, s24, 0
    buffer_load_dwordx4 v2, s[16:19], s29 offen offset:0 lds
    s_add_u32 s29, s29, 9216
    buffer_load_dwordx4 v3, s[16:19], s29 offen offset:1024 lds
    s_add_u32 s29, s29, 9216
    buffer_load_dwordx4 v2, s[16:19], s29 offen offset:2048 lds
    s_add_u32 s29, s29, 9216
    buffer_load_dwordx4 v3, s[16:19], s29 offen offset:3072 lds
    s_add_u32 s28, s28, 16384
    s_mov_b32 m0, s28
    s_add_u32 s29, s25, 0
    buffer_load_dwordx4 v1, s[8:11], s29 offen offset:0 lds
    buffer_load_dwordx4 v1, s[8:11], s29 offen offset:1024 lds
    buffer_load_dwordx4 v1, s[8:11], s29 offen offset:2048 lds
    buffer_load_dwordx4 v1, s[8:11], s29 offen offset:3072 lds
    s_lshl_b32 s28, s13, 12
    s_add_u32 s28, s28, 32768
    s_mov_b32 m0, s28
    s_add_u32 s29, s24, 128
    buffer_load_dwordx4 v2, s[16:19], s29 offen offset:0 lds
    s_add_u32 s29, s29, 9216
    buffer_load_dwordx4 v3, s[16:19], s29 offen offset:1024 lds
    s_add_u32 s29, s29, 9216
    buffer_load_dwordx4 v2, s[16:19], s29 offen offset:2048 lds
    s_add_u32 s29, s29, 9216
    buffer_load_dwordx4 v3, s[16:19], s29 offen offset:3072 lds
    s_add_u32 s28, s28, 16384
    s_mov_b32 m0, s28
    s_add_u32 s29, s25, 8192
    buffer_load_dwordx4 v1, s[8:11], s29 offen offset:0 lds
    buffer_load_dwordx4 v1, s[8:11], s29 offen offset:1024 lds
    buffer_load_dwordx4 v1, s[8:11], s29 offen offset:2048 lds
    buffer_load_dwordx4 v1, s[8:11], s29 offen offset:3072 lds
    s_lshl_b32 s28, s13, 12
    s_add_u32 s28, s28, 65536
    s_mov_b32 m0, s28
    s_add_u32 s29, s24, 256
    buffer_load_dwordx4 v2, s[16:19], s29 offen offset:0 lds
    s_add_u32 s29, s29, 9216
    buffer_load_dwordx4 v3, s[16:19], s29 offen offset:1024 lds
    s_add_u32 s29, s29, 9216
    buffer_load_dwordx4 v2, s[16:19], s29 offen offset:2048 lds
    s_add_u32 s29, s29, 9216
    buffer_load_dwordx4 v3, s[16:19], s29 offen offset:3072 lds
    s_add_u32 s28, s28, 16384
    s_mov_b32 m0, s28
    s_add_u32 s29, s25, 16384
    buffer_load_dwordx4 v1, s[8:11], s29 offen offset:0 lds
    buffer_load_dwordx4 v1, s[8:11], s29 offen offset:1024 lds
    buffer_load_dwordx4 v1, s[8:11], s29 offen offset:2048 lds
    buffer_load_dwordx4 v1, s[8:11], s29 offen offset:3072 lds
    v_and_b32 v16, 31, v0
    v_lshrrev_b32 v17, 5, v0
    v_lshrrev_b32 v18, 1, v16
    v_and_b32 v18, 7, v18
    v_xor_b32 v18, v18, v17
    v_lshlrev_b32 v18, 4, v18
    v_lshl_add_u32 v18, v16, 7, v18
    s_lshl_b32 s28, s22, 13
    v_add_u32 v18, s28, v18
    v_xor_b32 v6, 0, v18
    v_add_u32 v10, 65536, v6
    v_xor_b32 v7, 32, v18
    v_add_u32 v11, 65536, v7
    v_xor_b32 v8, 64, v18
    v_add_u32 v12, 65536, v8
    v_xor_b32 v9, 96, v18
    v_add_u32 v13, 65536, v9
    s_lshl_b32 s28, s23, 13
    s_add_u32 s28, s28, 16384
    v_add_u32 v4, s28, v1
    v_add_u32 v5, 65536, v4
    v_mov_b32 v20, 0
    v_mov_b32 v21, 0
    v_mov_b32 v22, 0
    v_mov_b32 v23, 0
    s_waitcnt vmcnt(16)
    s_barrier
    ds_read_b128 v[32:35], v6 offset:0
    ds_read_b128 v[36:39], v6 offset:4096
    ds_read_b128 v[40:43], v4 offset:0
    ds_read_b128 v[44:47], v4 offset:1024
    s_cmp_eq_u32 s23, 1
    s_cbranch_scc1 afront2_kernel_af_h1
    s_waitcnt lgkmcnt(0)
    v_mfma_f32_32x32x16_bf16 v[64:79], v[32:35], v[40:43], 0
    v_dot2c_f32_bf16 v20, s27, v32
    v_dot2c_f32_bf16 v22, v32, v32
    v_mfma_f32_32x32x16_bf16 v[96:111], v[32:35], v[44:47], 0
    ds_read_b128 v[48:51], v7 offset:0
    v_dot2c_f32_bf16 v21, s27, v33
    v_mfma_f32_32x32x16_bf16 v[128:143], v[44:47], v[32:35], 0
    ds_read_b128 v[52:55], v7 offset:4096
    v_dot2c_f32_bf16 v23, v33, v33
    v_mfma_f32_32x32x16_bf16 v[80:95], v[36:39], v[40:43], 0
    ds_read_b128 v[56:59], v4 offset:2048
    v_dot2c_f32_bf16 v20, s27, v34
    v_dot2c_f32_bf16 v22, v34, v34
    v_mfma_f32_32x32x16_bf16 v[112:127], v[36:39], v[44:47], 0
    ds_read_b128 v[60:63], v4 offset:3072
    v_dot2c_f32_bf16 v21, s27, v35
    v_mfma_f32_32x32x16_bf16 v[144:159], v[44:47], v[36:39], 0
    v_dot2c_f32_bf16 v23, v35, v35
    s_waitcnt lgkmcnt(0)
    v_mfma_f32_32x32x16_bf16 v[64:79], v[48:51], v[56:59], v[64:79]
    v_dot2c_f32_bf16 v20, s27, v48
    v_dot2c_f32_bf16 v22, v48, v48
    v_mfma_f32_32x32x16_bf16 v[96:111], v[48:51], v[60:63], v[96:111]
    ds_read_b128 v[32:35], v8 offset:0
    v_dot2c_f32_bf16 v21, s27, v49
    v_mfma_f32_32x32x16_bf16 v[128:143], v[60:63], v[48:51], v[128:143]
    ds_read_b128 v[36:39], v8 offset:4096
    v_dot2c_f32_bf16 v23, v49, v49
    v_mfma_f32_32x32x16_bf16 v[80:95], v[52:55], v[56:59], v[80:95]
    ds_read_b128 v[40:43], v4 offset:4096
    v_dot2c_f32_bf16 v20, s27, v50
    v_dot2c_f32_bf16 v22, v50, v50
    v_mfma_f32_32x32x16_bf16 v[112:127], v[52:55], v[60:63], v[112:127]
    ds_read_b128 v[44:47], v4 offset:5120
    v_dot2c_f32_bf16 v21, s27, v51
    v_mfma_f32_32x32x16_bf16 v[144:159], v[60:63], v[52:55], v[144:159]
    v_dot2c_f32_bf16 v23, v51, v51
    s_waitcnt lgkmcnt(0)
    v_mfma_f32_32x32x16_bf16 v[64:79], v[32:35], v[40:43], v[64:79]
    v_dot2c_f32_bf16 v20, s27, v32
    v_dot2c_f32_bf16 v22, v32, v32
    v_mfma_f32_32x32x16_bf16 v[96:111], v[32:35], v[44:47], v[96:111]
    ds_read_b128 v[48:51], v9 offset:0
    v_dot2c_f32_bf16 v21, s27, v33
    v_mfma_f32_32x32x16_bf16 v[128:143], v[44:47], v[32:35], v[128:143]
    ds_read_b128 v[52:55], v9 offset:4096
    v_dot2c_f32_bf16 v23, v33, v33
    v_mfma_f32_32x32x16_bf16 v[80:95], v[36:39], v[40:43], v[80:95]
    ds_read_b128 v[56:59], v4 offset:6144
    v_dot2c_f32_bf16 v20, s27, v34
    v_dot2c_f32_bf16 v22, v34, v34
    v_mfma_f32_32x32x16_bf16 v[112:127], v[36:39], v[44:47], v[112:127]
    ds_read_b128 v[60:63], v4 offset:7168
    v_dot2c_f32_bf16 v21, s27, v35
    v_mfma_f32_32x32x16_bf16 v[144:159], v[44:47], v[36:39], v[144:159]
    v_dot2c_f32_bf16 v23, v35, v35
    s_waitcnt vmcnt(8)
    s_barrier
    s_lshl_b32 s28, s13, 12
    s_add_u32 s28, s28, 98304
    s_mov_b32 m0, s28
    s_add_u32 s29, s24, 384
    buffer_load_dwordx4 v2, s[16:19], s29 offen offset:0 lds
    s_add_u32 s29, s29, 9216
    buffer_load_dwordx4 v3, s[16:19], s29 offen offset:1024 lds
    s_add_u32 s29, s29, 9216
    buffer_load_dwordx4 v2, s[16:19], s29 offen offset:2048 lds
    s_add_u32 s29, s29, 9216
    buffer_load_dwordx4 v3, s[16:19], s29 offen offset:3072 lds
    s_add_u32 s28, s28, 16384
    s_mov_b32 m0, s28
    s_add_u32 s29, s25, 24576
    buffer_load_dwordx4 v1, s[8:11], s29 offen offset:0 lds
    buffer_load_dwordx4 v1, s[8:11], s29 offen offset:1024 lds
    buffer_load_dwordx4 v1, s[8:11], s29 offen offset:2048 lds
    buffer_load_dwordx4 v1, s[8:11], s29 offen offset:3072 lds
    s_waitcnt lgkmcnt(0)
    v_mfma_f32_32x32x16_bf16 v[64:79], v[48:51], v[56:59], v[64:79]
    v_dot2c_f32_bf16 v20, s27, v48
    v_dot2c_f32_bf16 v22, v48, v48
    v_mfma_f32_32x32x16_bf16 v[96:111], v[48:51], v[60:63], v[96:111]
    ds_read_b128 v[32:35], v6 offset:32768
    v_dot2c_f32_bf16 v21, s27, v49
    v_mfma_f32_32x32x16_bf16 v[128:143], v[60:63], v[48:51], v[128:143]
    ds_read_b128 v[36:39], v6 offset:36864
    v_dot2c_f32_bf16 v23, v49, v49
    v_mfma_f32_32x32x16_bf16 v[80:95], v[52:55], v[56:59], v[80:95]
    ds_read_b128 v[40:43], v4 offset:32768
    v_dot2c_f32_bf16 v20, s27, v50
    v_dot2c_f32_bf16 v22, v50, v50
    v_mfma_f32_32x32x16_bf16 v[112:127], v[52:55], v[60:63], v[112:127]
    ds_read_b128 v[44:47], v4 offset:33792
    v_dot2c_f32_bf16 v21, s27, v51
    v_mfma_f32_32x32x16_bf16 v[144:159], v[60:63], v[52:55], v[144:159]
    v_dot2c_f32_bf16 v23, v51, v51
    s_waitcnt lgkmcnt(0)
    v_mfma_f32_32x32x16_bf16 v[64:79], v[32:35], v[40:43], v[64:79]
    v_dot2c_f32_bf16 v20, s27, v32
    v_dot2c_f32_bf16 v22, v32, v32
    v_mfma_f32_32x32x16_bf16 v[96:111], v[32:35], v[44:47], v[96:111]
    ds_read_b128 v[48:51], v7 offset:32768
    v_dot2c_f32_bf16 v21, s27, v33
    v_mfma_f32_32x32x16_bf16 v[128:143], v[44:47], v[32:35], v[128:143]
    ds_read_b128 v[52:55], v7 offset:36864
    v_dot2c_f32_bf16 v23, v33, v33
    v_mfma_f32_32x32x16_bf16 v[80:95], v[36:39], v[40:43], v[80:95]
    ds_read_b128 v[56:59], v4 offset:34816
    v_dot2c_f32_bf16 v20, s27, v34
    v_dot2c_f32_bf16 v22, v34, v34
    v_mfma_f32_32x32x16_bf16 v[112:127], v[36:39], v[44:47], v[112:127]
    ds_read_b128 v[60:63], v4 offset:35840
    v_dot2c_f32_bf16 v21, s27, v35
    v_mfma_f32_32x32x16_bf16 v[144:159], v[44:47], v[36:39], v[144:159]
    v_dot2c_f32_bf16 v23, v35, v35
    s_waitcnt lgkmcnt(0)
    v_mfma_f32_32x32x16_bf16 v[64:79], v[48:51], v[56:59], v[64:79]
    v_dot2c_f32_bf16 v20, s27, v48
    v_dot2c_f32_bf16 v22, v48, v48
    v_mfma_f32_32x32x16_bf16 v[96:111], v[48:51], v[60:63], v[96:111]
    ds_read_b128 v[32:35], v8 offset:32768
    v_dot2c_f32_bf16 v21, s27, v49
    v_mfma_f32_32x32x16_bf16 v[128:143], v[60:63], v[48:51], v[128:143]
    ds_read_b128 v[36:39], v8 offset:36864
    v_dot2c_f32_bf16 v23, v49, v49
    v_mfma_f32_32x32x16_bf16 v[80:95], v[52:55], v[56:59], v[80:95]
    ds_read_b128 v[40:43], v4 offset:36864
    v_dot2c_f32_bf16 v20, s27, v50
    v_dot2c_f32_bf16 v22, v50, v50
    v_mfma_f32_32x32x16_bf16 v[112:127], v[52:55], v[60:63], v[112:127]
    ds_read_b128 v[44:47], v4 offset:37888
    v_dot2c_f32_bf16 v21, s27, v51
    v_mfma_f32_32x32x16_bf16 v[144:159], v[60:63], v[52:55], v[144:159]
    v_dot2c_f32_bf16 v23, v51, v51
    s_waitcnt lgkmcnt(0)
    v_mfma_f32_32x32x16_bf16 v[64:79], v[32:35], v[40:43], v[64:79]
    v_dot2c_f32_bf16 v20, s27, v32
    v_dot2c_f32_bf16 v22, v32, v32
    v_mfma_f32_32x32x16_bf16 v[96:111], v[32:35], v[44:47], v[96:111]
    ds_read_b128 v[48:51], v9 offset:32768
    v_dot2c_f32_bf16 v21, s27, v33
    v_mfma_f32_32x32x16_bf16 v[128:143], v[44:47], v[32:35], v[128:143]
    ds_read_b128 v[52:55], v9 offset:36864
    v_dot2c_f32_bf16 v23, v33, v33
    v_mfma_f32_32x32x16_bf16 v[80:95], v[36:39], v[40:43], v[80:95]
    ds_read_b128 v[56:59], v4 offset:38912
    v_dot2c_f32_bf16 v20, s27, v34
    v_dot2c_f32_bf16 v22, v34, v34
    v_mfma_f32_32x32x16_bf16 v[112:127], v[36:39], v[44:47], v[112:127]
    ds_read_b128 v[60:63], v4 offset:39936
    v_dot2c_f32_bf16 v21, s27, v35
    v_mfma_f32_32x32x16_bf16 v[144:159], v[44:47], v[36:39], v[144:159]
    v_dot2c_f32_bf16 v23, v35, v35
    s_waitcnt vmcnt(8)
    s_barrier
    s_lshl_b32 s28, s13, 12
    s_mov_b32 m0, s28
    s_add_u32 s29, s24, 512
    buffer_load_dwordx4 v2, s[16:19], s29 offen offset:0 lds
    s_add_u32 s29, s29, 9216
    buffer_load_dwordx4 v3, s[16:19], s29 offen offset:1024 lds
    s_add_u32 s29, s29, 9216
    buffer_load_dwordx4 v2, s[16:19], s29 offen offset:2048 lds
    s_add_u32 s29, s29, 9216
    buffer_load_dwordx4 v3, s[16:19], s29 offen offset:3072 lds
    s_add_u32 s28, s28, 16384
    s_mov_b32 m0, s28
    s_add_u32 s29, s25, 32768
    buffer_load_dwordx4 v1, s[8:11], s29 offen offset:0 lds
    buffer_load_dwordx4 v1, s[8:11], s29 offen offset:1024 lds
    buffer_load_dwordx4 v1, s[8:11], s29 offen offset:2048 lds
    buffer_load_dwordx4 v1, s[8:11], s29 offen offset:3072 lds
    s_waitcnt lgkmcnt(0)
    v_mfma_f32_32x32x16_bf16 v[64:79], v[48:51], v[56:59], v[64:79]
    v_dot2c_f32_bf16 v20, s27, v48
    v_dot2c_f32_bf16 v22, v48, v48
    v_mfma_f32_32x32x16_bf16 v[96:111], v[48:51], v[60:63], v[96:111]
    ds_read_b128 v[32:35], v10 offset:0
    v_dot2c_f32_bf16 v21, s27, v49
    v_mfma_f32_32x32x16_bf16 v[128:143], v[60:63], v[48:51], v[128:143]
    ds_read_b128 v[36:39], v10 offset:4096
    v_dot2c_f32_bf16 v23, v49, v49
    v_mfma_f32_32x32x16_bf16 v[80:95], v[52:55], v[56:59], v[80:95]
    ds_read_b128 v[40:43], v5 offset:0
    v_dot2c_f32_bf16 v20, s27, v50
    v_dot2c_f32_bf16 v22, v50, v50
    v_mfma_f32_32x32x16_bf16 v[112:127], v[52:55], v[60:63], v[112:127]
    ds_read_b128 v[44:47], v5 offset:1024
    v_dot2c_f32_bf16 v21, s27, v51
    v_mfma_f32_32x32x16_bf16 v[144:159], v[60:63], v[52:55], v[144:159]
    v_dot2c_f32_bf16 v23, v51, v51
    s_waitcnt lgkmcnt(0)
    v_mfma_f32_32x32x16_bf16 v[64:79], v[32:35], v[40:43], v[64:79]
    v_dot2c_f32_bf16 v20, s27, v32
    v_dot2c_f32_bf16 v22, v32, v32
    v_mfma_f32_32x32x16_bf16 v[96:111], v[32:35], v[44:47], v[96:111]
    ds_read_b128 v[48:51], v11 offset:0
    v_dot2c_f32_bf16 v21, s27, v33
    v_mfma_f32_32x32x16_bf16 v[128:143], v[44:47], v[32:35], v[128:143]
    ds_read_b128 v[52:55], v11 offset:4096
    v_dot2c_f32_bf16 v23, v33, v33
    v_mfma_f32_32x32x16_bf16 v[80:95], v[36:39], v[40:43], v[80:95]
    ds_read_b128 v[56:59], v5 offset:2048
    v_dot2c_f32_bf16 v20, s27, v34
    v_dot2c_f32_bf16 v22, v34, v34
    v_mfma_f32_32x32x16_bf16 v[112:127], v[36:39], v[44:47], v[112:127]
    ds_read_b128 v[60:63], v5 offset:3072
    v_dot2c_f32_bf16 v21, s27, v35
    v_mfma_f32_32x32x16_bf16 v[144:159], v[44:47], v[36:39], v[144:159]
    v_dot2c_f32_bf16 v23, v35, v35
    s_waitcnt lgkmcnt(0)
    v_mfma_f32_32x32x16_bf16 v[64:79], v[48:51], v[56:59], v[64:79]
    v_dot2c_f32_bf16 v20, s27, v48
    v_dot2c_f32_bf16 v22, v48, v48
    v_mfma_f32_32x32x16_bf16 v[96:111], v[48:51], v[60:63], v[96:111]
    ds_read_b128 v[32:35], v12 offset:0
    v_dot2c_f32_bf16 v21, s27, v49
    v_mfma_f32_32x32x16_bf16 v[128:143], v[60:63], v[48:51], v[128:143]
    ds_read_b128 v[36:39], v12 offset:4096
    v_dot2c_f32_bf16 v23, v49, v49
    v_mfma_f32_32x32x16_bf16 v[80:95], v[52:55], v[56:59], v[80:95]
    ds_read_b128 v[40:43], v5 offset:4096
    v_dot2c_f32_bf16 v20, s27, v50
    v_dot2c_f32_bf16 v22, v50, v50
    v_mfma_f32_32x32x16_bf16 v[112:127], v[52:55], v[60:63], v[112:127]
    ds_read_b128 v[44:47], v5 offset:5120
    v_dot2c_f32_bf16 v21, s27, v51
    v_mfma_f32_32x32x16_bf16 v[144:159], v[60:63], v[52:55], v[144:159]
    v_dot2c_f32_bf16 v23, v51, v51
    s_waitcnt lgkmcnt(0)
    v_mfma_f32_32x32x16_bf16 v[64:79], v[32:35], v[40:43], v[64:79]
    v_dot2c_f32_bf16 v20, s27, v32
    v_dot2c_f32_bf16 v22, v32, v32
    v_mfma_f32_32x32x16_bf16 v[96:111], v[32:35], v[44:47], v[96:111]
    ds_read_b128 v[48:51], v13 offset:0
    v_dot2c_f32_bf16 v21, s27, v33
    v_mfma_f32_32x32x16_bf16 v[128:143], v[44:47], v[32:35], v[128:143]
    ds_read_b128 v[52:55], v13 offset:4096
    v_dot2c_f32_bf16 v23, v33, v33
    v_mfma_f32_32x32x16_bf16 v[80:95], v[36:39], v[40:43], v[80:95]
    ds_read_b128 v[56:59], v5 offset:6144
    v_dot2c_f32_bf16 v20, s27, v34
    v_dot2c_f32_bf16 v22, v34, v34
    v_mfma_f32_32x32x16_bf16 v[112:127], v[36:39], v[44:47], v[112:127]
    ds_read_b128 v[60:63], v5 offset:7168
    v_dot2c_f32_bf16 v21, s27, v35
    v_mfma_f32_32x32x16_bf16 v[144:159], v[44:47], v[36:39], v[144:159]
    v_dot2c_f32_bf16 v23, v35, v35
    s_waitcnt vmcnt(8)
    s_barrier
    s_lshl_b32 s28, s13, 12
    s_add_u32 s28, s28, 32768
    s_mov_b32 m0, s28
    s_add_u32 s29, s24, 640
    buffer_load_dwordx4 v2, s[16:19], s29 offen offset:0 lds
    s_add_u32 s29, s29, 9216
    buffer_load_dwordx4 v3, s[16:19], s29 offen offset:1024 lds
    s_add_u32 s29, s29, 9216
    buffer_load_dwordx4 v2, s[16:19], s29 offen offset:2048 lds
    s_add_u32 s29, s29, 9216
    buffer_load_dwordx4 v3, s[16:19], s29 offen offset:3072 lds
    s_add_u32 s28, s28, 16384
    s_mov_b32 m0, s28
    s_add_u32 s29, s25, 40960
    buffer_load_dwordx4 v1, s[8:11], s29 offen offset:0 lds
    buffer_load_dwordx4 v1, s[8:11], s29 offen offset:1024 lds
    buffer_load_dwordx4 v1, s[8:11], s29 offen offset:2048 lds
    buffer_load_dwordx4 v1, s[8:11], s29 offen offset:3072 lds
    s_waitcnt lgkmcnt(0)
    v_mfma_f32_32x32x16_bf16 v[64:79], v[48:51], v[56:59], v[64:79]
    v_dot2c_f32_bf16 v20, s27, v48
    v_dot2c_f32_bf16 v22, v48, v48
    v_mfma_f32_32x32x16_bf16 v[96:111], v[48:51], v[60:63], v[96:111]
    ds_read_b128 v[32:35], v10 offset:32768
    v_dot2c_f32_bf16 v21, s27, v49
    v_mfma_f32_32x32x16_bf16 v[128:143], v[60:63], v[48:51], v[128:143]
    ds_read_b128 v[36:39], v10 offset:36864
    v_dot2c_f32_bf16 v23, v49, v49
    v_mfma_f32_32x32x16_bf16 v[80:95], v[52:55], v[56:59], v[80:95]
    ds_read_b128 v[40:43], v5 offset:32768
    v_dot2c_f32_bf16 v20, s27, v50
    v_dot2c_f32_bf16 v22, v50, v50
    v_mfma_f32_32x32x16_bf16 v[112:127], v[52:55], v[60:63], v[112:127]
    ds_read_b128 v[44:47], v5 offset:33792
    v_dot2c_f32_bf16 v21, s27, v51
    v_mfma_f32_32x32x16_bf16 v[144:159], v[60:63], v[52:55], v[144:159]
    v_dot2c_f32_bf16 v23, v51, v51
    s_waitcnt lgkmcnt(0)
    v_mfma_f32_32x32x16_bf16 v[64:79], v[32:35], v[40:43], v[64:79]
    v_dot2c_f32_bf16 v20, s27, v32
    v_dot2c_f32_bf16 v22, v32, v32
    v_mfma_f32_32x32x16_bf16 v[96:111], v[32:35], v[44:47], v[96:111]
    ds_read_b128 v[48:51], v11 offset:32768
    v_dot2c_f32_bf16 v21, s27, v33
    v_mfma_f32_32x32x16_bf16 v[128:143], v[44:47], v[32:35], v[128:143]
    ds_read_b128 v[52:55], v11 offset:36864
    v_dot2c_f32_bf16 v23, v33, v33
    v_mfma_f32_32x32x16_bf16 v[80:95], v[36:39], v[40:43], v[80:95]
    ds_read_b128 v[56:59], v5 offset:34816
    v_dot2c_f32_bf16 v20, s27, v34
    v_dot2c_f32_bf16 v22, v34, v34
    v_mfma_f32_32x32x16_bf16 v[112:127], v[36:39], v[44:47], v[112:127]
    ds_read_b128 v[60:63], v5 offset:35840
    v_dot2c_f32_bf16 v21, s27, v35
    v_mfma_f32_32x32x16_bf16 v[144:159], v[44:47], v[36:39], v[144:159]
    v_dot2c_f32_bf16 v23, v35, v35
    s_waitcnt lgkmcnt(0)
    v_mfma_f32_32x32x16_bf16 v[64:79], v[48:51], v[56:59], v[64:79]
    v_dot2c_f32_bf16 v20, s27, v48
    v_dot2c_f32_bf16 v22, v48, v48
    v_mfma_f32_32x32x16_bf16 v[96:111], v[48:51], v[60:63], v[96:111]
    ds_read_b128 v[32:35], v12 offset:32768
    v_dot2c_f32_bf16 v21, s27, v49
    v_mfma_f32_32x32x16_bf16 v[128:143], v[60:63], v[48:51], v[128:143]
    ds_read_b128 v[36:39], v12 offset:36864
    v_dot2c_f32_bf16 v23, v49, v49
    v_mfma_f32_32x32x16_bf16 v[80:95], v[52:55], v[56:59], v[80:95]
    ds_read_b128 v[40:43], v5 offset:36864
    v_dot2c_f32_bf16 v20, s27, v50
    v_dot2c_f32_bf16 v22, v50, v50
    v_mfma_f32_32x32x16_bf16 v[112:127], v[52:55], v[60:63], v[112:127]
    ds_read_b128 v[44:47], v5 offset:37888
    v_dot2c_f32_bf16 v21, s27, v51
    v_mfma_f32_32x32x16_bf16 v[144:159], v[60:63], v[52:55], v[144:159]
    v_dot2c_f32_bf16 v23, v51, v51
    s_waitcnt lgkmcnt(0)
    v_mfma_f32_32x32x16_bf16 v[64:79], v[32:35], v[40:43], v[64:79]
    v_dot2c_f32_bf16 v20, s27, v32
    v_dot2c_f32_bf16 v22, v32, v32
    v_mfma_f32_32x32x16_bf16 v[96:111], v[32:35], v[44:47], v[96:111]
    ds_read_b128 v[48:51], v13 offset:32768
    v_dot2c_f32_bf16 v21, s27, v33
    v_mfma_f32_32x32x16_bf16 v[128:143], v[44:47], v[32:35], v[128:143]
    ds_read_b128 v[52:55], v13 offset:36864
    v_dot2c_f32_bf16 v23, v33, v33
    v_mfma_f32_32x32x16_bf16 v[80:95], v[36:39], v[40:43], v[80:95]
    ds_read_b128 v[56:59], v5 offset:38912
    v_dot2c_f32_bf16 v20, s27, v34
    v_dot2c_f32_bf16 v22, v34, v34
    v_mfma_f32_32x32x16_bf16 v[112:127], v[36:39], v[44:47], v[112:127]
    ds_read_b128 v[60:63], v5 offset:39936
    v_dot2c_f32_bf16 v21, s27, v35
    v_mfma_f32_32x32x16_bf16 v[144:159], v[44:47], v[36:39], v[144:159]
    v_dot2c_f32_bf16 v23, v35, v35
    s_waitcnt vmcnt(8)
    s_barrier
    s_lshl_b32 s28, s13, 12
    s_add_u32 s28, s28, 65536
    s_mov_b32 m0, s28
    s_add_u32 s29, s24, 768
    buffer_load_dwordx4 v2, s[16:19], s29 offen offset:0 lds
    s_add_u32 s29, s29, 9216
    buffer_load_dwordx4 v3, s[16:19], s29 offen offset:1024 lds
    s_add_u32 s29, s29, 9216
    buffer_load_dwordx4 v2, s[16:19], s29 offen offset:2048 lds
    s_add_u32 s29, s29, 9216
    buffer_load_dwordx4 v3, s[16:19], s29 offen offset:3072 lds
    s_add_u32 s28, s28, 16384
    s_mov_b32 m0, s28
    s_add_u32 s29, s25, 49152
    buffer_load_dwordx4 v1, s[8:11], s29 offen offset:0 lds
    buffer_load_dwordx4 v1, s[8:11], s29 offen offset:1024 lds
    buffer_load_dwordx4 v1, s[8:11], s29 offen offset:2048 lds
    buffer_load_dwordx4 v1, s[8:11], s29 offen offset:3072 lds
    s_waitcnt lgkmcnt(0)
    v_mfma_f32_32x32x16_bf16 v[64:79], v[48:51], v[56:59], v[64:79]
    v_dot2c_f32_bf16 v20, s27, v48
    v_dot2c_f32_bf16 v22, v48, v48
    v_mfma_f32_32x32x16_bf16 v[96:111], v[48:51], v[60:63], v[96:111]
    ds_read_b128 v[32:35], v6 offset:0
    v_dot2c_f32_bf16 v21, s27, v49
    v_mfma_f32_32x32x16_bf16 v[128:143], v[60:63], v[48:51], v[128:143]
    ds_read_b128 v[36:39], v6 offset:4096
    v_dot2c_f32_bf16 v23, v49, v49
    v_mfma_f32_32x32x16_bf16 v[80:95], v[52:55], v[56:59], v[80:95]
    ds_read_b128 v[40:43], v4 offset:0
    v_dot2c_f32_bf16 v20, s27, v50
    v_dot2c_f32_bf16 v22, v50, v50
    v_mfma_f32_32x32x16_bf16 v[112:127], v[52:55], v[60:63], v[112:127]
    ds_read_b128 v[44:47], v4 offset:1024
    v_dot2c_f32_bf16 v21, s27, v51
    v_mfma_f32_32x32x16_bf16 v[144:159], v[60:63], v[52:55], v[144:159]
    v_dot2c_f32_bf16 v23, v51, v51
    s_waitcnt lgkmcnt(0)
    v_mfma_f32_32x32x16_bf16 v[64:79], v[32:35], v[40:43], v[64:79]
    v_dot2c_f32_bf16 v20, s27, v32
    v_dot2c_f32_bf16 v22, v32, v32
    v_mfma_f32_32x32x16_bf16 v[96:111], v[32:35], v[44:47], v[96:111]
    ds_read_b128 v[48:51], v7 offset:0
    v_dot2c_f32_bf16 v21, s27, v33
    v_mfma_f32_32x32x16_bf16 v[128:143], v[44:47], v[32:35], v[128:143]
    ds_read_b128 v[52:55], v7 offset:4096
    v_dot2c_f32_bf16 v23, v33, v33
    v_mfma_f32_32x32x16_bf16 v[80:95], v[36:39], v[40:43], v[80:95]
    ds_read_b128 v[56:59], v4 offset:2048
    v_dot2c_f32_bf16 v20, s27, v34
    v_dot2c_f32_bf16 v22, v34, v34
    v_mfma_f32_32x32x16_bf16 v[112:127], v[36:39], v[44:47], v[112:127]
    ds_read_b128 v[60:63], v4 offset:3072
    v_dot2c_f32_bf16 v21, s27, v35
    v_mfma_f32_32x32x16_bf16 v[144:159], v[44:47], v[36:39], v[144:159]
    v_dot2c_f32_bf16 v23, v35, v35
    s_waitcnt lgkmcnt(0)
    v_mfma_f32_32x32x16_bf16 v[64:79], v[48:51], v[56:59], v[64:79]
    v_dot2c_f32_bf16 v20, s27, v48
    v_dot2c_f32_bf16 v22, v48, v48
    v_mfma_f32_32x32x16_bf16 v[96:111], v[48:51], v[60:63], v[96:111]
    ds_read_b128 v[32:35], v8 offset:0
    v_dot2c_f32_bf16 v21, s27, v49
    v_mfma_f32_32x32x16_bf16 v[128:143], v[60:63], v[48:51], v[128:143]
    ds_read_b128 v[36:39], v8 offset:4096
    v_dot2c_f32_bf16 v23, v49, v49
    v_mfma_f32_32x32x16_bf16 v[80:95], v[52:55], v[56:59], v[80:95]
    ds_read_b128 v[40:43], v4 offset:4096
    v_dot2c_f32_bf16 v20, s27, v50
    v_dot2c_f32_bf16 v22, v50, v50
    v_mfma_f32_32x32x16_bf16 v[112:127], v[52:55], v[60:63], v[112:127]
    ds_read_b128 v[44:47], v4 offset:5120
    v_dot2c_f32_bf16 v21, s27, v51
    v_mfma_f32_32x32x16_bf16 v[144:159], v[60:63], v[52:55], v[144:159]
    v_dot2c_f32_bf16 v23, v51, v51
    s_waitcnt lgkmcnt(0)
    v_mfma_f32_32x32x16_bf16 v[64:79], v[32:35], v[40:43], v[64:79]
    v_dot2c_f32_bf16 v20, s27, v32
    v_dot2c_f32_bf16 v22, v32, v32
    v_mfma_f32_32x32x16_bf16 v[96:111], v[32:35], v[44:47], v[96:111]
    ds_read_b128 v[48:51], v9 offset:0
    v_dot2c_f32_bf16 v21, s27, v33
    v_mfma_f32_32x32x16_bf16 v[128:143], v[44:47], v[32:35], v[128:143]
    ds_read_b128 v[52:55], v9 offset:4096
    v_dot2c_f32_bf16 v23, v33, v33
    v_mfma_f32_32x32x16_bf16 v[80:95], v[36:39], v[40:43], v[80:95]
    ds_read_b128 v[56:59], v4 offset:6144
    v_dot2c_f32_bf16 v20, s27, v34
    v_dot2c_f32_bf16 v22, v34, v34
    v_mfma_f32_32x32x16_bf16 v[112:127], v[36:39], v[44:47], v[112:127]
    ds_read_b128 v[60:63], v4 offset:7168
    v_dot2c_f32_bf16 v21, s27, v35
    v_mfma_f32_32x32x16_bf16 v[144:159], v[44:47], v[36:39], v[144:159]
    v_dot2c_f32_bf16 v23, v35, v35
    s_waitcnt vmcnt(8)
    s_barrier
    s_lshl_b32 s28, s13, 12
    s_add_u32 s28, s28, 98304
    s_mov_b32 m0, s28
    s_add_u32 s29, s24, 896
    buffer_load_dwordx4 v2, s[16:19], s29 offen offset:0 lds
    s_add_u32 s29, s29, 9216
    buffer_load_dwordx4 v3, s[16:19], s29 offen offset:1024 lds
    s_add_u32 s29, s29, 9216
    buffer_load_dwordx4 v2, s[16:19], s29 offen offset:2048 lds
    s_add_u32 s29, s29, 9216
    buffer_load_dwordx4 v3, s[16:19], s29 offen offset:3072 lds
    s_add_u32 s28, s28, 16384
    s_mov_b32 m0, s28
    s_add_u32 s29, s25, 57344
    buffer_load_dwordx4 v1, s[8:11], s29 offen offset:0 lds
    buffer_load_dwordx4 v1, s[8:11], s29 offen offset:1024 lds
    buffer_load_dwordx4 v1, s[8:11], s29 offen offset:2048 lds
    buffer_load_dwordx4 v1, s[8:11], s29 offen offset:3072 lds
    s_waitcnt lgkmcnt(0)
    v_mfma_f32_32x32x16_bf16 v[64:79], v[48:51], v[56:59], v[64:79]
    v_dot2c_f32_bf16 v20, s27, v48
    v_dot2c_f32_bf16 v22, v48, v48
    v_mfma_f32_32x32x16_bf16 v[96:111], v[48:51], v[60:63], v[96:111]
    ds_read_b128 v[32:35], v6 offset:32768
    v_dot2c_f32_bf16 v21, s27, v49
    v_mfma_f32_32x32x16_bf16 v[128:143], v[60:63], v[48:51], v[128:143]
    ds_read_b128 v[36:39], v6 offset:36864
    v_dot2c_f32_bf16 v23, v49, v49
    v_mfma_f32_32x32x16_bf16 v[80:95], v[52:55], v[56:59], v[80:95]
    ds_read_b128 v[40:43], v4 offset:32768
    v_dot2c_f32_bf16 v20, s27, v50
    v_dot2c_f32_bf16 v22, v50, v50
    v_mfma_f32_32x32x16_bf16 v[112:127], v[52:55], v[60:63], v[112:127]
    ds_read_b128 v[44:47], v4 offset:33792
    v_dot2c_f32_bf16 v21, s27, v51
    v_mfma_f32_32x32x16_bf16 v[144:159], v[60:63], v[52:55], v[144:159]
    v_dot2c_f32_bf16 v23, v51, v51
    s_waitcnt lgkmcnt(0)
    v_mfma_f32_32x32x16_bf16 v[64:79], v[32:35], v[40:43], v[64:79]
    v_dot2c_f32_bf16 v20, s27, v32
    v_dot2c_f32_bf16 v22, v32, v32
    v_mfma_f32_32x32x16_bf16 v[96:111], v[32:35], v[44:47], v[96:111]
    ds_read_b128 v[48:51], v7 offset:32768
    v_dot2c_f32_bf16 v21, s27, v33
    v_mfma_f32_32x32x16_bf16 v[128:143], v[44:47], v[32:35], v[128:143]
    ds_read_b128 v[52:55], v7 offset:36864
    v_dot2c_f32_bf16 v23, v33, v33
    v_mfma_f32_32x32x16_bf16 v[80:95], v[36:39], v[40:43], v[80:95]
    ds_read_b128 v[56:59], v4 offset:34816
    v_dot2c_f32_bf16 v20, s27, v34
    v_dot2c_f32_bf16 v22, v34, v34
    v_mfma_f32_32x32x16_bf16 v[112:127], v[36:39], v[44:47], v[112:127]
    ds_read_b128 v[60:63], v4 offset:35840
    v_dot2c_f32_bf16 v21, s27, v35
    v_mfma_f32_32x32x16_bf16 v[144:159], v[44:47], v[36:39], v[144:159]
    v_dot2c_f32_bf16 v23, v35, v35
    s_waitcnt lgkmcnt(0)
    v_mfma_f32_32x32x16_bf16 v[64:79], v[48:51], v[56:59], v[64:79]
    v_dot2c_f32_bf16 v20, s27, v48
    v_dot2c_f32_bf16 v22, v48, v48
    v_mfma_f32_32x32x16_bf16 v[96:111], v[48:51], v[60:63], v[96:111]
    ds_read_b128 v[32:35], v8 offset:32768
    v_dot2c_f32_bf16 v21, s27, v49
    v_mfma_f32_32x32x16_bf16 v[128:143], v[60:63], v[48:51], v[128:143]
    ds_read_b128 v[36:39], v8 offset:36864
    v_dot2c_f32_bf16 v23, v49, v49
    v_mfma_f32_32x32x16_bf16 v[80:95], v[52:55], v[56:59], v[80:95]
    ds_read_b128 v[40:43], v4 offset:36864
    v_dot2c_f32_bf16 v20, s27, v50
    v_dot2c_f32_bf16 v22, v50, v50
    v_mfma_f32_32x32x16_bf16 v[112:127], v[52:55], v[60:63], v[112:127]
    ds_read_b128 v[44:47], v4 offset:37888
    v_dot2c_f32_bf16 v21, s27, v51
    v_mfma_f32_32x32x16_bf16 v[144:159], v[60:63], v[52:55], v[144:159]
    v_dot2c_f32_bf16 v23, v51, v51
    s_waitcnt lgkmcnt(0)
    v_mfma_f32_32x32x16_bf16 v[64:79], v[32:35], v[40:43], v[64:79]
    v_dot2c_f32_bf16 v20, s27, v32
    v_dot2c_f32_bf16 v22, v32, v32
    v_mfma_f32_32x32x16_bf16 v[96:111], v[32:35], v[44:47], v[96:111]
    ds_read_b128 v[48:51], v9 offset:32768
    v_dot2c_f32_bf16 v21, s27, v33
    v_mfma_f32_32x32x16_bf16 v[128:143], v[44:47], v[32:35], v[128:143]
    ds_read_b128 v[52:55], v9 offset:36864
    v_dot2c_f32_bf16 v23, v33, v33
    v_mfma_f32_32x32x16_bf16 v[80:95], v[36:39], v[40:43], v[80:95]
    ds_read_b128 v[56:59], v4 offset:38912
    v_dot2c_f32_bf16 v20, s27, v34
    v_dot2c_f32_bf16 v22, v34, v34
    v_mfma_f32_32x32x16_bf16 v[112:127], v[36:39], v[44:47], v[112:127]
    ds_read_b128 v[60:63], v4 offset:39936
    v_dot2c_f32_bf16 v21, s27, v35
    v_mfma_f32_32x32x16_bf16 v[144:159], v[44:47], v[36:39], v[144:159]
    v_dot2c_f32_bf16 v23, v35, v35
    s_waitcnt vmcnt(8)
    s_barrier
    s_lshl_b32 s28, s13, 12
    s_mov_b32 m0, s28
    s_add_u32 s29, s24, 1024
    buffer_load_dwordx4 v2, s[16:19], s29 offen offset:0 lds
    s_add_u32 s29, s29, 9216
    buffer_load_dwordx4 v3, s[16:19], s29 offen offset:1024 lds
    s_add_u32 s29, s29, 9216
    buffer_load_dwordx4 v2, s[16:19], s29 offen offset:2048 lds
    s_add_u32 s29, s29, 9216
    buffer_load_dwordx4 v3, s[16:19], s29 offen offset:3072 lds
    s_add_u32 s28, s28, 16384
    s_mov_b32 m0, s28
    s_add_u32 s29, s25, 65536
    buffer_load_dwordx4 v1, s[8:11], s29 offen offset:0 lds
    buffer_load_dwordx4 v1, s[8:11], s29 offen offset:1024 lds
    buffer_load_dwordx4 v1, s[8:11], s29 offen offset:2048 lds
    buffer_load_dwordx4 v1, s[8:11], s29 offen offset:3072 lds
    s_waitcnt lgkmcnt(0)
    v_mfma_f32_32x32x16_bf16 v[64:79], v[48:51], v[56:59], v[64:79]
    v_dot2c_f32_bf16 v20, s27, v48
    v_dot2c_f32_bf16 v22, v48, v48
    v_mfma_f32_32x32x16_bf16 v[96:111], v[48:51], v[60:63], v[96:111]
    ds_read_b128 v[32:35], v10 offset:0
    v_dot2c_f32_bf16 v21, s27, v49
    v_mfma_f32_32x32x16_bf16 v[128:143], v[60:63], v[48:51], v[128:143]
    ds_read_b128 v[36:39], v10 offset:4096
    v_dot2c_f32_bf16 v23, v49, v49
    v_mfma_f32_32x32x16_bf16 v[80:95], v[52:55], v[56:59], v[80:95]
    ds_read_b128 v[40:43], v5 offset:0
    v_dot2c_f32_bf16 v20, s27, v50
    v_dot2c_f32_bf16 v22, v50, v50
    v_mfma_f32_32x32x16_bf16 v[112:127], v[52:55], v[60:63], v[112:127]
    ds_read_b128 v[44:47], v5 offset:1024
    v_dot2c_f32_bf16 v21, s27, v51
    v_mfma_f32_32x32x16_bf16 v[144:159], v[60:63], v[52:55], v[144:159]
    v_dot2c_f32_bf16 v23, v51, v51
    s_waitcnt lgkmcnt(0)
    v_mfma_f32_32x32x16_bf16 v[64:79], v[32:35], v[40:43], v[64:79]
    v_dot2c_f32_bf16 v20, s27, v32
    v_dot2c_f32_bf16 v22, v32, v32
    v_mfma_f32_32x32x16_bf16 v[96:111], v[32:35], v[44:47], v[96:111]
    ds_read_b128 v[48:51], v11 offset:0
    v_dot2c_f32_bf16 v21, s27, v33
    v_mfma_f32_32x32x16_bf16 v[128:143], v[44:47], v[32:35], v[128:143]
    ds_read_b128 v[52:55], v11 offset:4096
    v_dot2c_f32_bf16 v23, v33, v33
    v_mfma_f32_32x32x16_bf16 v[80:95], v[36:39], v[40:43], v[80:95]
    ds_read_b128 v[56:59], v5 offset:2048
    v_dot2c_f32_bf16 v20, s27, v34
    v_dot2c_f32_bf16 v22, v34, v34
    v_mfma_f32_32x32x16_bf16 v[112:127], v[36:39], v[44:47], v[112:127]
    ds_read_b128 v[60:63], v5 offset:3072
    v_dot2c_f32_bf16 v21, s27, v35
    v_mfma_f32_32x32x16_bf16 v[144:159], v[44:47], v[36:39], v[144:159]
    v_dot2c_f32_bf16 v23, v35, v35
    s_waitcnt lgkmcnt(0)
    v_mfma_f32_32x32x16_bf16 v[64:79], v[48:51], v[56:59], v[64:79]
    v_dot2c_f32_bf16 v20, s27, v48
    v_dot2c_f32_bf16 v22, v48, v48
    v_mfma_f32_32x32x16_bf16 v[96:111], v[48:51], v[60:63], v[96:111]
    ds_read_b128 v[32:35], v12 offset:0
    v_dot2c_f32_bf16 v21, s27, v49
    v_mfma_f32_32x32x16_bf16 v[128:143], v[60:63], v[48:51], v[128:143]
    ds_read_b128 v[36:39], v12 offset:4096
    v_dot2c_f32_bf16 v23, v49, v49
    v_mfma_f32_32x32x16_bf16 v[80:95], v[52:55], v[56:59], v[80:95]
    ds_read_b128 v[40:43], v5 offset:4096
    v_dot2c_f32_bf16 v20, s27, v50
    v_dot2c_f32_bf16 v22, v50, v50
    v_mfma_f32_32x32x16_bf16 v[112:127], v[52:55], v[60:63], v[112:127]
    ds_read_b128 v[44:47], v5 offset:5120
    v_dot2c_f32_bf16 v21, s27, v51
    v_mfma_f32_32x32x16_bf16 v[144:159], v[60:63], v[52:55], v[144:159]
    v_dot2c_f32_bf16 v23, v51, v51
    s_waitcnt lgkmcnt(0)
    v_mfma_f32_32x32x16_bf16 v[64:79], v[32:35], v[40:43], v[64:79]
    v_dot2c_f32_bf16 v20, s27, v32
    v_dot2c_f32_bf16 v22, v32, v32
    v_mfma_f32_32x32x16_bf16 v[96:111], v[32:35], v[44:47], v[96:111]
    ds_read_b128 v[48:51], v13 offset:0
    v_dot2c_f32_bf16 v21, s27, v33
    v_mfma_f32_32x32x16_bf16 v[128:143], v[44:47], v[32:35], v[128:143]
    ds_read_b128 v[52:55], v13 offset:4096
    v_dot2c_f32_bf16 v23, v33, v33
    v_mfma_f32_32x32x16_bf16 v[80:95], v[36:39], v[40:43], v[80:95]
    ds_read_b128 v[56:59], v5 offset:6144
    v_dot2c_f32_bf16 v20, s27, v34
    v_dot2c_f32_bf16 v22, v34, v34
    v_mfma_f32_32x32x16_bf16 v[112:127], v[36:39], v[44:47], v[112:127]
    ds_read_b128 v[60:63], v5 offset:7168
    v_dot2c_f32_bf16 v21, s27, v35
    v_mfma_f32_32x32x16_bf16 v[144:159], v[44:47], v[36:39], v[144:159]
    v_dot2c_f32_bf16 v23, v35, v35
    s_waitcnt vmcnt(8)
    s_barrier
    s_lshl_b32 s28, s13, 12
    s_add_u32 s28, s28, 32768
    s_mov_b32 m0, s28
    s_add_u32 s29, s24, 1152
    buffer_load_dwordx4 v2, s[16:19], s29 offen offset:0 lds
    s_add_u32 s29, s29, 9216
    buffer_load_dwordx4 v3, s[16:19], s29 offen offset:1024 lds
    s_add_u32 s29, s29, 9216
    buffer_load_dwordx4 v2, s[16:19], s29 offen offset:2048 lds
    s_add_u32 s29, s29, 9216
    buffer_load_dwordx4 v3, s[16:19], s29 offen offset:3072 lds
    s_add_u32 s28, s28, 16384
    s_mov_b32 m0, s28
    s_add_u32 s29, s25, 73728
    buffer_load_dwordx4 v1, s[8:11], s29 offen offset:0 lds
    buffer_load_dwordx4 v1, s[8:11], s29 offen offset:1024 lds
    buffer_load_dwordx4 v1, s[8:11], s29 offen offset:2048 lds
    buffer_load_dwordx4 v1, s[8:11], s29 offen offset:3072 lds
    s_waitcnt lgkmcnt(0)
    v_mfma_f32_32x32x16_bf16 v[64:79], v[48:51], v[56:59], v[64:79]
    v_dot2c_f32_bf16 v20, s27, v48
    v_dot2c_f32_bf16 v22, v48, v48
    v_mfma_f32_32x32x16_bf16 v[96:111], v[48:51], v[60:63], v[96:111]
    ds_read_b128 v[32:35], v10 offset:32768
    v_dot2c_f32_bf16 v21, s27, v49
    v_mfma_f32_32x32x16_bf16 v[128:143], v[60:63], v[48:51], v[128:143]
    ds_read_b128 v[36:39], v10 offset:36864
    v_dot2c_f32_bf16 v23, v49, v49
    v_mfma_f32_32x32x16_bf16 v[80:95], v[52:55], v[56:59], v[80:95]
    ds_read_b128 v[40:43], v5 offset:32768
    v_dot2c_f32_bf16 v20, s27, v50
    v_dot2c_f32_bf16 v22, v50, v50
    v_mfma_f32_32x32x16_bf16 v[112:127], v[52:55], v[60:63], v[112:127]
    ds_read_b128 v[44:47], v5 offset:33792
    v_dot2c_f32_bf16 v21, s27, v51
    v_mfma_f32_32x32x16_bf16 v[144:159], v[60:63], v[52:55], v[144:159]
    v_dot2c_f32_bf16 v23, v51, v51
    s_waitcnt lgkmcnt(0)
    v_mfma_f32_32x32x16_bf16 v[64:79], v[32:35], v[40:43], v[64:79]
    v_dot2c_f32_bf16 v20, s27, v32
    v_dot2c_f32_bf16 v22, v32, v32
    v_mfma_f32_32x32x16_bf16 v[96:111], v[32:35], v[44:47], v[96:111]
    ds_read_b128 v[48:51], v11 offset:32768
    v_dot2c_f32_bf16 v21, s27, v33
    v_mfma_f32_32x32x16_bf16 v[128:143], v[44:47], v[32:35], v[128:143]
    ds_read_b128 v[52:55], v11 offset:36864
    v_dot2c_f32_bf16 v23, v33, v33
    v_mfma_f32_32x32x16_bf16 v[80:95], v[36:39], v[40:43], v[80:95]
    ds_read_b128 v[56:59], v5 offset:34816
    v_dot2c_f32_bf16 v20, s27, v34
    v_dot2c_f32_bf16 v22, v34, v34
    v_mfma_f32_32x32x16_bf16 v[112:127], v[36:39], v[44:47], v[112:127]
    ds_read_b128 v[60:63], v5 offset:35840
    v_dot2c_f32_bf16 v21, s27, v35
    v_mfma_f32_32x32x16_bf16 v[144:159], v[44:47], v[36:39], v[144:159]
    v_dot2c_f32_bf16 v23, v35, v35
    s_waitcnt lgkmcnt(0)
    v_mfma_f32_32x32x16_bf16 v[64:79], v[48:51], v[56:59], v[64:79]
    v_dot2c_f32_bf16 v20, s27, v48
    v_dot2c_f32_bf16 v22, v48, v48
    v_mfma_f32_32x32x16_bf16 v[96:111], v[48:51], v[60:63], v[96:111]
    ds_read_b128 v[32:35], v12 offset:32768
    v_dot2c_f32_bf16 v21, s27, v49
    v_mfma_f32_32x32x16_bf16 v[128:143], v[60:63], v[48:51], v[128:143]
    ds_read_b128 v[36:39], v12 offset:36864
    v_dot2c_f32_bf16 v23, v49, v49
    v_mfma_f32_32x32x16_bf16 v[80:95], v[52:55], v[56:59], v[80:95]
    ds_read_b128 v[40:43], v5 offset:36864
    v_dot2c_f32_bf16 v20, s27, v50
    v_dot2c_f32_bf16 v22, v50, v50
    v_mfma_f32_32x32x16_bf16 v[112:127], v[52:55], v[60:63], v[112:127]
    ds_read_b128 v[44:47], v5 offset:37888
    v_dot2c_f32_bf16 v21, s27, v51
    v_mfma_f32_32x32x16_bf16 v[144:159], v[60:63], v[52:55], v[144:159]
    v_dot2c_f32_bf16 v23, v51, v51
    s_waitcnt lgkmcnt(0)
    v_mfma_f32_32x32x16_bf16 v[64:79], v[32:35], v[40:43], v[64:79]
    v_dot2c_f32_bf16 v20, s27, v32
    v_dot2c_f32_bf16 v22, v32, v32
    v_mfma_f32_32x32x16_bf16 v[96:111], v[32:35], v[44:47], v[96:111]
    ds_read_b128 v[48:51], v13 offset:32768
    v_dot2c_f32_bf16 v21, s27, v33
    v_mfma_f32_32x32x16_bf16 v[128:143], v[44:47], v[32:35], v[128:143]
    ds_read_b128 v[52:55], v13 offset:36864
    v_dot2c_f32_bf16 v23, v33, v33
    v_mfma_f32_32x32x16_bf16 v[80:95], v[36:39], v[40:43], v[80:95]
    ds_read_b128 v[56:59], v5 offset:38912
    v_dot2c_f32_bf16 v20, s27, v34
    v_dot2c_f32_bf16 v22, v34, v34
    v_mfma_f32_32x32x16_bf16 v[112:127], v[36:39], v[44:47], v[112:127]
    ds_read_b128 v[60:63], v5 offset:39936
    v_dot2c_f32_bf16 v21, s27, v35
    v_mfma_f32_32x32x16_bf16 v[144:159], v[44:47], v[36:39], v[144:159]
    v_dot2c_f32_bf16 v23, v35, v35
    s_waitcnt vmcnt(8)
    s_barrier
    s_waitcnt lgkmcnt(0)
    v_mfma_f32_32x32x16_bf16 v[64:79], v[48:51], v[56:59], v[64:79]
    v_dot2c_f32_bf16 v20, s27, v48
    v_dot2c_f32_bf16 v22, v48, v48
    v_mfma_f32_32x32x16_bf16 v[96:111], v[48:51], v[60:63], v[96:111]
    ds_read_b128 v[32:35], v6 offset:0
    v_dot2c_f32_bf16 v21, s27, v49
    v_mfma_f32_32x32x16_bf16 v[128:143], v[60:63], v[48:51], v[128:143]
    ds_read_b128 v[36:39], v6 offset:4096
    v_dot2c_f32_bf16 v23, v49, v49
    v_mfma_f32_32x32x16_bf16 v[80:95], v[52:55], v[56:59], v[80:95]
    ds_read_b128 v[40:43], v4 offset:0
    v_dot2c_f32_bf16 v20, s27, v50
    v_dot2c_f32_bf16 v22, v50, v50
    v_mfma_f32_32x32x16_bf16 v[112:127], v[52:55], v[60:63], v[112:127]
    ds_read_b128 v[44:47], v4 offset:1024
    v_dot2c_f32_bf16 v21, s27, v51
    v_mfma_f32_32x32x16_bf16 v[144:159], v[60:63], v[52:55], v[144:159]
    v_dot2c_f32_bf16 v23, v51, v51
    s_waitcnt lgkmcnt(0)
    v_mfma_f32_32x32x16_bf16 v[64:79], v[32:35], v[40:43], v[64:79]
    v_dot2c_f32_bf16 v20, s27, v32
    v_dot2c_f32_bf16 v22, v32, v32
    v_mfma_f32_32x32x16_bf16 v[96:111], v[32:35], v[44:47], v[96:111]
    ds_read_b128 v[48:51], v7 offset:0
    v_dot2c_f32_bf16 v21, s27, v33
    v_mfma_f32_32x32x16_bf16 v[128:143], v[44:47], v[32:35], v[128:143]
    ds_read_b128 v[52:55], v7 offset:4096
    v_dot2c_f32_bf16 v23, v33, v33
    v_mfma_f32_32x32x16_bf16 v[80:95], v[36:39], v[40:43], v[80:95]
    ds_read_b128 v[56:59], v4 offset:2048
    v_dot2c_f32_bf16 v20, s27, v34
    v_dot2c_f32_bf16 v22, v34, v34
    v_mfma_f32_32x32x16_bf16 v[112:127], v[36:39], v[44:47], v[112:127]
    ds_read_b128 v[60:63], v4 offset:3072
    v_dot2c_f32_bf16 v21, s27, v35
    v_mfma_f32_32x32x16_bf16 v[144:159], v[44:47], v[36:39], v[144:159]
    v_dot2c_f32_bf16 v23, v35, v35
    s_waitcnt lgkmcnt(0)
    v_mfma_f32_32x32x16_bf16 v[64:79], v[48:51], v[56:59], v[64:79]
    v_dot2c_f32_bf16 v20, s27, v48
    v_dot2c_f32_bf16 v22, v48, v48
    v_mfma_f32_32x32x16_bf16 v[96:111], v[48:51], v[60:63], v[96:111]
    ds_read_b128 v[32:35], v8 offset:0
    v_dot2c_f32_bf16 v21, s27, v49
    v_mfma_f32_32x32x16_bf16 v[128:143], v[60:63], v[48:51], v[128:143]
    ds_read_b128 v[36:39], v8 offset:4096
    v_dot2c_f32_bf16 v23, v49, v49
    v_mfma_f32_32x32x16_bf16 v[80:95], v[52:55], v[56:59], v[80:95]
    ds_read_b128 v[40:43], v4 offset:4096
    v_dot2c_f32_bf16 v20, s27, v50
    v_dot2c_f32_bf16 v22, v50, v50
    v_mfma_f32_32x32x16_bf16 v[112:127], v[52:55], v[60:63], v[112:127]
    ds_read_b128 v[44:47], v4 offset:5120
    v_dot2c_f32_bf16 v21, s27, v51
    v_mfma_f32_32x32x16_bf16 v[144:159], v[60:63], v[52:55], v[144:159]
    v_dot2c_f32_bf16 v23, v51, v51
    s_waitcnt lgkmcnt(0)
    v_mfma_f32_32x32x16_bf16 v[64:79], v[32:35], v[40:43], v[64:79]
    v_dot2c_f32_bf16 v20, s27, v32
    v_dot2c_f32_bf16 v22, v32, v32
    v_mfma_f32_32x32x16_bf16 v[96:111], v[32:35], v[44:47], v[96:111]
    ds_read_b128 v[48:51], v9 offset:0
    v_dot2c_f32_bf16 v21, s27, v33
    v_mfma_f32_32x32x16_bf16 v[128:143], v[44:47], v[32:35], v[128:143]
    ds_read_b128 v[52:55], v9 offset:4096
    v_dot2c_f32_bf16 v23, v33, v33
    v_mfma_f32_32x32x16_bf16 v[80:95], v[36:39], v[40:43], v[80:95]
    ds_read_b128 v[56:59], v4 offset:6144
    v_dot2c_f32_bf16 v20, s27, v34
    v_dot2c_f32_bf16 v22, v34, v34
    v_mfma_f32_32x32x16_bf16 v[112:127], v[36:39], v[44:47], v[112:127]
    ds_read_b128 v[60:63], v4 offset:7168
    v_dot2c_f32_bf16 v21, s27, v35
    v_mfma_f32_32x32x16_bf16 v[144:159], v[44:47], v[36:39], v[144:159]
    v_dot2c_f32_bf16 v23, v35, v35
    s_waitcnt vmcnt(0)
    s_barrier
    s_waitcnt lgkmcnt(0)
    v_mfma_f32_32x32x16_bf16 v[64:79], v[48:51], v[56:59], v[64:79]
    v_dot2c_f32_bf16 v20, s27, v48
    v_dot2c_f32_bf16 v22, v48, v48
    v_mfma_f32_32x32x16_bf16 v[96:111], v[48:51], v[60:63], v[96:111]
    ds_read_b128 v[32:35], v6 offset:32768
    v_dot2c_f32_bf16 v21, s27, v49
    v_mfma_f32_32x32x16_bf16 v[128:143], v[60:63], v[48:51], v[128:143]
    ds_read_b128 v[36:39], v6 offset:36864
    v_dot2c_f32_bf16 v23, v49, v49
    v_mfma_f32_32x32x16_bf16 v[80:95], v[52:55], v[56:59], v[80:95]
    ds_read_b128 v[40:43], v4 offset:32768
    v_dot2c_f32_bf16 v20, s27, v50
    v_dot2c_f32_bf16 v22, v50, v50
    v_mfma_f32_32x32x16_bf16 v[112:127], v[52:55], v[60:63], v[112:127]
    ds_read_b128 v[44:47], v4 offset:33792
    v_dot2c_f32_bf16 v21, s27, v51
    v_mfma_f32_32x32x16_bf16 v[144:159], v[60:63], v[52:55], v[144:159]
    v_dot2c_f32_bf16 v23, v51, v51
    s_waitcnt lgkmcnt(0)
    v_mfma_f32_32x32x16_bf16 v[64:79], v[32:35], v[40:43], v[64:79]
    v_dot2c_f32_bf16 v20, s27, v32
    v_dot2c_f32_bf16 v22, v32, v32
    v_mfma_f32_32x32x16_bf16 v[96:111], v[32:35], v[44:47], v[96:111]
    ds_read_b128 v[48:51], v7 offset:32768
    v_dot2c_f32_bf16 v21, s27, v33
    v_mfma_f32_32x32x16_bf16 v[128:143], v[44:47], v[32:35], v[128:143]
    ds_read_b128 v[52:55], v7 offset:36864
    v_dot2c_f32_bf16 v23, v33, v33
    v_mfma_f32_32x32x16_bf16 v[80:95], v[36:39], v[40:43], v[80:95]
    ds_read_b128 v[56:59], v4 offset:34816
    v_dot2c_f32_bf16 v20, s27, v34
    v_dot2c_f32_bf16 v22, v34, v34
    v_mfma_f32_32x32x16_bf16 v[112:127], v[36:39], v[44:47], v[112:127]
    ds_read_b128 v[60:63], v4 offset:35840
    v_dot2c_f32_bf16 v21, s27, v35
    v_mfma_f32_32x32x16_bf16 v[144:159], v[44:47], v[36:39], v[144:159]
    v_dot2c_f32_bf16 v23, v35, v35
    s_waitcnt lgkmcnt(0)
    v_mfma_f32_32x32x16_bf16 v[64:79], v[48:51], v[56:59], v[64:79]
    v_dot2c_f32_bf16 v20, s27, v48
    v_dot2c_f32_bf16 v22, v48, v48
    v_mfma_f32_32x32x16_bf16 v[96:111], v[48:51], v[60:63], v[96:111]
    ds_read_b128 v[32:35], v8 offset:32768
    v_dot2c_f32_bf16 v21, s27, v49
    v_mfma_f32_32x32x16_bf16 v[128:143], v[60:63], v[48:51], v[128:143]
    ds_read_b128 v[36:39], v8 offset:36864
    v_dot2c_f32_bf16 v23, v49, v49
    v_mfma_f32_32x32x16_bf16 v[80:95], v[52:55], v[56:59], v[80:95]
    ds_read_b128 v[40:43], v4 offset:36864
    v_dot2c_f32_bf16 v20, s27, v50
    v_dot2c_f32_bf16 v22, v50, v50
    v_mfma_f32_32x32x16_bf16 v[112:127], v[52:55], v[60:63], v[112:127]
    ds_read_b128 v[44:47], v4 offset:37888
    v_dot2c_f32_bf16 v21, s27, v51
    v_mfma_f32_32x32x16_bf16 v[144:159], v[60:63], v[52:55], v[144:159]
    v_dot2c_f32_bf16 v23, v51, v51
    s_waitcnt lgkmcnt(0)
    v_mfma_f32_32x32x16_bf16 v[64:79], v[32:35], v[40:43], v[64:79]
    v_dot2c_f32_bf16 v20, s27, v32
    v_dot2c_f32_bf16 v22, v32, v32
    v_mfma_f32_32x32x16_bf16 v[96:111], v[32:35], v[44:47], v[96:111]
    ds_read_b128 v[48:51], v9 offset:32768
    v_dot2c_f32_bf16 v21, s27, v33
    v_mfma_f32_32x32x16_bf16 v[128:143], v[44:47], v[32:35], v[128:143]
    ds_read_b128 v[52:55], v9 offset:36864
    v_dot2c_f32_bf16 v23, v33, v33
    v_mfma_f32_32x32x16_bf16 v[80:95], v[36:39], v[40:43], v[80:95]
    ds_read_b128 v[56:59], v4 offset:38912
    v_dot2c_f32_bf16 v20, s27, v34
    v_dot2c_f32_bf16 v22, v34, v34
    v_mfma_f32_32x32x16_bf16 v[112:127], v[36:39], v[44:47], v[112:127]
    ds_read_b128 v[60:63], v4 offset:39936
    v_dot2c_f32_bf16 v21, s27, v35
    v_mfma_f32_32x32x16_bf16 v[144:159], v[44:47], v[36:39], v[144:159]
    v_dot2c_f32_bf16 v23, v35, v35
    s_waitcnt lgkmcnt(0)
    v_mfma_f32_32x32x16_bf16 v[64:79], v[48:51], v[56:59], v[64:79]
    v_dot2c_f32_bf16 v20, s27, v48
    v_dot2c_f32_bf16 v22, v48, v48
    v_mfma_f32_32x32x16_bf16 v[96:111], v[48:51], v[60:63], v[96:111]
    v_dot2c_f32_bf16 v21, s27, v49
    v_mfma_f32_32x32x16_bf16 v[128:143], v[60:63], v[48:51], v[128:143]
    v_dot2c_f32_bf16 v23, v49, v49
    v_mfma_f32_32x32x16_bf16 v[80:95], v[52:55], v[56:59], v[80:95]
    v_dot2c_f32_bf16 v20, s27, v50
    v_dot2c_f32_bf16 v22, v50, v50
    v_mfma_f32_32x32x16_bf16 v[112:127], v[52:55], v[60:63], v[112:127]
    v_dot2c_f32_bf16 v21, s27, v51
    v_mfma_f32_32x32x16_bf16 v[144:159], v[60:63], v[52:55], v[144:159]
    v_dot2c_f32_bf16 v23, v51, v51
    s_branch afront2_kernel_af_epi
afront2_kernel_af_h1:
    s_waitcnt lgkmcnt(0)
    v_mfma_f32_32x32x16_bf16 v[64:79], v[32:35], v[40:43], 0
    v_dot2c_f32_bf16 v20, s27, v36
    v_dot2c_f32_bf16 v22, v36, v36
    v_mfma_f32_32x32x16_bf16 v[96:111], v[32:35], v[44:47], 0
    ds_read_b128 v[48:51], v7 offset:0
    v_dot2c_f32_bf16 v21, s27, v37
    v_mfma_f32_32x32x16_bf16 v[128:143], v[44:47], v[32:35], 0
    ds_read_b128 v[52:55], v7 offset:4096
    v_dot2c_f32_bf16 v23, v37, v37
    v_mfma_f32_32x32x16_bf16 v[80:95], v[36:39], v[40:43], 0
    ds_read_b128 v[56:59], v4 offset:2048
    v_dot2c_f32_bf16 v20, s27, v38
    v_dot2c_f32_bf16 v22, v38, v38
    v_mfma_f32_32x32x16_bf16 v[112:127], v[36:39], v[44:47], 0
    ds_read_b128 v[60:63], v4 offset:3072
    v_dot2c_f32_bf16 v21, s27, v39
    v_mfma_f32_32x32x16_bf16 v[144:159], v[44:47], v[36:39], 0
    v_dot2c_f32_bf16 v23, v39, v39
    s_waitcnt lgkmcnt(0)
    v_mfma_f32_32x32x16_bf16 v[64:79], v[48:51], v[56:59], v[64:79]
    v_dot2c_f32_bf16 v20, s27, v52
    v_dot2c_f32_bf16 v22, v52, v52
    v_mfma_f32_32x32x16_bf16 v[96:111], v[48:51], v[60:63], v[96:111]
    ds_read_b128 v[32:35], v8 offset:0
    v_dot2c_f32_bf16 v21, s27, v53
    v_mfma_f32_32x32x16_bf16 v[128:143], v[60:63], v[48:51], v[128:143]
    ds_read_b128 v[36:39], v8 offset:4096
    v_dot2c_f32_bf16 v23, v53, v53
    v_mfma_f32_32x32x16_bf16 v[80:95], v[52:55], v[56:59], v[80:95]
    ds_read_b128 v[40:43], v4 offset:4096
    v_dot2c_f32_bf16 v20, s27, v54
    v_dot2c_f32_bf16 v22, v54, v54
    v_mfma_f32_32x32x16_bf16 v[112:127], v[52:55], v[60:63], v[112:127]
    ds_read_b128 v[44:47], v4 offset:5120
    v_dot2c_f32_bf16 v21, s27, v55
    v_mfma_f32_32x32x16_bf16 v[144:159], v[60:63], v[52:55], v[144:159]
    v_dot2c_f32_bf16 v23, v55, v55
    s_waitcnt lgkmcnt(0)
    v_mfma_f32_32x32x16_bf16 v[64:79], v[32:35], v[40:43], v[64:79]
    v_dot2c_f32_bf16 v20, s27, v36
    v_dot2c_f32_bf16 v22, v36, v36
    v_mfma_f32_32x32x16_bf16 v[96:111], v[32:35], v[44:47], v[96:111]
    ds_read_b128 v[48:51], v9 offset:0
    v_dot2c_f32_bf16 v21, s27, v37
    v_mfma_f32_32x32x16_bf16 v[128:143], v[44:47], v[32:35], v[128:143]
    ds_read_b128 v[52:55], v9 offset:4096
    v_dot2c_f32_bf16 v23, v37, v37
    v_mfma_f32_32x32x16_bf16 v[80:95], v[36:39], v[40:43], v[80:95]
    ds_read_b128 v[56:59], v4 offset:6144
    v_dot2c_f32_bf16 v20, s27, v38
    v_dot2c_f32_bf16 v22, v38, v38
    v_mfma_f32_32x32x16_bf16 v[112:127], v[36:39], v[44:47], v[112:127]
    ds_read_b128 v[60:63], v4 offset:7168
    v_dot2c_f32_bf16 v21, s27, v39
    v_mfma_f32_32x32x16_bf16 v[144:159], v[44:47], v[36:39], v[144:159]
    v_dot2c_f32_bf16 v23, v39, v39
    s_waitcnt vmcnt(8)
    s_barrier
    s_lshl_b32 s28, s13, 12
    s_add_u32 s28, s28, 98304
    s_mov_b32 m0, s28
    s_add_u32 s29, s24, 384
    buffer_load_dwordx4 v2, s[16:19], s29 offen offset:0 lds
    s_add_u32 s29, s29, 9216
    buffer_load_dwordx4 v3, s[16:19], s29 offen offset:1024 lds
    s_add_u32 s29, s29, 9216
    buffer_load_dwordx4 v2, s[16:19], s29 offen offset:2048 lds
    s_add_u32 s29, s29, 9216
    buffer_load_dwordx4 v3, s[16:19], s29 offen offset:3072 lds
    s_add_u32 s28, s28, 16384
    s_mov_b32 m0, s28
    s_add_u32 s29, s25, 24576
    buffer_load_dwordx4 v1, s[8:11], s29 offen offset:0 lds
    buffer_load_dwordx4 v1, s[8:11], s29 offen offset:1024 lds
    buffer_load_dwordx4 v1, s[8:11], s29 offen offset:2048 lds
    buffer_load_dwordx4 v1, s[8:11], s29 offen offset:3072 lds
    s_waitcnt lgkmcnt(0)
    v_mfma_f32_32x32x16_bf16 v[64:79], v[48:51], v[56:59], v[64:79]
    v_dot2c_f32_bf16 v20, s27, v52
    v_dot2c_f32_bf16 v22, v52, v52
    v_mfma_f32_32x32x16_bf16 v[96:111], v[48:51], v[60:63], v[96:111]
    ds_read_b128 v[32:35], v6 offset:32768
    v_dot2c_f32_bf16 v21, s27, v53
    v_mfma_f32_32x32x16_bf16 v[128:143], v[60:63], v[48:51], v[128:143]
    ds_read_b128 v[36:39], v6 offset:36864
    v_dot2c_f32_bf16 v23, v53, v53
    v_mfma_f32_32x32x16_bf16 v[80:95], v[52:55], v[56:59], v[80:95]
    ds_read_b128 v[40:43], v4 offset:32768
    v_dot2c_f32_bf16 v20, s27, v54
    v_dot2c_f32_bf16 v22, v54, v54
    v_mfma_f32_32x32x16_bf16 v[112:127], v[52:55], v[60:63], v[112:127]
    ds_read_b128 v[44:47], v4 offset:33792
    v_dot2c_f32_bf16 v21, s27, v55
    v_mfma_f32_32x32x16_bf16 v[144:159], v[60:63], v[52:55], v[144:159]
    v_dot2c_f32_bf16 v23, v55, v55
    s_waitcnt lgkmcnt(0)
    v_mfma_f32_32x32x16_bf16 v[64:79], v[32:35], v[40:43], v[64:79]
    v_dot2c_f32_bf16 v20, s27, v36
    v_dot2c_f32_bf16 v22, v36, v36
    v_mfma_f32_32x32x16_bf16 v[96:111], v[32:35], v[44:47], v[96:111]
    ds_read_b128 v[48:51], v7 offset:32768
    v_dot2c_f32_bf16 v21, s27, v37
    v_mfma_f32_32x32x16_bf16 v[128:143], v[44:47], v[32:35], v[128:143]
    ds_read_b128 v[52:55], v7 offset:36864
    v_dot2c_f32_bf16 v23, v37, v37
    v_mfma_f32_32x32x16_bf16 v[80:95], v[36:39], v[40:43], v[80:95]
    ds_read_b128 v[56:59], v4 offset:34816
    v_dot2c_f32_bf16 v20, s27, v38
    v_dot2c_f32_bf16 v22, v38, v38
    v_mfma_f32_32x32x16_bf16 v[112:127], v[36:39], v[44:47], v[112:127]
    ds_read_b128 v[60:63], v4 offset:35840
    v_dot2c_f32_bf16 v21, s27, v39
    v_mfma_f32_32x32x16_bf16 v[144:159], v[44:47], v[36:39], v[144:159]
    v_dot2c_f32_bf16 v23, v39, v39
    s_waitcnt lgkmcnt(0)
    v_mfma_f32_32x32x16_bf16 v[64:79], v[48:51], v[56:59], v[64:79]
    v_dot2c_f32_bf16 v20, s27, v52
    v_dot2c_f32_bf16 v22, v52, v52
    v_mfma_f32_32x32x16_bf16 v[96:111], v[48:51], v[60:63], v[96:111]
    ds_read_b128 v[32:35], v8 offset:32768
    v_dot2c_f32_bf16 v21, s27, v53
    v_mfma_f32_32x32x16_bf16 v[128:143], v[60:63], v[48:51], v[128:143]
    ds_read_b128 v[36:39], v8 offset:36864
    v_dot2c_f32_bf16 v23, v53, v53
    v_mfma_f32_32x32x16_bf16 v[80:95], v[52:55], v[56:59], v[80:95]
    ds_read_b128 v[40:43], v4 offset:36864
    v_dot2c_f32_bf16 v20, s27, v54
    v_dot2c_f32_bf16 v22, v54, v54
    v_mfma_f32_32x32x16_bf16 v[112:127], v[52:55], v[60:63], v[112:127]
    ds_read_b128 v[44:47], v4 offset:37888
    v_dot2c_f32_bf16 v21, s27, v55
    v_mfma_f32_32x32x16_bf16 v[144:159], v[60:63], v[52:55], v[144:159]
    v_dot2c_f32_bf16 v23, v55, v55
    s_waitcnt lgkmcnt(0)
    v_mfma_f32_32x32x16_bf16 v[64:79], v[32:35], v[40:43], v[64:79]
    v_dot2c_f32_bf16 v20, s27, v36
    v_dot2c_f32_bf16 v22, v36, v36
    v_mfma_f32_32x32x16_bf16 v[96:111], v[32:35], v[44:47], v[96:111]
    ds_read_b128 v[48:51], v9 offset:32768
    v_dot2c_f32_bf16 v21, s27, v37
    v_mfma_f32_32x32x16_bf16 v[128:143], v[44:47], v[32:35], v[128:143]
    ds_read_b128 v[52:55], v9 offset:36864
    v_dot2c_f32_bf16 v23, v37, v37
    v_mfma_f32_32x32x16_bf16 v[80:95], v[36:39], v[40:43], v[80:95]
    ds_read_b128 v[56:59], v4 offset:38912
    v_dot2c_f32_bf16 v20, s27, v38
    v_dot2c_f32_bf16 v22, v38, v38
    v_mfma_f32_32x32x16_bf16 v[112:127], v[36:39], v[44:47], v[112:127]
    ds_read_b128 v[60:63], v4 offset:39936
    v_dot2c_f32_bf16 v21, s27, v39
    v_mfma_f32_32x32x16_bf16 v[144:159], v[44:47], v[36:39], v[144:159]
    v_dot2c_f32_bf16 v23, v39, v39
    s_waitcnt vmcnt(8)
    s_barrier
    s_lshl_b32 s28, s13, 12
    s_mov_b32 m0, s28
    s_add_u32 s29, s24, 512
    buffer_load_dwordx4 v2, s[16:19], s29 offen offset:0 lds
    s_add_u32 s29, s29, 9216
    buffer_load_dwordx4 v3, s[16:19], s29 offen offset:1024 lds
    s_add_u32 s29, s29, 9216
    buffer_load_dwordx4 v2, s[16:19], s29 offen offset:2048 lds
    s_add_u32 s29, s29, 9216
    buffer_load_dwordx4 v3, s[16:19], s29 offen offset:3072 lds
    s_add_u32 s28, s28, 16384
    s_mov_b32 m0, s28
    s_add_u32 s29, s25, 32768
    buffer_load_dwordx4 v1, s[8:11], s29 offen offset:0 lds
    buffer_load_dwordx4 v1, s[8:11], s29 offen offset:1024 lds
    buffer_load_dwordx4 v1, s[8:11], s29 offen offset:2048 lds
    buffer_load_dwordx4 v1, s[8:11], s29 offen offset:3072 lds
    s_waitcnt lgkmcnt(0)
    v_mfma_f32_32x32x16_bf16 v[64:79], v[48:51], v[56:59], v[64:79]
    v_dot2c_f32_bf16 v20, s27, v52
    v_dot2c_f32_bf16 v22, v52, v52
    v_mfma_f32_32x32x16_bf16 v[96:111], v[48:51], v[60:63], v[96:111]
    ds_read_b128 v[32:35], v10 offset:0
    v_dot2c_f32_bf16 v21, s27, v53
    v_mfma_f32_32x32x16_bf16 v[128:143], v[60:63], v[48:51], v[128:143]
    ds_read_b128 v[36:39], v10 offset:4096
    v_dot2c_f32_bf16 v23, v53, v53
    v_mfma_f32_32x32x16_bf16 v[80:95], v[52:55], v[56:59], v[80:95]
    ds_read_b128 v[40:43], v5 offset:0
    v_dot2c_f32_bf16 v20, s27, v54
    v_dot2c_f32_bf16 v22, v54, v54
    v_mfma_f32_32x32x16_bf16 v[112:127], v[52:55], v[60:63], v[112:127]
    ds_read_b128 v[44:47], v5 offset:1024
    v_dot2c_f32_bf16 v21, s27, v55
    v_mfma_f32_32x32x16_bf16 v[144:159], v[60:63], v[52:55], v[144:159]
    v_dot2c_f32_bf16 v23, v55, v55
    s_waitcnt lgkmcnt(0)
    v_mfma_f32_32x32x16_bf16 v[64:79], v[32:35], v[40:43], v[64:79]
    v_dot2c_f32_bf16 v20, s27, v36
    v_dot2c_f32_bf16 v22, v36, v36
    v_mfma_f32_32x32x16_bf16 v[96:111], v[32:35], v[44:47], v[96:111]
    ds_read_b128 v[48:51], v11 offset:0
    v_dot2c_f32_bf16 v21, s27, v37
    v_mfma_f32_32x32x16_bf16 v[128:143], v[44:47], v[32:35], v[128:143]
    ds_read_b128 v[52:55], v11 offset:4096
    v_dot2c_f32_bf16 v23, v37, v37
    v_mfma_f32_32x32x16_bf16 v[80:95], v[36:39], v[40:43], v[80:95]
    ds_read_b128 v[56:59], v5 offset:2048
    v_dot2c_f32_bf16 v20, s27, v38
    v_dot2c_f32_bf16 v22, v38, v38
    v_mfma_f32_32x32x16_bf16 v[112:127], v[36:39], v[44:47], v[112:127]
    ds_read_b128 v[60:63], v5 offset:3072
    v_dot2c_f32_bf16 v21, s27, v39
    v_mfma_f32_32x32x16_bf16 v[144:159], v[44:47], v[36:39], v[144:159]
    v_dot2c_f32_bf16 v23, v39, v39
    s_waitcnt lgkmcnt(0)
    v_mfma_f32_32x32x16_bf16 v[64:79], v[48:51], v[56:59], v[64:79]
    v_dot2c_f32_bf16 v20, s27, v52
    v_dot2c_f32_bf16 v22, v52, v52
    v_mfma_f32_32x32x16_bf16 v[96:111], v[48:51], v[60:63], v[96:111]
    ds_read_b128 v[32:35], v12 offset:0
    v_dot2c_f32_bf16 v21, s27, v53
    v_mfma_f32_32x32x16_bf16 v[128:143], v[60:63], v[48:51], v[128:143]
    ds_read_b128 v[36:39], v12 offset:4096
    v_dot2c_f32_bf16 v23, v53, v53
    v_mfma_f32_32x32x16_bf16 v[80:95], v[52:55], v[56:59], v[80:95]
    ds_read_b128 v[40:43], v5 offset:4096
    v_dot2c_f32_bf16 v20, s27, v54
    v_dot2c_f32_bf16 v22, v54, v54
    v_mfma_f32_32x32x16_bf16 v[112:127], v[52:55], v[60:63], v[112:127]
    ds_read_b128 v[44:47], v5 offset:5120
    v_dot2c_f32_bf16 v21, s27, v55
    v_mfma_f32_32x32x16_bf16 v[144:159], v[60:63], v[52:55], v[144:159]
    v_dot2c_f32_bf16 v23, v55, v55
    s_waitcnt lgkmcnt(0)
    v_mfma_f32_32x32x16_bf16 v[64:79], v[32:35], v[40:43], v[64:79]
    v_dot2c_f32_bf16 v20, s27, v36
    v_dot2c_f32_bf16 v22, v36, v36
    v_mfma_f32_32x32x16_bf16 v[96:111], v[32:35], v[44:47], v[96:111]
    ds_read_b128 v[48:51], v13 offset:0
    v_dot2c_f32_bf16 v21, s27, v37
    v_mfma_f32_32x32x16_bf16 v[128:143], v[44:47], v[32:35], v[128:143]
    ds_read_b128 v[52:55], v13 offset:4096
    v_dot2c_f32_bf16 v23, v37, v37
    v_mfma_f32_32x32x16_bf16 v[80:95], v[36:39], v[40:43], v[80:95]
    ds_read_b128 v[56:59], v5 offset:6144
    v_dot2c_f32_bf16 v20, s27, v38
    v_dot2c_f32_bf16 v22, v38, v38
    v_mfma_f32_32x32x16_bf16 v[112:127], v[36:39], v[44:47], v[112:127]
    ds_read_b128 v[60:63], v5 offset:7168
    v_dot2c_f32_bf16 v21, s27, v39
    v_mfma_f32_32x32x16_bf16 v[144:159], v[44:47], v[36:39], v[144:159]
    v_dot2c_f32_bf16 v23, v39, v39
    s_waitcnt vmcnt(8)
    s_barrier
    s_lshl_b32 s28, s13, 12
    s_add_u32 s28, s28, 32768
    s_mov_b32 m0, s28
    s_add_u32 s29, s24, 640
    buffer_load_dwordx4 v2, s[16:19], s29 offen offset:0 lds
    s_add_u32 s29, s29, 9216
    buffer_load_dwordx4 v3, s[16:19], s29 offen offset:1024 lds
    s_add_u32 s29, s29, 9216
    buffer_load_dwordx4 v2, s[16:19], s29 offen offset:2048 lds
    s_add_u32 s29, s29, 9216
    buffer_load_dwordx4 v3, s[16:19], s29 offen offset:3072 lds
    s_add_u32 s28, s28, 16384
    s_mov_b32 m0, s28
    s_add_u32 s29, s25, 40960
    buffer_load_dwordx4 v1, s[8:11], s29 offen offset:0 lds
    buffer_load_dwordx4 v1, s[8:11], s29 offen offset:1024 lds
    buffer_load_dwordx4 v1, s[8:11], s29 offen offset:2048 lds
    buffer_load_dwordx4 v1, s[8:11], s29 offen offset:3072 lds
    s_waitcnt lgkmcnt(0)
    v_mfma_f32_32x32x16_bf16 v[64:79], v[48:51], v[56:59], v[64:79]
    v_dot2c_f32_bf16 v20, s27, v52
    v_dot2c_f32_bf16 v22, v52, v52
    v_mfma_f32_32x32x16_bf16 v[96:111], v[48:51], v[60:63], v[96:111]
    ds_read_b128 v[32:35], v10 offset:32768
    v_dot2c_f32_bf16 v21, s27, v53
    v_mfma_f32_32x32x16_bf16 v[128:143], v[60:63], v[48:51], v[128:143]
    ds_read_b128 v[36:39], v10 offset:36864
    v_dot2c_f32_bf16 v23, v53, v53
    v_mfma_f32_32x32x16_bf16 v[80:95], v[52:55], v[56:59], v[80:95]
    ds_read_b128 v[40:43], v5 offset:32768
    v_dot2c_f32_bf16 v20, s27, v54
    v_dot2c_f32_bf16 v22, v54, v54
    v_mfma_f32_32x32x16_bf16 v[112:127], v[52:55], v[60:63], v[112:127]
    ds_read_b128 v[44:47], v5 offset:33792
    v_dot2c_f32_bf16 v21, s27, v55
    v_mfma_f32_32x32x16_bf16 v[144:159], v[60:63], v[52:55], v[144:159]
    v_dot2c_f32_bf16 v23, v55, v55
    s_waitcnt lgkmcnt(0)
    v_mfma_f32_32x32x16_bf16 v[64:79], v[32:35], v[40:43], v[64:79]
    v_dot2c_f32_bf16 v20, s27, v36
    v_dot2c_f32_bf16 v22, v36, v36
    v_mfma_f32_32x32x16_bf16 v[96:111], v[32:35], v[44:47], v[96:111]
    ds_read_b128 v[48:51], v11 offset:32768
    v_dot2c_f32_bf16 v21, s27, v37
    v_mfma_f32_32x32x16_bf16 v[128:143], v[44:47], v[32:35], v[128:143]
    ds_read_b128 v[52:55], v11 offset:36864
    v_dot2c_f32_bf16 v23, v37, v37
    v_mfma_f32_32x32x16_bf16 v[80:95], v[36:39], v[40:43], v[80:95]
    ds_read_b128 v[56:59], v5 offset:34816
    v_dot2c_f32_bf16 v20, s27, v38
    v_dot2c_f32_bf16 v22, v38, v38
    v_mfma_f32_32x32x16_bf16 v[112:127], v[36:39], v[44:47], v[112:127]
    ds_read_b128 v[60:63], v5 offset:35840
    v_dot2c_f32_bf16 v21, s27, v39
    v_mfma_f32_32x32x16_bf16 v[144:159], v[44:47], v[36:39], v[144:159]
    v_dot2c_f32_bf16 v23, v39, v39
    s_waitcnt lgkmcnt(0)
    v_mfma_f32_32x32x16_bf16 v[64:79], v[48:51], v[56:59], v[64:79]
    v_dot2c_f32_bf16 v20, s27, v52
    v_dot2c_f32_bf16 v22, v52, v52
    v_mfma_f32_32x32x16_bf16 v[96:111], v[48:51], v[60:63], v[96:111]
    ds_read_b128 v[32:35], v12 offset:32768
    v_dot2c_f32_bf16 v21, s27, v53
    v_mfma_f32_32x32x16_bf16 v[128:143], v[60:63], v[48:51], v[128:143]
    ds_read_b128 v[36:39], v12 offset:36864
    v_dot2c_f32_bf16 v23, v53, v53
    v_mfma_f32_32x32x16_bf16 v[80:95], v[52:55], v[56:59], v[80:95]
    ds_read_b128 v[40:43], v5 offset:36864
    v_dot2c_f32_bf16 v20, s27, v54
    v_dot2c_f32_bf16 v22, v54, v54
    v_mfma_f32_32x32x16_bf16 v[112:127], v[52:55], v[60:63], v[112:127]
    ds_read_b128 v[44:47], v5 offset:37888
    v_dot2c_f32_bf16 v21, s27, v55
    v_mfma_f32_32x32x16_bf16 v[144:159], v[60:63], v[52:55], v[144:159]
    v_dot2c_f32_bf16 v23, v55, v55
    s_waitcnt lgkmcnt(0)
    v_mfma_f32_32x32x16_bf16 v[64:79], v[32:35], v[40:43], v[64:79]
    v_dot2c_f32_bf16 v20, s27, v36
    v_dot2c_f32_bf16 v22, v36, v36
    v_mfma_f32_32x32x16_bf16 v[96:111], v[32:35], v[44:47], v[96:111]
    ds_read_b128 v[48:51], v13 offset:32768
    v_dot2c_f32_bf16 v21, s27, v37
    v_mfma_f32_32x32x16_bf16 v[128:143], v[44:47], v[32:35], v[128:143]
    ds_read_b128 v[52:55], v13 offset:36864
    v_dot2c_f32_bf16 v23, v37, v37
    v_mfma_f32_32x32x16_bf16 v[80:95], v[36:39], v[40:43], v[80:95]
    ds_read_b128 v[56:59], v5 offset:38912
    v_dot2c_f32_bf16 v20, s27, v38
    v_dot2c_f32_bf16 v22, v38, v38
    v_mfma_f32_32x32x16_bf16 v[112:127], v[36:39], v[44:47], v[112:127]
    ds_read_b128 v[60:63], v5 offset:39936
    v_dot2c_f32_bf16 v21, s27, v39
    v_mfma_f32_32x32x16_bf16 v[144:159], v[44:47], v[36:39], v[144:159]
    v_dot2c_f32_bf16 v23, v39, v39
    s_waitcnt vmcnt(8)
    s_barrier
    s_lshl_b32 s28, s13, 12
    s_add_u32 s28, s28, 65536
    s_mov_b32 m0, s28
    s_add_u32 s29, s24, 768
    buffer_load_dwordx4 v2, s[16:19], s29 offen offset:0 lds
    s_add_u32 s29, s29, 9216
    buffer_load_dwordx4 v3, s[16:19], s29 offen offset:1024 lds
    s_add_u32 s29, s29, 9216
    buffer_load_dwordx4 v2, s[16:19], s29 offen offset:2048 lds
    s_add_u32 s29, s29, 9216
    buffer_load_dwordx4 v3, s[16:19], s29 offen offset:3072 lds
    s_add_u32 s28, s28, 16384
    s_mov_b32 m0, s28
    s_add_u32 s29, s25, 49152
    buffer_load_dwordx4 v1, s[8:11], s29 offen offset:0 lds
    buffer_load_dwordx4 v1, s[8:11], s29 offen offset:1024 lds
    buffer_load_dwordx4 v1, s[8:11], s29 offen offset:2048 lds
    buffer_load_dwordx4 v1, s[8:11], s29 offen offset:3072 lds
    s_waitcnt lgkmcnt(0)
    v_mfma_f32_32x32x16_bf16 v[64:79], v[48:51], v[56:59], v[64:79]
    v_dot2c_f32_bf16 v20, s27, v52
    v_dot2c_f32_bf16 v22, v52, v52
    v_mfma_f32_32x32x16_bf16 v[96:111], v[48:51], v[60:63], v[96:111]
    ds_read_b128 v[32:35], v6 offset:0
    v_dot2c_f32_bf16 v21, s27, v53
    v_mfma_f32_32x32x16_bf16 v[128:143], v[60:63], v[48:51], v[128:143]
    ds_read_b128 v[36:39], v6 offset:4096
    v_dot2c_f32_bf16 v23, v53, v53
    v_mfma_f32_32x32x16_bf16 v[80:95], v[52:55], v[56:59], v[80:95]
    ds_read_b128 v[40:43], v4 offset:0
    v_dot2c_f32_bf16 v20, s27, v54
    v_dot2c_f32_bf16 v22, v54, v54
    v_mfma_f32_32x32x16_bf16 v[112:127], v[52:55], v[60:63], v[112:127]
    ds_read_b128 v[44:47], v4 offset:1024
    v_dot2c_f32_bf16 v21, s27, v55
    v_mfma_f32_32x32x16_bf16 v[144:159], v[60:63], v[52:55], v[144:159]
    v_dot2c_f32_bf16 v23, v55, v55
    s_waitcnt lgkmcnt(0)
    v_mfma_f32_32x32x16_bf16 v[64:79], v[32:35], v[40:43], v[64:79]
    v_dot2c_f32_bf16 v20, s27, v36
    v_dot2c_f32_bf16 v22, v36, v36
    v_mfma_f32_32x32x16_bf16 v[96:111], v[32:35], v[44:47], v[96:111]
    ds_read_b128 v[48:51], v7 offset:0
    v_dot2c_f32_bf16 v21, s27, v37
    v_mfma_f32_32x32x16_bf16 v[128:143], v[44:47], v[32:35], v[128:143]
    ds_read_b128 v[52:55], v7 offset:4096
    v_dot2c_f32_bf16 v23, v37, v37
    v_mfma_f32_32x32x16_bf16 v[80:95], v[36:39], v[40:43], v[80:95]
    ds_read_b128 v[56:59], v4 offset:2048
    v_dot2c_f32_bf16 v20, s27, v38
    v_dot2c_f32_bf16 v22, v38, v38
    v_mfma_f32_32x32x16_bf16 v[112:127], v[36:39], v[44:47], v[112:127]
    ds_read_b128 v[60:63], v4 offset:3072
    v_dot2c_f32_bf16 v21, s27, v39
    v_mfma_f32_32x32x16_bf16 v[144:159], v[44:47], v[36:39], v[144:159]
    v_dot2c_f32_bf16 v23, v39, v39
    s_waitcnt lgkmcnt(0)
    v_mfma_f32_32x32x16_bf16 v[64:79], v[48:51], v[56:59], v[64:79]
    v_dot2c_f32_bf16 v20, s27, v52
    v_dot2c_f32_bf16 v22, v52, v52
    v_mfma_f32_32x32x16_bf16 v[96:111], v[48:51], v[60:63], v[96:111]
    ds_read_b128 v[32:35], v8 offset:0
    v_dot2c_f32_bf16 v21, s27, v53
    v_mfma_f32_32x32x16_bf16 v[128:143], v[60:63], v[48:51], v[128:143]
    ds_read_b128 v[36:39], v8 offset:4096
    v_dot2c_f32_bf16 v23, v53, v53
    v_mfma_f32_32x32x16_bf16 v[80:95], v[52:55], v[56:59], v[80:95]
    ds_read_b128 v[40:43], v4 offset:4096
    v_dot2c_f32_bf16 v20, s27, v54
    v_dot2c_f32_bf16 v22, v54, v54
    v_mfma_f32_32x32x16_bf16 v[112:127], v[52:55], v[60:63], v[112:127]
    ds_read_b128 v[44:47], v4 offset:5120
    v_dot2c_f32_bf16 v21, s27, v55
    v_mfma_f32_32x32x16_bf16 v[144:159], v[60:63], v[52:55], v[144:159]
    v_dot2c_f32_bf16 v23, v55, v55
    s_waitcnt lgkmcnt(0)
    v_mfma_f32_32x32x16_bf16 v[64:79], v[32:35], v[40:43], v[64:79]
    v_dot2c_f32_bf16 v20, s27, v36
    v_dot2c_f32_bf16 v22, v36, v36
    v_mfma_f32_32x32x16_bf16 v[96:111], v[32:35], v[44:47], v[96:111]
    ds_read_b128 v[48:51], v9 offset:0
    v_dot2c_f32_bf16 v21, s27, v37
    v_mfma_f32_32x32x16_bf16 v[128:143], v[44:47], v[32:35], v[128:143]
    ds_read_b128 v[52:55], v9 offset:4096
    v_dot2c_f32_bf16 v23, v37, v37
    v_mfma_f32_32x32x16_bf16 v[80:95], v[36:39], v[40:43], v[80:95]
    ds_read_b128 v[56:59], v4 offset:6144
    v_dot2c_f32_bf16 v20, s27, v38
    v_dot2c_f32_bf16 v22, v38, v38
    v_mfma_f32_32x32x16_bf16 v[112:127], v[36:39], v[44:47], v[112:127]
    ds_read_b128 v[60:63], v4 offset:7168
    v_dot2c_f32_bf16 v21, s27, v39
    v_mfma_f32_32x32x16_bf16 v[144:159], v[44:47], v[36:39], v[144:159]
    v_dot2c_f32_bf16 v23, v39, v39
    s_waitcnt vmcnt(8)
    s_barrier
    s_lshl_b32 s28, s13, 12
    s_add_u32 s28, s28, 98304
    s_mov_b32 m0, s28
    s_add_u32 s29, s24, 896
    buffer_load_dwordx4 v2, s[16:19], s29 offen offset:0 lds
    s_add_u32 s29, s29, 9216
    buffer_load_dwordx4 v3, s[16:19], s29 offen offset:1024 lds
    s_add_u32 s29, s29, 9216
    buffer_load_dwordx4 v2, s[16:19], s29 offen offset:2048 lds
    s_add_u32 s29, s29, 9216
    buffer_load_dwordx4 v3, s[16:19], s29 offen offset:3072 lds
    s_add_u32 s28, s28, 16384
    s_mov_b32 m0, s28
    s_add_u32 s29, s25, 57344
    buffer_load_dwordx4 v1, s[8:11], s29 offen offset:0 lds
    buffer_load_dwordx4 v1, s[8:11], s29 offen offset:1024 lds
    buffer_load_dwordx4 v1, s[8:11], s29 offen offset:2048 lds
    buffer_load_dwordx4 v1, s[8:11], s29 offen offset:3072 lds
    s_waitcnt lgkmcnt(0)
    v_mfma_f32_32x32x16_bf16 v[64:79], v[48:51], v[56:59], v[64:79]
    v_dot2c_f32_bf16 v20, s27, v52
    v_dot2c_f32_bf16 v22, v52, v52
    v_mfma_f32_32x32x16_bf16 v[96:111], v[48:51], v[60:63], v[96:111]
    ds_read_b128 v[32:35], v6 offset:32768
    v_dot2c_f32_bf16 v21, s27, v53
    v_mfma_f32_32x32x16_bf16 v[128:143], v[60:63], v[48:51], v[128:143]
    ds_read_b128 v[36:39], v6 offset:36864
    v_dot2c_f32_bf16 v23, v53, v53
    v_mfma_f32_32x32x16_bf16 v[80:95], v[52:55], v[56:59], v[80:95]
    ds_read_b128 v[40:43], v4 offset:32768
    v_dot2c_f32_bf16 v20, s27, v54
    v_dot2c_f32_bf16 v22, v54, v54
    v_mfma_f32_32x32x16_bf16 v[112:127], v[52:55], v[60:63], v[112:127]
    ds_read_b128 v[44:47], v4 offset:33792
    v_dot2c_f32_bf16 v21, s27, v55
    v_mfma_f32_32x32x16_bf16 v[144:159], v[60:63], v[52:55], v[144:159]
    v_dot2c_f32_bf16 v23, v55, v55
    s_waitcnt lgkmcnt(0)
    v_mfma_f32_32x32x16_bf16 v[64:79], v[32:35], v[40:43], v[64:79]
    v_dot2c_f32_bf16 v20, s27, v36
    v_dot2c_f32_bf16 v22, v36, v36
    v_mfma_f32_32x32x16_bf16 v[96:111], v[32:35], v[44:47], v[96:111]
    ds_read_b128 v[48:51], v7 offset:32768
    v_dot2c_f32_bf16 v21, s27, v37
    v_mfma_f32_32x32x16_bf16 v[128:143], v[44:47], v[32:35], v[128:143]
    ds_read_b128 v[52:55], v7 offset:36864
    v_dot2c_f32_bf16 v23, v37, v37
    v_mfma_f32_32x32x16_bf16 v[80:95], v[36:39], v[40:43], v[80:95]
    ds_read_b128 v[56:59], v4 offset:34816
    v_dot2c_f32_bf16 v20, s27, v38
    v_dot2c_f32_bf16 v22, v38, v38
    v_mfma_f32_32x32x16_bf16 v[112:127], v[36:39], v[44:47], v[112:127]
    ds_read_b128 v[60:63], v4 offset:35840
    v_dot2c_f32_bf16 v21, s27, v39
    v_mfma_f32_32x32x16_bf16 v[144:159], v[44:47], v[36:39], v[144:159]
    v_dot2c_f32_bf16 v23, v39, v39
    s_waitcnt lgkmcnt(0)
    v_mfma_f32_32x32x16_bf16 v[64:79], v[48:51], v[56:59], v[64:79]
    v_dot2c_f32_bf16 v20, s27, v52
    v_dot2c_f32_bf16 v22, v52, v52
    v_mfma_f32_32x32x16_bf16 v[96:111], v[48:51], v[60:63], v[96:111]
    ds_read_b128 v[32:35], v8 offset:32768
    v_dot2c_f32_bf16 v21, s27, v53
    v_mfma_f32_32x32x16_bf16 v[128:143], v[60:63], v[48:51], v[128:143]
    ds_read_b128 v[36:39], v8 offset:36864
    v_dot2c_f32_bf16 v23, v53, v53
    v_mfma_f32_32x32x16_bf16 v[80:95], v[52:55], v[56:59], v[80:95]
    ds_read_b128 v[40:43], v4 offset:36864
    v_dot2c_f32_bf16 v20, s27, v54
    v_dot2c_f32_bf16 v22, v54, v54
    v_mfma_f32_32x32x16_bf16 v[112:127], v[52:55], v[60:63], v[112:127]
    ds_read_b128 v[44:47], v4 offset:37888
    v_dot2c_f32_bf16 v21, s27, v55
    v_mfma_f32_32x32x16_bf16 v[144:159], v[60:63], v[52:55], v[144:159]
    v_dot2c_f32_bf16 v23, v55, v55
    s_waitcnt lgkmcnt(0)
    v_mfma_f32_32x32x16_bf16 v[64:79], v[32:35], v[40:43], v[64:79]
    v_dot2c_f32_bf16 v20, s27, v36
    v_dot2c_f32_bf16 v22, v36, v36
    v_mfma_f32_32x32x16_bf16 v[96:111], v[32:35], v[44:47], v[96:111]
    ds_read_b128 v[48:51], v9 offset:32768
    v_dot2c_f32_bf16 v21, s27, v37
    v_mfma_f32_32x32x16_bf16 v[128:143], v[44:47], v[32:35], v[128:143]
    ds_read_b128 v[52:55], v9 offset:36864
    v_dot2c_f32_bf16 v23, v37, v37
    v_mfma_f32_32x32x16_bf16 v[80:95], v[36:39], v[40:43], v[80:95]
    ds_read_b128 v[56:59], v4 offset:38912
    v_dot2c_f32_bf16 v20, s27, v38
    v_dot2c_f32_bf16 v22, v38, v38
    v_mfma_f32_32x32x16_bf16 v[112:127], v[36:39], v[44:47], v[112:127]
    ds_read_b128 v[60:63], v4 offset:39936
    v_dot2c_f32_bf16 v21, s27, v39
    v_mfma_f32_32x32x16_bf16 v[144:159], v[44:47], v[36:39], v[144:159]
    v_dot2c_f32_bf16 v23, v39, v39
    s_waitcnt vmcnt(8)
    s_barrier
    s_lshl_b32 s28, s13, 12
    s_mov_b32 m0, s28
    s_add_u32 s29, s24, 1024
    buffer_load_dwordx4 v2, s[16:19], s29 offen offset:0 lds
    s_add_u32 s29, s29, 9216
    buffer_load_dwordx4 v3, s[16:19], s29 offen offset:1024 lds
    s_add_u32 s29, s29, 9216
    buffer_load_dwordx4 v2, s[16:19], s29 offen offset:2048 lds
    s_add_u32 s29, s29, 9216
    buffer_load_dwordx4 v3, s[16:19], s29 offen offset:3072 lds
    s_add_u32 s28, s28, 16384
    s_mov_b32 m0, s28
    s_add_u32 s29, s25, 65536
    buffer_load_dwordx4 v1, s[8:11], s29 offen offset:0 lds
    buffer_load_dwordx4 v1, s[8:11], s29 offen offset:1024 lds
    buffer_load_dwordx4 v1, s[8:11], s29 offen offset:2048 lds
    buffer_load_dwordx4 v1, s[8:11], s29 offen offset:3072 lds
    s_waitcnt lgkmcnt(0)
    v_mfma_f32_32x32x16_bf16 v[64:79], v[48:51], v[56:59], v[64:79]
    v_dot2c_f32_bf16 v20, s27, v52
    v_dot2c_f32_bf16 v22, v52, v52
    v_mfma_f32_32x32x16_bf16 v[96:111], v[48:51], v[60:63], v[96:111]
    ds_read_b128 v[32:35], v10 offset:0
    v_dot2c_f32_bf16 v21, s27, v53
    v_mfma_f32_32x32x16_bf16 v[128:143], v[60:63], v[48:51], v[128:143]
    ds_read_b128 v[36:39], v10 offset:4096
    v_dot2c_f32_bf16 v23, v53, v53
    v_mfma_f32_32x32x16_bf16 v[80:95], v[52:55], v[56:59], v[80:95]
    ds_read_b128 v[40:43], v5 offset:0
    v_dot2c_f32_bf16 v20, s27, v54
    v_dot2c_f32_bf16 v22, v54, v54
    v_mfma_f32_32x32x16_bf16 v[112:127], v[52:55], v[60:63], v[112:127]
    ds_read_b128 v[44:47], v5 offset:1024
    v_dot2c_f32_bf16 v21, s27, v55
    v_mfma_f32_32x32x16_bf16 v[144:159], v[60:63], v[52:55], v[144:159]
    v_dot2c_f32_bf16 v23, v55, v55
    s_waitcnt lgkmcnt(0)
    v_mfma_f32_32x32x16_bf16 v[64:79], v[32:35], v[40:43], v[64:79]
    v_dot2c_f32_bf16 v20, s27, v36
    v_dot2c_f32_bf16 v22, v36, v36
    v_mfma_f32_32x32x16_bf16 v[96:111], v[32:35], v[44:47], v[96:111]
    ds_read_b128 v[48:51], v11 offset:0
    v_dot2c_f32_bf16 v21, s27, v37
    v_mfma_f32_32x32x16_bf16 v[128:143], v[44:47], v[32:35], v[128:143]
    ds_read_b128 v[52:55], v11 offset:4096
    v_dot2c_f32_bf16 v23, v37, v37
    v_mfma_f32_32x32x16_bf16 v[80:95], v[36:39], v[40:43], v[80:95]
    ds_read_b128 v[56:59], v5 offset:2048
    v_dot2c_f32_bf16 v20, s27, v38
    v_dot2c_f32_bf16 v22, v38, v38
    v_mfma_f32_32x32x16_bf16 v[112:127], v[36:39], v[44:47], v[112:127]
    ds_read_b128 v[60:63], v5 offset:3072
    v_dot2c_f32_bf16 v21, s27, v39
    v_mfma_f32_32x32x16_bf16 v[144:159], v[44:47], v[36:39], v[144:159]
    v_dot2c_f32_bf16 v23, v39, v39
    s_waitcnt lgkmcnt(0)
    v_mfma_f32_32x32x16_bf16 v[64:79], v[48:51], v[56:59], v[64:79]
    v_dot2c_f32_bf16 v20, s27, v52
    v_dot2c_f32_bf16 v22, v52, v52
    v_mfma_f32_32x32x16_bf16 v[96:111], v[48:51], v[60:63], v[96:111]
    ds_read_b128 v[32:35], v12 offset:0
    v_dot2c_f32_bf16 v21, s27, v53
    v_mfma_f32_32x32x16_bf16 v[128:143], v[60:63], v[48:51], v[128:143]
    ds_read_b128 v[36:39], v12 offset:4096
    v_dot2c_f32_bf16 v23, v53, v53
    v_mfma_f32_32x32x16_bf16 v[80:95], v[52:55], v[56:59], v[80:95]
    ds_read_b128 v[40:43], v5 offset:4096
    v_dot2c_f32_bf16 v20, s27, v54
    v_dot2c_f32_bf16 v22, v54, v54
    v_mfma_f32_32x32x16_bf16 v[112:127], v[52:55], v[60:63], v[112:127]
    ds_read_b128 v[44:47], v5 offset:5120
    v_dot2c_f32_bf16 v21, s27, v55
    v_mfma_f32_32x32x16_bf16 v[144:159], v[60:63], v[52:55], v[144:159]
    v_dot2c_f32_bf16 v23, v55, v55
    s_waitcnt lgkmcnt(0)
    v_mfma_f32_32x32x16_bf16 v[64:79], v[32:35], v[40:43], v[64:79]
    v_dot2c_f32_bf16 v20, s27, v36
    v_dot2c_f32_bf16 v22, v36, v36
    v_mfma_f32_32x32x16_bf16 v[96:111], v[32:35], v[44:47], v[96:111]
    ds_read_b128 v[48:51], v13 offset:0
    v_dot2c_f32_bf16 v21, s27, v37
    v_mfma_f32_32x32x16_bf16 v[128:143], v[44:47], v[32:35], v[128:143]
    ds_read_b128 v[52:55], v13 offset:4096
    v_dot2c_f32_bf16 v23, v37, v37
    v_mfma_f32_32x32x16_bf16 v[80:95], v[36:39], v[40:43], v[80:95]
    ds_read_b128 v[56:59], v5 offset:6144
    v_dot2c_f32_bf16 v20, s27, v38
    v_dot2c_f32_bf16 v22, v38, v38
    v_mfma_f32_32x32x16_bf16 v[112:127], v[36:39], v[44:47], v[112:127]
    ds_read_b128 v[60:63], v5 offset:7168
    v_dot2c_f32_bf16 v21, s27, v39
    v_mfma_f32_32x32x16_bf16 v[144:159], v[44:47], v[36:39], v[144:159]
    v_dot2c_f32_bf16 v23, v39, v39
    s_waitcnt vmcnt(8)
    s_barrier
    s_lshl_b32 s28, s13, 12
    s_add_u32 s28, s28, 32768
    s_mov_b32 m0, s28
    s_add_u32 s29, s24, 1152
    buffer_load_dwordx4 v2, s[16:19], s29 offen offset:0 lds
    s_add_u32 s29, s29, 9216
    buffer_load_dwordx4 v3, s[16:19], s29 offen offset:1024 lds
    s_add_u32 s29, s29, 9216
    buffer_load_dwordx4 v2, s[16:19], s29 offen offset:2048 lds
    s_add_u32 s29, s29, 9216
    buffer_load_dwordx4 v3, s[16:19], s29 offen offset:3072 lds
    s_add_u32 s28, s28, 16384
    s_mov_b32 m0, s28
    s_add_u32 s29, s25, 73728
    buffer_load_dwordx4 v1, s[8:11], s29 offen offset:0 lds
    buffer_load_dwordx4 v1, s[8:11], s29 offen offset:1024 lds
    buffer_load_dwordx4 v1, s[8:11], s29 offen offset:2048 lds
    buffer_load_dwordx4 v1, s[8:11], s29 offen offset:3072 lds
    s_waitcnt lgkmcnt(0)
    v_mfma_f32_32x32x16_bf16 v[64:79], v[48:51], v[56:59], v[64:79]
    v_dot2c_f32_bf16 v20, s27, v52
    v_dot2c_f32_bf16 v22, v52, v52
    v_mfma_f32_32x32x16_bf16 v[96:111], v[48:51], v[60:63], v[96:111]
    ds_read_b128 v[32:35], v10 offset:32768
    v_dot2c_f32_bf16 v21, s27, v53
    v_mfma_f32_32x32x16_bf16 v[128:143], v[60:63], v[48:51], v[128:143]
    ds_read_b128 v[36:39], v10 offset:36864
    v_dot2c_f32_bf16 v23, v53, v53
    v_mfma_f32_32x32x16_bf16 v[80:95], v[52:55], v[56:59], v[80:95]
    ds_read_b128 v[40:43], v5 offset:32768
    v_dot2c_f32_bf16 v20, s27, v54
    v_dot2c_f32_bf16 v22, v54, v54
    v_mfma_f32_32x32x16_bf16 v[112:127], v[52:55], v[60:63], v[112:127]
    ds_read_b128 v[44:47], v5 offset:33792
    v_dot2c_f32_bf16 v21, s27, v55
    v_mfma_f32_32x32x16_bf16 v[144:159], v[60:63], v[52:55], v[144:159]
    v_dot2c_f32_bf16 v23, v55, v55
    s_waitcnt lgkmcnt(0)
    v_mfma_f32_32x32x16_bf16 v[64:79], v[32:35], v[40:43], v[64:79]
    v_dot2c_f32_bf16 v20, s27, v36
    v_dot2c_f32_bf16 v22, v36, v36
    v_mfma_f32_32x32x16_bf16 v[96:111], v[32:35], v[44:47], v[96:111]
    ds_read_b128 v[48:51], v11 offset:32768
    v_dot2c_f32_bf16 v21, s27, v37
    v_mfma_f32_32x32x16_bf16 v[128:143], v[44:47], v[32:35], v[128:143]
    ds_read_b128 v[52:55], v11 offset:36864
    v_dot2c_f32_bf16 v23, v37, v37
    v_mfma_f32_32x32x16_bf16 v[80:95], v[36:39], v[40:43], v[80:95]
    ds_read_b128 v[56:59], v5 offset:34816
    v_dot2c_f32_bf16 v20, s27, v38
    v_dot2c_f32_bf16 v22, v38, v38
    v_mfma_f32_32x32x16_bf16 v[112:127], v[36:39], v[44:47], v[112:127]
    ds_read_b128 v[60:63], v5 offset:35840
    v_dot2c_f32_bf16 v21, s27, v39
    v_mfma_f32_32x32x16_bf16 v[144:159], v[44:47], v[36:39], v[144:159]
    v_dot2c_f32_bf16 v23, v39, v39
    s_waitcnt lgkmcnt(0)
    v_mfma_f32_32x32x16_bf16 v[64:79], v[48:51], v[56:59], v[64:79]
    v_dot2c_f32_bf16 v20, s27, v52
    v_dot2c_f32_bf16 v22, v52, v52
    v_mfma_f32_32x32x16_bf16 v[96:111], v[48:51], v[60:63], v[96:111]
    ds_read_b128 v[32:35], v12 offset:32768
    v_dot2c_f32_bf16 v21, s27, v53
    v_mfma_f32_32x32x16_bf16 v[128:143], v[60:63], v[48:51], v[128:143]
    ds_read_b128 v[36:39], v12 offset:36864
    v_dot2c_f32_bf16 v23, v53, v53
    v_mfma_f32_32x32x16_bf16 v[80:95], v[52:55], v[56:59], v[80:95]
    ds_read_b128 v[40:43], v5 offset:36864
    v_dot2c_f32_bf16 v20, s27, v54
    v_dot2c_f32_bf16 v22, v54, v54
    v_mfma_f32_32x32x16_bf16 v[112:127], v[52:55], v[60:63], v[112:127]
    ds_read_b128 v[44:47], v5 offset:37888
    v_dot2c_f32_bf16 v21, s27, v55
    v_mfma_f32_32x32x16_bf16 v[144:159], v[60:63], v[52:55], v[144:159]
    v_dot2c_f32_bf16 v23, v55, v55
    s_waitcnt lgkmcnt(0)
    v_mfma_f32_32x32x16_bf16 v[64:79], v[32:35], v[40:43], v[64:79]
    v_dot2c_f32_bf16 v20, s27, v36
    v_dot2c_f32_bf16 v22, v36, v36
    v_mfma_f32_32x32x16_bf16 v[96:111], v[32:35], v[44:47], v[96:111]
    ds_read_b128 v[48:51], v13 offset:32768
    v_dot2c_f32_bf16 v21, s27, v37
    v_mfma_f32_32x32x16_bf16 v[128:143], v[44:47], v[32:35], v[128:143]
    ds_read_b128 v[52:55], v13 offset:36864
    v_dot2c_f32_bf16 v23, v37, v37
    v_mfma_f32_32x32x16_bf16 v[80:95], v[36:39], v[40:43], v[80:95]
    ds_read_b128 v[56:59], v5 offset:38912
    v_dot2c_f32_bf16 v20, s27, v38
    v_dot2c_f32_bf16 v22, v38, v38
    v_mfma_f32_32x32x16_bf16 v[112:127], v[36:39], v[44:47], v[112:127]
    ds_read_b128 v[60:63], v5 offset:39936
    v_dot2c_f32_bf16 v21, s27, v39
    v_mfma_f32_32x32x16_bf16 v[144:159], v[44:47], v[36:39], v[144:159]
    v_dot2c_f32_bf16 v23, v39, v39
    s_waitcnt vmcnt(8)
    s_barrier
    s_waitcnt lgkmcnt(0)
    v_mfma_f32_32x32x16_bf16 v[64:79], v[48:51], v[56:59], v[64:79]
    v_dot2c_f32_bf16 v20, s27, v52
    v_dot2c_f32_bf16 v22, v52, v52
    v_mfma_f32_32x32x16_bf16 v[96:111], v[48:51], v[60:63], v[96:111]
    ds_read_b128 v[32:35], v6 offset:0
    v_dot2c_f32_bf16 v21, s27, v53
    v_mfma_f32_32x32x16_bf16 v[128:143], v[60:63], v[48:51], v[128:143]
    ds_read_b128 v[36:39], v6 offset:4096
    v_dot2c_f32_bf16 v23, v53, v53
    v_mfma_f32_32x32x16_bf16 v[80:95], v[52:55], v[56:59], v[80:95]
    ds_read_b128 v[40:43], v4 offset:0
    v_dot2c_f32_bf16 v20, s27, v54
    v_dot2c_f32_bf16 v22, v54, v54
    v_mfma_f32_32x32x16_bf16 v[112:127], v[52:55], v[60:63], v[112:127]
    ds_read_b128 v[44:47], v4 offset:1024
    v_dot2c_f32_bf16 v21, s27, v55
    v_mfma_f32_32x32x16_bf16 v[144:159], v[60:63], v[52:55], v[144:159]
    v_dot2c_f32_bf16 v23, v55, v55
    s_waitcnt lgkmcnt(0)
    v_mfma_f32_32x32x16_bf16 v[64:79], v[32:35], v[40:43], v[64:79]
    v_dot2c_f32_bf16 v20, s27, v36
    v_dot2c_f32_bf16 v22, v36, v36
    v_mfma_f32_32x32x16_bf16 v[96:111], v[32:35], v[44:47], v[96:111]
    ds_read_b128 v[48:51], v7 offset:0
    v_dot2c_f32_bf16 v21, s27, v37
    v_mfma_f32_32x32x16_bf16 v[128:143], v[44:47], v[32:35], v[128:143]
    ds_read_b128 v[52:55], v7 offset:4096
    v_dot2c_f32_bf16 v23, v37, v37
    v_mfma_f32_32x32x16_bf16 v[80:95], v[36:39], v[40:43], v[80:95]
    ds_read_b128 v[56:59], v4 offset:2048
    v_dot2c_f32_bf16 v20, s27, v38
    v_dot2c_f32_bf16 v22, v38, v38
    v_mfma_f32_32x32x16_bf16 v[112:127], v[36:39], v[44:47], v[112:127]
    ds_read_b128 v[60:63], v4 offset:3072
    v_dot2c_f32_bf16 v21, s27, v39
    v_mfma_f32_32x32x16_bf16 v[144:159], v[44:47], v[36:39], v[144:159]
    v_dot2c_f32_bf16 v23, v39, v39
    s_waitcnt lgkmcnt(0)
    v_mfma_f32_32x32x16_bf16 v[64:79], v[48:51], v[56:59], v[64:79]
    v_dot2c_f32_bf16 v20, s27, v52
    v_dot2c_f32_bf16 v22, v52, v52
    v_mfma_f32_32x32x16_bf16 v[96:111], v[48:51], v[60:63], v[96:111]
    ds_read_b128 v[32:35], v8 offset:0
    v_dot2c_f32_bf16 v21, s27, v53
    v_mfma_f32_32x32x16_bf16 v[128:143], v[60:63], v[48:51], v[128:143]
    ds_read_b128 v[36:39], v8 offset:4096
    v_dot2c_f32_bf16 v23, v53, v53
    v_mfma_f32_32x32x16_bf16 v[80:95], v[52:55], v[56:59], v[80:95]
    ds_read_b128 v[40:43], v4 offset:4096
    v_dot2c_f32_bf16 v20, s27, v54
    v_dot2c_f32_bf16 v22, v54, v54
    v_mfma_f32_32x32x16_bf16 v[112:127], v[52:55], v[60:63], v[112:127]
    ds_read_b128 v[44:47], v4 offset:5120
    v_dot2c_f32_bf16 v21, s27, v55
    v_mfma_f32_32x32x16_bf16 v[144:159], v[60:63], v[52:55], v[144:159]
    v_dot2c_f32_bf16 v23, v55, v55
    s_waitcnt lgkmcnt(0)
    v_mfma_f32_32x32x16_bf16 v[64:79], v[32:35], v[40:43], v[64:79]
    v_dot2c_f32_bf16 v20, s27, v36
    v_dot2c_f32_bf16 v22, v36, v36
    v_mfma_f32_32x32x16_bf16 v[96:111], v[32:35], v[44:47], v[96:111]
    ds_read_b128 v[48:51], v9 offset:0
    v_dot2c_f32_bf16 v21, s27, v37
    v_mfma_f32_32x32x16_bf16 v[128:143], v[44:47], v[32:35], v[128:143]
    ds_read_b128 v[52:55], v9 offset:4096
    v_dot2c_f32_bf16 v23, v37, v37
    v_mfma_f32_32x32x16_bf16 v[80:95], v[36:39], v[40:43], v[80:95]
    ds_read_b128 v[56:59], v4 offset:6144
    v_dot2c_f32_bf16 v20, s27, v38
    v_dot2c_f32_bf16 v22, v38, v38
    v_mfma_f32_32x32x16_bf16 v[112:127], v[36:39], v[44:47], v[112:127]
    ds_read_b128 v[60:63], v4 offset:7168
    v_dot2c_f32_bf16 v21, s27, v39
    v_mfma_f32_32x32x16_bf16 v[144:159], v[44:47], v[36:39], v[144:159]
    v_dot2c_f32_bf16 v23, v39, v39
    s_waitcnt vmcnt(0)
    s_barrier
    s_waitcnt lgkmcnt(0)
    v_mfma_f32_32x32x16_bf16 v[64:79], v[48:51], v[56:59], v[64:79]
    v_dot2c_f32_bf16 v20, s27, v52
    v_dot2c_f32_bf16 v22, v52, v52
    v_mfma_f32_32x32x16_bf16 v[96:111], v[48:51], v[60:63], v[96:111]
    ds_read_b128 v[32:35], v6 offset:32768
    v_dot2c_f32_bf16 v21, s27, v53
    v_mfma_f32_32x32x16_bf16 v[128:143], v[60:63], v[48:51], v[128:143]
    ds_read_b128 v[36:39], v6 offset:36864
    v_dot2c_f32_bf16 v23, v53, v53
    v_mfma_f32_32x32x16_bf16 v[80:95], v[52:55], v[56:59], v[80:95]
    ds_read_b128 v[40:43], v4 offset:32768
    v_dot2c_f32_bf16 v20, s27, v54
    v_dot2c_f32_bf16 v22, v54, v54
    v_mfma_f32_32x32x16_bf16 v[112:127], v[52:55], v[60:63], v[112:127]
    ds_read_b128 v[44:47], v4 offset:33792
    v_dot2c_f32_bf16 v21, s27, v55
    v_mfma_f32_32x32x16_bf16 v[144:159], v[60:63], v[52:55], v[144:159]
    v_dot2c_f32_bf16 v23, v55, v55
    s_waitcnt lgkmcnt(0)
    v_mfma_f32_32x32x16_bf16 v[64:79], v[32:35], v[40:43], v[64:79]
    v_dot2c_f32_bf16 v20, s27, v36
    v_dot2c_f32_bf16 v22, v36, v36
    v_mfma_f32_32x32x16_bf16 v[96:111], v[32:35], v[44:47], v[96:111]
    ds_read_b128 v[48:51], v7 offset:32768
    v_dot2c_f32_bf16 v21, s27, v37
    v_mfma_f32_32x32x16_bf16 v[128:143], v[44:47], v[32:35], v[128:143]
    ds_read_b128 v[52:55], v7 offset:36864
    v_dot2c_f32_bf16 v23, v37, v37
    v_mfma_f32_32x32x16_bf16 v[80:95], v[36:39], v[40:43], v[80:95]
    ds_read_b128 v[56:59], v4 offset:34816
    v_dot2c_f32_bf16 v20, s27, v38
    v_dot2c_f32_bf16 v22, v38, v38
    v_mfma_f32_32x32x16_bf16 v[112:127], v[36:39], v[44:47], v[112:127]
    ds_read_b128 v[60:63], v4 offset:35840
    v_dot2c_f32_bf16 v21, s27, v39
    v_mfma_f32_32x32x16_bf16 v[144:159], v[44:47], v[36:39], v[144:159]
    v_dot2c_f32_bf16 v23, v39, v39
    s_waitcnt lgkmcnt(0)
    v_mfma_f32_32x32x16_bf16 v[64:79], v[48:51], v[56:59], v[64:79]
    v_dot2c_f32_bf16 v20, s27, v52
    v_dot2c_f32_bf16 v22, v52, v52
    v_mfma_f32_32x32x16_bf16 v[96:111], v[48:51], v[60:63], v[96:111]
    ds_read_b128 v[32:35], v8 offset:32768
    v_dot2c_f32_bf16 v21, s27, v53
    v_mfma_f32_32x32x16_bf16 v[128:143], v[60:63], v[48:51], v[128:143]
    ds_read_b128 v[36:39], v8 offset:36864
    v_dot2c_f32_bf16 v23, v53, v53
    v_mfma_f32_32x32x16_bf16 v[80:95], v[52:55], v[56:59], v[80:95]
    ds_read_b128 v[40:43], v4 offset:36864
    v_dot2c_f32_bf16 v20, s27, v54
    v_dot2c_f32_bf16 v22, v54, v54
    v_mfma_f32_32x32x16_bf16 v[112:127], v[52:55], v[60:63], v[112:127]
    ds_read_b128 v[44:47], v4 offset:37888
    v_dot2c_f32_bf16 v21, s27, v55
    v_mfma_f32_32x32x16_bf16 v[144:159], v[60:63], v[52:55], v[144:159]
    v_dot2c_f32_bf16 v23, v55, v55
    s_waitcnt lgkmcnt(0)
    v_mfma_f32_32x32x16_bf16 v[64:79], v[32:35], v[40:43], v[64:79]
    v_dot2c_f32_bf16 v20, s27, v36
    v_dot2c_f32_bf16 v22, v36, v36
    v_mfma_f32_32x32x16_bf16 v[96:111], v[32:35], v[44:47], v[96:111]
    ds_read_b128 v[48:51], v9 offset:32768
    v_dot2c_f32_bf16 v21, s27, v37
    v_mfma_f32_32x32x16_bf16 v[128:143], v[44:47], v[32:35], v[128:143]
    ds_read_b128 v[52:55], v9 offset:36864
    v_dot2c_f32_bf16 v23, v37, v37
    v_mfma_f32_32x32x16_bf16 v[80:95], v[36:39], v[40:43], v[80:95]
    ds_read_b128 v[56:59], v4 offset:38912
    v_dot2c_f32_bf16 v20, s27, v38
    v_dot2c_f32_bf16 v22, v38, v38
    v_mfma_f32_32x32x16_bf16 v[112:127], v[36:39], v[44:47], v[112:127]
    ds_read_b128 v[60:63], v4 offset:39936
    v_dot2c_f32_bf16 v21, s27, v39
    v_mfma_f32_32x32x16_bf16 v[144:159], v[44:47], v[36:39], v[144:159]
    v_dot2c_f32_bf16 v23, v39, v39
    s_waitcnt lgkmcnt(0)
    v_mfma_f32_32x32x16_bf16 v[64:79], v[48:51], v[56:59], v[64:79]
    v_dot2c_f32_bf16 v20, s27, v52
    v_dot2c_f32_bf16 v22, v52, v52
    v_mfma_f32_32x32x16_bf16 v[96:111], v[48:51], v[60:63], v[96:111]
    v_dot2c_f32_bf16 v21, s27, v53
    v_mfma_f32_32x32x16_bf16 v[128:143], v[60:63], v[48:51], v[128:143]
    v_dot2c_f32_bf16 v23, v53, v53
    v_mfma_f32_32x32x16_bf16 v[80:95], v[52:55], v[56:59], v[80:95]
    v_dot2c_f32_bf16 v20, s27, v54
    v_dot2c_f32_bf16 v22, v54, v54
    v_mfma_f32_32x32x16_bf16 v[112:127], v[52:55], v[60:63], v[112:127]
    v_dot2c_f32_bf16 v21, s27, v55
    v_mfma_f32_32x32x16_bf16 v[144:159], v[60:63], v[52:55], v[144:159]
    v_dot2c_f32_bf16 v23, v55, v55
afront2_kernel_af_epi:
    v_add_f32 v20, v20, v21
    v_add_f32 v22, v22, v23
    v_mov_b32 v21, v20
    v_mov_b32 v23, v22
    s_nop 1
    v_permlane32_swap_b32 v20, v21
    v_permlane32_swap_b32 v22, v23
    v_add_f32 v20, v20, v21
    v_add_f32 v22, v22, v23
    v_mul_f32 v20, 0x3acccccd, v20
    v_mul_f32 v21, v20, v20
    v_mul_f32 v22, 0x3acccccd, v22
    v_sub_f32 v22, v22, v21
    v_max_f32 v22, 0, v22
    v_add_f32 v22, 0x3727c5ac, v22
    v_rsq_f32 v22, v22
    v_and_b32 v16, 31, v0
    s_lshl_b32 s28, s13, 7
    s_add_u32 s28, s28, 65536
    v_lshl_add_u32 v17, v16, 2, s28
    ds_write_b32 v17, v22
    s_waitcnt lgkmcnt(0)
    s_barrier
    s_lshl_b32 s28, s22, 8
    s_add_u32 s28, s28, 65536
    v_lshl_add_u32 v17, v16, 2, s28
    v_lshrrev_b32 v18, 5, v0
    v_lshlrev_b32 v18, 4, v18
    v_add_u32 v18, s28, v18
    ds_read_b32 v224, v17 offset:0
    ds_read_b128 v[192:195], v18 offset:0
    ds_read_b128 v[196:199], v18 offset:32
    ds_read_b128 v[200:203], v18 offset:64
    ds_read_b128 v[204:207], v18 offset:96
    ds_read_b32 v225, v17 offset:128
    ds_read_b128 v[208:211], v18 offset:128
    ds_read_b128 v[212:215], v18 offset:160
    ds_read_b128 v[216:219], v18 offset:192
    ds_read_b128 v[220:223], v18 offset:224
    v_and_b32 v16, 31, v0
    v_mov_b32 v228, 0x358637bd
    v_cmp_gt_u32 vcc, 20, v16
    s_mov_b64 s[30:31], vcc
    s_nop 0
    v_cndmask_b32 v226, 0, v228, vcc
    v_cmp_eq_u32 vcc, 8, v16
    s_nop 1
    v_cndmask_b32 v227, 0, 1.0, vcc
    s_waitcnt lgkmcnt(0)
    v_fma_f32 v64, v64, v192, v226
    v_mul_f32 v48, 0x3fb8aa3b, v64
    v_exp_f32 v48, v48 clamp
    v_max_f32 v49, v64, v228
    v_fma_f32 v96, v96, v192, v227
    v_add_f32 v48, v48, v49
    v_cndmask_b32 v64, v64, v48, s[30:31]
    v_fma_f32 v65, v65, v193, v226
    v_mul_f32 v50, 0x3fb8aa3b, v65
    v_exp_f32 v50, v50 clamp
    v_max_f32 v51, v65, v228
    v_fma_f32 v97, v97, v193, v227
    v_add_f32 v50, v50, v51
    v_cndmask_b32 v65, v65, v50, s[30:31]
    v_fma_f32 v66, v66, v194, v226
    v_mul_f32 v52, 0x3fb8aa3b, v66
    v_exp_f32 v52, v52 clamp
    v_max_f32 v53, v66, v228
    v_fma_f32 v98, v98, v194, v227
    v_add_f32 v52, v52, v53
    v_cndmask_b32 v66, v66, v52, s[30:31]
    v_fma_f32 v67, v67, v195, v226
    v_mul_f32 v54, 0x3fb8aa3b, v67
    v_exp_f32 v54, v54 clamp
    v_max_f32 v55, v67, v228
    v_fma_f32 v99, v99, v195, v227
    v_add_f32 v54, v54, v55
    v_cndmask_b32 v67, v67, v54, s[30:31]
    v_fma_f32 v68, v68, v196, v226
    v_mul_f32 v48, 0x3fb8aa3b, v68
    v_exp_f32 v48, v48 clamp
    v_max_f32 v49, v68, v228
    v_fma_f32 v100, v100, v196, v227
    v_add_f32 v48, v48, v49
    v_cndmask_b32 v68, v68, v48, s[30:31]
    v_fma_f32 v69, v69, v197, v226
    v_mul_f32 v50, 0x3fb8aa3b, v69
    v_exp_f32 v50, v50 clamp
    v_max_f32 v51, v69, v228
    v_fma_f32 v101, v101, v197, v227
    v_add_f32 v50, v50, v51
    v_cndmask_b32 v69, v69, v50, s[30:31]
    v_fma_f32 v70, v70, v198, v226
    v_mul_f32 v52, 0x3fb8aa3b, v70
    v_exp_f32 v52, v52 clamp
    v_max_f32 v53, v70, v228
    v_fma_f32 v102, v102, v198, v227
    v_add_f32 v52, v52, v53
    v_cndmask_b32 v70, v70, v52, s[30:31]
    v_fma_f32 v71, v71, v199, v226
    v_mul_f32 v54, 0x3fb8aa3b, v71
    v_exp_f32 v54, v54 clamp
    v_max_f32 v55, v71, v228
    v_fma_f32 v103, v103, v199, v227
    v_add_f32 v54, v54, v55
    v_cndmask_b32 v71, v71, v54, s[30:31]
    v_fma_f32 v72, v72, v200, v226
    v_mul_f32 v48, 0x3fb8aa3b, v72
    v_exp_f32 v48, v48 clamp
    v_max_f32 v49, v72, v228
    v_fma_f32 v104, v104, v200, v227
    v_add_f32 v48, v48, v49
    v_cndmask_b32 v72, v72, v48, s[30:31]
    v_fma_f32 v73, v73, v201, v226
    v_mul_f32 v50, 0x3fb8aa3b, v73
    v_exp_f32 v50, v50 clamp
    v_max_f32 v51, v73, v228
    v_fma_f32 v105, v105, v201, v227
    v_add_f32 v50, v50, v51
    v_cndmask_b32 v73, v73, v50, s[30:31]
    v_fma_f32 v74, v74, v202, v226
    v_mul_f32 v52, 0x3fb8aa3b, v74
    v_exp_f32 v52, v52 clamp
    v_max_f32 v53, v74, v228
    v_fma_f32 v106, v106, v202, v227
    v_add_f32 v52, v52, v53
    v_cndmask_b32 v74, v74, v52, s[30:31]
    v_fma_f32 v75, v75, v203, v226
    v_mul_f32 v54, 0x3fb8aa3b, v75
    v_exp_f32 v54, v54 clamp
    v_max_f32 v55, v75, v228
    v_fma_f32 v107, v107, v203, v227
    v_add_f32 v54, v54, v55
    v_cndmask_b32 v75, v75, v54, s[30:31]
    v_fma_f32 v76, v76, v204, v226
    v_mul_f32 v48, 0x3fb8aa3b, v76
    v_exp_f32 v48, v48 clamp
    v_max_f32 v49, v76, v228
    v_fma_f32 v108, v108, v204, v227
    v_add_f32 v48, v48, v49
    v_cndmask_b32 v76, v76, v48, s[30:31]
    v_fma_f32 v77, v77, v205, v226
    v_mul_f32 v50, 0x3fb8aa3b, v77
    v_exp_f32 v50, v50 clamp
    v_max_f32 v51, v77, v228
    v_fma_f32 v109, v109, v205, v227
    v_add_f32 v50, v50, v51
    v_cndmask_b32 v77, v77, v50, s[30:31]
    v_fma_f32 v78, v78, v206, v226
    v_mul_f32 v52, 0x3fb8aa3b, v78
    v_exp_f32 v52, v52 clamp
    v_max_f32 v53, v78, v228
    v_fma_f32 v110, v110, v206, v227
    v_add_f32 v52, v52, v53
    v_cndmask_b32 v78, v78, v52, s[30:31]
    v_fma_f32 v79, v79, v207, v226
    v_mul_f32 v54, 0x3fb8aa3b, v79
    v_exp_f32 v54, v54 clamp
    v_max_f32 v55, v79, v228
    v_fma_f32 v111, v111, v207, v227
    v_add_f32 v54, v54, v55
    v_cndmask_b32 v79, v79, v54, s[30:31]
    v_cvt_pk_bf16_f32 v32, v64, v65
    v_cvt_pk_bf16_f32 v40, v96, v97
    v_cvt_pk_bf16_f32 v33, v66, v67
    v_cvt_pk_bf16_f32 v41, v98, v99
    v_cvt_pk_bf16_f32 v34, v68, v69
    v_cvt_pk_bf16_f32 v42, v100, v101
    v_cvt_pk_bf16_f32 v35, v70, v71
    v_cvt_pk_bf16_f32 v43, v102, v103
    v_cvt_pk_bf16_f32 v36, v72, v73
    v_cvt_pk_bf16_f32 v44, v104, v105
    v_cvt_pk_bf16_f32 v37, v74, v75
    v_cvt_pk_bf16_f32 v45, v106, v107
    v_cvt_pk_bf16_f32 v38, v76, v77
    v_cvt_pk_bf16_f32 v46, v108, v109
    v_cvt_pk_bf16_f32 v39, v78, v79
    v_cvt_pk_bf16_f32 v47, v110, v111
    s_nop 1
    v_mfma_f32_32x32x16_bf16 v[160:175], v[32:35], v[32:35], 0
    v_mfma_f32_32x32x16_bf16 v[176:191], v[40:43], v[32:35], 0
    v_mfma_f32_32x32x16_bf16 v[160:175], v[36:39], v[36:39], v[160:175]
    v_mfma_f32_32x32x16_bf16 v[176:191], v[44:47], v[36:39], v[176:191]
    v_fma_f32 v80, v80, v208, v226
    v_mul_f32 v48, 0x3fb8aa3b, v80
    v_exp_f32 v48, v48 clamp
    v_max_f32 v49, v80, v228
    v_fma_f32 v112, v112, v208, v227
    v_add_f32 v48, v48, v49
    v_cndmask_b32 v80, v80, v48, s[30:31]
    v_fma_f32 v81, v81, v209, v226
    v_mul_f32 v50, 0x3fb8aa3b, v81
    v_exp_f32 v50, v50 clamp
    v_max_f32 v51, v81, v228
    v_fma_f32 v113, v113, v209, v227
    v_add_f32 v50, v50, v51
    v_cndmask_b32 v81, v81, v50, s[30:31]
    v_fma_f32 v82, v82, v210, v226
    v_mul_f32 v52, 0x3fb8aa3b, v82
    v_exp_f32 v52, v52 clamp
    v_max_f32 v53, v82, v228
    v_fma_f32 v114, v114, v210, v227
    v_add_f32 v52, v52, v53
    v_cndmask_b32 v82, v82, v52, s[30:31]
    v_fma_f32 v83, v83, v211, v226
    v_mul_f32 v54, 0x3fb8aa3b, v83
    v_exp_f32 v54, v54 clamp
    v_max_f32 v55, v83, v228
    v_fma_f32 v115, v115, v211, v227
    v_add_f32 v54, v54, v55
    v_cndmask_b32 v83, v83, v54, s[30:31]
    v_fma_f32 v84, v84, v212, v226
    v_mul_f32 v48, 0x3fb8aa3b, v84
    v_exp_f32 v48, v48 clamp
    v_max_f32 v49, v84, v228
    v_fma_f32 v116, v116, v212, v227
    v_add_f32 v48, v48, v49
    v_cndmask_b32 v84, v84, v48, s[30:31]
    v_fma_f32 v85, v85, v213, v226
    v_mul_f32 v50, 0x3fb8aa3b, v85
    v_exp_f32 v50, v50 clamp
    v_max_f32 v51, v85, v228
    v_fma_f32 v117, v117, v213, v227
    v_add_f32 v50, v50, v51
    v_cndmask_b32 v85, v85, v50, s[30:31]
    v_fma_f32 v86, v86, v214, v226
    v_mul_f32 v52, 0x3fb8aa3b, v86
    v_exp_f32 v52, v52 clamp
    v_max_f32 v53, v86, v228
    v_fma_f32 v118, v118, v214, v227
    v_add_f32 v52, v52, v53
    v_cndmask_b32 v86, v86, v52, s[30:31]
    v_fma_f32 v87, v87, v215, v226
    v_mul_f32 v54, 0x3fb8aa3b, v87
    v_exp_f32 v54, v54 clamp
    v_max_f32 v55, v87, v228
    v_fma_f32 v119, v119, v215, v227
    v_add_f32 v54, v54, v55
    v_cndmask_b32 v87, v87, v54, s[30:31]
    v_fma_f32 v88, v88, v216, v226
    v_mul_f32 v48, 0x3fb8aa3b, v88
    v_exp_f32 v48, v48 clamp
    v_max_f32 v49, v88, v228
    v_fma_f32 v120, v120, v216, v227
    v_add_f32 v48, v48, v49
    v_cndmask_b32 v88, v88, v48, s[30:31]
    v_fma_f32 v89, v89, v217, v226
    v_mul_f32 v50, 0x3fb8aa3b, v89
    v_exp_f32 v50, v50 clamp
    v_max_f32 v51, v89, v228
    v_fma_f32 v121, v121, v217, v227
    v_add_f32 v50, v50, v51
    v_cndmask_b32 v89, v89, v50, s[30:31]
    v_fma_f32 v90, v90, v218, v226
    v_mul_f32 v52, 0x3fb8aa3b, v90
    v_exp_f32 v52, v52 clamp
    v_max_f32 v53, v90, v228
    v_fma_f32 v122, v122, v218, v227
    v_add_f32 v52, v52, v53
    v_cndmask_b32 v90, v90, v52, s[30:31]
    v_fma_f32 v91, v91, v219, v226
    v_mul_f32 v54, 0x3fb8aa3b, v91
    v_exp_f32 v54, v54 clamp
    v_max_f32 v55, v91, v228
    v_fma_f32 v123, v123, v219, v227
    v_add_f32 v54, v54, v55
    v_cndmask_b32 v91, v91, v54, s[30:31]
    v_fma_f32 v92, v92, v220, v226
    v_mul_f32 v48, 0x3fb8aa3b, v92
    v_exp_f32 v48, v48 clamp
    v_max_f32 v49, v92, v228
    v_fma_f32 v124, v124, v220, v227
    v_add_f32 v48, v48, v49
    v_cndmask_b32 v92, v92, v48, s[30:31]
    v_fma_f32 v93, v93, v221, v226
    v_mul_f32 v50, 0x3fb8aa3b, v93
    v_exp_f32 v50, v50 clamp
    v_max_f32 v51, v93, v228
    v_fma_f32 v125, v125, v221, v227
    v_add_f32 v50, v50, v51
    v_cndmask_b32 v93, v93, v50, s[30:31]
    v_fma_f32 v94, v94, v222, v226
    v_mul_f32 v52, 0x3fb8aa3b, v94
    v_exp_f32 v52, v52 clamp
    v_max_f32 v53, v94, v228
    v_fma_f32 v126, v126, v222, v227
    v_add_f32 v52, v52, v53
    v_cndmask_b32 v94, v94, v52, s[30:31]
    v_fma_f32 v95, v95, v223, v226
    v_mul_f32 v54, 0x3fb8aa3b, v95
    v_exp_f32 v54, v54 clamp
    v_max_f32 v55, v95, v228
    v_fma_f32 v127, v127, v223, v227
    v_add_f32 v54, v54, v55
    v_cndmask_b32 v95, v95, v54, s[30:31]
    v_cvt_pk_bf16_f32 v32, v80, v81
    v_cvt_pk_bf16_f32 v40, v112, v113
    v_cvt_pk_bf16_f32 v33, v82, v83
    v_cvt_pk_bf16_f32 v41, v114, v115
    v_cvt_pk_bf16_f32 v34, v84, v85
    v_cvt_pk_bf16_f32 v42, v116, v117
    v_cvt_pk_bf16_f32 v35, v86, v87
    v_cvt_pk_bf16_f32 v43, v118, v119
    v_cvt_pk_bf16_f32 v36, v88, v89
    v_cvt_pk_bf16_f32 v44, v120, v121
    v_cvt_pk_bf16_f32 v37, v90, v91
    v_cvt_pk_bf16_f32 v45, v122, v123
    v_cvt_pk_bf16_f32 v38, v92, v93
    v_cvt_pk_bf16_f32 v46, v124, v125
    v_cvt_pk_bf16_f32 v39, v94, v95
    v_cvt_pk_bf16_f32 v47, v126, v127
    s_nop 1
    v_mfma_f32_32x32x16_bf16 v[160:175], v[32:35], v[32:35], v[160:175]
    v_mfma_f32_32x32x16_bf16 v[176:191], v[40:43], v[32:35], v[176:191]
    v_mfma_f32_32x32x16_bf16 v[160:175], v[36:39], v[36:39], v[160:175]
    v_mfma_f32_32x32x16_bf16 v[176:191], v[44:47], v[36:39], v[176:191]
    v_fma_f32 v132, v132, v224, v228
    v_mul_f32 v48, 0x3fb8aa3b, v132
    v_exp_f32 v48, v48 clamp
    v_max_f32 v49, v132, v228
    v_add_f32 v132, v48, v49
    v_fma_f32 v133, v133, v224, v228
    v_mul_f32 v50, 0x3fb8aa3b, v133
    v_exp_f32 v50, v50 clamp
    v_max_f32 v51, v133, v228
    v_add_f32 v133, v50, v51
    v_fma_f32 v134, v134, v224, v228
    v_mul_f32 v52, 0x3fb8aa3b, v134
    v_exp_f32 v52, v52 clamp
    v_max_f32 v53, v134, v228
    v_add_f32 v134, v52, v53
    v_fma_f32 v135, v135, v224, v228
    v_mul_f32 v54, 0x3fb8aa3b, v135
    v_exp_f32 v54, v54 clamp
    v_max_f32 v55, v135, v228
    v_add_f32 v135, v54, v55
    v_fma_f32 v136, v136, v224, v228
    v_mul_f32 v48, 0x3fb8aa3b, v136
    v_exp_f32 v48, v48 clamp
    v_max_f32 v49, v136, v228
    v_add_f32 v136, v48, v49
    v_fma_f32 v137, v137, v224, v228
    v_mul_f32 v50, 0x3fb8aa3b, v137
    v_exp_f32 v50, v50 clamp
    v_max_f32 v51, v137, v228
    v_add_f32 v137, v50, v51
    v_fma_f32 v138, v138, v224, v228
    v_mul_f32 v52, 0x3fb8aa3b, v138
    v_exp_f32 v52, v52 clamp
    v_max_f32 v53, v138, v228
    v_add_f32 v138, v52, v53
    v_fma_f32 v139, v139, v224, v228
    v_mul_f32 v54, 0x3fb8aa3b, v139
    v_exp_f32 v54, v54 clamp
    v_max_f32 v55, v139, v228
    v_add_f32 v139, v54, v55
    v_fma_f32 v140, v140, v224, v228
    v_mul_f32 v48, 0x3fb8aa3b, v140
    v_exp_f32 v48, v48 clamp
    v_max_f32 v49, v140, v228
    v_add_f32 v140, v48, v49
    v_fma_f32 v141, v141, v224, v228
    v_mul_f32 v50, 0x3fb8aa3b, v141
    v_exp_f32 v50, v50 clamp
    v_max_f32 v51, v141, v228
    v_add_f32 v141, v50, v51
    v_fma_f32 v142, v142, v224, v228
    v_mul_f32 v52, 0x3fb8aa3b, v142
    v_exp_f32 v52, v52 clamp
    v_max_f32 v53, v142, v228
    v_add_f32 v142, v52, v53
    v_fma_f32 v143, v143, v224, v228
    v_mul_f32 v54, 0x3fb8aa3b, v143
    v_exp_f32 v54, v54 clamp
    v_max_f32 v55, v143, v228
    v_add_f32 v143, v54, v55
    v_cvt_pk_bf16_f32 v130, v132, v133
    v_cvt_pk_bf16_f32 v131, v134, v135
    v_cvt_pk_bf16_f32 v132, v136, v137
    v_cvt_pk_bf16_f32 v133, v138, v139
    v_cvt_pk_bf16_f32 v134, v140, v141
    v_cvt_pk_bf16_f32 v135, v142, v143
    v_mov_b32 v128, 0
    v_mov_b32 v129, 0
    s_lshl_b32 s28, s13, 13
    s_add_u32 s28, s28, 66560
    v_add_u32 v17, s28, v1
    ds_write_b128 v17, v[160:163] offset:0
    ds_write_b128 v17, v[164:167] offset:1024
    ds_write_b128 v17, v[168:171] offset:2048
    ds_write_b128 v17, v[172:175] offset:3072
    ds_write_b128 v17, v[176:179] offset:4096
    ds_write_b128 v17, v[180:183] offset:5120
    ds_write_b128 v17, v[184:187] offset:6144
    ds_write_b128 v17, v[188:191] offset:7168
    s_lshl_b32 s28, s13, 6
    v_add_u32 v32, s28, v0
    v_cmp_le_u32 vcc, 105, v32
    s_nop 1
    v_cndmask_b32 v33, 0, 1, vcc
    v_mul_u32_u24 v34, 105, v33
    v_sub_u32 v34, v32, v34
    v_mul_u32_u24 v35, 13108, v34
    v_lshrrev_b32 v35, 16, v35
    v_mul_u32_u24 v36, 5, v35
    v_sub_u32 v36, v34, v36
    v_add_u32 v37, 20, v35
    v_subrev_u32 v38, 12, v35
    v_cmp_gt_u32 vcc, 12, v35
    s_nop 1
    v_cndmask_b32 v37, v38, v37, vcc
    v_cndmask_b32 v38, 1, 0, vcc
    v_lshlrev_b32 v38, 12, v38
    v_lshl_add_u32 v38, v33, 13, v38
    v_lshrrev_b32 v39, 3, v37
    v_lshl_add_u32 v38, v39, 10, v38
    v_bfe_u32 v39, v37, 2, 1
    v_lshlrev_b32 v39, 5, v39
    v_lshl_add_u32 v39, v36, 2, v39
    v_lshl_add_u32 v38, v39, 4, v38
    v_and_b32 v39, 3, v37
    v_lshl_add_u32 v38, v39, 2, v38
    v_min_u32 v38, 16320, v38
    v_add_u32 v38, 66560, v38
    s_waitcnt lgkmcnt(0)
    s_barrier
    ds_read_b32 v40, v38 offset:0
    ds_read_b32 v41, v38 offset:16
    ds_read_b32 v42, v38 offset:32
    ds_read_b32 v43, v38 offset:48
    ds_read_b32 v44, v38 offset:16384
    ds_read_b32 v45, v38 offset:16400
    ds_read_b32 v46, v38 offset:16416
    ds_read_b32 v47, v38 offset:16432
    s_lshl_b32 s28, s20, 4
    s_add_u32 s28, s28, s21
    s_lshl_b32 s28, s28, 12
    s_add_u32 s28, s28, 233832448
    v_lshlrev_b32 v39, 4, v32
    v_cmp_gt_u32 vcc, 210, v32
    s_mov_b64 s[32:33], vcc
    s_waitcnt lgkmcnt(0)
    v_add_f32 v40, v40, v44
    v_add_f32 v41, v41, v45
    v_add_f32 v42, v42, v46
    v_add_f32 v43, v43, v47
    s_mov_b64 exec, s[32:33]
    buffer_store_dwordx4 v[40:43], v39, s[8:11], s28 offen sc1
    s_mov_b64 exec, -1
    v_fma_f32 v148, v148, v225, v228
    v_mul_f32 v48, 0x3fb8aa3b, v148
    v_exp_f32 v48, v48 clamp
    v_max_f32 v49, v148, v228
    v_add_f32 v148, v48, v49
    v_fma_f32 v149, v149, v225, v228
    v_mul_f32 v50, 0x3fb8aa3b, v149
    v_exp_f32 v50, v50 clamp
    v_max_f32 v51, v149, v228
    v_add_f32 v149, v50, v51
    v_fma_f32 v150, v150, v225, v228
    v_mul_f32 v52, 0x3fb8aa3b, v150
    v_exp_f32 v52, v52 clamp
    v_max_f32 v53, v150, v228
    v_add_f32 v150, v52, v53
    v_fma_f32 v151, v151, v225, v228
    v_mul_f32 v54, 0x3fb8aa3b, v151
    v_exp_f32 v54, v54 clamp
    v_max_f32 v55, v151, v228
    v_add_f32 v151, v54, v55
    v_fma_f32 v152, v152, v225, v228
    v_mul_f32 v48, 0x3fb8aa3b, v152
    v_exp_f32 v48, v48 clamp
    v_max_f32 v49, v152, v228
    v_add_f32 v152, v48, v49
    v_fma_f32 v153, v153, v225, v228
    v_mul_f32 v50, 0x3fb8aa3b, v153
    v_exp_f32 v50, v50 clamp
    v_max_f32 v51, v153, v228
    v_add_f32 v153, v50, v51
    v_fma_f32 v154, v154, v225, v228
    v_mul_f32 v52, 0x3fb8aa3b, v154
    v_exp_f32 v52, v52 clamp
    v_max_f32 v53, v154, v228
    v_add_f32 v154, v52, v53
    v_fma_f32 v155, v155, v225, v228
    v_mul_f32 v54, 0x3fb8aa3b, v155
    v_exp_f32 v54, v54 clamp
    v_max_f32 v55, v155, v228
    v_add_f32 v155, v54, v55
    v_fma_f32 v156, v156, v225, v228
    v_mul_f32 v48, 0x3fb8aa3b, v156
    v_exp_f32 v48, v48 clamp
    v_max_f32 v49, v156, v228
    v_add_f32 v156, v48, v49
    v_fma_f32 v157, v157, v225, v228
    v_mul_f32 v50, 0x3fb8aa3b, v157
    v_exp_f32 v50, v50 clamp
    v_max_f32 v51, v157, v228
    v_add_f32 v157, v50, v51
    v_fma_f32 v158, v158, v225, v228
    v_mul_f32 v52, 0x3fb8aa3b, v158
    v_exp_f32 v52, v52 clamp
    v_max_f32 v53, v158, v228
    v_add_f32 v158, v52, v53
    v_fma_f32 v159, v159, v225, v228
    v_mul_f32 v54, 0x3fb8aa3b, v159
    v_exp_f32 v54, v54 clamp
    v_max_f32 v55, v159, v228
    v_add_f32 v159, v54, v55
    v_cvt_pk_bf16_f32 v146, v148, v149
    v_cvt_pk_bf16_f32 v147, v150, v151
    v_cvt_pk_bf16_f32 v148, v152, v153
    v_cvt_pk_bf16_f32 v149, v154, v155
    v_cvt_pk_bf16_f32 v150, v156, v157
    v_cvt_pk_bf16_f32 v151, v158, v159
    v_mov_b32 v144, 0
    v_mov_b32 v145, 0
    s_mul_i32 s29, s26, 5
    v_lshrrev_b32 v17, 5, v0
    v_add_u32 v17, s29, v17
    v_lshrrev_b32 v18, 1, v17
    v_lshlrev_b32 v18, 9, v18
    v_and_b32 v17, 1, v17
    v_lshl_add_u32 v18, v17, 3, v18
    v_and_b32 v16, 31, v0
    v_lshl_add_u32 v14, v16, 4, v18
    v_mul_u32_u24 v15, 80, v16
    v_lshrrev_b32 v17, 5, v0
    v_lshl_add_u32 v15, v17, 4, v15
    s_mul_i32 s29, s23, 1680
    s_add_u32 s29, s29, 48
    v_add_u32 v15, s29, v15
    v_mov_b32 v48, 0
    v_mov_b32 v49, 0
    v_mov_b32 v50, 0
    v_mov_b32 v51, 0
    v_mov_b32 v52, 0
    v_mov_b32 v53, 0
    v_mov_b32 v54, 0
    v_mov_b32 v55, 0
    v_mov_b32 v56, 0
    v_mov_b32 v57, 0
    v_mov_b32 v58, 0
    v_mov_b32 v59, 0
    s_waitcnt vmcnt(0)
    s_barrier
    s_cmp_lg_u32 s13, 0
    s_cbranch_scc1 afront2_kernel_af_go
    s_lshl_b32 s29, s20, 7
    s_add_u32 s29, s29, 10715136
    s_lshl_b32 s30, s21, 2
    v_mov_b32 v16, s30
    v_mov_b32 v17, 1
    s_mov_b64 exec, 1
    buffer_store_dword v17, v16, s[8:11], s29 offen sc1
    s_mov_b64 exec, 0xffff
    v_lshlrev_b32 v16, 2, v0
    s_mov_b32 s31, 400000
afront2_kernel_af_poll:
    buffer_load_dword v17, v16, s[8:11], s29 offen sc1
    s_waitcnt vmcnt(0)
    v_cmp_eq_u32 vcc, 0, v17
    s_sub_u32 s31, s31, 1
    s_cbranch_scc1 afront2_kernel_af_fail
    s_cbranch_vccnz afront2_kernel_af_poll
    s_branch afront2_kernel_af_ok
afront2_kernel_af_fail:
    s_load_dwordx2 s[34:35], s[0:1], 88
    s_waitcnt lgkmcnt(0)
    s_mov_b32 s36, s34
    s_mov_b32 s37, s35
    s_mov_b32 s38, 256
    s_mov_b32 s39, 0x00020000
    s_mov_b64 exec, 1
    v_mov_b32 v16, 0
    v_mov_b32 v17, 0xdead
    buffer_store_dword v17, v16, s[36:39], 0 offen
afront2_kernel_af_ok:
    s_mov_b64 exec, -1
afront2_kernel_af_go:
    s_barrier
    s_lshl_b32 s28, s20, 16
    s_add_u32 s28, s28, 233832448
    s_mov_b64 exec, s[32:33]
    buffer_load_dwordx4 v[160:163], v39, s[8:11], s28 offen sc1
    s_add_u32 s28, s28, 4096
    buffer_load_dwordx4 v[164:167], v39, s[8:11], s28 offen sc1
    s_add_u32 s28, s28, 4096
    buffer_load_dwordx4 v[168:171], v39, s[8:11], s28 offen sc1
    s_add_u32 s28, s28, 4096
    buffer_load_dwordx4 v[172:175], v39, s[8:11], s28 offen sc1
    s_add_u32 s28, s28, 4096
    buffer_load_dwordx4 v[176:179], v39, s[8:11], s28 offen sc1
    s_add_u32 s28, s28, 4096
    buffer_load_dwordx4 v[180:183], v39, s[8:11], s28 offen sc1
    s_add_u32 s28, s28, 4096
    buffer_load_dwordx4 v[184:187], v39, s[8:11], s28 offen sc1
    s_add_u32 s28, s28, 4096
    buffer_load_dwordx4 v[188:191], v39, s[8:11], s28 offen sc1
    s_add_u32 s28, s28, 4096
    buffer_load_dwordx4 v[192:195], v39, s[8:11], s28 offen sc1
    s_add_u32 s28, s28, 4096
    buffer_load_dwordx4 v[196:199], v39, s[8:11], s28 offen sc1
    s_add_u32 s28, s28, 4096
    buffer_load_dwordx4 v[200:203], v39, s[8:11], s28 offen sc1
    s_add_u32 s28, s28, 4096
    buffer_load_dwordx4 v[204:207], v39, s[8:11], s28 offen sc1
    s_add_u32 s28, s28, 4096
    buffer_load_dwordx4 v[208:211], v39, s[8:11], s28 offen sc1
    s_add_u32 s28, s28, 4096
    buffer_load_dwordx4 v[212:215], v39, s[8:11], s28 offen sc1
    s_add_u32 s28, s28, 4096
    buffer_load_dwordx4 v[216:219], v39, s[8:11], s28 offen sc1
    s_add_u32 s28, s28, 4096
    buffer_load_dwordx4 v[220:223], v39, s[8:11], s28 offen sc1
    s_mov_b64 exec, -1
    s_waitcnt vmcnt(14)
    v_add_f32 v160, v160, v164
    v_add_f32 v161, v161, v165
    v_add_f32 v162, v162, v166
    v_add_f32 v163, v163, v167
    s_waitcnt vmcnt(12)
    v_add_f32 v168, v168, v172
    v_add_f32 v169, v169, v173
    v_add_f32 v170, v170, v174
    v_add_f32 v171, v171, v175
    s_waitcnt vmcnt(10)
    v_add_f32 v176, v176, v180
    v_add_f32 v177, v177, v181
    v_add_f32 v178, v178, v182
    v_add_f32 v179, v179, v183
    s_waitcnt vmcnt(8)
    v_add_f32 v184, v184, v188
    v_add_f32 v185, v185, v189
    v_add_f32 v186, v186, v190
    v_add_f32 v187, v187, v191
    s_waitcnt vmcnt(6)
    v_add_f32 v192, v192, v196
    v_add_f32 v193, v193, v197
    v_add_f32 v194, v194, v198
    v_add_f32 v195, v195, v199
    s_waitcnt vmcnt(4)
    v_add_f32 v200, v200, v204
    v_add_f32 v201, v201, v205
    v_add_f32 v202, v202, v206
    v_add_f32 v203, v203, v207
    s_waitcnt vmcnt(2)
    v_add_f32 v208, v208, v212
    v_add_f32 v209, v209, v213
    v_add_f32 v210, v210, v214
    v_add_f32 v211, v211, v215
    s_waitcnt vmcnt(0)
    v_add_f32 v216, v216, v220
    v_add_f32 v217, v217, v221
    v_add_f32 v218, v218, v222
    v_add_f32 v219, v219, v223
    v_add_f32 v160, v160, v168
    v_add_f32 v161, v161, v169
    v_add_f32 v162, v162, v170
    v_add_f32 v163, v163, v171
    v_add_f32 v176, v176, v184
    v_add_f32 v177, v177, v185
    v_add_f32 v178, v178, v186
    v_add_f32 v179, v179, v187
    v_add_f32 v192, v192, v200
    v_add_f32 v193, v193, v201
    v_add_f32 v194, v194, v202
    v_add_f32 v195, v195, v203
    v_add_f32 v208, v208, v216
    v_add_f32 v209, v209, v217
    v_add_f32 v210, v210, v218
    v_add_f32 v211, v211, v219
    v_add_f32 v160, v160, v176
    v_add_f32 v161, v161, v177
    v_add_f32 v162, v162, v178
    v_add_f32 v163, v163, v179
    v_add_f32 v192, v192, v208
    v_add_f32 v193, v193, v209
    v_add_f32 v194, v194, v210
    v_add_f32 v195, v195, v211
    v_add_f32 v160, v160, v192
    v_add_f32 v161, v161, v193
    v_add_f32 v162, v162, v194
    v_add_f32 v163, v163, v195
    v_add_u32 v39, 64, v39
    s_mov_b64 exec, s[32:33]
    ds_write_b128 v39, v[160:163]
    s_mov_b64 exec, -1
    s_waitcnt lgkmcnt(0)
    s_barrier
    s_mov_b32 exec_lo, 0x1fffff
    s_mov_b32 exec_hi, 0x1fffff
    ds_read_b128 v[52:55], v15 offset:32
    ds_read_b128 v[56:59], v15 offset:64
    s_mov_b32 exec_lo, 0
    ds_read_b128 v[48:51], v15
    s_mov_b64 exec, -1
    v_mov_b32 v32, 0
    v_mov_b32 v33, 0
    s_waitcnt lgkmcnt(0)
    v_cvt_pk_bf16_f32 v34, v48, v49
    v_cvt_pk_bf16_f32 v35, v50, v51
    v_cvt_pk_bf16_f32 v36, v52, v53
    v_cvt_pk_bf16_f32 v37, v54, v55
    v_cvt_pk_bf16_f32 v38, v56, v57
    v_cvt_pk_bf16_f32 v39, v58, v59
    s_nop 1
    v_mfma_f32_32x32x16_bf16 v[64:79], v[32:35], v[128:131], 0
    v_mfma_f32_32x32x16_bf16 v[64:79], v[36:39], v[132:135], v[64:79]
    v_mfma_f32_32x32x16_bf16 v[80:95], v[32:35], v[144:147], 0
    v_mfma_f32_32x32x16_bf16 v[80:95], v[36:39], v[148:151], v[80:95]
    s_lshl_b32 s28, s21, 2
    s_lshl_b32 s29, s22, 1
    s_add_u32 s28, s28, s29
    s_mul_i32 s28, s28, 40960
    s_add_u32 s28, s28, 229638144
    s_nop 7
    s_nop 3
    v_add_f32 v40, 0x358637bd, v72
    v_mov_b32 v41, v40
    s_nop 1
    v_permlane32_swap_b32 v40, v41
    v_rcp_f32 v41, v41
    s_nop 0
    v_mul_f32 v64, v64, v41
    v_mul_f32 v65, v65, v41
    v_mul_f32 v66, v66, v41
    v_mul_f32 v67, v67, v41
    v_mul_f32 v68, v68, v41
    v_mul_f32 v69, v69, v41
    v_mul_f32 v70, v70, v41
    v_mul_f32 v71, v71, v41
    v_mul_f32 v72, v72, v41
    v_mul_f32 v73, v73, v41
    v_mul_f32 v74, v74, v41
    v_mul_f32 v75, v75, v41
    v_cvt_pk_bf16_f32 v42, v64, v65
    v_cvt_pk_bf16_f32 v43, v66, v67
    v_cvt_pk_bf16_f32 v44, v68, v69
    v_cvt_pk_bf16_f32 v45, v70, v71
    v_cvt_pk_bf16_f32 v46, v72, v73
    v_cvt_pk_bf16_f32 v47, v74, v75
    buffer_store_dwordx2 v[42:43], v14, s[8:11], s28 offen offset:0
    buffer_store_dwordx2 v[44:45], v14, s[8:11], s28 offen offset:512
    s_mov_b32 exec_hi, 0
    buffer_store_dwordx2 v[46:47], v14, s[8:11], s28 offen offset:1024
    s_mov_b32 exec_hi, -1
    s_add_u32 s28, s28, 40960
    s_nop 7
    v_add_f32 v40, 0x358637bd, v88
    v_mov_b32 v41, v40
    s_nop 1
    v_permlane32_swap_b32 v40, v41
    v_rcp_f32 v41, v41
    s_nop 0
    v_mul_f32 v80, v80, v41
    v_mul_f32 v81, v81, v41
    v_mul_f32 v82, v82, v41
    v_mul_f32 v83, v83, v41
    v_mul_f32 v84, v84, v41
    v_mul_f32 v85, v85, v41
    v_mul_f32 v86, v86, v41
    v_mul_f32 v87, v87, v41
    v_mul_f32 v88, v88, v41
    v_mul_f32 v89, v89, v41
    v_mul_f32 v90, v90, v41
    v_mul_f32 v91, v91, v41
    v_cvt_pk_bf16_f32 v48, v80, v81
    v_cvt_pk_bf16_f32 v49, v82, v83
    v_cvt_pk_bf16_f32 v50, v84, v85
    v_cvt_pk_bf16_f32 v51, v86, v87
    v_cvt_pk_bf16_f32 v52, v88, v89
    v_cvt_pk_bf16_f32 v53, v90, v91
    buffer_store_dwordx2 v[48:49], v14, s[8:11], s28 offen offset:0
    buffer_store_dwordx2 v[50:51], v14, s[8:11], s28 offen offset:512
    s_mov_b32 exec_hi, 0
    buffer_store_dwordx2 v[52:53], v14, s[8:11], s28 offen offset:1024
    s_mov_b32 exec_hi, -1
afront2_kernel_end:
    s_endpgm
.section .rodata,"a"
.p2align 6
.amdhsa_kernel afront2_kernel
  .amdhsa_next_free_vgpr 256
  .amdhsa_next_free_sgpr 64
  .amdhsa_accum_offset 256
  .amdhsa_group_segment_fixed_size 0
  .amdhsa_kernarg_size 104
  .amdhsa_user_sgpr_count 2
  .amdhsa_user_sgpr_kernarg_segment_ptr 1
  .amdhsa_system_sgpr_workgroup_id_x 1
.end_amdhsa_kernel
.text
.globl aback2_kernel
.p2align 8
.type aback2_kernel,@function
aback2_kernel:
    s_cmp_ge_u32 s2, 160
    s_cbranch_scc1 aback2_kernel_end
    s_load_dwordx2 s[4:5], s[0:1], 96
    v_lshrrev_b32 v1, 6, v0
    v_and_b32 v0, 63, v0
    s_nop 0
    v_readfirstlane_b32 s13, v1
    s_waitcnt lgkmcnt(0)
    s_mov_b32 s8, s4
    s_mov_b32 s9, s5
    s_mov_b32 s10, 268435456
    s_mov_b32 s11, 0x00020000
    s_mov_b32 s49, 1
    s_mul_i32 s28, s2, 13108
    s_lshr_b32 s28, s28, 16
    s_mul_i32 s29, s28, 5
    s_sub_u32 s29, s2, s29
    s_lshl_b32 s14, s28, 1
    s_add_u32 s15, s14, 2
    s_load_dwordx2 s[52:53], s[0:1], 0
    v_lshlrev_b32 v1, 4, v0
    s_lshl_b32 s21, s29, 2
    s_add_u32 s21, s21, s13
    s_mul_i32 s24, s21, 40960
    s_add_u32 s24, s24, 246415360
    buffer_load_dwordx4 a[0:3], v1, s[8:11], s24 offen offset:0
    buffer_load_dwordx4 a[4:7], v1, s[8:11], s24 offen offset:1024
    buffer_load_dwordx4 a[8:11], v1, s[8:11], s24 offen offset:2048
    buffer_load_dwordx4 a[12:15], v1, s[8:11], s24 offen offset:3072
    s_add_u32 s24, s24, 4096
    buffer_load_dwordx4 a[16:19], v1, s[8:11], s24 offen offset:0
    buffer_load_dwordx4 a[20:23], v1, s[8:11], s24 offen offset:1024
    buffer_load_dwordx4 a[24:27], v1, s[8:11], s24 offen offset:2048
    buffer_load_dwordx4 a[28:31], v1, s[8:11], s24 offen offset:3072
    s_add_u32 s24, s24, 4096
    buffer_load_dwordx4 a[32:35], v1, s[8:11], s24 offen offset:0
    buffer_load_dwordx4 a[36:39], v1, s[8:11], s24 offen offset:1024
    buffer_load_dwordx4 a[40:43], v1, s[8:11], s24 offen offset:2048
    buffer_load_dwordx4 a[44:47], v1, s[8:11], s24 offen offset:3072
    s_add_u32 s24, s24, 4096
    buffer_load_dwordx4 a[48:51], v1, s[8:11], s24 offen offset:0
    buffer_load_dwordx4 a[52:55], v1, s[8:11], s24 offen offset:1024
    buffer_load_dwordx4 a[56:59], v1, s[8:11], s24 offen offset:2048
    buffer_load_dwordx4 a[60:63], v1, s[8:11], s24 offen offset:3072
    s_add_u32 s24, s24, 4096
    buffer_load_dwordx4 a[64:67], v1, s[8:11], s24 offen offset:0
    buffer_load_dwordx4 a[68:71], v1, s[8:11], s24 offen offset:1024
    buffer_load_dwordx4 a[72:75], v1, s[8:11], s24 offen offset:2048
    buffer_load_dwordx4 a[76:79], v1, s[8:11], s24 offen offset:3072
    s_add_u32 s24, s24, 4096
    buffer_load_dwordx4 a[80:83], v1, s[8:11], s24 offen offset:0
    buffer_load_dwordx4 a[84:87], v1, s[8:11], s24 offen offset:1024
    buffer_load_dwordx4 a[88:91], v1, s[8:11], s24 offen offset:2048
    buffer_load_dwordx4 a[92:95], v1, s[8:11], s24 offen offset:3072
    s_add_u32 s24, s24, 4096
    buffer_load_dwordx4 a[96:99], v1, s[8:11], s24 offen offset:0
    buffer_load_dwordx4 a[100:103], v1, s[8:11], s24 offen offset:1024
    buffer_load_dwordx4 a[104:107], v1, s[8:11], s24 offen offset:2048
    buffer_load_dwordx4 a[108:111], v1, s[8:11], s24 offen offset:3072
    s_add_u32 s24, s24, 4096
    buffer_load_dwordx4 a[112:115], v1, s[8:11], s24 offen offset:0
    buffer_load_dwordx4 a[116:119], v1, s[8:11], s24 offen offset:1024
    buffer_load_dwordx4 a[120:123], v1, s[8:11], s24 offen offset:2048
    buffer_load_dwordx4 a[124:127], v1, s[8:11], s24 offen offset:3072
    s_add_u32 s24, s24, 4096
    buffer_load_dwordx4 a[128:131], v1, s[8:11], s24 offen offset:0
    buffer_load_dwordx4 a[132:135], v1, s[8:11], s24 offen offset:1024
    buffer_load_dwordx4 a[136:139], v1, s[8:11], s24 offen offset:2048
    buffer_load_dwordx4 a[140:143], v1, s[8:11], s24 offen offset:3072
    s_add_u32 s24, s24, 4096
    buffer_load_dwordx4 a[144:147], v1, s[8:11], s24 offen offset:0
    buffer_load_dwordx4 a[148:151], v1, s[8:11], s24 offen offset:1024
    buffer_load_dwordx4 a[152:155], v1, s[8:11], s24 offen offset:2048
    buffer_load_dwordx4 a[156:159], v1, s[8:11], s24 offen offset:3072
    s_add_u32 s24, s4, 247463936
    s_addc_u32 s25, s5, 0
    s_waitcnt lgkmcnt(0)
    s_cmp_eq_u32 s49, 0
    s_cselect_b32 s52, s52, s24
    s_cselect_b32 s53, s53, s25
    s_mov_b32 s54, 2621440
    s_mov_b32 s55, 0x00020000
    v_and_b32 v6, 31, v0
    v_lshrrev_b32 v7, 5, v0
    v_mul_u32_u24 v6, 1280, v6
    v_lshl_add_u32 v3, v7, 4, v6
    s_mul_i32 s19, s14, 40960
    s_lshl_b32 s24, s21, 6
    s_add_u32 s19, s19, s24
    s_lshl_b32 s20, s14, 7
    s_lshl_b32 s24, s21, 2
    s_add_u32 s20, s20, s24
    s_add_u32 s20, s20, 36864
    v_mov_b32 v5, 1
    v_mov_b32 v4, 0
    s_mul_i32 s18, s13, 10240
    s_add_u32 s18, s18, 229638144
    s_mov_b32 s17, 0
    s_min_u32 s24, s14, 63
    s_mul_i32 s24, s24, 40960
    s_add_u32 s24, s24, s18
    s_mul_i32 s25, s13, 10240
    s_add_u32 s25, s25, s17
    s_mov_b32 m0, s25
    s_nop 0
    buffer_load_dwordx4 v1, s[8:11], s24 offen offset:0 lds
    buffer_load_dwordx4 v1, s[8:11], s24 offen offset:1024 lds
    buffer_load_dwordx4 v1, s[8:11], s24 offen offset:2048 lds
    buffer_load_dwordx4 v1, s[8:11], s24 offen offset:3072 lds
    s_add_u32 s24, s24, 4096
    s_add_u32 s25, s25, 4096
    s_mov_b32 m0, s25
    s_nop 0
    buffer_load_dwordx4 v1, s[8:11], s24 offen offset:0 lds
    buffer_load_dwordx4 v1, s[8:11], s24 offen offset:1024 lds
    buffer_load_dwordx4 v1, s[8:11], s24 offen offset:2048 lds
    buffer_load_dwordx4 v1, s[8:11], s24 offen offset:3072 lds
    s_add_u32 s24, s24, 4096
    s_add_u32 s25, s25, 4096
    s_mov_b32 m0, s25
    s_nop 0
    buffer_load_dwordx4 v1, s[8:11], s24 offen offset:0 lds
    buffer_load_dwordx4 v1, s[8:11], s24 offen offset:1024 lds
    s_mov_b32 s17, 40960
    s_add_u32 s23, s14, 1
    s_min_u32 s24, s23, 63
    s_mul_i32 s24, s24, 40960
    s_add_u32 s24, s24, s18
    s_mul_i32 s25, s13, 10240
    s_add_u32 s25, s25, s17
    s_mov_b32 m0, s25
    s_nop 0
    buffer_load_dwordx4 v1, s[8:11], s24 offen offset:0 lds
    buffer_load_dwordx4 v1, s[8:11], s24 offen offset:1024 lds
    buffer_load_dwordx4 v1, s[8:11], s24 offen offset:2048 lds
    buffer_load_dwordx4 v1, s[8:11], s24 offen offset:3072 lds
    s_add_u32 s24, s24, 4096
    s_add_u32 s25, s25, 4096
    s_mov_b32 m0, s25
    s_nop 0
    buffer_load_dwordx4 v1, s[8:11], s24 offen offset:0 lds
    buffer_load_dwordx4 v1, s[8:11], s24 offen offset:1024 lds
    buffer_load_dwordx4 v1, s[8:11], s24 offen offset:2048 lds
    buffer_load_dwordx4 v1, s[8:11], s24 offen offset:3072 lds
    s_add_u32 s24, s24, 4096
    s_add_u32 s25, s25, 4096
    s_mov_b32 m0, s25
    s_nop 0
    buffer_load_dwordx4 v1, s[8:11], s24 offen offset:0 lds
    buffer_load_dwordx4 v1, s[8:11], s24 offen offset:1024 lds
    s_mov_b32 s17, 81920
    s_mov_b32 s16, 0
    s_waitcnt vmcnt(10)
    s_barrier
    v_add_u32 v2, s16, v1
    buffer_load_dwordx4 v[8:11], v3, s[52:55], s19 offen offset:0
    buffer_load_dwordx4 v[12:15], v3, s[52:55], s19 offen offset:32
    s_add_u32 s23, s14, 2
    s_min_u32 s24, s23, 63
    s_mul_i32 s24, s24, 40960
    s_add_u32 s24, s24, s18
    s_mul_i32 s25, s13, 10240
    s_add_u32 s25, s25, s17
    s_mov_b32 m0, s25
    s_nop 0
    buffer_load_dwordx4 v1, s[8:11], s24 offen offset:0 lds
    buffer_load_dwordx4 v1, s[8:11], s24 offen offset:1024 lds
    buffer_load_dwordx4 v1, s[8:11], s24 offen offset:2048 lds
    buffer_load_dwordx4 v1, s[8:11], s24 offen offset:3072 lds
    s_add_u32 s24, s24, 4096
    s_add_u32 s25, s25, 4096
    s_mov_b32 m0, s25
    s_nop 0
    buffer_load_dwordx4 v1, s[8:11], s24 offen offset:0 lds
    buffer_load_dwordx4 v1, s[8:11], s24 offen offset:1024 lds
    buffer_load_dwordx4 v1, s[8:11], s24 offen offset:2048 lds
    buffer_load_dwordx4 v1, s[8:11], s24 offen offset:3072 lds
    s_add_u32 s24, s24, 4096
    s_add_u32 s25, s25, 4096
    s_mov_b32 m0, s25
    s_nop 0
    buffer_load_dwordx4 v1, s[8:11], s24 offen offset:0 lds
    buffer_load_dwordx4 v1, s[8:11], s24 offen offset:1024 lds
    s_add_u32 s17, s17, 40960
    s_cmp_eq_u32 s17, 122880
    s_cselect_b32 s17, 0, s17
    ds_read_b128 v[16:19], v2 offset:0
    ds_read_b128 v[20:23], v2 offset:1024
    ds_read_b128 v[24:27], v2 offset:2048
    ds_read_b128 v[28:31], v2 offset:3072
    ds_read_b128 v[32:35], v2 offset:4096
    ds_read_b128 v[36:39], v2 offset:5120
    ds_read_b128 v[40:43], v2 offset:6144
    s_waitcnt lgkmcnt(6)
    v_mfma_f32_32x32x16_bf16 v[48:63], a[0:3], v[16:19], 0
    ds_read_b128 v[44:47], v2 offset:7168
    s_waitcnt lgkmcnt(6)
    v_mfma_f32_32x32x16_bf16 v[64:79], a[4:7], v[20:23], 0
    ds_read_b128 v[16:19], v2 offset:8192
    s_waitcnt lgkmcnt(6)
    v_mfma_f32_32x32x16_bf16 v[48:63], a[8:11], v[24:27], v[48:63]
    ds_read_b128 v[20:23], v2 offset:9216
    s_waitcnt lgkmcnt(6)
    v_mfma_f32_32x32x16_bf16 v[64:79], a[12:15], v[28:31], v[64:79]
    ds_read_b128 v[24:27], v2 offset:10240
    s_waitcnt lgkmcnt(6)
    v_mfma_f32_32x32x16_bf16 v[48:63], a[16:19], v[32:35], v[48:63]
    ds_read_b128 v[28:31], v2 offset:11264
    s_waitcnt lgkmcnt(6)
    v_mfma_f32_32x32x16_bf16 v[64:79], a[20:23], v[36:39], v[64:79]
    ds_read_b128 v[32:35], v2 offset:12288
    s_waitcnt lgkmcnt(6)
    v_mfma_f32_32x32x16_bf16 v[48:63], a[24:27], v[40:43], v[48:63]
    ds_read_b128 v[36:39], v2 offset:13312
    s_waitcnt lgkmcnt(6)
    v_mfma_f32_32x32x16_bf16 v[64:79], a[28:31], v[44:47], v[64:79]
    ds_read_b128 v[40:43], v2 offset:14336
    s_waitcnt lgkmcnt(6)
    v_mfma_f32_32x32x16_bf16 v[48:63], a[32:35], v[16:19], v[48:63]
    ds_read_b128 v[44:47], v2 offset:15360
    s_waitcnt lgkmcnt(6)
    v_mfma_f32_32x32x16_bf16 v[64:79], a[36:39], v[20:23], v[64:79]
    ds_read_b128 v[16:19], v2 offset:16384
    s_waitcnt lgkmcnt(6)
    v_mfma_f32_32x32x16_bf16 v[48:63], a[40:43], v[24:27], v[48:63]
    ds_read_b128 v[20:23], v2 offset:17408
    s_waitcnt lgkmcnt(6)
    v_mfma_f32_32x32x16_bf16 v[64:79], a[44:47], v[28:31], v[64:79]
    ds_read_b128 v[24:27], v2 offset:18432
    s_waitcnt lgkmcnt(6)
    v_mfma_f32_32x32x16_bf16 v[48:63], a[48:51], v[32:35], v[48:63]
    ds_read_b128 v[28:31], v2 offset:19456
    s_waitcnt lgkmcnt(6)
    v_mfma_f32_32x32x16_bf16 v[64:79], a[52:55], v[36:39], v[64:79]
    ds_read_b128 v[32:35], v2 offset:20480
    s_waitcnt lgkmcnt(6)
    v_mfma_f32_32x32x16_bf16 v[48:63], a[56:59], v[40:43], v[48:63]
    ds_read_b128 v[36:39], v2 offset:21504
    s_waitcnt lgkmcnt(6)
    v_mfma_f32_32x32x16_bf16 v[64:79], a[60:63], v[44:47], v[64:79]
    ds_read_b128 v[40:43], v2 offset:22528
    s_waitcnt lgkmcnt(6)
    v_mfma_f32_32x32x16_bf16 v[48:63], a[64:67], v[16:19], v[48:63]
    ds_read_b128 v[44:47], v2 offset:23552
    s_waitcnt lgkmcnt(6)
    v_mfma_f32_32x32x16_bf16 v[64:79], a[68:71], v[20:23], v[64:79]
    ds_read_b128 v[16:19], v2 offset:24576
    s_waitcnt lgkmcnt(6)
    v_mfma_f32_32x32x16_bf16 v[48:63], a[72:75], v[24:27], v[48:63]
    ds_read_b128 v[20:23], v2 offset:25600
    s_waitcnt lgkmcnt(6)
    v_mfma_f32_32x32x16_bf16 v[64:79], a[76:79], v[28:31], v[64:79]
    ds_read_b128 v[24:27], v2 offset:26624
    s_waitcnt lgkmcnt(6)
    v_mfma_f32_32x32x16_bf16 v[48:63], a[80:83], v[32:35], v[48:63]
    ds_read_b128 v[28:31], v2 offset:27648
    s_waitcnt lgkmcnt(6)
    v_mfma_f32_32x32x16_bf16 v[64:79], a[84:87], v[36:39], v[64:79]
    ds_read_b128 v[32:35], v2 offset:28672
    s_waitcnt lgkmcnt(6)
    v_mfma_f32_32x32x16_bf16 v[48:63], a[88:91], v[40:43], v[48:63]
    ds_read_b128 v[36:39], v2 offset:29696
    s_waitcnt lgkmcnt(6)
    v_mfma_f32_32x32x16_bf16 v[64:79], a[92:95], v[44:47], v[64:79]
    ds_read_b128 v[40:43], v2 offset:30720
    s_waitcnt lgkmcnt(6)
    v_mfma_f32_32x32x16_bf16 v[48:63], a[96:99], v[16:19], v[48:63]
    ds_read_b128 v[44:47], v2 offset:31744
    s_waitcnt lgkmcnt(6)
    v_mfma_f32_32x32x16_bf16 v[64:79], a[100:103], v[20:23], v[64:79]
    ds_read_b128 v[16:19], v2 offset:32768
    s_waitcnt lgkmcnt(6)
    v_mfma_f32_32x32x16_bf16 v[48:63], a[104:107], v[24:27], v[48:63]
    ds_read_b128 v[20:23], v2 offset:33792
    s_waitcnt lgkmcnt(6)
    v_mfma_f32_32x32x16_bf16 v[64:79], a[108:111], v[28:31], v[64:79]
    ds_read_b128 v[24:27], v2 offset:34816
    s_waitcnt lgkmcnt(6)
    v_mfma_f32_32x32x16_bf16 v[48:63], a[112:115], v[32:35], v[48:63]
    ds_read_b128 v[28:31], v2 offset:35840
    s_waitcnt lgkmcnt(6)
    v_mfma_f32_32x32x16_bf16 v[64:79], a[116:119], v[36:39], v[64:79]
    ds_read_b128 v[32:35], v2 offset:36864
    s_waitcnt lgkmcnt(6)
    v_mfma_f32_32x32x16_bf16 v[48:63], a[120:123], v[40:43], v[48:63]
    ds_read_b128 v[36:39], v2 offset:37888
    s_waitcnt lgkmcnt(6)
    v_mfma_f32_32x32x16_bf16 v[64:79], a[124:127], v[44:47], v[64:79]
    ds_read_b128 v[40:43], v2 offset:38912
    s_waitcnt lgkmcnt(6)
    v_mfma_f32_32x32x16_bf16 v[48:63], a[128:131], v[16:19], v[48:63]
    ds_read_b128 v[44:47], v2 offset:39936
    s_waitcnt lgkmcnt(6)
    v_mfma_f32_32x32x16_bf16 v[64:79], a[132:135], v[20:23], v[64:79]
    s_waitcnt lgkmcnt(5)
    v_mfma_f32_32x32x16_bf16 v[48:63], a[136:139], v[24:27], v[48:63]
    s_waitcnt lgkmcnt(4)
    v_mfma_f32_32x32x16_bf16 v[64:79], a[140:143], v[28:31], v[64:79]
    s_waitcnt lgkmcnt(3)
    v_mfma_f32_32x32x16_bf16 v[48:63], a[144:147], v[32:35], v[48:63]
    s_waitcnt lgkmcnt(2)
    v_mfma_f32_32x32x16_bf16 v[64:79], a[148:151], v[36:39], v[64:79]
    s_waitcnt lgkmcnt(1)
    v_mfma_f32_32x32x16_bf16 v[48:63], a[152:155], v[40:43], v[48:63]
    s_waitcnt lgkmcnt(0)
    v_mfma_f32_32x32x16_bf16 v[64:79], a[156:159], v[44:47], v[64:79]
    s_waitcnt vmcnt(10)
    s_nop 7
    s_nop 3
    v_add_f32 v48, v48, v64
    v_add_f32 v49, v49, v65
    v_add_f32 v50, v50, v66
    v_add_f32 v51, v51, v67
    v_add_f32 v52, v52, v68
    v_add_f32 v53, v53, v69
    v_add_f32 v54, v54, v70
    v_add_f32 v55, v55, v71
    v_add_f32 v56, v56, v72
    v_add_f32 v57, v57, v73
    v_add_f32 v58, v58, v74
    v_add_f32 v59, v59, v75
    v_add_f32 v60, v60, v76
    v_add_f32 v61, v61, v77
    v_add_f32 v62, v62, v78
    v_add_f32 v63, v63, v79
    v_cvt_pk_bf16_f32 v80, v48, v49
    v_cvt_pk_bf16_f32 v81, v50, v51
    v_cvt_pk_bf16_f32 v82, v52, v53
    v_cvt_pk_bf16_f32 v83, v54, v55
    s_nop 1
    v_permlane32_swap_b32 v80, v82
    v_permlane32_swap_b32 v81, v83
    s_nop 1
    v_lshlrev_b32 v88, 16, v80
    v_and_b32 v89, 0xffff0000, v80
    v_lshlrev_b32 v90, 16, v8
    v_and_b32 v91, 0xffff0000, v8
    v_add_f32 v88, v88, v90
    v_add_f32 v89, v89, v91
    v_cvt_pk_bf16_f32 v80, v88, v89
    v_lshlrev_b32 v92, 16, v81
    v_and_b32 v93, 0xffff0000, v81
    v_lshlrev_b32 v94, 16, v9
    v_and_b32 v95, 0xffff0000, v9
    v_add_f32 v92, v92, v94
    v_add_f32 v93, v93, v95
    v_cvt_pk_bf16_f32 v81, v92, v93
    v_lshlrev_b32 v88, 16, v82
    v_and_b32 v89, 0xffff0000, v82
    v_lshlrev_b32 v90, 16, v10
    v_and_b32 v91, 0xffff0000, v10
    v_add_f32 v88, v88, v90
    v_add_f32 v89, v89, v91
    v_cvt_pk_bf16_f32 v82, v88, v89
    v_lshlrev_b32 v92, 16, v83
    v_and_b32 v93, 0xffff0000, v83
    v_lshlrev_b32 v94, 16, v11
    v_and_b32 v95, 0xffff0000, v11
    v_add_f32 v92, v92, v94
    v_add_f32 v93, v93, v95
    v_cvt_pk_bf16_f32 v83, v92, v93
    s_add_u32 s26, s19, 226492416
    buffer_store_dwordx4 v[80:83], v3, s[8:11], s26 offen offset:0
    v_cvt_pk_bf16_f32 v84, v56, v57
    v_cvt_pk_bf16_f32 v85, v58, v59
    v_cvt_pk_bf16_f32 v86, v60, v61
    v_cvt_pk_bf16_f32 v87, v62, v63
    s_nop 1
    v_permlane32_swap_b32 v84, v86
    v_permlane32_swap_b32 v85, v87
    s_nop 1
    v_lshlrev_b32 v88, 16, v84
    v_and_b32 v89, 0xffff0000, v84
    v_lshlrev_b32 v90, 16, v12
    v_and_b32 v91, 0xffff0000, v12
    v_add_f32 v88, v88, v90
    v_add_f32 v89, v89, v91
    v_cvt_pk_bf16_f32 v84, v88, v89
    v_lshlrev_b32 v92, 16, v85
    v_and_b32 v93, 0xffff0000, v85
    v_lshlrev_b32 v94, 16, v13
    v_and_b32 v95, 0xffff0000, v13
    v_add_f32 v92, v92, v94
    v_add_f32 v93, v93, v95
    v_cvt_pk_bf16_f32 v85, v92, v93
    v_lshlrev_b32 v88, 16, v86
    v_and_b32 v89, 0xffff0000, v86
    v_lshlrev_b32 v90, 16, v14
    v_and_b32 v91, 0xffff0000, v14
    v_add_f32 v88, v88, v90
    v_add_f32 v89, v89, v91
    v_cvt_pk_bf16_f32 v86, v88, v89
    v_lshlrev_b32 v92, 16, v87
    v_and_b32 v93, 0xffff0000, v87
    v_lshlrev_b32 v94, 16, v15
    v_and_b32 v95, 0xffff0000, v15
    v_add_f32 v92, v92, v94
    v_add_f32 v93, v93, v95
    v_cvt_pk_bf16_f32 v87, v92, v93
    s_add_u32 s26, s19, 226492416
    buffer_store_dwordx4 v[84:87], v3, s[8:11], s26 offen offset:32
    s_add_u32 s19, s19, 40960
    s_add_u32 s16, s16, 40960
    s_cmp_eq_u32 s16, 122880
    s_cselect_b32 s16, 0, s16
    s_add_u32 s14, s14, 1
    s_cmp_ge_u32 s14, s15
    s_cbranch_scc1 aback2_kernel_ab_fin
aback2_kernel_ab_loop:
    s_barrier
    v_add_u32 v2, s16, v1
    buffer_load_dwordx4 v[8:11], v3, s[52:55], s19 offen offset:0
    buffer_load_dwordx4 v[12:15], v3, s[52:55], s19 offen offset:32
    s_add_u32 s23, s14, 2
    s_min_u32 s24, s23, 63
    s_mul_i32 s24, s24, 40960
    s_add_u32 s24, s24, s18
    s_mul_i32 s25, s13, 10240
    s_add_u32 s25, s25, s17
    s_mov_b32 m0, s25
    s_nop 0
    buffer_load_dwordx4 v1, s[8:11], s24 offen offset:0 lds
    buffer_load_dwordx4 v1, s[8:11], s24 offen offset:1024 lds
    buffer_load_dwordx4 v1, s[8:11], s24 offen offset:2048 lds
    buffer_load_dwordx4 v1, s[8:11], s24 offen offset:3072 lds
    s_add_u32 s24, s24, 4096
    s_add_u32 s25, s25, 4096
    s_mov_b32 m0, s25
    s_nop 0
    buffer_load_dwordx4 v1, s[8:11], s24 offen offset:0 lds
    buffer_load_dwordx4 v1, s[8:11], s24 offen offset:1024 lds
    buffer_load_dwordx4 v1, s[8:11], s24 offen offset:2048 lds
    buffer_load_dwordx4 v1, s[8:11], s24 offen offset:3072 lds
    s_add_u32 s24, s24, 4096
    s_add_u32 s25, s25, 4096
    s_mov_b32 m0, s25
    s_nop 0
    buffer_load_dwordx4 v1, s[8:11], s24 offen offset:0 lds
    buffer_load_dwordx4 v1, s[8:11], s24 offen offset:1024 lds
    s_add_u32 s17, s17, 40960
    s_cmp_eq_u32 s17, 122880
    s_cselect_b32 s17, 0, s17
    ds_read_b128 v[16:19], v2 offset:0
    ds_read_b128 v[20:23], v2 offset:1024
    ds_read_b128 v[24:27], v2 offset:2048
    ds_read_b128 v[28:31], v2 offset:3072
    ds_read_b128 v[32:35], v2 offset:4096
    ds_read_b128 v[36:39], v2 offset:5120
    ds_read_b128 v[40:43], v2 offset:6144
    s_waitcnt lgkmcnt(6)
    v_mfma_f32_32x32x16_bf16 v[48:63], a[0:3], v[16:19], 0
    ds_read_b128 v[44:47], v2 offset:7168
    s_waitcnt lgkmcnt(6)
    v_mfma_f32_32x32x16_bf16 v[64:79], a[4:7], v[20:23], 0
    ds_read_b128 v[16:19], v2 offset:8192
    s_waitcnt lgkmcnt(6)
    v_mfma_f32_32x32x16_bf16 v[48:63], a[8:11], v[24:27], v[48:63]
    ds_read_b128 v[20:23], v2 offset:9216
    s_waitcnt lgkmcnt(6)
    v_mfma_f32_32x32x16_bf16 v[64:79], a[12:15], v[28:31], v[64:79]
    ds_read_b128 v[24:27], v2 offset:10240
    s_waitcnt lgkmcnt(6)
    v_mfma_f32_32x32x16_bf16 v[48:63], a[16:19], v[32:35], v[48:63]
    ds_read_b128 v[28:31], v2 offset:11264
    s_waitcnt lgkmcnt(6)
    v_mfma_f32_32x32x16_bf16 v[64:79], a[20:23], v[36:39], v[64:79]
    ds_read_b128 v[32:35], v2 offset:12288
    s_waitcnt lgkmcnt(6)
    v_mfma_f32_32x32x16_bf16 v[48:63], a[24:27], v[40:43], v[48:63]
    ds_read_b128 v[36:39], v2 offset:13312
    s_waitcnt lgkmcnt(6)
    v_mfma_f32_32x32x16_bf16 v[64:79], a[28:31], v[44:47], v[64:79]
    ds_read_b128 v[40:43], v2 offset:14336
    s_waitcnt lgkmcnt(6)
    v_mfma_f32_32x32x16_bf16 v[48:63], a[32:35], v[16:19], v[48:63]
    ds_read_b128 v[44:47], v2 offset:15360
    s_waitcnt lgkmcnt(6)
    v_mfma_f32_32x32x16_bf16 v[64:79], a[36:39], v[20:23], v[64:79]
    ds_read_b128 v[16:19], v2 offset:16384
    s_waitcnt lgkmcnt(6)
    v_mfma_f32_32x32x16_bf16 v[48:63], a[40:43], v[24:27], v[48:63]
    ds_read_b128 v[20:23], v2 offset:17408
    s_waitcnt lgkmcnt(6)
    v_mfma_f32_32x32x16_bf16 v[64:79], a[44:47], v[28:31], v[64:79]
    ds_read_b128 v[24:27], v2 offset:18432
    s_waitcnt lgkmcnt(6)
    v_mfma_f32_32x32x16_bf16 v[48:63], a[48:51], v[32:35], v[48:63]
    ds_read_b128 v[28:31], v2 offset:19456
    s_waitcnt lgkmcnt(6)
    v_mfma_f32_32x32x16_bf16 v[64:79], a[52:55], v[36:39], v[64:79]
    ds_read_b128 v[32:35], v2 offset:20480
    s_waitcnt lgkmcnt(6)
    v_mfma_f32_32x32x16_bf16 v[48:63], a[56:59], v[40:43], v[48:63]
    ds_read_b128 v[36:39], v2 offset:21504
    s_waitcnt lgkmcnt(6)
    v_mfma_f32_32x32x16_bf16 v[64:79], a[60:63], v[44:47], v[64:79]
    ds_read_b128 v[40:43], v2 offset:22528
    s_waitcnt lgkmcnt(6)
    v_mfma_f32_32x32x16_bf16 v[48:63], a[64:67], v[16:19], v[48:63]
    ds_read_b128 v[44:47], v2 offset:23552
    s_waitcnt lgkmcnt(6)
    v_mfma_f32_32x32x16_bf16 v[64:79], a[68:71], v[20:23], v[64:79]
    ds_read_b128 v[16:19], v2 offset:24576
    s_waitcnt lgkmcnt(6)
    v_mfma_f32_32x32x16_bf16 v[48:63], a[72:75], v[24:27], v[48:63]
    ds_read_b128 v[20:23], v2 offset:25600
    s_waitcnt lgkmcnt(6)
    v_mfma_f32_32x32x16_bf16 v[64:79], a[76:79], v[28:31], v[64:79]
    ds_read_b128 v[24:27], v2 offset:26624
    s_waitcnt lgkmcnt(6)
    v_mfma_f32_32x32x16_bf16 v[48:63], a[80:83], v[32:35], v[48:63]
    ds_read_b128 v[28:31], v2 offset:27648
    s_waitcnt lgkmcnt(6)
    v_mfma_f32_32x32x16_bf16 v[64:79], a[84:87], v[36:39], v[64:79]
    ds_read_b128 v[32:35], v2 offset:28672
    s_waitcnt lgkmcnt(6)
    v_mfma_f32_32x32x16_bf16 v[48:63], a[88:91], v[40:43], v[48:63]
    ds_read_b128 v[36:39], v2 offset:29696
    s_waitcnt lgkmcnt(6)
    v_mfma_f32_32x32x16_bf16 v[64:79], a[92:95], v[44:47], v[64:79]
    ds_read_b128 v[40:43], v2 offset:30720
    s_waitcnt lgkmcnt(6)
    v_mfma_f32_32x32x16_bf16 v[48:63], a[96:99], v[16:19], v[48:63]
    ds_read_b128 v[44:47], v2 offset:31744
    s_waitcnt lgkmcnt(6)
    v_mfma_f32_32x32x16_bf16 v[64:79], a[100:103], v[20:23], v[64:79]
    ds_read_b128 v[16:19], v2 offset:32768
    s_waitcnt lgkmcnt(6)
    v_mfma_f32_32x32x16_bf16 v[48:63], a[104:107], v[24:27], v[48:63]
    ds_read_b128 v[20:23], v2 offset:33792
    s_waitcnt lgkmcnt(6)
    v_mfma_f32_32x32x16_bf16 v[64:79], a[108:111], v[28:31], v[64:79]
    ds_read_b128 v[24:27], v2 offset:34816
    s_waitcnt lgkmcnt(6)
    v_mfma_f32_32x32x16_bf16 v[48:63], a[112:115], v[32:35], v[48:63]
    ds_read_b128 v[28:31], v2 offset:35840
    s_waitcnt lgkmcnt(6)
    v_mfma_f32_32x32x16_bf16 v[64:79], a[116:119], v[36:39], v[64:79]
    ds_read_b128 v[32:35], v2 offset:36864
    s_waitcnt lgkmcnt(6)
    v_mfma_f32_32x32x16_bf16 v[48:63], a[120:123], v[40:43], v[48:63]
    ds_read_b128 v[36:39], v2 offset:37888
    s_waitcnt lgkmcnt(6)
    v_mfma_f32_32x32x16_bf16 v[64:79], a[124:127], v[44:47], v[64:79]
    ds_read_b128 v[40:43], v2 offset:38912
    s_waitcnt lgkmcnt(6)
    v_mfma_f32_32x32x16_bf16 v[48:63], a[128:131], v[16:19], v[48:63]
    ds_read_b128 v[44:47], v2 offset:39936
    s_waitcnt lgkmcnt(6)
    v_mfma_f32_32x32x16_bf16 v[64:79], a[132:135], v[20:23], v[64:79]
    s_waitcnt lgkmcnt(5)
    v_mfma_f32_32x32x16_bf16 v[48:63], a[136:139], v[24:27], v[48:63]
    s_waitcnt lgkmcnt(4)
    v_mfma_f32_32x32x16_bf16 v[64:79], a[140:143], v[28:31], v[64:79]
    s_waitcnt lgkmcnt(3)
    v_mfma_f32_32x32x16_bf16 v[48:63], a[144:147], v[32:35], v[48:63]
    s_waitcnt lgkmcnt(2)
    v_mfma_f32_32x32x16_bf16 v[64:79], a[148:151], v[36:39], v[64:79]
    s_waitcnt lgkmcnt(1)
    v_mfma_f32_32x32x16_bf16 v[48:63], a[152:155], v[40:43], v[48:63]
    s_waitcnt lgkmcnt(0)
    v_mfma_f32_32x32x16_bf16 v[64:79], a[156:159], v[44:47], v[64:79]
    s_waitcnt vmcnt(10)
    s_nop 7
    s_nop 3
    v_add_f32 v48, v48, v64
    v_add_f32 v49, v49, v65
    v_add_f32 v50, v50, v66
    v_add_f32 v51, v51, v67
    v_add_f32 v52, v52, v68
    v_add_f32 v53, v53, v69
    v_add_f32 v54, v54, v70
    v_add_f32 v55, v55, v71
    v_add_f32 v56, v56, v72
    v_add_f32 v57, v57, v73
    v_add_f32 v58, v58, v74
    v_add_f32 v59, v59, v75
    v_add_f32 v60, v60, v76
    v_add_f32 v61, v61, v77
    v_add_f32 v62, v62, v78
    v_add_f32 v63, v63, v79
    v_cvt_pk_bf16_f32 v80, v48, v49
    v_cvt_pk_bf16_f32 v81, v50, v51
    v_cvt_pk_bf16_f32 v82, v52, v53
    v_cvt_pk_bf16_f32 v83, v54, v55
    s_nop 1
    v_permlane32_swap_b32 v80, v82
    v_permlane32_swap_b32 v81, v83
    s_nop 1
    v_lshlrev_b32 v88, 16, v80
    v_and_b32 v89, 0xffff0000, v80
    v_lshlrev_b32 v90, 16, v8
    v_and_b32 v91, 0xffff0000, v8
    v_add_f32 v88, v88, v90
    v_add_f32 v89, v89, v91
    v_cvt_pk_bf16_f32 v80, v88, v89
    v_lshlrev_b32 v92, 16, v81
    v_and_b32 v93, 0xffff0000, v81
    v_lshlrev_b32 v94, 16, v9
    v_and_b32 v95, 0xffff0000, v9
    v_add_f32 v92, v92, v94
    v_add_f32 v93, v93, v95
    v_cvt_pk_bf16_f32 v81, v92, v93
    v_lshlrev_b32 v88, 16, v82
    v_and_b32 v89, 0xffff0000, v82
    v_lshlrev_b32 v90, 16, v10
    v_and_b32 v91, 0xffff0000, v10
    v_add_f32 v88, v88, v90
    v_add_f32 v89, v89, v91
    v_cvt_pk_bf16_f32 v82, v88, v89
    v_lshlrev_b32 v92, 16, v83
    v_and_b32 v93, 0xffff0000, v83
    v_lshlrev_b32 v94, 16, v11
    v_and_b32 v95, 0xffff0000, v11
    v_add_f32 v92, v92, v94
    v_add_f32 v93, v93, v95
    v_cvt_pk_bf16_f32 v83, v92, v93
    s_add_u32 s26, s19, 226492416
    buffer_store_dwordx4 v[80:83], v3, s[8:11], s26 offen offset:0
    v_cvt_pk_bf16_f32 v84, v56, v57
    v_cvt_pk_bf16_f32 v85, v58, v59
    v_cvt_pk_bf16_f32 v86, v60, v61
    v_cvt_pk_bf16_f32 v87, v62, v63
    s_nop 1
    v_permlane32_swap_b32 v84, v86
    v_permlane32_swap_b32 v85, v87
    s_nop 1
    v_lshlrev_b32 v88, 16, v84
    v_and_b32 v89, 0xffff0000, v84
    v_lshlrev_b32 v90, 16, v12
    v_and_b32 v91, 0xffff0000, v12
    v_add_f32 v88, v88, v90
    v_add_f32 v89, v89, v91
    v_cvt_pk_bf16_f32 v84, v88, v89
    v_lshlrev_b32 v92, 16, v85
    v_and_b32 v93, 0xffff0000, v85
    v_lshlrev_b32 v94, 16, v13
    v_and_b32 v95, 0xffff0000, v13
    v_add_f32 v92, v92, v94
    v_add_f32 v93, v93, v95
    v_cvt_pk_bf16_f32 v85, v92, v93
    v_lshlrev_b32 v88, 16, v86
    v_and_b32 v89, 0xffff0000, v86
    v_lshlrev_b32 v90, 16, v14
    v_and_b32 v91, 0xffff0000, v14
    v_add_f32 v88, v88, v90
    v_add_f32 v89, v89, v91
    v_cvt_pk_bf16_f32 v86, v88, v89
    v_lshlrev_b32 v92, 16, v87
    v_and_b32 v93, 0xffff0000, v87
    v_lshlrev_b32 v94, 16, v15
    v_and_b32 v95, 0xffff0000, v15
    v_add_f32 v92, v92, v94
    v_add_f32 v93, v93, v95
    v_cvt_pk_bf16_f32 v87, v92, v93
    s_add_u32 s26, s19, 226492416
    buffer_store_dwordx4 v[84:87], v3, s[8:11], s26 offen offset:32
    s_add_u32 s19, s19, 40960
    s_add_u32 s16, s16, 40960
    s_cmp_eq_u32 s16, 122880
    s_cselect_b32 s16, 0, s16
    s_add_u32 s14, s14, 1
    s_cmp_lt_u32 s14, s15
    s_cbranch_scc1 aback2_kernel_ab_loop
aback2_kernel_ab_fin:
    s_waitcnt vmcnt(0) lgkmcnt(0)
    s_barrier
aback2_kernel_end:
    s_endpgm
.section .rodata,"a"
.p2align 6
.amdhsa_kernel aback2_kernel
  .amdhsa_next_free_vgpr 288
  .amdhsa_next_free_sgpr 64
  .amdhsa_accum_offset 128
  .amdhsa_group_segment_fixed_size 0
  .amdhsa_kernarg_size 104
  .amdhsa_user_sgpr_count 2
  .amdhsa_user_sgpr_kernarg_segment_ptr 1
  .amdhsa_system_sgpr_workgroup_id_x 1
.end_amdhsa_kernel
.text
.globl ln_b2_kernel
.p2align 8
.type ln_b2_kernel,@function
ln_b2_kernel:
    s_cmp_gt_u32 s2, 512
    s_cbranch_scc1 ln_b2_kernel_end
    s_load_dwordx2 s[4:5], s[0:1], 96
    s_load_dwordx2 s[6:7], s[0:1], 32
    v_lshrrev_b32 v1, 6, v0
    v_and_b32 v0, 63, v0
    s_nop 0
    v_readfirstlane_b32 s13, v1
    s_waitcnt lgkmcnt(0)
    s_mov_b32 s8, s4
    s_mov_b32 s9, s5
    s_mov_b32 s10, 268435456
    s_mov_b32 s11, 0x00020000
    s_cmp_eq_u32 s2, 512
    s_cbranch_scc1 ln_b2_kernel_mem0
    s_lshl_b32 s20, s2, 2
    s_add_u32 s20, s20, s13
    s_mul_i32 s21, s20, 1280
    s_add_u32 s21, s21, 226492416
    v_lshlrev_b32 v3, 2, v0
    buffer_load_dword v4, v3, s[8:11], s21 offen offset:0
    buffer_load_dword v5, v3, s[8:11], s21 offen offset:256
    buffer_load_dword v6, v3, s[8:11], s21 offen offset:512
    buffer_load_dword v7, v3, s[8:11], s21 offen offset:768
    buffer_load_dword v8, v3, s[8:11], s21 offen offset:1024
    v_lshrrev_b32 v20, 4, v0
    v_lshlrev_b32 v20, 2, v20
    v_bfe_u32 v21, v0, 3, 1
    v_lshl_add_u32 v20, v21, 1, v20
    v_bfe_u32 v21, v0, 1, 1
    v_add_u32 v20, v20, v21
    v_lshlrev_b32 v20, 9, v20
    v_and_b32 v21, 1, v0
    v_lshl_add_u32 v20, v21, 3, v20
    v_bfe_u32 v21, v0, 2, 1
    v_lshl_add_u32 v23, v21, 2, v20
    s_lshr_b32 s22, s20, 5
    s_mul_i32 s22, s22, 40960
    s_and_b32 s23, s20, 31
    s_lshl_b32 s23, s23, 4
    s_add_u32 s22, s22, s23
    s_add_u32 s22, s22, 220200960
    s_waitcnt vmcnt(0)
    v_lshlrev_b32 v10, 16, v4
    v_and_b32 v11, 0xffff0000, v4
    v_lshlrev_b32 v12, 16, v5
    v_and_b32 v13, 0xffff0000, v5
    v_lshlrev_b32 v14, 16, v6
    v_and_b32 v15, 0xffff0000, v6
    v_lshlrev_b32 v16, 16, v7
    v_and_b32 v17, 0xffff0000, v7
    v_lshlrev_b32 v18, 16, v8
    v_and_b32 v19, 0xffff0000, v8
    v_add_f32 v20, v10, v11
    v_add_f32 v20, v20, v12
    v_add_f32 v20, v20, v13
    v_add_f32 v20, v20, v14
    v_add_f32 v20, v20, v15
    v_add_f32 v20, v20, v16
    v_add_f32 v20, v20, v17
    v_add_f32 v20, v20, v18
    v_add_f32 v20, v20, v19
    s_nop 1
    v_add_f32 v21, v20, v20 quad_perm:[1,0,3,2] row_mask:0xf bank_mask:0xf
    s_nop 1
    v_add_f32 v21, v21, v21 quad_perm:[2,3,0,1] row_mask:0xf bank_mask:0xf
    s_nop 1
    v_add_f32 v21, v21, v21 row_half_mirror row_mask:0xf bank_mask:0xf
    s_nop 1
    v_add_f32 v21, v21, v21 row_mirror row_mask:0xf bank_mask:0xf
    s_nop 1
    v_readlane_b32 s24, v21, 0
    v_readlane_b32 s25, v21, 16
    v_readlane_b32 s26, v21, 32
    v_readlane_b32 s27, v21, 48
    s_nop 1
    v_mov_b32 v20, s24
    v_add_f32 v20, s25, v20
    v_add_f32 v20, s26, v20
    v_add_f32 v20, s27, v20
    v_mul_f32 v20, 0x3acccccd, v20
    v_sub_f32 v10, v10, v20
    v_sub_f32 v11, v11, v20
    v_sub_f32 v12, v12, v20
    v_sub_f32 v13, v13, v20
    v_sub_f32 v14, v14, v20
    v_sub_f32 v15, v15, v20
    v_sub_f32 v16, v16, v20
    v_sub_f32 v17, v17, v20
    v_sub_f32 v18, v18, v20
    v_sub_f32 v19, v19, v20
    v_mul_f32 v21, v10, v10
    v_fmac_f32 v21, v11, v11
    v_fmac_f32 v21, v12, v12
    v_fmac_f32 v21, v13, v13
    v_fmac_f32 v21, v14, v14
    v_fmac_f32 v21, v15, v15
    v_fmac_f32 v21, v16, v16
    v_fmac_f32 v21, v17, v17
    v_fmac_f32 v21, v18, v18
    v_fmac_f32 v21, v19, v19
    s_nop 1
    v_add_f32 v22, v21, v21 quad_perm:[1,0,3,2] row_mask:0xf bank_mask:0xf
    s_nop 1
    v_add_f32 v22, v22, v22 quad_perm:[2,3,0,1] row_mask:0xf bank_mask:0xf
    s_nop 1
    v_add_f32 v22, v22, v22 row_half_mirror row_mask:0xf bank_mask:0xf
    s_nop 1
    v_add_f32 v22, v22, v22 row_mirror row_mask:0xf bank_mask:0xf
    s_nop 1
    v_readlane_b32 s24, v22, 0
    v_readlane_b32 s25, v22, 16
    v_readlane_b32 s26, v22, 32
    v_readlane_b32 s27, v22, 48
    s_nop 1
    v_mov_b32 v21, s24
    v_add_f32 v21, s25, v21
    v_add_f32 v21, s26, v21
    v_add_f32 v21, s27, v21
    v_mov_b32 v22, 0x3727c5ac
    v_fmac_f32 v22, 0x3acccccd, v21
    v_rsq_f32 v22, v22
    s_nop 0
    v_mul_f32 v10, v10, v22
    v_mul_f32 v11, v11, v22
    v_mul_f32 v12, v12, v22
    v_mul_f32 v13, v13, v22
    v_mul_f32 v14, v14, v22
    v_mul_f32 v15, v15, v22
    v_mul_f32 v16, v16, v22
    v_mul_f32 v17, v17, v22
    v_mul_f32 v18, v18, v22
    v_mul_f32 v19, v19, v22
    v_cvt_pk_bf16_f32 v4, v10, v11
    v_cvt_pk_bf16_f32 v5, v12, v13
    v_cvt_pk_bf16_f32 v6, v14, v15
    v_cvt_pk_bf16_f32 v7, v16, v17
    v_cvt_pk_bf16_f32 v8, v18, v19
    s_add_u32 s23, s22, 0
    buffer_store_dword v4, v23, s[8:11], s23 offen
    s_add_u32 s23, s22, 8192
    buffer_store_dword v5, v23, s[8:11], s23 offen
    s_add_u32 s23, s22, 16384
    buffer_store_dword v6, v23, s[8:11], s23 offen
    s_add_u32 s23, s22, 24576
    buffer_store_dword v7, v23, s[8:11], s23 offen
    s_add_u32 s23, s22, 32768
    buffer_store_dword v8, v23, s[8:11], s23 offen
    s_branch ln_b2_kernel_end
ln_b2_kernel_mem0:
    s_mov_b32 s16, s6
    s_mov_b32 s17, s7
    s_mov_b32 s18, 10240
    s_mov_b32 s19, 0x00020000
    s_sub_u32 s22, 0, s4
    s_and_b32 s22, s22, 0x1fffff
    s_mov_b32 s23, 10551304
    s_buffer_load_dword s24, s[8:11], s23
    s_waitcnt lgkmcnt(0)
    s_and_b32 s24, s24, 8192
    s_add_u32 s22, s22, 4194304
    s_xor_b32 s25, s24, 8192
    s_add_u32 s26, s22, s25
    s_add_u32 s22, s22, s24
    s_lshl_b32 s25, s13, 6
    v_add_u32 v1, s25, v0
    v_add_u32 v2, 0, v1
    v_and_b32 v3, 7, v2
    v_mul_u32_u24 v3, 1280, v3
    v_lshrrev_b32 v4, 3, v2
    v_lshl_add_u32 v3, v4, 4, v3
    v_lshlrev_b32 v5, 4, v2
    v_add_u32 v5, 20480, v5
    v_lshrrev_b32 v6, 13, v5
    v_lshlrev_b32 v6, 14, v6
    v_and_b32 v5, 8191, v5
    v_add_u32 v5, v5, v6
    v_cmp_gt_u32 vcc, 640, v2
    s_and_saveexec_b64 s[30:31], vcc
    s_cbranch_execz ln_b2_kernel_m0s0
    buffer_load_dwordx4 v[8:11], v3, s[16:19], 0 offen
    s_waitcnt vmcnt(0)
    buffer_store_dwordx4 v[8:11], v5, s[8:11], s22 offen
    buffer_store_dwordx4 v[8:11], v5, s[8:11], s26 offen
ln_b2_kernel_m0s0:
    s_mov_b64 exec, s[30:31]
    v_add_u32 v2, 256, v1
    v_and_b32 v3, 7, v2
    v_mul_u32_u24 v3, 1280, v3
    v_lshrrev_b32 v4, 3, v2
    v_lshl_add_u32 v3, v4, 4, v3
    v_lshlrev_b32 v5, 4, v2
    v_add_u32 v5, 20480, v5
    v_lshrrev_b32 v6, 13, v5
    v_lshlrev_b32 v6, 14, v6
    v_and_b32 v5, 8191, v5
    v_add_u32 v5, v5, v6
    v_cmp_gt_u32 vcc, 640, v2
    s_and_saveexec_b64 s[30:31], vcc
    s_cbranch_execz ln_b2_kernel_m0s1
    buffer_load_dwordx4 v[8:11], v3, s[16:19], 0 offen
    s_waitcnt vmcnt(0)
    buffer_store_dwordx4 v[8:11], v5, s[8:11], s22 offen
    buffer_store_dwordx4 v[8:11], v5, s[8:11], s26 offen
ln_b2_kernel_m0s1:
    s_mov_b64 exec, s[30:31]
    v_add_u32 v2, 512, v1
    v_and_b32 v3, 7, v2
    v_mul_u32_u24 v3, 1280, v3
    v_lshrrev_b32 v4, 3, v2
    v_lshl_add_u32 v3, v4, 4, v3
    v_lshlrev_b32 v5, 4, v2
    v_add_u32 v5, 20480, v5
    v_lshrrev_b32 v6, 13, v5
    v_lshlrev_b32 v6, 14, v6
    v_and_b32 v5, 8191, v5
    v_add_u32 v5, v5, v6
    v_cmp_gt_u32 vcc, 640, v2
    s_and_saveexec_b64 s[30:31], vcc
    s_cbranch_execz ln_b2_kernel_m0s2
    buffer_load_dwordx4 v[8:11], v3, s[16:19], 0 offen
    s_waitcnt vmcnt(0)
    buffer_store_dwordx4 v[8:11], v5, s[8:11], s22 offen
    buffer_store_dwordx4 v[8:11], v5, s[8:11], s26 offen
ln_b2_kernel_m0s2:
    s_mov_b64 exec, s[30:31]
ln_b2_kernel_end:
    s_endpgm
.section .rodata,"a"
.p2align 6
.amdhsa_kernel ln_b2_kernel
  .amdhsa_next_free_vgpr 32
  .amdhsa_next_free_sgpr 48
  .amdhsa_accum_offset 32
  .amdhsa_group_segment_fixed_size 0
  .amdhsa_kernarg_size 104
  .amdhsa_user_sgpr_count 2
  .amdhsa_user_sgpr_kernarg_segment_ptr 1
  .amdhsa_system_sgpr_workgroup_id_x 1
.end_amdhsa_kernel
```

```asm
; @launch kernel=prep_kernel grid=(573,1,1) block=(256,1,1) lds=1024
; @launch kernel=afront1_kernel grid=(256,1,1) block=(256,1,1) lds=131072
; @launch kernel=layerb1_kernel grid=(256,1,1) block=(256,1,1) lds=143616
; @launch kernel=afront2_kernel grid=(256,1,1) block=(256,1,1) lds=131072
; @launch kernel=layerb2_kernel grid=(256,1,1) block=(256,1,1) lds=143616
.amdgcn_target "amdgcn-amd-amdhsa--gfx950"
.text
.globl prep_kernel
.p2align 8
.type prep_kernel,@function
prep_kernel:
    s_cmp_ge_u32 s2, 573
    s_cbranch_scc1 prep_kernel_end
    s_load_dwordx2 s[4:5], s[0:1], 96
    v_lshrrev_b32 v1, 6, v0
    v_and_b32 v0, 63, v0
    s_nop 0
    v_readfirstlane_b32 s13, v1
    s_waitcnt lgkmcnt(0)
    s_mov_b32 s8, s4
    s_mov_b32 s9, s5
    s_mov_b32 s10, 268435456
    s_mov_b32 s11, 0x00020000
    s_mov_b32 s20, s2
    s_cmp_lt_u32 s2, 4
    s_cbranch_scc1 prep_kernel_r_cal
    s_cmp_eq_u32 s2, 4
    s_cbranch_scc1 prep_kernel_r_zero
    s_sub_u32 s20, s2, 5
    s_cmp_lt_u32 s20, 64
    s_cbranch_scc1 prep_kernel_r_pwa
    s_sub_u32 s20, s20, 64
    s_cmp_lt_u32 s20, 40
    s_cbranch_scc1 prep_kernel_r_pwo
    s_sub_u32 s20, s20, 40
    s_cmp_lt_u32 s20, 160
    s_cbranch_scc1 prep_kernel_r_wvo
    s_sub_u32 s20, s20, 160
    s_cmp_lt_u32 s20, 240
    s_cbranch_scc1 prep_kernel_r_pwp
    s_sub_u32 s20, s20, 240
    s_sub_u32 s21, 0, s4
    s_and_b32 s21, s21, 0x1fffff
    s_mul_i32 s22, s20, 131072
    s_add_u32 s21, s21, s22
    s_lshl_b32 s22, s13, 10
    s_add_u32 s21, s21, s22
    v_lshlrev_b32 v1, 4, v0
    v_mov_b32 v4, -1
    v_mov_b32 v5, -1
    v_mov_b32 v6, -1
    v_mov_b32 v7, -1
    s_mov_b32 s22, 32
prep_kernel_clr_loop:
    buffer_store_dwordx4 v[4:7], v1, s[8:11], s21 offen
    s_add_u32 s21, s21, 4096
    s_sub_u32 s22, s22, 1
    s_cmp_lg_u32 s22, 0
    s_cbranch_scc1 prep_kernel_clr_loop
    s_branch prep_kernel_end
prep_kernel_r_cal:
    s_cmp_lg_u32 s13, 0
    s_cbranch_scc1 prep_kernel_end
    s_sub_u32 s22, 0, s4
    s_and_b32 s22, s22, 0x1fffff
    s_getreg_b32 s23, hwreg(HW_REG_XCC_ID)
    s_bfe_u32 s23, s23, 0x10002
    s_mov_b64 exec, 1
    v_mov_b32 v1, 0
    s_mul_i32 s24, s20, 2097152
    s_add_u32 s22, s22, s24
    s_add_u32 s22, s22, 2086912
    s_mov_b32 s30, -1
    s_mov_b32 s31, -1
    s_mov_b32 s25, 15
    v_mov_b32 v2, 0
prep_kernel_cal:
    s_and_b32 s24, s25, 15
    s_lshl_b32 s24, s24, 7
    s_add_u32 s24, s24, s22
    s_memtime s[26:27]
    s_waitcnt lgkmcnt(0)
    buffer_atomic_add v2, v1, s[8:11], s24 offen sc0 sc1
    s_waitcnt vmcnt(0)
    s_memtime s[28:29]
    v_mov_b32 v2, 0
    s_waitcnt lgkmcnt(0)
    s_sub_u32 s26, s28, s26
    s_min_u32 s30, s30, s26
    s_and_b32 s24, s25, 15
    s_lshl_b32 s24, s24, 7
    s_add_u32 s24, s24, s22
    s_add_u32 s24, s24, 8192
    s_memtime s[26:27]
    s_waitcnt lgkmcnt(0)
    buffer_atomic_add v2, v1, s[8:11], s24 offen sc0 sc1
    s_waitcnt vmcnt(0)
    s_memtime s[28:29]
    v_mov_b32 v2, 0
    s_waitcnt lgkmcnt(0)
    s_sub_u32 s26, s28, s26
    s_min_u32 s31, s31, s26
    s_sub_u32 s25, s25, 1
    s_cmp_lg_u32 s25, 0
    s_cbranch_scc1 prep_kernel_cal
    s_cmp_lt_u32 s31, s30
    s_cselect_b32 s24, 1, 0
    s_xor_b32 s24, s24, s23
    s_lshl_b32 s24, s24, 13
    v_mov_b32 v3, s24
    s_lshl_b32 s25, s20, 2
    s_add_u32 s25, s25, 10551296
    buffer_store_dword v3, v1, s[8:11], s25 offen
    s_lshl_b32 s26, s30, 16
    s_or_b32 s26, s26, s31
    v_mov_b32 v3, s26
    buffer_store_dword v3, v1, s[8:11], s25 offen offset:64
    s_branch prep_kernel_end
prep_kernel_r_zero:
    v_lshlrev_b32 v1, 4, v0
    v_mov_b32 v4, 0
    v_mov_b32 v5, 0
    v_mov_b32 v6, 0
    v_mov_b32 v7, 0
    s_lshl_b32 s21, s13, 10
    s_add_u32 s21, s21, 10485760
    buffer_store_dwordx4 v[4:7], v1, s[8:11], s21 offen
    s_lshl_b32 s21, s13, 15
    s_add_u32 s21, s21, 10616832
    buffer_store_dwordx4 v[4:7], v1, s[8:11], s21 offen offset:0
    buffer_store_dwordx4 v[4:7], v1, s[8:11], s21 offen offset:1024
    buffer_store_dwordx4 v[4:7], v1, s[8:11], s21 offen offset:2048
    buffer_store_dwordx4 v[4:7], v1, s[8:11], s21 offen offset:3072
    s_add_u32 s21, s21, 4096
    buffer_store_dwordx4 v[4:7], v1, s[8:11], s21 offen offset:0
    buffer_store_dwordx4 v[4:7], v1, s[8:11], s21 offen offset:1024
    buffer_store_dwordx4 v[4:7], v1, s[8:11], s21 offen offset:2048
    buffer_store_dwordx4 v[4:7], v1, s[8:11], s21 offen offset:3072
    s_add_u32 s21, s21, 4096
    buffer_store_dwordx4 v[4:7], v1, s[8:11], s21 offen offset:0
    buffer_store_dwordx4 v[4:7], v1, s[8:11], s21 offen offset:1024
    buffer_store_dwordx4 v[4:7], v1, s[8:11], s21 offen offset:2048
    buffer_store_dwordx4 v[4:7], v1, s[8:11], s21 offen offset:3072
    s_add_u32 s21, s21, 4096
    buffer_store_dwordx4 v[4:7], v1, s[8:11], s21 offen offset:0
    buffer_store_dwordx4 v[4:7], v1, s[8:11], s21 offen offset:1024
    buffer_store_dwordx4 v[4:7], v1, s[8:11], s21 offen offset:2048
    buffer_store_dwordx4 v[4:7], v1, s[8:11], s21 offen offset:3072
    s_add_u32 s21, s21, 4096
    buffer_store_dwordx4 v[4:7], v1, s[8:11], s21 offen offset:0
    buffer_store_dwordx4 v[4:7], v1, s[8:11], s21 offen offset:1024
    buffer_store_dwordx4 v[4:7], v1, s[8:11], s21 offen offset:2048
    buffer_store_dwordx4 v[4:7], v1, s[8:11], s21 offen offset:3072
    s_add_u32 s21, s21, 4096
    buffer_store_dwordx4 v[4:7], v1, s[8:11], s21 offen offset:0
    buffer_store_dwordx4 v[4:7], v1, s[8:11], s21 offen offset:1024
    buffer_store_dwordx4 v[4:7], v1, s[8:11], s21 offen offset:2048
    buffer_store_dwordx4 v[4:7], v1, s[8:11], s21 offen offset:3072
    s_add_u32 s21, s21, 4096
    buffer_store_dwordx4 v[4:7], v1, s[8:11], s21 offen offset:0
    buffer_store_dwordx4 v[4:7], v1, s[8:11], s21 offen offset:1024
    buffer_store_dwordx4 v[4:7], v1, s[8:11], s21 offen offset:2048
    buffer_store_dwordx4 v[4:7], v1, s[8:11], s21 offen offset:3072
    s_add_u32 s21, s21, 4096
    buffer_store_dwordx4 v[4:7], v1, s[8:11], s21 offen offset:0
    buffer_store_dwordx4 v[4:7], v1, s[8:11], s21 offen offset:1024
    buffer_store_dwordx4 v[4:7], v1, s[8:11], s21 offen offset:2048
    buffer_store_dwordx4 v[4:7], v1, s[8:11], s21 offen offset:3072
    s_add_u32 s21, s21, 4096
    s_branch prep_kernel_end
prep_kernel_r_wvo:
    s_lshl_b32 s20, s20, 2
    s_add_u32 s20, s20, s13
    s_load_dwordx2 s[24:25], s[0:1], 56
    s_load_dwordx2 s[26:27], s[0:1], 64
    s_and_b32 s21, s20, 1
    s_lshr_b32 s22, s20, 1
    s_mul_i32 s23, s22, 205
    s_lshr_b32 s23, s23, 11
    s_mul_i32 s28, s23, 10
    s_sub_u32 s22, s22, s28
    s_waitcnt lgkmcnt(0)
    s_mov_b32 s32, s24
    s_mov_b32 s33, s25
    s_mov_b32 s34, 7864320
    s_mov_b32 s35, 0x00020000
    s_mov_b32 s36, s26
    s_mov_b32 s37, s27
    s_mov_b32 s38, 7864320
    s_mov_b32 s39, 0x00020000
    v_and_b32 v1, 31, v0
    v_lshrrev_b32 v2, 5, v0
    v_mul_u32_u24 v3, 10240, v2
    v_lshl_add_u32 v3, v1, 2, v3
    s_mul_i32 s28, s23, 245760
    s_lshl_b32 s29, s22, 7
    s_add_u32 s28, s28, s29
    s_add_u32 s29, s28, 0
    buffer_load_dword v112, v3, s[36:39], s29 offen
    s_add_u32 s29, s28, 1280
    buffer_load_dword v113, v3, s[36:39], s29 offen
    s_add_u32 s29, s28, 2560
    buffer_load_dword v114, v3, s[36:39], s29 offen
    s_add_u32 s29, s28, 3840
    buffer_load_dword v115, v3, s[36:39], s29 offen
    s_add_u32 s29, s28, 5120
    buffer_load_dword v116, v3, s[36:39], s29 offen
    s_add_u32 s29, s28, 6400
    buffer_load_dword v117, v3, s[36:39], s29 offen
    s_add_u32 s29, s28, 7680
    buffer_load_dword v118, v3, s[36:39], s29 offen
    s_add_u32 s29, s28, 8960
    buffer_load_dword v119, v3, s[36:39], s29 offen
    s_add_u32 s29, s28, 20480
    buffer_load_dword v120, v3, s[36:39], s29 offen
    s_add_u32 s29, s28, 21760
    buffer_load_dword v121, v3, s[36:39], s29 offen
    s_add_u32 s29, s28, 23040
    buffer_load_dword v122, v3, s[36:39], s29 offen
    s_add_u32 s29, s28, 24320
    buffer_load_dword v123, v3, s[36:39], s29 offen
    s_add_u32 s29, s28, 25600
    buffer_load_dword v124, v3, s[36:39], s29 offen
    s_add_u32 s29, s28, 26880
    buffer_load_dword v125, v3, s[36:39], s29 offen
    s_add_u32 s29, s28, 28160
    buffer_load_dword v126, v3, s[36:39], s29 offen
    s_add_u32 s29, s28, 29440
    buffer_load_dword v127, v3, s[36:39], s29 offen
    s_add_u32 s29, s28, 40960
    buffer_load_dword v128, v3, s[36:39], s29 offen
    s_add_u32 s29, s28, 42240
    buffer_load_dword v129, v3, s[36:39], s29 offen
    s_add_u32 s29, s28, 43520
    buffer_load_dword v130, v3, s[36:39], s29 offen
    s_add_u32 s29, s28, 44800
    buffer_load_dword v131, v3, s[36:39], s29 offen
    s_add_u32 s29, s28, 46080
    buffer_load_dword v132, v3, s[36:39], s29 offen
    s_add_u32 s29, s28, 47360
    buffer_load_dword v133, v3, s[36:39], s29 offen
    s_add_u32 s29, s28, 48640
    buffer_load_dword v134, v3, s[36:39], s29 offen
    s_add_u32 s29, s28, 49920
    buffer_load_dword v135, v3, s[36:39], s29 offen
    s_add_u32 s29, s28, 61440
    buffer_load_dword v136, v3, s[36:39], s29 offen
    s_add_u32 s29, s28, 62720
    buffer_load_dword v137, v3, s[36:39], s29 offen
    s_add_u32 s29, s28, 64000
    buffer_load_dword v138, v3, s[36:39], s29 offen
    s_add_u32 s29, s28, 65280
    buffer_load_dword v139, v3, s[36:39], s29 offen
    s_add_u32 s29, s28, 66560
    buffer_load_dword v140, v3, s[36:39], s29 offen
    s_add_u32 s29, s28, 67840
    buffer_load_dword v141, v3, s[36:39], s29 offen
    s_add_u32 s29, s28, 69120
    buffer_load_dword v142, v3, s[36:39], s29 offen
    s_add_u32 s29, s28, 70400
    buffer_load_dword v143, v3, s[36:39], s29 offen
    s_add_u32 s29, s28, 81920
    buffer_load_dword v144, v3, s[36:39], s29 offen
    s_add_u32 s29, s28, 83200
    buffer_load_dword v145, v3, s[36:39], s29 offen
    s_add_u32 s29, s28, 84480
    buffer_load_dword v146, v3, s[36:39], s29 offen
    s_add_u32 s29, s28, 85760
    buffer_load_dword v147, v3, s[36:39], s29 offen
    s_add_u32 s29, s28, 87040
    buffer_load_dword v148, v3, s[36:39], s29 offen
    s_add_u32 s29, s28, 88320
    buffer_load_dword v149, v3, s[36:39], s29 offen
    s_add_u32 s29, s28, 89600
    buffer_load_dword v150, v3, s[36:39], s29 offen
    s_add_u32 s29, s28, 90880
    buffer_load_dword v151, v3, s[36:39], s29 offen
    s_add_u32 s29, s28, 102400
    buffer_load_dword v152, v3, s[36:39], s29 offen
    s_add_u32 s29, s28, 103680
    buffer_load_dword v153, v3, s[36:39], s29 offen
    s_add_u32 s29, s28, 104960
    buffer_load_dword v154, v3, s[36:39], s29 offen
    s_add_u32 s29, s28, 106240
    buffer_load_dword v155, v3, s[36:39], s29 offen
    s_add_u32 s29, s28, 107520
    buffer_load_dword v156, v3, s[36:39], s29 offen
    s_add_u32 s29, s28, 108800
    buffer_load_dword v157, v3, s[36:39], s29 offen
    s_add_u32 s29, s28, 110080
    buffer_load_dword v158, v3, s[36:39], s29 offen
    s_add_u32 s29, s28, 111360
    buffer_load_dword v159, v3, s[36:39], s29 offen
    v_mov_b32 v4, 0x05040100
    v_mov_b32 v5, 0x07060302
    s_waitcnt vmcnt(0)
    v_perm_b32 v16, v113, v112, v4
    v_perm_b32 v64, v113, v112, v5
    v_perm_b32 v17, v115, v114, v4
    v_perm_b32 v65, v115, v114, v5
    v_perm_b32 v18, v117, v116, v4
    v_perm_b32 v66, v117, v116, v5
    v_perm_b32 v19, v119, v118, v4
    v_perm_b32 v67, v119, v118, v5
    v_perm_b32 v20, v121, v120, v4
    v_perm_b32 v68, v121, v120, v5
    v_perm_b32 v21, v123, v122, v4
    v_perm_b32 v69, v123, v122, v5
    v_perm_b32 v22, v125, v124, v4
    v_perm_b32 v70, v125, v124, v5
    v_perm_b32 v23, v127, v126, v4
    v_perm_b32 v71, v127, v126, v5
    v_perm_b32 v24, v129, v128, v4
    v_perm_b32 v72, v129, v128, v5
    v_perm_b32 v25, v131, v130, v4
    v_perm_b32 v73, v131, v130, v5
    v_perm_b32 v26, v133, v132, v4
    v_perm_b32 v74, v133, v132, v5
    v_perm_b32 v27, v135, v134, v4
    v_perm_b32 v75, v135, v134, v5
    v_perm_b32 v28, v137, v136, v4
    v_perm_b32 v76, v137, v136, v5
    v_perm_b32 v29, v139, v138, v4
    v_perm_b32 v77, v139, v138, v5
    v_perm_b32 v30, v141, v140, v4
    v_perm_b32 v78, v141, v140, v5
    v_perm_b32 v31, v143, v142, v4
    v_perm_b32 v79, v143, v142, v5
    v_perm_b32 v32, v145, v144, v4
    v_perm_b32 v80, v145, v144, v5
    v_perm_b32 v33, v147, v146, v4
    v_perm_b32 v81, v147, v146, v5
    v_perm_b32 v34, v149, v148, v4
    v_perm_b32 v82, v149, v148, v5
    v_perm_b32 v35, v151, v150, v4
    v_perm_b32 v83, v151, v150, v5
    v_perm_b32 v36, v153, v152, v4
    v_perm_b32 v84, v153, v152, v5
    v_perm_b32 v37, v155, v154, v4
    v_perm_b32 v85, v155, v154, v5
    v_perm_b32 v38, v157, v156, v4
    v_perm_b32 v86, v157, v156, v5
    v_perm_b32 v39, v159, v158, v4
    v_perm_b32 v87, v159, v158, v5
    s_add_u32 s29, s28, 122880
    buffer_load_dword v112, v3, s[36:39], s29 offen
    s_add_u32 s29, s28, 124160
    buffer_load_dword v113, v3, s[36:39], s29 offen
    s_add_u32 s29, s28, 125440
    buffer_load_dword v114, v3, s[36:39], s29 offen
    s_add_u32 s29, s28, 126720
    buffer_load_dword v115, v3, s[36:39], s29 offen
    s_add_u32 s29, s28, 128000
    buffer_load_dword v116, v3, s[36:39], s29 offen
    s_add_u32 s29, s28, 129280
    buffer_load_dword v117, v3, s[36:39], s29 offen
    s_add_u32 s29, s28, 130560
    buffer_load_dword v118, v3, s[36:39], s29 offen
    s_add_u32 s29, s28, 131840
    buffer_load_dword v119, v3, s[36:39], s29 offen
    s_add_u32 s29, s28, 143360
    buffer_load_dword v120, v3, s[36:39], s29 offen
    s_add_u32 s29, s28, 144640
    buffer_load_dword v121, v3, s[36:39], s29 offen
    s_add_u32 s29, s28, 145920
    buffer_load_dword v122, v3, s[36:39], s29 offen
    s_add_u32 s29, s28, 147200
    buffer_load_dword v123, v3, s[36:39], s29 offen
    s_add_u32 s29, s28, 148480
    buffer_load_dword v124, v3, s[36:39], s29 offen
    s_add_u32 s29, s28, 149760
    buffer_load_dword v125, v3, s[36:39], s29 offen
    s_add_u32 s29, s28, 151040
    buffer_load_dword v126, v3, s[36:39], s29 offen
    s_add_u32 s29, s28, 152320
    buffer_load_dword v127, v3, s[36:39], s29 offen
    s_add_u32 s29, s28, 163840
    buffer_load_dword v128, v3, s[36:39], s29 offen
    s_add_u32 s29, s28, 165120
    buffer_load_dword v129, v3, s[36:39], s29 offen
    s_add_u32 s29, s28, 166400
    buffer_load_dword v130, v3, s[36:39], s29 offen
    s_add_u32 s29, s28, 167680
    buffer_load_dword v131, v3, s[36:39], s29 offen
    s_add_u32 s29, s28, 168960
    buffer_load_dword v132, v3, s[36:39], s29 offen
    s_add_u32 s29, s28, 170240
    buffer_load_dword v133, v3, s[36:39], s29 offen
    s_add_u32 s29, s28, 171520
    buffer_load_dword v134, v3, s[36:39], s29 offen
    s_add_u32 s29, s28, 172800
    buffer_load_dword v135, v3, s[36:39], s29 offen
    s_add_u32 s29, s28, 184320
    buffer_load_dword v136, v3, s[36:39], s29 offen
    s_add_u32 s29, s28, 185600
    buffer_load_dword v137, v3, s[36:39], s29 offen
    s_add_u32 s29, s28, 186880
    buffer_load_dword v138, v3, s[36:39], s29 offen
    s_add_u32 s29, s28, 188160
    buffer_load_dword v139, v3, s[36:39], s29 offen
    s_add_u32 s29, s28, 189440
    buffer_load_dword v140, v3, s[36:39], s29 offen
    s_add_u32 s29, s28, 190720
    buffer_load_dword v141, v3, s[36:39], s29 offen
    s_add_u32 s29, s28, 192000
    buffer_load_dword v142, v3, s[36:39], s29 offen
    s_add_u32 s29, s28, 193280
    buffer_load_dword v143, v3, s[36:39], s29 offen
    s_add_u32 s29, s28, 204800
    buffer_load_dword v144, v3, s[36:39], s29 offen
    s_add_u32 s29, s28, 206080
    buffer_load_dword v145, v3, s[36:39], s29 offen
    s_add_u32 s29, s28, 207360
    buffer_load_dword v146, v3, s[36:39], s29 offen
    s_add_u32 s29, s28, 208640
    buffer_load_dword v147, v3, s[36:39], s29 offen
    s_add_u32 s29, s28, 209920
    buffer_load_dword v148, v3, s[36:39], s29 offen
    s_add_u32 s29, s28, 211200
    buffer_load_dword v149, v3, s[36:39], s29 offen
    s_add_u32 s29, s28, 212480
    buffer_load_dword v150, v3, s[36:39], s29 offen
    s_add_u32 s29, s28, 213760
    buffer_load_dword v151, v3, s[36:39], s29 offen
    s_add_u32 s29, s28, 225280
    buffer_load_dword v152, v3, s[36:39], s29 offen
    s_add_u32 s29, s28, 226560
    buffer_load_dword v153, v3, s[36:39], s29 offen
    s_add_u32 s29, s28, 227840
    buffer_load_dword v154, v3, s[36:39], s29 offen
    s_add_u32 s29, s28, 229120
    buffer_load_dword v155, v3, s[36:39], s29 offen
    s_add_u32 s29, s28, 230400
    buffer_load_dword v156, v3, s[36:39], s29 offen
    s_add_u32 s29, s28, 231680
    buffer_load_dword v157, v3, s[36:39], s29 offen
    s_add_u32 s29, s28, 232960
    buffer_load_dword v158, v3, s[36:39], s29 offen
    s_add_u32 s29, s28, 234240
    buffer_load_dword v159, v3, s[36:39], s29 offen
    v_mov_b32 v4, 0x05040100
    v_mov_b32 v5, 0x07060302
    s_waitcnt vmcnt(0)
    v_perm_b32 v40, v113, v112, v4
    v_perm_b32 v88, v113, v112, v5
    v_perm_b32 v41, v115, v114, v4
    v_perm_b32 v89, v115, v114, v5
    v_perm_b32 v42, v117, v116, v4
    v_perm_b32 v90, v117, v116, v5
    v_perm_b32 v43, v119, v118, v4
    v_perm_b32 v91, v119, v118, v5
    v_perm_b32 v44, v121, v120, v4
    v_perm_b32 v92, v121, v120, v5
    v_perm_b32 v45, v123, v122, v4
    v_perm_b32 v93, v123, v122, v5
    v_perm_b32 v46, v125, v124, v4
    v_perm_b32 v94, v125, v124, v5
    v_perm_b32 v47, v127, v126, v4
    v_perm_b32 v95, v127, v126, v5
    v_perm_b32 v48, v129, v128, v4
    v_perm_b32 v96, v129, v128, v5
    v_perm_b32 v49, v131, v130, v4
    v_perm_b32 v97, v131, v130, v5
    v_perm_b32 v50, v133, v132, v4
    v_perm_b32 v98, v133, v132, v5
    v_perm_b32 v51, v135, v134, v4
    v_perm_b32 v99, v135, v134, v5
    v_perm_b32 v52, v137, v136, v4
    v_perm_b32 v100, v137, v136, v5
    v_perm_b32 v53, v139, v138, v4
    v_perm_b32 v101, v139, v138, v5
    v_perm_b32 v54, v141, v140, v4
    v_perm_b32 v102, v141, v140, v5
    v_perm_b32 v55, v143, v142, v4
    v_perm_b32 v103, v143, v142, v5
    v_perm_b32 v56, v145, v144, v4
    v_perm_b32 v104, v145, v144, v5
    v_perm_b32 v57, v147, v146, v4
    v_perm_b32 v105, v147, v146, v5
    v_perm_b32 v58, v149, v148, v4
    v_perm_b32 v106, v149, v148, v5
    v_perm_b32 v59, v151, v150, v4
    v_perm_b32 v107, v151, v150, v5
    v_perm_b32 v60, v153, v152, v4
    v_perm_b32 v108, v153, v152, v5
    v_perm_b32 v61, v155, v154, v4
    v_perm_b32 v109, v155, v154, v5
    v_perm_b32 v62, v157, v156, v4
    v_perm_b32 v110, v157, v156, v5
    v_perm_b32 v63, v159, v158, v4
    v_perm_b32 v111, v159, v158, v5
    v_lshrrev_b32 v6, 3, v1
    v_lshrrev_b32 v7, 2, v6
    v_lshlrev_b32 v7, 5, v7
    v_and_b32 v8, 2, v6
    v_lshl_add_u32 v7, v8, 3, v7
    v_and_b32 v8, 1, v6
    v_lshl_add_u32 v7, v8, 2, v7
    v_and_b32 v8, 7, v1
    v_and_b32 v9, 1, v8
    v_add_u32 v7, v7, v9
    v_and_b32 v9, 2, v8
    v_lshl_add_u32 v7, v9, 2, v7
    v_lshrrev_b32 v9, 2, v8
    v_lshl_add_u32 v7, v9, 1, v7
    v_mul_u32_u24 v7, 12288, v7
    v_lshl_add_u32 v7, v2, 4, v7
    s_mul_i32 s28, s23, 384
    s_mul_i32 s29, s21, 3932160
    s_add_u32 s28, s28, s29
    v_lshrrev_b32 v10, 2, v1
    v_mul_u32_u24 v10, 20480, v10
    v_lshlrev_b32 v10, 4, v10
    v_and_b32 v11, 3, v1
    v_lshl_add_u32 v10, v11, 5, v10
    v_lshl_add_u32 v10, v2, 8, v10
    s_mul_i32 s30, s22, 2621440
    s_lshr_b32 s31, s23, 3
    s_mul_i32 s31, s31, 81920
    s_add_u32 s30, s30, s31
    s_and_b32 s31, s23, 3
    s_mul_i32 s31, s31, 20480
    s_add_u32 s30, s30, s31
    s_bfe_u32 s31, s23, 0x10002
    s_lshl_b32 s31, s31, 7
    s_add_u32 s30, s30, s31
    s_mul_i32 s31, s21, 10240
    s_add_u32 s30, s30, s31
    s_add_u32 s30, s30, 27262976
    buffer_load_dwordx4 v[112:115], v7, s[32:35], s28 offen offset:0
    buffer_load_dwordx4 v[116:119], v7, s[32:35], s28 offen offset:32
    buffer_load_dwordx4 v[120:123], v7, s[32:35], s28 offen offset:64
    buffer_load_dwordx4 v[124:127], v7, s[32:35], s28 offen offset:96
    buffer_load_dwordx4 v[128:131], v7, s[32:35], s28 offen offset:128
    buffer_load_dwordx4 v[132:135], v7, s[32:35], s28 offen offset:160
    buffer_load_dwordx4 v[136:139], v7, s[32:35], s28 offen offset:192
    buffer_load_dwordx4 v[140:143], v7, s[32:35], s28 offen offset:224
    buffer_load_dwordx4 v[144:147], v7, s[32:35], s28 offen offset:256
    buffer_load_dwordx4 v[148:151], v7, s[32:35], s28 offen offset:288
    buffer_load_dwordx4 v[152:155], v7, s[32:35], s28 offen offset:320
    buffer_load_dwordx4 v[156:159], v7, s[32:35], s28 offen offset:352
    s_add_u32 s28, s28, 393216
    s_mov_b32 s31, 5
prep_kernel_wvo_loop:
    buffer_load_dwordx4 v[160:163], v7, s[32:35], s28 offen offset:0
    buffer_load_dwordx4 v[164:167], v7, s[32:35], s28 offen offset:32
    buffer_load_dwordx4 v[168:171], v7, s[32:35], s28 offen offset:64
    buffer_load_dwordx4 v[172:175], v7, s[32:35], s28 offen offset:96
    buffer_load_dwordx4 v[176:179], v7, s[32:35], s28 offen offset:128
    buffer_load_dwordx4 v[180:183], v7, s[32:35], s28 offen offset:160
    buffer_load_dwordx4 v[184:187], v7, s[32:35], s28 offen offset:192
    buffer_load_dwordx4 v[188:191], v7, s[32:35], s28 offen offset:224
    buffer_load_dwordx4 v[192:195], v7, s[32:35], s28 offen offset:256
    buffer_load_dwordx4 v[196:199], v7, s[32:35], s28 offen offset:288
    buffer_load_dwordx4 v[200:203], v7, s[32:35], s28 offen offset:320
    buffer_load_dwordx4 v[204:207], v7, s[32:35], s28 offen offset:352
    s_add_u32 s28, s28, 393216
    s_waitcnt vmcnt(12)
    v_mfma_f32_32x32x16_bf16 v[208:223], v[112:115], v[16:19], 0
    v_mfma_f32_32x32x16_bf16 v[224:239], v[112:115], v[64:67], 0
    v_mfma_f32_32x32x16_bf16 v[208:223], v[116:119], v[20:23], v[208:223]
    v_mfma_f32_32x32x16_bf16 v[224:239], v[116:119], v[68:71], v[224:239]
    v_mfma_f32_32x32x16_bf16 v[208:223], v[120:123], v[24:27], v[208:223]
    v_mfma_f32_32x32x16_bf16 v[224:239], v[120:123], v[72:75], v[224:239]
    v_mfma_f32_32x32x16_bf16 v[208:223], v[124:127], v[28:31], v[208:223]
    v_mfma_f32_32x32x16_bf16 v[224:239], v[124:127], v[76:79], v[224:239]
    v_mfma_f32_32x32x16_bf16 v[208:223], v[128:131], v[32:35], v[208:223]
    v_mfma_f32_32x32x16_bf16 v[224:239], v[128:131], v[80:83], v[224:239]
    v_mfma_f32_32x32x16_bf16 v[208:223], v[132:135], v[36:39], v[208:223]
    v_mfma_f32_32x32x16_bf16 v[224:239], v[132:135], v[84:87], v[224:239]
    v_mfma_f32_32x32x16_bf16 v[208:223], v[136:139], v[40:43], v[208:223]
    v_mfma_f32_32x32x16_bf16 v[224:239], v[136:139], v[88:91], v[224:239]
    v_mfma_f32_32x32x16_bf16 v[208:223], v[140:143], v[44:47], v[208:223]
    v_mfma_f32_32x32x16_bf16 v[224:239], v[140:143], v[92:95], v[224:239]
    v_mfma_f32_32x32x16_bf16 v[208:223], v[144:147], v[48:51], v[208:223]
    v_mfma_f32_32x32x16_bf16 v[224:239], v[144:147], v[96:99], v[224:239]
    v_mfma_f32_32x32x16_bf16 v[208:223], v[148:151], v[52:55], v[208:223]
    v_mfma_f32_32x32x16_bf16 v[224:239], v[148:151], v[100:103], v[224:239]
    v_mfma_f32_32x32x16_bf16 v[208:223], v[152:155], v[56:59], v[208:223]
    v_mfma_f32_32x32x16_bf16 v[224:239], v[152:155], v[104:107], v[224:239]
    v_mfma_f32_32x32x16_bf16 v[208:223], v[156:159], v[60:63], v[208:223]
    v_mfma_f32_32x32x16_bf16 v[224:239], v[156:159], v[108:111], v[224:239]
    s_nop 7
    s_nop 7
    v_cvt_pk_bf16_f32 v240, v208, v209
    v_cvt_pk_bf16_f32 v241, v210, v211
    v_cvt_pk_bf16_f32 v242, v212, v213
    v_cvt_pk_bf16_f32 v243, v214, v215
    s_nop 1
    v_permlane32_swap_b32 v240, v242
    v_permlane32_swap_b32 v241, v243
    buffer_store_dwordx4 v[240:243], v10, s[8:11], s30 offen offset:0
    v_cvt_pk_bf16_f32 v244, v216, v217
    v_cvt_pk_bf16_f32 v245, v218, v219
    v_cvt_pk_bf16_f32 v246, v220, v221
    v_cvt_pk_bf16_f32 v247, v222, v223
    s_nop 1
    v_permlane32_swap_b32 v244, v246
    v_permlane32_swap_b32 v245, v247
    buffer_store_dwordx4 v[244:247], v10, s[8:11], s30 offen offset:512
    s_nop 1
    v_cvt_pk_bf16_f32 v240, v224, v225
    v_cvt_pk_bf16_f32 v241, v226, v227
    v_cvt_pk_bf16_f32 v242, v228, v229
    v_cvt_pk_bf16_f32 v243, v230, v231
    s_nop 1
    v_permlane32_swap_b32 v240, v242
    v_permlane32_swap_b32 v241, v243
    buffer_store_dwordx4 v[240:243], v10, s[8:11], s30 offen offset:16
    v_cvt_pk_bf16_f32 v244, v232, v233
    v_cvt_pk_bf16_f32 v245, v234, v235
    v_cvt_pk_bf16_f32 v246, v236, v237
    v_cvt_pk_bf16_f32 v247, v238, v239
    s_nop 1
    v_permlane32_swap_b32 v244, v246
    v_permlane32_swap_b32 v245, v247
    buffer_store_dwordx4 v[244:247], v10, s[8:11], s30 offen offset:528
    s_nop 1
    s_add_u32 s30, s30, 1024
    s_cmp_eq_u32 s31, 1
    s_cbranch_scc1 prep_kernel_wvo_last
    buffer_load_dwordx4 v[112:115], v7, s[32:35], s28 offen offset:0
    buffer_load_dwordx4 v[116:119], v7, s[32:35], s28 offen offset:32
    buffer_load_dwordx4 v[120:123], v7, s[32:35], s28 offen offset:64
    buffer_load_dwordx4 v[124:127], v7, s[32:35], s28 offen offset:96
    buffer_load_dwordx4 v[128:131], v7, s[32:35], s28 offen offset:128
    buffer_load_dwordx4 v[132:135], v7, s[32:35], s28 offen offset:160
    buffer_load_dwordx4 v[136:139], v7, s[32:35], s28 offen offset:192
    buffer_load_dwordx4 v[140:143], v7, s[32:35], s28 offen offset:224
    buffer_load_dwordx4 v[144:147], v7, s[32:35], s28 offen offset:256
    buffer_load_dwordx4 v[148:151], v7, s[32:35], s28 offen offset:288
    buffer_load_dwordx4 v[152:155], v7, s[32:35], s28 offen offset:320
    buffer_load_dwordx4 v[156:159], v7, s[32:35], s28 offen offset:352
    s_add_u32 s28, s28, 393216
    s_waitcnt vmcnt(12)
    v_mfma_f32_32x32x16_bf16 v[208:223], v[160:163], v[16:19], 0
    v_mfma_f32_32x32x16_bf16 v[224:239], v[160:163], v[64:67], 0
    v_mfma_f32_32x32x16_bf16 v[208:223], v[164:167], v[20:23], v[208:223]
    v_mfma_f32_32x32x16_bf16 v[224:239], v[164:167], v[68:71], v[224:239]
    v_mfma_f32_32x32x16_bf16 v[208:223], v[168:171], v[24:27], v[208:223]
    v_mfma_f32_32x32x16_bf16 v[224:239], v[168:171], v[72:75], v[224:239]
    v_mfma_f32_32x32x16_bf16 v[208:223], v[172:175], v[28:31], v[208:223]
    v_mfma_f32_32x32x16_bf16 v[224:239], v[172:175], v[76:79], v[224:239]
    v_mfma_f32_32x32x16_bf16 v[208:223], v[176:179], v[32:35], v[208:223]
    v_mfma_f32_32x32x16_bf16 v[224:239], v[176:179], v[80:83], v[224:239]
    v_mfma_f32_32x32x16_bf16 v[208:223], v[180:183], v[36:39], v[208:223]
    v_mfma_f32_32x32x16_bf16 v[224:239], v[180:183], v[84:87], v[224:239]
    v_mfma_f32_32x32x16_bf16 v[208:223], v[184:187], v[40:43], v[208:223]
    v_mfma_f32_32x32x16_bf16 v[224:239], v[184:187], v[88:91], v[224:239]
    v_mfma_f32_32x32x16_bf16 v[208:223], v[188:191], v[44:47], v[208:223]
    v_mfma_f32_32x32x16_bf16 v[224:239], v[188:191], v[92:95], v[224:239]
    v_mfma_f32_32x32x16_bf16 v[208:223], v[192:195], v[48:51], v[208:223]
    v_mfma_f32_32x32x16_bf16 v[224:239], v[192:195], v[96:99], v[224:239]
    v_mfma_f32_32x32x16_bf16 v[208:223], v[196:199], v[52:55], v[208:223]
    v_mfma_f32_32x32x16_bf16 v[224:239], v[196:199], v[100:103], v[224:239]
    v_mfma_f32_32x32x16_bf16 v[208:223], v[200:203], v[56:59], v[208:223]
    v_mfma_f32_32x32x16_bf16 v[224:239], v[200:203], v[104:107], v[224:239]
    v_mfma_f32_32x32x16_bf16 v[208:223], v[204:207], v[60:63], v[208:223]
    v_mfma_f32_32x32x16_bf16 v[224:239], v[204:207], v[108:111], v[224:239]
    s_nop 7
    s_nop 7
    v_cvt_pk_bf16_f32 v240, v208, v209
    v_cvt_pk_bf16_f32 v241, v210, v211
    v_cvt_pk_bf16_f32 v242, v212, v213
    v_cvt_pk_bf16_f32 v243, v214, v215
    s_nop 1
    v_permlane32_swap_b32 v240, v242
    v_permlane32_swap_b32 v241, v243
    buffer_store_dwordx4 v[240:243], v10, s[8:11], s30 offen offset:0
    v_cvt_pk_bf16_f32 v244, v216, v217
    v_cvt_pk_bf16_f32 v245, v218, v219
    v_cvt_pk_bf16_f32 v246, v220, v221
    v_cvt_pk_bf16_f32 v247, v222, v223
    s_nop 1
    v_permlane32_swap_b32 v244, v246
    v_permlane32_swap_b32 v245, v247
    buffer_store_dwordx4 v[244:247], v10, s[8:11], s30 offen offset:512
    s_nop 1
    v_cvt_pk_bf16_f32 v240, v224, v225
    v_cvt_pk_bf16_f32 v241, v226, v227
    v_cvt_pk_bf16_f32 v242, v228, v229
    v_cvt_pk_bf16_f32 v243, v230, v231
    s_nop 1
    v_permlane32_swap_b32 v240, v242
    v_permlane32_swap_b32 v241, v243
    buffer_store_dwordx4 v[240:243], v10, s[8:11], s30 offen offset:16
    v_cvt_pk_bf16_f32 v244, v232, v233
    v_cvt_pk_bf16_f32 v245, v234, v235
    v_cvt_pk_bf16_f32 v246, v236, v237
    v_cvt_pk_bf16_f32 v247, v238, v239
    s_nop 1
    v_permlane32_swap_b32 v244, v246
    v_permlane32_swap_b32 v245, v247
    buffer_store_dwordx4 v[244:247], v10, s[8:11], s30 offen offset:528
    s_nop 1
    s_add_u32 s30, s30, 1024
    s_sub_u32 s31, s31, 1
    s_branch prep_kernel_wvo_loop
prep_kernel_wvo_last:
    s_waitcnt vmcnt(0)
    v_mfma_f32_32x32x16_bf16 v[208:223], v[160:163], v[16:19], 0
    v_mfma_f32_32x32x16_bf16 v[224:239], v[160:163], v[64:67], 0
    v_mfma_f32_32x32x16_bf16 v[208:223], v[164:167], v[20:23], v[208:223]
    v_mfma_f32_32x32x16_bf16 v[224:239], v[164:167], v[68:71], v[224:239]
    v_mfma_f32_32x32x16_bf16 v[208:223], v[168:171], v[24:27], v[208:223]
    v_mfma_f32_32x32x16_bf16 v[224:239], v[168:171], v[72:75], v[224:239]
    v_mfma_f32_32x32x16_bf16 v[208:223], v[172:175], v[28:31], v[208:223]
    v_mfma_f32_32x32x16_bf16 v[224:239], v[172:175], v[76:79], v[224:239]
    v_mfma_f32_32x32x16_bf16 v[208:223], v[176:179], v[32:35], v[208:223]
    v_mfma_f32_32x32x16_bf16 v[224:239], v[176:179], v[80:83], v[224:239]
    v_mfma_f32_32x32x16_bf16 v[208:223], v[180:183], v[36:39], v[208:223]
    v_mfma_f32_32x32x16_bf16 v[224:239], v[180:183], v[84:87], v[224:239]
    v_mfma_f32_32x32x16_bf16 v[208:223], v[184:187], v[40:43], v[208:223]
    v_mfma_f32_32x32x16_bf16 v[224:239], v[184:187], v[88:91], v[224:239]
    v_mfma_f32_32x32x16_bf16 v[208:223], v[188:191], v[44:47], v[208:223]
    v_mfma_f32_32x32x16_bf16 v[224:239], v[188:191], v[92:95], v[224:239]
    v_mfma_f32_32x32x16_bf16 v[208:223], v[192:195], v[48:51], v[208:223]
    v_mfma_f32_32x32x16_bf16 v[224:239], v[192:195], v[96:99], v[224:239]
    v_mfma_f32_32x32x16_bf16 v[208:223], v[196:199], v[52:55], v[208:223]
    v_mfma_f32_32x32x16_bf16 v[224:239], v[196:199], v[100:103], v[224:239]
    v_mfma_f32_32x32x16_bf16 v[208:223], v[200:203], v[56:59], v[208:223]
    v_mfma_f32_32x32x16_bf16 v[224:239], v[200:203], v[104:107], v[224:239]
    v_mfma_f32_32x32x16_bf16 v[208:223], v[204:207], v[60:63], v[208:223]
    v_mfma_f32_32x32x16_bf16 v[224:239], v[204:207], v[108:111], v[224:239]
    s_nop 7
    s_nop 7
    v_cvt_pk_bf16_f32 v240, v208, v209
    v_cvt_pk_bf16_f32 v241, v210, v211
    v_cvt_pk_bf16_f32 v242, v212, v213
    v_cvt_pk_bf16_f32 v243, v214, v215
    s_nop 1
    v_permlane32_swap_b32 v240, v242
    v_permlane32_swap_b32 v241, v243
    buffer_store_dwordx4 v[240:243], v10, s[8:11], s30 offen offset:0
    v_cvt_pk_bf16_f32 v244, v216, v217
    v_cvt_pk_bf16_f32 v245, v218, v219
    v_cvt_pk_bf16_f32 v246, v220, v221
    v_cvt_pk_bf16_f32 v247, v222, v223
    s_nop 1
    v_permlane32_swap_b32 v244, v246
    v_permlane32_swap_b32 v245, v247
    buffer_store_dwordx4 v[244:247], v10, s[8:11], s30 offen offset:512
    s_nop 1
    v_cvt_pk_bf16_f32 v240, v224, v225
    v_cvt_pk_bf16_f32 v241, v226, v227
    v_cvt_pk_bf16_f32 v242, v228, v229
    v_cvt_pk_bf16_f32 v243, v230, v231
    s_nop 1
    v_permlane32_swap_b32 v240, v242
    v_permlane32_swap_b32 v241, v243
    buffer_store_dwordx4 v[240:243], v10, s[8:11], s30 offen offset:16
    v_cvt_pk_bf16_f32 v244, v232, v233
    v_cvt_pk_bf16_f32 v245, v234, v235
    v_cvt_pk_bf16_f32 v246, v236, v237
    v_cvt_pk_bf16_f32 v247, v238, v239
    s_nop 1
    v_permlane32_swap_b32 v244, v246
    v_permlane32_swap_b32 v245, v247
    buffer_store_dwordx4 v[244:247], v10, s[8:11], s30 offen offset:528
    s_nop 1
    s_add_u32 s30, s30, 1024
    s_branch prep_kernel_end
prep_kernel_r_pwp:
    s_lshl_b32 s20, s20, 2
    s_add_u32 s20, s20, s13
    s_mul_i32 s21, s20, 13108
    s_lshr_b32 s21, s21, 16
    s_mul_i32 s22, s21, 5
    s_sub_u32 s22, s20, s22
    s_mul_i32 s23, s21, 21846
    s_lshr_b32 s23, s23, 16
    s_mul_i32 s28, s23, 3
    s_sub_u32 s21, s21, s28
    s_lshr_b32 s29, s23, 5
    s_and_b32 s23, s23, 31
    s_cmp_eq_u32 s29, 0
    s_cbranch_scc0 prep_kernel_pwp_k
    s_load_dwordx2 s[24:25], s[0:1], 40
    s_branch prep_kernel_pwp_go
prep_kernel_pwp_k:
    s_load_dwordx2 s[24:25], s[0:1], 48
prep_kernel_pwp_go:
    v_and_b32 v1, 31, v0
    v_lshrrev_b32 v2, 5, v0
    s_lshl_b32 s28, s21, 6
    v_lshlrev_b32 v3, 1, v1
    v_add_u32 v3, s28, v3
    v_and_b32 v4, 0xc1, v3
    v_and_b32 v5, 8, v3
    v_lshl_or_b32 v4, v5, 2, v4
    v_and_b32 v5, 32, v3
    v_lshrrev_b32 v5, 1, v5
    v_or_b32 v4, v4, v5
    v_and_b32 v5, 2, v3
    v_lshl_or_b32 v4, v5, 2, v4
    v_and_b32 v5, 16, v3
    v_lshrrev_b32 v5, 2, v5
    v_or_b32 v4, v4, v5
    v_and_b32 v5, 4, v3
    v_lshrrev_b32 v5, 1, v5
    v_or_b32 v4, v4, v5
    s_cmp_eq_u32 s29, 0
    s_cselect_b64 vcc, -1, 0
    s_nop 1
    v_cndmask_b32 v4, v4, v3, vcc
    v_lshrrev_b32 v5, 4, v3
    v_mul_u32_u24 v6, 11, v5
    v_lshrrev_b32 v6, 5, v6
    v_mul_u32_u24 v6, 3, v6
    v_add_u32 v5, v5, v6
    v_mul_u32_u24 v5, 20480, v5
    v_and_b32 v6, 15, v3
    v_lshl_add_u32 v7, v6, 4, v5
    s_mul_i32 s30, s29, 61440
    s_mul_i32 s31, s23, 491520
    s_add_u32 s30, s30, s31
    s_add_u32 s30, s30, 11534336
    s_lshl_b32 s31, s22, 4
    v_add_u32 v8, s31, v2
    s_waitcnt lgkmcnt(0)
    s_mov_b32 s32, s24
    s_mov_b32 s33, s25
    s_mov_b32 s34, 7864320
    s_mov_b32 s35, 0x00020000
    s_mul_i32 s28, s23, 384
    v_add_u32 v9, 0, v8
    v_lshrrev_b32 v10, 2, v9
    v_lshlrev_b32 v10, 5, v10
    v_and_b32 v11, 2, v9
    v_lshl_add_u32 v10, v11, 3, v10
    v_and_b32 v11, 1, v9
    v_lshl_add_u32 v10, v11, 2, v10
    v_mul_u32_u24 v10, 12288, v10
    v_lshl_add_u32 v10, v4, 1, v10
    s_add_u32 s31, s28, 0
    buffer_load_dword v16, v10, s[32:35], s31 offen
    s_add_u32 s31, s28, 12288
    buffer_load_dword v17, v10, s[32:35], s31 offen
    s_add_u32 s31, s28, 98304
    buffer_load_dword v18, v10, s[32:35], s31 offen
    s_add_u32 s31, s28, 110592
    buffer_load_dword v19, v10, s[32:35], s31 offen
    s_add_u32 s31, s28, 24576
    buffer_load_dword v20, v10, s[32:35], s31 offen
    s_add_u32 s31, s28, 36864
    buffer_load_dword v21, v10, s[32:35], s31 offen
    s_add_u32 s31, s28, 122880
    buffer_load_dword v22, v10, s[32:35], s31 offen
    s_add_u32 s31, s28, 135168
    buffer_load_dword v23, v10, s[32:35], s31 offen
    v_add_u32 v9, 2, v8
    v_lshrrev_b32 v10, 2, v9
    v_lshlrev_b32 v10, 5, v10
    v_and_b32 v11, 2, v9
    v_lshl_add_u32 v10, v11, 3, v10
    v_and_b32 v11, 1, v9
    v_lshl_add_u32 v10, v11, 2, v10
    v_mul_u32_u24 v10, 12288, v10
    v_lshl_add_u32 v10, v4, 1, v10
    s_add_u32 s31, s28, 0
    buffer_load_dword v24, v10, s[32:35], s31 offen
    s_add_u32 s31, s28, 12288
    buffer_load_dword v25, v10, s[32:35], s31 offen
    s_add_u32 s31, s28, 98304
    buffer_load_dword v26, v10, s[32:35], s31 offen
    s_add_u32 s31, s28, 110592
    buffer_load_dword v27, v10, s[32:35], s31 offen
    s_add_u32 s31, s28, 24576
    buffer_load_dword v28, v10, s[32:35], s31 offen
    s_add_u32 s31, s28, 36864
    buffer_load_dword v29, v10, s[32:35], s31 offen
    s_add_u32 s31, s28, 122880
    buffer_load_dword v30, v10, s[32:35], s31 offen
    s_add_u32 s31, s28, 135168
    buffer_load_dword v31, v10, s[32:35], s31 offen
    v_add_u32 v9, 4, v8
    v_lshrrev_b32 v10, 2, v9
    v_lshlrev_b32 v10, 5, v10
    v_and_b32 v11, 2, v9
    v_lshl_add_u32 v10, v11, 3, v10
    v_and_b32 v11, 1, v9
    v_lshl_add_u32 v10, v11, 2, v10
    v_mul_u32_u24 v10, 12288, v10
    v_lshl_add_u32 v10, v4, 1, v10
    s_add_u32 s31, s28, 0
    buffer_load_dword v32, v10, s[32:35], s31 offen
    s_add_u32 s31, s28, 12288
    buffer_load_dword v33, v10, s[32:35], s31 offen
    s_add_u32 s31, s28, 98304
    buffer_load_dword v34, v10, s[32:35], s31 offen
    s_add_u32 s31, s28, 110592
    buffer_load_dword v35, v10, s[32:35], s31 offen
    s_add_u32 s31, s28, 24576
    buffer_load_dword v36, v10, s[32:35], s31 offen
    s_add_u32 s31, s28, 36864
    buffer_load_dword v37, v10, s[32:35], s31 offen
    s_add_u32 s31, s28, 122880
    buffer_load_dword v38, v10, s[32:35], s31 offen
    s_add_u32 s31, s28, 135168
    buffer_load_dword v39, v10, s[32:35], s31 offen
    v_add_u32 v9, 6, v8
    v_lshrrev_b32 v10, 2, v9
    v_lshlrev_b32 v10, 5, v10
    v_and_b32 v11, 2, v9
    v_lshl_add_u32 v10, v11, 3, v10
    v_and_b32 v11, 1, v9
    v_lshl_add_u32 v10, v11, 2, v10
    v_mul_u32_u24 v10, 12288, v10
    v_lshl_add_u32 v10, v4, 1, v10
    s_add_u32 s31, s28, 0
    buffer_load_dword v40, v10, s[32:35], s31 offen
    s_add_u32 s31, s28, 12288
    buffer_load_dword v41, v10, s[32:35], s31 offen
    s_add_u32 s31, s28, 98304
    buffer_load_dword v42, v10, s[32:35], s31 offen
    s_add_u32 s31, s28, 110592
    buffer_load_dword v43, v10, s[32:35], s31 offen
    s_add_u32 s31, s28, 24576
    buffer_load_dword v44, v10, s[32:35], s31 offen
    s_add_u32 s31, s28, 36864
    buffer_load_dword v45, v10, s[32:35], s31 offen
    s_add_u32 s31, s28, 122880
    buffer_load_dword v46, v10, s[32:35], s31 offen
    s_add_u32 s31, s28, 135168
    buffer_load_dword v47, v10, s[32:35], s31 offen
    v_add_u32 v9, 8, v8
    v_lshrrev_b32 v10, 2, v9
    v_lshlrev_b32 v10, 5, v10
    v_and_b32 v11, 2, v9
    v_lshl_add_u32 v10, v11, 3, v10
    v_and_b32 v11, 1, v9
    v_lshl_add_u32 v10, v11, 2, v10
    v_mul_u32_u24 v10, 12288, v10
    v_lshl_add_u32 v10, v4, 1, v10
    s_add_u32 s31, s28, 0
    buffer_load_dword v48, v10, s[32:35], s31 offen
    s_add_u32 s31, s28, 12288
    buffer_load_dword v49, v10, s[32:35], s31 offen
    s_add_u32 s31, s28, 98304
    buffer_load_dword v50, v10, s[32:35], s31 offen
    s_add_u32 s31, s28, 110592
    buffer_load_dword v51, v10, s[32:35], s31 offen
    s_add_u32 s31, s28, 24576
    buffer_load_dword v52, v10, s[32:35], s31 offen
    s_add_u32 s31, s28, 36864
    buffer_load_dword v53, v10, s[32:35], s31 offen
    s_add_u32 s31, s28, 122880
    buffer_load_dword v54, v10, s[32:35], s31 offen
    s_add_u32 s31, s28, 135168
    buffer_load_dword v55, v10, s[32:35], s31 offen
    v_add_u32 v9, 10, v8
    v_lshrrev_b32 v10, 2, v9
    v_lshlrev_b32 v10, 5, v10
    v_and_b32 v11, 2, v9
    v_lshl_add_u32 v10, v11, 3, v10
    v_and_b32 v11, 1, v9
    v_lshl_add_u32 v10, v11, 2, v10
    v_mul_u32_u24 v10, 12288, v10
    v_lshl_add_u32 v10, v4, 1, v10
    s_add_u32 s31, s28, 0
    buffer_load_dword v56, v10, s[32:35], s31 offen
    s_add_u32 s31, s28, 12288
    buffer_load_dword v57, v10, s[32:35], s31 offen
    s_add_u32 s31, s28, 98304
    buffer_load_dword v58, v10, s[32:35], s31 offen
    s_add_u32 s31, s28, 110592
    buffer_load_dword v59, v10, s[32:35], s31 offen
    s_add_u32 s31, s28, 24576
    buffer_load_dword v60, v10, s[32:35], s31 offen
    s_add_u32 s31, s28, 36864
    buffer_load_dword v61, v10, s[32:35], s31 offen
    s_add_u32 s31, s28, 122880
    buffer_load_dword v62, v10, s[32:35], s31 offen
    s_add_u32 s31, s28, 135168
    buffer_load_dword v63, v10, s[32:35], s31 offen
    v_add_u32 v9, 12, v8
    v_lshrrev_b32 v10, 2, v9
    v_lshlrev_b32 v10, 5, v10
    v_and_b32 v11, 2, v9
    v_lshl_add_u32 v10, v11, 3, v10
    v_and_b32 v11, 1, v9
    v_lshl_add_u32 v10, v11, 2, v10
    v_mul_u32_u24 v10, 12288, v10
    v_lshl_add_u32 v10, v4, 1, v10
    s_add_u32 s31, s28, 0
    buffer_load_dword v64, v10, s[32:35], s31 offen
    s_add_u32 s31, s28, 12288
    buffer_load_dword v65, v10, s[32:35], s31 offen
    s_add_u32 s31, s28, 98304
    buffer_load_dword v66, v10, s[32:35], s31 offen
    s_add_u32 s31, s28, 110592
    buffer_load_dword v67, v10, s[32:35], s31 offen
    s_add_u32 s31, s28, 24576
    buffer_load_dword v68, v10, s[32:35], s31 offen
    s_add_u32 s31, s28, 36864
    buffer_load_dword v69, v10, s[32:35], s31 offen
    s_add_u32 s31, s28, 122880
    buffer_load_dword v70, v10, s[32:35], s31 offen
    s_add_u32 s31, s28, 135168
    buffer_load_dword v71, v10, s[32:35], s31 offen
    v_add_u32 v9, 14, v8
    v_lshrrev_b32 v10, 2, v9
    v_lshlrev_b32 v10, 5, v10
    v_and_b32 v11, 2, v9
    v_lshl_add_u32 v10, v11, 3, v10
    v_and_b32 v11, 1, v9
    v_lshl_add_u32 v10, v11, 2, v10
    v_mul_u32_u24 v10, 12288, v10
    v_lshl_add_u32 v10, v4, 1, v10
    s_add_u32 s31, s28, 0
    buffer_load_dword v72, v10, s[32:35], s31 offen
    s_add_u32 s31, s28, 12288
    buffer_load_dword v73, v10, s[32:35], s31 offen
    s_add_u32 s31, s28, 98304
    buffer_load_dword v74, v10, s[32:35], s31 offen
    s_add_u32 s31, s28, 110592
    buffer_load_dword v75, v10, s[32:35], s31 offen
    s_add_u32 s31, s28, 24576
    buffer_load_dword v76, v10, s[32:35], s31 offen
    s_add_u32 s31, s28, 36864
    buffer_load_dword v77, v10, s[32:35], s31 offen
    s_add_u32 s31, s28, 122880
    buffer_load_dword v78, v10, s[32:35], s31 offen
    s_add_u32 s31, s28, 135168
    buffer_load_dword v79, v10, s[32:35], s31 offen
    v_lshl_add_u32 v7, v8, 8, v7
    v_mov_b32 v4, 0x05040100
    v_mov_b32 v5, 0x07060302
    s_waitcnt vmcnt(56)
    v_perm_b32 v80, v17, v16, v4
    v_perm_b32 v84, v17, v16, v5
    v_perm_b32 v81, v19, v18, v4
    v_perm_b32 v85, v19, v18, v5
    v_perm_b32 v82, v21, v20, v4
    v_perm_b32 v86, v21, v20, v5
    v_perm_b32 v83, v23, v22, v4
    v_perm_b32 v87, v23, v22, v5
    buffer_store_dwordx4 v[80:83], v7, s[8:11], s30 offen offset:0
    buffer_store_dwordx4 v[84:87], v7, s[8:11], s30 offen offset:16
    s_waitcnt vmcnt(48)
    v_perm_b32 v88, v25, v24, v4
    v_perm_b32 v92, v25, v24, v5
    v_perm_b32 v89, v27, v26, v4
    v_perm_b32 v93, v27, v26, v5
    v_perm_b32 v90, v29, v28, v4
    v_perm_b32 v94, v29, v28, v5
    v_perm_b32 v91, v31, v30, v4
    v_perm_b32 v95, v31, v30, v5
    buffer_store_dwordx4 v[88:91], v7, s[8:11], s30 offen offset:512
    buffer_store_dwordx4 v[92:95], v7, s[8:11], s30 offen offset:528
    s_nop 0
    s_waitcnt vmcnt(40)
    v_perm_b32 v80, v33, v32, v4
    v_perm_b32 v84, v33, v32, v5
    v_perm_b32 v81, v35, v34, v4
    v_perm_b32 v85, v35, v34, v5
    v_perm_b32 v82, v37, v36, v4
    v_perm_b32 v86, v37, v36, v5
    v_perm_b32 v83, v39, v38, v4
    v_perm_b32 v87, v39, v38, v5
    buffer_store_dwordx4 v[80:83], v7, s[8:11], s30 offen offset:1024
    buffer_store_dwordx4 v[84:87], v7, s[8:11], s30 offen offset:1040
    s_nop 0
    s_waitcnt vmcnt(32)
    v_perm_b32 v88, v41, v40, v4
    v_perm_b32 v92, v41, v40, v5
    v_perm_b32 v89, v43, v42, v4
    v_perm_b32 v93, v43, v42, v5
    v_perm_b32 v90, v45, v44, v4
    v_perm_b32 v94, v45, v44, v5
    v_perm_b32 v91, v47, v46, v4
    v_perm_b32 v95, v47, v46, v5
    buffer_store_dwordx4 v[88:91], v7, s[8:11], s30 offen offset:1536
    buffer_store_dwordx4 v[92:95], v7, s[8:11], s30 offen offset:1552
    s_nop 0
    s_waitcnt vmcnt(24)
    v_perm_b32 v80, v49, v48, v4
    v_perm_b32 v84, v49, v48, v5
    v_perm_b32 v81, v51, v50, v4
    v_perm_b32 v85, v51, v50, v5
    v_perm_b32 v82, v53, v52, v4
    v_perm_b32 v86, v53, v52, v5
    v_perm_b32 v83, v55, v54, v4
    v_perm_b32 v87, v55, v54, v5
    buffer_store_dwordx4 v[80:83], v7, s[8:11], s30 offen offset:2048
    buffer_store_dwordx4 v[84:87], v7, s[8:11], s30 offen offset:2064
    s_nop 0
    s_waitcnt vmcnt(16)
    v_perm_b32 v88, v57, v56, v4
    v_perm_b32 v92, v57, v56, v5
    v_perm_b32 v89, v59, v58, v4
    v_perm_b32 v93, v59, v58, v5
    v_perm_b32 v90, v61, v60, v4
    v_perm_b32 v94, v61, v60, v5
    v_perm_b32 v91, v63, v62, v4
    v_perm_b32 v95, v63, v62, v5
    buffer_store_dwordx4 v[88:91], v7, s[8:11], s30 offen offset:2560
    buffer_store_dwordx4 v[92:95], v7, s[8:11], s30 offen offset:2576
    s_nop 0
    s_waitcnt vmcnt(8)
    v_perm_b32 v80, v65, v64, v4
    v_perm_b32 v84, v65, v64, v5
    v_perm_b32 v81, v67, v66, v4
    v_perm_b32 v85, v67, v66, v5
    v_perm_b32 v82, v69, v68, v4
    v_perm_b32 v86, v69, v68, v5
    v_perm_b32 v83, v71, v70, v4
    v_perm_b32 v87, v71, v70, v5
    buffer_store_dwordx4 v[80:83], v7, s[8:11], s30 offen offset:3072
    buffer_store_dwordx4 v[84:87], v7, s[8:11], s30 offen offset:3088
    s_nop 0
    s_waitcnt vmcnt(0)
    v_perm_b32 v88, v73, v72, v4
    v_perm_b32 v92, v73, v72, v5
    v_perm_b32 v89, v75, v74, v4
    v_perm_b32 v93, v75, v74, v5
    v_perm_b32 v90, v77, v76, v4
    v_perm_b32 v94, v77, v76, v5
    v_perm_b32 v91, v79, v78, v4
    v_perm_b32 v95, v79, v78, v5
    buffer_store_dwordx4 v[88:91], v7, s[8:11], s30 offen offset:3584
    buffer_store_dwordx4 v[92:95], v7, s[8:11], s30 offen offset:3600
    s_nop 0
    s_branch prep_kernel_end
prep_kernel_r_pwa:
    s_load_dwordx2 s[24:25], s[0:1], 8
    s_lshr_b32 s21, s20, 1
    s_and_b32 s22, s20, 1
    v_and_b32 v1, 31, v0
    v_lshrrev_b32 v2, 5, v0
    s_mul_i32 s23, s21, 20
    v_add_u32 v3, 640, v1
    v_add_u32 v4, 1260, v1
    v_cmp_gt_u32 vcc, 20, v1
    s_nop 1
    v_cndmask_b32 v3, v4, v3, vcc
    v_add_u32 v4, 1292, v1
    v_subrev_u32 v5, 12, v1
    v_cmp_gt_u32 vcc, 8, v1
    s_nop 1
    v_cndmask_b32 v4, v5, v4, vcc
    s_cmp_eq_u32 s22, 0
    s_cselect_b64 vcc, -1, 0
    s_nop 1
    v_cndmask_b32 v3, v4, v3, vcc
    v_add_u32 v3, s23, v3
    v_lshlrev_b32 v3, 1, v3
    v_mul_u32_u24 v4, 30720, v2
    v_add_u32 v3, v3, v4
    s_mov_b32 s26, 0xfffff0ff
    s_cmp_eq_u32 s22, 0
    s_cselect_b32 s26, -1, s26
    s_mov_b32 s27, s26
    v_mov_b32 v16, 0
    v_mov_b32 v17, 0
    v_mov_b32 v18, 0
    v_mov_b32 v19, 0
    v_mov_b32 v20, 0
    v_mov_b32 v21, 0
    v_mov_b32 v22, 0
    v_mov_b32 v23, 0
    v_mov_b32 v24, 0
    v_mov_b32 v25, 0
    v_mov_b32 v26, 0
    v_mov_b32 v27, 0
    v_mov_b32 v28, 0
    v_mov_b32 v29, 0
    v_mov_b32 v30, 0
    v_mov_b32 v31, 0
    v_mov_b32 v32, 0
    v_mov_b32 v33, 0
    v_mov_b32 v34, 0
    v_mov_b32 v35, 0
    v_mov_b32 v36, 0
    v_mov_b32 v37, 0
    v_mov_b32 v38, 0
    v_mov_b32 v39, 0
    v_mov_b32 v40, 0
    v_mov_b32 v41, 0
    v_mov_b32 v42, 0
    v_mov_b32 v43, 0
    v_mov_b32 v44, 0
    v_mov_b32 v45, 0
    v_mov_b32 v46, 0
    v_mov_b32 v47, 0
    v_mov_b32 v48, 0
    v_mov_b32 v49, 0
    v_mov_b32 v50, 0
    v_mov_b32 v51, 0
    v_mov_b32 v52, 0
    v_mov_b32 v53, 0
    v_mov_b32 v54, 0
    v_mov_b32 v55, 0
    v_mov_b32 v56, 0
    v_mov_b32 v57, 0
    v_mov_b32 v58, 0
    v_mov_b32 v59, 0
    v_mov_b32 v60, 0
    v_mov_b32 v61, 0
    v_mov_b32 v62, 0
    v_mov_b32 v63, 0
    v_mov_b32 v64, 0
    v_mov_b32 v65, 0
    v_mov_b32 v66, 0
    v_mov_b32 v67, 0
    v_mov_b32 v68, 0
    v_mov_b32 v69, 0
    v_mov_b32 v70, 0
    v_mov_b32 v71, 0
    v_mov_b32 v72, 0
    v_mov_b32 v73, 0
    v_mov_b32 v74, 0
    v_mov_b32 v75, 0
    v_mov_b32 v76, 0
    v_mov_b32 v77, 0
    v_mov_b32 v78, 0
    v_mov_b32 v79, 0
    v_mov_b32 v80, 0
    v_mov_b32 v81, 0
    v_mov_b32 v82, 0
    v_mov_b32 v83, 0
    v_mov_b32 v84, 0
    v_mov_b32 v85, 0
    v_mov_b32 v86, 0
    v_mov_b32 v87, 0
    v_mov_b32 v88, 0
    v_mov_b32 v89, 0
    v_mov_b32 v90, 0
    v_mov_b32 v91, 0
    v_mov_b32 v92, 0
    v_mov_b32 v93, 0
    v_mov_b32 v94, 0
    v_mov_b32 v95, 0
    s_waitcnt lgkmcnt(0)
    s_mov_b32 s32, s24
    s_mov_b32 s33, s25
    s_mov_b32 s34, 2457600
    s_mov_b32 s35, 0x00020000
    s_mul_i32 s28, s13, 614400
    s_mov_b64 exec, s[26:27]
    s_add_u32 s29, s28, 0
    buffer_load_short_d16_hi v16, v3, s[32:35], s29 offen
    s_add_u32 s29, s28, 3840
    buffer_load_short_d16_hi v17, v3, s[32:35], s29 offen
    s_add_u32 s29, s28, 7680
    buffer_load_short_d16_hi v18, v3, s[32:35], s29 offen
    s_add_u32 s29, s28, 11520
    buffer_load_short_d16_hi v19, v3, s[32:35], s29 offen
    s_add_u32 s29, s28, 15360
    buffer_load_short_d16_hi v20, v3, s[32:35], s29 offen
    s_add_u32 s29, s28, 19200
    buffer_load_short_d16_hi v21, v3, s[32:35], s29 offen
    s_add_u32 s29, s28, 23040
    buffer_load_short_d16_hi v22, v3, s[32:35], s29 offen
    s_add_u32 s29, s28, 26880
    buffer_load_short_d16_hi v23, v3, s[32:35], s29 offen
    s_add_u32 s29, s28, 61440
    buffer_load_short_d16_hi v24, v3, s[32:35], s29 offen
    s_add_u32 s29, s28, 65280
    buffer_load_short_d16_hi v25, v3, s[32:35], s29 offen
    s_add_u32 s29, s28, 69120
    buffer_load_short_d16_hi v26, v3, s[32:35], s29 offen
    s_add_u32 s29, s28, 72960
    buffer_load_short_d16_hi v27, v3, s[32:35], s29 offen
    s_add_u32 s29, s28, 76800
    buffer_load_short_d16_hi v28, v3, s[32:35], s29 offen
    s_add_u32 s29, s28, 80640
    buffer_load_short_d16_hi v29, v3, s[32:35], s29 offen
    s_add_u32 s29, s28, 84480
    buffer_load_short_d16_hi v30, v3, s[32:35], s29 offen
    s_add_u32 s29, s28, 88320
    buffer_load_short_d16_hi v31, v3, s[32:35], s29 offen
    s_add_u32 s29, s28, 122880
    buffer_load_short_d16_hi v32, v3, s[32:35], s29 offen
    s_add_u32 s29, s28, 126720
    buffer_load_short_d16_hi v33, v3, s[32:35], s29 offen
    s_add_u32 s29, s28, 130560
    buffer_load_short_d16_hi v34, v3, s[32:35], s29 offen
    s_add_u32 s29, s28, 134400
    buffer_load_short_d16_hi v35, v3, s[32:35], s29 offen
    s_add_u32 s29, s28, 138240
    buffer_load_short_d16_hi v36, v3, s[32:35], s29 offen
    s_add_u32 s29, s28, 142080
    buffer_load_short_d16_hi v37, v3, s[32:35], s29 offen
    s_add_u32 s29, s28, 145920
    buffer_load_short_d16_hi v38, v3, s[32:35], s29 offen
    s_add_u32 s29, s28, 149760
    buffer_load_short_d16_hi v39, v3, s[32:35], s29 offen
    s_add_u32 s29, s28, 184320
    buffer_load_short_d16_hi v40, v3, s[32:35], s29 offen
    s_add_u32 s29, s28, 188160
    buffer_load_short_d16_hi v41, v3, s[32:35], s29 offen
    s_add_u32 s29, s28, 192000
    buffer_load_short_d16_hi v42, v3, s[32:35], s29 offen
    s_add_u32 s29, s28, 195840
    buffer_load_short_d16_hi v43, v3, s[32:35], s29 offen
    s_add_u32 s29, s28, 199680
    buffer_load_short_d16_hi v44, v3, s[32:35], s29 offen
    s_add_u32 s29, s28, 203520
    buffer_load_short_d16_hi v45, v3, s[32:35], s29 offen
    s_add_u32 s29, s28, 207360
    buffer_load_short_d16_hi v46, v3, s[32:35], s29 offen
    s_add_u32 s29, s28, 211200
    buffer_load_short_d16_hi v47, v3, s[32:35], s29 offen
    s_add_u32 s29, s28, 245760
    buffer_load_short_d16_hi v48, v3, s[32:35], s29 offen
    s_add_u32 s29, s28, 249600
    buffer_load_short_d16_hi v49, v3, s[32:35], s29 offen
    s_add_u32 s29, s28, 253440
    buffer_load_short_d16_hi v50, v3, s[32:35], s29 offen
    s_add_u32 s29, s28, 257280
    buffer_load_short_d16_hi v51, v3, s[32:35], s29 offen
    s_add_u32 s29, s28, 261120
    buffer_load_short_d16_hi v52, v3, s[32:35], s29 offen
    s_add_u32 s29, s28, 264960
    buffer_load_short_d16_hi v53, v3, s[32:35], s29 offen
    s_add_u32 s29, s28, 268800
    buffer_load_short_d16_hi v54, v3, s[32:35], s29 offen
    s_add_u32 s29, s28, 272640
    buffer_load_short_d16_hi v55, v3, s[32:35], s29 offen
    s_add_u32 s29, s28, 307200
    buffer_load_short_d16_hi v56, v3, s[32:35], s29 offen
    s_add_u32 s29, s28, 311040
    buffer_load_short_d16_hi v57, v3, s[32:35], s29 offen
    s_add_u32 s29, s28, 314880
    buffer_load_short_d16_hi v58, v3, s[32:35], s29 offen
    s_add_u32 s29, s28, 318720
    buffer_load_short_d16_hi v59, v3, s[32:35], s29 offen
    s_add_u32 s29, s28, 322560
    buffer_load_short_d16_hi v60, v3, s[32:35], s29 offen
    s_add_u32 s29, s28, 326400
    buffer_load_short_d16_hi v61, v3, s[32:35], s29 offen
    s_add_u32 s29, s28, 330240
    buffer_load_short_d16_hi v62, v3, s[32:35], s29 offen
    s_add_u32 s29, s28, 334080
    buffer_load_short_d16_hi v63, v3, s[32:35], s29 offen
    s_add_u32 s29, s28, 368640
    buffer_load_short_d16_hi v64, v3, s[32:35], s29 offen
    s_add_u32 s29, s28, 372480
    buffer_load_short_d16_hi v65, v3, s[32:35], s29 offen
    s_add_u32 s29, s28, 376320
    buffer_load_short_d16_hi v66, v3, s[32:35], s29 offen
    s_add_u32 s29, s28, 380160
    buffer_load_short_d16_hi v67, v3, s[32:35], s29 offen
    s_add_u32 s29, s28, 384000
    buffer_load_short_d16_hi v68, v3, s[32:35], s29 offen
    s_add_u32 s29, s28, 387840
    buffer_load_short_d16_hi v69, v3, s[32:35], s29 offen
    s_add_u32 s29, s28, 391680
    buffer_load_short_d16_hi v70, v3, s[32:35], s29 offen
    s_add_u32 s29, s28, 395520
    buffer_load_short_d16_hi v71, v3, s[32:35], s29 offen
    s_add_u32 s29, s28, 430080
    buffer_load_short_d16_hi v72, v3, s[32:35], s29 offen
    s_add_u32 s29, s28, 433920
    buffer_load_short_d16_hi v73, v3, s[32:35], s29 offen
    s_add_u32 s29, s28, 437760
    buffer_load_short_d16_hi v74, v3, s[32:35], s29 offen
    s_add_u32 s29, s28, 441600
    buffer_load_short_d16_hi v75, v3, s[32:35], s29 offen
    s_add_u32 s29, s28, 445440
    buffer_load_short_d16_hi v76, v3, s[32:35], s29 offen
    s_add_u32 s29, s28, 449280
    buffer_load_short_d16_hi v77, v3, s[32:35], s29 offen
    s_add_u32 s29, s28, 453120
    buffer_load_short_d16_hi v78, v3, s[32:35], s29 offen
    s_add_u32 s29, s28, 456960
    buffer_load_short_d16_hi v79, v3, s[32:35], s29 offen
    s_add_u32 s29, s28, 491520
    buffer_load_short_d16_hi v80, v3, s[32:35], s29 offen
    s_add_u32 s29, s28, 495360
    buffer_load_short_d16_hi v81, v3, s[32:35], s29 offen
    s_add_u32 s29, s28, 499200
    buffer_load_short_d16_hi v82, v3, s[32:35], s29 offen
    s_add_u32 s29, s28, 503040
    buffer_load_short_d16_hi v83, v3, s[32:35], s29 offen
    s_add_u32 s29, s28, 506880
    buffer_load_short_d16_hi v84, v3, s[32:35], s29 offen
    s_add_u32 s29, s28, 510720
    buffer_load_short_d16_hi v85, v3, s[32:35], s29 offen
    s_add_u32 s29, s28, 514560
    buffer_load_short_d16_hi v86, v3, s[32:35], s29 offen
    s_add_u32 s29, s28, 518400
    buffer_load_short_d16_hi v87, v3, s[32:35], s29 offen
    s_add_u32 s29, s28, 552960
    buffer_load_short_d16_hi v88, v3, s[32:35], s29 offen
    s_add_u32 s29, s28, 556800
    buffer_load_short_d16_hi v89, v3, s[32:35], s29 offen
    s_add_u32 s29, s28, 560640
    buffer_load_short_d16_hi v90, v3, s[32:35], s29 offen
    s_add_u32 s29, s28, 564480
    buffer_load_short_d16_hi v91, v3, s[32:35], s29 offen
    s_add_u32 s29, s28, 568320
    buffer_load_short_d16_hi v92, v3, s[32:35], s29 offen
    s_add_u32 s29, s28, 572160
    buffer_load_short_d16_hi v93, v3, s[32:35], s29 offen
    s_add_u32 s29, s28, 576000
    buffer_load_short_d16_hi v94, v3, s[32:35], s29 offen
    s_add_u32 s29, s28, 579840
    buffer_load_short_d16_hi v95, v3, s[32:35], s29 offen
    s_mov_b64 exec, -1
    s_waitcnt vmcnt(0)
    v_add_f32 v5, v16, v17
    v_add_f32 v5, v5, v18
    v_add_f32 v5, v5, v19
    v_add_f32 v5, v5, v20
    v_add_f32 v5, v5, v21
    v_add_f32 v5, v5, v22
    v_add_f32 v5, v5, v23
    v_add_f32 v5, v5, v24
    v_add_f32 v5, v5, v25
    v_add_f32 v5, v5, v26
    v_add_f32 v5, v5, v27
    v_add_f32 v5, v5, v28
    v_add_f32 v5, v5, v29
    v_add_f32 v5, v5, v30
    v_add_f32 v5, v5, v31
    v_add_f32 v5, v5, v32
    v_add_f32 v5, v5, v33
    v_add_f32 v5, v5, v34
    v_add_f32 v5, v5, v35
    v_add_f32 v5, v5, v36
    v_add_f32 v5, v5, v37
    v_add_f32 v5, v5, v38
    v_add_f32 v5, v5, v39
    v_add_f32 v5, v5, v40
    v_add_f32 v5, v5, v41
    v_add_f32 v5, v5, v42
    v_add_f32 v5, v5, v43
    v_add_f32 v5, v5, v44
    v_add_f32 v5, v5, v45
    v_add_f32 v5, v5, v46
    v_add_f32 v5, v5, v47
    v_add_f32 v5, v5, v48
    v_add_f32 v5, v5, v49
    v_add_f32 v5, v5, v50
    v_add_f32 v5, v5, v51
    v_add_f32 v5, v5, v52
    v_add_f32 v5, v5, v53
    v_add_f32 v5, v5, v54
    v_add_f32 v5, v5, v55
    v_add_f32 v5, v5, v56
    v_add_f32 v5, v5, v57
    v_add_f32 v5, v5, v58
    v_add_f32 v5, v5, v59
    v_add_f32 v5, v5, v60
    v_add_f32 v5, v5, v61
    v_add_f32 v5, v5, v62
    v_add_f32 v5, v5, v63
    v_add_f32 v5, v5, v64
    v_add_f32 v5, v5, v65
    v_add_f32 v5, v5, v66
    v_add_f32 v5, v5, v67
    v_add_f32 v5, v5, v68
    v_add_f32 v5, v5, v69
    v_add_f32 v5, v5, v70
    v_add_f32 v5, v5, v71
    v_add_f32 v5, v5, v72
    v_add_f32 v5, v5, v73
    v_add_f32 v5, v5, v74
    v_add_f32 v5, v5, v75
    v_add_f32 v5, v5, v76
    v_add_f32 v5, v5, v77
    v_add_f32 v5, v5, v78
    v_add_f32 v5, v5, v79
    v_add_f32 v5, v5, v80
    v_add_f32 v5, v5, v81
    v_add_f32 v5, v5, v82
    v_add_f32 v5, v5, v83
    v_add_f32 v5, v5, v84
    v_add_f32 v5, v5, v85
    v_add_f32 v5, v5, v86
    v_add_f32 v5, v5, v87
    v_add_f32 v5, v5, v88
    v_add_f32 v5, v5, v89
    v_add_f32 v5, v5, v90
    v_add_f32 v5, v5, v91
    v_add_f32 v5, v5, v92
    v_add_f32 v5, v5, v93
    v_add_f32 v5, v5, v94
    v_add_f32 v5, v5, v95
    v_mov_b32 v6, v5
    s_nop 1
    v_permlane32_swap_b32 v5, v6
    v_add_f32 v5, v5, v6
    s_lshl_b32 s29, s13, 8
    v_lshlrev_b32 v7, 2, v0
    v_add_u32 v8, s29, v7
    ds_write_b32 v8, v5
    s_waitcnt lgkmcnt(0)
    s_barrier
    ds_read_b32 v8, v7 offset:0
    ds_read_b32 v9, v7 offset:256
    ds_read_b32 v10, v7 offset:512
    ds_read_b32 v11, v7 offset:768
    s_waitcnt lgkmcnt(0)
    v_add_f32 v8, v8, v9
    v_add_f32 v10, v10, v11
    v_add_f32 v8, v8, v10
    v_mul_f32 v8, 0x3acccccd, v8
    v_sub_f32 v16, v16, v8
    v_sub_f32 v17, v17, v8
    v_sub_f32 v18, v18, v8
    v_sub_f32 v19, v19, v8
    v_sub_f32 v20, v20, v8
    v_sub_f32 v21, v21, v8
    v_sub_f32 v22, v22, v8
    v_sub_f32 v23, v23, v8
    v_sub_f32 v24, v24, v8
    v_sub_f32 v25, v25, v8
    v_sub_f32 v26, v26, v8
    v_sub_f32 v27, v27, v8
    v_sub_f32 v28, v28, v8
    v_sub_f32 v29, v29, v8
    v_sub_f32 v30, v30, v8
    v_sub_f32 v31, v31, v8
    v_sub_f32 v32, v32, v8
    v_sub_f32 v33, v33, v8
    v_sub_f32 v34, v34, v8
    v_sub_f32 v35, v35, v8
    v_sub_f32 v36, v36, v8
    v_sub_f32 v37, v37, v8
    v_sub_f32 v38, v38, v8
    v_sub_f32 v39, v39, v8
    v_sub_f32 v40, v40, v8
    v_sub_f32 v41, v41, v8
    v_sub_f32 v42, v42, v8
    v_sub_f32 v43, v43, v8
    v_sub_f32 v44, v44, v8
    v_sub_f32 v45, v45, v8
    v_sub_f32 v46, v46, v8
    v_sub_f32 v47, v47, v8
    v_sub_f32 v48, v48, v8
    v_sub_f32 v49, v49, v8
    v_sub_f32 v50, v50, v8
    v_sub_f32 v51, v51, v8
    v_sub_f32 v52, v52, v8
    v_sub_f32 v53, v53, v8
    v_sub_f32 v54, v54, v8
    v_sub_f32 v55, v55, v8
    v_sub_f32 v56, v56, v8
    v_sub_f32 v57, v57, v8
    v_sub_f32 v58, v58, v8
    v_sub_f32 v59, v59, v8
    v_sub_f32 v60, v60, v8
    v_sub_f32 v61, v61, v8
    v_sub_f32 v62, v62, v8
    v_sub_f32 v63, v63, v8
    v_sub_f32 v64, v64, v8
    v_sub_f32 v65, v65, v8
    v_sub_f32 v66, v66, v8
    v_sub_f32 v67, v67, v8
    v_sub_f32 v68, v68, v8
    v_sub_f32 v69, v69, v8
    v_sub_f32 v70, v70, v8
    v_sub_f32 v71, v71, v8
    v_sub_f32 v72, v72, v8
    v_sub_f32 v73, v73, v8
    v_sub_f32 v74, v74, v8
    v_sub_f32 v75, v75, v8
    v_sub_f32 v76, v76, v8
    v_sub_f32 v77, v77, v8
    v_sub_f32 v78, v78, v8
    v_sub_f32 v79, v79, v8
    v_sub_f32 v80, v80, v8
    v_sub_f32 v81, v81, v8
    v_sub_f32 v82, v82, v8
    v_sub_f32 v83, v83, v8
    v_sub_f32 v84, v84, v8
    v_sub_f32 v85, v85, v8
    v_sub_f32 v86, v86, v8
    v_sub_f32 v87, v87, v8
    v_sub_f32 v88, v88, v8
    v_sub_f32 v89, v89, v8
    v_sub_f32 v90, v90, v8
    v_sub_f32 v91, v91, v8
    v_sub_f32 v92, v92, v8
    v_sub_f32 v93, v93, v8
    v_sub_f32 v94, v94, v8
    v_sub_f32 v95, v95, v8
    s_mul_i32 s29, s21, 81920
    s_lshl_b32 s30, s22, 10
    s_add_u32 s29, s29, s30
    s_mul_i32 s30, s13, 20480
    s_add_u32 s29, s29, s30
    s_add_u32 s29, s29, 243269632
    v_lshlrev_b32 v7, 4, v0
    v_cvt_pk_bf16_f32 v100, v16, v17
    v_cvt_pk_bf16_f32 v101, v18, v19
    v_cvt_pk_bf16_f32 v102, v20, v21
    v_cvt_pk_bf16_f32 v103, v22, v23
    buffer_store_dwordx4 v[100:103], v7, s[8:11], s29 offen
    s_add_u32 s29, s29, 2048
    v_cvt_pk_bf16_f32 v104, v24, v25
    v_cvt_pk_bf16_f32 v105, v26, v27
    v_cvt_pk_bf16_f32 v106, v28, v29
    v_cvt_pk_bf16_f32 v107, v30, v31
    buffer_store_dwordx4 v[104:107], v7, s[8:11], s29 offen
    s_add_u32 s29, s29, 2048
    v_cvt_pk_bf16_f32 v100, v32, v33
    v_cvt_pk_bf16_f32 v101, v34, v35
    v_cvt_pk_bf16_f32 v102, v36, v37
    v_cvt_pk_bf16_f32 v103, v38, v39
    buffer_store_dwordx4 v[100:103], v7, s[8:11], s29 offen
    s_add_u32 s29, s29, 2048
    v_cvt_pk_bf16_f32 v104, v40, v41
    v_cvt_pk_bf16_f32 v105, v42, v43
    v_cvt_pk_bf16_f32 v106, v44, v45
    v_cvt_pk_bf16_f32 v107, v46, v47
    buffer_store_dwordx4 v[104:107], v7, s[8:11], s29 offen
    s_add_u32 s29, s29, 2048
    v_cvt_pk_bf16_f32 v100, v48, v49
    v_cvt_pk_bf16_f32 v101, v50, v51
    v_cvt_pk_bf16_f32 v102, v52, v53
    v_cvt_pk_bf16_f32 v103, v54, v55
    buffer_store_dwordx4 v[100:103], v7, s[8:11], s29 offen
    s_add_u32 s29, s29, 2048
    v_cvt_pk_bf16_f32 v104, v56, v57
    v_cvt_pk_bf16_f32 v105, v58, v59
    v_cvt_pk_bf16_f32 v106, v60, v61
    v_cvt_pk_bf16_f32 v107, v62, v63
    buffer_store_dwordx4 v[104:107], v7, s[8:11], s29 offen
    s_add_u32 s29, s29, 2048
    v_cvt_pk_bf16_f32 v100, v64, v65
    v_cvt_pk_bf16_f32 v101, v66, v67
    v_cvt_pk_bf16_f32 v102, v68, v69
    v_cvt_pk_bf16_f32 v103, v70, v71
    buffer_store_dwordx4 v[100:103], v7, s[8:11], s29 offen
    s_add_u32 s29, s29, 2048
    v_cvt_pk_bf16_f32 v104, v72, v73
    v_cvt_pk_bf16_f32 v105, v74, v75
    v_cvt_pk_bf16_f32 v106, v76, v77
    v_cvt_pk_bf16_f32 v107, v78, v79
    buffer_store_dwordx4 v[104:107], v7, s[8:11], s29 offen
    s_add_u32 s29, s29, 2048
    v_cvt_pk_bf16_f32 v100, v80, v81
    v_cvt_pk_bf16_f32 v101, v82, v83
    v_cvt_pk_bf16_f32 v102, v84, v85
    v_cvt_pk_bf16_f32 v103, v86, v87
    buffer_store_dwordx4 v[100:103], v7, s[8:11], s29 offen
    s_add_u32 s29, s29, 2048
    v_cvt_pk_bf16_f32 v104, v88, v89
    v_cvt_pk_bf16_f32 v105, v90, v91
    v_cvt_pk_bf16_f32 v106, v92, v93
    v_cvt_pk_bf16_f32 v107, v94, v95
    buffer_store_dwordx4 v[104:107], v7, s[8:11], s29 offen
    s_add_u32 s29, s29, 2048
    s_branch prep_kernel_end
prep_kernel_r_pwo:
    s_lshl_b32 s20, s20, 2
    s_add_u32 s20, s20, s13
    s_load_dwordx2 s[24:25], s[0:1], 16
    s_lshr_b32 s21, s20, 3
    s_and_b32 s22, s20, 7
    v_and_b32 v1, 31, v0
    v_lshrrev_b32 v2, 5, v0
    v_lshlrev_b32 v3, 1, v1
    v_mul_u32_u24 v4, 10240, v2
    v_add_u32 v3, v3, v4
    s_lshl_b32 s29, s21, 6
    s_mul_i32 s30, s22, 102400
    s_add_u32 s29, s29, s30
    s_waitcnt lgkmcnt(0)
    s_mov_b32 s32, s24
    s_mov_b32 s33, s25
    s_mov_b32 s34, 819200
    s_mov_b32 s35, 0x00020000
    s_add_u32 s30, s29, 0
    buffer_load_ushort v16, v3, s[32:35], s30 offen
    s_add_u32 s30, s29, 1280
    buffer_load_ushort v17, v3, s[32:35], s30 offen
    s_add_u32 s30, s29, 2560
    buffer_load_ushort v18, v3, s[32:35], s30 offen
    s_add_u32 s30, s29, 3840
    buffer_load_ushort v19, v3, s[32:35], s30 offen
    s_add_u32 s30, s29, 5120
    buffer_load_ushort v20, v3, s[32:35], s30 offen
    s_add_u32 s30, s29, 6400
    buffer_load_ushort v21, v3, s[32:35], s30 offen
    s_add_u32 s30, s29, 7680
    buffer_load_ushort v22, v3, s[32:35], s30 offen
    s_add_u32 s30, s29, 8960
    buffer_load_ushort v23, v3, s[32:35], s30 offen
    s_add_u32 s30, s29, 20480
    buffer_load_ushort v24, v3, s[32:35], s30 offen
    s_add_u32 s30, s29, 21760
    buffer_load_ushort v25, v3, s[32:35], s30 offen
    s_add_u32 s30, s29, 23040
    buffer_load_ushort v26, v3, s[32:35], s30 offen
    s_add_u32 s30, s29, 24320
    buffer_load_ushort v27, v3, s[32:35], s30 offen
    s_add_u32 s30, s29, 25600
    buffer_load_ushort v28, v3, s[32:35], s30 offen
    s_add_u32 s30, s29, 26880
    buffer_load_ushort v29, v3, s[32:35], s30 offen
    s_add_u32 s30, s29, 28160
    buffer_load_ushort v30, v3, s[32:35], s30 offen
    s_add_u32 s30, s29, 29440
    buffer_load_ushort v31, v3, s[32:35], s30 offen
    s_add_u32 s30, s29, 40960
    buffer_load_ushort v32, v3, s[32:35], s30 offen
    s_add_u32 s30, s29, 42240
    buffer_load_ushort v33, v3, s[32:35], s30 offen
    s_add_u32 s30, s29, 43520
    buffer_load_ushort v34, v3, s[32:35], s30 offen
    s_add_u32 s30, s29, 44800
    buffer_load_ushort v35, v3, s[32:35], s30 offen
    s_add_u32 s30, s29, 46080
    buffer_load_ushort v36, v3, s[32:35], s30 offen
    s_add_u32 s30, s29, 47360
    buffer_load_ushort v37, v3, s[32:35], s30 offen
    s_add_u32 s30, s29, 48640
    buffer_load_ushort v38, v3, s[32:35], s30 offen
    s_add_u32 s30, s29, 49920
    buffer_load_ushort v39, v3, s[32:35], s30 offen
    s_add_u32 s30, s29, 61440
    buffer_load_ushort v40, v3, s[32:35], s30 offen
    s_add_u32 s30, s29, 62720
    buffer_load_ushort v41, v3, s[32:35], s30 offen
    s_add_u32 s30, s29, 64000
    buffer_load_ushort v42, v3, s[32:35], s30 offen
    s_add_u32 s30, s29, 65280
    buffer_load_ushort v43, v3, s[32:35], s30 offen
    s_add_u32 s30, s29, 66560
    buffer_load_ushort v44, v3, s[32:35], s30 offen
    s_add_u32 s30, s29, 67840
    buffer_load_ushort v45, v3, s[32:35], s30 offen
    s_add_u32 s30, s29, 69120
    buffer_load_ushort v46, v3, s[32:35], s30 offen
    s_add_u32 s30, s29, 70400
    buffer_load_ushort v47, v3, s[32:35], s30 offen
    s_add_u32 s30, s29, 81920
    buffer_load_ushort v48, v3, s[32:35], s30 offen
    s_add_u32 s30, s29, 83200
    buffer_load_ushort v49, v3, s[32:35], s30 offen
    s_add_u32 s30, s29, 84480
    buffer_load_ushort v50, v3, s[32:35], s30 offen
    s_add_u32 s30, s29, 85760
    buffer_load_ushort v51, v3, s[32:35], s30 offen
    s_add_u32 s30, s29, 87040
    buffer_load_ushort v52, v3, s[32:35], s30 offen
    s_add_u32 s30, s29, 88320
    buffer_load_ushort v53, v3, s[32:35], s30 offen
    s_add_u32 s30, s29, 89600
    buffer_load_ushort v54, v3, s[32:35], s30 offen
    s_add_u32 s30, s29, 90880
    buffer_load_ushort v55, v3, s[32:35], s30 offen
    s_mul_i32 s29, s20, 5120
    s_add_u32 s29, s29, 246415360
    v_lshlrev_b32 v7, 4, v0
    s_waitcnt vmcnt(32)
    v_lshl_or_b32 v64, v17, 16, v16
    v_lshl_or_b32 v65, v19, 16, v18
    v_lshl_or_b32 v66, v21, 16, v20
    v_lshl_or_b32 v67, v23, 16, v22
    buffer_store_dwordx4 v[64:67], v7, s[8:11], s29 offen offset:0
    s_waitcnt vmcnt(25)
    v_lshl_or_b32 v68, v25, 16, v24
    v_lshl_or_b32 v69, v27, 16, v26
    v_lshl_or_b32 v70, v29, 16, v28
    v_lshl_or_b32 v71, v31, 16, v30
    buffer_store_dwordx4 v[68:71], v7, s[8:11], s29 offen offset:1024
    s_waitcnt vmcnt(18)
    v_lshl_or_b32 v72, v33, 16, v32
    v_lshl_or_b32 v73, v35, 16, v34
    v_lshl_or_b32 v74, v37, 16, v36
    v_lshl_or_b32 v75, v39, 16, v38
    buffer_store_dwordx4 v[72:75], v7, s[8:11], s29 offen offset:2048
    s_waitcnt vmcnt(11)
    v_lshl_or_b32 v76, v41, 16, v40
    v_lshl_or_b32 v77, v43, 16, v42
    v_lshl_or_b32 v78, v45, 16, v44
    v_lshl_or_b32 v79, v47, 16, v46
    buffer_store_dwordx4 v[76:79], v7, s[8:11], s29 offen offset:3072
    s_add_u32 s29, s29, 4096
    s_waitcnt vmcnt(4)
    v_lshl_or_b32 v80, v49, 16, v48
    v_lshl_or_b32 v81, v51, 16, v50
    v_lshl_or_b32 v82, v53, 16, v52
    v_lshl_or_b32 v83, v55, 16, v54
    buffer_store_dwordx4 v[80:83], v7, s[8:11], s29 offen offset:0
    s_branch prep_kernel_end
prep_kernel_end:
    s_endpgm
.section .rodata,"a"
.p2align 6
.amdhsa_kernel prep_kernel
  .amdhsa_next_free_vgpr 248
  .amdhsa_next_free_sgpr 64
  .amdhsa_accum_offset 248
  .amdhsa_group_segment_fixed_size 0
  .amdhsa_kernarg_size 104
  .amdhsa_user_sgpr_count 2
  .amdhsa_user_sgpr_kernarg_segment_ptr 1
  .amdhsa_system_sgpr_workgroup_id_x 1
.end_amdhsa_kernel
.text
.globl afront1_kernel
.p2align 8
.type afront1_kernel,@function
afront1_kernel:
    s_cmp_ge_u32 s2, 256
    s_cbranch_scc1 afront1_kernel_end
    s_load_dwordx2 s[4:5], s[0:1], 96
    s_load_dwordx2 s[6:7], s[0:1], 0
    v_lshrrev_b32 v1, 6, v0
    v_and_b32 v0, 63, v0
    s_nop 0
    v_readfirstlane_b32 s13, v1
    s_waitcnt lgkmcnt(0)
    s_mov_b32 s8, s4
    s_mov_b32 s9, s5
    s_mov_b32 s10, 268435456
    s_mov_b32 s11, 0x00020000
    s_mov_b32 s16, s6
    s_mov_b32 s17, s7
    s_mov_b32 s18, 2621440
    s_mov_b32 s19, 0x00020000
    s_and_b32 s28, s2, 7
    s_lshr_b32 s29, s2, 3
    s_and_b32 s30, s28, 3
    s_lshl_b32 s30, s30, 2
    s_and_b32 s31, s29, 3
    s_add_u32 s20, s30, s31
    s_lshr_b32 s30, s28, 2
    s_lshl_b32 s30, s30, 3
    s_lshr_b32 s31, s29, 2
    s_add_u32 s21, s30, s31
    s_lshr_b32 s22, s13, 1
    s_and_b32 s23, s13, 1
    s_lshl_b32 s26, s20, 1
    s_add_u32 s26, s26, s23
    s_mov_b32 s27, 0x3f803f80
    s_lshl_b32 s28, s21, 7
    s_lshl_b32 s29, s13, 5
    s_add_u32 s28, s28, s29
    s_mul_i32 s24, s28, 1280
    s_lshl_b32 s28, s20, 1
    s_add_u32 s28, s28, s22
    s_mul_i32 s25, s28, 81920
    s_lshl_b32 s29, s23, 12
    s_add_u32 s25, s25, s29
    s_add_u32 s25, s25, 243269632
    v_lshlrev_b32 v1, 4, v0
    v_lshrrev_b32 v16, 3, v0
    v_mul_u32_u24 v16, 1280, v16
    v_and_b32 v17, 7, v0
    v_lshrrev_b32 v18, 4, v0
    v_xor_b32 v19, v17, v18
    v_lshl_add_u32 v2, v19, 4, v16
    v_xor_b32 v19, 4, v19
    v_lshl_add_u32 v3, v19, 4, v16
    s_lshl_b32 s28, s13, 12
    s_mov_b32 m0, s28
    s_add_u32 s29, s24, 0
    buffer_load_dwordx4 v2, s[16:19], s29 offen offset:0 lds
    s_add_u32 s29, s29, 9216
    buffer_load_dwordx4 v3, s[16:19], s29 offen offset:1024 lds
    s_add_u32 s29, s29, 9216
    buffer_load_dwordx4 v2, s[16:19], s29 offen offset:2048 lds
    s_add_u32 s29, s29, 9216
    buffer_load_dwordx4 v3, s[16:19], s29 offen offset:3072 lds
    s_add_u32 s28, s28, 16384
    s_mov_b32 m0, s28
    s_add_u32 s29, s25, 0
    buffer_load_dwordx4 v1, s[8:11], s29 offen offset:0 lds
    buffer_load_dwordx4 v1, s[8:11], s29 offen offset:1024 lds
    buffer_load_dwordx4 v1, s[8:11], s29 offen offset:2048 lds
    buffer_load_dwordx4 v1, s[8:11], s29 offen offset:3072 lds
    s_lshl_b32 s28, s13, 12
    s_add_u32 s28, s28, 32768
    s_mov_b32 m0, s28
    s_add_u32 s29, s24, 128
    buffer_load_dwordx4 v2, s[16:19], s29 offen offset:0 lds
    s_add_u32 s29, s29, 9216
    buffer_load_dwordx4 v3, s[16:19], s29 offen offset:1024 lds
    s_add_u32 s29, s29, 9216
    buffer_load_dwordx4 v2, s[16:19], s29 offen offset:2048 lds
    s_add_u32 s29, s29, 9216
    buffer_load_dwordx4 v3, s[16:19], s29 offen offset:3072 lds
    s_add_u32 s28, s28, 16384
    s_mov_b32 m0, s28
    s_add_u32 s29, s25, 8192
    buffer_load_dwordx4 v1, s[8:11], s29 offen offset:0 lds
    buffer_load_dwordx4 v1, s[8:11], s29 offen offset:1024 lds
    buffer_load_dwordx4 v1, s[8:11], s29 offen offset:2048 lds
    buffer_load_dwordx4 v1, s[8:11], s29 offen offset:3072 lds
    s_lshl_b32 s28, s13, 12
    s_add_u32 s28, s28, 65536
    s_mov_b32 m0, s28
    s_add_u32 s29, s24, 256
    buffer_load_dwordx4 v2, s[16:19], s29 offen offset:0 lds
    s_add_u32 s29, s29, 9216
    buffer_load_dwordx4 v3, s[16:19], s29 offen offset:1024 lds
    s_add_u32 s29, s29, 9216
    buffer_load_dwordx4 v2, s[16:19], s29 offen offset:2048 lds
    s_add_u32 s29, s29, 9216
    buffer_load_dwordx4 v3, s[16:19], s29 offen offset:3072 lds
    s_add_u32 s28, s28, 16384
    s_mov_b32 m0, s28
    s_add_u32 s29, s25, 16384
    buffer_load_dwordx4 v1, s[8:11], s29 offen offset:0 lds
    buffer_load_dwordx4 v1, s[8:11], s29 offen offset:1024 lds
    buffer_load_dwordx4 v1, s[8:11], s29 offen offset:2048 lds
    buffer_load_dwordx4 v1, s[8:11], s29 offen offset:3072 lds
    v_and_b32 v16, 31, v0
    v_lshrrev_b32 v17, 5, v0
    v_lshrrev_b32 v18, 1, v16
    v_and_b32 v18, 7, v18
    v_xor_b32 v18, v18, v17
    v_lshlrev_b32 v18, 4, v18
    v_lshl_add_u32 v18, v16, 7, v18
    s_lshl_b32 s28, s22, 13
    v_add_u32 v18, s28, v18
    v_xor_b32 v6, 0, v18
    v_add_u32 v10, 65536, v6
    v_xor_b32 v7, 32, v18
    v_add_u32 v11, 65536, v7
    v_xor_b32 v8, 64, v18
    v_add_u32 v12, 65536, v8
    v_xor_b32 v9, 96, v18
    v_add_u32 v13, 65536, v9
    s_lshl_b32 s28, s23, 13
    s_add_u32 s28, s28, 16384
    v_add_u32 v4, s28, v1
    v_add_u32 v5, 65536, v4
    v_mov_b32 v20, 0
    v_mov_b32 v21, 0
    v_mov_b32 v22, 0
    v_mov_b32 v23, 0
    s_waitcnt vmcnt(16)
    s_barrier
    ds_read_b128 v[32:35], v6 offset:0
    ds_read_b128 v[36:39], v6 offset:4096
    ds_read_b128 v[40:43], v4 offset:0
    ds_read_b128 v[44:47], v4 offset:1024
    s_cmp_eq_u32 s23, 1
    s_cbranch_scc1 afront1_kernel_af_h1
    s_waitcnt lgkmcnt(0)
    v_mfma_f32_32x32x16_bf16 v[64:79], v[32:35], v[40:43], 0
    v_dot2c_f32_bf16 v20, s27, v32
    v_dot2c_f32_bf16 v22, v32, v32
    v_mfma_f32_32x32x16_bf16 v[96:111], v[32:35], v[44:47], 0
    ds_read_b128 v[48:51], v7 offset:0
    v_dot2c_f32_bf16 v21, s27, v33
    v_mfma_f32_32x32x16_bf16 v[128:143], v[44:47], v[32:35], 0
    ds_read_b128 v[52:55], v7 offset:4096
    v_dot2c_f32_bf16 v23, v33, v33
    v_mfma_f32_32x32x16_bf16 v[80:95], v[36:39], v[40:43], 0
    ds_read_b128 v[56:59], v4 offset:2048
    v_dot2c_f32_bf16 v20, s27, v34
    v_dot2c_f32_bf16 v22, v34, v34
    v_mfma_f32_32x32x16_bf16 v[112:127], v[36:39], v[44:47], 0
    ds_read_b128 v[60:63], v4 offset:3072
    v_dot2c_f32_bf16 v21, s27, v35
    v_mfma_f32_32x32x16_bf16 v[144:159], v[44:47], v[36:39], 0
    v_dot2c_f32_bf16 v23, v35, v35
    s_waitcnt lgkmcnt(0)
    v_mfma_f32_32x32x16_bf16 v[64:79], v[48:51], v[56:59], v[64:79]
    v_dot2c_f32_bf16 v20, s27, v48
    v_dot2c_f32_bf16 v22, v48, v48
    v_mfma_f32_32x32x16_bf16 v[96:111], v[48:51], v[60:63], v[96:111]
    ds_read_b128 v[32:35], v8 offset:0
    v_dot2c_f32_bf16 v21, s27, v49
    v_mfma_f32_32x32x16_bf16 v[128:143], v[60:63], v[48:51], v[128:143]
    ds_read_b128 v[36:39], v8 offset:4096
    v_dot2c_f32_bf16 v23, v49, v49
    v_mfma_f32_32x32x16_bf16 v[80:95], v[52:55], v[56:59], v[80:95]
    ds_read_b128 v[40:43], v4 offset:4096
    v_dot2c_f32_bf16 v20, s27, v50
    v_dot2c_f32_bf16 v22, v50, v50
    v_mfma_f32_32x32x16_bf16 v[112:127], v[52:55], v[60:63], v[112:127]
    ds_read_b128 v[44:47], v4 offset:5120
    v_dot2c_f32_bf16 v21, s27, v51
    v_mfma_f32_32x32x16_bf16 v[144:159], v[60:63], v[52:55], v[144:159]
    v_dot2c_f32_bf16 v23, v51, v51
    s_waitcnt lgkmcnt(0)
    v_mfma_f32_32x32x16_bf16 v[64:79], v[32:35], v[40:43], v[64:79]
    v_dot2c_f32_bf16 v20, s27, v32
    v_dot2c_f32_bf16 v22, v32, v32
    v_mfma_f32_32x32x16_bf16 v[96:111], v[32:35], v[44:47], v[96:111]
    ds_read_b128 v[48:51], v9 offset:0
    v_dot2c_f32_bf16 v21, s27, v33
    v_mfma_f32_32x32x16_bf16 v[128:143], v[44:47], v[32:35], v[128:143]
    ds_read_b128 v[52:55], v9 offset:4096
    v_dot2c_f32_bf16 v23, v33, v33
    v_mfma_f32_32x32x16_bf16 v[80:95], v[36:39], v[40:43], v[80:95]
    ds_read_b128 v[56:59], v4 offset:6144
    v_dot2c_f32_bf16 v20, s27, v34
    v_dot2c_f32_bf16 v22, v34, v34
    v_mfma_f32_32x32x16_bf16 v[112:127], v[36:39], v[44:47], v[112:127]
    ds_read_b128 v[60:63], v4 offset:7168
    v_dot2c_f32_bf16 v21, s27, v35
    v_mfma_f32_32x32x16_bf16 v[144:159], v[44:47], v[36:39], v[144:159]
    v_dot2c_f32_bf16 v23, v35, v35
    s_waitcnt vmcnt(8)
    s_barrier
    s_lshl_b32 s28, s13, 12
    s_add_u32 s28, s28, 98304
    s_mov_b32 m0, s28
    s_add_u32 s29, s24, 384
    buffer_load_dwordx4 v2, s[16:19], s29 offen offset:0 lds
    s_add_u32 s29, s29, 9216
    buffer_load_dwordx4 v3, s[16:19], s29 offen offset:1024 lds
    s_add_u32 s29, s29, 9216
    buffer_load_dwordx4 v2, s[16:19], s29 offen offset:2048 lds
    s_add_u32 s29, s29, 9216
    buffer_load_dwordx4 v3, s[16:19], s29 offen offset:3072 lds
    s_add_u32 s28, s28, 16384
    s_mov_b32 m0, s28
    s_add_u32 s29, s25, 24576
    buffer_load_dwordx4 v1, s[8:11], s29 offen offset:0 lds
    buffer_load_dwordx4 v1, s[8:11], s29 offen offset:1024 lds
    buffer_load_dwordx4 v1, s[8:11], s29 offen offset:2048 lds
    buffer_load_dwordx4 v1, s[8:11], s29 offen offset:3072 lds
    s_waitcnt lgkmcnt(0)
    v_mfma_f32_32x32x16_bf16 v[64:79], v[48:51], v[56:59], v[64:79]
    v_dot2c_f32_bf16 v20, s27, v48
    v_dot2c_f32_bf16 v22, v48, v48
    v_mfma_f32_32x32x16_bf16 v[96:111], v[48:51], v[60:63], v[96:111]
    ds_read_b128 v[32:35], v6 offset:32768
    v_dot2c_f32_bf16 v21, s27, v49
    v_mfma_f32_32x32x16_bf16 v[128:143], v[60:63], v[48:51], v[128:143]
    ds_read_b128 v[36:39], v6 offset:36864
    v_dot2c_f32_bf16 v23, v49, v49
    v_mfma_f32_32x32x16_bf16 v[80:95], v[52:55], v[56:59], v[80:95]
    ds_read_b128 v[40:43], v4 offset:32768
    v_dot2c_f32_bf16 v20, s27, v50
    v_dot2c_f32_bf16 v22, v50, v50
    v_mfma_f32_32x32x16_bf16 v[112:127], v[52:55], v[60:63], v[112:127]
    ds_read_b128 v[44:47], v4 offset:33792
    v_dot2c_f32_bf16 v21, s27, v51
    v_mfma_f32_32x32x16_bf16 v[144:159], v[60:63], v[52:55], v[144:159]
    v_dot2c_f32_bf16 v23, v51, v51
    s_waitcnt lgkmcnt(0)
    v_mfma_f32_32x32x16_bf16 v[64:79], v[32:35], v[40:43], v[64:79]
    v_dot2c_f32_bf16 v20, s27, v32
    v_dot2c_f32_bf16 v22, v32, v32
    v_mfma_f32_32x32x16_bf16 v[96:111], v[32:35], v[44:47], v[96:111]
    ds_read_b128 v[48:51], v7 offset:32768
    v_dot2c_f32_bf16 v21, s27, v33
    v_mfma_f32_32x32x16_bf16 v[128:143], v[44:47], v[32:35], v[128:143]
    ds_read_b128 v[52:55], v7 offset:36864
    v_dot2c_f32_bf16 v23, v33, v33
    v_mfma_f32_32x32x16_bf16 v[80:95], v[36:39], v[40:43], v[80:95]
    ds_read_b128 v[56:59], v4 offset:34816
    v_dot2c_f32_bf16 v20, s27, v34
    v_dot2c_f32_bf16 v22, v34, v34
    v_mfma_f32_32x32x16_bf16 v[112:127], v[36:39], v[44:47], v[112:127]
    ds_read_b128 v[60:63], v4 offset:35840
    v_dot2c_f32_bf16 v21, s27, v35
    v_mfma_f32_32x32x16_bf16 v[144:159], v[44:47], v[36:39], v[144:159]
    v_dot2c_f32_bf16 v23, v35, v35
    s_waitcnt lgkmcnt(0)
    v_mfma_f32_32x32x16_bf16 v[64:79], v[48:51], v[56:59], v[64:79]
    v_dot2c_f32_bf16 v20, s27, v48
    v_dot2c_f32_bf16 v22, v48, v48
    v_mfma_f32_32x32x16_bf16 v[96:111], v[48:51], v[60:63], v[96:111]
    ds_read_b128 v[32:35], v8 offset:32768
    v_dot2c_f32_bf16 v21, s27, v49
    v_mfma_f32_32x32x16_bf16 v[128:143], v[60:63], v[48:51], v[128:143]
    ds_read_b128 v[36:39], v8 offset:36864
    v_dot2c_f32_bf16 v23, v49, v49
    v_mfma_f32_32x32x16_bf16 v[80:95], v[52:55], v[56:59], v[80:95]
    ds_read_b128 v[40:43], v4 offset:36864
    v_dot2c_f32_bf16 v20, s27, v50
    v_dot2c_f32_bf16 v22, v50, v50
    v_mfma_f32_32x32x16_bf16 v[112:127], v[52:55], v[60:63], v[112:127]
    ds_read_b128 v[44:47], v4 offset:37888
    v_dot2c_f32_bf16 v21, s27, v51
    v_mfma_f32_32x32x16_bf16 v[144:159], v[60:63], v[52:55], v[144:159]
    v_dot2c_f32_bf16 v23, v51, v51
    s_waitcnt lgkmcnt(0)
    v_mfma_f32_32x32x16_bf16 v[64:79], v[32:35], v[40:43], v[64:79]
    v_dot2c_f32_bf16 v20, s27, v32
    v_dot2c_f32_bf16 v22, v32, v32
    v_mfma_f32_32x32x16_bf16 v[96:111], v[32:35], v[44:47], v[96:111]
    ds_read_b128 v[48:51], v9 offset:32768
    v_dot2c_f32_bf16 v21, s27, v33
    v_mfma_f32_32x32x16_bf16 v[128:143], v[44:47], v[32:35], v[128:143]
    ds_read_b128 v[52:55], v9 offset:36864
    v_dot2c_f32_bf16 v23, v33, v33
    v_mfma_f32_32x32x16_bf16 v[80:95], v[36:39], v[40:43], v[80:95]
    ds_read_b128 v[56:59], v4 offset:38912
    v_dot2c_f32_bf16 v20, s27, v34
    v_dot2c_f32_bf16 v22, v34, v34
    v_mfma_f32_32x32x16_bf16 v[112:127], v[36:39], v[44:47], v[112:127]
    ds_read_b128 v[60:63], v4 offset:39936
    v_dot2c_f32_bf16 v21, s27, v35
    v_mfma_f32_32x32x16_bf16 v[144:159], v[44:47], v[36:39], v[144:159]
    v_dot2c_f32_bf16 v23, v35, v35
    s_waitcnt vmcnt(8)
    s_barrier
    s_lshl_b32 s28, s13, 12
    s_mov_b32 m0, s28
    s_add_u32 s29, s24, 512
    buffer_load_dwordx4 v2, s[16:19], s29 offen offset:0 lds
    s_add_u32 s29, s29, 9216
    buffer_load_dwordx4 v3, s[16:19], s29 offen offset:1024 lds
    s_add_u32 s29, s29, 9216
    buffer_load_dwordx4 v2, s[16:19], s29 offen offset:2048 lds
    s_add_u32 s29, s29, 9216
    buffer_load_dwordx4 v3, s[16:19], s29 offen offset:3072 lds
    s_add_u32 s28, s28, 16384
    s_mov_b32 m0, s28
    s_add_u32 s29, s25, 32768
    buffer_load_dwordx4 v1, s[8:11], s29 offen offset:0 lds
    buffer_load_dwordx4 v1, s[8:11], s29 offen offset:1024 lds
    buffer_load_dwordx4 v1, s[8:11], s29 offen offset:2048 lds
    buffer_load_dwordx4 v1, s[8:11], s29 offen offset:3072 lds
    s_waitcnt lgkmcnt(0)
    v_mfma_f32_32x32x16_bf16 v[64:79], v[48:51], v[56:59], v[64:79]
    v_dot2c_f32_bf16 v20, s27, v48
    v_dot2c_f32_bf16 v22, v48, v48
    v_mfma_f32_32x32x16_bf16 v[96:111], v[48:51], v[60:63], v[96:111]
    ds_read_b128 v[32:35], v10 offset:0
    v_dot2c_f32_bf16 v21, s27, v49
    v_mfma_f32_32x32x16_bf16 v[128:143], v[60:63], v[48:51], v[128:143]
    ds_read_b128 v[36:39], v10 offset:4096
    v_dot2c_f32_bf16 v23, v49, v49
    v_mfma_f32_32x32x16_bf16 v[80:95], v[52:55], v[56:59], v[80:95]
    ds_read_b128 v[40:43], v5 offset:0
    v_dot2c_f32_bf16 v20, s27, v50
    v_dot2c_f32_bf16 v22, v50, v50
    v_mfma_f32_32x32x16_bf16 v[112:127], v[52:55], v[60:63], v[112:127]
    ds_read_b128 v[44:47], v5 offset:1024
    v_dot2c_f32_bf16 v21, s27, v51
    v_mfma_f32_32x32x16_bf16 v[144:159], v[60:63], v[52:55], v[144:159]
    v_dot2c_f32_bf16 v23, v51, v51
    s_waitcnt lgkmcnt(0)
    v_mfma_f32_32x32x16_bf16 v[64:79], v[32:35], v[40:43], v[64:79]
    v_dot2c_f32_bf16 v20, s27, v32
    v_dot2c_f32_bf16 v22, v32, v32
    v_mfma_f32_32x32x16_bf16 v[96:111], v[32:35], v[44:47], v[96:111]
    ds_read_b128 v[48:51], v11 offset:0
    v_dot2c_f32_bf16 v21, s27, v33
    v_mfma_f32_32x32x16_bf16 v[128:143], v[44:47], v[32:35], v[128:143]
    ds_read_b128 v[52:55], v11 offset:4096
    v_dot2c_f32_bf16 v23, v33, v33
    v_mfma_f32_32x32x16_bf16 v[80:95], v[36:39], v[40:43], v[80:95]
    ds_read_b128 v[56:59], v5 offset:2048
    v_dot2c_f32_bf16 v20, s27, v34
    v_dot2c_f32_bf16 v22, v34, v34
    v_mfma_f32_32x32x16_bf16 v[112:127], v[36:39], v[44:47], v[112:127]
    ds_read_b128 v[60:63], v5 offset:3072
    v_dot2c_f32_bf16 v21, s27, v35
    v_mfma_f32_32x32x16_bf16 v[144:159], v[44:47], v[36:39], v[144:159]
    v_dot2c_f32_bf16 v23, v35, v35
    s_waitcnt lgkmcnt(0)
    v_mfma_f32_32x32x16_bf16 v[64:79], v[48:51], v[56:59], v[64:79]
    v_dot2c_f32_bf16 v20, s27, v48
    v_dot2c_f32_bf16 v22, v48, v48
    v_mfma_f32_32x32x16_bf16 v[96:111], v[48:51], v[60:63], v[96:111]
    ds_read_b128 v[32:35], v12 offset:0
    v_dot2c_f32_bf16 v21, s27, v49
    v_mfma_f32_32x32x16_bf16 v[128:143], v[60:63], v[48:51], v[128:143]
    ds_read_b128 v[36:39], v12 offset:4096
    v_dot2c_f32_bf16 v23, v49, v49
    v_mfma_f32_32x32x16_bf16 v[80:95], v[52:55], v[56:59], v[80:95]
    ds_read_b128 v[40:43], v5 offset:4096
    v_dot2c_f32_bf16 v20, s27, v50
    v_dot2c_f32_bf16 v22, v50, v50
    v_mfma_f32_32x32x16_bf16 v[112:127], v[52:55], v[60:63], v[112:127]
    ds_read_b128 v[44:47], v5 offset:5120
    v_dot2c_f32_bf16 v21, s27, v51
    v_mfma_f32_32x32x16_bf16 v[144:159], v[60:63], v[52:55], v[144:159]
    v_dot2c_f32_bf16 v23, v51, v51
    s_waitcnt lgkmcnt(0)
    v_mfma_f32_32x32x16_bf16 v[64:79], v[32:35], v[40:43], v[64:79]
    v_dot2c_f32_bf16 v20, s27, v32
    v_dot2c_f32_bf16 v22, v32, v32
    v_mfma_f32_32x32x16_bf16 v[96:111], v[32:35], v[44:47], v[96:111]
    ds_read_b128 v[48:51], v13 offset:0
    v_dot2c_f32_bf16 v21, s27, v33
    v_mfma_f32_32x32x16_bf16 v[128:143], v[44:47], v[32:35], v[128:143]
    ds_read_b128 v[52:55], v13 offset:4096
    v_dot2c_f32_bf16 v23, v33, v33
    v_mfma_f32_32x32x16_bf16 v[80:95], v[36:39], v[40:43], v[80:95]
    ds_read_b128 v[56:59], v5 offset:6144
    v_dot2c_f32_bf16 v20, s27, v34
    v_dot2c_f32_bf16 v22, v34, v34
    v_mfma_f32_32x32x16_bf16 v[112:127], v[36:39], v[44:47], v[112:127]
    ds_read_b128 v[60:63], v5 offset:7168
    v_dot2c_f32_bf16 v21, s27, v35
    v_mfma_f32_32x32x16_bf16 v[144:159], v[44:47], v[36:39], v[144:159]
    v_dot2c_f32_bf16 v23, v35, v35
    s_waitcnt vmcnt(8)
    s_barrier
    s_lshl_b32 s28, s13, 12
    s_add_u32 s28, s28, 32768
    s_mov_b32 m0, s28
    s_add_u32 s29, s24, 640
    buffer_load_dwordx4 v2, s[16:19], s29 offen offset:0 lds
    s_add_u32 s29, s29, 9216
    buffer_load_dwordx4 v3, s[16:19], s29 offen offset:1024 lds
    s_add_u32 s29, s29, 9216
    buffer_load_dwordx4 v2, s[16:19], s29 offen offset:2048 lds
    s_add_u32 s29, s29, 9216
    buffer_load_dwordx4 v3, s[16:19], s29 offen offset:3072 lds
    s_add_u32 s28, s28, 16384
    s_mov_b32 m0, s28
    s_add_u32 s29, s25, 40960
    buffer_load_dwordx4 v1, s[8:11], s29 offen offset:0 lds
    buffer_load_dwordx4 v1, s[8:11], s29 offen offset:1024 lds
    buffer_load_dwordx4 v1, s[8:11], s29 offen offset:2048 lds
    buffer_load_dwordx4 v1, s[8:11], s29 offen offset:3072 lds
    s_waitcnt lgkmcnt(0)
    v_mfma_f32_32x32x16_bf16 v[64:79], v[48:51], v[56:59], v[64:79]
    v_dot2c_f32_bf16 v20, s27, v48
    v_dot2c_f32_bf16 v22, v48, v48
    v_mfma_f32_32x32x16_bf16 v[96:111], v[48:51], v[60:63], v[96:111]
    ds_read_b128 v[32:35], v10 offset:32768
    v_dot2c_f32_bf16 v21, s27, v49
    v_mfma_f32_32x32x16_bf16 v[128:143], v[60:63], v[48:51], v[128:143]
    ds_read_b128 v[36:39], v10 offset:36864
    v_dot2c_f32_bf16 v23, v49, v49
    v_mfma_f32_32x32x16_bf16 v[80:95], v[52:55], v[56:59], v[80:95]
    ds_read_b128 v[40:43], v5 offset:32768
    v_dot2c_f32_bf16 v20, s27, v50
    v_dot2c_f32_bf16 v22, v50, v50
    v_mfma_f32_32x32x16_bf16 v[112:127], v[52:55], v[60:63], v[112:127]
    ds_read_b128 v[44:47], v5 offset:33792
    v_dot2c_f32_bf16 v21, s27, v51
    v_mfma_f32_32x32x16_bf16 v[144:159], v[60:63], v[52:55], v[144:159]
    v_dot2c_f32_bf16 v23, v51, v51
    s_waitcnt lgkmcnt(0)
    v_mfma_f32_32x32x16_bf16 v[64:79], v[32:35], v[40:43], v[64:79]
    v_dot2c_f32_bf16 v20, s27, v32
    v_dot2c_f32_bf16 v22, v32, v32
    v_mfma_f32_32x32x16_bf16 v[96:111], v[32:35], v[44:47], v[96:111]
    ds_read_b128 v[48:51], v11 offset:32768
    v_dot2c_f32_bf16 v21, s27, v33
    v_mfma_f32_32x32x16_bf16 v[128:143], v[44:47], v[32:35], v[128:143]
    ds_read_b128 v[52:55], v11 offset:36864
    v_dot2c_f32_bf16 v23, v33, v33
    v_mfma_f32_32x32x16_bf16 v[80:95], v[36:39], v[40:43], v[80:95]
    ds_read_b128 v[56:59], v5 offset:34816
    v_dot2c_f32_bf16 v20, s27, v34
    v_dot2c_f32_bf16 v22, v34, v34
    v_mfma_f32_32x32x16_bf16 v[112:127], v[36:39], v[44:47], v[112:127]
    ds_read_b128 v[60:63], v5 offset:35840
    v_dot2c_f32_bf16 v21, s27, v35
    v_mfma_f32_32x32x16_bf16 v[144:159], v[44:47], v[36:39], v[144:159]
    v_dot2c_f32_bf16 v23, v35, v35
    s_waitcnt lgkmcnt(0)
    v_mfma_f32_32x32x16_bf16 v[64:79], v[48:51], v[56:59], v[64:79]
    v_dot2c_f32_bf16 v20, s27, v48
    v_dot2c_f32_bf16 v22, v48, v48
    v_mfma_f32_32x32x16_bf16 v[96:111], v[48:51], v[60:63], v[96:111]
    ds_read_b128 v[32:35], v12 offset:32768
    v_dot2c_f32_bf16 v21, s27, v49
    v_mfma_f32_32x32x16_bf16 v[128:143], v[60:63], v[48:51], v[128:143]
    ds_read_b128 v[36:39], v12 offset:36864
    v_dot2c_f32_bf16 v23, v49, v49
    v_mfma_f32_32x32x16_bf16 v[80:95], v[52:55], v[56:59], v[80:95]
    ds_read_b128 v[40:43], v5 offset:36864
    v_dot2c_f32_bf16 v20, s27, v50
    v_dot2c_f32_bf16 v22, v50, v50
    v_mfma_f32_32x32x16_bf16 v[112:127], v[52:55], v[60:63], v[112:127]
    ds_read_b128 v[44:47], v5 offset:37888
    v_dot2c_f32_bf16 v21, s27, v51
    v_mfma_f32_32x32x16_bf16 v[144:159], v[60:63], v[52:55], v[144:159]
    v_dot2c_f32_bf16 v23, v51, v51
    s_waitcnt lgkmcnt(0)
    v_mfma_f32_32x32x16_bf16 v[64:79], v[32:35], v[40:43], v[64:79]
    v_dot2c_f32_bf16 v20, s27, v32
    v_dot2c_f32_bf16 v22, v32, v32
    v_mfma_f32_32x32x16_bf16 v[96:111], v[32:35], v[44:47], v[96:111]
    ds_read_b128 v[48:51], v13 offset:32768
    v_dot2c_f32_bf16 v21, s27, v33
    v_mfma_f32_32x32x16_bf16 v[128:143], v[44:47], v[32:35], v[128:143]
    ds_read_b128 v[52:55], v13 offset:36864
    v_dot2c_f32_bf16 v23, v33, v33
    v_mfma_f32_32x32x16_bf16 v[80:95], v[36:39], v[40:43], v[80:95]
    ds_read_b128 v[56:59], v5 offset:38912
    v_dot2c_f32_bf16 v20, s27, v34
    v_dot2c_f32_bf16 v22, v34, v34
    v_mfma_f32_32x32x16_bf16 v[112:127], v[36:39], v[44:47], v[112:127]
    ds_read_b128 v[60:63], v5 offset:39936
    v_dot2c_f32_bf16 v21, s27, v35
    v_mfma_f32_32x32x16_bf16 v[144:159], v[44:47], v[36:39], v[144:159]
    v_dot2c_f32_bf16 v23, v35, v35
    s_waitcnt vmcnt(8)
    s_barrier
    s_lshl_b32 s28, s13, 12
    s_add_u32 s28, s28, 65536
    s_mov_b32 m0, s28
    s_add_u32 s29, s24, 768
    buffer_load_dwordx4 v2, s[16:19], s29 offen offset:0 lds
    s_add_u32 s29, s29, 9216
    buffer_load_dwordx4 v3, s[16:19], s29 offen offset:1024 lds
    s_add_u32 s29, s29, 9216
    buffer_load_dwordx4 v2, s[16:19], s29 offen offset:2048 lds
    s_add_u32 s29, s29, 9216
    buffer_load_dwordx4 v3, s[16:19], s29 offen offset:3072 lds
    s_add_u32 s28, s28, 16384
    s_mov_b32 m0, s28
    s_add_u32 s29, s25, 49152
    buffer_load_dwordx4 v1, s[8:11], s29 offen offset:0 lds
    buffer_load_dwordx4 v1, s[8:11], s29 offen offset:1024 lds
    buffer_load_dwordx4 v1, s[8:11], s29 offen offset:2048 lds
    buffer_load_dwordx4 v1, s[8:11], s29 offen offset:3072 lds
    s_waitcnt lgkmcnt(0)
    v_mfma_f32_32x32x16_bf16 v[64:79], v[48:51], v[56:59], v[64:79]
    v_dot2c_f32_bf16 v20, s27, v48
    v_dot2c_f32_bf16 v22, v48, v48
    v_mfma_f32_32x32x16_bf16 v[96:111], v[48:51], v[60:63], v[96:111]
    ds_read_b128 v[32:35], v6 offset:0
    v_dot2c_f32_bf16 v21, s27, v49
    v_mfma_f32_32x32x16_bf16 v[128:143], v[60:63], v[48:51], v[128:143]
    ds_read_b128 v[36:39], v6 offset:4096
    v_dot2c_f32_bf16 v23, v49, v49
    v_mfma_f32_32x32x16_bf16 v[80:95], v[52:55], v[56:59], v[80:95]
    ds_read_b128 v[40:43], v4 offset:0
    v_dot2c_f32_bf16 v20, s27, v50
    v_dot2c_f32_bf16 v22, v50, v50
    v_mfma_f32_32x32x16_bf16 v[112:127], v[52:55], v[60:63], v[112:127]
    ds_read_b128 v[44:47], v4 offset:1024
    v_dot2c_f32_bf16 v21, s27, v51
    v_mfma_f32_32x32x16_bf16 v[144:159], v[60:63], v[52:55], v[144:159]
    v_dot2c_f32_bf16 v23, v51, v51
    s_waitcnt lgkmcnt(0)
    v_mfma_f32_32x32x16_bf16 v[64:79], v[32:35], v[40:43], v[64:79]
    v_dot2c_f32_bf16 v20, s27, v32
    v_dot2c_f32_bf16 v22, v32, v32
    v_mfma_f32_32x32x16_bf16 v[96:111], v[32:35], v[44:47], v[96:111]
    ds_read_b128 v[48:51], v7 offset:0
    v_dot2c_f32_bf16 v21, s27, v33
    v_mfma_f32_32x32x16_bf16 v[128:143], v[44:47], v[32:35], v[128:143]
    ds_read_b128 v[52:55], v7 offset:4096
    v_dot2c_f32_bf16 v23, v33, v33
    v_mfma_f32_32x32x16_bf16 v[80:95], v[36:39], v[40:43], v[80:95]
    ds_read_b128 v[56:59], v4 offset:2048
    v_dot2c_f32_bf16 v20, s27, v34
    v_dot2c_f32_bf16 v22, v34, v34
    v_mfma_f32_32x32x16_bf16 v[112:127], v[36:39], v[44:47], v[112:127]
    ds_read_b128 v[60:63], v4 offset:3072
    v_dot2c_f32_bf16 v21, s27, v35
    v_mfma_f32_32x32x16_bf16 v[144:159], v[44:47], v[36:39], v[144:159]
    v_dot2c_f32_bf16 v23, v35, v35
    s_waitcnt lgkmcnt(0)
    v_mfma_f32_32x32x16_bf16 v[64:79], v[48:51], v[56:59], v[64:79]
    v_dot2c_f32_bf16 v20, s27, v48
    v_dot2c_f32_bf16 v22, v48, v48
    v_mfma_f32_32x32x16_bf16 v[96:111], v[48:51], v[60:63], v[96:111]
    ds_read_b128 v[32:35], v8 offset:0
    v_dot2c_f32_bf16 v21, s27, v49
    v_mfma_f32_32x32x16_bf16 v[128:143], v[60:63], v[48:51], v[128:143]
    ds_read_b128 v[36:39], v8 offset:4096
    v_dot2c_f32_bf16 v23, v49, v49
    v_mfma_f32_32x32x16_bf16 v[80:95], v[52:55], v[56:59], v[80:95]
    ds_read_b128 v[40:43], v4 offset:4096
    v_dot2c_f32_bf16 v20, s27, v50
    v_dot2c_f32_bf16 v22, v50, v50
    v_mfma_f32_32x32x16_bf16 v[112:127], v[52:55], v[60:63], v[112:127]
    ds_read_b128 v[44:47], v4 offset:5120
    v_dot2c_f32_bf16 v21, s27, v51
    v_mfma_f32_32x32x16_bf16 v[144:159], v[60:63], v[52:55], v[144:159]
    v_dot2c_f32_bf16 v23, v51, v51
    s_waitcnt lgkmcnt(0)
    v_mfma_f32_32x32x16_bf16 v[64:79], v[32:35], v[40:43], v[64:79]
    v_dot2c_f32_bf16 v20, s27, v32
    v_dot2c_f32_bf16 v22, v32, v32
    v_mfma_f32_32x32x16_bf16 v[96:111], v[32:35], v[44:47], v[96:111]
    ds_read_b128 v[48:51], v9 offset:0
    v_dot2c_f32_bf16 v21, s27, v33
    v_mfma_f32_32x32x16_bf16 v[128:143], v[44:47], v[32:35], v[128:143]
    ds_read_b128 v[52:55], v9 offset:4096
    v_dot2c_f32_bf16 v23, v33, v33
    v_mfma_f32_32x32x16_bf16 v[80:95], v[36:39], v[40:43], v[80:95]
    ds_read_b128 v[56:59], v4 offset:6144
    v_dot2c_f32_bf16 v20, s27, v34
    v_dot2c_f32_bf16 v22, v34, v34
    v_mfma_f32_32x32x16_bf16 v[112:127], v[36:39], v[44:47], v[112:127]
    ds_read_b128 v[60:63], v4 offset:7168
    v_dot2c_f32_bf16 v21, s27, v35
    v_mfma_f32_32x32x16_bf16 v[144:159], v[44:47], v[36:39], v[144:159]
    v_dot2c_f32_bf16 v23, v35, v35
    s_waitcnt vmcnt(8)
    s_barrier
    s_lshl_b32 s28, s13, 12
    s_add_u32 s28, s28, 98304
    s_mov_b32 m0, s28
    s_add_u32 s29, s24, 896
    buffer_load_dwordx4 v2, s[16:19], s29 offen offset:0 lds
    s_add_u32 s29, s29, 9216
    buffer_load_dwordx4 v3, s[16:19], s29 offen offset:1024 lds
    s_add_u32 s29, s29, 9216
    buffer_load_dwordx4 v2, s[16:19], s29 offen offset:2048 lds
    s_add_u32 s29, s29, 9216
    buffer_load_dwordx4 v3, s[16:19], s29 offen offset:3072 lds
    s_add_u32 s28, s28, 16384
    s_mov_b32 m0, s28
    s_add_u32 s29, s25, 57344
    buffer_load_dwordx4 v1, s[8:11], s29 offen offset:0 lds
    buffer_load_dwordx4 v1, s[8:11], s29 offen offset:1024 lds
    buffer_load_dwordx4 v1, s[8:11], s29 offen offset:2048 lds
    buffer_load_dwordx4 v1, s[8:11], s29 offen offset:3072 lds
    s_waitcnt lgkmcnt(0)
    v_mfma_f32_32x32x16_bf16 v[64:79], v[48:51], v[56:59], v[64:79]
    v_dot2c_f32_bf16 v20, s27, v48
    v_dot2c_f32_bf16 v22, v48, v48
    v_mfma_f32_32x32x16_bf16 v[96:111], v[48:51], v[60:63], v[96:111]
    ds_read_b128 v[32:35], v6 offset:32768
    v_dot2c_f32_bf16 v21, s27, v49
    v_mfma_f32_32x32x16_bf16 v[128:143], v[60:63], v[48:51], v[128:143]
    ds_read_b128 v[36:39], v6 offset:36864
    v_dot2c_f32_bf16 v23, v49, v49
    v_mfma_f32_32x32x16_bf16 v[80:95], v[52:55], v[56:59], v[80:95]
    ds_read_b128 v[40:43], v4 offset:32768
    v_dot2c_f32_bf16 v20, s27, v50
    v_dot2c_f32_bf16 v22, v50, v50
    v_mfma_f32_32x32x16_bf16 v[112:127], v[52:55], v[60:63], v[112:127]
    ds_read_b128 v[44:47], v4 offset:33792
    v_dot2c_f32_bf16 v21, s27, v51
    v_mfma_f32_32x32x16_bf16 v[144:159], v[60:63], v[52:55], v[144:159]
    v_dot2c_f32_bf16 v23, v51, v51
    s_waitcnt lgkmcnt(0)
    v_mfma_f32_32x32x16_bf16 v[64:79], v[32:35], v[40:43], v[64:79]
    v_dot2c_f32_bf16 v20, s27, v32
    v_dot2c_f32_bf16 v22, v32, v32
    v_mfma_f32_32x32x16_bf16 v[96:111], v[32:35], v[44:47], v[96:111]
    ds_read_b128 v[48:51], v7 offset:32768
    v_dot2c_f32_bf16 v21, s27, v33
    v_mfma_f32_32x32x16_bf16 v[128:143], v[44:47], v[32:35], v[128:143]
    ds_read_b128 v[52:55], v7 offset:36864
    v_dot2c_f32_bf16 v23, v33, v33
    v_mfma_f32_32x32x16_bf16 v[80:95], v[36:39], v[40:43], v[80:95]
    ds_read_b128 v[56:59], v4 offset:34816
    v_dot2c_f32_bf16 v20, s27, v34
    v_dot2c_f32_bf16 v22, v34, v34
    v_mfma_f32_32x32x16_bf16 v[112:127], v[36:39], v[44:47], v[112:127]
    ds_read_b128 v[60:63], v4 offset:35840
    v_dot2c_f32_bf16 v21, s27, v35
    v_mfma_f32_32x32x16_bf16 v[144:159], v[44:47], v[36:39], v[144:159]
    v_dot2c_f32_bf16 v23, v35, v35
    s_waitcnt lgkmcnt(0)
    v_mfma_f32_32x32x16_bf16 v[64:79], v[48:51], v[56:59], v[64:79]
    v_dot2c_f32_bf16 v20, s27, v48
    v_dot2c_f32_bf16 v22, v48, v48
    v_mfma_f32_32x32x16_bf16 v[96:111], v[48:51], v[60:63], v[96:111]
    ds_read_b128 v[32:35], v8 offset:32768
    v_dot2c_f32_bf16 v21, s27, v49
    v_mfma_f32_32x32x16_bf16 v[128:143], v[60:63], v[48:51], v[128:143]
    ds_read_b128 v[36:39], v8 offset:36864
    v_dot2c_f32_bf16 v23, v49, v49
    v_mfma_f32_32x32x16_bf16 v[80:95], v[52:55], v[56:59], v[80:95]
    ds_read_b128 v[40:43], v4 offset:36864
    v_dot2c_f32_bf16 v20, s27, v50
    v_dot2c_f32_bf16 v22, v50, v50
    v_mfma_f32_32x32x16_bf16 v[112:127], v[52:55], v[60:63], v[112:127]
    ds_read_b128 v[44:47], v4 offset:37888
    v_dot2c_f32_bf16 v21, s27, v51
    v_mfma_f32_32x32x16_bf16 v[144:159], v[60:63], v[52:55], v[144:159]
    v_dot2c_f32_bf16 v23, v51, v51
    s_waitcnt lgkmcnt(0)
    v_mfma_f32_32x32x16_bf16 v[64:79], v[32:35], v[40:43], v[64:79]
    v_dot2c_f32_bf16 v20, s27, v32
    v_dot2c_f32_bf16 v22, v32, v32
    v_mfma_f32_32x32x16_bf16 v[96:111], v[32:35], v[44:47], v[96:111]
    ds_read_b128 v[48:51], v9 offset:32768
    v_dot2c_f32_bf16 v21, s27, v33
    v_mfma_f32_32x32x16_bf16 v[128:143], v[44:47], v[32:35], v[128:143]
    ds_read_b128 v[52:55], v9 offset:36864
    v_dot2c_f32_bf16 v23, v33, v33
    v_mfma_f32_32x32x16_bf16 v[80:95], v[36:39], v[40:43], v[80:95]
    ds_read_b128 v[56:59], v4 offset:38912
    v_dot2c_f32_bf16 v20, s27, v34
    v_dot2c_f32_bf16 v22, v34, v34
    v_mfma_f32_32x32x16_bf16 v[112:127], v[36:39], v[44:47], v[112:127]
    ds_read_b128 v[60:63], v4 offset:39936
    v_dot2c_f32_bf16 v21, s27, v35
    v_mfma_f32_32x32x16_bf16 v[144:159], v[44:47], v[36:39], v[144:159]
    v_dot2c_f32_bf16 v23, v35, v35
    s_waitcnt vmcnt(8)
    s_barrier
    s_lshl_b32 s28, s13, 12
    s_mov_b32 m0, s28
    s_add_u32 s29, s24, 1024
    buffer_load_dwordx4 v2, s[16:19], s29 offen offset:0 lds
    s_add_u32 s29, s29, 9216
    buffer_load_dwordx4 v3, s[16:19], s29 offen offset:1024 lds
    s_add_u32 s29, s29, 9216
    buffer_load_dwordx4 v2, s[16:19], s29 offen offset:2048 lds
    s_add_u32 s29, s29, 9216
    buffer_load_dwordx4 v3, s[16:19], s29 offen offset:3072 lds
    s_add_u32 s28, s28, 16384
    s_mov_b32 m0, s28
    s_add_u32 s29, s25, 65536
    buffer_load_dwordx4 v1, s[8:11], s29 offen offset:0 lds
    buffer_load_dwordx4 v1, s[8:11], s29 offen offset:1024 lds
    buffer_load_dwordx4 v1, s[8:11], s29 offen offset:2048 lds
    buffer_load_dwordx4 v1, s[8:11], s29 offen offset:3072 lds
    s_waitcnt lgkmcnt(0)
    v_mfma_f32_32x32x16_bf16 v[64:79], v[48:51], v[56:59], v[64:79]
    v_dot2c_f32_bf16 v20, s27, v48
    v_dot2c_f32_bf16 v22, v48, v48
    v_mfma_f32_32x32x16_bf16 v[96:111], v[48:51], v[60:63], v[96:111]
    ds_read_b128 v[32:35], v10 offset:0
    v_dot2c_f32_bf16 v21, s27, v49
    v_mfma_f32_32x32x16_bf16 v[128:143], v[60:63], v[48:51], v[128:143]
    ds_read_b128 v[36:39], v10 offset:4096
    v_dot2c_f32_bf16 v23, v49, v49
    v_mfma_f32_32x32x16_bf16 v[80:95], v[52:55], v[56:59], v[80:95]
    ds_read_b128 v[40:43], v5 offset:0
    v_dot2c_f32_bf16 v20, s27, v50
    v_dot2c_f32_bf16 v22, v50, v50
    v_mfma_f32_32x32x16_bf16 v[112:127], v[52:55], v[60:63], v[112:127]
    ds_read_b128 v[44:47], v5 offset:1024
    v_dot2c_f32_bf16 v21, s27, v51
    v_mfma_f32_32x32x16_bf16 v[144:159], v[60:63], v[52:55], v[144:159]
    v_dot2c_f32_bf16 v23, v51, v51
    s_waitcnt lgkmcnt(0)
    v_mfma_f32_32x32x16_bf16 v[64:79], v[32:35], v[40:43], v[64:79]
    v_dot2c_f32_bf16 v20, s27, v32
    v_dot2c_f32_bf16 v22, v32, v32
    v_mfma_f32_32x32x16_bf16 v[96:111], v[32:35], v[44:47], v[96:111]
    ds_read_b128 v[48:51], v11 offset:0
    v_dot2c_f32_bf16 v21, s27, v33
    v_mfma_f32_32x32x16_bf16 v[128:143], v[44:47], v[32:35], v[128:143]
    ds_read_b128 v[52:55], v11 offset:4096
    v_dot2c_f32_bf16 v23, v33, v33
    v_mfma_f32_32x32x16_bf16 v[80:95], v[36:39], v[40:43], v[80:95]
    ds_read_b128 v[56:59], v5 offset:2048
    v_dot2c_f32_bf16 v20, s27, v34
    v_dot2c_f32_bf16 v22, v34, v34
    v_mfma_f32_32x32x16_bf16 v[112:127], v[36:39], v[44:47], v[112:127]
    ds_read_b128 v[60:63], v5 offset:3072
    v_dot2c_f32_bf16 v21, s27, v35
    v_mfma_f32_32x32x16_bf16 v[144:159], v[44:47], v[36:39], v[144:159]
    v_dot2c_f32_bf16 v23, v35, v35
    s_waitcnt lgkmcnt(0)
    v_mfma_f32_32x32x16_bf16 v[64:79], v[48:51], v[56:59], v[64:79]
    v_dot2c_f32_bf16 v20, s27, v48
    v_dot2c_f32_bf16 v22, v48, v48
    v_mfma_f32_32x32x16_bf16 v[96:111], v[48:51], v[60:63], v[96:111]
    ds_read_b128 v[32:35], v12 offset:0
    v_dot2c_f32_bf16 v21, s27, v49
    v_mfma_f32_32x32x16_bf16 v[128:143], v[60:63], v[48:51], v[128:143]
    ds_read_b128 v[36:39], v12 offset:4096
    v_dot2c_f32_bf16 v23, v49, v49
    v_mfma_f32_32x32x16_bf16 v[80:95], v[52:55], v[56:59], v[80:95]
    ds_read_b128 v[40:43], v5 offset:4096
    v_dot2c_f32_bf16 v20, s27, v50
    v_dot2c_f32_bf16 v22, v50, v50
    v_mfma_f32_32x32x16_bf16 v[112:127], v[52:55], v[60:63], v[112:127]
    ds_read_b128 v[44:47], v5 offset:5120
    v_dot2c_f32_bf16 v21, s27, v51
    v_mfma_f32_32x32x16_bf16 v[144:159], v[60:63], v[52:55], v[144:159]
    v_dot2c_f32_bf16 v23, v51, v51
    s_waitcnt lgkmcnt(0)
    v_mfma_f32_32x32x16_bf16 v[64:79], v[32:35], v[40:43], v[64:79]
    v_dot2c_f32_bf16 v20, s27, v32
    v_dot2c_f32_bf16 v22, v32, v32
    v_mfma_f32_32x32x16_bf16 v[96:111], v[32:35], v[44:47], v[96:111]
    ds_read_b128 v[48:51], v13 offset:0
    v_dot2c_f32_bf16 v21, s27, v33
    v_mfma_f32_32x32x16_bf16 v[128:143], v[44:47], v[32:35], v[128:143]
    ds_read_b128 v[52:55], v13 offset:4096
    v_dot2c_f32_bf16 v23, v33, v33
    v_mfma_f32_32x32x16_bf16 v[80:95], v[36:39], v[40:43], v[80:95]
    ds_read_b128 v[56:59], v5 offset:6144
    v_dot2c_f32_bf16 v20, s27, v34
    v_dot2c_f32_bf16 v22, v34, v34
    v_mfma_f32_32x32x16_bf16 v[112:127], v[36:39], v[44:47], v[112:127]
    ds_read_b128 v[60:63], v5 offset:7168
    v_dot2c_f32_bf16 v21, s27, v35
    v_mfma_f32_32x32x16_bf16 v[144:159], v[44:47], v[36:39], v[144:159]
    v_dot2c_f32_bf16 v23, v35, v35
    s_waitcnt vmcnt(8)
    s_barrier
    s_lshl_b32 s28, s13, 12
    s_add_u32 s28, s28, 32768
    s_mov_b32 m0, s28
    s_add_u32 s29, s24, 1152
    buffer_load_dwordx4 v2, s[16:19], s29 offen offset:0 lds
    s_add_u32 s29, s29, 9216
    buffer_load_dwordx4 v3, s[16:19], s29 offen offset:1024 lds
    s_add_u32 s29, s29, 9216
    buffer_load_dwordx4 v2, s[16:19], s29 offen offset:2048 lds
    s_add_u32 s29, s29, 9216
    buffer_load_dwordx4 v3, s[16:19], s29 offen offset:3072 lds
    s_add_u32 s28, s28, 16384
    s_mov_b32 m0, s28
    s_add_u32 s29, s25, 73728
    buffer_load_dwordx4 v1, s[8:11], s29 offen offset:0 lds
    buffer_load_dwordx4 v1, s[8:11], s29 offen offset:1024 lds
    buffer_load_dwordx4 v1, s[8:11], s29 offen offset:2048 lds
    buffer_load_dwordx4 v1, s[8:11], s29 offen offset:3072 lds
    s_waitcnt lgkmcnt(0)
    v_mfma_f32_32x32x16_bf16 v[64:79], v[48:51], v[56:59], v[64:79]
    v_dot2c_f32_bf16 v20, s27, v48
    v_dot2c_f32_bf16 v22, v48, v48
    v_mfma_f32_32x32x16_bf16 v[96:111], v[48:51], v[60:63], v[96:111]
    ds_read_b128 v[32:35], v10 offset:32768
    v_dot2c_f32_bf16 v21, s27, v49
    v_mfma_f32_32x32x16_bf16 v[128:143], v[60:63], v[48:51], v[128:143]
    ds_read_b128 v[36:39], v10 offset:36864
    v_dot2c_f32_bf16 v23, v49, v49
    v_mfma_f32_32x32x16_bf16 v[80:95], v[52:55], v[56:59], v[80:95]
    ds_read_b128 v[40:43], v5 offset:32768
    v_dot2c_f32_bf16 v20, s27, v50
    v_dot2c_f32_bf16 v22, v50, v50
    v_mfma_f32_32x32x16_bf16 v[112:127], v[52:55], v[60:63], v[112:127]
    ds_read_b128 v[44:47], v5 offset:33792
    v_dot2c_f32_bf16 v21, s27, v51
    v_mfma_f32_32x32x16_bf16 v[144:159], v[60:63], v[52:55], v[144:159]
    v_dot2c_f32_bf16 v23, v51, v51
    s_waitcnt lgkmcnt(0)
    v_mfma_f32_32x32x16_bf16 v[64:79], v[32:35], v[40:43], v[64:79]
    v_dot2c_f32_bf16 v20, s27, v32
    v_dot2c_f32_bf16 v22, v32, v32
    v_mfma_f32_32x32x16_bf16 v[96:111], v[32:35], v[44:47], v[96:111]
    ds_read_b128 v[48:51], v11 offset:32768
    v_dot2c_f32_bf16 v21, s27, v33
    v_mfma_f32_32x32x16_bf16 v[128:143], v[44:47], v[32:35], v[128:143]
    ds_read_b128 v[52:55], v11 offset:36864
    v_dot2c_f32_bf16 v23, v33, v33
    v_mfma_f32_32x32x16_bf16 v[80:95], v[36:39], v[40:43], v[80:95]
    ds_read_b128 v[56:59], v5 offset:34816
    v_dot2c_f32_bf16 v20, s27, v34
    v_dot2c_f32_bf16 v22, v34, v34
    v_mfma_f32_32x32x16_bf16 v[112:127], v[36:39], v[44:47], v[112:127]
    ds_read_b128 v[60:63], v5 offset:35840
    v_dot2c_f32_bf16 v21, s27, v35
    v_mfma_f32_32x32x16_bf16 v[144:159], v[44:47], v[36:39], v[144:159]
    v_dot2c_f32_bf16 v23, v35, v35
    s_waitcnt lgkmcnt(0)
    v_mfma_f32_32x32x16_bf16 v[64:79], v[48:51], v[56:59], v[64:79]
    v_dot2c_f32_bf16 v20, s27, v48
    v_dot2c_f32_bf16 v22, v48, v48
    v_mfma_f32_32x32x16_bf16 v[96:111], v[48:51], v[60:63], v[96:111]
    ds_read_b128 v[32:35], v12 offset:32768
    v_dot2c_f32_bf16 v21, s27, v49
    v_mfma_f32_32x32x16_bf16 v[128:143], v[60:63], v[48:51], v[128:143]
    ds_read_b128 v[36:39], v12 offset:36864
    v_dot2c_f32_bf16 v23, v49, v49
    v_mfma_f32_32x32x16_bf16 v[80:95], v[52:55], v[56:59], v[80:95]
    ds_read_b128 v[40:43], v5 offset:36864
    v_dot2c_f32_bf16 v20, s27, v50
    v_dot2c_f32_bf16 v22, v50, v50
    v_mfma_f32_32x32x16_bf16 v[112:127], v[52:55], v[60:63], v[112:127]
    ds_read_b128 v[44:47], v5 offset:37888
    v_dot2c_f32_bf16 v21, s27, v51
    v_mfma_f32_32x32x16_bf16 v[144:159], v[60:63], v[52:55], v[144:159]
    v_dot2c_f32_bf16 v23, v51, v51
    s_waitcnt lgkmcnt(0)
    v_mfma_f32_32x32x16_bf16 v[64:79], v[32:35], v[40:43], v[64:79]
    v_dot2c_f32_bf16 v20, s27, v32
    v_dot2c_f32_bf16 v22, v32, v32
    v_mfma_f32_32x32x16_bf16 v[96:111], v[32:35], v[44:47], v[96:111]
    ds_read_b128 v[48:51], v13 offset:32768
    v_dot2c_f32_bf16 v21, s27, v33
    v_mfma_f32_32x32x16_bf16 v[128:143], v[44:47], v[32:35], v[128:143]
    ds_read_b128 v[52:55], v13 offset:36864
    v_dot2c_f32_bf16 v23, v33, v33
    v_mfma_f32_32x32x16_bf16 v[80:95], v[36:39], v[40:43], v[80:95]
    ds_read_b128 v[56:59], v5 offset:38912
    v_dot2c_f32_bf16 v20, s27, v34
    v_dot2c_f32_bf16 v22, v34, v34
    v_mfma_f32_32x32x16_bf16 v[112:127], v[36:39], v[44:47], v[112:127]
    ds_read_b128 v[60:63], v5 offset:39936
    v_dot2c_f32_bf16 v21, s27, v35
    v_mfma_f32_32x32x16_bf16 v[144:159], v[44:47], v[36:39], v[144:159]
    v_dot2c_f32_bf16 v23, v35, v35
    s_waitcnt vmcnt(8)
    s_barrier
    s_waitcnt lgkmcnt(0)
    v_mfma_f32_32x32x16_bf16 v[64:79], v[48:51], v[56:59], v[64:79]
    v_dot2c_f32_bf16 v20, s27, v48
    v_dot2c_f32_bf16 v22, v48, v48
    v_mfma_f32_32x32x16_bf16 v[96:111], v[48:51], v[60:63], v[96:111]
    ds_read_b128 v[32:35], v6 offset:0
    v_dot2c_f32_bf16 v21, s27, v49
    v_mfma_f32_32x32x16_bf16 v[128:143], v[60:63], v[48:51], v[128:143]
    ds_read_b128 v[36:39], v6 offset:4096
    v_dot2c_f32_bf16 v23, v49, v49
    v_mfma_f32_32x32x16_bf16 v[80:95], v[52:55], v[56:59], v[80:95]
    ds_read_b128 v[40:43], v4 offset:0
    v_dot2c_f32_bf16 v20, s27, v50
    v_dot2c_f32_bf16 v22, v50, v50
    v_mfma_f32_32x32x16_bf16 v[112:127], v[52:55], v[60:63], v[112:127]
    ds_read_b128 v[44:47], v4 offset:1024
    v_dot2c_f32_bf16 v21, s27, v51
    v_mfma_f32_32x32x16_bf16 v[144:159], v[60:63], v[52:55], v[144:159]
    v_dot2c_f32_bf16 v23, v51, v51
    s_waitcnt lgkmcnt(0)
    v_mfma_f32_32x32x16_bf16 v[64:79], v[32:35], v[40:43], v[64:79]
    v_dot2c_f32_bf16 v20, s27, v32
    v_dot2c_f32_bf16 v22, v32, v32
    v_mfma_f32_32x32x16_bf16 v[96:111], v[32:35], v[44:47], v[96:111]
    ds_read_b128 v[48:51], v7 offset:0
    v_dot2c_f32_bf16 v21, s27, v33
    v_mfma_f32_32x32x16_bf16 v[128:143], v[44:47], v[32:35], v[128:143]
    ds_read_b128 v[52:55], v7 offset:4096
    v_dot2c_f32_bf16 v23, v33, v33
    v_mfma_f32_32x32x16_bf16 v[80:95], v[36:39], v[40:43], v[80:95]
    ds_read_b128 v[56:59], v4 offset:2048
    v_dot2c_f32_bf16 v20, s27, v34
    v_dot2c_f32_bf16 v22, v34, v34
    v_mfma_f32_32x32x16_bf16 v[112:127], v[36:39], v[44:47], v[112:127]
    ds_read_b128 v[60:63], v4 offset:3072
    v_dot2c_f32_bf16 v21, s27, v35
    v_mfma_f32_32x32x16_bf16 v[144:159], v[44:47], v[36:39], v[144:159]
    v_dot2c_f32_bf16 v23, v35, v35
    s_waitcnt lgkmcnt(0)
    v_mfma_f32_32x32x16_bf16 v[64:79], v[48:51], v[56:59], v[64:79]
    v_dot2c_f32_bf16 v20, s27, v48
    v_dot2c_f32_bf16 v22, v48, v48
    v_mfma_f32_32x32x16_bf16 v[96:111], v[48:51], v[60:63], v[96:111]
    ds_read_b128 v[32:35], v8 offset:0
    v_dot2c_f32_bf16 v21, s27, v49
    v_mfma_f32_32x32x16_bf16 v[128:143], v[60:63], v[48:51], v[128:143]
    ds_read_b128 v[36:39], v8 offset:4096
    v_dot2c_f32_bf16 v23, v49, v49
    v_mfma_f32_32x32x16_bf16 v[80:95], v[52:55], v[56:59], v[80:95]
    ds_read_b128 v[40:43], v4 offset:4096
    v_dot2c_f32_bf16 v20, s27, v50
    v_dot2c_f32_bf16 v22, v50, v50
    v_mfma_f32_32x32x16_bf16 v[112:127], v[52:55], v[60:63], v[112:127]
    ds_read_b128 v[44:47], v4 offset:5120
    v_dot2c_f32_bf16 v21, s27, v51
    v_mfma_f32_32x32x16_bf16 v[144:159], v[60:63], v[52:55], v[144:159]
    v_dot2c_f32_bf16 v23, v51, v51
    s_waitcnt lgkmcnt(0)
    v_mfma_f32_32x32x16_bf16 v[64:79], v[32:35], v[40:43], v[64:79]
    v_dot2c_f32_bf16 v20, s27, v32
    v_dot2c_f32_bf16 v22, v32, v32
    v_mfma_f32_32x32x16_bf16 v[96:111], v[32:35], v[44:47], v[96:111]
    ds_read_b128 v[48:51], v9 offset:0
    v_dot2c_f32_bf16 v21, s27, v33
    v_mfma_f32_32x32x16_bf16 v[128:143], v[44:47], v[32:35], v[128:143]
    ds_read_b128 v[52:55], v9 offset:4096
    v_dot2c_f32_bf16 v23, v33, v33
    v_mfma_f32_32x32x16_bf16 v[80:95], v[36:39], v[40:43], v[80:95]
    ds_read_b128 v[56:59], v4 offset:6144
    v_dot2c_f32_bf16 v20, s27, v34
    v_dot2c_f32_bf16 v22, v34, v34
    v_mfma_f32_32x32x16_bf16 v[112:127], v[36:39], v[44:47], v[112:127]
    ds_read_b128 v[60:63], v4 offset:7168
    v_dot2c_f32_bf16 v21, s27, v35
    v_mfma_f32_32x32x16_bf16 v[144:159], v[44:47], v[36:39], v[144:159]
    v_dot2c_f32_bf16 v23, v35, v35
    s_waitcnt vmcnt(0)
    s_barrier
    s_waitcnt lgkmcnt(0)
    v_mfma_f32_32x32x16_bf16 v[64:79], v[48:51], v[56:59], v[64:79]
    v_dot2c_f32_bf16 v20, s27, v48
    v_dot2c_f32_bf16 v22, v48, v48
    v_mfma_f32_32x32x16_bf16 v[96:111], v[48:51], v[60:63], v[96:111]
    ds_read_b128 v[32:35], v6 offset:32768
    v_dot2c_f32_bf16 v21, s27, v49
    v_mfma_f32_32x32x16_bf16 v[128:143], v[60:63], v[48:51], v[128:143]
    ds_read_b128 v[36:39], v6 offset:36864
    v_dot2c_f32_bf16 v23, v49, v49
    v_mfma_f32_32x32x16_bf16 v[80:95], v[52:55], v[56:59], v[80:95]
    ds_read_b128 v[40:43], v4 offset:32768
    v_dot2c_f32_bf16 v20, s27, v50
    v_dot2c_f32_bf16 v22, v50, v50
    v_mfma_f32_32x32x16_bf16 v[112:127], v[52:55], v[60:63], v[112:127]
    ds_read_b128 v[44:47], v4 offset:33792
    v_dot2c_f32_bf16 v21, s27, v51
    v_mfma_f32_32x32x16_bf16 v[144:159], v[60:63], v[52:55], v[144:159]
    v_dot2c_f32_bf16 v23, v51, v51
    s_waitcnt lgkmcnt(0)
    v_mfma_f32_32x32x16_bf16 v[64:79], v[32:35], v[40:43], v[64:79]
    v_dot2c_f32_bf16 v20, s27, v32
    v_dot2c_f32_bf16 v22, v32, v32
    v_mfma_f32_32x32x16_bf16 v[96:111], v[32:35], v[44:47], v[96:111]
    ds_read_b128 v[48:51], v7 offset:32768
    v_dot2c_f32_bf16 v21, s27, v33
    v_mfma_f32_32x32x16_bf16 v[128:143], v[44:47], v[32:35], v[128:143]
    ds_read_b128 v[52:55], v7 offset:36864
    v_dot2c_f32_bf16 v23, v33, v33
    v_mfma_f32_32x32x16_bf16 v[80:95], v[36:39], v[40:43], v[80:95]
    ds_read_b128 v[56:59], v4 offset:34816
    v_dot2c_f32_bf16 v20, s27, v34
    v_dot2c_f32_bf16 v22, v34, v34
    v_mfma_f32_32x32x16_bf16 v[112:127], v[36:39], v[44:47], v[112:127]
    ds_read_b128 v[60:63], v4 offset:35840
    v_dot2c_f32_bf16 v21, s27, v35
    v_mfma_f32_32x32x16_bf16 v[144:159], v[44:47], v[36:39], v[144:159]
    v_dot2c_f32_bf16 v23, v35, v35
    s_waitcnt lgkmcnt(0)
    v_mfma_f32_32x32x16_bf16 v[64:79], v[48:51], v[56:59], v[64:79]
    v_dot2c_f32_bf16 v20, s27, v48
    v_dot2c_f32_bf16 v22, v48, v48
    v_mfma_f32_32x32x16_bf16 v[96:111], v[48:51], v[60:63], v[96:111]
    ds_read_b128 v[32:35], v8 offset:32768
    v_dot2c_f32_bf16 v21, s27, v49
    v_mfma_f32_32x32x16_bf16 v[128:143], v[60:63], v[48:51], v[128:143]
    ds_read_b128 v[36:39], v8 offset:36864
    v_dot2c_f32_bf16 v23, v49, v49
    v_mfma_f32_32x32x16_bf16 v[80:95], v[52:55], v[56:59], v[80:95]
    ds_read_b128 v[40:43], v4 offset:36864
    v_dot2c_f32_bf16 v20, s27, v50
    v_dot2c_f32_bf16 v22, v50, v50
    v_mfma_f32_32x32x16_bf16 v[112:127], v[52:55], v[60:63], v[112:127]
    ds_read_b128 v[44:47], v4 offset:37888
    v_dot2c_f32_bf16 v21, s27, v51
    v_mfma_f32_32x32x16_bf16 v[144:159], v[60:63], v[52:55], v[144:159]
    v_dot2c_f32_bf16 v23, v51, v51
    s_waitcnt lgkmcnt(0)
    v_mfma_f32_32x32x16_bf16 v[64:79], v[32:35], v[40:43], v[64:79]
    v_dot2c_f32_bf16 v20, s27, v32
    v_dot2c_f32_bf16 v22, v32, v32
    v_mfma_f32_32x32x16_bf16 v[96:111], v[32:35], v[44:47], v[96:111]
    ds_read_b128 v[48:51], v9 offset:32768
    v_dot2c_f32_bf16 v21, s27, v33
    v_mfma_f32_32x32x16_bf16 v[128:143], v[44:47], v[32:35], v[128:143]
    ds_read_b128 v[52:55], v9 offset:36864
    v_dot2c_f32_bf16 v23, v33, v33
    v_mfma_f32_32x32x16_bf16 v[80:95], v[36:39], v[40:43], v[80:95]
    ds_read_b128 v[56:59], v4 offset:38912
    v_dot2c_f32_bf16 v20, s27, v34
    v_dot2c_f32_bf16 v22, v34, v34
    v_mfma_f32_32x32x16_bf16 v[112:127], v[36:39], v[44:47], v[112:127]
    ds_read_b128 v[60:63], v4 offset:39936
    v_dot2c_f32_bf16 v21, s27, v35
    v_mfma_f32_32x32x16_bf16 v[144:159], v[44:47], v[36:39], v[144:159]
    v_dot2c_f32_bf16 v23, v35, v35
    s_waitcnt lgkmcnt(0)
    v_mfma_f32_32x32x16_bf16 v[64:79], v[48:51], v[56:59], v[64:79]
    v_dot2c_f32_bf16 v20, s27, v48
    v_dot2c_f32_bf16 v22, v48, v48
    v_mfma_f32_32x32x16_bf16 v[96:111], v[48:51], v[60:63], v[96:111]
    v_dot2c_f32_bf16 v21, s27, v49
    v_mfma_f32_32x32x16_bf16 v[128:143], v[60:63], v[48:51], v[128:143]
    v_dot2c_f32_bf16 v23, v49, v49
    v_mfma_f32_32x32x16_bf16 v[80:95], v[52:55], v[56:59], v[80:95]
    v_dot2c_f32_bf16 v20, s27, v50
    v_dot2c_f32_bf16 v22, v50, v50
    v_mfma_f32_32x32x16_bf16 v[112:127], v[52:55], v[60:63], v[112:127]
    v_dot2c_f32_bf16 v21, s27, v51
    v_mfma_f32_32x32x16_bf16 v[144:159], v[60:63], v[52:55], v[144:159]
    v_dot2c_f32_bf16 v23, v51, v51
    s_branch afront1_kernel_af_epi
afront1_kernel_af_h1:
    s_waitcnt lgkmcnt(0)
    v_mfma_f32_32x32x16_bf16 v[64:79], v[32:35], v[40:43], 0
    v_dot2c_f32_bf16 v20, s27, v36
    v_dot2c_f32_bf16 v22, v36, v36
    v_mfma_f32_32x32x16_bf16 v[96:111], v[32:35], v[44:47], 0
    ds_read_b128 v[48:51], v7 offset:0
    v_dot2c_f32_bf16 v21, s27, v37
    v_mfma_f32_32x32x16_bf16 v[128:143], v[44:47], v[32:35], 0
    ds_read_b128 v[52:55], v7 offset:4096
    v_dot2c_f32_bf16 v23, v37, v37
    v_mfma_f32_32x32x16_bf16 v[80:95], v[36:39], v[40:43], 0
    ds_read_b128 v[56:59], v4 offset:2048
    v_dot2c_f32_bf16 v20, s27, v38
    v_dot2c_f32_bf16 v22, v38, v38
    v_mfma_f32_32x32x16_bf16 v[112:127], v[36:39], v[44:47], 0
    ds_read_b128 v[60:63], v4 offset:3072
    v_dot2c_f32_bf16 v21, s27, v39
    v_mfma_f32_32x32x16_bf16 v[144:159], v[44:47], v[36:39], 0
    v_dot2c_f32_bf16 v23, v39, v39
    s_waitcnt lgkmcnt(0)
    v_mfma_f32_32x32x16_bf16 v[64:79], v[48:51], v[56:59], v[64:79]
    v_dot2c_f32_bf16 v20, s27, v52
    v_dot2c_f32_bf16 v22, v52, v52
    v_mfma_f32_32x32x16_bf16 v[96:111], v[48:51], v[60:63], v[96:111]
    ds_read_b128 v[32:35], v8 offset:0
    v_dot2c_f32_bf16 v21, s27, v53
    v_mfma_f32_32x32x16_bf16 v[128:143], v[60:63], v[48:51], v[128:143]
    ds_read_b128 v[36:39], v8 offset:4096
    v_dot2c_f32_bf16 v23, v53, v53
    v_mfma_f32_32x32x16_bf16 v[80:95], v[52:55], v[56:59], v[80:95]
    ds_read_b128 v[40:43], v4 offset:4096
    v_dot2c_f32_bf16 v20, s27, v54
    v_dot2c_f32_bf16 v22, v54, v54
    v_mfma_f32_32x32x16_bf16 v[112:127], v[52:55], v[60:63], v[112:127]
    ds_read_b128 v[44:47], v4 offset:5120
    v_dot2c_f32_bf16 v21, s27, v55
    v_mfma_f32_32x32x16_bf16 v[144:159], v[60:63], v[52:55], v[144:159]
    v_dot2c_f32_bf16 v23, v55, v55
    s_waitcnt lgkmcnt(0)
    v_mfma_f32_32x32x16_bf16 v[64:79], v[32:35], v[40:43], v[64:79]
    v_dot2c_f32_bf16 v20, s27, v36
    v_dot2c_f32_bf16 v22, v36, v36
    v_mfma_f32_32x32x16_bf16 v[96:111], v[32:35], v[44:47], v[96:111]
    ds_read_b128 v[48:51], v9 offset:0
    v_dot2c_f32_bf16 v21, s27, v37
    v_mfma_f32_32x32x16_bf16 v[128:143], v[44:47], v[32:35], v[128:143]
    ds_read_b128 v[52:55], v9 offset:4096
    v_dot2c_f32_bf16 v23, v37, v37
    v_mfma_f32_32x32x16_bf16 v[80:95], v[36:39], v[40:43], v[80:95]
    ds_read_b128 v[56:59], v4 offset:6144
    v_dot2c_f32_bf16 v20, s27, v38
    v_dot2c_f32_bf16 v22, v38, v38
    v_mfma_f32_32x32x16_bf16 v[112:127], v[36:39], v[44:47], v[112:127]
    ds_read_b128 v[60:63], v4 offset:7168
    v_dot2c_f32_bf16 v21, s27, v39
    v_mfma_f32_32x32x16_bf16 v[144:159], v[44:47], v[36:39], v[144:159]
    v_dot2c_f32_bf16 v23, v39, v39
    s_waitcnt vmcnt(8)
    s_barrier
    s_lshl_b32 s28, s13, 12
    s_add_u32 s28, s28, 98304
    s_mov_b32 m0, s28
    s_add_u32 s29, s24, 384
    buffer_load_dwordx4 v2, s[16:19], s29 offen offset:0 lds
    s_add_u32 s29, s29, 9216
    buffer_load_dwordx4 v3, s[16:19], s29 offen offset:1024 lds
    s_add_u32 s29, s29, 9216
    buffer_load_dwordx4 v2, s[16:19], s29 offen offset:2048 lds
    s_add_u32 s29, s29, 9216
    buffer_load_dwordx4 v3, s[16:19], s29 offen offset:3072 lds
    s_add_u32 s28, s28, 16384
    s_mov_b32 m0, s28
    s_add_u32 s29, s25, 24576
    buffer_load_dwordx4 v1, s[8:11], s29 offen offset:0 lds
    buffer_load_dwordx4 v1, s[8:11], s29 offen offset:1024 lds
    buffer_load_dwordx4 v1, s[8:11], s29 offen offset:2048 lds
    buffer_load_dwordx4 v1, s[8:11], s29 offen offset:3072 lds
    s_waitcnt lgkmcnt(0)
    v_mfma_f32_32x32x16_bf16 v[64:79], v[48:51], v[56:59], v[64:79]
    v_dot2c_f32_bf16 v20, s27, v52
    v_dot2c_f32_bf16 v22, v52, v52
    v_mfma_f32_32x32x16_bf16 v[96:111], v[48:51], v[60:63], v[96:111]
    ds_read_b128 v[32:35], v6 offset:32768
    v_dot2c_f32_bf16 v21, s27, v53
    v_mfma_f32_32x32x16_bf16 v[128:143], v[60:63], v[48:51], v[128:143]
    ds_read_b128 v[36:39], v6 offset:36864
    v_dot2c_f32_bf16 v23, v53, v53
    v_mfma_f32_32x32x16_bf16 v[80:95], v[52:55], v[56:59], v[80:95]
    ds_read_b128 v[40:43], v4 offset:32768
    v_dot2c_f32_bf16 v20, s27, v54
    v_dot2c_f32_bf16 v22, v54, v54
    v_mfma_f32_32x32x16_bf16 v[112:127], v[52:55], v[60:63], v[112:127]
    ds_read_b128 v[44:47], v4 offset:33792
    v_dot2c_f32_bf16 v21, s27, v55
    v_mfma_f32_32x32x16_bf16 v[144:159], v[60:63], v[52:55], v[144:159]
    v_dot2c_f32_bf16 v23, v55, v55
    s_waitcnt lgkmcnt(0)
    v_mfma_f32_32x32x16_bf16 v[64:79], v[32:35], v[40:43], v[64:79]
    v_dot2c_f32_bf16 v20, s27, v36
    v_dot2c_f32_bf16 v22, v36, v36
    v_mfma_f32_32x32x16_bf16 v[96:111], v[32:35], v[44:47], v[96:111]
    ds_read_b128 v[48:51], v7 offset:32768
    v_dot2c_f32_bf16 v21, s27, v37
    v_mfma_f32_32x32x16_bf16 v[128:143], v[44:47], v[32:35], v[128:143]
    ds_read_b128 v[52:55], v7 offset:36864
    v_dot2c_f32_bf16 v23, v37, v37
    v_mfma_f32_32x32x16_bf16 v[80:95], v[36:39], v[40:43], v[80:95]
    ds_read_b128 v[56:59], v4 offset:34816
    v_dot2c_f32_bf16 v20, s27, v38
    v_dot2c_f32_bf16 v22, v38, v38
    v_mfma_f32_32x32x16_bf16 v[112:127], v[36:39], v[44:47], v[112:127]
    ds_read_b128 v[60:63], v4 offset:35840
    v_dot2c_f32_bf16 v21, s27, v39
    v_mfma_f32_32x32x16_bf16 v[144:159], v[44:47], v[36:39], v[144:159]
    v_dot2c_f32_bf16 v23, v39, v39
    s_waitcnt lgkmcnt(0)
    v_mfma_f32_32x32x16_bf16 v[64:79], v[48:51], v[56:59], v[64:79]
    v_dot2c_f32_bf16 v20, s27, v52
    v_dot2c_f32_bf16 v22, v52, v52
    v_mfma_f32_32x32x16_bf16 v[96:111], v[48:51], v[60:63], v[96:111]
    ds_read_b128 v[32:35], v8 offset:32768
    v_dot2c_f32_bf16 v21, s27, v53
    v_mfma_f32_32x32x16_bf16 v[128:143], v[60:63], v[48:51], v[128:143]
    ds_read_b128 v[36:39], v8 offset:36864
    v_dot2c_f32_bf16 v23, v53, v53
    v_mfma_f32_32x32x16_bf16 v[80:95], v[52:55], v[56:59], v[80:95]
    ds_read_b128 v[40:43], v4 offset:36864
    v_dot2c_f32_bf16 v20, s27, v54
    v_dot2c_f32_bf16 v22, v54, v54
    v_mfma_f32_32x32x16_bf16 v[112:127], v[52:55], v[60:63], v[112:127]
    ds_read_b128 v[44:47], v4 offset:37888
    v_dot2c_f32_bf16 v21, s27, v55
    v_mfma_f32_32x32x16_bf16 v[144:159], v[60:63], v[52:55], v[144:159]
    v_dot2c_f32_bf16 v23, v55, v55
    s_waitcnt lgkmcnt(0)
    v_mfma_f32_32x32x16_bf16 v[64:79], v[32:35], v[40:43], v[64:79]
    v_dot2c_f32_bf16 v20, s27, v36
    v_dot2c_f32_bf16 v22, v36, v36
    v_mfma_f32_32x32x16_bf16 v[96:111], v[32:35], v[44:47], v[96:111]
    ds_read_b128 v[48:51], v9 offset:32768
    v_dot2c_f32_bf16 v21, s27, v37
    v_mfma_f32_32x32x16_bf16 v[128:143], v[44:47], v[32:35], v[128:143]
    ds_read_b128 v[52:55], v9 offset:36864
    v_dot2c_f32_bf16 v23, v37, v37
    v_mfma_f32_32x32x16_bf16 v[80:95], v[36:39], v[40:43], v[80:95]
    ds_read_b128 v[56:59], v4 offset:38912
    v_dot2c_f32_bf16 v20, s27, v38
    v_dot2c_f32_bf16 v22, v38, v38
    v_mfma_f32_32x32x16_bf16 v[112:127], v[36:39], v[44:47], v[112:127]
    ds_read_b128 v[60:63], v4 offset:39936
    v_dot2c_f32_bf16 v21, s27, v39
    v_mfma_f32_32x32x16_bf16 v[144:159], v[44:47], v[36:39], v[144:159]
    v_dot2c_f32_bf16 v23, v39, v39
    s_waitcnt vmcnt(8)
    s_barrier
    s_lshl_b32 s28, s13, 12
    s_mov_b32 m0, s28
    s_add_u32 s29, s24, 512
    buffer_load_dwordx4 v2, s[16:19], s29 offen offset:0 lds
    s_add_u32 s29, s29, 9216
    buffer_load_dwordx4 v3, s[16:19], s29 offen offset:1024 lds
    s_add_u32 s29, s29, 9216
    buffer_load_dwordx4 v2, s[16:19], s29 offen offset:2048 lds
    s_add_u32 s29, s29, 9216
    buffer_load_dwordx4 v3, s[16:19], s29 offen offset:3072 lds
    s_add_u32 s28, s28, 16384
    s_mov_b32 m0, s28
    s_add_u32 s29, s25, 32768
    buffer_load_dwordx4 v1, s[8:11], s29 offen offset:0 lds
    buffer_load_dwordx4 v1, s[8:11], s29 offen offset:1024 lds
    buffer_load_dwordx4 v1, s[8:11], s29 offen offset:2048 lds
    buffer_load_dwordx4 v1, s[8:11], s29 offen offset:3072 lds
    s_waitcnt lgkmcnt(0)
    v_mfma_f32_32x32x16_bf16 v[64:79], v[48:51], v[56:59], v[64:79]
    v_dot2c_f32_bf16 v20, s27, v52
    v_dot2c_f32_bf16 v22, v52, v52
    v_mfma_f32_32x32x16_bf16 v[96:111], v[48:51], v[60:63], v[96:111]
    ds_read_b128 v[32:35], v10 offset:0
    v_dot2c_f32_bf16 v21, s27, v53
    v_mfma_f32_32x32x16_bf16 v[128:143], v[60:63], v[48:51], v[128:143]
    ds_read_b128 v[36:39], v10 offset:4096
    v_dot2c_f32_bf16 v23, v53, v53
    v_mfma_f32_32x32x16_bf16 v[80:95], v[52:55], v[56:59], v[80:95]
    ds_read_b128 v[40:43], v5 offset:0
    v_dot2c_f32_bf16 v20, s27, v54
    v_dot2c_f32_bf16 v22, v54, v54
    v_mfma_f32_32x32x16_bf16 v[112:127], v[52:55], v[60:63], v[112:127]
    ds_read_b128 v[44:47], v5 offset:1024
    v_dot2c_f32_bf16 v21, s27, v55
    v_mfma_f32_32x32x16_bf16 v[144:159], v[60:63], v[52:55], v[144:159]
    v_dot2c_f32_bf16 v23, v55, v55
    s_waitcnt lgkmcnt(0)
    v_mfma_f32_32x32x16_bf16 v[64:79], v[32:35], v[40:43], v[64:79]
    v_dot2c_f32_bf16 v20, s27, v36
    v_dot2c_f32_bf16 v22, v36, v36
    v_mfma_f32_32x32x16_bf16 v[96:111], v[32:35], v[44:47], v[96:111]
    ds_read_b128 v[48:51], v11 offset:0
    v_dot2c_f32_bf16 v21, s27, v37
    v_mfma_f32_32x32x16_bf16 v[128:143], v[44:47], v[32:35], v[128:143]
    ds_read_b128 v[52:55], v11 offset:4096
    v_dot2c_f32_bf16 v23, v37, v37
    v_mfma_f32_32x32x16_bf16 v[80:95], v[36:39], v[40:43], v[80:95]
    ds_read_b128 v[56:59], v5 offset:2048
    v_dot2c_f32_bf16 v20, s27, v38
    v_dot2c_f32_bf16 v22, v38, v38
    v_mfma_f32_32x32x16_bf16 v[112:127], v[36:39], v[44:47], v[112:127]
    ds_read_b128 v[60:63], v5 offset:3072
    v_dot2c_f32_bf16 v21, s27, v39
    v_mfma_f32_32x32x16_bf16 v[144:159], v[44:47], v[36:39], v[144:159]
    v_dot2c_f32_bf16 v23, v39, v39
    s_waitcnt lgkmcnt(0)
    v_mfma_f32_32x32x16_bf16 v[64:79], v[48:51], v[56:59], v[64:79]
    v_dot2c_f32_bf16 v20, s27, v52
    v_dot2c_f32_bf16 v22, v52, v52
    v_mfma_f32_32x32x16_bf16 v[96:111], v[48:51], v[60:63], v[96:111]
    ds_read_b128 v[32:35], v12 offset:0
    v_dot2c_f32_bf16 v21, s27, v53
    v_mfma_f32_32x32x16_bf16 v[128:143], v[60:63], v[48:51], v[128:143]
    ds_read_b128 v[36:39], v12 offset:4096
    v_dot2c_f32_bf16 v23, v53, v53
    v_mfma_f32_32x32x16_bf16 v[80:95], v[52:55], v[56:59], v[80:95]
    ds_read_b128 v[40:43], v5 offset:4096
    v_dot2c_f32_bf16 v20, s27, v54
    v_dot2c_f32_bf16 v22, v54, v54
    v_mfma_f32_32x32x16_bf16 v[112:127], v[52:55], v[60:63], v[112:127]
    ds_read_b128 v[44:47], v5 offset:5120
    v_dot2c_f32_bf16 v21, s27, v55
    v_mfma_f32_32x32x16_bf16 v[144:159], v[60:63], v[52:55], v[144:159]
    v_dot2c_f32_bf16 v23, v55, v55
    s_waitcnt lgkmcnt(0)
    v_mfma_f32_32x32x16_bf16 v[64:79], v[32:35], v[40:43], v[64:79]
    v_dot2c_f32_bf16 v20, s27, v36
    v_dot2c_f32_bf16 v22, v36, v36
    v_mfma_f32_32x32x16_bf16 v[96:111], v[32:35], v[44:47], v[96:111]
    ds_read_b128 v[48:51], v13 offset:0
    v_dot2c_f32_bf16 v21, s27, v37
    v_mfma_f32_32x32x16_bf16 v[128:143], v[44:47], v[32:35], v[128:143]
    ds_read_b128 v[52:55], v13 offset:4096
    v_dot2c_f32_bf16 v23, v37, v37
    v_mfma_f32_32x32x16_bf16 v[80:95], v[36:39], v[40:43], v[80:95]
    ds_read_b128 v[56:59], v5 offset:6144
    v_dot2c_f32_bf16 v20, s27, v38
    v_dot2c_f32_bf16 v22, v38, v38
    v_mfma_f32_32x32x16_bf16 v[112:127], v[36:39], v[44:47], v[112:127]
    ds_read_b128 v[60:63], v5 offset:7168
    v_dot2c_f32_bf16 v21, s27, v39
    v_mfma_f32_32x32x16_bf16 v[144:159], v[44:47], v[36:39], v[144:159]
    v_dot2c_f32_bf16 v23, v39, v39
    s_waitcnt vmcnt(8)
    s_barrier
    s_lshl_b32 s28, s13, 12
    s_add_u32 s28, s28, 32768
    s_mov_b32 m0, s28
    s_add_u32 s29, s24, 640
    buffer_load_dwordx4 v2, s[16:19], s29 offen offset:0 lds
    s_add_u32 s29, s29, 9216
    buffer_load_dwordx4 v3, s[16:19], s29 offen offset:1024 lds
    s_add_u32 s29, s29, 9216
    buffer_load_dwordx4 v2, s[16:19], s29 offen offset:2048 lds
    s_add_u32 s29, s29, 9216
    buffer_load_dwordx4 v3, s[16:19], s29 offen offset:3072 lds
    s_add_u32 s28, s28, 16384
    s_mov_b32 m0, s28
    s_add_u32 s29, s25, 40960
    buffer_load_dwordx4 v1, s[8:11], s29 offen offset:0 lds
    buffer_load_dwordx4 v1, s[8:11], s29 offen offset:1024 lds
    buffer_load_dwordx4 v1, s[8:11], s29 offen offset:2048 lds
    buffer_load_dwordx4 v1, s[8:11], s29 offen offset:3072 lds
    s_waitcnt lgkmcnt(0)
    v_mfma_f32_32x32x16_bf16 v[64:79], v[48:51], v[56:59], v[64:79]
    v_dot2c_f32_bf16 v20, s27, v52
    v_dot2c_f32_bf16 v22, v52, v52
    v_mfma_f32_32x32x16_bf16 v[96:111], v[48:51], v[60:63], v[96:111]
    ds_read_b128 v[32:35], v10 offset:32768
    v_dot2c_f32_bf16 v21, s27, v53
    v_mfma_f32_32x32x16_bf16 v[128:143], v[60:63], v[48:51], v[128:143]
    ds_read_b128 v[36:39], v10 offset:36864
    v_dot2c_f32_bf16 v23, v53, v53
    v_mfma_f32_32x32x16_bf16 v[80:95], v[52:55], v[56:59], v[80:95]
    ds_read_b128 v[40:43], v5 offset:32768
    v_dot2c_f32_bf16 v20, s27, v54
    v_dot2c_f32_bf16 v22, v54, v54
    v_mfma_f32_32x32x16_bf16 v[112:127], v[52:55], v[60:63], v[112:127]
    ds_read_b128 v[44:47], v5 offset:33792
    v_dot2c_f32_bf16 v21, s27, v55
    v_mfma_f32_32x32x16_bf16 v[144:159], v[60:63], v[52:55], v[144:159]
    v_dot2c_f32_bf16 v23, v55, v55
    s_waitcnt lgkmcnt(0)
    v_mfma_f32_32x32x16_bf16 v[64:79], v[32:35], v[40:43], v[64:79]
    v_dot2c_f32_bf16 v20, s27, v36
    v_dot2c_f32_bf16 v22, v36, v36
    v_mfma_f32_32x32x16_bf16 v[96:111], v[32:35], v[44:47], v[96:111]
    ds_read_b128 v[48:51], v11 offset:32768
    v_dot2c_f32_bf16 v21, s27, v37
    v_mfma_f32_32x32x16_bf16 v[128:143], v[44:47], v[32:35], v[128:143]
    ds_read_b128 v[52:55], v11 offset:36864
    v_dot2c_f32_bf16 v23, v37, v37
    v_mfma_f32_32x32x16_bf16 v[80:95], v[36:39], v[40:43], v[80:95]
    ds_read_b128 v[56:59], v5 offset:34816
    v_dot2c_f32_bf16 v20, s27, v38
    v_dot2c_f32_bf16 v22, v38, v38
    v_mfma_f32_32x32x16_bf16 v[112:127], v[36:39], v[44:47], v[112:127]
    ds_read_b128 v[60:63], v5 offset:35840
    v_dot2c_f32_bf16 v21, s27, v39
    v_mfma_f32_32x32x16_bf16 v[144:159], v[44:47], v[36:39], v[144:159]
    v_dot2c_f32_bf16 v23, v39, v39
    s_waitcnt lgkmcnt(0)
    v_mfma_f32_32x32x16_bf16 v[64:79], v[48:51], v[56:59], v[64:79]
    v_dot2c_f32_bf16 v20, s27, v52
    v_dot2c_f32_bf16 v22, v52, v52
    v_mfma_f32_32x32x16_bf16 v[96:111], v[48:51], v[60:63], v[96:111]
    ds_read_b128 v[32:35], v12 offset:32768
    v_dot2c_f32_bf16 v21, s27, v53
    v_mfma_f32_32x32x16_bf16 v[128:143], v[60:63], v[48:51], v[128:143]
    ds_read_b128 v[36:39], v12 offset:36864
    v_dot2c_f32_bf16 v23, v53, v53
    v_mfma_f32_32x32x16_bf16 v[80:95], v[52:55], v[56:59], v[80:95]
    ds_read_b128 v[40:43], v5 offset:36864
    v_dot2c_f32_bf16 v20, s27, v54
    v_dot2c_f32_bf16 v22, v54, v54
    v_mfma_f32_32x32x16_bf16 v[112:127], v[52:55], v[60:63], v[112:127]
    ds_read_b128 v[44:47], v5 offset:37888
    v_dot2c_f32_bf16 v21, s27, v55
    v_mfma_f32_32x32x16_bf16 v[144:159], v[60:63], v[52:55], v[144:159]
    v_dot2c_f32_bf16 v23, v55, v55
    s_waitcnt lgkmcnt(0)
    v_mfma_f32_32x32x16_bf16 v[64:79], v[32:35], v[40:43], v[64:79]
    v_dot2c_f32_bf16 v20, s27, v36
    v_dot2c_f32_bf16 v22, v36, v36
    v_mfma_f32_32x32x16_bf16 v[96:111], v[32:35], v[44:47], v[96:111]
    ds_read_b128 v[48:51], v13 offset:32768
    v_dot2c_f32_bf16 v21, s27, v37
    v_mfma_f32_32x32x16_bf16 v[128:143], v[44:47], v[32:35], v[128:143]
    ds_read_b128 v[52:55], v13 offset:36864
    v_dot2c_f32_bf16 v23, v37, v37
    v_mfma_f32_32x32x16_bf16 v[80:95], v[36:39], v[40:43], v[80:95]
    ds_read_b128 v[56:59], v5 offset:38912
    v_dot2c_f32_bf16 v20, s27, v38
    v_dot2c_f32_bf16 v22, v38, v38
    v_mfma_f32_32x32x16_bf16 v[112:127], v[36:39], v[44:47], v[112:127]
    ds_read_b128 v[60:63], v5 offset:39936
    v_dot2c_f32_bf16 v21, s27, v39
    v_mfma_f32_32x32x16_bf16 v[144:159], v[44:47], v[36:39], v[144:159]
    v_dot2c_f32_bf16 v23, v39, v39
    s_waitcnt vmcnt(8)
    s_barrier
    s_lshl_b32 s28, s13, 12
    s_add_u32 s28, s28, 65536
    s_mov_b32 m0, s28
    s_add_u32 s29, s24, 768
    buffer_load_dwordx4 v2, s[16:19], s29 offen offset:0 lds
    s_add_u32 s29, s29, 9216
    buffer_load_dwordx4 v3, s[16:19], s29 offen offset:1024 lds
    s_add_u32 s29, s29, 9216
    buffer_load_dwordx4 v2, s[16:19], s29 offen offset:2048 lds
    s_add_u32 s29, s29, 9216
    buffer_load_dwordx4 v3, s[16:19], s29 offen offset:3072 lds
    s_add_u32 s28, s28, 16384
    s_mov_b32 m0, s28
    s_add_u32 s29, s25, 49152
    buffer_load_dwordx4 v1, s[8:11], s29 offen offset:0 lds
    buffer_load_dwordx4 v1, s[8:11], s29 offen offset:1024 lds
    buffer_load_dwordx4 v1, s[8:11], s29 offen offset:2048 lds
    buffer_load_dwordx4 v1, s[8:11], s29 offen offset:3072 lds
    s_waitcnt lgkmcnt(0)
    v_mfma_f32_32x32x16_bf16 v[64:79], v[48:51], v[56:59], v[64:79]
    v_dot2c_f32_bf16 v20, s27, v52
    v_dot2c_f32_bf16 v22, v52, v52
    v_mfma_f32_32x32x16_bf16 v[96:111], v[48:51], v[60:63], v[96:111]
    ds_read_b128 v[32:35], v6 offset:0
    v_dot2c_f32_bf16 v21, s27, v53
    v_mfma_f32_32x32x16_bf16 v[128:143], v[60:63], v[48:51], v[128:143]
    ds_read_b128 v[36:39], v6 offset:4096
    v_dot2c_f32_bf16 v23, v53, v53
    v_mfma_f32_32x32x16_bf16 v[80:95], v[52:55], v[56:59], v[80:95]
    ds_read_b128 v[40:43], v4 offset:0
    v_dot2c_f32_bf16 v20, s27, v54
    v_dot2c_f32_bf16 v22, v54, v54
    v_mfma_f32_32x32x16_bf16 v[112:127], v[52:55], v[60:63], v[112:127]
    ds_read_b128 v[44:47], v4 offset:1024
    v_dot2c_f32_bf16 v21, s27, v55
    v_mfma_f32_32x32x16_bf16 v[144:159], v[60:63], v[52:55], v[144:159]
    v_dot2c_f32_bf16 v23, v55, v55
    s_waitcnt lgkmcnt(0)
    v_mfma_f32_32x32x16_bf16 v[64:79], v[32:35], v[40:43], v[64:79]
    v_dot2c_f32_bf16 v20, s27, v36
    v_dot2c_f32_bf16 v22, v36, v36
    v_mfma_f32_32x32x16_bf16 v[96:111], v[32:35], v[44:47], v[96:111]
    ds_read_b128 v[48:51], v7 offset:0
    v_dot2c_f32_bf16 v21, s27, v37
    v_mfma_f32_32x32x16_bf16 v[128:143], v[44:47], v[32:35], v[128:143]
    ds_read_b128 v[52:55], v7 offset:4096
    v_dot2c_f32_bf16 v23, v37, v37
    v_mfma_f32_32x32x16_bf16 v[80:95], v[36:39], v[40:43], v[80:95]
    ds_read_b128 v[56:59], v4 offset:2048
    v_dot2c_f32_bf16 v20, s27, v38
    v_dot2c_f32_bf16 v22, v38, v38
    v_mfma_f32_32x32x16_bf16 v[112:127], v[36:39], v[44:47], v[112:127]
    ds_read_b128 v[60:63], v4 offset:3072
    v_dot2c_f32_bf16 v21, s27, v39
    v_mfma_f32_32x32x16_bf16 v[144:159], v[44:47], v[36:39], v[144:159]
    v_dot2c_f32_bf16 v23, v39, v39
    s_waitcnt lgkmcnt(0)
    v_mfma_f32_32x32x16_bf16 v[64:79], v[48:51], v[56:59], v[64:79]
    v_dot2c_f32_bf16 v20, s27, v52
    v_dot2c_f32_bf16 v22, v52, v52
    v_mfma_f32_32x32x16_bf16 v[96:111], v[48:51], v[60:63], v[96:111]
    ds_read_b128 v[32:35], v8 offset:0
    v_dot2c_f32_bf16 v21, s27, v53
    v_mfma_f32_32x32x16_bf16 v[128:143], v[60:63], v[48:51], v[128:143]
    ds_read_b128 v[36:39], v8 offset:4096
    v_dot2c_f32_bf16 v23, v53, v53
    v_mfma_f32_32x32x16_bf16 v[80:95], v[52:55], v[56:59], v[80:95]
    ds_read_b128 v[40:43], v4 offset:4096
    v_dot2c_f32_bf16 v20, s27, v54
    v_dot2c_f32_bf16 v22, v54, v54
    v_mfma_f32_32x32x16_bf16 v[112:127], v[52:55], v[60:63], v[112:127]
    ds_read_b128 v[44:47], v4 offset:5120
    v_dot2c_f32_bf16 v21, s27, v55
    v_mfma_f32_32x32x16_bf16 v[144:159], v[60:63], v[52:55], v[144:159]
    v_dot2c_f32_bf16 v23, v55, v55
    s_waitcnt lgkmcnt(0)
    v_mfma_f32_32x32x16_bf16 v[64:79], v[32:35], v[40:43], v[64:79]
    v_dot2c_f32_bf16 v20, s27, v36
    v_dot2c_f32_bf16 v22, v36, v36
    v_mfma_f32_32x32x16_bf16 v[96:111], v[32:35], v[44:47], v[96:111]
    ds_read_b128 v[48:51], v9 offset:0
    v_dot2c_f32_bf16 v21, s27, v37
    v_mfma_f32_32x32x16_bf16 v[128:143], v[44:47], v[32:35], v[128:143]
    ds_read_b128 v[52:55], v9 offset:4096
    v_dot2c_f32_bf16 v23, v37, v37
    v_mfma_f32_32x32x16_bf16 v[80:95], v[36:39], v[40:43], v[80:95]
    ds_read_b128 v[56:59], v4 offset:6144
    v_dot2c_f32_bf16 v20, s27, v38
    v_dot2c_f32_bf16 v22, v38, v38
    v_mfma_f32_32x32x16_bf16 v[112:127], v[36:39], v[44:47], v[112:127]
    ds_read_b128 v[60:63], v4 offset:7168
    v_dot2c_f32_bf16 v21, s27, v39
    v_mfma_f32_32x32x16_bf16 v[144:159], v[44:47], v[36:39], v[144:159]
    v_dot2c_f32_bf16 v23, v39, v39
    s_waitcnt vmcnt(8)
    s_barrier
    s_lshl_b32 s28, s13, 12
    s_add_u32 s28, s28, 98304
    s_mov_b32 m0, s28
    s_add_u32 s29, s24, 896
    buffer_load_dwordx4 v2, s[16:19], s29 offen offset:0 lds
    s_add_u32 s29, s29, 9216
    buffer_load_dwordx4 v3, s[16:19], s29 offen offset:1024 lds
    s_add_u32 s29, s29, 9216
    buffer_load_dwordx4 v2, s[16:19], s29 offen offset:2048 lds
    s_add_u32 s29, s29, 9216
    buffer_load_dwordx4 v3, s[16:19], s29 offen offset:3072 lds
    s_add_u32 s28, s28, 16384
    s_mov_b32 m0, s28
    s_add_u32 s29, s25, 57344
    buffer_load_dwordx4 v1, s[8:11], s29 offen offset:0 lds
    buffer_load_dwordx4 v1, s[8:11], s29 offen offset:1024 lds
    buffer_load_dwordx4 v1, s[8:11], s29 offen offset:2048 lds
    buffer_load_dwordx4 v1, s[8:11], s29 offen offset:3072 lds
    s_waitcnt lgkmcnt(0)
    v_mfma_f32_32x32x16_bf16 v[64:79], v[48:51], v[56:59], v[64:79]
    v_dot2c_f32_bf16 v20, s27, v52
    v_dot2c_f32_bf16 v22, v52, v52
    v_mfma_f32_32x32x16_bf16 v[96:111], v[48:51], v[60:63], v[96:111]
    ds_read_b128 v[32:35], v6 offset:32768
    v_dot2c_f32_bf16 v21, s27, v53
    v_mfma_f32_32x32x16_bf16 v[128:143], v[60:63], v[48:51], v[128:143]
    ds_read_b128 v[36:39], v6 offset:36864
    v_dot2c_f32_bf16 v23, v53, v53
    v_mfma_f32_32x32x16_bf16 v[80:95], v[52:55], v[56:59], v[80:95]
    ds_read_b128 v[40:43], v4 offset:32768
    v_dot2c_f32_bf16 v20, s27, v54
    v_dot2c_f32_bf16 v22, v54, v54
    v_mfma_f32_32x32x16_bf16 v[112:127], v[52:55], v[60:63], v[112:127]
    ds_read_b128 v[44:47], v4 offset:33792
    v_dot2c_f32_bf16 v21, s27, v55
    v_mfma_f32_32x32x16_bf16 v[144:159], v[60:63], v[52:55], v[144:159]
    v_dot2c_f32_bf16 v23, v55, v55
    s_waitcnt lgkmcnt(0)
    v_mfma_f32_32x32x16_bf16 v[64:79], v[32:35], v[40:43], v[64:79]
    v_dot2c_f32_bf16 v20, s27, v36
    v_dot2c_f32_bf16 v22, v36, v36
    v_mfma_f32_32x32x16_bf16 v[96:111], v[32:35], v[44:47], v[96:111]
    ds_read_b128 v[48:51], v7 offset:32768
    v_dot2c_f32_bf16 v21, s27, v37
    v_mfma_f32_32x32x16_bf16 v[128:143], v[44:47], v[32:35], v[128:143]
    ds_read_b128 v[52:55], v7 offset:36864
    v_dot2c_f32_bf16 v23, v37, v37
    v_mfma_f32_32x32x16_bf16 v[80:95], v[36:39], v[40:43], v[80:95]
    ds_read_b128 v[56:59], v4 offset:34816
    v_dot2c_f32_bf16 v20, s27, v38
    v_dot2c_f32_bf16 v22, v38, v38
    v_mfma_f32_32x32x16_bf16 v[112:127], v[36:39], v[44:47], v[112:127]
    ds_read_b128 v[60:63], v4 offset:35840
    v_dot2c_f32_bf16 v21, s27, v39
    v_mfma_f32_32x32x16_bf16 v[144:159], v[44:47], v[36:39], v[144:159]
    v_dot2c_f32_bf16 v23, v39, v39
    s_waitcnt lgkmcnt(0)
    v_mfma_f32_32x32x16_bf16 v[64:79], v[48:51], v[56:59], v[64:79]
    v_dot2c_f32_bf16 v20, s27, v52
    v_dot2c_f32_bf16 v22, v52, v52
    v_mfma_f32_32x32x16_bf16 v[96:111], v[48:51], v[60:63], v[96:111]
    ds_read_b128 v[32:35], v8 offset:32768
    v_dot2c_f32_bf16 v21, s27, v53
    v_mfma_f32_32x32x16_bf16 v[128:143], v[60:63], v[48:51], v[128:143]
    ds_read_b128 v[36:39], v8 offset:36864
    v_dot2c_f32_bf16 v23, v53, v53
    v_mfma_f32_32x32x16_bf16 v[80:95], v[52:55], v[56:59], v[80:95]
    ds_read_b128 v[40:43], v4 offset:36864
    v_dot2c_f32_bf16 v20, s27, v54
    v_dot2c_f32_bf16 v22, v54, v54
    v_mfma_f32_32x32x16_bf16 v[112:127], v[52:55], v[60:63], v[112:127]
    ds_read_b128 v[44:47], v4 offset:37888
    v_dot2c_f32_bf16 v21, s27, v55
    v_mfma_f32_32x32x16_bf16 v[144:159], v[60:63], v[52:55], v[144:159]
    v_dot2c_f32_bf16 v23, v55, v55
    s_waitcnt lgkmcnt(0)
    v_mfma_f32_32x32x16_bf16 v[64:79], v[32:35], v[40:43], v[64:79]
    v_dot2c_f32_bf16 v20, s27, v36
    v_dot2c_f32_bf16 v22, v36, v36
    v_mfma_f32_32x32x16_bf16 v[96:111], v[32:35], v[44:47], v[96:111]
    ds_read_b128 v[48:51], v9 offset:32768
    v_dot2c_f32_bf16 v21, s27, v37
    v_mfma_f32_32x32x16_bf16 v[128:143], v[44:47], v[32:35], v[128:143]
    ds_read_b128 v[52:55], v9 offset:36864
    v_dot2c_f32_bf16 v23, v37, v37
    v_mfma_f32_32x32x16_bf16 v[80:95], v[36:39], v[40:43], v[80:95]
    ds_read_b128 v[56:59], v4 offset:38912
    v_dot2c_f32_bf16 v20, s27, v38
    v_dot2c_f32_bf16 v22, v38, v38
    v_mfma_f32_32x32x16_bf16 v[112:127], v[36:39], v[44:47], v[112:127]
    ds_read_b128 v[60:63], v4 offset:39936
    v_dot2c_f32_bf16 v21, s27, v39
    v_mfma_f32_32x32x16_bf16 v[144:159], v[44:47], v[36:39], v[144:159]
    v_dot2c_f32_bf16 v23, v39, v39
    s_waitcnt vmcnt(8)
    s_barrier
    s_lshl_b32 s28, s13, 12
    s_mov_b32 m0, s28
    s_add_u32 s29, s24, 1024
    buffer_load_dwordx4 v2, s[16:19], s29 offen offset:0 lds
    s_add_u32 s29, s29, 9216
    buffer_load_dwordx4 v3, s[16:19], s29 offen offset:1024 lds
    s_add_u32 s29, s29, 9216
    buffer_load_dwordx4 v2, s[16:19], s29 offen offset:2048 lds
    s_add_u32 s29, s29, 9216
    buffer_load_dwordx4 v3, s[16:19], s29 offen offset:3072 lds
    s_add_u32 s28, s28, 16384
    s_mov_b32 m0, s28
    s_add_u32 s29, s25, 65536
    buffer_load_dwordx4 v1, s[8:11], s29 offen offset:0 lds
    buffer_load_dwordx4 v1, s[8:11], s29 offen offset:1024 lds
    buffer_load_dwordx4 v1, s[8:11], s29 offen offset:2048 lds
    buffer_load_dwordx4 v1, s[8:11], s29 offen offset:3072 lds
    s_waitcnt lgkmcnt(0)
    v_mfma_f32_32x32x16_bf16 v[64:79], v[48:51], v[56:59], v[64:79]
    v_dot2c_f32_bf16 v20, s27, v52
    v_dot2c_f32_bf16 v22, v52, v52
    v_mfma_f32_32x32x16_bf16 v[96:111], v[48:51], v[60:63], v[96:111]
    ds_read_b128 v[32:35], v10 offset:0
    v_dot2c_f32_bf16 v21, s27, v53
    v_mfma_f32_32x32x16_bf16 v[128:143], v[60:63], v[48:51], v[128:143]
    ds_read_b128 v[36:39], v10 offset:4096
    v_dot2c_f32_bf16 v23, v53, v53
    v_mfma_f32_32x32x16_bf16 v[80:95], v[52:55], v[56:59], v[80:95]
    ds_read_b128 v[40:43], v5 offset:0
    v_dot2c_f32_bf16 v20, s27, v54
    v_dot2c_f32_bf16 v22, v54, v54
    v_mfma_f32_32x32x16_bf16 v[112:127], v[52:55], v[60:63], v[112:127]
    ds_read_b128 v[44:47], v5 offset:1024
    v_dot2c_f32_bf16 v21, s27, v55
    v_mfma_f32_32x32x16_bf16 v[144:159], v[60:63], v[52:55], v[144:159]
    v_dot2c_f32_bf16 v23, v55, v55
    s_waitcnt lgkmcnt(0)
    v_mfma_f32_32x32x16_bf16 v[64:79], v[32:35], v[40:43], v[64:79]
    v_dot2c_f32_bf16 v20, s27, v36
    v_dot2c_f32_bf16 v22, v36, v36
    v_mfma_f32_32x32x16_bf16 v[96:111], v[32:35], v[44:47], v[96:111]
    ds_read_b128 v[48:51], v11 offset:0
    v_dot2c_f32_bf16 v21, s27, v37
    v_mfma_f32_32x32x16_bf16 v[128:143], v[44:47], v[32:35], v[128:143]
    ds_read_b128 v[52:55], v11 offset:4096
    v_dot2c_f32_bf16 v23, v37, v37
    v_mfma_f32_32x32x16_bf16 v[80:95], v[36:39], v[40:43], v[80:95]
    ds_read_b128 v[56:59], v5 offset:2048
    v_dot2c_f32_bf16 v20, s27, v38
    v_dot2c_f32_bf16 v22, v38, v38
    v_mfma_f32_32x32x16_bf16 v[112:127], v[36:39], v[44:47], v[112:127]
    ds_read_b128 v[60:63], v5 offset:3072
    v_dot2c_f32_bf16 v21, s27, v39
    v_mfma_f32_32x32x16_bf16 v[144:159], v[44:47], v[36:39], v[144:159]
    v_dot2c_f32_bf16 v23, v39, v39
    s_waitcnt lgkmcnt(0)
    v_mfma_f32_32x32x16_bf16 v[64:79], v[48:51], v[56:59], v[64:79]
    v_dot2c_f32_bf16 v20, s27, v52
    v_dot2c_f32_bf16 v22, v52, v52
    v_mfma_f32_32x32x16_bf16 v[96:111], v[48:51], v[60:63], v[96:111]
    ds_read_b128 v[32:35], v12 offset:0
    v_dot2c_f32_bf16 v21, s27, v53
    v_mfma_f32_32x32x16_bf16 v[128:143], v[60:63], v[48:51], v[128:143]
    ds_read_b128 v[36:39], v12 offset:4096
    v_dot2c_f32_bf16 v23, v53, v53
    v_mfma_f32_32x32x16_bf16 v[80:95], v[52:55], v[56:59], v[80:95]
    ds_read_b128 v[40:43], v5 offset:4096
    v_dot2c_f32_bf16 v20, s27, v54
    v_dot2c_f32_bf16 v22, v54, v54
    v_mfma_f32_32x32x16_bf16 v[112:127], v[52:55], v[60:63], v[112:127]
    ds_read_b128 v[44:47], v5 offset:5120
    v_dot2c_f32_bf16 v21, s27, v55
    v_mfma_f32_32x32x16_bf16 v[144:159], v[60:63], v[52:55], v[144:159]
    v_dot2c_f32_bf16 v23, v55, v55
    s_waitcnt lgkmcnt(0)
    v_mfma_f32_32x32x16_bf16 v[64:79], v[32:35], v[40:43], v[64:79]
    v_dot2c_f32_bf16 v20, s27, v36
    v_dot2c_f32_bf16 v22, v36, v36
    v_mfma_f32_32x32x16_bf16 v[96:111], v[32:35], v[44:47], v[96:111]
    ds_read_b128 v[48:51], v13 offset:0
    v_dot2c_f32_bf16 v21, s27, v37
    v_mfma_f32_32x32x16_bf16 v[128:143], v[44:47], v[32:35], v[128:143]
    ds_read_b128 v[52:55], v13 offset:4096
    v_dot2c_f32_bf16 v23, v37, v37
    v_mfma_f32_32x32x16_bf16 v[80:95], v[36:39], v[40:43], v[80:95]
    ds_read_b128 v[56:59], v5 offset:6144
    v_dot2c_f32_bf16 v20, s27, v38
    v_dot2c_f32_bf16 v22, v38, v38
    v_mfma_f32_32x32x16_bf16 v[112:127], v[36:39], v[44:47], v[112:127]
    ds_read_b128 v[60:63], v5 offset:7168
    v_dot2c_f32_bf16 v21, s27, v39
    v_mfma_f32_32x32x16_bf16 v[144:159], v[44:47], v[36:39], v[144:159]
    v_dot2c_f32_bf16 v23, v39, v39
    s_waitcnt vmcnt(8)
    s_barrier
    s_lshl_b32 s28, s13, 12
    s_add_u32 s28, s28, 32768
    s_mov_b32 m0, s28
    s_add_u32 s29, s24, 1152
    buffer_load_dwordx4 v2, s[16:19], s29 offen offset:0 lds
    s_add_u32 s29, s29, 9216
    buffer_load_dwordx4 v3, s[16:19], s29 offen offset:1024 lds
    s_add_u32 s29, s29, 9216
    buffer_load_dwordx4 v2, s[16:19], s29 offen offset:2048 lds
    s_add_u32 s29, s29, 9216
    buffer_load_dwordx4 v3, s[16:19], s29 offen offset:3072 lds
    s_add_u32 s28, s28, 16384
    s_mov_b32 m0, s28
    s_add_u32 s29, s25, 73728
    buffer_load_dwordx4 v1, s[8:11], s29 offen offset:0 lds
    buffer_load_dwordx4 v1, s[8:11], s29 offen offset:1024 lds
    buffer_load_dwordx4 v1, s[8:11], s29 offen offset:2048 lds
    buffer_load_dwordx4 v1, s[8:11], s29 offen offset:3072 lds
    s_waitcnt lgkmcnt(0)
    v_mfma_f32_32x32x16_bf16 v[64:79], v[48:51], v[56:59], v[64:79]
    v_dot2c_f32_bf16 v20, s27, v52
    v_dot2c_f32_bf16 v22, v52, v52
    v_mfma_f32_32x32x16_bf16 v[96:111], v[48:51], v[60:63], v[96:111]
    ds_read_b128 v[32:35], v10 offset:32768
    v_dot2c_f32_bf16 v21, s27, v53
    v_mfma_f32_32x32x16_bf16 v[128:143], v[60:63], v[48:51], v[128:143]
    ds_read_b128 v[36:39], v10 offset:36864
    v_dot2c_f32_bf16 v23, v53, v53
    v_mfma_f32_32x32x16_bf16 v[80:95], v[52:55], v[56:59], v[80:95]
    ds_read_b128 v[40:43], v5 offset:32768
    v_dot2c_f32_bf16 v20, s27, v54
    v_dot2c_f32_bf16 v22, v54, v54
    v_mfma_f32_32x32x16_bf16 v[112:127], v[52:55], v[60:63], v[112:127]
    ds_read_b128 v[44:47], v5 offset:33792
    v_dot2c_f32_bf16 v21, s27, v55
    v_mfma_f32_32x32x16_bf16 v[144:159], v[60:63], v[52:55], v[144:159]
    v_dot2c_f32_bf16 v23, v55, v55
    s_waitcnt lgkmcnt(0)
    v_mfma_f32_32x32x16_bf16 v[64:79], v[32:35], v[40:43], v[64:79]
    v_dot2c_f32_bf16 v20, s27, v36
    v_dot2c_f32_bf16 v22, v36, v36
    v_mfma_f32_32x32x16_bf16 v[96:111], v[32:35], v[44:47], v[96:111]
    ds_read_b128 v[48:51], v11 offset:32768
    v_dot2c_f32_bf16 v21, s27, v37
    v_mfma_f32_32x32x16_bf16 v[128:143], v[44:47], v[32:35], v[128:143]
    ds_read_b128 v[52:55], v11 offset:36864
    v_dot2c_f32_bf16 v23, v37, v37
    v_mfma_f32_32x32x16_bf16 v[80:95], v[36:39], v[40:43], v[80:95]
    ds_read_b128 v[56:59], v5 offset:34816
    v_dot2c_f32_bf16 v20, s27, v38
    v_dot2c_f32_bf16 v22, v38, v38
    v_mfma_f32_32x32x16_bf16 v[112:127], v[36:39], v[44:47], v[112:127]
    ds_read_b128 v[60:63], v5 offset:35840
    v_dot2c_f32_bf16 v21, s27, v39
    v_mfma_f32_32x32x16_bf16 v[144:159], v[44:47], v[36:39], v[144:159]
    v_dot2c_f32_bf16 v23, v39, v39
    s_waitcnt lgkmcnt(0)
    v_mfma_f32_32x32x16_bf16 v[64:79], v[48:51], v[56:59], v[64:79]
    v_dot2c_f32_bf16 v20, s27, v52
    v_dot2c_f32_bf16 v22, v52, v52
    v_mfma_f32_32x32x16_bf16 v[96:111], v[48:51], v[60:63], v[96:111]
    ds_read_b128 v[32:35], v12 offset:32768
    v_dot2c_f32_bf16 v21, s27, v53
    v_mfma_f32_32x32x16_bf16 v[128:143], v[60:63], v[48:51], v[128:143]
    ds_read_b128 v[36:39], v12 offset:36864
    v_dot2c_f32_bf16 v23, v53, v53
    v_mfma_f32_32x32x16_bf16 v[80:95], v[52:55], v[56:59], v[80:95]
    ds_read_b128 v[40:43], v5 offset:36864
    v_dot2c_f32_bf16 v20, s27, v54
    v_dot2c_f32_bf16 v22, v54, v54
    v_mfma_f32_32x32x16_bf16 v[112:127], v[52:55], v[60:63], v[112:127]
    ds_read_b128 v[44:47], v5 offset:37888
    v_dot2c_f32_bf16 v21, s27, v55
    v_mfma_f32_32x32x16_bf16 v[144:159], v[60:63], v[52:55], v[144:159]
    v_dot2c_f32_bf16 v23, v55, v55
    s_waitcnt lgkmcnt(0)
    v_mfma_f32_32x32x16_bf16 v[64:79], v[32:35], v[40:43], v[64:79]
    v_dot2c_f32_bf16 v20, s27, v36
    v_dot2c_f32_bf16 v22, v36, v36
    v_mfma_f32_32x32x16_bf16 v[96:111], v[32:35], v[44:47], v[96:111]
    ds_read_b128 v[48:51], v13 offset:32768
    v_dot2c_f32_bf16 v21, s27, v37
    v_mfma_f32_32x32x16_bf16 v[128:143], v[44:47], v[32:35], v[128:143]
    ds_read_b128 v[52:55], v13 offset:36864
    v_dot2c_f32_bf16 v23, v37, v37
    v_mfma_f32_32x32x16_bf16 v[80:95], v[36:39], v[40:43], v[80:95]
    ds_read_b128 v[56:59], v5 offset:38912
    v_dot2c_f32_bf16 v20, s27, v38
    v_dot2c_f32_bf16 v22, v38, v38
    v_mfma_f32_32x32x16_bf16 v[112:127], v[36:39], v[44:47], v[112:127]
    ds_read_b128 v[60:63], v5 offset:39936
    v_dot2c_f32_bf16 v21, s27, v39
    v_mfma_f32_32x32x16_bf16 v[144:159], v[44:47], v[36:39], v[144:159]
    v_dot2c_f32_bf16 v23, v39, v39
    s_waitcnt vmcnt(8)
    s_barrier
    s_waitcnt lgkmcnt(0)
    v_mfma_f32_32x32x16_bf16 v[64:79], v[48:51], v[56:59], v[64:79]
    v_dot2c_f32_bf16 v20, s27, v52
    v_dot2c_f32_bf16 v22, v52, v52
    v_mfma_f32_32x32x16_bf16 v[96:111], v[48:51], v[60:63], v[96:111]
    ds_read_b128 v[32:35], v6 offset:0
    v_dot2c_f32_bf16 v21, s27, v53
    v_mfma_f32_32x32x16_bf16 v[128:143], v[60:63], v[48:51], v[128:143]
    ds_read_b128 v[36:39], v6 offset:4096
    v_dot2c_f32_bf16 v23, v53, v53
    v_mfma_f32_32x32x16_bf16 v[80:95], v[52:55], v[56:59], v[80:95]
    ds_read_b128 v[40:43], v4 offset:0
    v_dot2c_f32_bf16 v20, s27, v54
    v_dot2c_f32_bf16 v22, v54, v54
    v_mfma_f32_32x32x16_bf16 v[112:127], v[52:55], v[60:63], v[112:127]
    ds_read_b128 v[44:47], v4 offset:1024
    v_dot2c_f32_bf16 v21, s27, v55
    v_mfma_f32_32x32x16_bf16 v[144:159], v[60:63], v[52:55], v[144:159]
    v_dot2c_f32_bf16 v23, v55, v55
    s_waitcnt lgkmcnt(0)
    v_mfma_f32_32x32x16_bf16 v[64:79], v[32:35], v[40:43], v[64:79]
    v_dot2c_f32_bf16 v20, s27, v36
    v_dot2c_f32_bf16 v22, v36, v36
    v_mfma_f32_32x32x16_bf16 v[96:111], v[32:35], v[44:47], v[96:111]
    ds_read_b128 v[48:51], v7 offset:0
    v_dot2c_f32_bf16 v21, s27, v37
    v_mfma_f32_32x32x16_bf16 v[128:143], v[44:47], v[32:35], v[128:143]
    ds_read_b128 v[52:55], v7 offset:4096
    v_dot2c_f32_bf16 v23, v37, v37
    v_mfma_f32_32x32x16_bf16 v[80:95], v[36:39], v[40:43], v[80:95]
    ds_read_b128 v[56:59], v4 offset:2048
    v_dot2c_f32_bf16 v20, s27, v38
    v_dot2c_f32_bf16 v22, v38, v38
    v_mfma_f32_32x32x16_bf16 v[112:127], v[36:39], v[44:47], v[112:127]
    ds_read_b128 v[60:63], v4 offset:3072
    v_dot2c_f32_bf16 v21, s27, v39
    v_mfma_f32_32x32x16_bf16 v[144:159], v[44:47], v[36:39], v[144:159]
    v_dot2c_f32_bf16 v23, v39, v39
    s_waitcnt lgkmcnt(0)
    v_mfma_f32_32x32x16_bf16 v[64:79], v[48:51], v[56:59], v[64:79]
    v_dot2c_f32_bf16 v20, s27, v52
    v_dot2c_f32_bf16 v22, v52, v52
    v_mfma_f32_32x32x16_bf16 v[96:111], v[48:51], v[60:63], v[96:111]
    ds_read_b128 v[32:35], v8 offset:0
    v_dot2c_f32_bf16 v21, s27, v53
    v_mfma_f32_32x32x16_bf16 v[128:143], v[60:63], v[48:51], v[128:143]
    ds_read_b128 v[36:39], v8 offset:4096
    v_dot2c_f32_bf16 v23, v53, v53
    v_mfma_f32_32x32x16_bf16 v[80:95], v[52:55], v[56:59], v[80:95]
    ds_read_b128 v[40:43], v4 offset:4096
    v_dot2c_f32_bf16 v20, s27, v54
    v_dot2c_f32_bf16 v22, v54, v54
    v_mfma_f32_32x32x16_bf16 v[112:127], v[52:55], v[60:63], v[112:127]
    ds_read_b128 v[44:47], v4 offset:5120
    v_dot2c_f32_bf16 v21, s27, v55
    v_mfma_f32_32x32x16_bf16 v[144:159], v[60:63], v[52:55], v[144:159]
    v_dot2c_f32_bf16 v23, v55, v55
    s_waitcnt lgkmcnt(0)
    v_mfma_f32_32x32x16_bf16 v[64:79], v[32:35], v[40:43], v[64:79]
    v_dot2c_f32_bf16 v20, s27, v36
    v_dot2c_f32_bf16 v22, v36, v36
    v_mfma_f32_32x32x16_bf16 v[96:111], v[32:35], v[44:47], v[96:111]
    ds_read_b128 v[48:51], v9 offset:0
    v_dot2c_f32_bf16 v21, s27, v37
    v_mfma_f32_32x32x16_bf16 v[128:143], v[44:47], v[32:35], v[128:143]
    ds_read_b128 v[52:55], v9 offset:4096
    v_dot2c_f32_bf16 v23, v37, v37
    v_mfma_f32_32x32x16_bf16 v[80:95], v[36:39], v[40:43], v[80:95]
    ds_read_b128 v[56:59], v4 offset:6144
    v_dot2c_f32_bf16 v20, s27, v38
    v_dot2c_f32_bf16 v22, v38, v38
    v_mfma_f32_32x32x16_bf16 v[112:127], v[36:39], v[44:47], v[112:127]
    ds_read_b128 v[60:63], v4 offset:7168
    v_dot2c_f32_bf16 v21, s27, v39
    v_mfma_f32_32x32x16_bf16 v[144:159], v[44:47], v[36:39], v[144:159]
    v_dot2c_f32_bf16 v23, v39, v39
    s_waitcnt vmcnt(0)
    s_barrier
    s_waitcnt lgkmcnt(0)
    v_mfma_f32_32x32x16_bf16 v[64:79], v[48:51], v[56:59], v[64:79]
    v_dot2c_f32_bf16 v20, s27, v52
    v_dot2c_f32_bf16 v22, v52, v52
    v_mfma_f32_32x32x16_bf16 v[96:111], v[48:51], v[60:63], v[96:111]
    ds_read_b128 v[32:35], v6 offset:32768
    v_dot2c_f32_bf16 v21, s27, v53
    v_mfma_f32_32x32x16_bf16 v[128:143], v[60:63], v[48:51], v[128:143]
    ds_read_b128 v[36:39], v6 offset:36864
    v_dot2c_f32_bf16 v23, v53, v53
    v_mfma_f32_32x32x16_bf16 v[80:95], v[52:55], v[56:59], v[80:95]
    ds_read_b128 v[40:43], v4 offset:32768
    v_dot2c_f32_bf16 v20, s27, v54
    v_dot2c_f32_bf16 v22, v54, v54
    v_mfma_f32_32x32x16_bf16 v[112:127], v[52:55], v[60:63], v[112:127]
    ds_read_b128 v[44:47], v4 offset:33792
    v_dot2c_f32_bf16 v21, s27, v55
    v_mfma_f32_32x32x16_bf16 v[144:159], v[60:63], v[52:55], v[144:159]
    v_dot2c_f32_bf16 v23, v55, v55
    s_waitcnt lgkmcnt(0)
    v_mfma_f32_32x32x16_bf16 v[64:79], v[32:35], v[40:43], v[64:79]
    v_dot2c_f32_bf16 v20, s27, v36
    v_dot2c_f32_bf16 v22, v36, v36
    v_mfma_f32_32x32x16_bf16 v[96:111], v[32:35], v[44:47], v[96:111]
    ds_read_b128 v[48:51], v7 offset:32768
    v_dot2c_f32_bf16 v21, s27, v37
    v_mfma_f32_32x32x16_bf16 v[128:143], v[44:47], v[32:35], v[128:143]
    ds_read_b128 v[52:55], v7 offset:36864
    v_dot2c_f32_bf16 v23, v37, v37
    v_mfma_f32_32x32x16_bf16 v[80:95], v[36:39], v[40:43], v[80:95]
    ds_read_b128 v[56:59], v4 offset:34816
    v_dot2c_f32_bf16 v20, s27, v38
    v_dot2c_f32_bf16 v22, v38, v38
    v_mfma_f32_32x32x16_bf16 v[112:127], v[36:39], v[44:47], v[112:127]
    ds_read_b128 v[60:63], v4 offset:35840
    v_dot2c_f32_bf16 v21, s27, v39
    v_mfma_f32_32x32x16_bf16 v[144:159], v[44:47], v[36:39], v[144:159]
    v_dot2c_f32_bf16 v23, v39, v39
    s_waitcnt lgkmcnt(0)
    v_mfma_f32_32x32x16_bf16 v[64:79], v[48:51], v[56:59], v[64:79]
    v_dot2c_f32_bf16 v20, s27, v52
    v_dot2c_f32_bf16 v22, v52, v52
    v_mfma_f32_32x32x16_bf16 v[96:111], v[48:51], v[60:63], v[96:111]
    ds_read_b128 v[32:35], v8 offset:32768
    v_dot2c_f32_bf16 v21, s27, v53
    v_mfma_f32_32x32x16_bf16 v[128:143], v[60:63], v[48:51], v[128:143]
    ds_read_b128 v[36:39], v8 offset:36864
    v_dot2c_f32_bf16 v23, v53, v53
    v_mfma_f32_32x32x16_bf16 v[80:95], v[52:55], v[56:59], v[80:95]
    ds_read_b128 v[40:43], v4 offset:36864
    v_dot2c_f32_bf16 v20, s27, v54
    v_dot2c_f32_bf16 v22, v54, v54
    v_mfma_f32_32x32x16_bf16 v[112:127], v[52:55], v[60:63], v[112:127]
    ds_read_b128 v[44:47], v4 offset:37888
    v_dot2c_f32_bf16 v21, s27, v55
    v_mfma_f32_32x32x16_bf16 v[144:159], v[60:63], v[52:55], v[144:159]
    v_dot2c_f32_bf16 v23, v55, v55
    s_waitcnt lgkmcnt(0)
    v_mfma_f32_32x32x16_bf16 v[64:79], v[32:35], v[40:43], v[64:79]
    v_dot2c_f32_bf16 v20, s27, v36
    v_dot2c_f32_bf16 v22, v36, v36
    v_mfma_f32_32x32x16_bf16 v[96:111], v[32:35], v[44:47], v[96:111]
    ds_read_b128 v[48:51], v9 offset:32768
    v_dot2c_f32_bf16 v21, s27, v37
    v_mfma_f32_32x32x16_bf16 v[128:143], v[44:47], v[32:35], v[128:143]
    ds_read_b128 v[52:55], v9 offset:36864
    v_dot2c_f32_bf16 v23, v37, v37
    v_mfma_f32_32x32x16_bf16 v[80:95], v[36:39], v[40:43], v[80:95]
    ds_read_b128 v[56:59], v4 offset:38912
    v_dot2c_f32_bf16 v20, s27, v38
    v_dot2c_f32_bf16 v22, v38, v38
    v_mfma_f32_32x32x16_bf16 v[112:127], v[36:39], v[44:47], v[112:127]
    ds_read_b128 v[60:63], v4 offset:39936
    v_dot2c_f32_bf16 v21, s27, v39
    v_mfma_f32_32x32x16_bf16 v[144:159], v[44:47], v[36:39], v[144:159]
    v_dot2c_f32_bf16 v23, v39, v39
    s_waitcnt lgkmcnt(0)
    v_mfma_f32_32x32x16_bf16 v[64:79], v[48:51], v[56:59], v[64:79]
    v_dot2c_f32_bf16 v20, s27, v52
    v_dot2c_f32_bf16 v22, v52, v52
    v_mfma_f32_32x32x16_bf16 v[96:111], v[48:51], v[60:63], v[96:111]
    v_dot2c_f32_bf16 v21, s27, v53
    v_mfma_f32_32x32x16_bf16 v[128:143], v[60:63], v[48:51], v[128:143]
    v_dot2c_f32_bf16 v23, v53, v53
    v_mfma_f32_32x32x16_bf16 v[80:95], v[52:55], v[56:59], v[80:95]
    v_dot2c_f32_bf16 v20, s27, v54
    v_dot2c_f32_bf16 v22, v54, v54
    v_mfma_f32_32x32x16_bf16 v[112:127], v[52:55], v[60:63], v[112:127]
    v_dot2c_f32_bf16 v21, s27, v55
    v_mfma_f32_32x32x16_bf16 v[144:159], v[60:63], v[52:55], v[144:159]
    v_dot2c_f32_bf16 v23, v55, v55
afront1_kernel_af_epi:
    v_add_f32 v20, v20, v21
    v_add_f32 v22, v22, v23
    v_mov_b32 v21, v20
    v_mov_b32 v23, v22
    s_nop 1
    v_permlane32_swap_b32 v20, v21
    v_permlane32_swap_b32 v22, v23
    v_add_f32 v20, v20, v21
    v_add_f32 v22, v22, v23
    v_mul_f32 v20, 0x3acccccd, v20
    v_mul_f32 v21, v20, v20
    v_mul_f32 v22, 0x3acccccd, v22
    v_sub_f32 v22, v22, v21
    v_max_f32 v22, 0, v22
    v_add_f32 v22, 0x3727c5ac, v22
    v_rsq_f32 v22, v22
    v_and_b32 v16, 31, v0
    s_lshl_b32 s28, s13, 7
    s_add_u32 s28, s28, 65536
    v_lshl_add_u32 v17, v16, 2, s28
    ds_write_b32 v17, v22
    s_waitcnt lgkmcnt(0)
    s_barrier
    s_lshl_b32 s28, s22, 8
    s_add_u32 s28, s28, 65536
    v_lshl_add_u32 v17, v16, 2, s28
    v_lshrrev_b32 v18, 5, v0
    v_lshlrev_b32 v18, 4, v18
    v_add_u32 v18, s28, v18
    ds_read_b32 v224, v17 offset:0
    ds_read_b128 v[192:195], v18 offset:0
    ds_read_b128 v[196:199], v18 offset:32
    ds_read_b128 v[200:203], v18 offset:64
    ds_read_b128 v[204:207], v18 offset:96
    ds_read_b32 v225, v17 offset:128
    ds_read_b128 v[208:211], v18 offset:128
    ds_read_b128 v[212:215], v18 offset:160
    ds_read_b128 v[216:219], v18 offset:192
    ds_read_b128 v[220:223], v18 offset:224
    v_and_b32 v16, 31, v0
    v_mov_b32 v228, 0x358637bd
    v_cmp_gt_u32 vcc, 20, v16
    s_mov_b64 s[30:31], vcc
    s_nop 0
    v_cndmask_b32 v226, 0, v228, vcc
    v_cmp_eq_u32 vcc, 8, v16
    s_nop 1
    v_cndmask_b32 v227, 0, 1.0, vcc
    s_waitcnt lgkmcnt(0)
    v_fma_f32 v64, v64, v192, v226
    v_mul_f32 v48, 0x3fb8aa3b, v64
    v_exp_f32 v48, v48 clamp
    v_max_f32 v49, v64, v228
    v_fma_f32 v96, v96, v192, v227
    v_add_f32 v48, v48, v49
    v_cndmask_b32 v64, v64, v48, s[30:31]
    v_fma_f32 v65, v65, v193, v226
    v_mul_f32 v50, 0x3fb8aa3b, v65
    v_exp_f32 v50, v50 clamp
    v_max_f32 v51, v65, v228
    v_fma_f32 v97, v97, v193, v227
    v_add_f32 v50, v50, v51
    v_cndmask_b32 v65, v65, v50, s[30:31]
    v_fma_f32 v66, v66, v194, v226
    v_mul_f32 v52, 0x3fb8aa3b, v66
    v_exp_f32 v52, v52 clamp
    v_max_f32 v53, v66, v228
    v_fma_f32 v98, v98, v194, v227
    v_add_f32 v52, v52, v53
    v_cndmask_b32 v66, v66, v52, s[30:31]
    v_fma_f32 v67, v67, v195, v226
    v_mul_f32 v54, 0x3fb8aa3b, v67
    v_exp_f32 v54, v54 clamp
    v_max_f32 v55, v67, v228
    v_fma_f32 v99, v99, v195, v227
    v_add_f32 v54, v54, v55
    v_cndmask_b32 v67, v67, v54, s[30:31]
    v_fma_f32 v68, v68, v196, v226
    v_mul_f32 v48, 0x3fb8aa3b, v68
    v_exp_f32 v48, v48 clamp
    v_max_f32 v49, v68, v228
    v_fma_f32 v100, v100, v196, v227
    v_add_f32 v48, v48, v49
    v_cndmask_b32 v68, v68, v48, s[30:31]
    v_fma_f32 v69, v69, v197, v226
    v_mul_f32 v50, 0x3fb8aa3b, v69
    v_exp_f32 v50, v50 clamp
    v_max_f32 v51, v69, v228
    v_fma_f32 v101, v101, v197, v227
    v_add_f32 v50, v50, v51
    v_cndmask_b32 v69, v69, v50, s[30:31]
    v_fma_f32 v70, v70, v198, v226
    v_mul_f32 v52, 0x3fb8aa3b, v70
    v_exp_f32 v52, v52 clamp
    v_max_f32 v53, v70, v228
    v_fma_f32 v102, v102, v198, v227
    v_add_f32 v52, v52, v53
    v_cndmask_b32 v70, v70, v52, s[30:31]
    v_fma_f32 v71, v71, v199, v226
    v_mul_f32 v54, 0x3fb8aa3b, v71
    v_exp_f32 v54, v54 clamp
    v_max_f32 v55, v71, v228
    v_fma_f32 v103, v103, v199, v227
    v_add_f32 v54, v54, v55
    v_cndmask_b32 v71, v71, v54, s[30:31]
    v_fma_f32 v72, v72, v200, v226
    v_mul_f32 v48, 0x3fb8aa3b, v72
    v_exp_f32 v48, v48 clamp
    v_max_f32 v49, v72, v228
    v_fma_f32 v104, v104, v200, v227
    v_add_f32 v48, v48, v49
    v_cndmask_b32 v72, v72, v48, s[30:31]
    v_fma_f32 v73, v73, v201, v226
    v_mul_f32 v50, 0x3fb8aa3b, v73
    v_exp_f32 v50, v50 clamp
    v_max_f32 v51, v73, v228
    v_fma_f32 v105, v105, v201, v227
    v_add_f32 v50, v50, v51
    v_cndmask_b32 v73, v73, v50, s[30:31]
    v_fma_f32 v74, v74, v202, v226
    v_mul_f32 v52, 0x3fb8aa3b, v74
    v_exp_f32 v52, v52 clamp
    v_max_f32 v53, v74, v228
    v_fma_f32 v106, v106, v202, v227
    v_add_f32 v52, v52, v53
    v_cndmask_b32 v74, v74, v52, s[30:31]
    v_fma_f32 v75, v75, v203, v226
    v_mul_f32 v54, 0x3fb8aa3b, v75
    v_exp_f32 v54, v54 clamp
    v_max_f32 v55, v75, v228
    v_fma_f32 v107, v107, v203, v227
    v_add_f32 v54, v54, v55
    v_cndmask_b32 v75, v75, v54, s[30:31]
    v_fma_f32 v76, v76, v204, v226
    v_mul_f32 v48, 0x3fb8aa3b, v76
    v_exp_f32 v48, v48 clamp
    v_max_f32 v49, v76, v228
    v_fma_f32 v108, v108, v204, v227
    v_add_f32 v48, v48, v49
    v_cndmask_b32 v76, v76, v48, s[30:31]
    v_fma_f32 v77, v77, v205, v226
    v_mul_f32 v50, 0x3fb8aa3b, v77
    v_exp_f32 v50, v50 clamp
    v_max_f32 v51, v77, v228
    v_fma_f32 v109, v109, v205, v227
    v_add_f32 v50, v50, v51
    v_cndmask_b32 v77, v77, v50, s[30:31]
    v_fma_f32 v78, v78, v206, v226
    v_mul_f32 v52, 0x3fb8aa3b, v78
    v_exp_f32 v52, v52 clamp
    v_max_f32 v53, v78, v228
    v_fma_f32 v110, v110, v206, v227
    v_add_f32 v52, v52, v53
    v_cndmask_b32 v78, v78, v52, s[30:31]
    v_fma_f32 v79, v79, v207, v226
    v_mul_f32 v54, 0x3fb8aa3b, v79
    v_exp_f32 v54, v54 clamp
    v_max_f32 v55, v79, v228
    v_fma_f32 v111, v111, v207, v227
    v_add_f32 v54, v54, v55
    v_cndmask_b32 v79, v79, v54, s[30:31]
    v_cvt_pk_bf16_f32 v32, v64, v65
    v_cvt_pk_bf16_f32 v40, v96, v97
    v_cvt_pk_bf16_f32 v33, v66, v67
    v_cvt_pk_bf16_f32 v41, v98, v99
    v_cvt_pk_bf16_f32 v34, v68, v69
    v_cvt_pk_bf16_f32 v42, v100, v101
    v_cvt_pk_bf16_f32 v35, v70, v71
    v_cvt_pk_bf16_f32 v43, v102, v103
    v_cvt_pk_bf16_f32 v36, v72, v73
    v_cvt_pk_bf16_f32 v44, v104, v105
    v_cvt_pk_bf16_f32 v37, v74, v75
    v_cvt_pk_bf16_f32 v45, v106, v107
    v_cvt_pk_bf16_f32 v38, v76, v77
    v_cvt_pk_bf16_f32 v46, v108, v109
    v_cvt_pk_bf16_f32 v39, v78, v79
    v_cvt_pk_bf16_f32 v47, v110, v111
    s_nop 1
    v_mfma_f32_32x32x16_bf16 v[160:175], v[32:35], v[32:35], 0
    v_mfma_f32_32x32x16_bf16 v[176:191], v[40:43], v[32:35], 0
    v_mfma_f32_32x32x16_bf16 v[160:175], v[36:39], v[36:39], v[160:175]
    v_mfma_f32_32x32x16_bf16 v[176:191], v[44:47], v[36:39], v[176:191]
    v_fma_f32 v80, v80, v208, v226
    v_mul_f32 v48, 0x3fb8aa3b, v80
    v_exp_f32 v48, v48 clamp
    v_max_f32 v49, v80, v228
    v_fma_f32 v112, v112, v208, v227
    v_add_f32 v48, v48, v49
    v_cndmask_b32 v80, v80, v48, s[30:31]
    v_fma_f32 v81, v81, v209, v226
    v_mul_f32 v50, 0x3fb8aa3b, v81
    v_exp_f32 v50, v50 clamp
    v_max_f32 v51, v81, v228
    v_fma_f32 v113, v113, v209, v227
    v_add_f32 v50, v50, v51
    v_cndmask_b32 v81, v81, v50, s[30:31]
    v_fma_f32 v82, v82, v210, v226
    v_mul_f32 v52, 0x3fb8aa3b, v82
    v_exp_f32 v52, v52 clamp
    v_max_f32 v53, v82, v228
    v_fma_f32 v114, v114, v210, v227
    v_add_f32 v52, v52, v53
    v_cndmask_b32 v82, v82, v52, s[30:31]
    v_fma_f32 v83, v83, v211, v226
    v_mul_f32 v54, 0x3fb8aa3b, v83
    v_exp_f32 v54, v54 clamp
    v_max_f32 v55, v83, v228
    v_fma_f32 v115, v115, v211, v227
    v_add_f32 v54, v54, v55
    v_cndmask_b32 v83, v83, v54, s[30:31]
    v_fma_f32 v84, v84, v212, v226
    v_mul_f32 v48, 0x3fb8aa3b, v84
    v_exp_f32 v48, v48 clamp
    v_max_f32 v49, v84, v228
    v_fma_f32 v116, v116, v212, v227
    v_add_f32 v48, v48, v49
    v_cndmask_b32 v84, v84, v48, s[30:31]
    v_fma_f32 v85, v85, v213, v226
    v_mul_f32 v50, 0x3fb8aa3b, v85
    v_exp_f32 v50, v50 clamp
    v_max_f32 v51, v85, v228
    v_fma_f32 v117, v117, v213, v227
    v_add_f32 v50, v50, v51
    v_cndmask_b32 v85, v85, v50, s[30:31]
    v_fma_f32 v86, v86, v214, v226
    v_mul_f32 v52, 0x3fb8aa3b, v86
    v_exp_f32 v52, v52 clamp
    v_max_f32 v53, v86, v228
    v_fma_f32 v118, v118, v214, v227
    v_add_f32 v52, v52, v53
    v_cndmask_b32 v86, v86, v52, s[30:31]
    v_fma_f32 v87, v87, v215, v226
    v_mul_f32 v54, 0x3fb8aa3b, v87
    v_exp_f32 v54, v54 clamp
    v_max_f32 v55, v87, v228
    v_fma_f32 v119, v119, v215, v227
    v_add_f32 v54, v54, v55
    v_cndmask_b32 v87, v87, v54, s[30:31]
    v_fma_f32 v88, v88, v216, v226
    v_mul_f32 v48, 0x3fb8aa3b, v88
    v_exp_f32 v48, v48 clamp
    v_max_f32 v49, v88, v228
    v_fma_f32 v120, v120, v216, v227
    v_add_f32 v48, v48, v49
    v_cndmask_b32 v88, v88, v48, s[30:31]
    v_fma_f32 v89, v89, v217, v226
    v_mul_f32 v50, 0x3fb8aa3b, v89
    v_exp_f32 v50, v50 clamp
    v_max_f32 v51, v89, v228
    v_fma_f32 v121, v121, v217, v227
    v_add_f32 v50, v50, v51
    v_cndmask_b32 v89, v89, v50, s[30:31]
    v_fma_f32 v90, v90, v218, v226
    v_mul_f32 v52, 0x3fb8aa3b, v90
    v_exp_f32 v52, v52 clamp
    v_max_f32 v53, v90, v228
    v_fma_f32 v122, v122, v218, v227
    v_add_f32 v52, v52, v53
    v_cndmask_b32 v90, v90, v52, s[30:31]
    v_fma_f32 v91, v91, v219, v226
    v_mul_f32 v54, 0x3fb8aa3b, v91
    v_exp_f32 v54, v54 clamp
    v_max_f32 v55, v91, v228
    v_fma_f32 v123, v123, v219, v227
    v_add_f32 v54, v54, v55
    v_cndmask_b32 v91, v91, v54, s[30:31]
    v_fma_f32 v92, v92, v220, v226
    v_mul_f32 v48, 0x3fb8aa3b, v92
    v_exp_f32 v48, v48 clamp
    v_max_f32 v49, v92, v228
    v_fma_f32 v124, v124, v220, v227
    v_add_f32 v48, v48, v49
    v_cndmask_b32 v92, v92, v48, s[30:31]
    v_fma_f32 v93, v93, v221, v226
    v_mul_f32 v50, 0x3fb8aa3b, v93
    v_exp_f32 v50, v50 clamp
    v_max_f32 v51, v93, v228
    v_fma_f32 v125, v125, v221, v227
    v_add_f32 v50, v50, v51
    v_cndmask_b32 v93, v93, v50, s[30:31]
    v_fma_f32 v94, v94, v222, v226
    v_mul_f32 v52, 0x3fb8aa3b, v94
    v_exp_f32 v52, v52 clamp
    v_max_f32 v53, v94, v228
    v_fma_f32 v126, v126, v222, v227
    v_add_f32 v52, v52, v53
    v_cndmask_b32 v94, v94, v52, s[30:31]
    v_fma_f32 v95, v95, v223, v226
    v_mul_f32 v54, 0x3fb8aa3b, v95
    v_exp_f32 v54, v54 clamp
    v_max_f32 v55, v95, v228
    v_fma_f32 v127, v127, v223, v227
    v_add_f32 v54, v54, v55
    v_cndmask_b32 v95, v95, v54, s[30:31]
    v_cvt_pk_bf16_f32 v32, v80, v81
    v_cvt_pk_bf16_f32 v40, v112, v113
    v_cvt_pk_bf16_f32 v33, v82, v83
    v_cvt_pk_bf16_f32 v41, v114, v115
    v_cvt_pk_bf16_f32 v34, v84, v85
    v_cvt_pk_bf16_f32 v42, v116, v117
    v_cvt_pk_bf16_f32 v35, v86, v87
    v_cvt_pk_bf16_f32 v43, v118, v119
    v_cvt_pk_bf16_f32 v36, v88, v89
    v_cvt_pk_bf16_f32 v44, v120, v121
    v_cvt_pk_bf16_f32 v37, v90, v91
    v_cvt_pk_bf16_f32 v45, v122, v123
    v_cvt_pk_bf16_f32 v38, v92, v93
    v_cvt_pk_bf16_f32 v46, v124, v125
    v_cvt_pk_bf16_f32 v39, v94, v95
    v_cvt_pk_bf16_f32 v47, v126, v127
    s_nop 1
    v_mfma_f32_32x32x16_bf16 v[160:175], v[32:35], v[32:35], v[160:175]
    v_mfma_f32_32x32x16_bf16 v[176:191], v[40:43], v[32:35], v[176:191]
    v_mfma_f32_32x32x16_bf16 v[160:175], v[36:39], v[36:39], v[160:175]
    v_mfma_f32_32x32x16_bf16 v[176:191], v[44:47], v[36:39], v[176:191]
    v_fma_f32 v132, v132, v224, v228
    v_mul_f32 v48, 0x3fb8aa3b, v132
    v_exp_f32 v48, v48 clamp
    v_max_f32 v49, v132, v228
    v_add_f32 v132, v48, v49
    v_fma_f32 v133, v133, v224, v228
    v_mul_f32 v50, 0x3fb8aa3b, v133
    v_exp_f32 v50, v50 clamp
    v_max_f32 v51, v133, v228
    v_add_f32 v133, v50, v51
    v_fma_f32 v134, v134, v224, v228
    v_mul_f32 v52, 0x3fb8aa3b, v134
    v_exp_f32 v52, v52 clamp
    v_max_f32 v53, v134, v228
    v_add_f32 v134, v52, v53
    v_fma_f32 v135, v135, v224, v228
    v_mul_f32 v54, 0x3fb8aa3b, v135
    v_exp_f32 v54, v54 clamp
    v_max_f32 v55, v135, v228
    v_add_f32 v135, v54, v55
    v_fma_f32 v136, v136, v224, v228
    v_mul_f32 v48, 0x3fb8aa3b, v136
    v_exp_f32 v48, v48 clamp
    v_max_f32 v49, v136, v228
    v_add_f32 v136, v48, v49
    v_fma_f32 v137, v137, v224, v228
    v_mul_f32 v50, 0x3fb8aa3b, v137
    v_exp_f32 v50, v50 clamp
    v_max_f32 v51, v137, v228
    v_add_f32 v137, v50, v51
    v_fma_f32 v138, v138, v224, v228
    v_mul_f32 v52, 0x3fb8aa3b, v138
    v_exp_f32 v52, v52 clamp
    v_max_f32 v53, v138, v228
    v_add_f32 v138, v52, v53
    v_fma_f32 v139, v139, v224, v228
    v_mul_f32 v54, 0x3fb8aa3b, v139
    v_exp_f32 v54, v54 clamp
    v_max_f32 v55, v139, v228
    v_add_f32 v139, v54, v55
    v_fma_f32 v140, v140, v224, v228
    v_mul_f32 v48, 0x3fb8aa3b, v140
    v_exp_f32 v48, v48 clamp
    v_max_f32 v49, v140, v228
    v_add_f32 v140, v48, v49
    v_fma_f32 v141, v141, v224, v228
    v_mul_f32 v50, 0x3fb8aa3b, v141
    v_exp_f32 v50, v50 clamp
    v_max_f32 v51, v141, v228
    v_add_f32 v141, v50, v51
    v_fma_f32 v142, v142, v224, v228
    v_mul_f32 v52, 0x3fb8aa3b, v142
    v_exp_f32 v52, v52 clamp
    v_max_f32 v53, v142, v228
    v_add_f32 v142, v52, v53
    v_fma_f32 v143, v143, v224, v228
    v_mul_f32 v54, 0x3fb8aa3b, v143
    v_exp_f32 v54, v54 clamp
    v_max_f32 v55, v143, v228
    v_add_f32 v143, v54, v55
    v_cvt_pk_bf16_f32 v130, v132, v133
    v_cvt_pk_bf16_f32 v131, v134, v135
    v_cvt_pk_bf16_f32 v132, v136, v137
    v_cvt_pk_bf16_f32 v133, v138, v139
    v_cvt_pk_bf16_f32 v134, v140, v141
    v_cvt_pk_bf16_f32 v135, v142, v143
    v_mov_b32 v128, 0
    v_mov_b32 v129, 0
    s_lshl_b32 s28, s13, 13
    s_add_u32 s28, s28, 66560
    v_add_u32 v17, s28, v1
    ds_write_b128 v17, v[160:163] offset:0
    ds_write_b128 v17, v[164:167] offset:1024
    ds_write_b128 v17, v[168:171] offset:2048
    ds_write_b128 v17, v[172:175] offset:3072
    ds_write_b128 v17, v[176:179] offset:4096
    ds_write_b128 v17, v[180:183] offset:5120
    ds_write_b128 v17, v[184:187] offset:6144
    ds_write_b128 v17, v[188:191] offset:7168
    s_lshl_b32 s28, s13, 6
    v_add_u32 v32, s28, v0
    v_cmp_le_u32 vcc, 105, v32
    s_nop 1
    v_cndmask_b32 v33, 0, 1, vcc
    v_mul_u32_u24 v34, 105, v33
    v_sub_u32 v34, v32, v34
    v_mul_u32_u24 v35, 13108, v34
    v_lshrrev_b32 v35, 16, v35
    v_mul_u32_u24 v36, 5, v35
    v_sub_u32 v36, v34, v36
    v_add_u32 v37, 20, v35
    v_subrev_u32 v38, 12, v35
    v_cmp_gt_u32 vcc, 12, v35
    s_nop 1
    v_cndmask_b32 v37, v38, v37, vcc
    v_cndmask_b32 v38, 1, 0, vcc
    v_lshlrev_b32 v38, 12, v38
    v_lshl_add_u32 v38, v33, 13, v38
    v_lshrrev_b32 v39, 3, v37
    v_lshl_add_u32 v38, v39, 10, v38
    v_bfe_u32 v39, v37, 2, 1
    v_lshlrev_b32 v39, 5, v39
    v_lshl_add_u32 v39, v36, 2, v39
    v_lshl_add_u32 v38, v39, 4, v38
    v_and_b32 v39, 3, v37
    v_lshl_add_u32 v38, v39, 2, v38
    v_min_u32 v38, 16320, v38
    v_add_u32 v38, 66560, v38
    s_waitcnt lgkmcnt(0)
    s_barrier
    ds_read_b32 v40, v38 offset:0
    ds_read_b32 v41, v38 offset:16
    ds_read_b32 v42, v38 offset:32
    ds_read_b32 v43, v38 offset:48
    ds_read_b32 v44, v38 offset:16384
    ds_read_b32 v45, v38 offset:16400
    ds_read_b32 v46, v38 offset:16416
    ds_read_b32 v47, v38 offset:16432
    s_lshl_b32 s28, s20, 4
    s_add_u32 s28, s28, s21
    s_lshl_b32 s28, s28, 12
    s_add_u32 s28, s28, 232783872
    v_lshlrev_b32 v39, 4, v32
    v_cmp_gt_u32 vcc, 210, v32
    s_mov_b64 s[32:33], vcc
    s_waitcnt lgkmcnt(0)
    v_add_f32 v40, v40, v44
    v_add_f32 v41, v41, v45
    v_add_f32 v42, v42, v46
    v_add_f32 v43, v43, v47
    s_mov_b64 exec, s[32:33]
    buffer_store_dwordx4 v[40:43], v39, s[8:11], s28 offen sc1
    s_mov_b64 exec, -1
    v_fma_f32 v148, v148, v225, v228
    v_mul_f32 v48, 0x3fb8aa3b, v148
    v_exp_f32 v48, v48 clamp
    v_max_f32 v49, v148, v228
    v_add_f32 v148, v48, v49
    v_fma_f32 v149, v149, v225, v228
    v_mul_f32 v50, 0x3fb8aa3b, v149
    v_exp_f32 v50, v50 clamp
    v_max_f32 v51, v149, v228
    v_add_f32 v149, v50, v51
    v_fma_f32 v150, v150, v225, v228
    v_mul_f32 v52, 0x3fb8aa3b, v150
    v_exp_f32 v52, v52 clamp
    v_max_f32 v53, v150, v228
    v_add_f32 v150, v52, v53
    v_fma_f32 v151, v151, v225, v228
    v_mul_f32 v54, 0x3fb8aa3b, v151
    v_exp_f32 v54, v54 clamp
    v_max_f32 v55, v151, v228
    v_add_f32 v151, v54, v55
    v_fma_f32 v152, v152, v225, v228
    v_mul_f32 v48, 0x3fb8aa3b, v152
    v_exp_f32 v48, v48 clamp
    v_max_f32 v49, v152, v228
    v_add_f32 v152, v48, v49
    v_fma_f32 v153, v153, v225, v228
    v_mul_f32 v50, 0x3fb8aa3b, v153
    v_exp_f32 v50, v50 clamp
    v_max_f32 v51, v153, v228
    v_add_f32 v153, v50, v51
    v_fma_f32 v154, v154, v225, v228
    v_mul_f32 v52, 0x3fb8aa3b, v154
    v_exp_f32 v52, v52 clamp
    v_max_f32 v53, v154, v228
    v_add_f32 v154, v52, v53
    v_fma_f32 v155, v155, v225, v228
    v_mul_f32 v54, 0x3fb8aa3b, v155
    v_exp_f32 v54, v54 clamp
    v_max_f32 v55, v155, v228
    v_add_f32 v155, v54, v55
    v_fma_f32 v156, v156, v225, v228
    v_mul_f32 v48, 0x3fb8aa3b, v156
    v_exp_f32 v48, v48 clamp
    v_max_f32 v49, v156, v228
    v_add_f32 v156, v48, v49
    v_fma_f32 v157, v157, v225, v228
    v_mul_f32 v50, 0x3fb8aa3b, v157
    v_exp_f32 v50, v50 clamp
    v_max_f32 v51, v157, v228
    v_add_f32 v157, v50, v51
    v_fma_f32 v158, v158, v225, v228
    v_mul_f32 v52, 0x3fb8aa3b, v158
    v_exp_f32 v52, v52 clamp
    v_max_f32 v53, v158, v228
    v_add_f32 v158, v52, v53
    v_fma_f32 v159, v159, v225, v228
    v_mul_f32 v54, 0x3fb8aa3b, v159
    v_exp_f32 v54, v54 clamp
    v_max_f32 v55, v159, v228
    v_add_f32 v159, v54, v55
    v_cvt_pk_bf16_f32 v146, v148, v149
    v_cvt_pk_bf16_f32 v147, v150, v151
    v_cvt_pk_bf16_f32 v148, v152, v153
    v_cvt_pk_bf16_f32 v149, v154, v155
    v_cvt_pk_bf16_f32 v150, v156, v157
    v_cvt_pk_bf16_f32 v151, v158, v159
    v_mov_b32 v144, 0
    v_mov_b32 v145, 0
    s_mul_i32 s29, s26, 5
    v_lshrrev_b32 v17, 5, v0
    v_add_u32 v17, s29, v17
    v_lshrrev_b32 v18, 1, v17
    v_lshlrev_b32 v18, 9, v18
    v_and_b32 v17, 1, v17
    v_lshl_add_u32 v18, v17, 3, v18
    v_and_b32 v16, 31, v0
    v_lshl_add_u32 v14, v16, 4, v18
    v_mul_u32_u24 v15, 80, v16
    v_lshrrev_b32 v17, 5, v0
    v_lshl_add_u32 v15, v17, 4, v15
    s_mul_i32 s29, s23, 1680
    s_add_u32 s29, s29, 48
    v_add_u32 v15, s29, v15
    v_mov_b32 v48, 0
    v_mov_b32 v49, 0
    v_mov_b32 v50, 0
    v_mov_b32 v51, 0
    v_mov_b32 v52, 0
    v_mov_b32 v53, 0
    v_mov_b32 v54, 0
    v_mov_b32 v55, 0
    v_mov_b32 v56, 0
    v_mov_b32 v57, 0
    v_mov_b32 v58, 0
    v_mov_b32 v59, 0
    s_waitcnt vmcnt(0)
    s_barrier
    s_cmp_lg_u32 s13, 0
    s_cbranch_scc1 afront1_kernel_af_go
    s_lshl_b32 s29, s20, 7
    s_add_u32 s29, s29, 10649600
    s_lshl_b32 s30, s21, 2
    v_mov_b32 v16, s30
    v_mov_b32 v17, 1
    s_mov_b64 exec, 1
    buffer_store_dword v17, v16, s[8:11], s29 offen sc1
    s_mov_b64 exec, 0xffff
    v_lshlrev_b32 v16, 2, v0
    s_mov_b32 s31, 400000
afront1_kernel_af_poll:
    buffer_load_dword v17, v16, s[8:11], s29 offen sc1
    s_waitcnt vmcnt(0)
    v_cmp_eq_u32 vcc, 0, v17
    s_sub_u32 s31, s31, 1
    s_cbranch_scc1 afront1_kernel_af_fail
    s_cbranch_vccnz afront1_kernel_af_poll
    s_branch afront1_kernel_af_ok
afront1_kernel_af_fail:
    s_load_dwordx2 s[34:35], s[0:1], 88
    s_waitcnt lgkmcnt(0)
    s_mov_b32 s36, s34
    s_mov_b32 s37, s35
    s_mov_b32 s38, 256
    s_mov_b32 s39, 0x00020000
    s_mov_b64 exec, 1
    v_mov_b32 v16, 0
    v_mov_b32 v17, 0xdead
    buffer_store_dword v17, v16, s[36:39], 0 offen
afront1_kernel_af_ok:
    s_mov_b64 exec, -1
afront1_kernel_af_go:
    s_barrier
    s_lshl_b32 s28, s20, 16
    s_add_u32 s28, s28, 232783872
    s_mov_b64 exec, s[32:33]
    buffer_load_dwordx4 v[160:163], v39, s[8:11], s28 offen sc1
    s_add_u32 s28, s28, 4096
    buffer_load_dwordx4 v[164:167], v39, s[8:11], s28 offen sc1
    s_add_u32 s28, s28, 4096
    buffer_load_dwordx4 v[168:171], v39, s[8:11], s28 offen sc1
    s_add_u32 s28, s28, 4096
    buffer_load_dwordx4 v[172:175], v39, s[8:11], s28 offen sc1
    s_add_u32 s28, s28, 4096
    buffer_load_dwordx4 v[176:179], v39, s[8:11], s28 offen sc1
    s_add_u32 s28, s28, 4096
    buffer_load_dwordx4 v[180:183], v39, s[8:11], s28 offen sc1
    s_add_u32 s28, s28, 4096
    buffer_load_dwordx4 v[184:187], v39, s[8:11], s28 offen sc1
    s_add_u32 s28, s28, 4096
    buffer_load_dwordx4 v[188:191], v39, s[8:11], s28 offen sc1
    s_add_u32 s28, s28, 4096
    buffer_load_dwordx4 v[192:195], v39, s[8:11], s28 offen sc1
    s_add_u32 s28, s28, 4096
    buffer_load_dwordx4 v[196:199], v39, s[8:11], s28 offen sc1
    s_add_u32 s28, s28, 4096
    buffer_load_dwordx4 v[200:203], v39, s[8:11], s28 offen sc1
    s_add_u32 s28, s28, 4096
    buffer_load_dwordx4 v[204:207], v39, s[8:11], s28 offen sc1
    s_add_u32 s28, s28, 4096
    buffer_load_dwordx4 v[208:211], v39, s[8:11], s28 offen sc1
    s_add_u32 s28, s28, 4096
    buffer_load_dwordx4 v[212:215], v39, s[8:11], s28 offen sc1
    s_add_u32 s28, s28, 4096
    buffer_load_dwordx4 v[216:219], v39, s[8:11], s28 offen sc1
    s_add_u32 s28, s28, 4096
    buffer_load_dwordx4 v[220:223], v39, s[8:11], s28 offen sc1
    s_mov_b64 exec, -1
    s_waitcnt vmcnt(14)
    v_add_f32 v160, v160, v164
    v_add_f32 v161, v161, v165
    v_add_f32 v162, v162, v166
    v_add_f32 v163, v163, v167
    s_waitcnt vmcnt(12)
    v_add_f32 v168, v168, v172
    v_add_f32 v169, v169, v173
    v_add_f32 v170, v170, v174
    v_add_f32 v171, v171, v175
    s_waitcnt vmcnt(10)
    v_add_f32 v176, v176, v180
    v_add_f32 v177, v177, v181
    v_add_f32 v178, v178, v182
    v_add_f32 v179, v179, v183
    s_waitcnt vmcnt(8)
    v_add_f32 v184, v184, v188
    v_add_f32 v185, v185, v189
    v_add_f32 v186, v186, v190
    v_add_f32 v187, v187, v191
    s_waitcnt vmcnt(6)
    v_add_f32 v192, v192, v196
    v_add_f32 v193, v193, v197
    v_add_f32 v194, v194, v198
    v_add_f32 v195, v195, v199
    s_waitcnt vmcnt(4)
    v_add_f32 v200, v200, v204
    v_add_f32 v201, v201, v205
    v_add_f32 v202, v202, v206
    v_add_f32 v203, v203, v207
    s_waitcnt vmcnt(2)
    v_add_f32 v208, v208, v212
    v_add_f32 v209, v209, v213
    v_add_f32 v210, v210, v214
    v_add_f32 v211, v211, v215
    s_waitcnt vmcnt(0)
    v_add_f32 v216, v216, v220
    v_add_f32 v217, v217, v221
    v_add_f32 v218, v218, v222
    v_add_f32 v219, v219, v223
    v_add_f32 v160, v160, v168
    v_add_f32 v161, v161, v169
    v_add_f32 v162, v162, v170
    v_add_f32 v163, v163, v171
    v_add_f32 v176, v176, v184
    v_add_f32 v177, v177, v185
    v_add_f32 v178, v178, v186
    v_add_f32 v179, v179, v187
    v_add_f32 v192, v192, v200
    v_add_f32 v193, v193, v201
    v_add_f32 v194, v194, v202
    v_add_f32 v195, v195, v203
    v_add_f32 v208, v208, v216
    v_add_f32 v209, v209, v217
    v_add_f32 v210, v210, v218
    v_add_f32 v211, v211, v219
    v_add_f32 v160, v160, v176
    v_add_f32 v161, v161, v177
    v_add_f32 v162, v162, v178
    v_add_f32 v163, v163, v179
    v_add_f32 v192, v192, v208
    v_add_f32 v193, v193, v209
    v_add_f32 v194, v194, v210
    v_add_f32 v195, v195, v211
    v_add_f32 v160, v160, v192
    v_add_f32 v161, v161, v193
    v_add_f32 v162, v162, v194
    v_add_f32 v163, v163, v195
    v_add_u32 v39, 64, v39
    s_mov_b64 exec, s[32:33]
    ds_write_b128 v39, v[160:163]
    s_mov_b64 exec, -1
    s_waitcnt lgkmcnt(0)
    s_barrier
    s_mov_b32 exec_lo, 0x1fffff
    s_mov_b32 exec_hi, 0x1fffff
    ds_read_b128 v[52:55], v15 offset:32
    ds_read_b128 v[56:59], v15 offset:64
    s_mov_b32 exec_lo, 0
    ds_read_b128 v[48:51], v15
    s_mov_b64 exec, -1
    v_mov_b32 v32, 0
    v_mov_b32 v33, 0
    s_waitcnt lgkmcnt(0)
    v_cvt_pk_bf16_f32 v34, v48, v49
    v_cvt_pk_bf16_f32 v35, v50, v51
    v_cvt_pk_bf16_f32 v36, v52, v53
    v_cvt_pk_bf16_f32 v37, v54, v55
    v_cvt_pk_bf16_f32 v38, v56, v57
    v_cvt_pk_bf16_f32 v39, v58, v59
    s_nop 1
    v_mfma_f32_32x32x16_bf16 v[64:79], v[32:35], v[128:131], 0
    v_mfma_f32_32x32x16_bf16 v[64:79], v[36:39], v[132:135], v[64:79]
    v_mfma_f32_32x32x16_bf16 v[80:95], v[32:35], v[144:147], 0
    v_mfma_f32_32x32x16_bf16 v[80:95], v[36:39], v[148:151], v[80:95]
    s_lshl_b32 s28, s21, 2
    s_lshl_b32 s29, s22, 1
    s_add_u32 s28, s28, s29
    s_mul_i32 s28, s28, 40960
    s_add_u32 s28, s28, 229638144
    s_nop 7
    s_nop 3
    v_add_f32 v40, 0x358637bd, v72
    v_mov_b32 v41, v40
    s_nop 1
    v_permlane32_swap_b32 v40, v41
    v_rcp_f32 v41, v41
    s_nop 0
    v_mul_f32 v64, v64, v41
    v_mul_f32 v65, v65, v41
    v_mul_f32 v66, v66, v41
    v_mul_f32 v67, v67, v41
    v_mul_f32 v68, v68, v41
    v_mul_f32 v69, v69, v41
    v_mul_f32 v70, v70, v41
    v_mul_f32 v71, v71, v41
    v_mul_f32 v72, v72, v41
    v_mul_f32 v73, v73, v41
    v_mul_f32 v74, v74, v41
    v_mul_f32 v75, v75, v41
    v_cvt_pk_bf16_f32 v42, v64, v65
    v_cvt_pk_bf16_f32 v43, v66, v67
    v_cvt_pk_bf16_f32 v44, v68, v69
    v_cvt_pk_bf16_f32 v45, v70, v71
    v_cvt_pk_bf16_f32 v46, v72, v73
    v_cvt_pk_bf16_f32 v47, v74, v75
    buffer_store_dwordx2 v[42:43], v14, s[8:11], s28 offen offset:0
    buffer_store_dwordx2 v[44:45], v14, s[8:11], s28 offen offset:512
    s_mov_b32 exec_hi, 0
    buffer_store_dwordx2 v[46:47], v14, s[8:11], s28 offen offset:1024
    s_mov_b32 exec_hi, -1
    s_add_u32 s28, s28, 40960
    s_nop 7
    v_add_f32 v40, 0x358637bd, v88
    v_mov_b32 v41, v40
    s_nop 1
    v_permlane32_swap_b32 v40, v41
    v_rcp_f32 v41, v41
    s_nop 0
    v_mul_f32 v80, v80, v41
    v_mul_f32 v81, v81, v41
    v_mul_f32 v82, v82, v41
    v_mul_f32 v83, v83, v41
    v_mul_f32 v84, v84, v41
    v_mul_f32 v85, v85, v41
    v_mul_f32 v86, v86, v41
    v_mul_f32 v87, v87, v41
    v_mul_f32 v88, v88, v41
    v_mul_f32 v89, v89, v41
    v_mul_f32 v90, v90, v41
    v_mul_f32 v91, v91, v41
    v_cvt_pk_bf16_f32 v48, v80, v81
    v_cvt_pk_bf16_f32 v49, v82, v83
    v_cvt_pk_bf16_f32 v50, v84, v85
    v_cvt_pk_bf16_f32 v51, v86, v87
    v_cvt_pk_bf16_f32 v52, v88, v89
    v_cvt_pk_bf16_f32 v53, v90, v91
    buffer_store_dwordx2 v[48:49], v14, s[8:11], s28 offen offset:0
    buffer_store_dwordx2 v[50:51], v14, s[8:11], s28 offen offset:512
    s_mov_b32 exec_hi, 0
    buffer_store_dwordx2 v[52:53], v14, s[8:11], s28 offen offset:1024
    s_mov_b32 exec_hi, -1
afront1_kernel_end:
    s_endpgm
.section .rodata,"a"
.p2align 6
.amdhsa_kernel afront1_kernel
  .amdhsa_next_free_vgpr 256
  .amdhsa_next_free_sgpr 64
  .amdhsa_accum_offset 256
  .amdhsa_group_segment_fixed_size 0
  .amdhsa_kernarg_size 104
  .amdhsa_user_sgpr_count 2
  .amdhsa_user_sgpr_kernarg_segment_ptr 1
  .amdhsa_system_sgpr_workgroup_id_x 1
.end_amdhsa_kernel
.text
.globl layerb2_kernel
.p2align 8
.type layerb2_kernel,@function
layerb2_kernel:
    s_mov_b32 s49, 1
    s_branch layerb1_kernel_body
    s_endpgm
.section .rodata,"a"
.p2align 6
.amdhsa_kernel layerb2_kernel
  .amdhsa_next_free_vgpr 512
  .amdhsa_next_free_sgpr 100
  .amdhsa_accum_offset 256
  .amdhsa_group_segment_fixed_size 0
  .amdhsa_kernarg_size 104
  .amdhsa_user_sgpr_count 2
  .amdhsa_user_sgpr_kernarg_segment_ptr 1
  .amdhsa_system_sgpr_workgroup_id_x 1
.end_amdhsa_kernel
.text
.globl layerb1_kernel
.p2align 8
.type layerb1_kernel,@function
layerb1_kernel:
    s_mov_b32 s49, 0
layerb1_kernel_body:
    s_cmp_ge_u32 s2, 256
    s_cbranch_scc1 layerb1_kernel_end0
    s_load_dwordx2 s[4:5], s[0:1], 96
    s_load_dwordx2 s[6:7], s[0:1], 80
    v_lshrrev_b32 v1, 6, v0
    v_and_b32 v0, 63, v0
    s_nop 0
    v_readfirstlane_b32 s13, v1
    s_mov_b32 s15, 400000
    s_waitcnt lgkmcnt(0)
    s_mov_b32 s8, s4
    s_mov_b32 s9, s5
    s_mov_b32 s10, 268435456
    s_mov_b32 s11, 0x00020000
    s_add_u32 s22, s4, 247463936
    s_addc_u32 s23, s5, 0
    s_cmp_eq_u32 s49, 0
    s_cselect_b32 s84, s22, s6
    s_cselect_b32 s85, s23, s7
    s_mov_b32 s86, 2621440
    s_mov_b32 s87, 0x00020000
    s_mul_i32 s48, s49, 65536
    s_add_u32 s48, s48, 10616832
    s_lshl_b32 s19, s49, 11
    s_add_u32 s19, s19, 10485760
    s_getreg_b32 s20, hwreg(HW_REG_XCC_ID)
    s_and_b32 s20, s20, 7
    s_cmp_lg_u32 s13, 0
    s_cbranch_scc1 layerb1_kernel_tk_wait
    s_lshl_b32 s22, s20, 8
    s_add_u32 s22, s22, s19
    s_mov_b64 exec, 1
    v_mov_b32 v2, 0
    v_mov_b32 v3, 1
    buffer_atomic_add v3, v2, s[8:11], s22 offen sc0 sc1
    s_waitcnt vmcnt(0)
    s_mov_b64 exec, -1
    s_nop 0
    v_readfirstlane_b32 s21, v3
    s_cmp_lt_u32 s21, 32
    s_cbranch_scc1 layerb1_kernel_tk_pub
    v_lshlrev_b32 v2, 8, v0
    v_and_b32 v2, 0x7ff, v2
    s_mov_b32 s22, s19
layerb1_kernel_tk_poll:
    buffer_load_dword v3, v2, s[8:11], s22 offen sc1
    s_waitcnt vmcnt(0)
    s_mov_b32 s23, 0
    v_readlane_b32 s24, v3, 0
    s_nop 0
    s_add_u32 s23, s23, s24
    v_readlane_b32 s25, v3, 1
    s_nop 0
    s_add_u32 s23, s23, s25
    v_readlane_b32 s26, v3, 2
    s_nop 0
    s_add_u32 s23, s23, s26
    v_readlane_b32 s27, v3, 3
    s_nop 0
    s_add_u32 s23, s23, s27
    v_readlane_b32 s28, v3, 4
    s_nop 0
    s_add_u32 s23, s23, s28
    v_readlane_b32 s29, v3, 5
    s_nop 0
    s_add_u32 s23, s23, s29
    v_readlane_b32 s30, v3, 6
    s_nop 0
    s_add_u32 s23, s23, s30
    v_readlane_b32 s31, v3, 7
    s_nop 0
    s_add_u32 s23, s23, s31
    s_sub_u32 s15, s15, 1
    s_cbranch_scc1 layerb1_kernel_bail
    s_cmp_lt_u32 s23, 256
    s_cbranch_scc1 layerb1_kernel_tk_poll
    s_sub_u32 s21, s21, 32
    s_max_u32 s23, s24, 32
    s_sub_u32 s23, s23, 32
    s_cmp_gt_u32 s20, 0
    s_cselect_b32 s23, s23, 0
    s_add_u32 s21, s21, s23
    s_max_u32 s23, s25, 32
    s_sub_u32 s23, s23, 32
    s_cmp_gt_u32 s20, 1
    s_cselect_b32 s23, s23, 0
    s_add_u32 s21, s21, s23
    s_max_u32 s23, s26, 32
    s_sub_u32 s23, s23, 32
    s_cmp_gt_u32 s20, 2
    s_cselect_b32 s23, s23, 0
    s_add_u32 s21, s21, s23
    s_max_u32 s23, s27, 32
    s_sub_u32 s23, s23, 32
    s_cmp_gt_u32 s20, 3
    s_cselect_b32 s23, s23, 0
    s_add_u32 s21, s21, s23
    s_max_u32 s23, s28, 32
    s_sub_u32 s23, s23, 32
    s_cmp_gt_u32 s20, 4
    s_cselect_b32 s23, s23, 0
    s_add_u32 s21, s21, s23
    s_max_u32 s23, s29, 32
    s_sub_u32 s23, s23, 32
    s_cmp_gt_u32 s20, 5
    s_cselect_b32 s23, s23, 0
    s_add_u32 s21, s21, s23
    s_max_u32 s23, s30, 32
    s_sub_u32 s23, s23, 32
    s_cmp_gt_u32 s20, 6
    s_cselect_b32 s23, s23, 0
    s_add_u32 s21, s21, s23
    s_min_u32 s23, s24, 32
    s_sub_u32 s22, 32, s23
    s_cmp_lt_u32 s21, s22
    s_cbranch_scc0 layerb1_kernel_tk_n0
    s_mov_b32 s20, 0
    s_add_u32 s21, s21, s23
    s_branch layerb1_kernel_tk_pub
layerb1_kernel_tk_n0:
    s_sub_u32 s21, s21, s22
    s_min_u32 s23, s25, 32
    s_sub_u32 s22, 32, s23
    s_cmp_lt_u32 s21, s22
    s_cbranch_scc0 layerb1_kernel_tk_n1
    s_mov_b32 s20, 1
    s_add_u32 s21, s21, s23
    s_branch layerb1_kernel_tk_pub
layerb1_kernel_tk_n1:
    s_sub_u32 s21, s21, s22
    s_min_u32 s23, s26, 32
    s_sub_u32 s22, 32, s23
    s_cmp_lt_u32 s21, s22
    s_cbranch_scc0 layerb1_kernel_tk_n2
    s_mov_b32 s20, 2
    s_add_u32 s21, s21, s23
    s_branch layerb1_kernel_tk_pub
layerb1_kernel_tk_n2:
    s_sub_u32 s21, s21, s22
    s_min_u32 s23, s27, 32
    s_sub_u32 s22, 32, s23
    s_cmp_lt_u32 s21, s22
    s_cbranch_scc0 layerb1_kernel_tk_n3
    s_mov_b32 s20, 3
    s_add_u32 s21, s21, s23
    s_branch layerb1_kernel_tk_pub
layerb1_kernel_tk_n3:
    s_sub_u32 s21, s21, s22
    s_min_u32 s23, s28, 32
    s_sub_u32 s22, 32, s23
    s_cmp_lt_u32 s21, s22
    s_cbranch_scc0 layerb1_kernel_tk_n4
    s_mov_b32 s20, 4
    s_add_u32 s21, s21, s23
    s_branch layerb1_kernel_tk_pub
layerb1_kernel_tk_n4:
    s_sub_u32 s21, s21, s22
    s_min_u32 s23, s29, 32
    s_sub_u32 s22, 32, s23
    s_cmp_lt_u32 s21, s22
    s_cbranch_scc0 layerb1_kernel_tk_n5
    s_mov_b32 s20, 5
    s_add_u32 s21, s21, s23
    s_branch layerb1_kernel_tk_pub
layerb1_kernel_tk_n5:
    s_sub_u32 s21, s21, s22
    s_min_u32 s23, s30, 32
    s_sub_u32 s22, 32, s23
    s_cmp_lt_u32 s21, s22
    s_cbranch_scc0 layerb1_kernel_tk_n6
    s_mov_b32 s20, 6
    s_add_u32 s21, s21, s23
    s_branch layerb1_kernel_tk_pub
layerb1_kernel_tk_n6:
    s_sub_u32 s21, s21, s22
    s_min_u32 s23, s31, 32
    s_sub_u32 s22, 32, s23
    s_cmp_lt_u32 s21, s22
    s_cbranch_scc0 layerb1_kernel_tk_n7
    s_mov_b32 s20, 7
    s_add_u32 s21, s21, s23
    s_branch layerb1_kernel_tk_pub
layerb1_kernel_tk_n7:
    s_sub_u32 s21, s21, s22
    s_branch layerb1_kernel_bail
layerb1_kernel_tk_pub:
    s_lshl_b32 s22, s20, 8
    s_or_b32 s22, s22, s21
    v_mov_b32 v2, 0
    v_mov_b32 v3, s22
    ds_write_b32 v2, v3
    s_waitcnt lgkmcnt(0)
layerb1_kernel_tk_wait:
    s_barrier
    v_mov_b32 v2, 0
    ds_read_b32 v3, v2
    s_waitcnt lgkmcnt(0)
    v_readfirstlane_b32 s22, v3
    s_barrier
    s_lshr_b32 s20, s22, 8
    s_and_b32 s21, s22, 255
    s_sub_u32 s22, 0, s4
    s_and_b32 s22, s22, 0x1fffff
    s_lshl_b32 s23, s49, 3
    s_add_u32 s23, s23, 10551296
    s_buffer_load_dwordx2 s[24:25], s[8:11], s23
    s_waitcnt lgkmcnt(0)
    s_and_b32 s24, s24, 8192
    s_and_b32 s25, s25, 8192
    s_lshl_b32 s82, s24, 1
    s_sub_u32 s82, 8192, s82
    s_lshl_b32 s83, s25, 1
    s_sub_u32 s83, 8192, s83
    s_mul_i32 s23, s49, 4194304
    s_add_u32 s22, s22, s23
    s_add_u32 s16, s22, s24
    s_add_u32 s17, s22, s25
    s_add_u32 s17, s17, 2097152
    s_mov_b32 s40, 0x01010101
    s_mov_b32 s41, 0x01010101
    s_mov_b32 s42, 0x00010001
    s_mov_b32 s43, 0
    v_lshlrev_b32 v1, 4, v0
    v_and_b32 v16, 8, v0
    v_cmp_eq_u32 vcc, 0, v16
    v_mov_b32 v17, 0xeeeeeeee
    v_mov_b32 v18, 0x44444444
    v_cndmask_b32 v2, v17, v18, vcc
    s_cmp_eq_u32 s20, 0
    s_cbranch_scc0 layerb1_kernel_notp
    s_mov_b32 s12, s21
    s_cmp_eq_u32 s13, 0
    s_cbranch_scc1 layerb1_kernel_p0_start
    s_cmp_eq_u32 s13, 1
    s_cbranch_scc1 layerb1_kernel_p1_start
    s_cmp_eq_u32 s13, 2
    s_cbranch_scc1 layerb1_kernel_p2_start
    s_cmp_eq_u32 s13, 3
    s_cbranch_scc1 layerb1_kernel_p3_start
layerb1_kernel_notp:
    s_cmp_ge_u32 s20, 4
    s_cbranch_scc1 layerb1_kernel_proj
    s_cmp_ge_u32 s21, 27
    s_cbranch_scc1 layerb1_kernel_spare
    s_sub_u32 s22, s20, 1
    s_mul_i32 s22, s22, 27
    s_add_u32 s12, s22, s21
    s_cmp_ge_u32 s12, 80
    s_cbranch_scc1 layerb1_kernel_spare
    s_cmp_eq_u32 s13, 0
    s_cbranch_scc1 layerb1_kernel_y0_start
    s_cmp_eq_u32 s13, 1
    s_cbranch_scc1 layerb1_kernel_y1_start
    s_cmp_eq_u32 s13, 2
    s_cbranch_scc1 layerb1_kernel_y2_start
    s_cmp_eq_u32 s13, 3
    s_cbranch_scc1 layerb1_kernel_y3_start
    s_branch layerb1_kernel_end
layerb1_kernel_p0_start:
    v_lshrrev_b32 v16, 4, v0
    v_and_b32 v17, 15, v0
    v_and_b32 v18, 1, v16
    v_lshlrev_b32 v18, 2, v18
    v_lshrrev_b32 v19, 1, v16
    v_lshl_add_u32 v18, v19, 1, v18
    v_mul_u32_u24 v18, 400, v18
    v_lshl_add_u32 v18, v17, 1, v18
    v_add_u32 v3, 133120, v18
    v_and_b32 v18, 7, v0
    v_mul_u32_u24 v18, 400, v18
    v_lshrrev_b32 v19, 3, v0
    v_lshl_add_u32 v18, v19, 4, v18
    v_add_u32 v4, 133120, v18
    v_and_b32 v18, 7, v0
    v_mul_u32_u24 v18, 400, v18
    v_lshl_add_u32 v18, v16, 5, v18
    v_add_u32 v5, 136320, v18
    v_lshrrev_b32 v18, 1, v16
    v_lshlrev_b32 v18, 10, v18
    v_and_b32 v19, 31, v0
    v_lshl_add_u32 v18, v19, 4, v18
    v_add_u32 v6, 139520, v18
    v_add_u32 v15, 139520, v1
    v_lshrrev_b32 v18, 1, v16
    v_lshlrev_b32 v18, 1, v18
    v_lshrrev_b32 v19, 3, v17
    v_add3_u32 v18, v18, v19, 1
    v_lshrrev_b32 v19, 1, v18
    v_lshlrev_b32 v19, 14, v19
    v_and_b32 v18, 1, v18
    v_lshl_add_u32 v18, v18, 12, v19
    v_and_b32 v19, 1, v16
    v_lshlrev_b32 v19, 4, v19
    v_add_u32 v19, 0, v19
    s_lshl_b32 s20, s12, 7
    v_add_u32 v8, s20, v19
    v_add_u32 v7, v8, v18
    v_lshlrev_b32 v18, 4, v17
    v_lshl_add_u32 v18, v16, 10, v18
    v_add_u32 v9, 0, v18
    v_add_u32 v18, 0, v0
    v_mul_u32_u24 v19, 2731, v18
    v_lshrrev_b32 v19, 16, v19
    v_mul_u32_u24 v20, 24, v19
    v_sub_u32 v20, v18, v20
    v_mul_u32_u24 v21, 400, v19
    v_lshl_add_u32 v21, v20, 4, v21
    v_add_u32 v10, 136320, v21
    v_lshlrev_b32 v21, 4, v19
    v_lshl_add_u32 v11, v20, 7, v21
    v_and_b32 v18, 0x28, v0
    v_cmp_eq_u32 vcc, 0, v18
    v_mov_b32 v18, 1.0
    v_mov_b32 v19, 0
    v_cndmask_b32 v12, v19, v18, vcc
    v_add_u32 v13, 0, v1
    v_add_u32 v14, 122880, v1
    s_mul_i32 s44, s12, 12288
    s_add_u32 s44, s44, 53477376
    s_mul_i32 s45, s12, 3072
    s_add_u32 s45, s45, 208666624
    s_mul_i32 s20, s12, 6
    s_add_u32 s21, s20, 5
    s_lshr_b32 s20, s20, 3
    s_lshr_b32 s21, s21, 3
    s_add_u32 s20, s20, 80
    s_add_u32 s21, s21, 80
    s_lshl_b32 s20, s20, 7
    s_lshl_b32 s21, s21, 7
    v_mov_b32 v255, s21
    v_mov_b32 v253, s20
    v_cmp_eq_u32 vcc, 0, v0
    s_nop 1
    v_cndmask_b32 v255, v255, v253, vcc
    s_mov_b32 s47, 0
    s_mul_i32 s20, s12, 491520
    s_add_u32 s20, s20, 11534336
    s_add_u32 s21, s20, 6144
    buffer_load_dwordx4 v[16:19], v1, s[8:11], s21 offen offset:0
    buffer_load_dwordx4 v[20:23], v1, s[8:11], s21 offen offset:1024
    s_add_u32 s21, s20, 47104
    buffer_load_dwordx4 v[24:27], v1, s[8:11], s21 offen offset:0
    buffer_load_dwordx4 v[28:31], v1, s[8:11], s21 offen offset:1024
    s_add_u32 s21, s20, 28672
    buffer_load_dwordx4 v[32:35], v1, s[8:11], s21 offen offset:0
    buffer_load_dwordx4 v[36:39], v1, s[8:11], s21 offen offset:1024
    s_add_u32 s21, s20, 10240
    buffer_load_dwordx4 v[40:43], v1, s[8:11], s21 offen offset:0
    buffer_load_dwordx4 v[44:47], v1, s[8:11], s21 offen offset:1024
    s_add_u32 s21, s20, 51200
    buffer_load_dwordx4 v[48:51], v1, s[8:11], s21 offen offset:0
    buffer_load_dwordx4 v[52:55], v1, s[8:11], s21 offen offset:1024
    s_add_u32 s21, s20, 32768
    buffer_load_dwordx4 v[56:59], v1, s[8:11], s21 offen offset:0
    buffer_load_dwordx4 v[60:63], v1, s[8:11], s21 offen offset:1024
    s_add_u32 s21, s20, 14336
    buffer_load_dwordx4 v[64:67], v1, s[8:11], s21 offen offset:0
    buffer_load_dwordx4 v[68:71], v1, s[8:11], s21 offen offset:1024
    s_add_u32 s21, s20, 55296
    buffer_load_dwordx4 v[72:75], v1, s[8:11], s21 offen offset:0
    buffer_load_dwordx4 v[76:79], v1, s[8:11], s21 offen offset:1024
    s_add_u32 s21, s20, 36864
    buffer_load_dwordx4 v[80:83], v1, s[8:11], s21 offen offset:0
    buffer_load_dwordx4 v[84:87], v1, s[8:11], s21 offen offset:1024
    s_add_u32 s21, s20, 18432
    buffer_load_dwordx4 v[88:91], v1, s[8:11], s21 offen offset:0
    buffer_load_dwordx4 v[92:95], v1, s[8:11], s21 offen offset:1024
    s_add_u32 s21, s20, 59392
    buffer_load_dwordx4 v[96:99], v1, s[8:11], s21 offen offset:0
    buffer_load_dwordx4 v[100:103], v1, s[8:11], s21 offen offset:1024
    s_add_u32 s21, s20, 90112
    buffer_load_dwordx4 v[104:107], v1, s[8:11], s21 offen offset:0
    buffer_load_dwordx4 v[108:111], v1, s[8:11], s21 offen offset:1024
    s_add_u32 s21, s20, 98304
    buffer_load_dwordx4 v[112:115], v1, s[8:11], s21 offen offset:0
    buffer_load_dwordx4 v[116:119], v1, s[8:11], s21 offen offset:1024
    s_add_u32 s21, s20, 106496
    buffer_load_dwordx4 v[120:123], v1, s[8:11], s21 offen offset:0
    buffer_load_dwordx4 v[124:127], v1, s[8:11], s21 offen offset:1024
    s_add_u32 s21, s20, 114688
    buffer_load_dwordx4 v[128:131], v1, s[8:11], s21 offen offset:0
    buffer_load_dwordx4 v[132:135], v1, s[8:11], s21 offen offset:1024
    s_add_u32 s21, s20, 0
    buffer_load_dwordx4 a[0:3], v1, s[8:11], s21 offen offset:0
    buffer_load_dwordx4 a[4:7], v1, s[8:11], s21 offen offset:1024
    s_add_u32 s21, s20, 20480
    buffer_load_dwordx4 a[8:11], v1, s[8:11], s21 offen offset:0
    buffer_load_dwordx4 a[12:15], v1, s[8:11], s21 offen offset:1024
    s_add_u32 s21, s20, 40960
    buffer_load_dwordx4 a[16:19], v1, s[8:11], s21 offen offset:0
    buffer_load_dwordx4 a[20:23], v1, s[8:11], s21 offen offset:1024
    s_add_u32 s21, s20, 2048
    buffer_load_dwordx4 a[24:27], v1, s[8:11], s21 offen offset:0
    buffer_load_dwordx4 a[28:31], v1, s[8:11], s21 offen offset:1024
    s_add_u32 s21, s20, 22528
    buffer_load_dwordx4 a[32:35], v1, s[8:11], s21 offen offset:0
    buffer_load_dwordx4 a[36:39], v1, s[8:11], s21 offen offset:1024
    s_add_u32 s21, s20, 43008
    buffer_load_dwordx4 a[40:43], v1, s[8:11], s21 offen offset:0
    buffer_load_dwordx4 a[44:47], v1, s[8:11], s21 offen offset:1024
    s_add_u32 s21, s20, 4096
    buffer_load_dwordx4 a[48:51], v1, s[8:11], s21 offen offset:0
    buffer_load_dwordx4 a[52:55], v1, s[8:11], s21 offen offset:1024
    s_add_u32 s21, s20, 24576
    buffer_load_dwordx4 a[56:59], v1, s[8:11], s21 offen offset:0
    buffer_load_dwordx4 a[60:63], v1, s[8:11], s21 offen offset:1024
    s_add_u32 s21, s20, 45056
    buffer_load_dwordx4 a[64:67], v1, s[8:11], s21 offen offset:0
    buffer_load_dwordx4 a[68:71], v1, s[8:11], s21 offen offset:1024
    s_add_u32 s21, s20, 26624
    buffer_load_dwordx4 a[72:75], v1, s[8:11], s21 offen offset:0
    buffer_load_dwordx4 a[76:79], v1, s[8:11], s21 offen offset:1024
    s_add_u32 s21, s20, 8192
    buffer_load_dwordx4 a[80:83], v1, s[8:11], s21 offen offset:0
    buffer_load_dwordx4 a[84:87], v1, s[8:11], s21 offen offset:1024
    s_add_u32 s21, s20, 49152
    buffer_load_dwordx4 a[88:91], v1, s[8:11], s21 offen offset:0
    buffer_load_dwordx4 a[92:95], v1, s[8:11], s21 offen offset:1024
    s_add_u32 s21, s20, 30720
    buffer_load_dwordx4 a[96:99], v1, s[8:11], s21 offen offset:0
    buffer_load_dwordx4 a[100:103], v1, s[8:11], s21 offen offset:1024
    s_add_u32 s21, s20, 12288
    buffer_load_dwordx4 a[104:107], v1, s[8:11], s21 offen offset:0
    buffer_load_dwordx4 a[108:111], v1, s[8:11], s21 offen offset:1024
    s_add_u32 s21, s20, 53248
    buffer_load_dwordx4 a[112:115], v1, s[8:11], s21 offen offset:0
    buffer_load_dwordx4 a[116:119], v1, s[8:11], s21 offen offset:1024
    s_add_u32 s21, s20, 34816
    buffer_load_dwordx4 a[120:123], v1, s[8:11], s21 offen offset:0
    buffer_load_dwordx4 a[124:127], v1, s[8:11], s21 offen offset:1024
    s_waitcnt vmcnt(32)
    ds_write_b128 v13, v[16:19] offset:0
    ds_write_b128 v13, v[20:23] offset:1024
    ds_write_b128 v13, v[24:27] offset:2048
    ds_write_b128 v13, v[28:31] offset:3072
    ds_write_b128 v13, v[32:35] offset:4096
    ds_write_b128 v13, v[36:39] offset:5120
    ds_write_b128 v13, v[40:43] offset:6144
    ds_write_b128 v13, v[44:47] offset:7168
    ds_write_b128 v13, v[48:51] offset:8192
    ds_write_b128 v13, v[52:55] offset:9216
    ds_write_b128 v13, v[56:59] offset:10240
    ds_write_b128 v13, v[60:63] offset:11264
    ds_write_b128 v13, v[64:67] offset:12288
    ds_write_b128 v13, v[68:71] offset:13312
    ds_write_b128 v13, v[72:75] offset:14336
    ds_write_b128 v13, v[76:79] offset:15360
    ds_write_b128 v13, v[80:83] offset:16384
    ds_write_b128 v13, v[84:87] offset:17408
    ds_write_b128 v13, v[88:91] offset:18432
    ds_write_b128 v13, v[92:95] offset:19456
    ds_write_b128 v13, v[96:99] offset:20480
    ds_write_b128 v13, v[100:103] offset:21504
    ds_write_b128 v13, v[104:107] offset:22528
    ds_write_b128 v13, v[108:111] offset:23552
    ds_write_b128 v13, v[112:115] offset:24576
    ds_write_b128 v13, v[116:119] offset:25600
    ds_write_b128 v13, v[120:123] offset:26624
    ds_write_b128 v13, v[124:127] offset:27648
    ds_write_b128 v13, v[128:131] offset:28672
    ds_write_b128 v13, v[132:135] offset:29696
    s_add_u32 s21, s20, 16384
    buffer_load_dwordx4 a[128:131], v1, s[8:11], s21 offen offset:0
    buffer_load_dwordx4 a[132:135], v1, s[8:11], s21 offen offset:1024
    s_add_u32 s21, s20, 57344
    buffer_load_dwordx4 a[136:139], v1, s[8:11], s21 offen offset:0
    buffer_load_dwordx4 a[140:143], v1, s[8:11], s21 offen offset:1024
    s_add_u32 s21, s20, 38912
    buffer_load_dwordx4 a[144:147], v1, s[8:11], s21 offen offset:0
    buffer_load_dwordx4 a[148:151], v1, s[8:11], s21 offen offset:1024
    s_add_u32 s21, s20, 61440
    buffer_load_dwordx4 a[152:155], v1, s[8:11], s21 offen offset:0
    buffer_load_dwordx4 a[156:159], v1, s[8:11], s21 offen offset:1024
    s_add_u32 s21, s20, 63488
    buffer_load_dwordx4 a[160:163], v1, s[8:11], s21 offen offset:0
    buffer_load_dwordx4 a[164:167], v1, s[8:11], s21 offen offset:1024
    s_add_u32 s21, s20, 65536
    buffer_load_dwordx4 a[168:171], v1, s[8:11], s21 offen offset:0
    buffer_load_dwordx4 a[172:175], v1, s[8:11], s21 offen offset:1024
    s_add_u32 s21, s20, 67584
    buffer_load_dwordx4 a[176:179], v1, s[8:11], s21 offen offset:0
    buffer_load_dwordx4 a[180:183], v1, s[8:11], s21 offen offset:1024
    s_add_u32 s21, s20, 69632
    buffer_load_dwordx4 a[184:187], v1, s[8:11], s21 offen offset:0
    buffer_load_dwordx4 a[188:191], v1, s[8:11], s21 offen offset:1024
    s_add_u32 s21, s20, 71680
    buffer_load_dwordx4 a[192:195], v1, s[8:11], s21 offen offset:0
    buffer_load_dwordx4 a[196:199], v1, s[8:11], s21 offen offset:1024
    s_add_u32 s21, s20, 73728
    buffer_load_dwordx4 a[200:203], v1, s[8:11], s21 offen offset:0
    buffer_load_dwordx4 a[204:207], v1, s[8:11], s21 offen offset:1024
    s_add_u32 s21, s20, 75776
    buffer_load_dwordx4 a[208:211], v1, s[8:11], s21 offen offset:0
    buffer_load_dwordx4 a[212:215], v1, s[8:11], s21 offen offset:1024
    s_add_u32 s21, s20, 77824
    buffer_load_dwordx4 a[216:219], v1, s[8:11], s21 offen offset:0
    buffer_load_dwordx4 a[220:223], v1, s[8:11], s21 offen offset:1024
    s_add_u32 s21, s20, 79872
    buffer_load_dwordx4 a[224:227], v1, s[8:11], s21 offen offset:0
    buffer_load_dwordx4 a[228:231], v1, s[8:11], s21 offen offset:1024
    s_add_u32 s21, s20, 81920
    buffer_load_dwordx4 a[232:235], v1, s[8:11], s21 offen offset:0
    buffer_load_dwordx4 a[236:239], v1, s[8:11], s21 offen offset:1024
    s_add_u32 s21, s20, 83968
    buffer_load_dwordx4 a[240:243], v1, s[8:11], s21 offen offset:0
    buffer_load_dwordx4 a[244:247], v1, s[8:11], s21 offen offset:1024
    s_add_u32 s21, s20, 86016
    buffer_load_dwordx4 a[248:251], v1, s[8:11], s21 offen offset:0
    buffer_load_dwordx4 a[252:255], v1, s[8:11], s21 offen offset:1024
    s_add_u32 s21, s20, 88064
    buffer_load_dwordx4 v[148:151], v1, s[8:11], s21 offen offset:0
    buffer_load_dwordx4 v[152:155], v1, s[8:11], s21 offen offset:1024
    s_add_u32 s21, s20, 92160
    buffer_load_dwordx4 v[156:159], v1, s[8:11], s21 offen offset:0
    buffer_load_dwordx4 v[160:163], v1, s[8:11], s21 offen offset:1024
    s_add_u32 s21, s20, 94208
    buffer_load_dwordx4 v[164:167], v1, s[8:11], s21 offen offset:0
    buffer_load_dwordx4 v[168:171], v1, s[8:11], s21 offen offset:1024
    s_add_u32 s21, s20, 96256
    buffer_load_dwordx4 v[172:175], v1, s[8:11], s21 offen offset:0
    buffer_load_dwordx4 v[176:179], v1, s[8:11], s21 offen offset:1024
    s_add_u32 s21, s20, 100352
    buffer_load_dwordx4 v[180:183], v1, s[8:11], s21 offen offset:0
    buffer_load_dwordx4 v[184:187], v1, s[8:11], s21 offen offset:1024
    s_add_u32 s21, s20, 102400
    buffer_load_dwordx4 v[188:191], v1, s[8:11], s21 offen offset:0
    buffer_load_dwordx4 v[192:195], v1, s[8:11], s21 offen offset:1024
    s_add_u32 s21, s20, 104448
    buffer_load_dwordx4 v[196:199], v1, s[8:11], s21 offen offset:0
    buffer_load_dwordx4 v[200:203], v1, s[8:11], s21 offen offset:1024
    s_add_u32 s21, s20, 108544
    buffer_load_dwordx4 v[204:207], v1, s[8:11], s21 offen offset:0
    buffer_load_dwordx4 v[208:211], v1, s[8:11], s21 offen offset:1024
    s_add_u32 s21, s20, 110592
    buffer_load_dwordx4 v[212:215], v1, s[8:11], s21 offen offset:0
    buffer_load_dwordx4 v[216:219], v1, s[8:11], s21 offen offset:1024
    s_add_u32 s21, s20, 112640
    buffer_load_dwordx4 v[220:223], v1, s[8:11], s21 offen offset:0
    buffer_load_dwordx4 v[224:227], v1, s[8:11], s21 offen offset:1024
    s_add_u32 s21, s20, 116736
    buffer_load_dwordx4 v[228:231], v1, s[8:11], s21 offen offset:0
    buffer_load_dwordx4 v[232:235], v1, s[8:11], s21 offen offset:1024
    s_add_u32 s21, s20, 118784
    buffer_load_dwordx4 v[236:239], v1, s[8:11], s21 offen offset:0
    buffer_load_dwordx4 v[240:243], v1, s[8:11], s21 offen offset:1024
    s_add_u32 s21, s20, 120832
    buffer_load_dwordx4 v[244:247], v1, s[8:11], s21 offen offset:0
    buffer_load_dwordx4 v[248:251], v1, s[8:11], s21 offen offset:1024
    s_waitcnt lgkmcnt(0)
    s_mov_b32 s14, 0
    s_cmp_gt_u32 s47, s14
    s_cbranch_scc1 layerb1_kernel_p0_gw1_ok
layerb1_kernel_p0_gw1_lp:
    buffer_load_dword v253, v255, s[8:11], s48 offen sc1
    s_waitcnt vmcnt(0)
    v_readlane_b32 s47, v253, 0
    v_readlane_b32 s29, v253, 1
    s_nop 0
    s_min_u32 s47, s47, s29
    s_sub_u32 s15, s15, 1
    s_cbranch_scc1 layerb1_kernel_bail
    s_cmp_gt_u32 s47, s14
    s_cbranch_scc0 layerb1_kernel_p0_gw1_lp
layerb1_kernel_p0_gw1_ok:
    s_mul_i32 s20, s14, 393216
    s_add_u32 s20, s20, s44
    s_add_u32 s21, s20, 0
    buffer_load_dwordx4 v[100:103], v9, s[8:11], s21 offen offset:0 sc1
    buffer_load_dwordx4 v[104:107], v9, s[8:11], s21 offen offset:512 sc1
    s_add_u32 s21, s20, 4096
    buffer_load_dwordx4 v[108:111], v9, s[8:11], s21 offen offset:0 sc1
    buffer_load_dwordx4 v[112:115], v9, s[8:11], s21 offen offset:512 sc1
    v_mov_b32 v56, 0
    v_mov_b32 v57, 0
    v_mov_b32 v58, 0
    v_mov_b32 v59, 0
    v_mov_b32 v60, 0
    v_mov_b32 v61, 0
    v_mov_b32 v62, 0
    v_mov_b32 v63, 0
    v_mov_b32 v64, 0
    v_mov_b32 v65, 0
    v_mov_b32 v66, 0
    v_mov_b32 v67, 0
    v_mov_b32 v68, 0
    v_mov_b32 v69, 0
    v_mov_b32 v70, 0
    v_mov_b32 v71, 0
    v_mov_b32 v72, 0
    v_mov_b32 v73, 0
    v_mov_b32 v74, 0
    v_mov_b32 v75, 0
    v_mov_b32 v76, 0
    v_mov_b32 v77, 0
    v_mov_b32 v78, 0
    v_mov_b32 v79, 0
    v_mov_b32 v80, 0
    v_mov_b32 v81, 0
    v_mov_b32 v82, 0
    v_mov_b32 v83, 0
    v_mov_b32 v84, 0
    v_mov_b32 v85, 0
    v_mov_b32 v86, 0
    v_mov_b32 v87, 0
    ds_read_b128 v[116:119], v13 offset:0
    ds_read_b128 v[120:123], v13 offset:1024
    ds_read_b128 v[124:127], v13 offset:2048
    ds_read_b128 v[128:131], v13 offset:3072
    ds_read_b128 v[132:135], v13 offset:4096
    ds_read_b128 v[136:139], v13 offset:5120
    ds_read_b128 v[140:143], v13 offset:6144
    ds_read_b128 v[144:147], v13 offset:7168
    s_waitcnt lgkmcnt(0)
layerb1_kernel_p0_step:
    s_cmp_lt_u32 s14, 32
    s_cselect_b32 s18, s16, s17
    s_and_b32 s20, s14, 31
    s_lshl_b32 s20, s20, 16
    s_add_u32 s18, s18, s20
    s_add_u32 s22, s18, 36864
    s_add_u32 s23, s18, 37888
    s_add_u32 s24, s18, 38912
layerb1_kernel_p0_poll:
    buffer_load_dwordx4 v[16:19], v1, s[8:11], s22 offen sc1
    buffer_load_dwordx4 v[20:23], v1, s[8:11], s23 offen sc1
    buffer_load_dwordx4 v[24:27], v1, s[8:11], s24 offen sc1
    s_waitcnt vmcnt(0)
    ds_write_b128 v14, v[16:19] offset:0
    ds_write_b128 v14, v[20:23] offset:1024
    ds_write_b128 v14, v[24:27] offset:2048
    v_max3_u32 v88, v16, v17, v18
    v_max3_u32 v88, v88, v19, v20
    v_max3_u32 v88, v88, v21, v22
    v_max3_u32 v88, v88, v23, v24
    v_max3_u32 v88, v88, v25, v26
    v_max_u32 v88, v88, v27
    v_cmp_eq_u32 vcc, -1, v88
    s_sub_u32 s15, s15, 1
    s_cbranch_scc1 layerb1_kernel_bail
    s_cbranch_vccnz layerb1_kernel_p0_poll
    s_waitcnt lgkmcnt(0)
    s_barrier
    ds_read_b128 v[28:31], v14 offset:3072
    ds_read_b128 v[32:35], v14 offset:4096
    ds_read_b128 v[36:39], v14 offset:5120
    ds_read_b128 v[40:43], v14 offset:6144
    ds_read_b128 v[44:47], v14 offset:7168
    ds_read_b128 v[48:51], v14 offset:8192
    ds_read_b128 v[52:55], v14 offset:9216
    v_smfmac_f32_16x16x64_bf16 v[56:59], v[16:19], a[0:7], v2
    v_smfmac_f32_16x16x64_bf16 v[60:63], v[16:19], a[8:15], v2
    v_smfmac_f32_16x16x64_bf16 v[64:67], v[16:19], a[16:23], v2
    v_smfmac_f32_16x16x64_bf16 v[56:59], v[20:23], a[24:31], v2
    v_smfmac_f32_16x16x64_bf16 v[60:63], v[20:23], a[32:39], v2
    v_smfmac_f32_16x16x64_bf16 v[64:67], v[20:23], a[40:47], v2
    v_smfmac_f32_16x16x64_bf16 v[56:59], v[24:27], a[48:55], v2
    v_smfmac_f32_16x16x64_bf16 v[60:63], v[24:27], a[56:63], v2
    v_smfmac_f32_16x16x64_bf16 v[64:67], v[24:27], a[64:71], v2
    s_waitcnt lgkmcnt(6)
    v_smfmac_f32_16x16x64_bf16 v[56:59], v[28:31], v[116:123], v2
    ds_read_b128 v[116:119], v13 offset:8192
    ds_read_b128 v[120:123], v13 offset:9216
    v_smfmac_f32_16x16x64_bf16 v[60:63], v[28:31], a[72:79], v2
    v_smfmac_f32_16x16x64_bf16 v[64:67], v[28:31], v[124:131], v2
    ds_read_b128 v[124:127], v13 offset:10240
    ds_read_b128 v[128:131], v13 offset:11264
    s_waitcnt lgkmcnt(9)
    v_smfmac_f32_16x16x64_bf16 v[56:59], v[32:35], a[80:87], v2
    v_smfmac_f32_16x16x64_bf16 v[60:63], v[32:35], v[132:139], v2
    ds_read_b128 v[132:135], v13 offset:12288
    ds_read_b128 v[136:139], v13 offset:13312
    v_smfmac_f32_16x16x64_bf16 v[64:67], v[32:35], a[88:95], v2
    s_waitcnt lgkmcnt(10)
    v_smfmac_f32_16x16x64_bf16 v[56:59], v[36:39], v[140:147], v2
    ds_read_b128 v[140:143], v13 offset:14336
    ds_read_b128 v[144:147], v13 offset:15360
    v_smfmac_f32_16x16x64_bf16 v[60:63], v[36:39], a[96:103], v2
    s_waitcnt lgkmcnt(6)
    v_smfmac_f32_16x16x64_bf16 v[64:67], v[36:39], v[116:123], v2
    ds_read_b128 v[116:119], v13 offset:16384
    ds_read_b128 v[120:123], v13 offset:17408
    v_smfmac_f32_16x16x64_bf16 v[56:59], v[40:43], a[104:111], v2
    s_waitcnt lgkmcnt(6)
    v_smfmac_f32_16x16x64_bf16 v[60:63], v[40:43], v[124:131], v2
    ds_read_b128 v[124:127], v13 offset:18432
    ds_read_b128 v[128:131], v13 offset:19456
    v_smfmac_f32_16x16x64_bf16 v[64:67], v[40:43], a[112:119], v2
    s_waitcnt lgkmcnt(6)
    v_smfmac_f32_16x16x64_bf16 v[56:59], v[44:47], v[132:139], v2
    ds_read_b128 v[132:135], v13 offset:20480
    ds_read_b128 v[136:139], v13 offset:21504
    v_smfmac_f32_16x16x64_bf16 v[60:63], v[44:47], a[120:127], v2
    s_waitcnt lgkmcnt(6)
    v_smfmac_f32_16x16x64_bf16 v[64:67], v[44:47], v[140:147], v2
    ds_read_b128 v[140:143], v13 offset:22528
    ds_read_b128 v[144:147], v13 offset:23552
    v_smfmac_f32_16x16x64_bf16 v[56:59], v[48:51], a[128:135], v2
    s_waitcnt lgkmcnt(6)
    v_smfmac_f32_16x16x64_bf16 v[60:63], v[48:51], v[116:123], v2
    ds_read_b128 v[116:119], v13 offset:24576
    ds_read_b128 v[120:123], v13 offset:25600
    v_smfmac_f32_16x16x64_bf16 v[64:67], v[48:51], a[136:143], v2
    s_waitcnt lgkmcnt(6)
    v_smfmac_f32_16x16x64_bf16 v[56:59], v[52:55], v[124:131], v2
    ds_read_b128 v[124:127], v13 offset:26624
    ds_read_b128 v[128:131], v13 offset:27648
    v_smfmac_f32_16x16x64_bf16 v[60:63], v[52:55], a[144:151], v2
    s_waitcnt lgkmcnt(6)
    v_smfmac_f32_16x16x64_bf16 v[64:67], v[52:55], v[132:139], v2
    ds_read_b128 v[132:135], v13 offset:28672
    ds_read_b128 v[136:139], v13 offset:29696
    v_smfmac_f32_16x16x64_bf16 v[68:71], v[16:19], a[152:159], v2
    v_smfmac_f32_16x16x64_bf16 v[68:71], v[20:23], a[160:167], v2
    v_permlane32_swap_b32 v56, v58
    v_permlane32_swap_b32 v57, v59
    v_smfmac_f32_16x16x64_bf16 v[68:71], v[24:27], a[168:175], v2
    v_add_f32 v56, v56, v58
    v_add_f32 v57, v57, v59
    v_smfmac_f32_16x16x64_bf16 v[68:71], v[28:31], a[176:183], v2
    v_cvt_pk_bf16_f32 v56, v56, v57
    ds_write_b16 v3, v56 offset:0
    v_smfmac_f32_16x16x64_bf16 v[68:71], v[32:35], a[184:191], v2
    ds_write_b16_d16_hi v3, v56 offset:400
    v_permlane32_swap_b32 v60, v62
    v_smfmac_f32_16x16x64_bf16 v[68:71], v[36:39], a[192:199], v2
    v_permlane32_swap_b32 v61, v63
    v_add_f32 v60, v60, v62
    v_smfmac_f32_16x16x64_bf16 v[68:71], v[40:43], a[200:207], v2
    v_add_f32 v61, v61, v63
    v_cvt_pk_bf16_f32 v60, v60, v61
    v_smfmac_f32_16x16x64_bf16 v[68:71], v[44:47], a[208:215], v2
    ds_write_b16 v3, v60 offset:32
    ds_write_b16_d16_hi v3, v60 offset:432
    v_smfmac_f32_16x16x64_bf16 v[68:71], v[48:51], a[216:223], v2
    v_permlane32_swap_b32 v64, v66
    v_permlane32_swap_b32 v65, v67
    v_smfmac_f32_16x16x64_bf16 v[68:71], v[52:55], a[224:231], v2
    v_add_f32 v64, v64, v66
    v_add_f32 v65, v65, v67
    v_smfmac_f32_16x16x64_bf16 v[72:75], v[16:19], a[232:239], v2
    v_cvt_pk_bf16_f32 v64, v64, v65
    ds_write_b16 v3, v64 offset:64
    v_smfmac_f32_16x16x64_bf16 v[72:75], v[20:23], a[240:247], v2
    ds_write_b16_d16_hi v3, v64 offset:464
    v_smfmac_f32_16x16x64_bf16 v[72:75], v[24:27], a[248:255], v2
    v_smfmac_f32_16x16x64_bf16 v[72:75], v[28:31], v[148:155], v2
    s_waitcnt lgkmcnt(0)
    s_barrier
    ds_read_b128 v[88:91], v4 offset:0
    v_smfmac_f32_16x16x64_bf16 v[72:75], v[32:35], v[140:147], v2
    ds_read_b128 v[92:95], v4 offset:128
    ds_read_b128 v[96:99], v4 offset:256
    v_smfmac_f32_16x16x64_bf16 v[72:75], v[36:39], v[156:163], v2
    v_permlane32_swap_b32 v68, v70
    v_permlane32_swap_b32 v69, v71
    v_smfmac_f32_16x16x64_bf16 v[72:75], v[40:43], v[164:171], v2
    v_add_f32 v68, v68, v70
    v_add_f32 v69, v69, v71
    v_smfmac_f32_16x16x64_bf16 v[72:75], v[44:47], v[172:179], v2
    v_cvt_pk_bf16_f32 v68, v68, v69
    ds_write_b16 v3, v68 offset:3200
    v_smfmac_f32_16x16x64_bf16 v[72:75], v[48:51], v[116:123], v2
    ds_write_b16_d16_hi v3, v68 offset:3600
    v_smfmac_f32_16x16x64_bf16 v[72:75], v[52:55], v[180:187], v2
    s_waitcnt lgkmcnt(2)
    v_smfmac_f32_16x16x64_bf16 v[80:83], v[88:91], v[100:107], v2
    v_smfmac_f32_16x16x64_bf16 v[80:83], v[92:95], v[108:115], v2
    v_smfmac_f32_16x16x64_bf16 v[76:79], v[16:19], v[188:195], v2
    v_smfmac_f32_16x16x64_bf16 v[76:79], v[20:23], v[196:203], v2
    v_smfmac_f32_16x16x64_bf16 v[76:79], v[24:27], v[124:131], v2
    v_permlane32_swap_b32 v72, v74
    v_permlane32_swap_b32 v73, v75
    v_smfmac_f32_16x16x64_bf16 v[76:79], v[28:31], v[204:211], v2
    v_add_f32 v72, v72, v74
    v_add_f32 v73, v73, v75
    ds_write_b128 v15, v[80:83]
    v_smfmac_f32_16x16x64_bf16 v[76:79], v[32:35], v[212:219], v2
    v_cvt_pk_bf16_f32 v72, v72, v73
    ds_write_b16 v3, v72 offset:3232
    v_smfmac_f32_16x16x64_bf16 v[76:79], v[36:39], v[220:227], v2
    ds_write_b16_d16_hi v3, v72 offset:3632
    v_smfmac_f32_16x16x64_bf16 v[76:79], v[40:43], v[132:139], v2
    v_smfmac_f32_16x16x64_bf16 v[76:79], v[44:47], v[228:235], v2
    v_smfmac_f32_16x16x64_bf16 v[76:79], v[48:51], v[236:243], v2
    v_smfmac_f32_16x16x64_bf16 v[76:79], v[52:55], v[244:251], v2
    s_nop 7
    v_permlane32_swap_b32 v76, v78
    v_permlane32_swap_b32 v77, v79
    v_add_f32 v76, v76, v78
    v_add_f32 v77, v77, v79
    v_cvt_pk_bf16_f32 v76, v76, v77
    ds_write_b16 v3, v76 offset:3264
    ds_write_b16_d16_hi v3, v76 offset:3664
    s_waitcnt lgkmcnt(0)
    s_barrier
    ds_read2st64_b32 v[40:41], v6 offset0:0 offset1:2
    ds_read2st64_b32 v[42:43], v6 offset0:8 offset1:10
    ds_read_b128 v[16:19], v5 offset:0
    ds_read_b128 v[20:23], v5 offset:16
    ds_read_b128 v[24:27], v5 offset:128
    ds_read_b128 v[28:31], v5 offset:144
    ds_read_b128 v[32:35], v5 offset:256
    ds_read_b128 v[36:39], v5 offset:272
    s_waitcnt lgkmcnt(6)
    v_add_f32 v40, v40, v41
    v_add_f32 v42, v42, v43
    v_add_f32 v44, v40, v42
    v_mul_f32 v44, 0x3dd53b95, v44
    s_waitcnt lgkmcnt(4)
    v_smfmac_f32_16x16x64_bf16 v[84:87], v[88:91], v[16:23], v2
    s_waitcnt lgkmcnt(2)
    v_smfmac_f32_16x16x64_bf16 v[84:87], v[92:95], v[24:31], v2
    s_waitcnt lgkmcnt(0)
    v_smfmac_f32_16x16x64_bf16 v[84:87], v[96:99], v[32:39], v2
    v_max_f32_dpp v45, v44, v44 row_ror:8 row_mask:0xf bank_mask:0xf
    s_nop 1
    v_max_f32_dpp v45, v45, v45 row_ror:4 row_mask:0xf bank_mask:0xf
    s_nop 1
    v_max_f32_dpp v45, v45, v45 row_ror:2 row_mask:0xf bank_mask:0xf
    s_nop 1
    v_max_f32_dpp v45, v45, v45 row_ror:1 row_mask:0xf bank_mask:0xf
    v_mov_b32 v47, v45
    s_nop 1
    v_permlane32_swap_b32 v45, v47
    v_max_f32 v45, v45, v47
    v_mov_b32 v47, v84
    s_nop 1
    v_permlane32_swap_b32 v84, v47
    v_add_f32 v48, v84, v47
    v_mul_f32 v48, 0x3dd53b95, v48
    s_nop 1
    v_max_f32_dpp v46, v48, v48 row_ror:4 row_mask:0xf bank_mask:0xf
    s_nop 1
    v_max_f32_dpp v46, v46, v46 row_ror:2 row_mask:0xf bank_mask:0xf
    s_nop 1
    v_max_f32_dpp v46, v46, v46 row_ror:1 row_mask:0xf bank_mask:0xf
    v_max_f32 v45, v45, v46
    v_sub_f32 v49, v44, v45
    v_sub_f32 v50, v48, v45
    v_exp_f32 v49, v49
    v_exp_f32 v50, v50
    s_nop 0
    v_fma_f32 v51, v50, v12, v49
    s_nop 1
    v_add_f32_dpp v51, v51, v51 row_ror:8 row_mask:0xf bank_mask:0xf
    s_nop 1
    v_add_f32_dpp v51, v51, v51 row_ror:4 row_mask:0xf bank_mask:0xf
    s_nop 1
    v_add_f32_dpp v51, v51, v51 row_ror:2 row_mask:0xf bank_mask:0xf
    s_nop 1
    v_add_f32_dpp v51, v51, v51 row_ror:1 row_mask:0xf bank_mask:0xf
    v_mov_b32 v47, v51
    s_nop 1
    v_permlane32_swap_b32 v51, v47
    v_add_f32 v51, v51, v47
    v_rcp_f32 v51, v51
    s_nop 0
    v_mul_f32 v49, v49, v51
    v_mul_f32 v50, v50, v51
    s_nop 0
    v_mov_b32_dpp v46, v49 quad_perm:[1,0,3,2] row_mask:0xf bank_mask:0xf
    v_mov_b32_dpp v47, v50 quad_perm:[1,0,3,2] row_mask:0xf bank_mask:0xf
    v_cvt_pk_bf16_f32 v16, v49, v46
    v_cvt_pk_bf16_f32 v20, v50, v47
    s_nop 0
    v_mov_b32_dpp v17, v16 row_shl:2 row_mask:0xf bank_mask:0xf
    v_mov_b32_dpp v18, v16 row_shl:4 row_mask:0xf bank_mask:0xf
    v_mov_b32_dpp v19, v16 row_shl:6 row_mask:0xf bank_mask:0xf
    v_mov_b32_dpp v21, v20 row_shl:2 row_mask:0xf bank_mask:0xf
    v_mov_b32_dpp v22, v20 row_shl:4 row_mask:0xf bank_mask:0xf
    v_mov_b32_dpp v23, v20 row_shl:6 row_mask:0xf bank_mask:0xf
    s_mov_b64 exec, s[40:41]
    buffer_store_dwordx4 v[16:19], v7, s[8:11], s18 offen sc1
    s_mov_b64 exec, s[42:43]
    buffer_store_dwordx4 v[20:23], v8, s[8:11], s18 offen sc1
    s_mov_b64 exec, -1
    ds_read_b128 v[40:43], v10
    s_add_u32 s28, s14, 1
    s_min_u32 s28, s28, 63
    s_cmp_gt_u32 s47, s28
    s_cbranch_scc1 layerb1_kernel_p0_gw2_ok
layerb1_kernel_p0_gw2_lp:
    buffer_load_dword v253, v255, s[8:11], s48 offen sc1
    s_waitcnt vmcnt(0)
    v_readlane_b32 s47, v253, 0
    v_readlane_b32 s29, v253, 1
    s_nop 0
    s_min_u32 s47, s47, s29
    s_sub_u32 s15, s15, 1
    s_cbranch_scc1 layerb1_kernel_bail
    s_cmp_gt_u32 s47, s28
    s_cbranch_scc0 layerb1_kernel_p0_gw2_lp
layerb1_kernel_p0_gw2_ok:
    s_mul_i32 s20, s28, 393216
    s_add_u32 s20, s20, s44
    s_add_u32 s21, s20, 0
    buffer_load_dwordx4 v[100:103], v9, s[8:11], s21 offen offset:0 sc1
    buffer_load_dwordx4 v[104:107], v9, s[8:11], s21 offen offset:512 sc1
    s_add_u32 s21, s20, 4096
    buffer_load_dwordx4 v[108:111], v9, s[8:11], s21 offen offset:0 sc1
    buffer_load_dwordx4 v[112:115], v9, s[8:11], s21 offen offset:512 sc1
    v_mov_b32 v56, 0
    v_mov_b32 v57, 0
    v_mov_b32 v58, 0
    v_mov_b32 v59, 0
    v_mov_b32 v60, 0
    v_mov_b32 v61, 0
    v_mov_b32 v62, 0
    v_mov_b32 v63, 0
    v_mov_b32 v64, 0
    v_mov_b32 v65, 0
    v_mov_b32 v66, 0
    v_mov_b32 v67, 0
    v_mov_b32 v68, 0
    v_mov_b32 v69, 0
    v_mov_b32 v70, 0
    v_mov_b32 v71, 0
    v_mov_b32 v72, 0
    v_mov_b32 v73, 0
    v_mov_b32 v74, 0
    v_mov_b32 v75, 0
    v_mov_b32 v76, 0
    v_mov_b32 v77, 0
    v_mov_b32 v78, 0
    v_mov_b32 v79, 0
    v_mov_b32 v80, 0
    v_mov_b32 v81, 0
    v_mov_b32 v82, 0
    v_mov_b32 v83, 0
    v_mov_b32 v84, 0
    v_mov_b32 v85, 0
    v_mov_b32 v86, 0
    v_mov_b32 v87, 0
    s_waitcnt lgkmcnt(0)
    s_mul_i32 s20, s14, 98304
    s_add_u32 s20, s20, s45
    buffer_store_dwordx4 v[40:43], v11, s[8:11], s20 offen sc1
    ds_read_b128 v[116:119], v13 offset:0
    ds_read_b128 v[120:123], v13 offset:1024
    ds_read_b128 v[124:127], v13 offset:2048
    ds_read_b128 v[128:131], v13 offset:3072
    ds_read_b128 v[132:135], v13 offset:4096
    ds_read_b128 v[136:139], v13 offset:5120
    ds_read_b128 v[140:143], v13 offset:6144
    ds_read_b128 v[144:147], v13 offset:7168
    s_waitcnt lgkmcnt(0)
    s_add_u32 s14, s14, 1
    s_cmp_lt_u32 s14, 64
    s_cbranch_scc1 layerb1_kernel_p0_step
    s_waitcnt vmcnt(0)
    s_barrier
    s_branch layerb1_kernel_end
layerb1_kernel_p1_start:
    v_lshrrev_b32 v16, 4, v0
    v_and_b32 v17, 15, v0
    v_and_b32 v18, 1, v16
    v_lshlrev_b32 v18, 2, v18
    v_lshrrev_b32 v19, 1, v16
    v_lshl_add_u32 v18, v19, 1, v18
    v_mul_u32_u24 v18, 400, v18
    v_lshl_add_u32 v18, v17, 1, v18
    v_add_u32 v3, 133216, v18
    v_and_b32 v18, 7, v0
    v_mul_u32_u24 v18, 400, v18
    v_lshrrev_b32 v19, 3, v0
    v_lshl_add_u32 v18, v19, 4, v18
    v_add_u32 v4, 133120, v18
    v_and_b32 v18, 7, v0
    v_mul_u32_u24 v18, 400, v18
    v_lshl_add_u32 v18, v16, 5, v18
    v_add_u32 v5, 136320, v18
    v_lshrrev_b32 v18, 1, v16
    v_lshlrev_b32 v18, 10, v18
    v_and_b32 v19, 31, v0
    v_lshl_add_u32 v18, v19, 4, v18
    v_add_u32 v6, 139524, v18
    v_add_u32 v15, 140544, v1
    v_lshrrev_b32 v18, 1, v16
    v_lshlrev_b32 v18, 1, v18
    v_lshrrev_b32 v19, 3, v17
    v_add3_u32 v18, v18, v19, 1
    v_lshrrev_b32 v19, 1, v18
    v_lshlrev_b32 v19, 14, v19
    v_and_b32 v18, 1, v18
    v_lshl_add_u32 v18, v18, 12, v19
    v_and_b32 v19, 1, v16
    v_lshlrev_b32 v19, 4, v19
    v_add_u32 v19, 32, v19
    s_lshl_b32 s20, s12, 7
    v_add_u32 v8, s20, v19
    v_add_u32 v7, v8, v18
    v_lshlrev_b32 v18, 4, v17
    v_lshl_add_u32 v18, v16, 10, v18
    v_add_u32 v9, 256, v18
    v_add_u32 v18, 64, v0
    v_mul_u32_u24 v19, 2731, v18
    v_lshrrev_b32 v19, 16, v19
    v_mul_u32_u24 v20, 24, v19
    v_sub_u32 v20, v18, v20
    v_mul_u32_u24 v21, 400, v19
    v_lshl_add_u32 v21, v20, 4, v21
    v_add_u32 v10, 136320, v21
    v_lshlrev_b32 v21, 4, v19
    v_lshl_add_u32 v11, v20, 7, v21
    v_and_b32 v18, 0x28, v0
    v_cmp_eq_u32 vcc, 0, v18
    v_mov_b32 v18, 1.0
    v_mov_b32 v19, 0
    v_cndmask_b32 v12, v19, v18, vcc
    v_add_u32 v13, 30720, v1
    v_add_u32 v14, 122880, v1
    s_mul_i32 s44, s12, 12288
    s_add_u32 s44, s44, 53477376
    s_mul_i32 s45, s12, 3072
    s_add_u32 s45, s45, 208666624
    s_mul_i32 s20, s12, 6
    s_add_u32 s21, s20, 5
    s_lshr_b32 s20, s20, 3
    s_lshr_b32 s21, s21, 3
    s_add_u32 s20, s20, 80
    s_add_u32 s21, s21, 80
    s_lshl_b32 s20, s20, 7
    s_lshl_b32 s21, s21, 7
    v_mov_b32 v255, s21
    v_mov_b32 v253, s20
    v_cmp_eq_u32 vcc, 0, v0
    s_nop 1
    v_cndmask_b32 v255, v255, v253, vcc
    s_mov_b32 s47, 0
    s_mul_i32 s20, s12, 491520
    s_add_u32 s20, s20, 11657216
    s_add_u32 s21, s20, 0
    buffer_load_dwordx4 v[16:19], v1, s[8:11], s21 offen offset:0
    buffer_load_dwordx4 v[20:23], v1, s[8:11], s21 offen offset:1024
    s_add_u32 s21, s20, 40960
    buffer_load_dwordx4 v[24:27], v1, s[8:11], s21 offen offset:0
    buffer_load_dwordx4 v[28:31], v1, s[8:11], s21 offen offset:1024
    s_add_u32 s21, s20, 22528
    buffer_load_dwordx4 v[32:35], v1, s[8:11], s21 offen offset:0
    buffer_load_dwordx4 v[36:39], v1, s[8:11], s21 offen offset:1024
    s_add_u32 s21, s20, 4096
    buffer_load_dwordx4 v[40:43], v1, s[8:11], s21 offen offset:0
    buffer_load_dwordx4 v[44:47], v1, s[8:11], s21 offen offset:1024
    s_add_u32 s21, s20, 45056
    buffer_load_dwordx4 v[48:51], v1, s[8:11], s21 offen offset:0
    buffer_load_dwordx4 v[52:55], v1, s[8:11], s21 offen offset:1024
    s_add_u32 s21, s20, 32768
    buffer_load_dwordx4 v[56:59], v1, s[8:11], s21 offen offset:0
    buffer_load_dwordx4 v[60:63], v1, s[8:11], s21 offen offset:1024
    s_add_u32 s21, s20, 14336
    buffer_load_dwordx4 v[64:67], v1, s[8:11], s21 offen offset:0
    buffer_load_dwordx4 v[68:71], v1, s[8:11], s21 offen offset:1024
    s_add_u32 s21, s20, 55296
    buffer_load_dwordx4 v[72:75], v1, s[8:11], s21 offen offset:0
    buffer_load_dwordx4 v[76:79], v1, s[8:11], s21 offen offset:1024
    s_add_u32 s21, s20, 36864
    buffer_load_dwordx4 v[80:83], v1, s[8:11], s21 offen offset:0
    buffer_load_dwordx4 v[84:87], v1, s[8:11], s21 offen offset:1024
    s_add_u32 s21, s20, 18432
    buffer_load_dwordx4 v[88:91], v1, s[8:11], s21 offen offset:0
    buffer_load_dwordx4 v[92:95], v1, s[8:11], s21 offen offset:1024
    s_add_u32 s21, s20, 59392
    buffer_load_dwordx4 v[96:99], v1, s[8:11], s21 offen offset:0
    buffer_load_dwordx4 v[100:103], v1, s[8:11], s21 offen offset:1024
    s_add_u32 s21, s20, 90112
    buffer_load_dwordx4 v[104:107], v1, s[8:11], s21 offen offset:0
    buffer_load_dwordx4 v[108:111], v1, s[8:11], s21 offen offset:1024
    s_add_u32 s21, s20, 98304
    buffer_load_dwordx4 v[112:115], v1, s[8:11], s21 offen offset:0
    buffer_load_dwordx4 v[116:119], v1, s[8:11], s21 offen offset:1024
    s_add_u32 s21, s20, 106496
    buffer_load_dwordx4 v[120:123], v1, s[8:11], s21 offen offset:0
    buffer_load_dwordx4 v[124:127], v1, s[8:11], s21 offen offset:1024
    s_add_u32 s21, s20, 114688
    buffer_load_dwordx4 v[128:131], v1, s[8:11], s21 offen offset:0
    buffer_load_dwordx4 v[132:135], v1, s[8:11], s21 offen offset:1024
    s_add_u32 s21, s20, 6144
    buffer_load_dwordx4 a[0:3], v1, s[8:11], s21 offen offset:0
    buffer_load_dwordx4 a[4:7], v1, s[8:11], s21 offen offset:1024
    s_add_u32 s21, s20, 26624
    buffer_load_dwordx4 a[8:11], v1, s[8:11], s21 offen offset:0
    buffer_load_dwordx4 a[12:15], v1, s[8:11], s21 offen offset:1024
    s_add_u32 s21, s20, 47104
    buffer_load_dwordx4 a[16:19], v1, s[8:11], s21 offen offset:0
    buffer_load_dwordx4 a[20:23], v1, s[8:11], s21 offen offset:1024
    s_add_u32 s21, s20, 8192
    buffer_load_dwordx4 a[24:27], v1, s[8:11], s21 offen offset:0
    buffer_load_dwordx4 a[28:31], v1, s[8:11], s21 offen offset:1024
    s_add_u32 s21, s20, 28672
    buffer_load_dwordx4 a[32:35], v1, s[8:11], s21 offen offset:0
    buffer_load_dwordx4 a[36:39], v1, s[8:11], s21 offen offset:1024
    s_add_u32 s21, s20, 49152
    buffer_load_dwordx4 a[40:43], v1, s[8:11], s21 offen offset:0
    buffer_load_dwordx4 a[44:47], v1, s[8:11], s21 offen offset:1024
    s_add_u32 s21, s20, 10240
    buffer_load_dwordx4 a[48:51], v1, s[8:11], s21 offen offset:0
    buffer_load_dwordx4 a[52:55], v1, s[8:11], s21 offen offset:1024
    s_add_u32 s21, s20, 30720
    buffer_load_dwordx4 a[56:59], v1, s[8:11], s21 offen offset:0
    buffer_load_dwordx4 a[60:63], v1, s[8:11], s21 offen offset:1024
    s_add_u32 s21, s20, 51200
    buffer_load_dwordx4 a[64:67], v1, s[8:11], s21 offen offset:0
    buffer_load_dwordx4 a[68:71], v1, s[8:11], s21 offen offset:1024
    s_add_u32 s21, s20, 20480
    buffer_load_dwordx4 a[72:75], v1, s[8:11], s21 offen offset:0
    buffer_load_dwordx4 a[76:79], v1, s[8:11], s21 offen offset:1024
    s_add_u32 s21, s20, 2048
    buffer_load_dwordx4 a[80:83], v1, s[8:11], s21 offen offset:0
    buffer_load_dwordx4 a[84:87], v1, s[8:11], s21 offen offset:1024
    s_add_u32 s21, s20, 43008
    buffer_load_dwordx4 a[88:91], v1, s[8:11], s21 offen offset:0
    buffer_load_dwordx4 a[92:95], v1, s[8:11], s21 offen offset:1024
    s_add_u32 s21, s20, 24576
    buffer_load_dwordx4 a[96:99], v1, s[8:11], s21 offen offset:0
    buffer_load_dwordx4 a[100:103], v1, s[8:11], s21 offen offset:1024
    s_add_u32 s21, s20, 12288
    buffer_load_dwordx4 a[104:107], v1, s[8:11], s21 offen offset:0
    buffer_load_dwordx4 a[108:111], v1, s[8:11], s21 offen offset:1024
    s_add_u32 s21, s20, 53248
    buffer_load_dwordx4 a[112:115], v1, s[8:11], s21 offen offset:0
    buffer_load_dwordx4 a[116:119], v1, s[8:11], s21 offen offset:1024
    s_add_u32 s21, s20, 34816
    buffer_load_dwordx4 a[120:123], v1, s[8:11], s21 offen offset:0
    buffer_load_dwordx4 a[124:127], v1, s[8:11], s21 offen offset:1024
    s_waitcnt vmcnt(32)
    ds_write_b128 v13, v[16:19] offset:0
    ds_write_b128 v13, v[20:23] offset:1024
    ds_write_b128 v13, v[24:27] offset:2048
    ds_write_b128 v13, v[28:31] offset:3072
    ds_write_b128 v13, v[32:35] offset:4096
    ds_write_b128 v13, v[36:39] offset:5120
    ds_write_b128 v13, v[40:43] offset:6144
    ds_write_b128 v13, v[44:47] offset:7168
    ds_write_b128 v13, v[48:51] offset:8192
    ds_write_b128 v13, v[52:55] offset:9216
    ds_write_b128 v13, v[56:59] offset:10240
    ds_write_b128 v13, v[60:63] offset:11264
    ds_write_b128 v13, v[64:67] offset:12288
    ds_write_b128 v13, v[68:71] offset:13312
    ds_write_b128 v13, v[72:75] offset:14336
    ds_write_b128 v13, v[76:79] offset:15360
    ds_write_b128 v13, v[80:83] offset:16384
    ds_write_b128 v13, v[84:87] offset:17408
    ds_write_b128 v13, v[88:91] offset:18432
    ds_write_b128 v13, v[92:95] offset:19456
    ds_write_b128 v13, v[96:99] offset:20480
    ds_write_b128 v13, v[100:103] offset:21504
    ds_write_b128 v13, v[104:107] offset:22528
    ds_write_b128 v13, v[108:111] offset:23552
    ds_write_b128 v13, v[112:115] offset:24576
    ds_write_b128 v13, v[116:119] offset:25600
    ds_write_b128 v13, v[120:123] offset:26624
    ds_write_b128 v13, v[124:127] offset:27648
    ds_write_b128 v13, v[128:131] offset:28672
    ds_write_b128 v13, v[132:135] offset:29696
    s_add_u32 s21, s20, 16384
    buffer_load_dwordx4 a[128:131], v1, s[8:11], s21 offen offset:0
    buffer_load_dwordx4 a[132:135], v1, s[8:11], s21 offen offset:1024
    s_add_u32 s21, s20, 57344
    buffer_load_dwordx4 a[136:139], v1, s[8:11], s21 offen offset:0
    buffer_load_dwordx4 a[140:143], v1, s[8:11], s21 offen offset:1024
    s_add_u32 s21, s20, 38912
    buffer_load_dwordx4 a[144:147], v1, s[8:11], s21 offen offset:0
    buffer_load_dwordx4 a[148:151], v1, s[8:11], s21 offen offset:1024
    s_add_u32 s21, s20, 61440
    buffer_load_dwordx4 a[152:155], v1, s[8:11], s21 offen offset:0
    buffer_load_dwordx4 a[156:159], v1, s[8:11], s21 offen offset:1024
    s_add_u32 s21, s20, 63488
    buffer_load_dwordx4 a[160:163], v1, s[8:11], s21 offen offset:0
    buffer_load_dwordx4 a[164:167], v1, s[8:11], s21 offen offset:1024
    s_add_u32 s21, s20, 65536
    buffer_load_dwordx4 a[168:171], v1, s[8:11], s21 offen offset:0
    buffer_load_dwordx4 a[172:175], v1, s[8:11], s21 offen offset:1024
    s_add_u32 s21, s20, 67584
    buffer_load_dwordx4 a[176:179], v1, s[8:11], s21 offen offset:0
    buffer_load_dwordx4 a[180:183], v1, s[8:11], s21 offen offset:1024
    s_add_u32 s21, s20, 69632
    buffer_load_dwordx4 a[184:187], v1, s[8:11], s21 offen offset:0
    buffer_load_dwordx4 a[188:191], v1, s[8:11], s21 offen offset:1024
    s_add_u32 s21, s20, 71680
    buffer_load_dwordx4 a[192:195], v1, s[8:11], s21 offen offset:0
    buffer_load_dwordx4 a[196:199], v1, s[8:11], s21 offen offset:1024
    s_add_u32 s21, s20, 73728
    buffer_load_dwordx4 a[200:203], v1, s[8:11], s21 offen offset:0
    buffer_load_dwordx4 a[204:207], v1, s[8:11], s21 offen offset:1024
    s_add_u32 s21, s20, 75776
    buffer_load_dwordx4 a[208:211], v1, s[8:11], s21 offen offset:0
    buffer_load_dwordx4 a[212:215], v1, s[8:11], s21 offen offset:1024
    s_add_u32 s21, s20, 77824
    buffer_load_dwordx4 a[216:219], v1, s[8:11], s21 offen offset:0
    buffer_load_dwordx4 a[220:223], v1, s[8:11], s21 offen offset:1024
    s_add_u32 s21, s20, 79872
    buffer_load_dwordx4 a[224:227], v1, s[8:11], s21 offen offset:0
    buffer_load_dwordx4 a[228:231], v1, s[8:11], s21 offen offset:1024
    s_add_u32 s21, s20, 81920
    buffer_load_dwordx4 a[232:235], v1, s[8:11], s21 offen offset:0
    buffer_load_dwordx4 a[236:239], v1, s[8:11], s21 offen offset:1024
    s_add_u32 s21, s20, 83968
    buffer_load_dwordx4 a[240:243], v1, s[8:11], s21 offen offset:0
    buffer_load_dwordx4 a[244:247], v1, s[8:11], s21 offen offset:1024
    s_add_u32 s21, s20, 86016
    buffer_load_dwordx4 a[248:251], v1, s[8:11], s21 offen offset:0
    buffer_load_dwordx4 a[252:255], v1, s[8:11], s21 offen offset:1024
    s_add_u32 s21, s20, 88064
    buffer_load_dwordx4 v[148:151], v1, s[8:11], s21 offen offset:0
    buffer_load_dwordx4 v[152:155], v1, s[8:11], s21 offen offset:1024
    s_add_u32 s21, s20, 92160
    buffer_load_dwordx4 v[156:159], v1, s[8:11], s21 offen offset:0
    buffer_load_dwordx4 v[160:163], v1, s[8:11], s21 offen offset:1024
    s_add_u32 s21, s20, 94208
    buffer_load_dwordx4 v[164:167], v1, s[8:11], s21 offen offset:0
    buffer_load_dwordx4 v[168:171], v1, s[8:11], s21 offen offset:1024
    s_add_u32 s21, s20, 96256
    buffer_load_dwordx4 v[172:175], v1, s[8:11], s21 offen offset:0
    buffer_load_dwordx4 v[176:179], v1, s[8:11], s21 offen offset:1024
    s_add_u32 s21, s20, 100352
    buffer_load_dwordx4 v[180:183], v1, s[8:11], s21 offen offset:0
    buffer_load_dwordx4 v[184:187], v1, s[8:11], s21 offen offset:1024
    s_add_u32 s21, s20, 102400
    buffer_load_dwordx4 v[188:191], v1, s[8:11], s21 offen offset:0
    buffer_load_dwordx4 v[192:195], v1, s[8:11], s21 offen offset:1024
    s_add_u32 s21, s20, 104448
    buffer_load_dwordx4 v[196:199], v1, s[8:11], s21 offen offset:0
    buffer_load_dwordx4 v[200:203], v1, s[8:11], s21 offen offset:1024
    s_add_u32 s21, s20, 108544
    buffer_load_dwordx4 v[204:207], v1, s[8:11], s21 offen offset:0
    buffer_load_dwordx4 v[208:211], v1, s[8:11], s21 offen offset:1024
    s_add_u32 s21, s20, 110592
    buffer_load_dwordx4 v[212:215], v1, s[8:11], s21 offen offset:0
    buffer_load_dwordx4 v[216:219], v1, s[8:11], s21 offen offset:1024
    s_add_u32 s21, s20, 112640
    buffer_load_dwordx4 v[220:223], v1, s[8:11], s21 offen offset:0
    buffer_load_dwordx4 v[224:227], v1, s[8:11], s21 offen offset:1024
    s_add_u32 s21, s20, 116736
    buffer_load_dwordx4 v[228:231], v1, s[8:11], s21 offen offset:0
    buffer_load_dwordx4 v[232:235], v1, s[8:11], s21 offen offset:1024
    s_add_u32 s21, s20, 118784
    buffer_load_dwordx4 v[236:239], v1, s[8:11], s21 offen offset:0
    buffer_load_dwordx4 v[240:243], v1, s[8:11], s21 offen offset:1024
    s_add_u32 s21, s20, 120832
    buffer_load_dwordx4 v[244:247], v1, s[8:11], s21 offen offset:0
    buffer_load_dwordx4 v[248:251], v1, s[8:11], s21 offen offset:1024
    s_waitcnt lgkmcnt(0)
    s_mov_b32 s14, 0
    s_cmp_gt_u32 s47, s14
    s_cbranch_scc1 layerb1_kernel_p1_gw1_ok
layerb1_kernel_p1_gw1_lp:
    buffer_load_dword v253, v255, s[8:11], s48 offen sc1
    s_waitcnt vmcnt(0)
    v_readlane_b32 s47, v253, 0
    v_readlane_b32 s29, v253, 1
    s_nop 0
    s_min_u32 s47, s47, s29
    s_sub_u32 s15, s15, 1
    s_cbranch_scc1 layerb1_kernel_bail
    s_cmp_gt_u32 s47, s14
    s_cbranch_scc0 layerb1_kernel_p1_gw1_lp
layerb1_kernel_p1_gw1_ok:
    s_mul_i32 s20, s14, 393216
    s_add_u32 s20, s20, s44
    s_add_u32 s21, s20, 0
    buffer_load_dwordx4 v[100:103], v9, s[8:11], s21 offen offset:0 sc1
    buffer_load_dwordx4 v[104:107], v9, s[8:11], s21 offen offset:512 sc1
    s_add_u32 s21, s20, 4096
    buffer_load_dwordx4 v[108:111], v9, s[8:11], s21 offen offset:0 sc1
    buffer_load_dwordx4 v[112:115], v9, s[8:11], s21 offen offset:512 sc1
    v_mov_b32 v56, 0
    v_mov_b32 v57, 0
    v_mov_b32 v58, 0
    v_mov_b32 v59, 0
    v_mov_b32 v60, 0
    v_mov_b32 v61, 0
    v_mov_b32 v62, 0
    v_mov_b32 v63, 0
    v_mov_b32 v64, 0
    v_mov_b32 v65, 0
    v_mov_b32 v66, 0
    v_mov_b32 v67, 0
    v_mov_b32 v68, 0
    v_mov_b32 v69, 0
    v_mov_b32 v70, 0
    v_mov_b32 v71, 0
    v_mov_b32 v72, 0
    v_mov_b32 v73, 0
    v_mov_b32 v74, 0
    v_mov_b32 v75, 0
    v_mov_b32 v76, 0
    v_mov_b32 v77, 0
    v_mov_b32 v78, 0
    v_mov_b32 v79, 0
    v_mov_b32 v80, 0
    v_mov_b32 v81, 0
    v_mov_b32 v82, 0
    v_mov_b32 v83, 0
    v_mov_b32 v84, 0
    v_mov_b32 v85, 0
    v_mov_b32 v86, 0
    v_mov_b32 v87, 0
    ds_read_b128 v[116:119], v13 offset:0
    ds_read_b128 v[120:123], v13 offset:1024
    ds_read_b128 v[124:127], v13 offset:2048
    ds_read_b128 v[128:131], v13 offset:3072
    ds_read_b128 v[132:135], v13 offset:4096
    ds_read_b128 v[136:139], v13 offset:5120
    ds_read_b128 v[140:143], v13 offset:6144
    ds_read_b128 v[144:147], v13 offset:7168
    s_waitcnt lgkmcnt(0)
layerb1_kernel_p1_step:
    s_cmp_lt_u32 s14, 32
    s_cselect_b32 s18, s16, s17
    s_and_b32 s20, s14, 31
    s_lshl_b32 s20, s20, 16
    s_add_u32 s18, s18, s20
    s_add_u32 s22, s18, 39936
    s_add_u32 s23, s18, 49152
    s_add_u32 s24, s18, 50176
layerb1_kernel_p1_poll:
    buffer_load_dwordx4 v[28:31], v1, s[8:11], s22 offen sc1
    buffer_load_dwordx4 v[32:35], v1, s[8:11], s23 offen sc1
    buffer_load_dwordx4 v[36:39], v1, s[8:11], s24 offen sc1
    s_waitcnt vmcnt(0)
    ds_write_b128 v14, v[28:31] offset:3072
    ds_write_b128 v14, v[32:35] offset:4096
    ds_write_b128 v14, v[36:39] offset:5120
    v_max3_u32 v88, v28, v29, v30
    v_max3_u32 v88, v88, v31, v32
    v_max3_u32 v88, v88, v33, v34
    v_max3_u32 v88, v88, v35, v36
    v_max3_u32 v88, v88, v37, v38
    v_max_u32 v88, v88, v39
    v_cmp_eq_u32 vcc, -1, v88
    s_sub_u32 s15, s15, 1
    s_cbranch_scc1 layerb1_kernel_bail
    s_cbranch_vccnz layerb1_kernel_p1_poll
    s_waitcnt lgkmcnt(0)
    s_barrier
    ds_read_b128 v[16:19], v14 offset:0
    ds_read_b128 v[20:23], v14 offset:1024
    ds_read_b128 v[24:27], v14 offset:2048
    ds_read_b128 v[40:43], v14 offset:6144
    ds_read_b128 v[44:47], v14 offset:7168
    ds_read_b128 v[48:51], v14 offset:8192
    ds_read_b128 v[52:55], v14 offset:9216
    v_smfmac_f32_16x16x64_bf16 v[56:59], v[28:31], a[0:7], v2
    v_smfmac_f32_16x16x64_bf16 v[60:63], v[28:31], a[8:15], v2
    v_smfmac_f32_16x16x64_bf16 v[64:67], v[28:31], a[16:23], v2
    v_smfmac_f32_16x16x64_bf16 v[56:59], v[32:35], a[24:31], v2
    v_smfmac_f32_16x16x64_bf16 v[60:63], v[32:35], a[32:39], v2
    v_smfmac_f32_16x16x64_bf16 v[64:67], v[32:35], a[40:47], v2
    v_smfmac_f32_16x16x64_bf16 v[56:59], v[36:39], a[48:55], v2
    v_smfmac_f32_16x16x64_bf16 v[60:63], v[36:39], a[56:63], v2
    v_smfmac_f32_16x16x64_bf16 v[64:67], v[36:39], a[64:71], v2
    s_waitcnt lgkmcnt(6)
    v_smfmac_f32_16x16x64_bf16 v[56:59], v[16:19], v[116:123], v2
    ds_read_b128 v[116:119], v13 offset:8192
    ds_read_b128 v[120:123], v13 offset:9216
    v_smfmac_f32_16x16x64_bf16 v[60:63], v[16:19], a[72:79], v2
    v_smfmac_f32_16x16x64_bf16 v[64:67], v[16:19], v[124:131], v2
    ds_read_b128 v[124:127], v13 offset:10240
    ds_read_b128 v[128:131], v13 offset:11264
    s_waitcnt lgkmcnt(9)
    v_smfmac_f32_16x16x64_bf16 v[56:59], v[20:23], a[80:87], v2
    v_smfmac_f32_16x16x64_bf16 v[60:63], v[20:23], v[132:139], v2
    ds_read_b128 v[132:135], v13 offset:12288
    ds_read_b128 v[136:139], v13 offset:13312
    v_smfmac_f32_16x16x64_bf16 v[64:67], v[20:23], a[88:95], v2
    s_waitcnt lgkmcnt(10)
    v_smfmac_f32_16x16x64_bf16 v[56:59], v[24:27], v[140:147], v2
    ds_read_b128 v[140:143], v13 offset:14336
    ds_read_b128 v[144:147], v13 offset:15360
    v_smfmac_f32_16x16x64_bf16 v[60:63], v[24:27], a[96:103], v2
    s_waitcnt lgkmcnt(6)
    v_smfmac_f32_16x16x64_bf16 v[64:67], v[24:27], v[116:123], v2
    ds_read_b128 v[116:119], v13 offset:16384
    ds_read_b128 v[120:123], v13 offset:17408
    v_smfmac_f32_16x16x64_bf16 v[56:59], v[40:43], a[104:111], v2
    s_waitcnt lgkmcnt(6)
    v_smfmac_f32_16x16x64_bf16 v[60:63], v[40:43], v[124:131], v2
    ds_read_b128 v[124:127], v13 offset:18432
    ds_read_b128 v[128:131], v13 offset:19456
    v_smfmac_f32_16x16x64_bf16 v[64:67], v[40:43], a[112:119], v2
    s_waitcnt lgkmcnt(6)
    v_smfmac_f32_16x16x64_bf16 v[56:59], v[44:47], v[132:139], v2
    ds_read_b128 v[132:135], v13 offset:20480
    ds_read_b128 v[136:139], v13 offset:21504
    v_smfmac_f32_16x16x64_bf16 v[60:63], v[44:47], a[120:127], v2
    s_waitcnt lgkmcnt(6)
    v_smfmac_f32_16x16x64_bf16 v[64:67], v[44:47], v[140:147], v2
    ds_read_b128 v[140:143], v13 offset:22528
    ds_read_b128 v[144:147], v13 offset:23552
    v_smfmac_f32_16x16x64_bf16 v[56:59], v[48:51], a[128:135], v2
    s_waitcnt lgkmcnt(6)
    v_smfmac_f32_16x16x64_bf16 v[60:63], v[48:51], v[116:123], v2
    ds_read_b128 v[116:119], v13 offset:24576
    ds_read_b128 v[120:123], v13 offset:25600
    v_smfmac_f32_16x16x64_bf16 v[64:67], v[48:51], a[136:143], v2
    s_waitcnt lgkmcnt(6)
    v_smfmac_f32_16x16x64_bf16 v[56:59], v[52:55], v[124:131], v2
    ds_read_b128 v[124:127], v13 offset:26624
    ds_read_b128 v[128:131], v13 offset:27648
    v_smfmac_f32_16x16x64_bf16 v[60:63], v[52:55], a[144:151], v2
    s_waitcnt lgkmcnt(6)
    v_smfmac_f32_16x16x64_bf16 v[64:67], v[52:55], v[132:139], v2
    ds_read_b128 v[132:135], v13 offset:28672
    ds_read_b128 v[136:139], v13 offset:29696
    v_smfmac_f32_16x16x64_bf16 v[68:71], v[16:19], a[152:159], v2
    v_smfmac_f32_16x16x64_bf16 v[68:71], v[20:23], a[160:167], v2
    v_permlane32_swap_b32 v56, v58
    v_permlane32_swap_b32 v57, v59
    v_smfmac_f32_16x16x64_bf16 v[68:71], v[24:27], a[168:175], v2
    v_add_f32 v56, v56, v58
    v_add_f32 v57, v57, v59
    v_smfmac_f32_16x16x64_bf16 v[68:71], v[28:31], a[176:183], v2
    v_cvt_pk_bf16_f32 v56, v56, v57
    ds_write_b16 v3, v56 offset:0
    v_smfmac_f32_16x16x64_bf16 v[68:71], v[32:35], a[184:191], v2
    ds_write_b16_d16_hi v3, v56 offset:400
    v_permlane32_swap_b32 v60, v62
    v_smfmac_f32_16x16x64_bf16 v[68:71], v[36:39], a[192:199], v2
    v_permlane32_swap_b32 v61, v63
    v_add_f32 v60, v60, v62
    v_smfmac_f32_16x16x64_bf16 v[68:71], v[40:43], a[200:207], v2
    v_add_f32 v61, v61, v63
    v_cvt_pk_bf16_f32 v60, v60, v61
    v_smfmac_f32_16x16x64_bf16 v[68:71], v[44:47], a[208:215], v2
    ds_write_b16 v3, v60 offset:32
    ds_write_b16_d16_hi v3, v60 offset:432
    v_smfmac_f32_16x16x64_bf16 v[68:71], v[48:51], a[216:223], v2
    v_permlane32_swap_b32 v64, v66
    v_permlane32_swap_b32 v65, v67
    v_smfmac_f32_16x16x64_bf16 v[68:71], v[52:55], a[224:231], v2
    v_add_f32 v64, v64, v66
    v_add_f32 v65, v65, v67
    v_smfmac_f32_16x16x64_bf16 v[72:75], v[16:19], a[232:239], v2
    v_cvt_pk_bf16_f32 v64, v64, v65
    ds_write_b16 v3, v64 offset:64
    v_smfmac_f32_16x16x64_bf16 v[72:75], v[20:23], a[240:247], v2
    ds_write_b16_d16_hi v3, v64 offset:464
    v_smfmac_f32_16x16x64_bf16 v[72:75], v[24:27], a[248:255], v2
    v_smfmac_f32_16x16x64_bf16 v[72:75], v[28:31], v[148:155], v2
    s_waitcnt lgkmcnt(0)
    s_barrier
    ds_read_b128 v[88:91], v4 offset:0
    v_smfmac_f32_16x16x64_bf16 v[72:75], v[32:35], v[140:147], v2
    ds_read_b128 v[92:95], v4 offset:128
    ds_read_b128 v[96:99], v4 offset:256
    v_smfmac_f32_16x16x64_bf16 v[72:75], v[36:39], v[156:163], v2
    v_permlane32_swap_b32 v68, v70
    v_permlane32_swap_b32 v69, v71
    v_smfmac_f32_16x16x64_bf16 v[72:75], v[40:43], v[164:171], v2
    v_add_f32 v68, v68, v70
    v_add_f32 v69, v69, v71
    v_smfmac_f32_16x16x64_bf16 v[72:75], v[44:47], v[172:179], v2
    v_cvt_pk_bf16_f32 v68, v68, v69
    ds_write_b16 v3, v68 offset:3200
    v_smfmac_f32_16x16x64_bf16 v[72:75], v[48:51], v[116:123], v2
    ds_write_b16_d16_hi v3, v68 offset:3600
    v_smfmac_f32_16x16x64_bf16 v[72:75], v[52:55], v[180:187], v2
    s_waitcnt lgkmcnt(2)
    v_smfmac_f32_16x16x64_bf16 v[80:83], v[88:91], v[100:107], v2
    v_smfmac_f32_16x16x64_bf16 v[80:83], v[92:95], v[108:115], v2
    v_smfmac_f32_16x16x64_bf16 v[76:79], v[16:19], v[188:195], v2
    v_smfmac_f32_16x16x64_bf16 v[76:79], v[20:23], v[196:203], v2
    v_smfmac_f32_16x16x64_bf16 v[76:79], v[24:27], v[124:131], v2
    v_permlane32_swap_b32 v72, v74
    v_permlane32_swap_b32 v73, v75
    v_smfmac_f32_16x16x64_bf16 v[76:79], v[28:31], v[204:211], v2
    v_add_f32 v72, v72, v74
    v_add_f32 v73, v73, v75
    ds_write_b128 v15, v[80:83]
    v_smfmac_f32_16x16x64_bf16 v[76:79], v[32:35], v[212:219], v2
    v_cvt_pk_bf16_f32 v72, v72, v73
    ds_write_b16 v3, v72 offset:3232
    v_smfmac_f32_16x16x64_bf16 v[76:79], v[36:39], v[220:227], v2
    ds_write_b16_d16_hi v3, v72 offset:3632
    v_smfmac_f32_16x16x64_bf16 v[76:79], v[40:43], v[132:139], v2
    v_smfmac_f32_16x16x64_bf16 v[76:79], v[44:47], v[228:235], v2
    v_smfmac_f32_16x16x64_bf16 v[76:79], v[48:51], v[236:243], v2
    v_smfmac_f32_16x16x64_bf16 v[76:79], v[52:55], v[244:251], v2
    s_nop 7
    v_permlane32_swap_b32 v76, v78
    v_permlane32_swap_b32 v77, v79
    v_add_f32 v76, v76, v78
    v_add_f32 v77, v77, v79
    v_cvt_pk_bf16_f32 v76, v76, v77
    ds_write_b16 v3, v76 offset:3264
    ds_write_b16_d16_hi v3, v76 offset:3664
    s_waitcnt lgkmcnt(0)
    s_barrier
    ds_read2st64_b32 v[40:41], v6 offset0:0 offset1:2
    ds_read2st64_b32 v[42:43], v6 offset0:8 offset1:10
    ds_read_b128 v[16:19], v5 offset:0
    ds_read_b128 v[20:23], v5 offset:16
    ds_read_b128 v[24:27], v5 offset:128
    ds_read_b128 v[28:31], v5 offset:144
    ds_read_b128 v[32:35], v5 offset:256
    ds_read_b128 v[36:39], v5 offset:272
    s_waitcnt lgkmcnt(6)
    v_add_f32 v40, v40, v41
    v_add_f32 v42, v42, v43
    v_add_f32 v44, v40, v42
    v_mul_f32 v44, 0x3dd53b95, v44
    s_waitcnt lgkmcnt(4)
    v_smfmac_f32_16x16x64_bf16 v[84:87], v[88:91], v[16:23], v2
    s_waitcnt lgkmcnt(2)
    v_smfmac_f32_16x16x64_bf16 v[84:87], v[92:95], v[24:31], v2
    s_waitcnt lgkmcnt(0)
    v_smfmac_f32_16x16x64_bf16 v[84:87], v[96:99], v[32:39], v2
    v_max_f32_dpp v45, v44, v44 row_ror:8 row_mask:0xf bank_mask:0xf
    s_nop 1
    v_max_f32_dpp v45, v45, v45 row_ror:4 row_mask:0xf bank_mask:0xf
    s_nop 1
    v_max_f32_dpp v45, v45, v45 row_ror:2 row_mask:0xf bank_mask:0xf
    s_nop 1
    v_max_f32_dpp v45, v45, v45 row_ror:1 row_mask:0xf bank_mask:0xf
    v_mov_b32 v47, v45
    s_nop 1
    v_permlane32_swap_b32 v45, v47
    v_max_f32 v45, v45, v47
    v_mov_b32 v47, v85
    s_nop 1
    v_permlane32_swap_b32 v85, v47
    v_add_f32 v48, v85, v47
    v_mul_f32 v48, 0x3dd53b95, v48
    s_nop 1
    v_max_f32_dpp v46, v48, v48 row_ror:4 row_mask:0xf bank_mask:0xf
    s_nop 1
    v_max_f32_dpp v46, v46, v46 row_ror:2 row_mask:0xf bank_mask:0xf
    s_nop 1
    v_max_f32_dpp v46, v46, v46 row_ror:1 row_mask:0xf bank_mask:0xf
    v_max_f32 v45, v45, v46
    v_sub_f32 v49, v44, v45
    v_sub_f32 v50, v48, v45
    v_exp_f32 v49, v49
    v_exp_f32 v50, v50
    s_nop 0
    v_fma_f32 v51, v50, v12, v49
    s_nop 1
    v_add_f32_dpp v51, v51, v51 row_ror:8 row_mask:0xf bank_mask:0xf
    s_nop 1
    v_add_f32_dpp v51, v51, v51 row_ror:4 row_mask:0xf bank_mask:0xf
    s_nop 1
    v_add_f32_dpp v51, v51, v51 row_ror:2 row_mask:0xf bank_mask:0xf
    s_nop 1
    v_add_f32_dpp v51, v51, v51 row_ror:1 row_mask:0xf bank_mask:0xf
    v_mov_b32 v47, v51
    s_nop 1
    v_permlane32_swap_b32 v51, v47
    v_add_f32 v51, v51, v47
    v_rcp_f32 v51, v51
    s_nop 0
    v_mul_f32 v49, v49, v51
    v_mul_f32 v50, v50, v51
    s_nop 0
    v_mov_b32_dpp v46, v49 quad_perm:[1,0,3,2] row_mask:0xf bank_mask:0xf
    v_mov_b32_dpp v47, v50 quad_perm:[1,0,3,2] row_mask:0xf bank_mask:0xf
    v_cvt_pk_bf16_f32 v16, v49, v46
    v_cvt_pk_bf16_f32 v20, v50, v47
    s_nop 0
    v_mov_b32_dpp v17, v16 row_shl:2 row_mask:0xf bank_mask:0xf
    v_mov_b32_dpp v18, v16 row_shl:4 row_mask:0xf bank_mask:0xf
    v_mov_b32_dpp v19, v16 row_shl:6 row_mask:0xf bank_mask:0xf
    v_mov_b32_dpp v21, v20 row_shl:2 row_mask:0xf bank_mask:0xf
    v_mov_b32_dpp v22, v20 row_shl:4 row_mask:0xf bank_mask:0xf
    v_mov_b32_dpp v23, v20 row_shl:6 row_mask:0xf bank_mask:0xf
    s_mov_b64 exec, s[40:41]
    buffer_store_dwordx4 v[16:19], v7, s[8:11], s18 offen sc1
    s_mov_b64 exec, s[42:43]
    buffer_store_dwordx4 v[20:23], v8, s[8:11], s18 offen sc1
    s_mov_b64 exec, -1
    ds_read_b128 v[40:43], v10
    s_add_u32 s28, s14, 1
    s_min_u32 s28, s28, 63
    s_cmp_gt_u32 s47, s28
    s_cbranch_scc1 layerb1_kernel_p1_gw2_ok
layerb1_kernel_p1_gw2_lp:
    buffer_load_dword v253, v255, s[8:11], s48 offen sc1
    s_waitcnt vmcnt(0)
    v_readlane_b32 s47, v253, 0
    v_readlane_b32 s29, v253, 1
    s_nop 0
    s_min_u32 s47, s47, s29
    s_sub_u32 s15, s15, 1
    s_cbranch_scc1 layerb1_kernel_bail
    s_cmp_gt_u32 s47, s28
    s_cbranch_scc0 layerb1_kernel_p1_gw2_lp
layerb1_kernel_p1_gw2_ok:
    s_mul_i32 s20, s28, 393216
    s_add_u32 s20, s20, s44
    s_add_u32 s21, s20, 0
    buffer_load_dwordx4 v[100:103], v9, s[8:11], s21 offen offset:0 sc1
    buffer_load_dwordx4 v[104:107], v9, s[8:11], s21 offen offset:512 sc1
    s_add_u32 s21, s20, 4096
    buffer_load_dwordx4 v[108:111], v9, s[8:11], s21 offen offset:0 sc1
    buffer_load_dwordx4 v[112:115], v9, s[8:11], s21 offen offset:512 sc1
    v_mov_b32 v56, 0
    v_mov_b32 v57, 0
    v_mov_b32 v58, 0
    v_mov_b32 v59, 0
    v_mov_b32 v60, 0
    v_mov_b32 v61, 0
    v_mov_b32 v62, 0
    v_mov_b32 v63, 0
    v_mov_b32 v64, 0
    v_mov_b32 v65, 0
    v_mov_b32 v66, 0
    v_mov_b32 v67, 0
    v_mov_b32 v68, 0
    v_mov_b32 v69, 0
    v_mov_b32 v70, 0
    v_mov_b32 v71, 0
    v_mov_b32 v72, 0
    v_mov_b32 v73, 0
    v_mov_b32 v74, 0
    v_mov_b32 v75, 0
    v_mov_b32 v76, 0
    v_mov_b32 v77, 0
    v_mov_b32 v78, 0
    v_mov_b32 v79, 0
    v_mov_b32 v80, 0
    v_mov_b32 v81, 0
    v_mov_b32 v82, 0
    v_mov_b32 v83, 0
    v_mov_b32 v84, 0
    v_mov_b32 v85, 0
    v_mov_b32 v86, 0
    v_mov_b32 v87, 0
    s_waitcnt lgkmcnt(0)
    s_mul_i32 s20, s14, 98304
    s_add_u32 s20, s20, s45
    buffer_store_dwordx4 v[40:43], v11, s[8:11], s20 offen sc1
    ds_read_b128 v[116:119], v13 offset:0
    ds_read_b128 v[120:123], v13 offset:1024
    ds_read_b128 v[124:127], v13 offset:2048
    ds_read_b128 v[128:131], v13 offset:3072
    ds_read_b128 v[132:135], v13 offset:4096
    ds_read_b128 v[136:139], v13 offset:5120
    ds_read_b128 v[140:143], v13 offset:6144
    ds_read_b128 v[144:147], v13 offset:7168
    s_waitcnt lgkmcnt(0)
    s_add_u32 s14, s14, 1
    s_cmp_lt_u32 s14, 64
    s_cbranch_scc1 layerb1_kernel_p1_step
    s_waitcnt vmcnt(0)
    s_barrier
    s_branch layerb1_kernel_end
layerb1_kernel_p2_start:
    v_lshrrev_b32 v16, 4, v0
    v_and_b32 v17, 15, v0
    v_and_b32 v18, 1, v16
    v_lshlrev_b32 v18, 2, v18
    v_lshrrev_b32 v19, 1, v16
    v_lshl_add_u32 v18, v19, 1, v18
    v_mul_u32_u24 v18, 400, v18
    v_lshl_add_u32 v18, v17, 1, v18
    v_add_u32 v3, 133312, v18
    v_and_b32 v18, 7, v0
    v_mul_u32_u24 v18, 400, v18
    v_lshrrev_b32 v19, 3, v0
    v_lshl_add_u32 v18, v19, 4, v18
    v_add_u32 v4, 133120, v18
    v_and_b32 v18, 7, v0
    v_mul_u32_u24 v18, 400, v18
    v_lshl_add_u32 v18, v16, 5, v18
    v_add_u32 v5, 136320, v18
    v_lshrrev_b32 v18, 1, v16
    v_lshlrev_b32 v18, 10, v18
    v_and_b32 v19, 31, v0
    v_lshl_add_u32 v18, v19, 4, v18
    v_add_u32 v6, 139528, v18
    v_add_u32 v15, 141568, v1
    v_lshrrev_b32 v18, 1, v16
    v_lshlrev_b32 v18, 1, v18
    v_lshrrev_b32 v19, 3, v17
    v_add3_u32 v18, v18, v19, 1
    v_lshrrev_b32 v19, 1, v18
    v_lshlrev_b32 v19, 14, v19
    v_and_b32 v18, 1, v18
    v_lshl_add_u32 v18, v18, 12, v19
    v_and_b32 v19, 1, v16
    v_lshlrev_b32 v19, 4, v19
    v_add_u32 v19, 64, v19
    s_lshl_b32 s20, s12, 7
    v_add_u32 v8, s20, v19
    v_add_u32 v7, v8, v18
    v_lshlrev_b32 v18, 4, v17
    v_lshl_add_u32 v18, v16, 10, v18
    v_add_u32 v9, 0, v18
    v_add_u32 v18, 128, v0
    v_mul_u32_u24 v19, 2731, v18
    v_lshrrev_b32 v19, 16, v19
    v_mul_u32_u24 v20, 24, v19
    v_sub_u32 v20, v18, v20
    v_mul_u32_u24 v21, 400, v19
    v_lshl_add_u32 v21, v20, 4, v21
    v_add_u32 v10, 136320, v21
    v_lshlrev_b32 v21, 4, v19
    v_lshl_add_u32 v11, v20, 7, v21
    v_and_b32 v18, 0x28, v0
    v_cmp_eq_u32 vcc, 0, v18
    v_mov_b32 v18, 1.0
    v_mov_b32 v19, 0
    v_cndmask_b32 v12, v19, v18, vcc
    v_add_u32 v13, 61440, v1
    v_add_u32 v14, 122880, v1
    s_mul_i32 s44, s12, 12288
    s_add_u32 s44, s44, 53477376
    s_mul_i32 s45, s12, 3072
    s_add_u32 s45, s45, 208666624
    s_mul_i32 s20, s12, 6
    s_add_u32 s21, s20, 5
    s_lshr_b32 s20, s20, 3
    s_lshr_b32 s21, s21, 3
    s_add_u32 s20, s20, 80
    s_add_u32 s21, s21, 80
    s_lshl_b32 s20, s20, 7
    s_lshl_b32 s21, s21, 7
    v_mov_b32 v255, s21
    v_mov_b32 v253, s20
    v_cmp_eq_u32 vcc, 0, v0
    s_nop 1
    v_cndmask_b32 v255, v255, v253, vcc
    s_mov_b32 s47, 0
    s_mul_i32 s20, s12, 491520
    s_add_u32 s20, s20, 11780096
    s_add_u32 s21, s20, 2048
    buffer_load_dwordx4 v[16:19], v1, s[8:11], s21 offen offset:0
    buffer_load_dwordx4 v[20:23], v1, s[8:11], s21 offen offset:1024
    s_add_u32 s21, s20, 43008
    buffer_load_dwordx4 v[24:27], v1, s[8:11], s21 offen offset:0
    buffer_load_dwordx4 v[28:31], v1, s[8:11], s21 offen offset:1024
    s_add_u32 s21, s20, 24576
    buffer_load_dwordx4 v[32:35], v1, s[8:11], s21 offen offset:0
    buffer_load_dwordx4 v[36:39], v1, s[8:11], s21 offen offset:1024
    s_add_u32 s21, s20, 6144
    buffer_load_dwordx4 v[40:43], v1, s[8:11], s21 offen offset:0
    buffer_load_dwordx4 v[44:47], v1, s[8:11], s21 offen offset:1024
    s_add_u32 s21, s20, 47104
    buffer_load_dwordx4 v[48:51], v1, s[8:11], s21 offen offset:0
    buffer_load_dwordx4 v[52:55], v1, s[8:11], s21 offen offset:1024
    s_add_u32 s21, s20, 28672
    buffer_load_dwordx4 v[56:59], v1, s[8:11], s21 offen offset:0
    buffer_load_dwordx4 v[60:63], v1, s[8:11], s21 offen offset:1024
    s_add_u32 s21, s20, 10240
    buffer_load_dwordx4 v[64:67], v1, s[8:11], s21 offen offset:0
    buffer_load_dwordx4 v[68:71], v1, s[8:11], s21 offen offset:1024
    s_add_u32 s21, s20, 51200
    buffer_load_dwordx4 v[72:75], v1, s[8:11], s21 offen offset:0
    buffer_load_dwordx4 v[76:79], v1, s[8:11], s21 offen offset:1024
    s_add_u32 s21, s20, 36864
    buffer_load_dwordx4 v[80:83], v1, s[8:11], s21 offen offset:0
    buffer_load_dwordx4 v[84:87], v1, s[8:11], s21 offen offset:1024
    s_add_u32 s21, s20, 18432
    buffer_load_dwordx4 v[88:91], v1, s[8:11], s21 offen offset:0
    buffer_load_dwordx4 v[92:95], v1, s[8:11], s21 offen offset:1024
    s_add_u32 s21, s20, 59392
    buffer_load_dwordx4 v[96:99], v1, s[8:11], s21 offen offset:0
    buffer_load_dwordx4 v[100:103], v1, s[8:11], s21 offen offset:1024
    s_add_u32 s21, s20, 90112
    buffer_load_dwordx4 v[104:107], v1, s[8:11], s21 offen offset:0
    buffer_load_dwordx4 v[108:111], v1, s[8:11], s21 offen offset:1024
    s_add_u32 s21, s20, 98304
    buffer_load_dwordx4 v[112:115], v1, s[8:11], s21 offen offset:0
    buffer_load_dwordx4 v[116:119], v1, s[8:11], s21 offen offset:1024
    s_add_u32 s21, s20, 106496
    buffer_load_dwordx4 v[120:123], v1, s[8:11], s21 offen offset:0
    buffer_load_dwordx4 v[124:127], v1, s[8:11], s21 offen offset:1024
    s_add_u32 s21, s20, 114688
    buffer_load_dwordx4 v[128:131], v1, s[8:11], s21 offen offset:0
    buffer_load_dwordx4 v[132:135], v1, s[8:11], s21 offen offset:1024
    s_add_u32 s21, s20, 12288
    buffer_load_dwordx4 a[0:3], v1, s[8:11], s21 offen offset:0
    buffer_load_dwordx4 a[4:7], v1, s[8:11], s21 offen offset:1024
    s_add_u32 s21, s20, 32768
    buffer_load_dwordx4 a[8:11], v1, s[8:11], s21 offen offset:0
    buffer_load_dwordx4 a[12:15], v1, s[8:11], s21 offen offset:1024
    s_add_u32 s21, s20, 53248
    buffer_load_dwordx4 a[16:19], v1, s[8:11], s21 offen offset:0
    buffer_load_dwordx4 a[20:23], v1, s[8:11], s21 offen offset:1024
    s_add_u32 s21, s20, 14336
    buffer_load_dwordx4 a[24:27], v1, s[8:11], s21 offen offset:0
    buffer_load_dwordx4 a[28:31], v1, s[8:11], s21 offen offset:1024
    s_add_u32 s21, s20, 34816
    buffer_load_dwordx4 a[32:35], v1, s[8:11], s21 offen offset:0
    buffer_load_dwordx4 a[36:39], v1, s[8:11], s21 offen offset:1024
    s_add_u32 s21, s20, 55296
    buffer_load_dwordx4 a[40:43], v1, s[8:11], s21 offen offset:0
    buffer_load_dwordx4 a[44:47], v1, s[8:11], s21 offen offset:1024
    s_add_u32 s21, s20, 0
    buffer_load_dwordx4 a[48:51], v1, s[8:11], s21 offen offset:0
    buffer_load_dwordx4 a[52:55], v1, s[8:11], s21 offen offset:1024
    s_add_u32 s21, s20, 20480
    buffer_load_dwordx4 a[56:59], v1, s[8:11], s21 offen offset:0
    buffer_load_dwordx4 a[60:63], v1, s[8:11], s21 offen offset:1024
    s_add_u32 s21, s20, 40960
    buffer_load_dwordx4 a[64:67], v1, s[8:11], s21 offen offset:0
    buffer_load_dwordx4 a[68:71], v1, s[8:11], s21 offen offset:1024
    s_add_u32 s21, s20, 22528
    buffer_load_dwordx4 a[72:75], v1, s[8:11], s21 offen offset:0
    buffer_load_dwordx4 a[76:79], v1, s[8:11], s21 offen offset:1024
    s_add_u32 s21, s20, 4096
    buffer_load_dwordx4 a[80:83], v1, s[8:11], s21 offen offset:0
    buffer_load_dwordx4 a[84:87], v1, s[8:11], s21 offen offset:1024
    s_add_u32 s21, s20, 45056
    buffer_load_dwordx4 a[88:91], v1, s[8:11], s21 offen offset:0
    buffer_load_dwordx4 a[92:95], v1, s[8:11], s21 offen offset:1024
    s_add_u32 s21, s20, 26624
    buffer_load_dwordx4 a[96:99], v1, s[8:11], s21 offen offset:0
    buffer_load_dwordx4 a[100:103], v1, s[8:11], s21 offen offset:1024
    s_add_u32 s21, s20, 8192
    buffer_load_dwordx4 a[104:107], v1, s[8:11], s21 offen offset:0
    buffer_load_dwordx4 a[108:111], v1, s[8:11], s21 offen offset:1024
    s_add_u32 s21, s20, 49152
    buffer_load_dwordx4 a[112:115], v1, s[8:11], s21 offen offset:0
    buffer_load_dwordx4 a[116:119], v1, s[8:11], s21 offen offset:1024
    s_add_u32 s21, s20, 30720
    buffer_load_dwordx4 a[120:123], v1, s[8:11], s21 offen offset:0
    buffer_load_dwordx4 a[124:127], v1, s[8:11], s21 offen offset:1024
    s_waitcnt vmcnt(32)
    ds_write_b128 v13, v[16:19] offset:0
    ds_write_b128 v13, v[20:23] offset:1024
    ds_write_b128 v13, v[24:27] offset:2048
    ds_write_b128 v13, v[28:31] offset:3072
    ds_write_b128 v13, v[32:35] offset:4096
    ds_write_b128 v13, v[36:39] offset:5120
    ds_write_b128 v13, v[40:43] offset:6144
    ds_write_b128 v13, v[44:47] offset:7168
    ds_write_b128 v13, v[48:51] offset:8192
    ds_write_b128 v13, v[52:55] offset:9216
    ds_write_b128 v13, v[56:59] offset:10240
    ds_write_b128 v13, v[60:63] offset:11264
    ds_write_b128 v13, v[64:67] offset:12288
    ds_write_b128 v13, v[68:71] offset:13312
    ds_write_b128 v13, v[72:75] offset:14336
    ds_write_b128 v13, v[76:79] offset:15360
    ds_write_b128 v13, v[80:83] offset:16384
    ds_write_b128 v13, v[84:87] offset:17408
    ds_write_b128 v13, v[88:91] offset:18432
    ds_write_b128 v13, v[92:95] offset:19456
    ds_write_b128 v13, v[96:99] offset:20480
    ds_write_b128 v13, v[100:103] offset:21504
    ds_write_b128 v13, v[104:107] offset:22528
    ds_write_b128 v13, v[108:111] offset:23552
    ds_write_b128 v13, v[112:115] offset:24576
    ds_write_b128 v13, v[116:119] offset:25600
    ds_write_b128 v13, v[120:123] offset:26624
    ds_write_b128 v13, v[124:127] offset:27648
    ds_write_b128 v13, v[128:131] offset:28672
    ds_write_b128 v13, v[132:135] offset:29696
    s_add_u32 s21, s20, 16384
    buffer_load_dwordx4 a[128:131], v1, s[8:11], s21 offen offset:0
    buffer_load_dwordx4 a[132:135], v1, s[8:11], s21 offen offset:1024
    s_add_u32 s21, s20, 57344
    buffer_load_dwordx4 a[136:139], v1, s[8:11], s21 offen offset:0
    buffer_load_dwordx4 a[140:143], v1, s[8:11], s21 offen offset:1024
    s_add_u32 s21, s20, 38912
    buffer_load_dwordx4 a[144:147], v1, s[8:11], s21 offen offset:0
    buffer_load_dwordx4 a[148:151], v1, s[8:11], s21 offen offset:1024
    s_add_u32 s21, s20, 61440
    buffer_load_dwordx4 a[152:155], v1, s[8:11], s21 offen offset:0
    buffer_load_dwordx4 a[156:159], v1, s[8:11], s21 offen offset:1024
    s_add_u32 s21, s20, 63488
    buffer_load_dwordx4 a[160:163], v1, s[8:11], s21 offen offset:0
    buffer_load_dwordx4 a[164:167], v1, s[8:11], s21 offen offset:1024
    s_add_u32 s21, s20, 65536
    buffer_load_dwordx4 a[168:171], v1, s[8:11], s21 offen offset:0
    buffer_load_dwordx4 a[172:175], v1, s[8:11], s21 offen offset:1024
    s_add_u32 s21, s20, 67584
    buffer_load_dwordx4 a[176:179], v1, s[8:11], s21 offen offset:0
    buffer_load_dwordx4 a[180:183], v1, s[8:11], s21 offen offset:1024
    s_add_u32 s21, s20, 69632
    buffer_load_dwordx4 a[184:187], v1, s[8:11], s21 offen offset:0
    buffer_load_dwordx4 a[188:191], v1, s[8:11], s21 offen offset:1024
    s_add_u32 s21, s20, 71680
    buffer_load_dwordx4 a[192:195], v1, s[8:11], s21 offen offset:0
    buffer_load_dwordx4 a[196:199], v1, s[8:11], s21 offen offset:1024
    s_add_u32 s21, s20, 73728
    buffer_load_dwordx4 a[200:203], v1, s[8:11], s21 offen offset:0
    buffer_load_dwordx4 a[204:207], v1, s[8:11], s21 offen offset:1024
    s_add_u32 s21, s20, 75776
    buffer_load_dwordx4 a[208:211], v1, s[8:11], s21 offen offset:0
    buffer_load_dwordx4 a[212:215], v1, s[8:11], s21 offen offset:1024
    s_add_u32 s21, s20, 77824
    buffer_load_dwordx4 a[216:219], v1, s[8:11], s21 offen offset:0
    buffer_load_dwordx4 a[220:223], v1, s[8:11], s21 offen offset:1024
    s_add_u32 s21, s20, 79872
    buffer_load_dwordx4 a[224:227], v1, s[8:11], s21 offen offset:0
    buffer_load_dwordx4 a[228:231], v1, s[8:11], s21 offen offset:1024
    s_add_u32 s21, s20, 81920
    buffer_load_dwordx4 a[232:235], v1, s[8:11], s21 offen offset:0
    buffer_load_dwordx4 a[236:239], v1, s[8:11], s21 offen offset:1024
    s_add_u32 s21, s20, 83968
    buffer_load_dwordx4 a[240:243], v1, s[8:11], s21 offen offset:0
    buffer_load_dwordx4 a[244:247], v1, s[8:11], s21 offen offset:1024
    s_add_u32 s21, s20, 86016
    buffer_load_dwordx4 a[248:251], v1, s[8:11], s21 offen offset:0
    buffer_load_dwordx4 a[252:255], v1, s[8:11], s21 offen offset:1024
    s_add_u32 s21, s20, 88064
    buffer_load_dwordx4 v[148:151], v1, s[8:11], s21 offen offset:0
    buffer_load_dwordx4 v[152:155], v1, s[8:11], s21 offen offset:1024
    s_add_u32 s21, s20, 92160
    buffer_load_dwordx4 v[156:159], v1, s[8:11], s21 offen offset:0
    buffer_load_dwordx4 v[160:163], v1, s[8:11], s21 offen offset:1024
    s_add_u32 s21, s20, 94208
    buffer_load_dwordx4 v[164:167], v1, s[8:11], s21 offen offset:0
    buffer_load_dwordx4 v[168:171], v1, s[8:11], s21 offen offset:1024
    s_add_u32 s21, s20, 96256
    buffer_load_dwordx4 v[172:175], v1, s[8:11], s21 offen offset:0
    buffer_load_dwordx4 v[176:179], v1, s[8:11], s21 offen offset:1024
    s_add_u32 s21, s20, 100352
    buffer_load_dwordx4 v[180:183], v1, s[8:11], s21 offen offset:0
    buffer_load_dwordx4 v[184:187], v1, s[8:11], s21 offen offset:1024
    s_add_u32 s21, s20, 102400
    buffer_load_dwordx4 v[188:191], v1, s[8:11], s21 offen offset:0
    buffer_load_dwordx4 v[192:195], v1, s[8:11], s21 offen offset:1024
    s_add_u32 s21, s20, 104448
    buffer_load_dwordx4 v[196:199], v1, s[8:11], s21 offen offset:0
    buffer_load_dwordx4 v[200:203], v1, s[8:11], s21 offen offset:1024
    s_add_u32 s21, s20, 108544
    buffer_load_dwordx4 v[204:207], v1, s[8:11], s21 offen offset:0
    buffer_load_dwordx4 v[208:211], v1, s[8:11], s21 offen offset:1024
    s_add_u32 s21, s20, 110592
    buffer_load_dwordx4 v[212:215], v1, s[8:11], s21 offen offset:0
    buffer_load_dwordx4 v[216:219], v1, s[8:11], s21 offen offset:1024
    s_add_u32 s21, s20, 112640
    buffer_load_dwordx4 v[220:223], v1, s[8:11], s21 offen offset:0
    buffer_load_dwordx4 v[224:227], v1, s[8:11], s21 offen offset:1024
    s_add_u32 s21, s20, 116736
    buffer_load_dwordx4 v[228:231], v1, s[8:11], s21 offen offset:0
    buffer_load_dwordx4 v[232:235], v1, s[8:11], s21 offen offset:1024
    s_add_u32 s21, s20, 118784
    buffer_load_dwordx4 v[236:239], v1, s[8:11], s21 offen offset:0
    buffer_load_dwordx4 v[240:243], v1, s[8:11], s21 offen offset:1024
    s_add_u32 s21, s20, 120832
    buffer_load_dwordx4 v[244:247], v1, s[8:11], s21 offen offset:0
    buffer_load_dwordx4 v[248:251], v1, s[8:11], s21 offen offset:1024
    s_waitcnt lgkmcnt(0)
    s_mov_b32 s14, 0
    s_cmp_gt_u32 s47, s14
    s_cbranch_scc1 layerb1_kernel_p2_gw1_ok
layerb1_kernel_p2_gw1_lp:
    buffer_load_dword v253, v255, s[8:11], s48 offen sc1
    s_waitcnt vmcnt(0)
    v_readlane_b32 s47, v253, 0
    v_readlane_b32 s29, v253, 1
    s_nop 0
    s_min_u32 s47, s47, s29
    s_sub_u32 s15, s15, 1
    s_cbranch_scc1 layerb1_kernel_bail
    s_cmp_gt_u32 s47, s14
    s_cbranch_scc0 layerb1_kernel_p2_gw1_lp
layerb1_kernel_p2_gw1_ok:
    s_mul_i32 s20, s14, 393216
    s_add_u32 s20, s20, s44
    s_add_u32 s21, s20, 8192
    buffer_load_dwordx4 v[100:103], v9, s[8:11], s21 offen offset:0 sc1
    buffer_load_dwordx4 v[104:107], v9, s[8:11], s21 offen offset:512 sc1
    v_mov_b32 v56, 0
    v_mov_b32 v57, 0
    v_mov_b32 v58, 0
    v_mov_b32 v59, 0
    v_mov_b32 v60, 0
    v_mov_b32 v61, 0
    v_mov_b32 v62, 0
    v_mov_b32 v63, 0
    v_mov_b32 v64, 0
    v_mov_b32 v65, 0
    v_mov_b32 v66, 0
    v_mov_b32 v67, 0
    v_mov_b32 v68, 0
    v_mov_b32 v69, 0
    v_mov_b32 v70, 0
    v_mov_b32 v71, 0
    v_mov_b32 v72, 0
    v_mov_b32 v73, 0
    v_mov_b32 v74, 0
    v_mov_b32 v75, 0
    v_mov_b32 v76, 0
    v_mov_b32 v77, 0
    v_mov_b32 v78, 0
    v_mov_b32 v79, 0
    v_mov_b32 v80, 0
    v_mov_b32 v81, 0
    v_mov_b32 v82, 0
    v_mov_b32 v83, 0
    v_mov_b32 v84, 0
    v_mov_b32 v85, 0
    v_mov_b32 v86, 0
    v_mov_b32 v87, 0
    ds_read_b128 v[116:119], v13 offset:0
    ds_read_b128 v[120:123], v13 offset:1024
    ds_read_b128 v[124:127], v13 offset:2048
    ds_read_b128 v[128:131], v13 offset:3072
    ds_read_b128 v[132:135], v13 offset:4096
    ds_read_b128 v[136:139], v13 offset:5120
    ds_read_b128 v[140:143], v13 offset:6144
    ds_read_b128 v[144:147], v13 offset:7168
    s_waitcnt lgkmcnt(0)
layerb1_kernel_p2_step:
    s_cmp_lt_u32 s14, 32
    s_cselect_b32 s18, s16, s17
    s_and_b32 s20, s14, 31
    s_lshl_b32 s20, s20, 16
    s_add_u32 s18, s18, s20
    s_add_u32 s22, s18, 51200
    s_add_u32 s23, s18, 52224
layerb1_kernel_p2_poll:
    buffer_load_dwordx4 v[40:43], v1, s[8:11], s22 offen sc1
    buffer_load_dwordx4 v[44:47], v1, s[8:11], s23 offen sc1
    s_waitcnt vmcnt(0)
    ds_write_b128 v14, v[40:43] offset:6144
    ds_write_b128 v14, v[44:47] offset:7168
    v_max3_u32 v88, v40, v41, v42
    v_max3_u32 v88, v88, v43, v44
    v_max3_u32 v88, v88, v45, v46
    v_max_u32 v88, v88, v47
    v_cmp_eq_u32 vcc, -1, v88
    s_sub_u32 s15, s15, 1
    s_cbranch_scc1 layerb1_kernel_bail
    s_cbranch_vccnz layerb1_kernel_p2_poll
    s_waitcnt lgkmcnt(0)
    s_barrier
    ds_read_b128 v[16:19], v14 offset:0
    ds_read_b128 v[20:23], v14 offset:1024
    ds_read_b128 v[24:27], v14 offset:2048
    ds_read_b128 v[28:31], v14 offset:3072
    ds_read_b128 v[32:35], v14 offset:4096
    ds_read_b128 v[36:39], v14 offset:5120
    ds_read_b128 v[48:51], v14 offset:8192
    ds_read_b128 v[52:55], v14 offset:9216
    v_smfmac_f32_16x16x64_bf16 v[56:59], v[40:43], a[0:7], v2
    v_smfmac_f32_16x16x64_bf16 v[60:63], v[40:43], a[8:15], v2
    v_smfmac_f32_16x16x64_bf16 v[64:67], v[40:43], a[16:23], v2
    v_smfmac_f32_16x16x64_bf16 v[56:59], v[44:47], a[24:31], v2
    v_smfmac_f32_16x16x64_bf16 v[60:63], v[44:47], a[32:39], v2
    v_smfmac_f32_16x16x64_bf16 v[64:67], v[44:47], a[40:47], v2
    s_waitcnt lgkmcnt(7)
    v_smfmac_f32_16x16x64_bf16 v[56:59], v[16:19], a[48:55], v2
    v_smfmac_f32_16x16x64_bf16 v[60:63], v[16:19], a[56:63], v2
    v_smfmac_f32_16x16x64_bf16 v[64:67], v[16:19], a[64:71], v2
    s_waitcnt lgkmcnt(6)
    v_smfmac_f32_16x16x64_bf16 v[56:59], v[20:23], v[116:123], v2
    ds_read_b128 v[116:119], v13 offset:8192
    ds_read_b128 v[120:123], v13 offset:9216
    v_smfmac_f32_16x16x64_bf16 v[60:63], v[20:23], a[72:79], v2
    v_smfmac_f32_16x16x64_bf16 v[64:67], v[20:23], v[124:131], v2
    ds_read_b128 v[124:127], v13 offset:10240
    ds_read_b128 v[128:131], v13 offset:11264
    s_waitcnt lgkmcnt(9)
    v_smfmac_f32_16x16x64_bf16 v[56:59], v[24:27], a[80:87], v2
    v_smfmac_f32_16x16x64_bf16 v[60:63], v[24:27], v[132:139], v2
    ds_read_b128 v[132:135], v13 offset:12288
    ds_read_b128 v[136:139], v13 offset:13312
    v_smfmac_f32_16x16x64_bf16 v[64:67], v[24:27], a[88:95], v2
    s_waitcnt lgkmcnt(10)
    v_smfmac_f32_16x16x64_bf16 v[56:59], v[28:31], v[140:147], v2
    ds_read_b128 v[140:143], v13 offset:14336
    ds_read_b128 v[144:147], v13 offset:15360
    v_smfmac_f32_16x16x64_bf16 v[60:63], v[28:31], a[96:103], v2
    s_waitcnt lgkmcnt(6)
    v_smfmac_f32_16x16x64_bf16 v[64:67], v[28:31], v[116:123], v2
    ds_read_b128 v[116:119], v13 offset:16384
    ds_read_b128 v[120:123], v13 offset:17408
    v_smfmac_f32_16x16x64_bf16 v[56:59], v[32:35], a[104:111], v2
    s_waitcnt lgkmcnt(6)
    v_smfmac_f32_16x16x64_bf16 v[60:63], v[32:35], v[124:131], v2
    ds_read_b128 v[124:127], v13 offset:18432
    ds_read_b128 v[128:131], v13 offset:19456
    v_smfmac_f32_16x16x64_bf16 v[64:67], v[32:35], a[112:119], v2
    s_waitcnt lgkmcnt(6)
    v_smfmac_f32_16x16x64_bf16 v[56:59], v[36:39], v[132:139], v2
    ds_read_b128 v[132:135], v13 offset:20480
    ds_read_b128 v[136:139], v13 offset:21504
    v_smfmac_f32_16x16x64_bf16 v[60:63], v[36:39], a[120:127], v2
    s_waitcnt lgkmcnt(6)
    v_smfmac_f32_16x16x64_bf16 v[64:67], v[36:39], v[140:147], v2
    ds_read_b128 v[140:143], v13 offset:22528
    ds_read_b128 v[144:147], v13 offset:23552
    v_smfmac_f32_16x16x64_bf16 v[56:59], v[48:51], a[128:135], v2
    s_waitcnt lgkmcnt(6)
    v_smfmac_f32_16x16x64_bf16 v[60:63], v[48:51], v[116:123], v2
    ds_read_b128 v[116:119], v13 offset:24576
    ds_read_b128 v[120:123], v13 offset:25600
    v_smfmac_f32_16x16x64_bf16 v[64:67], v[48:51], a[136:143], v2
    s_waitcnt lgkmcnt(6)
    v_smfmac_f32_16x16x64_bf16 v[56:59], v[52:55], v[124:131], v2
    ds_read_b128 v[124:127], v13 offset:26624
    ds_read_b128 v[128:131], v13 offset:27648
    v_smfmac_f32_16x16x64_bf16 v[60:63], v[52:55], a[144:151], v2
    s_waitcnt lgkmcnt(6)
    v_smfmac_f32_16x16x64_bf16 v[64:67], v[52:55], v[132:139], v2
    ds_read_b128 v[132:135], v13 offset:28672
    ds_read_b128 v[136:139], v13 offset:29696
    v_smfmac_f32_16x16x64_bf16 v[68:71], v[16:19], a[152:159], v2
    v_smfmac_f32_16x16x64_bf16 v[68:71], v[20:23], a[160:167], v2
    v_permlane32_swap_b32 v56, v58
    v_permlane32_swap_b32 v57, v59
    v_smfmac_f32_16x16x64_bf16 v[68:71], v[24:27], a[168:175], v2
    v_add_f32 v56, v56, v58
    v_add_f32 v57, v57, v59
    v_smfmac_f32_16x16x64_bf16 v[68:71], v[28:31], a[176:183], v2
    v_cvt_pk_bf16_f32 v56, v56, v57
    ds_write_b16 v3, v56 offset:0
    v_smfmac_f32_16x16x64_bf16 v[68:71], v[32:35], a[184:191], v2
    ds_write_b16_d16_hi v3, v56 offset:400
    v_permlane32_swap_b32 v60, v62
    v_smfmac_f32_16x16x64_bf16 v[68:71], v[36:39], a[192:199], v2
    v_permlane32_swap_b32 v61, v63
    v_add_f32 v60, v60, v62
    v_smfmac_f32_16x16x64_bf16 v[68:71], v[40:43], a[200:207], v2
    v_add_f32 v61, v61, v63
    v_cvt_pk_bf16_f32 v60, v60, v61
    v_smfmac_f32_16x16x64_bf16 v[68:71], v[44:47], a[208:215], v2
    ds_write_b16 v3, v60 offset:32
    ds_write_b16_d16_hi v3, v60 offset:432
    v_smfmac_f32_16x16x64_bf16 v[68:71], v[48:51], a[216:223], v2
    v_permlane32_swap_b32 v64, v66
    v_permlane32_swap_b32 v65, v67
    v_smfmac_f32_16x16x64_bf16 v[68:71], v[52:55], a[224:231], v2
    v_add_f32 v64, v64, v66
    v_add_f32 v65, v65, v67
    v_smfmac_f32_16x16x64_bf16 v[72:75], v[16:19], a[232:239], v2
    v_cvt_pk_bf16_f32 v64, v64, v65
    ds_write_b16 v3, v64 offset:64
    v_smfmac_f32_16x16x64_bf16 v[72:75], v[20:23], a[240:247], v2
    ds_write_b16_d16_hi v3, v64 offset:464
    v_smfmac_f32_16x16x64_bf16 v[72:75], v[24:27], a[248:255], v2
    v_smfmac_f32_16x16x64_bf16 v[72:75], v[28:31], v[148:155], v2
    s_waitcnt lgkmcnt(0)
    s_barrier
    ds_read_b128 v[88:91], v4 offset:0
    v_smfmac_f32_16x16x64_bf16 v[72:75], v[32:35], v[140:147], v2
    ds_read_b128 v[92:95], v4 offset:128
    ds_read_b128 v[96:99], v4 offset:256
    v_smfmac_f32_16x16x64_bf16 v[72:75], v[36:39], v[156:163], v2
    v_permlane32_swap_b32 v68, v70
    v_permlane32_swap_b32 v69, v71
    v_smfmac_f32_16x16x64_bf16 v[72:75], v[40:43], v[164:171], v2
    v_add_f32 v68, v68, v70
    v_add_f32 v69, v69, v71
    v_smfmac_f32_16x16x64_bf16 v[72:75], v[44:47], v[172:179], v2
    v_cvt_pk_bf16_f32 v68, v68, v69
    ds_write_b16 v3, v68 offset:3200
    v_smfmac_f32_16x16x64_bf16 v[72:75], v[48:51], v[116:123], v2
    ds_write_b16_d16_hi v3, v68 offset:3600
    v_smfmac_f32_16x16x64_bf16 v[72:75], v[52:55], v[180:187], v2
    s_waitcnt lgkmcnt(2)
    v_smfmac_f32_16x16x64_bf16 v[80:83], v[96:99], v[100:107], v2
    v_smfmac_f32_16x16x64_bf16 v[76:79], v[16:19], v[188:195], v2
    v_smfmac_f32_16x16x64_bf16 v[76:79], v[20:23], v[196:203], v2
    v_smfmac_f32_16x16x64_bf16 v[76:79], v[24:27], v[124:131], v2
    v_permlane32_swap_b32 v72, v74
    v_permlane32_swap_b32 v73, v75
    v_smfmac_f32_16x16x64_bf16 v[76:79], v[28:31], v[204:211], v2
    v_add_f32 v72, v72, v74
    v_add_f32 v73, v73, v75
    ds_write_b128 v15, v[80:83]
    v_smfmac_f32_16x16x64_bf16 v[76:79], v[32:35], v[212:219], v2
    v_cvt_pk_bf16_f32 v72, v72, v73
    ds_write_b16 v3, v72 offset:3232
    v_smfmac_f32_16x16x64_bf16 v[76:79], v[36:39], v[220:227], v2
    ds_write_b16_d16_hi v3, v72 offset:3632
    v_smfmac_f32_16x16x64_bf16 v[76:79], v[40:43], v[132:139], v2
    v_smfmac_f32_16x16x64_bf16 v[76:79], v[44:47], v[228:235], v2
    v_smfmac_f32_16x16x64_bf16 v[76:79], v[48:51], v[236:243], v2
    v_smfmac_f32_16x16x64_bf16 v[76:79], v[52:55], v[244:251], v2
    s_nop 7
    v_permlane32_swap_b32 v76, v78
    v_permlane32_swap_b32 v77, v79
    v_add_f32 v76, v76, v78
    v_add_f32 v77, v77, v79
    v_cvt_pk_bf16_f32 v76, v76, v77
    ds_write_b16 v3, v76 offset:3264
    ds_write_b16_d16_hi v3, v76 offset:3664
    s_waitcnt lgkmcnt(0)
    s_barrier
    ds_read2st64_b32 v[40:41], v6 offset0:0 offset1:2
    ds_read2st64_b32 v[42:43], v6 offset0:8 offset1:10
    ds_read_b128 v[16:19], v5 offset:0
    ds_read_b128 v[20:23], v5 offset:16
    ds_read_b128 v[24:27], v5 offset:128
    ds_read_b128 v[28:31], v5 offset:144
    ds_read_b128 v[32:35], v5 offset:256
    ds_read_b128 v[36:39], v5 offset:272
    s_waitcnt lgkmcnt(6)
    v_add_f32 v40, v40, v41
    v_add_f32 v42, v42, v43
    v_add_f32 v44, v40, v42
    v_mul_f32 v44, 0x3dd53b95, v44
    s_waitcnt lgkmcnt(4)
    v_smfmac_f32_16x16x64_bf16 v[84:87], v[88:91], v[16:23], v2
    s_waitcnt lgkmcnt(2)
    v_smfmac_f32_16x16x64_bf16 v[84:87], v[92:95], v[24:31], v2
    s_waitcnt lgkmcnt(0)
    v_smfmac_f32_16x16x64_bf16 v[84:87], v[96:99], v[32:39], v2
    v_max_f32_dpp v45, v44, v44 row_ror:8 row_mask:0xf bank_mask:0xf
    s_nop 1
    v_max_f32_dpp v45, v45, v45 row_ror:4 row_mask:0xf bank_mask:0xf
    s_nop 1
    v_max_f32_dpp v45, v45, v45 row_ror:2 row_mask:0xf bank_mask:0xf
    s_nop 1
    v_max_f32_dpp v45, v45, v45 row_ror:1 row_mask:0xf bank_mask:0xf
    v_mov_b32 v47, v45
    s_nop 1
    v_permlane32_swap_b32 v45, v47
    v_max_f32 v45, v45, v47
    v_mov_b32 v47, v86
    s_nop 1
    v_permlane32_swap_b32 v86, v47
    v_add_f32 v48, v86, v47
    v_mul_f32 v48, 0x3dd53b95, v48
    s_nop 1
    v_max_f32_dpp v46, v48, v48 row_ror:4 row_mask:0xf bank_mask:0xf
    s_nop 1
    v_max_f32_dpp v46, v46, v46 row_ror:2 row_mask:0xf bank_mask:0xf
    s_nop 1
    v_max_f32_dpp v46, v46, v46 row_ror:1 row_mask:0xf bank_mask:0xf
    v_max_f32 v45, v45, v46
    v_sub_f32 v49, v44, v45
    v_sub_f32 v50, v48, v45
    v_exp_f32 v49, v49
    v_exp_f32 v50, v50
    s_nop 0
    v_fma_f32 v51, v50, v12, v49
    s_nop 1
    v_add_f32_dpp v51, v51, v51 row_ror:8 row_mask:0xf bank_mask:0xf
    s_nop 1
    v_add_f32_dpp v51, v51, v51 row_ror:4 row_mask:0xf bank_mask:0xf
    s_nop 1
    v_add_f32_dpp v51, v51, v51 row_ror:2 row_mask:0xf bank_mask:0xf
    s_nop 1
    v_add_f32_dpp v51, v51, v51 row_ror:1 row_mask:0xf bank_mask:0xf
    v_mov_b32 v47, v51
    s_nop 1
    v_permlane32_swap_b32 v51, v47
    v_add_f32 v51, v51, v47
    v_rcp_f32 v51, v51
    s_nop 0
    v_mul_f32 v49, v49, v51
    v_mul_f32 v50, v50, v51
    s_nop 0
    v_mov_b32_dpp v46, v49 quad_perm:[1,0,3,2] row_mask:0xf bank_mask:0xf
    v_mov_b32_dpp v47, v50 quad_perm:[1,0,3,2] row_mask:0xf bank_mask:0xf
    v_cvt_pk_bf16_f32 v16, v49, v46
    v_cvt_pk_bf16_f32 v20, v50, v47
    s_nop 0
    v_mov_b32_dpp v17, v16 row_shl:2 row_mask:0xf bank_mask:0xf
    v_mov_b32_dpp v18, v16 row_shl:4 row_mask:0xf bank_mask:0xf
    v_mov_b32_dpp v19, v16 row_shl:6 row_mask:0xf bank_mask:0xf
    v_mov_b32_dpp v21, v20 row_shl:2 row_mask:0xf bank_mask:0xf
    v_mov_b32_dpp v22, v20 row_shl:4 row_mask:0xf bank_mask:0xf
    v_mov_b32_dpp v23, v20 row_shl:6 row_mask:0xf bank_mask:0xf
    s_mov_b64 exec, s[40:41]
    buffer_store_dwordx4 v[16:19], v7, s[8:11], s18 offen sc1
    s_mov_b64 exec, s[42:43]
    buffer_store_dwordx4 v[20:23], v8, s[8:11], s18 offen sc1
    s_mov_b64 exec, -1
    ds_read_b128 v[40:43], v10
    s_add_u32 s28, s14, 1
    s_min_u32 s28, s28, 63
    s_cmp_gt_u32 s47, s28
    s_cbranch_scc1 layerb1_kernel_p2_gw2_ok
layerb1_kernel_p2_gw2_lp:
    buffer_load_dword v253, v255, s[8:11], s48 offen sc1
    s_waitcnt vmcnt(0)
    v_readlane_b32 s47, v253, 0
    v_readlane_b32 s29, v253, 1
    s_nop 0
    s_min_u32 s47, s47, s29
    s_sub_u32 s15, s15, 1
    s_cbranch_scc1 layerb1_kernel_bail
    s_cmp_gt_u32 s47, s28
    s_cbranch_scc0 layerb1_kernel_p2_gw2_lp
layerb1_kernel_p2_gw2_ok:
    s_mul_i32 s20, s28, 393216
    s_add_u32 s20, s20, s44
    s_add_u32 s21, s20, 8192
    buffer_load_dwordx4 v[100:103], v9, s[8:11], s21 offen offset:0 sc1
    buffer_load_dwordx4 v[104:107], v9, s[8:11], s21 offen offset:512 sc1
    v_mov_b32 v56, 0
    v_mov_b32 v57, 0
    v_mov_b32 v58, 0
    v_mov_b32 v59, 0
    v_mov_b32 v60, 0
    v_mov_b32 v61, 0
    v_mov_b32 v62, 0
    v_mov_b32 v63, 0
    v_mov_b32 v64, 0
    v_mov_b32 v65, 0
    v_mov_b32 v66, 0
    v_mov_b32 v67, 0
    v_mov_b32 v68, 0
    v_mov_b32 v69, 0
    v_mov_b32 v70, 0
    v_mov_b32 v71, 0
    v_mov_b32 v72, 0
    v_mov_b32 v73, 0
    v_mov_b32 v74, 0
    v_mov_b32 v75, 0
    v_mov_b32 v76, 0
    v_mov_b32 v77, 0
    v_mov_b32 v78, 0
    v_mov_b32 v79, 0
    v_mov_b32 v80, 0
    v_mov_b32 v81, 0
    v_mov_b32 v82, 0
    v_mov_b32 v83, 0
    v_mov_b32 v84, 0
    v_mov_b32 v85, 0
    v_mov_b32 v86, 0
    v_mov_b32 v87, 0
    s_waitcnt lgkmcnt(0)
    s_mul_i32 s20, s14, 98304
    s_add_u32 s20, s20, s45
    buffer_store_dwordx4 v[40:43], v11, s[8:11], s20 offen sc1
    ds_read_b128 v[116:119], v13 offset:0
    ds_read_b128 v[120:123], v13 offset:1024
    ds_read_b128 v[124:127], v13 offset:2048
    ds_read_b128 v[128:131], v13 offset:3072
    ds_read_b128 v[132:135], v13 offset:4096
    ds_read_b128 v[136:139], v13 offset:5120
    ds_read_b128 v[140:143], v13 offset:6144
    ds_read_b128 v[144:147], v13 offset:7168
    s_waitcnt lgkmcnt(0)
    s_add_u32 s14, s14, 1
    s_cmp_lt_u32 s14, 64
    s_cbranch_scc1 layerb1_kernel_p2_step
    s_waitcnt vmcnt(0)
    s_barrier
    s_branch layerb1_kernel_end
layerb1_kernel_p3_start:
    v_lshrrev_b32 v16, 4, v0
    v_and_b32 v17, 15, v0
    v_and_b32 v18, 1, v16
    v_lshlrev_b32 v18, 2, v18
    v_lshrrev_b32 v19, 1, v16
    v_lshl_add_u32 v18, v19, 1, v18
    v_mul_u32_u24 v18, 400, v18
    v_lshl_add_u32 v18, v17, 1, v18
    v_add_u32 v3, 133408, v18
    v_and_b32 v18, 7, v0
    v_mul_u32_u24 v18, 400, v18
    v_lshrrev_b32 v19, 3, v0
    v_lshl_add_u32 v18, v19, 4, v18
    v_add_u32 v4, 133120, v18
    v_and_b32 v18, 7, v0
    v_mul_u32_u24 v18, 400, v18
    v_lshl_add_u32 v18, v16, 5, v18
    v_add_u32 v5, 136320, v18
    v_lshrrev_b32 v18, 1, v16
    v_lshlrev_b32 v18, 10, v18
    v_and_b32 v19, 31, v0
    v_lshl_add_u32 v18, v19, 4, v18
    v_add_u32 v6, 139532, v18
    v_add_u32 v15, 142592, v1
    v_lshrrev_b32 v18, 1, v16
    v_lshlrev_b32 v18, 1, v18
    v_lshrrev_b32 v19, 3, v17
    v_add3_u32 v18, v18, v19, 1
    v_lshrrev_b32 v19, 1, v18
    v_lshlrev_b32 v19, 14, v19
    v_and_b32 v18, 1, v18
    v_lshl_add_u32 v18, v18, 12, v19
    v_and_b32 v19, 1, v16
    v_lshlrev_b32 v19, 4, v19
    v_add_u32 v19, 96, v19
    s_lshl_b32 s20, s12, 7
    v_add_u32 v8, s20, v19
    v_add_u32 v7, v8, v18
    v_lshlrev_b32 v18, 4, v17
    v_lshl_add_u32 v18, v16, 10, v18
    v_add_u32 v9, 256, v18
    v_add_u32 v18, 192, v0
    v_mul_u32_u24 v19, 2731, v18
    v_lshrrev_b32 v19, 16, v19
    v_mul_u32_u24 v20, 24, v19
    v_sub_u32 v20, v18, v20
    v_mul_u32_u24 v21, 400, v19
    v_lshl_add_u32 v21, v20, 4, v21
    v_add_u32 v10, 136320, v21
    v_lshlrev_b32 v21, 4, v19
    v_lshl_add_u32 v11, v20, 7, v21
    v_and_b32 v18, 0x28, v0
    v_cmp_eq_u32 vcc, 0, v18
    v_mov_b32 v18, 1.0
    v_mov_b32 v19, 0
    v_cndmask_b32 v12, v19, v18, vcc
    v_add_u32 v13, 92160, v1
    v_add_u32 v14, 122880, v1
    s_mul_i32 s44, s12, 12288
    s_add_u32 s44, s44, 53477376
    s_mul_i32 s45, s12, 3072
    s_add_u32 s45, s45, 208666624
    s_mul_i32 s20, s12, 6
    s_add_u32 s21, s20, 5
    s_lshr_b32 s20, s20, 3
    s_lshr_b32 s21, s21, 3
    s_add_u32 s20, s20, 80
    s_add_u32 s21, s21, 80
    s_lshl_b32 s20, s20, 7
    s_lshl_b32 s21, s21, 7
    v_mov_b32 v255, s21
    v_mov_b32 v253, s20
    v_cmp_eq_u32 vcc, 0, v0
    s_nop 1
    v_cndmask_b32 v255, v255, v253, vcc
    s_mov_b32 s47, 0
    s_mul_i32 s20, s12, 491520
    s_add_u32 s20, s20, 11902976
    s_add_u32 s21, s20, 2048
    buffer_load_dwordx4 v[16:19], v1, s[8:11], s21 offen offset:0
    buffer_load_dwordx4 v[20:23], v1, s[8:11], s21 offen offset:1024
    s_add_u32 s21, s20, 43008
    buffer_load_dwordx4 v[24:27], v1, s[8:11], s21 offen offset:0
    buffer_load_dwordx4 v[28:31], v1, s[8:11], s21 offen offset:1024
    s_add_u32 s21, s20, 24576
    buffer_load_dwordx4 v[32:35], v1, s[8:11], s21 offen offset:0
    buffer_load_dwordx4 v[36:39], v1, s[8:11], s21 offen offset:1024
    s_add_u32 s21, s20, 6144
    buffer_load_dwordx4 v[40:43], v1, s[8:11], s21 offen offset:0
    buffer_load_dwordx4 v[44:47], v1, s[8:11], s21 offen offset:1024
    s_add_u32 s21, s20, 47104
    buffer_load_dwordx4 v[48:51], v1, s[8:11], s21 offen offset:0
    buffer_load_dwordx4 v[52:55], v1, s[8:11], s21 offen offset:1024
    s_add_u32 s21, s20, 28672
    buffer_load_dwordx4 v[56:59], v1, s[8:11], s21 offen offset:0
    buffer_load_dwordx4 v[60:63], v1, s[8:11], s21 offen offset:1024
    s_add_u32 s21, s20, 10240
    buffer_load_dwordx4 v[64:67], v1, s[8:11], s21 offen offset:0
    buffer_load_dwordx4 v[68:71], v1, s[8:11], s21 offen offset:1024
    s_add_u32 s21, s20, 51200
    buffer_load_dwordx4 v[72:75], v1, s[8:11], s21 offen offset:0
    buffer_load_dwordx4 v[76:79], v1, s[8:11], s21 offen offset:1024
    s_add_u32 s21, s20, 32768
    buffer_load_dwordx4 v[80:83], v1, s[8:11], s21 offen offset:0
    buffer_load_dwordx4 v[84:87], v1, s[8:11], s21 offen offset:1024
    s_add_u32 s21, s20, 14336
    buffer_load_dwordx4 v[88:91], v1, s[8:11], s21 offen offset:0
    buffer_load_dwordx4 v[92:95], v1, s[8:11], s21 offen offset:1024
    s_add_u32 s21, s20, 55296
    buffer_load_dwordx4 v[96:99], v1, s[8:11], s21 offen offset:0
    buffer_load_dwordx4 v[100:103], v1, s[8:11], s21 offen offset:1024
    s_add_u32 s21, s20, 90112
    buffer_load_dwordx4 v[104:107], v1, s[8:11], s21 offen offset:0
    buffer_load_dwordx4 v[108:111], v1, s[8:11], s21 offen offset:1024
    s_add_u32 s21, s20, 98304
    buffer_load_dwordx4 v[112:115], v1, s[8:11], s21 offen offset:0
    buffer_load_dwordx4 v[116:119], v1, s[8:11], s21 offen offset:1024
    s_add_u32 s21, s20, 106496
    buffer_load_dwordx4 v[120:123], v1, s[8:11], s21 offen offset:0
    buffer_load_dwordx4 v[124:127], v1, s[8:11], s21 offen offset:1024
    s_add_u32 s21, s20, 114688
    buffer_load_dwordx4 v[128:131], v1, s[8:11], s21 offen offset:0
    buffer_load_dwordx4 v[132:135], v1, s[8:11], s21 offen offset:1024
    s_add_u32 s21, s20, 16384
    buffer_load_dwordx4 a[0:3], v1, s[8:11], s21 offen offset:0
    buffer_load_dwordx4 a[4:7], v1, s[8:11], s21 offen offset:1024
    s_add_u32 s21, s20, 36864
    buffer_load_dwordx4 a[8:11], v1, s[8:11], s21 offen offset:0
    buffer_load_dwordx4 a[12:15], v1, s[8:11], s21 offen offset:1024
    s_add_u32 s21, s20, 57344
    buffer_load_dwordx4 a[16:19], v1, s[8:11], s21 offen offset:0
    buffer_load_dwordx4 a[20:23], v1, s[8:11], s21 offen offset:1024
    s_add_u32 s21, s20, 18432
    buffer_load_dwordx4 a[24:27], v1, s[8:11], s21 offen offset:0
    buffer_load_dwordx4 a[28:31], v1, s[8:11], s21 offen offset:1024
    s_add_u32 s21, s20, 38912
    buffer_load_dwordx4 a[32:35], v1, s[8:11], s21 offen offset:0
    buffer_load_dwordx4 a[36:39], v1, s[8:11], s21 offen offset:1024
    s_add_u32 s21, s20, 59392
    buffer_load_dwordx4 a[40:43], v1, s[8:11], s21 offen offset:0
    buffer_load_dwordx4 a[44:47], v1, s[8:11], s21 offen offset:1024
    s_add_u32 s21, s20, 0
    buffer_load_dwordx4 a[48:51], v1, s[8:11], s21 offen offset:0
    buffer_load_dwordx4 a[52:55], v1, s[8:11], s21 offen offset:1024
    s_add_u32 s21, s20, 20480
    buffer_load_dwordx4 a[56:59], v1, s[8:11], s21 offen offset:0
    buffer_load_dwordx4 a[60:63], v1, s[8:11], s21 offen offset:1024
    s_add_u32 s21, s20, 40960
    buffer_load_dwordx4 a[64:67], v1, s[8:11], s21 offen offset:0
    buffer_load_dwordx4 a[68:71], v1, s[8:11], s21 offen offset:1024
    s_add_u32 s21, s20, 22528
    buffer_load_dwordx4 a[72:75], v1, s[8:11], s21 offen offset:0
    buffer_load_dwordx4 a[76:79], v1, s[8:11], s21 offen offset:1024
    s_add_u32 s21, s20, 4096
    buffer_load_dwordx4 a[80:83], v1, s[8:11], s21 offen offset:0
    buffer_load_dwordx4 a[84:87], v1, s[8:11], s21 offen offset:1024
    s_add_u32 s21, s20, 45056
    buffer_load_dwordx4 a[88:91], v1, s[8:11], s21 offen offset:0
    buffer_load_dwordx4 a[92:95], v1, s[8:11], s21 offen offset:1024
    s_add_u32 s21, s20, 26624
    buffer_load_dwordx4 a[96:99], v1, s[8:11], s21 offen offset:0
    buffer_load_dwordx4 a[100:103], v1, s[8:11], s21 offen offset:1024
    s_add_u32 s21, s20, 8192
    buffer_load_dwordx4 a[104:107], v1, s[8:11], s21 offen offset:0
    buffer_load_dwordx4 a[108:111], v1, s[8:11], s21 offen offset:1024
    s_add_u32 s21, s20, 49152
    buffer_load_dwordx4 a[112:115], v1, s[8:11], s21 offen offset:0
    buffer_load_dwordx4 a[116:119], v1, s[8:11], s21 offen offset:1024
    s_add_u32 s21, s20, 30720
    buffer_load_dwordx4 a[120:123], v1, s[8:11], s21 offen offset:0
    buffer_load_dwordx4 a[124:127], v1, s[8:11], s21 offen offset:1024
    s_waitcnt vmcnt(32)
    ds_write_b128 v13, v[16:19] offset:0
    ds_write_b128 v13, v[20:23] offset:1024
    ds_write_b128 v13, v[24:27] offset:2048
    ds_write_b128 v13, v[28:31] offset:3072
    ds_write_b128 v13, v[32:35] offset:4096
    ds_write_b128 v13, v[36:39] offset:5120
    ds_write_b128 v13, v[40:43] offset:6144
    ds_write_b128 v13, v[44:47] offset:7168
    ds_write_b128 v13, v[48:51] offset:8192
    ds_write_b128 v13, v[52:55] offset:9216
    ds_write_b128 v13, v[56:59] offset:10240
    ds_write_b128 v13, v[60:63] offset:11264
    ds_write_b128 v13, v[64:67] offset:12288
    ds_write_b128 v13, v[68:71] offset:13312
    ds_write_b128 v13, v[72:75] offset:14336
    ds_write_b128 v13, v[76:79] offset:15360
    ds_write_b128 v13, v[80:83] offset:16384
    ds_write_b128 v13, v[84:87] offset:17408
    ds_write_b128 v13, v[88:91] offset:18432
    ds_write_b128 v13, v[92:95] offset:19456
    ds_write_b128 v13, v[96:99] offset:20480
    ds_write_b128 v13, v[100:103] offset:21504
    ds_write_b128 v13, v[104:107] offset:22528
    ds_write_b128 v13, v[108:111] offset:23552
    ds_write_b128 v13, v[112:115] offset:24576
    ds_write_b128 v13, v[116:119] offset:25600
    ds_write_b128 v13, v[120:123] offset:26624
    ds_write_b128 v13, v[124:127] offset:27648
    ds_write_b128 v13, v[128:131] offset:28672
    ds_write_b128 v13, v[132:135] offset:29696
    s_add_u32 s21, s20, 12288
    buffer_load_dwordx4 a[128:131], v1, s[8:11], s21 offen offset:0
    buffer_load_dwordx4 a[132:135], v1, s[8:11], s21 offen offset:1024
    s_add_u32 s21, s20, 53248
    buffer_load_dwordx4 a[136:139], v1, s[8:11], s21 offen offset:0
    buffer_load_dwordx4 a[140:143], v1, s[8:11], s21 offen offset:1024
    s_add_u32 s21, s20, 34816
    buffer_load_dwordx4 a[144:147], v1, s[8:11], s21 offen offset:0
    buffer_load_dwordx4 a[148:151], v1, s[8:11], s21 offen offset:1024
    s_add_u32 s21, s20, 61440
    buffer_load_dwordx4 a[152:155], v1, s[8:11], s21 offen offset:0
    buffer_load_dwordx4 a[156:159], v1, s[8:11], s21 offen offset:1024
    s_add_u32 s21, s20, 63488
    buffer_load_dwordx4 a[160:163], v1, s[8:11], s21 offen offset:0
    buffer_load_dwordx4 a[164:167], v1, s[8:11], s21 offen offset:1024
    s_add_u32 s21, s20, 65536
    buffer_load_dwordx4 a[168:171], v1, s[8:11], s21 offen offset:0
    buffer_load_dwordx4 a[172:175], v1, s[8:11], s21 offen offset:1024
    s_add_u32 s21, s20, 67584
    buffer_load_dwordx4 a[176:179], v1, s[8:11], s21 offen offset:0
    buffer_load_dwordx4 a[180:183], v1, s[8:11], s21 offen offset:1024
    s_add_u32 s21, s20, 69632
    buffer_load_dwordx4 a[184:187], v1, s[8:11], s21 offen offset:0
    buffer_load_dwordx4 a[188:191], v1, s[8:11], s21 offen offset:1024
    s_add_u32 s21, s20, 71680
    buffer_load_dwordx4 a[192:195], v1, s[8:11], s21 offen offset:0
    buffer_load_dwordx4 a[196:199], v1, s[8:11], s21 offen offset:1024
    s_add_u32 s21, s20, 73728
    buffer_load_dwordx4 a[200:203], v1, s[8:11], s21 offen offset:0
    buffer_load_dwordx4 a[204:207], v1, s[8:11], s21 offen offset:1024
    s_add_u32 s21, s20, 75776
    buffer_load_dwordx4 a[208:211], v1, s[8:11], s21 offen offset:0
    buffer_load_dwordx4 a[212:215], v1, s[8:11], s21 offen offset:1024
    s_add_u32 s21, s20, 77824
    buffer_load_dwordx4 a[216:219], v1, s[8:11], s21 offen offset:0
    buffer_load_dwordx4 a[220:223], v1, s[8:11], s21 offen offset:1024
    s_add_u32 s21, s20, 79872
    buffer_load_dwordx4 a[224:227], v1, s[8:11], s21 offen offset:0
    buffer_load_dwordx4 a[228:231], v1, s[8:11], s21 offen offset:1024
    s_add_u32 s21, s20, 81920
    buffer_load_dwordx4 a[232:235], v1, s[8:11], s21 offen offset:0
    buffer_load_dwordx4 a[236:239], v1, s[8:11], s21 offen offset:1024
    s_add_u32 s21, s20, 83968
    buffer_load_dwordx4 a[240:243], v1, s[8:11], s21 offen offset:0
    buffer_load_dwordx4 a[244:247], v1, s[8:11], s21 offen offset:1024
    s_add_u32 s21, s20, 86016
    buffer_load_dwordx4 a[248:251], v1, s[8:11], s21 offen offset:0
    buffer_load_dwordx4 a[252:255], v1, s[8:11], s21 offen offset:1024
    s_add_u32 s21, s20, 88064
    buffer_load_dwordx4 v[148:151], v1, s[8:11], s21 offen offset:0
    buffer_load_dwordx4 v[152:155], v1, s[8:11], s21 offen offset:1024
    s_add_u32 s21, s20, 92160
    buffer_load_dwordx4 v[156:159], v1, s[8:11], s21 offen offset:0
    buffer_load_dwordx4 v[160:163], v1, s[8:11], s21 offen offset:1024
    s_add_u32 s21, s20, 94208
    buffer_load_dwordx4 v[164:167], v1, s[8:11], s21 offen offset:0
    buffer_load_dwordx4 v[168:171], v1, s[8:11], s21 offen offset:1024
    s_add_u32 s21, s20, 96256
    buffer_load_dwordx4 v[172:175], v1, s[8:11], s21 offen offset:0
    buffer_load_dwordx4 v[176:179], v1, s[8:11], s21 offen offset:1024
    s_add_u32 s21, s20, 100352
    buffer_load_dwordx4 v[180:183], v1, s[8:11], s21 offen offset:0
    buffer_load_dwordx4 v[184:187], v1, s[8:11], s21 offen offset:1024
    s_add_u32 s21, s20, 102400
    buffer_load_dwordx4 v[188:191], v1, s[8:11], s21 offen offset:0
    buffer_load_dwordx4 v[192:195], v1, s[8:11], s21 offen offset:1024
    s_add_u32 s21, s20, 104448
    buffer_load_dwordx4 v[196:199], v1, s[8:11], s21 offen offset:0
    buffer_load_dwordx4 v[200:203], v1, s[8:11], s21 offen offset:1024
    s_add_u32 s21, s20, 108544
    buffer_load_dwordx4 v[204:207], v1, s[8:11], s21 offen offset:0
    buffer_load_dwordx4 v[208:211], v1, s[8:11], s21 offen offset:1024
    s_add_u32 s21, s20, 110592
    buffer_load_dwordx4 v[212:215], v1, s[8:11], s21 offen offset:0
    buffer_load_dwordx4 v[216:219], v1, s[8:11], s21 offen offset:1024
    s_add_u32 s21, s20, 112640
    buffer_load_dwordx4 v[220:223], v1, s[8:11], s21 offen offset:0
    buffer_load_dwordx4 v[224:227], v1, s[8:11], s21 offen offset:1024
    s_add_u32 s21, s20, 116736
    buffer_load_dwordx4 v[228:231], v1, s[8:11], s21 offen offset:0
    buffer_load_dwordx4 v[232:235], v1, s[8:11], s21 offen offset:1024
    s_add_u32 s21, s20, 118784
    buffer_load_dwordx4 v[236:239], v1, s[8:11], s21 offen offset:0
    buffer_load_dwordx4 v[240:243], v1, s[8:11], s21 offen offset:1024
    s_add_u32 s21, s20, 120832
    buffer_load_dwordx4 v[244:247], v1, s[8:11], s21 offen offset:0
    buffer_load_dwordx4 v[248:251], v1, s[8:11], s21 offen offset:1024
    s_waitcnt lgkmcnt(0)
    s_mov_b32 s14, 0
    s_cmp_gt_u32 s47, s14
    s_cbranch_scc1 layerb1_kernel_p3_gw1_ok
layerb1_kernel_p3_gw1_lp:
    buffer_load_dword v253, v255, s[8:11], s48 offen sc1
    s_waitcnt vmcnt(0)
    v_readlane_b32 s47, v253, 0
    v_readlane_b32 s29, v253, 1
    s_nop 0
    s_min_u32 s47, s47, s29
    s_sub_u32 s15, s15, 1
    s_cbranch_scc1 layerb1_kernel_bail
    s_cmp_gt_u32 s47, s14
    s_cbranch_scc0 layerb1_kernel_p3_gw1_lp
layerb1_kernel_p3_gw1_ok:
    s_mul_i32 s20, s14, 393216
    s_add_u32 s20, s20, s44
    s_add_u32 s21, s20, 8192
    buffer_load_dwordx4 v[100:103], v9, s[8:11], s21 offen offset:0 sc1
    buffer_load_dwordx4 v[104:107], v9, s[8:11], s21 offen offset:512 sc1
    v_mov_b32 v56, 0
    v_mov_b32 v57, 0
    v_mov_b32 v58, 0
    v_mov_b32 v59, 0
    v_mov_b32 v60, 0
    v_mov_b32 v61, 0
    v_mov_b32 v62, 0
    v_mov_b32 v63, 0
    v_mov_b32 v64, 0
    v_mov_b32 v65, 0
    v_mov_b32 v66, 0
    v_mov_b32 v67, 0
    v_mov_b32 v68, 0
    v_mov_b32 v69, 0
    v_mov_b32 v70, 0
    v_mov_b32 v71, 0
    v_mov_b32 v72, 0
    v_mov_b32 v73, 0
    v_mov_b32 v74, 0
    v_mov_b32 v75, 0
    v_mov_b32 v76, 0
    v_mov_b32 v77, 0
    v_mov_b32 v78, 0
    v_mov_b32 v79, 0
    v_mov_b32 v80, 0
    v_mov_b32 v81, 0
    v_mov_b32 v82, 0
    v_mov_b32 v83, 0
    v_mov_b32 v84, 0
    v_mov_b32 v85, 0
    v_mov_b32 v86, 0
    v_mov_b32 v87, 0
    ds_read_b128 v[116:119], v13 offset:0
    ds_read_b128 v[120:123], v13 offset:1024
    ds_read_b128 v[124:127], v13 offset:2048
    ds_read_b128 v[128:131], v13 offset:3072
    ds_read_b128 v[132:135], v13 offset:4096
    ds_read_b128 v[136:139], v13 offset:5120
    ds_read_b128 v[140:143], v13 offset:6144
    ds_read_b128 v[144:147], v13 offset:7168
    s_waitcnt lgkmcnt(0)
layerb1_kernel_p3_step:
    s_cmp_lt_u32 s14, 32
    s_cselect_b32 s18, s16, s17
    s_and_b32 s20, s14, 31
    s_lshl_b32 s20, s20, 16
    s_add_u32 s18, s18, s20
    s_add_u32 s22, s18, 53248
    s_add_u32 s23, s18, 54272
layerb1_kernel_p3_poll:
    buffer_load_dwordx4 v[48:51], v1, s[8:11], s22 offen sc1
    buffer_load_dwordx4 v[52:55], v1, s[8:11], s23 offen sc1
    s_waitcnt vmcnt(0)
    ds_write_b128 v14, v[48:51] offset:8192
    ds_write_b128 v14, v[52:55] offset:9216
    v_max3_u32 v88, v48, v49, v50
    v_max3_u32 v88, v88, v51, v52
    v_max3_u32 v88, v88, v53, v54
    v_max_u32 v88, v88, v55
    v_cmp_eq_u32 vcc, -1, v88
    s_sub_u32 s15, s15, 1
    s_cbranch_scc1 layerb1_kernel_bail
    s_cbranch_vccnz layerb1_kernel_p3_poll
    s_waitcnt lgkmcnt(0)
    s_barrier
    ds_read_b128 v[16:19], v14 offset:0
    ds_read_b128 v[20:23], v14 offset:1024
    ds_read_b128 v[24:27], v14 offset:2048
    ds_read_b128 v[28:31], v14 offset:3072
    ds_read_b128 v[32:35], v14 offset:4096
    ds_read_b128 v[36:39], v14 offset:5120
    ds_read_b128 v[40:43], v14 offset:6144
    ds_read_b128 v[44:47], v14 offset:7168
    v_smfmac_f32_16x16x64_bf16 v[56:59], v[48:51], a[0:7], v2
    v_smfmac_f32_16x16x64_bf16 v[60:63], v[48:51], a[8:15], v2
    v_smfmac_f32_16x16x64_bf16 v[64:67], v[48:51], a[16:23], v2
    v_smfmac_f32_16x16x64_bf16 v[56:59], v[52:55], a[24:31], v2
    v_smfmac_f32_16x16x64_bf16 v[60:63], v[52:55], a[32:39], v2
    v_smfmac_f32_16x16x64_bf16 v[64:67], v[52:55], a[40:47], v2
    s_waitcnt lgkmcnt(7)
    v_smfmac_f32_16x16x64_bf16 v[56:59], v[16:19], a[48:55], v2
    v_smfmac_f32_16x16x64_bf16 v[60:63], v[16:19], a[56:63], v2
    v_smfmac_f32_16x16x64_bf16 v[64:67], v[16:19], a[64:71], v2
    s_waitcnt lgkmcnt(6)
    v_smfmac_f32_16x16x64_bf16 v[56:59], v[20:23], v[116:123], v2
    ds_read_b128 v[116:119], v13 offset:8192
    ds_read_b128 v[120:123], v13 offset:9216
    v_smfmac_f32_16x16x64_bf16 v[60:63], v[20:23], a[72:79], v2
    v_smfmac_f32_16x16x64_bf16 v[64:67], v[20:23], v[124:131], v2
    ds_read_b128 v[124:127], v13 offset:10240
    ds_read_b128 v[128:131], v13 offset:11264
    s_waitcnt lgkmcnt(9)
    v_smfmac_f32_16x16x64_bf16 v[56:59], v[24:27], a[80:87], v2
    v_smfmac_f32_16x16x64_bf16 v[60:63], v[24:27], v[132:139], v2
    ds_read_b128 v[132:135], v13 offset:12288
    ds_read_b128 v[136:139], v13 offset:13312
    v_smfmac_f32_16x16x64_bf16 v[64:67], v[24:27], a[88:95], v2
    s_waitcnt lgkmcnt(10)
    v_smfmac_f32_16x16x64_bf16 v[56:59], v[28:31], v[140:147], v2
    ds_read_b128 v[140:143], v13 offset:14336
    ds_read_b128 v[144:147], v13 offset:15360
    v_smfmac_f32_16x16x64_bf16 v[60:63], v[28:31], a[96:103], v2
    s_waitcnt lgkmcnt(6)
    v_smfmac_f32_16x16x64_bf16 v[64:67], v[28:31], v[116:123], v2
    ds_read_b128 v[116:119], v13 offset:16384
    ds_read_b128 v[120:123], v13 offset:17408
    v_smfmac_f32_16x16x64_bf16 v[56:59], v[32:35], a[104:111], v2
    s_waitcnt lgkmcnt(6)
    v_smfmac_f32_16x16x64_bf16 v[60:63], v[32:35], v[124:131], v2
    ds_read_b128 v[124:127], v13 offset:18432
    ds_read_b128 v[128:131], v13 offset:19456
    v_smfmac_f32_16x16x64_bf16 v[64:67], v[32:35], a[112:119], v2
    s_waitcnt lgkmcnt(6)
    v_smfmac_f32_16x16x64_bf16 v[56:59], v[36:39], v[132:139], v2
    ds_read_b128 v[132:135], v13 offset:20480
    ds_read_b128 v[136:139], v13 offset:21504
    v_smfmac_f32_16x16x64_bf16 v[60:63], v[36:39], a[120:127], v2
    s_waitcnt lgkmcnt(6)
    v_smfmac_f32_16x16x64_bf16 v[64:67], v[36:39], v[140:147], v2
    ds_read_b128 v[140:143], v13 offset:22528
    ds_read_b128 v[144:147], v13 offset:23552
    v_smfmac_f32_16x16x64_bf16 v[56:59], v[40:43], a[128:135], v2
    s_waitcnt lgkmcnt(6)
    v_smfmac_f32_16x16x64_bf16 v[60:63], v[40:43], v[116:123], v2
    ds_read_b128 v[116:119], v13 offset:24576
    ds_read_b128 v[120:123], v13 offset:25600
    v_smfmac_f32_16x16x64_bf16 v[64:67], v[40:43], a[136:143], v2
    s_waitcnt lgkmcnt(6)
    v_smfmac_f32_16x16x64_bf16 v[56:59], v[44:47], v[124:131], v2
    ds_read_b128 v[124:127], v13 offset:26624
    ds_read_b128 v[128:131], v13 offset:27648
    v_smfmac_f32_16x16x64_bf16 v[60:63], v[44:47], a[144:151], v2
    s_waitcnt lgkmcnt(6)
    v_smfmac_f32_16x16x64_bf16 v[64:67], v[44:47], v[132:139], v2
    ds_read_b128 v[132:135], v13 offset:28672
    ds_read_b128 v[136:139], v13 offset:29696
    v_smfmac_f32_16x16x64_bf16 v[68:71], v[16:19], a[152:159], v2
    v_smfmac_f32_16x16x64_bf16 v[68:71], v[20:23], a[160:167], v2
    v_permlane32_swap_b32 v56, v58
    v_permlane32_swap_b32 v57, v59
    v_smfmac_f32_16x16x64_bf16 v[68:71], v[24:27], a[168:175], v2
    v_add_f32 v56, v56, v58
    v_add_f32 v57, v57, v59
    v_smfmac_f32_16x16x64_bf16 v[68:71], v[28:31], a[176:183], v2
    v_cvt_pk_bf16_f32 v56, v56, v57
    ds_write_b16 v3, v56 offset:0
    v_smfmac_f32_16x16x64_bf16 v[68:71], v[32:35], a[184:191], v2
    ds_write_b16_d16_hi v3, v56 offset:400
    v_permlane32_swap_b32 v60, v62
    v_smfmac_f32_16x16x64_bf16 v[68:71], v[36:39], a[192:199], v2
    v_permlane32_swap_b32 v61, v63
    v_add_f32 v60, v60, v62
    v_smfmac_f32_16x16x64_bf16 v[68:71], v[40:43], a[200:207], v2
    v_add_f32 v61, v61, v63
    v_cvt_pk_bf16_f32 v60, v60, v61
    v_smfmac_f32_16x16x64_bf16 v[68:71], v[44:47], a[208:215], v2
    ds_write_b16 v3, v60 offset:32
    ds_write_b16_d16_hi v3, v60 offset:432
    v_smfmac_f32_16x16x64_bf16 v[68:71], v[48:51], a[216:223], v2
    v_permlane32_swap_b32 v64, v66
    v_permlane32_swap_b32 v65, v67
    v_smfmac_f32_16x16x64_bf16 v[68:71], v[52:55], a[224:231], v2
    v_add_f32 v64, v64, v66
    v_add_f32 v65, v65, v67
    v_smfmac_f32_16x16x64_bf16 v[72:75], v[16:19], a[232:239], v2
    v_cvt_pk_bf16_f32 v64, v64, v65
    ds_write_b16 v3, v64 offset:64
    v_smfmac_f32_16x16x64_bf16 v[72:75], v[20:23], a[240:247], v2
    ds_write_b16_d16_hi v3, v64 offset:464
    v_smfmac_f32_16x16x64_bf16 v[72:75], v[24:27], a[248:255], v2
    v_smfmac_f32_16x16x64_bf16 v[72:75], v[28:31], v[148:155], v2
    s_waitcnt lgkmcnt(0)
    s_barrier
    ds_read_b128 v[88:91], v4 offset:0
    v_smfmac_f32_16x16x64_bf16 v[72:75], v[32:35], v[140:147], v2
    ds_read_b128 v[92:95], v4 offset:128
    ds_read_b128 v[96:99], v4 offset:256
    v_smfmac_f32_16x16x64_bf16 v[72:75], v[36:39], v[156:163], v2
    v_permlane32_swap_b32 v68, v70
    v_permlane32_swap_b32 v69, v71
    v_smfmac_f32_16x16x64_bf16 v[72:75], v[40:43], v[164:171], v2
    v_add_f32 v68, v68, v70
    v_add_f32 v69, v69, v71
    v_smfmac_f32_16x16x64_bf16 v[72:75], v[44:47], v[172:179], v2
    v_cvt_pk_bf16_f32 v68, v68, v69
    ds_write_b16 v3, v68 offset:3200
    v_smfmac_f32_16x16x64_bf16 v[72:75], v[48:51], v[116:123], v2
    ds_write_b16_d16_hi v3, v68 offset:3600
    v_smfmac_f32_16x16x64_bf16 v[72:75], v[52:55], v[180:187], v2
    s_waitcnt lgkmcnt(2)
    v_smfmac_f32_16x16x64_bf16 v[80:83], v[96:99], v[100:107], v2
    v_smfmac_f32_16x16x64_bf16 v[76:79], v[16:19], v[188:195], v2
    v_smfmac_f32_16x16x64_bf16 v[76:79], v[20:23], v[196:203], v2
    v_smfmac_f32_16x16x64_bf16 v[76:79], v[24:27], v[124:131], v2
    v_permlane32_swap_b32 v72, v74
    v_permlane32_swap_b32 v73, v75
    v_smfmac_f32_16x16x64_bf16 v[76:79], v[28:31], v[204:211], v2
    v_add_f32 v72, v72, v74
    v_add_f32 v73, v73, v75
    ds_write_b128 v15, v[80:83]
    v_smfmac_f32_16x16x64_bf16 v[76:79], v[32:35], v[212:219], v2
    v_cvt_pk_bf16_f32 v72, v72, v73
    ds_write_b16 v3, v72 offset:3232
    v_smfmac_f32_16x16x64_bf16 v[76:79], v[36:39], v[220:227], v2
    ds_write_b16_d16_hi v3, v72 offset:3632
    v_smfmac_f32_16x16x64_bf16 v[76:79], v[40:43], v[132:139], v2
    v_smfmac_f32_16x16x64_bf16 v[76:79], v[44:47], v[228:235], v2
    v_smfmac_f32_16x16x64_bf16 v[76:79], v[48:51], v[236:243], v2
    v_smfmac_f32_16x16x64_bf16 v[76:79], v[52:55], v[244:251], v2
    s_nop 7
    v_permlane32_swap_b32 v76, v78
    v_permlane32_swap_b32 v77, v79
    v_add_f32 v76, v76, v78
    v_add_f32 v77, v77, v79
    v_cvt_pk_bf16_f32 v76, v76, v77
    ds_write_b16 v3, v76 offset:3264
    ds_write_b16_d16_hi v3, v76 offset:3664
    s_waitcnt lgkmcnt(0)
    s_barrier
    ds_read2st64_b32 v[40:41], v6 offset0:0 offset1:2
    ds_read2st64_b32 v[42:43], v6 offset0:8 offset1:10
    ds_read_b128 v[16:19], v5 offset:0
    ds_read_b128 v[20:23], v5 offset:16
    ds_read_b128 v[24:27], v5 offset:128
    ds_read_b128 v[28:31], v5 offset:144
    ds_read_b128 v[32:35], v5 offset:256
    ds_read_b128 v[36:39], v5 offset:272
    s_waitcnt lgkmcnt(6)
    v_add_f32 v40, v40, v41
    v_add_f32 v42, v42, v43
    v_add_f32 v44, v40, v42
    v_mul_f32 v44, 0x3dd53b95, v44
    s_waitcnt lgkmcnt(4)
    v_smfmac_f32_16x16x64_bf16 v[84:87], v[88:91], v[16:23], v2
    s_waitcnt lgkmcnt(2)
    v_smfmac_f32_16x16x64_bf16 v[84:87], v[92:95], v[24:31], v2
    s_waitcnt lgkmcnt(0)
    v_smfmac_f32_16x16x64_bf16 v[84:87], v[96:99], v[32:39], v2
    v_max_f32_dpp v45, v44, v44 row_ror:8 row_mask:0xf bank_mask:0xf
    s_nop 1
    v_max_f32_dpp v45, v45, v45 row_ror:4 row_mask:0xf bank_mask:0xf
    s_nop 1
    v_max_f32_dpp v45, v45, v45 row_ror:2 row_mask:0xf bank_mask:0xf
    s_nop 1
    v_max_f32_dpp v45, v45, v45 row_ror:1 row_mask:0xf bank_mask:0xf
    v_mov_b32 v47, v45
    s_nop 1
    v_permlane32_swap_b32 v45, v47
    v_max_f32 v45, v45, v47
    v_mov_b32 v47, v87
    s_nop 1
    v_permlane32_swap_b32 v87, v47
    v_add_f32 v48, v87, v47
    v_mul_f32 v48, 0x3dd53b95, v48
    s_nop 1
    v_max_f32_dpp v46, v48, v48 row_ror:4 row_mask:0xf bank_mask:0xf
    s_nop 1
    v_max_f32_dpp v46, v46, v46 row_ror:2 row_mask:0xf bank_mask:0xf
    s_nop 1
    v_max_f32_dpp v46, v46, v46 row_ror:1 row_mask:0xf bank_mask:0xf
    v_max_f32 v45, v45, v46
    v_sub_f32 v49, v44, v45
    v_sub_f32 v50, v48, v45
    v_exp_f32 v49, v49
    v_exp_f32 v50, v50
    s_nop 0
    v_fma_f32 v51, v50, v12, v49
    s_nop 1
    v_add_f32_dpp v51, v51, v51 row_ror:8 row_mask:0xf bank_mask:0xf
    s_nop 1
    v_add_f32_dpp v51, v51, v51 row_ror:4 row_mask:0xf bank_mask:0xf
    s_nop 1
    v_add_f32_dpp v51, v51, v51 row_ror:2 row_mask:0xf bank_mask:0xf
    s_nop 1
    v_add_f32_dpp v51, v51, v51 row_ror:1 row_mask:0xf bank_mask:0xf
    v_mov_b32 v47, v51
    s_nop 1
    v_permlane32_swap_b32 v51, v47
    v_add_f32 v51, v51, v47
    v_rcp_f32 v51, v51
    s_nop 0
    v_mul_f32 v49, v49, v51
    v_mul_f32 v50, v50, v51
    s_nop 0
    v_mov_b32_dpp v46, v49 quad_perm:[1,0,3,2] row_mask:0xf bank_mask:0xf
    v_mov_b32_dpp v47, v50 quad_perm:[1,0,3,2] row_mask:0xf bank_mask:0xf
    v_cvt_pk_bf16_f32 v16, v49, v46
    v_cvt_pk_bf16_f32 v20, v50, v47
    s_nop 0
    v_mov_b32_dpp v17, v16 row_shl:2 row_mask:0xf bank_mask:0xf
    v_mov_b32_dpp v18, v16 row_shl:4 row_mask:0xf bank_mask:0xf
    v_mov_b32_dpp v19, v16 row_shl:6 row_mask:0xf bank_mask:0xf
    v_mov_b32_dpp v21, v20 row_shl:2 row_mask:0xf bank_mask:0xf
    v_mov_b32_dpp v22, v20 row_shl:4 row_mask:0xf bank_mask:0xf
    v_mov_b32_dpp v23, v20 row_shl:6 row_mask:0xf bank_mask:0xf
    s_mov_b64 exec, s[40:41]
    buffer_store_dwordx4 v[16:19], v7, s[8:11], s18 offen sc1
    s_mov_b64 exec, s[42:43]
    buffer_store_dwordx4 v[20:23], v8, s[8:11], s18 offen sc1
    s_mov_b64 exec, -1
    s_add_u32 s28, s14, 1
    s_min_u32 s28, s28, 63
    s_cmp_gt_u32 s47, s28
    s_cbranch_scc1 layerb1_kernel_p3_gw2_ok
layerb1_kernel_p3_gw2_lp:
    buffer_load_dword v253, v255, s[8:11], s48 offen sc1
    s_waitcnt vmcnt(0)
    v_readlane_b32 s47, v253, 0
    v_readlane_b32 s29, v253, 1
    s_nop 0
    s_min_u32 s47, s47, s29
    s_sub_u32 s15, s15, 1
    s_cbranch_scc1 layerb1_kernel_bail
    s_cmp_gt_u32 s47, s28
    s_cbranch_scc0 layerb1_kernel_p3_gw2_lp
layerb1_kernel_p3_gw2_ok:
    s_mul_i32 s20, s28, 393216
    s_add_u32 s20, s20, s44
    s_add_u32 s21, s20, 8192
    buffer_load_dwordx4 v[100:103], v9, s[8:11], s21 offen offset:0 sc1
    buffer_load_dwordx4 v[104:107], v9, s[8:11], s21 offen offset:512 sc1
    v_mov_b32 v56, 0
    v_mov_b32 v57, 0
    v_mov_b32 v58, 0
    v_mov_b32 v59, 0
    v_mov_b32 v60, 0
    v_mov_b32 v61, 0
    v_mov_b32 v62, 0
    v_mov_b32 v63, 0
    v_mov_b32 v64, 0
    v_mov_b32 v65, 0
    v_mov_b32 v66, 0
    v_mov_b32 v67, 0
    v_mov_b32 v68, 0
    v_mov_b32 v69, 0
    v_mov_b32 v70, 0
    v_mov_b32 v71, 0
    v_mov_b32 v72, 0
    v_mov_b32 v73, 0
    v_mov_b32 v74, 0
    v_mov_b32 v75, 0
    v_mov_b32 v76, 0
    v_mov_b32 v77, 0
    v_mov_b32 v78, 0
    v_mov_b32 v79, 0
    v_mov_b32 v80, 0
    v_mov_b32 v81, 0
    v_mov_b32 v82, 0
    v_mov_b32 v83, 0
    v_mov_b32 v84, 0
    v_mov_b32 v85, 0
    v_mov_b32 v86, 0
    v_mov_b32 v87, 0
    s_lshl_b32 s20, s12, 7
    s_add_u32 s20, s20, 16384
    s_mov_b64 exec, 1
    v_mov_b32 v253, s20
    v_mov_b32 v254, s14
    buffer_store_dword v254, v253, s[8:11], s48 offen sc1
    s_mov_b64 exec, -1
    ds_read_b128 v[116:119], v13 offset:0
    ds_read_b128 v[120:123], v13 offset:1024
    ds_read_b128 v[124:127], v13 offset:2048
    ds_read_b128 v[128:131], v13 offset:3072
    ds_read_b128 v[132:135], v13 offset:4096
    ds_read_b128 v[136:139], v13 offset:5120
    ds_read_b128 v[140:143], v13 offset:6144
    ds_read_b128 v[144:147], v13 offset:7168
    s_waitcnt lgkmcnt(0)
    s_add_u32 s14, s14, 1
    s_cmp_lt_u32 s14, 64
    s_cbranch_scc1 layerb1_kernel_p3_step
    s_waitcnt vmcnt(0)
    s_barrier
    s_lshl_b32 s20, s12, 7
    s_add_u32 s20, s20, 16384
    s_mov_b64 exec, 1
    v_mov_b32 v253, s20
    v_mov_b32 v254, s14
    buffer_store_dword v254, v253, s[8:11], s48 offen sc1
    s_mov_b64 exec, -1
    s_branch layerb1_kernel_end
layerb1_kernel_y0_start:
    v_lshrrev_b32 v16, 4, v0
    v_and_b32 v17, 7, v0
    v_lshrrev_b32 v18, 3, v0
    v_and_b32 v18, 1, v18
    v_lshl_add_u32 v19, v18, 2, v16
    v_add_u32 v19, 0, v19
    v_mul_u32_u24 v20, 640, v19
    v_lshl_add_u32 v4, v17, 4, v20
    v_and_b32 v20, 3, v17
    v_lshlrev_b32 v20, 1, v20
    v_lshrrev_b32 v21, 2, v17
    v_add_u32 v20, v20, v21
    v_lshlrev_b32 v20, 4, v20
    v_lshl_add_u32 v5, v19, 7, v20
    v_add_u32 v3, 0, v1
    v_lshrrev_b32 v20, 1, v17
    v_lshlrev_b32 v20, 7, v20
    v_and_b32 v21, 1, v17
    v_lshl_add_u32 v20, v21, 2, v20
    v_add_u32 v10, 0, v20
    v_lshlrev_b32 v20, 8, v18
    v_lshl_add_u32 v20, v17, 5, v20
    v_and_b32 v21, 1, v16
    v_lshl_add_u32 v20, v21, 4, v20
    v_add_u32 v20, 10240, v20
    v_add_u32 v21, 12288, v1
    v_lshrrev_b32 v22, 1, v16
    v_cmp_eq_u32 vcc, v22, v18
    s_nop 1
    v_cndmask_b32 v6, v21, v20, vcc
    v_lshrrev_b32 v20, 3, v0
    v_lshlrev_b32 v20, 2, v20
    v_lshl_add_u32 v20, v17, 5, v20
    v_add_u32 v7, 10240, v20
    s_lshl_b32 s20, s12, 7
    s_add_u32 s20, s20, 20480
    s_lshr_b32 s21, s20, 13
    s_lshl_b32 s21, s21, 14
    s_and_b32 s20, s20, 8191
    s_add_u32 s20, s20, s21
    v_lshrrev_b32 v20, 3, v0
    v_lshlrev_b32 v20, 4, v20
    v_add_u32 v8, s20, v20
    s_mul_i32 s46, s12, 20480
    s_add_u32 s46, s46, 103809024
    s_mul_i32 s20, s12, 327680
    s_add_u32 s20, s20, 27262976
    s_add_u32 s21, s20, 0
    buffer_load_dwordx4 a[0:3], v1, s[8:11], s21 offen offset:0
    buffer_load_dwordx4 a[4:7], v1, s[8:11], s21 offen offset:1024
    s_add_u32 s21, s20, 2048
    buffer_load_dwordx4 a[8:11], v1, s[8:11], s21 offen offset:0
    buffer_load_dwordx4 a[12:15], v1, s[8:11], s21 offen offset:1024
    s_add_u32 s21, s20, 4096
    buffer_load_dwordx4 a[16:19], v1, s[8:11], s21 offen offset:0
    buffer_load_dwordx4 a[20:23], v1, s[8:11], s21 offen offset:1024
    s_add_u32 s21, s20, 6144
    buffer_load_dwordx4 a[24:27], v1, s[8:11], s21 offen offset:0
    buffer_load_dwordx4 a[28:31], v1, s[8:11], s21 offen offset:1024
    s_add_u32 s21, s20, 8192
    buffer_load_dwordx4 a[32:35], v1, s[8:11], s21 offen offset:0
    buffer_load_dwordx4 a[36:39], v1, s[8:11], s21 offen offset:1024
    s_add_u32 s21, s20, 10240
    buffer_load_dwordx4 a[40:43], v1, s[8:11], s21 offen offset:0
    buffer_load_dwordx4 a[44:47], v1, s[8:11], s21 offen offset:1024
    s_add_u32 s21, s20, 12288
    buffer_load_dwordx4 a[48:51], v1, s[8:11], s21 offen offset:0
    buffer_load_dwordx4 a[52:55], v1, s[8:11], s21 offen offset:1024
    s_add_u32 s21, s20, 14336
    buffer_load_dwordx4 a[56:59], v1, s[8:11], s21 offen offset:0
    buffer_load_dwordx4 a[60:63], v1, s[8:11], s21 offen offset:1024
    s_add_u32 s21, s20, 16384
    buffer_load_dwordx4 a[64:67], v1, s[8:11], s21 offen offset:0
    buffer_load_dwordx4 a[68:71], v1, s[8:11], s21 offen offset:1024
    s_add_u32 s21, s20, 18432
    buffer_load_dwordx4 a[72:75], v1, s[8:11], s21 offen offset:0
    buffer_load_dwordx4 a[76:79], v1, s[8:11], s21 offen offset:1024
    s_add_u32 s21, s20, 20480
    buffer_load_dwordx4 a[80:83], v1, s[8:11], s21 offen offset:0
    buffer_load_dwordx4 a[84:87], v1, s[8:11], s21 offen offset:1024
    s_add_u32 s21, s20, 22528
    buffer_load_dwordx4 a[88:91], v1, s[8:11], s21 offen offset:0
    buffer_load_dwordx4 a[92:95], v1, s[8:11], s21 offen offset:1024
    s_add_u32 s21, s20, 24576
    buffer_load_dwordx4 a[96:99], v1, s[8:11], s21 offen offset:0
    buffer_load_dwordx4 a[100:103], v1, s[8:11], s21 offen offset:1024
    s_add_u32 s21, s20, 26624
    buffer_load_dwordx4 a[104:107], v1, s[8:11], s21 offen offset:0
    buffer_load_dwordx4 a[108:111], v1, s[8:11], s21 offen offset:1024
    s_add_u32 s21, s20, 28672
    buffer_load_dwordx4 a[112:115], v1, s[8:11], s21 offen offset:0
    buffer_load_dwordx4 a[116:119], v1, s[8:11], s21 offen offset:1024
    s_add_u32 s21, s20, 30720
    buffer_load_dwordx4 a[120:123], v1, s[8:11], s21 offen offset:0
    buffer_load_dwordx4 a[124:127], v1, s[8:11], s21 offen offset:1024
    s_add_u32 s21, s20, 32768
    buffer_load_dwordx4 a[128:131], v1, s[8:11], s21 offen offset:0
    buffer_load_dwordx4 a[132:135], v1, s[8:11], s21 offen offset:1024
    s_add_u32 s21, s20, 34816
    buffer_load_dwordx4 a[136:139], v1, s[8:11], s21 offen offset:0
    buffer_load_dwordx4 a[140:143], v1, s[8:11], s21 offen offset:1024
    s_add_u32 s21, s20, 36864
    buffer_load_dwordx4 a[144:147], v1, s[8:11], s21 offen offset:0
    buffer_load_dwordx4 a[148:151], v1, s[8:11], s21 offen offset:1024
    s_add_u32 s21, s20, 38912
    buffer_load_dwordx4 a[152:155], v1, s[8:11], s21 offen offset:0
    buffer_load_dwordx4 a[156:159], v1, s[8:11], s21 offen offset:1024
    s_add_u32 s21, s20, 40960
    buffer_load_dwordx4 a[160:163], v1, s[8:11], s21 offen offset:0
    buffer_load_dwordx4 a[164:167], v1, s[8:11], s21 offen offset:1024
    s_add_u32 s21, s20, 43008
    buffer_load_dwordx4 a[168:171], v1, s[8:11], s21 offen offset:0
    buffer_load_dwordx4 a[172:175], v1, s[8:11], s21 offen offset:1024
    s_add_u32 s21, s20, 45056
    buffer_load_dwordx4 a[176:179], v1, s[8:11], s21 offen offset:0
    buffer_load_dwordx4 a[180:183], v1, s[8:11], s21 offen offset:1024
    s_add_u32 s21, s20, 47104
    buffer_load_dwordx4 a[184:187], v1, s[8:11], s21 offen offset:0
    buffer_load_dwordx4 a[188:191], v1, s[8:11], s21 offen offset:1024
    s_add_u32 s21, s20, 49152
    buffer_load_dwordx4 a[192:195], v1, s[8:11], s21 offen offset:0
    buffer_load_dwordx4 a[196:199], v1, s[8:11], s21 offen offset:1024
    s_add_u32 s21, s20, 51200
    buffer_load_dwordx4 a[200:203], v1, s[8:11], s21 offen offset:0
    buffer_load_dwordx4 a[204:207], v1, s[8:11], s21 offen offset:1024
    s_add_u32 s21, s20, 53248
    buffer_load_dwordx4 a[208:211], v1, s[8:11], s21 offen offset:0
    buffer_load_dwordx4 a[212:215], v1, s[8:11], s21 offen offset:1024
    s_add_u32 s21, s20, 55296
    buffer_load_dwordx4 a[216:219], v1, s[8:11], s21 offen offset:0
    buffer_load_dwordx4 a[220:223], v1, s[8:11], s21 offen offset:1024
    s_add_u32 s21, s20, 57344
    buffer_load_dwordx4 a[224:227], v1, s[8:11], s21 offen offset:0
    buffer_load_dwordx4 a[228:231], v1, s[8:11], s21 offen offset:1024
    s_add_u32 s21, s20, 59392
    buffer_load_dwordx4 a[232:235], v1, s[8:11], s21 offen offset:0
    buffer_load_dwordx4 a[236:239], v1, s[8:11], s21 offen offset:1024
    s_add_u32 s21, s20, 61440
    buffer_load_dwordx4 a[240:243], v1, s[8:11], s21 offen offset:0
    buffer_load_dwordx4 a[244:247], v1, s[8:11], s21 offen offset:1024
    s_add_u32 s21, s20, 63488
    buffer_load_dwordx4 a[248:251], v1, s[8:11], s21 offen offset:0
    buffer_load_dwordx4 a[252:255], v1, s[8:11], s21 offen offset:1024
    s_add_u32 s21, s20, 65536
    buffer_load_dwordx4 v[176:179], v1, s[8:11], s21 offen offset:0
    buffer_load_dwordx4 v[180:183], v1, s[8:11], s21 offen offset:1024
    s_add_u32 s21, s20, 67584
    buffer_load_dwordx4 v[184:187], v1, s[8:11], s21 offen offset:0
    buffer_load_dwordx4 v[188:191], v1, s[8:11], s21 offen offset:1024
    s_add_u32 s21, s20, 69632
    buffer_load_dwordx4 v[192:195], v1, s[8:11], s21 offen offset:0
    buffer_load_dwordx4 v[196:199], v1, s[8:11], s21 offen offset:1024
    s_add_u32 s21, s20, 71680
    buffer_load_dwordx4 v[200:203], v1, s[8:11], s21 offen offset:0
    buffer_load_dwordx4 v[204:207], v1, s[8:11], s21 offen offset:1024
    s_add_u32 s21, s20, 73728
    buffer_load_dwordx4 v[208:211], v1, s[8:11], s21 offen offset:0
    buffer_load_dwordx4 v[212:215], v1, s[8:11], s21 offen offset:1024
    s_add_u32 s21, s20, 75776
    buffer_load_dwordx4 v[216:219], v1, s[8:11], s21 offen offset:0
    buffer_load_dwordx4 v[220:223], v1, s[8:11], s21 offen offset:1024
    s_add_u32 s21, s20, 77824
    buffer_load_dwordx4 v[224:227], v1, s[8:11], s21 offen offset:0
    buffer_load_dwordx4 v[228:231], v1, s[8:11], s21 offen offset:1024
    s_add_u32 s21, s20, 79872
    buffer_load_dwordx4 v[232:235], v1, s[8:11], s21 offen offset:0
    buffer_load_dwordx4 v[236:239], v1, s[8:11], s21 offen offset:1024
    s_mov_b32 s14, 0
    s_lshl_b32 s20, s12, 7
    v_mov_b32 v9, s20
    s_mov_b32 s47, 0
layerb1_kernel_y0_step:
    s_cmp_lt_u32 s14, 32
    s_cselect_b32 s18, s16, s17
    s_and_b32 s20, s14, 31
    s_lshl_b32 s20, s20, 16
    s_add_u32 s18, s18, s20
    s_mul_i32 s28, s14, 1638400
    s_add_u32 s28, s28, s46
    v_mov_b32 v56, 0
    v_mov_b32 v57, 0
    v_mov_b32 v58, 0
    v_mov_b32 v59, 0
    v_mov_b32 v60, 0
    v_mov_b32 v61, 0
    v_mov_b32 v62, 0
    v_mov_b32 v63, 0
    v_mov_b32 v64, 0
    v_mov_b32 v65, 0
    v_mov_b32 v66, 0
    v_mov_b32 v67, 0
    v_mov_b32 v68, 0
    v_mov_b32 v69, 0
    v_mov_b32 v70, 0
    v_mov_b32 v71, 0
    s_add_u32 s22, s18, 36864
    s_add_u32 s23, s18, 37888
    s_add_u32 s24, s18, 38912
layerb1_kernel_y0_poll:
    buffer_load_dwordx4 v[16:19], v1, s[8:11], s22 offen sc1
    buffer_load_dwordx4 v[20:23], v1, s[8:11], s23 offen sc1
    buffer_load_dwordx4 v[24:27], v1, s[8:11], s24 offen sc1
    s_waitcnt vmcnt(0)
    ds_write_b128 v3, v[16:19] offset:0
    ds_write_b128 v3, v[20:23] offset:1024
    ds_write_b128 v3, v[24:27] offset:2048
    v_max3_u32 v116, v16, v17, v18
    v_max3_u32 v116, v116, v19, v20
    v_max3_u32 v116, v116, v21, v22
    v_max3_u32 v116, v116, v23, v24
    v_max3_u32 v116, v116, v25, v26
    v_max_u32 v116, v116, v27
    v_cmp_eq_u32 vcc, -1, v116
    s_sub_u32 s15, s15, 1
    s_cbranch_scc1 layerb1_kernel_bail
    s_cbranch_vccnz layerb1_kernel_y0_poll
    s_waitcnt lgkmcnt(0)
    s_barrier
    ds_read_b128 v[28:31], v3 offset:3072
    ds_read_b128 v[32:35], v3 offset:4096
    ds_read_b128 v[36:39], v3 offset:5120
    ds_read_b128 v[40:43], v3 offset:6144
    ds_read_b128 v[44:47], v3 offset:7168
    ds_read_b128 v[48:51], v3 offset:8192
    ds_read_b128 v[52:55], v3 offset:9216
    s_cmp_gt_u32 s47, s14
    s_cbranch_scc1 layerb1_kernel_y0_gw_ok
layerb1_kernel_y0_gw_lp:
    buffer_load_dword v116, v9, s[8:11], s48 offen sc1
    s_waitcnt vmcnt(0)
    v_readlane_b32 s47, v116, 0
    s_nop 0
    s_sub_u32 s15, s15, 1
    s_cbranch_scc1 layerb1_kernel_bail
    s_cmp_gt_u32 s47, s14
    s_cbranch_scc0 layerb1_kernel_y0_gw_lp
layerb1_kernel_y0_gw_ok:
    buffer_load_dwordx4 v[76:79], v4, s[8:11], s28 offen offset:128 sc1
    buffer_load_dwordx4 v[80:83], v4, s[8:11], s28 offen offset:256 sc1
    buffer_load_dwordx4 v[84:87], v4, s[8:11], s28 offen offset:384 sc1
    buffer_load_dwordx4 v[88:91], v4, s[8:11], s28 offen offset:512 sc1
    v_smfmac_f32_16x16x64_bf16 v[56:59], v[16:19], a[0:7], v2
    v_smfmac_f32_16x16x64_bf16 v[60:63], v[16:19], a[80:87], v2
    v_smfmac_f32_16x16x64_bf16 v[64:67], v[16:19], a[160:167], v2
    v_smfmac_f32_16x16x64_bf16 v[68:71], v[16:19], a[240:247], v2
    v_smfmac_f32_16x16x64_bf16 v[56:59], v[20:23], a[8:15], v2
    v_smfmac_f32_16x16x64_bf16 v[60:63], v[20:23], a[88:95], v2
    v_smfmac_f32_16x16x64_bf16 v[64:67], v[20:23], a[168:175], v2
    v_smfmac_f32_16x16x64_bf16 v[68:71], v[20:23], a[248:255], v2
    v_smfmac_f32_16x16x64_bf16 v[56:59], v[24:27], a[16:23], v2
    v_smfmac_f32_16x16x64_bf16 v[60:63], v[24:27], a[96:103], v2
    v_smfmac_f32_16x16x64_bf16 v[64:67], v[24:27], a[176:183], v2
    v_smfmac_f32_16x16x64_bf16 v[68:71], v[24:27], v[176:183], v2
    s_waitcnt lgkmcnt(6)
    v_smfmac_f32_16x16x64_bf16 v[56:59], v[28:31], a[24:31], v2
    v_smfmac_f32_16x16x64_bf16 v[60:63], v[28:31], a[104:111], v2
    v_smfmac_f32_16x16x64_bf16 v[64:67], v[28:31], a[184:191], v2
    v_smfmac_f32_16x16x64_bf16 v[68:71], v[28:31], v[184:191], v2
    s_waitcnt lgkmcnt(5)
    v_smfmac_f32_16x16x64_bf16 v[56:59], v[32:35], a[32:39], v2
    v_smfmac_f32_16x16x64_bf16 v[60:63], v[32:35], a[112:119], v2
    v_smfmac_f32_16x16x64_bf16 v[64:67], v[32:35], a[192:199], v2
    v_smfmac_f32_16x16x64_bf16 v[68:71], v[32:35], v[192:199], v2
    s_waitcnt lgkmcnt(4)
    v_smfmac_f32_16x16x64_bf16 v[56:59], v[36:39], a[40:47], v2
    v_smfmac_f32_16x16x64_bf16 v[60:63], v[36:39], a[120:127], v2
    v_smfmac_f32_16x16x64_bf16 v[64:67], v[36:39], a[200:207], v2
    v_smfmac_f32_16x16x64_bf16 v[68:71], v[36:39], v[200:207], v2
    s_waitcnt lgkmcnt(3)
    v_smfmac_f32_16x16x64_bf16 v[56:59], v[40:43], a[48:55], v2
    v_smfmac_f32_16x16x64_bf16 v[60:63], v[40:43], a[128:135], v2
    v_smfmac_f32_16x16x64_bf16 v[64:67], v[40:43], a[208:215], v2
    v_smfmac_f32_16x16x64_bf16 v[68:71], v[40:43], v[208:215], v2
    s_waitcnt lgkmcnt(2)
    v_smfmac_f32_16x16x64_bf16 v[56:59], v[44:47], a[56:63], v2
    v_smfmac_f32_16x16x64_bf16 v[60:63], v[44:47], a[136:143], v2
    v_smfmac_f32_16x16x64_bf16 v[64:67], v[44:47], a[216:223], v2
    v_smfmac_f32_16x16x64_bf16 v[68:71], v[44:47], v[216:223], v2
    s_waitcnt lgkmcnt(1)
    v_smfmac_f32_16x16x64_bf16 v[56:59], v[48:51], a[64:71], v2
    v_smfmac_f32_16x16x64_bf16 v[60:63], v[48:51], a[144:151], v2
    v_smfmac_f32_16x16x64_bf16 v[64:67], v[48:51], a[224:231], v2
    v_smfmac_f32_16x16x64_bf16 v[68:71], v[48:51], v[224:231], v2
    s_waitcnt lgkmcnt(0)
    v_smfmac_f32_16x16x64_bf16 v[56:59], v[52:55], a[72:79], v2
    v_smfmac_f32_16x16x64_bf16 v[60:63], v[52:55], a[152:159], v2
    v_smfmac_f32_16x16x64_bf16 v[64:67], v[52:55], a[232:239], v2
    v_smfmac_f32_16x16x64_bf16 v[68:71], v[52:55], v[232:239], v2
    s_nop 7
    v_permlane32_swap_b32 v56, v64
    v_permlane32_swap_b32 v60, v68
    v_permlane32_swap_b32 v57, v65
    v_permlane32_swap_b32 v61, v69
    v_permlane32_swap_b32 v58, v66
    v_permlane32_swap_b32 v62, v70
    v_permlane32_swap_b32 v59, v67
    v_permlane32_swap_b32 v63, v71
    v_add_f32 v56, v56, v64
    v_add_f32 v60, v60, v68
    v_add_f32 v57, v57, v65
    v_add_f32 v61, v61, v69
    v_add_f32 v58, v58, v66
    v_add_f32 v62, v62, v70
    v_add_f32 v59, v59, v67
    v_add_f32 v63, v63, v71
    s_nop 1
    v_permlane16_swap_b32 v56, v60
    v_permlane16_swap_b32 v57, v61
    v_permlane16_swap_b32 v58, v62
    v_permlane16_swap_b32 v59, v63
    s_nop 1
    v_cvt_pk_bf16_f32 v72, v56, v57
    v_cvt_pk_bf16_f32 v73, v58, v59
    v_cvt_pk_bf16_f32 v74, v60, v61
    v_cvt_pk_bf16_f32 v75, v62, v63
    buffer_store_dwordx4 v[72:75], v4, s[8:11], s28 offen sc1
    s_cmp_eq_u32 s14, 63
    s_cbranch_scc1 layerb1_kernel_y0_last
    s_add_u32 s30, s18, 0
    s_add_u32 s31, s18, 4096
    s_add_u32 s32, s18, 16384
    s_add_u32 s33, s18, 20480
    s_add_u32 s34, s18, 32768
    s_add_u32 s29, s14, 1
    s_cmp_lt_u32 s29, 32
    s_cselect_b32 s19, s16, s17
    s_and_b32 s20, s29, 31
    s_lshl_b32 s20, s20, 16
    s_add_u32 s19, s19, s20
layerb1_kernel_y0_ppoll:
    buffer_load_dwordx4 v[92:95], v5, s[8:11], s30 offen sc1
    buffer_load_dwordx4 v[96:99], v5, s[8:11], s31 offen sc1
    buffer_load_dwordx4 v[100:103], v5, s[8:11], s32 offen sc1
    buffer_load_dwordx4 v[104:107], v5, s[8:11], s33 offen sc1
    buffer_load_dwordx4 v[108:111], v5, s[8:11], s34 offen sc1
    s_waitcnt vmcnt(0)
    v_mfma_f32_16x16x32_bf16 v[112:115], v[92:95], v[72:75], 0
    v_mfma_f32_16x16x32_bf16 v[112:115], v[96:99], v[76:79], v[112:115]
    v_mfma_f32_16x16x32_bf16 v[112:115], v[100:103], v[80:83], v[112:115]
    v_mfma_f32_16x16x32_bf16 v[112:115], v[104:107], v[84:87], v[112:115]
    v_mfma_f32_16x16x32_bf16 v[112:115], v[108:111], v[88:91], v[112:115]
    v_max3_u32 v116, v92, v93, v94
    v_max3_u32 v116, v116, v95, v96
    v_max3_u32 v116, v116, v97, v98
    v_max3_u32 v116, v116, v99, v100
    v_max3_u32 v116, v116, v101, v102
    v_max3_u32 v116, v116, v103, v104
    v_max3_u32 v116, v116, v105, v106
    v_max3_u32 v116, v116, v107, v108
    v_max3_u32 v116, v116, v109, v110
    v_max_u32 v116, v116, v111
    v_cmp_eq_u32 vcc, -1, v116
    s_sub_u32 s15, s15, 1
    s_cbranch_scc1 layerb1_kernel_bail
    s_cbranch_vccnz layerb1_kernel_y0_ppoll
    ds_write_b128 v6, v[112:115]
    s_waitcnt lgkmcnt(0)
    s_barrier
    ds_read2st64_b32 v[116:117], v7 offset0:0 offset1:1
    ds_read2st64_b32 v[118:119], v7 offset0:2 offset1:3
    ds_read2st64_b32 v[120:121], v7 offset0:4 offset1:5
    ds_read2st64_b32 v[122:123], v7 offset0:6 offset1:7
    s_waitcnt lgkmcnt(2)
    v_add_f32 v116, v116, v117
    v_add_f32 v118, v118, v119
    s_waitcnt lgkmcnt(0)
    v_add_f32 v120, v120, v121
    v_add_f32 v122, v122, v123
    v_add_f32 v116, v116, v118
    v_add_f32 v120, v120, v122
    v_add_f32 v116, v116, v120
    s_nop 1
    v_mov_b32_dpp v117, v116 quad_perm:[1,0,3,2] row_mask:0xf bank_mask:0xf
    v_cvt_pk_bf16_f32 v124, v116, v117
    s_nop 1
    v_mov_b32_dpp v125, v124 row_shl:2 row_mask:0xf bank_mask:0xf
    v_mov_b32_dpp v126, v124 row_shl:4 row_mask:0xf bank_mask:0xf
    v_mov_b32_dpp v127, v124 row_shl:6 row_mask:0xf bank_mask:0xf
    s_mov_b64 exec, s[40:41]
    buffer_store_dwordx4 v[124:127], v8, s[8:11], s19 offen sc1
    s_mov_b64 exec, -1
    s_lshl_b32 s20, s12, 7
    s_add_u32 s20, s20, 20480
    s_mov_b64 exec, 1
    v_mov_b32 v116, s20
    v_mov_b32 v117, s29
    buffer_store_dword v117, v116, s[8:11], s48 offen sc1
    s_mov_b64 exec, -1
    s_waitcnt vmcnt(0)
    s_barrier
    s_add_u32 s14, s14, 1
    s_branch layerb1_kernel_y0_step
layerb1_kernel_y0_last:
    s_waitcnt vmcnt(0)
    s_barrier
    s_lshl_b32 s20, s12, 7
    s_add_u32 s20, s20, 20480
    s_mov_b32 s29, 64
    s_mov_b64 exec, 1
    v_mov_b32 v116, s20
    v_mov_b32 v117, s29
    buffer_store_dword v117, v116, s[8:11], s48 offen sc1
    s_mov_b64 exec, -1
    s_branch layerb1_kernel_end
layerb1_kernel_y1_start:
    v_lshrrev_b32 v16, 4, v0
    v_and_b32 v17, 7, v0
    v_lshrrev_b32 v18, 3, v0
    v_and_b32 v18, 1, v18
    v_lshl_add_u32 v19, v18, 2, v16
    v_add_u32 v19, 8, v19
    v_mul_u32_u24 v20, 640, v19
    v_lshl_add_u32 v4, v17, 4, v20
    v_and_b32 v20, 3, v17
    v_lshlrev_b32 v20, 1, v20
    v_lshrrev_b32 v21, 2, v17
    v_add_u32 v20, v20, v21
    v_lshlrev_b32 v20, 4, v20
    v_lshl_add_u32 v5, v19, 7, v20
    v_add_u32 v3, 0, v1
    v_lshrrev_b32 v20, 1, v17
    v_lshlrev_b32 v20, 7, v20
    v_and_b32 v21, 1, v17
    v_lshl_add_u32 v20, v21, 2, v20
    v_add_u32 v10, 512, v20
    v_lshlrev_b32 v20, 8, v18
    v_lshl_add_u32 v20, v17, 5, v20
    v_and_b32 v21, 1, v16
    v_lshl_add_u32 v20, v21, 4, v20
    v_add_u32 v20, 10752, v20
    v_add_u32 v21, 12288, v1
    v_lshrrev_b32 v22, 1, v16
    v_cmp_eq_u32 vcc, v22, v18
    s_nop 1
    v_cndmask_b32 v6, v21, v20, vcc
    v_lshrrev_b32 v20, 3, v0
    v_lshlrev_b32 v20, 2, v20
    v_lshl_add_u32 v20, v17, 5, v20
    v_add_u32 v7, 10240, v20
    s_lshl_b32 s20, s12, 7
    s_add_u32 s20, s20, 20480
    s_lshr_b32 s21, s20, 13
    s_lshl_b32 s21, s21, 14
    s_and_b32 s20, s20, 8191
    s_add_u32 s20, s20, s21
    v_lshrrev_b32 v20, 3, v0
    v_lshlrev_b32 v20, 4, v20
    v_add_u32 v8, s20, v20
    s_mul_i32 s46, s12, 20480
    s_add_u32 s46, s46, 103809024
    s_mul_i32 s20, s12, 327680
    s_add_u32 s20, s20, 27344896
    s_add_u32 s21, s20, 0
    buffer_load_dwordx4 a[0:3], v1, s[8:11], s21 offen offset:0
    buffer_load_dwordx4 a[4:7], v1, s[8:11], s21 offen offset:1024
    s_add_u32 s21, s20, 2048
    buffer_load_dwordx4 a[8:11], v1, s[8:11], s21 offen offset:0
    buffer_load_dwordx4 a[12:15], v1, s[8:11], s21 offen offset:1024
    s_add_u32 s21, s20, 4096
    buffer_load_dwordx4 a[16:19], v1, s[8:11], s21 offen offset:0
    buffer_load_dwordx4 a[20:23], v1, s[8:11], s21 offen offset:1024
    s_add_u32 s21, s20, 6144
    buffer_load_dwordx4 a[24:27], v1, s[8:11], s21 offen offset:0
    buffer_load_dwordx4 a[28:31], v1, s[8:11], s21 offen offset:1024
    s_add_u32 s21, s20, 8192
    buffer_load_dwordx4 a[32:35], v1, s[8:11], s21 offen offset:0
    buffer_load_dwordx4 a[36:39], v1, s[8:11], s21 offen offset:1024
    s_add_u32 s21, s20, 10240
    buffer_load_dwordx4 a[40:43], v1, s[8:11], s21 offen offset:0
    buffer_load_dwordx4 a[44:47], v1, s[8:11], s21 offen offset:1024
    s_add_u32 s21, s20, 12288
    buffer_load_dwordx4 a[48:51], v1, s[8:11], s21 offen offset:0
    buffer_load_dwordx4 a[52:55], v1, s[8:11], s21 offen offset:1024
    s_add_u32 s21, s20, 14336
    buffer_load_dwordx4 a[56:59], v1, s[8:11], s21 offen offset:0
    buffer_load_dwordx4 a[60:63], v1, s[8:11], s21 offen offset:1024
    s_add_u32 s21, s20, 16384
    buffer_load_dwordx4 a[64:67], v1, s[8:11], s21 offen offset:0
    buffer_load_dwordx4 a[68:71], v1, s[8:11], s21 offen offset:1024
    s_add_u32 s21, s20, 18432
    buffer_load_dwordx4 a[72:75], v1, s[8:11], s21 offen offset:0
    buffer_load_dwordx4 a[76:79], v1, s[8:11], s21 offen offset:1024
    s_add_u32 s21, s20, 20480
    buffer_load_dwordx4 a[80:83], v1, s[8:11], s21 offen offset:0
    buffer_load_dwordx4 a[84:87], v1, s[8:11], s21 offen offset:1024
    s_add_u32 s21, s20, 22528
    buffer_load_dwordx4 a[88:91], v1, s[8:11], s21 offen offset:0
    buffer_load_dwordx4 a[92:95], v1, s[8:11], s21 offen offset:1024
    s_add_u32 s21, s20, 24576
    buffer_load_dwordx4 a[96:99], v1, s[8:11], s21 offen offset:0
    buffer_load_dwordx4 a[100:103], v1, s[8:11], s21 offen offset:1024
    s_add_u32 s21, s20, 26624
    buffer_load_dwordx4 a[104:107], v1, s[8:11], s21 offen offset:0
    buffer_load_dwordx4 a[108:111], v1, s[8:11], s21 offen offset:1024
    s_add_u32 s21, s20, 28672
    buffer_load_dwordx4 a[112:115], v1, s[8:11], s21 offen offset:0
    buffer_load_dwordx4 a[116:119], v1, s[8:11], s21 offen offset:1024
    s_add_u32 s21, s20, 30720
    buffer_load_dwordx4 a[120:123], v1, s[8:11], s21 offen offset:0
    buffer_load_dwordx4 a[124:127], v1, s[8:11], s21 offen offset:1024
    s_add_u32 s21, s20, 32768
    buffer_load_dwordx4 a[128:131], v1, s[8:11], s21 offen offset:0
    buffer_load_dwordx4 a[132:135], v1, s[8:11], s21 offen offset:1024
    s_add_u32 s21, s20, 34816
    buffer_load_dwordx4 a[136:139], v1, s[8:11], s21 offen offset:0
    buffer_load_dwordx4 a[140:143], v1, s[8:11], s21 offen offset:1024
    s_add_u32 s21, s20, 36864
    buffer_load_dwordx4 a[144:147], v1, s[8:11], s21 offen offset:0
    buffer_load_dwordx4 a[148:151], v1, s[8:11], s21 offen offset:1024
    s_add_u32 s21, s20, 38912
    buffer_load_dwordx4 a[152:155], v1, s[8:11], s21 offen offset:0
    buffer_load_dwordx4 a[156:159], v1, s[8:11], s21 offen offset:1024
    s_add_u32 s21, s20, 40960
    buffer_load_dwordx4 a[160:163], v1, s[8:11], s21 offen offset:0
    buffer_load_dwordx4 a[164:167], v1, s[8:11], s21 offen offset:1024
    s_add_u32 s21, s20, 43008
    buffer_load_dwordx4 a[168:171], v1, s[8:11], s21 offen offset:0
    buffer_load_dwordx4 a[172:175], v1, s[8:11], s21 offen offset:1024
    s_add_u32 s21, s20, 45056
    buffer_load_dwordx4 a[176:179], v1, s[8:11], s21 offen offset:0
    buffer_load_dwordx4 a[180:183], v1, s[8:11], s21 offen offset:1024
    s_add_u32 s21, s20, 47104
    buffer_load_dwordx4 a[184:187], v1, s[8:11], s21 offen offset:0
    buffer_load_dwordx4 a[188:191], v1, s[8:11], s21 offen offset:1024
    s_add_u32 s21, s20, 49152
    buffer_load_dwordx4 a[192:195], v1, s[8:11], s21 offen offset:0
    buffer_load_dwordx4 a[196:199], v1, s[8:11], s21 offen offset:1024
    s_add_u32 s21, s20, 51200
    buffer_load_dwordx4 a[200:203], v1, s[8:11], s21 offen offset:0
    buffer_load_dwordx4 a[204:207], v1, s[8:11], s21 offen offset:1024
    s_add_u32 s21, s20, 53248
    buffer_load_dwordx4 a[208:211], v1, s[8:11], s21 offen offset:0
    buffer_load_dwordx4 a[212:215], v1, s[8:11], s21 offen offset:1024
    s_add_u32 s21, s20, 55296
    buffer_load_dwordx4 a[216:219], v1, s[8:11], s21 offen offset:0
    buffer_load_dwordx4 a[220:223], v1, s[8:11], s21 offen offset:1024
    s_add_u32 s21, s20, 57344
    buffer_load_dwordx4 a[224:227], v1, s[8:11], s21 offen offset:0
    buffer_load_dwordx4 a[228:231], v1, s[8:11], s21 offen offset:1024
    s_add_u32 s21, s20, 59392
    buffer_load_dwordx4 a[232:235], v1, s[8:11], s21 offen offset:0
    buffer_load_dwordx4 a[236:239], v1, s[8:11], s21 offen offset:1024
    s_add_u32 s21, s20, 61440
    buffer_load_dwordx4 a[240:243], v1, s[8:11], s21 offen offset:0
    buffer_load_dwordx4 a[244:247], v1, s[8:11], s21 offen offset:1024
    s_add_u32 s21, s20, 63488
    buffer_load_dwordx4 a[248:251], v1, s[8:11], s21 offen offset:0
    buffer_load_dwordx4 a[252:255], v1, s[8:11], s21 offen offset:1024
    s_add_u32 s21, s20, 65536
    buffer_load_dwordx4 v[176:179], v1, s[8:11], s21 offen offset:0
    buffer_load_dwordx4 v[180:183], v1, s[8:11], s21 offen offset:1024
    s_add_u32 s21, s20, 67584
    buffer_load_dwordx4 v[184:187], v1, s[8:11], s21 offen offset:0
    buffer_load_dwordx4 v[188:191], v1, s[8:11], s21 offen offset:1024
    s_add_u32 s21, s20, 69632
    buffer_load_dwordx4 v[192:195], v1, s[8:11], s21 offen offset:0
    buffer_load_dwordx4 v[196:199], v1, s[8:11], s21 offen offset:1024
    s_add_u32 s21, s20, 71680
    buffer_load_dwordx4 v[200:203], v1, s[8:11], s21 offen offset:0
    buffer_load_dwordx4 v[204:207], v1, s[8:11], s21 offen offset:1024
    s_add_u32 s21, s20, 73728
    buffer_load_dwordx4 v[208:211], v1, s[8:11], s21 offen offset:0
    buffer_load_dwordx4 v[212:215], v1, s[8:11], s21 offen offset:1024
    s_add_u32 s21, s20, 75776
    buffer_load_dwordx4 v[216:219], v1, s[8:11], s21 offen offset:0
    buffer_load_dwordx4 v[220:223], v1, s[8:11], s21 offen offset:1024
    s_add_u32 s21, s20, 77824
    buffer_load_dwordx4 v[224:227], v1, s[8:11], s21 offen offset:0
    buffer_load_dwordx4 v[228:231], v1, s[8:11], s21 offen offset:1024
    s_add_u32 s21, s20, 79872
    buffer_load_dwordx4 v[232:235], v1, s[8:11], s21 offen offset:0
    buffer_load_dwordx4 v[236:239], v1, s[8:11], s21 offen offset:1024
    s_mov_b32 s14, 0
    s_lshl_b32 s20, s12, 7
    v_mov_b32 v9, s20
    s_mov_b32 s47, 0
layerb1_kernel_y1_step:
    s_cmp_lt_u32 s14, 32
    s_cselect_b32 s18, s16, s17
    s_and_b32 s20, s14, 31
    s_lshl_b32 s20, s20, 16
    s_add_u32 s18, s18, s20
    s_mul_i32 s28, s14, 1638400
    s_add_u32 s28, s28, s46
    v_mov_b32 v56, 0
    v_mov_b32 v57, 0
    v_mov_b32 v58, 0
    v_mov_b32 v59, 0
    v_mov_b32 v60, 0
    v_mov_b32 v61, 0
    v_mov_b32 v62, 0
    v_mov_b32 v63, 0
    v_mov_b32 v64, 0
    v_mov_b32 v65, 0
    v_mov_b32 v66, 0
    v_mov_b32 v67, 0
    v_mov_b32 v68, 0
    v_mov_b32 v69, 0
    v_mov_b32 v70, 0
    v_mov_b32 v71, 0
    s_add_u32 s22, s18, 39936
    s_add_u32 s23, s18, 49152
    s_add_u32 s24, s18, 50176
layerb1_kernel_y1_poll:
    buffer_load_dwordx4 v[28:31], v1, s[8:11], s22 offen sc1
    buffer_load_dwordx4 v[32:35], v1, s[8:11], s23 offen sc1
    buffer_load_dwordx4 v[36:39], v1, s[8:11], s24 offen sc1
    s_waitcnt vmcnt(0)
    ds_write_b128 v3, v[28:31] offset:3072
    ds_write_b128 v3, v[32:35] offset:4096
    ds_write_b128 v3, v[36:39] offset:5120
    v_max3_u32 v116, v28, v29, v30
    v_max3_u32 v116, v116, v31, v32
    v_max3_u32 v116, v116, v33, v34
    v_max3_u32 v116, v116, v35, v36
    v_max3_u32 v116, v116, v37, v38
    v_max_u32 v116, v116, v39
    v_cmp_eq_u32 vcc, -1, v116
    s_sub_u32 s15, s15, 1
    s_cbranch_scc1 layerb1_kernel_bail
    s_cbranch_vccnz layerb1_kernel_y1_poll
    s_waitcnt lgkmcnt(0)
    s_barrier
    ds_read_b128 v[16:19], v3 offset:0
    ds_read_b128 v[20:23], v3 offset:1024
    ds_read_b128 v[24:27], v3 offset:2048
    ds_read_b128 v[40:43], v3 offset:6144
    ds_read_b128 v[44:47], v3 offset:7168
    ds_read_b128 v[48:51], v3 offset:8192
    ds_read_b128 v[52:55], v3 offset:9216
    s_cmp_gt_u32 s47, s14
    s_cbranch_scc1 layerb1_kernel_y1_gw_ok
layerb1_kernel_y1_gw_lp:
    buffer_load_dword v116, v9, s[8:11], s48 offen sc1
    s_waitcnt vmcnt(0)
    v_readlane_b32 s47, v116, 0
    s_nop 0
    s_sub_u32 s15, s15, 1
    s_cbranch_scc1 layerb1_kernel_bail
    s_cmp_gt_u32 s47, s14
    s_cbranch_scc0 layerb1_kernel_y1_gw_lp
layerb1_kernel_y1_gw_ok:
    buffer_load_dwordx4 v[76:79], v4, s[8:11], s28 offen offset:128 sc1
    buffer_load_dwordx4 v[80:83], v4, s[8:11], s28 offen offset:256 sc1
    buffer_load_dwordx4 v[84:87], v4, s[8:11], s28 offen offset:384 sc1
    buffer_load_dwordx4 v[88:91], v4, s[8:11], s28 offen offset:512 sc1
    v_smfmac_f32_16x16x64_bf16 v[56:59], v[28:31], a[24:31], v2
    v_smfmac_f32_16x16x64_bf16 v[60:63], v[28:31], a[104:111], v2
    v_smfmac_f32_16x16x64_bf16 v[64:67], v[28:31], a[184:191], v2
    v_smfmac_f32_16x16x64_bf16 v[68:71], v[28:31], v[184:191], v2
    v_smfmac_f32_16x16x64_bf16 v[56:59], v[32:35], a[32:39], v2
    v_smfmac_f32_16x16x64_bf16 v[60:63], v[32:35], a[112:119], v2
    v_smfmac_f32_16x16x64_bf16 v[64:67], v[32:35], a[192:199], v2
    v_smfmac_f32_16x16x64_bf16 v[68:71], v[32:35], v[192:199], v2
    v_smfmac_f32_16x16x64_bf16 v[56:59], v[36:39], a[40:47], v2
    v_smfmac_f32_16x16x64_bf16 v[60:63], v[36:39], a[120:127], v2
    v_smfmac_f32_16x16x64_bf16 v[64:67], v[36:39], a[200:207], v2
    v_smfmac_f32_16x16x64_bf16 v[68:71], v[36:39], v[200:207], v2
    s_waitcnt lgkmcnt(6)
    v_smfmac_f32_16x16x64_bf16 v[56:59], v[16:19], a[0:7], v2
    v_smfmac_f32_16x16x64_bf16 v[60:63], v[16:19], a[80:87], v2
    v_smfmac_f32_16x16x64_bf16 v[64:67], v[16:19], a[160:167], v2
    v_smfmac_f32_16x16x64_bf16 v[68:71], v[16:19], a[240:247], v2
    s_waitcnt lgkmcnt(5)
    v_smfmac_f32_16x16x64_bf16 v[56:59], v[20:23], a[8:15], v2
    v_smfmac_f32_16x16x64_bf16 v[60:63], v[20:23], a[88:95], v2
    v_smfmac_f32_16x16x64_bf16 v[64:67], v[20:23], a[168:175], v2
    v_smfmac_f32_16x16x64_bf16 v[68:71], v[20:23], a[248:255], v2
    s_waitcnt lgkmcnt(4)
    v_smfmac_f32_16x16x64_bf16 v[56:59], v[24:27], a[16:23], v2
    v_smfmac_f32_16x16x64_bf16 v[60:63], v[24:27], a[96:103], v2
    v_smfmac_f32_16x16x64_bf16 v[64:67], v[24:27], a[176:183], v2
    v_smfmac_f32_16x16x64_bf16 v[68:71], v[24:27], v[176:183], v2
    s_waitcnt lgkmcnt(3)
    v_smfmac_f32_16x16x64_bf16 v[56:59], v[40:43], a[48:55], v2
    v_smfmac_f32_16x16x64_bf16 v[60:63], v[40:43], a[128:135], v2
    v_smfmac_f32_16x16x64_bf16 v[64:67], v[40:43], a[208:215], v2
    v_smfmac_f32_16x16x64_bf16 v[68:71], v[40:43], v[208:215], v2
    s_waitcnt lgkmcnt(2)
    v_smfmac_f32_16x16x64_bf16 v[56:59], v[44:47], a[56:63], v2
    v_smfmac_f32_16x16x64_bf16 v[60:63], v[44:47], a[136:143], v2
    v_smfmac_f32_16x16x64_bf16 v[64:67], v[44:47], a[216:223], v2
    v_smfmac_f32_16x16x64_bf16 v[68:71], v[44:47], v[216:223], v2
    s_waitcnt lgkmcnt(1)
    v_smfmac_f32_16x16x64_bf16 v[56:59], v[48:51], a[64:71], v2
    v_smfmac_f32_16x16x64_bf16 v[60:63], v[48:51], a[144:151], v2
    v_smfmac_f32_16x16x64_bf16 v[64:67], v[48:51], a[224:231], v2
    v_smfmac_f32_16x16x64_bf16 v[68:71], v[48:51], v[224:231], v2
    s_waitcnt lgkmcnt(0)
    v_smfmac_f32_16x16x64_bf16 v[56:59], v[52:55], a[72:79], v2
    v_smfmac_f32_16x16x64_bf16 v[60:63], v[52:55], a[152:159], v2
    v_smfmac_f32_16x16x64_bf16 v[64:67], v[52:55], a[232:239], v2
    v_smfmac_f32_16x16x64_bf16 v[68:71], v[52:55], v[232:239], v2
    s_nop 7
    v_permlane32_swap_b32 v56, v64
    v_permlane32_swap_b32 v60, v68
    v_permlane32_swap_b32 v57, v65
    v_permlane32_swap_b32 v61, v69
    v_permlane32_swap_b32 v58, v66
    v_permlane32_swap_b32 v62, v70
    v_permlane32_swap_b32 v59, v67
    v_permlane32_swap_b32 v63, v71
    v_add_f32 v56, v56, v64
    v_add_f32 v60, v60, v68
    v_add_f32 v57, v57, v65
    v_add_f32 v61, v61, v69
    v_add_f32 v58, v58, v66
    v_add_f32 v62, v62, v70
    v_add_f32 v59, v59, v67
    v_add_f32 v63, v63, v71
    s_nop 1
    v_permlane16_swap_b32 v56, v60
    v_permlane16_swap_b32 v57, v61
    v_permlane16_swap_b32 v58, v62
    v_permlane16_swap_b32 v59, v63
    s_nop 1
    v_cvt_pk_bf16_f32 v72, v56, v57
    v_cvt_pk_bf16_f32 v73, v58, v59
    v_cvt_pk_bf16_f32 v74, v60, v61
    v_cvt_pk_bf16_f32 v75, v62, v63
    buffer_store_dwordx4 v[72:75], v4, s[8:11], s28 offen sc1
    s_cmp_eq_u32 s14, 63
    s_cbranch_scc1 layerb1_kernel_y1_last
    s_add_u32 s30, s18, 0
    s_add_u32 s31, s18, 4096
    s_add_u32 s32, s18, 16384
    s_add_u32 s33, s18, 20480
    s_add_u32 s34, s18, 32768
    s_add_u32 s29, s14, 1
    s_cmp_lt_u32 s29, 32
    s_cselect_b32 s19, s16, s17
    s_and_b32 s20, s29, 31
    s_lshl_b32 s20, s20, 16
    s_add_u32 s19, s19, s20
layerb1_kernel_y1_ppoll:
    buffer_load_dwordx4 v[92:95], v5, s[8:11], s30 offen sc1
    buffer_load_dwordx4 v[96:99], v5, s[8:11], s31 offen sc1
    buffer_load_dwordx4 v[100:103], v5, s[8:11], s32 offen sc1
    buffer_load_dwordx4 v[104:107], v5, s[8:11], s33 offen sc1
    buffer_load_dwordx4 v[108:111], v5, s[8:11], s34 offen sc1
    s_waitcnt vmcnt(0)
    v_mfma_f32_16x16x32_bf16 v[112:115], v[92:95], v[72:75], 0
    v_mfma_f32_16x16x32_bf16 v[112:115], v[96:99], v[76:79], v[112:115]
    v_mfma_f32_16x16x32_bf16 v[112:115], v[100:103], v[80:83], v[112:115]
    v_mfma_f32_16x16x32_bf16 v[112:115], v[104:107], v[84:87], v[112:115]
    v_mfma_f32_16x16x32_bf16 v[112:115], v[108:111], v[88:91], v[112:115]
    v_max3_u32 v116, v92, v93, v94
    v_max3_u32 v116, v116, v95, v96
    v_max3_u32 v116, v116, v97, v98
    v_max3_u32 v116, v116, v99, v100
    v_max3_u32 v116, v116, v101, v102
    v_max3_u32 v116, v116, v103, v104
    v_max3_u32 v116, v116, v105, v106
    v_max3_u32 v116, v116, v107, v108
    v_max3_u32 v116, v116, v109, v110
    v_max_u32 v116, v116, v111
    v_cmp_eq_u32 vcc, -1, v116
    s_sub_u32 s15, s15, 1
    s_cbranch_scc1 layerb1_kernel_bail
    s_cbranch_vccnz layerb1_kernel_y1_ppoll
    ds_write_b128 v6, v[112:115]
    s_waitcnt lgkmcnt(0)
    s_barrier
    s_barrier
    s_add_u32 s14, s14, 1
    s_branch layerb1_kernel_y1_step
layerb1_kernel_y1_last:
    s_waitcnt vmcnt(0)
    s_barrier
    s_branch layerb1_kernel_end
layerb1_kernel_y2_start:
    v_lshrrev_b32 v16, 4, v0
    v_and_b32 v17, 7, v0
    v_lshrrev_b32 v18, 3, v0
    v_and_b32 v18, 1, v18
    v_lshl_add_u32 v19, v18, 2, v16
    v_add_u32 v19, 16, v19
    v_mul_u32_u24 v20, 640, v19
    v_lshl_add_u32 v4, v17, 4, v20
    v_and_b32 v20, 3, v17
    v_lshlrev_b32 v20, 1, v20
    v_lshrrev_b32 v21, 2, v17
    v_add_u32 v20, v20, v21
    v_lshlrev_b32 v20, 4, v20
    v_lshl_add_u32 v5, v19, 7, v20
    v_add_u32 v3, 0, v1
    v_lshrrev_b32 v20, 1, v17
    v_lshlrev_b32 v20, 7, v20
    v_and_b32 v21, 1, v17
    v_lshl_add_u32 v20, v21, 2, v20
    v_add_u32 v10, 1024, v20
    v_lshlrev_b32 v20, 8, v18
    v_lshl_add_u32 v20, v17, 5, v20
    v_and_b32 v21, 1, v16
    v_lshl_add_u32 v20, v21, 4, v20
    v_add_u32 v20, 11264, v20
    v_add_u32 v21, 12288, v1
    v_lshrrev_b32 v22, 1, v16
    v_cmp_eq_u32 vcc, v22, v18
    s_nop 1
    v_cndmask_b32 v6, v21, v20, vcc
    v_lshrrev_b32 v20, 3, v0
    v_lshlrev_b32 v20, 2, v20
    v_lshl_add_u32 v20, v17, 5, v20
    v_add_u32 v7, 10240, v20
    s_lshl_b32 s20, s12, 7
    s_add_u32 s20, s20, 20480
    s_lshr_b32 s21, s20, 13
    s_lshl_b32 s21, s21, 14
    s_and_b32 s20, s20, 8191
    s_add_u32 s20, s20, s21
    v_lshrrev_b32 v20, 3, v0
    v_lshlrev_b32 v20, 4, v20
    v_add_u32 v8, s20, v20
    s_mul_i32 s46, s12, 20480
    s_add_u32 s46, s46, 103809024
    s_mul_i32 s20, s12, 327680
    s_add_u32 s20, s20, 27426816
    s_add_u32 s21, s20, 0
    buffer_load_dwordx4 a[0:3], v1, s[8:11], s21 offen offset:0
    buffer_load_dwordx4 a[4:7], v1, s[8:11], s21 offen offset:1024
    s_add_u32 s21, s20, 2048
    buffer_load_dwordx4 a[8:11], v1, s[8:11], s21 offen offset:0
    buffer_load_dwordx4 a[12:15], v1, s[8:11], s21 offen offset:1024
    s_add_u32 s21, s20, 4096
    buffer_load_dwordx4 a[16:19], v1, s[8:11], s21 offen offset:0
    buffer_load_dwordx4 a[20:23], v1, s[8:11], s21 offen offset:1024
    s_add_u32 s21, s20, 6144
    buffer_load_dwordx4 a[24:27], v1, s[8:11], s21 offen offset:0
    buffer_load_dwordx4 a[28:31], v1, s[8:11], s21 offen offset:1024
    s_add_u32 s21, s20, 8192
    buffer_load_dwordx4 a[32:35], v1, s[8:11], s21 offen offset:0
    buffer_load_dwordx4 a[36:39], v1, s[8:11], s21 offen offset:1024
    s_add_u32 s21, s20, 10240
    buffer_load_dwordx4 a[40:43], v1, s[8:11], s21 offen offset:0
    buffer_load_dwordx4 a[44:47], v1, s[8:11], s21 offen offset:1024
    s_add_u32 s21, s20, 12288
    buffer_load_dwordx4 a[48:51], v1, s[8:11], s21 offen offset:0
    buffer_load_dwordx4 a[52:55], v1, s[8:11], s21 offen offset:1024
    s_add_u32 s21, s20, 14336
    buffer_load_dwordx4 a[56:59], v1, s[8:11], s21 offen offset:0
    buffer_load_dwordx4 a[60:63], v1, s[8:11], s21 offen offset:1024
    s_add_u32 s21, s20, 16384
    buffer_load_dwordx4 a[64:67], v1, s[8:11], s21 offen offset:0
    buffer_load_dwordx4 a[68:71], v1, s[8:11], s21 offen offset:1024
    s_add_u32 s21, s20, 18432
    buffer_load_dwordx4 a[72:75], v1, s[8:11], s21 offen offset:0
    buffer_load_dwordx4 a[76:79], v1, s[8:11], s21 offen offset:1024
    s_add_u32 s21, s20, 20480
    buffer_load_dwordx4 a[80:83], v1, s[8:11], s21 offen offset:0
    buffer_load_dwordx4 a[84:87], v1, s[8:11], s21 offen offset:1024
    s_add_u32 s21, s20, 22528
    buffer_load_dwordx4 a[88:91], v1, s[8:11], s21 offen offset:0
    buffer_load_dwordx4 a[92:95], v1, s[8:11], s21 offen offset:1024
    s_add_u32 s21, s20, 24576
    buffer_load_dwordx4 a[96:99], v1, s[8:11], s21 offen offset:0
    buffer_load_dwordx4 a[100:103], v1, s[8:11], s21 offen offset:1024
    s_add_u32 s21, s20, 26624
    buffer_load_dwordx4 a[104:107], v1, s[8:11], s21 offen offset:0
    buffer_load_dwordx4 a[108:111], v1, s[8:11], s21 offen offset:1024
    s_add_u32 s21, s20, 28672
    buffer_load_dwordx4 a[112:115], v1, s[8:11], s21 offen offset:0
    buffer_load_dwordx4 a[116:119], v1, s[8:11], s21 offen offset:1024
    s_add_u32 s21, s20, 30720
    buffer_load_dwordx4 a[120:123], v1, s[8:11], s21 offen offset:0
    buffer_load_dwordx4 a[124:127], v1, s[8:11], s21 offen offset:1024
    s_add_u32 s21, s20, 32768
    buffer_load_dwordx4 a[128:131], v1, s[8:11], s21 offen offset:0
    buffer_load_dwordx4 a[132:135], v1, s[8:11], s21 offen offset:1024
    s_add_u32 s21, s20, 34816
    buffer_load_dwordx4 a[136:139], v1, s[8:11], s21 offen offset:0
    buffer_load_dwordx4 a[140:143], v1, s[8:11], s21 offen offset:1024
    s_add_u32 s21, s20, 36864
    buffer_load_dwordx4 a[144:147], v1, s[8:11], s21 offen offset:0
    buffer_load_dwordx4 a[148:151], v1, s[8:11], s21 offen offset:1024
    s_add_u32 s21, s20, 38912
    buffer_load_dwordx4 a[152:155], v1, s[8:11], s21 offen offset:0
    buffer_load_dwordx4 a[156:159], v1, s[8:11], s21 offen offset:1024
    s_add_u32 s21, s20, 40960
    buffer_load_dwordx4 a[160:163], v1, s[8:11], s21 offen offset:0
    buffer_load_dwordx4 a[164:167], v1, s[8:11], s21 offen offset:1024
    s_add_u32 s21, s20, 43008
    buffer_load_dwordx4 a[168:171], v1, s[8:11], s21 offen offset:0
    buffer_load_dwordx4 a[172:175], v1, s[8:11], s21 offen offset:1024
    s_add_u32 s21, s20, 45056
    buffer_load_dwordx4 a[176:179], v1, s[8:11], s21 offen offset:0
    buffer_load_dwordx4 a[180:183], v1, s[8:11], s21 offen offset:1024
    s_add_u32 s21, s20, 47104
    buffer_load_dwordx4 a[184:187], v1, s[8:11], s21 offen offset:0
    buffer_load_dwordx4 a[188:191], v1, s[8:11], s21 offen offset:1024
    s_add_u32 s21, s20, 49152
    buffer_load_dwordx4 a[192:195], v1, s[8:11], s21 offen offset:0
    buffer_load_dwordx4 a[196:199], v1, s[8:11], s21 offen offset:1024
    s_add_u32 s21, s20, 51200
    buffer_load_dwordx4 a[200:203], v1, s[8:11], s21 offen offset:0
    buffer_load_dwordx4 a[204:207], v1, s[8:11], s21 offen offset:1024
    s_add_u32 s21, s20, 53248
    buffer_load_dwordx4 a[208:211], v1, s[8:11], s21 offen offset:0
    buffer_load_dwordx4 a[212:215], v1, s[8:11], s21 offen offset:1024
    s_add_u32 s21, s20, 55296
    buffer_load_dwordx4 a[216:219], v1, s[8:11], s21 offen offset:0
    buffer_load_dwordx4 a[220:223], v1, s[8:11], s21 offen offset:1024
    s_add_u32 s21, s20, 57344
    buffer_load_dwordx4 a[224:227], v1, s[8:11], s21 offen offset:0
    buffer_load_dwordx4 a[228:231], v1, s[8:11], s21 offen offset:1024
    s_add_u32 s21, s20, 59392
    buffer_load_dwordx4 a[232:235], v1, s[8:11], s21 offen offset:0
    buffer_load_dwordx4 a[236:239], v1, s[8:11], s21 offen offset:1024
    s_add_u32 s21, s20, 61440
    buffer_load_dwordx4 a[240:243], v1, s[8:11], s21 offen offset:0
    buffer_load_dwordx4 a[244:247], v1, s[8:11], s21 offen offset:1024
    s_add_u32 s21, s20, 63488
    buffer_load_dwordx4 a[248:251], v1, s[8:11], s21 offen offset:0
    buffer_load_dwordx4 a[252:255], v1, s[8:11], s21 offen offset:1024
    s_add_u32 s21, s20, 65536
    buffer_load_dwordx4 v[176:179], v1, s[8:11], s21 offen offset:0
    buffer_load_dwordx4 v[180:183], v1, s[8:11], s21 offen offset:1024
    s_add_u32 s21, s20, 67584
    buffer_load_dwordx4 v[184:187], v1, s[8:11], s21 offen offset:0
    buffer_load_dwordx4 v[188:191], v1, s[8:11], s21 offen offset:1024
    s_add_u32 s21, s20, 69632
    buffer_load_dwordx4 v[192:195], v1, s[8:11], s21 offen offset:0
    buffer_load_dwordx4 v[196:199], v1, s[8:11], s21 offen offset:1024
    s_add_u32 s21, s20, 71680
    buffer_load_dwordx4 v[200:203], v1, s[8:11], s21 offen offset:0
    buffer_load_dwordx4 v[204:207], v1, s[8:11], s21 offen offset:1024
    s_add_u32 s21, s20, 73728
    buffer_load_dwordx4 v[208:211], v1, s[8:11], s21 offen offset:0
    buffer_load_dwordx4 v[212:215], v1, s[8:11], s21 offen offset:1024
    s_add_u32 s21, s20, 75776
    buffer_load_dwordx4 v[216:219], v1, s[8:11], s21 offen offset:0
    buffer_load_dwordx4 v[220:223], v1, s[8:11], s21 offen offset:1024
    s_add_u32 s21, s20, 77824
    buffer_load_dwordx4 v[224:227], v1, s[8:11], s21 offen offset:0
    buffer_load_dwordx4 v[228:231], v1, s[8:11], s21 offen offset:1024
    s_add_u32 s21, s20, 79872
    buffer_load_dwordx4 v[232:235], v1, s[8:11], s21 offen offset:0
    buffer_load_dwordx4 v[236:239], v1, s[8:11], s21 offen offset:1024
    s_mov_b32 s14, 0
    s_lshl_b32 s20, s12, 7
    v_mov_b32 v9, s20
    s_mov_b32 s47, 0
layerb1_kernel_y2_step:
    s_cmp_lt_u32 s14, 32
    s_cselect_b32 s18, s16, s17
    s_and_b32 s20, s14, 31
    s_lshl_b32 s20, s20, 16
    s_add_u32 s18, s18, s20
    s_mul_i32 s28, s14, 1638400
    s_add_u32 s28, s28, s46
    v_mov_b32 v56, 0
    v_mov_b32 v57, 0
    v_mov_b32 v58, 0
    v_mov_b32 v59, 0
    v_mov_b32 v60, 0
    v_mov_b32 v61, 0
    v_mov_b32 v62, 0
    v_mov_b32 v63, 0
    v_mov_b32 v64, 0
    v_mov_b32 v65, 0
    v_mov_b32 v66, 0
    v_mov_b32 v67, 0
    v_mov_b32 v68, 0
    v_mov_b32 v69, 0
    v_mov_b32 v70, 0
    v_mov_b32 v71, 0
    s_add_u32 s22, s18, 51200
    s_add_u32 s23, s18, 52224
layerb1_kernel_y2_poll:
    buffer_load_dwordx4 v[40:43], v1, s[8:11], s22 offen sc1
    buffer_load_dwordx4 v[44:47], v1, s[8:11], s23 offen sc1
    s_waitcnt vmcnt(0)
    ds_write_b128 v3, v[40:43] offset:6144
    ds_write_b128 v3, v[44:47] offset:7168
    v_max3_u32 v116, v40, v41, v42
    v_max3_u32 v116, v116, v43, v44
    v_max3_u32 v116, v116, v45, v46
    v_max_u32 v116, v116, v47
    v_cmp_eq_u32 vcc, -1, v116
    s_sub_u32 s15, s15, 1
    s_cbranch_scc1 layerb1_kernel_bail
    s_cbranch_vccnz layerb1_kernel_y2_poll
    s_waitcnt lgkmcnt(0)
    s_barrier
    ds_read_b128 v[16:19], v3 offset:0
    ds_read_b128 v[20:23], v3 offset:1024
    ds_read_b128 v[24:27], v3 offset:2048
    ds_read_b128 v[28:31], v3 offset:3072
    ds_read_b128 v[32:35], v3 offset:4096
    ds_read_b128 v[36:39], v3 offset:5120
    ds_read_b128 v[48:51], v3 offset:8192
    ds_read_b128 v[52:55], v3 offset:9216
    s_cmp_gt_u32 s47, s14
    s_cbranch_scc1 layerb1_kernel_y2_gw_ok
layerb1_kernel_y2_gw_lp:
    buffer_load_dword v116, v9, s[8:11], s48 offen sc1
    s_waitcnt vmcnt(0)
    v_readlane_b32 s47, v116, 0
    s_nop 0
    s_sub_u32 s15, s15, 1
    s_cbranch_scc1 layerb1_kernel_bail
    s_cmp_gt_u32 s47, s14
    s_cbranch_scc0 layerb1_kernel_y2_gw_lp
layerb1_kernel_y2_gw_ok:
    buffer_load_dwordx4 v[76:79], v4, s[8:11], s28 offen offset:128 sc1
    buffer_load_dwordx4 v[80:83], v4, s[8:11], s28 offen offset:256 sc1
    buffer_load_dwordx4 v[84:87], v4, s[8:11], s28 offen offset:384 sc1
    buffer_load_dwordx4 v[88:91], v4, s[8:11], s28 offen offset:512 sc1
    v_smfmac_f32_16x16x64_bf16 v[56:59], v[40:43], a[48:55], v2
    v_smfmac_f32_16x16x64_bf16 v[60:63], v[40:43], a[128:135], v2
    v_smfmac_f32_16x16x64_bf16 v[64:67], v[40:43], a[208:215], v2
    v_smfmac_f32_16x16x64_bf16 v[68:71], v[40:43], v[208:215], v2
    v_smfmac_f32_16x16x64_bf16 v[56:59], v[44:47], a[56:63], v2
    v_smfmac_f32_16x16x64_bf16 v[60:63], v[44:47], a[136:143], v2
    v_smfmac_f32_16x16x64_bf16 v[64:67], v[44:47], a[216:223], v2
    v_smfmac_f32_16x16x64_bf16 v[68:71], v[44:47], v[216:223], v2
    s_waitcnt lgkmcnt(7)
    v_smfmac_f32_16x16x64_bf16 v[56:59], v[16:19], a[0:7], v2
    v_smfmac_f32_16x16x64_bf16 v[60:63], v[16:19], a[80:87], v2
    v_smfmac_f32_16x16x64_bf16 v[64:67], v[16:19], a[160:167], v2
    v_smfmac_f32_16x16x64_bf16 v[68:71], v[16:19], a[240:247], v2
    s_waitcnt lgkmcnt(6)
    v_smfmac_f32_16x16x64_bf16 v[56:59], v[20:23], a[8:15], v2
    v_smfmac_f32_16x16x64_bf16 v[60:63], v[20:23], a[88:95], v2
    v_smfmac_f32_16x16x64_bf16 v[64:67], v[20:23], a[168:175], v2
    v_smfmac_f32_16x16x64_bf16 v[68:71], v[20:23], a[248:255], v2
    s_waitcnt lgkmcnt(5)
    v_smfmac_f32_16x16x64_bf16 v[56:59], v[24:27], a[16:23], v2
    v_smfmac_f32_16x16x64_bf16 v[60:63], v[24:27], a[96:103], v2
    v_smfmac_f32_16x16x64_bf16 v[64:67], v[24:27], a[176:183], v2
    v_smfmac_f32_16x16x64_bf16 v[68:71], v[24:27], v[176:183], v2
    s_waitcnt lgkmcnt(4)
    v_smfmac_f32_16x16x64_bf16 v[56:59], v[28:31], a[24:31], v2
    v_smfmac_f32_16x16x64_bf16 v[60:63], v[28:31], a[104:111], v2
    v_smfmac_f32_16x16x64_bf16 v[64:67], v[28:31], a[184:191], v2
    v_smfmac_f32_16x16x64_bf16 v[68:71], v[28:31], v[184:191], v2
    s_waitcnt lgkmcnt(3)
    v_smfmac_f32_16x16x64_bf16 v[56:59], v[32:35], a[32:39], v2
    v_smfmac_f32_16x16x64_bf16 v[60:63], v[32:35], a[112:119], v2
    v_smfmac_f32_16x16x64_bf16 v[64:67], v[32:35], a[192:199], v2
    v_smfmac_f32_16x16x64_bf16 v[68:71], v[32:35], v[192:199], v2
    s_waitcnt lgkmcnt(2)
    v_smfmac_f32_16x16x64_bf16 v[56:59], v[36:39], a[40:47], v2
    v_smfmac_f32_16x16x64_bf16 v[60:63], v[36:39], a[120:127], v2
    v_smfmac_f32_16x16x64_bf16 v[64:67], v[36:39], a[200:207], v2
    v_smfmac_f32_16x16x64_bf16 v[68:71], v[36:39], v[200:207], v2
    s_waitcnt lgkmcnt(1)
    v_smfmac_f32_16x16x64_bf16 v[56:59], v[48:51], a[64:71], v2
    v_smfmac_f32_16x16x64_bf16 v[60:63], v[48:51], a[144:151], v2
    v_smfmac_f32_16x16x64_bf16 v[64:67], v[48:51], a[224:231], v2
    v_smfmac_f32_16x16x64_bf16 v[68:71], v[48:51], v[224:231], v2
    s_waitcnt lgkmcnt(0)
    v_smfmac_f32_16x16x64_bf16 v[56:59], v[52:55], a[72:79], v2
    v_smfmac_f32_16x16x64_bf16 v[60:63], v[52:55], a[152:159], v2
    v_smfmac_f32_16x16x64_bf16 v[64:67], v[52:55], a[232:239], v2
    v_smfmac_f32_16x16x64_bf16 v[68:71], v[52:55], v[232:239], v2
    s_nop 7
    v_permlane32_swap_b32 v56, v64
    v_permlane32_swap_b32 v60, v68
    v_permlane32_swap_b32 v57, v65
    v_permlane32_swap_b32 v61, v69
    v_permlane32_swap_b32 v58, v66
    v_permlane32_swap_b32 v62, v70
    v_permlane32_swap_b32 v59, v67
    v_permlane32_swap_b32 v63, v71
    v_add_f32 v56, v56, v64
    v_add_f32 v60, v60, v68
    v_add_f32 v57, v57, v65
    v_add_f32 v61, v61, v69
    v_add_f32 v58, v58, v66
    v_add_f32 v62, v62, v70
    v_add_f32 v59, v59, v67
    v_add_f32 v63, v63, v71
    s_nop 1
    v_permlane16_swap_b32 v56, v60
    v_permlane16_swap_b32 v57, v61
    v_permlane16_swap_b32 v58, v62
    v_permlane16_swap_b32 v59, v63
    s_nop 1
    v_cvt_pk_bf16_f32 v72, v56, v57
    v_cvt_pk_bf16_f32 v73, v58, v59
    v_cvt_pk_bf16_f32 v74, v60, v61
    v_cvt_pk_bf16_f32 v75, v62, v63
    buffer_store_dwordx4 v[72:75], v4, s[8:11], s28 offen sc1
    s_cmp_eq_u32 s14, 63
    s_cbranch_scc1 layerb1_kernel_y2_last
    s_add_u32 s30, s18, 0
    s_add_u32 s31, s18, 4096
    s_add_u32 s32, s18, 16384
    s_add_u32 s33, s18, 20480
    s_add_u32 s34, s18, 32768
    s_add_u32 s29, s14, 1
    s_cmp_lt_u32 s29, 32
    s_cselect_b32 s19, s16, s17
    s_and_b32 s20, s29, 31
    s_lshl_b32 s20, s20, 16
    s_add_u32 s19, s19, s20
layerb1_kernel_y2_ppoll:
    buffer_load_dwordx4 v[92:95], v5, s[8:11], s30 offen sc1
    buffer_load_dwordx4 v[96:99], v5, s[8:11], s31 offen sc1
    buffer_load_dwordx4 v[100:103], v5, s[8:11], s32 offen sc1
    buffer_load_dwordx4 v[104:107], v5, s[8:11], s33 offen sc1
    buffer_load_dwordx4 v[108:111], v5, s[8:11], s34 offen sc1
    s_waitcnt vmcnt(0)
    v_mfma_f32_16x16x32_bf16 v[112:115], v[92:95], v[72:75], 0
    v_mfma_f32_16x16x32_bf16 v[112:115], v[96:99], v[76:79], v[112:115]
    v_mfma_f32_16x16x32_bf16 v[112:115], v[100:103], v[80:83], v[112:115]
    v_mfma_f32_16x16x32_bf16 v[112:115], v[104:107], v[84:87], v[112:115]
    v_mfma_f32_16x16x32_bf16 v[112:115], v[108:111], v[88:91], v[112:115]
    v_max3_u32 v116, v92, v93, v94
    v_max3_u32 v116, v116, v95, v96
    v_max3_u32 v116, v116, v97, v98
    v_max3_u32 v116, v116, v99, v100
    v_max3_u32 v116, v116, v101, v102
    v_max3_u32 v116, v116, v103, v104
    v_max3_u32 v116, v116, v105, v106
    v_max3_u32 v116, v116, v107, v108
    v_max3_u32 v116, v116, v109, v110
    v_max_u32 v116, v116, v111
    v_cmp_eq_u32 vcc, -1, v116
    s_sub_u32 s15, s15, 1
    s_cbranch_scc1 layerb1_kernel_bail
    s_cbranch_vccnz layerb1_kernel_y2_ppoll
    ds_write_b128 v6, v[112:115]
    s_waitcnt lgkmcnt(0)
    s_barrier
    s_barrier
    s_add_u32 s14, s14, 1
    s_branch layerb1_kernel_y2_step
layerb1_kernel_y2_last:
    s_waitcnt vmcnt(0)
    s_barrier
    s_branch layerb1_kernel_end
layerb1_kernel_y3_start:
    v_lshrrev_b32 v16, 4, v0
    v_and_b32 v17, 7, v0
    v_lshrrev_b32 v18, 3, v0
    v_and_b32 v18, 1, v18
    v_lshl_add_u32 v19, v18, 2, v16
    v_add_u32 v19, 24, v19
    v_mul_u32_u24 v20, 640, v19
    v_lshl_add_u32 v4, v17, 4, v20
    v_and_b32 v20, 3, v17
    v_lshlrev_b32 v20, 1, v20
    v_lshrrev_b32 v21, 2, v17
    v_add_u32 v20, v20, v21
    v_lshlrev_b32 v20, 4, v20
    v_lshl_add_u32 v5, v19, 7, v20
    v_add_u32 v3, 0, v1
    v_lshrrev_b32 v20, 1, v17
    v_lshlrev_b32 v20, 7, v20
    v_and_b32 v21, 1, v17
    v_lshl_add_u32 v20, v21, 2, v20
    v_add_u32 v10, 1536, v20
    v_lshlrev_b32 v20, 8, v18
    v_lshl_add_u32 v20, v17, 5, v20
    v_and_b32 v21, 1, v16
    v_lshl_add_u32 v20, v21, 4, v20
    v_add_u32 v20, 11776, v20
    v_add_u32 v21, 12288, v1
    v_lshrrev_b32 v22, 1, v16
    v_cmp_eq_u32 vcc, v22, v18
    s_nop 1
    v_cndmask_b32 v6, v21, v20, vcc
    v_lshrrev_b32 v20, 3, v0
    v_lshlrev_b32 v20, 2, v20
    v_lshl_add_u32 v20, v17, 5, v20
    v_add_u32 v7, 10240, v20
    s_lshl_b32 s20, s12, 7
    s_add_u32 s20, s20, 20480
    s_lshr_b32 s21, s20, 13
    s_lshl_b32 s21, s21, 14
    s_and_b32 s20, s20, 8191
    s_add_u32 s20, s20, s21
    v_lshrrev_b32 v20, 3, v0
    v_lshlrev_b32 v20, 4, v20
    v_add_u32 v8, s20, v20
    s_mul_i32 s46, s12, 20480
    s_add_u32 s46, s46, 103809024
    s_mul_i32 s20, s12, 327680
    s_add_u32 s20, s20, 27508736
    s_add_u32 s21, s20, 0
    buffer_load_dwordx4 a[0:3], v1, s[8:11], s21 offen offset:0
    buffer_load_dwordx4 a[4:7], v1, s[8:11], s21 offen offset:1024
    s_add_u32 s21, s20, 2048
    buffer_load_dwordx4 a[8:11], v1, s[8:11], s21 offen offset:0
    buffer_load_dwordx4 a[12:15], v1, s[8:11], s21 offen offset:1024
    s_add_u32 s21, s20, 4096
    buffer_load_dwordx4 a[16:19], v1, s[8:11], s21 offen offset:0
    buffer_load_dwordx4 a[20:23], v1, s[8:11], s21 offen offset:1024
    s_add_u32 s21, s20, 6144
    buffer_load_dwordx4 a[24:27], v1, s[8:11], s21 offen offset:0
    buffer_load_dwordx4 a[28:31], v1, s[8:11], s21 offen offset:1024
    s_add_u32 s21, s20, 8192
    buffer_load_dwordx4 a[32:35], v1, s[8:11], s21 offen offset:0
    buffer_load_dwordx4 a[36:39], v1, s[8:11], s21 offen offset:1024
    s_add_u32 s21, s20, 10240
    buffer_load_dwordx4 a[40:43], v1, s[8:11], s21 offen offset:0
    buffer_load_dwordx4 a[44:47], v1, s[8:11], s21 offen offset:1024
    s_add_u32 s21, s20, 12288
    buffer_load_dwordx4 a[48:51], v1, s[8:11], s21 offen offset:0
    buffer_load_dwordx4 a[52:55], v1, s[8:11], s21 offen offset:1024
    s_add_u32 s21, s20, 14336
    buffer_load_dwordx4 a[56:59], v1, s[8:11], s21 offen offset:0
    buffer_load_dwordx4 a[60:63], v1, s[8:11], s21 offen offset:1024
    s_add_u32 s21, s20, 16384
    buffer_load_dwordx4 a[64:67], v1, s[8:11], s21 offen offset:0
    buffer_load_dwordx4 a[68:71], v1, s[8:11], s21 offen offset:1024
    s_add_u32 s21, s20, 18432
    buffer_load_dwordx4 a[72:75], v1, s[8:11], s21 offen offset:0
    buffer_load_dwordx4 a[76:79], v1, s[8:11], s21 offen offset:1024
    s_add_u32 s21, s20, 20480
    buffer_load_dwordx4 a[80:83], v1, s[8:11], s21 offen offset:0
    buffer_load_dwordx4 a[84:87], v1, s[8:11], s21 offen offset:1024
    s_add_u32 s21, s20, 22528
    buffer_load_dwordx4 a[88:91], v1, s[8:11], s21 offen offset:0
    buffer_load_dwordx4 a[92:95], v1, s[8:11], s21 offen offset:1024
    s_add_u32 s21, s20, 24576
    buffer_load_dwordx4 a[96:99], v1, s[8:11], s21 offen offset:0
    buffer_load_dwordx4 a[100:103], v1, s[8:11], s21 offen offset:1024
    s_add_u32 s21, s20, 26624
    buffer_load_dwordx4 a[104:107], v1, s[8:11], s21 offen offset:0
    buffer_load_dwordx4 a[108:111], v1, s[8:11], s21 offen offset:1024
    s_add_u32 s21, s20, 28672
    buffer_load_dwordx4 a[112:115], v1, s[8:11], s21 offen offset:0
    buffer_load_dwordx4 a[116:119], v1, s[8:11], s21 offen offset:1024
    s_add_u32 s21, s20, 30720
    buffer_load_dwordx4 a[120:123], v1, s[8:11], s21 offen offset:0
    buffer_load_dwordx4 a[124:127], v1, s[8:11], s21 offen offset:1024
    s_add_u32 s21, s20, 32768
    buffer_load_dwordx4 a[128:131], v1, s[8:11], s21 offen offset:0
    buffer_load_dwordx4 a[132:135], v1, s[8:11], s21 offen offset:1024
    s_add_u32 s21, s20, 34816
    buffer_load_dwordx4 a[136:139], v1, s[8:11], s21 offen offset:0
    buffer_load_dwordx4 a[140:143], v1, s[8:11], s21 offen offset:1024
    s_add_u32 s21, s20, 36864
    buffer_load_dwordx4 a[144:147], v1, s[8:11], s21 offen offset:0
    buffer_load_dwordx4 a[148:151], v1, s[8:11], s21 offen offset:1024
    s_add_u32 s21, s20, 38912
    buffer_load_dwordx4 a[152:155], v1, s[8:11], s21 offen offset:0
    buffer_load_dwordx4 a[156:159], v1, s[8:11], s21 offen offset:1024
    s_add_u32 s21, s20, 40960
    buffer_load_dwordx4 a[160:163], v1, s[8:11], s21 offen offset:0
    buffer_load_dwordx4 a[164:167], v1, s[8:11], s21 offen offset:1024
    s_add_u32 s21, s20, 43008
    buffer_load_dwordx4 a[168:171], v1, s[8:11], s21 offen offset:0
    buffer_load_dwordx4 a[172:175], v1, s[8:11], s21 offen offset:1024
    s_add_u32 s21, s20, 45056
    buffer_load_dwordx4 a[176:179], v1, s[8:11], s21 offen offset:0
    buffer_load_dwordx4 a[180:183], v1, s[8:11], s21 offen offset:1024
    s_add_u32 s21, s20, 47104
    buffer_load_dwordx4 a[184:187], v1, s[8:11], s21 offen offset:0
    buffer_load_dwordx4 a[188:191], v1, s[8:11], s21 offen offset:1024
    s_add_u32 s21, s20, 49152
    buffer_load_dwordx4 a[192:195], v1, s[8:11], s21 offen offset:0
    buffer_load_dwordx4 a[196:199], v1, s[8:11], s21 offen offset:1024
    s_add_u32 s21, s20, 51200
    buffer_load_dwordx4 a[200:203], v1, s[8:11], s21 offen offset:0
    buffer_load_dwordx4 a[204:207], v1, s[8:11], s21 offen offset:1024
    s_add_u32 s21, s20, 53248
    buffer_load_dwordx4 a[208:211], v1, s[8:11], s21 offen offset:0
    buffer_load_dwordx4 a[212:215], v1, s[8:11], s21 offen offset:1024
    s_add_u32 s21, s20, 55296
    buffer_load_dwordx4 a[216:219], v1, s[8:11], s21 offen offset:0
    buffer_load_dwordx4 a[220:223], v1, s[8:11], s21 offen offset:1024
    s_add_u32 s21, s20, 57344
    buffer_load_dwordx4 a[224:227], v1, s[8:11], s21 offen offset:0
    buffer_load_dwordx4 a[228:231], v1, s[8:11], s21 offen offset:1024
    s_add_u32 s21, s20, 59392
    buffer_load_dwordx4 a[232:235], v1, s[8:11], s21 offen offset:0
    buffer_load_dwordx4 a[236:239], v1, s[8:11], s21 offen offset:1024
    s_add_u32 s21, s20, 61440
    buffer_load_dwordx4 a[240:243], v1, s[8:11], s21 offen offset:0
    buffer_load_dwordx4 a[244:247], v1, s[8:11], s21 offen offset:1024
    s_add_u32 s21, s20, 63488
    buffer_load_dwordx4 a[248:251], v1, s[8:11], s21 offen offset:0
    buffer_load_dwordx4 a[252:255], v1, s[8:11], s21 offen offset:1024
    s_add_u32 s21, s20, 65536
    buffer_load_dwordx4 v[176:179], v1, s[8:11], s21 offen offset:0
    buffer_load_dwordx4 v[180:183], v1, s[8:11], s21 offen offset:1024
    s_add_u32 s21, s20, 67584
    buffer_load_dwordx4 v[184:187], v1, s[8:11], s21 offen offset:0
    buffer_load_dwordx4 v[188:191], v1, s[8:11], s21 offen offset:1024
    s_add_u32 s21, s20, 69632
    buffer_load_dwordx4 v[192:195], v1, s[8:11], s21 offen offset:0
    buffer_load_dwordx4 v[196:199], v1, s[8:11], s21 offen offset:1024
    s_add_u32 s21, s20, 71680
    buffer_load_dwordx4 v[200:203], v1, s[8:11], s21 offen offset:0
    buffer_load_dwordx4 v[204:207], v1, s[8:11], s21 offen offset:1024
    s_add_u32 s21, s20, 73728
    buffer_load_dwordx4 v[208:211], v1, s[8:11], s21 offen offset:0
    buffer_load_dwordx4 v[212:215], v1, s[8:11], s21 offen offset:1024
    s_add_u32 s21, s20, 75776
    buffer_load_dwordx4 v[216:219], v1, s[8:11], s21 offen offset:0
    buffer_load_dwordx4 v[220:223], v1, s[8:11], s21 offen offset:1024
    s_add_u32 s21, s20, 77824
    buffer_load_dwordx4 v[224:227], v1, s[8:11], s21 offen offset:0
    buffer_load_dwordx4 v[228:231], v1, s[8:11], s21 offen offset:1024
    s_add_u32 s21, s20, 79872
    buffer_load_dwordx4 v[232:235], v1, s[8:11], s21 offen offset:0
    buffer_load_dwordx4 v[236:239], v1, s[8:11], s21 offen offset:1024
    s_mov_b32 s14, 0
    s_lshl_b32 s20, s12, 7
    v_mov_b32 v9, s20
    s_mov_b32 s47, 0
layerb1_kernel_y3_step:
    s_cmp_lt_u32 s14, 32
    s_cselect_b32 s18, s16, s17
    s_and_b32 s20, s14, 31
    s_lshl_b32 s20, s20, 16
    s_add_u32 s18, s18, s20
    s_mul_i32 s28, s14, 1638400
    s_add_u32 s28, s28, s46
    v_mov_b32 v56, 0
    v_mov_b32 v57, 0
    v_mov_b32 v58, 0
    v_mov_b32 v59, 0
    v_mov_b32 v60, 0
    v_mov_b32 v61, 0
    v_mov_b32 v62, 0
    v_mov_b32 v63, 0
    v_mov_b32 v64, 0
    v_mov_b32 v65, 0
    v_mov_b32 v66, 0
    v_mov_b32 v67, 0
    v_mov_b32 v68, 0
    v_mov_b32 v69, 0
    v_mov_b32 v70, 0
    v_mov_b32 v71, 0
    s_add_u32 s22, s18, 53248
    s_add_u32 s23, s18, 54272
layerb1_kernel_y3_poll:
    buffer_load_dwordx4 v[48:51], v1, s[8:11], s22 offen sc1
    buffer_load_dwordx4 v[52:55], v1, s[8:11], s23 offen sc1
    s_waitcnt vmcnt(0)
    ds_write_b128 v3, v[48:51] offset:8192
    ds_write_b128 v3, v[52:55] offset:9216
    v_max3_u32 v116, v48, v49, v50
    v_max3_u32 v116, v116, v51, v52
    v_max3_u32 v116, v116, v53, v54
    v_max_u32 v116, v116, v55
    v_cmp_eq_u32 vcc, -1, v116
    s_sub_u32 s15, s15, 1
    s_cbranch_scc1 layerb1_kernel_bail
    s_cbranch_vccnz layerb1_kernel_y3_poll
    s_waitcnt lgkmcnt(0)
    s_barrier
    ds_read_b128 v[16:19], v3 offset:0
    ds_read_b128 v[20:23], v3 offset:1024
    ds_read_b128 v[24:27], v3 offset:2048
    ds_read_b128 v[28:31], v3 offset:3072
    ds_read_b128 v[32:35], v3 offset:4096
    ds_read_b128 v[36:39], v3 offset:5120
    ds_read_b128 v[40:43], v3 offset:6144
    ds_read_b128 v[44:47], v3 offset:7168
    s_cmp_gt_u32 s47, s14
    s_cbranch_scc1 layerb1_kernel_y3_gw_ok
layerb1_kernel_y3_gw_lp:
    buffer_load_dword v116, v9, s[8:11], s48 offen sc1
    s_waitcnt vmcnt(0)
    v_readlane_b32 s47, v116, 0
    s_nop 0
    s_sub_u32 s15, s15, 1
    s_cbranch_scc1 layerb1_kernel_bail
    s_cmp_gt_u32 s47, s14
    s_cbranch_scc0 layerb1_kernel_y3_gw_lp
layerb1_kernel_y3_gw_ok:
    buffer_load_dwordx4 v[76:79], v4, s[8:11], s28 offen offset:128 sc1
    buffer_load_dwordx4 v[80:83], v4, s[8:11], s28 offen offset:256 sc1
    buffer_load_dwordx4 v[84:87], v4, s[8:11], s28 offen offset:384 sc1
    buffer_load_dwordx4 v[88:91], v4, s[8:11], s28 offen offset:512 sc1
    v_smfmac_f32_16x16x64_bf16 v[56:59], v[48:51], a[64:71], v2
    v_smfmac_f32_16x16x64_bf16 v[60:63], v[48:51], a[144:151], v2
    v_smfmac_f32_16x16x64_bf16 v[64:67], v[48:51], a[224:231], v2
    v_smfmac_f32_16x16x64_bf16 v[68:71], v[48:51], v[224:231], v2
    v_smfmac_f32_16x16x64_bf16 v[56:59], v[52:55], a[72:79], v2
    v_smfmac_f32_16x16x64_bf16 v[60:63], v[52:55], a[152:159], v2
    v_smfmac_f32_16x16x64_bf16 v[64:67], v[52:55], a[232:239], v2
    v_smfmac_f32_16x16x64_bf16 v[68:71], v[52:55], v[232:239], v2
    s_waitcnt lgkmcnt(7)
    v_smfmac_f32_16x16x64_bf16 v[56:59], v[16:19], a[0:7], v2
    v_smfmac_f32_16x16x64_bf16 v[60:63], v[16:19], a[80:87], v2
    v_smfmac_f32_16x16x64_bf16 v[64:67], v[16:19], a[160:167], v2
    v_smfmac_f32_16x16x64_bf16 v[68:71], v[16:19], a[240:247], v2
    s_waitcnt lgkmcnt(6)
    v_smfmac_f32_16x16x64_bf16 v[56:59], v[20:23], a[8:15], v2
    v_smfmac_f32_16x16x64_bf16 v[60:63], v[20:23], a[88:95], v2
    v_smfmac_f32_16x16x64_bf16 v[64:67], v[20:23], a[168:175], v2
    v_smfmac_f32_16x16x64_bf16 v[68:71], v[20:23], a[248:255], v2
    s_waitcnt lgkmcnt(5)
    v_smfmac_f32_16x16x64_bf16 v[56:59], v[24:27], a[16:23], v2
    v_smfmac_f32_16x16x64_bf16 v[60:63], v[24:27], a[96:103], v2
    v_smfmac_f32_16x16x64_bf16 v[64:67], v[24:27], a[176:183], v2
    v_smfmac_f32_16x16x64_bf16 v[68:71], v[24:27], v[176:183], v2
    s_waitcnt lgkmcnt(4)
    v_smfmac_f32_16x16x64_bf16 v[56:59], v[28:31], a[24:31], v2
    v_smfmac_f32_16x16x64_bf16 v[60:63], v[28:31], a[104:111], v2
    v_smfmac_f32_16x16x64_bf16 v[64:67], v[28:31], a[184:191], v2
    v_smfmac_f32_16x16x64_bf16 v[68:71], v[28:31], v[184:191], v2
    s_waitcnt lgkmcnt(3)
    v_smfmac_f32_16x16x64_bf16 v[56:59], v[32:35], a[32:39], v2
    v_smfmac_f32_16x16x64_bf16 v[60:63], v[32:35], a[112:119], v2
    v_smfmac_f32_16x16x64_bf16 v[64:67], v[32:35], a[192:199], v2
    v_smfmac_f32_16x16x64_bf16 v[68:71], v[32:35], v[192:199], v2
    s_waitcnt lgkmcnt(2)
    v_smfmac_f32_16x16x64_bf16 v[56:59], v[36:39], a[40:47], v2
    v_smfmac_f32_16x16x64_bf16 v[60:63], v[36:39], a[120:127], v2
    v_smfmac_f32_16x16x64_bf16 v[64:67], v[36:39], a[200:207], v2
    v_smfmac_f32_16x16x64_bf16 v[68:71], v[36:39], v[200:207], v2
    s_waitcnt lgkmcnt(1)
    v_smfmac_f32_16x16x64_bf16 v[56:59], v[40:43], a[48:55], v2
    v_smfmac_f32_16x16x64_bf16 v[60:63], v[40:43], a[128:135], v2
    v_smfmac_f32_16x16x64_bf16 v[64:67], v[40:43], a[208:215], v2
    v_smfmac_f32_16x16x64_bf16 v[68:71], v[40:43], v[208:215], v2
    s_waitcnt lgkmcnt(0)
    v_smfmac_f32_16x16x64_bf16 v[56:59], v[44:47], a[56:63], v2
    v_smfmac_f32_16x16x64_bf16 v[60:63], v[44:47], a[136:143], v2
    v_smfmac_f32_16x16x64_bf16 v[64:67], v[44:47], a[216:223], v2
    v_smfmac_f32_16x16x64_bf16 v[68:71], v[44:47], v[216:223], v2
    s_nop 7
    v_permlane32_swap_b32 v56, v64
    v_permlane32_swap_b32 v60, v68
    v_permlane32_swap_b32 v57, v65
    v_permlane32_swap_b32 v61, v69
    v_permlane32_swap_b32 v58, v66
    v_permlane32_swap_b32 v62, v70
    v_permlane32_swap_b32 v59, v67
    v_permlane32_swap_b32 v63, v71
    v_add_f32 v56, v56, v64
    v_add_f32 v60, v60, v68
    v_add_f32 v57, v57, v65
    v_add_f32 v61, v61, v69
    v_add_f32 v58, v58, v66
    v_add_f32 v62, v62, v70
    v_add_f32 v59, v59, v67
    v_add_f32 v63, v63, v71
    s_nop 1
    v_permlane16_swap_b32 v56, v60
    v_permlane16_swap_b32 v57, v61
    v_permlane16_swap_b32 v58, v62
    v_permlane16_swap_b32 v59, v63
    s_nop 1
    v_cvt_pk_bf16_f32 v72, v56, v57
    v_cvt_pk_bf16_f32 v73, v58, v59
    v_cvt_pk_bf16_f32 v74, v60, v61
    v_cvt_pk_bf16_f32 v75, v62, v63
    buffer_store_dwordx4 v[72:75], v4, s[8:11], s28 offen sc1
    s_cmp_eq_u32 s14, 63
    s_cbranch_scc1 layerb1_kernel_y3_last
    s_add_u32 s30, s18, 0
    s_add_u32 s31, s18, 4096
    s_add_u32 s32, s18, 16384
    s_add_u32 s33, s18, 20480
    s_add_u32 s34, s18, 32768
    s_add_u32 s29, s14, 1
    s_cmp_lt_u32 s29, 32
    s_cselect_b32 s19, s16, s17
    s_and_b32 s20, s29, 31
    s_lshl_b32 s20, s20, 16
    s_add_u32 s19, s19, s20
layerb1_kernel_y3_ppoll:
    buffer_load_dwordx4 v[92:95], v5, s[8:11], s30 offen sc1
    buffer_load_dwordx4 v[96:99], v5, s[8:11], s31 offen sc1
    buffer_load_dwordx4 v[100:103], v5, s[8:11], s32 offen sc1
    buffer_load_dwordx4 v[104:107], v5, s[8:11], s33 offen sc1
    buffer_load_dwordx4 v[108:111], v5, s[8:11], s34 offen sc1
    s_waitcnt vmcnt(0)
    v_mfma_f32_16x16x32_bf16 v[112:115], v[92:95], v[72:75], 0
    v_mfma_f32_16x16x32_bf16 v[112:115], v[96:99], v[76:79], v[112:115]
    v_mfma_f32_16x16x32_bf16 v[112:115], v[100:103], v[80:83], v[112:115]
    v_mfma_f32_16x16x32_bf16 v[112:115], v[104:107], v[84:87], v[112:115]
    v_mfma_f32_16x16x32_bf16 v[112:115], v[108:111], v[88:91], v[112:115]
    v_max3_u32 v116, v92, v93, v94
    v_max3_u32 v116, v116, v95, v96
    v_max3_u32 v116, v116, v97, v98
    v_max3_u32 v116, v116, v99, v100
    v_max3_u32 v116, v116, v101, v102
    v_max3_u32 v116, v116, v103, v104
    v_max3_u32 v116, v116, v105, v106
    v_max3_u32 v116, v116, v107, v108
    v_max3_u32 v116, v116, v109, v110
    v_max_u32 v116, v116, v111
    v_cmp_eq_u32 vcc, -1, v116
    s_sub_u32 s15, s15, 1
    s_cbranch_scc1 layerb1_kernel_bail
    s_cbranch_vccnz layerb1_kernel_y3_ppoll
    ds_write_b128 v6, v[112:115]
    s_waitcnt lgkmcnt(0)
    s_barrier
    s_barrier
    s_add_u32 s14, s14, 1
    s_branch layerb1_kernel_y3_step
layerb1_kernel_y3_last:
    s_waitcnt vmcnt(0)
    s_barrier
    s_branch layerb1_kernel_end
layerb1_kernel_proj:
    s_sub_u32 s22, s20, 4
    s_lshl_b32 s22, s22, 5
    s_add_u32 s12, s22, s21
    s_mov_b32 s14, 0
    s_mov_b32 s15, 64
    v_lshlrev_b32 v1, 4, v0
    v_and_b32 v8, 31, v0
    v_lshrrev_b32 v9, 5, v0
    s_cmp_ge_u32 s12, 80
    s_cbranch_scc1 layerb1_kernel_g_qk
    v_lshrrev_b32 v10, 3, v8
    v_and_b32 v11, 7, v8
    v_mul_u32_u24 v12, 20480, v10
    v_lshl_add_u32 v12, v11, 4, v12
    v_lshl_add_u32 v4, v9, 8, v12
    s_mul_i32 s24, s12, 327680
    s_mul_i32 s25, s13, 81920
    s_add_u32 s24, s24, s25
    s_add_u32 s24, s24, 27262976
    buffer_load_dwordx4 a[0:3], v4, s[8:11], s24 offen offset:0
    buffer_load_dwordx4 a[4:7], v4, s[8:11], s24 offen offset:128
    buffer_load_dwordx4 a[8:11], v4, s[8:11], s24 offen offset:512
    buffer_load_dwordx4 a[12:15], v4, s[8:11], s24 offen offset:640
    buffer_load_dwordx4 a[16:19], v4, s[8:11], s24 offen offset:1024
    buffer_load_dwordx4 a[20:23], v4, s[8:11], s24 offen offset:1152
    buffer_load_dwordx4 a[24:27], v4, s[8:11], s24 offen offset:1536
    buffer_load_dwordx4 a[28:31], v4, s[8:11], s24 offen offset:1664
    buffer_load_dwordx4 a[32:35], v4, s[8:11], s24 offen offset:2048
    buffer_load_dwordx4 a[36:39], v4, s[8:11], s24 offen offset:2176
    buffer_load_dwordx4 a[40:43], v4, s[8:11], s24 offen offset:2560
    buffer_load_dwordx4 a[44:47], v4, s[8:11], s24 offen offset:2688
    buffer_load_dwordx4 a[48:51], v4, s[8:11], s24 offen offset:3072
    buffer_load_dwordx4 a[52:55], v4, s[8:11], s24 offen offset:3200
    s_add_u32 s24, s24, 3584
    buffer_load_dwordx4 a[56:59], v4, s[8:11], s24 offen offset:0
    buffer_load_dwordx4 a[60:63], v4, s[8:11], s24 offen offset:128
    buffer_load_dwordx4 a[64:67], v4, s[8:11], s24 offen offset:512
    buffer_load_dwordx4 a[68:71], v4, s[8:11], s24 offen offset:640
    buffer_load_dwordx4 a[72:75], v4, s[8:11], s24 offen offset:1024
    buffer_load_dwordx4 a[76:79], v4, s[8:11], s24 offen offset:1152
    buffer_load_dwordx4 a[80:83], v4, s[8:11], s24 offen offset:1536
    buffer_load_dwordx4 a[84:87], v4, s[8:11], s24 offen offset:1664
    buffer_load_dwordx4 a[88:91], v4, s[8:11], s24 offen offset:2048
    buffer_load_dwordx4 a[92:95], v4, s[8:11], s24 offen offset:2176
    buffer_load_dwordx4 a[96:99], v4, s[8:11], s24 offen offset:2560
    buffer_load_dwordx4 a[100:103], v4, s[8:11], s24 offen offset:2688
    buffer_load_dwordx4 a[104:107], v4, s[8:11], s24 offen offset:3072
    buffer_load_dwordx4 a[108:111], v4, s[8:11], s24 offen offset:3200
    s_add_u32 s24, s24, 3584
    buffer_load_dwordx4 a[112:115], v4, s[8:11], s24 offen offset:0
    buffer_load_dwordx4 a[116:119], v4, s[8:11], s24 offen offset:128
    buffer_load_dwordx4 a[120:123], v4, s[8:11], s24 offen offset:512
    buffer_load_dwordx4 a[124:127], v4, s[8:11], s24 offen offset:640
    buffer_load_dwordx4 a[128:131], v4, s[8:11], s24 offen offset:1024
    buffer_load_dwordx4 a[132:135], v4, s[8:11], s24 offen offset:1152
    buffer_load_dwordx4 a[136:139], v4, s[8:11], s24 offen offset:1536
    buffer_load_dwordx4 a[140:143], v4, s[8:11], s24 offen offset:1664
    buffer_load_dwordx4 a[144:147], v4, s[8:11], s24 offen offset:2048
    buffer_load_dwordx4 a[148:151], v4, s[8:11], s24 offen offset:2176
    buffer_load_dwordx4 a[152:155], v4, s[8:11], s24 offen offset:2560
    buffer_load_dwordx4 a[156:159], v4, s[8:11], s24 offen offset:2688
    buffer_load_dwordx4 a[160:163], v4, s[8:11], s24 offen offset:3072
    buffer_load_dwordx4 a[164:167], v4, s[8:11], s24 offen offset:3200
    s_add_u32 s24, s24, 3584
    buffer_load_dwordx4 a[168:171], v4, s[8:11], s24 offen offset:0
    buffer_load_dwordx4 a[172:175], v4, s[8:11], s24 offen offset:128
    buffer_load_dwordx4 a[176:179], v4, s[8:11], s24 offen offset:512
    buffer_load_dwordx4 a[180:183], v4, s[8:11], s24 offen offset:640
    buffer_load_dwordx4 a[184:187], v4, s[8:11], s24 offen offset:1024
    buffer_load_dwordx4 a[188:191], v4, s[8:11], s24 offen offset:1152
    buffer_load_dwordx4 a[192:195], v4, s[8:11], s24 offen offset:1536
    buffer_load_dwordx4 a[196:199], v4, s[8:11], s24 offen offset:1664
    buffer_load_dwordx4 a[200:203], v4, s[8:11], s24 offen offset:2048
    buffer_load_dwordx4 a[204:207], v4, s[8:11], s24 offen offset:2176
    buffer_load_dwordx4 a[208:211], v4, s[8:11], s24 offen offset:2560
    buffer_load_dwordx4 a[212:215], v4, s[8:11], s24 offen offset:2688
    buffer_load_dwordx4 a[216:219], v4, s[8:11], s24 offen offset:3072
    buffer_load_dwordx4 a[220:223], v4, s[8:11], s24 offen offset:3200
    s_add_u32 s24, s24, 3584
    buffer_load_dwordx4 a[224:227], v4, s[8:11], s24 offen offset:0
    buffer_load_dwordx4 a[228:231], v4, s[8:11], s24 offen offset:128
    buffer_load_dwordx4 a[232:235], v4, s[8:11], s24 offen offset:512
    buffer_load_dwordx4 a[236:239], v4, s[8:11], s24 offen offset:640
    buffer_load_dwordx4 a[240:243], v4, s[8:11], s24 offen offset:1024
    buffer_load_dwordx4 a[244:247], v4, s[8:11], s24 offen offset:1152
    buffer_load_dwordx4 a[248:251], v4, s[8:11], s24 offen offset:1536
    buffer_load_dwordx4 a[252:255], v4, s[8:11], s24 offen offset:1664
    buffer_load_dwordx4 v[192:195], v4, s[8:11], s24 offen offset:2048
    buffer_load_dwordx4 v[196:199], v4, s[8:11], s24 offen offset:2176
    buffer_load_dwordx4 v[200:203], v4, s[8:11], s24 offen offset:2560
    buffer_load_dwordx4 v[204:207], v4, s[8:11], s24 offen offset:2688
    buffer_load_dwordx4 v[208:211], v4, s[8:11], s24 offen offset:3072
    buffer_load_dwordx4 v[212:215], v4, s[8:11], s24 offen offset:3200
    s_add_u32 s24, s24, 3584
    buffer_load_dwordx4 v[216:219], v4, s[8:11], s24 offen offset:0
    buffer_load_dwordx4 v[220:223], v4, s[8:11], s24 offen offset:128
    buffer_load_dwordx4 v[224:227], v4, s[8:11], s24 offen offset:512
    buffer_load_dwordx4 v[228:231], v4, s[8:11], s24 offen offset:640
    buffer_load_dwordx4 v[232:235], v4, s[8:11], s24 offen offset:1024
    buffer_load_dwordx4 v[236:239], v4, s[8:11], s24 offen offset:1152
    buffer_load_dwordx4 v[240:243], v4, s[8:11], s24 offen offset:1536
    buffer_load_dwordx4 v[244:247], v4, s[8:11], s24 offen offset:1664
    buffer_load_dwordx4 v[248:251], v4, s[8:11], s24 offen offset:2048
    buffer_load_dwordx4 v[252:255], v4, s[8:11], s24 offen offset:2176
    s_lshl_b32 s25, s13, 3
    v_add_u32 v10, s25, v10
    v_mul_u32_u24 v10, 640, v10
    v_lshl_add_u32 v10, v9, 7, v10
    v_lshl_add_u32 v10, v11, 4, v10
    v_add_u32 v3, 128, v10
    s_mul_i32 s17, s12, 20480
    s_mul_i32 s25, s14, 1638400
    s_add_u32 s17, s17, s25
    s_add_u32 s17, s17, 103809024
    s_mov_b32 s20, 1638400
    s_mul_i32 s19, s13, 10240
    s_add_u32 s19, s19, 220200960
    s_mov_b32 s22, 0
    s_mov_b32 s56, 0
    s_mov_b32 s58, 400000
    s_add_u32 s57, s48, 45056
    s_cmp_lg_u32 s13, 0
    s_cbranch_scc1 layerb1_kernel_gu_lw1
    s_min_u32 s28, s14, 63
    s_cmp_gt_u32 s56, s28
    s_cbranch_scc1 layerb1_kernel_gu_lw1
layerb1_kernel_gu_lp1:
    buffer_load_dwordx4 v[124:127], v1, s[8:11], s57 offen sc1
    s_waitcnt vmcnt(0)
    v_min_u32 v124, v124, v125
    v_min_u32 v126, v126, v127
    v_min_u32 v124, v124, v126
    v_cmp_eq_u32 vcc, 0, v124
    s_nop 1
    s_ff1_i32_b64 s56, vcc
    s_min_u32 s56, s56, 64
    s_sub_u32 s58, s58, 1
    s_cbranch_scc1 layerb1_kernel_bail
    s_cmp_gt_u32 s56, s28
    s_cbranch_scc0 layerb1_kernel_gu_lp1
layerb1_kernel_gu_lw1:
    s_barrier
    s_min_u32 s24, s14, 63
    s_mul_i32 s24, s24, 40960
    s_add_u32 s24, s24, s19
    s_mul_i32 s25, s13, 10240
    s_add_u32 s25, s25, s22
    s_mov_b32 m0, s25
    s_nop 0
    buffer_load_dwordx4 v1, s[8:11], s24 offen offset:0 sc1 lds
    buffer_load_dwordx4 v1, s[8:11], s24 offen offset:1024 sc1 lds
    buffer_load_dwordx4 v1, s[8:11], s24 offen offset:2048 sc1 lds
    buffer_load_dwordx4 v1, s[8:11], s24 offen offset:3072 sc1 lds
    s_add_u32 s24, s24, 4096
    s_add_u32 s25, s25, 4096
    s_mov_b32 m0, s25
    s_nop 0
    buffer_load_dwordx4 v1, s[8:11], s24 offen offset:0 sc1 lds
    buffer_load_dwordx4 v1, s[8:11], s24 offen offset:1024 sc1 lds
    buffer_load_dwordx4 v1, s[8:11], s24 offen offset:2048 sc1 lds
    buffer_load_dwordx4 v1, s[8:11], s24 offen offset:3072 sc1 lds
    s_add_u32 s24, s24, 4096
    s_add_u32 s25, s25, 4096
    s_mov_b32 m0, s25
    s_nop 0
    buffer_load_dwordx4 v1, s[8:11], s24 offen offset:0 sc1 lds
    buffer_load_dwordx4 v1, s[8:11], s24 offen offset:1024 sc1 lds
    s_mov_b32 s22, 40960
    s_mov_b32 s16, 0
    s_waitcnt vmcnt(0)
    s_barrier
    v_mov_b32 v2, v1
    ds_read_b128 v[8:11], v2 offset:0
    ds_read_b128 v[12:15], v2 offset:1024
    ds_read_b128 v[16:19], v2 offset:2048
    ds_read_b128 v[20:23], v2 offset:3072
    ds_read_b128 v[24:27], v2 offset:4096
    ds_read_b128 v[28:31], v2 offset:5120
    ds_read_b128 v[32:35], v2 offset:6144
    s_waitcnt lgkmcnt(6)
    v_mfma_f32_32x32x16_bf16 v[40:55], v[8:11], a[0:3], 0
    v_mfma_f32_32x32x16_bf16 v[56:71], v[8:11], a[4:7], 0
    ds_read_b128 v[36:39], v2 offset:7168
    s_waitcnt lgkmcnt(6)
    v_mfma_f32_32x32x16_bf16 v[40:55], v[12:15], a[8:11], v[40:55]
    v_mfma_f32_32x32x16_bf16 v[56:71], v[12:15], a[12:15], v[56:71]
    ds_read_b128 v[8:11], v2 offset:8192
    s_waitcnt lgkmcnt(6)
    v_mfma_f32_32x32x16_bf16 v[40:55], v[16:19], a[16:19], v[40:55]
    v_mfma_f32_32x32x16_bf16 v[56:71], v[16:19], a[20:23], v[56:71]
    ds_read_b128 v[12:15], v2 offset:9216
    s_waitcnt lgkmcnt(6)
    v_mfma_f32_32x32x16_bf16 v[40:55], v[20:23], a[24:27], v[40:55]
    v_mfma_f32_32x32x16_bf16 v[56:71], v[20:23], a[28:31], v[56:71]
    ds_read_b128 v[16:19], v2 offset:10240
    s_waitcnt lgkmcnt(6)
    v_mfma_f32_32x32x16_bf16 v[40:55], v[24:27], a[32:35], v[40:55]
    v_mfma_f32_32x32x16_bf16 v[56:71], v[24:27], a[36:39], v[56:71]
    ds_read_b128 v[20:23], v2 offset:11264
    s_waitcnt lgkmcnt(6)
    v_mfma_f32_32x32x16_bf16 v[40:55], v[28:31], a[40:43], v[40:55]
    v_mfma_f32_32x32x16_bf16 v[56:71], v[28:31], a[44:47], v[56:71]
    ds_read_b128 v[24:27], v2 offset:12288
    s_waitcnt lgkmcnt(6)
    v_mfma_f32_32x32x16_bf16 v[40:55], v[32:35], a[48:51], v[40:55]
    v_mfma_f32_32x32x16_bf16 v[56:71], v[32:35], a[52:55], v[56:71]
    s_add_u32 s23, s14, 1
    s_cmp_lg_u32 s13, 0
    s_cbranch_scc1 layerb1_kernel_gu_lw2
    s_min_u32 s28, s23, 63
    s_cmp_gt_u32 s56, s28
    s_cbranch_scc1 layerb1_kernel_gu_lw2
layerb1_kernel_gu_lp2:
    buffer_load_dwordx4 v[124:127], v1, s[8:11], s57 offen sc1
    s_waitcnt vmcnt(0)
    v_min_u32 v124, v124, v125
    v_min_u32 v126, v126, v127
    v_min_u32 v124, v124, v126
    v_cmp_eq_u32 vcc, 0, v124
    s_nop 1
    s_ff1_i32_b64 s56, vcc
    s_min_u32 s56, s56, 64
    s_sub_u32 s58, s58, 1
    s_cbranch_scc1 layerb1_kernel_bail
    s_cmp_gt_u32 s56, s28
    s_cbranch_scc0 layerb1_kernel_gu_lp2
layerb1_kernel_gu_lw2:
    s_barrier
    s_min_u32 s24, s23, 63
    s_mul_i32 s24, s24, 40960
    s_add_u32 s24, s24, s19
    s_mul_i32 s25, s13, 10240
    s_add_u32 s25, s25, s22
    s_add_u32 s22, s22, 40960
    s_cmp_eq_u32 s22, 122880
    s_cselect_b32 s22, 0, s22
    ds_read_b128 v[28:31], v2 offset:13312
    s_waitcnt lgkmcnt(6)
    v_mfma_f32_32x32x16_bf16 v[40:55], v[36:39], a[56:59], v[40:55]
    s_mov_b32 m0, s25
    s_nop 0
    buffer_load_dwordx4 v1, s[8:11], s24 offen offset:0 sc1 lds
    v_mfma_f32_32x32x16_bf16 v[56:71], v[36:39], a[60:63], v[56:71]
    ds_read_b128 v[32:35], v2 offset:14336
    s_waitcnt lgkmcnt(6)
    v_mfma_f32_32x32x16_bf16 v[40:55], v[8:11], a[64:67], v[40:55]
    buffer_load_dwordx4 v1, s[8:11], s24 offen offset:1024 sc1 lds
    v_mfma_f32_32x32x16_bf16 v[56:71], v[8:11], a[68:71], v[56:71]
    ds_read_b128 v[36:39], v2 offset:15360
    s_waitcnt lgkmcnt(6)
    v_mfma_f32_32x32x16_bf16 v[40:55], v[12:15], a[72:75], v[40:55]
    buffer_load_dwordx4 v1, s[8:11], s24 offen offset:2048 sc1 lds
    v_mfma_f32_32x32x16_bf16 v[56:71], v[12:15], a[76:79], v[56:71]
    ds_read_b128 v[8:11], v2 offset:16384
    s_waitcnt lgkmcnt(6)
    v_mfma_f32_32x32x16_bf16 v[40:55], v[16:19], a[80:83], v[40:55]
    buffer_load_dwordx4 v1, s[8:11], s24 offen offset:3072 sc1 lds
    v_mfma_f32_32x32x16_bf16 v[56:71], v[16:19], a[84:87], v[56:71]
    ds_read_b128 v[12:15], v2 offset:17408
    s_waitcnt lgkmcnt(6)
    v_mfma_f32_32x32x16_bf16 v[40:55], v[20:23], a[88:91], v[40:55]
    s_add_u32 s24, s24, 4096
    s_add_u32 s25, s25, 4096
    s_mov_b32 m0, s25
    s_nop 0
    buffer_load_dwordx4 v1, s[8:11], s24 offen offset:0 sc1 lds
    v_mfma_f32_32x32x16_bf16 v[56:71], v[20:23], a[92:95], v[56:71]
    ds_read_b128 v[16:19], v2 offset:18432
    s_waitcnt lgkmcnt(6)
    v_mfma_f32_32x32x16_bf16 v[40:55], v[24:27], a[96:99], v[40:55]
    buffer_load_dwordx4 v1, s[8:11], s24 offen offset:1024 sc1 lds
    v_mfma_f32_32x32x16_bf16 v[56:71], v[24:27], a[100:103], v[56:71]
    ds_read_b128 v[20:23], v2 offset:19456
    s_waitcnt lgkmcnt(6)
    v_mfma_f32_32x32x16_bf16 v[40:55], v[28:31], a[104:107], v[40:55]
    buffer_load_dwordx4 v1, s[8:11], s24 offen offset:2048 sc1 lds
    v_mfma_f32_32x32x16_bf16 v[56:71], v[28:31], a[108:111], v[56:71]
    ds_read_b128 v[24:27], v2 offset:20480
    s_waitcnt lgkmcnt(6)
    v_mfma_f32_32x32x16_bf16 v[40:55], v[32:35], a[112:115], v[40:55]
    buffer_load_dwordx4 v1, s[8:11], s24 offen offset:3072 sc1 lds
    v_mfma_f32_32x32x16_bf16 v[56:71], v[32:35], a[116:119], v[56:71]
    ds_read_b128 v[28:31], v2 offset:21504
    s_waitcnt lgkmcnt(6)
    v_mfma_f32_32x32x16_bf16 v[40:55], v[36:39], a[120:123], v[40:55]
    s_add_u32 s24, s24, 4096
    s_add_u32 s25, s25, 4096
    s_mov_b32 m0, s25
    s_nop 0
    buffer_load_dwordx4 v1, s[8:11], s24 offen offset:0 sc1 lds
    v_mfma_f32_32x32x16_bf16 v[56:71], v[36:39], a[124:127], v[56:71]
    ds_read_b128 v[32:35], v2 offset:22528
    s_waitcnt lgkmcnt(6)
    v_mfma_f32_32x32x16_bf16 v[40:55], v[8:11], a[128:131], v[40:55]
    buffer_load_dwordx4 v1, s[8:11], s24 offen offset:1024 sc1 lds
    v_mfma_f32_32x32x16_bf16 v[56:71], v[8:11], a[132:135], v[56:71]
    ds_read_b128 v[36:39], v2 offset:23552
    s_waitcnt lgkmcnt(6)
    v_mfma_f32_32x32x16_bf16 v[40:55], v[12:15], a[136:139], v[40:55]
    v_mfma_f32_32x32x16_bf16 v[56:71], v[12:15], a[140:143], v[56:71]
    ds_read_b128 v[8:11], v2 offset:24576
    s_waitcnt lgkmcnt(6)
    v_mfma_f32_32x32x16_bf16 v[40:55], v[16:19], a[144:147], v[40:55]
    v_mfma_f32_32x32x16_bf16 v[56:71], v[16:19], a[148:151], v[56:71]
    ds_read_b128 v[12:15], v2 offset:25600
    s_waitcnt lgkmcnt(6)
    v_mfma_f32_32x32x16_bf16 v[40:55], v[20:23], a[152:155], v[40:55]
    v_mfma_f32_32x32x16_bf16 v[56:71], v[20:23], a[156:159], v[56:71]
    ds_read_b128 v[16:19], v2 offset:26624
    s_waitcnt lgkmcnt(6)
    v_mfma_f32_32x32x16_bf16 v[40:55], v[24:27], a[160:163], v[40:55]
    v_mfma_f32_32x32x16_bf16 v[56:71], v[24:27], a[164:167], v[56:71]
    ds_read_b128 v[20:23], v2 offset:27648
    s_waitcnt lgkmcnt(6)
    v_mfma_f32_32x32x16_bf16 v[40:55], v[28:31], a[168:171], v[40:55]
    v_mfma_f32_32x32x16_bf16 v[56:71], v[28:31], a[172:175], v[56:71]
    ds_read_b128 v[24:27], v2 offset:28672
    s_waitcnt lgkmcnt(6)
    v_mfma_f32_32x32x16_bf16 v[40:55], v[32:35], a[176:179], v[40:55]
    v_mfma_f32_32x32x16_bf16 v[56:71], v[32:35], a[180:183], v[56:71]
    ds_read_b128 v[28:31], v2 offset:29696
    s_waitcnt lgkmcnt(6)
    v_mfma_f32_32x32x16_bf16 v[40:55], v[36:39], a[184:187], v[40:55]
    v_mfma_f32_32x32x16_bf16 v[56:71], v[36:39], a[188:191], v[56:71]
    ds_read_b128 v[32:35], v2 offset:30720
    s_waitcnt lgkmcnt(6)
    v_mfma_f32_32x32x16_bf16 v[40:55], v[8:11], a[192:195], v[40:55]
    v_mfma_f32_32x32x16_bf16 v[56:71], v[8:11], a[196:199], v[56:71]
    ds_read_b128 v[36:39], v2 offset:31744
    s_waitcnt lgkmcnt(6)
    v_mfma_f32_32x32x16_bf16 v[40:55], v[12:15], a[200:203], v[40:55]
    v_mfma_f32_32x32x16_bf16 v[56:71], v[12:15], a[204:207], v[56:71]
    ds_read_b128 v[8:11], v2 offset:32768
    s_waitcnt lgkmcnt(6)
    v_mfma_f32_32x32x16_bf16 v[40:55], v[16:19], a[208:211], v[40:55]
    v_mfma_f32_32x32x16_bf16 v[56:71], v[16:19], a[212:215], v[56:71]
    ds_read_b128 v[12:15], v2 offset:33792
    s_waitcnt lgkmcnt(6)
    v_mfma_f32_32x32x16_bf16 v[40:55], v[20:23], a[216:219], v[40:55]
    v_mfma_f32_32x32x16_bf16 v[56:71], v[20:23], a[220:223], v[56:71]
    ds_read_b128 v[16:19], v2 offset:34816
    s_waitcnt lgkmcnt(6)
    v_mfma_f32_32x32x16_bf16 v[40:55], v[24:27], a[224:227], v[40:55]
    v_mfma_f32_32x32x16_bf16 v[56:71], v[24:27], a[228:231], v[56:71]
    s_waitcnt vmcnt(0)
    s_barrier
    s_add_u32 s21, s16, 40960
    s_cmp_eq_u32 s21, 122880
    s_cselect_b32 s21, 0, s21
    ds_read_b128 v[20:23], v2 offset:35840
    s_waitcnt lgkmcnt(6)
    v_mfma_f32_32x32x16_bf16 v[40:55], v[28:31], a[232:235], v[40:55]
    v_mfma_f32_32x32x16_bf16 v[56:71], v[28:31], a[236:239], v[56:71]
    ds_read_b128 v[24:27], v2 offset:36864
    s_waitcnt lgkmcnt(6)
    v_mfma_f32_32x32x16_bf16 v[40:55], v[32:35], a[240:243], v[40:55]
    v_mfma_f32_32x32x16_bf16 v[56:71], v[32:35], a[244:247], v[56:71]
    ds_read_b128 v[28:31], v2 offset:37888
    s_waitcnt lgkmcnt(6)
    v_mfma_f32_32x32x16_bf16 v[40:55], v[36:39], a[248:251], v[40:55]
    v_mfma_f32_32x32x16_bf16 v[56:71], v[36:39], a[252:255], v[56:71]
    ds_read_b128 v[32:35], v2 offset:38912
    s_waitcnt lgkmcnt(6)
    v_mfma_f32_32x32x16_bf16 v[40:55], v[8:11], v[192:195], v[40:55]
    v_mfma_f32_32x32x16_bf16 v[56:71], v[8:11], v[196:199], v[56:71]
    ds_read_b128 v[36:39], v2 offset:39936
    s_waitcnt lgkmcnt(6)
    v_mfma_f32_32x32x16_bf16 v[40:55], v[12:15], v[200:203], v[40:55]
    v_mfma_f32_32x32x16_bf16 v[56:71], v[12:15], v[204:207], v[56:71]
    v_add_u32 v6, s21, v1
    ds_read_b128 v[8:11], v6 offset:0
    s_waitcnt lgkmcnt(6)
    v_mfma_f32_32x32x16_bf16 v[40:55], v[16:19], v[208:211], v[40:55]
    v_mfma_f32_32x32x16_bf16 v[56:71], v[16:19], v[212:215], v[56:71]
    ds_read_b128 v[12:15], v6 offset:1024
    s_waitcnt lgkmcnt(6)
    v_mfma_f32_32x32x16_bf16 v[40:55], v[20:23], v[216:219], v[40:55]
    v_mfma_f32_32x32x16_bf16 v[56:71], v[20:23], v[220:223], v[56:71]
    ds_read_b128 v[16:19], v6 offset:2048
    s_waitcnt lgkmcnt(6)
    v_mfma_f32_32x32x16_bf16 v[40:55], v[24:27], v[224:227], v[40:55]
    v_mfma_f32_32x32x16_bf16 v[56:71], v[24:27], v[228:231], v[56:71]
    ds_read_b128 v[20:23], v6 offset:3072
    s_waitcnt lgkmcnt(6)
    v_mfma_f32_32x32x16_bf16 v[40:55], v[28:31], v[232:235], v[40:55]
    v_mfma_f32_32x32x16_bf16 v[56:71], v[28:31], v[236:239], v[56:71]
    ds_read_b128 v[24:27], v6 offset:4096
    s_waitcnt lgkmcnt(6)
    v_mfma_f32_32x32x16_bf16 v[40:55], v[32:35], v[240:243], v[40:55]
    v_mfma_f32_32x32x16_bf16 v[56:71], v[32:35], v[244:247], v[56:71]
    ds_read_b128 v[28:31], v6 offset:5120
    s_waitcnt lgkmcnt(6)
    v_mfma_f32_32x32x16_bf16 v[40:55], v[36:39], v[248:251], v[40:55]
    v_mfma_f32_32x32x16_bf16 v[56:71], v[36:39], v[252:255], v[56:71]
    v_mov_b32 v2, v6
    s_mov_b32 s16, s21
    s_add_u32 s14, s14, 1
    s_nop 7
    s_nop 7
    v_cvt_pk_bf16_f32 v104, v40, v41
    v_cvt_pk_bf16_f32 v105, v42, v43
    v_cvt_pk_bf16_f32 v106, v44, v45
    v_cvt_pk_bf16_f32 v107, v46, v47
    s_nop 1
    v_permlane32_swap_b32 v104, v106
    v_permlane32_swap_b32 v105, v107
    buffer_store_dwordx4 v[104:107], v3, s[8:11], s17 offen offset:0 sc1
    v_cvt_pk_bf16_f32 v108, v48, v49
    v_cvt_pk_bf16_f32 v109, v50, v51
    v_cvt_pk_bf16_f32 v110, v52, v53
    v_cvt_pk_bf16_f32 v111, v54, v55
    s_nop 1
    v_permlane32_swap_b32 v108, v110
    v_permlane32_swap_b32 v109, v111
    buffer_store_dwordx4 v[108:111], v3, s[8:11], s17 offen offset:256 sc1
    v_cvt_pk_bf16_f32 v112, v56, v57
    v_cvt_pk_bf16_f32 v113, v58, v59
    v_cvt_pk_bf16_f32 v114, v60, v61
    v_cvt_pk_bf16_f32 v115, v62, v63
    s_nop 1
    v_permlane32_swap_b32 v112, v114
    v_permlane32_swap_b32 v113, v115
    buffer_store_dwordx4 v[112:115], v3, s[8:11], s17 offen offset:2560 sc1
    v_cvt_pk_bf16_f32 v116, v64, v65
    v_cvt_pk_bf16_f32 v117, v66, v67
    v_cvt_pk_bf16_f32 v118, v68, v69
    v_cvt_pk_bf16_f32 v119, v70, v71
    s_nop 1
    v_permlane32_swap_b32 v116, v118
    v_permlane32_swap_b32 v117, v119
    buffer_store_dwordx4 v[116:119], v3, s[8:11], s17 offen offset:2816 sc1
    s_add_u32 s17, s17, s20
    s_add_u32 s18, s18, s20
    s_waitcnt vmcnt(0)
    s_barrier
    s_cmp_lg_u32 s13, 0
    s_cbranch_scc1 layerb1_kernel_gu_fl3
    s_mov_b64 exec, 1
    s_lshl_b32 s26, s12, 7
    v_mov_b32 v7, s26
    v_mov_b32 v120, s14
    buffer_store_dword v120, v7, s[8:11], s48 offen sc1
    s_mov_b64 exec, -1
layerb1_kernel_gu_fl3:
    ds_read_b128 v[32:35], v2 offset:6144
    s_waitcnt lgkmcnt(6)
    v_mfma_f32_32x32x16_bf16 v[72:87], v[8:11], a[0:3], 0
    v_mfma_f32_32x32x16_bf16 v[88:103], v[8:11], a[4:7], 0
    ds_read_b128 v[36:39], v2 offset:7168
    s_waitcnt lgkmcnt(6)
    v_mfma_f32_32x32x16_bf16 v[72:87], v[12:15], a[8:11], v[72:87]
    v_mfma_f32_32x32x16_bf16 v[88:103], v[12:15], a[12:15], v[88:103]
    ds_read_b128 v[8:11], v2 offset:8192
    s_waitcnt lgkmcnt(6)
    v_mfma_f32_32x32x16_bf16 v[72:87], v[16:19], a[16:19], v[72:87]
    v_mfma_f32_32x32x16_bf16 v[88:103], v[16:19], a[20:23], v[88:103]
    s_add_u32 s23, s14, 1
    s_cmp_lg_u32 s13, 0
    s_cbranch_scc1 layerb1_kernel_gu_lw4
    s_min_u32 s28, s23, 63
    s_cmp_gt_u32 s56, s28
    s_cbranch_scc1 layerb1_kernel_gu_lw4
layerb1_kernel_gu_lp4:
    buffer_load_dwordx4 v[124:127], v1, s[8:11], s57 offen sc1
    s_waitcnt vmcnt(0)
    v_min_u32 v124, v124, v125
    v_min_u32 v126, v126, v127
    v_min_u32 v124, v124, v126
    v_cmp_eq_u32 vcc, 0, v124
    s_nop 1
    s_ff1_i32_b64 s56, vcc
    s_min_u32 s56, s56, 64
    s_sub_u32 s58, s58, 1
    s_cbranch_scc1 layerb1_kernel_bail
    s_cmp_gt_u32 s56, s28
    s_cbranch_scc0 layerb1_kernel_gu_lp4
layerb1_kernel_gu_lw4:
    s_barrier
    s_min_u32 s24, s23, 63
    s_mul_i32 s24, s24, 40960
    s_add_u32 s24, s24, s19
    s_mul_i32 s25, s13, 10240
    s_add_u32 s25, s25, s22
    s_add_u32 s22, s22, 40960
    s_cmp_eq_u32 s22, 122880
    s_cselect_b32 s22, 0, s22
    ds_read_b128 v[12:15], v2 offset:9216
    s_waitcnt lgkmcnt(6)
    v_mfma_f32_32x32x16_bf16 v[72:87], v[20:23], a[24:27], v[72:87]
    s_mov_b32 m0, s25
    s_nop 0
    buffer_load_dwordx4 v1, s[8:11], s24 offen offset:0 sc1 lds
    v_mfma_f32_32x32x16_bf16 v[88:103], v[20:23], a[28:31], v[88:103]
    ds_read_b128 v[16:19], v2 offset:10240
    s_waitcnt lgkmcnt(6)
    v_mfma_f32_32x32x16_bf16 v[72:87], v[24:27], a[32:35], v[72:87]
    buffer_load_dwordx4 v1, s[8:11], s24 offen offset:1024 sc1 lds
    v_mfma_f32_32x32x16_bf16 v[88:103], v[24:27], a[36:39], v[88:103]
    ds_read_b128 v[20:23], v2 offset:11264
    s_waitcnt lgkmcnt(6)
    v_mfma_f32_32x32x16_bf16 v[72:87], v[28:31], a[40:43], v[72:87]
    buffer_load_dwordx4 v1, s[8:11], s24 offen offset:2048 sc1 lds
    v_mfma_f32_32x32x16_bf16 v[88:103], v[28:31], a[44:47], v[88:103]
    ds_read_b128 v[24:27], v2 offset:12288
    s_waitcnt lgkmcnt(6)
    v_mfma_f32_32x32x16_bf16 v[72:87], v[32:35], a[48:51], v[72:87]
    buffer_load_dwordx4 v1, s[8:11], s24 offen offset:3072 sc1 lds
    v_mfma_f32_32x32x16_bf16 v[88:103], v[32:35], a[52:55], v[88:103]
    ds_read_b128 v[28:31], v2 offset:13312
    s_waitcnt lgkmcnt(6)
    v_mfma_f32_32x32x16_bf16 v[72:87], v[36:39], a[56:59], v[72:87]
    s_add_u32 s24, s24, 4096
    s_add_u32 s25, s25, 4096
    s_mov_b32 m0, s25
    s_nop 0
    buffer_load_dwordx4 v1, s[8:11], s24 offen offset:0 sc1 lds
    v_mfma_f32_32x32x16_bf16 v[88:103], v[36:39], a[60:63], v[88:103]
    ds_read_b128 v[32:35], v2 offset:14336
    s_waitcnt lgkmcnt(6)
    v_mfma_f32_32x32x16_bf16 v[72:87], v[8:11], a[64:67], v[72:87]
    buffer_load_dwordx4 v1, s[8:11], s24 offen offset:1024 sc1 lds
    v_mfma_f32_32x32x16_bf16 v[88:103], v[8:11], a[68:71], v[88:103]
    ds_read_b128 v[36:39], v2 offset:15360
    s_waitcnt lgkmcnt(6)
    v_mfma_f32_32x32x16_bf16 v[72:87], v[12:15], a[72:75], v[72:87]
    buffer_load_dwordx4 v1, s[8:11], s24 offen offset:2048 sc1 lds
    v_mfma_f32_32x32x16_bf16 v[88:103], v[12:15], a[76:79], v[88:103]
    ds_read_b128 v[8:11], v2 offset:16384
    s_waitcnt lgkmcnt(6)
    v_mfma_f32_32x32x16_bf16 v[72:87], v[16:19], a[80:83], v[72:87]
    buffer_load_dwordx4 v1, s[8:11], s24 offen offset:3072 sc1 lds
    v_mfma_f32_32x32x16_bf16 v[88:103], v[16:19], a[84:87], v[88:103]
    ds_read_b128 v[12:15], v2 offset:17408
    s_waitcnt lgkmcnt(6)
    v_mfma_f32_32x32x16_bf16 v[72:87], v[20:23], a[88:91], v[72:87]
    s_add_u32 s24, s24, 4096
    s_add_u32 s25, s25, 4096
    s_mov_b32 m0, s25
    s_nop 0
    buffer_load_dwordx4 v1, s[8:11], s24 offen offset:0 sc1 lds
    v_mfma_f32_32x32x16_bf16 v[88:103], v[20:23], a[92:95], v[88:103]
    ds_read_b128 v[16:19], v2 offset:18432
    s_waitcnt lgkmcnt(6)
    v_mfma_f32_32x32x16_bf16 v[72:87], v[24:27], a[96:99], v[72:87]
    buffer_load_dwordx4 v1, s[8:11], s24 offen offset:1024 sc1 lds
    v_mfma_f32_32x32x16_bf16 v[88:103], v[24:27], a[100:103], v[88:103]
    ds_read_b128 v[20:23], v2 offset:19456
    s_waitcnt lgkmcnt(6)
    v_mfma_f32_32x32x16_bf16 v[72:87], v[28:31], a[104:107], v[72:87]
    v_mfma_f32_32x32x16_bf16 v[88:103], v[28:31], a[108:111], v[88:103]
    ds_read_b128 v[24:27], v2 offset:20480
    s_waitcnt lgkmcnt(6)
    v_mfma_f32_32x32x16_bf16 v[72:87], v[32:35], a[112:115], v[72:87]
    v_mfma_f32_32x32x16_bf16 v[88:103], v[32:35], a[116:119], v[88:103]
    ds_read_b128 v[28:31], v2 offset:21504
    s_waitcnt lgkmcnt(6)
    v_mfma_f32_32x32x16_bf16 v[72:87], v[36:39], a[120:123], v[72:87]
    v_mfma_f32_32x32x16_bf16 v[88:103], v[36:39], a[124:127], v[88:103]
    ds_read_b128 v[32:35], v2 offset:22528
    s_waitcnt lgkmcnt(6)
    v_mfma_f32_32x32x16_bf16 v[72:87], v[8:11], a[128:131], v[72:87]
    v_mfma_f32_32x32x16_bf16 v[88:103], v[8:11], a[132:135], v[88:103]
    ds_read_b128 v[36:39], v2 offset:23552
    s_waitcnt lgkmcnt(6)
    v_mfma_f32_32x32x16_bf16 v[72:87], v[12:15], a[136:139], v[72:87]
    v_mfma_f32_32x32x16_bf16 v[88:103], v[12:15], a[140:143], v[88:103]
    ds_read_b128 v[8:11], v2 offset:24576
    s_waitcnt lgkmcnt(6)
    v_mfma_f32_32x32x16_bf16 v[72:87], v[16:19], a[144:147], v[72:87]
    v_mfma_f32_32x32x16_bf16 v[88:103], v[16:19], a[148:151], v[88:103]
    ds_read_b128 v[12:15], v2 offset:25600
    s_waitcnt lgkmcnt(6)
    v_mfma_f32_32x32x16_bf16 v[72:87], v[20:23], a[152:155], v[72:87]
    v_mfma_f32_32x32x16_bf16 v[88:103], v[20:23], a[156:159], v[88:103]
    ds_read_b128 v[16:19], v2 offset:26624
    s_waitcnt lgkmcnt(6)
    v_mfma_f32_32x32x16_bf16 v[72:87], v[24:27], a[160:163], v[72:87]
    v_mfma_f32_32x32x16_bf16 v[88:103], v[24:27], a[164:167], v[88:103]
    ds_read_b128 v[20:23], v2 offset:27648
    s_waitcnt lgkmcnt(6)
    v_mfma_f32_32x32x16_bf16 v[72:87], v[28:31], a[168:171], v[72:87]
    v_mfma_f32_32x32x16_bf16 v[88:103], v[28:31], a[172:175], v[88:103]
    ds_read_b128 v[24:27], v2 offset:28672
    s_waitcnt lgkmcnt(6)
    v_mfma_f32_32x32x16_bf16 v[72:87], v[32:35], a[176:179], v[72:87]
    v_mfma_f32_32x32x16_bf16 v[88:103], v[32:35], a[180:183], v[88:103]
    ds_read_b128 v[28:31], v2 offset:29696
    s_waitcnt lgkmcnt(6)
    v_mfma_f32_32x32x16_bf16 v[72:87], v[36:39], a[184:187], v[72:87]
    v_mfma_f32_32x32x16_bf16 v[88:103], v[36:39], a[188:191], v[88:103]
    ds_read_b128 v[32:35], v2 offset:30720
    s_waitcnt lgkmcnt(6)
    v_mfma_f32_32x32x16_bf16 v[72:87], v[8:11], a[192:195], v[72:87]
    v_mfma_f32_32x32x16_bf16 v[88:103], v[8:11], a[196:199], v[88:103]
    ds_read_b128 v[36:39], v2 offset:31744
    s_waitcnt lgkmcnt(6)
    v_mfma_f32_32x32x16_bf16 v[72:87], v[12:15], a[200:203], v[72:87]
    v_mfma_f32_32x32x16_bf16 v[88:103], v[12:15], a[204:207], v[88:103]
    ds_read_b128 v[8:11], v2 offset:32768
    s_waitcnt lgkmcnt(6)
    v_mfma_f32_32x32x16_bf16 v[72:87], v[16:19], a[208:211], v[72:87]
    v_mfma_f32_32x32x16_bf16 v[88:103], v[16:19], a[212:215], v[88:103]
    ds_read_b128 v[12:15], v2 offset:33792
    s_waitcnt lgkmcnt(6)
    v_mfma_f32_32x32x16_bf16 v[72:87], v[20:23], a[216:219], v[72:87]
    v_mfma_f32_32x32x16_bf16 v[88:103], v[20:23], a[220:223], v[88:103]
    ds_read_b128 v[16:19], v2 offset:34816
    s_waitcnt lgkmcnt(6)
    v_mfma_f32_32x32x16_bf16 v[72:87], v[24:27], a[224:227], v[72:87]
    v_mfma_f32_32x32x16_bf16 v[88:103], v[24:27], a[228:231], v[88:103]
    s_add_u32 s23, s14, 2
    s_cmp_lg_u32 s13, 0
    s_cbranch_scc1 layerb1_kernel_gu_lw5
    s_min_u32 s28, s23, 63
    s_cmp_gt_u32 s56, s28
    s_cbranch_scc1 layerb1_kernel_gu_lw5
layerb1_kernel_gu_lp5:
    buffer_load_dwordx4 v[124:127], v1, s[8:11], s57 offen sc1
    s_waitcnt vmcnt(0)
    v_min_u32 v124, v124, v125
    v_min_u32 v126, v126, v127
    v_min_u32 v124, v124, v126
    v_cmp_eq_u32 vcc, 0, v124
    s_nop 1
    s_ff1_i32_b64 s56, vcc
    s_min_u32 s56, s56, 64
    s_sub_u32 s58, s58, 1
    s_cbranch_scc1 layerb1_kernel_bail
    s_cmp_gt_u32 s56, s28
    s_cbranch_scc0 layerb1_kernel_gu_lp5
layerb1_kernel_gu_lw5:
    s_waitcnt vmcnt(0)
    s_barrier
    s_add_u32 s21, s16, 40960
    s_cmp_eq_u32 s21, 122880
    s_cselect_b32 s21, 0, s21
    s_add_u32 s23, s14, 2
    s_min_u32 s24, s23, 63
    s_mul_i32 s24, s24, 40960
    s_add_u32 s24, s24, s19
    s_mul_i32 s25, s13, 10240
    s_add_u32 s25, s25, s22
    s_add_u32 s22, s22, 40960
    s_cmp_eq_u32 s22, 122880
    s_cselect_b32 s22, 0, s22
    ds_read_b128 v[20:23], v2 offset:35840
    s_waitcnt lgkmcnt(6)
    v_mfma_f32_32x32x16_bf16 v[72:87], v[28:31], a[232:235], v[72:87]
    s_mov_b32 m0, s25
    s_nop 0
    buffer_load_dwordx4 v1, s[8:11], s24 offen offset:0 sc1 lds
    v_mfma_f32_32x32x16_bf16 v[88:103], v[28:31], a[236:239], v[88:103]
    ds_read_b128 v[24:27], v2 offset:36864
    s_waitcnt lgkmcnt(6)
    v_mfma_f32_32x32x16_bf16 v[72:87], v[32:35], a[240:243], v[72:87]
    buffer_load_dwordx4 v1, s[8:11], s24 offen offset:1024 sc1 lds
    v_mfma_f32_32x32x16_bf16 v[88:103], v[32:35], a[244:247], v[88:103]
    ds_read_b128 v[28:31], v2 offset:37888
    s_waitcnt lgkmcnt(6)
    v_mfma_f32_32x32x16_bf16 v[72:87], v[36:39], a[248:251], v[72:87]
    buffer_load_dwordx4 v1, s[8:11], s24 offen offset:2048 sc1 lds
    v_mfma_f32_32x32x16_bf16 v[88:103], v[36:39], a[252:255], v[88:103]
    ds_read_b128 v[32:35], v2 offset:38912
    s_waitcnt lgkmcnt(6)
    v_mfma_f32_32x32x16_bf16 v[72:87], v[8:11], v[192:195], v[72:87]
    buffer_load_dwordx4 v1, s[8:11], s24 offen offset:3072 sc1 lds
    v_mfma_f32_32x32x16_bf16 v[88:103], v[8:11], v[196:199], v[88:103]
    ds_read_b128 v[36:39], v2 offset:39936
    s_waitcnt lgkmcnt(6)
    v_mfma_f32_32x32x16_bf16 v[72:87], v[12:15], v[200:203], v[72:87]
    s_add_u32 s24, s24, 4096
    s_add_u32 s25, s25, 4096
    s_mov_b32 m0, s25
    s_nop 0
    buffer_load_dwordx4 v1, s[8:11], s24 offen offset:0 sc1 lds
    v_mfma_f32_32x32x16_bf16 v[88:103], v[12:15], v[204:207], v[88:103]
    v_add_u32 v6, s21, v1
    ds_read_b128 v[8:11], v6 offset:0
    s_waitcnt lgkmcnt(6)
    v_mfma_f32_32x32x16_bf16 v[72:87], v[16:19], v[208:211], v[72:87]
    buffer_load_dwordx4 v1, s[8:11], s24 offen offset:1024 sc1 lds
    v_mfma_f32_32x32x16_bf16 v[88:103], v[16:19], v[212:215], v[88:103]
    ds_read_b128 v[12:15], v6 offset:1024
    s_waitcnt lgkmcnt(6)
    v_mfma_f32_32x32x16_bf16 v[72:87], v[20:23], v[216:219], v[72:87]
    buffer_load_dwordx4 v1, s[8:11], s24 offen offset:2048 sc1 lds
    v_mfma_f32_32x32x16_bf16 v[88:103], v[20:23], v[220:223], v[88:103]
    ds_read_b128 v[16:19], v6 offset:2048
    s_waitcnt lgkmcnt(6)
    v_mfma_f32_32x32x16_bf16 v[72:87], v[24:27], v[224:227], v[72:87]
    buffer_load_dwordx4 v1, s[8:11], s24 offen offset:3072 sc1 lds
    v_mfma_f32_32x32x16_bf16 v[88:103], v[24:27], v[228:231], v[88:103]
    ds_read_b128 v[20:23], v6 offset:3072
    s_waitcnt lgkmcnt(6)
    v_mfma_f32_32x32x16_bf16 v[72:87], v[28:31], v[232:235], v[72:87]
    s_add_u32 s24, s24, 4096
    s_add_u32 s25, s25, 4096
    s_mov_b32 m0, s25
    s_nop 0
    buffer_load_dwordx4 v1, s[8:11], s24 offen offset:0 sc1 lds
    v_mfma_f32_32x32x16_bf16 v[88:103], v[28:31], v[236:239], v[88:103]
    ds_read_b128 v[24:27], v6 offset:4096
    s_waitcnt lgkmcnt(6)
    v_mfma_f32_32x32x16_bf16 v[72:87], v[32:35], v[240:243], v[72:87]
    buffer_load_dwordx4 v1, s[8:11], s24 offen offset:1024 sc1 lds
    v_mfma_f32_32x32x16_bf16 v[88:103], v[32:35], v[244:247], v[88:103]
    ds_read_b128 v[28:31], v6 offset:5120
    s_waitcnt lgkmcnt(6)
    v_mfma_f32_32x32x16_bf16 v[72:87], v[36:39], v[248:251], v[72:87]
    v_mfma_f32_32x32x16_bf16 v[88:103], v[36:39], v[252:255], v[88:103]
    v_mov_b32 v2, v6
    s_mov_b32 s16, s21
    s_add_u32 s14, s14, 1
layerb1_kernel_gu_loop:
    ds_read_b128 v[32:35], v2 offset:6144
    s_waitcnt lgkmcnt(6)
    v_mfma_f32_32x32x16_bf16 v[40:55], v[8:11], a[0:3], 0
    v_mfma_f32_32x32x16_bf16 v[56:71], v[8:11], a[4:7], 0
    ds_read_b128 v[36:39], v2 offset:7168
    s_waitcnt lgkmcnt(6)
    v_mfma_f32_32x32x16_bf16 v[40:55], v[12:15], a[8:11], v[40:55]
    v_mfma_f32_32x32x16_bf16 v[56:71], v[12:15], a[12:15], v[56:71]
    ds_read_b128 v[8:11], v2 offset:8192
    s_waitcnt lgkmcnt(6)
    v_mfma_f32_32x32x16_bf16 v[40:55], v[16:19], a[16:19], v[40:55]
    v_cvt_pk_bf16_f32 v104, v72, v73
    v_mfma_f32_32x32x16_bf16 v[56:71], v[16:19], a[20:23], v[56:71]
    v_cvt_pk_bf16_f32 v105, v74, v75
    ds_read_b128 v[12:15], v2 offset:9216
    s_waitcnt lgkmcnt(6)
    v_mfma_f32_32x32x16_bf16 v[40:55], v[20:23], a[24:27], v[40:55]
    v_cvt_pk_bf16_f32 v106, v76, v77
    v_mfma_f32_32x32x16_bf16 v[56:71], v[20:23], a[28:31], v[56:71]
    v_cvt_pk_bf16_f32 v107, v78, v79
    ds_read_b128 v[16:19], v2 offset:10240
    s_waitcnt lgkmcnt(6)
    v_mfma_f32_32x32x16_bf16 v[40:55], v[24:27], a[32:35], v[40:55]
    s_nop 1
    v_mfma_f32_32x32x16_bf16 v[56:71], v[24:27], a[36:39], v[56:71]
    v_permlane32_swap_b32 v104, v106
    ds_read_b128 v[20:23], v2 offset:11264
    s_waitcnt lgkmcnt(6)
    v_mfma_f32_32x32x16_bf16 v[40:55], v[28:31], a[40:43], v[40:55]
    v_permlane32_swap_b32 v105, v107
    v_mfma_f32_32x32x16_bf16 v[56:71], v[28:31], a[44:47], v[56:71]
    buffer_store_dwordx4 v[104:107], v3, s[8:11], s17 offen offset:0 sc1
    ds_read_b128 v[24:27], v2 offset:12288
    s_waitcnt lgkmcnt(6)
    v_mfma_f32_32x32x16_bf16 v[40:55], v[32:35], a[48:51], v[40:55]
    v_cvt_pk_bf16_f32 v108, v80, v81
    v_mfma_f32_32x32x16_bf16 v[56:71], v[32:35], a[52:55], v[56:71]
    v_cvt_pk_bf16_f32 v109, v82, v83
    ds_read_b128 v[28:31], v2 offset:13312
    s_waitcnt lgkmcnt(6)
    v_mfma_f32_32x32x16_bf16 v[40:55], v[36:39], a[56:59], v[40:55]
    v_cvt_pk_bf16_f32 v110, v84, v85
    v_mfma_f32_32x32x16_bf16 v[56:71], v[36:39], a[60:63], v[56:71]
    v_cvt_pk_bf16_f32 v111, v86, v87
    ds_read_b128 v[32:35], v2 offset:14336
    s_waitcnt lgkmcnt(6)
    v_mfma_f32_32x32x16_bf16 v[40:55], v[8:11], a[64:67], v[40:55]
    s_nop 1
    v_mfma_f32_32x32x16_bf16 v[56:71], v[8:11], a[68:71], v[56:71]
    v_permlane32_swap_b32 v108, v110
    ds_read_b128 v[36:39], v2 offset:15360
    s_waitcnt lgkmcnt(6)
    v_mfma_f32_32x32x16_bf16 v[40:55], v[12:15], a[72:75], v[40:55]
    v_permlane32_swap_b32 v109, v111
    v_mfma_f32_32x32x16_bf16 v[56:71], v[12:15], a[76:79], v[56:71]
    buffer_store_dwordx4 v[108:111], v3, s[8:11], s17 offen offset:256 sc1
    ds_read_b128 v[8:11], v2 offset:16384
    s_waitcnt lgkmcnt(6)
    v_mfma_f32_32x32x16_bf16 v[40:55], v[16:19], a[80:83], v[40:55]
    v_cvt_pk_bf16_f32 v112, v88, v89
    v_mfma_f32_32x32x16_bf16 v[56:71], v[16:19], a[84:87], v[56:71]
    v_cvt_pk_bf16_f32 v113, v90, v91
    ds_read_b128 v[12:15], v2 offset:17408
    s_waitcnt lgkmcnt(6)
    v_mfma_f32_32x32x16_bf16 v[40:55], v[20:23], a[88:91], v[40:55]
    v_cvt_pk_bf16_f32 v114, v92, v93
    v_mfma_f32_32x32x16_bf16 v[56:71], v[20:23], a[92:95], v[56:71]
    v_cvt_pk_bf16_f32 v115, v94, v95
    ds_read_b128 v[16:19], v2 offset:18432
    s_waitcnt lgkmcnt(6)
    v_mfma_f32_32x32x16_bf16 v[40:55], v[24:27], a[96:99], v[40:55]
    s_nop 1
    v_mfma_f32_32x32x16_bf16 v[56:71], v[24:27], a[100:103], v[56:71]
    v_permlane32_swap_b32 v112, v114
    ds_read_b128 v[20:23], v2 offset:19456
    s_waitcnt lgkmcnt(6)
    v_mfma_f32_32x32x16_bf16 v[40:55], v[28:31], a[104:107], v[40:55]
    v_permlane32_swap_b32 v113, v115
    v_mfma_f32_32x32x16_bf16 v[56:71], v[28:31], a[108:111], v[56:71]
    buffer_store_dwordx4 v[112:115], v3, s[8:11], s17 offen offset:2560 sc1
    ds_read_b128 v[24:27], v2 offset:20480
    s_waitcnt lgkmcnt(6)
    v_mfma_f32_32x32x16_bf16 v[40:55], v[32:35], a[112:115], v[40:55]
    v_cvt_pk_bf16_f32 v116, v96, v97
    v_mfma_f32_32x32x16_bf16 v[56:71], v[32:35], a[116:119], v[56:71]
    v_cvt_pk_bf16_f32 v117, v98, v99
    ds_read_b128 v[28:31], v2 offset:21504
    s_waitcnt lgkmcnt(6)
    v_mfma_f32_32x32x16_bf16 v[40:55], v[36:39], a[120:123], v[40:55]
    v_cvt_pk_bf16_f32 v118, v100, v101
    v_mfma_f32_32x32x16_bf16 v[56:71], v[36:39], a[124:127], v[56:71]
    v_cvt_pk_bf16_f32 v119, v102, v103
    ds_read_b128 v[32:35], v2 offset:22528
    s_waitcnt lgkmcnt(6)
    v_mfma_f32_32x32x16_bf16 v[40:55], v[8:11], a[128:131], v[40:55]
    s_nop 1
    v_mfma_f32_32x32x16_bf16 v[56:71], v[8:11], a[132:135], v[56:71]
    v_permlane32_swap_b32 v116, v118
    ds_read_b128 v[36:39], v2 offset:23552
    s_waitcnt lgkmcnt(6)
    v_mfma_f32_32x32x16_bf16 v[40:55], v[12:15], a[136:139], v[40:55]
    v_permlane32_swap_b32 v117, v119
    v_mfma_f32_32x32x16_bf16 v[56:71], v[12:15], a[140:143], v[56:71]
    buffer_store_dwordx4 v[116:119], v3, s[8:11], s17 offen offset:2816 sc1
    ds_read_b128 v[8:11], v2 offset:24576
    s_waitcnt lgkmcnt(6)
    v_mfma_f32_32x32x16_bf16 v[40:55], v[16:19], a[144:147], v[40:55]
    s_add_u32 s17, s17, s20
    v_mfma_f32_32x32x16_bf16 v[56:71], v[16:19], a[148:151], v[56:71]
    s_add_u32 s18, s18, s20
    ds_read_b128 v[12:15], v2 offset:25600
    s_waitcnt lgkmcnt(6)
    v_mfma_f32_32x32x16_bf16 v[40:55], v[20:23], a[152:155], v[40:55]
    v_mfma_f32_32x32x16_bf16 v[56:71], v[20:23], a[156:159], v[56:71]
    ds_read_b128 v[16:19], v2 offset:26624
    s_waitcnt lgkmcnt(6)
    v_mfma_f32_32x32x16_bf16 v[40:55], v[24:27], a[160:163], v[40:55]
    v_mfma_f32_32x32x16_bf16 v[56:71], v[24:27], a[164:167], v[56:71]
    ds_read_b128 v[20:23], v2 offset:27648
    s_waitcnt lgkmcnt(6)
    v_mfma_f32_32x32x16_bf16 v[40:55], v[28:31], a[168:171], v[40:55]
    v_mfma_f32_32x32x16_bf16 v[56:71], v[28:31], a[172:175], v[56:71]
    ds_read_b128 v[24:27], v2 offset:28672
    s_waitcnt lgkmcnt(6)
    v_mfma_f32_32x32x16_bf16 v[40:55], v[32:35], a[176:179], v[40:55]
    v_mfma_f32_32x32x16_bf16 v[56:71], v[32:35], a[180:183], v[56:71]
    ds_read_b128 v[28:31], v2 offset:29696
    s_waitcnt lgkmcnt(6)
    v_mfma_f32_32x32x16_bf16 v[40:55], v[36:39], a[184:187], v[40:55]
    v_mfma_f32_32x32x16_bf16 v[56:71], v[36:39], a[188:191], v[56:71]
    ds_read_b128 v[32:35], v2 offset:30720
    s_waitcnt lgkmcnt(6)
    v_mfma_f32_32x32x16_bf16 v[40:55], v[8:11], a[192:195], v[40:55]
    v_mfma_f32_32x32x16_bf16 v[56:71], v[8:11], a[196:199], v[56:71]
    ds_read_b128 v[36:39], v2 offset:31744
    s_waitcnt lgkmcnt(6)
    v_mfma_f32_32x32x16_bf16 v[40:55], v[12:15], a[200:203], v[40:55]
    v_mfma_f32_32x32x16_bf16 v[56:71], v[12:15], a[204:207], v[56:71]
    ds_read_b128 v[8:11], v2 offset:32768
    s_waitcnt lgkmcnt(6)
    v_mfma_f32_32x32x16_bf16 v[40:55], v[16:19], a[208:211], v[40:55]
    v_mfma_f32_32x32x16_bf16 v[56:71], v[16:19], a[212:215], v[56:71]
    ds_read_b128 v[12:15], v2 offset:33792
    s_waitcnt lgkmcnt(6)
    v_mfma_f32_32x32x16_bf16 v[40:55], v[20:23], a[216:219], v[40:55]
    v_mfma_f32_32x32x16_bf16 v[56:71], v[20:23], a[220:223], v[56:71]
    ds_read_b128 v[16:19], v2 offset:34816
    s_waitcnt lgkmcnt(6)
    v_mfma_f32_32x32x16_bf16 v[40:55], v[24:27], a[224:227], v[40:55]
    v_mfma_f32_32x32x16_bf16 v[56:71], v[24:27], a[228:231], v[56:71]
    s_add_u32 s23, s14, 2
    s_cmp_lg_u32 s13, 0
    s_cbranch_scc1 layerb1_kernel_gu_lw6
    s_min_u32 s28, s23, 63
    s_cmp_gt_u32 s56, s28
    s_cbranch_scc1 layerb1_kernel_gu_lw6
layerb1_kernel_gu_lp6:
    buffer_load_dwordx4 v[124:127], v1, s[8:11], s57 offen sc1
    s_waitcnt vmcnt(0)
    v_min_u32 v124, v124, v125
    v_min_u32 v126, v126, v127
    v_min_u32 v124, v124, v126
    v_cmp_eq_u32 vcc, 0, v124
    s_nop 1
    s_ff1_i32_b64 s56, vcc
    s_min_u32 s56, s56, 64
    s_sub_u32 s58, s58, 1
    s_cbranch_scc1 layerb1_kernel_bail
    s_cmp_gt_u32 s56, s28
    s_cbranch_scc0 layerb1_kernel_gu_lp6
layerb1_kernel_gu_lw6:
    s_cmp_gt_u32 s14, 2
    s_cbranch_scc1 layerb1_kernel_gu_dr7
    s_waitcnt vmcnt(0)
    s_mov_b32 s27, s14
    s_branch layerb1_kernel_gu_dq7
layerb1_kernel_gu_dr7:
    s_waitcnt vmcnt(4)
    s_sub_u32 s27, s14, 1
layerb1_kernel_gu_dq7:
    s_barrier
    s_cmp_lg_u32 s13, 0
    s_cbranch_scc1 layerb1_kernel_gu_fl8
    s_mov_b64 exec, 1
    s_lshl_b32 s26, s12, 7
    v_mov_b32 v7, s26
    v_mov_b32 v120, s27
    buffer_store_dword v120, v7, s[8:11], s48 offen sc1
    s_mov_b64 exec, -1
layerb1_kernel_gu_fl8:
    s_add_u32 s21, s16, 40960
    s_cmp_eq_u32 s21, 122880
    s_cselect_b32 s21, 0, s21
    s_add_u32 s23, s14, 2
    s_min_u32 s24, s23, 63
    s_mul_i32 s24, s24, 40960
    s_add_u32 s24, s24, s19
    s_mul_i32 s25, s13, 10240
    s_add_u32 s25, s25, s22
    s_add_u32 s22, s22, 40960
    s_cmp_eq_u32 s22, 122880
    s_cselect_b32 s22, 0, s22
    ds_read_b128 v[20:23], v2 offset:35840
    s_waitcnt lgkmcnt(6)
    v_mfma_f32_32x32x16_bf16 v[40:55], v[28:31], a[232:235], v[40:55]
    s_mov_b32 m0, s25
    s_nop 0
    buffer_load_dwordx4 v1, s[8:11], s24 offen offset:0 sc1 lds
    v_mfma_f32_32x32x16_bf16 v[56:71], v[28:31], a[236:239], v[56:71]
    ds_read_b128 v[24:27], v2 offset:36864
    s_waitcnt lgkmcnt(6)
    v_mfma_f32_32x32x16_bf16 v[40:55], v[32:35], a[240:243], v[40:55]
    buffer_load_dwordx4 v1, s[8:11], s24 offen offset:1024 sc1 lds
    v_mfma_f32_32x32x16_bf16 v[56:71], v[32:35], a[244:247], v[56:71]
    ds_read_b128 v[28:31], v2 offset:37888
    s_waitcnt lgkmcnt(6)
    v_mfma_f32_32x32x16_bf16 v[40:55], v[36:39], a[248:251], v[40:55]
    buffer_load_dwordx4 v1, s[8:11], s24 offen offset:2048 sc1 lds
    v_mfma_f32_32x32x16_bf16 v[56:71], v[36:39], a[252:255], v[56:71]
    ds_read_b128 v[32:35], v2 offset:38912
    s_waitcnt lgkmcnt(6)
    v_mfma_f32_32x32x16_bf16 v[40:55], v[8:11], v[192:195], v[40:55]
    buffer_load_dwordx4 v1, s[8:11], s24 offen offset:3072 sc1 lds
    v_mfma_f32_32x32x16_bf16 v[56:71], v[8:11], v[196:199], v[56:71]
    ds_read_b128 v[36:39], v2 offset:39936
    s_waitcnt lgkmcnt(6)
    v_mfma_f32_32x32x16_bf16 v[40:55], v[12:15], v[200:203], v[40:55]
    s_add_u32 s24, s24, 4096
    s_add_u32 s25, s25, 4096
    s_mov_b32 m0, s25
    s_nop 0
    buffer_load_dwordx4 v1, s[8:11], s24 offen offset:0 sc1 lds
    v_mfma_f32_32x32x16_bf16 v[56:71], v[12:15], v[204:207], v[56:71]
    v_add_u32 v6, s21, v1
    ds_read_b128 v[8:11], v6 offset:0
    s_waitcnt lgkmcnt(6)
    v_mfma_f32_32x32x16_bf16 v[40:55], v[16:19], v[208:211], v[40:55]
    buffer_load_dwordx4 v1, s[8:11], s24 offen offset:1024 sc1 lds
    v_mfma_f32_32x32x16_bf16 v[56:71], v[16:19], v[212:215], v[56:71]
    ds_read_b128 v[12:15], v6 offset:1024
    s_waitcnt lgkmcnt(6)
    v_mfma_f32_32x32x16_bf16 v[40:55], v[20:23], v[216:219], v[40:55]
    buffer_load_dwordx4 v1, s[8:11], s24 offen offset:2048 sc1 lds
    v_mfma_f32_32x32x16_bf16 v[56:71], v[20:23], v[220:223], v[56:71]
    ds_read_b128 v[16:19], v6 offset:2048
    s_waitcnt lgkmcnt(6)
    v_mfma_f32_32x32x16_bf16 v[40:55], v[24:27], v[224:227], v[40:55]
    buffer_load_dwordx4 v1, s[8:11], s24 offen offset:3072 sc1 lds
    v_mfma_f32_32x32x16_bf16 v[56:71], v[24:27], v[228:231], v[56:71]
    ds_read_b128 v[20:23], v6 offset:3072
    s_waitcnt lgkmcnt(6)
    v_mfma_f32_32x32x16_bf16 v[40:55], v[28:31], v[232:235], v[40:55]
    s_add_u32 s24, s24, 4096
    s_add_u32 s25, s25, 4096
    s_mov_b32 m0, s25
    s_nop 0
    buffer_load_dwordx4 v1, s[8:11], s24 offen offset:0 sc1 lds
    v_mfma_f32_32x32x16_bf16 v[56:71], v[28:31], v[236:239], v[56:71]
    ds_read_b128 v[24:27], v6 offset:4096
    s_waitcnt lgkmcnt(6)
    v_mfma_f32_32x32x16_bf16 v[40:55], v[32:35], v[240:243], v[40:55]
    buffer_load_dwordx4 v1, s[8:11], s24 offen offset:1024 sc1 lds
    v_mfma_f32_32x32x16_bf16 v[56:71], v[32:35], v[244:247], v[56:71]
    ds_read_b128 v[28:31], v6 offset:5120
    s_waitcnt lgkmcnt(6)
    v_mfma_f32_32x32x16_bf16 v[40:55], v[36:39], v[248:251], v[40:55]
    v_mfma_f32_32x32x16_bf16 v[56:71], v[36:39], v[252:255], v[56:71]
    v_mov_b32 v2, v6
    s_mov_b32 s16, s21
    s_add_u32 s14, s14, 1
    s_cmp_ge_u32 s14, s15
    s_cbranch_scc1 layerb1_kernel_gu_fin0
    ds_read_b128 v[32:35], v2 offset:6144
    s_waitcnt lgkmcnt(6)
    v_mfma_f32_32x32x16_bf16 v[72:87], v[8:11], a[0:3], 0
    v_mfma_f32_32x32x16_bf16 v[88:103], v[8:11], a[4:7], 0
    ds_read_b128 v[36:39], v2 offset:7168
    s_waitcnt lgkmcnt(6)
    v_mfma_f32_32x32x16_bf16 v[72:87], v[12:15], a[8:11], v[72:87]
    v_mfma_f32_32x32x16_bf16 v[88:103], v[12:15], a[12:15], v[88:103]
    ds_read_b128 v[8:11], v2 offset:8192
    s_waitcnt lgkmcnt(6)
    v_mfma_f32_32x32x16_bf16 v[72:87], v[16:19], a[16:19], v[72:87]
    v_cvt_pk_bf16_f32 v104, v40, v41
    v_mfma_f32_32x32x16_bf16 v[88:103], v[16:19], a[20:23], v[88:103]
    v_cvt_pk_bf16_f32 v105, v42, v43
    ds_read_b128 v[12:15], v2 offset:9216
    s_waitcnt lgkmcnt(6)
    v_mfma_f32_32x32x16_bf16 v[72:87], v[20:23], a[24:27], v[72:87]
    v_cvt_pk_bf16_f32 v106, v44, v45
    v_mfma_f32_32x32x16_bf16 v[88:103], v[20:23], a[28:31], v[88:103]
    v_cvt_pk_bf16_f32 v107, v46, v47
    ds_read_b128 v[16:19], v2 offset:10240
    s_waitcnt lgkmcnt(6)
    v_mfma_f32_32x32x16_bf16 v[72:87], v[24:27], a[32:35], v[72:87]
    s_nop 1
    v_mfma_f32_32x32x16_bf16 v[88:103], v[24:27], a[36:39], v[88:103]
    v_permlane32_swap_b32 v104, v106
    ds_read_b128 v[20:23], v2 offset:11264
    s_waitcnt lgkmcnt(6)
    v_mfma_f32_32x32x16_bf16 v[72:87], v[28:31], a[40:43], v[72:87]
    v_permlane32_swap_b32 v105, v107
    v_mfma_f32_32x32x16_bf16 v[88:103], v[28:31], a[44:47], v[88:103]
    buffer_store_dwordx4 v[104:107], v3, s[8:11], s17 offen offset:0 sc1
    ds_read_b128 v[24:27], v2 offset:12288
    s_waitcnt lgkmcnt(6)
    v_mfma_f32_32x32x16_bf16 v[72:87], v[32:35], a[48:51], v[72:87]
    v_cvt_pk_bf16_f32 v108, v48, v49
    v_mfma_f32_32x32x16_bf16 v[88:103], v[32:35], a[52:55], v[88:103]
    v_cvt_pk_bf16_f32 v109, v50, v51
    ds_read_b128 v[28:31], v2 offset:13312
    s_waitcnt lgkmcnt(6)
    v_mfma_f32_32x32x16_bf16 v[72:87], v[36:39], a[56:59], v[72:87]
    v_cvt_pk_bf16_f32 v110, v52, v53
    v_mfma_f32_32x32x16_bf16 v[88:103], v[36:39], a[60:63], v[88:103]
    v_cvt_pk_bf16_f32 v111, v54, v55
    ds_read_b128 v[32:35], v2 offset:14336
    s_waitcnt lgkmcnt(6)
    v_mfma_f32_32x32x16_bf16 v[72:87], v[8:11], a[64:67], v[72:87]
    s_nop 1
    v_mfma_f32_32x32x16_bf16 v[88:103], v[8:11], a[68:71], v[88:103]
    v_permlane32_swap_b32 v108, v110
    ds_read_b128 v[36:39], v2 offset:15360
    s_waitcnt lgkmcnt(6)
    v_mfma_f32_32x32x16_bf16 v[72:87], v[12:15], a[72:75], v[72:87]
    v_permlane32_swap_b32 v109, v111
    v_mfma_f32_32x32x16_bf16 v[88:103], v[12:15], a[76:79], v[88:103]
    buffer_store_dwordx4 v[108:111], v3, s[8:11], s17 offen offset:256 sc1
    ds_read_b128 v[8:11], v2 offset:16384
    s_waitcnt lgkmcnt(6)
    v_mfma_f32_32x32x16_bf16 v[72:87], v[16:19], a[80:83], v[72:87]
    v_cvt_pk_bf16_f32 v112, v56, v57
    v_mfma_f32_32x32x16_bf16 v[88:103], v[16:19], a[84:87], v[88:103]
    v_cvt_pk_bf16_f32 v113, v58, v59
    ds_read_b128 v[12:15], v2 offset:17408
    s_waitcnt lgkmcnt(6)
    v_mfma_f32_32x32x16_bf16 v[72:87], v[20:23], a[88:91], v[72:87]
    v_cvt_pk_bf16_f32 v114, v60, v61
    v_mfma_f32_32x32x16_bf16 v[88:103], v[20:23], a[92:95], v[88:103]
    v_cvt_pk_bf16_f32 v115, v62, v63
    ds_read_b128 v[16:19], v2 offset:18432
    s_waitcnt lgkmcnt(6)
    v_mfma_f32_32x32x16_bf16 v[72:87], v[24:27], a[96:99], v[72:87]
    s_nop 1
    v_mfma_f32_32x32x16_bf16 v[88:103], v[24:27], a[100:103], v[88:103]
    v_permlane32_swap_b32 v112, v114
    ds_read_b128 v[20:23], v2 offset:19456
    s_waitcnt lgkmcnt(6)
    v_mfma_f32_32x32x16_bf16 v[72:87], v[28:31], a[104:107], v[72:87]
    v_permlane32_swap_b32 v113, v115
    v_mfma_f32_32x32x16_bf16 v[88:103], v[28:31], a[108:111], v[88:103]
    buffer_store_dwordx4 v[112:115], v3, s[8:11], s17 offen offset:2560 sc1
    ds_read_b128 v[24:27], v2 offset:20480
    s_waitcnt lgkmcnt(6)
    v_mfma_f32_32x32x16_bf16 v[72:87], v[32:35], a[112:115], v[72:87]
    v_cvt_pk_bf16_f32 v116, v64, v65
    v_mfma_f32_32x32x16_bf16 v[88:103], v[32:35], a[116:119], v[88:103]
    v_cvt_pk_bf16_f32 v117, v66, v67
    ds_read_b128 v[28:31], v2 offset:21504
    s_waitcnt lgkmcnt(6)
    v_mfma_f32_32x32x16_bf16 v[72:87], v[36:39], a[120:123], v[72:87]
    v_cvt_pk_bf16_f32 v118, v68, v69
    v_mfma_f32_32x32x16_bf16 v[88:103], v[36:39], a[124:127], v[88:103]
    v_cvt_pk_bf16_f32 v119, v70, v71
    ds_read_b128 v[32:35], v2 offset:22528
    s_waitcnt lgkmcnt(6)
    v_mfma_f32_32x32x16_bf16 v[72:87], v[8:11], a[128:131], v[72:87]
    s_nop 1
    v_mfma_f32_32x32x16_bf16 v[88:103], v[8:11], a[132:135], v[88:103]
    v_permlane32_swap_b32 v116, v118
    ds_read_b128 v[36:39], v2 offset:23552
    s_waitcnt lgkmcnt(6)
    v_mfma_f32_32x32x16_bf16 v[72:87], v[12:15], a[136:139], v[72:87]
    v_permlane32_swap_b32 v117, v119
    v_mfma_f32_32x32x16_bf16 v[88:103], v[12:15], a[140:143], v[88:103]
    buffer_store_dwordx4 v[116:119], v3, s[8:11], s17 offen offset:2816 sc1
    ds_read_b128 v[8:11], v2 offset:24576
    s_waitcnt lgkmcnt(6)
    v_mfma_f32_32x32x16_bf16 v[72:87], v[16:19], a[144:147], v[72:87]
    s_add_u32 s17, s17, s20
    v_mfma_f32_32x32x16_bf16 v[88:103], v[16:19], a[148:151], v[88:103]
    s_add_u32 s18, s18, s20
    ds_read_b128 v[12:15], v2 offset:25600
    s_waitcnt lgkmcnt(6)
    v_mfma_f32_32x32x16_bf16 v[72:87], v[20:23], a[152:155], v[72:87]
    v_mfma_f32_32x32x16_bf16 v[88:103], v[20:23], a[156:159], v[88:103]
    ds_read_b128 v[16:19], v2 offset:26624
    s_waitcnt lgkmcnt(6)
    v_mfma_f32_32x32x16_bf16 v[72:87], v[24:27], a[160:163], v[72:87]
    v_mfma_f32_32x32x16_bf16 v[88:103], v[24:27], a[164:167], v[88:103]
    ds_read_b128 v[20:23], v2 offset:27648
    s_waitcnt lgkmcnt(6)
    v_mfma_f32_32x32x16_bf16 v[72:87], v[28:31], a[168:171], v[72:87]
    v_mfma_f32_32x32x16_bf16 v[88:103], v[28:31], a[172:175], v[88:103]
    ds_read_b128 v[24:27], v2 offset:28672
    s_waitcnt lgkmcnt(6)
    v_mfma_f32_32x32x16_bf16 v[72:87], v[32:35], a[176:179], v[72:87]
    v_mfma_f32_32x32x16_bf16 v[88:103], v[32:35], a[180:183], v[88:103]
    ds_read_b128 v[28:31], v2 offset:29696
    s_waitcnt lgkmcnt(6)
    v_mfma_f32_32x32x16_bf16 v[72:87], v[36:39], a[184:187], v[72:87]
    v_mfma_f32_32x32x16_bf16 v[88:103], v[36:39], a[188:191], v[88:103]
    ds_read_b128 v[32:35], v2 offset:30720
    s_waitcnt lgkmcnt(6)
    v_mfma_f32_32x32x16_bf16 v[72:87], v[8:11], a[192:195], v[72:87]
    v_mfma_f32_32x32x16_bf16 v[88:103], v[8:11], a[196:199], v[88:103]
    ds_read_b128 v[36:39], v2 offset:31744
    s_waitcnt lgkmcnt(6)
    v_mfma_f32_32x32x16_bf16 v[72:87], v[12:15], a[200:203], v[72:87]
    v_mfma_f32_32x32x16_bf16 v[88:103], v[12:15], a[204:207], v[88:103]
    ds_read_b128 v[8:11], v2 offset:32768
    s_waitcnt lgkmcnt(6)
    v_mfma_f32_32x32x16_bf16 v[72:87], v[16:19], a[208:211], v[72:87]
    v_mfma_f32_32x32x16_bf16 v[88:103], v[16:19], a[212:215], v[88:103]
    ds_read_b128 v[12:15], v2 offset:33792
    s_waitcnt lgkmcnt(6)
    v_mfma_f32_32x32x16_bf16 v[72:87], v[20:23], a[216:219], v[72:87]
    v_mfma_f32_32x32x16_bf16 v[88:103], v[20:23], a[220:223], v[88:103]
    ds_read_b128 v[16:19], v2 offset:34816
    s_waitcnt lgkmcnt(6)
    v_mfma_f32_32x32x16_bf16 v[72:87], v[24:27], a[224:227], v[72:87]
    v_mfma_f32_32x32x16_bf16 v[88:103], v[24:27], a[228:231], v[88:103]
    s_add_u32 s23, s14, 2
    s_cmp_lg_u32 s13, 0
    s_cbranch_scc1 layerb1_kernel_gu_lw9
    s_min_u32 s28, s23, 63
    s_cmp_gt_u32 s56, s28
    s_cbranch_scc1 layerb1_kernel_gu_lw9
layerb1_kernel_gu_lp9:
    buffer_load_dwordx4 v[124:127], v1, s[8:11], s57 offen sc1
    s_waitcnt vmcnt(0)
    v_min_u32 v124, v124, v125
    v_min_u32 v126, v126, v127
    v_min_u32 v124, v124, v126
    v_cmp_eq_u32 vcc, 0, v124
    s_nop 1
    s_ff1_i32_b64 s56, vcc
    s_min_u32 s56, s56, 64
    s_sub_u32 s58, s58, 1
    s_cbranch_scc1 layerb1_kernel_bail
    s_cmp_gt_u32 s56, s28
    s_cbranch_scc0 layerb1_kernel_gu_lp9
layerb1_kernel_gu_lw9:
    s_cmp_gt_u32 s14, 2
    s_cbranch_scc1 layerb1_kernel_gu_dr10
    s_waitcnt vmcnt(0)
    s_mov_b32 s27, s14
    s_branch layerb1_kernel_gu_dq10
layerb1_kernel_gu_dr10:
    s_waitcnt vmcnt(4)
    s_sub_u32 s27, s14, 1
layerb1_kernel_gu_dq10:
    s_barrier
    s_cmp_lg_u32 s13, 0
    s_cbranch_scc1 layerb1_kernel_gu_fl11
    s_mov_b64 exec, 1
    s_lshl_b32 s26, s12, 7
    v_mov_b32 v7, s26
    v_mov_b32 v120, s27
    buffer_store_dword v120, v7, s[8:11], s48 offen sc1
    s_mov_b64 exec, -1
layerb1_kernel_gu_fl11:
    s_add_u32 s21, s16, 40960
    s_cmp_eq_u32 s21, 122880
    s_cselect_b32 s21, 0, s21
    s_add_u32 s23, s14, 2
    s_min_u32 s24, s23, 63
    s_mul_i32 s24, s24, 40960
    s_add_u32 s24, s24, s19
    s_mul_i32 s25, s13, 10240
    s_add_u32 s25, s25, s22
    s_add_u32 s22, s22, 40960
    s_cmp_eq_u32 s22, 122880
    s_cselect_b32 s22, 0, s22
    ds_read_b128 v[20:23], v2 offset:35840
    s_waitcnt lgkmcnt(6)
    v_mfma_f32_32x32x16_bf16 v[72:87], v[28:31], a[232:235], v[72:87]
    s_mov_b32 m0, s25
    s_nop 0
    buffer_load_dwordx4 v1, s[8:11], s24 offen offset:0 sc1 lds
    v_mfma_f32_32x32x16_bf16 v[88:103], v[28:31], a[236:239], v[88:103]
    ds_read_b128 v[24:27], v2 offset:36864
    s_waitcnt lgkmcnt(6)
    v_mfma_f32_32x32x16_bf16 v[72:87], v[32:35], a[240:243], v[72:87]
    buffer_load_dwordx4 v1, s[8:11], s24 offen offset:1024 sc1 lds
    v_mfma_f32_32x32x16_bf16 v[88:103], v[32:35], a[244:247], v[88:103]
    ds_read_b128 v[28:31], v2 offset:37888
    s_waitcnt lgkmcnt(6)
    v_mfma_f32_32x32x16_bf16 v[72:87], v[36:39], a[248:251], v[72:87]
    buffer_load_dwordx4 v1, s[8:11], s24 offen offset:2048 sc1 lds
    v_mfma_f32_32x32x16_bf16 v[88:103], v[36:39], a[252:255], v[88:103]
    ds_read_b128 v[32:35], v2 offset:38912
    s_waitcnt lgkmcnt(6)
    v_mfma_f32_32x32x16_bf16 v[72:87], v[8:11], v[192:195], v[72:87]
    buffer_load_dwordx4 v1, s[8:11], s24 offen offset:3072 sc1 lds
    v_mfma_f32_32x32x16_bf16 v[88:103], v[8:11], v[196:199], v[88:103]
    ds_read_b128 v[36:39], v2 offset:39936
    s_waitcnt lgkmcnt(6)
    v_mfma_f32_32x32x16_bf16 v[72:87], v[12:15], v[200:203], v[72:87]
    s_add_u32 s24, s24, 4096
    s_add_u32 s25, s25, 4096
    s_mov_b32 m0, s25
    s_nop 0
    buffer_load_dwordx4 v1, s[8:11], s24 offen offset:0 sc1 lds
    v_mfma_f32_32x32x16_bf16 v[88:103], v[12:15], v[204:207], v[88:103]
    v_add_u32 v6, s21, v1
    ds_read_b128 v[8:11], v6 offset:0
    s_waitcnt lgkmcnt(6)
    v_mfma_f32_32x32x16_bf16 v[72:87], v[16:19], v[208:211], v[72:87]
    buffer_load_dwordx4 v1, s[8:11], s24 offen offset:1024 sc1 lds
    v_mfma_f32_32x32x16_bf16 v[88:103], v[16:19], v[212:215], v[88:103]
    ds_read_b128 v[12:15], v6 offset:1024
    s_waitcnt lgkmcnt(6)
    v_mfma_f32_32x32x16_bf16 v[72:87], v[20:23], v[216:219], v[72:87]
    buffer_load_dwordx4 v1, s[8:11], s24 offen offset:2048 sc1 lds
    v_mfma_f32_32x32x16_bf16 v[88:103], v[20:23], v[220:223], v[88:103]
    ds_read_b128 v[16:19], v6 offset:2048
    s_waitcnt lgkmcnt(6)
    v_mfma_f32_32x32x16_bf16 v[72:87], v[24:27], v[224:227], v[72:87]
    buffer_load_dwordx4 v1, s[8:11], s24 offen offset:3072 sc1 lds
    v_mfma_f32_32x32x16_bf16 v[88:103], v[24:27], v[228:231], v[88:103]
    ds_read_b128 v[20:23], v6 offset:3072
    s_waitcnt lgkmcnt(6)
    v_mfma_f32_32x32x16_bf16 v[72:87], v[28:31], v[232:235], v[72:87]
    s_add_u32 s24, s24, 4096
    s_add_u32 s25, s25, 4096
    s_mov_b32 m0, s25
    s_nop 0
    buffer_load_dwordx4 v1, s[8:11], s24 offen offset:0 sc1 lds
    v_mfma_f32_32x32x16_bf16 v[88:103], v[28:31], v[236:239], v[88:103]
    ds_read_b128 v[24:27], v6 offset:4096
    s_waitcnt lgkmcnt(6)
    v_mfma_f32_32x32x16_bf16 v[72:87], v[32:35], v[240:243], v[72:87]
    buffer_load_dwordx4 v1, s[8:11], s24 offen offset:1024 sc1 lds
    v_mfma_f32_32x32x16_bf16 v[88:103], v[32:35], v[244:247], v[88:103]
    ds_read_b128 v[28:31], v6 offset:5120
    s_waitcnt lgkmcnt(6)
    v_mfma_f32_32x32x16_bf16 v[72:87], v[36:39], v[248:251], v[72:87]
    v_mfma_f32_32x32x16_bf16 v[88:103], v[36:39], v[252:255], v[88:103]
    v_mov_b32 v2, v6
    s_mov_b32 s16, s21
    s_add_u32 s14, s14, 1
    s_cmp_lt_u32 s14, s15
    s_cbranch_scc1 layerb1_kernel_gu_loop
    s_branch layerb1_kernel_gu_fin1
layerb1_kernel_gu_fin0:
    s_nop 7
    s_nop 7
    v_cvt_pk_bf16_f32 v104, v40, v41
    v_cvt_pk_bf16_f32 v105, v42, v43
    v_cvt_pk_bf16_f32 v106, v44, v45
    v_cvt_pk_bf16_f32 v107, v46, v47
    s_nop 1
    v_permlane32_swap_b32 v104, v106
    v_permlane32_swap_b32 v105, v107
    buffer_store_dwordx4 v[104:107], v3, s[8:11], s17 offen offset:0 sc1
    v_cvt_pk_bf16_f32 v108, v48, v49
    v_cvt_pk_bf16_f32 v109, v50, v51
    v_cvt_pk_bf16_f32 v110, v52, v53
    v_cvt_pk_bf16_f32 v111, v54, v55
    s_nop 1
    v_permlane32_swap_b32 v108, v110
    v_permlane32_swap_b32 v109, v111
    buffer_store_dwordx4 v[108:111], v3, s[8:11], s17 offen offset:256 sc1
    v_cvt_pk_bf16_f32 v112, v56, v57
    v_cvt_pk_bf16_f32 v113, v58, v59
    v_cvt_pk_bf16_f32 v114, v60, v61
    v_cvt_pk_bf16_f32 v115, v62, v63
    s_nop 1
    v_permlane32_swap_b32 v112, v114
    v_permlane32_swap_b32 v113, v115
    buffer_store_dwordx4 v[112:115], v3, s[8:11], s17 offen offset:2560 sc1
    v_cvt_pk_bf16_f32 v116, v64, v65
    v_cvt_pk_bf16_f32 v117, v66, v67
    v_cvt_pk_bf16_f32 v118, v68, v69
    v_cvt_pk_bf16_f32 v119, v70, v71
    s_nop 1
    v_permlane32_swap_b32 v116, v118
    v_permlane32_swap_b32 v117, v119
    buffer_store_dwordx4 v[116:119], v3, s[8:11], s17 offen offset:2816 sc1
    s_add_u32 s17, s17, s20
    s_add_u32 s18, s18, s20
    s_branch layerb1_kernel_gu_done
layerb1_kernel_gu_fin1:
    s_nop 7
    s_nop 7
    v_cvt_pk_bf16_f32 v104, v72, v73
    v_cvt_pk_bf16_f32 v105, v74, v75
    v_cvt_pk_bf16_f32 v106, v76, v77
    v_cvt_pk_bf16_f32 v107, v78, v79
    s_nop 1
    v_permlane32_swap_b32 v104, v106
    v_permlane32_swap_b32 v105, v107
    buffer_store_dwordx4 v[104:107], v3, s[8:11], s17 offen offset:0 sc1
    v_cvt_pk_bf16_f32 v108, v80, v81
    v_cvt_pk_bf16_f32 v109, v82, v83
    v_cvt_pk_bf16_f32 v110, v84, v85
    v_cvt_pk_bf16_f32 v111, v86, v87
    s_nop 1
    v_permlane32_swap_b32 v108, v110
    v_permlane32_swap_b32 v109, v111
    buffer_store_dwordx4 v[108:111], v3, s[8:11], s17 offen offset:256 sc1
    v_cvt_pk_bf16_f32 v112, v88, v89
    v_cvt_pk_bf16_f32 v113, v90, v91
    v_cvt_pk_bf16_f32 v114, v92, v93
    v_cvt_pk_bf16_f32 v115, v94, v95
    s_nop 1
    v_permlane32_swap_b32 v112, v114
    v_permlane32_swap_b32 v113, v115
    buffer_store_dwordx4 v[112:115], v3, s[8:11], s17 offen offset:2560 sc1
    v_cvt_pk_bf16_f32 v116, v96, v97
    v_cvt_pk_bf16_f32 v117, v98, v99
    v_cvt_pk_bf16_f32 v118, v100, v101
    v_cvt_pk_bf16_f32 v119, v102, v103
    s_nop 1
    v_permlane32_swap_b32 v116, v118
    v_permlane32_swap_b32 v117, v119
    buffer_store_dwordx4 v[116:119], v3, s[8:11], s17 offen offset:2816 sc1
    s_add_u32 s17, s17, s20
    s_add_u32 s18, s18, s20
layerb1_kernel_gu_done:
    s_waitcnt vmcnt(0) lgkmcnt(0)
    s_barrier
    s_cmp_lg_u32 s13, 0
    s_cbranch_scc1 layerb1_kernel_gu_fl12
    s_mov_b64 exec, 1
    s_lshl_b32 s26, s12, 7
    v_mov_b32 v7, s26
    v_mov_b32 v120, s14
    buffer_store_dword v120, v7, s[8:11], s48 offen sc1
    s_mov_b64 exec, -1
layerb1_kernel_gu_fl12:
    s_branch layerb1_kernel_g_done
layerb1_kernel_g_qk:
    s_sub_u32 s26, s12, 80
    s_cmp_ge_u32 s26, 24
    s_cselect_b32 s27, 1, 0
    s_cselect_b32 s28, 24, 0
    s_sub_u32 s26, s26, s28
    s_lshl_b32 s26, s26, 3
    s_lshl_b32 s28, s13, 1
    s_add_u32 s26, s26, s28
    s_add_u32 s28, s26, 0
    s_mul_i32 s29, s28, 171
    s_lshr_b32 s29, s29, 10
    s_mul_i32 s30, s29, 6
    s_sub_u32 s30, s28, s30
    s_mul_i32 s31, s29, 12288
    s_lshl_b32 s32, s30, 11
    s_add_u32 s31, s31, s32
    s_mul_i32 s32, s14, 393216
    s_add_u32 s31, s31, s32
    s_mul_i32 s32, s27, 25165824
    s_add_u32 s31, s31, s32
    s_add_u32 s17, s31, 53477376
    s_lshl_b32 s30, s30, 5
    v_add_u32 v10, s30, v8
    v_and_b32 v11, 0xc1, v10
    v_and_b32 v12, 8, v10
    v_lshl_or_b32 v11, v12, 2, v11
    v_and_b32 v12, 32, v10
    v_lshrrev_b32 v12, 1, v12
    v_or_b32 v11, v11, v12
    v_and_b32 v12, 2, v10
    v_lshl_or_b32 v11, v12, 2, v11
    v_and_b32 v12, 16, v10
    v_lshrrev_b32 v12, 2, v12
    v_or_b32 v11, v11, v12
    v_and_b32 v12, 4, v10
    v_lshrrev_b32 v12, 1, v12
    v_or_b32 v11, v11, v12
    s_cmp_eq_u32 s27, 1
    s_cselect_b64 vcc, -1, 0
    s_nop 1
    v_cndmask_b32 v10, v10, v11, vcc
    v_lshrrev_b32 v12, 4, v10
    v_mul_u32_u24 v13, 11, v12
    v_lshrrev_b32 v13, 5, v13
    v_mul_u32_u24 v13, 3, v13
    v_add_u32 v12, v12, v13
    v_mul_u32_u24 v12, 20480, v12
    v_and_b32 v13, 15, v10
    v_lshl_add_u32 v11, v13, 4, v12
    v_lshl_add_u32 v4, v9, 8, v11
    s_xor_b32 s30, s27, 1
    s_mul_i32 s30, s30, 61440
    s_mul_i32 s31, s29, 491520
    s_add_u32 s30, s30, s31
    s_add_u32 s34, s30, 11534336
    s_add_u32 s28, s26, 1
    s_mul_i32 s29, s28, 171
    s_lshr_b32 s29, s29, 10
    s_mul_i32 s30, s29, 6
    s_sub_u32 s30, s28, s30
    s_mul_i32 s31, s29, 12288
    s_lshl_b32 s32, s30, 11
    s_add_u32 s31, s31, s32
    s_mul_i32 s32, s14, 393216
    s_add_u32 s31, s31, s32
    s_mul_i32 s32, s27, 25165824
    s_add_u32 s31, s31, s32
    s_add_u32 s18, s31, 53477376
    s_lshl_b32 s30, s30, 5
    v_add_u32 v10, s30, v8
    v_and_b32 v11, 0xc1, v10
    v_and_b32 v12, 8, v10
    v_lshl_or_b32 v11, v12, 2, v11
    v_and_b32 v12, 32, v10
    v_lshrrev_b32 v12, 1, v12
    v_or_b32 v11, v11, v12
    v_and_b32 v12, 2, v10
    v_lshl_or_b32 v11, v12, 2, v11
    v_and_b32 v12, 16, v10
    v_lshrrev_b32 v12, 2, v12
    v_or_b32 v11, v11, v12
    v_and_b32 v12, 4, v10
    v_lshrrev_b32 v12, 1, v12
    v_or_b32 v11, v11, v12
    s_cmp_eq_u32 s27, 1
    s_cselect_b64 vcc, -1, 0
    s_nop 1
    v_cndmask_b32 v10, v10, v11, vcc
    v_lshrrev_b32 v12, 4, v10
    v_mul_u32_u24 v13, 11, v12
    v_lshrrev_b32 v13, 5, v13
    v_mul_u32_u24 v13, 3, v13
    v_add_u32 v12, v12, v13
    v_mul_u32_u24 v12, 20480, v12
    v_and_b32 v13, 15, v10
    v_lshl_add_u32 v11, v13, 4, v12
    v_lshl_add_u32 v5, v9, 8, v11
    s_xor_b32 s30, s27, 1
    s_mul_i32 s30, s30, 61440
    s_mul_i32 s31, s29, 491520
    s_add_u32 s30, s30, s31
    s_add_u32 s35, s30, 11534336
    buffer_load_dwordx4 a[0:3], v4, s[8:11], s34 offen offset:0
    buffer_load_dwordx4 a[4:7], v5, s[8:11], s35 offen offset:0
    buffer_load_dwordx4 a[8:11], v4, s[8:11], s34 offen offset:512
    buffer_load_dwordx4 a[12:15], v5, s[8:11], s35 offen offset:512
    buffer_load_dwordx4 a[16:19], v4, s[8:11], s34 offen offset:1024
    buffer_load_dwordx4 a[20:23], v5, s[8:11], s35 offen offset:1024
    buffer_load_dwordx4 a[24:27], v4, s[8:11], s34 offen offset:1536
    buffer_load_dwordx4 a[28:31], v5, s[8:11], s35 offen offset:1536
    buffer_load_dwordx4 a[32:35], v4, s[8:11], s34 offen offset:2048
    buffer_load_dwordx4 a[36:39], v5, s[8:11], s35 offen offset:2048
    buffer_load_dwordx4 a[40:43], v4, s[8:11], s34 offen offset:2560
    buffer_load_dwordx4 a[44:47], v5, s[8:11], s35 offen offset:2560
    buffer_load_dwordx4 a[48:51], v4, s[8:11], s34 offen offset:3072
    buffer_load_dwordx4 a[52:55], v5, s[8:11], s35 offen offset:3072
    buffer_load_dwordx4 a[56:59], v4, s[8:11], s34 offen offset:3584
    buffer_load_dwordx4 a[60:63], v5, s[8:11], s35 offen offset:3584
    s_add_u32 s34, s34, 4096
    s_add_u32 s35, s35, 4096
    buffer_load_dwordx4 a[64:67], v4, s[8:11], s34 offen offset:0
    buffer_load_dwordx4 a[68:71], v5, s[8:11], s35 offen offset:0
    buffer_load_dwordx4 a[72:75], v4, s[8:11], s34 offen offset:512
    buffer_load_dwordx4 a[76:79], v5, s[8:11], s35 offen offset:512
    buffer_load_dwordx4 a[80:83], v4, s[8:11], s34 offen offset:1024
    buffer_load_dwordx4 a[84:87], v5, s[8:11], s35 offen offset:1024
    buffer_load_dwordx4 a[88:91], v4, s[8:11], s34 offen offset:1536
    buffer_load_dwordx4 a[92:95], v5, s[8:11], s35 offen offset:1536
    buffer_load_dwordx4 a[96:99], v4, s[8:11], s34 offen offset:2048
    buffer_load_dwordx4 a[100:103], v5, s[8:11], s35 offen offset:2048
    buffer_load_dwordx4 a[104:107], v4, s[8:11], s34 offen offset:2560
    buffer_load_dwordx4 a[108:111], v5, s[8:11], s35 offen offset:2560
    buffer_load_dwordx4 a[112:115], v4, s[8:11], s34 offen offset:3072
    buffer_load_dwordx4 a[116:119], v5, s[8:11], s35 offen offset:3072
    buffer_load_dwordx4 a[120:123], v4, s[8:11], s34 offen offset:3584
    buffer_load_dwordx4 a[124:127], v5, s[8:11], s35 offen offset:3584
    s_add_u32 s34, s34, 4096
    s_add_u32 s35, s35, 4096
    buffer_load_dwordx4 a[128:131], v4, s[8:11], s34 offen offset:0
    buffer_load_dwordx4 a[132:135], v5, s[8:11], s35 offen offset:0
    buffer_load_dwordx4 a[136:139], v4, s[8:11], s34 offen offset:512
    buffer_load_dwordx4 a[140:143], v5, s[8:11], s35 offen offset:512
    buffer_load_dwordx4 a[144:147], v4, s[8:11], s34 offen offset:1024
    buffer_load_dwordx4 a[148:151], v5, s[8:11], s35 offen offset:1024
    buffer_load_dwordx4 a[152:155], v4, s[8:11], s34 offen offset:1536
    buffer_load_dwordx4 a[156:159], v5, s[8:11], s35 offen offset:1536
    buffer_load_dwordx4 a[160:163], v4, s[8:11], s34 offen offset:2048
    buffer_load_dwordx4 a[164:167], v5, s[8:11], s35 offen offset:2048
    buffer_load_dwordx4 a[168:171], v4, s[8:11], s34 offen offset:2560
    buffer_load_dwordx4 a[172:175], v5, s[8:11], s35 offen offset:2560
    buffer_load_dwordx4 a[176:179], v4, s[8:11], s34 offen offset:3072
    buffer_load_dwordx4 a[180:183], v5, s[8:11], s35 offen offset:3072
    buffer_load_dwordx4 a[184:187], v4, s[8:11], s34 offen offset:3584
    buffer_load_dwordx4 a[188:191], v5, s[8:11], s35 offen offset:3584
    s_add_u32 s34, s34, 4096
    s_add_u32 s35, s35, 4096
    buffer_load_dwordx4 a[192:195], v4, s[8:11], s34 offen offset:0
    buffer_load_dwordx4 a[196:199], v5, s[8:11], s35 offen offset:0
    buffer_load_dwordx4 a[200:203], v4, s[8:11], s34 offen offset:512
    buffer_load_dwordx4 a[204:207], v5, s[8:11], s35 offen offset:512
    buffer_load_dwordx4 a[208:211], v4, s[8:11], s34 offen offset:1024
    buffer_load_dwordx4 a[212:215], v5, s[8:11], s35 offen offset:1024
    buffer_load_dwordx4 a[216:219], v4, s[8:11], s34 offen offset:1536
    buffer_load_dwordx4 a[220:223], v5, s[8:11], s35 offen offset:1536
    buffer_load_dwordx4 a[224:227], v4, s[8:11], s34 offen offset:2048
    buffer_load_dwordx4 a[228:231], v5, s[8:11], s35 offen offset:2048
    buffer_load_dwordx4 a[232:235], v4, s[8:11], s34 offen offset:2560
    buffer_load_dwordx4 a[236:239], v5, s[8:11], s35 offen offset:2560
    buffer_load_dwordx4 a[240:243], v4, s[8:11], s34 offen offset:3072
    buffer_load_dwordx4 a[244:247], v5, s[8:11], s35 offen offset:3072
    buffer_load_dwordx4 a[248:251], v4, s[8:11], s34 offen offset:3584
    buffer_load_dwordx4 a[252:255], v5, s[8:11], s35 offen offset:3584
    s_add_u32 s34, s34, 4096
    s_add_u32 s35, s35, 4096
    buffer_load_dwordx4 v[192:195], v4, s[8:11], s34 offen offset:0
    buffer_load_dwordx4 v[196:199], v5, s[8:11], s35 offen offset:0
    buffer_load_dwordx4 v[200:203], v4, s[8:11], s34 offen offset:512
    buffer_load_dwordx4 v[204:207], v5, s[8:11], s35 offen offset:512
    buffer_load_dwordx4 v[208:211], v4, s[8:11], s34 offen offset:1024
    buffer_load_dwordx4 v[212:215], v5, s[8:11], s35 offen offset:1024
    buffer_load_dwordx4 v[216:219], v4, s[8:11], s34 offen offset:1536
    buffer_load_dwordx4 v[220:223], v5, s[8:11], s35 offen offset:1536
    buffer_load_dwordx4 v[224:227], v4, s[8:11], s34 offen offset:2048
    buffer_load_dwordx4 v[228:231], v5, s[8:11], s35 offen offset:2048
    buffer_load_dwordx4 v[232:235], v4, s[8:11], s34 offen offset:2560
    buffer_load_dwordx4 v[236:239], v5, s[8:11], s35 offen offset:2560
    buffer_load_dwordx4 v[240:243], v4, s[8:11], s34 offen offset:3072
    buffer_load_dwordx4 v[244:247], v5, s[8:11], s35 offen offset:3072
    buffer_load_dwordx4 v[248:251], v4, s[8:11], s34 offen offset:3584
    buffer_load_dwordx4 v[252:255], v5, s[8:11], s35 offen offset:3584
    v_mov_b32 v3, v1
    s_mov_b32 s20, 393216
    s_mul_i32 s19, s13, 10240
    s_add_u32 s19, s19, 220200960
    s_mov_b32 s22, 0
    s_mov_b32 s56, 0
    s_mov_b32 s58, 400000
    s_add_u32 s57, s48, 45056
    s_cmp_lg_u32 s13, 0
    s_cbranch_scc1 layerb1_kernel_gk_lw1
    s_min_u32 s28, s14, 63
    s_cmp_gt_u32 s56, s28
    s_cbranch_scc1 layerb1_kernel_gk_lw1
layerb1_kernel_gk_lp1:
    buffer_load_dwordx4 v[124:127], v1, s[8:11], s57 offen sc1
    s_waitcnt vmcnt(0)
    v_min_u32 v124, v124, v125
    v_min_u32 v126, v126, v127
    v_min_u32 v124, v124, v126
    v_cmp_eq_u32 vcc, 0, v124
    s_nop 1
    s_ff1_i32_b64 s56, vcc
    s_min_u32 s56, s56, 64
    s_sub_u32 s58, s58, 1
    s_cbranch_scc1 layerb1_kernel_bail
    s_cmp_gt_u32 s56, s28
    s_cbranch_scc0 layerb1_kernel_gk_lp1
layerb1_kernel_gk_lw1:
    s_barrier
    s_min_u32 s24, s14, 63
    s_mul_i32 s24, s24, 40960
    s_add_u32 s24, s24, s19
    s_mul_i32 s25, s13, 10240
    s_add_u32 s25, s25, s22
    s_mov_b32 m0, s25
    s_nop 0
    buffer_load_dwordx4 v1, s[8:11], s24 offen offset:0 sc1 lds
    buffer_load_dwordx4 v1, s[8:11], s24 offen offset:1024 sc1 lds
    buffer_load_dwordx4 v1, s[8:11], s24 offen offset:2048 sc1 lds
    buffer_load_dwordx4 v1, s[8:11], s24 offen offset:3072 sc1 lds
    s_add_u32 s24, s24, 4096
    s_add_u32 s25, s25, 4096
    s_mov_b32 m0, s25
    s_nop 0
    buffer_load_dwordx4 v1, s[8:11], s24 offen offset:0 sc1 lds
    buffer_load_dwordx4 v1, s[8:11], s24 offen offset:1024 sc1 lds
    buffer_load_dwordx4 v1, s[8:11], s24 offen offset:2048 sc1 lds
    buffer_load_dwordx4 v1, s[8:11], s24 offen offset:3072 sc1 lds
    s_add_u32 s24, s24, 4096
    s_add_u32 s25, s25, 4096
    s_mov_b32 m0, s25
    s_nop 0
    buffer_load_dwordx4 v1, s[8:11], s24 offen offset:0 sc1 lds
    buffer_load_dwordx4 v1, s[8:11], s24 offen offset:1024 sc1 lds
    s_mov_b32 s22, 40960
    s_mov_b32 s16, 0
    s_waitcnt vmcnt(0)
    s_barrier
    v_mov_b32 v2, v1
    ds_read_b128 v[8:11], v2 offset:0
    ds_read_b128 v[12:15], v2 offset:1024
    ds_read_b128 v[16:19], v2 offset:2048
    ds_read_b128 v[20:23], v2 offset:3072
    ds_read_b128 v[24:27], v2 offset:4096
    ds_read_b128 v[28:31], v2 offset:5120
    ds_read_b128 v[32:35], v2 offset:6144
    s_waitcnt lgkmcnt(6)
    v_mfma_f32_32x32x16_bf16 v[40:55], a[0:3], v[8:11], 0
    v_mfma_f32_32x32x16_bf16 v[56:71], a[4:7], v[8:11], 0
    ds_read_b128 v[36:39], v2 offset:7168
    s_waitcnt lgkmcnt(6)
    v_mfma_f32_32x32x16_bf16 v[40:55], a[8:11], v[12:15], v[40:55]
    v_mfma_f32_32x32x16_bf16 v[56:71], a[12:15], v[12:15], v[56:71]
    ds_read_b128 v[8:11], v2 offset:8192
    s_waitcnt lgkmcnt(6)
    v_mfma_f32_32x32x16_bf16 v[40:55], a[16:19], v[16:19], v[40:55]
    v_mfma_f32_32x32x16_bf16 v[56:71], a[20:23], v[16:19], v[56:71]
    ds_read_b128 v[12:15], v2 offset:9216
    s_waitcnt lgkmcnt(6)
    v_mfma_f32_32x32x16_bf16 v[40:55], a[24:27], v[20:23], v[40:55]
    v_mfma_f32_32x32x16_bf16 v[56:71], a[28:31], v[20:23], v[56:71]
    ds_read_b128 v[16:19], v2 offset:10240
    s_waitcnt lgkmcnt(6)
    v_mfma_f32_32x32x16_bf16 v[40:55], a[32:35], v[24:27], v[40:55]
    v_mfma_f32_32x32x16_bf16 v[56:71], a[36:39], v[24:27], v[56:71]
    ds_read_b128 v[20:23], v2 offset:11264
    s_waitcnt lgkmcnt(6)
    v_mfma_f32_32x32x16_bf16 v[40:55], a[40:43], v[28:31], v[40:55]
    v_mfma_f32_32x32x16_bf16 v[56:71], a[44:47], v[28:31], v[56:71]
    ds_read_b128 v[24:27], v2 offset:12288
    s_waitcnt lgkmcnt(6)
    v_mfma_f32_32x32x16_bf16 v[40:55], a[48:51], v[32:35], v[40:55]
    v_mfma_f32_32x32x16_bf16 v[56:71], a[52:55], v[32:35], v[56:71]
    s_add_u32 s23, s14, 1
    s_cmp_lg_u32 s13, 0
    s_cbranch_scc1 layerb1_kernel_gk_lw2
    s_min_u32 s28, s23, 63
    s_cmp_gt_u32 s56, s28
    s_cbranch_scc1 layerb1_kernel_gk_lw2
layerb1_kernel_gk_lp2:
    buffer_load_dwordx4 v[124:127], v1, s[8:11], s57 offen sc1
    s_waitcnt vmcnt(0)
    v_min_u32 v124, v124, v125
    v_min_u32 v126, v126, v127
    v_min_u32 v124, v124, v126
    v_cmp_eq_u32 vcc, 0, v124
    s_nop 1
    s_ff1_i32_b64 s56, vcc
    s_min_u32 s56, s56, 64
    s_sub_u32 s58, s58, 1
    s_cbranch_scc1 layerb1_kernel_bail
    s_cmp_gt_u32 s56, s28
    s_cbranch_scc0 layerb1_kernel_gk_lp2
layerb1_kernel_gk_lw2:
    s_barrier
    s_min_u32 s24, s23, 63
    s_mul_i32 s24, s24, 40960
    s_add_u32 s24, s24, s19
    s_mul_i32 s25, s13, 10240
    s_add_u32 s25, s25, s22
    s_add_u32 s22, s22, 40960
    s_cmp_eq_u32 s22, 122880
    s_cselect_b32 s22, 0, s22
    ds_read_b128 v[28:31], v2 offset:13312
    s_waitcnt lgkmcnt(6)
    v_mfma_f32_32x32x16_bf16 v[40:55], a[56:59], v[36:39], v[40:55]
    s_mov_b32 m0, s25
    s_nop 0
    buffer_load_dwordx4 v1, s[8:11], s24 offen offset:0 sc1 lds
    v_mfma_f32_32x32x16_bf16 v[56:71], a[60:63], v[36:39], v[56:71]
    ds_read_b128 v[32:35], v2 offset:14336
    s_waitcnt lgkmcnt(6)
    v_mfma_f32_32x32x16_bf16 v[40:55], a[64:67], v[8:11], v[40:55]
    buffer_load_dwordx4 v1, s[8:11], s24 offen offset:1024 sc1 lds
    v_mfma_f32_32x32x16_bf16 v[56:71], a[68:71], v[8:11], v[56:71]
    ds_read_b128 v[36:39], v2 offset:15360
    s_waitcnt lgkmcnt(6)
    v_mfma_f32_32x32x16_bf16 v[40:55], a[72:75], v[12:15], v[40:55]
    buffer_load_dwordx4 v1, s[8:11], s24 offen offset:2048 sc1 lds
    v_mfma_f32_32x32x16_bf16 v[56:71], a[76:79], v[12:15], v[56:71]
    ds_read_b128 v[8:11], v2 offset:16384
    s_waitcnt lgkmcnt(6)
    v_mfma_f32_32x32x16_bf16 v[40:55], a[80:83], v[16:19], v[40:55]
    buffer_load_dwordx4 v1, s[8:11], s24 offen offset:3072 sc1 lds
    v_mfma_f32_32x32x16_bf16 v[56:71], a[84:87], v[16:19], v[56:71]
    ds_read_b128 v[12:15], v2 offset:17408
    s_waitcnt lgkmcnt(6)
    v_mfma_f32_32x32x16_bf16 v[40:55], a[88:91], v[20:23], v[40:55]
    s_add_u32 s24, s24, 4096
    s_add_u32 s25, s25, 4096
    s_mov_b32 m0, s25
    s_nop 0
    buffer_load_dwordx4 v1, s[8:11], s24 offen offset:0 sc1 lds
    v_mfma_f32_32x32x16_bf16 v[56:71], a[92:95], v[20:23], v[56:71]
    ds_read_b128 v[16:19], v2 offset:18432
    s_waitcnt lgkmcnt(6)
    v_mfma_f32_32x32x16_bf16 v[40:55], a[96:99], v[24:27], v[40:55]
    buffer_load_dwordx4 v1, s[8:11], s24 offen offset:1024 sc1 lds
    v_mfma_f32_32x32x16_bf16 v[56:71], a[100:103], v[24:27], v[56:71]
    ds_read_b128 v[20:23], v2 offset:19456
    s_waitcnt lgkmcnt(6)
    v_mfma_f32_32x32x16_bf16 v[40:55], a[104:107], v[28:31], v[40:55]
    buffer_load_dwordx4 v1, s[8:11], s24 offen offset:2048 sc1 lds
    v_mfma_f32_32x32x16_bf16 v[56:71], a[108:111], v[28:31], v[56:71]
    ds_read_b128 v[24:27], v2 offset:20480
    s_waitcnt lgkmcnt(6)
    v_mfma_f32_32x32x16_bf16 v[40:55], a[112:115], v[32:35], v[40:55]
    buffer_load_dwordx4 v1, s[8:11], s24 offen offset:3072 sc1 lds
    v_mfma_f32_32x32x16_bf16 v[56:71], a[116:119], v[32:35], v[56:71]
    ds_read_b128 v[28:31], v2 offset:21504
    s_waitcnt lgkmcnt(6)
    v_mfma_f32_32x32x16_bf16 v[40:55], a[120:123], v[36:39], v[40:55]
    s_add_u32 s24, s24, 4096
    s_add_u32 s25, s25, 4096
    s_mov_b32 m0, s25
    s_nop 0
    buffer_load_dwordx4 v1, s[8:11], s24 offen offset:0 sc1 lds
    v_mfma_f32_32x32x16_bf16 v[56:71], a[124:127], v[36:39], v[56:71]
    ds_read_b128 v[32:35], v2 offset:22528
    s_waitcnt lgkmcnt(6)
    v_mfma_f32_32x32x16_bf16 v[40:55], a[128:131], v[8:11], v[40:55]
    buffer_load_dwordx4 v1, s[8:11], s24 offen offset:1024 sc1 lds
    v_mfma_f32_32x32x16_bf16 v[56:71], a[132:135], v[8:11], v[56:71]
    ds_read_b128 v[36:39], v2 offset:23552
    s_waitcnt lgkmcnt(6)
    v_mfma_f32_32x32x16_bf16 v[40:55], a[136:139], v[12:15], v[40:55]
    v_mfma_f32_32x32x16_bf16 v[56:71], a[140:143], v[12:15], v[56:71]
    ds_read_b128 v[8:11], v2 offset:24576
    s_waitcnt lgkmcnt(6)
    v_mfma_f32_32x32x16_bf16 v[40:55], a[144:147], v[16:19], v[40:55]
    v_mfma_f32_32x32x16_bf16 v[56:71], a[148:151], v[16:19], v[56:71]
    ds_read_b128 v[12:15], v2 offset:25600
    s_waitcnt lgkmcnt(6)
    v_mfma_f32_32x32x16_bf16 v[40:55], a[152:155], v[20:23], v[40:55]
    v_mfma_f32_32x32x16_bf16 v[56:71], a[156:159], v[20:23], v[56:71]
    ds_read_b128 v[16:19], v2 offset:26624
    s_waitcnt lgkmcnt(6)
    v_mfma_f32_32x32x16_bf16 v[40:55], a[160:163], v[24:27], v[40:55]
    v_mfma_f32_32x32x16_bf16 v[56:71], a[164:167], v[24:27], v[56:71]
    ds_read_b128 v[20:23], v2 offset:27648
    s_waitcnt lgkmcnt(6)
    v_mfma_f32_32x32x16_bf16 v[40:55], a[168:171], v[28:31], v[40:55]
    v_mfma_f32_32x32x16_bf16 v[56:71], a[172:175], v[28:31], v[56:71]
    ds_read_b128 v[24:27], v2 offset:28672
    s_waitcnt lgkmcnt(6)
    v_mfma_f32_32x32x16_bf16 v[40:55], a[176:179], v[32:35], v[40:55]
    v_mfma_f32_32x32x16_bf16 v[56:71], a[180:183], v[32:35], v[56:71]
    ds_read_b128 v[28:31], v2 offset:29696
    s_waitcnt lgkmcnt(6)
    v_mfma_f32_32x32x16_bf16 v[40:55], a[184:187], v[36:39], v[40:55]
    v_mfma_f32_32x32x16_bf16 v[56:71], a[188:191], v[36:39], v[56:71]
    ds_read_b128 v[32:35], v2 offset:30720
    s_waitcnt lgkmcnt(6)
    v_mfma_f32_32x32x16_bf16 v[40:55], a[192:195], v[8:11], v[40:55]
    v_mfma_f32_32x32x16_bf16 v[56:71], a[196:199], v[8:11], v[56:71]
    ds_read_b128 v[36:39], v2 offset:31744
    s_waitcnt lgkmcnt(6)
    v_mfma_f32_32x32x16_bf16 v[40:55], a[200:203], v[12:15], v[40:55]
    v_mfma_f32_32x32x16_bf16 v[56:71], a[204:207], v[12:15], v[56:71]
    ds_read_b128 v[8:11], v2 offset:32768
    s_waitcnt lgkmcnt(6)
    v_mfma_f32_32x32x16_bf16 v[40:55], a[208:211], v[16:19], v[40:55]
    v_mfma_f32_32x32x16_bf16 v[56:71], a[212:215], v[16:19], v[56:71]
    ds_read_b128 v[12:15], v2 offset:33792
    s_waitcnt lgkmcnt(6)
    v_mfma_f32_32x32x16_bf16 v[40:55], a[216:219], v[20:23], v[40:55]
    v_mfma_f32_32x32x16_bf16 v[56:71], a[220:223], v[20:23], v[56:71]
    ds_read_b128 v[16:19], v2 offset:34816
    s_waitcnt lgkmcnt(6)
    v_mfma_f32_32x32x16_bf16 v[40:55], a[224:227], v[24:27], v[40:55]
    v_mfma_f32_32x32x16_bf16 v[56:71], a[228:231], v[24:27], v[56:71]
    s_waitcnt vmcnt(0)
    s_barrier
    s_add_u32 s21, s16, 40960
    s_cmp_eq_u32 s21, 122880
    s_cselect_b32 s21, 0, s21
    ds_read_b128 v[20:23], v2 offset:35840
    s_waitcnt lgkmcnt(6)
    v_mfma_f32_32x32x16_bf16 v[40:55], a[232:235], v[28:31], v[40:55]
    v_mfma_f32_32x32x16_bf16 v[56:71], a[236:239], v[28:31], v[56:71]
    ds_read_b128 v[24:27], v2 offset:36864
    s_waitcnt lgkmcnt(6)
    v_mfma_f32_32x32x16_bf16 v[40:55], a[240:243], v[32:35], v[40:55]
    v_mfma_f32_32x32x16_bf16 v[56:71], a[244:247], v[32:35], v[56:71]
    ds_read_b128 v[28:31], v2 offset:37888
    s_waitcnt lgkmcnt(6)
    v_mfma_f32_32x32x16_bf16 v[40:55], a[248:251], v[36:39], v[40:55]
    v_mfma_f32_32x32x16_bf16 v[56:71], a[252:255], v[36:39], v[56:71]
    ds_read_b128 v[32:35], v2 offset:38912
    s_waitcnt lgkmcnt(6)
    v_mfma_f32_32x32x16_bf16 v[40:55], v[192:195], v[8:11], v[40:55]
    v_mfma_f32_32x32x16_bf16 v[56:71], v[196:199], v[8:11], v[56:71]
    ds_read_b128 v[36:39], v2 offset:39936
    s_waitcnt lgkmcnt(6)
    v_mfma_f32_32x32x16_bf16 v[40:55], v[200:203], v[12:15], v[40:55]
    v_mfma_f32_32x32x16_bf16 v[56:71], v[204:207], v[12:15], v[56:71]
    v_add_u32 v6, s21, v1
    ds_read_b128 v[8:11], v6 offset:0
    s_waitcnt lgkmcnt(6)
    v_mfma_f32_32x32x16_bf16 v[40:55], v[208:211], v[16:19], v[40:55]
    v_mfma_f32_32x32x16_bf16 v[56:71], v[212:215], v[16:19], v[56:71]
    ds_read_b128 v[12:15], v6 offset:1024
    s_waitcnt lgkmcnt(6)
    v_mfma_f32_32x32x16_bf16 v[40:55], v[216:219], v[20:23], v[40:55]
    v_mfma_f32_32x32x16_bf16 v[56:71], v[220:223], v[20:23], v[56:71]
    ds_read_b128 v[16:19], v6 offset:2048
    s_waitcnt lgkmcnt(6)
    v_mfma_f32_32x32x16_bf16 v[40:55], v[224:227], v[24:27], v[40:55]
    v_mfma_f32_32x32x16_bf16 v[56:71], v[228:231], v[24:27], v[56:71]
    ds_read_b128 v[20:23], v6 offset:3072
    s_waitcnt lgkmcnt(6)
    v_mfma_f32_32x32x16_bf16 v[40:55], v[232:235], v[28:31], v[40:55]
    v_mfma_f32_32x32x16_bf16 v[56:71], v[236:239], v[28:31], v[56:71]
    ds_read_b128 v[24:27], v6 offset:4096
    s_waitcnt lgkmcnt(6)
    v_mfma_f32_32x32x16_bf16 v[40:55], v[240:243], v[32:35], v[40:55]
    v_mfma_f32_32x32x16_bf16 v[56:71], v[244:247], v[32:35], v[56:71]
    ds_read_b128 v[28:31], v6 offset:5120
    s_waitcnt lgkmcnt(6)
    v_mfma_f32_32x32x16_bf16 v[40:55], v[248:251], v[36:39], v[40:55]
    v_mfma_f32_32x32x16_bf16 v[56:71], v[252:255], v[36:39], v[56:71]
    v_mov_b32 v2, v6
    s_mov_b32 s16, s21
    s_add_u32 s14, s14, 1
    s_nop 7
    s_nop 7
    v_cvt_pk_bf16_f32 v104, v40, v41
    v_cvt_pk_bf16_f32 v105, v42, v43
    v_cvt_pk_bf16_f32 v106, v44, v45
    v_cvt_pk_bf16_f32 v107, v46, v47
    s_nop 1
    v_permlane32_swap_b32 v104, v106
    v_permlane32_swap_b32 v105, v107
    buffer_store_dwordx4 v[104:107], v3, s[8:11], s17 offen offset:0 sc1
    v_cvt_pk_bf16_f32 v108, v48, v49
    v_cvt_pk_bf16_f32 v109, v50, v51
    v_cvt_pk_bf16_f32 v110, v52, v53
    v_cvt_pk_bf16_f32 v111, v54, v55
    s_nop 1
    v_permlane32_swap_b32 v108, v110
    v_permlane32_swap_b32 v109, v111
    buffer_store_dwordx4 v[108:111], v3, s[8:11], s17 offen offset:1024 sc1
    v_cvt_pk_bf16_f32 v112, v56, v57
    v_cvt_pk_bf16_f32 v113, v58, v59
    v_cvt_pk_bf16_f32 v114, v60, v61
    v_cvt_pk_bf16_f32 v115, v62, v63
    s_nop 1
    v_permlane32_swap_b32 v112, v114
    v_permlane32_swap_b32 v113, v115
    buffer_store_dwordx4 v[112:115], v3, s[8:11], s18 offen offset:0 sc1
    v_cvt_pk_bf16_f32 v116, v64, v65
    v_cvt_pk_bf16_f32 v117, v66, v67
    v_cvt_pk_bf16_f32 v118, v68, v69
    v_cvt_pk_bf16_f32 v119, v70, v71
    s_nop 1
    v_permlane32_swap_b32 v116, v118
    v_permlane32_swap_b32 v117, v119
    buffer_store_dwordx4 v[116:119], v3, s[8:11], s18 offen offset:1024 sc1
    s_add_u32 s17, s17, s20
    s_add_u32 s18, s18, s20
    s_waitcnt vmcnt(0)
    s_barrier
    s_cmp_lg_u32 s13, 0
    s_cbranch_scc1 layerb1_kernel_gk_fl3
    s_mov_b64 exec, 1
    s_lshl_b32 s26, s12, 7
    v_mov_b32 v7, s26
    v_mov_b32 v120, s14
    buffer_store_dword v120, v7, s[8:11], s48 offen sc1
    s_mov_b64 exec, -1
layerb1_kernel_gk_fl3:
    ds_read_b128 v[32:35], v2 offset:6144
    s_waitcnt lgkmcnt(6)
    v_mfma_f32_32x32x16_bf16 v[72:87], a[0:3], v[8:11], 0
    v_mfma_f32_32x32x16_bf16 v[88:103], a[4:7], v[8:11], 0
    ds_read_b128 v[36:39], v2 offset:7168
    s_waitcnt lgkmcnt(6)
    v_mfma_f32_32x32x16_bf16 v[72:87], a[8:11], v[12:15], v[72:87]
    v_mfma_f32_32x32x16_bf16 v[88:103], a[12:15], v[12:15], v[88:103]
    ds_read_b128 v[8:11], v2 offset:8192
    s_waitcnt lgkmcnt(6)
    v_mfma_f32_32x32x16_bf16 v[72:87], a[16:19], v[16:19], v[72:87]
    v_mfma_f32_32x32x16_bf16 v[88:103], a[20:23], v[16:19], v[88:103]
    s_add_u32 s23, s14, 1
    s_cmp_lg_u32 s13, 0
    s_cbranch_scc1 layerb1_kernel_gk_lw4
    s_min_u32 s28, s23, 63
    s_cmp_gt_u32 s56, s28
    s_cbranch_scc1 layerb1_kernel_gk_lw4
layerb1_kernel_gk_lp4:
    buffer_load_dwordx4 v[124:127], v1, s[8:11], s57 offen sc1
    s_waitcnt vmcnt(0)
    v_min_u32 v124, v124, v125
    v_min_u32 v126, v126, v127
    v_min_u32 v124, v124, v126
    v_cmp_eq_u32 vcc, 0, v124
    s_nop 1
    s_ff1_i32_b64 s56, vcc
    s_min_u32 s56, s56, 64
    s_sub_u32 s58, s58, 1
    s_cbranch_scc1 layerb1_kernel_bail
    s_cmp_gt_u32 s56, s28
    s_cbranch_scc0 layerb1_kernel_gk_lp4
layerb1_kernel_gk_lw4:
    s_barrier
    s_min_u32 s24, s23, 63
    s_mul_i32 s24, s24, 40960
    s_add_u32 s24, s24, s19
    s_mul_i32 s25, s13, 10240
    s_add_u32 s25, s25, s22
    s_add_u32 s22, s22, 40960
    s_cmp_eq_u32 s22, 122880
    s_cselect_b32 s22, 0, s22
    ds_read_b128 v[12:15], v2 offset:9216
    s_waitcnt lgkmcnt(6)
    v_mfma_f32_32x32x16_bf16 v[72:87], a[24:27], v[20:23], v[72:87]
    s_mov_b32 m0, s25
    s_nop 0
    buffer_load_dwordx4 v1, s[8:11], s24 offen offset:0 sc1 lds
    v_mfma_f32_32x32x16_bf16 v[88:103], a[28:31], v[20:23], v[88:103]
    ds_read_b128 v[16:19], v2 offset:10240
    s_waitcnt lgkmcnt(6)
    v_mfma_f32_32x32x16_bf16 v[72:87], a[32:35], v[24:27], v[72:87]
    buffer_load_dwordx4 v1, s[8:11], s24 offen offset:1024 sc1 lds
    v_mfma_f32_32x32x16_bf16 v[88:103], a[36:39], v[24:27], v[88:103]
    ds_read_b128 v[20:23], v2 offset:11264
    s_waitcnt lgkmcnt(6)
    v_mfma_f32_32x32x16_bf16 v[72:87], a[40:43], v[28:31], v[72:87]
    buffer_load_dwordx4 v1, s[8:11], s24 offen offset:2048 sc1 lds
    v_mfma_f32_32x32x16_bf16 v[88:103], a[44:47], v[28:31], v[88:103]
    ds_read_b128 v[24:27], v2 offset:12288
    s_waitcnt lgkmcnt(6)
    v_mfma_f32_32x32x16_bf16 v[72:87], a[48:51], v[32:35], v[72:87]
    buffer_load_dwordx4 v1, s[8:11], s24 offen offset:3072 sc1 lds
    v_mfma_f32_32x32x16_bf16 v[88:103], a[52:55], v[32:35], v[88:103]
    ds_read_b128 v[28:31], v2 offset:13312
    s_waitcnt lgkmcnt(6)
    v_mfma_f32_32x32x16_bf16 v[72:87], a[56:59], v[36:39], v[72:87]
    s_add_u32 s24, s24, 4096
    s_add_u32 s25, s25, 4096
    s_mov_b32 m0, s25
    s_nop 0
    buffer_load_dwordx4 v1, s[8:11], s24 offen offset:0 sc1 lds
    v_mfma_f32_32x32x16_bf16 v[88:103], a[60:63], v[36:39], v[88:103]
    ds_read_b128 v[32:35], v2 offset:14336
    s_waitcnt lgkmcnt(6)
    v_mfma_f32_32x32x16_bf16 v[72:87], a[64:67], v[8:11], v[72:87]
    buffer_load_dwordx4 v1, s[8:11], s24 offen offset:1024 sc1 lds
    v_mfma_f32_32x32x16_bf16 v[88:103], a[68:71], v[8:11], v[88:103]
    ds_read_b128 v[36:39], v2 offset:15360
    s_waitcnt lgkmcnt(6)
    v_mfma_f32_32x32x16_bf16 v[72:87], a[72:75], v[12:15], v[72:87]
    buffer_load_dwordx4 v1, s[8:11], s24 offen offset:2048 sc1 lds
    v_mfma_f32_32x32x16_bf16 v[88:103], a[76:79], v[12:15], v[88:103]
    ds_read_b128 v[8:11], v2 offset:16384
    s_waitcnt lgkmcnt(6)
    v_mfma_f32_32x32x16_bf16 v[72:87], a[80:83], v[16:19], v[72:87]
    buffer_load_dwordx4 v1, s[8:11], s24 offen offset:3072 sc1 lds
    v_mfma_f32_32x32x16_bf16 v[88:103], a[84:87], v[16:19], v[88:103]
    ds_read_b128 v[12:15], v2 offset:17408
    s_waitcnt lgkmcnt(6)
    v_mfma_f32_32x32x16_bf16 v[72:87], a[88:91], v[20:23], v[72:87]
    s_add_u32 s24, s24, 4096
    s_add_u32 s25, s25, 4096
    s_mov_b32 m0, s25
    s_nop 0
    buffer_load_dwordx4 v1, s[8:11], s24 offen offset:0 sc1 lds
    v_mfma_f32_32x32x16_bf16 v[88:103], a[92:95], v[20:23], v[88:103]
    ds_read_b128 v[16:19], v2 offset:18432
    s_waitcnt lgkmcnt(6)
    v_mfma_f32_32x32x16_bf16 v[72:87], a[96:99], v[24:27], v[72:87]
    buffer_load_dwordx4 v1, s[8:11], s24 offen offset:1024 sc1 lds
    v_mfma_f32_32x32x16_bf16 v[88:103], a[100:103], v[24:27], v[88:103]
    ds_read_b128 v[20:23], v2 offset:19456
    s_waitcnt lgkmcnt(6)
    v_mfma_f32_32x32x16_bf16 v[72:87], a[104:107], v[28:31], v[72:87]
    v_mfma_f32_32x32x16_bf16 v[88:103], a[108:111], v[28:31], v[88:103]
    ds_read_b128 v[24:27], v2 offset:20480
    s_waitcnt lgkmcnt(6)
    v_mfma_f32_32x32x16_bf16 v[72:87], a[112:115], v[32:35], v[72:87]
    v_mfma_f32_32x32x16_bf16 v[88:103], a[116:119], v[32:35], v[88:103]
    ds_read_b128 v[28:31], v2 offset:21504
    s_waitcnt lgkmcnt(6)
    v_mfma_f32_32x32x16_bf16 v[72:87], a[120:123], v[36:39], v[72:87]
    v_mfma_f32_32x32x16_bf16 v[88:103], a[124:127], v[36:39], v[88:103]
    ds_read_b128 v[32:35], v2 offset:22528
    s_waitcnt lgkmcnt(6)
    v_mfma_f32_32x32x16_bf16 v[72:87], a[128:131], v[8:11], v[72:87]
    v_mfma_f32_32x32x16_bf16 v[88:103], a[132:135], v[8:11], v[88:103]
    ds_read_b128 v[36:39], v2 offset:23552
    s_waitcnt lgkmcnt(6)
    v_mfma_f32_32x32x16_bf16 v[72:87], a[136:139], v[12:15], v[72:87]
    v_mfma_f32_32x32x16_bf16 v[88:103], a[140:143], v[12:15], v[88:103]
    ds_read_b128 v[8:11], v2 offset:24576
    s_waitcnt lgkmcnt(6)
    v_mfma_f32_32x32x16_bf16 v[72:87], a[144:147], v[16:19], v[72:87]
    v_mfma_f32_32x32x16_bf16 v[88:103], a[148:151], v[16:19], v[88:103]
    ds_read_b128 v[12:15], v2 offset:25600
    s_waitcnt lgkmcnt(6)
    v_mfma_f32_32x32x16_bf16 v[72:87], a[152:155], v[20:23], v[72:87]
    v_mfma_f32_32x32x16_bf16 v[88:103], a[156:159], v[20:23], v[88:103]
    ds_read_b128 v[16:19], v2 offset:26624
    s_waitcnt lgkmcnt(6)
    v_mfma_f32_32x32x16_bf16 v[72:87], a[160:163], v[24:27], v[72:87]
    v_mfma_f32_32x32x16_bf16 v[88:103], a[164:167], v[24:27], v[88:103]
    ds_read_b128 v[20:23], v2 offset:27648
    s_waitcnt lgkmcnt(6)
    v_mfma_f32_32x32x16_bf16 v[72:87], a[168:171], v[28:31], v[72:87]
    v_mfma_f32_32x32x16_bf16 v[88:103], a[172:175], v[28:31], v[88:103]
    ds_read_b128 v[24:27], v2 offset:28672
    s_waitcnt lgkmcnt(6)
    v_mfma_f32_32x32x16_bf16 v[72:87], a[176:179], v[32:35], v[72:87]
    v_mfma_f32_32x32x16_bf16 v[88:103], a[180:183], v[32:35], v[88:103]
    ds_read_b128 v[28:31], v2 offset:29696
    s_waitcnt lgkmcnt(6)
    v_mfma_f32_32x32x16_bf16 v[72:87], a[184:187], v[36:39], v[72:87]
    v_mfma_f32_32x32x16_bf16 v[88:103], a[188:191], v[36:39], v[88:103]
    ds_read_b128 v[32:35], v2 offset:30720
    s_waitcnt lgkmcnt(6)
    v_mfma_f32_32x32x16_bf16 v[72:87], a[192:195], v[8:11], v[72:87]
    v_mfma_f32_32x32x16_bf16 v[88:103], a[196:199], v[8:11], v[88:103]
    ds_read_b128 v[36:39], v2 offset:31744
    s_waitcnt lgkmcnt(6)
    v_mfma_f32_32x32x16_bf16 v[72:87], a[200:203], v[12:15], v[72:87]
    v_mfma_f32_32x32x16_bf16 v[88:103], a[204:207], v[12:15], v[88:103]
    ds_read_b128 v[8:11], v2 offset:32768
    s_waitcnt lgkmcnt(6)
    v_mfma_f32_32x32x16_bf16 v[72:87], a[208:211], v[16:19], v[72:87]
    v_mfma_f32_32x32x16_bf16 v[88:103], a[212:215], v[16:19], v[88:103]
    ds_read_b128 v[12:15], v2 offset:33792
    s_waitcnt lgkmcnt(6)
    v_mfma_f32_32x32x16_bf16 v[72:87], a[216:219], v[20:23], v[72:87]
    v_mfma_f32_32x32x16_bf16 v[88:103], a[220:223], v[20:23], v[88:103]
    ds_read_b128 v[16:19], v2 offset:34816
    s_waitcnt lgkmcnt(6)
    v_mfma_f32_32x32x16_bf16 v[72:87], a[224:227], v[24:27], v[72:87]
    v_mfma_f32_32x32x16_bf16 v[88:103], a[228:231], v[24:27], v[88:103]
    s_add_u32 s23, s14, 2
    s_cmp_lg_u32 s13, 0
    s_cbranch_scc1 layerb1_kernel_gk_lw5
    s_min_u32 s28, s23, 63
    s_cmp_gt_u32 s56, s28
    s_cbranch_scc1 layerb1_kernel_gk_lw5
layerb1_kernel_gk_lp5:
    buffer_load_dwordx4 v[124:127], v1, s[8:11], s57 offen sc1
    s_waitcnt vmcnt(0)
    v_min_u32 v124, v124, v125
    v_min_u32 v126, v126, v127
    v_min_u32 v124, v124, v126
    v_cmp_eq_u32 vcc, 0, v124
    s_nop 1
    s_ff1_i32_b64 s56, vcc
    s_min_u32 s56, s56, 64
    s_sub_u32 s58, s58, 1
    s_cbranch_scc1 layerb1_kernel_bail
    s_cmp_gt_u32 s56, s28
    s_cbranch_scc0 layerb1_kernel_gk_lp5
layerb1_kernel_gk_lw5:
    s_waitcnt vmcnt(0)
    s_barrier
    s_add_u32 s21, s16, 40960
    s_cmp_eq_u32 s21, 122880
    s_cselect_b32 s21, 0, s21
    s_add_u32 s23, s14, 2
    s_min_u32 s24, s23, 63
    s_mul_i32 s24, s24, 40960
    s_add_u32 s24, s24, s19
    s_mul_i32 s25, s13, 10240
    s_add_u32 s25, s25, s22
    s_add_u32 s22, s22, 40960
    s_cmp_eq_u32 s22, 122880
    s_cselect_b32 s22, 0, s22
    ds_read_b128 v[20:23], v2 offset:35840
    s_waitcnt lgkmcnt(6)
    v_mfma_f32_32x32x16_bf16 v[72:87], a[232:235], v[28:31], v[72:87]
    s_mov_b32 m0, s25
    s_nop 0
    buffer_load_dwordx4 v1, s[8:11], s24 offen offset:0 sc1 lds
    v_mfma_f32_32x32x16_bf16 v[88:103], a[236:239], v[28:31], v[88:103]
    ds_read_b128 v[24:27], v2 offset:36864
    s_waitcnt lgkmcnt(6)
    v_mfma_f32_32x32x16_bf16 v[72:87], a[240:243], v[32:35], v[72:87]
    buffer_load_dwordx4 v1, s[8:11], s24 offen offset:1024 sc1 lds
    v_mfma_f32_32x32x16_bf16 v[88:103], a[244:247], v[32:35], v[88:103]
    ds_read_b128 v[28:31], v2 offset:37888
    s_waitcnt lgkmcnt(6)
    v_mfma_f32_32x32x16_bf16 v[72:87], a[248:251], v[36:39], v[72:87]
    buffer_load_dwordx4 v1, s[8:11], s24 offen offset:2048 sc1 lds
    v_mfma_f32_32x32x16_bf16 v[88:103], a[252:255], v[36:39], v[88:103]
    ds_read_b128 v[32:35], v2 offset:38912
    s_waitcnt lgkmcnt(6)
    v_mfma_f32_32x32x16_bf16 v[72:87], v[192:195], v[8:11], v[72:87]
    buffer_load_dwordx4 v1, s[8:11], s24 offen offset:3072 sc1 lds
    v_mfma_f32_32x32x16_bf16 v[88:103], v[196:199], v[8:11], v[88:103]
    ds_read_b128 v[36:39], v2 offset:39936
    s_waitcnt lgkmcnt(6)
    v_mfma_f32_32x32x16_bf16 v[72:87], v[200:203], v[12:15], v[72:87]
    s_add_u32 s24, s24, 4096
    s_add_u32 s25, s25, 4096
    s_mov_b32 m0, s25
    s_nop 0
    buffer_load_dwordx4 v1, s[8:11], s24 offen offset:0 sc1 lds
    v_mfma_f32_32x32x16_bf16 v[88:103], v[204:207], v[12:15], v[88:103]
    v_add_u32 v6, s21, v1
    ds_read_b128 v[8:11], v6 offset:0
    s_waitcnt lgkmcnt(6)
    v_mfma_f32_32x32x16_bf16 v[72:87], v[208:211], v[16:19], v[72:87]
    buffer_load_dwordx4 v1, s[8:11], s24 offen offset:1024 sc1 lds
    v_mfma_f32_32x32x16_bf16 v[88:103], v[212:215], v[16:19], v[88:103]
    ds_read_b128 v[12:15], v6 offset:1024
    s_waitcnt lgkmcnt(6)
    v_mfma_f32_32x32x16_bf16 v[72:87], v[216:219], v[20:23], v[72:87]
    buffer_load_dwordx4 v1, s[8:11], s24 offen offset:2048 sc1 lds
    v_mfma_f32_32x32x16_bf16 v[88:103], v[220:223], v[20:23], v[88:103]
    ds_read_b128 v[16:19], v6 offset:2048
    s_waitcnt lgkmcnt(6)
    v_mfma_f32_32x32x16_bf16 v[72:87], v[224:227], v[24:27], v[72:87]
    buffer_load_dwordx4 v1, s[8:11], s24 offen offset:3072 sc1 lds
    v_mfma_f32_32x32x16_bf16 v[88:103], v[228:231], v[24:27], v[88:103]
    ds_read_b128 v[20:23], v6 offset:3072
    s_waitcnt lgkmcnt(6)
    v_mfma_f32_32x32x16_bf16 v[72:87], v[232:235], v[28:31], v[72:87]
    s_add_u32 s24, s24, 4096
    s_add_u32 s25, s25, 4096
    s_mov_b32 m0, s25
    s_nop 0
    buffer_load_dwordx4 v1, s[8:11], s24 offen offset:0 sc1 lds
    v_mfma_f32_32x32x16_bf16 v[88:103], v[236:239], v[28:31], v[88:103]
    ds_read_b128 v[24:27], v6 offset:4096
    s_waitcnt lgkmcnt(6)
    v_mfma_f32_32x32x16_bf16 v[72:87], v[240:243], v[32:35], v[72:87]
    buffer_load_dwordx4 v1, s[8:11], s24 offen offset:1024 sc1 lds
    v_mfma_f32_32x32x16_bf16 v[88:103], v[244:247], v[32:35], v[88:103]
    ds_read_b128 v[28:31], v6 offset:5120
    s_waitcnt lgkmcnt(6)
    v_mfma_f32_32x32x16_bf16 v[72:87], v[248:251], v[36:39], v[72:87]
    v_mfma_f32_32x32x16_bf16 v[88:103], v[252:255], v[36:39], v[88:103]
    v_mov_b32 v2, v6
    s_mov_b32 s16, s21
    s_add_u32 s14, s14, 1
layerb1_kernel_gk_loop:
    ds_read_b128 v[32:35], v2 offset:6144
    s_waitcnt lgkmcnt(6)
    v_mfma_f32_32x32x16_bf16 v[40:55], a[0:3], v[8:11], 0
    v_mfma_f32_32x32x16_bf16 v[56:71], a[4:7], v[8:11], 0
    ds_read_b128 v[36:39], v2 offset:7168
    s_waitcnt lgkmcnt(6)
    v_mfma_f32_32x32x16_bf16 v[40:55], a[8:11], v[12:15], v[40:55]
    v_mfma_f32_32x32x16_bf16 v[56:71], a[12:15], v[12:15], v[56:71]
    ds_read_b128 v[8:11], v2 offset:8192
    s_waitcnt lgkmcnt(6)
    v_mfma_f32_32x32x16_bf16 v[40:55], a[16:19], v[16:19], v[40:55]
    v_cvt_pk_bf16_f32 v104, v72, v73
    v_mfma_f32_32x32x16_bf16 v[56:71], a[20:23], v[16:19], v[56:71]
    v_cvt_pk_bf16_f32 v105, v74, v75
    ds_read_b128 v[12:15], v2 offset:9216
    s_waitcnt lgkmcnt(6)
    v_mfma_f32_32x32x16_bf16 v[40:55], a[24:27], v[20:23], v[40:55]
    v_cvt_pk_bf16_f32 v106, v76, v77
    v_mfma_f32_32x32x16_bf16 v[56:71], a[28:31], v[20:23], v[56:71]
    v_cvt_pk_bf16_f32 v107, v78, v79
    ds_read_b128 v[16:19], v2 offset:10240
    s_waitcnt lgkmcnt(6)
    v_mfma_f32_32x32x16_bf16 v[40:55], a[32:35], v[24:27], v[40:55]
    s_nop 1
    v_mfma_f32_32x32x16_bf16 v[56:71], a[36:39], v[24:27], v[56:71]
    v_permlane32_swap_b32 v104, v106
    ds_read_b128 v[20:23], v2 offset:11264
    s_waitcnt lgkmcnt(6)
    v_mfma_f32_32x32x16_bf16 v[40:55], a[40:43], v[28:31], v[40:55]
    v_permlane32_swap_b32 v105, v107
    v_mfma_f32_32x32x16_bf16 v[56:71], a[44:47], v[28:31], v[56:71]
    buffer_store_dwordx4 v[104:107], v3, s[8:11], s17 offen offset:0 sc1
    ds_read_b128 v[24:27], v2 offset:12288
    s_waitcnt lgkmcnt(6)
    v_mfma_f32_32x32x16_bf16 v[40:55], a[48:51], v[32:35], v[40:55]
    v_cvt_pk_bf16_f32 v108, v80, v81
    v_mfma_f32_32x32x16_bf16 v[56:71], a[52:55], v[32:35], v[56:71]
    v_cvt_pk_bf16_f32 v109, v82, v83
    ds_read_b128 v[28:31], v2 offset:13312
    s_waitcnt lgkmcnt(6)
    v_mfma_f32_32x32x16_bf16 v[40:55], a[56:59], v[36:39], v[40:55]
    v_cvt_pk_bf16_f32 v110, v84, v85
    v_mfma_f32_32x32x16_bf16 v[56:71], a[60:63], v[36:39], v[56:71]
    v_cvt_pk_bf16_f32 v111, v86, v87
    ds_read_b128 v[32:35], v2 offset:14336
    s_waitcnt lgkmcnt(6)
    v_mfma_f32_32x32x16_bf16 v[40:55], a[64:67], v[8:11], v[40:55]
    s_nop 1
    v_mfma_f32_32x32x16_bf16 v[56:71], a[68:71], v[8:11], v[56:71]
    v_permlane32_swap_b32 v108, v110
    ds_read_b128 v[36:39], v2 offset:15360
    s_waitcnt lgkmcnt(6)
    v_mfma_f32_32x32x16_bf16 v[40:55], a[72:75], v[12:15], v[40:55]
    v_permlane32_swap_b32 v109, v111
    v_mfma_f32_32x32x16_bf16 v[56:71], a[76:79], v[12:15], v[56:71]
    buffer_store_dwordx4 v[108:111], v3, s[8:11], s17 offen offset:1024 sc1
    ds_read_b128 v[8:11], v2 offset:16384
    s_waitcnt lgkmcnt(6)
    v_mfma_f32_32x32x16_bf16 v[40:55], a[80:83], v[16:19], v[40:55]
    v_cvt_pk_bf16_f32 v112, v88, v89
    v_mfma_f32_32x32x16_bf16 v[56:71], a[84:87], v[16:19], v[56:71]
    v_cvt_pk_bf16_f32 v113, v90, v91
    ds_read_b128 v[12:15], v2 offset:17408
    s_waitcnt lgkmcnt(6)
    v_mfma_f32_32x32x16_bf16 v[40:55], a[88:91], v[20:23], v[40:55]
    v_cvt_pk_bf16_f32 v114, v92, v93
    v_mfma_f32_32x32x16_bf16 v[56:71], a[92:95], v[20:23], v[56:71]
    v_cvt_pk_bf16_f32 v115, v94, v95
    ds_read_b128 v[16:19], v2 offset:18432
    s_waitcnt lgkmcnt(6)
    v_mfma_f32_32x32x16_bf16 v[40:55], a[96:99], v[24:27], v[40:55]
    s_nop 1
    v_mfma_f32_32x32x16_bf16 v[56:71], a[100:103], v[24:27], v[56:71]
    v_permlane32_swap_b32 v112, v114
    ds_read_b128 v[20:23], v2 offset:19456
    s_waitcnt lgkmcnt(6)
    v_mfma_f32_32x32x16_bf16 v[40:55], a[104:107], v[28:31], v[40:55]
    v_permlane32_swap_b32 v113, v115
    v_mfma_f32_32x32x16_bf16 v[56:71], a[108:111], v[28:31], v[56:71]
    buffer_store_dwordx4 v[112:115], v3, s[8:11], s18 offen offset:0 sc1
    ds_read_b128 v[24:27], v2 offset:20480
    s_waitcnt lgkmcnt(6)
    v_mfma_f32_32x32x16_bf16 v[40:55], a[112:115], v[32:35], v[40:55]
    v_cvt_pk_bf16_f32 v116, v96, v97
    v_mfma_f32_32x32x16_bf16 v[56:71], a[116:119], v[32:35], v[56:71]
    v_cvt_pk_bf16_f32 v117, v98, v99
    ds_read_b128 v[28:31], v2 offset:21504
    s_waitcnt lgkmcnt(6)
    v_mfma_f32_32x32x16_bf16 v[40:55], a[120:123], v[36:39], v[40:55]
    v_cvt_pk_bf16_f32 v118, v100, v101
    v_mfma_f32_32x32x16_bf16 v[56:71], a[124:127], v[36:39], v[56:71]
    v_cvt_pk_bf16_f32 v119, v102, v103
    ds_read_b128 v[32:35], v2 offset:22528
    s_waitcnt lgkmcnt(6)
    v_mfma_f32_32x32x16_bf16 v[40:55], a[128:131], v[8:11], v[40:55]
    s_nop 1
    v_mfma_f32_32x32x16_bf16 v[56:71], a[132:135], v[8:11], v[56:71]
    v_permlane32_swap_b32 v116, v118
    ds_read_b128 v[36:39], v2 offset:23552
    s_waitcnt lgkmcnt(6)
    v_mfma_f32_32x32x16_bf16 v[40:55], a[136:139], v[12:15], v[40:55]
    v_permlane32_swap_b32 v117, v119
    v_mfma_f32_32x32x16_bf16 v[56:71], a[140:143], v[12:15], v[56:71]
    buffer_store_dwordx4 v[116:119], v3, s[8:11], s18 offen offset:1024 sc1
    ds_read_b128 v[8:11], v2 offset:24576
    s_waitcnt lgkmcnt(6)
    v_mfma_f32_32x32x16_bf16 v[40:55], a[144:147], v[16:19], v[40:55]
    s_add_u32 s17, s17, s20
    v_mfma_f32_32x32x16_bf16 v[56:71], a[148:151], v[16:19], v[56:71]
    s_add_u32 s18, s18, s20
    ds_read_b128 v[12:15], v2 offset:25600
    s_waitcnt lgkmcnt(6)
    v_mfma_f32_32x32x16_bf16 v[40:55], a[152:155], v[20:23], v[40:55]
    v_mfma_f32_32x32x16_bf16 v[56:71], a[156:159], v[20:23], v[56:71]
    ds_read_b128 v[16:19], v2 offset:26624
    s_waitcnt lgkmcnt(6)
    v_mfma_f32_32x32x16_bf16 v[40:55], a[160:163], v[24:27], v[40:55]
    v_mfma_f32_32x32x16_bf16 v[56:71], a[164:167], v[24:27], v[56:71]
    ds_read_b128 v[20:23], v2 offset:27648
    s_waitcnt lgkmcnt(6)
    v_mfma_f32_32x32x16_bf16 v[40:55], a[168:171], v[28:31], v[40:55]
    v_mfma_f32_32x32x16_bf16 v[56:71], a[172:175], v[28:31], v[56:71]
    ds_read_b128 v[24:27], v2 offset:28672
    s_waitcnt lgkmcnt(6)
    v_mfma_f32_32x32x16_bf16 v[40:55], a[176:179], v[32:35], v[40:55]
    v_mfma_f32_32x32x16_bf16 v[56:71], a[180:183], v[32:35], v[56:71]
    ds_read_b128 v[28:31], v2 offset:29696
    s_waitcnt lgkmcnt(6)
    v_mfma_f32_32x32x16_bf16 v[40:55], a[184:187], v[36:39], v[40:55]
    v_mfma_f32_32x32x16_bf16 v[56:71], a[188:191], v[36:39], v[56:71]
    ds_read_b128 v[32:35], v2 offset:30720
    s_waitcnt lgkmcnt(6)
    v_mfma_f32_32x32x16_bf16 v[40:55], a[192:195], v[8:11], v[40:55]
    v_mfma_f32_32x32x16_bf16 v[56:71], a[196:199], v[8:11], v[56:71]
    ds_read_b128 v[36:39], v2 offset:31744
    s_waitcnt lgkmcnt(6)
    v_mfma_f32_32x32x16_bf16 v[40:55], a[200:203], v[12:15], v[40:55]
    v_mfma_f32_32x32x16_bf16 v[56:71], a[204:207], v[12:15], v[56:71]
    ds_read_b128 v[8:11], v2 offset:32768
    s_waitcnt lgkmcnt(6)
    v_mfma_f32_32x32x16_bf16 v[40:55], a[208:211], v[16:19], v[40:55]
    v_mfma_f32_32x32x16_bf16 v[56:71], a[212:215], v[16:19], v[56:71]
    ds_read_b128 v[12:15], v2 offset:33792
    s_waitcnt lgkmcnt(6)
    v_mfma_f32_32x32x16_bf16 v[40:55], a[216:219], v[20:23], v[40:55]
    v_mfma_f32_32x32x16_bf16 v[56:71], a[220:223], v[20:23], v[56:71]
    ds_read_b128 v[16:19], v2 offset:34816
    s_waitcnt lgkmcnt(6)
    v_mfma_f32_32x32x16_bf16 v[40:55], a[224:227], v[24:27], v[40:55]
    v_mfma_f32_32x32x16_bf16 v[56:71], a[228:231], v[24:27], v[56:71]
    s_add_u32 s23, s14, 2
    s_cmp_lg_u32 s13, 0
    s_cbranch_scc1 layerb1_kernel_gk_lw6
    s_min_u32 s28, s23, 63
    s_cmp_gt_u32 s56, s28
    s_cbranch_scc1 layerb1_kernel_gk_lw6
layerb1_kernel_gk_lp6:
    buffer_load_dwordx4 v[124:127], v1, s[8:11], s57 offen sc1
    s_waitcnt vmcnt(0)
    v_min_u32 v124, v124, v125
    v_min_u32 v126, v126, v127
    v_min_u32 v124, v124, v126
    v_cmp_eq_u32 vcc, 0, v124
    s_nop 1
    s_ff1_i32_b64 s56, vcc
    s_min_u32 s56, s56, 64
    s_sub_u32 s58, s58, 1
    s_cbranch_scc1 layerb1_kernel_bail
    s_cmp_gt_u32 s56, s28
    s_cbranch_scc0 layerb1_kernel_gk_lp6
layerb1_kernel_gk_lw6:
    s_cmp_gt_u32 s14, 2
    s_cbranch_scc1 layerb1_kernel_gk_dr7
    s_waitcnt vmcnt(0)
    s_mov_b32 s27, s14
    s_branch layerb1_kernel_gk_dq7
layerb1_kernel_gk_dr7:
    s_waitcnt vmcnt(4)
    s_sub_u32 s27, s14, 1
layerb1_kernel_gk_dq7:
    s_barrier
    s_cmp_lg_u32 s13, 0
    s_cbranch_scc1 layerb1_kernel_gk_fl8
    s_mov_b64 exec, 1
    s_lshl_b32 s26, s12, 7
    v_mov_b32 v7, s26
    v_mov_b32 v120, s27
    buffer_store_dword v120, v7, s[8:11], s48 offen sc1
    s_mov_b64 exec, -1
layerb1_kernel_gk_fl8:
    s_add_u32 s21, s16, 40960
    s_cmp_eq_u32 s21, 122880
    s_cselect_b32 s21, 0, s21
    s_add_u32 s23, s14, 2
    s_min_u32 s24, s23, 63
    s_mul_i32 s24, s24, 40960
    s_add_u32 s24, s24, s19
    s_mul_i32 s25, s13, 10240
    s_add_u32 s25, s25, s22
    s_add_u32 s22, s22, 40960
    s_cmp_eq_u32 s22, 122880
    s_cselect_b32 s22, 0, s22
    ds_read_b128 v[20:23], v2 offset:35840
    s_waitcnt lgkmcnt(6)
    v_mfma_f32_32x32x16_bf16 v[40:55], a[232:235], v[28:31], v[40:55]
    s_mov_b32 m0, s25
    s_nop 0
    buffer_load_dwordx4 v1, s[8:11], s24 offen offset:0 sc1 lds
    v_mfma_f32_32x32x16_bf16 v[56:71], a[236:239], v[28:31], v[56:71]
    ds_read_b128 v[24:27], v2 offset:36864
    s_waitcnt lgkmcnt(6)
    v_mfma_f32_32x32x16_bf16 v[40:55], a[240:243], v[32:35], v[40:55]
    buffer_load_dwordx4 v1, s[8:11], s24 offen offset:1024 sc1 lds
    v_mfma_f32_32x32x16_bf16 v[56:71], a[244:247], v[32:35], v[56:71]
    ds_read_b128 v[28:31], v2 offset:37888
    s_waitcnt lgkmcnt(6)
    v_mfma_f32_32x32x16_bf16 v[40:55], a[248:251], v[36:39], v[40:55]
    buffer_load_dwordx4 v1, s[8:11], s24 offen offset:2048 sc1 lds
    v_mfma_f32_32x32x16_bf16 v[56:71], a[252:255], v[36:39], v[56:71]
    ds_read_b128 v[32:35], v2 offset:38912
    s_waitcnt lgkmcnt(6)
    v_mfma_f32_32x32x16_bf16 v[40:55], v[192:195], v[8:11], v[40:55]
    buffer_load_dwordx4 v1, s[8:11], s24 offen offset:3072 sc1 lds
    v_mfma_f32_32x32x16_bf16 v[56:71], v[196:199], v[8:11], v[56:71]
    ds_read_b128 v[36:39], v2 offset:39936
    s_waitcnt lgkmcnt(6)
    v_mfma_f32_32x32x16_bf16 v[40:55], v[200:203], v[12:15], v[40:55]
    s_add_u32 s24, s24, 4096
    s_add_u32 s25, s25, 4096
    s_mov_b32 m0, s25
    s_nop 0
    buffer_load_dwordx4 v1, s[8:11], s24 offen offset:0 sc1 lds
    v_mfma_f32_32x32x16_bf16 v[56:71], v[204:207], v[12:15], v[56:71]
    v_add_u32 v6, s21, v1
    ds_read_b128 v[8:11], v6 offset:0
    s_waitcnt lgkmcnt(6)
    v_mfma_f32_32x32x16_bf16 v[40:55], v[208:211], v[16:19], v[40:55]
    buffer_load_dwordx4 v1, s[8:11], s24 offen offset:1024 sc1 lds
    v_mfma_f32_32x32x16_bf16 v[56:71], v[212:215], v[16:19], v[56:71]
    ds_read_b128 v[12:15], v6 offset:1024
    s_waitcnt lgkmcnt(6)
    v_mfma_f32_32x32x16_bf16 v[40:55], v[216:219], v[20:23], v[40:55]
    buffer_load_dwordx4 v1, s[8:11], s24 offen offset:2048 sc1 lds
    v_mfma_f32_32x32x16_bf16 v[56:71], v[220:223], v[20:23], v[56:71]
    ds_read_b128 v[16:19], v6 offset:2048
    s_waitcnt lgkmcnt(6)
    v_mfma_f32_32x32x16_bf16 v[40:55], v[224:227], v[24:27], v[40:55]
    buffer_load_dwordx4 v1, s[8:11], s24 offen offset:3072 sc1 lds
    v_mfma_f32_32x32x16_bf16 v[56:71], v[228:231], v[24:27], v[56:71]
    ds_read_b128 v[20:23], v6 offset:3072
    s_waitcnt lgkmcnt(6)
    v_mfma_f32_32x32x16_bf16 v[40:55], v[232:235], v[28:31], v[40:55]
    s_add_u32 s24, s24, 4096
    s_add_u32 s25, s25, 4096
    s_mov_b32 m0, s25
    s_nop 0
    buffer_load_dwordx4 v1, s[8:11], s24 offen offset:0 sc1 lds
    v_mfma_f32_32x32x16_bf16 v[56:71], v[236:239], v[28:31], v[56:71]
    ds_read_b128 v[24:27], v6 offset:4096
    s_waitcnt lgkmcnt(6)
    v_mfma_f32_32x32x16_bf16 v[40:55], v[240:243], v[32:35], v[40:55]
    buffer_load_dwordx4 v1, s[8:11], s24 offen offset:1024 sc1 lds
    v_mfma_f32_32x32x16_bf16 v[56:71], v[244:247], v[32:35], v[56:71]
    ds_read_b128 v[28:31], v6 offset:5120
    s_waitcnt lgkmcnt(6)
    v_mfma_f32_32x32x16_bf16 v[40:55], v[248:251], v[36:39], v[40:55]
    v_mfma_f32_32x32x16_bf16 v[56:71], v[252:255], v[36:39], v[56:71]
    v_mov_b32 v2, v6
    s_mov_b32 s16, s21
    s_add_u32 s14, s14, 1
    s_cmp_ge_u32 s14, s15
    s_cbranch_scc1 layerb1_kernel_gk_fin0
    ds_read_b128 v[32:35], v2 offset:6144
    s_waitcnt lgkmcnt(6)
    v_mfma_f32_32x32x16_bf16 v[72:87], a[0:3], v[8:11], 0
    v_mfma_f32_32x32x16_bf16 v[88:103], a[4:7], v[8:11], 0
    ds_read_b128 v[36:39], v2 offset:7168
    s_waitcnt lgkmcnt(6)
    v_mfma_f32_32x32x16_bf16 v[72:87], a[8:11], v[12:15], v[72:87]
    v_mfma_f32_32x32x16_bf16 v[88:103], a[12:15], v[12:15], v[88:103]
    ds_read_b128 v[8:11], v2 offset:8192
    s_waitcnt lgkmcnt(6)
    v_mfma_f32_32x32x16_bf16 v[72:87], a[16:19], v[16:19], v[72:87]
    v_cvt_pk_bf16_f32 v104, v40, v41
    v_mfma_f32_32x32x16_bf16 v[88:103], a[20:23], v[16:19], v[88:103]
    v_cvt_pk_bf16_f32 v105, v42, v43
    ds_read_b128 v[12:15], v2 offset:9216
    s_waitcnt lgkmcnt(6)
    v_mfma_f32_32x32x16_bf16 v[72:87], a[24:27], v[20:23], v[72:87]
    v_cvt_pk_bf16_f32 v106, v44, v45
    v_mfma_f32_32x32x16_bf16 v[88:103], a[28:31], v[20:23], v[88:103]
    v_cvt_pk_bf16_f32 v107, v46, v47
    ds_read_b128 v[16:19], v2 offset:10240
    s_waitcnt lgkmcnt(6)
    v_mfma_f32_32x32x16_bf16 v[72:87], a[32:35], v[24:27], v[72:87]
    s_nop 1
    v_mfma_f32_32x32x16_bf16 v[88:103], a[36:39], v[24:27], v[88:103]
    v_permlane32_swap_b32 v104, v106
    ds_read_b128 v[20:23], v2 offset:11264
    s_waitcnt lgkmcnt(6)
    v_mfma_f32_32x32x16_bf16 v[72:87], a[40:43], v[28:31], v[72:87]
    v_permlane32_swap_b32 v105, v107
    v_mfma_f32_32x32x16_bf16 v[88:103], a[44:47], v[28:31], v[88:103]
    buffer_store_dwordx4 v[104:107], v3, s[8:11], s17 offen offset:0 sc1
    ds_read_b128 v[24:27], v2 offset:12288
    s_waitcnt lgkmcnt(6)
    v_mfma_f32_32x32x16_bf16 v[72:87], a[48:51], v[32:35], v[72:87]
    v_cvt_pk_bf16_f32 v108, v48, v49
    v_mfma_f32_32x32x16_bf16 v[88:103], a[52:55], v[32:35], v[88:103]
    v_cvt_pk_bf16_f32 v109, v50, v51
    ds_read_b128 v[28:31], v2 offset:13312
    s_waitcnt lgkmcnt(6)
    v_mfma_f32_32x32x16_bf16 v[72:87], a[56:59], v[36:39], v[72:87]
    v_cvt_pk_bf16_f32 v110, v52, v53
    v_mfma_f32_32x32x16_bf16 v[88:103], a[60:63], v[36:39], v[88:103]
    v_cvt_pk_bf16_f32 v111, v54, v55
    ds_read_b128 v[32:35], v2 offset:14336
    s_waitcnt lgkmcnt(6)
    v_mfma_f32_32x32x16_bf16 v[72:87], a[64:67], v[8:11], v[72:87]
    s_nop 1
    v_mfma_f32_32x32x16_bf16 v[88:103], a[68:71], v[8:11], v[88:103]
    v_permlane32_swap_b32 v108, v110
    ds_read_b128 v[36:39], v2 offset:15360
    s_waitcnt lgkmcnt(6)
    v_mfma_f32_32x32x16_bf16 v[72:87], a[72:75], v[12:15], v[72:87]
    v_permlane32_swap_b32 v109, v111
    v_mfma_f32_32x32x16_bf16 v[88:103], a[76:79], v[12:15], v[88:103]
    buffer_store_dwordx4 v[108:111], v3, s[8:11], s17 offen offset:1024 sc1
    ds_read_b128 v[8:11], v2 offset:16384
    s_waitcnt lgkmcnt(6)
    v_mfma_f32_32x32x16_bf16 v[72:87], a[80:83], v[16:19], v[72:87]
    v_cvt_pk_bf16_f32 v112, v56, v57
    v_mfma_f32_32x32x16_bf16 v[88:103], a[84:87], v[16:19], v[88:103]
    v_cvt_pk_bf16_f32 v113, v58, v59
    ds_read_b128 v[12:15], v2 offset:17408
    s_waitcnt lgkmcnt(6)
    v_mfma_f32_32x32x16_bf16 v[72:87], a[88:91], v[20:23], v[72:87]
    v_cvt_pk_bf16_f32 v114, v60, v61
    v_mfma_f32_32x32x16_bf16 v[88:103], a[92:95], v[20:23], v[88:103]
    v_cvt_pk_bf16_f32 v115, v62, v63
    ds_read_b128 v[16:19], v2 offset:18432
    s_waitcnt lgkmcnt(6)
    v_mfma_f32_32x32x16_bf16 v[72:87], a[96:99], v[24:27], v[72:87]
    s_nop 1
    v_mfma_f32_32x32x16_bf16 v[88:103], a[100:103], v[24:27], v[88:103]
    v_permlane32_swap_b32 v112, v114
    ds_read_b128 v[20:23], v2 offset:19456
    s_waitcnt lgkmcnt(6)
    v_mfma_f32_32x32x16_bf16 v[72:87], a[104:107], v[28:31], v[72:87]
    v_permlane32_swap_b32 v113, v115
    v_mfma_f32_32x32x16_bf16 v[88:103], a[108:111], v[28:31], v[88:103]
    buffer_store_dwordx4 v[112:115], v3, s[8:11], s18 offen offset:0 sc1
    ds_read_b128 v[24:27], v2 offset:20480
    s_waitcnt lgkmcnt(6)
    v_mfma_f32_32x32x16_bf16 v[72:87], a[112:115], v[32:35], v[72:87]
    v_cvt_pk_bf16_f32 v116, v64, v65
    v_mfma_f32_32x32x16_bf16 v[88:103], a[116:119], v[32:35], v[88:103]
    v_cvt_pk_bf16_f32 v117, v66, v67
    ds_read_b128 v[28:31], v2 offset:21504
    s_waitcnt lgkmcnt(6)
    v_mfma_f32_32x32x16_bf16 v[72:87], a[120:123], v[36:39], v[72:87]
    v_cvt_pk_bf16_f32 v118, v68, v69
    v_mfma_f32_32x32x16_bf16 v[88:103], a[124:127], v[36:39], v[88:103]
    v_cvt_pk_bf16_f32 v119, v70, v71
    ds_read_b128 v[32:35], v2 offset:22528
    s_waitcnt lgkmcnt(6)
    v_mfma_f32_32x32x16_bf16 v[72:87], a[128:131], v[8:11], v[72:87]
    s_nop 1
    v_mfma_f32_32x32x16_bf16 v[88:103], a[132:135], v[8:11], v[88:103]
    v_permlane32_swap_b32 v116, v118
    ds_read_b128 v[36:39], v2 offset:23552
    s_waitcnt lgkmcnt(6)
    v_mfma_f32_32x32x16_bf16 v[72:87], a[136:139], v[12:15], v[72:87]
    v_permlane32_swap_b32 v117, v119
    v_mfma_f32_32x32x16_bf16 v[88:103], a[140:143], v[12:15], v[88:103]
    buffer_store_dwordx4 v[116:119], v3, s[8:11], s18 offen offset:1024 sc1
    ds_read_b128 v[8:11], v2 offset:24576
    s_waitcnt lgkmcnt(6)
    v_mfma_f32_32x32x16_bf16 v[72:87], a[144:147], v[16:19], v[72:87]
    s_add_u32 s17, s17, s20
    v_mfma_f32_32x32x16_bf16 v[88:103], a[148:151], v[16:19], v[88:103]
    s_add_u32 s18, s18, s20
    ds_read_b128 v[12:15], v2 offset:25600
    s_waitcnt lgkmcnt(6)
    v_mfma_f32_32x32x16_bf16 v[72:87], a[152:155], v[20:23], v[72:87]
    v_mfma_f32_32x32x16_bf16 v[88:103], a[156:159], v[20:23], v[88:103]
    ds_read_b128 v[16:19], v2 offset:26624
    s_waitcnt lgkmcnt(6)
    v_mfma_f32_32x32x16_bf16 v[72:87], a[160:163], v[24:27], v[72:87]
    v_mfma_f32_32x32x16_bf16 v[88:103], a[164:167], v[24:27], v[88:103]
    ds_read_b128 v[20:23], v2 offset:27648
    s_waitcnt lgkmcnt(6)
    v_mfma_f32_32x32x16_bf16 v[72:87], a[168:171], v[28:31], v[72:87]
    v_mfma_f32_32x32x16_bf16 v[88:103], a[172:175], v[28:31], v[88:103]
    ds_read_b128 v[24:27], v2 offset:28672
    s_waitcnt lgkmcnt(6)
    v_mfma_f32_32x32x16_bf16 v[72:87], a[176:179], v[32:35], v[72:87]
    v_mfma_f32_32x32x16_bf16 v[88:103], a[180:183], v[32:35], v[88:103]
    ds_read_b128 v[28:31], v2 offset:29696
    s_waitcnt lgkmcnt(6)
    v_mfma_f32_32x32x16_bf16 v[72:87], a[184:187], v[36:39], v[72:87]
    v_mfma_f32_32x32x16_bf16 v[88:103], a[188:191], v[36:39], v[88:103]
    ds_read_b128 v[32:35], v2 offset:30720
    s_waitcnt lgkmcnt(6)
    v_mfma_f32_32x32x16_bf16 v[72:87], a[192:195], v[8:11], v[72:87]
    v_mfma_f32_32x32x16_bf16 v[88:103], a[196:199], v[8:11], v[88:103]
    ds_read_b128 v[36:39], v2 offset:31744
    s_waitcnt lgkmcnt(6)
    v_mfma_f32_32x32x16_bf16 v[72:87], a[200:203], v[12:15], v[72:87]
    v_mfma_f32_32x32x16_bf16 v[88:103], a[204:207], v[12:15], v[88:103]
    ds_read_b128 v[8:11], v2 offset:32768
    s_waitcnt lgkmcnt(6)
    v_mfma_f32_32x32x16_bf16 v[72:87], a[208:211], v[16:19], v[72:87]
    v_mfma_f32_32x32x16_bf16 v[88:103], a[212:215], v[16:19], v[88:103]
    ds_read_b128 v[12:15], v2 offset:33792
    s_waitcnt lgkmcnt(6)
    v_mfma_f32_32x32x16_bf16 v[72:87], a[216:219], v[20:23], v[72:87]
    v_mfma_f32_32x32x16_bf16 v[88:103], a[220:223], v[20:23], v[88:103]
    ds_read_b128 v[16:19], v2 offset:34816
    s_waitcnt lgkmcnt(6)
    v_mfma_f32_32x32x16_bf16 v[72:87], a[224:227], v[24:27], v[72:87]
    v_mfma_f32_32x32x16_bf16 v[88:103], a[228:231], v[24:27], v[88:103]
    s_add_u32 s23, s14, 2
    s_cmp_lg_u32 s13, 0
    s_cbranch_scc1 layerb1_kernel_gk_lw9
    s_min_u32 s28, s23, 63
    s_cmp_gt_u32 s56, s28
    s_cbranch_scc1 layerb1_kernel_gk_lw9
layerb1_kernel_gk_lp9:
    buffer_load_dwordx4 v[124:127], v1, s[8:11], s57 offen sc1
    s_waitcnt vmcnt(0)
    v_min_u32 v124, v124, v125
    v_min_u32 v126, v126, v127
    v_min_u32 v124, v124, v126
    v_cmp_eq_u32 vcc, 0, v124
    s_nop 1
    s_ff1_i32_b64 s56, vcc
    s_min_u32 s56, s56, 64
    s_sub_u32 s58, s58, 1
    s_cbranch_scc1 layerb1_kernel_bail
    s_cmp_gt_u32 s56, s28
    s_cbranch_scc0 layerb1_kernel_gk_lp9
layerb1_kernel_gk_lw9:
    s_cmp_gt_u32 s14, 2
    s_cbranch_scc1 layerb1_kernel_gk_dr10
    s_waitcnt vmcnt(0)
    s_mov_b32 s27, s14
    s_branch layerb1_kernel_gk_dq10
layerb1_kernel_gk_dr10:
    s_waitcnt vmcnt(4)
    s_sub_u32 s27, s14, 1
layerb1_kernel_gk_dq10:
    s_barrier
    s_cmp_lg_u32 s13, 0
    s_cbranch_scc1 layerb1_kernel_gk_fl11
    s_mov_b64 exec, 1
    s_lshl_b32 s26, s12, 7
    v_mov_b32 v7, s26
    v_mov_b32 v120, s27
    buffer_store_dword v120, v7, s[8:11], s48 offen sc1
    s_mov_b64 exec, -1
layerb1_kernel_gk_fl11:
    s_add_u32 s21, s16, 40960
    s_cmp_eq_u32 s21, 122880
    s_cselect_b32 s21, 0, s21
    s_add_u32 s23, s14, 2
    s_min_u32 s24, s23, 63
    s_mul_i32 s24, s24, 40960
    s_add_u32 s24, s24, s19
    s_mul_i32 s25, s13, 10240
    s_add_u32 s25, s25, s22
    s_add_u32 s22, s22, 40960
    s_cmp_eq_u32 s22, 122880
    s_cselect_b32 s22, 0, s22
    ds_read_b128 v[20:23], v2 offset:35840
    s_waitcnt lgkmcnt(6)
    v_mfma_f32_32x32x16_bf16 v[72:87], a[232:235], v[28:31], v[72:87]
    s_mov_b32 m0, s25
    s_nop 0
    buffer_load_dwordx4 v1, s[8:11], s24 offen offset:0 sc1 lds
    v_mfma_f32_32x32x16_bf16 v[88:103], a[236:239], v[28:31], v[88:103]
    ds_read_b128 v[24:27], v2 offset:36864
    s_waitcnt lgkmcnt(6)
    v_mfma_f32_32x32x16_bf16 v[72:87], a[240:243], v[32:35], v[72:87]
    buffer_load_dwordx4 v1, s[8:11], s24 offen offset:1024 sc1 lds
    v_mfma_f32_32x32x16_bf16 v[88:103], a[244:247], v[32:35], v[88:103]
    ds_read_b128 v[28:31], v2 offset:37888
    s_waitcnt lgkmcnt(6)
    v_mfma_f32_32x32x16_bf16 v[72:87], a[248:251], v[36:39], v[72:87]
    buffer_load_dwordx4 v1, s[8:11], s24 offen offset:2048 sc1 lds
    v_mfma_f32_32x32x16_bf16 v[88:103], a[252:255], v[36:39], v[88:103]
    ds_read_b128 v[32:35], v2 offset:38912
    s_waitcnt lgkmcnt(6)
    v_mfma_f32_32x32x16_bf16 v[72:87], v[192:195], v[8:11], v[72:87]
    buffer_load_dwordx4 v1, s[8:11], s24 offen offset:3072 sc1 lds
    v_mfma_f32_32x32x16_bf16 v[88:103], v[196:199], v[8:11], v[88:103]
    ds_read_b128 v[36:39], v2 offset:39936
    s_waitcnt lgkmcnt(6)
    v_mfma_f32_32x32x16_bf16 v[72:87], v[200:203], v[12:15], v[72:87]
    s_add_u32 s24, s24, 4096
    s_add_u32 s25, s25, 4096
    s_mov_b32 m0, s25
    s_nop 0
    buffer_load_dwordx4 v1, s[8:11], s24 offen offset:0 sc1 lds
    v_mfma_f32_32x32x16_bf16 v[88:103], v[204:207], v[12:15], v[88:103]
    v_add_u32 v6, s21, v1
    ds_read_b128 v[8:11], v6 offset:0
    s_waitcnt lgkmcnt(6)
    v_mfma_f32_32x32x16_bf16 v[72:87], v[208:211], v[16:19], v[72:87]
    buffer_load_dwordx4 v1, s[8:11], s24 offen offset:1024 sc1 lds
    v_mfma_f32_32x32x16_bf16 v[88:103], v[212:215], v[16:19], v[88:103]
    ds_read_b128 v[12:15], v6 offset:1024
    s_waitcnt lgkmcnt(6)
    v_mfma_f32_32x32x16_bf16 v[72:87], v[216:219], v[20:23], v[72:87]
    buffer_load_dwordx4 v1, s[8:11], s24 offen offset:2048 sc1 lds
    v_mfma_f32_32x32x16_bf16 v[88:103], v[220:223], v[20:23], v[88:103]
    ds_read_b128 v[16:19], v6 offset:2048
    s_waitcnt lgkmcnt(6)
    v_mfma_f32_32x32x16_bf16 v[72:87], v[224:227], v[24:27], v[72:87]
    buffer_load_dwordx4 v1, s[8:11], s24 offen offset:3072 sc1 lds
    v_mfma_f32_32x32x16_bf16 v[88:103], v[228:231], v[24:27], v[88:103]
    ds_read_b128 v[20:23], v6 offset:3072
    s_waitcnt lgkmcnt(6)
    v_mfma_f32_32x32x16_bf16 v[72:87], v[232:235], v[28:31], v[72:87]
    s_add_u32 s24, s24, 4096
    s_add_u32 s25, s25, 4096
    s_mov_b32 m0, s25
    s_nop 0
    buffer_load_dwordx4 v1, s[8:11], s24 offen offset:0 sc1 lds
    v_mfma_f32_32x32x16_bf16 v[88:103], v[236:239], v[28:31], v[88:103]
    ds_read_b128 v[24:27], v6 offset:4096
    s_waitcnt lgkmcnt(6)
    v_mfma_f32_32x32x16_bf16 v[72:87], v[240:243], v[32:35], v[72:87]
    buffer_load_dwordx4 v1, s[8:11], s24 offen offset:1024 sc1 lds
    v_mfma_f32_32x32x16_bf16 v[88:103], v[244:247], v[32:35], v[88:103]
    ds_read_b128 v[28:31], v6 offset:5120
    s_waitcnt lgkmcnt(6)
    v_mfma_f32_32x32x16_bf16 v[72:87], v[248:251], v[36:39], v[72:87]
    v_mfma_f32_32x32x16_bf16 v[88:103], v[252:255], v[36:39], v[88:103]
    v_mov_b32 v2, v6
    s_mov_b32 s16, s21
    s_add_u32 s14, s14, 1
    s_cmp_lt_u32 s14, s15
    s_cbranch_scc1 layerb1_kernel_gk_loop
    s_branch layerb1_kernel_gk_fin1
layerb1_kernel_gk_fin0:
    s_nop 7
    s_nop 7
    v_cvt_pk_bf16_f32 v104, v40, v41
    v_cvt_pk_bf16_f32 v105, v42, v43
    v_cvt_pk_bf16_f32 v106, v44, v45
    v_cvt_pk_bf16_f32 v107, v46, v47
    s_nop 1
    v_permlane32_swap_b32 v104, v106
    v_permlane32_swap_b32 v105, v107
    buffer_store_dwordx4 v[104:107], v3, s[8:11], s17 offen offset:0 sc1
    v_cvt_pk_bf16_f32 v108, v48, v49
    v_cvt_pk_bf16_f32 v109, v50, v51
    v_cvt_pk_bf16_f32 v110, v52, v53
    v_cvt_pk_bf16_f32 v111, v54, v55
    s_nop 1
    v_permlane32_swap_b32 v108, v110
    v_permlane32_swap_b32 v109, v111
    buffer_store_dwordx4 v[108:111], v3, s[8:11], s17 offen offset:1024 sc1
    v_cvt_pk_bf16_f32 v112, v56, v57
    v_cvt_pk_bf16_f32 v113, v58, v59
    v_cvt_pk_bf16_f32 v114, v60, v61
    v_cvt_pk_bf16_f32 v115, v62, v63
    s_nop 1
    v_permlane32_swap_b32 v112, v114
    v_permlane32_swap_b32 v113, v115
    buffer_store_dwordx4 v[112:115], v3, s[8:11], s18 offen offset:0 sc1
    v_cvt_pk_bf16_f32 v116, v64, v65
    v_cvt_pk_bf16_f32 v117, v66, v67
    v_cvt_pk_bf16_f32 v118, v68, v69
    v_cvt_pk_bf16_f32 v119, v70, v71
    s_nop 1
    v_permlane32_swap_b32 v116, v118
    v_permlane32_swap_b32 v117, v119
    buffer_store_dwordx4 v[116:119], v3, s[8:11], s18 offen offset:1024 sc1
    s_add_u32 s17, s17, s20
    s_add_u32 s18, s18, s20
    s_branch layerb1_kernel_gk_done
layerb1_kernel_gk_fin1:
    s_nop 7
    s_nop 7
    v_cvt_pk_bf16_f32 v104, v72, v73
    v_cvt_pk_bf16_f32 v105, v74, v75
    v_cvt_pk_bf16_f32 v106, v76, v77
    v_cvt_pk_bf16_f32 v107, v78, v79
    s_nop 1
    v_permlane32_swap_b32 v104, v106
    v_permlane32_swap_b32 v105, v107
    buffer_store_dwordx4 v[104:107], v3, s[8:11], s17 offen offset:0 sc1
    v_cvt_pk_bf16_f32 v108, v80, v81
    v_cvt_pk_bf16_f32 v109, v82, v83
    v_cvt_pk_bf16_f32 v110, v84, v85
    v_cvt_pk_bf16_f32 v111, v86, v87
    s_nop 1
    v_permlane32_swap_b32 v108, v110
    v_permlane32_swap_b32 v109, v111
    buffer_store_dwordx4 v[108:111], v3, s[8:11], s17 offen offset:1024 sc1
    v_cvt_pk_bf16_f32 v112, v88, v89
    v_cvt_pk_bf16_f32 v113, v90, v91
    v_cvt_pk_bf16_f32 v114, v92, v93
    v_cvt_pk_bf16_f32 v115, v94, v95
    s_nop 1
    v_permlane32_swap_b32 v112, v114
    v_permlane32_swap_b32 v113, v115
    buffer_store_dwordx4 v[112:115], v3, s[8:11], s18 offen offset:0 sc1
    v_cvt_pk_bf16_f32 v116, v96, v97
    v_cvt_pk_bf16_f32 v117, v98, v99
    v_cvt_pk_bf16_f32 v118, v100, v101
    v_cvt_pk_bf16_f32 v119, v102, v103
    s_nop 1
    v_permlane32_swap_b32 v116, v118
    v_permlane32_swap_b32 v117, v119
    buffer_store_dwordx4 v[116:119], v3, s[8:11], s18 offen offset:1024 sc1
    s_add_u32 s17, s17, s20
    s_add_u32 s18, s18, s20
layerb1_kernel_gk_done:
    s_waitcnt vmcnt(0) lgkmcnt(0)
    s_barrier
    s_cmp_lg_u32 s13, 0
    s_cbranch_scc1 layerb1_kernel_gk_fl12
    s_mov_b64 exec, 1
    s_lshl_b32 s26, s12, 7
    v_mov_b32 v7, s26
    v_mov_b32 v120, s14
    buffer_store_dword v120, v7, s[8:11], s48 offen sc1
    s_mov_b64 exec, -1
layerb1_kernel_gk_fl12:
layerb1_kernel_g_done:
    s_branch layerb1_kernel_w3
layerb1_kernel_spare:
    s_sub_u32 s22, s20, 1
    s_mul_i32 s22, s22, 5
    s_add_u32 s22, s22, s21
    s_sub_u32 s22, s22, 27
    s_cmp_ge_u32 s21, 27
    s_cselect_b32 s22, s22, 15
    s_cmp_lt_u32 s22, 5
    s_cbranch_scc1 layerb1_kernel_sp_ab
    s_cmp_lt_u32 s22, 9
    s_cbranch_scc1 layerb1_kernel_sp_ln
    s_cmp_eq_u32 s22, 9
    s_cbranch_scc0 layerb1_kernel_w3
    s_load_dwordx2 s[24:25], s[0:1], 32
    s_lshl_b32 s26, s13, 6
    v_add_u32 v1, s26, v0
    s_waitcnt lgkmcnt(0)
    s_mov_b32 s28, s24
    s_mov_b32 s29, s25
    s_mov_b32 s30, 10240
    s_mov_b32 s31, 0x00020000
    v_add_u32 v2, 0, v1
    v_and_b32 v3, 7, v2
    v_mul_u32_u24 v3, 1280, v3
    v_lshrrev_b32 v4, 3, v2
    v_lshl_add_u32 v3, v4, 4, v3
    v_lshlrev_b32 v5, 4, v2
    v_add_u32 v5, 20480, v5
    v_lshrrev_b32 v6, 13, v5
    v_lshlrev_b32 v6, 14, v6
    v_and_b32 v5, 8191, v5
    v_add_u32 v5, v5, v6
    v_cmp_gt_u32 vcc, 640, v2
    s_and_saveexec_b64 s[32:33], vcc
    s_cbranch_execz layerb1_kernel_m0s0
    buffer_load_dwordx4 v[8:11], v3, s[28:31], 0 offen
    s_waitcnt vmcnt(0)
    buffer_store_dwordx4 v[8:11], v5, s[8:11], s16 offen sc1
layerb1_kernel_m0s0:
    s_mov_b64 exec, s[32:33]
    v_add_u32 v2, 256, v1
    v_and_b32 v3, 7, v2
    v_mul_u32_u24 v3, 1280, v3
    v_lshrrev_b32 v4, 3, v2
    v_lshl_add_u32 v3, v4, 4, v3
    v_lshlrev_b32 v5, 4, v2
    v_add_u32 v5, 20480, v5
    v_lshrrev_b32 v6, 13, v5
    v_lshlrev_b32 v6, 14, v6
    v_and_b32 v5, 8191, v5
    v_add_u32 v5, v5, v6
    v_cmp_gt_u32 vcc, 640, v2
    s_and_saveexec_b64 s[32:33], vcc
    s_cbranch_execz layerb1_kernel_m0s1
    buffer_load_dwordx4 v[8:11], v3, s[28:31], 0 offen
    s_waitcnt vmcnt(0)
    buffer_store_dwordx4 v[8:11], v5, s[8:11], s16 offen sc1
layerb1_kernel_m0s1:
    s_mov_b64 exec, s[32:33]
    v_add_u32 v2, 512, v1
    v_and_b32 v3, 7, v2
    v_mul_u32_u24 v3, 1280, v3
    v_lshrrev_b32 v4, 3, v2
    v_lshl_add_u32 v3, v4, 4, v3
    v_lshlrev_b32 v5, 4, v2
    v_add_u32 v5, 20480, v5
    v_lshrrev_b32 v6, 13, v5
    v_lshlrev_b32 v6, 14, v6
    v_and_b32 v5, 8191, v5
    v_add_u32 v5, v5, v6
    v_cmp_gt_u32 vcc, 640, v2
    s_and_saveexec_b64 s[32:33], vcc
    s_cbranch_execz layerb1_kernel_m0s2
    buffer_load_dwordx4 v[8:11], v3, s[28:31], 0 offen
    s_waitcnt vmcnt(0)
    buffer_store_dwordx4 v[8:11], v5, s[8:11], s16 offen sc1
layerb1_kernel_m0s2:
    s_mov_b64 exec, s[32:33]
    s_waitcnt vmcnt(0)
    s_branch layerb1_kernel_w3
layerb1_kernel_sp_ab:
    s_mov_b32 s12, s22
    s_mov_b32 s14, 0
    s_mov_b32 s15, 64
    s_load_dwordx2 s[52:53], s[0:1], 0
    v_lshlrev_b32 v1, 4, v0
    s_lshl_b32 s21, s12, 2
    s_add_u32 s21, s21, s13
    s_add_u32 s24, s4, 247463936
    s_addc_u32 s25, s5, 0
    s_waitcnt lgkmcnt(0)
    s_cmp_eq_u32 s49, 0
    s_cselect_b32 s52, s52, s24
    s_cselect_b32 s53, s53, s25
    s_mov_b32 s54, 2621440
    s_mov_b32 s55, 0x00020000
    v_and_b32 v6, 31, v0
    v_lshrrev_b32 v7, 5, v0
    v_mul_u32_u24 v6, 1280, v6
    v_lshl_add_u32 v3, v7, 4, v6
    s_mul_i32 s19, s14, 40960
    s_lshl_b32 s24, s21, 6
    s_add_u32 s19, s19, s24
    s_lshl_b32 s20, s14, 7
    s_lshl_b32 s24, s21, 2
    s_add_u32 s20, s20, s24
    s_add_u32 s20, s20, 36864
    v_mov_b32 v5, 1
    v_mov_b32 v4, 0
    s_mul_i32 s18, s13, 10240
    s_add_u32 s18, s18, 229638144
    s_mov_b32 s17, 0
    s_min_u32 s24, s14, 63
    s_mul_i32 s24, s24, 40960
    s_add_u32 s24, s24, s18
    s_mul_i32 s25, s13, 10240
    s_add_u32 s25, s25, s17
    s_mov_b32 m0, s25
    s_nop 0
    buffer_load_dwordx4 v1, s[8:11], s24 offen offset:0 lds
    buffer_load_dwordx4 v1, s[8:11], s24 offen offset:1024 lds
    buffer_load_dwordx4 v1, s[8:11], s24 offen offset:2048 lds
    buffer_load_dwordx4 v1, s[8:11], s24 offen offset:3072 lds
    s_add_u32 s24, s24, 4096
    s_add_u32 s25, s25, 4096
    s_mov_b32 m0, s25
    s_nop 0
    buffer_load_dwordx4 v1, s[8:11], s24 offen offset:0 lds
    buffer_load_dwordx4 v1, s[8:11], s24 offen offset:1024 lds
    buffer_load_dwordx4 v1, s[8:11], s24 offen offset:2048 lds
    buffer_load_dwordx4 v1, s[8:11], s24 offen offset:3072 lds
    s_add_u32 s24, s24, 4096
    s_add_u32 s25, s25, 4096
    s_mov_b32 m0, s25
    s_nop 0
    buffer_load_dwordx4 v1, s[8:11], s24 offen offset:0 lds
    buffer_load_dwordx4 v1, s[8:11], s24 offen offset:1024 lds
    buffer_load_dwordx4 v[96:99], v3, s[52:55], s19 offen offset:0
    buffer_load_dwordx4 v[100:103], v3, s[52:55], s19 offen offset:32
    s_mul_i32 s24, s21, 40960
    s_add_u32 s24, s24, 246415360
    buffer_load_dwordx4 a[0:3], v1, s[8:11], s24 offen offset:0
    buffer_load_dwordx4 a[4:7], v1, s[8:11], s24 offen offset:1024
    buffer_load_dwordx4 a[8:11], v1, s[8:11], s24 offen offset:2048
    buffer_load_dwordx4 a[12:15], v1, s[8:11], s24 offen offset:3072
    s_add_u32 s24, s24, 4096
    buffer_load_dwordx4 a[16:19], v1, s[8:11], s24 offen offset:0
    buffer_load_dwordx4 a[20:23], v1, s[8:11], s24 offen offset:1024
    buffer_load_dwordx4 a[24:27], v1, s[8:11], s24 offen offset:2048
    buffer_load_dwordx4 a[28:31], v1, s[8:11], s24 offen offset:3072
    s_add_u32 s24, s24, 4096
    buffer_load_dwordx4 a[32:35], v1, s[8:11], s24 offen offset:0
    buffer_load_dwordx4 a[36:39], v1, s[8:11], s24 offen offset:1024
    buffer_load_dwordx4 a[40:43], v1, s[8:11], s24 offen offset:2048
    buffer_load_dwordx4 a[44:47], v1, s[8:11], s24 offen offset:3072
    s_add_u32 s24, s24, 4096
    buffer_load_dwordx4 a[48:51], v1, s[8:11], s24 offen offset:0
    buffer_load_dwordx4 a[52:55], v1, s[8:11], s24 offen offset:1024
    buffer_load_dwordx4 a[56:59], v1, s[8:11], s24 offen offset:2048
    buffer_load_dwordx4 a[60:63], v1, s[8:11], s24 offen offset:3072
    s_add_u32 s24, s24, 4096
    buffer_load_dwordx4 a[64:67], v1, s[8:11], s24 offen offset:0
    buffer_load_dwordx4 a[68:71], v1, s[8:11], s24 offen offset:1024
    buffer_load_dwordx4 a[72:75], v1, s[8:11], s24 offen offset:2048
    buffer_load_dwordx4 a[76:79], v1, s[8:11], s24 offen offset:3072
    s_add_u32 s24, s24, 4096
    buffer_load_dwordx4 a[80:83], v1, s[8:11], s24 offen offset:0
    buffer_load_dwordx4 a[84:87], v1, s[8:11], s24 offen offset:1024
    buffer_load_dwordx4 a[88:91], v1, s[8:11], s24 offen offset:2048
    buffer_load_dwordx4 a[92:95], v1, s[8:11], s24 offen offset:3072
    s_add_u32 s24, s24, 4096
    buffer_load_dwordx4 a[96:99], v1, s[8:11], s24 offen offset:0
    buffer_load_dwordx4 a[100:103], v1, s[8:11], s24 offen offset:1024
    buffer_load_dwordx4 a[104:107], v1, s[8:11], s24 offen offset:2048
    buffer_load_dwordx4 a[108:111], v1, s[8:11], s24 offen offset:3072
    s_add_u32 s24, s24, 4096
    buffer_load_dwordx4 a[112:115], v1, s[8:11], s24 offen offset:0
    buffer_load_dwordx4 a[116:119], v1, s[8:11], s24 offen offset:1024
    buffer_load_dwordx4 a[120:123], v1, s[8:11], s24 offen offset:2048
    buffer_load_dwordx4 a[124:127], v1, s[8:11], s24 offen offset:3072
    s_add_u32 s24, s24, 4096
    buffer_load_dwordx4 a[128:131], v1, s[8:11], s24 offen offset:0
    buffer_load_dwordx4 a[132:135], v1, s[8:11], s24 offen offset:1024
    buffer_load_dwordx4 a[136:139], v1, s[8:11], s24 offen offset:2048
    buffer_load_dwordx4 a[140:143], v1, s[8:11], s24 offen offset:3072
    s_add_u32 s24, s24, 4096
    buffer_load_dwordx4 a[144:147], v1, s[8:11], s24 offen offset:0
    buffer_load_dwordx4 a[148:151], v1, s[8:11], s24 offen offset:1024
    buffer_load_dwordx4 a[152:155], v1, s[8:11], s24 offen offset:2048
    buffer_load_dwordx4 a[156:159], v1, s[8:11], s24 offen offset:3072
    s_mov_b32 s17, 40960
    s_add_u32 s23, s14, 1
    s_min_u32 s24, s23, 63
    s_mul_i32 s24, s24, 40960
    s_add_u32 s24, s24, s18
    s_mul_i32 s25, s13, 10240
    s_add_u32 s25, s25, s17
    s_mov_b32 m0, s25
    s_nop 0
    buffer_load_dwordx4 v1, s[8:11], s24 offen offset:0 lds
    buffer_load_dwordx4 v1, s[8:11], s24 offen offset:1024 lds
    buffer_load_dwordx4 v1, s[8:11], s24 offen offset:2048 lds
    buffer_load_dwordx4 v1, s[8:11], s24 offen offset:3072 lds
    s_add_u32 s24, s24, 4096
    s_add_u32 s25, s25, 4096
    s_mov_b32 m0, s25
    s_nop 0
    buffer_load_dwordx4 v1, s[8:11], s24 offen offset:0 lds
    buffer_load_dwordx4 v1, s[8:11], s24 offen offset:1024 lds
    buffer_load_dwordx4 v1, s[8:11], s24 offen offset:2048 lds
    buffer_load_dwordx4 v1, s[8:11], s24 offen offset:3072 lds
    s_add_u32 s24, s24, 4096
    s_add_u32 s25, s25, 4096
    s_mov_b32 m0, s25
    s_nop 0
    buffer_load_dwordx4 v1, s[8:11], s24 offen offset:0 lds
    buffer_load_dwordx4 v1, s[8:11], s24 offen offset:1024 lds
    s_mov_b32 s17, 81920
    s_mov_b32 s16, 0
    s_waitcnt vmcnt(52)
    s_barrier
    v_add_u32 v2, s16, v1
    ds_read_b128 v[16:19], v2 offset:0
    ds_read_b128 v[20:23], v2 offset:1024
    ds_read_b128 v[24:27], v2 offset:2048
    ds_read_b128 v[28:31], v2 offset:3072
    ds_read_b128 v[32:35], v2 offset:4096
    ds_read_b128 v[36:39], v2 offset:5120
    s_add_u32 s27, s19, 40960
    s_cmp_ge_u32 s14, 63
    s_cselect_b32 s27, s19, s27
    buffer_load_dwordx4 v[104:107], v3, s[52:55], s27 offen offset:0
    buffer_load_dwordx4 v[108:111], v3, s[52:55], s27 offen offset:32
    s_add_u32 s23, s14, 2
    s_min_u32 s24, s23, 63
    s_mul_i32 s24, s24, 40960
    s_add_u32 s24, s24, s18
    s_mul_i32 s25, s13, 10240
    s_add_u32 s25, s25, s17
    s_add_u32 s17, s17, 40960
    s_cmp_eq_u32 s17, 122880
    s_cselect_b32 s17, 0, s17
    ds_read_b128 v[40:43], v2 offset:6144
    s_waitcnt vmcnt(51) lgkmcnt(6)
    v_mfma_f32_32x32x16_bf16 v[48:63], a[0:3], v[16:19], 0
    ds_read_b128 v[44:47], v2 offset:7168
    s_waitcnt vmcnt(50) lgkmcnt(6)
    v_mfma_f32_32x32x16_bf16 v[64:79], a[4:7], v[20:23], 0
    s_mov_b32 m0, s25
    s_nop 0
    buffer_load_dwordx4 v1, s[8:11], s24 offen offset:0 lds
    ds_read_b128 v[16:19], v2 offset:8192
    s_waitcnt vmcnt(50) lgkmcnt(6)
    v_mfma_f32_32x32x16_bf16 v[48:63], a[8:11], v[24:27], v[48:63]
    ds_read_b128 v[20:23], v2 offset:9216
    s_waitcnt vmcnt(49) lgkmcnt(6)
    v_mfma_f32_32x32x16_bf16 v[64:79], a[12:15], v[28:31], v[64:79]
    ds_read_b128 v[24:27], v2 offset:10240
    s_waitcnt vmcnt(48) lgkmcnt(6)
    v_mfma_f32_32x32x16_bf16 v[48:63], a[16:19], v[32:35], v[48:63]
    buffer_load_dwordx4 v1, s[8:11], s24 offen offset:1024 lds
    ds_read_b128 v[28:31], v2 offset:11264
    s_waitcnt vmcnt(48) lgkmcnt(6)
    v_mfma_f32_32x32x16_bf16 v[64:79], a[20:23], v[36:39], v[64:79]
    ds_read_b128 v[32:35], v2 offset:12288
    s_waitcnt vmcnt(47) lgkmcnt(6)
    v_mfma_f32_32x32x16_bf16 v[48:63], a[24:27], v[40:43], v[48:63]
    ds_read_b128 v[36:39], v2 offset:13312
    s_waitcnt vmcnt(46) lgkmcnt(6)
    v_mfma_f32_32x32x16_bf16 v[64:79], a[28:31], v[44:47], v[64:79]
    buffer_load_dwordx4 v1, s[8:11], s24 offen offset:2048 lds
    ds_read_b128 v[40:43], v2 offset:14336
    s_waitcnt vmcnt(46) lgkmcnt(6)
    v_mfma_f32_32x32x16_bf16 v[48:63], a[32:35], v[16:19], v[48:63]
    ds_read_b128 v[44:47], v2 offset:15360
    s_waitcnt vmcnt(45) lgkmcnt(6)
    v_mfma_f32_32x32x16_bf16 v[64:79], a[36:39], v[20:23], v[64:79]
    ds_read_b128 v[16:19], v2 offset:16384
    s_waitcnt vmcnt(44) lgkmcnt(6)
    v_mfma_f32_32x32x16_bf16 v[48:63], a[40:43], v[24:27], v[48:63]
    buffer_load_dwordx4 v1, s[8:11], s24 offen offset:3072 lds
    ds_read_b128 v[20:23], v2 offset:17408
    s_waitcnt vmcnt(44) lgkmcnt(6)
    v_mfma_f32_32x32x16_bf16 v[64:79], a[44:47], v[28:31], v[64:79]
    ds_read_b128 v[24:27], v2 offset:18432
    s_waitcnt vmcnt(43) lgkmcnt(6)
    v_mfma_f32_32x32x16_bf16 v[48:63], a[48:51], v[32:35], v[48:63]
    ds_read_b128 v[28:31], v2 offset:19456
    s_waitcnt vmcnt(42) lgkmcnt(6)
    v_mfma_f32_32x32x16_bf16 v[64:79], a[52:55], v[36:39], v[64:79]
    s_add_u32 s24, s24, 4096
    s_add_u32 s25, s25, 4096
    s_mov_b32 m0, s25
    s_nop 0
    buffer_load_dwordx4 v1, s[8:11], s24 offen offset:0 lds
    ds_read_b128 v[32:35], v2 offset:20480
    s_waitcnt vmcnt(42) lgkmcnt(6)
    v_mfma_f32_32x32x16_bf16 v[48:63], a[56:59], v[40:43], v[48:63]
    ds_read_b128 v[36:39], v2 offset:21504
    s_waitcnt vmcnt(41) lgkmcnt(6)
    v_mfma_f32_32x32x16_bf16 v[64:79], a[60:63], v[44:47], v[64:79]
    ds_read_b128 v[40:43], v2 offset:22528
    s_waitcnt vmcnt(40) lgkmcnt(6)
    v_mfma_f32_32x32x16_bf16 v[48:63], a[64:67], v[16:19], v[48:63]
    buffer_load_dwordx4 v1, s[8:11], s24 offen offset:1024 lds
    ds_read_b128 v[44:47], v2 offset:23552
    s_waitcnt vmcnt(40) lgkmcnt(6)
    v_mfma_f32_32x32x16_bf16 v[64:79], a[68:71], v[20:23], v[64:79]
    ds_read_b128 v[16:19], v2 offset:24576
    s_waitcnt vmcnt(39) lgkmcnt(6)
    v_mfma_f32_32x32x16_bf16 v[48:63], a[72:75], v[24:27], v[48:63]
    ds_read_b128 v[20:23], v2 offset:25600
    s_waitcnt vmcnt(38) lgkmcnt(6)
    v_mfma_f32_32x32x16_bf16 v[64:79], a[76:79], v[28:31], v[64:79]
    buffer_load_dwordx4 v1, s[8:11], s24 offen offset:2048 lds
    ds_read_b128 v[24:27], v2 offset:26624
    s_waitcnt vmcnt(38) lgkmcnt(6)
    v_mfma_f32_32x32x16_bf16 v[48:63], a[80:83], v[32:35], v[48:63]
    ds_read_b128 v[28:31], v2 offset:27648
    s_waitcnt vmcnt(37) lgkmcnt(6)
    v_mfma_f32_32x32x16_bf16 v[64:79], a[84:87], v[36:39], v[64:79]
    ds_read_b128 v[32:35], v2 offset:28672
    s_waitcnt vmcnt(36) lgkmcnt(6)
    v_mfma_f32_32x32x16_bf16 v[48:63], a[88:91], v[40:43], v[48:63]
    buffer_load_dwordx4 v1, s[8:11], s24 offen offset:3072 lds
    ds_read_b128 v[36:39], v2 offset:29696
    s_waitcnt vmcnt(36) lgkmcnt(6)
    v_mfma_f32_32x32x16_bf16 v[64:79], a[92:95], v[44:47], v[64:79]
    ds_read_b128 v[40:43], v2 offset:30720
    s_waitcnt vmcnt(35) lgkmcnt(6)
    v_mfma_f32_32x32x16_bf16 v[48:63], a[96:99], v[16:19], v[48:63]
    ds_read_b128 v[44:47], v2 offset:31744
    s_waitcnt vmcnt(34) lgkmcnt(6)
    v_mfma_f32_32x32x16_bf16 v[64:79], a[100:103], v[20:23], v[64:79]
    s_add_u32 s24, s24, 4096
    s_add_u32 s25, s25, 4096
    s_mov_b32 m0, s25
    s_nop 0
    buffer_load_dwordx4 v1, s[8:11], s24 offen offset:0 lds
    ds_read_b128 v[16:19], v2 offset:32768
    s_waitcnt vmcnt(34) lgkmcnt(6)
    v_mfma_f32_32x32x16_bf16 v[48:63], a[104:107], v[24:27], v[48:63]
    ds_read_b128 v[20:23], v2 offset:33792
    s_waitcnt vmcnt(33) lgkmcnt(6)
    v_mfma_f32_32x32x16_bf16 v[64:79], a[108:111], v[28:31], v[64:79]
    ds_read_b128 v[24:27], v2 offset:34816
    s_waitcnt vmcnt(32) lgkmcnt(6)
    v_mfma_f32_32x32x16_bf16 v[48:63], a[112:115], v[32:35], v[48:63]
    buffer_load_dwordx4 v1, s[8:11], s24 offen offset:1024 lds
    ds_read_b128 v[28:31], v2 offset:35840
    s_waitcnt vmcnt(32) lgkmcnt(6)
    v_mfma_f32_32x32x16_bf16 v[64:79], a[116:119], v[36:39], v[64:79]
    ds_read_b128 v[32:35], v2 offset:36864
    s_waitcnt vmcnt(31) lgkmcnt(6)
    v_mfma_f32_32x32x16_bf16 v[48:63], a[120:123], v[40:43], v[48:63]
    ds_read_b128 v[36:39], v2 offset:37888
    s_waitcnt vmcnt(30) lgkmcnt(6)
    v_mfma_f32_32x32x16_bf16 v[64:79], a[124:127], v[44:47], v[64:79]
    ds_read_b128 v[40:43], v2 offset:38912
    s_waitcnt vmcnt(29) lgkmcnt(6)
    v_mfma_f32_32x32x16_bf16 v[48:63], a[128:131], v[16:19], v[48:63]
    ds_read_b128 v[44:47], v2 offset:39936
    s_waitcnt vmcnt(28) lgkmcnt(6)
    v_mfma_f32_32x32x16_bf16 v[64:79], a[132:135], v[20:23], v[64:79]
    s_waitcnt vmcnt(27) lgkmcnt(5)
    v_mfma_f32_32x32x16_bf16 v[48:63], a[136:139], v[24:27], v[48:63]
    s_waitcnt vmcnt(26) lgkmcnt(4)
    v_mfma_f32_32x32x16_bf16 v[64:79], a[140:143], v[28:31], v[64:79]
    s_waitcnt vmcnt(25) lgkmcnt(3)
    v_mfma_f32_32x32x16_bf16 v[48:63], a[144:147], v[32:35], v[48:63]
    s_waitcnt vmcnt(24) lgkmcnt(2)
    v_mfma_f32_32x32x16_bf16 v[64:79], a[148:151], v[36:39], v[64:79]
    s_waitcnt vmcnt(23) lgkmcnt(1)
    v_mfma_f32_32x32x16_bf16 v[48:63], a[152:155], v[40:43], v[48:63]
    s_waitcnt vmcnt(22) lgkmcnt(0)
    v_mfma_f32_32x32x16_bf16 v[64:79], a[156:159], v[44:47], v[64:79]
    s_waitcnt vmcnt(12)
    s_nop 7
    s_nop 3
    v_add_f32 v48, v48, v64
    v_add_f32 v49, v49, v65
    v_add_f32 v50, v50, v66
    v_add_f32 v51, v51, v67
    v_add_f32 v52, v52, v68
    v_add_f32 v53, v53, v69
    v_add_f32 v54, v54, v70
    v_add_f32 v55, v55, v71
    v_add_f32 v56, v56, v72
    v_add_f32 v57, v57, v73
    v_add_f32 v58, v58, v74
    v_add_f32 v59, v59, v75
    v_add_f32 v60, v60, v76
    v_add_f32 v61, v61, v77
    v_add_f32 v62, v62, v78
    v_add_f32 v63, v63, v79
    s_add_u32 s26, s19, 226492416
    v_cvt_pk_bf16_f32 v80, v48, v49
    v_cvt_pk_bf16_f32 v81, v50, v51
    v_cvt_pk_bf16_f32 v82, v52, v53
    v_cvt_pk_bf16_f32 v83, v54, v55
    s_nop 1
    v_permlane32_swap_b32 v80, v82
    v_permlane32_swap_b32 v81, v83
    s_nop 1
    v_lshlrev_b32 v88, 16, v80
    v_and_b32 v89, 0xffff0000, v80
    v_lshlrev_b32 v90, 16, v96
    v_and_b32 v91, 0xffff0000, v96
    v_add_f32 v88, v88, v90
    v_add_f32 v89, v89, v91
    v_cvt_pk_bf16_f32 v80, v88, v89
    v_lshlrev_b32 v92, 16, v81
    v_and_b32 v93, 0xffff0000, v81
    v_lshlrev_b32 v94, 16, v97
    v_and_b32 v95, 0xffff0000, v97
    v_add_f32 v92, v92, v94
    v_add_f32 v93, v93, v95
    v_cvt_pk_bf16_f32 v81, v92, v93
    v_lshlrev_b32 v88, 16, v82
    v_and_b32 v89, 0xffff0000, v82
    v_lshlrev_b32 v90, 16, v98
    v_and_b32 v91, 0xffff0000, v98
    v_add_f32 v88, v88, v90
    v_add_f32 v89, v89, v91
    v_cvt_pk_bf16_f32 v82, v88, v89
    v_lshlrev_b32 v92, 16, v83
    v_and_b32 v93, 0xffff0000, v83
    v_lshlrev_b32 v94, 16, v99
    v_and_b32 v95, 0xffff0000, v99
    v_add_f32 v92, v92, v94
    v_add_f32 v93, v93, v95
    v_cvt_pk_bf16_f32 v83, v92, v93
    buffer_store_dwordx4 v[80:83], v3, s[8:11], s26 offen offset:0 sc1
    v_cvt_pk_bf16_f32 v84, v56, v57
    v_cvt_pk_bf16_f32 v85, v58, v59
    v_cvt_pk_bf16_f32 v86, v60, v61
    v_cvt_pk_bf16_f32 v87, v62, v63
    s_nop 1
    v_permlane32_swap_b32 v84, v86
    v_permlane32_swap_b32 v85, v87
    s_nop 1
    v_lshlrev_b32 v88, 16, v84
    v_and_b32 v89, 0xffff0000, v84
    v_lshlrev_b32 v90, 16, v100
    v_and_b32 v91, 0xffff0000, v100
    v_add_f32 v88, v88, v90
    v_add_f32 v89, v89, v91
    v_cvt_pk_bf16_f32 v84, v88, v89
    v_lshlrev_b32 v92, 16, v85
    v_and_b32 v93, 0xffff0000, v85
    v_lshlrev_b32 v94, 16, v101
    v_and_b32 v95, 0xffff0000, v101
    v_add_f32 v92, v92, v94
    v_add_f32 v93, v93, v95
    v_cvt_pk_bf16_f32 v85, v92, v93
    v_lshlrev_b32 v88, 16, v86
    v_and_b32 v89, 0xffff0000, v86
    v_lshlrev_b32 v90, 16, v102
    v_and_b32 v91, 0xffff0000, v102
    v_add_f32 v88, v88, v90
    v_add_f32 v89, v89, v91
    v_cvt_pk_bf16_f32 v86, v88, v89
    v_lshlrev_b32 v92, 16, v87
    v_and_b32 v93, 0xffff0000, v87
    v_lshlrev_b32 v94, 16, v103
    v_and_b32 v95, 0xffff0000, v103
    v_add_f32 v92, v92, v94
    v_add_f32 v93, v93, v95
    v_cvt_pk_bf16_f32 v87, v92, v93
    buffer_store_dwordx4 v[84:87], v3, s[8:11], s26 offen offset:32 sc1
    s_waitcnt vmcnt(0)
    s_mov_b64 exec, 1
    s_add_u32 s26, s48, s20
    buffer_store_dword v5, v4, s[8:11], s26 offen sc1
    s_mov_b64 exec, -1
    s_add_u32 s20, s20, 128
    s_add_u32 s19, s19, 40960
    s_add_u32 s16, s16, 40960
    s_cmp_eq_u32 s16, 122880
    s_cselect_b32 s16, 0, s16
    s_add_u32 s14, s14, 1
    s_cmp_ge_u32 s14, s15
    s_cbranch_scc1 layerb1_kernel_ab_fin
    s_barrier
    v_add_u32 v2, s16, v1
    ds_read_b128 v[16:19], v2 offset:0
    ds_read_b128 v[20:23], v2 offset:1024
    ds_read_b128 v[24:27], v2 offset:2048
    ds_read_b128 v[28:31], v2 offset:3072
    ds_read_b128 v[32:35], v2 offset:4096
    ds_read_b128 v[36:39], v2 offset:5120
    s_add_u32 s27, s19, 40960
    s_cmp_ge_u32 s14, 63
    s_cselect_b32 s27, s19, s27
    buffer_load_dwordx4 v[96:99], v3, s[52:55], s27 offen offset:0
    buffer_load_dwordx4 v[100:103], v3, s[52:55], s27 offen offset:32
    s_add_u32 s23, s14, 2
    s_min_u32 s24, s23, 63
    s_mul_i32 s24, s24, 40960
    s_add_u32 s24, s24, s18
    s_mul_i32 s25, s13, 10240
    s_add_u32 s25, s25, s17
    s_add_u32 s17, s17, 40960
    s_cmp_eq_u32 s17, 122880
    s_cselect_b32 s17, 0, s17
    ds_read_b128 v[40:43], v2 offset:6144
    s_waitcnt lgkmcnt(6)
    v_mfma_f32_32x32x16_bf16 v[48:63], a[0:3], v[16:19], 0
    ds_read_b128 v[44:47], v2 offset:7168
    s_waitcnt lgkmcnt(6)
    v_mfma_f32_32x32x16_bf16 v[64:79], a[4:7], v[20:23], 0
    s_mov_b32 m0, s25
    s_nop 0
    buffer_load_dwordx4 v1, s[8:11], s24 offen offset:0 lds
    ds_read_b128 v[16:19], v2 offset:8192
    s_waitcnt lgkmcnt(6)
    v_mfma_f32_32x32x16_bf16 v[48:63], a[8:11], v[24:27], v[48:63]
    ds_read_b128 v[20:23], v2 offset:9216
    s_waitcnt lgkmcnt(6)
    v_mfma_f32_32x32x16_bf16 v[64:79], a[12:15], v[28:31], v[64:79]
    ds_read_b128 v[24:27], v2 offset:10240
    s_waitcnt lgkmcnt(6)
    v_mfma_f32_32x32x16_bf16 v[48:63], a[16:19], v[32:35], v[48:63]
    buffer_load_dwordx4 v1, s[8:11], s24 offen offset:1024 lds
    ds_read_b128 v[28:31], v2 offset:11264
    s_waitcnt lgkmcnt(6)
    v_mfma_f32_32x32x16_bf16 v[64:79], a[20:23], v[36:39], v[64:79]
    ds_read_b128 v[32:35], v2 offset:12288
    s_waitcnt lgkmcnt(6)
    v_mfma_f32_32x32x16_bf16 v[48:63], a[24:27], v[40:43], v[48:63]
    ds_read_b128 v[36:39], v2 offset:13312
    s_waitcnt lgkmcnt(6)
    v_mfma_f32_32x32x16_bf16 v[64:79], a[28:31], v[44:47], v[64:79]
    buffer_load_dwordx4 v1, s[8:11], s24 offen offset:2048 lds
    ds_read_b128 v[40:43], v2 offset:14336
    s_waitcnt lgkmcnt(6)
    v_mfma_f32_32x32x16_bf16 v[48:63], a[32:35], v[16:19], v[48:63]
    ds_read_b128 v[44:47], v2 offset:15360
    s_waitcnt lgkmcnt(6)
    v_mfma_f32_32x32x16_bf16 v[64:79], a[36:39], v[20:23], v[64:79]
    ds_read_b128 v[16:19], v2 offset:16384
    s_waitcnt lgkmcnt(6)
    v_mfma_f32_32x32x16_bf16 v[48:63], a[40:43], v[24:27], v[48:63]
    buffer_load_dwordx4 v1, s[8:11], s24 offen offset:3072 lds
    ds_read_b128 v[20:23], v2 offset:17408
    s_waitcnt lgkmcnt(6)
    v_mfma_f32_32x32x16_bf16 v[64:79], a[44:47], v[28:31], v[64:79]
    ds_read_b128 v[24:27], v2 offset:18432
    s_waitcnt lgkmcnt(6)
    v_mfma_f32_32x32x16_bf16 v[48:63], a[48:51], v[32:35], v[48:63]
    ds_read_b128 v[28:31], v2 offset:19456
    s_waitcnt lgkmcnt(6)
    v_mfma_f32_32x32x16_bf16 v[64:79], a[52:55], v[36:39], v[64:79]
    s_add_u32 s24, s24, 4096
    s_add_u32 s25, s25, 4096
    s_mov_b32 m0, s25
    s_nop 0
    buffer_load_dwordx4 v1, s[8:11], s24 offen offset:0 lds
    ds_read_b128 v[32:35], v2 offset:20480
    s_waitcnt lgkmcnt(6)
    v_mfma_f32_32x32x16_bf16 v[48:63], a[56:59], v[40:43], v[48:63]
    ds_read_b128 v[36:39], v2 offset:21504
    s_waitcnt lgkmcnt(6)
    v_mfma_f32_32x32x16_bf16 v[64:79], a[60:63], v[44:47], v[64:79]
    ds_read_b128 v[40:43], v2 offset:22528
    s_waitcnt lgkmcnt(6)
    v_mfma_f32_32x32x16_bf16 v[48:63], a[64:67], v[16:19], v[48:63]
    buffer_load_dwordx4 v1, s[8:11], s24 offen offset:1024 lds
    ds_read_b128 v[44:47], v2 offset:23552
    s_waitcnt lgkmcnt(6)
    v_mfma_f32_32x32x16_bf16 v[64:79], a[68:71], v[20:23], v[64:79]
    ds_read_b128 v[16:19], v2 offset:24576
    s_waitcnt lgkmcnt(6)
    v_mfma_f32_32x32x16_bf16 v[48:63], a[72:75], v[24:27], v[48:63]
    ds_read_b128 v[20:23], v2 offset:25600
    s_waitcnt lgkmcnt(6)
    v_mfma_f32_32x32x16_bf16 v[64:79], a[76:79], v[28:31], v[64:79]
    buffer_load_dwordx4 v1, s[8:11], s24 offen offset:2048 lds
    ds_read_b128 v[24:27], v2 offset:26624
    s_waitcnt lgkmcnt(6)
    v_mfma_f32_32x32x16_bf16 v[48:63], a[80:83], v[32:35], v[48:63]
    ds_read_b128 v[28:31], v2 offset:27648
    s_waitcnt lgkmcnt(6)
    v_mfma_f32_32x32x16_bf16 v[64:79], a[84:87], v[36:39], v[64:79]
    ds_read_b128 v[32:35], v2 offset:28672
    s_waitcnt lgkmcnt(6)
    v_mfma_f32_32x32x16_bf16 v[48:63], a[88:91], v[40:43], v[48:63]
    buffer_load_dwordx4 v1, s[8:11], s24 offen offset:3072 lds
    ds_read_b128 v[36:39], v2 offset:29696
    s_waitcnt lgkmcnt(6)
    v_mfma_f32_32x32x16_bf16 v[64:79], a[92:95], v[44:47], v[64:79]
    ds_read_b128 v[40:43], v2 offset:30720
    s_waitcnt lgkmcnt(6)
    v_mfma_f32_32x32x16_bf16 v[48:63], a[96:99], v[16:19], v[48:63]
    ds_read_b128 v[44:47], v2 offset:31744
    s_waitcnt lgkmcnt(6)
    v_mfma_f32_32x32x16_bf16 v[64:79], a[100:103], v[20:23], v[64:79]
    s_add_u32 s24, s24, 4096
    s_add_u32 s25, s25, 4096
    s_mov_b32 m0, s25
    s_nop 0
    buffer_load_dwordx4 v1, s[8:11], s24 offen offset:0 lds
    ds_read_b128 v[16:19], v2 offset:32768
    s_waitcnt lgkmcnt(6)
    v_mfma_f32_32x32x16_bf16 v[48:63], a[104:107], v[24:27], v[48:63]
    ds_read_b128 v[20:23], v2 offset:33792
    s_waitcnt lgkmcnt(6)
    v_mfma_f32_32x32x16_bf16 v[64:79], a[108:111], v[28:31], v[64:79]
    ds_read_b128 v[24:27], v2 offset:34816
    s_waitcnt lgkmcnt(6)
    v_mfma_f32_32x32x16_bf16 v[48:63], a[112:115], v[32:35], v[48:63]
    buffer_load_dwordx4 v1, s[8:11], s24 offen offset:1024 lds
    ds_read_b128 v[28:31], v2 offset:35840
    s_waitcnt lgkmcnt(6)
    v_mfma_f32_32x32x16_bf16 v[64:79], a[116:119], v[36:39], v[64:79]
    ds_read_b128 v[32:35], v2 offset:36864
    s_waitcnt lgkmcnt(6)
    v_mfma_f32_32x32x16_bf16 v[48:63], a[120:123], v[40:43], v[48:63]
    ds_read_b128 v[36:39], v2 offset:37888
    s_waitcnt lgkmcnt(6)
    v_mfma_f32_32x32x16_bf16 v[64:79], a[124:127], v[44:47], v[64:79]
    ds_read_b128 v[40:43], v2 offset:38912
    s_waitcnt lgkmcnt(6)
    v_mfma_f32_32x32x16_bf16 v[48:63], a[128:131], v[16:19], v[48:63]
    ds_read_b128 v[44:47], v2 offset:39936
    s_waitcnt lgkmcnt(6)
    v_mfma_f32_32x32x16_bf16 v[64:79], a[132:135], v[20:23], v[64:79]
    s_waitcnt lgkmcnt(5)
    v_mfma_f32_32x32x16_bf16 v[48:63], a[136:139], v[24:27], v[48:63]
    s_waitcnt lgkmcnt(4)
    v_mfma_f32_32x32x16_bf16 v[64:79], a[140:143], v[28:31], v[64:79]
    s_waitcnt lgkmcnt(3)
    v_mfma_f32_32x32x16_bf16 v[48:63], a[144:147], v[32:35], v[48:63]
    s_waitcnt lgkmcnt(2)
    v_mfma_f32_32x32x16_bf16 v[64:79], a[148:151], v[36:39], v[64:79]
    s_waitcnt lgkmcnt(1)
    v_mfma_f32_32x32x16_bf16 v[48:63], a[152:155], v[40:43], v[48:63]
    s_waitcnt lgkmcnt(0)
    v_mfma_f32_32x32x16_bf16 v[64:79], a[156:159], v[44:47], v[64:79]
    s_waitcnt vmcnt(12)
    s_nop 7
    s_nop 3
    v_add_f32 v48, v48, v64
    v_add_f32 v49, v49, v65
    v_add_f32 v50, v50, v66
    v_add_f32 v51, v51, v67
    v_add_f32 v52, v52, v68
    v_add_f32 v53, v53, v69
    v_add_f32 v54, v54, v70
    v_add_f32 v55, v55, v71
    v_add_f32 v56, v56, v72
    v_add_f32 v57, v57, v73
    v_add_f32 v58, v58, v74
    v_add_f32 v59, v59, v75
    v_add_f32 v60, v60, v76
    v_add_f32 v61, v61, v77
    v_add_f32 v62, v62, v78
    v_add_f32 v63, v63, v79
    s_add_u32 s26, s19, 226492416
    v_cvt_pk_bf16_f32 v80, v48, v49
    v_cvt_pk_bf16_f32 v81, v50, v51
    v_cvt_pk_bf16_f32 v82, v52, v53
    v_cvt_pk_bf16_f32 v83, v54, v55
    s_nop 1
    v_permlane32_swap_b32 v80, v82
    v_permlane32_swap_b32 v81, v83
    s_nop 1
    v_lshlrev_b32 v88, 16, v80
    v_and_b32 v89, 0xffff0000, v80
    v_lshlrev_b32 v90, 16, v104
    v_and_b32 v91, 0xffff0000, v104
    v_add_f32 v88, v88, v90
    v_add_f32 v89, v89, v91
    v_cvt_pk_bf16_f32 v80, v88, v89
    v_lshlrev_b32 v92, 16, v81
    v_and_b32 v93, 0xffff0000, v81
    v_lshlrev_b32 v94, 16, v105
    v_and_b32 v95, 0xffff0000, v105
    v_add_f32 v92, v92, v94
    v_add_f32 v93, v93, v95
    v_cvt_pk_bf16_f32 v81, v92, v93
    v_lshlrev_b32 v88, 16, v82
    v_and_b32 v89, 0xffff0000, v82
    v_lshlrev_b32 v90, 16, v106
    v_and_b32 v91, 0xffff0000, v106
    v_add_f32 v88, v88, v90
    v_add_f32 v89, v89, v91
    v_cvt_pk_bf16_f32 v82, v88, v89
    v_lshlrev_b32 v92, 16, v83
    v_and_b32 v93, 0xffff0000, v83
    v_lshlrev_b32 v94, 16, v107
    v_and_b32 v95, 0xffff0000, v107
    v_add_f32 v92, v92, v94
    v_add_f32 v93, v93, v95
    v_cvt_pk_bf16_f32 v83, v92, v93
    buffer_store_dwordx4 v[80:83], v3, s[8:11], s26 offen offset:0 sc1
    v_cvt_pk_bf16_f32 v84, v56, v57
    v_cvt_pk_bf16_f32 v85, v58, v59
    v_cvt_pk_bf16_f32 v86, v60, v61
    v_cvt_pk_bf16_f32 v87, v62, v63
    s_nop 1
    v_permlane32_swap_b32 v84, v86
    v_permlane32_swap_b32 v85, v87
    s_nop 1
    v_lshlrev_b32 v88, 16, v84
    v_and_b32 v89, 0xffff0000, v84
    v_lshlrev_b32 v90, 16, v108
    v_and_b32 v91, 0xffff0000, v108
    v_add_f32 v88, v88, v90
    v_add_f32 v89, v89, v91
    v_cvt_pk_bf16_f32 v84, v88, v89
    v_lshlrev_b32 v92, 16, v85
    v_and_b32 v93, 0xffff0000, v85
    v_lshlrev_b32 v94, 16, v109
    v_and_b32 v95, 0xffff0000, v109
    v_add_f32 v92, v92, v94
    v_add_f32 v93, v93, v95
    v_cvt_pk_bf16_f32 v85, v92, v93
    v_lshlrev_b32 v88, 16, v86
    v_and_b32 v89, 0xffff0000, v86
    v_lshlrev_b32 v90, 16, v110
    v_and_b32 v91, 0xffff0000, v110
    v_add_f32 v88, v88, v90
    v_add_f32 v89, v89, v91
    v_cvt_pk_bf16_f32 v86, v88, v89
    v_lshlrev_b32 v92, 16, v87
    v_and_b32 v93, 0xffff0000, v87
    v_lshlrev_b32 v94, 16, v111
    v_and_b32 v95, 0xffff0000, v111
    v_add_f32 v92, v92, v94
    v_add_f32 v93, v93, v95
    v_cvt_pk_bf16_f32 v87, v92, v93
    buffer_store_dwordx4 v[84:87], v3, s[8:11], s26 offen offset:32 sc1
    s_waitcnt vmcnt(0)
    s_mov_b64 exec, 1
    s_add_u32 s26, s48, s20
    buffer_store_dword v5, v4, s[8:11], s26 offen sc1
    s_mov_b64 exec, -1
    s_add_u32 s20, s20, 128
    s_add_u32 s19, s19, 40960
    s_add_u32 s16, s16, 40960
    s_cmp_eq_u32 s16, 122880
    s_cselect_b32 s16, 0, s16
    s_add_u32 s14, s14, 1
    s_cmp_ge_u32 s14, s15
    s_cbranch_scc1 layerb1_kernel_ab_fin
    s_barrier
    v_add_u32 v2, s16, v1
    ds_read_b128 v[16:19], v2 offset:0
    ds_read_b128 v[20:23], v2 offset:1024
    ds_read_b128 v[24:27], v2 offset:2048
    ds_read_b128 v[28:31], v2 offset:3072
    ds_read_b128 v[32:35], v2 offset:4096
    ds_read_b128 v[36:39], v2 offset:5120
    s_add_u32 s27, s19, 40960
    s_cmp_ge_u32 s14, 63
    s_cselect_b32 s27, s19, s27
    buffer_load_dwordx4 v[104:107], v3, s[52:55], s27 offen offset:0
    buffer_load_dwordx4 v[108:111], v3, s[52:55], s27 offen offset:32
    s_add_u32 s23, s14, 2
    s_min_u32 s24, s23, 63
    s_mul_i32 s24, s24, 40960
    s_add_u32 s24, s24, s18
    s_mul_i32 s25, s13, 10240
    s_add_u32 s25, s25, s17
    s_add_u32 s17, s17, 40960
    s_cmp_eq_u32 s17, 122880
    s_cselect_b32 s17, 0, s17
    ds_read_b128 v[40:43], v2 offset:6144
    s_waitcnt lgkmcnt(6)
    v_mfma_f32_32x32x16_bf16 v[48:63], a[0:3], v[16:19], 0
    ds_read_b128 v[44:47], v2 offset:7168
    s_waitcnt lgkmcnt(6)
    v_mfma_f32_32x32x16_bf16 v[64:79], a[4:7], v[20:23], 0
    s_mov_b32 m0, s25
    s_nop 0
    buffer_load_dwordx4 v1, s[8:11], s24 offen offset:0 lds
    ds_read_b128 v[16:19], v2 offset:8192
    s_waitcnt lgkmcnt(6)
    v_mfma_f32_32x32x16_bf16 v[48:63], a[8:11], v[24:27], v[48:63]
    ds_read_b128 v[20:23], v2 offset:9216
    s_waitcnt lgkmcnt(6)
    v_mfma_f32_32x32x16_bf16 v[64:79], a[12:15], v[28:31], v[64:79]
    ds_read_b128 v[24:27], v2 offset:10240
    s_waitcnt lgkmcnt(6)
    v_mfma_f32_32x32x16_bf16 v[48:63], a[16:19], v[32:35], v[48:63]
    buffer_load_dwordx4 v1, s[8:11], s24 offen offset:1024 lds
    ds_read_b128 v[28:31], v2 offset:11264
    s_waitcnt lgkmcnt(6)
    v_mfma_f32_32x32x16_bf16 v[64:79], a[20:23], v[36:39], v[64:79]
    ds_read_b128 v[32:35], v2 offset:12288
    s_waitcnt lgkmcnt(6)
    v_mfma_f32_32x32x16_bf16 v[48:63], a[24:27], v[40:43], v[48:63]
    ds_read_b128 v[36:39], v2 offset:13312
    s_waitcnt lgkmcnt(6)
    v_mfma_f32_32x32x16_bf16 v[64:79], a[28:31], v[44:47], v[64:79]
    buffer_load_dwordx4 v1, s[8:11], s24 offen offset:2048 lds
    ds_read_b128 v[40:43], v2 offset:14336
    s_waitcnt lgkmcnt(6)
    v_mfma_f32_32x32x16_bf16 v[48:63], a[32:35], v[16:19], v[48:63]
    ds_read_b128 v[44:47], v2 offset:15360
    s_waitcnt lgkmcnt(6)
    v_mfma_f32_32x32x16_bf16 v[64:79], a[36:39], v[20:23], v[64:79]
    ds_read_b128 v[16:19], v2 offset:16384
    s_waitcnt lgkmcnt(6)
    v_mfma_f32_32x32x16_bf16 v[48:63], a[40:43], v[24:27], v[48:63]
    buffer_load_dwordx4 v1, s[8:11], s24 offen offset:3072 lds
    ds_read_b128 v[20:23], v2 offset:17408
    s_waitcnt lgkmcnt(6)
    v_mfma_f32_32x32x16_bf16 v[64:79], a[44:47], v[28:31], v[64:79]
    ds_read_b128 v[24:27], v2 offset:18432
    s_waitcnt lgkmcnt(6)
    v_mfma_f32_32x32x16_bf16 v[48:63], a[48:51], v[32:35], v[48:63]
    ds_read_b128 v[28:31], v2 offset:19456
    s_waitcnt lgkmcnt(6)
    v_mfma_f32_32x32x16_bf16 v[64:79], a[52:55], v[36:39], v[64:79]
    s_add_u32 s24, s24, 4096
    s_add_u32 s25, s25, 4096
    s_mov_b32 m0, s25
    s_nop 0
    buffer_load_dwordx4 v1, s[8:11], s24 offen offset:0 lds
    ds_read_b128 v[32:35], v2 offset:20480
    s_waitcnt lgkmcnt(6)
    v_mfma_f32_32x32x16_bf16 v[48:63], a[56:59], v[40:43], v[48:63]
    ds_read_b128 v[36:39], v2 offset:21504
    s_waitcnt lgkmcnt(6)
    v_mfma_f32_32x32x16_bf16 v[64:79], a[60:63], v[44:47], v[64:79]
    ds_read_b128 v[40:43], v2 offset:22528
    s_waitcnt lgkmcnt(6)
    v_mfma_f32_32x32x16_bf16 v[48:63], a[64:67], v[16:19], v[48:63]
    buffer_load_dwordx4 v1, s[8:11], s24 offen offset:1024 lds
    ds_read_b128 v[44:47], v2 offset:23552
    s_waitcnt lgkmcnt(6)
    v_mfma_f32_32x32x16_bf16 v[64:79], a[68:71], v[20:23], v[64:79]
    ds_read_b128 v[16:19], v2 offset:24576
    s_waitcnt lgkmcnt(6)
    v_mfma_f32_32x32x16_bf16 v[48:63], a[72:75], v[24:27], v[48:63]
    ds_read_b128 v[20:23], v2 offset:25600
    s_waitcnt lgkmcnt(6)
    v_mfma_f32_32x32x16_bf16 v[64:79], a[76:79], v[28:31], v[64:79]
    buffer_load_dwordx4 v1, s[8:11], s24 offen offset:2048 lds
    ds_read_b128 v[24:27], v2 offset:26624
    s_waitcnt lgkmcnt(6)
    v_mfma_f32_32x32x16_bf16 v[48:63], a[80:83], v[32:35], v[48:63]
    ds_read_b128 v[28:31], v2 offset:27648
    s_waitcnt lgkmcnt(6)
    v_mfma_f32_32x32x16_bf16 v[64:79], a[84:87], v[36:39], v[64:79]
    ds_read_b128 v[32:35], v2 offset:28672
    s_waitcnt lgkmcnt(6)
    v_mfma_f32_32x32x16_bf16 v[48:63], a[88:91], v[40:43], v[48:63]
    buffer_load_dwordx4 v1, s[8:11], s24 offen offset:3072 lds
    ds_read_b128 v[36:39], v2 offset:29696
    s_waitcnt lgkmcnt(6)
    v_mfma_f32_32x32x16_bf16 v[64:79], a[92:95], v[44:47], v[64:79]
    ds_read_b128 v[40:43], v2 offset:30720
    s_waitcnt lgkmcnt(6)
    v_mfma_f32_32x32x16_bf16 v[48:63], a[96:99], v[16:19], v[48:63]
    ds_read_b128 v[44:47], v2 offset:31744
    s_waitcnt lgkmcnt(6)
    v_mfma_f32_32x32x16_bf16 v[64:79], a[100:103], v[20:23], v[64:79]
    s_add_u32 s24, s24, 4096
    s_add_u32 s25, s25, 4096
    s_mov_b32 m0, s25
    s_nop 0
    buffer_load_dwordx4 v1, s[8:11], s24 offen offset:0 lds
    ds_read_b128 v[16:19], v2 offset:32768
    s_waitcnt lgkmcnt(6)
    v_mfma_f32_32x32x16_bf16 v[48:63], a[104:107], v[24:27], v[48:63]
    ds_read_b128 v[20:23], v2 offset:33792
    s_waitcnt lgkmcnt(6)
    v_mfma_f32_32x32x16_bf16 v[64:79], a[108:111], v[28:31], v[64:79]
    ds_read_b128 v[24:27], v2 offset:34816
    s_waitcnt lgkmcnt(6)
    v_mfma_f32_32x32x16_bf16 v[48:63], a[112:115], v[32:35], v[48:63]
    buffer_load_dwordx4 v1, s[8:11], s24 offen offset:1024 lds
    ds_read_b128 v[28:31], v2 offset:35840
    s_waitcnt lgkmcnt(6)
    v_mfma_f32_32x32x16_bf16 v[64:79], a[116:119], v[36:39], v[64:79]
    ds_read_b128 v[32:35], v2 offset:36864
    s_waitcnt lgkmcnt(6)
    v_mfma_f32_32x32x16_bf16 v[48:63], a[120:123], v[40:43], v[48:63]
    ds_read_b128 v[36:39], v2 offset:37888
    s_waitcnt lgkmcnt(6)
    v_mfma_f32_32x32x16_bf16 v[64:79], a[124:127], v[44:47], v[64:79]
    ds_read_b128 v[40:43], v2 offset:38912
    s_waitcnt lgkmcnt(6)
    v_mfma_f32_32x32x16_bf16 v[48:63], a[128:131], v[16:19], v[48:63]
    ds_read_b128 v[44:47], v2 offset:39936
    s_waitcnt lgkmcnt(6)
    v_mfma_f32_32x32x16_bf16 v[64:79], a[132:135], v[20:23], v[64:79]
    s_waitcnt lgkmcnt(5)
    v_mfma_f32_32x32x16_bf16 v[48:63], a[136:139], v[24:27], v[48:63]
    s_waitcnt lgkmcnt(4)
    v_mfma_f32_32x32x16_bf16 v[64:79], a[140:143], v[28:31], v[64:79]
    s_waitcnt lgkmcnt(3)
    v_mfma_f32_32x32x16_bf16 v[48:63], a[144:147], v[32:35], v[48:63]
    s_waitcnt lgkmcnt(2)
    v_mfma_f32_32x32x16_bf16 v[64:79], a[148:151], v[36:39], v[64:79]
    s_waitcnt lgkmcnt(1)
    v_mfma_f32_32x32x16_bf16 v[48:63], a[152:155], v[40:43], v[48:63]
    s_waitcnt lgkmcnt(0)
    v_mfma_f32_32x32x16_bf16 v[64:79], a[156:159], v[44:47], v[64:79]
    s_waitcnt vmcnt(12)
    s_nop 7
    s_nop 3
    v_add_f32 v48, v48, v64
    v_add_f32 v49, v49, v65
    v_add_f32 v50, v50, v66
    v_add_f32 v51, v51, v67
    v_add_f32 v52, v52, v68
    v_add_f32 v53, v53, v69
    v_add_f32 v54, v54, v70
    v_add_f32 v55, v55, v71
    v_add_f32 v56, v56, v72
    v_add_f32 v57, v57, v73
    v_add_f32 v58, v58, v74
    v_add_f32 v59, v59, v75
    v_add_f32 v60, v60, v76
    v_add_f32 v61, v61, v77
    v_add_f32 v62, v62, v78
    v_add_f32 v63, v63, v79
    s_add_u32 s26, s19, 226492416
    v_cvt_pk_bf16_f32 v80, v48, v49
    v_cvt_pk_bf16_f32 v81, v50, v51
    v_cvt_pk_bf16_f32 v82, v52, v53
    v_cvt_pk_bf16_f32 v83, v54, v55
    s_nop 1
    v_permlane32_swap_b32 v80, v82
    v_permlane32_swap_b32 v81, v83
    s_nop 1
    v_lshlrev_b32 v88, 16, v80
    v_and_b32 v89, 0xffff0000, v80
    v_lshlrev_b32 v90, 16, v96
    v_and_b32 v91, 0xffff0000, v96
    v_add_f32 v88, v88, v90
    v_add_f32 v89, v89, v91
    v_cvt_pk_bf16_f32 v80, v88, v89
    v_lshlrev_b32 v92, 16, v81
    v_and_b32 v93, 0xffff0000, v81
    v_lshlrev_b32 v94, 16, v97
    v_and_b32 v95, 0xffff0000, v97
    v_add_f32 v92, v92, v94
    v_add_f32 v93, v93, v95
    v_cvt_pk_bf16_f32 v81, v92, v93
    v_lshlrev_b32 v88, 16, v82
    v_and_b32 v89, 0xffff0000, v82
    v_lshlrev_b32 v90, 16, v98
    v_and_b32 v91, 0xffff0000, v98
    v_add_f32 v88, v88, v90
    v_add_f32 v89, v89, v91
    v_cvt_pk_bf16_f32 v82, v88, v89
    v_lshlrev_b32 v92, 16, v83
    v_and_b32 v93, 0xffff0000, v83
    v_lshlrev_b32 v94, 16, v99
    v_and_b32 v95, 0xffff0000, v99
    v_add_f32 v92, v92, v94
    v_add_f32 v93, v93, v95
    v_cvt_pk_bf16_f32 v83, v92, v93
    buffer_store_dwordx4 v[80:83], v3, s[8:11], s26 offen offset:0 sc1
    v_cvt_pk_bf16_f32 v84, v56, v57
    v_cvt_pk_bf16_f32 v85, v58, v59
    v_cvt_pk_bf16_f32 v86, v60, v61
    v_cvt_pk_bf16_f32 v87, v62, v63
    s_nop 1
    v_permlane32_swap_b32 v84, v86
    v_permlane32_swap_b32 v85, v87
    s_nop 1
    v_lshlrev_b32 v88, 16, v84
    v_and_b32 v89, 0xffff0000, v84
    v_lshlrev_b32 v90, 16, v100
    v_and_b32 v91, 0xffff0000, v100
    v_add_f32 v88, v88, v90
    v_add_f32 v89, v89, v91
    v_cvt_pk_bf16_f32 v84, v88, v89
    v_lshlrev_b32 v92, 16, v85
    v_and_b32 v93, 0xffff0000, v85
    v_lshlrev_b32 v94, 16, v101
    v_and_b32 v95, 0xffff0000, v101
    v_add_f32 v92, v92, v94
    v_add_f32 v93, v93, v95
    v_cvt_pk_bf16_f32 v85, v92, v93
    v_lshlrev_b32 v88, 16, v86
    v_and_b32 v89, 0xffff0000, v86
    v_lshlrev_b32 v90, 16, v102
    v_and_b32 v91, 0xffff0000, v102
    v_add_f32 v88, v88, v90
    v_add_f32 v89, v89, v91
    v_cvt_pk_bf16_f32 v86, v88, v89
    v_lshlrev_b32 v92, 16, v87
    v_and_b32 v93, 0xffff0000, v87
    v_lshlrev_b32 v94, 16, v103
    v_and_b32 v95, 0xffff0000, v103
    v_add_f32 v92, v92, v94
    v_add_f32 v93, v93, v95
    v_cvt_pk_bf16_f32 v87, v92, v93
    buffer_store_dwordx4 v[84:87], v3, s[8:11], s26 offen offset:32 sc1
    s_waitcnt vmcnt(0)
    s_mov_b64 exec, 1
    s_add_u32 s26, s48, s20
    buffer_store_dword v5, v4, s[8:11], s26 offen sc1
    s_mov_b64 exec, -1
    s_add_u32 s20, s20, 128
    s_add_u32 s19, s19, 40960
    s_add_u32 s16, s16, 40960
    s_cmp_eq_u32 s16, 122880
    s_cselect_b32 s16, 0, s16
    s_add_u32 s14, s14, 1
    s_cmp_ge_u32 s14, s15
    s_cbranch_scc1 layerb1_kernel_ab_fin
    s_sub_u32 s20, s20, 128
layerb1_kernel_ab_loop:
    s_barrier
    v_add_u32 v2, s16, v1
    ds_read_b128 v[16:19], v2 offset:0
    ds_read_b128 v[20:23], v2 offset:1024
    ds_read_b128 v[24:27], v2 offset:2048
    ds_read_b128 v[28:31], v2 offset:3072
    ds_read_b128 v[32:35], v2 offset:4096
    ds_read_b128 v[36:39], v2 offset:5120
    s_add_u32 s27, s19, 40960
    s_cmp_ge_u32 s14, 63
    s_cselect_b32 s27, s19, s27
    buffer_load_dwordx4 v[96:99], v3, s[52:55], s27 offen offset:0
    buffer_load_dwordx4 v[100:103], v3, s[52:55], s27 offen offset:32
    s_add_u32 s23, s14, 2
    s_min_u32 s24, s23, 63
    s_mul_i32 s24, s24, 40960
    s_add_u32 s24, s24, s18
    s_mul_i32 s25, s13, 10240
    s_add_u32 s25, s25, s17
    s_add_u32 s17, s17, 40960
    s_cmp_eq_u32 s17, 122880
    s_cselect_b32 s17, 0, s17
    ds_read_b128 v[40:43], v2 offset:6144
    s_waitcnt lgkmcnt(6)
    v_mfma_f32_32x32x16_bf16 v[48:63], a[0:3], v[16:19], 0
    ds_read_b128 v[44:47], v2 offset:7168
    s_waitcnt lgkmcnt(6)
    v_mfma_f32_32x32x16_bf16 v[64:79], a[4:7], v[20:23], 0
    s_mov_b32 m0, s25
    s_nop 0
    buffer_load_dwordx4 v1, s[8:11], s24 offen offset:0 lds
    ds_read_b128 v[16:19], v2 offset:8192
    s_waitcnt lgkmcnt(6)
    v_mfma_f32_32x32x16_bf16 v[48:63], a[8:11], v[24:27], v[48:63]
    ds_read_b128 v[20:23], v2 offset:9216
    s_waitcnt lgkmcnt(6)
    v_mfma_f32_32x32x16_bf16 v[64:79], a[12:15], v[28:31], v[64:79]
    ds_read_b128 v[24:27], v2 offset:10240
    s_waitcnt lgkmcnt(6)
    v_mfma_f32_32x32x16_bf16 v[48:63], a[16:19], v[32:35], v[48:63]
    buffer_load_dwordx4 v1, s[8:11], s24 offen offset:1024 lds
    ds_read_b128 v[28:31], v2 offset:11264
    s_waitcnt lgkmcnt(6)
    v_mfma_f32_32x32x16_bf16 v[64:79], a[20:23], v[36:39], v[64:79]
    ds_read_b128 v[32:35], v2 offset:12288
    s_waitcnt lgkmcnt(6)
    v_mfma_f32_32x32x16_bf16 v[48:63], a[24:27], v[40:43], v[48:63]
    ds_read_b128 v[36:39], v2 offset:13312
    s_waitcnt lgkmcnt(6)
    v_mfma_f32_32x32x16_bf16 v[64:79], a[28:31], v[44:47], v[64:79]
    buffer_load_dwordx4 v1, s[8:11], s24 offen offset:2048 lds
    ds_read_b128 v[40:43], v2 offset:14336
    s_waitcnt lgkmcnt(6)
    v_mfma_f32_32x32x16_bf16 v[48:63], a[32:35], v[16:19], v[48:63]
    ds_read_b128 v[44:47], v2 offset:15360
    s_waitcnt lgkmcnt(6)
    v_mfma_f32_32x32x16_bf16 v[64:79], a[36:39], v[20:23], v[64:79]
    ds_read_b128 v[16:19], v2 offset:16384
    s_waitcnt lgkmcnt(6)
    v_mfma_f32_32x32x16_bf16 v[48:63], a[40:43], v[24:27], v[48:63]
    buffer_load_dwordx4 v1, s[8:11], s24 offen offset:3072 lds
    ds_read_b128 v[20:23], v2 offset:17408
    s_waitcnt lgkmcnt(6)
    v_mfma_f32_32x32x16_bf16 v[64:79], a[44:47], v[28:31], v[64:79]
    ds_read_b128 v[24:27], v2 offset:18432
    s_waitcnt lgkmcnt(6)
    v_mfma_f32_32x32x16_bf16 v[48:63], a[48:51], v[32:35], v[48:63]
    ds_read_b128 v[28:31], v2 offset:19456
    s_waitcnt lgkmcnt(6)
    v_mfma_f32_32x32x16_bf16 v[64:79], a[52:55], v[36:39], v[64:79]
    s_add_u32 s24, s24, 4096
    s_add_u32 s25, s25, 4096
    s_mov_b32 m0, s25
    s_nop 0
    buffer_load_dwordx4 v1, s[8:11], s24 offen offset:0 lds
    ds_read_b128 v[32:35], v2 offset:20480
    s_waitcnt lgkmcnt(6)
    v_mfma_f32_32x32x16_bf16 v[48:63], a[56:59], v[40:43], v[48:63]
    ds_read_b128 v[36:39], v2 offset:21504
    s_waitcnt lgkmcnt(6)
    v_mfma_f32_32x32x16_bf16 v[64:79], a[60:63], v[44:47], v[64:79]
    ds_read_b128 v[40:43], v2 offset:22528
    s_waitcnt lgkmcnt(6)
    v_mfma_f32_32x32x16_bf16 v[48:63], a[64:67], v[16:19], v[48:63]
    buffer_load_dwordx4 v1, s[8:11], s24 offen offset:1024 lds
    ds_read_b128 v[44:47], v2 offset:23552
    s_waitcnt lgkmcnt(6)
    v_mfma_f32_32x32x16_bf16 v[64:79], a[68:71], v[20:23], v[64:79]
    ds_read_b128 v[16:19], v2 offset:24576
    s_waitcnt lgkmcnt(6)
    v_mfma_f32_32x32x16_bf16 v[48:63], a[72:75], v[24:27], v[48:63]
    ds_read_b128 v[20:23], v2 offset:25600
    s_waitcnt lgkmcnt(6)
    v_mfma_f32_32x32x16_bf16 v[64:79], a[76:79], v[28:31], v[64:79]
    buffer_load_dwordx4 v1, s[8:11], s24 offen offset:2048 lds
    ds_read_b128 v[24:27], v2 offset:26624
    s_waitcnt lgkmcnt(6)
    v_mfma_f32_32x32x16_bf16 v[48:63], a[80:83], v[32:35], v[48:63]
    ds_read_b128 v[28:31], v2 offset:27648
    s_waitcnt lgkmcnt(6)
    v_mfma_f32_32x32x16_bf16 v[64:79], a[84:87], v[36:39], v[64:79]
    ds_read_b128 v[32:35], v2 offset:28672
    s_waitcnt lgkmcnt(6)
    v_mfma_f32_32x32x16_bf16 v[48:63], a[88:91], v[40:43], v[48:63]
    buffer_load_dwordx4 v1, s[8:11], s24 offen offset:3072 lds
    ds_read_b128 v[36:39], v2 offset:29696
    s_waitcnt lgkmcnt(6)
    v_mfma_f32_32x32x16_bf16 v[64:79], a[92:95], v[44:47], v[64:79]
    ds_read_b128 v[40:43], v2 offset:30720
    s_waitcnt lgkmcnt(6)
    v_mfma_f32_32x32x16_bf16 v[48:63], a[96:99], v[16:19], v[48:63]
    ds_read_b128 v[44:47], v2 offset:31744
    s_waitcnt lgkmcnt(6)
    v_mfma_f32_32x32x16_bf16 v[64:79], a[100:103], v[20:23], v[64:79]
    s_add_u32 s24, s24, 4096
    s_add_u32 s25, s25, 4096
    s_mov_b32 m0, s25
    s_nop 0
    buffer_load_dwordx4 v1, s[8:11], s24 offen offset:0 lds
    ds_read_b128 v[16:19], v2 offset:32768
    s_waitcnt lgkmcnt(6)
    v_mfma_f32_32x32x16_bf16 v[48:63], a[104:107], v[24:27], v[48:63]
    ds_read_b128 v[20:23], v2 offset:33792
    s_waitcnt lgkmcnt(6)
    v_mfma_f32_32x32x16_bf16 v[64:79], a[108:111], v[28:31], v[64:79]
    ds_read_b128 v[24:27], v2 offset:34816
    s_waitcnt lgkmcnt(6)
    v_mfma_f32_32x32x16_bf16 v[48:63], a[112:115], v[32:35], v[48:63]
    buffer_load_dwordx4 v1, s[8:11], s24 offen offset:1024 lds
    ds_read_b128 v[28:31], v2 offset:35840
    s_waitcnt lgkmcnt(6)
    v_mfma_f32_32x32x16_bf16 v[64:79], a[116:119], v[36:39], v[64:79]
    ds_read_b128 v[32:35], v2 offset:36864
    s_waitcnt lgkmcnt(6)
    v_mfma_f32_32x32x16_bf16 v[48:63], a[120:123], v[40:43], v[48:63]
    ds_read_b128 v[36:39], v2 offset:37888
    s_waitcnt lgkmcnt(6)
    v_mfma_f32_32x32x16_bf16 v[64:79], a[124:127], v[44:47], v[64:79]
    ds_read_b128 v[40:43], v2 offset:38912
    s_waitcnt lgkmcnt(6)
    v_mfma_f32_32x32x16_bf16 v[48:63], a[128:131], v[16:19], v[48:63]
    ds_read_b128 v[44:47], v2 offset:39936
    s_waitcnt lgkmcnt(6)
    v_mfma_f32_32x32x16_bf16 v[64:79], a[132:135], v[20:23], v[64:79]
    s_waitcnt lgkmcnt(5)
    v_mfma_f32_32x32x16_bf16 v[48:63], a[136:139], v[24:27], v[48:63]
    s_waitcnt lgkmcnt(4)
    v_mfma_f32_32x32x16_bf16 v[64:79], a[140:143], v[28:31], v[64:79]
    s_waitcnt lgkmcnt(3)
    v_mfma_f32_32x32x16_bf16 v[48:63], a[144:147], v[32:35], v[48:63]
    s_waitcnt lgkmcnt(2)
    v_mfma_f32_32x32x16_bf16 v[64:79], a[148:151], v[36:39], v[64:79]
    s_waitcnt lgkmcnt(1)
    v_mfma_f32_32x32x16_bf16 v[48:63], a[152:155], v[40:43], v[48:63]
    s_waitcnt lgkmcnt(0)
    v_mfma_f32_32x32x16_bf16 v[64:79], a[156:159], v[44:47], v[64:79]
    s_waitcnt vmcnt(15)
    s_nop 7
    s_nop 3
    v_add_f32 v48, v48, v64
    v_add_f32 v49, v49, v65
    v_add_f32 v50, v50, v66
    v_add_f32 v51, v51, v67
    v_add_f32 v52, v52, v68
    v_add_f32 v53, v53, v69
    v_add_f32 v54, v54, v70
    v_add_f32 v55, v55, v71
    v_add_f32 v56, v56, v72
    v_add_f32 v57, v57, v73
    v_add_f32 v58, v58, v74
    v_add_f32 v59, v59, v75
    v_add_f32 v60, v60, v76
    v_add_f32 v61, v61, v77
    v_add_f32 v62, v62, v78
    v_add_f32 v63, v63, v79
    s_add_u32 s26, s19, 226492416
    v_cvt_pk_bf16_f32 v80, v48, v49
    v_cvt_pk_bf16_f32 v81, v50, v51
    v_cvt_pk_bf16_f32 v82, v52, v53
    v_cvt_pk_bf16_f32 v83, v54, v55
    s_nop 1
    v_permlane32_swap_b32 v80, v82
    v_permlane32_swap_b32 v81, v83
    s_nop 1
    v_lshlrev_b32 v88, 16, v80
    v_and_b32 v89, 0xffff0000, v80
    v_lshlrev_b32 v90, 16, v104
    v_and_b32 v91, 0xffff0000, v104
    v_add_f32 v88, v88, v90
    v_add_f32 v89, v89, v91
    v_cvt_pk_bf16_f32 v80, v88, v89
    v_lshlrev_b32 v92, 16, v81
    v_and_b32 v93, 0xffff0000, v81
    v_lshlrev_b32 v94, 16, v105
    v_and_b32 v95, 0xffff0000, v105
    v_add_f32 v92, v92, v94
    v_add_f32 v93, v93, v95
    v_cvt_pk_bf16_f32 v81, v92, v93
    v_lshlrev_b32 v88, 16, v82
    v_and_b32 v89, 0xffff0000, v82
    v_lshlrev_b32 v90, 16, v106
    v_and_b32 v91, 0xffff0000, v106
    v_add_f32 v88, v88, v90
    v_add_f32 v89, v89, v91
    v_cvt_pk_bf16_f32 v82, v88, v89
    v_lshlrev_b32 v92, 16, v83
    v_and_b32 v93, 0xffff0000, v83
    v_lshlrev_b32 v94, 16, v107
    v_and_b32 v95, 0xffff0000, v107
    v_add_f32 v92, v92, v94
    v_add_f32 v93, v93, v95
    v_cvt_pk_bf16_f32 v83, v92, v93
    buffer_store_dwordx4 v[80:83], v3, s[8:11], s26 offen offset:0 sc1
    v_cvt_pk_bf16_f32 v84, v56, v57
    v_cvt_pk_bf16_f32 v85, v58, v59
    v_cvt_pk_bf16_f32 v86, v60, v61
    v_cvt_pk_bf16_f32 v87, v62, v63
    s_nop 1
    v_permlane32_swap_b32 v84, v86
    v_permlane32_swap_b32 v85, v87
    s_nop 1
    v_lshlrev_b32 v88, 16, v84
    v_and_b32 v89, 0xffff0000, v84
    v_lshlrev_b32 v90, 16, v108
    v_and_b32 v91, 0xffff0000, v108
    v_add_f32 v88, v88, v90
    v_add_f32 v89, v89, v91
    v_cvt_pk_bf16_f32 v84, v88, v89
    v_lshlrev_b32 v92, 16, v85
    v_and_b32 v93, 0xffff0000, v85
    v_lshlrev_b32 v94, 16, v109
    v_and_b32 v95, 0xffff0000, v109
    v_add_f32 v92, v92, v94
    v_add_f32 v93, v93, v95
    v_cvt_pk_bf16_f32 v85, v92, v93
    v_lshlrev_b32 v88, 16, v86
    v_and_b32 v89, 0xffff0000, v86
    v_lshlrev_b32 v90, 16, v110
    v_and_b32 v91, 0xffff0000, v110
    v_add_f32 v88, v88, v90
    v_add_f32 v89, v89, v91
    v_cvt_pk_bf16_f32 v86, v88, v89
    v_lshlrev_b32 v92, 16, v87
    v_and_b32 v93, 0xffff0000, v87
    v_lshlrev_b32 v94, 16, v111
    v_and_b32 v95, 0xffff0000, v111
    v_add_f32 v92, v92, v94
    v_add_f32 v93, v93, v95
    v_cvt_pk_bf16_f32 v87, v92, v93
    buffer_store_dwordx4 v[84:87], v3, s[8:11], s26 offen offset:32 sc1
    s_waitcnt vmcnt(15)
    s_mov_b64 exec, 1
    s_add_u32 s26, s48, s20
    buffer_store_dword v5, v4, s[8:11], s26 offen sc1
    s_mov_b64 exec, -1
    s_add_u32 s20, s20, 128
    s_add_u32 s19, s19, 40960
    s_add_u32 s16, s16, 40960
    s_cmp_eq_u32 s16, 122880
    s_cselect_b32 s16, 0, s16
    s_add_u32 s14, s14, 1
    s_cmp_ge_u32 s14, s15
    s_cbranch_scc1 layerb1_kernel_ab_fin
    s_barrier
    v_add_u32 v2, s16, v1
    ds_read_b128 v[16:19], v2 offset:0
    ds_read_b128 v[20:23], v2 offset:1024
    ds_read_b128 v[24:27], v2 offset:2048
    ds_read_b128 v[28:31], v2 offset:3072
    ds_read_b128 v[32:35], v2 offset:4096
    ds_read_b128 v[36:39], v2 offset:5120
    s_add_u32 s27, s19, 40960
    s_cmp_ge_u32 s14, 63
    s_cselect_b32 s27, s19, s27
    buffer_load_dwordx4 v[104:107], v3, s[52:55], s27 offen offset:0
    buffer_load_dwordx4 v[108:111], v3, s[52:55], s27 offen offset:32
    s_add_u32 s23, s14, 2
    s_min_u32 s24, s23, 63
    s_mul_i32 s24, s24, 40960
    s_add_u32 s24, s24, s18
    s_mul_i32 s25, s13, 10240
    s_add_u32 s25, s25, s17
    s_add_u32 s17, s17, 40960
    s_cmp_eq_u32 s17, 122880
    s_cselect_b32 s17, 0, s17
    ds_read_b128 v[40:43], v2 offset:6144
    s_waitcnt lgkmcnt(6)
    v_mfma_f32_32x32x16_bf16 v[48:63], a[0:3], v[16:19], 0
    ds_read_b128 v[44:47], v2 offset:7168
    s_waitcnt lgkmcnt(6)
    v_mfma_f32_32x32x16_bf16 v[64:79], a[4:7], v[20:23], 0
    s_mov_b32 m0, s25
    s_nop 0
    buffer_load_dwordx4 v1, s[8:11], s24 offen offset:0 lds
    ds_read_b128 v[16:19], v2 offset:8192
    s_waitcnt lgkmcnt(6)
    v_mfma_f32_32x32x16_bf16 v[48:63], a[8:11], v[24:27], v[48:63]
    ds_read_b128 v[20:23], v2 offset:9216
    s_waitcnt lgkmcnt(6)
    v_mfma_f32_32x32x16_bf16 v[64:79], a[12:15], v[28:31], v[64:79]
    ds_read_b128 v[24:27], v2 offset:10240
    s_waitcnt lgkmcnt(6)
    v_mfma_f32_32x32x16_bf16 v[48:63], a[16:19], v[32:35], v[48:63]
    buffer_load_dwordx4 v1, s[8:11], s24 offen offset:1024 lds
    ds_read_b128 v[28:31], v2 offset:11264
    s_waitcnt lgkmcnt(6)
    v_mfma_f32_32x32x16_bf16 v[64:79], a[20:23], v[36:39], v[64:79]
    ds_read_b128 v[32:35], v2 offset:12288
    s_waitcnt lgkmcnt(6)
    v_mfma_f32_32x32x16_bf16 v[48:63], a[24:27], v[40:43], v[48:63]
    ds_read_b128 v[36:39], v2 offset:13312
    s_waitcnt lgkmcnt(6)
    v_mfma_f32_32x32x16_bf16 v[64:79], a[28:31], v[44:47], v[64:79]
    buffer_load_dwordx4 v1, s[8:11], s24 offen offset:2048 lds
    ds_read_b128 v[40:43], v2 offset:14336
    s_waitcnt lgkmcnt(6)
    v_mfma_f32_32x32x16_bf16 v[48:63], a[32:35], v[16:19], v[48:63]
    ds_read_b128 v[44:47], v2 offset:15360
    s_waitcnt lgkmcnt(6)
    v_mfma_f32_32x32x16_bf16 v[64:79], a[36:39], v[20:23], v[64:79]
    ds_read_b128 v[16:19], v2 offset:16384
    s_waitcnt lgkmcnt(6)
    v_mfma_f32_32x32x16_bf16 v[48:63], a[40:43], v[24:27], v[48:63]
    buffer_load_dwordx4 v1, s[8:11], s24 offen offset:3072 lds
    ds_read_b128 v[20:23], v2 offset:17408
    s_waitcnt lgkmcnt(6)
    v_mfma_f32_32x32x16_bf16 v[64:79], a[44:47], v[28:31], v[64:79]
    ds_read_b128 v[24:27], v2 offset:18432
    s_waitcnt lgkmcnt(6)
    v_mfma_f32_32x32x16_bf16 v[48:63], a[48:51], v[32:35], v[48:63]
    ds_read_b128 v[28:31], v2 offset:19456
    s_waitcnt lgkmcnt(6)
    v_mfma_f32_32x32x16_bf16 v[64:79], a[52:55], v[36:39], v[64:79]
    s_add_u32 s24, s24, 4096
    s_add_u32 s25, s25, 4096
    s_mov_b32 m0, s25
    s_nop 0
    buffer_load_dwordx4 v1, s[8:11], s24 offen offset:0 lds
    ds_read_b128 v[32:35], v2 offset:20480
    s_waitcnt lgkmcnt(6)
    v_mfma_f32_32x32x16_bf16 v[48:63], a[56:59], v[40:43], v[48:63]
    ds_read_b128 v[36:39], v2 offset:21504
    s_waitcnt lgkmcnt(6)
    v_mfma_f32_32x32x16_bf16 v[64:79], a[60:63], v[44:47], v[64:79]
    ds_read_b128 v[40:43], v2 offset:22528
    s_waitcnt lgkmcnt(6)
    v_mfma_f32_32x32x16_bf16 v[48:63], a[64:67], v[16:19], v[48:63]
    buffer_load_dwordx4 v1, s[8:11], s24 offen offset:1024 lds
    ds_read_b128 v[44:47], v2 offset:23552
    s_waitcnt lgkmcnt(6)
    v_mfma_f32_32x32x16_bf16 v[64:79], a[68:71], v[20:23], v[64:79]
    ds_read_b128 v[16:19], v2 offset:24576
    s_waitcnt lgkmcnt(6)
    v_mfma_f32_32x32x16_bf16 v[48:63], a[72:75], v[24:27], v[48:63]
    ds_read_b128 v[20:23], v2 offset:25600
    s_waitcnt lgkmcnt(6)
    v_mfma_f32_32x32x16_bf16 v[64:79], a[76:79], v[28:31], v[64:79]
    buffer_load_dwordx4 v1, s[8:11], s24 offen offset:2048 lds
    ds_read_b128 v[24:27], v2 offset:26624
    s_waitcnt lgkmcnt(6)
    v_mfma_f32_32x32x16_bf16 v[48:63], a[80:83], v[32:35], v[48:63]
    ds_read_b128 v[28:31], v2 offset:27648
    s_waitcnt lgkmcnt(6)
    v_mfma_f32_32x32x16_bf16 v[64:79], a[84:87], v[36:39], v[64:79]
    ds_read_b128 v[32:35], v2 offset:28672
    s_waitcnt lgkmcnt(6)
    v_mfma_f32_32x32x16_bf16 v[48:63], a[88:91], v[40:43], v[48:63]
    buffer_load_dwordx4 v1, s[8:11], s24 offen offset:3072 lds
    ds_read_b128 v[36:39], v2 offset:29696
    s_waitcnt lgkmcnt(6)
    v_mfma_f32_32x32x16_bf16 v[64:79], a[92:95], v[44:47], v[64:79]
    ds_read_b128 v[40:43], v2 offset:30720
    s_waitcnt lgkmcnt(6)
    v_mfma_f32_32x32x16_bf16 v[48:63], a[96:99], v[16:19], v[48:63]
    ds_read_b128 v[44:47], v2 offset:31744
    s_waitcnt lgkmcnt(6)
    v_mfma_f32_32x32x16_bf16 v[64:79], a[100:103], v[20:23], v[64:79]
    s_add_u32 s24, s24, 4096
    s_add_u32 s25, s25, 4096
    s_mov_b32 m0, s25
    s_nop 0
    buffer_load_dwordx4 v1, s[8:11], s24 offen offset:0 lds
    ds_read_b128 v[16:19], v2 offset:32768
    s_waitcnt lgkmcnt(6)
    v_mfma_f32_32x32x16_bf16 v[48:63], a[104:107], v[24:27], v[48:63]
    ds_read_b128 v[20:23], v2 offset:33792
    s_waitcnt lgkmcnt(6)
    v_mfma_f32_32x32x16_bf16 v[64:79], a[108:111], v[28:31], v[64:79]
    ds_read_b128 v[24:27], v2 offset:34816
    s_waitcnt lgkmcnt(6)
    v_mfma_f32_32x32x16_bf16 v[48:63], a[112:115], v[32:35], v[48:63]
    buffer_load_dwordx4 v1, s[8:11], s24 offen offset:1024 lds
    ds_read_b128 v[28:31], v2 offset:35840
    s_waitcnt lgkmcnt(6)
    v_mfma_f32_32x32x16_bf16 v[64:79], a[116:119], v[36:39], v[64:79]
    ds_read_b128 v[32:35], v2 offset:36864
    s_waitcnt lgkmcnt(6)
    v_mfma_f32_32x32x16_bf16 v[48:63], a[120:123], v[40:43], v[48:63]
    ds_read_b128 v[36:39], v2 offset:37888
    s_waitcnt lgkmcnt(6)
    v_mfma_f32_32x32x16_bf16 v[64:79], a[124:127], v[44:47], v[64:79]
    ds_read_b128 v[40:43], v2 offset:38912
    s_waitcnt lgkmcnt(6)
    v_mfma_f32_32x32x16_bf16 v[48:63], a[128:131], v[16:19], v[48:63]
    ds_read_b128 v[44:47], v2 offset:39936
    s_waitcnt lgkmcnt(6)
    v_mfma_f32_32x32x16_bf16 v[64:79], a[132:135], v[20:23], v[64:79]
    s_waitcnt lgkmcnt(5)
    v_mfma_f32_32x32x16_bf16 v[48:63], a[136:139], v[24:27], v[48:63]
    s_waitcnt lgkmcnt(4)
    v_mfma_f32_32x32x16_bf16 v[64:79], a[140:143], v[28:31], v[64:79]
    s_waitcnt lgkmcnt(3)
    v_mfma_f32_32x32x16_bf16 v[48:63], a[144:147], v[32:35], v[48:63]
    s_waitcnt lgkmcnt(2)
    v_mfma_f32_32x32x16_bf16 v[64:79], a[148:151], v[36:39], v[64:79]
    s_waitcnt lgkmcnt(1)
    v_mfma_f32_32x32x16_bf16 v[48:63], a[152:155], v[40:43], v[48:63]
    s_waitcnt lgkmcnt(0)
    v_mfma_f32_32x32x16_bf16 v[64:79], a[156:159], v[44:47], v[64:79]
    s_waitcnt vmcnt(15)
    s_nop 7
    s_nop 3
    v_add_f32 v48, v48, v64
    v_add_f32 v49, v49, v65
    v_add_f32 v50, v50, v66
    v_add_f32 v51, v51, v67
    v_add_f32 v52, v52, v68
    v_add_f32 v53, v53, v69
    v_add_f32 v54, v54, v70
    v_add_f32 v55, v55, v71
    v_add_f32 v56, v56, v72
    v_add_f32 v57, v57, v73
    v_add_f32 v58, v58, v74
    v_add_f32 v59, v59, v75
    v_add_f32 v60, v60, v76
    v_add_f32 v61, v61, v77
    v_add_f32 v62, v62, v78
    v_add_f32 v63, v63, v79
    s_add_u32 s26, s19, 226492416
    v_cvt_pk_bf16_f32 v80, v48, v49
    v_cvt_pk_bf16_f32 v81, v50, v51
    v_cvt_pk_bf16_f32 v82, v52, v53
    v_cvt_pk_bf16_f32 v83, v54, v55
    s_nop 1
    v_permlane32_swap_b32 v80, v82
    v_permlane32_swap_b32 v81, v83
    s_nop 1
    v_lshlrev_b32 v88, 16, v80
    v_and_b32 v89, 0xffff0000, v80
    v_lshlrev_b32 v90, 16, v96
    v_and_b32 v91, 0xffff0000, v96
    v_add_f32 v88, v88, v90
    v_add_f32 v89, v89, v91
    v_cvt_pk_bf16_f32 v80, v88, v89
    v_lshlrev_b32 v92, 16, v81
    v_and_b32 v93, 0xffff0000, v81
    v_lshlrev_b32 v94, 16, v97
    v_and_b32 v95, 0xffff0000, v97
    v_add_f32 v92, v92, v94
    v_add_f32 v93, v93, v95
    v_cvt_pk_bf16_f32 v81, v92, v93
    v_lshlrev_b32 v88, 16, v82
    v_and_b32 v89, 0xffff0000, v82
    v_lshlrev_b32 v90, 16, v98
    v_and_b32 v91, 0xffff0000, v98
    v_add_f32 v88, v88, v90
    v_add_f32 v89, v89, v91
    v_cvt_pk_bf16_f32 v82, v88, v89
    v_lshlrev_b32 v92, 16, v83
    v_and_b32 v93, 0xffff0000, v83
    v_lshlrev_b32 v94, 16, v99
    v_and_b32 v95, 0xffff0000, v99
    v_add_f32 v92, v92, v94
    v_add_f32 v93, v93, v95
    v_cvt_pk_bf16_f32 v83, v92, v93
    buffer_store_dwordx4 v[80:83], v3, s[8:11], s26 offen offset:0 sc1
    v_cvt_pk_bf16_f32 v84, v56, v57
    v_cvt_pk_bf16_f32 v85, v58, v59
    v_cvt_pk_bf16_f32 v86, v60, v61
    v_cvt_pk_bf16_f32 v87, v62, v63
    s_nop 1
    v_permlane32_swap_b32 v84, v86
    v_permlane32_swap_b32 v85, v87
    s_nop 1
    v_lshlrev_b32 v88, 16, v84
    v_and_b32 v89, 0xffff0000, v84
    v_lshlrev_b32 v90, 16, v100
    v_and_b32 v91, 0xffff0000, v100
    v_add_f32 v88, v88, v90
    v_add_f32 v89, v89, v91
    v_cvt_pk_bf16_f32 v84, v88, v89
    v_lshlrev_b32 v92, 16, v85
    v_and_b32 v93, 0xffff0000, v85
    v_lshlrev_b32 v94, 16, v101
    v_and_b32 v95, 0xffff0000, v101
    v_add_f32 v92, v92, v94
    v_add_f32 v93, v93, v95
    v_cvt_pk_bf16_f32 v85, v92, v93
    v_lshlrev_b32 v88, 16, v86
    v_and_b32 v89, 0xffff0000, v86
    v_lshlrev_b32 v90, 16, v102
    v_and_b32 v91, 0xffff0000, v102
    v_add_f32 v88, v88, v90
    v_add_f32 v89, v89, v91
    v_cvt_pk_bf16_f32 v86, v88, v89
    v_lshlrev_b32 v92, 16, v87
    v_and_b32 v93, 0xffff0000, v87
    v_lshlrev_b32 v94, 16, v103
    v_and_b32 v95, 0xffff0000, v103
    v_add_f32 v92, v92, v94
    v_add_f32 v93, v93, v95
    v_cvt_pk_bf16_f32 v87, v92, v93
    buffer_store_dwordx4 v[84:87], v3, s[8:11], s26 offen offset:32 sc1
    s_waitcnt vmcnt(15)
    s_mov_b64 exec, 1
    s_add_u32 s26, s48, s20
    buffer_store_dword v5, v4, s[8:11], s26 offen sc1
    s_mov_b64 exec, -1
    s_add_u32 s20, s20, 128
    s_add_u32 s19, s19, 40960
    s_add_u32 s16, s16, 40960
    s_cmp_eq_u32 s16, 122880
    s_cselect_b32 s16, 0, s16
    s_add_u32 s14, s14, 1
    s_cmp_lt_u32 s14, s15
    s_cbranch_scc1 layerb1_kernel_ab_loop
layerb1_kernel_ab_fin:
    s_waitcnt vmcnt(0) lgkmcnt(0)
    s_mov_b64 exec, 1
    s_add_u32 s26, s48, s20
    buffer_store_dword v5, v4, s[8:11], s26 offen sc1
    s_mov_b64 exec, -1
    s_add_u32 s20, s20, 128
    s_barrier
    s_branch layerb1_kernel_w3
layerb1_kernel_sp_ln:
    s_sub_u32 s12, s22, 5
    s_mov_b32 s14, s12
    s_mov_b32 s16, 0x3f803f80
    v_lshrrev_b32 v6, 3, v0
    v_and_b32 v7, 7, v0
    v_mul_u32_u24 v1, 1280, v6
    v_lshl_add_u32 v1, v7, 5, v1
    v_lshlrev_b32 v2, 10, v7
    v_lshl_add_u32 v2, v6, 4, v2
    v_lshlrev_b32 v3, 2, v0
    v_mov_b32 v4, 1
layerb1_kernel_ln_seg:
    s_lshl_b32 s17, s14, 7
    s_add_u32 s17, s17, s48
    s_add_u32 s17, s17, 36864
    s_mov_b64 exec, 0xfffff
layerb1_kernel_ln_poll:
    buffer_load_dword v5, v3, s[8:11], s17 offen sc1
    s_waitcnt vmcnt(0)
    v_cmp_eq_u32 vcc, 0, v5
    s_sub_u32 s15, s15, 1
    s_cbranch_scc1 layerb1_kernel_bail
    s_cbranch_vccnz layerb1_kernel_ln_poll
    s_mov_b64 exec, -1
    s_lshl_b32 s18, s14, 5
    s_lshl_b32 s19, s13, 3
    s_add_u32 s18, s18, s19
    s_mul_i32 s18, s18, 1280
    s_add_u32 s18, s18, 226492416
    buffer_load_dwordx4 v[16:19], v1, s[8:11], s18 offen offset:0 sc1
    buffer_load_dwordx4 v[20:23], v1, s[8:11], s18 offen offset:16 sc1
    buffer_load_dwordx4 v[24:27], v1, s[8:11], s18 offen offset:256 sc1
    buffer_load_dwordx4 v[28:31], v1, s[8:11], s18 offen offset:272 sc1
    buffer_load_dwordx4 v[32:35], v1, s[8:11], s18 offen offset:512 sc1
    buffer_load_dwordx4 v[36:39], v1, s[8:11], s18 offen offset:528 sc1
    buffer_load_dwordx4 v[40:43], v1, s[8:11], s18 offen offset:768 sc1
    buffer_load_dwordx4 v[44:47], v1, s[8:11], s18 offen offset:784 sc1
    buffer_load_dwordx4 v[48:51], v1, s[8:11], s18 offen offset:1024 sc1
    buffer_load_dwordx4 v[52:55], v1, s[8:11], s18 offen offset:1040 sc1
    v_mov_b32 v8, 0
    v_mov_b32 v9, 0
    v_mov_b32 v10, 0
    v_mov_b32 v11, 0
    s_waitcnt vmcnt(9)
    v_dot2c_f32_bf16 v8, s16, v16
    v_dot2c_f32_bf16 v10, v16, v16
    v_dot2c_f32_bf16 v9, s16, v17
    v_dot2c_f32_bf16 v11, v17, v17
    v_dot2c_f32_bf16 v8, s16, v18
    v_dot2c_f32_bf16 v10, v18, v18
    v_dot2c_f32_bf16 v9, s16, v19
    v_dot2c_f32_bf16 v11, v19, v19
    s_waitcnt vmcnt(8)
    v_dot2c_f32_bf16 v8, s16, v20
    v_dot2c_f32_bf16 v10, v20, v20
    v_dot2c_f32_bf16 v9, s16, v21
    v_dot2c_f32_bf16 v11, v21, v21
    v_dot2c_f32_bf16 v8, s16, v22
    v_dot2c_f32_bf16 v10, v22, v22
    v_dot2c_f32_bf16 v9, s16, v23
    v_dot2c_f32_bf16 v11, v23, v23
    s_waitcnt vmcnt(7)
    v_dot2c_f32_bf16 v8, s16, v24
    v_dot2c_f32_bf16 v10, v24, v24
    v_dot2c_f32_bf16 v9, s16, v25
    v_dot2c_f32_bf16 v11, v25, v25
    v_dot2c_f32_bf16 v8, s16, v26
    v_dot2c_f32_bf16 v10, v26, v26
    v_dot2c_f32_bf16 v9, s16, v27
    v_dot2c_f32_bf16 v11, v27, v27
    s_waitcnt vmcnt(6)
    v_dot2c_f32_bf16 v8, s16, v28
    v_dot2c_f32_bf16 v10, v28, v28
    v_dot2c_f32_bf16 v9, s16, v29
    v_dot2c_f32_bf16 v11, v29, v29
    v_dot2c_f32_bf16 v8, s16, v30
    v_dot2c_f32_bf16 v10, v30, v30
    v_dot2c_f32_bf16 v9, s16, v31
    v_dot2c_f32_bf16 v11, v31, v31
    s_waitcnt vmcnt(5)
    v_dot2c_f32_bf16 v8, s16, v32
    v_dot2c_f32_bf16 v10, v32, v32
    v_dot2c_f32_bf16 v9, s16, v33
    v_dot2c_f32_bf16 v11, v33, v33
    v_dot2c_f32_bf16 v8, s16, v34
    v_dot2c_f32_bf16 v10, v34, v34
    v_dot2c_f32_bf16 v9, s16, v35
    v_dot2c_f32_bf16 v11, v35, v35
    s_waitcnt vmcnt(4)
    v_dot2c_f32_bf16 v8, s16, v36
    v_dot2c_f32_bf16 v10, v36, v36
    v_dot2c_f32_bf16 v9, s16, v37
    v_dot2c_f32_bf16 v11, v37, v37
    v_dot2c_f32_bf16 v8, s16, v38
    v_dot2c_f32_bf16 v10, v38, v38
    v_dot2c_f32_bf16 v9, s16, v39
    v_dot2c_f32_bf16 v11, v39, v39
    s_waitcnt vmcnt(3)
    v_dot2c_f32_bf16 v8, s16, v40
    v_dot2c_f32_bf16 v10, v40, v40
    v_dot2c_f32_bf16 v9, s16, v41
    v_dot2c_f32_bf16 v11, v41, v41
    v_dot2c_f32_bf16 v8, s16, v42
    v_dot2c_f32_bf16 v10, v42, v42
    v_dot2c_f32_bf16 v9, s16, v43
    v_dot2c_f32_bf16 v11, v43, v43
    s_waitcnt vmcnt(2)
    v_dot2c_f32_bf16 v8, s16, v44
    v_dot2c_f32_bf16 v10, v44, v44
    v_dot2c_f32_bf16 v9, s16, v45
    v_dot2c_f32_bf16 v11, v45, v45
    v_dot2c_f32_bf16 v8, s16, v46
    v_dot2c_f32_bf16 v10, v46, v46
    v_dot2c_f32_bf16 v9, s16, v47
    v_dot2c_f32_bf16 v11, v47, v47
    s_waitcnt vmcnt(1)
    v_dot2c_f32_bf16 v8, s16, v48
    v_dot2c_f32_bf16 v10, v48, v48
    v_dot2c_f32_bf16 v9, s16, v49
    v_dot2c_f32_bf16 v11, v49, v49
    v_dot2c_f32_bf16 v8, s16, v50
    v_dot2c_f32_bf16 v10, v50, v50
    v_dot2c_f32_bf16 v9, s16, v51
    v_dot2c_f32_bf16 v11, v51, v51
    s_waitcnt vmcnt(0)
    v_dot2c_f32_bf16 v8, s16, v52
    v_dot2c_f32_bf16 v10, v52, v52
    v_dot2c_f32_bf16 v9, s16, v53
    v_dot2c_f32_bf16 v11, v53, v53
    v_dot2c_f32_bf16 v8, s16, v54
    v_dot2c_f32_bf16 v10, v54, v54
    v_dot2c_f32_bf16 v9, s16, v55
    v_dot2c_f32_bf16 v11, v55, v55
    s_nop 3
    v_add_f32 v8, v8, v9
    v_add_f32 v10, v10, v11
    s_nop 1
    v_add_f32_dpp v8, v8, v8 quad_perm:[1,0,3,2] row_mask:0xf bank_mask:0xf
    v_add_f32_dpp v10, v10, v10 quad_perm:[1,0,3,2] row_mask:0xf bank_mask:0xf
    s_nop 1
    v_add_f32_dpp v8, v8, v8 quad_perm:[2,3,0,1] row_mask:0xf bank_mask:0xf
    v_add_f32_dpp v10, v10, v10 quad_perm:[2,3,0,1] row_mask:0xf bank_mask:0xf
    s_nop 1
    v_add_f32_dpp v8, v8, v8 row_half_mirror row_mask:0xf bank_mask:0xf
    v_add_f32_dpp v10, v10, v10 row_half_mirror row_mask:0xf bank_mask:0xf
    v_mul_f32 v8, 0x3acccccd, v8
    v_mul_f32 v9, v8, v8
    v_mul_f32 v10, 0x3acccccd, v10
    v_sub_f32 v10, v10, v9
    v_max_f32 v10, 0, v10
    v_add_f32 v10, 0x3727c5ac, v10
    v_rsq_f32 v10, v10
    s_nop 0
    v_mul_f32 v8, v8, v10
    v_sub_f32 v8, 0, v8
    s_mul_i32 s18, s14, 40960
    s_lshl_b32 s19, s13, 7
    s_add_u32 s18, s18, s19
    s_add_u32 s18, s18, 220200960
    v_lshlrev_b32 v64, 16, v16
    v_and_b32 v65, 0xffff0000, v16
    v_fma_f32 v64, v64, v10, v8
    v_fma_f32 v65, v65, v10, v8
    v_cvt_pk_bf16_f32 v72, v64, v65
    v_lshlrev_b32 v66, 16, v17
    v_and_b32 v67, 0xffff0000, v17
    v_fma_f32 v66, v66, v10, v8
    v_fma_f32 v67, v67, v10, v8
    v_cvt_pk_bf16_f32 v74, v66, v67
    v_lshlrev_b32 v68, 16, v18
    v_and_b32 v69, 0xffff0000, v18
    v_fma_f32 v68, v68, v10, v8
    v_fma_f32 v69, v69, v10, v8
    v_cvt_pk_bf16_f32 v76, v68, v69
    v_lshlrev_b32 v70, 16, v19
    v_and_b32 v71, 0xffff0000, v19
    v_fma_f32 v70, v70, v10, v8
    v_fma_f32 v71, v71, v10, v8
    v_cvt_pk_bf16_f32 v78, v70, v71
    v_lshlrev_b32 v64, 16, v20
    v_and_b32 v65, 0xffff0000, v20
    v_fma_f32 v64, v64, v10, v8
    v_fma_f32 v65, v65, v10, v8
    v_cvt_pk_bf16_f32 v73, v64, v65
    v_lshlrev_b32 v66, 16, v21
    v_and_b32 v67, 0xffff0000, v21
    v_fma_f32 v66, v66, v10, v8
    v_fma_f32 v67, v67, v10, v8
    v_cvt_pk_bf16_f32 v75, v66, v67
    v_lshlrev_b32 v68, 16, v22
    v_and_b32 v69, 0xffff0000, v22
    v_fma_f32 v68, v68, v10, v8
    v_fma_f32 v69, v69, v10, v8
    v_cvt_pk_bf16_f32 v77, v68, v69
    v_lshlrev_b32 v70, 16, v23
    v_and_b32 v71, 0xffff0000, v23
    v_fma_f32 v70, v70, v10, v8
    v_fma_f32 v71, v71, v10, v8
    v_cvt_pk_bf16_f32 v79, v70, v71
    buffer_store_dwordx4 v[72:75], v2, s[8:11], s18 offen offset:0 sc1
    buffer_store_dwordx4 v[76:79], v2, s[8:11], s18 offen offset:512 sc1
    s_add_u32 s18, s18, 8192
    v_lshlrev_b32 v64, 16, v24
    v_and_b32 v65, 0xffff0000, v24
    v_fma_f32 v64, v64, v10, v8
    v_fma_f32 v65, v65, v10, v8
    v_cvt_pk_bf16_f32 v80, v64, v65
    v_lshlrev_b32 v66, 16, v25
    v_and_b32 v67, 0xffff0000, v25
    v_fma_f32 v66, v66, v10, v8
    v_fma_f32 v67, v67, v10, v8
    v_cvt_pk_bf16_f32 v82, v66, v67
    v_lshlrev_b32 v68, 16, v26
    v_and_b32 v69, 0xffff0000, v26
    v_fma_f32 v68, v68, v10, v8
    v_fma_f32 v69, v69, v10, v8
    v_cvt_pk_bf16_f32 v84, v68, v69
    v_lshlrev_b32 v70, 16, v27
    v_and_b32 v71, 0xffff0000, v27
    v_fma_f32 v70, v70, v10, v8
    v_fma_f32 v71, v71, v10, v8
    v_cvt_pk_bf16_f32 v86, v70, v71
    v_lshlrev_b32 v64, 16, v28
    v_and_b32 v65, 0xffff0000, v28
    v_fma_f32 v64, v64, v10, v8
    v_fma_f32 v65, v65, v10, v8
    v_cvt_pk_bf16_f32 v81, v64, v65
    v_lshlrev_b32 v66, 16, v29
    v_and_b32 v67, 0xffff0000, v29
    v_fma_f32 v66, v66, v10, v8
    v_fma_f32 v67, v67, v10, v8
    v_cvt_pk_bf16_f32 v83, v66, v67
    v_lshlrev_b32 v68, 16, v30
    v_and_b32 v69, 0xffff0000, v30
    v_fma_f32 v68, v68, v10, v8
    v_fma_f32 v69, v69, v10, v8
    v_cvt_pk_bf16_f32 v85, v68, v69
    v_lshlrev_b32 v70, 16, v31
    v_and_b32 v71, 0xffff0000, v31
    v_fma_f32 v70, v70, v10, v8
    v_fma_f32 v71, v71, v10, v8
    v_cvt_pk_bf16_f32 v87, v70, v71
    buffer_store_dwordx4 v[80:83], v2, s[8:11], s18 offen offset:0 sc1
    buffer_store_dwordx4 v[84:87], v2, s[8:11], s18 offen offset:512 sc1
    s_add_u32 s18, s18, 8192
    v_lshlrev_b32 v64, 16, v32
    v_and_b32 v65, 0xffff0000, v32
    v_fma_f32 v64, v64, v10, v8
    v_fma_f32 v65, v65, v10, v8
    v_cvt_pk_bf16_f32 v72, v64, v65
    v_lshlrev_b32 v66, 16, v33
    v_and_b32 v67, 0xffff0000, v33
    v_fma_f32 v66, v66, v10, v8
    v_fma_f32 v67, v67, v10, v8
    v_cvt_pk_bf16_f32 v74, v66, v67
    v_lshlrev_b32 v68, 16, v34
    v_and_b32 v69, 0xffff0000, v34
    v_fma_f32 v68, v68, v10, v8
    v_fma_f32 v69, v69, v10, v8
    v_cvt_pk_bf16_f32 v76, v68, v69
    v_lshlrev_b32 v70, 16, v35
    v_and_b32 v71, 0xffff0000, v35
    v_fma_f32 v70, v70, v10, v8
    v_fma_f32 v71, v71, v10, v8
    v_cvt_pk_bf16_f32 v78, v70, v71
    v_lshlrev_b32 v64, 16, v36
    v_and_b32 v65, 0xffff0000, v36
    v_fma_f32 v64, v64, v10, v8
    v_fma_f32 v65, v65, v10, v8
    v_cvt_pk_bf16_f32 v73, v64, v65
    v_lshlrev_b32 v66, 16, v37
    v_and_b32 v67, 0xffff0000, v37
    v_fma_f32 v66, v66, v10, v8
    v_fma_f32 v67, v67, v10, v8
    v_cvt_pk_bf16_f32 v75, v66, v67
    v_lshlrev_b32 v68, 16, v38
    v_and_b32 v69, 0xffff0000, v38
    v_fma_f32 v68, v68, v10, v8
    v_fma_f32 v69, v69, v10, v8
    v_cvt_pk_bf16_f32 v77, v68, v69
    v_lshlrev_b32 v70, 16, v39
    v_and_b32 v71, 0xffff0000, v39
    v_fma_f32 v70, v70, v10, v8
    v_fma_f32 v71, v71, v10, v8
    v_cvt_pk_bf16_f32 v79, v70, v71
    buffer_store_dwordx4 v[72:75], v2, s[8:11], s18 offen offset:0 sc1
    buffer_store_dwordx4 v[76:79], v2, s[8:11], s18 offen offset:512 sc1
    s_add_u32 s18, s18, 8192
    v_lshlrev_b32 v64, 16, v40
    v_and_b32 v65, 0xffff0000, v40
    v_fma_f32 v64, v64, v10, v8
    v_fma_f32 v65, v65, v10, v8
    v_cvt_pk_bf16_f32 v80, v64, v65
    v_lshlrev_b32 v66, 16, v41
    v_and_b32 v67, 0xffff0000, v41
    v_fma_f32 v66, v66, v10, v8
    v_fma_f32 v67, v67, v10, v8
    v_cvt_pk_bf16_f32 v82, v66, v67
    v_lshlrev_b32 v68, 16, v42
    v_and_b32 v69, 0xffff0000, v42
    v_fma_f32 v68, v68, v10, v8
    v_fma_f32 v69, v69, v10, v8
    v_cvt_pk_bf16_f32 v84, v68, v69
    v_lshlrev_b32 v70, 16, v43
    v_and_b32 v71, 0xffff0000, v43
    v_fma_f32 v70, v70, v10, v8
    v_fma_f32 v71, v71, v10, v8
    v_cvt_pk_bf16_f32 v86, v70, v71
    v_lshlrev_b32 v64, 16, v44
    v_and_b32 v65, 0xffff0000, v44
    v_fma_f32 v64, v64, v10, v8
    v_fma_f32 v65, v65, v10, v8
    v_cvt_pk_bf16_f32 v81, v64, v65
    v_lshlrev_b32 v66, 16, v45
    v_and_b32 v67, 0xffff0000, v45
    v_fma_f32 v66, v66, v10, v8
    v_fma_f32 v67, v67, v10, v8
    v_cvt_pk_bf16_f32 v83, v66, v67
    v_lshlrev_b32 v68, 16, v46
    v_and_b32 v69, 0xffff0000, v46
    v_fma_f32 v68, v68, v10, v8
    v_fma_f32 v69, v69, v10, v8
    v_cvt_pk_bf16_f32 v85, v68, v69
    v_lshlrev_b32 v70, 16, v47
    v_and_b32 v71, 0xffff0000, v47
    v_fma_f32 v70, v70, v10, v8
    v_fma_f32 v71, v71, v10, v8
    v_cvt_pk_bf16_f32 v87, v70, v71
    buffer_store_dwordx4 v[80:83], v2, s[8:11], s18 offen offset:0 sc1
    buffer_store_dwordx4 v[84:87], v2, s[8:11], s18 offen offset:512 sc1
    s_add_u32 s18, s18, 8192
    v_lshlrev_b32 v64, 16, v48
    v_and_b32 v65, 0xffff0000, v48
    v_fma_f32 v64, v64, v10, v8
    v_fma_f32 v65, v65, v10, v8
    v_cvt_pk_bf16_f32 v72, v64, v65
    v_lshlrev_b32 v66, 16, v49
    v_and_b32 v67, 0xffff0000, v49
    v_fma_f32 v66, v66, v10, v8
    v_fma_f32 v67, v67, v10, v8
    v_cvt_pk_bf16_f32 v74, v66, v67
    v_lshlrev_b32 v68, 16, v50
    v_and_b32 v69, 0xffff0000, v50
    v_fma_f32 v68, v68, v10, v8
    v_fma_f32 v69, v69, v10, v8
    v_cvt_pk_bf16_f32 v76, v68, v69
    v_lshlrev_b32 v70, 16, v51
    v_and_b32 v71, 0xffff0000, v51
    v_fma_f32 v70, v70, v10, v8
    v_fma_f32 v71, v71, v10, v8
    v_cvt_pk_bf16_f32 v78, v70, v71
    v_lshlrev_b32 v64, 16, v52
    v_and_b32 v65, 0xffff0000, v52
    v_fma_f32 v64, v64, v10, v8
    v_fma_f32 v65, v65, v10, v8
    v_cvt_pk_bf16_f32 v73, v64, v65
    v_lshlrev_b32 v66, 16, v53
    v_and_b32 v67, 0xffff0000, v53
    v_fma_f32 v66, v66, v10, v8
    v_fma_f32 v67, v67, v10, v8
    v_cvt_pk_bf16_f32 v75, v66, v67
    v_lshlrev_b32 v68, 16, v54
    v_and_b32 v69, 0xffff0000, v54
    v_fma_f32 v68, v68, v10, v8
    v_fma_f32 v69, v69, v10, v8
    v_cvt_pk_bf16_f32 v77, v68, v69
    v_lshlrev_b32 v70, 16, v55
    v_and_b32 v71, 0xffff0000, v55
    v_fma_f32 v70, v70, v10, v8
    v_fma_f32 v71, v71, v10, v8
    v_cvt_pk_bf16_f32 v79, v70, v71
    buffer_store_dwordx4 v[72:75], v2, s[8:11], s18 offen offset:0 sc1
    buffer_store_dwordx4 v[76:79], v2, s[8:11], s18 offen offset:512 sc1
    s_waitcnt vmcnt(0)
    s_lshl_b32 s17, s14, 4
    s_lshl_b32 s19, s13, 2
    s_add_u32 s17, s17, s19
    s_add_u32 s17, s17, s48
    s_add_u32 s17, s17, 45056
    v_mov_b32 v5, 0
    s_mov_b64 exec, 1
    buffer_store_dword v4, v5, s[8:11], s17 offen sc1
    s_mov_b64 exec, -1
    s_add_u32 s14, s14, 4
    s_cmp_lt_u32 s14, 64
    s_cbranch_scc1 layerb1_kernel_ln_seg
    s_waitcnt vmcnt(0)
    s_barrier
layerb1_kernel_w3:
    s_mov_b32 s15, 400000
layerb1_kernel_j_next:
    s_cmp_lg_u32 s13, 0
    s_cbranch_scc1 layerb1_kernel_j_rel
    s_mov_b64 exec, 1
    v_mov_b32 v2, 31744
    v_mov_b32 v3, 1
    buffer_atomic_add v3, v2, s[8:11], s48 offen sc0 sc1
    s_waitcnt vmcnt(0)
    s_mov_b64 exec, -1
    s_nop 0
    v_readfirstlane_b32 s38, v3
    s_cmp_ge_u32 s38, 1152
    s_cbranch_scc1 layerb1_kernel_j_pub
    s_mul_i32 s39, s38, 58255
    s_lshr_b32 s40, s39, 20
    s_mul_i32 s39, s40, 18
    s_sub_u32 s41, s38, s39
    s_add_u32 s42, s40, 1
    v_mov_b32 v4, s42
    s_cmp_ge_u32 s41, 8
    s_cbranch_scc1 layerb1_kernel_j_dep_b
    s_lshl_b32 s24, s41, 9
    s_add_u32 s24, s24, 16384
    v_lshlrev_b32 v2, 7, v0
    v_add_u32 v2, s24, v2
    s_mul_i32 s25, s41, 3
    s_add_u32 s25, s25, 104
    s_lshl_b32 s25, s25, 7
    v_writelane_b32 v2, s25, 4
    s_add_u32 s25, s25, 128
    v_writelane_b32 v2, s25, 5
    s_add_u32 s25, s25, 128
    v_writelane_b32 v2, s25, 6
    s_mov_b64 exec, 0x7f
    s_branch layerb1_kernel_j_poll
layerb1_kernel_j_dep_b:
    s_sub_u32 s24, s41, 8
    s_lshl_b32 s24, s24, 10
    s_add_u32 s24, s24, 20480
    v_lshlrev_b32 v2, 7, v0
    v_add_u32 v2, s24, v2
    s_lshl_b32 s25, s40, 4
    s_add_u32 s25, s25, 30720
    v_writelane_b32 v2, s25, 8
    s_mov_b32 s26, 8
    v_writelane_b32 v4, s26, 8
    s_mov_b64 exec, 0x1ff
layerb1_kernel_j_poll:
    buffer_load_dword v3, v2, s[8:11], s48 offen sc1
    s_waitcnt vmcnt(0)
    v_cmp_gt_u32 vcc, v4, v3
    s_sub_u32 s15, s15, 1
    s_cbranch_scc1 layerb1_kernel_j_giveup
    s_cbranch_vccnz layerb1_kernel_j_poll
    s_mov_b64 exec, -1
layerb1_kernel_j_pub:
    v_mov_b32 v2, 0
    v_mov_b32 v3, s38
    ds_write_b32 v2, v3 offset:32768
    s_waitcnt lgkmcnt(0)
layerb1_kernel_j_rel:
    s_barrier
    v_mov_b32 v2, 0
    ds_read_b32 v3, v2 offset:32768
    s_waitcnt lgkmcnt(0)
    v_readfirstlane_b32 s38, v3
    s_cmp_ge_u32 s38, 1152
    s_cbranch_scc1 layerb1_kernel_j_done
    s_mul_i32 s39, s38, 58255
    s_lshr_b32 s40, s39, 20
    s_mul_i32 s39, s40, 18
    s_sub_u32 s41, s38, s39
    s_cmp_ge_u32 s41, 8
    s_cbranch_scc1 layerb1_kernel_j_b
    s_lshl_b32 s41, s41, 2
    s_add_u32 s41, s41, s13
    v_lshlrev_b32 v1, 4, v0
    v_and_b32 v2, 31, v0
    v_lshrrev_b32 v3, 5, v0
    s_lshl_b32 s24, s40, 5
    s_add_u32 s24, s24, s41
    s_mul_i32 s25, s24, 12288
    s_add_u32 s26, s25, 78643200
    s_add_u32 s27, s25, 53477376
    s_mul_i32 s28, s24, 3072
    s_add_u32 s28, s28, 208666624
    v_and_b32 v4, 7, v0
    v_lshlrev_b32 v4, 4, v4
    v_lshl_add_u32 v4, v3, 7, v4
    buffer_load_dwordx4 v[16:19], v1, s[8:11], s26 offen offset:0 sc1
    buffer_load_dwordx4 v[64:67], v1, s[8:11], s27 offen offset:0 sc1
    buffer_load_dwordx4 v[112:115], v4, s[8:11], s28 offen offset:0 sc1
    buffer_load_dwordx4 v[20:23], v1, s[8:11], s26 offen offset:1024 sc1
    buffer_load_dwordx4 v[68:71], v1, s[8:11], s27 offen offset:1024 sc1
    buffer_load_dwordx4 v[116:119], v4, s[8:11], s28 offen offset:256 sc1
    buffer_load_dwordx4 v[24:27], v1, s[8:11], s26 offen offset:2048 sc1
    buffer_load_dwordx4 v[72:75], v1, s[8:11], s27 offen offset:2048 sc1
    buffer_load_dwordx4 v[120:123], v4, s[8:11], s28 offen offset:512 sc1
    buffer_load_dwordx4 v[28:31], v1, s[8:11], s26 offen offset:3072 sc1
    buffer_load_dwordx4 v[76:79], v1, s[8:11], s27 offen offset:3072 sc1
    buffer_load_dwordx4 v[124:127], v4, s[8:11], s28 offen offset:768 sc1
    s_add_u32 s26, s26, 4096
    s_add_u32 s27, s27, 4096
    buffer_load_dwordx4 v[32:35], v1, s[8:11], s26 offen offset:0 sc1
    buffer_load_dwordx4 v[80:83], v1, s[8:11], s27 offen offset:0 sc1
    buffer_load_dwordx4 v[128:131], v4, s[8:11], s28 offen offset:1024 sc1
    buffer_load_dwordx4 v[36:39], v1, s[8:11], s26 offen offset:1024 sc1
    buffer_load_dwordx4 v[84:87], v1, s[8:11], s27 offen offset:1024 sc1
    buffer_load_dwordx4 v[132:135], v4, s[8:11], s28 offen offset:1280 sc1
    buffer_load_dwordx4 v[40:43], v1, s[8:11], s26 offen offset:2048 sc1
    buffer_load_dwordx4 v[88:91], v1, s[8:11], s27 offen offset:2048 sc1
    buffer_load_dwordx4 v[136:139], v4, s[8:11], s28 offen offset:1536 sc1
    buffer_load_dwordx4 v[44:47], v1, s[8:11], s26 offen offset:3072 sc1
    buffer_load_dwordx4 v[92:95], v1, s[8:11], s27 offen offset:3072 sc1
    buffer_load_dwordx4 v[140:143], v4, s[8:11], s28 offen offset:1792 sc1
    s_add_u32 s26, s26, 4096
    s_add_u32 s27, s27, 4096
    buffer_load_dwordx4 v[48:51], v1, s[8:11], s26 offen offset:0 sc1
    buffer_load_dwordx4 v[96:99], v1, s[8:11], s27 offen offset:0 sc1
    buffer_load_dwordx4 v[144:147], v4, s[8:11], s28 offen offset:2048 sc1
    buffer_load_dwordx4 v[52:55], v1, s[8:11], s26 offen offset:1024 sc1
    buffer_load_dwordx4 v[100:103], v1, s[8:11], s27 offen offset:1024 sc1
    buffer_load_dwordx4 v[148:151], v4, s[8:11], s28 offen offset:2304 sc1
    buffer_load_dwordx4 v[56:59], v1, s[8:11], s26 offen offset:2048 sc1
    buffer_load_dwordx4 v[104:107], v1, s[8:11], s27 offen offset:2048 sc1
    buffer_load_dwordx4 v[152:155], v4, s[8:11], s28 offen offset:2560 sc1
    buffer_load_dwordx4 v[60:63], v1, s[8:11], s26 offen offset:3072 sc1
    buffer_load_dwordx4 v[108:111], v1, s[8:11], s27 offen offset:3072 sc1
    buffer_load_dwordx4 v[156:159], v4, s[8:11], s28 offen offset:2816 sc1
    v_lshlrev_b32 v5, 2, v3
    v_sub_u32 v5, v2, v5
    v_mov_b32 v6, 0xf149f2ca
    v_cmp_gt_i32 vcc, 0, v5
    s_nop 1
    v_cndmask_b32 v192, 0, v6, vcc
    v_cmp_gt_i32 vcc, 1, v5
    s_nop 1
    v_cndmask_b32 v193, 0, v6, vcc
    v_cmp_gt_i32 vcc, 2, v5
    s_nop 1
    v_cndmask_b32 v194, 0, v6, vcc
    v_cmp_gt_i32 vcc, 3, v5
    s_nop 1
    v_cndmask_b32 v195, 0, v6, vcc
    v_cmp_gt_i32 vcc, 8, v5
    s_nop 1
    v_cndmask_b32 v196, 0, v6, vcc
    v_cmp_gt_i32 vcc, 9, v5
    s_nop 1
    v_cndmask_b32 v197, 0, v6, vcc
    v_cmp_gt_i32 vcc, 10, v5
    s_nop 1
    v_cndmask_b32 v198, 0, v6, vcc
    v_cmp_gt_i32 vcc, 11, v5
    s_nop 1
    v_cndmask_b32 v199, 0, v6, vcc
    v_cmp_gt_i32 vcc, 16, v5
    s_nop 1
    v_cndmask_b32 v200, 0, v6, vcc
    v_cmp_gt_i32 vcc, 17, v5
    s_nop 1
    v_cndmask_b32 v201, 0, v6, vcc
    v_cmp_gt_i32 vcc, 18, v5
    s_nop 1
    v_cndmask_b32 v202, 0, v6, vcc
    v_cmp_gt_i32 vcc, 19, v5
    s_nop 1
    v_cndmask_b32 v203, 0, v6, vcc
    v_cmp_gt_i32 vcc, 24, v5
    s_nop 1
    v_cndmask_b32 v204, 0, v6, vcc
    v_cmp_gt_i32 vcc, 25, v5
    s_nop 1
    v_cndmask_b32 v205, 0, v6, vcc
    v_cmp_gt_i32 vcc, 26, v5
    s_nop 1
    v_cndmask_b32 v206, 0, v6, vcc
    v_cmp_gt_i32 vcc, 27, v5
    s_nop 1
    v_cndmask_b32 v207, 0, v6, vcc
    s_waitcnt vmcnt(33)
    v_mfma_f32_32x32x16_bf16 v[160:175], v[64:67], v[16:19], 0
    v_mfma_f32_32x32x16_bf16 v[176:191], v[112:115], v[16:19], 0
    s_waitcnt vmcnt(30)
    v_mfma_f32_32x32x16_bf16 v[160:175], v[68:71], v[20:23], v[160:175]
    v_mfma_f32_32x32x16_bf16 v[176:191], v[116:119], v[20:23], v[176:191]
    s_waitcnt vmcnt(27)
    v_mfma_f32_32x32x16_bf16 v[160:175], v[72:75], v[24:27], v[160:175]
    v_mfma_f32_32x32x16_bf16 v[176:191], v[120:123], v[24:27], v[176:191]
    s_waitcnt vmcnt(24)
    v_mfma_f32_32x32x16_bf16 v[160:175], v[76:79], v[28:31], v[160:175]
    v_mfma_f32_32x32x16_bf16 v[176:191], v[124:127], v[28:31], v[176:191]
    s_waitcnt vmcnt(21)
    v_mfma_f32_32x32x16_bf16 v[160:175], v[80:83], v[32:35], v[160:175]
    v_mfma_f32_32x32x16_bf16 v[176:191], v[128:131], v[32:35], v[176:191]
    s_waitcnt vmcnt(18)
    v_mfma_f32_32x32x16_bf16 v[160:175], v[84:87], v[36:39], v[160:175]
    v_mfma_f32_32x32x16_bf16 v[176:191], v[132:135], v[36:39], v[176:191]
    s_waitcnt vmcnt(15)
    v_mfma_f32_32x32x16_bf16 v[160:175], v[88:91], v[40:43], v[160:175]
    v_mfma_f32_32x32x16_bf16 v[176:191], v[136:139], v[40:43], v[176:191]
    s_waitcnt vmcnt(12)
    v_mfma_f32_32x32x16_bf16 v[160:175], v[92:95], v[44:47], v[160:175]
    v_mfma_f32_32x32x16_bf16 v[176:191], v[140:143], v[44:47], v[176:191]
    s_waitcnt vmcnt(9)
    v_mfma_f32_32x32x16_bf16 v[160:175], v[96:99], v[48:51], v[160:175]
    v_mfma_f32_32x32x16_bf16 v[176:191], v[144:147], v[48:51], v[176:191]
    s_waitcnt vmcnt(6)
    v_mfma_f32_32x32x16_bf16 v[160:175], v[100:103], v[52:55], v[160:175]
    v_mfma_f32_32x32x16_bf16 v[176:191], v[148:151], v[52:55], v[176:191]
    s_waitcnt vmcnt(3)
    v_mfma_f32_32x32x16_bf16 v[160:175], v[104:107], v[56:59], v[160:175]
    v_mfma_f32_32x32x16_bf16 v[176:191], v[152:155], v[56:59], v[176:191]
    s_waitcnt vmcnt(0)
    v_mfma_f32_32x32x16_bf16 v[160:175], v[108:111], v[60:63], v[160:175]
    v_mfma_f32_32x32x16_bf16 v[176:191], v[156:159], v[60:63], v[176:191]
    s_nop 7
    s_nop 7
    v_mov_b32 v7, 0x3dd53b95
    v_fma_f32 v160, v160, v7, v192
    v_fma_f32 v161, v161, v7, v193
    v_fma_f32 v162, v162, v7, v194
    v_fma_f32 v163, v163, v7, v195
    v_fma_f32 v164, v164, v7, v196
    v_fma_f32 v165, v165, v7, v197
    v_fma_f32 v166, v166, v7, v198
    v_fma_f32 v167, v167, v7, v199
    v_fma_f32 v168, v168, v7, v200
    v_fma_f32 v169, v169, v7, v201
    v_fma_f32 v170, v170, v7, v202
    v_fma_f32 v171, v171, v7, v203
    v_fma_f32 v172, v172, v7, v204
    v_fma_f32 v173, v173, v7, v205
    v_fma_f32 v174, v174, v7, v206
    v_fma_f32 v175, v175, v7, v207
    v_mul_f32 v176, v176, v7
    v_mul_f32 v177, v177, v7
    v_mul_f32 v178, v178, v7
    v_mul_f32 v179, v179, v7
    v_max3_f32 v208, v160, v161, v162
    v_max3_f32 v208, v208, v163, v164
    v_max3_f32 v208, v208, v165, v166
    v_max3_f32 v208, v208, v167, v168
    v_max3_f32 v208, v208, v169, v170
    v_max3_f32 v208, v208, v171, v172
    v_max3_f32 v208, v208, v173, v174
    v_max3_f32 v208, v208, v175, v176
    v_max3_f32 v208, v208, v177, v178
    v_max_f32 v208, v208, v179
    v_mov_b32 v209, v208
    s_nop 1
    v_permlane32_swap_b32 v208, v209
    v_max_f32 v208, v208, v209
    v_sub_f32 v160, v160, v208
    v_sub_f32 v161, v161, v208
    v_sub_f32 v162, v162, v208
    v_sub_f32 v163, v163, v208
    v_sub_f32 v164, v164, v208
    v_sub_f32 v165, v165, v208
    v_sub_f32 v166, v166, v208
    v_sub_f32 v167, v167, v208
    v_sub_f32 v168, v168, v208
    v_sub_f32 v169, v169, v208
    v_sub_f32 v170, v170, v208
    v_sub_f32 v171, v171, v208
    v_sub_f32 v172, v172, v208
    v_sub_f32 v173, v173, v208
    v_sub_f32 v174, v174, v208
    v_sub_f32 v175, v175, v208
    v_sub_f32 v176, v176, v208
    v_sub_f32 v177, v177, v208
    v_sub_f32 v178, v178, v208
    v_sub_f32 v179, v179, v208
    v_exp_f32 v160, v160
    v_exp_f32 v161, v161
    v_exp_f32 v162, v162
    v_exp_f32 v163, v163
    v_exp_f32 v164, v164
    v_exp_f32 v165, v165
    v_exp_f32 v166, v166
    v_exp_f32 v167, v167
    v_exp_f32 v168, v168
    v_exp_f32 v169, v169
    v_exp_f32 v170, v170
    v_exp_f32 v171, v171
    v_exp_f32 v172, v172
    v_exp_f32 v173, v173
    v_exp_f32 v174, v174
    v_exp_f32 v175, v175
    v_exp_f32 v176, v176
    v_exp_f32 v177, v177
    v_exp_f32 v178, v178
    v_exp_f32 v179, v179
    s_nop 0
    v_add_f32 v210, v160, v161
    v_add_f32 v210, v210, v162
    v_add_f32 v210, v210, v163
    v_add_f32 v210, v210, v164
    v_add_f32 v210, v210, v165
    v_add_f32 v210, v210, v166
    v_add_f32 v210, v210, v167
    v_add_f32 v210, v210, v168
    v_add_f32 v210, v210, v169
    v_add_f32 v210, v210, v170
    v_add_f32 v210, v210, v171
    v_add_f32 v210, v210, v172
    v_add_f32 v210, v210, v173
    v_add_f32 v210, v210, v174
    v_add_f32 v210, v210, v175
    v_add_f32 v210, v210, v176
    v_add_f32 v210, v210, v177
    v_add_f32 v210, v210, v178
    v_add_f32 v210, v210, v179
    v_mov_b32 v209, v210
    s_nop 1
    v_permlane32_swap_b32 v210, v209
    v_add_f32 v210, v210, v209
    v_rcp_f32 v210, v210
    s_nop 0
    v_mul_f32 v160, v160, v210
    v_mul_f32 v161, v161, v210
    v_mul_f32 v162, v162, v210
    v_mul_f32 v163, v163, v210
    v_mul_f32 v164, v164, v210
    v_mul_f32 v165, v165, v210
    v_mul_f32 v166, v166, v210
    v_mul_f32 v167, v167, v210
    v_mul_f32 v168, v168, v210
    v_mul_f32 v169, v169, v210
    v_mul_f32 v170, v170, v210
    v_mul_f32 v171, v171, v210
    v_mul_f32 v172, v172, v210
    v_mul_f32 v173, v173, v210
    v_mul_f32 v174, v174, v210
    v_mul_f32 v175, v175, v210
    v_mul_f32 v176, v176, v210
    v_mul_f32 v177, v177, v210
    v_mul_f32 v178, v178, v210
    v_mul_f32 v179, v179, v210
    s_mul_i32 s25, s40, 81920
    s_mul_i32 s26, s41, 2560
    s_add_u32 s25, s25, s26
    s_add_u32 s25, s25, 214958080
    v_cvt_pk_bf16_f32 v16, v160, v161
    v_cvt_pk_bf16_f32 v17, v162, v163
    v_cvt_pk_bf16_f32 v18, v164, v165
    v_cvt_pk_bf16_f32 v19, v166, v167
    s_nop 1
    v_permlane32_swap_b32 v16, v18
    v_permlane32_swap_b32 v17, v19
    buffer_store_dwordx4 v[16:19], v1, s[8:11], s25 offen offset:512 sc1
    v_cvt_pk_bf16_f32 v20, v168, v169
    v_cvt_pk_bf16_f32 v21, v170, v171
    v_cvt_pk_bf16_f32 v22, v172, v173
    v_cvt_pk_bf16_f32 v23, v174, v175
    s_nop 1
    v_permlane32_swap_b32 v20, v22
    v_permlane32_swap_b32 v21, v23
    buffer_store_dwordx4 v[20:23], v1, s[8:11], s25 offen offset:1536 sc1
    v_cvt_pk_bf16_f32 v24, v176, v177
    v_cvt_pk_bf16_f32 v25, v178, v179
    v_lshlrev_b32 v4, 4, v2
    v_lshl_add_u32 v4, v3, 3, v4
    buffer_store_dwordx2 v[24:25], v4, s[8:11], s25 offen sc1
    s_waitcnt vmcnt(0)
    s_barrier
    s_cmp_lg_u32 s13, 0
    s_cbranch_scc1 layerb1_kernel_j_next
    s_mov_b64 exec, 1
    s_lshl_b32 s24, s40, 4
    s_add_u32 s24, s24, 30720
    v_mov_b32 v2, s24
    v_mov_b32 v3, 1
    buffer_atomic_add v3, v2, s[8:11], s48 offen sc1
    s_mov_b64 exec, -1
    s_branch layerb1_kernel_j_next
layerb1_kernel_j_b:
    s_sub_u32 s41, s41, 8
    v_lshlrev_b32 v1, 4, v0
    v_and_b32 v2, 31, v0
    v_lshrrev_b32 v3, 5, v0
    v_lshrrev_b32 v4, 3, v2
    v_mul_u32_u24 v4, 20480, v4
    v_and_b32 v5, 7, v2
    v_lshl_add_u32 v4, v5, 4, v4
    v_lshl_add_u32 v4, v3, 7, v4
    s_mul_i32 s24, s40, 1638400
    s_mul_i32 s25, s41, 163840
    s_add_u32 s24, s24, s25
    s_mul_i32 s25, s13, 5120
    s_add_u32 s24, s24, s25
    s_add_u32 s24, s24, 103809024
    s_add_u32 s28, s24, 81920
    s_mul_i32 s25, s40, 81920
    s_mul_i32 s26, s13, 20480
    s_add_u32 s25, s25, s26
    s_add_u32 s25, s25, 214958080
    v_mul_u32_u24 v6, 1280, v2
    v_lshl_add_u32 v6, v3, 4, v6
    s_mul_i32 s26, s40, 40960
    s_lshl_b32 s27, s41, 7
    s_add_u32 s26, s26, s27
    s_lshl_b32 s27, s13, 5
    s_add_u32 s26, s26, s27
    s_add_u32 s27, s26, 226492416
    buffer_load_dwordx4 v[8:11], v6, s[8:11], s27 offen sc1
    buffer_load_dwordx4 a[160:163], v1, s[8:11], s25 offen offset:0 sc1
    buffer_load_dwordx4 a[0:3], v4, s[8:11], s24 offen offset:0 sc1
    buffer_load_dwordx4 a[80:83], v4, s[8:11], s28 offen offset:0 sc1
    buffer_load_dwordx4 a[164:167], v1, s[8:11], s25 offen offset:1024 sc1
    buffer_load_dwordx4 a[4:7], v4, s[8:11], s24 offen offset:256 sc1
    buffer_load_dwordx4 a[84:87], v4, s[8:11], s28 offen offset:256 sc1
    buffer_load_dwordx4 a[168:171], v1, s[8:11], s25 offen offset:2048 sc1
    buffer_load_dwordx4 a[8:11], v4, s[8:11], s24 offen offset:512 sc1
    buffer_load_dwordx4 a[88:91], v4, s[8:11], s28 offen offset:512 sc1
    buffer_load_dwordx4 a[172:175], v1, s[8:11], s25 offen offset:3072 sc1
    buffer_load_dwordx4 a[12:15], v4, s[8:11], s24 offen offset:768 sc1
    buffer_load_dwordx4 a[92:95], v4, s[8:11], s28 offen offset:768 sc1
    s_add_u32 s25, s25, 4096
    buffer_load_dwordx4 a[176:179], v1, s[8:11], s25 offen offset:0 sc1
    buffer_load_dwordx4 a[16:19], v4, s[8:11], s24 offen offset:1024 sc1
    buffer_load_dwordx4 a[96:99], v4, s[8:11], s28 offen offset:1024 sc1
    buffer_load_dwordx4 a[180:183], v1, s[8:11], s25 offen offset:1024 sc1
    buffer_load_dwordx4 a[20:23], v4, s[8:11], s24 offen offset:1280 sc1
    buffer_load_dwordx4 a[100:103], v4, s[8:11], s28 offen offset:1280 sc1
    buffer_load_dwordx4 a[184:187], v1, s[8:11], s25 offen offset:2048 sc1
    buffer_load_dwordx4 a[24:27], v4, s[8:11], s24 offen offset:1536 sc1
    buffer_load_dwordx4 a[104:107], v4, s[8:11], s28 offen offset:1536 sc1
    buffer_load_dwordx4 a[188:191], v1, s[8:11], s25 offen offset:3072 sc1
    buffer_load_dwordx4 a[28:31], v4, s[8:11], s24 offen offset:1792 sc1
    buffer_load_dwordx4 a[108:111], v4, s[8:11], s28 offen offset:1792 sc1
    s_add_u32 s25, s25, 4096
    buffer_load_dwordx4 a[192:195], v1, s[8:11], s25 offen offset:0 sc1
    buffer_load_dwordx4 a[32:35], v4, s[8:11], s24 offen offset:2048 sc1
    buffer_load_dwordx4 a[112:115], v4, s[8:11], s28 offen offset:2048 sc1
    buffer_load_dwordx4 a[196:199], v1, s[8:11], s25 offen offset:1024 sc1
    buffer_load_dwordx4 a[36:39], v4, s[8:11], s24 offen offset:2304 sc1
    buffer_load_dwordx4 a[116:119], v4, s[8:11], s28 offen offset:2304 sc1
    buffer_load_dwordx4 a[200:203], v1, s[8:11], s25 offen offset:2048 sc1
    buffer_load_dwordx4 a[40:43], v4, s[8:11], s24 offen offset:2560 sc1
    buffer_load_dwordx4 a[120:123], v4, s[8:11], s28 offen offset:2560 sc1
    buffer_load_dwordx4 a[204:207], v1, s[8:11], s25 offen offset:3072 sc1
    buffer_load_dwordx4 a[44:47], v4, s[8:11], s24 offen offset:2816 sc1
    buffer_load_dwordx4 a[124:127], v4, s[8:11], s28 offen offset:2816 sc1
    s_add_u32 s25, s25, 4096
    buffer_load_dwordx4 a[208:211], v1, s[8:11], s25 offen offset:0 sc1
    buffer_load_dwordx4 a[48:51], v4, s[8:11], s24 offen offset:3072 sc1
    buffer_load_dwordx4 a[128:131], v4, s[8:11], s28 offen offset:3072 sc1
    buffer_load_dwordx4 a[212:215], v1, s[8:11], s25 offen offset:1024 sc1
    buffer_load_dwordx4 a[52:55], v4, s[8:11], s24 offen offset:3328 sc1
    buffer_load_dwordx4 a[132:135], v4, s[8:11], s28 offen offset:3328 sc1
    buffer_load_dwordx4 a[216:219], v1, s[8:11], s25 offen offset:2048 sc1
    buffer_load_dwordx4 a[56:59], v4, s[8:11], s24 offen offset:3584 sc1
    buffer_load_dwordx4 a[136:139], v4, s[8:11], s28 offen offset:3584 sc1
    buffer_load_dwordx4 a[220:223], v1, s[8:11], s25 offen offset:3072 sc1
    buffer_load_dwordx4 a[60:63], v4, s[8:11], s24 offen offset:3840 sc1
    buffer_load_dwordx4 a[140:143], v4, s[8:11], s28 offen offset:3840 sc1
    s_add_u32 s25, s25, 4096
    s_add_u32 s24, s24, 4096
    s_add_u32 s28, s28, 4096
    buffer_load_dwordx4 a[224:227], v1, s[8:11], s25 offen offset:0 sc1
    buffer_load_dwordx4 a[64:67], v4, s[8:11], s24 offen offset:0 sc1
    buffer_load_dwordx4 a[144:147], v4, s[8:11], s28 offen offset:0 sc1
    buffer_load_dwordx4 a[228:231], v1, s[8:11], s25 offen offset:1024 sc1
    buffer_load_dwordx4 a[68:71], v4, s[8:11], s24 offen offset:256 sc1
    buffer_load_dwordx4 a[148:151], v4, s[8:11], s28 offen offset:256 sc1
    buffer_load_dwordx4 a[232:235], v1, s[8:11], s25 offen offset:2048 sc1
    buffer_load_dwordx4 a[72:75], v4, s[8:11], s24 offen offset:512 sc1
    buffer_load_dwordx4 a[152:155], v4, s[8:11], s28 offen offset:512 sc1
    buffer_load_dwordx4 a[236:239], v1, s[8:11], s25 offen offset:3072 sc1
    buffer_load_dwordx4 a[76:79], v4, s[8:11], s24 offen offset:768 sc1
    buffer_load_dwordx4 a[156:159], v4, s[8:11], s28 offen offset:768 sc1
    s_waitcnt vmcnt(57)
    v_mfma_f32_32x32x16_bf16 v[16:31], a[0:3], a[160:163], 0
    v_mfma_f32_32x32x16_bf16 v[32:47], a[80:83], a[160:163], 0
    s_waitcnt vmcnt(54)
    v_mfma_f32_32x32x16_bf16 v[16:31], a[4:7], a[164:167], v[16:31]
    v_mfma_f32_32x32x16_bf16 v[32:47], a[84:87], a[164:167], v[32:47]
    s_waitcnt vmcnt(51)
    v_mfma_f32_32x32x16_bf16 v[16:31], a[8:11], a[168:171], v[16:31]
    v_mfma_f32_32x32x16_bf16 v[32:47], a[88:91], a[168:171], v[32:47]
    s_waitcnt vmcnt(48)
    v_mfma_f32_32x32x16_bf16 v[16:31], a[12:15], a[172:175], v[16:31]
    v_mfma_f32_32x32x16_bf16 v[32:47], a[92:95], a[172:175], v[32:47]
    s_waitcnt vmcnt(45)
    v_mfma_f32_32x32x16_bf16 v[16:31], a[16:19], a[176:179], v[16:31]
    v_mfma_f32_32x32x16_bf16 v[32:47], a[96:99], a[176:179], v[32:47]
    s_waitcnt vmcnt(42)
    v_mfma_f32_32x32x16_bf16 v[16:31], a[20:23], a[180:183], v[16:31]
    v_mfma_f32_32x32x16_bf16 v[32:47], a[100:103], a[180:183], v[32:47]
    s_waitcnt vmcnt(39)
    v_mfma_f32_32x32x16_bf16 v[16:31], a[24:27], a[184:187], v[16:31]
    v_mfma_f32_32x32x16_bf16 v[32:47], a[104:107], a[184:187], v[32:47]
    s_waitcnt vmcnt(36)
    v_mfma_f32_32x32x16_bf16 v[16:31], a[28:31], a[188:191], v[16:31]
    v_mfma_f32_32x32x16_bf16 v[32:47], a[108:111], a[188:191], v[32:47]
    s_waitcnt vmcnt(33)
    v_mfma_f32_32x32x16_bf16 v[16:31], a[32:35], a[192:195], v[16:31]
    v_mfma_f32_32x32x16_bf16 v[32:47], a[112:115], a[192:195], v[32:47]
    s_waitcnt vmcnt(30)
    v_mfma_f32_32x32x16_bf16 v[16:31], a[36:39], a[196:199], v[16:31]
    v_mfma_f32_32x32x16_bf16 v[32:47], a[116:119], a[196:199], v[32:47]
    s_waitcnt vmcnt(27)
    v_mfma_f32_32x32x16_bf16 v[16:31], a[40:43], a[200:203], v[16:31]
    v_mfma_f32_32x32x16_bf16 v[32:47], a[120:123], a[200:203], v[32:47]
    s_waitcnt vmcnt(24)
    v_mfma_f32_32x32x16_bf16 v[16:31], a[44:47], a[204:207], v[16:31]
    v_mfma_f32_32x32x16_bf16 v[32:47], a[124:127], a[204:207], v[32:47]
    s_waitcnt vmcnt(21)
    v_mfma_f32_32x32x16_bf16 v[16:31], a[48:51], a[208:211], v[16:31]
    v_mfma_f32_32x32x16_bf16 v[32:47], a[128:131], a[208:211], v[32:47]
    s_waitcnt vmcnt(18)
    v_mfma_f32_32x32x16_bf16 v[16:31], a[52:55], a[212:215], v[16:31]
    v_mfma_f32_32x32x16_bf16 v[32:47], a[132:135], a[212:215], v[32:47]
    s_waitcnt vmcnt(15)
    v_mfma_f32_32x32x16_bf16 v[16:31], a[56:59], a[216:219], v[16:31]
    v_mfma_f32_32x32x16_bf16 v[32:47], a[136:139], a[216:219], v[32:47]
    s_waitcnt vmcnt(12)
    v_mfma_f32_32x32x16_bf16 v[16:31], a[60:63], a[220:223], v[16:31]
    v_mfma_f32_32x32x16_bf16 v[32:47], a[140:143], a[220:223], v[32:47]
    s_waitcnt vmcnt(9)
    v_mfma_f32_32x32x16_bf16 v[16:31], a[64:67], a[224:227], v[16:31]
    v_mfma_f32_32x32x16_bf16 v[32:47], a[144:147], a[224:227], v[32:47]
    s_waitcnt vmcnt(6)
    v_mfma_f32_32x32x16_bf16 v[16:31], a[68:71], a[228:231], v[16:31]
    v_mfma_f32_32x32x16_bf16 v[32:47], a[148:151], a[228:231], v[32:47]
    s_waitcnt vmcnt(3)
    v_mfma_f32_32x32x16_bf16 v[16:31], a[72:75], a[232:235], v[16:31]
    v_mfma_f32_32x32x16_bf16 v[32:47], a[152:155], a[232:235], v[32:47]
    s_waitcnt vmcnt(0)
    v_mfma_f32_32x32x16_bf16 v[16:31], a[76:79], a[236:239], v[16:31]
    v_mfma_f32_32x32x16_bf16 v[32:47], a[156:159], a[236:239], v[32:47]
    s_lshl_b32 s27, s13, 11
    v_add_u32 v7, s27, v1
    s_nop 7
    s_nop 7
    ds_write_b128 v7, v[16:19] offset:0
    ds_write_b128 v7, v[20:23] offset:1024
    ds_write_b128 v7, v[24:27] offset:8192
    ds_write_b128 v7, v[28:31] offset:9216
    ds_write_b128 v7, v[32:35] offset:16384
    ds_write_b128 v7, v[36:39] offset:17408
    ds_write_b128 v7, v[40:43] offset:24576
    ds_write_b128 v7, v[44:47] offset:25600
    s_waitcnt lgkmcnt(0)
    s_barrier
    s_lshl_b32 s27, s13, 13
    v_add_u32 v7, s27, v1
    ds_read_b128 v[48:51], v7 offset:0
    ds_read_b128 v[52:55], v7 offset:1024
    ds_read_b128 v[56:59], v7 offset:2048
    ds_read_b128 v[60:63], v7 offset:3072
    ds_read_b128 v[64:67], v7 offset:4096
    ds_read_b128 v[68:71], v7 offset:5120
    ds_read_b128 v[72:75], v7 offset:6144
    ds_read_b128 v[76:79], v7 offset:7168
    s_waitcnt lgkmcnt(4)
    v_add_f32 v48, v48, v56
    v_add_f32 v49, v49, v57
    v_add_f32 v50, v50, v58
    v_add_f32 v51, v51, v59
    v_add_f32 v52, v52, v60
    v_add_f32 v53, v53, v61
    v_add_f32 v54, v54, v62
    v_add_f32 v55, v55, v63
    s_waitcnt lgkmcnt(0)
    v_add_f32 v64, v64, v72
    v_add_f32 v65, v65, v73
    v_add_f32 v66, v66, v74
    v_add_f32 v67, v67, v75
    v_add_f32 v68, v68, v76
    v_add_f32 v69, v69, v77
    v_add_f32 v70, v70, v78
    v_add_f32 v71, v71, v79
    v_add_f32 v48, v48, v64
    v_add_f32 v49, v49, v65
    v_add_f32 v50, v50, v66
    v_add_f32 v51, v51, v67
    v_add_f32 v52, v52, v68
    v_add_f32 v53, v53, v69
    v_add_f32 v54, v54, v70
    v_add_f32 v55, v55, v71
    v_cvt_pk_bf16_f32 v16, v48, v49
    v_cvt_pk_bf16_f32 v17, v50, v51
    v_cvt_pk_bf16_f32 v18, v52, v53
    v_cvt_pk_bf16_f32 v19, v54, v55
    s_nop 1
    v_permlane32_swap_b32 v16, v18
    v_permlane32_swap_b32 v17, v19
    s_nop 1
    v_lshlrev_b32 v48, 16, v16
    v_and_b32 v49, 0xffff0000, v16
    v_lshlrev_b32 v50, 16, v8
    v_and_b32 v51, 0xffff0000, v8
    v_add_f32 v48, v48, v50
    v_add_f32 v49, v49, v51
    v_cvt_pk_bf16_f32 v16, v48, v49
    v_lshlrev_b32 v48, 16, v17
    v_and_b32 v49, 0xffff0000, v17
    v_lshlrev_b32 v50, 16, v9
    v_and_b32 v51, 0xffff0000, v9
    v_add_f32 v48, v48, v50
    v_add_f32 v49, v49, v51
    v_cvt_pk_bf16_f32 v17, v48, v49
    v_lshlrev_b32 v48, 16, v18
    v_and_b32 v49, 0xffff0000, v18
    v_lshlrev_b32 v50, 16, v10
    v_and_b32 v51, 0xffff0000, v10
    v_add_f32 v48, v48, v50
    v_add_f32 v49, v49, v51
    v_cvt_pk_bf16_f32 v18, v48, v49
    v_lshlrev_b32 v48, 16, v19
    v_and_b32 v49, 0xffff0000, v19
    v_lshlrev_b32 v50, 16, v11
    v_and_b32 v51, 0xffff0000, v11
    v_add_f32 v48, v48, v50
    v_add_f32 v49, v49, v51
    v_cvt_pk_bf16_f32 v19, v48, v49
    buffer_store_dwordx4 v[16:19], v6, s[84:87], s26 offen
    s_branch layerb1_kernel_j_next
layerb1_kernel_j_giveup:
    s_mov_b64 exec, -1
    v_mov_b32 v2, 0
    v_mov_b32 v3, -1
    ds_write_b32 v2, v3 offset:32768
    s_waitcnt lgkmcnt(0)
    s_barrier
    s_branch layerb1_kernel_bail
layerb1_kernel_j_done:
    s_branch layerb1_kernel_end
layerb1_kernel_bail:
    s_mov_b64 exec, 1
    s_load_dwordx2 s[6:7], s[0:1], 88
    s_waitcnt lgkmcnt(0)
    s_mov_b32 s24, s6
    s_mov_b32 s25, s7
    s_mov_b32 s26, 256
    s_mov_b32 s27, 0x00020000
    v_mov_b32 v1, 0xdead
    v_mov_b32 v2, s14
    v_mov_b32 v3, 0
    buffer_store_dword v1, v3, s[24:27], 0 offen
    buffer_store_dword v2, v3, s[24:27], 0 offen offset:4
layerb1_kernel_end:
layerb1_kernel_end0:
    s_endpgm
.section .rodata,"a"
.p2align 6
.amdhsa_kernel layerb1_kernel
  .amdhsa_next_free_vgpr 512
  .amdhsa_next_free_sgpr 100
  .amdhsa_accum_offset 256
  .amdhsa_group_segment_fixed_size 0
  .amdhsa_kernarg_size 104
  .amdhsa_user_sgpr_count 2
  .amdhsa_user_sgpr_kernarg_segment_ptr 1
  .amdhsa_system_sgpr_workgroup_id_x 1
.end_amdhsa_kernel
.text
.globl afront2_kernel
.p2align 8
.type afront2_kernel,@function
afront2_kernel:
    s_cmp_ge_u32 s2, 256
    s_cbranch_scc1 afront2_kernel_end
    s_load_dwordx2 s[4:5], s[0:1], 96
    v_lshrrev_b32 v1, 6, v0
    v_and_b32 v0, 63, v0
    s_nop 0
    v_readfirstlane_b32 s13, v1
    s_waitcnt lgkmcnt(0)
    s_mov_b32 s8, s4
    s_mov_b32 s9, s5
    s_mov_b32 s10, 268435456
    s_mov_b32 s11, 0x00020000
    s_add_u32 s16, s4, 247463936
    s_addc_u32 s17, s5, 0
    s_mov_b32 s18, 2621440
    s_mov_b32 s19, 0x00020000
    s_and_b32 s28, s2, 7
    s_lshr_b32 s29, s2, 3
    s_and_b32 s30, s28, 3
    s_lshl_b32 s30, s30, 2
    s_and_b32 s31, s29, 3
    s_add_u32 s20, s30, s31
    s_lshr_b32 s30, s28, 2
    s_lshl_b32 s30, s30, 3
    s_lshr_b32 s31, s29, 2
    s_add_u32 s21, s30, s31
    s_lshr_b32 s22, s13, 1
    s_and_b32 s23, s13, 1
    s_lshl_b32 s26, s20, 1
    s_add_u32 s26, s26, s23
    s_mov_b32 s27, 0x3f803f80
    s_lshl_b32 s28, s21, 7
    s_lshl_b32 s29, s13, 5
    s_add_u32 s28, s28, s29
    s_mul_i32 s24, s28, 1280
    s_lshl_b32 s28, s20, 1
    s_add_u32 s28, s28, s22
    s_mul_i32 s25, s28, 81920
    s_lshl_b32 s29, s23, 12
    s_add_u32 s25, s25, s29
    s_add_u32 s25, s25, 243269632
    v_lshlrev_b32 v1, 4, v0
    v_lshrrev_b32 v16, 3, v0
    v_mul_u32_u24 v16, 1280, v16
    v_and_b32 v17, 7, v0
    v_lshrrev_b32 v18, 4, v0
    v_xor_b32 v19, v17, v18
    v_lshl_add_u32 v2, v19, 4, v16
    v_xor_b32 v19, 4, v19
    v_lshl_add_u32 v3, v19, 4, v16
    s_lshl_b32 s28, s13, 12
    s_mov_b32 m0, s28
    s_add_u32 s29, s24, 0
    buffer_load_dwordx4 v2, s[16:19], s29 offen offset:0 lds
    s_add_u32 s29, s29, 9216
    buffer_load_dwordx4 v3, s[16:19], s29 offen offset:1024 lds
    s_add_u32 s29, s29, 9216
    buffer_load_dwordx4 v2, s[16:19], s29 offen offset:2048 lds
    s_add_u32 s29, s29, 9216
    buffer_load_dwordx4 v3, s[16:19], s29 offen offset:3072 lds
    s_add_u32 s28, s28, 16384
    s_mov_b32 m0, s28
    s_add_u32 s29, s25, 0
    buffer_load_dwordx4 v1, s[8:11], s29 offen offset:0 lds
    buffer_load_dwordx4 v1, s[8:11], s29 offen offset:1024 lds
    buffer_load_dwordx4 v1, s[8:11], s29 offen offset:2048 lds
    buffer_load_dwordx4 v1, s[8:11], s29 offen offset:3072 lds
    s_lshl_b32 s28, s13, 12
    s_add_u32 s28, s28, 32768
    s_mov_b32 m0, s28
    s_add_u32 s29, s24, 128
    buffer_load_dwordx4 v2, s[16:19], s29 offen offset:0 lds
    s_add_u32 s29, s29, 9216
    buffer_load_dwordx4 v3, s[16:19], s29 offen offset:1024 lds
    s_add_u32 s29, s29, 9216
    buffer_load_dwordx4 v2, s[16:19], s29 offen offset:2048 lds
    s_add_u32 s29, s29, 9216
    buffer_load_dwordx4 v3, s[16:19], s29 offen offset:3072 lds
    s_add_u32 s28, s28, 16384
    s_mov_b32 m0, s28
    s_add_u32 s29, s25, 8192
    buffer_load_dwordx4 v1, s[8:11], s29 offen offset:0 lds
    buffer_load_dwordx4 v1, s[8:11], s29 offen offset:1024 lds
    buffer_load_dwordx4 v1, s[8:11], s29 offen offset:2048 lds
    buffer_load_dwordx4 v1, s[8:11], s29 offen offset:3072 lds
    s_lshl_b32 s28, s13, 12
    s_add_u32 s28, s28, 65536
    s_mov_b32 m0, s28
    s_add_u32 s29, s24, 256
    buffer_load_dwordx4 v2, s[16:19], s29 offen offset:0 lds
    s_add_u32 s29, s29, 9216
    buffer_load_dwordx4 v3, s[16:19], s29 offen offset:1024 lds
    s_add_u32 s29, s29, 9216
    buffer_load_dwordx4 v2, s[16:19], s29 offen offset:2048 lds
    s_add_u32 s29, s29, 9216
    buffer_load_dwordx4 v3, s[16:19], s29 offen offset:3072 lds
    s_add_u32 s28, s28, 16384
    s_mov_b32 m0, s28
    s_add_u32 s29, s25, 16384
    buffer_load_dwordx4 v1, s[8:11], s29 offen offset:0 lds
    buffer_load_dwordx4 v1, s[8:11], s29 offen offset:1024 lds
    buffer_load_dwordx4 v1, s[8:11], s29 offen offset:2048 lds
    buffer_load_dwordx4 v1, s[8:11], s29 offen offset:3072 lds
    v_and_b32 v16, 31, v0
    v_lshrrev_b32 v17, 5, v0
    v_lshrrev_b32 v18, 1, v16
    v_and_b32 v18, 7, v18
    v_xor_b32 v18, v18, v17
    v_lshlrev_b32 v18, 4, v18
    v_lshl_add_u32 v18, v16, 7, v18
    s_lshl_b32 s28, s22, 13
    v_add_u32 v18, s28, v18
    v_xor_b32 v6, 0, v18
    v_add_u32 v10, 65536, v6
    v_xor_b32 v7, 32, v18
    v_add_u32 v11, 65536, v7
    v_xor_b32 v8, 64, v18
    v_add_u32 v12, 65536, v8
    v_xor_b32 v9, 96, v18
    v_add_u32 v13, 65536, v9
    s_lshl_b32 s28, s23, 13
    s_add_u32 s28, s28, 16384
    v_add_u32 v4, s28, v1
    v_add_u32 v5, 65536, v4
    v_mov_b32 v20, 0
    v_mov_b32 v21, 0
    v_mov_b32 v22, 0
    v_mov_b32 v23, 0
    s_waitcnt vmcnt(16)
    s_barrier
    ds_read_b128 v[32:35], v6 offset:0
    ds_read_b128 v[36:39], v6 offset:4096
    ds_read_b128 v[40:43], v4 offset:0
    ds_read_b128 v[44:47], v4 offset:1024
    s_cmp_eq_u32 s23, 1
    s_cbranch_scc1 afront2_kernel_af_h1
    s_waitcnt lgkmcnt(0)
    v_mfma_f32_32x32x16_bf16 v[64:79], v[32:35], v[40:43], 0
    v_dot2c_f32_bf16 v20, s27, v32
    v_dot2c_f32_bf16 v22, v32, v32
    v_mfma_f32_32x32x16_bf16 v[96:111], v[32:35], v[44:47], 0
    ds_read_b128 v[48:51], v7 offset:0
    v_dot2c_f32_bf16 v21, s27, v33
    v_mfma_f32_32x32x16_bf16 v[128:143], v[44:47], v[32:35], 0
    ds_read_b128 v[52:55], v7 offset:4096
    v_dot2c_f32_bf16 v23, v33, v33
    v_mfma_f32_32x32x16_bf16 v[80:95], v[36:39], v[40:43], 0
    ds_read_b128 v[56:59], v4 offset:2048
    v_dot2c_f32_bf16 v20, s27, v34
    v_dot2c_f32_bf16 v22, v34, v34
    v_mfma_f32_32x32x16_bf16 v[112:127], v[36:39], v[44:47], 0
    ds_read_b128 v[60:63], v4 offset:3072
    v_dot2c_f32_bf16 v21, s27, v35
    v_mfma_f32_32x32x16_bf16 v[144:159], v[44:47], v[36:39], 0
    v_dot2c_f32_bf16 v23, v35, v35
    s_waitcnt lgkmcnt(0)
    v_mfma_f32_32x32x16_bf16 v[64:79], v[48:51], v[56:59], v[64:79]
    v_dot2c_f32_bf16 v20, s27, v48
    v_dot2c_f32_bf16 v22, v48, v48
    v_mfma_f32_32x32x16_bf16 v[96:111], v[48:51], v[60:63], v[96:111]
    ds_read_b128 v[32:35], v8 offset:0
    v_dot2c_f32_bf16 v21, s27, v49
    v_mfma_f32_32x32x16_bf16 v[128:143], v[60:63], v[48:51], v[128:143]
    ds_read_b128 v[36:39], v8 offset:4096
    v_dot2c_f32_bf16 v23, v49, v49
    v_mfma_f32_32x32x16_bf16 v[80:95], v[52:55], v[56:59], v[80:95]
    ds_read_b128 v[40:43], v4 offset:4096
    v_dot2c_f32_bf16 v20, s27, v50
    v_dot2c_f32_bf16 v22, v50, v50
    v_mfma_f32_32x32x16_bf16 v[112:127], v[52:55], v[60:63], v[112:127]
    ds_read_b128 v[44:47], v4 offset:5120
    v_dot2c_f32_bf16 v21, s27, v51
    v_mfma_f32_32x32x16_bf16 v[144:159], v[60:63], v[52:55], v[144:159]
    v_dot2c_f32_bf16 v23, v51, v51
    s_waitcnt lgkmcnt(0)
    v_mfma_f32_32x32x16_bf16 v[64:79], v[32:35], v[40:43], v[64:79]
    v_dot2c_f32_bf16 v20, s27, v32
    v_dot2c_f32_bf16 v22, v32, v32
    v_mfma_f32_32x32x16_bf16 v[96:111], v[32:35], v[44:47], v[96:111]
    ds_read_b128 v[48:51], v9 offset:0
    v_dot2c_f32_bf16 v21, s27, v33
    v_mfma_f32_32x32x16_bf16 v[128:143], v[44:47], v[32:35], v[128:143]
    ds_read_b128 v[52:55], v9 offset:4096
    v_dot2c_f32_bf16 v23, v33, v33
    v_mfma_f32_32x32x16_bf16 v[80:95], v[36:39], v[40:43], v[80:95]
    ds_read_b128 v[56:59], v4 offset:6144
    v_dot2c_f32_bf16 v20, s27, v34
    v_dot2c_f32_bf16 v22, v34, v34
    v_mfma_f32_32x32x16_bf16 v[112:127], v[36:39], v[44:47], v[112:127]
    ds_read_b128 v[60:63], v4 offset:7168
    v_dot2c_f32_bf16 v21, s27, v35
    v_mfma_f32_32x32x16_bf16 v[144:159], v[44:47], v[36:39], v[144:159]
    v_dot2c_f32_bf16 v23, v35, v35
    s_waitcnt vmcnt(8)
    s_barrier
    s_lshl_b32 s28, s13, 12
    s_add_u32 s28, s28, 98304
    s_mov_b32 m0, s28
    s_add_u32 s29, s24, 384
    buffer_load_dwordx4 v2, s[16:19], s29 offen offset:0 lds
    s_add_u32 s29, s29, 9216
    buffer_load_dwordx4 v3, s[16:19], s29 offen offset:1024 lds
    s_add_u32 s29, s29, 9216
    buffer_load_dwordx4 v2, s[16:19], s29 offen offset:2048 lds
    s_add_u32 s29, s29, 9216
    buffer_load_dwordx4 v3, s[16:19], s29 offen offset:3072 lds
    s_add_u32 s28, s28, 16384
    s_mov_b32 m0, s28
    s_add_u32 s29, s25, 24576
    buffer_load_dwordx4 v1, s[8:11], s29 offen offset:0 lds
    buffer_load_dwordx4 v1, s[8:11], s29 offen offset:1024 lds
    buffer_load_dwordx4 v1, s[8:11], s29 offen offset:2048 lds
    buffer_load_dwordx4 v1, s[8:11], s29 offen offset:3072 lds
    s_waitcnt lgkmcnt(0)
    v_mfma_f32_32x32x16_bf16 v[64:79], v[48:51], v[56:59], v[64:79]
    v_dot2c_f32_bf16 v20, s27, v48
    v_dot2c_f32_bf16 v22, v48, v48
    v_mfma_f32_32x32x16_bf16 v[96:111], v[48:51], v[60:63], v[96:111]
    ds_read_b128 v[32:35], v6 offset:32768
    v_dot2c_f32_bf16 v21, s27, v49
    v_mfma_f32_32x32x16_bf16 v[128:143], v[60:63], v[48:51], v[128:143]
    ds_read_b128 v[36:39], v6 offset:36864
    v_dot2c_f32_bf16 v23, v49, v49
    v_mfma_f32_32x32x16_bf16 v[80:95], v[52:55], v[56:59], v[80:95]
    ds_read_b128 v[40:43], v4 offset:32768
    v_dot2c_f32_bf16 v20, s27, v50
    v_dot2c_f32_bf16 v22, v50, v50
    v_mfma_f32_32x32x16_bf16 v[112:127], v[52:55], v[60:63], v[112:127]
    ds_read_b128 v[44:47], v4 offset:33792
    v_dot2c_f32_bf16 v21, s27, v51
    v_mfma_f32_32x32x16_bf16 v[144:159], v[60:63], v[52:55], v[144:159]
    v_dot2c_f32_bf16 v23, v51, v51
    s_waitcnt lgkmcnt(0)
    v_mfma_f32_32x32x16_bf16 v[64:79], v[32:35], v[40:43], v[64:79]
    v_dot2c_f32_bf16 v20, s27, v32
    v_dot2c_f32_bf16 v22, v32, v32
    v_mfma_f32_32x32x16_bf16 v[96:111], v[32:35], v[44:47], v[96:111]
    ds_read_b128 v[48:51], v7 offset:32768
    v_dot2c_f32_bf16 v21, s27, v33
    v_mfma_f32_32x32x16_bf16 v[128:143], v[44:47], v[32:35], v[128:143]
    ds_read_b128 v[52:55], v7 offset:36864
    v_dot2c_f32_bf16 v23, v33, v33
    v_mfma_f32_32x32x16_bf16 v[80:95], v[36:39], v[40:43], v[80:95]
    ds_read_b128 v[56:59], v4 offset:34816
    v_dot2c_f32_bf16 v20, s27, v34
    v_dot2c_f32_bf16 v22, v34, v34
    v_mfma_f32_32x32x16_bf16 v[112:127], v[36:39], v[44:47], v[112:127]
    ds_read_b128 v[60:63], v4 offset:35840
    v_dot2c_f32_bf16 v21, s27, v35
    v_mfma_f32_32x32x16_bf16 v[144:159], v[44:47], v[36:39], v[144:159]
    v_dot2c_f32_bf16 v23, v35, v35
    s_waitcnt lgkmcnt(0)
    v_mfma_f32_32x32x16_bf16 v[64:79], v[48:51], v[56:59], v[64:79]
    v_dot2c_f32_bf16 v20, s27, v48
    v_dot2c_f32_bf16 v22, v48, v48
    v_mfma_f32_32x32x16_bf16 v[96:111], v[48:51], v[60:63], v[96:111]
    ds_read_b128 v[32:35], v8 offset:32768
    v_dot2c_f32_bf16 v21, s27, v49
    v_mfma_f32_32x32x16_bf16 v[128:143], v[60:63], v[48:51], v[128:143]
    ds_read_b128 v[36:39], v8 offset:36864
    v_dot2c_f32_bf16 v23, v49, v49
    v_mfma_f32_32x32x16_bf16 v[80:95], v[52:55], v[56:59], v[80:95]
    ds_read_b128 v[40:43], v4 offset:36864
    v_dot2c_f32_bf16 v20, s27, v50
    v_dot2c_f32_bf16 v22, v50, v50
    v_mfma_f32_32x32x16_bf16 v[112:127], v[52:55], v[60:63], v[112:127]
    ds_read_b128 v[44:47], v4 offset:37888
    v_dot2c_f32_bf16 v21, s27, v51
    v_mfma_f32_32x32x16_bf16 v[144:159], v[60:63], v[52:55], v[144:159]
    v_dot2c_f32_bf16 v23, v51, v51
    s_waitcnt lgkmcnt(0)
    v_mfma_f32_32x32x16_bf16 v[64:79], v[32:35], v[40:43], v[64:79]
    v_dot2c_f32_bf16 v20, s27, v32
    v_dot2c_f32_bf16 v22, v32, v32
    v_mfma_f32_32x32x16_bf16 v[96:111], v[32:35], v[44:47], v[96:111]
    ds_read_b128 v[48:51], v9 offset:32768
    v_dot2c_f32_bf16 v21, s27, v33
    v_mfma_f32_32x32x16_bf16 v[128:143], v[44:47], v[32:35], v[128:143]
    ds_read_b128 v[52:55], v9 offset:36864
    v_dot2c_f32_bf16 v23, v33, v33
    v_mfma_f32_32x32x16_bf16 v[80:95], v[36:39], v[40:43], v[80:95]
    ds_read_b128 v[56:59], v4 offset:38912
    v_dot2c_f32_bf16 v20, s27, v34
    v_dot2c_f32_bf16 v22, v34, v34
    v_mfma_f32_32x32x16_bf16 v[112:127], v[36:39], v[44:47], v[112:127]
    ds_read_b128 v[60:63], v4 offset:39936
    v_dot2c_f32_bf16 v21, s27, v35
    v_mfma_f32_32x32x16_bf16 v[144:159], v[44:47], v[36:39], v[144:159]
    v_dot2c_f32_bf16 v23, v35, v35
    s_waitcnt vmcnt(8)
    s_barrier
    s_lshl_b32 s28, s13, 12
    s_mov_b32 m0, s28
    s_add_u32 s29, s24, 512
    buffer_load_dwordx4 v2, s[16:19], s29 offen offset:0 lds
    s_add_u32 s29, s29, 9216
    buffer_load_dwordx4 v3, s[16:19], s29 offen offset:1024 lds
    s_add_u32 s29, s29, 9216
    buffer_load_dwordx4 v2, s[16:19], s29 offen offset:2048 lds
    s_add_u32 s29, s29, 9216
    buffer_load_dwordx4 v3, s[16:19], s29 offen offset:3072 lds
    s_add_u32 s28, s28, 16384
    s_mov_b32 m0, s28
    s_add_u32 s29, s25, 32768
    buffer_load_dwordx4 v1, s[8:11], s29 offen offset:0 lds
    buffer_load_dwordx4 v1, s[8:11], s29 offen offset:1024 lds
    buffer_load_dwordx4 v1, s[8:11], s29 offen offset:2048 lds
    buffer_load_dwordx4 v1, s[8:11], s29 offen offset:3072 lds
    s_waitcnt lgkmcnt(0)
    v_mfma_f32_32x32x16_bf16 v[64:79], v[48:51], v[56:59], v[64:79]
    v_dot2c_f32_bf16 v20, s27, v48
    v_dot2c_f32_bf16 v22, v48, v48
    v_mfma_f32_32x32x16_bf16 v[96:111], v[48:51], v[60:63], v[96:111]
    ds_read_b128 v[32:35], v10 offset:0
    v_dot2c_f32_bf16 v21, s27, v49
    v_mfma_f32_32x32x16_bf16 v[128:143], v[60:63], v[48:51], v[128:143]
    ds_read_b128 v[36:39], v10 offset:4096
    v_dot2c_f32_bf16 v23, v49, v49
    v_mfma_f32_32x32x16_bf16 v[80:95], v[52:55], v[56:59], v[80:95]
    ds_read_b128 v[40:43], v5 offset:0
    v_dot2c_f32_bf16 v20, s27, v50
    v_dot2c_f32_bf16 v22, v50, v50
    v_mfma_f32_32x32x16_bf16 v[112:127], v[52:55], v[60:63], v[112:127]
    ds_read_b128 v[44:47], v5 offset:1024
    v_dot2c_f32_bf16 v21, s27, v51
    v_mfma_f32_32x32x16_bf16 v[144:159], v[60:63], v[52:55], v[144:159]
    v_dot2c_f32_bf16 v23, v51, v51
    s_waitcnt lgkmcnt(0)
    v_mfma_f32_32x32x16_bf16 v[64:79], v[32:35], v[40:43], v[64:79]
    v_dot2c_f32_bf16 v20, s27, v32
    v_dot2c_f32_bf16 v22, v32, v32
    v_mfma_f32_32x32x16_bf16 v[96:111], v[32:35], v[44:47], v[96:111]
    ds_read_b128 v[48:51], v11 offset:0
    v_dot2c_f32_bf16 v21, s27, v33
    v_mfma_f32_32x32x16_bf16 v[128:143], v[44:47], v[32:35], v[128:143]
    ds_read_b128 v[52:55], v11 offset:4096
    v_dot2c_f32_bf16 v23, v33, v33
    v_mfma_f32_32x32x16_bf16 v[80:95], v[36:39], v[40:43], v[80:95]
    ds_read_b128 v[56:59], v5 offset:2048
    v_dot2c_f32_bf16 v20, s27, v34
    v_dot2c_f32_bf16 v22, v34, v34
    v_mfma_f32_32x32x16_bf16 v[112:127], v[36:39], v[44:47], v[112:127]
    ds_read_b128 v[60:63], v5 offset:3072
    v_dot2c_f32_bf16 v21, s27, v35
    v_mfma_f32_32x32x16_bf16 v[144:159], v[44:47], v[36:39], v[144:159]
    v_dot2c_f32_bf16 v23, v35, v35
    s_waitcnt lgkmcnt(0)
    v_mfma_f32_32x32x16_bf16 v[64:79], v[48:51], v[56:59], v[64:79]
    v_dot2c_f32_bf16 v20, s27, v48
    v_dot2c_f32_bf16 v22, v48, v48
    v_mfma_f32_32x32x16_bf16 v[96:111], v[48:51], v[60:63], v[96:111]
    ds_read_b128 v[32:35], v12 offset:0
    v_dot2c_f32_bf16 v21, s27, v49
    v_mfma_f32_32x32x16_bf16 v[128:143], v[60:63], v[48:51], v[128:143]
    ds_read_b128 v[36:39], v12 offset:4096
    v_dot2c_f32_bf16 v23, v49, v49
    v_mfma_f32_32x32x16_bf16 v[80:95], v[52:55], v[56:59], v[80:95]
    ds_read_b128 v[40:43], v5 offset:4096
    v_dot2c_f32_bf16 v20, s27, v50
    v_dot2c_f32_bf16 v22, v50, v50
    v_mfma_f32_32x32x16_bf16 v[112:127], v[52:55], v[60:63], v[112:127]
    ds_read_b128 v[44:47], v5 offset:5120
    v_dot2c_f32_bf16 v21, s27, v51
    v_mfma_f32_32x32x16_bf16 v[144:159], v[60:63], v[52:55], v[144:159]
    v_dot2c_f32_bf16 v23, v51, v51
    s_waitcnt lgkmcnt(0)
    v_mfma_f32_32x32x16_bf16 v[64:79], v[32:35], v[40:43], v[64:79]
    v_dot2c_f32_bf16 v20, s27, v32
    v_dot2c_f32_bf16 v22, v32, v32
    v_mfma_f32_32x32x16_bf16 v[96:111], v[32:35], v[44:47], v[96:111]
    ds_read_b128 v[48:51], v13 offset:0
    v_dot2c_f32_bf16 v21, s27, v33
    v_mfma_f32_32x32x16_bf16 v[128:143], v[44:47], v[32:35], v[128:143]
    ds_read_b128 v[52:55], v13 offset:4096
    v_dot2c_f32_bf16 v23, v33, v33
    v_mfma_f32_32x32x16_bf16 v[80:95], v[36:39], v[40:43], v[80:95]
    ds_read_b128 v[56:59], v5 offset:6144
    v_dot2c_f32_bf16 v20, s27, v34
    v_dot2c_f32_bf16 v22, v34, v34
    v_mfma_f32_32x32x16_bf16 v[112:127], v[36:39], v[44:47], v[112:127]
    ds_read_b128 v[60:63], v5 offset:7168
    v_dot2c_f32_bf16 v21, s27, v35
    v_mfma_f32_32x32x16_bf16 v[144:159], v[44:47], v[36:39], v[144:159]
    v_dot2c_f32_bf16 v23, v35, v35
    s_waitcnt vmcnt(8)
    s_barrier
    s_lshl_b32 s28, s13, 12
    s_add_u32 s28, s28, 32768
    s_mov_b32 m0, s28
    s_add_u32 s29, s24, 640
    buffer_load_dwordx4 v2, s[16:19], s29 offen offset:0 lds
    s_add_u32 s29, s29, 9216
    buffer_load_dwordx4 v3, s[16:19], s29 offen offset:1024 lds
    s_add_u32 s29, s29, 9216
    buffer_load_dwordx4 v2, s[16:19], s29 offen offset:2048 lds
    s_add_u32 s29, s29, 9216
    buffer_load_dwordx4 v3, s[16:19], s29 offen offset:3072 lds
    s_add_u32 s28, s28, 16384
    s_mov_b32 m0, s28
    s_add_u32 s29, s25, 40960
    buffer_load_dwordx4 v1, s[8:11], s29 offen offset:0 lds
    buffer_load_dwordx4 v1, s[8:11], s29 offen offset:1024 lds
    buffer_load_dwordx4 v1, s[8:11], s29 offen offset:2048 lds
    buffer_load_dwordx4 v1, s[8:11], s29 offen offset:3072 lds
    s_waitcnt lgkmcnt(0)
    v_mfma_f32_32x32x16_bf16 v[64:79], v[48:51], v[56:59], v[64:79]
    v_dot2c_f32_bf16 v20, s27, v48
    v_dot2c_f32_bf16 v22, v48, v48
    v_mfma_f32_32x32x16_bf16 v[96:111], v[48:51], v[60:63], v[96:111]
    ds_read_b128 v[32:35], v10 offset:32768
    v_dot2c_f32_bf16 v21, s27, v49
    v_mfma_f32_32x32x16_bf16 v[128:143], v[60:63], v[48:51], v[128:143]
    ds_read_b128 v[36:39], v10 offset:36864
    v_dot2c_f32_bf16 v23, v49, v49
    v_mfma_f32_32x32x16_bf16 v[80:95], v[52:55], v[56:59], v[80:95]
    ds_read_b128 v[40:43], v5 offset:32768
    v_dot2c_f32_bf16 v20, s27, v50
    v_dot2c_f32_bf16 v22, v50, v50
    v_mfma_f32_32x32x16_bf16 v[112:127], v[52:55], v[60:63], v[112:127]
    ds_read_b128 v[44:47], v5 offset:33792
    v_dot2c_f32_bf16 v21, s27, v51
    v_mfma_f32_32x32x16_bf16 v[144:159], v[60:63], v[52:55], v[144:159]
    v_dot2c_f32_bf16 v23, v51, v51
    s_waitcnt lgkmcnt(0)
    v_mfma_f32_32x32x16_bf16 v[64:79], v[32:35], v[40:43], v[64:79]
    v_dot2c_f32_bf16 v20, s27, v32
    v_dot2c_f32_bf16 v22, v32, v32
    v_mfma_f32_32x32x16_bf16 v[96:111], v[32:35], v[44:47], v[96:111]
    ds_read_b128 v[48:51], v11 offset:32768
    v_dot2c_f32_bf16 v21, s27, v33
    v_mfma_f32_32x32x16_bf16 v[128:143], v[44:47], v[32:35], v[128:143]
    ds_read_b128 v[52:55], v11 offset:36864
    v_dot2c_f32_bf16 v23, v33, v33
    v_mfma_f32_32x32x16_bf16 v[80:95], v[36:39], v[40:43], v[80:95]
    ds_read_b128 v[56:59], v5 offset:34816
    v_dot2c_f32_bf16 v20, s27, v34
    v_dot2c_f32_bf16 v22, v34, v34
    v_mfma_f32_32x32x16_bf16 v[112:127], v[36:39], v[44:47], v[112:127]
    ds_read_b128 v[60:63], v5 offset:35840
    v_dot2c_f32_bf16 v21, s27, v35
    v_mfma_f32_32x32x16_bf16 v[144:159], v[44:47], v[36:39], v[144:159]
    v_dot2c_f32_bf16 v23, v35, v35
    s_waitcnt lgkmcnt(0)
    v_mfma_f32_32x32x16_bf16 v[64:79], v[48:51], v[56:59], v[64:79]
    v_dot2c_f32_bf16 v20, s27, v48
    v_dot2c_f32_bf16 v22, v48, v48
    v_mfma_f32_32x32x16_bf16 v[96:111], v[48:51], v[60:63], v[96:111]
    ds_read_b128 v[32:35], v12 offset:32768
    v_dot2c_f32_bf16 v21, s27, v49
    v_mfma_f32_32x32x16_bf16 v[128:143], v[60:63], v[48:51], v[128:143]
    ds_read_b128 v[36:39], v12 offset:36864
    v_dot2c_f32_bf16 v23, v49, v49
    v_mfma_f32_32x32x16_bf16 v[80:95], v[52:55], v[56:59], v[80:95]
    ds_read_b128 v[40:43], v5 offset:36864
    v_dot2c_f32_bf16 v20, s27, v50
    v_dot2c_f32_bf16 v22, v50, v50
    v_mfma_f32_32x32x16_bf16 v[112:127], v[52:55], v[60:63], v[112:127]
    ds_read_b128 v[44:47], v5 offset:37888
    v_dot2c_f32_bf16 v21, s27, v51
    v_mfma_f32_32x32x16_bf16 v[144:159], v[60:63], v[52:55], v[144:159]
    v_dot2c_f32_bf16 v23, v51, v51
    s_waitcnt lgkmcnt(0)
    v_mfma_f32_32x32x16_bf16 v[64:79], v[32:35], v[40:43], v[64:79]
    v_dot2c_f32_bf16 v20, s27, v32
    v_dot2c_f32_bf16 v22, v32, v32
    v_mfma_f32_32x32x16_bf16 v[96:111], v[32:35], v[44:47], v[96:111]
    ds_read_b128 v[48:51], v13 offset:32768
    v_dot2c_f32_bf16 v21, s27, v33
    v_mfma_f32_32x32x16_bf16 v[128:143], v[44:47], v[32:35], v[128:143]
    ds_read_b128 v[52:55], v13 offset:36864
    v_dot2c_f32_bf16 v23, v33, v33
    v_mfma_f32_32x32x16_bf16 v[80:95], v[36:39], v[40:43], v[80:95]
    ds_read_b128 v[56:59], v5 offset:38912
    v_dot2c_f32_bf16 v20, s27, v34
    v_dot2c_f32_bf16 v22, v34, v34
    v_mfma_f32_32x32x16_bf16 v[112:127], v[36:39], v[44:47], v[112:127]
    ds_read_b128 v[60:63], v5 offset:39936
    v_dot2c_f32_bf16 v21, s27, v35
    v_mfma_f32_32x32x16_bf16 v[144:159], v[44:47], v[36:39], v[144:159]
    v_dot2c_f32_bf16 v23, v35, v35
    s_waitcnt vmcnt(8)
    s_barrier
    s_lshl_b32 s28, s13, 12
    s_add_u32 s28, s28, 65536
    s_mov_b32 m0, s28
    s_add_u32 s29, s24, 768
    buffer_load_dwordx4 v2, s[16:19], s29 offen offset:0 lds
    s_add_u32 s29, s29, 9216
    buffer_load_dwordx4 v3, s[16:19], s29 offen offset:1024 lds
    s_add_u32 s29, s29, 9216
    buffer_load_dwordx4 v2, s[16:19], s29 offen offset:2048 lds
    s_add_u32 s29, s29, 9216
    buffer_load_dwordx4 v3, s[16:19], s29 offen offset:3072 lds
    s_add_u32 s28, s28, 16384
    s_mov_b32 m0, s28
    s_add_u32 s29, s25, 49152
    buffer_load_dwordx4 v1, s[8:11], s29 offen offset:0 lds
    buffer_load_dwordx4 v1, s[8:11], s29 offen offset:1024 lds
    buffer_load_dwordx4 v1, s[8:11], s29 offen offset:2048 lds
    buffer_load_dwordx4 v1, s[8:11], s29 offen offset:3072 lds
    s_waitcnt lgkmcnt(0)
    v_mfma_f32_32x32x16_bf16 v[64:79], v[48:51], v[56:59], v[64:79]
    v_dot2c_f32_bf16 v20, s27, v48
    v_dot2c_f32_bf16 v22, v48, v48
    v_mfma_f32_32x32x16_bf16 v[96:111], v[48:51], v[60:63], v[96:111]
    ds_read_b128 v[32:35], v6 offset:0
    v_dot2c_f32_bf16 v21, s27, v49
    v_mfma_f32_32x32x16_bf16 v[128:143], v[60:63], v[48:51], v[128:143]
    ds_read_b128 v[36:39], v6 offset:4096
    v_dot2c_f32_bf16 v23, v49, v49
    v_mfma_f32_32x32x16_bf16 v[80:95], v[52:55], v[56:59], v[80:95]
    ds_read_b128 v[40:43], v4 offset:0
    v_dot2c_f32_bf16 v20, s27, v50
    v_dot2c_f32_bf16 v22, v50, v50
    v_mfma_f32_32x32x16_bf16 v[112:127], v[52:55], v[60:63], v[112:127]
    ds_read_b128 v[44:47], v4 offset:1024
    v_dot2c_f32_bf16 v21, s27, v51
    v_mfma_f32_32x32x16_bf16 v[144:159], v[60:63], v[52:55], v[144:159]
    v_dot2c_f32_bf16 v23, v51, v51
    s_waitcnt lgkmcnt(0)
    v_mfma_f32_32x32x16_bf16 v[64:79], v[32:35], v[40:43], v[64:79]
    v_dot2c_f32_bf16 v20, s27, v32
    v_dot2c_f32_bf16 v22, v32, v32
    v_mfma_f32_32x32x16_bf16 v[96:111], v[32:35], v[44:47], v[96:111]
    ds_read_b128 v[48:51], v7 offset:0
    v_dot2c_f32_bf16 v21, s27, v33
    v_mfma_f32_32x32x16_bf16 v[128:143], v[44:47], v[32:35], v[128:143]
    ds_read_b128 v[52:55], v7 offset:4096
    v_dot2c_f32_bf16 v23, v33, v33
    v_mfma_f32_32x32x16_bf16 v[80:95], v[36:39], v[40:43], v[80:95]
    ds_read_b128 v[56:59], v4 offset:2048
    v_dot2c_f32_bf16 v20, s27, v34
    v_dot2c_f32_bf16 v22, v34, v34
    v_mfma_f32_32x32x16_bf16 v[112:127], v[36:39], v[44:47], v[112:127]
    ds_read_b128 v[60:63], v4 offset:3072
    v_dot2c_f32_bf16 v21, s27, v35
    v_mfma_f32_32x32x16_bf16 v[144:159], v[44:47], v[36:39], v[144:159]
    v_dot2c_f32_bf16 v23, v35, v35
    s_waitcnt lgkmcnt(0)
    v_mfma_f32_32x32x16_bf16 v[64:79], v[48:51], v[56:59], v[64:79]
    v_dot2c_f32_bf16 v20, s27, v48
    v_dot2c_f32_bf16 v22, v48, v48
    v_mfma_f32_32x32x16_bf16 v[96:111], v[48:51], v[60:63], v[96:111]
    ds_read_b128 v[32:35], v8 offset:0
    v_dot2c_f32_bf16 v21, s27, v49
    v_mfma_f32_32x32x16_bf16 v[128:143], v[60:63], v[48:51], v[128:143]
    ds_read_b128 v[36:39], v8 offset:4096
    v_dot2c_f32_bf16 v23, v49, v49
    v_mfma_f32_32x32x16_bf16 v[80:95], v[52:55], v[56:59], v[80:95]
    ds_read_b128 v[40:43], v4 offset:4096
    v_dot2c_f32_bf16 v20, s27, v50
    v_dot2c_f32_bf16 v22, v50, v50
    v_mfma_f32_32x32x16_bf16 v[112:127], v[52:55], v[60:63], v[112:127]
    ds_read_b128 v[44:47], v4 offset:5120
    v_dot2c_f32_bf16 v21, s27, v51
    v_mfma_f32_32x32x16_bf16 v[144:159], v[60:63], v[52:55], v[144:159]
    v_dot2c_f32_bf16 v23, v51, v51
    s_waitcnt lgkmcnt(0)
    v_mfma_f32_32x32x16_bf16 v[64:79], v[32:35], v[40:43], v[64:79]
    v_dot2c_f32_bf16 v20, s27, v32
    v_dot2c_f32_bf16 v22, v32, v32
    v_mfma_f32_32x32x16_bf16 v[96:111], v[32:35], v[44:47], v[96:111]
    ds_read_b128 v[48:51], v9 offset:0
    v_dot2c_f32_bf16 v21, s27, v33
    v_mfma_f32_32x32x16_bf16 v[128:143], v[44:47], v[32:35], v[128:143]
    ds_read_b128 v[52:55], v9 offset:4096
    v_dot2c_f32_bf16 v23, v33, v33
    v_mfma_f32_32x32x16_bf16 v[80:95], v[36:39], v[40:43], v[80:95]
    ds_read_b128 v[56:59], v4 offset:6144
    v_dot2c_f32_bf16 v20, s27, v34
    v_dot2c_f32_bf16 v22, v34, v34
    v_mfma_f32_32x32x16_bf16 v[112:127], v[36:39], v[44:47], v[112:127]
    ds_read_b128 v[60:63], v4 offset:7168
    v_dot2c_f32_bf16 v21, s27, v35
    v_mfma_f32_32x32x16_bf16 v[144:159], v[44:47], v[36:39], v[144:159]
    v_dot2c_f32_bf16 v23, v35, v35
    s_waitcnt vmcnt(8)
    s_barrier
    s_lshl_b32 s28, s13, 12
    s_add_u32 s28, s28, 98304
    s_mov_b32 m0, s28
    s_add_u32 s29, s24, 896
    buffer_load_dwordx4 v2, s[16:19], s29 offen offset:0 lds
    s_add_u32 s29, s29, 9216
    buffer_load_dwordx4 v3, s[16:19], s29 offen offset:1024 lds
    s_add_u32 s29, s29, 9216
    buffer_load_dwordx4 v2, s[16:19], s29 offen offset:2048 lds
    s_add_u32 s29, s29, 9216
    buffer_load_dwordx4 v3, s[16:19], s29 offen offset:3072 lds
    s_add_u32 s28, s28, 16384
    s_mov_b32 m0, s28
    s_add_u32 s29, s25, 57344
    buffer_load_dwordx4 v1, s[8:11], s29 offen offset:0 lds
    buffer_load_dwordx4 v1, s[8:11], s29 offen offset:1024 lds
    buffer_load_dwordx4 v1, s[8:11], s29 offen offset:2048 lds
    buffer_load_dwordx4 v1, s[8:11], s29 offen offset:3072 lds
    s_waitcnt lgkmcnt(0)
    v_mfma_f32_32x32x16_bf16 v[64:79], v[48:51], v[56:59], v[64:79]
    v_dot2c_f32_bf16 v20, s27, v48
    v_dot2c_f32_bf16 v22, v48, v48
    v_mfma_f32_32x32x16_bf16 v[96:111], v[48:51], v[60:63], v[96:111]
    ds_read_b128 v[32:35], v6 offset:32768
    v_dot2c_f32_bf16 v21, s27, v49
    v_mfma_f32_32x32x16_bf16 v[128:143], v[60:63], v[48:51], v[128:143]
    ds_read_b128 v[36:39], v6 offset:36864
    v_dot2c_f32_bf16 v23, v49, v49
    v_mfma_f32_32x32x16_bf16 v[80:95], v[52:55], v[56:59], v[80:95]
    ds_read_b128 v[40:43], v4 offset:32768
    v_dot2c_f32_bf16 v20, s27, v50
    v_dot2c_f32_bf16 v22, v50, v50
    v_mfma_f32_32x32x16_bf16 v[112:127], v[52:55], v[60:63], v[112:127]
    ds_read_b128 v[44:47], v4 offset:33792
    v_dot2c_f32_bf16 v21, s27, v51
    v_mfma_f32_32x32x16_bf16 v[144:159], v[60:63], v[52:55], v[144:159]
    v_dot2c_f32_bf16 v23, v51, v51
    s_waitcnt lgkmcnt(0)
    v_mfma_f32_32x32x16_bf16 v[64:79], v[32:35], v[40:43], v[64:79]
    v_dot2c_f32_bf16 v20, s27, v32
    v_dot2c_f32_bf16 v22, v32, v32
    v_mfma_f32_32x32x16_bf16 v[96:111], v[32:35], v[44:47], v[96:111]
    ds_read_b128 v[48:51], v7 offset:32768
    v_dot2c_f32_bf16 v21, s27, v33
    v_mfma_f32_32x32x16_bf16 v[128:143], v[44:47], v[32:35], v[128:143]
    ds_read_b128 v[52:55], v7 offset:36864
    v_dot2c_f32_bf16 v23, v33, v33
    v_mfma_f32_32x32x16_bf16 v[80:95], v[36:39], v[40:43], v[80:95]
    ds_read_b128 v[56:59], v4 offset:34816
    v_dot2c_f32_bf16 v20, s27, v34
    v_dot2c_f32_bf16 v22, v34, v34
    v_mfma_f32_32x32x16_bf16 v[112:127], v[36:39], v[44:47], v[112:127]
    ds_read_b128 v[60:63], v4 offset:35840
    v_dot2c_f32_bf16 v21, s27, v35
    v_mfma_f32_32x32x16_bf16 v[144:159], v[44:47], v[36:39], v[144:159]
    v_dot2c_f32_bf16 v23, v35, v35
    s_waitcnt lgkmcnt(0)
    v_mfma_f32_32x32x16_bf16 v[64:79], v[48:51], v[56:59], v[64:79]
    v_dot2c_f32_bf16 v20, s27, v48
    v_dot2c_f32_bf16 v22, v48, v48
    v_mfma_f32_32x32x16_bf16 v[96:111], v[48:51], v[60:63], v[96:111]
    ds_read_b128 v[32:35], v8 offset:32768
    v_dot2c_f32_bf16 v21, s27, v49
    v_mfma_f32_32x32x16_bf16 v[128:143], v[60:63], v[48:51], v[128:143]
    ds_read_b128 v[36:39], v8 offset:36864
    v_dot2c_f32_bf16 v23, v49, v49
    v_mfma_f32_32x32x16_bf16 v[80:95], v[52:55], v[56:59], v[80:95]
    ds_read_b128 v[40:43], v4 offset:36864
    v_dot2c_f32_bf16 v20, s27, v50
    v_dot2c_f32_bf16 v22, v50, v50
    v_mfma_f32_32x32x16_bf16 v[112:127], v[52:55], v[60:63], v[112:127]
    ds_read_b128 v[44:47], v4 offset:37888
    v_dot2c_f32_bf16 v21, s27, v51
    v_mfma_f32_32x32x16_bf16 v[144:159], v[60:63], v[52:55], v[144:159]
    v_dot2c_f32_bf16 v23, v51, v51
    s_waitcnt lgkmcnt(0)
    v_mfma_f32_32x32x16_bf16 v[64:79], v[32:35], v[40:43], v[64:79]
    v_dot2c_f32_bf16 v20, s27, v32
    v_dot2c_f32_bf16 v22, v32, v32
    v_mfma_f32_32x32x16_bf16 v[96:111], v[32:35], v[44:47], v[96:111]
    ds_read_b128 v[48:51], v9 offset:32768
    v_dot2c_f32_bf16 v21, s27, v33
    v_mfma_f32_32x32x16_bf16 v[128:143], v[44:47], v[32:35], v[128:143]
    ds_read_b128 v[52:55], v9 offset:36864
    v_dot2c_f32_bf16 v23, v33, v33
    v_mfma_f32_32x32x16_bf16 v[80:95], v[36:39], v[40:43], v[80:95]
    ds_read_b128 v[56:59], v4 offset:38912
    v_dot2c_f32_bf16 v20, s27, v34
    v_dot2c_f32_bf16 v22, v34, v34
    v_mfma_f32_32x32x16_bf16 v[112:127], v[36:39], v[44:47], v[112:127]
    ds_read_b128 v[60:63], v4 offset:39936
    v_dot2c_f32_bf16 v21, s27, v35
    v_mfma_f32_32x32x16_bf16 v[144:159], v[44:47], v[36:39], v[144:159]
    v_dot2c_f32_bf16 v23, v35, v35
    s_waitcnt vmcnt(8)
    s_barrier
    s_lshl_b32 s28, s13, 12
    s_mov_b32 m0, s28
    s_add_u32 s29, s24, 1024
    buffer_load_dwordx4 v2, s[16:19], s29 offen offset:0 lds
    s_add_u32 s29, s29, 9216
    buffer_load_dwordx4 v3, s[16:19], s29 offen offset:1024 lds
    s_add_u32 s29, s29, 9216
    buffer_load_dwordx4 v2, s[16:19], s29 offen offset:2048 lds
    s_add_u32 s29, s29, 9216
    buffer_load_dwordx4 v3, s[16:19], s29 offen offset:3072 lds
    s_add_u32 s28, s28, 16384
    s_mov_b32 m0, s28
    s_add_u32 s29, s25, 65536
    buffer_load_dwordx4 v1, s[8:11], s29 offen offset:0 lds
    buffer_load_dwordx4 v1, s[8:11], s29 offen offset:1024 lds
    buffer_load_dwordx4 v1, s[8:11], s29 offen offset:2048 lds
    buffer_load_dwordx4 v1, s[8:11], s29 offen offset:3072 lds
    s_waitcnt lgkmcnt(0)
    v_mfma_f32_32x32x16_bf16 v[64:79], v[48:51], v[56:59], v[64:79]
    v_dot2c_f32_bf16 v20, s27, v48
    v_dot2c_f32_bf16 v22, v48, v48
    v_mfma_f32_32x32x16_bf16 v[96:111], v[48:51], v[60:63], v[96:111]
    ds_read_b128 v[32:35], v10 offset:0
    v_dot2c_f32_bf16 v21, s27, v49
    v_mfma_f32_32x32x16_bf16 v[128:143], v[60:63], v[48:51], v[128:143]
    ds_read_b128 v[36:39], v10 offset:4096
    v_dot2c_f32_bf16 v23, v49, v49
    v_mfma_f32_32x32x16_bf16 v[80:95], v[52:55], v[56:59], v[80:95]
    ds_read_b128 v[40:43], v5 offset:0
    v_dot2c_f32_bf16 v20, s27, v50
    v_dot2c_f32_bf16 v22, v50, v50
    v_mfma_f32_32x32x16_bf16 v[112:127], v[52:55], v[60:63], v[112:127]
    ds_read_b128 v[44:47], v5 offset:1024
    v_dot2c_f32_bf16 v21, s27, v51
    v_mfma_f32_32x32x16_bf16 v[144:159], v[60:63], v[52:55], v[144:159]
    v_dot2c_f32_bf16 v23, v51, v51
    s_waitcnt lgkmcnt(0)
    v_mfma_f32_32x32x16_bf16 v[64:79], v[32:35], v[40:43], v[64:79]
    v_dot2c_f32_bf16 v20, s27, v32
    v_dot2c_f32_bf16 v22, v32, v32
    v_mfma_f32_32x32x16_bf16 v[96:111], v[32:35], v[44:47], v[96:111]
    ds_read_b128 v[48:51], v11 offset:0
    v_dot2c_f32_bf16 v21, s27, v33
    v_mfma_f32_32x32x16_bf16 v[128:143], v[44:47], v[32:35], v[128:143]
    ds_read_b128 v[52:55], v11 offset:4096
    v_dot2c_f32_bf16 v23, v33, v33
    v_mfma_f32_32x32x16_bf16 v[80:95], v[36:39], v[40:43], v[80:95]
    ds_read_b128 v[56:59], v5 offset:2048
    v_dot2c_f32_bf16 v20, s27, v34
    v_dot2c_f32_bf16 v22, v34, v34
    v_mfma_f32_32x32x16_bf16 v[112:127], v[36:39], v[44:47], v[112:127]
    ds_read_b128 v[60:63], v5 offset:3072
    v_dot2c_f32_bf16 v21, s27, v35
    v_mfma_f32_32x32x16_bf16 v[144:159], v[44:47], v[36:39], v[144:159]
    v_dot2c_f32_bf16 v23, v35, v35
    s_waitcnt lgkmcnt(0)
    v_mfma_f32_32x32x16_bf16 v[64:79], v[48:51], v[56:59], v[64:79]
    v_dot2c_f32_bf16 v20, s27, v48
    v_dot2c_f32_bf16 v22, v48, v48
    v_mfma_f32_32x32x16_bf16 v[96:111], v[48:51], v[60:63], v[96:111]
    ds_read_b128 v[32:35], v12 offset:0
    v_dot2c_f32_bf16 v21, s27, v49
    v_mfma_f32_32x32x16_bf16 v[128:143], v[60:63], v[48:51], v[128:143]
    ds_read_b128 v[36:39], v12 offset:4096
    v_dot2c_f32_bf16 v23, v49, v49
    v_mfma_f32_32x32x16_bf16 v[80:95], v[52:55], v[56:59], v[80:95]
    ds_read_b128 v[40:43], v5 offset:4096
    v_dot2c_f32_bf16 v20, s27, v50
    v_dot2c_f32_bf16 v22, v50, v50
    v_mfma_f32_32x32x16_bf16 v[112:127], v[52:55], v[60:63], v[112:127]
    ds_read_b128 v[44:47], v5 offset:5120
    v_dot2c_f32_bf16 v21, s27, v51
    v_mfma_f32_32x32x16_bf16 v[144:159], v[60:63], v[52:55], v[144:159]
    v_dot2c_f32_bf16 v23, v51, v51
    s_waitcnt lgkmcnt(0)
    v_mfma_f32_32x32x16_bf16 v[64:79], v[32:35], v[40:43], v[64:79]
    v_dot2c_f32_bf16 v20, s27, v32
    v_dot2c_f32_bf16 v22, v32, v32
    v_mfma_f32_32x32x16_bf16 v[96:111], v[32:35], v[44:47], v[96:111]
    ds_read_b128 v[48:51], v13 offset:0
    v_dot2c_f32_bf16 v21, s27, v33
    v_mfma_f32_32x32x16_bf16 v[128:143], v[44:47], v[32:35], v[128:143]
    ds_read_b128 v[52:55], v13 offset:4096
    v_dot2c_f32_bf16 v23, v33, v33
    v_mfma_f32_32x32x16_bf16 v[80:95], v[36:39], v[40:43], v[80:95]
    ds_read_b128 v[56:59], v5 offset:6144
    v_dot2c_f32_bf16 v20, s27, v34
    v_dot2c_f32_bf16 v22, v34, v34
    v_mfma_f32_32x32x16_bf16 v[112:127], v[36:39], v[44:47], v[112:127]
    ds_read_b128 v[60:63], v5 offset:7168
    v_dot2c_f32_bf16 v21, s27, v35
    v_mfma_f32_32x32x16_bf16 v[144:159], v[44:47], v[36:39], v[144:159]
    v_dot2c_f32_bf16 v23, v35, v35
    s_waitcnt vmcnt(8)
    s_barrier
    s_lshl_b32 s28, s13, 12
    s_add_u32 s28, s28, 32768
    s_mov_b32 m0, s28
    s_add_u32 s29, s24, 1152
    buffer_load_dwordx4 v2, s[16:19], s29 offen offset:0 lds
    s_add_u32 s29, s29, 9216
    buffer_load_dwordx4 v3, s[16:19], s29 offen offset:1024 lds
    s_add_u32 s29, s29, 9216
    buffer_load_dwordx4 v2, s[16:19], s29 offen offset:2048 lds
    s_add_u32 s29, s29, 9216
    buffer_load_dwordx4 v3, s[16:19], s29 offen offset:3072 lds
    s_add_u32 s28, s28, 16384
    s_mov_b32 m0, s28
    s_add_u32 s29, s25, 73728
    buffer_load_dwordx4 v1, s[8:11], s29 offen offset:0 lds
    buffer_load_dwordx4 v1, s[8:11], s29 offen offset:1024 lds
    buffer_load_dwordx4 v1, s[8:11], s29 offen offset:2048 lds
    buffer_load_dwordx4 v1, s[8:11], s29 offen offset:3072 lds
    s_waitcnt lgkmcnt(0)
    v_mfma_f32_32x32x16_bf16 v[64:79], v[48:51], v[56:59], v[64:79]
    v_dot2c_f32_bf16 v20, s27, v48
    v_dot2c_f32_bf16 v22, v48, v48
    v_mfma_f32_32x32x16_bf16 v[96:111], v[48:51], v[60:63], v[96:111]
    ds_read_b128 v[32:35], v10 offset:32768
    v_dot2c_f32_bf16 v21, s27, v49
    v_mfma_f32_32x32x16_bf16 v[128:143], v[60:63], v[48:51], v[128:143]
    ds_read_b128 v[36:39], v10 offset:36864
    v_dot2c_f32_bf16 v23, v49, v49
    v_mfma_f32_32x32x16_bf16 v[80:95], v[52:55], v[56:59], v[80:95]
    ds_read_b128 v[40:43], v5 offset:32768
    v_dot2c_f32_bf16 v20, s27, v50
    v_dot2c_f32_bf16 v22, v50, v50
    v_mfma_f32_32x32x16_bf16 v[112:127], v[52:55], v[60:63], v[112:127]
    ds_read_b128 v[44:47], v5 offset:33792
    v_dot2c_f32_bf16 v21, s27, v51
    v_mfma_f32_32x32x16_bf16 v[144:159], v[60:63], v[52:55], v[144:159]
    v_dot2c_f32_bf16 v23, v51, v51
    s_waitcnt lgkmcnt(0)
    v_mfma_f32_32x32x16_bf16 v[64:79], v[32:35], v[40:43], v[64:79]
    v_dot2c_f32_bf16 v20, s27, v32
    v_dot2c_f32_bf16 v22, v32, v32
    v_mfma_f32_32x32x16_bf16 v[96:111], v[32:35], v[44:47], v[96:111]
    ds_read_b128 v[48:51], v11 offset:32768
    v_dot2c_f32_bf16 v21, s27, v33
    v_mfma_f32_32x32x16_bf16 v[128:143], v[44:47], v[32:35], v[128:143]
    ds_read_b128 v[52:55], v11 offset:36864
    v_dot2c_f32_bf16 v23, v33, v33
    v_mfma_f32_32x32x16_bf16 v[80:95], v[36:39], v[40:43], v[80:95]
    ds_read_b128 v[56:59], v5 offset:34816
    v_dot2c_f32_bf16 v20, s27, v34
    v_dot2c_f32_bf16 v22, v34, v34
    v_mfma_f32_32x32x16_bf16 v[112:127], v[36:39], v[44:47], v[112:127]
    ds_read_b128 v[60:63], v5 offset:35840
    v_dot2c_f32_bf16 v21, s27, v35
    v_mfma_f32_32x32x16_bf16 v[144:159], v[44:47], v[36:39], v[144:159]
    v_dot2c_f32_bf16 v23, v35, v35
    s_waitcnt lgkmcnt(0)
    v_mfma_f32_32x32x16_bf16 v[64:79], v[48:51], v[56:59], v[64:79]
    v_dot2c_f32_bf16 v20, s27, v48
    v_dot2c_f32_bf16 v22, v48, v48
    v_mfma_f32_32x32x16_bf16 v[96:111], v[48:51], v[60:63], v[96:111]
    ds_read_b128 v[32:35], v12 offset:32768
    v_dot2c_f32_bf16 v21, s27, v49
    v_mfma_f32_32x32x16_bf16 v[128:143], v[60:63], v[48:51], v[128:143]
    ds_read_b128 v[36:39], v12 offset:36864
    v_dot2c_f32_bf16 v23, v49, v49
    v_mfma_f32_32x32x16_bf16 v[80:95], v[52:55], v[56:59], v[80:95]
    ds_read_b128 v[40:43], v5 offset:36864
    v_dot2c_f32_bf16 v20, s27, v50
    v_dot2c_f32_bf16 v22, v50, v50
    v_mfma_f32_32x32x16_bf16 v[112:127], v[52:55], v[60:63], v[112:127]
    ds_read_b128 v[44:47], v5 offset:37888
    v_dot2c_f32_bf16 v21, s27, v51
    v_mfma_f32_32x32x16_bf16 v[144:159], v[60:63], v[52:55], v[144:159]
    v_dot2c_f32_bf16 v23, v51, v51
    s_waitcnt lgkmcnt(0)
    v_mfma_f32_32x32x16_bf16 v[64:79], v[32:35], v[40:43], v[64:79]
    v_dot2c_f32_bf16 v20, s27, v32
    v_dot2c_f32_bf16 v22, v32, v32
    v_mfma_f32_32x32x16_bf16 v[96:111], v[32:35], v[44:47], v[96:111]
    ds_read_b128 v[48:51], v13 offset:32768
    v_dot2c_f32_bf16 v21, s27, v33
    v_mfma_f32_32x32x16_bf16 v[128:143], v[44:47], v[32:35], v[128:143]
    ds_read_b128 v[52:55], v13 offset:36864
    v_dot2c_f32_bf16 v23, v33, v33
    v_mfma_f32_32x32x16_bf16 v[80:95], v[36:39], v[40:43], v[80:95]
    ds_read_b128 v[56:59], v5 offset:38912
    v_dot2c_f32_bf16 v20, s27, v34
    v_dot2c_f32_bf16 v22, v34, v34
    v_mfma_f32_32x32x16_bf16 v[112:127], v[36:39], v[44:47], v[112:127]
    ds_read_b128 v[60:63], v5 offset:39936
    v_dot2c_f32_bf16 v21, s27, v35
    v_mfma_f32_32x32x16_bf16 v[144:159], v[44:47], v[36:39], v[144:159]
    v_dot2c_f32_bf16 v23, v35, v35
    s_waitcnt vmcnt(8)
    s_barrier
    s_waitcnt lgkmcnt(0)
    v_mfma_f32_32x32x16_bf16 v[64:79], v[48:51], v[56:59], v[64:79]
    v_dot2c_f32_bf16 v20, s27, v48
    v_dot2c_f32_bf16 v22, v48, v48
    v_mfma_f32_32x32x16_bf16 v[96:111], v[48:51], v[60:63], v[96:111]
    ds_read_b128 v[32:35], v6 offset:0
    v_dot2c_f32_bf16 v21, s27, v49
    v_mfma_f32_32x32x16_bf16 v[128:143], v[60:63], v[48:51], v[128:143]
    ds_read_b128 v[36:39], v6 offset:4096
    v_dot2c_f32_bf16 v23, v49, v49
    v_mfma_f32_32x32x16_bf16 v[80:95], v[52:55], v[56:59], v[80:95]
    ds_read_b128 v[40:43], v4 offset:0
    v_dot2c_f32_bf16 v20, s27, v50
    v_dot2c_f32_bf16 v22, v50, v50
    v_mfma_f32_32x32x16_bf16 v[112:127], v[52:55], v[60:63], v[112:127]
    ds_read_b128 v[44:47], v4 offset:1024
    v_dot2c_f32_bf16 v21, s27, v51
    v_mfma_f32_32x32x16_bf16 v[144:159], v[60:63], v[52:55], v[144:159]
    v_dot2c_f32_bf16 v23, v51, v51
    s_waitcnt lgkmcnt(0)
    v_mfma_f32_32x32x16_bf16 v[64:79], v[32:35], v[40:43], v[64:79]
    v_dot2c_f32_bf16 v20, s27, v32
    v_dot2c_f32_bf16 v22, v32, v32
    v_mfma_f32_32x32x16_bf16 v[96:111], v[32:35], v[44:47], v[96:111]
    ds_read_b128 v[48:51], v7 offset:0
    v_dot2c_f32_bf16 v21, s27, v33
    v_mfma_f32_32x32x16_bf16 v[128:143], v[44:47], v[32:35], v[128:143]
    ds_read_b128 v[52:55], v7 offset:4096
    v_dot2c_f32_bf16 v23, v33, v33
    v_mfma_f32_32x32x16_bf16 v[80:95], v[36:39], v[40:43], v[80:95]
    ds_read_b128 v[56:59], v4 offset:2048
    v_dot2c_f32_bf16 v20, s27, v34
    v_dot2c_f32_bf16 v22, v34, v34
    v_mfma_f32_32x32x16_bf16 v[112:127], v[36:39], v[44:47], v[112:127]
    ds_read_b128 v[60:63], v4 offset:3072
    v_dot2c_f32_bf16 v21, s27, v35
    v_mfma_f32_32x32x16_bf16 v[144:159], v[44:47], v[36:39], v[144:159]
    v_dot2c_f32_bf16 v23, v35, v35
    s_waitcnt lgkmcnt(0)
    v_mfma_f32_32x32x16_bf16 v[64:79], v[48:51], v[56:59], v[64:79]
    v_dot2c_f32_bf16 v20, s27, v48
    v_dot2c_f32_bf16 v22, v48, v48
    v_mfma_f32_32x32x16_bf16 v[96:111], v[48:51], v[60:63], v[96:111]
    ds_read_b128 v[32:35], v8 offset:0
    v_dot2c_f32_bf16 v21, s27, v49
    v_mfma_f32_32x32x16_bf16 v[128:143], v[60:63], v[48:51], v[128:143]
    ds_read_b128 v[36:39], v8 offset:4096
    v_dot2c_f32_bf16 v23, v49, v49
    v_mfma_f32_32x32x16_bf16 v[80:95], v[52:55], v[56:59], v[80:95]
    ds_read_b128 v[40:43], v4 offset:4096
    v_dot2c_f32_bf16 v20, s27, v50
    v_dot2c_f32_bf16 v22, v50, v50
    v_mfma_f32_32x32x16_bf16 v[112:127], v[52:55], v[60:63], v[112:127]
    ds_read_b128 v[44:47], v4 offset:5120
    v_dot2c_f32_bf16 v21, s27, v51
    v_mfma_f32_32x32x16_bf16 v[144:159], v[60:63], v[52:55], v[144:159]
    v_dot2c_f32_bf16 v23, v51, v51
    s_waitcnt lgkmcnt(0)
    v_mfma_f32_32x32x16_bf16 v[64:79], v[32:35], v[40:43], v[64:79]
    v_dot2c_f32_bf16 v20, s27, v32
    v_dot2c_f32_bf16 v22, v32, v32
    v_mfma_f32_32x32x16_bf16 v[96:111], v[32:35], v[44:47], v[96:111]
    ds_read_b128 v[48:51], v9 offset:0
    v_dot2c_f32_bf16 v21, s27, v33
    v_mfma_f32_32x32x16_bf16 v[128:143], v[44:47], v[32:35], v[128:143]
    ds_read_b128 v[52:55], v9 offset:4096
    v_dot2c_f32_bf16 v23, v33, v33
    v_mfma_f32_32x32x16_bf16 v[80:95], v[36:39], v[40:43], v[80:95]
    ds_read_b128 v[56:59], v4 offset:6144
    v_dot2c_f32_bf16 v20, s27, v34
    v_dot2c_f32_bf16 v22, v34, v34
    v_mfma_f32_32x32x16_bf16 v[112:127], v[36:39], v[44:47], v[112:127]
    ds_read_b128 v[60:63], v4 offset:7168
    v_dot2c_f32_bf16 v21, s27, v35
    v_mfma_f32_32x32x16_bf16 v[144:159], v[44:47], v[36:39], v[144:159]
    v_dot2c_f32_bf16 v23, v35, v35
    s_waitcnt vmcnt(0)
    s_barrier
    s_waitcnt lgkmcnt(0)
    v_mfma_f32_32x32x16_bf16 v[64:79], v[48:51], v[56:59], v[64:79]
    v_dot2c_f32_bf16 v20, s27, v48
    v_dot2c_f32_bf16 v22, v48, v48
    v_mfma_f32_32x32x16_bf16 v[96:111], v[48:51], v[60:63], v[96:111]
    ds_read_b128 v[32:35], v6 offset:32768
    v_dot2c_f32_bf16 v21, s27, v49
    v_mfma_f32_32x32x16_bf16 v[128:143], v[60:63], v[48:51], v[128:143]
    ds_read_b128 v[36:39], v6 offset:36864
    v_dot2c_f32_bf16 v23, v49, v49
    v_mfma_f32_32x32x16_bf16 v[80:95], v[52:55], v[56:59], v[80:95]
    ds_read_b128 v[40:43], v4 offset:32768
    v_dot2c_f32_bf16 v20, s27, v50
    v_dot2c_f32_bf16 v22, v50, v50
    v_mfma_f32_32x32x16_bf16 v[112:127], v[52:55], v[60:63], v[112:127]
    ds_read_b128 v[44:47], v4 offset:33792
    v_dot2c_f32_bf16 v21, s27, v51
    v_mfma_f32_32x32x16_bf16 v[144:159], v[60:63], v[52:55], v[144:159]
    v_dot2c_f32_bf16 v23, v51, v51
    s_waitcnt lgkmcnt(0)
    v_mfma_f32_32x32x16_bf16 v[64:79], v[32:35], v[40:43], v[64:79]
    v_dot2c_f32_bf16 v20, s27, v32
    v_dot2c_f32_bf16 v22, v32, v32
    v_mfma_f32_32x32x16_bf16 v[96:111], v[32:35], v[44:47], v[96:111]
    ds_read_b128 v[48:51], v7 offset:32768
    v_dot2c_f32_bf16 v21, s27, v33
    v_mfma_f32_32x32x16_bf16 v[128:143], v[44:47], v[32:35], v[128:143]
    ds_read_b128 v[52:55], v7 offset:36864
    v_dot2c_f32_bf16 v23, v33, v33
    v_mfma_f32_32x32x16_bf16 v[80:95], v[36:39], v[40:43], v[80:95]
    ds_read_b128 v[56:59], v4 offset:34816
    v_dot2c_f32_bf16 v20, s27, v34
    v_dot2c_f32_bf16 v22, v34, v34
    v_mfma_f32_32x32x16_bf16 v[112:127], v[36:39], v[44:47], v[112:127]
    ds_read_b128 v[60:63], v4 offset:35840
    v_dot2c_f32_bf16 v21, s27, v35
    v_mfma_f32_32x32x16_bf16 v[144:159], v[44:47], v[36:39], v[144:159]
    v_dot2c_f32_bf16 v23, v35, v35
    s_waitcnt lgkmcnt(0)
    v_mfma_f32_32x32x16_bf16 v[64:79], v[48:51], v[56:59], v[64:79]
    v_dot2c_f32_bf16 v20, s27, v48
    v_dot2c_f32_bf16 v22, v48, v48
    v_mfma_f32_32x32x16_bf16 v[96:111], v[48:51], v[60:63], v[96:111]
    ds_read_b128 v[32:35], v8 offset:32768
    v_dot2c_f32_bf16 v21, s27, v49
    v_mfma_f32_32x32x16_bf16 v[128:143], v[60:63], v[48:51], v[128:143]
    ds_read_b128 v[36:39], v8 offset:36864
    v_dot2c_f32_bf16 v23, v49, v49
    v_mfma_f32_32x32x16_bf16 v[80:95], v[52:55], v[56:59], v[80:95]
    ds_read_b128 v[40:43], v4 offset:36864
    v_dot2c_f32_bf16 v20, s27, v50
    v_dot2c_f32_bf16 v22, v50, v50
    v_mfma_f32_32x32x16_bf16 v[112:127], v[52:55], v[60:63], v[112:127]
    ds_read_b128 v[44:47], v4 offset:37888
    v_dot2c_f32_bf16 v21, s27, v51
    v_mfma_f32_32x32x16_bf16 v[144:159], v[60:63], v[52:55], v[144:159]
    v_dot2c_f32_bf16 v23, v51, v51
    s_waitcnt lgkmcnt(0)
    v_mfma_f32_32x32x16_bf16 v[64:79], v[32:35], v[40:43], v[64:79]
    v_dot2c_f32_bf16 v20, s27, v32
    v_dot2c_f32_bf16 v22, v32, v32
    v_mfma_f32_32x32x16_bf16 v[96:111], v[32:35], v[44:47], v[96:111]
    ds_read_b128 v[48:51], v9 offset:32768
    v_dot2c_f32_bf16 v21, s27, v33
    v_mfma_f32_32x32x16_bf16 v[128:143], v[44:47], v[32:35], v[128:143]
    ds_read_b128 v[52:55], v9 offset:36864
    v_dot2c_f32_bf16 v23, v33, v33
    v_mfma_f32_32x32x16_bf16 v[80:95], v[36:39], v[40:43], v[80:95]
    ds_read_b128 v[56:59], v4 offset:38912
    v_dot2c_f32_bf16 v20, s27, v34
    v_dot2c_f32_bf16 v22, v34, v34
    v_mfma_f32_32x32x16_bf16 v[112:127], v[36:39], v[44:47], v[112:127]
    ds_read_b128 v[60:63], v4 offset:39936
    v_dot2c_f32_bf16 v21, s27, v35
    v_mfma_f32_32x32x16_bf16 v[144:159], v[44:47], v[36:39], v[144:159]
    v_dot2c_f32_bf16 v23, v35, v35
    s_waitcnt lgkmcnt(0)
    v_mfma_f32_32x32x16_bf16 v[64:79], v[48:51], v[56:59], v[64:79]
    v_dot2c_f32_bf16 v20, s27, v48
    v_dot2c_f32_bf16 v22, v48, v48
    v_mfma_f32_32x32x16_bf16 v[96:111], v[48:51], v[60:63], v[96:111]
    v_dot2c_f32_bf16 v21, s27, v49
    v_mfma_f32_32x32x16_bf16 v[128:143], v[60:63], v[48:51], v[128:143]
    v_dot2c_f32_bf16 v23, v49, v49
    v_mfma_f32_32x32x16_bf16 v[80:95], v[52:55], v[56:59], v[80:95]
    v_dot2c_f32_bf16 v20, s27, v50
    v_dot2c_f32_bf16 v22, v50, v50
    v_mfma_f32_32x32x16_bf16 v[112:127], v[52:55], v[60:63], v[112:127]
    v_dot2c_f32_bf16 v21, s27, v51
    v_mfma_f32_32x32x16_bf16 v[144:159], v[60:63], v[52:55], v[144:159]
    v_dot2c_f32_bf16 v23, v51, v51
    s_branch afront2_kernel_af_epi
afront2_kernel_af_h1:
    s_waitcnt lgkmcnt(0)
    v_mfma_f32_32x32x16_bf16 v[64:79], v[32:35], v[40:43], 0
    v_dot2c_f32_bf16 v20, s27, v36
    v_dot2c_f32_bf16 v22, v36, v36
    v_mfma_f32_32x32x16_bf16 v[96:111], v[32:35], v[44:47], 0
    ds_read_b128 v[48:51], v7 offset:0
    v_dot2c_f32_bf16 v21, s27, v37
    v_mfma_f32_32x32x16_bf16 v[128:143], v[44:47], v[32:35], 0
    ds_read_b128 v[52:55], v7 offset:4096
    v_dot2c_f32_bf16 v23, v37, v37
    v_mfma_f32_32x32x16_bf16 v[80:95], v[36:39], v[40:43], 0
    ds_read_b128 v[56:59], v4 offset:2048
    v_dot2c_f32_bf16 v20, s27, v38
    v_dot2c_f32_bf16 v22, v38, v38
    v_mfma_f32_32x32x16_bf16 v[112:127], v[36:39], v[44:47], 0
    ds_read_b128 v[60:63], v4 offset:3072
    v_dot2c_f32_bf16 v21, s27, v39
    v_mfma_f32_32x32x16_bf16 v[144:159], v[44:47], v[36:39], 0
    v_dot2c_f32_bf16 v23, v39, v39
    s_waitcnt lgkmcnt(0)
    v_mfma_f32_32x32x16_bf16 v[64:79], v[48:51], v[56:59], v[64:79]
    v_dot2c_f32_bf16 v20, s27, v52
    v_dot2c_f32_bf16 v22, v52, v52
    v_mfma_f32_32x32x16_bf16 v[96:111], v[48:51], v[60:63], v[96:111]
    ds_read_b128 v[32:35], v8 offset:0
    v_dot2c_f32_bf16 v21, s27, v53
    v_mfma_f32_32x32x16_bf16 v[128:143], v[60:63], v[48:51], v[128:143]
    ds_read_b128 v[36:39], v8 offset:4096
    v_dot2c_f32_bf16 v23, v53, v53
    v_mfma_f32_32x32x16_bf16 v[80:95], v[52:55], v[56:59], v[80:95]
    ds_read_b128 v[40:43], v4 offset:4096
    v_dot2c_f32_bf16 v20, s27, v54
    v_dot2c_f32_bf16 v22, v54, v54
    v_mfma_f32_32x32x16_bf16 v[112:127], v[52:55], v[60:63], v[112:127]
    ds_read_b128 v[44:47], v4 offset:5120
    v_dot2c_f32_bf16 v21, s27, v55
    v_mfma_f32_32x32x16_bf16 v[144:159], v[60:63], v[52:55], v[144:159]
    v_dot2c_f32_bf16 v23, v55, v55
    s_waitcnt lgkmcnt(0)
    v_mfma_f32_32x32x16_bf16 v[64:79], v[32:35], v[40:43], v[64:79]
    v_dot2c_f32_bf16 v20, s27, v36
    v_dot2c_f32_bf16 v22, v36, v36
    v_mfma_f32_32x32x16_bf16 v[96:111], v[32:35], v[44:47], v[96:111]
    ds_read_b128 v[48:51], v9 offset:0
    v_dot2c_f32_bf16 v21, s27, v37
    v_mfma_f32_32x32x16_bf16 v[128:143], v[44:47], v[32:35], v[128:143]
    ds_read_b128 v[52:55], v9 offset:4096
    v_dot2c_f32_bf16 v23, v37, v37
    v_mfma_f32_32x32x16_bf16 v[80:95], v[36:39], v[40:43], v[80:95]
    ds_read_b128 v[56:59], v4 offset:6144
    v_dot2c_f32_bf16 v20, s27, v38
    v_dot2c_f32_bf16 v22, v38, v38
    v_mfma_f32_32x32x16_bf16 v[112:127], v[36:39], v[44:47], v[112:127]
    ds_read_b128 v[60:63], v4 offset:7168
    v_dot2c_f32_bf16 v21, s27, v39
    v_mfma_f32_32x32x16_bf16 v[144:159], v[44:47], v[36:39], v[144:159]
    v_dot2c_f32_bf16 v23, v39, v39
    s_waitcnt vmcnt(8)
    s_barrier
    s_lshl_b32 s28, s13, 12
    s_add_u32 s28, s28, 98304
    s_mov_b32 m0, s28
    s_add_u32 s29, s24, 384
    buffer_load_dwordx4 v2, s[16:19], s29 offen offset:0 lds
    s_add_u32 s29, s29, 9216
    buffer_load_dwordx4 v3, s[16:19], s29 offen offset:1024 lds
    s_add_u32 s29, s29, 9216
    buffer_load_dwordx4 v2, s[16:19], s29 offen offset:2048 lds
    s_add_u32 s29, s29, 9216
    buffer_load_dwordx4 v3, s[16:19], s29 offen offset:3072 lds
    s_add_u32 s28, s28, 16384
    s_mov_b32 m0, s28
    s_add_u32 s29, s25, 24576
    buffer_load_dwordx4 v1, s[8:11], s29 offen offset:0 lds
    buffer_load_dwordx4 v1, s[8:11], s29 offen offset:1024 lds
    buffer_load_dwordx4 v1, s[8:11], s29 offen offset:2048 lds
    buffer_load_dwordx4 v1, s[8:11], s29 offen offset:3072 lds
    s_waitcnt lgkmcnt(0)
    v_mfma_f32_32x32x16_bf16 v[64:79], v[48:51], v[56:59], v[64:79]
    v_dot2c_f32_bf16 v20, s27, v52
    v_dot2c_f32_bf16 v22, v52, v52
    v_mfma_f32_32x32x16_bf16 v[96:111], v[48:51], v[60:63], v[96:111]
    ds_read_b128 v[32:35], v6 offset:32768
    v_dot2c_f32_bf16 v21, s27, v53
    v_mfma_f32_32x32x16_bf16 v[128:143], v[60:63], v[48:51], v[128:143]
    ds_read_b128 v[36:39], v6 offset:36864
    v_dot2c_f32_bf16 v23, v53, v53
    v_mfma_f32_32x32x16_bf16 v[80:95], v[52:55], v[56:59], v[80:95]
    ds_read_b128 v[40:43], v4 offset:32768
    v_dot2c_f32_bf16 v20, s27, v54
    v_dot2c_f32_bf16 v22, v54, v54
    v_mfma_f32_32x32x16_bf16 v[112:127], v[52:55], v[60:63], v[112:127]
    ds_read_b128 v[44:47], v4 offset:33792
    v_dot2c_f32_bf16 v21, s27, v55
    v_mfma_f32_32x32x16_bf16 v[144:159], v[60:63], v[52:55], v[144:159]
    v_dot2c_f32_bf16 v23, v55, v55
    s_waitcnt lgkmcnt(0)
    v_mfma_f32_32x32x16_bf16 v[64:79], v[32:35], v[40:43], v[64:79]
    v_dot2c_f32_bf16 v20, s27, v36
    v_dot2c_f32_bf16 v22, v36, v36
    v_mfma_f32_32x32x16_bf16 v[96:111], v[32:35], v[44:47], v[96:111]
    ds_read_b128 v[48:51], v7 offset:32768
    v_dot2c_f32_bf16 v21, s27, v37
    v_mfma_f32_32x32x16_bf16 v[128:143], v[44:47], v[32:35], v[128:143]
    ds_read_b128 v[52:55], v7 offset:36864
    v_dot2c_f32_bf16 v23, v37, v37
    v_mfma_f32_32x32x16_bf16 v[80:95], v[36:39], v[40:43], v[80:95]
    ds_read_b128 v[56:59], v4 offset:34816
    v_dot2c_f32_bf16 v20, s27, v38
    v_dot2c_f32_bf16 v22, v38, v38
    v_mfma_f32_32x32x16_bf16 v[112:127], v[36:39], v[44:47], v[112:127]
    ds_read_b128 v[60:63], v4 offset:35840
    v_dot2c_f32_bf16 v21, s27, v39
    v_mfma_f32_32x32x16_bf16 v[144:159], v[44:47], v[36:39], v[144:159]
    v_dot2c_f32_bf16 v23, v39, v39
    s_waitcnt lgkmcnt(0)
    v_mfma_f32_32x32x16_bf16 v[64:79], v[48:51], v[56:59], v[64:79]
    v_dot2c_f32_bf16 v20, s27, v52
    v_dot2c_f32_bf16 v22, v52, v52
    v_mfma_f32_32x32x16_bf16 v[96:111], v[48:51], v[60:63], v[96:111]
    ds_read_b128 v[32:35], v8 offset:32768
    v_dot2c_f32_bf16 v21, s27, v53
    v_mfma_f32_32x32x16_bf16 v[128:143], v[60:63], v[48:51], v[128:143]
    ds_read_b128 v[36:39], v8 offset:36864
    v_dot2c_f32_bf16 v23, v53, v53
    v_mfma_f32_32x32x16_bf16 v[80:95], v[52:55], v[56:59], v[80:95]
    ds_read_b128 v[40:43], v4 offset:36864
    v_dot2c_f32_bf16 v20, s27, v54
    v_dot2c_f32_bf16 v22, v54, v54
    v_mfma_f32_32x32x16_bf16 v[112:127], v[52:55], v[60:63], v[112:127]
    ds_read_b128 v[44:47], v4 offset:37888
    v_dot2c_f32_bf16 v21, s27, v55
    v_mfma_f32_32x32x16_bf16 v[144:159], v[60:63], v[52:55], v[144:159]
    v_dot2c_f32_bf16 v23, v55, v55
    s_waitcnt lgkmcnt(0)
    v_mfma_f32_32x32x16_bf16 v[64:79], v[32:35], v[40:43], v[64:79]
    v_dot2c_f32_bf16 v20, s27, v36
    v_dot2c_f32_bf16 v22, v36, v36
    v_mfma_f32_32x32x16_bf16 v[96:111], v[32:35], v[44:47], v[96:111]
    ds_read_b128 v[48:51], v9 offset:32768
    v_dot2c_f32_bf16 v21, s27, v37
    v_mfma_f32_32x32x16_bf16 v[128:143], v[44:47], v[32:35], v[128:143]
    ds_read_b128 v[52:55], v9 offset:36864
    v_dot2c_f32_bf16 v23, v37, v37
    v_mfma_f32_32x32x16_bf16 v[80:95], v[36:39], v[40:43], v[80:95]
    ds_read_b128 v[56:59], v4 offset:38912
    v_dot2c_f32_bf16 v20, s27, v38
    v_dot2c_f32_bf16 v22, v38, v38
    v_mfma_f32_32x32x16_bf16 v[112:127], v[36:39], v[44:47], v[112:127]
    ds_read_b128 v[60:63], v4 offset:39936
    v_dot2c_f32_bf16 v21, s27, v39
    v_mfma_f32_32x32x16_bf16 v[144:159], v[44:47], v[36:39], v[144:159]
    v_dot2c_f32_bf16 v23, v39, v39
    s_waitcnt vmcnt(8)
    s_barrier
    s_lshl_b32 s28, s13, 12
    s_mov_b32 m0, s28
    s_add_u32 s29, s24, 512
    buffer_load_dwordx4 v2, s[16:19], s29 offen offset:0 lds
    s_add_u32 s29, s29, 9216
    buffer_load_dwordx4 v3, s[16:19], s29 offen offset:1024 lds
    s_add_u32 s29, s29, 9216
    buffer_load_dwordx4 v2, s[16:19], s29 offen offset:2048 lds
    s_add_u32 s29, s29, 9216
    buffer_load_dwordx4 v3, s[16:19], s29 offen offset:3072 lds
    s_add_u32 s28, s28, 16384
    s_mov_b32 m0, s28
    s_add_u32 s29, s25, 32768
    buffer_load_dwordx4 v1, s[8:11], s29 offen offset:0 lds
    buffer_load_dwordx4 v1, s[8:11], s29 offen offset:1024 lds
    buffer_load_dwordx4 v1, s[8:11], s29 offen offset:2048 lds
    buffer_load_dwordx4 v1, s[8:11], s29 offen offset:3072 lds
    s_waitcnt lgkmcnt(0)
    v_mfma_f32_32x32x16_bf16 v[64:79], v[48:51], v[56:59], v[64:79]
    v_dot2c_f32_bf16 v20, s27, v52
    v_dot2c_f32_bf16 v22, v52, v52
    v_mfma_f32_32x32x16_bf16 v[96:111], v[48:51], v[60:63], v[96:111]
    ds_read_b128 v[32:35], v10 offset:0
    v_dot2c_f32_bf16 v21, s27, v53
    v_mfma_f32_32x32x16_bf16 v[128:143], v[60:63], v[48:51], v[128:143]
    ds_read_b128 v[36:39], v10 offset:4096
    v_dot2c_f32_bf16 v23, v53, v53
    v_mfma_f32_32x32x16_bf16 v[80:95], v[52:55], v[56:59], v[80:95]
    ds_read_b128 v[40:43], v5 offset:0
    v_dot2c_f32_bf16 v20, s27, v54
    v_dot2c_f32_bf16 v22, v54, v54
    v_mfma_f32_32x32x16_bf16 v[112:127], v[52:55], v[60:63], v[112:127]
    ds_read_b128 v[44:47], v5 offset:1024
    v_dot2c_f32_bf16 v21, s27, v55
    v_mfma_f32_32x32x16_bf16 v[144:159], v[60:63], v[52:55], v[144:159]
    v_dot2c_f32_bf16 v23, v55, v55
    s_waitcnt lgkmcnt(0)
    v_mfma_f32_32x32x16_bf16 v[64:79], v[32:35], v[40:43], v[64:79]
    v_dot2c_f32_bf16 v20, s27, v36
    v_dot2c_f32_bf16 v22, v36, v36
    v_mfma_f32_32x32x16_bf16 v[96:111], v[32:35], v[44:47], v[96:111]
    ds_read_b128 v[48:51], v11 offset:0
    v_dot2c_f32_bf16 v21, s27, v37
    v_mfma_f32_32x32x16_bf16 v[128:143], v[44:47], v[32:35], v[128:143]
    ds_read_b128 v[52:55], v11 offset:4096
    v_dot2c_f32_bf16 v23, v37, v37
    v_mfma_f32_32x32x16_bf16 v[80:95], v[36:39], v[40:43], v[80:95]
    ds_read_b128 v[56:59], v5 offset:2048
    v_dot2c_f32_bf16 v20, s27, v38
    v_dot2c_f32_bf16 v22, v38, v38
    v_mfma_f32_32x32x16_bf16 v[112:127], v[36:39], v[44:47], v[112:127]
    ds_read_b128 v[60:63], v5 offset:3072
    v_dot2c_f32_bf16 v21, s27, v39
    v_mfma_f32_32x32x16_bf16 v[144:159], v[44:47], v[36:39], v[144:159]
    v_dot2c_f32_bf16 v23, v39, v39
    s_waitcnt lgkmcnt(0)
    v_mfma_f32_32x32x16_bf16 v[64:79], v[48:51], v[56:59], v[64:79]
    v_dot2c_f32_bf16 v20, s27, v52
    v_dot2c_f32_bf16 v22, v52, v52
    v_mfma_f32_32x32x16_bf16 v[96:111], v[48:51], v[60:63], v[96:111]
    ds_read_b128 v[32:35], v12 offset:0
    v_dot2c_f32_bf16 v21, s27, v53
    v_mfma_f32_32x32x16_bf16 v[128:143], v[60:63], v[48:51], v[128:143]
    ds_read_b128 v[36:39], v12 offset:4096
    v_dot2c_f32_bf16 v23, v53, v53
    v_mfma_f32_32x32x16_bf16 v[80:95], v[52:55], v[56:59], v[80:95]
    ds_read_b128 v[40:43], v5 offset:4096
    v_dot2c_f32_bf16 v20, s27, v54
    v_dot2c_f32_bf16 v22, v54, v54
    v_mfma_f32_32x32x16_bf16 v[112:127], v[52:55], v[60:63], v[112:127]
    ds_read_b128 v[44:47], v5 offset:5120
    v_dot2c_f32_bf16 v21, s27, v55
    v_mfma_f32_32x32x16_bf16 v[144:159], v[60:63], v[52:55], v[144:159]
    v_dot2c_f32_bf16 v23, v55, v55
    s_waitcnt lgkmcnt(0)
    v_mfma_f32_32x32x16_bf16 v[64:79], v[32:35], v[40:43], v[64:79]
    v_dot2c_f32_bf16 v20, s27, v36
    v_dot2c_f32_bf16 v22, v36, v36
    v_mfma_f32_32x32x16_bf16 v[96:111], v[32:35], v[44:47], v[96:111]
    ds_read_b128 v[48:51], v13 offset:0
    v_dot2c_f32_bf16 v21, s27, v37
    v_mfma_f32_32x32x16_bf16 v[128:143], v[44:47], v[32:35], v[128:143]
    ds_read_b128 v[52:55], v13 offset:4096
    v_dot2c_f32_bf16 v23, v37, v37
    v_mfma_f32_32x32x16_bf16 v[80:95], v[36:39], v[40:43], v[80:95]
    ds_read_b128 v[56:59], v5 offset:6144
    v_dot2c_f32_bf16 v20, s27, v38
    v_dot2c_f32_bf16 v22, v38, v38
    v_mfma_f32_32x32x16_bf16 v[112:127], v[36:39], v[44:47], v[112:127]
    ds_read_b128 v[60:63], v5 offset:7168
    v_dot2c_f32_bf16 v21, s27, v39
    v_mfma_f32_32x32x16_bf16 v[144:159], v[44:47], v[36:39], v[144:159]
    v_dot2c_f32_bf16 v23, v39, v39
    s_waitcnt vmcnt(8)
    s_barrier
    s_lshl_b32 s28, s13, 12
    s_add_u32 s28, s28, 32768
    s_mov_b32 m0, s28
    s_add_u32 s29, s24, 640
    buffer_load_dwordx4 v2, s[16:19], s29 offen offset:0 lds
    s_add_u32 s29, s29, 9216
    buffer_load_dwordx4 v3, s[16:19], s29 offen offset:1024 lds
    s_add_u32 s29, s29, 9216
    buffer_load_dwordx4 v2, s[16:19], s29 offen offset:2048 lds
    s_add_u32 s29, s29, 9216
    buffer_load_dwordx4 v3, s[16:19], s29 offen offset:3072 lds
    s_add_u32 s28, s28, 16384
    s_mov_b32 m0, s28
    s_add_u32 s29, s25, 40960
    buffer_load_dwordx4 v1, s[8:11], s29 offen offset:0 lds
    buffer_load_dwordx4 v1, s[8:11], s29 offen offset:1024 lds
    buffer_load_dwordx4 v1, s[8:11], s29 offen offset:2048 lds
    buffer_load_dwordx4 v1, s[8:11], s29 offen offset:3072 lds
    s_waitcnt lgkmcnt(0)
    v_mfma_f32_32x32x16_bf16 v[64:79], v[48:51], v[56:59], v[64:79]
    v_dot2c_f32_bf16 v20, s27, v52
    v_dot2c_f32_bf16 v22, v52, v52
    v_mfma_f32_32x32x16_bf16 v[96:111], v[48:51], v[60:63], v[96:111]
    ds_read_b128 v[32:35], v10 offset:32768
    v_dot2c_f32_bf16 v21, s27, v53
    v_mfma_f32_32x32x16_bf16 v[128:143], v[60:63], v[48:51], v[128:143]
    ds_read_b128 v[36:39], v10 offset:36864
    v_dot2c_f32_bf16 v23, v53, v53
    v_mfma_f32_32x32x16_bf16 v[80:95], v[52:55], v[56:59], v[80:95]
    ds_read_b128 v[40:43], v5 offset:32768
    v_dot2c_f32_bf16 v20, s27, v54
    v_dot2c_f32_bf16 v22, v54, v54
    v_mfma_f32_32x32x16_bf16 v[112:127], v[52:55], v[60:63], v[112:127]
    ds_read_b128 v[44:47], v5 offset:33792
    v_dot2c_f32_bf16 v21, s27, v55
    v_mfma_f32_32x32x16_bf16 v[144:159], v[60:63], v[52:55], v[144:159]
    v_dot2c_f32_bf16 v23, v55, v55
    s_waitcnt lgkmcnt(0)
    v_mfma_f32_32x32x16_bf16 v[64:79], v[32:35], v[40:43], v[64:79]
    v_dot2c_f32_bf16 v20, s27, v36
    v_dot2c_f32_bf16 v22, v36, v36
    v_mfma_f32_32x32x16_bf16 v[96:111], v[32:35], v[44:47], v[96:111]
    ds_read_b128 v[48:51], v11 offset:32768
    v_dot2c_f32_bf16 v21, s27, v37
    v_mfma_f32_32x32x16_bf16 v[128:143], v[44:47], v[32:35], v[128:143]
    ds_read_b128 v[52:55], v11 offset:36864
    v_dot2c_f32_bf16 v23, v37, v37
    v_mfma_f32_32x32x16_bf16 v[80:95], v[36:39], v[40:43], v[80:95]
    ds_read_b128 v[56:59], v5 offset:34816
    v_dot2c_f32_bf16 v20, s27, v38
    v_dot2c_f32_bf16 v22, v38, v38
    v_mfma_f32_32x32x16_bf16 v[112:127], v[36:39], v[44:47], v[112:127]
    ds_read_b128 v[60:63], v5 offset:35840
    v_dot2c_f32_bf16 v21, s27, v39
    v_mfma_f32_32x32x16_bf16 v[144:159], v[44:47], v[36:39], v[144:159]
    v_dot2c_f32_bf16 v23, v39, v39
    s_waitcnt lgkmcnt(0)
    v_mfma_f32_32x32x16_bf16 v[64:79], v[48:51], v[56:59], v[64:79]
    v_dot2c_f32_bf16 v20, s27, v52
    v_dot2c_f32_bf16 v22, v52, v52
    v_mfma_f32_32x32x16_bf16 v[96:111], v[48:51], v[60:63], v[96:111]
    ds_read_b128 v[32:35], v12 offset:32768
    v_dot2c_f32_bf16 v21, s27, v53
    v_mfma_f32_32x32x16_bf16 v[128:143], v[60:63], v[48:51], v[128:143]
    ds_read_b128 v[36:39], v12 offset:36864
    v_dot2c_f32_bf16 v23, v53, v53
    v_mfma_f32_32x32x16_bf16 v[80:95], v[52:55], v[56:59], v[80:95]
    ds_read_b128 v[40:43], v5 offset:36864
    v_dot2c_f32_bf16 v20, s27, v54
    v_dot2c_f32_bf16 v22, v54, v54
    v_mfma_f32_32x32x16_bf16 v[112:127], v[52:55], v[60:63], v[112:127]
    ds_read_b128 v[44:47], v5 offset:37888
    v_dot2c_f32_bf16 v21, s27, v55
    v_mfma_f32_32x32x16_bf16 v[144:159], v[60:63], v[52:55], v[144:159]
    v_dot2c_f32_bf16 v23, v55, v55
    s_waitcnt lgkmcnt(0)
    v_mfma_f32_32x32x16_bf16 v[64:79], v[32:35], v[40:43], v[64:79]
    v_dot2c_f32_bf16 v20, s27, v36
    v_dot2c_f32_bf16 v22, v36, v36
    v_mfma_f32_32x32x16_bf16 v[96:111], v[32:35], v[44:47], v[96:111]
    ds_read_b128 v[48:51], v13 offset:32768
    v_dot2c_f32_bf16 v21, s27, v37
    v_mfma_f32_32x32x16_bf16 v[128:143], v[44:47], v[32:35], v[128:143]
    ds_read_b128 v[52:55], v13 offset:36864
    v_dot2c_f32_bf16 v23, v37, v37
    v_mfma_f32_32x32x16_bf16 v[80:95], v[36:39], v[40:43], v[80:95]
    ds_read_b128 v[56:59], v5 offset:38912
    v_dot2c_f32_bf16 v20, s27, v38
    v_dot2c_f32_bf16 v22, v38, v38
    v_mfma_f32_32x32x16_bf16 v[112:127], v[36:39], v[44:47], v[112:127]
    ds_read_b128 v[60:63], v5 offset:39936
    v_dot2c_f32_bf16 v21, s27, v39
    v_mfma_f32_32x32x16_bf16 v[144:159], v[44:47], v[36:39], v[144:159]
    v_dot2c_f32_bf16 v23, v39, v39
    s_waitcnt vmcnt(8)
    s_barrier
    s_lshl_b32 s28, s13, 12
    s_add_u32 s28, s28, 65536
    s_mov_b32 m0, s28
    s_add_u32 s29, s24, 768
    buffer_load_dwordx4 v2, s[16:19], s29 offen offset:0 lds
    s_add_u32 s29, s29, 9216
    buffer_load_dwordx4 v3, s[16:19], s29 offen offset:1024 lds
    s_add_u32 s29, s29, 9216
    buffer_load_dwordx4 v2, s[16:19], s29 offen offset:2048 lds
    s_add_u32 s29, s29, 9216
    buffer_load_dwordx4 v3, s[16:19], s29 offen offset:3072 lds
    s_add_u32 s28, s28, 16384
    s_mov_b32 m0, s28
    s_add_u32 s29, s25, 49152
    buffer_load_dwordx4 v1, s[8:11], s29 offen offset:0 lds
    buffer_load_dwordx4 v1, s[8:11], s29 offen offset:1024 lds
    buffer_load_dwordx4 v1, s[8:11], s29 offen offset:2048 lds
    buffer_load_dwordx4 v1, s[8:11], s29 offen offset:3072 lds
    s_waitcnt lgkmcnt(0)
    v_mfma_f32_32x32x16_bf16 v[64:79], v[48:51], v[56:59], v[64:79]
    v_dot2c_f32_bf16 v20, s27, v52
    v_dot2c_f32_bf16 v22, v52, v52
    v_mfma_f32_32x32x16_bf16 v[96:111], v[48:51], v[60:63], v[96:111]
    ds_read_b128 v[32:35], v6 offset:0
    v_dot2c_f32_bf16 v21, s27, v53
    v_mfma_f32_32x32x16_bf16 v[128:143], v[60:63], v[48:51], v[128:143]
    ds_read_b128 v[36:39], v6 offset:4096
    v_dot2c_f32_bf16 v23, v53, v53
    v_mfma_f32_32x32x16_bf16 v[80:95], v[52:55], v[56:59], v[80:95]
    ds_read_b128 v[40:43], v4 offset:0
    v_dot2c_f32_bf16 v20, s27, v54
    v_dot2c_f32_bf16 v22, v54, v54
    v_mfma_f32_32x32x16_bf16 v[112:127], v[52:55], v[60:63], v[112:127]
    ds_read_b128 v[44:47], v4 offset:1024
    v_dot2c_f32_bf16 v21, s27, v55
    v_mfma_f32_32x32x16_bf16 v[144:159], v[60:63], v[52:55], v[144:159]
    v_dot2c_f32_bf16 v23, v55, v55
    s_waitcnt lgkmcnt(0)
    v_mfma_f32_32x32x16_bf16 v[64:79], v[32:35], v[40:43], v[64:79]
    v_dot2c_f32_bf16 v20, s27, v36
    v_dot2c_f32_bf16 v22, v36, v36
    v_mfma_f32_32x32x16_bf16 v[96:111], v[32:35], v[44:47], v[96:111]
    ds_read_b128 v[48:51], v7 offset:0
    v_dot2c_f32_bf16 v21, s27, v37
    v_mfma_f32_32x32x16_bf16 v[128:143], v[44:47], v[32:35], v[128:143]
    ds_read_b128 v[52:55], v7 offset:4096
    v_dot2c_f32_bf16 v23, v37, v37
    v_mfma_f32_32x32x16_bf16 v[80:95], v[36:39], v[40:43], v[80:95]
    ds_read_b128 v[56:59], v4 offset:2048
    v_dot2c_f32_bf16 v20, s27, v38
    v_dot2c_f32_bf16 v22, v38, v38
    v_mfma_f32_32x32x16_bf16 v[112:127], v[36:39], v[44:47], v[112:127]
    ds_read_b128 v[60:63], v4 offset:3072
    v_dot2c_f32_bf16 v21, s27, v39
    v_mfma_f32_32x32x16_bf16 v[144:159], v[44:47], v[36:39], v[144:159]
    v_dot2c_f32_bf16 v23, v39, v39
    s_waitcnt lgkmcnt(0)
    v_mfma_f32_32x32x16_bf16 v[64:79], v[48:51], v[56:59], v[64:79]
    v_dot2c_f32_bf16 v20, s27, v52
    v_dot2c_f32_bf16 v22, v52, v52
    v_mfma_f32_32x32x16_bf16 v[96:111], v[48:51], v[60:63], v[96:111]
    ds_read_b128 v[32:35], v8 offset:0
    v_dot2c_f32_bf16 v21, s27, v53
    v_mfma_f32_32x32x16_bf16 v[128:143], v[60:63], v[48:51], v[128:143]
    ds_read_b128 v[36:39], v8 offset:4096
    v_dot2c_f32_bf16 v23, v53, v53
    v_mfma_f32_32x32x16_bf16 v[80:95], v[52:55], v[56:59], v[80:95]
    ds_read_b128 v[40:43], v4 offset:4096
    v_dot2c_f32_bf16 v20, s27, v54
    v_dot2c_f32_bf16 v22, v54, v54
    v_mfma_f32_32x32x16_bf16 v[112:127], v[52:55], v[60:63], v[112:127]
    ds_read_b128 v[44:47], v4 offset:5120
    v_dot2c_f32_bf16 v21, s27, v55
    v_mfma_f32_32x32x16_bf16 v[144:159], v[60:63], v[52:55], v[144:159]
    v_dot2c_f32_bf16 v23, v55, v55
    s_waitcnt lgkmcnt(0)
    v_mfma_f32_32x32x16_bf16 v[64:79], v[32:35], v[40:43], v[64:79]
    v_dot2c_f32_bf16 v20, s27, v36
    v_dot2c_f32_bf16 v22, v36, v36
    v_mfma_f32_32x32x16_bf16 v[96:111], v[32:35], v[44:47], v[96:111]
    ds_read_b128 v[48:51], v9 offset:0
    v_dot2c_f32_bf16 v21, s27, v37
    v_mfma_f32_32x32x16_bf16 v[128:143], v[44:47], v[32:35], v[128:143]
    ds_read_b128 v[52:55], v9 offset:4096
    v_dot2c_f32_bf16 v23, v37, v37
    v_mfma_f32_32x32x16_bf16 v[80:95], v[36:39], v[40:43], v[80:95]
    ds_read_b128 v[56:59], v4 offset:6144
    v_dot2c_f32_bf16 v20, s27, v38
    v_dot2c_f32_bf16 v22, v38, v38
    v_mfma_f32_32x32x16_bf16 v[112:127], v[36:39], v[44:47], v[112:127]
    ds_read_b128 v[60:63], v4 offset:7168
    v_dot2c_f32_bf16 v21, s27, v39
    v_mfma_f32_32x32x16_bf16 v[144:159], v[44:47], v[36:39], v[144:159]
    v_dot2c_f32_bf16 v23, v39, v39
    s_waitcnt vmcnt(8)
    s_barrier
    s_lshl_b32 s28, s13, 12
    s_add_u32 s28, s28, 98304
    s_mov_b32 m0, s28
    s_add_u32 s29, s24, 896
    buffer_load_dwordx4 v2, s[16:19], s29 offen offset:0 lds
    s_add_u32 s29, s29, 9216
    buffer_load_dwordx4 v3, s[16:19], s29 offen offset:1024 lds
    s_add_u32 s29, s29, 9216
    buffer_load_dwordx4 v2, s[16:19], s29 offen offset:2048 lds
    s_add_u32 s29, s29, 9216
    buffer_load_dwordx4 v3, s[16:19], s29 offen offset:3072 lds
    s_add_u32 s28, s28, 16384
    s_mov_b32 m0, s28
    s_add_u32 s29, s25, 57344
    buffer_load_dwordx4 v1, s[8:11], s29 offen offset:0 lds
    buffer_load_dwordx4 v1, s[8:11], s29 offen offset:1024 lds
    buffer_load_dwordx4 v1, s[8:11], s29 offen offset:2048 lds
    buffer_load_dwordx4 v1, s[8:11], s29 offen offset:3072 lds
    s_waitcnt lgkmcnt(0)
    v_mfma_f32_32x32x16_bf16 v[64:79], v[48:51], v[56:59], v[64:79]
    v_dot2c_f32_bf16 v20, s27, v52
    v_dot2c_f32_bf16 v22, v52, v52
    v_mfma_f32_32x32x16_bf16 v[96:111], v[48:51], v[60:63], v[96:111]
    ds_read_b128 v[32:35], v6 offset:32768
    v_dot2c_f32_bf16 v21, s27, v53
    v_mfma_f32_32x32x16_bf16 v[128:143], v[60:63], v[48:51], v[128:143]
    ds_read_b128 v[36:39], v6 offset:36864
    v_dot2c_f32_bf16 v23, v53, v53
    v_mfma_f32_32x32x16_bf16 v[80:95], v[52:55], v[56:59], v[80:95]
    ds_read_b128 v[40:43], v4 offset:32768
    v_dot2c_f32_bf16 v20, s27, v54
    v_dot2c_f32_bf16 v22, v54, v54
    v_mfma_f32_32x32x16_bf16 v[112:127], v[52:55], v[60:63], v[112:127]
    ds_read_b128 v[44:47], v4 offset:33792
    v_dot2c_f32_bf16 v21, s27, v55
    v_mfma_f32_32x32x16_bf16 v[144:159], v[60:63], v[52:55], v[144:159]
    v_dot2c_f32_bf16 v23, v55, v55
    s_waitcnt lgkmcnt(0)
    v_mfma_f32_32x32x16_bf16 v[64:79], v[32:35], v[40:43], v[64:79]
    v_dot2c_f32_bf16 v20, s27, v36
    v_dot2c_f32_bf16 v22, v36, v36
    v_mfma_f32_32x32x16_bf16 v[96:111], v[32:35], v[44:47], v[96:111]
    ds_read_b128 v[48:51], v7 offset:32768
    v_dot2c_f32_bf16 v21, s27, v37
    v_mfma_f32_32x32x16_bf16 v[128:143], v[44:47], v[32:35], v[128:143]
    ds_read_b128 v[52:55], v7 offset:36864
    v_dot2c_f32_bf16 v23, v37, v37
    v_mfma_f32_32x32x16_bf16 v[80:95], v[36:39], v[40:43], v[80:95]
    ds_read_b128 v[56:59], v4 offset:34816
    v_dot2c_f32_bf16 v20, s27, v38
    v_dot2c_f32_bf16 v22, v38, v38
    v_mfma_f32_32x32x16_bf16 v[112:127], v[36:39], v[44:47], v[112:127]
    ds_read_b128 v[60:63], v4 offset:35840
    v_dot2c_f32_bf16 v21, s27, v39
    v_mfma_f32_32x32x16_bf16 v[144:159], v[44:47], v[36:39], v[144:159]
    v_dot2c_f32_bf16 v23, v39, v39
    s_waitcnt lgkmcnt(0)
    v_mfma_f32_32x32x16_bf16 v[64:79], v[48:51], v[56:59], v[64:79]
    v_dot2c_f32_bf16 v20, s27, v52
    v_dot2c_f32_bf16 v22, v52, v52
    v_mfma_f32_32x32x16_bf16 v[96:111], v[48:51], v[60:63], v[96:111]
    ds_read_b128 v[32:35], v8 offset:32768
    v_dot2c_f32_bf16 v21, s27, v53
    v_mfma_f32_32x32x16_bf16 v[128:143], v[60:63], v[48:51], v[128:143]
    ds_read_b128 v[36:39], v8 offset:36864
    v_dot2c_f32_bf16 v23, v53, v53
    v_mfma_f32_32x32x16_bf16 v[80:95], v[52:55], v[56:59], v[80:95]
    ds_read_b128 v[40:43], v4 offset:36864
    v_dot2c_f32_bf16 v20, s27, v54
    v_dot2c_f32_bf16 v22, v54, v54
    v_mfma_f32_32x32x16_bf16 v[112:127], v[52:55], v[60:63], v[112:127]
    ds_read_b128 v[44:47], v4 offset:37888
    v_dot2c_f32_bf16 v21, s27, v55
    v_mfma_f32_32x32x16_bf16 v[144:159], v[60:63], v[52:55], v[144:159]
    v_dot2c_f32_bf16 v23, v55, v55
    s_waitcnt lgkmcnt(0)
    v_mfma_f32_32x32x16_bf16 v[64:79], v[32:35], v[40:43], v[64:79]
    v_dot2c_f32_bf16 v20, s27, v36
    v_dot2c_f32_bf16 v22, v36, v36
    v_mfma_f32_32x32x16_bf16 v[96:111], v[32:35], v[44:47], v[96:111]
    ds_read_b128 v[48:51], v9 offset:32768
    v_dot2c_f32_bf16 v21, s27, v37
    v_mfma_f32_32x32x16_bf16 v[128:143], v[44:47], v[32:35], v[128:143]
    ds_read_b128 v[52:55], v9 offset:36864
    v_dot2c_f32_bf16 v23, v37, v37
    v_mfma_f32_32x32x16_bf16 v[80:95], v[36:39], v[40:43], v[80:95]
    ds_read_b128 v[56:59], v4 offset:38912
    v_dot2c_f32_bf16 v20, s27, v38
    v_dot2c_f32_bf16 v22, v38, v38
    v_mfma_f32_32x32x16_bf16 v[112:127], v[36:39], v[44:47], v[112:127]
    ds_read_b128 v[60:63], v4 offset:39936
    v_dot2c_f32_bf16 v21, s27, v39
    v_mfma_f32_32x32x16_bf16 v[144:159], v[44:47], v[36:39], v[144:159]
    v_dot2c_f32_bf16 v23, v39, v39
    s_waitcnt vmcnt(8)
    s_barrier
    s_lshl_b32 s28, s13, 12
    s_mov_b32 m0, s28
    s_add_u32 s29, s24, 1024
    buffer_load_dwordx4 v2, s[16:19], s29 offen offset:0 lds
    s_add_u32 s29, s29, 9216
    buffer_load_dwordx4 v3, s[16:19], s29 offen offset:1024 lds
    s_add_u32 s29, s29, 9216
    buffer_load_dwordx4 v2, s[16:19], s29 offen offset:2048 lds
    s_add_u32 s29, s29, 9216
    buffer_load_dwordx4 v3, s[16:19], s29 offen offset:3072 lds
    s_add_u32 s28, s28, 16384
    s_mov_b32 m0, s28
    s_add_u32 s29, s25, 65536
    buffer_load_dwordx4 v1, s[8:11], s29 offen offset:0 lds
    buffer_load_dwordx4 v1, s[8:11], s29 offen offset:1024 lds
    buffer_load_dwordx4 v1, s[8:11], s29 offen offset:2048 lds
    buffer_load_dwordx4 v1, s[8:11], s29 offen offset:3072 lds
    s_waitcnt lgkmcnt(0)
    v_mfma_f32_32x32x16_bf16 v[64:79], v[48:51], v[56:59], v[64:79]
    v_dot2c_f32_bf16 v20, s27, v52
    v_dot2c_f32_bf16 v22, v52, v52
    v_mfma_f32_32x32x16_bf16 v[96:111], v[48:51], v[60:63], v[96:111]
    ds_read_b128 v[32:35], v10 offset:0
    v_dot2c_f32_bf16 v21, s27, v53
    v_mfma_f32_32x32x16_bf16 v[128:143], v[60:63], v[48:51], v[128:143]
    ds_read_b128 v[36:39], v10 offset:4096
    v_dot2c_f32_bf16 v23, v53, v53
    v_mfma_f32_32x32x16_bf16 v[80:95], v[52:55], v[56:59], v[80:95]
    ds_read_b128 v[40:43], v5 offset:0
    v_dot2c_f32_bf16 v20, s27, v54
    v_dot2c_f32_bf16 v22, v54, v54
    v_mfma_f32_32x32x16_bf16 v[112:127], v[52:55], v[60:63], v[112:127]
    ds_read_b128 v[44:47], v5 offset:1024
    v_dot2c_f32_bf16 v21, s27, v55
    v_mfma_f32_32x32x16_bf16 v[144:159], v[60:63], v[52:55], v[144:159]
    v_dot2c_f32_bf16 v23, v55, v55
    s_waitcnt lgkmcnt(0)
    v_mfma_f32_32x32x16_bf16 v[64:79], v[32:35], v[40:43], v[64:79]
    v_dot2c_f32_bf16 v20, s27, v36
    v_dot2c_f32_bf16 v22, v36, v36
    v_mfma_f32_32x32x16_bf16 v[96:111], v[32:35], v[44:47], v[96:111]
    ds_read_b128 v[48:51], v11 offset:0
    v_dot2c_f32_bf16 v21, s27, v37
    v_mfma_f32_32x32x16_bf16 v[128:143], v[44:47], v[32:35], v[128:143]
    ds_read_b128 v[52:55], v11 offset:4096
    v_dot2c_f32_bf16 v23, v37, v37
    v_mfma_f32_32x32x16_bf16 v[80:95], v[36:39], v[40:43], v[80:95]
    ds_read_b128 v[56:59], v5 offset:2048
    v_dot2c_f32_bf16 v20, s27, v38
    v_dot2c_f32_bf16 v22, v38, v38
    v_mfma_f32_32x32x16_bf16 v[112:127], v[36:39], v[44:47], v[112:127]
    ds_read_b128 v[60:63], v5 offset:3072
    v_dot2c_f32_bf16 v21, s27, v39
    v_mfma_f32_32x32x16_bf16 v[144:159], v[44:47], v[36:39], v[144:159]
    v_dot2c_f32_bf16 v23, v39, v39
    s_waitcnt lgkmcnt(0)
    v_mfma_f32_32x32x16_bf16 v[64:79], v[48:51], v[56:59], v[64:79]
    v_dot2c_f32_bf16 v20, s27, v52
    v_dot2c_f32_bf16 v22, v52, v52
    v_mfma_f32_32x32x16_bf16 v[96:111], v[48:51], v[60:63], v[96:111]
    ds_read_b128 v[32:35], v12 offset:0
    v_dot2c_f32_bf16 v21, s27, v53
    v_mfma_f32_32x32x16_bf16 v[128:143], v[60:63], v[48:51], v[128:143]
    ds_read_b128 v[36:39], v12 offset:4096
    v_dot2c_f32_bf16 v23, v53, v53
    v_mfma_f32_32x32x16_bf16 v[80:95], v[52:55], v[56:59], v[80:95]
    ds_read_b128 v[40:43], v5 offset:4096
    v_dot2c_f32_bf16 v20, s27, v54
    v_dot2c_f32_bf16 v22, v54, v54
    v_mfma_f32_32x32x16_bf16 v[112:127], v[52:55], v[60:63], v[112:127]
    ds_read_b128 v[44:47], v5 offset:5120
    v_dot2c_f32_bf16 v21, s27, v55
    v_mfma_f32_32x32x16_bf16 v[144:159], v[60:63], v[52:55], v[144:159]
    v_dot2c_f32_bf16 v23, v55, v55
    s_waitcnt lgkmcnt(0)
    v_mfma_f32_32x32x16_bf16 v[64:79], v[32:35], v[40:43], v[64:79]
    v_dot2c_f32_bf16 v20, s27, v36
    v_dot2c_f32_bf16 v22, v36, v36
    v_mfma_f32_32x32x16_bf16 v[96:111], v[32:35], v[44:47], v[96:111]
    ds_read_b128 v[48:51], v13 offset:0
    v_dot2c_f32_bf16 v21, s27, v37
    v_mfma_f32_32x32x16_bf16 v[128:143], v[44:47], v[32:35], v[128:143]
    ds_read_b128 v[52:55], v13 offset:4096
    v_dot2c_f32_bf16 v23, v37, v37
    v_mfma_f32_32x32x16_bf16 v[80:95], v[36:39], v[40:43], v[80:95]
    ds_read_b128 v[56:59], v5 offset:6144
    v_dot2c_f32_bf16 v20, s27, v38
    v_dot2c_f32_bf16 v22, v38, v38
    v_mfma_f32_32x32x16_bf16 v[112:127], v[36:39], v[44:47], v[112:127]
    ds_read_b128 v[60:63], v5 offset:7168
    v_dot2c_f32_bf16 v21, s27, v39
    v_mfma_f32_32x32x16_bf16 v[144:159], v[44:47], v[36:39], v[144:159]
    v_dot2c_f32_bf16 v23, v39, v39
    s_waitcnt vmcnt(8)
    s_barrier
    s_lshl_b32 s28, s13, 12
    s_add_u32 s28, s28, 32768
    s_mov_b32 m0, s28
    s_add_u32 s29, s24, 1152
    buffer_load_dwordx4 v2, s[16:19], s29 offen offset:0 lds
    s_add_u32 s29, s29, 9216
    buffer_load_dwordx4 v3, s[16:19], s29 offen offset:1024 lds
    s_add_u32 s29, s29, 9216
    buffer_load_dwordx4 v2, s[16:19], s29 offen offset:2048 lds
    s_add_u32 s29, s29, 9216
    buffer_load_dwordx4 v3, s[16:19], s29 offen offset:3072 lds
    s_add_u32 s28, s28, 16384
    s_mov_b32 m0, s28
    s_add_u32 s29, s25, 73728
    buffer_load_dwordx4 v1, s[8:11], s29 offen offset:0 lds
    buffer_load_dwordx4 v1, s[8:11], s29 offen offset:1024 lds
    buffer_load_dwordx4 v1, s[8:11], s29 offen offset:2048 lds
    buffer_load_dwordx4 v1, s[8:11], s29 offen offset:3072 lds
    s_waitcnt lgkmcnt(0)
    v_mfma_f32_32x32x16_bf16 v[64:79], v[48:51], v[56:59], v[64:79]
    v_dot2c_f32_bf16 v20, s27, v52
    v_dot2c_f32_bf16 v22, v52, v52
    v_mfma_f32_32x32x16_bf16 v[96:111], v[48:51], v[60:63], v[96:111]
    ds_read_b128 v[32:35], v10 offset:32768
    v_dot2c_f32_bf16 v21, s27, v53
    v_mfma_f32_32x32x16_bf16 v[128:143], v[60:63], v[48:51], v[128:143]
    ds_read_b128 v[36:39], v10 offset:36864
    v_dot2c_f32_bf16 v23, v53, v53
    v_mfma_f32_32x32x16_bf16 v[80:95], v[52:55], v[56:59], v[80:95]
    ds_read_b128 v[40:43], v5 offset:32768
    v_dot2c_f32_bf16 v20, s27, v54
    v_dot2c_f32_bf16 v22, v54, v54
    v_mfma_f32_32x32x16_bf16 v[112:127], v[52:55], v[60:63], v[112:127]
    ds_read_b128 v[44:47], v5 offset:33792
    v_dot2c_f32_bf16 v21, s27, v55
    v_mfma_f32_32x32x16_bf16 v[144:159], v[60:63], v[52:55], v[144:159]
    v_dot2c_f32_bf16 v23, v55, v55
    s_waitcnt lgkmcnt(0)
    v_mfma_f32_32x32x16_bf16 v[64:79], v[32:35], v[40:43], v[64:79]
    v_dot2c_f32_bf16 v20, s27, v36
    v_dot2c_f32_bf16 v22, v36, v36
    v_mfma_f32_32x32x16_bf16 v[96:111], v[32:35], v[44:47], v[96:111]
    ds_read_b128 v[48:51], v11 offset:32768
    v_dot2c_f32_bf16 v21, s27, v37
    v_mfma_f32_32x32x16_bf16 v[128:143], v[44:47], v[32:35], v[128:143]
    ds_read_b128 v[52:55], v11 offset:36864
    v_dot2c_f32_bf16 v23, v37, v37
    v_mfma_f32_32x32x16_bf16 v[80:95], v[36:39], v[40:43], v[80:95]
    ds_read_b128 v[56:59], v5 offset:34816
    v_dot2c_f32_bf16 v20, s27, v38
    v_dot2c_f32_bf16 v22, v38, v38
    v_mfma_f32_32x32x16_bf16 v[112:127], v[36:39], v[44:47], v[112:127]
    ds_read_b128 v[60:63], v5 offset:35840
    v_dot2c_f32_bf16 v21, s27, v39
    v_mfma_f32_32x32x16_bf16 v[144:159], v[44:47], v[36:39], v[144:159]
    v_dot2c_f32_bf16 v23, v39, v39
    s_waitcnt lgkmcnt(0)
    v_mfma_f32_32x32x16_bf16 v[64:79], v[48:51], v[56:59], v[64:79]
    v_dot2c_f32_bf16 v20, s27, v52
    v_dot2c_f32_bf16 v22, v52, v52
    v_mfma_f32_32x32x16_bf16 v[96:111], v[48:51], v[60:63], v[96:111]
    ds_read_b128 v[32:35], v12 offset:32768
    v_dot2c_f32_bf16 v21, s27, v53
    v_mfma_f32_32x32x16_bf16 v[128:143], v[60:63], v[48:51], v[128:143]
    ds_read_b128 v[36:39], v12 offset:36864
    v_dot2c_f32_bf16 v23, v53, v53
    v_mfma_f32_32x32x16_bf16 v[80:95], v[52:55], v[56:59], v[80:95]
    ds_read_b128 v[40:43], v5 offset:36864
    v_dot2c_f32_bf16 v20, s27, v54
    v_dot2c_f32_bf16 v22, v54, v54
    v_mfma_f32_32x32x16_bf16 v[112:127], v[52:55], v[60:63], v[112:127]
    ds_read_b128 v[44:47], v5 offset:37888
    v_dot2c_f32_bf16 v21, s27, v55
    v_mfma_f32_32x32x16_bf16 v[144:159], v[60:63], v[52:55], v[144:159]
    v_dot2c_f32_bf16 v23, v55, v55
    s_waitcnt lgkmcnt(0)
    v_mfma_f32_32x32x16_bf16 v[64:79], v[32:35], v[40:43], v[64:79]
    v_dot2c_f32_bf16 v20, s27, v36
    v_dot2c_f32_bf16 v22, v36, v36
    v_mfma_f32_32x32x16_bf16 v[96:111], v[32:35], v[44:47], v[96:111]
    ds_read_b128 v[48:51], v13 offset:32768
    v_dot2c_f32_bf16 v21, s27, v37
    v_mfma_f32_32x32x16_bf16 v[128:143], v[44:47], v[32:35], v[128:143]
    ds_read_b128 v[52:55], v13 offset:36864
    v_dot2c_f32_bf16 v23, v37, v37
    v_mfma_f32_32x32x16_bf16 v[80:95], v[36:39], v[40:43], v[80:95]
    ds_read_b128 v[56:59], v5 offset:38912
    v_dot2c_f32_bf16 v20, s27, v38
    v_dot2c_f32_bf16 v22, v38, v38
    v_mfma_f32_32x32x16_bf16 v[112:127], v[36:39], v[44:47], v[112:127]
    ds_read_b128 v[60:63], v5 offset:39936
    v_dot2c_f32_bf16 v21, s27, v39
    v_mfma_f32_32x32x16_bf16 v[144:159], v[44:47], v[36:39], v[144:159]
    v_dot2c_f32_bf16 v23, v39, v39
    s_waitcnt vmcnt(8)
    s_barrier
    s_waitcnt lgkmcnt(0)
    v_mfma_f32_32x32x16_bf16 v[64:79], v[48:51], v[56:59], v[64:79]
    v_dot2c_f32_bf16 v20, s27, v52
    v_dot2c_f32_bf16 v22, v52, v52
    v_mfma_f32_32x32x16_bf16 v[96:111], v[48:51], v[60:63], v[96:111]
    ds_read_b128 v[32:35], v6 offset:0
    v_dot2c_f32_bf16 v21, s27, v53
    v_mfma_f32_32x32x16_bf16 v[128:143], v[60:63], v[48:51], v[128:143]
    ds_read_b128 v[36:39], v6 offset:4096
    v_dot2c_f32_bf16 v23, v53, v53
    v_mfma_f32_32x32x16_bf16 v[80:95], v[52:55], v[56:59], v[80:95]
    ds_read_b128 v[40:43], v4 offset:0
    v_dot2c_f32_bf16 v20, s27, v54
    v_dot2c_f32_bf16 v22, v54, v54
    v_mfma_f32_32x32x16_bf16 v[112:127], v[52:55], v[60:63], v[112:127]
    ds_read_b128 v[44:47], v4 offset:1024
    v_dot2c_f32_bf16 v21, s27, v55
    v_mfma_f32_32x32x16_bf16 v[144:159], v[60:63], v[52:55], v[144:159]
    v_dot2c_f32_bf16 v23, v55, v55
    s_waitcnt lgkmcnt(0)
    v_mfma_f32_32x32x16_bf16 v[64:79], v[32:35], v[40:43], v[64:79]
    v_dot2c_f32_bf16 v20, s27, v36
    v_dot2c_f32_bf16 v22, v36, v36
    v_mfma_f32_32x32x16_bf16 v[96:111], v[32:35], v[44:47], v[96:111]
    ds_read_b128 v[48:51], v7 offset:0
    v_dot2c_f32_bf16 v21, s27, v37
    v_mfma_f32_32x32x16_bf16 v[128:143], v[44:47], v[32:35], v[128:143]
    ds_read_b128 v[52:55], v7 offset:4096
    v_dot2c_f32_bf16 v23, v37, v37
    v_mfma_f32_32x32x16_bf16 v[80:95], v[36:39], v[40:43], v[80:95]
    ds_read_b128 v[56:59], v4 offset:2048
    v_dot2c_f32_bf16 v20, s27, v38
    v_dot2c_f32_bf16 v22, v38, v38
    v_mfma_f32_32x32x16_bf16 v[112:127], v[36:39], v[44:47], v[112:127]
    ds_read_b128 v[60:63], v4 offset:3072
    v_dot2c_f32_bf16 v21, s27, v39
    v_mfma_f32_32x32x16_bf16 v[144:159], v[44:47], v[36:39], v[144:159]
    v_dot2c_f32_bf16 v23, v39, v39
    s_waitcnt lgkmcnt(0)
    v_mfma_f32_32x32x16_bf16 v[64:79], v[48:51], v[56:59], v[64:79]
    v_dot2c_f32_bf16 v20, s27, v52
    v_dot2c_f32_bf16 v22, v52, v52
    v_mfma_f32_32x32x16_bf16 v[96:111], v[48:51], v[60:63], v[96:111]
    ds_read_b128 v[32:35], v8 offset:0
    v_dot2c_f32_bf16 v21, s27, v53
    v_mfma_f32_32x32x16_bf16 v[128:143], v[60:63], v[48:51], v[128:143]
    ds_read_b128 v[36:39], v8 offset:4096
    v_dot2c_f32_bf16 v23, v53, v53
    v_mfma_f32_32x32x16_bf16 v[80:95], v[52:55], v[56:59], v[80:95]
    ds_read_b128 v[40:43], v4 offset:4096
    v_dot2c_f32_bf16 v20, s27, v54
    v_dot2c_f32_bf16 v22, v54, v54
    v_mfma_f32_32x32x16_bf16 v[112:127], v[52:55], v[60:63], v[112:127]
    ds_read_b128 v[44:47], v4 offset:5120
    v_dot2c_f32_bf16 v21, s27, v55
    v_mfma_f32_32x32x16_bf16 v[144:159], v[60:63], v[52:55], v[144:159]
    v_dot2c_f32_bf16 v23, v55, v55
    s_waitcnt lgkmcnt(0)
    v_mfma_f32_32x32x16_bf16 v[64:79], v[32:35], v[40:43], v[64:79]
    v_dot2c_f32_bf16 v20, s27, v36
    v_dot2c_f32_bf16 v22, v36, v36
    v_mfma_f32_32x32x16_bf16 v[96:111], v[32:35], v[44:47], v[96:111]
    ds_read_b128 v[48:51], v9 offset:0
    v_dot2c_f32_bf16 v21, s27, v37
    v_mfma_f32_32x32x16_bf16 v[128:143], v[44:47], v[32:35], v[128:143]
    ds_read_b128 v[52:55], v9 offset:4096
    v_dot2c_f32_bf16 v23, v37, v37
    v_mfma_f32_32x32x16_bf16 v[80:95], v[36:39], v[40:43], v[80:95]
    ds_read_b128 v[56:59], v4 offset:6144
    v_dot2c_f32_bf16 v20, s27, v38
    v_dot2c_f32_bf16 v22, v38, v38
    v_mfma_f32_32x32x16_bf16 v[112:127], v[36:39], v[44:47], v[112:127]
    ds_read_b128 v[60:63], v4 offset:7168
    v_dot2c_f32_bf16 v21, s27, v39
    v_mfma_f32_32x32x16_bf16 v[144:159], v[44:47], v[36:39], v[144:159]
    v_dot2c_f32_bf16 v23, v39, v39
    s_waitcnt vmcnt(0)
    s_barrier
    s_waitcnt lgkmcnt(0)
    v_mfma_f32_32x32x16_bf16 v[64:79], v[48:51], v[56:59], v[64:79]
    v_dot2c_f32_bf16 v20, s27, v52
    v_dot2c_f32_bf16 v22, v52, v52
    v_mfma_f32_32x32x16_bf16 v[96:111], v[48:51], v[60:63], v[96:111]
    ds_read_b128 v[32:35], v6 offset:32768
    v_dot2c_f32_bf16 v21, s27, v53
    v_mfma_f32_32x32x16_bf16 v[128:143], v[60:63], v[48:51], v[128:143]
    ds_read_b128 v[36:39], v6 offset:36864
    v_dot2c_f32_bf16 v23, v53, v53
    v_mfma_f32_32x32x16_bf16 v[80:95], v[52:55], v[56:59], v[80:95]
    ds_read_b128 v[40:43], v4 offset:32768
    v_dot2c_f32_bf16 v20, s27, v54
    v_dot2c_f32_bf16 v22, v54, v54
    v_mfma_f32_32x32x16_bf16 v[112:127], v[52:55], v[60:63], v[112:127]
    ds_read_b128 v[44:47], v4 offset:33792
    v_dot2c_f32_bf16 v21, s27, v55
    v_mfma_f32_32x32x16_bf16 v[144:159], v[60:63], v[52:55], v[144:159]
    v_dot2c_f32_bf16 v23, v55, v55
    s_waitcnt lgkmcnt(0)
    v_mfma_f32_32x32x16_bf16 v[64:79], v[32:35], v[40:43], v[64:79]
    v_dot2c_f32_bf16 v20, s27, v36
    v_dot2c_f32_bf16 v22, v36, v36
    v_mfma_f32_32x32x16_bf16 v[96:111], v[32:35], v[44:47], v[96:111]
    ds_read_b128 v[48:51], v7 offset:32768
    v_dot2c_f32_bf16 v21, s27, v37
    v_mfma_f32_32x32x16_bf16 v[128:143], v[44:47], v[32:35], v[128:143]
    ds_read_b128 v[52:55], v7 offset:36864
    v_dot2c_f32_bf16 v23, v37, v37
    v_mfma_f32_32x32x16_bf16 v[80:95], v[36:39], v[40:43], v[80:95]
    ds_read_b128 v[56:59], v4 offset:34816
    v_dot2c_f32_bf16 v20, s27, v38
    v_dot2c_f32_bf16 v22, v38, v38
    v_mfma_f32_32x32x16_bf16 v[112:127], v[36:39], v[44:47], v[112:127]
    ds_read_b128 v[60:63], v4 offset:35840
    v_dot2c_f32_bf16 v21, s27, v39
    v_mfma_f32_32x32x16_bf16 v[144:159], v[44:47], v[36:39], v[144:159]
    v_dot2c_f32_bf16 v23, v39, v39
    s_waitcnt lgkmcnt(0)
    v_mfma_f32_32x32x16_bf16 v[64:79], v[48:51], v[56:59], v[64:79]
    v_dot2c_f32_bf16 v20, s27, v52
    v_dot2c_f32_bf16 v22, v52, v52
    v_mfma_f32_32x32x16_bf16 v[96:111], v[48:51], v[60:63], v[96:111]
    ds_read_b128 v[32:35], v8 offset:32768
    v_dot2c_f32_bf16 v21, s27, v53
    v_mfma_f32_32x32x16_bf16 v[128:143], v[60:63], v[48:51], v[128:143]
    ds_read_b128 v[36:39], v8 offset:36864
    v_dot2c_f32_bf16 v23, v53, v53
    v_mfma_f32_32x32x16_bf16 v[80:95], v[52:55], v[56:59], v[80:95]
    ds_read_b128 v[40:43], v4 offset:36864
    v_dot2c_f32_bf16 v20, s27, v54
    v_dot2c_f32_bf16 v22, v54, v54
    v_mfma_f32_32x32x16_bf16 v[112:127], v[52:55], v[60:63], v[112:127]
    ds_read_b128 v[44:47], v4 offset:37888
    v_dot2c_f32_bf16 v21, s27, v55
    v_mfma_f32_32x32x16_bf16 v[144:159], v[60:63], v[52:55], v[144:159]
    v_dot2c_f32_bf16 v23, v55, v55
    s_waitcnt lgkmcnt(0)
    v_mfma_f32_32x32x16_bf16 v[64:79], v[32:35], v[40:43], v[64:79]
    v_dot2c_f32_bf16 v20, s27, v36
    v_dot2c_f32_bf16 v22, v36, v36
    v_mfma_f32_32x32x16_bf16 v[96:111], v[32:35], v[44:47], v[96:111]
    ds_read_b128 v[48:51], v9 offset:32768
    v_dot2c_f32_bf16 v21, s27, v37
    v_mfma_f32_32x32x16_bf16 v[128:143], v[44:47], v[32:35], v[128:143]
    ds_read_b128 v[52:55], v9 offset:36864
    v_dot2c_f32_bf16 v23, v37, v37
    v_mfma_f32_32x32x16_bf16 v[80:95], v[36:39], v[40:43], v[80:95]
    ds_read_b128 v[56:59], v4 offset:38912
    v_dot2c_f32_bf16 v20, s27, v38
    v_dot2c_f32_bf16 v22, v38, v38
    v_mfma_f32_32x32x16_bf16 v[112:127], v[36:39], v[44:47], v[112:127]
    ds_read_b128 v[60:63], v4 offset:39936
    v_dot2c_f32_bf16 v21, s27, v39
    v_mfma_f32_32x32x16_bf16 v[144:159], v[44:47], v[36:39], v[144:159]
    v_dot2c_f32_bf16 v23, v39, v39
    s_waitcnt lgkmcnt(0)
    v_mfma_f32_32x32x16_bf16 v[64:79], v[48:51], v[56:59], v[64:79]
    v_dot2c_f32_bf16 v20, s27, v52
    v_dot2c_f32_bf16 v22, v52, v52
    v_mfma_f32_32x32x16_bf16 v[96:111], v[48:51], v[60:63], v[96:111]
    v_dot2c_f32_bf16 v21, s27, v53
    v_mfma_f32_32x32x16_bf16 v[128:143], v[60:63], v[48:51], v[128:143]
    v_dot2c_f32_bf16 v23, v53, v53
    v_mfma_f32_32x32x16_bf16 v[80:95], v[52:55], v[56:59], v[80:95]
    v_dot2c_f32_bf16 v20, s27, v54
    v_dot2c_f32_bf16 v22, v54, v54
    v_mfma_f32_32x32x16_bf16 v[112:127], v[52:55], v[60:63], v[112:127]
    v_dot2c_f32_bf16 v21, s27, v55
    v_mfma_f32_32x32x16_bf16 v[144:159], v[60:63], v[52:55], v[144:159]
    v_dot2c_f32_bf16 v23, v55, v55
afront2_kernel_af_epi:
    v_add_f32 v20, v20, v21
    v_add_f32 v22, v22, v23
    v_mov_b32 v21, v20
    v_mov_b32 v23, v22
    s_nop 1
    v_permlane32_swap_b32 v20, v21
    v_permlane32_swap_b32 v22, v23
    v_add_f32 v20, v20, v21
    v_add_f32 v22, v22, v23
    v_mul_f32 v20, 0x3acccccd, v20
    v_mul_f32 v21, v20, v20
    v_mul_f32 v22, 0x3acccccd, v22
    v_sub_f32 v22, v22, v21
    v_max_f32 v22, 0, v22
    v_add_f32 v22, 0x3727c5ac, v22
    v_rsq_f32 v22, v22
    v_and_b32 v16, 31, v0
    s_lshl_b32 s28, s13, 7
    s_add_u32 s28, s28, 65536
    v_lshl_add_u32 v17, v16, 2, s28
    ds_write_b32 v17, v22
    s_waitcnt lgkmcnt(0)
    s_barrier
    s_lshl_b32 s28, s22, 8
    s_add_u32 s28, s28, 65536
    v_lshl_add_u32 v17, v16, 2, s28
    v_lshrrev_b32 v18, 5, v0
    v_lshlrev_b32 v18, 4, v18
    v_add_u32 v18, s28, v18
    ds_read_b32 v224, v17 offset:0
    ds_read_b128 v[192:195], v18 offset:0
    ds_read_b128 v[196:199], v18 offset:32
    ds_read_b128 v[200:203], v18 offset:64
    ds_read_b128 v[204:207], v18 offset:96
    ds_read_b32 v225, v17 offset:128
    ds_read_b128 v[208:211], v18 offset:128
    ds_read_b128 v[212:215], v18 offset:160
    ds_read_b128 v[216:219], v18 offset:192
    ds_read_b128 v[220:223], v18 offset:224
    v_and_b32 v16, 31, v0
    v_mov_b32 v228, 0x358637bd
    v_cmp_gt_u32 vcc, 20, v16
    s_mov_b64 s[30:31], vcc
    s_nop 0
    v_cndmask_b32 v226, 0, v228, vcc
    v_cmp_eq_u32 vcc, 8, v16
    s_nop 1
    v_cndmask_b32 v227, 0, 1.0, vcc
    s_waitcnt lgkmcnt(0)
    v_fma_f32 v64, v64, v192, v226
    v_mul_f32 v48, 0x3fb8aa3b, v64
    v_exp_f32 v48, v48 clamp
    v_max_f32 v49, v64, v228
    v_fma_f32 v96, v96, v192, v227
    v_add_f32 v48, v48, v49
    v_cndmask_b32 v64, v64, v48, s[30:31]
    v_fma_f32 v65, v65, v193, v226
    v_mul_f32 v50, 0x3fb8aa3b, v65
    v_exp_f32 v50, v50 clamp
    v_max_f32 v51, v65, v228
    v_fma_f32 v97, v97, v193, v227
    v_add_f32 v50, v50, v51
    v_cndmask_b32 v65, v65, v50, s[30:31]
    v_fma_f32 v66, v66, v194, v226
    v_mul_f32 v52, 0x3fb8aa3b, v66
    v_exp_f32 v52, v52 clamp
    v_max_f32 v53, v66, v228
    v_fma_f32 v98, v98, v194, v227
    v_add_f32 v52, v52, v53
    v_cndmask_b32 v66, v66, v52, s[30:31]
    v_fma_f32 v67, v67, v195, v226
    v_mul_f32 v54, 0x3fb8aa3b, v67
    v_exp_f32 v54, v54 clamp
    v_max_f32 v55, v67, v228
    v_fma_f32 v99, v99, v195, v227
    v_add_f32 v54, v54, v55
    v_cndmask_b32 v67, v67, v54, s[30:31]
    v_fma_f32 v68, v68, v196, v226
    v_mul_f32 v48, 0x3fb8aa3b, v68
    v_exp_f32 v48, v48 clamp
    v_max_f32 v49, v68, v228
    v_fma_f32 v100, v100, v196, v227
    v_add_f32 v48, v48, v49
    v_cndmask_b32 v68, v68, v48, s[30:31]
    v_fma_f32 v69, v69, v197, v226
    v_mul_f32 v50, 0x3fb8aa3b, v69
    v_exp_f32 v50, v50 clamp
    v_max_f32 v51, v69, v228
    v_fma_f32 v101, v101, v197, v227
    v_add_f32 v50, v50, v51
    v_cndmask_b32 v69, v69, v50, s[30:31]
    v_fma_f32 v70, v70, v198, v226
    v_mul_f32 v52, 0x3fb8aa3b, v70
    v_exp_f32 v52, v52 clamp
    v_max_f32 v53, v70, v228
    v_fma_f32 v102, v102, v198, v227
    v_add_f32 v52, v52, v53
    v_cndmask_b32 v70, v70, v52, s[30:31]
    v_fma_f32 v71, v71, v199, v226
    v_mul_f32 v54, 0x3fb8aa3b, v71
    v_exp_f32 v54, v54 clamp
    v_max_f32 v55, v71, v228
    v_fma_f32 v103, v103, v199, v227
    v_add_f32 v54, v54, v55
    v_cndmask_b32 v71, v71, v54, s[30:31]
    v_fma_f32 v72, v72, v200, v226
    v_mul_f32 v48, 0x3fb8aa3b, v72
    v_exp_f32 v48, v48 clamp
    v_max_f32 v49, v72, v228
    v_fma_f32 v104, v104, v200, v227
    v_add_f32 v48, v48, v49
    v_cndmask_b32 v72, v72, v48, s[30:31]
    v_fma_f32 v73, v73, v201, v226
    v_mul_f32 v50, 0x3fb8aa3b, v73
    v_exp_f32 v50, v50 clamp
    v_max_f32 v51, v73, v228
    v_fma_f32 v105, v105, v201, v227
    v_add_f32 v50, v50, v51
    v_cndmask_b32 v73, v73, v50, s[30:31]
    v_fma_f32 v74, v74, v202, v226
    v_mul_f32 v52, 0x3fb8aa3b, v74
    v_exp_f32 v52, v52 clamp
    v_max_f32 v53, v74, v228
    v_fma_f32 v106, v106, v202, v227
    v_add_f32 v52, v52, v53
    v_cndmask_b32 v74, v74, v52, s[30:31]
    v_fma_f32 v75, v75, v203, v226
    v_mul_f32 v54, 0x3fb8aa3b, v75
    v_exp_f32 v54, v54 clamp
    v_max_f32 v55, v75, v228
    v_fma_f32 v107, v107, v203, v227
    v_add_f32 v54, v54, v55
    v_cndmask_b32 v75, v75, v54, s[30:31]
    v_fma_f32 v76, v76, v204, v226
    v_mul_f32 v48, 0x3fb8aa3b, v76
    v_exp_f32 v48, v48 clamp
    v_max_f32 v49, v76, v228
    v_fma_f32 v108, v108, v204, v227
    v_add_f32 v48, v48, v49
    v_cndmask_b32 v76, v76, v48, s[30:31]
    v_fma_f32 v77, v77, v205, v226
    v_mul_f32 v50, 0x3fb8aa3b, v77
    v_exp_f32 v50, v50 clamp
    v_max_f32 v51, v77, v228
    v_fma_f32 v109, v109, v205, v227
    v_add_f32 v50, v50, v51
    v_cndmask_b32 v77, v77, v50, s[30:31]
    v_fma_f32 v78, v78, v206, v226
    v_mul_f32 v52, 0x3fb8aa3b, v78
    v_exp_f32 v52, v52 clamp
    v_max_f32 v53, v78, v228
    v_fma_f32 v110, v110, v206, v227
    v_add_f32 v52, v52, v53
    v_cndmask_b32 v78, v78, v52, s[30:31]
    v_fma_f32 v79, v79, v207, v226
    v_mul_f32 v54, 0x3fb8aa3b, v79
    v_exp_f32 v54, v54 clamp
    v_max_f32 v55, v79, v228
    v_fma_f32 v111, v111, v207, v227
    v_add_f32 v54, v54, v55
    v_cndmask_b32 v79, v79, v54, s[30:31]
    v_cvt_pk_bf16_f32 v32, v64, v65
    v_cvt_pk_bf16_f32 v40, v96, v97
    v_cvt_pk_bf16_f32 v33, v66, v67
    v_cvt_pk_bf16_f32 v41, v98, v99
    v_cvt_pk_bf16_f32 v34, v68, v69
    v_cvt_pk_bf16_f32 v42, v100, v101
    v_cvt_pk_bf16_f32 v35, v70, v71
    v_cvt_pk_bf16_f32 v43, v102, v103
    v_cvt_pk_bf16_f32 v36, v72, v73
    v_cvt_pk_bf16_f32 v44, v104, v105
    v_cvt_pk_bf16_f32 v37, v74, v75
    v_cvt_pk_bf16_f32 v45, v106, v107
    v_cvt_pk_bf16_f32 v38, v76, v77
    v_cvt_pk_bf16_f32 v46, v108, v109
    v_cvt_pk_bf16_f32 v39, v78, v79
    v_cvt_pk_bf16_f32 v47, v110, v111
    s_nop 1
    v_mfma_f32_32x32x16_bf16 v[160:175], v[32:35], v[32:35], 0
    v_mfma_f32_32x32x16_bf16 v[176:191], v[40:43], v[32:35], 0
    v_mfma_f32_32x32x16_bf16 v[160:175], v[36:39], v[36:39], v[160:175]
    v_mfma_f32_32x32x16_bf16 v[176:191], v[44:47], v[36:39], v[176:191]
    v_fma_f32 v80, v80, v208, v226
    v_mul_f32 v48, 0x3fb8aa3b, v80
    v_exp_f32 v48, v48 clamp
    v_max_f32 v49, v80, v228
    v_fma_f32 v112, v112, v208, v227
    v_add_f32 v48, v48, v49
    v_cndmask_b32 v80, v80, v48, s[30:31]
    v_fma_f32 v81, v81, v209, v226
    v_mul_f32 v50, 0x3fb8aa3b, v81
    v_exp_f32 v50, v50 clamp
    v_max_f32 v51, v81, v228
    v_fma_f32 v113, v113, v209, v227
    v_add_f32 v50, v50, v51
    v_cndmask_b32 v81, v81, v50, s[30:31]
    v_fma_f32 v82, v82, v210, v226
    v_mul_f32 v52, 0x3fb8aa3b, v82
    v_exp_f32 v52, v52 clamp
    v_max_f32 v53, v82, v228
    v_fma_f32 v114, v114, v210, v227
    v_add_f32 v52, v52, v53
    v_cndmask_b32 v82, v82, v52, s[30:31]
    v_fma_f32 v83, v83, v211, v226
    v_mul_f32 v54, 0x3fb8aa3b, v83
    v_exp_f32 v54, v54 clamp
    v_max_f32 v55, v83, v228
    v_fma_f32 v115, v115, v211, v227
    v_add_f32 v54, v54, v55
    v_cndmask_b32 v83, v83, v54, s[30:31]
    v_fma_f32 v84, v84, v212, v226
    v_mul_f32 v48, 0x3fb8aa3b, v84
    v_exp_f32 v48, v48 clamp
    v_max_f32 v49, v84, v228
    v_fma_f32 v116, v116, v212, v227
    v_add_f32 v48, v48, v49
    v_cndmask_b32 v84, v84, v48, s[30:31]
    v_fma_f32 v85, v85, v213, v226
    v_mul_f32 v50, 0x3fb8aa3b, v85
    v_exp_f32 v50, v50 clamp
    v_max_f32 v51, v85, v228
    v_fma_f32 v117, v117, v213, v227
    v_add_f32 v50, v50, v51
    v_cndmask_b32 v85, v85, v50, s[30:31]
    v_fma_f32 v86, v86, v214, v226
    v_mul_f32 v52, 0x3fb8aa3b, v86
    v_exp_f32 v52, v52 clamp
    v_max_f32 v53, v86, v228
    v_fma_f32 v118, v118, v214, v227
    v_add_f32 v52, v52, v53
    v_cndmask_b32 v86, v86, v52, s[30:31]
    v_fma_f32 v87, v87, v215, v226
    v_mul_f32 v54, 0x3fb8aa3b, v87
    v_exp_f32 v54, v54 clamp
    v_max_f32 v55, v87, v228
    v_fma_f32 v119, v119, v215, v227
    v_add_f32 v54, v54, v55
    v_cndmask_b32 v87, v87, v54, s[30:31]
    v_fma_f32 v88, v88, v216, v226
    v_mul_f32 v48, 0x3fb8aa3b, v88
    v_exp_f32 v48, v48 clamp
    v_max_f32 v49, v88, v228
    v_fma_f32 v120, v120, v216, v227
    v_add_f32 v48, v48, v49
    v_cndmask_b32 v88, v88, v48, s[30:31]
    v_fma_f32 v89, v89, v217, v226
    v_mul_f32 v50, 0x3fb8aa3b, v89
    v_exp_f32 v50, v50 clamp
    v_max_f32 v51, v89, v228
    v_fma_f32 v121, v121, v217, v227
    v_add_f32 v50, v50, v51
    v_cndmask_b32 v89, v89, v50, s[30:31]
    v_fma_f32 v90, v90, v218, v226
    v_mul_f32 v52, 0x3fb8aa3b, v90
    v_exp_f32 v52, v52 clamp
    v_max_f32 v53, v90, v228
    v_fma_f32 v122, v122, v218, v227
    v_add_f32 v52, v52, v53
    v_cndmask_b32 v90, v90, v52, s[30:31]
    v_fma_f32 v91, v91, v219, v226
    v_mul_f32 v54, 0x3fb8aa3b, v91
    v_exp_f32 v54, v54 clamp
    v_max_f32 v55, v91, v228
    v_fma_f32 v123, v123, v219, v227
    v_add_f32 v54, v54, v55
    v_cndmask_b32 v91, v91, v54, s[30:31]
    v_fma_f32 v92, v92, v220, v226
    v_mul_f32 v48, 0x3fb8aa3b, v92
    v_exp_f32 v48, v48 clamp
    v_max_f32 v49, v92, v228
    v_fma_f32 v124, v124, v220, v227
    v_add_f32 v48, v48, v49
    v_cndmask_b32 v92, v92, v48, s[30:31]
    v_fma_f32 v93, v93, v221, v226
    v_mul_f32 v50, 0x3fb8aa3b, v93
    v_exp_f32 v50, v50 clamp
    v_max_f32 v51, v93, v228
    v_fma_f32 v125, v125, v221, v227
    v_add_f32 v50, v50, v51
    v_cndmask_b32 v93, v93, v50, s[30:31]
    v_fma_f32 v94, v94, v222, v226
    v_mul_f32 v52, 0x3fb8aa3b, v94
    v_exp_f32 v52, v52 clamp
    v_max_f32 v53, v94, v228
    v_fma_f32 v126, v126, v222, v227
    v_add_f32 v52, v52, v53
    v_cndmask_b32 v94, v94, v52, s[30:31]
    v_fma_f32 v95, v95, v223, v226
    v_mul_f32 v54, 0x3fb8aa3b, v95
    v_exp_f32 v54, v54 clamp
    v_max_f32 v55, v95, v228
    v_fma_f32 v127, v127, v223, v227
    v_add_f32 v54, v54, v55
    v_cndmask_b32 v95, v95, v54, s[30:31]
    v_cvt_pk_bf16_f32 v32, v80, v81
    v_cvt_pk_bf16_f32 v40, v112, v113
    v_cvt_pk_bf16_f32 v33, v82, v83
    v_cvt_pk_bf16_f32 v41, v114, v115
    v_cvt_pk_bf16_f32 v34, v84, v85
    v_cvt_pk_bf16_f32 v42, v116, v117
    v_cvt_pk_bf16_f32 v35, v86, v87
    v_cvt_pk_bf16_f32 v43, v118, v119
    v_cvt_pk_bf16_f32 v36, v88, v89
    v_cvt_pk_bf16_f32 v44, v120, v121
    v_cvt_pk_bf16_f32 v37, v90, v91
    v_cvt_pk_bf16_f32 v45, v122, v123
    v_cvt_pk_bf16_f32 v38, v92, v93
    v_cvt_pk_bf16_f32 v46, v124, v125
    v_cvt_pk_bf16_f32 v39, v94, v95
    v_cvt_pk_bf16_f32 v47, v126, v127
    s_nop 1
    v_mfma_f32_32x32x16_bf16 v[160:175], v[32:35], v[32:35], v[160:175]
    v_mfma_f32_32x32x16_bf16 v[176:191], v[40:43], v[32:35], v[176:191]
    v_mfma_f32_32x32x16_bf16 v[160:175], v[36:39], v[36:39], v[160:175]
    v_mfma_f32_32x32x16_bf16 v[176:191], v[44:47], v[36:39], v[176:191]
    v_fma_f32 v132, v132, v224, v228
    v_mul_f32 v48, 0x3fb8aa3b, v132
    v_exp_f32 v48, v48 clamp
    v_max_f32 v49, v132, v228
    v_add_f32 v132, v48, v49
    v_fma_f32 v133, v133, v224, v228
    v_mul_f32 v50, 0x3fb8aa3b, v133
    v_exp_f32 v50, v50 clamp
    v_max_f32 v51, v133, v228
    v_add_f32 v133, v50, v51
    v_fma_f32 v134, v134, v224, v228
    v_mul_f32 v52, 0x3fb8aa3b, v134
    v_exp_f32 v52, v52 clamp
    v_max_f32 v53, v134, v228
    v_add_f32 v134, v52, v53
    v_fma_f32 v135, v135, v224, v228
    v_mul_f32 v54, 0x3fb8aa3b, v135
    v_exp_f32 v54, v54 clamp
    v_max_f32 v55, v135, v228
    v_add_f32 v135, v54, v55
    v_fma_f32 v136, v136, v224, v228
    v_mul_f32 v48, 0x3fb8aa3b, v136
    v_exp_f32 v48, v48 clamp
    v_max_f32 v49, v136, v228
    v_add_f32 v136, v48, v49
    v_fma_f32 v137, v137, v224, v228
    v_mul_f32 v50, 0x3fb8aa3b, v137
    v_exp_f32 v50, v50 clamp
    v_max_f32 v51, v137, v228
    v_add_f32 v137, v50, v51
    v_fma_f32 v138, v138, v224, v228
    v_mul_f32 v52, 0x3fb8aa3b, v138
    v_exp_f32 v52, v52 clamp
    v_max_f32 v53, v138, v228
    v_add_f32 v138, v52, v53
    v_fma_f32 v139, v139, v224, v228
    v_mul_f32 v54, 0x3fb8aa3b, v139
    v_exp_f32 v54, v54 clamp
    v_max_f32 v55, v139, v228
    v_add_f32 v139, v54, v55
    v_fma_f32 v140, v140, v224, v228
    v_mul_f32 v48, 0x3fb8aa3b, v140
    v_exp_f32 v48, v48 clamp
    v_max_f32 v49, v140, v228
    v_add_f32 v140, v48, v49
    v_fma_f32 v141, v141, v224, v228
    v_mul_f32 v50, 0x3fb8aa3b, v141
    v_exp_f32 v50, v50 clamp
    v_max_f32 v51, v141, v228
    v_add_f32 v141, v50, v51
    v_fma_f32 v142, v142, v224, v228
    v_mul_f32 v52, 0x3fb8aa3b, v142
    v_exp_f32 v52, v52 clamp
    v_max_f32 v53, v142, v228
    v_add_f32 v142, v52, v53
    v_fma_f32 v143, v143, v224, v228
    v_mul_f32 v54, 0x3fb8aa3b, v143
    v_exp_f32 v54, v54 clamp
    v_max_f32 v55, v143, v228
    v_add_f32 v143, v54, v55
    v_cvt_pk_bf16_f32 v130, v132, v133
    v_cvt_pk_bf16_f32 v131, v134, v135
    v_cvt_pk_bf16_f32 v132, v136, v137
    v_cvt_pk_bf16_f32 v133, v138, v139
    v_cvt_pk_bf16_f32 v134, v140, v141
    v_cvt_pk_bf16_f32 v135, v142, v143
    v_mov_b32 v128, 0
    v_mov_b32 v129, 0
    s_lshl_b32 s28, s13, 13
    s_add_u32 s28, s28, 66560
    v_add_u32 v17, s28, v1
    ds_write_b128 v17, v[160:163] offset:0
    ds_write_b128 v17, v[164:167] offset:1024
    ds_write_b128 v17, v[168:171] offset:2048
    ds_write_b128 v17, v[172:175] offset:3072
    ds_write_b128 v17, v[176:179] offset:4096
    ds_write_b128 v17, v[180:183] offset:5120
    ds_write_b128 v17, v[184:187] offset:6144
    ds_write_b128 v17, v[188:191] offset:7168
    s_lshl_b32 s28, s13, 6
    v_add_u32 v32, s28, v0
    v_cmp_le_u32 vcc, 105, v32
    s_nop 1
    v_cndmask_b32 v33, 0, 1, vcc
    v_mul_u32_u24 v34, 105, v33
    v_sub_u32 v34, v32, v34
    v_mul_u32_u24 v35, 13108, v34
    v_lshrrev_b32 v35, 16, v35
    v_mul_u32_u24 v36, 5, v35
    v_sub_u32 v36, v34, v36
    v_add_u32 v37, 20, v35
    v_subrev_u32 v38, 12, v35
    v_cmp_gt_u32 vcc, 12, v35
    s_nop 1
    v_cndmask_b32 v37, v38, v37, vcc
    v_cndmask_b32 v38, 1, 0, vcc
    v_lshlrev_b32 v38, 12, v38
    v_lshl_add_u32 v38, v33, 13, v38
    v_lshrrev_b32 v39, 3, v37
    v_lshl_add_u32 v38, v39, 10, v38
    v_bfe_u32 v39, v37, 2, 1
    v_lshlrev_b32 v39, 5, v39
    v_lshl_add_u32 v39, v36, 2, v39
    v_lshl_add_u32 v38, v39, 4, v38
    v_and_b32 v39, 3, v37
    v_lshl_add_u32 v38, v39, 2, v38
    v_min_u32 v38, 16320, v38
    v_add_u32 v38, 66560, v38
    s_waitcnt lgkmcnt(0)
    s_barrier
    ds_read_b32 v40, v38 offset:0
    ds_read_b32 v41, v38 offset:16
    ds_read_b32 v42, v38 offset:32
    ds_read_b32 v43, v38 offset:48
    ds_read_b32 v44, v38 offset:16384
    ds_read_b32 v45, v38 offset:16400
    ds_read_b32 v46, v38 offset:16416
    ds_read_b32 v47, v38 offset:16432
    s_lshl_b32 s28, s20, 4
    s_add_u32 s28, s28, s21
    s_lshl_b32 s28, s28, 12
    s_add_u32 s28, s28, 233832448
    v_lshlrev_b32 v39, 4, v32
    v_cmp_gt_u32 vcc, 210, v32
    s_mov_b64 s[32:33], vcc
    s_waitcnt lgkmcnt(0)
    v_add_f32 v40, v40, v44
    v_add_f32 v41, v41, v45
    v_add_f32 v42, v42, v46
    v_add_f32 v43, v43, v47
    s_mov_b64 exec, s[32:33]
    buffer_store_dwordx4 v[40:43], v39, s[8:11], s28 offen sc1
    s_mov_b64 exec, -1
    v_fma_f32 v148, v148, v225, v228
    v_mul_f32 v48, 0x3fb8aa3b, v148
    v_exp_f32 v48, v48 clamp
    v_max_f32 v49, v148, v228
    v_add_f32 v148, v48, v49
    v_fma_f32 v149, v149, v225, v228
    v_mul_f32 v50, 0x3fb8aa3b, v149
    v_exp_f32 v50, v50 clamp
    v_max_f32 v51, v149, v228
    v_add_f32 v149, v50, v51
    v_fma_f32 v150, v150, v225, v228
    v_mul_f32 v52, 0x3fb8aa3b, v150
    v_exp_f32 v52, v52 clamp
    v_max_f32 v53, v150, v228
    v_add_f32 v150, v52, v53
    v_fma_f32 v151, v151, v225, v228
    v_mul_f32 v54, 0x3fb8aa3b, v151
    v_exp_f32 v54, v54 clamp
    v_max_f32 v55, v151, v228
    v_add_f32 v151, v54, v55
    v_fma_f32 v152, v152, v225, v228
    v_mul_f32 v48, 0x3fb8aa3b, v152
    v_exp_f32 v48, v48 clamp
    v_max_f32 v49, v152, v228
    v_add_f32 v152, v48, v49
    v_fma_f32 v153, v153, v225, v228
    v_mul_f32 v50, 0x3fb8aa3b, v153
    v_exp_f32 v50, v50 clamp
    v_max_f32 v51, v153, v228
    v_add_f32 v153, v50, v51
    v_fma_f32 v154, v154, v225, v228
    v_mul_f32 v52, 0x3fb8aa3b, v154
    v_exp_f32 v52, v52 clamp
    v_max_f32 v53, v154, v228
    v_add_f32 v154, v52, v53
    v_fma_f32 v155, v155, v225, v228
    v_mul_f32 v54, 0x3fb8aa3b, v155
    v_exp_f32 v54, v54 clamp
    v_max_f32 v55, v155, v228
    v_add_f32 v155, v54, v55
    v_fma_f32 v156, v156, v225, v228
    v_mul_f32 v48, 0x3fb8aa3b, v156
    v_exp_f32 v48, v48 clamp
    v_max_f32 v49, v156, v228
    v_add_f32 v156, v48, v49
    v_fma_f32 v157, v157, v225, v228
    v_mul_f32 v50, 0x3fb8aa3b, v157
    v_exp_f32 v50, v50 clamp
    v_max_f32 v51, v157, v228
    v_add_f32 v157, v50, v51
    v_fma_f32 v158, v158, v225, v228
    v_mul_f32 v52, 0x3fb8aa3b, v158
    v_exp_f32 v52, v52 clamp
    v_max_f32 v53, v158, v228
    v_add_f32 v158, v52, v53
    v_fma_f32 v159, v159, v225, v228
    v_mul_f32 v54, 0x3fb8aa3b, v159
    v_exp_f32 v54, v54 clamp
    v_max_f32 v55, v159, v228
    v_add_f32 v159, v54, v55
    v_cvt_pk_bf16_f32 v146, v148, v149
    v_cvt_pk_bf16_f32 v147, v150, v151
    v_cvt_pk_bf16_f32 v148, v152, v153
    v_cvt_pk_bf16_f32 v149, v154, v155
    v_cvt_pk_bf16_f32 v150, v156, v157
    v_cvt_pk_bf16_f32 v151, v158, v159
    v_mov_b32 v144, 0
    v_mov_b32 v145, 0
    s_mul_i32 s29, s26, 5
    v_lshrrev_b32 v17, 5, v0
    v_add_u32 v17, s29, v17
    v_lshrrev_b32 v18, 1, v17
    v_lshlrev_b32 v18, 9, v18
    v_and_b32 v17, 1, v17
    v_lshl_add_u32 v18, v17, 3, v18
    v_and_b32 v16, 31, v0
    v_lshl_add_u32 v14, v16, 4, v18
    v_mul_u32_u24 v15, 80, v16
    v_lshrrev_b32 v17, 5, v0
    v_lshl_add_u32 v15, v17, 4, v15
    s_mul_i32 s29, s23, 1680
    s_add_u32 s29, s29, 48
    v_add_u32 v15, s29, v15
    v_mov_b32 v48, 0
    v_mov_b32 v49, 0
    v_mov_b32 v50, 0
    v_mov_b32 v51, 0
    v_mov_b32 v52, 0
    v_mov_b32 v53, 0
    v_mov_b32 v54, 0
    v_mov_b32 v55, 0
    v_mov_b32 v56, 0
    v_mov_b32 v57, 0
    v_mov_b32 v58, 0
    v_mov_b32 v59, 0
    s_waitcnt vmcnt(0)
    s_barrier
    s_cmp_lg_u32 s13, 0
    s_cbranch_scc1 afront2_kernel_af_go
    s_lshl_b32 s29, s20, 7
    s_add_u32 s29, s29, 10715136
    s_lshl_b32 s30, s21, 2
    v_mov_b32 v16, s30
    v_mov_b32 v17, 1
    s_mov_b64 exec, 1
    buffer_store_dword v17, v16, s[8:11], s29 offen sc1
    s_mov_b64 exec, 0xffff
    v_lshlrev_b32 v16, 2, v0
    s_mov_b32 s31, 400000
afront2_kernel_af_poll:
    buffer_load_dword v17, v16, s[8:11], s29 offen sc1
    s_waitcnt vmcnt(0)
    v_cmp_eq_u32 vcc, 0, v17
    s_sub_u32 s31, s31, 1
    s_cbranch_scc1 afront2_kernel_af_fail
    s_cbranch_vccnz afront2_kernel_af_poll
    s_branch afront2_kernel_af_ok
afront2_kernel_af_fail:
    s_load_dwordx2 s[34:35], s[0:1], 88
    s_waitcnt lgkmcnt(0)
    s_mov_b32 s36, s34
    s_mov_b32 s37, s35
    s_mov_b32 s38, 256
    s_mov_b32 s39, 0x00020000
    s_mov_b64 exec, 1
    v_mov_b32 v16, 0
    v_mov_b32 v17, 0xdead
    buffer_store_dword v17, v16, s[36:39], 0 offen
afront2_kernel_af_ok:
    s_mov_b64 exec, -1
afront2_kernel_af_go:
    s_barrier
    s_lshl_b32 s28, s20, 16
    s_add_u32 s28, s28, 233832448
    s_mov_b64 exec, s[32:33]
    buffer_load_dwordx4 v[160:163], v39, s[8:11], s28 offen sc1
    s_add_u32 s28, s28, 4096
    buffer_load_dwordx4 v[164:167], v39, s[8:11], s28 offen sc1
    s_add_u32 s28, s28, 4096
    buffer_load_dwordx4 v[168:171], v39, s[8:11], s28 offen sc1
    s_add_u32 s28, s28, 4096
    buffer_load_dwordx4 v[172:175], v39, s[8:11], s28 offen sc1
    s_add_u32 s28, s28, 4096
    buffer_load_dwordx4 v[176:179], v39, s[8:11], s28 offen sc1
    s_add_u32 s28, s28, 4096
    buffer_load_dwordx4 v[180:183], v39, s[8:11], s28 offen sc1
    s_add_u32 s28, s28, 4096
    buffer_load_dwordx4 v[184:187], v39, s[8:11], s28 offen sc1
    s_add_u32 s28, s28, 4096
    buffer_load_dwordx4 v[188:191], v39, s[8:11], s28 offen sc1
    s_add_u32 s28, s28, 4096
    buffer_load_dwordx4 v[192:195], v39, s[8:11], s28 offen sc1
    s_add_u32 s28, s28, 4096
    buffer_load_dwordx4 v[196:199], v39, s[8:11], s28 offen sc1
    s_add_u32 s28, s28, 4096
    buffer_load_dwordx4 v[200:203], v39, s[8:11], s28 offen sc1
    s_add_u32 s28, s28, 4096
    buffer_load_dwordx4 v[204:207], v39, s[8:11], s28 offen sc1
    s_add_u32 s28, s28, 4096
    buffer_load_dwordx4 v[208:211], v39, s[8:11], s28 offen sc1
    s_add_u32 s28, s28, 4096
    buffer_load_dwordx4 v[212:215], v39, s[8:11], s28 offen sc1
    s_add_u32 s28, s28, 4096
    buffer_load_dwordx4 v[216:219], v39, s[8:11], s28 offen sc1
    s_add_u32 s28, s28, 4096
    buffer_load_dwordx4 v[220:223], v39, s[8:11], s28 offen sc1
    s_mov_b64 exec, -1
    s_waitcnt vmcnt(14)
    v_add_f32 v160, v160, v164
    v_add_f32 v161, v161, v165
    v_add_f32 v162, v162, v166
    v_add_f32 v163, v163, v167
    s_waitcnt vmcnt(12)
    v_add_f32 v168, v168, v172
    v_add_f32 v169, v169, v173
    v_add_f32 v170, v170, v174
    v_add_f32 v171, v171, v175
    s_waitcnt vmcnt(10)
    v_add_f32 v176, v176, v180
    v_add_f32 v177, v177, v181
    v_add_f32 v178, v178, v182
    v_add_f32 v179, v179, v183
    s_waitcnt vmcnt(8)
    v_add_f32 v184, v184, v188
    v_add_f32 v185, v185, v189
    v_add_f32 v186, v186, v190
    v_add_f32 v187, v187, v191
    s_waitcnt vmcnt(6)
    v_add_f32 v192, v192, v196
    v_add_f32 v193, v193, v197
    v_add_f32 v194, v194, v198
    v_add_f32 v195, v195, v199
    s_waitcnt vmcnt(4)
    v_add_f32 v200, v200, v204
    v_add_f32 v201, v201, v205
    v_add_f32 v202, v202, v206
    v_add_f32 v203, v203, v207
    s_waitcnt vmcnt(2)
    v_add_f32 v208, v208, v212
    v_add_f32 v209, v209, v213
    v_add_f32 v210, v210, v214
    v_add_f32 v211, v211, v215
    s_waitcnt vmcnt(0)
    v_add_f32 v216, v216, v220
    v_add_f32 v217, v217, v221
    v_add_f32 v218, v218, v222
    v_add_f32 v219, v219, v223
    v_add_f32 v160, v160, v168
    v_add_f32 v161, v161, v169
    v_add_f32 v162, v162, v170
    v_add_f32 v163, v163, v171
    v_add_f32 v176, v176, v184
    v_add_f32 v177, v177, v185
    v_add_f32 v178, v178, v186
    v_add_f32 v179, v179, v187
    v_add_f32 v192, v192, v200
    v_add_f32 v193, v193, v201
    v_add_f32 v194, v194, v202
    v_add_f32 v195, v195, v203
    v_add_f32 v208, v208, v216
    v_add_f32 v209, v209, v217
    v_add_f32 v210, v210, v218
    v_add_f32 v211, v211, v219
    v_add_f32 v160, v160, v176
    v_add_f32 v161, v161, v177
    v_add_f32 v162, v162, v178
    v_add_f32 v163, v163, v179
    v_add_f32 v192, v192, v208
    v_add_f32 v193, v193, v209
    v_add_f32 v194, v194, v210
    v_add_f32 v195, v195, v211
    v_add_f32 v160, v160, v192
    v_add_f32 v161, v161, v193
    v_add_f32 v162, v162, v194
    v_add_f32 v163, v163, v195
    v_add_u32 v39, 64, v39
    s_mov_b64 exec, s[32:33]
    ds_write_b128 v39, v[160:163]
    s_mov_b64 exec, -1
    s_waitcnt lgkmcnt(0)
    s_barrier
    s_mov_b32 exec_lo, 0x1fffff
    s_mov_b32 exec_hi, 0x1fffff
    ds_read_b128 v[52:55], v15 offset:32
    ds_read_b128 v[56:59], v15 offset:64
    s_mov_b32 exec_lo, 0
    ds_read_b128 v[48:51], v15
    s_mov_b64 exec, -1
    v_mov_b32 v32, 0
    v_mov_b32 v33, 0
    s_waitcnt lgkmcnt(0)
    v_cvt_pk_bf16_f32 v34, v48, v49
    v_cvt_pk_bf16_f32 v35, v50, v51
    v_cvt_pk_bf16_f32 v36, v52, v53
    v_cvt_pk_bf16_f32 v37, v54, v55
    v_cvt_pk_bf16_f32 v38, v56, v57
    v_cvt_pk_bf16_f32 v39, v58, v59
    s_nop 1
    v_mfma_f32_32x32x16_bf16 v[64:79], v[32:35], v[128:131], 0
    v_mfma_f32_32x32x16_bf16 v[64:79], v[36:39], v[132:135], v[64:79]
    v_mfma_f32_32x32x16_bf16 v[80:95], v[32:35], v[144:147], 0
    v_mfma_f32_32x32x16_bf16 v[80:95], v[36:39], v[148:151], v[80:95]
    s_lshl_b32 s28, s21, 2
    s_lshl_b32 s29, s22, 1
    s_add_u32 s28, s28, s29
    s_mul_i32 s28, s28, 40960
    s_add_u32 s28, s28, 229638144
    s_nop 7
    s_nop 3
    v_add_f32 v40, 0x358637bd, v72
    v_mov_b32 v41, v40
    s_nop 1
    v_permlane32_swap_b32 v40, v41
    v_rcp_f32 v41, v41
    s_nop 0
    v_mul_f32 v64, v64, v41
    v_mul_f32 v65, v65, v41
    v_mul_f32 v66, v66, v41
    v_mul_f32 v67, v67, v41
    v_mul_f32 v68, v68, v41
    v_mul_f32 v69, v69, v41
    v_mul_f32 v70, v70, v41
    v_mul_f32 v71, v71, v41
    v_mul_f32 v72, v72, v41
    v_mul_f32 v73, v73, v41
    v_mul_f32 v74, v74, v41
    v_mul_f32 v75, v75, v41
    v_cvt_pk_bf16_f32 v42, v64, v65
    v_cvt_pk_bf16_f32 v43, v66, v67
    v_cvt_pk_bf16_f32 v44, v68, v69
    v_cvt_pk_bf16_f32 v45, v70, v71
    v_cvt_pk_bf16_f32 v46, v72, v73
    v_cvt_pk_bf16_f32 v47, v74, v75
    buffer_store_dwordx2 v[42:43], v14, s[8:11], s28 offen offset:0
    buffer_store_dwordx2 v[44:45], v14, s[8:11], s28 offen offset:512
    s_mov_b32 exec_hi, 0
    buffer_store_dwordx2 v[46:47], v14, s[8:11], s28 offen offset:1024
    s_mov_b32 exec_hi, -1
    s_add_u32 s28, s28, 40960
    s_nop 7
    v_add_f32 v40, 0x358637bd, v88
    v_mov_b32 v41, v40
    s_nop 1
    v_permlane32_swap_b32 v40, v41
    v_rcp_f32 v41, v41
    s_nop 0
    v_mul_f32 v80, v80, v41
    v_mul_f32 v81, v81, v41
    v_mul_f32 v82, v82, v41
    v_mul_f32 v83, v83, v41
    v_mul_f32 v84, v84, v41
    v_mul_f32 v85, v85, v41
    v_mul_f32 v86, v86, v41
    v_mul_f32 v87, v87, v41
    v_mul_f32 v88, v88, v41
    v_mul_f32 v89, v89, v41
    v_mul_f32 v90, v90, v41
    v_mul_f32 v91, v91, v41
    v_cvt_pk_bf16_f32 v48, v80, v81
    v_cvt_pk_bf16_f32 v49, v82, v83
    v_cvt_pk_bf16_f32 v50, v84, v85
    v_cvt_pk_bf16_f32 v51, v86, v87
    v_cvt_pk_bf16_f32 v52, v88, v89
    v_cvt_pk_bf16_f32 v53, v90, v91
    buffer_store_dwordx2 v[48:49], v14, s[8:11], s28 offen offset:0
    buffer_store_dwordx2 v[50:51], v14, s[8:11], s28 offen offset:512
    s_mov_b32 exec_hi, 0
    buffer_store_dwordx2 v[52:53], v14, s[8:11], s28 offen offset:1024
    s_mov_b32 exec_hi, -1
afront2_kernel_end:
    s_endpgm
.section .rodata,"a"
.p2align 6
.amdhsa_kernel afront2_kernel
  .amdhsa_next_free_vgpr 256
  .amdhsa_next_free_sgpr 64
  .amdhsa_accum_offset 256
  .amdhsa_group_segment_fixed_size 0
  .amdhsa_kernarg_size 104
  .amdhsa_user_sgpr_count 2
  .amdhsa_user_sgpr_kernarg_segment_ptr 1
  .amdhsa_system_sgpr_workgroup_id_x 1
.end_amdhsa_kernel
```

```asm
; @launch kernel=prep_kernel grid=(573,1,1) block=(256,1,1) lds=1024
; @launch kernel=layerb1_kernel grid=(256,1,1) block=(256,1,1) lds=149760
; @launch kernel=layerb2_kernel grid=(256,1,1) block=(256,1,1) lds=149760
.amdgcn_target "amdgcn-amd-amdhsa--gfx950"
.text
.globl prep_kernel
.p2align 8
.type prep_kernel,@function
prep_kernel:
    s_cmp_ge_u32 s2, 573
    s_cbranch_scc1 prep_kernel_end
    s_load_dwordx2 s[4:5], s[0:1], 96
    v_lshrrev_b32 v1, 6, v0
    v_and_b32 v0, 63, v0
    s_nop 0
    v_readfirstlane_b32 s13, v1
    s_waitcnt lgkmcnt(0)
    s_mov_b32 s8, s4
    s_mov_b32 s9, s5
    s_mov_b32 s10, 268435456
    s_mov_b32 s11, 0x00020000
    s_mov_b32 s20, s2
    s_cmp_lt_u32 s2, 4
    s_cbranch_scc1 prep_kernel_r_cal
    s_cmp_eq_u32 s2, 4
    s_cbranch_scc1 prep_kernel_r_zero
    s_sub_u32 s20, s2, 5
    s_cmp_lt_u32 s20, 64
    s_cbranch_scc1 prep_kernel_r_pwa
    s_sub_u32 s20, s20, 64
    s_cmp_lt_u32 s20, 40
    s_cbranch_scc1 prep_kernel_r_pwo
    s_sub_u32 s20, s20, 40
    s_cmp_lt_u32 s20, 160
    s_cbranch_scc1 prep_kernel_r_wvo
    s_sub_u32 s20, s20, 160
    s_cmp_lt_u32 s20, 240
    s_cbranch_scc1 prep_kernel_r_pwp
    s_sub_u32 s20, s20, 240
    s_sub_u32 s21, 0, s4
    s_and_b32 s21, s21, 0x1fffff
    s_mul_i32 s22, s20, 131072
    s_add_u32 s21, s21, s22
    s_lshl_b32 s22, s13, 10
    s_add_u32 s21, s21, s22
    v_lshlrev_b32 v1, 4, v0
    v_mov_b32 v4, -1
    v_mov_b32 v5, -1
    v_mov_b32 v6, -1
    v_mov_b32 v7, -1
    s_mov_b32 s22, 32
prep_kernel_clr_loop:
    buffer_store_dwordx4 v[4:7], v1, s[8:11], s21 offen
    s_add_u32 s21, s21, 4096
    s_sub_u32 s22, s22, 1
    s_cmp_lg_u32 s22, 0
    s_cbranch_scc1 prep_kernel_clr_loop
    s_branch prep_kernel_end
prep_kernel_r_cal:
    s_cmp_lg_u32 s13, 0
    s_cbranch_scc1 prep_kernel_end
    s_sub_u32 s22, 0, s4
    s_and_b32 s22, s22, 0x1fffff
    s_getreg_b32 s23, hwreg(HW_REG_XCC_ID)
    s_bfe_u32 s23, s23, 0x10002
    s_mov_b64 exec, 1
    v_mov_b32 v1, 0
    s_mul_i32 s24, s20, 2097152
    s_add_u32 s22, s22, s24
    s_add_u32 s22, s22, 2086912
    s_mov_b32 s30, -1
    s_mov_b32 s31, -1
    s_mov_b32 s25, 15
    v_mov_b32 v2, 0
prep_kernel_cal:
    s_and_b32 s24, s25, 15
    s_lshl_b32 s24, s24, 7
    s_add_u32 s24, s24, s22
    s_memtime s[26:27]
    s_waitcnt lgkmcnt(0)
    buffer_atomic_add v2, v1, s[8:11], s24 offen sc0 sc1
    s_waitcnt vmcnt(0)
    s_memtime s[28:29]
    v_mov_b32 v2, 0
    s_waitcnt lgkmcnt(0)
    s_sub_u32 s26, s28, s26
    s_min_u32 s30, s30, s26
    s_and_b32 s24, s25, 15
    s_lshl_b32 s24, s24, 7
    s_add_u32 s24, s24, s22
    s_add_u32 s24, s24, 8192
    s_memtime s[26:27]
    s_waitcnt lgkmcnt(0)
    buffer_atomic_add v2, v1, s[8:11], s24 offen sc0 sc1
    s_waitcnt vmcnt(0)
    s_memtime s[28:29]
    v_mov_b32 v2, 0
    s_waitcnt lgkmcnt(0)
    s_sub_u32 s26, s28, s26
    s_min_u32 s31, s31, s26
    s_sub_u32 s25, s25, 1
    s_cmp_lg_u32 s25, 0
    s_cbranch_scc1 prep_kernel_cal
    s_cmp_lt_u32 s31, s30
    s_cselect_b32 s24, 1, 0
    s_xor_b32 s24, s24, s23
    s_lshl_b32 s24, s24, 13
    v_mov_b32 v3, s24
    s_lshl_b32 s25, s20, 2
    s_add_u32 s25, s25, 10551296
    buffer_store_dword v3, v1, s[8:11], s25 offen
    s_lshl_b32 s26, s30, 16
    s_or_b32 s26, s26, s31
    v_mov_b32 v3, s26
    buffer_store_dword v3, v1, s[8:11], s25 offen offset:64
    s_branch prep_kernel_end
prep_kernel_r_zero:
    v_lshlrev_b32 v1, 4, v0
    v_mov_b32 v4, 0
    v_mov_b32 v5, 0
    v_mov_b32 v6, 0
    v_mov_b32 v7, 0
    s_lshl_b32 s21, s13, 10
    s_add_u32 s21, s21, 10485760
    buffer_store_dwordx4 v[4:7], v1, s[8:11], s21 offen
    s_lshl_b32 s21, s13, 15
    s_add_u32 s21, s21, 10616832
    buffer_store_dwordx4 v[4:7], v1, s[8:11], s21 offen offset:0
    buffer_store_dwordx4 v[4:7], v1, s[8:11], s21 offen offset:1024
    buffer_store_dwordx4 v[4:7], v1, s[8:11], s21 offen offset:2048
    buffer_store_dwordx4 v[4:7], v1, s[8:11], s21 offen offset:3072
    s_add_u32 s21, s21, 4096
    buffer_store_dwordx4 v[4:7], v1, s[8:11], s21 offen offset:0
    buffer_store_dwordx4 v[4:7], v1, s[8:11], s21 offen offset:1024
    buffer_store_dwordx4 v[4:7], v1, s[8:11], s21 offen offset:2048
    buffer_store_dwordx4 v[4:7], v1, s[8:11], s21 offen offset:3072
    s_add_u32 s21, s21, 4096
    buffer_store_dwordx4 v[4:7], v1, s[8:11], s21 offen offset:0
    buffer_store_dwordx4 v[4:7], v1, s[8:11], s21 offen offset:1024
    buffer_store_dwordx4 v[4:7], v1, s[8:11], s21 offen offset:2048
    buffer_store_dwordx4 v[4:7], v1, s[8:11], s21 offen offset:3072
    s_add_u32 s21, s21, 4096
    buffer_store_dwordx4 v[4:7], v1, s[8:11], s21 offen offset:0
    buffer_store_dwordx4 v[4:7], v1, s[8:11], s21 offen offset:1024
    buffer_store_dwordx4 v[4:7], v1, s[8:11], s21 offen offset:2048
    buffer_store_dwordx4 v[4:7], v1, s[8:11], s21 offen offset:3072
    s_add_u32 s21, s21, 4096
    buffer_store_dwordx4 v[4:7], v1, s[8:11], s21 offen offset:0
    buffer_store_dwordx4 v[4:7], v1, s[8:11], s21 offen offset:1024
    buffer_store_dwordx4 v[4:7], v1, s[8:11], s21 offen offset:2048
    buffer_store_dwordx4 v[4:7], v1, s[8:11], s21 offen offset:3072
    s_add_u32 s21, s21, 4096
    buffer_store_dwordx4 v[4:7], v1, s[8:11], s21 offen offset:0
    buffer_store_dwordx4 v[4:7], v1, s[8:11], s21 offen offset:1024
    buffer_store_dwordx4 v[4:7], v1, s[8:11], s21 offen offset:2048
    buffer_store_dwordx4 v[4:7], v1, s[8:11], s21 offen offset:3072
    s_add_u32 s21, s21, 4096
    buffer_store_dwordx4 v[4:7], v1, s[8:11], s21 offen offset:0
    buffer_store_dwordx4 v[4:7], v1, s[8:11], s21 offen offset:1024
    buffer_store_dwordx4 v[4:7], v1, s[8:11], s21 offen offset:2048
    buffer_store_dwordx4 v[4:7], v1, s[8:11], s21 offen offset:3072
    s_add_u32 s21, s21, 4096
    buffer_store_dwordx4 v[4:7], v1, s[8:11], s21 offen offset:0
    buffer_store_dwordx4 v[4:7], v1, s[8:11], s21 offen offset:1024
    buffer_store_dwordx4 v[4:7], v1, s[8:11], s21 offen offset:2048
    buffer_store_dwordx4 v[4:7], v1, s[8:11], s21 offen offset:3072
    s_add_u32 s21, s21, 4096
    s_lshl_b32 s21, s13, 15
    s_add_u32 s21, s21, 10747904
    buffer_store_dwordx4 v[4:7], v1, s[8:11], s21 offen offset:0
    buffer_store_dwordx4 v[4:7], v1, s[8:11], s21 offen offset:1024
    buffer_store_dwordx4 v[4:7], v1, s[8:11], s21 offen offset:2048
    buffer_store_dwordx4 v[4:7], v1, s[8:11], s21 offen offset:3072
    s_add_u32 s21, s21, 4096
    buffer_store_dwordx4 v[4:7], v1, s[8:11], s21 offen offset:0
    buffer_store_dwordx4 v[4:7], v1, s[8:11], s21 offen offset:1024
    buffer_store_dwordx4 v[4:7], v1, s[8:11], s21 offen offset:2048
    buffer_store_dwordx4 v[4:7], v1, s[8:11], s21 offen offset:3072
    s_add_u32 s21, s21, 4096
    buffer_store_dwordx4 v[4:7], v1, s[8:11], s21 offen offset:0
    buffer_store_dwordx4 v[4:7], v1, s[8:11], s21 offen offset:1024
    buffer_store_dwordx4 v[4:7], v1, s[8:11], s21 offen offset:2048
    buffer_store_dwordx4 v[4:7], v1, s[8:11], s21 offen offset:3072
    s_add_u32 s21, s21, 4096
    buffer_store_dwordx4 v[4:7], v1, s[8:11], s21 offen offset:0
    buffer_store_dwordx4 v[4:7], v1, s[8:11], s21 offen offset:1024
    buffer_store_dwordx4 v[4:7], v1, s[8:11], s21 offen offset:2048
    buffer_store_dwordx4 v[4:7], v1, s[8:11], s21 offen offset:3072
    s_add_u32 s21, s21, 4096
    buffer_store_dwordx4 v[4:7], v1, s[8:11], s21 offen offset:0
    buffer_store_dwordx4 v[4:7], v1, s[8:11], s21 offen offset:1024
    buffer_store_dwordx4 v[4:7], v1, s[8:11], s21 offen offset:2048
    buffer_store_dwordx4 v[4:7], v1, s[8:11], s21 offen offset:3072
    s_add_u32 s21, s21, 4096
    buffer_store_dwordx4 v[4:7], v1, s[8:11], s21 offen offset:0
    buffer_store_dwordx4 v[4:7], v1, s[8:11], s21 offen offset:1024
    buffer_store_dwordx4 v[4:7], v1, s[8:11], s21 offen offset:2048
    buffer_store_dwordx4 v[4:7], v1, s[8:11], s21 offen offset:3072
    s_add_u32 s21, s21, 4096
    buffer_store_dwordx4 v[4:7], v1, s[8:11], s21 offen offset:0
    buffer_store_dwordx4 v[4:7], v1, s[8:11], s21 offen offset:1024
    buffer_store_dwordx4 v[4:7], v1, s[8:11], s21 offen offset:2048
    buffer_store_dwordx4 v[4:7], v1, s[8:11], s21 offen offset:3072
    s_add_u32 s21, s21, 4096
    buffer_store_dwordx4 v[4:7], v1, s[8:11], s21 offen offset:0
    buffer_store_dwordx4 v[4:7], v1, s[8:11], s21 offen offset:1024
    buffer_store_dwordx4 v[4:7], v1, s[8:11], s21 offen offset:2048
    buffer_store_dwordx4 v[4:7], v1, s[8:11], s21 offen offset:3072
    s_add_u32 s21, s21, 4096
    s_branch prep_kernel_end
prep_kernel_r_wvo:
    s_lshl_b32 s20, s20, 2
    s_add_u32 s20, s20, s13
    s_load_dwordx2 s[24:25], s[0:1], 56
    s_load_dwordx2 s[26:27], s[0:1], 64
    s_and_b32 s21, s20, 1
    s_lshr_b32 s22, s20, 1
    s_mul_i32 s23, s22, 205
    s_lshr_b32 s23, s23, 11
    s_mul_i32 s28, s23, 10
    s_sub_u32 s22, s22, s28
    s_waitcnt lgkmcnt(0)
    s_mov_b32 s32, s24
    s_mov_b32 s33, s25
    s_mov_b32 s34, 7864320
    s_mov_b32 s35, 0x00020000
    s_mov_b32 s36, s26
    s_mov_b32 s37, s27
    s_mov_b32 s38, 7864320
    s_mov_b32 s39, 0x00020000
    v_and_b32 v1, 31, v0
    v_lshrrev_b32 v2, 5, v0
    v_mul_u32_u24 v3, 10240, v2
    v_lshl_add_u32 v3, v1, 2, v3
    s_mul_i32 s28, s23, 245760
    s_lshl_b32 s29, s22, 7
    s_add_u32 s28, s28, s29
    s_add_u32 s29, s28, 0
    buffer_load_dword v112, v3, s[36:39], s29 offen
    s_add_u32 s29, s28, 1280
    buffer_load_dword v113, v3, s[36:39], s29 offen
    s_add_u32 s29, s28, 2560
    buffer_load_dword v114, v3, s[36:39], s29 offen
    s_add_u32 s29, s28, 3840
    buffer_load_dword v115, v3, s[36:39], s29 offen
    s_add_u32 s29, s28, 5120
    buffer_load_dword v116, v3, s[36:39], s29 offen
    s_add_u32 s29, s28, 6400
    buffer_load_dword v117, v3, s[36:39], s29 offen
    s_add_u32 s29, s28, 7680
    buffer_load_dword v118, v3, s[36:39], s29 offen
    s_add_u32 s29, s28, 8960
    buffer_load_dword v119, v3, s[36:39], s29 offen
    s_add_u32 s29, s28, 20480
    buffer_load_dword v120, v3, s[36:39], s29 offen
    s_add_u32 s29, s28, 21760
    buffer_load_dword v121, v3, s[36:39], s29 offen
    s_add_u32 s29, s28, 23040
    buffer_load_dword v122, v3, s[36:39], s29 offen
    s_add_u32 s29, s28, 24320
    buffer_load_dword v123, v3, s[36:39], s29 offen
    s_add_u32 s29, s28, 25600
    buffer_load_dword v124, v3, s[36:39], s29 offen
    s_add_u32 s29, s28, 26880
    buffer_load_dword v125, v3, s[36:39], s29 offen
    s_add_u32 s29, s28, 28160
    buffer_load_dword v126, v3, s[36:39], s29 offen
    s_add_u32 s29, s28, 29440
    buffer_load_dword v127, v3, s[36:39], s29 offen
    s_add_u32 s29, s28, 40960
    buffer_load_dword v128, v3, s[36:39], s29 offen
    s_add_u32 s29, s28, 42240
    buffer_load_dword v129, v3, s[36:39], s29 offen
    s_add_u32 s29, s28, 43520
    buffer_load_dword v130, v3, s[36:39], s29 offen
    s_add_u32 s29, s28, 44800
    buffer_load_dword v131, v3, s[36:39], s29 offen
    s_add_u32 s29, s28, 46080
    buffer_load_dword v132, v3, s[36:39], s29 offen
    s_add_u32 s29, s28, 47360
    buffer_load_dword v133, v3, s[36:39], s29 offen
    s_add_u32 s29, s28, 48640
    buffer_load_dword v134, v3, s[36:39], s29 offen
    s_add_u32 s29, s28, 49920
    buffer_load_dword v135, v3, s[36:39], s29 offen
    s_add_u32 s29, s28, 61440
    buffer_load_dword v136, v3, s[36:39], s29 offen
    s_add_u32 s29, s28, 62720
    buffer_load_dword v137, v3, s[36:39], s29 offen
    s_add_u32 s29, s28, 64000
    buffer_load_dword v138, v3, s[36:39], s29 offen
    s_add_u32 s29, s28, 65280
    buffer_load_dword v139, v3, s[36:39], s29 offen
    s_add_u32 s29, s28, 66560
    buffer_load_dword v140, v3, s[36:39], s29 offen
    s_add_u32 s29, s28, 67840
    buffer_load_dword v141, v3, s[36:39], s29 offen
    s_add_u32 s29, s28, 69120
    buffer_load_dword v142, v3, s[36:39], s29 offen
    s_add_u32 s29, s28, 70400
    buffer_load_dword v143, v3, s[36:39], s29 offen
    s_add_u32 s29, s28, 81920
    buffer_load_dword v144, v3, s[36:39], s29 offen
    s_add_u32 s29, s28, 83200
    buffer_load_dword v145, v3, s[36:39], s29 offen
    s_add_u32 s29, s28, 84480
    buffer_load_dword v146, v3, s[36:39], s29 offen
    s_add_u32 s29, s28, 85760
    buffer_load_dword v147, v3, s[36:39], s29 offen
    s_add_u32 s29, s28, 87040
    buffer_load_dword v148, v3, s[36:39], s29 offen
    s_add_u32 s29, s28, 88320
    buffer_load_dword v149, v3, s[36:39], s29 offen
    s_add_u32 s29, s28, 89600
    buffer_load_dword v150, v3, s[36:39], s29 offen
    s_add_u32 s29, s28, 90880
    buffer_load_dword v151, v3, s[36:39], s29 offen
    s_add_u32 s29, s28, 102400
    buffer_load_dword v152, v3, s[36:39], s29 offen
    s_add_u32 s29, s28, 103680
    buffer_load_dword v153, v3, s[36:39], s29 offen
    s_add_u32 s29, s28, 104960
    buffer_load_dword v154, v3, s[36:39], s29 offen
    s_add_u32 s29, s28, 106240
    buffer_load_dword v155, v3, s[36:39], s29 offen
    s_add_u32 s29, s28, 107520
    buffer_load_dword v156, v3, s[36:39], s29 offen
    s_add_u32 s29, s28, 108800
    buffer_load_dword v157, v3, s[36:39], s29 offen
    s_add_u32 s29, s28, 110080
    buffer_load_dword v158, v3, s[36:39], s29 offen
    s_add_u32 s29, s28, 111360
    buffer_load_dword v159, v3, s[36:39], s29 offen
    v_mov_b32 v4, 0x05040100
    v_mov_b32 v5, 0x07060302
    s_waitcnt vmcnt(0)
    v_perm_b32 v16, v113, v112, v4
    v_perm_b32 v64, v113, v112, v5
    v_perm_b32 v17, v115, v114, v4
    v_perm_b32 v65, v115, v114, v5
    v_perm_b32 v18, v117, v116, v4
    v_perm_b32 v66, v117, v116, v5
    v_perm_b32 v19, v119, v118, v4
    v_perm_b32 v67, v119, v118, v5
    v_perm_b32 v20, v121, v120, v4
    v_perm_b32 v68, v121, v120, v5
    v_perm_b32 v21, v123, v122, v4
    v_perm_b32 v69, v123, v122, v5
    v_perm_b32 v22, v125, v124, v4
    v_perm_b32 v70, v125, v124, v5
    v_perm_b32 v23, v127, v126, v4
    v_perm_b32 v71, v127, v126, v5
    v_perm_b32 v24, v129, v128, v4
    v_perm_b32 v72, v129, v128, v5
    v_perm_b32 v25, v131, v130, v4
    v_perm_b32 v73, v131, v130, v5
    v_perm_b32 v26, v133, v132, v4
    v_perm_b32 v74, v133, v132, v5
    v_perm_b32 v27, v135, v134, v4
    v_perm_b32 v75, v135, v134, v5
    v_perm_b32 v28, v137, v136, v4
    v_perm_b32 v76, v137, v136, v5
    v_perm_b32 v29, v139, v138, v4
    v_perm_b32 v77, v139, v138, v5
    v_perm_b32 v30, v141, v140, v4
    v_perm_b32 v78, v141, v140, v5
    v_perm_b32 v31, v143, v142, v4
    v_perm_b32 v79, v143, v142, v5
    v_perm_b32 v32, v145, v144, v4
    v_perm_b32 v80, v145, v144, v5
    v_perm_b32 v33, v147, v146, v4
    v_perm_b32 v81, v147, v146, v5
    v_perm_b32 v34, v149, v148, v4
    v_perm_b32 v82, v149, v148, v5
    v_perm_b32 v35, v151, v150, v4
    v_perm_b32 v83, v151, v150, v5
    v_perm_b32 v36, v153, v152, v4
    v_perm_b32 v84, v153, v152, v5
    v_perm_b32 v37, v155, v154, v4
    v_perm_b32 v85, v155, v154, v5
    v_perm_b32 v38, v157, v156, v4
    v_perm_b32 v86, v157, v156, v5
    v_perm_b32 v39, v159, v158, v4
    v_perm_b32 v87, v159, v158, v5
    s_add_u32 s29, s28, 122880
    buffer_load_dword v112, v3, s[36:39], s29 offen
    s_add_u32 s29, s28, 124160
    buffer_load_dword v113, v3, s[36:39], s29 offen
    s_add_u32 s29, s28, 125440
    buffer_load_dword v114, v3, s[36:39], s29 offen
    s_add_u32 s29, s28, 126720
    buffer_load_dword v115, v3, s[36:39], s29 offen
    s_add_u32 s29, s28, 128000
    buffer_load_dword v116, v3, s[36:39], s29 offen
    s_add_u32 s29, s28, 129280
    buffer_load_dword v117, v3, s[36:39], s29 offen
    s_add_u32 s29, s28, 130560
    buffer_load_dword v118, v3, s[36:39], s29 offen
    s_add_u32 s29, s28, 131840
    buffer_load_dword v119, v3, s[36:39], s29 offen
    s_add_u32 s29, s28, 143360
    buffer_load_dword v120, v3, s[36:39], s29 offen
    s_add_u32 s29, s28, 144640
    buffer_load_dword v121, v3, s[36:39], s29 offen
    s_add_u32 s29, s28, 145920
    buffer_load_dword v122, v3, s[36:39], s29 offen
    s_add_u32 s29, s28, 147200
    buffer_load_dword v123, v3, s[36:39], s29 offen
    s_add_u32 s29, s28, 148480
    buffer_load_dword v124, v3, s[36:39], s29 offen
    s_add_u32 s29, s28, 149760
    buffer_load_dword v125, v3, s[36:39], s29 offen
    s_add_u32 s29, s28, 151040
    buffer_load_dword v126, v3, s[36:39], s29 offen
    s_add_u32 s29, s28, 152320
    buffer_load_dword v127, v3, s[36:39], s29 offen
    s_add_u32 s29, s28, 163840
    buffer_load_dword v128, v3, s[36:39], s29 offen
    s_add_u32 s29, s28, 165120
    buffer_load_dword v129, v3, s[36:39], s29 offen
    s_add_u32 s29, s28, 166400
    buffer_load_dword v130, v3, s[36:39], s29 offen
    s_add_u32 s29, s28, 167680
    buffer_load_dword v131, v3, s[36:39], s29 offen
    s_add_u32 s29, s28, 168960
    buffer_load_dword v132, v3, s[36:39], s29 offen
    s_add_u32 s29, s28, 170240
    buffer_load_dword v133, v3, s[36:39], s29 offen
    s_add_u32 s29, s28, 171520
    buffer_load_dword v134, v3, s[36:39], s29 offen
    s_add_u32 s29, s28, 172800
    buffer_load_dword v135, v3, s[36:39], s29 offen
    s_add_u32 s29, s28, 184320
    buffer_load_dword v136, v3, s[36:39], s29 offen
    s_add_u32 s29, s28, 185600
    buffer_load_dword v137, v3, s[36:39], s29 offen
    s_add_u32 s29, s28, 186880
    buffer_load_dword v138, v3, s[36:39], s29 offen
    s_add_u32 s29, s28, 188160
    buffer_load_dword v139, v3, s[36:39], s29 offen
    s_add_u32 s29, s28, 189440
    buffer_load_dword v140, v3, s[36:39], s29 offen
    s_add_u32 s29, s28, 190720
    buffer_load_dword v141, v3, s[36:39], s29 offen
    s_add_u32 s29, s28, 192000
    buffer_load_dword v142, v3, s[36:39], s29 offen
    s_add_u32 s29, s28, 193280
    buffer_load_dword v143, v3, s[36:39], s29 offen
    s_add_u32 s29, s28, 204800
    buffer_load_dword v144, v3, s[36:39], s29 offen
    s_add_u32 s29, s28, 206080
    buffer_load_dword v145, v3, s[36:39], s29 offen
    s_add_u32 s29, s28, 207360
    buffer_load_dword v146, v3, s[36:39], s29 offen
    s_add_u32 s29, s28, 208640
    buffer_load_dword v147, v3, s[36:39], s29 offen
    s_add_u32 s29, s28, 209920
    buffer_load_dword v148, v3, s[36:39], s29 offen
    s_add_u32 s29, s28, 211200
    buffer_load_dword v149, v3, s[36:39], s29 offen
    s_add_u32 s29, s28, 212480
    buffer_load_dword v150, v3, s[36:39], s29 offen
    s_add_u32 s29, s28, 213760
    buffer_load_dword v151, v3, s[36:39], s29 offen
    s_add_u32 s29, s28, 225280
    buffer_load_dword v152, v3, s[36:39], s29 offen
    s_add_u32 s29, s28, 226560
    buffer_load_dword v153, v3, s[36:39], s29 offen
    s_add_u32 s29, s28, 227840
    buffer_load_dword v154, v3, s[36:39], s29 offen
    s_add_u32 s29, s28, 229120
    buffer_load_dword v155, v3, s[36:39], s29 offen
    s_add_u32 s29, s28, 230400
    buffer_load_dword v156, v3, s[36:39], s29 offen
    s_add_u32 s29, s28, 231680
    buffer_load_dword v157, v3, s[36:39], s29 offen
    s_add_u32 s29, s28, 232960
    buffer_load_dword v158, v3, s[36:39], s29 offen
    s_add_u32 s29, s28, 234240
    buffer_load_dword v159, v3, s[36:39], s29 offen
    v_mov_b32 v4, 0x05040100
    v_mov_b32 v5, 0x07060302
    s_waitcnt vmcnt(0)
    v_perm_b32 v40, v113, v112, v4
    v_perm_b32 v88, v113, v112, v5
    v_perm_b32 v41, v115, v114, v4
    v_perm_b32 v89, v115, v114, v5
    v_perm_b32 v42, v117, v116, v4
    v_perm_b32 v90, v117, v116, v5
    v_perm_b32 v43, v119, v118, v4
    v_perm_b32 v91, v119, v118, v5
    v_perm_b32 v44, v121, v120, v4
    v_perm_b32 v92, v121, v120, v5
    v_perm_b32 v45, v123, v122, v4
    v_perm_b32 v93, v123, v122, v5
    v_perm_b32 v46, v125, v124, v4
    v_perm_b32 v94, v125, v124, v5
    v_perm_b32 v47, v127, v126, v4
    v_perm_b32 v95, v127, v126, v5
    v_perm_b32 v48, v129, v128, v4
    v_perm_b32 v96, v129, v128, v5
    v_perm_b32 v49, v131, v130, v4
    v_perm_b32 v97, v131, v130, v5
    v_perm_b32 v50, v133, v132, v4
    v_perm_b32 v98, v133, v132, v5
    v_perm_b32 v51, v135, v134, v4
    v_perm_b32 v99, v135, v134, v5
    v_perm_b32 v52, v137, v136, v4
    v_perm_b32 v100, v137, v136, v5
    v_perm_b32 v53, v139, v138, v4
    v_perm_b32 v101, v139, v138, v5
    v_perm_b32 v54, v141, v140, v4
    v_perm_b32 v102, v141, v140, v5
    v_perm_b32 v55, v143, v142, v4
    v_perm_b32 v103, v143, v142, v5
    v_perm_b32 v56, v145, v144, v4
    v_perm_b32 v104, v145, v144, v5
    v_perm_b32 v57, v147, v146, v4
    v_perm_b32 v105, v147, v146, v5
    v_perm_b32 v58, v149, v148, v4
    v_perm_b32 v106, v149, v148, v5
    v_perm_b32 v59, v151, v150, v4
    v_perm_b32 v107, v151, v150, v5
    v_perm_b32 v60, v153, v152, v4
    v_perm_b32 v108, v153, v152, v5
    v_perm_b32 v61, v155, v154, v4
    v_perm_b32 v109, v155, v154, v5
    v_perm_b32 v62, v157, v156, v4
    v_perm_b32 v110, v157, v156, v5
    v_perm_b32 v63, v159, v158, v4
    v_perm_b32 v111, v159, v158, v5
    v_lshrrev_b32 v6, 3, v1
    v_lshrrev_b32 v7, 2, v6
    v_lshlrev_b32 v7, 5, v7
    v_and_b32 v8, 2, v6
    v_lshl_add_u32 v7, v8, 3, v7
    v_and_b32 v8, 1, v6
    v_lshl_add_u32 v7, v8, 2, v7
    v_and_b32 v8, 7, v1
    v_and_b32 v9, 1, v8
    v_add_u32 v7, v7, v9
    v_and_b32 v9, 2, v8
    v_lshl_add_u32 v7, v9, 2, v7
    v_lshrrev_b32 v9, 2, v8
    v_lshl_add_u32 v7, v9, 1, v7
    v_mul_u32_u24 v7, 12288, v7
    v_lshl_add_u32 v7, v2, 4, v7
    s_mul_i32 s28, s23, 384
    s_mul_i32 s29, s21, 3932160
    s_add_u32 s28, s28, s29
    v_lshrrev_b32 v10, 2, v1
    v_mul_u32_u24 v10, 20480, v10
    v_lshlrev_b32 v10, 4, v10
    v_and_b32 v11, 3, v1
    v_lshl_add_u32 v10, v11, 5, v10
    v_lshl_add_u32 v10, v2, 8, v10
    s_mul_i32 s30, s22, 2621440
    s_lshr_b32 s31, s23, 3
    s_mul_i32 s31, s31, 81920
    s_add_u32 s30, s30, s31
    s_and_b32 s31, s23, 3
    s_mul_i32 s31, s31, 20480
    s_add_u32 s30, s30, s31
    s_bfe_u32 s31, s23, 0x10002
    s_lshl_b32 s31, s31, 7
    s_add_u32 s30, s30, s31
    s_mul_i32 s31, s21, 10240
    s_add_u32 s30, s30, s31
    s_add_u32 s30, s30, 27262976
    buffer_load_dwordx4 v[112:115], v7, s[32:35], s28 offen offset:0
    buffer_load_dwordx4 v[116:119], v7, s[32:35], s28 offen offset:32
    buffer_load_dwordx4 v[120:123], v7, s[32:35], s28 offen offset:64
    buffer_load_dwordx4 v[124:127], v7, s[32:35], s28 offen offset:96
    buffer_load_dwordx4 v[128:131], v7, s[32:35], s28 offen offset:128
    buffer_load_dwordx4 v[132:135], v7, s[32:35], s28 offen offset:160
    buffer_load_dwordx4 v[136:139], v7, s[32:35], s28 offen offset:192
    buffer_load_dwordx4 v[140:143], v7, s[32:35], s28 offen offset:224
    buffer_load_dwordx4 v[144:147], v7, s[32:35], s28 offen offset:256
    buffer_load_dwordx4 v[148:151], v7, s[32:35], s28 offen offset:288
    buffer_load_dwordx4 v[152:155], v7, s[32:35], s28 offen offset:320
    buffer_load_dwordx4 v[156:159], v7, s[32:35], s28 offen offset:352
    s_add_u32 s28, s28, 393216
    s_mov_b32 s31, 5
prep_kernel_wvo_loop:
    buffer_load_dwordx4 v[160:163], v7, s[32:35], s28 offen offset:0
    buffer_load_dwordx4 v[164:167], v7, s[32:35], s28 offen offset:32
    buffer_load_dwordx4 v[168:171], v7, s[32:35], s28 offen offset:64
    buffer_load_dwordx4 v[172:175], v7, s[32:35], s28 offen offset:96
    buffer_load_dwordx4 v[176:179], v7, s[32:35], s28 offen offset:128
    buffer_load_dwordx4 v[180:183], v7, s[32:35], s28 offen offset:160
    buffer_load_dwordx4 v[184:187], v7, s[32:35], s28 offen offset:192
    buffer_load_dwordx4 v[188:191], v7, s[32:35], s28 offen offset:224
    buffer_load_dwordx4 v[192:195], v7, s[32:35], s28 offen offset:256
    buffer_load_dwordx4 v[196:199], v7, s[32:35], s28 offen offset:288
    buffer_load_dwordx4 v[200:203], v7, s[32:35], s28 offen offset:320
    buffer_load_dwordx4 v[204:207], v7, s[32:35], s28 offen offset:352
    s_add_u32 s28, s28, 393216
    s_waitcnt vmcnt(12)
    v_mfma_f32_32x32x16_bf16 v[208:223], v[112:115], v[16:19], 0
    v_mfma_f32_32x32x16_bf16 v[224:239], v[112:115], v[64:67], 0
    v_mfma_f32_32x32x16_bf16 v[208:223], v[116:119], v[20:23], v[208:223]
    v_mfma_f32_32x32x16_bf16 v[224:239], v[116:119], v[68:71], v[224:239]
    v_mfma_f32_32x32x16_bf16 v[208:223], v[120:123], v[24:27], v[208:223]
    v_mfma_f32_32x32x16_bf16 v[224:239], v[120:123], v[72:75], v[224:239]
    v_mfma_f32_32x32x16_bf16 v[208:223], v[124:127], v[28:31], v[208:223]
    v_mfma_f32_32x32x16_bf16 v[224:239], v[124:127], v[76:79], v[224:239]
    v_mfma_f32_32x32x16_bf16 v[208:223], v[128:131], v[32:35], v[208:223]
    v_mfma_f32_32x32x16_bf16 v[224:239], v[128:131], v[80:83], v[224:239]
    v_mfma_f32_32x32x16_bf16 v[208:223], v[132:135], v[36:39], v[208:223]
    v_mfma_f32_32x32x16_bf16 v[224:239], v[132:135], v[84:87], v[224:239]
    v_mfma_f32_32x32x16_bf16 v[208:223], v[136:139], v[40:43], v[208:223]
    v_mfma_f32_32x32x16_bf16 v[224:239], v[136:139], v[88:91], v[224:239]
    v_mfma_f32_32x32x16_bf16 v[208:223], v[140:143], v[44:47], v[208:223]
    v_mfma_f32_32x32x16_bf16 v[224:239], v[140:143], v[92:95], v[224:239]
    v_mfma_f32_32x32x16_bf16 v[208:223], v[144:147], v[48:51], v[208:223]
    v_mfma_f32_32x32x16_bf16 v[224:239], v[144:147], v[96:99], v[224:239]
    v_mfma_f32_32x32x16_bf16 v[208:223], v[148:151], v[52:55], v[208:223]
    v_mfma_f32_32x32x16_bf16 v[224:239], v[148:151], v[100:103], v[224:239]
    v_mfma_f32_32x32x16_bf16 v[208:223], v[152:155], v[56:59], v[208:223]
    v_mfma_f32_32x32x16_bf16 v[224:239], v[152:155], v[104:107], v[224:239]
    v_mfma_f32_32x32x16_bf16 v[208:223], v[156:159], v[60:63], v[208:223]
    v_mfma_f32_32x32x16_bf16 v[224:239], v[156:159], v[108:111], v[224:239]
    s_nop 7
    s_nop 7
    v_cvt_pk_bf16_f32 v240, v208, v209
    v_cvt_pk_bf16_f32 v241, v210, v211
    v_cvt_pk_bf16_f32 v242, v212, v213
    v_cvt_pk_bf16_f32 v243, v214, v215
    s_nop 1
    v_permlane32_swap_b32 v240, v242
    v_permlane32_swap_b32 v241, v243
    buffer_store_dwordx4 v[240:243], v10, s[8:11], s30 offen offset:0
    v_cvt_pk_bf16_f32 v244, v216, v217
    v_cvt_pk_bf16_f32 v245, v218, v219
    v_cvt_pk_bf16_f32 v246, v220, v221
    v_cvt_pk_bf16_f32 v247, v222, v223
    s_nop 1
    v_permlane32_swap_b32 v244, v246
    v_permlane32_swap_b32 v245, v247
    buffer_store_dwordx4 v[244:247], v10, s[8:11], s30 offen offset:512
    s_nop 1
    v_cvt_pk_bf16_f32 v240, v224, v225
    v_cvt_pk_bf16_f32 v241, v226, v227
    v_cvt_pk_bf16_f32 v242, v228, v229
    v_cvt_pk_bf16_f32 v243, v230, v231
    s_nop 1
    v_permlane32_swap_b32 v240, v242
    v_permlane32_swap_b32 v241, v243
    buffer_store_dwordx4 v[240:243], v10, s[8:11], s30 offen offset:16
    v_cvt_pk_bf16_f32 v244, v232, v233
    v_cvt_pk_bf16_f32 v245, v234, v235
    v_cvt_pk_bf16_f32 v246, v236, v237
    v_cvt_pk_bf16_f32 v247, v238, v239
    s_nop 1
    v_permlane32_swap_b32 v244, v246
    v_permlane32_swap_b32 v245, v247
    buffer_store_dwordx4 v[244:247], v10, s[8:11], s30 offen offset:528
    s_nop 1
    s_add_u32 s30, s30, 1024
    s_cmp_eq_u32 s31, 1
    s_cbranch_scc1 prep_kernel_wvo_last
    buffer_load_dwordx4 v[112:115], v7, s[32:35], s28 offen offset:0
    buffer_load_dwordx4 v[116:119], v7, s[32:35], s28 offen offset:32
    buffer_load_dwordx4 v[120:123], v7, s[32:35], s28 offen offset:64
    buffer_load_dwordx4 v[124:127], v7, s[32:35], s28 offen offset:96
    buffer_load_dwordx4 v[128:131], v7, s[32:35], s28 offen offset:128
    buffer_load_dwordx4 v[132:135], v7, s[32:35], s28 offen offset:160
    buffer_load_dwordx4 v[136:139], v7, s[32:35], s28 offen offset:192
    buffer_load_dwordx4 v[140:143], v7, s[32:35], s28 offen offset:224
    buffer_load_dwordx4 v[144:147], v7, s[32:35], s28 offen offset:256
    buffer_load_dwordx4 v[148:151], v7, s[32:35], s28 offen offset:288
    buffer_load_dwordx4 v[152:155], v7, s[32:35], s28 offen offset:320
    buffer_load_dwordx4 v[156:159], v7, s[32:35], s28 offen offset:352
    s_add_u32 s28, s28, 393216
    s_waitcnt vmcnt(12)
    v_mfma_f32_32x32x16_bf16 v[208:223], v[160:163], v[16:19], 0
    v_mfma_f32_32x32x16_bf16 v[224:239], v[160:163], v[64:67], 0
    v_mfma_f32_32x32x16_bf16 v[208:223], v[164:167], v[20:23], v[208:223]
    v_mfma_f32_32x32x16_bf16 v[224:239], v[164:167], v[68:71], v[224:239]
    v_mfma_f32_32x32x16_bf16 v[208:223], v[168:171], v[24:27], v[208:223]
    v_mfma_f32_32x32x16_bf16 v[224:239], v[168:171], v[72:75], v[224:239]
    v_mfma_f32_32x32x16_bf16 v[208:223], v[172:175], v[28:31], v[208:223]
    v_mfma_f32_32x32x16_bf16 v[224:239], v[172:175], v[76:79], v[224:239]
    v_mfma_f32_32x32x16_bf16 v[208:223], v[176:179], v[32:35], v[208:223]
    v_mfma_f32_32x32x16_bf16 v[224:239], v[176:179], v[80:83], v[224:239]
    v_mfma_f32_32x32x16_bf16 v[208:223], v[180:183], v[36:39], v[208:223]
    v_mfma_f32_32x32x16_bf16 v[224:239], v[180:183], v[84:87], v[224:239]
    v_mfma_f32_32x32x16_bf16 v[208:223], v[184:187], v[40:43], v[208:223]
    v_mfma_f32_32x32x16_bf16 v[224:239], v[184:187], v[88:91], v[224:239]
    v_mfma_f32_32x32x16_bf16 v[208:223], v[188:191], v[44:47], v[208:223]
    v_mfma_f32_32x32x16_bf16 v[224:239], v[188:191], v[92:95], v[224:239]
    v_mfma_f32_32x32x16_bf16 v[208:223], v[192:195], v[48:51], v[208:223]
    v_mfma_f32_32x32x16_bf16 v[224:239], v[192:195], v[96:99], v[224:239]
    v_mfma_f32_32x32x16_bf16 v[208:223], v[196:199], v[52:55], v[208:223]
    v_mfma_f32_32x32x16_bf16 v[224:239], v[196:199], v[100:103], v[224:239]
    v_mfma_f32_32x32x16_bf16 v[208:223], v[200:203], v[56:59], v[208:223]
    v_mfma_f32_32x32x16_bf16 v[224:239], v[200:203], v[104:107], v[224:239]
    v_mfma_f32_32x32x16_bf16 v[208:223], v[204:207], v[60:63], v[208:223]
    v_mfma_f32_32x32x16_bf16 v[224:239], v[204:207], v[108:111], v[224:239]
    s_nop 7
    s_nop 7
    v_cvt_pk_bf16_f32 v240, v208, v209
    v_cvt_pk_bf16_f32 v241, v210, v211
    v_cvt_pk_bf16_f32 v242, v212, v213
    v_cvt_pk_bf16_f32 v243, v214, v215
    s_nop 1
    v_permlane32_swap_b32 v240, v242
    v_permlane32_swap_b32 v241, v243
    buffer_store_dwordx4 v[240:243], v10, s[8:11], s30 offen offset:0
    v_cvt_pk_bf16_f32 v244, v216, v217
    v_cvt_pk_bf16_f32 v245, v218, v219
    v_cvt_pk_bf16_f32 v246, v220, v221
    v_cvt_pk_bf16_f32 v247, v222, v223
    s_nop 1
    v_permlane32_swap_b32 v244, v246
    v_permlane32_swap_b32 v245, v247
    buffer_store_dwordx4 v[244:247], v10, s[8:11], s30 offen offset:512
    s_nop 1
    v_cvt_pk_bf16_f32 v240, v224, v225
    v_cvt_pk_bf16_f32 v241, v226, v227
    v_cvt_pk_bf16_f32 v242, v228, v229
    v_cvt_pk_bf16_f32 v243, v230, v231
    s_nop 1
    v_permlane32_swap_b32 v240, v242
    v_permlane32_swap_b32 v241, v243
    buffer_store_dwordx4 v[240:243], v10, s[8:11], s30 offen offset:16
    v_cvt_pk_bf16_f32 v244, v232, v233
    v_cvt_pk_bf16_f32 v245, v234, v235
    v_cvt_pk_bf16_f32 v246, v236, v237
    v_cvt_pk_bf16_f32 v247, v238, v239
    s_nop 1
    v_permlane32_swap_b32 v244, v246
    v_permlane32_swap_b32 v245, v247
    buffer_store_dwordx4 v[244:247], v10, s[8:11], s30 offen offset:528
    s_nop 1
    s_add_u32 s30, s30, 1024
    s_sub_u32 s31, s31, 1
    s_branch prep_kernel_wvo_loop
prep_kernel_wvo_last:
    s_waitcnt vmcnt(0)
    v_mfma_f32_32x32x16_bf16 v[208:223], v[160:163], v[16:19], 0
    v_mfma_f32_32x32x16_bf16 v[224:239], v[160:163], v[64:67], 0
    v_mfma_f32_32x32x16_bf16 v[208:223], v[164:167], v[20:23], v[208:223]
    v_mfma_f32_32x32x16_bf16 v[224:239], v[164:167], v[68:71], v[224:239]
    v_mfma_f32_32x32x16_bf16 v[208:223], v[168:171], v[24:27], v[208:223]
    v_mfma_f32_32x32x16_bf16 v[224:239], v[168:171], v[72:75], v[224:239]
    v_mfma_f32_32x32x16_bf16 v[208:223], v[172:175], v[28:31], v[208:223]
    v_mfma_f32_32x32x16_bf16 v[224:239], v[172:175], v[76:79], v[224:239]
    v_mfma_f32_32x32x16_bf16 v[208:223], v[176:179], v[32:35], v[208:223]
    v_mfma_f32_32x32x16_bf16 v[224:239], v[176:179], v[80:83], v[224:239]
    v_mfma_f32_32x32x16_bf16 v[208:223], v[180:183], v[36:39], v[208:223]
    v_mfma_f32_32x32x16_bf16 v[224:239], v[180:183], v[84:87], v[224:239]
    v_mfma_f32_32x32x16_bf16 v[208:223], v[184:187], v[40:43], v[208:223]
    v_mfma_f32_32x32x16_bf16 v[224:239], v[184:187], v[88:91], v[224:239]
    v_mfma_f32_32x32x16_bf16 v[208:223], v[188:191], v[44:47], v[208:223]
    v_mfma_f32_32x32x16_bf16 v[224:239], v[188:191], v[92:95], v[224:239]
    v_mfma_f32_32x32x16_bf16 v[208:223], v[192:195], v[48:51], v[208:223]
    v_mfma_f32_32x32x16_bf16 v[224:239], v[192:195], v[96:99], v[224:239]
    v_mfma_f32_32x32x16_bf16 v[208:223], v[196:199], v[52:55], v[208:223]
    v_mfma_f32_32x32x16_bf16 v[224:239], v[196:199], v[100:103], v[224:239]
    v_mfma_f32_32x32x16_bf16 v[208:223], v[200:203], v[56:59], v[208:223]
    v_mfma_f32_32x32x16_bf16 v[224:239], v[200:203], v[104:107], v[224:239]
    v_mfma_f32_32x32x16_bf16 v[208:223], v[204:207], v[60:63], v[208:223]
    v_mfma_f32_32x32x16_bf16 v[224:239], v[204:207], v[108:111], v[224:239]
    s_nop 7
    s_nop 7
    v_cvt_pk_bf16_f32 v240, v208, v209
    v_cvt_pk_bf16_f32 v241, v210, v211
    v_cvt_pk_bf16_f32 v242, v212, v213
    v_cvt_pk_bf16_f32 v243, v214, v215
    s_nop 1
    v_permlane32_swap_b32 v240, v242
    v_permlane32_swap_b32 v241, v243
    buffer_store_dwordx4 v[240:243], v10, s[8:11], s30 offen offset:0
    v_cvt_pk_bf16_f32 v244, v216, v217
    v_cvt_pk_bf16_f32 v245, v218, v219
    v_cvt_pk_bf16_f32 v246, v220, v221
    v_cvt_pk_bf16_f32 v247, v222, v223
    s_nop 1
    v_permlane32_swap_b32 v244, v246
    v_permlane32_swap_b32 v245, v247
    buffer_store_dwordx4 v[244:247], v10, s[8:11], s30 offen offset:512
    s_nop 1
    v_cvt_pk_bf16_f32 v240, v224, v225
    v_cvt_pk_bf16_f32 v241, v226, v227
    v_cvt_pk_bf16_f32 v242, v228, v229
    v_cvt_pk_bf16_f32 v243, v230, v231
    s_nop 1
    v_permlane32_swap_b32 v240, v242
    v_permlane32_swap_b32 v241, v243
    buffer_store_dwordx4 v[240:243], v10, s[8:11], s30 offen offset:16
    v_cvt_pk_bf16_f32 v244, v232, v233
    v_cvt_pk_bf16_f32 v245, v234, v235
    v_cvt_pk_bf16_f32 v246, v236, v237
    v_cvt_pk_bf16_f32 v247, v238, v239
    s_nop 1
    v_permlane32_swap_b32 v244, v246
    v_permlane32_swap_b32 v245, v247
    buffer_store_dwordx4 v[244:247], v10, s[8:11], s30 offen offset:528
    s_nop 1
    s_add_u32 s30, s30, 1024
    s_branch prep_kernel_end
prep_kernel_r_pwp:
    s_lshl_b32 s20, s20, 2
    s_add_u32 s20, s20, s13
    s_mul_i32 s21, s20, 13108
    s_lshr_b32 s21, s21, 16
    s_mul_i32 s22, s21, 5
    s_sub_u32 s22, s20, s22
    s_mul_i32 s23, s21, 21846
    s_lshr_b32 s23, s23, 16
    s_mul_i32 s28, s23, 3
    s_sub_u32 s21, s21, s28
    s_lshr_b32 s29, s23, 5
    s_and_b32 s23, s23, 31
    s_cmp_eq_u32 s29, 0
    s_cbranch_scc0 prep_kernel_pwp_k
    s_load_dwordx2 s[24:25], s[0:1], 40
    s_branch prep_kernel_pwp_go
prep_kernel_pwp_k:
    s_load_dwordx2 s[24:25], s[0:1], 48
prep_kernel_pwp_go:
    v_and_b32 v1, 31, v0
    v_lshrrev_b32 v2, 5, v0
    s_lshl_b32 s28, s21, 6
    v_lshlrev_b32 v3, 1, v1
    v_add_u32 v3, s28, v3
    v_and_b32 v4, 0xc1, v3
    v_and_b32 v5, 8, v3
    v_lshl_or_b32 v4, v5, 2, v4
    v_and_b32 v5, 32, v3
    v_lshrrev_b32 v5, 1, v5
    v_or_b32 v4, v4, v5
    v_and_b32 v5, 2, v3
    v_lshl_or_b32 v4, v5, 2, v4
    v_and_b32 v5, 16, v3
    v_lshrrev_b32 v5, 2, v5
    v_or_b32 v4, v4, v5
    v_and_b32 v5, 4, v3
    v_lshrrev_b32 v5, 1, v5
    v_or_b32 v4, v4, v5
    s_cmp_eq_u32 s29, 0
    s_cselect_b64 vcc, -1, 0
    s_nop 1
    v_cndmask_b32 v4, v4, v3, vcc
    v_lshrrev_b32 v5, 4, v3
    v_and_b32 v6, 3, v5
    v_mul_u32_u24 v6, 6, v6
    v_lshrrev_b32 v5, 2, v5
    v_add_u32 v5, v5, v6
    v_mul_u32_u24 v5, 20480, v5
    v_and_b32 v6, 15, v3
    v_lshl_add_u32 v7, v6, 4, v5
    s_mul_i32 s30, s29, 61440
    s_mul_i32 s31, s23, 491520
    s_add_u32 s30, s30, s31
    s_add_u32 s30, s30, 11534336
    s_lshl_b32 s31, s22, 4
    v_add_u32 v8, s31, v2
    s_waitcnt lgkmcnt(0)
    s_mov_b32 s32, s24
    s_mov_b32 s33, s25
    s_mov_b32 s34, 7864320
    s_mov_b32 s35, 0x00020000
    s_mul_i32 s28, s23, 384
    v_add_u32 v9, 0, v8
    v_lshrrev_b32 v10, 2, v9
    v_lshlrev_b32 v10, 5, v10
    v_and_b32 v11, 2, v9
    v_lshl_add_u32 v10, v11, 3, v10
    v_and_b32 v11, 1, v9
    v_lshl_add_u32 v10, v11, 2, v10
    v_mul_u32_u24 v10, 12288, v10
    v_lshl_add_u32 v10, v4, 1, v10
    s_add_u32 s31, s28, 0
    buffer_load_dword v16, v10, s[32:35], s31 offen
    s_add_u32 s31, s28, 12288
    buffer_load_dword v17, v10, s[32:35], s31 offen
    s_add_u32 s31, s28, 98304
    buffer_load_dword v18, v10, s[32:35], s31 offen
    s_add_u32 s31, s28, 110592
    buffer_load_dword v19, v10, s[32:35], s31 offen
    s_add_u32 s31, s28, 24576
    buffer_load_dword v20, v10, s[32:35], s31 offen
    s_add_u32 s31, s28, 36864
    buffer_load_dword v21, v10, s[32:35], s31 offen
    s_add_u32 s31, s28, 122880
    buffer_load_dword v22, v10, s[32:35], s31 offen
    s_add_u32 s31, s28, 135168
    buffer_load_dword v23, v10, s[32:35], s31 offen
    v_add_u32 v9, 2, v8
    v_lshrrev_b32 v10, 2, v9
    v_lshlrev_b32 v10, 5, v10
    v_and_b32 v11, 2, v9
    v_lshl_add_u32 v10, v11, 3, v10
    v_and_b32 v11, 1, v9
    v_lshl_add_u32 v10, v11, 2, v10
    v_mul_u32_u24 v10, 12288, v10
    v_lshl_add_u32 v10, v4, 1, v10
    s_add_u32 s31, s28, 0
    buffer_load_dword v24, v10, s[32:35], s31 offen
    s_add_u32 s31, s28, 12288
    buffer_load_dword v25, v10, s[32:35], s31 offen
    s_add_u32 s31, s28, 98304
    buffer_load_dword v26, v10, s[32:35], s31 offen
    s_add_u32 s31, s28, 110592
    buffer_load_dword v27, v10, s[32:35], s31 offen
    s_add_u32 s31, s28, 24576
    buffer_load_dword v28, v10, s[32:35], s31 offen
    s_add_u32 s31, s28, 36864
    buffer_load_dword v29, v10, s[32:35], s31 offen
    s_add_u32 s31, s28, 122880
    buffer_load_dword v30, v10, s[32:35], s31 offen
    s_add_u32 s31, s28, 135168
    buffer_load_dword v31, v10, s[32:35], s31 offen
    v_add_u32 v9, 4, v8
    v_lshrrev_b32 v10, 2, v9
    v_lshlrev_b32 v10, 5, v10
    v_and_b32 v11, 2, v9
    v_lshl_add_u32 v10, v11, 3, v10
    v_and_b32 v11, 1, v9
    v_lshl_add_u32 v10, v11, 2, v10
    v_mul_u32_u24 v10, 12288, v10
    v_lshl_add_u32 v10, v4, 1, v10
    s_add_u32 s31, s28, 0
    buffer_load_dword v32, v10, s[32:35], s31 offen
    s_add_u32 s31, s28, 12288
    buffer_load_dword v33, v10, s[32:35], s31 offen
    s_add_u32 s31, s28, 98304
    buffer_load_dword v34, v10, s[32:35], s31 offen
    s_add_u32 s31, s28, 110592
    buffer_load_dword v35, v10, s[32:35], s31 offen
    s_add_u32 s31, s28, 24576
    buffer_load_dword v36, v10, s[32:35], s31 offen
    s_add_u32 s31, s28, 36864
    buffer_load_dword v37, v10, s[32:35], s31 offen
    s_add_u32 s31, s28, 122880
    buffer_load_dword v38, v10, s[32:35], s31 offen
    s_add_u32 s31, s28, 135168
    buffer_load_dword v39, v10, s[32:35], s31 offen
    v_add_u32 v9, 6, v8
    v_lshrrev_b32 v10, 2, v9
    v_lshlrev_b32 v10, 5, v10
    v_and_b32 v11, 2, v9
    v_lshl_add_u32 v10, v11, 3, v10
    v_and_b32 v11, 1, v9
    v_lshl_add_u32 v10, v11, 2, v10
    v_mul_u32_u24 v10, 12288, v10
    v_lshl_add_u32 v10, v4, 1, v10
    s_add_u32 s31, s28, 0
    buffer_load_dword v40, v10, s[32:35], s31 offen
    s_add_u32 s31, s28, 12288
    buffer_load_dword v41, v10, s[32:35], s31 offen
    s_add_u32 s31, s28, 98304
    buffer_load_dword v42, v10, s[32:35], s31 offen
    s_add_u32 s31, s28, 110592
    buffer_load_dword v43, v10, s[32:35], s31 offen
    s_add_u32 s31, s28, 24576
    buffer_load_dword v44, v10, s[32:35], s31 offen
    s_add_u32 s31, s28, 36864
    buffer_load_dword v45, v10, s[32:35], s31 offen
    s_add_u32 s31, s28, 122880
    buffer_load_dword v46, v10, s[32:35], s31 offen
    s_add_u32 s31, s28, 135168
    buffer_load_dword v47, v10, s[32:35], s31 offen
    v_add_u32 v9, 8, v8
    v_lshrrev_b32 v10, 2, v9
    v_lshlrev_b32 v10, 5, v10
    v_and_b32 v11, 2, v9
    v_lshl_add_u32 v10, v11, 3, v10
    v_and_b32 v11, 1, v9
    v_lshl_add_u32 v10, v11, 2, v10
    v_mul_u32_u24 v10, 12288, v10
    v_lshl_add_u32 v10, v4, 1, v10
    s_add_u32 s31, s28, 0
    buffer_load_dword v48, v10, s[32:35], s31 offen
    s_add_u32 s31, s28, 12288
    buffer_load_dword v49, v10, s[32:35], s31 offen
    s_add_u32 s31, s28, 98304
    buffer_load_dword v50, v10, s[32:35], s31 offen
    s_add_u32 s31, s28, 110592
    buffer_load_dword v51, v10, s[32:35], s31 offen
    s_add_u32 s31, s28, 24576
    buffer_load_dword v52, v10, s[32:35], s31 offen
    s_add_u32 s31, s28, 36864
    buffer_load_dword v53, v10, s[32:35], s31 offen
    s_add_u32 s31, s28, 122880
    buffer_load_dword v54, v10, s[32:35], s31 offen
    s_add_u32 s31, s28, 135168
    buffer_load_dword v55, v10, s[32:35], s31 offen
    v_add_u32 v9, 10, v8
    v_lshrrev_b32 v10, 2, v9
    v_lshlrev_b32 v10, 5, v10
    v_and_b32 v11, 2, v9
    v_lshl_add_u32 v10, v11, 3, v10
    v_and_b32 v11, 1, v9
    v_lshl_add_u32 v10, v11, 2, v10
    v_mul_u32_u24 v10, 12288, v10
    v_lshl_add_u32 v10, v4, 1, v10
    s_add_u32 s31, s28, 0
    buffer_load_dword v56, v10, s[32:35], s31 offen
    s_add_u32 s31, s28, 12288
    buffer_load_dword v57, v10, s[32:35], s31 offen
    s_add_u32 s31, s28, 98304
    buffer_load_dword v58, v10, s[32:35], s31 offen
    s_add_u32 s31, s28, 110592
    buffer_load_dword v59, v10, s[32:35], s31 offen
    s_add_u32 s31, s28, 24576
    buffer_load_dword v60, v10, s[32:35], s31 offen
    s_add_u32 s31, s28, 36864
    buffer_load_dword v61, v10, s[32:35], s31 offen
    s_add_u32 s31, s28, 122880
    buffer_load_dword v62, v10, s[32:35], s31 offen
    s_add_u32 s31, s28, 135168
    buffer_load_dword v63, v10, s[32:35], s31 offen
    v_add_u32 v9, 12, v8
    v_lshrrev_b32 v10, 2, v9
    v_lshlrev_b32 v10, 5, v10
    v_and_b32 v11, 2, v9
    v_lshl_add_u32 v10, v11, 3, v10
    v_and_b32 v11, 1, v9
    v_lshl_add_u32 v10, v11, 2, v10
    v_mul_u32_u24 v10, 12288, v10
    v_lshl_add_u32 v10, v4, 1, v10
    s_add_u32 s31, s28, 0
    buffer_load_dword v64, v10, s[32:35], s31 offen
    s_add_u32 s31, s28, 12288
    buffer_load_dword v65, v10, s[32:35], s31 offen
    s_add_u32 s31, s28, 98304
    buffer_load_dword v66, v10, s[32:35], s31 offen
    s_add_u32 s31, s28, 110592
    buffer_load_dword v67, v10, s[32:35], s31 offen
    s_add_u32 s31, s28, 24576
    buffer_load_dword v68, v10, s[32:35], s31 offen
    s_add_u32 s31, s28, 36864
    buffer_load_dword v69, v10, s[32:35], s31 offen
    s_add_u32 s31, s28, 122880
    buffer_load_dword v70, v10, s[32:35], s31 offen
    s_add_u32 s31, s28, 135168
    buffer_load_dword v71, v10, s[32:35], s31 offen
    v_add_u32 v9, 14, v8
    v_lshrrev_b32 v10, 2, v9
    v_lshlrev_b32 v10, 5, v10
    v_and_b32 v11, 2, v9
    v_lshl_add_u32 v10, v11, 3, v10
    v_and_b32 v11, 1, v9
    v_lshl_add_u32 v10, v11, 2, v10
    v_mul_u32_u24 v10, 12288, v10
    v_lshl_add_u32 v10, v4, 1, v10
    s_add_u32 s31, s28, 0
    buffer_load_dword v72, v10, s[32:35], s31 offen
    s_add_u32 s31, s28, 12288
    buffer_load_dword v73, v10, s[32:35], s31 offen
    s_add_u32 s31, s28, 98304
    buffer_load_dword v74, v10, s[32:35], s31 offen
    s_add_u32 s31, s28, 110592
    buffer_load_dword v75, v10, s[32:35], s31 offen
    s_add_u32 s31, s28, 24576
    buffer_load_dword v76, v10, s[32:35], s31 offen
    s_add_u32 s31, s28, 36864
    buffer_load_dword v77, v10, s[32:35], s31 offen
    s_add_u32 s31, s28, 122880
    buffer_load_dword v78, v10, s[32:35], s31 offen
    s_add_u32 s31, s28, 135168
    buffer_load_dword v79, v10, s[32:35], s31 offen
    v_lshl_add_u32 v7, v8, 8, v7
    v_mov_b32 v4, 0x05040100
    v_mov_b32 v5, 0x07060302
    s_waitcnt vmcnt(56)
    v_perm_b32 v80, v17, v16, v4
    v_perm_b32 v84, v17, v16, v5
    v_perm_b32 v81, v19, v18, v4
    v_perm_b32 v85, v19, v18, v5
    v_perm_b32 v82, v21, v20, v4
    v_perm_b32 v86, v21, v20, v5
    v_perm_b32 v83, v23, v22, v4
    v_perm_b32 v87, v23, v22, v5
    buffer_store_dwordx4 v[80:83], v7, s[8:11], s30 offen offset:0
    buffer_store_dwordx4 v[84:87], v7, s[8:11], s30 offen offset:16
    s_waitcnt vmcnt(48)
    v_perm_b32 v88, v25, v24, v4
    v_perm_b32 v92, v25, v24, v5
    v_perm_b32 v89, v27, v26, v4
    v_perm_b32 v93, v27, v26, v5
    v_perm_b32 v90, v29, v28, v4
    v_perm_b32 v94, v29, v28, v5
    v_perm_b32 v91, v31, v30, v4
    v_perm_b32 v95, v31, v30, v5
    buffer_store_dwordx4 v[88:91], v7, s[8:11], s30 offen offset:512
    buffer_store_dwordx4 v[92:95], v7, s[8:11], s30 offen offset:528
    s_nop 0
    s_waitcnt vmcnt(40)
    v_perm_b32 v80, v33, v32, v4
    v_perm_b32 v84, v33, v32, v5
    v_perm_b32 v81, v35, v34, v4
    v_perm_b32 v85, v35, v34, v5
    v_perm_b32 v82, v37, v36, v4
    v_perm_b32 v86, v37, v36, v5
    v_perm_b32 v83, v39, v38, v4
    v_perm_b32 v87, v39, v38, v5
    buffer_store_dwordx4 v[80:83], v7, s[8:11], s30 offen offset:1024
    buffer_store_dwordx4 v[84:87], v7, s[8:11], s30 offen offset:1040
    s_nop 0
    s_waitcnt vmcnt(32)
    v_perm_b32 v88, v41, v40, v4
    v_perm_b32 v92, v41, v40, v5
    v_perm_b32 v89, v43, v42, v4
    v_perm_b32 v93, v43, v42, v5
    v_perm_b32 v90, v45, v44, v4
    v_perm_b32 v94, v45, v44, v5
    v_perm_b32 v91, v47, v46, v4
    v_perm_b32 v95, v47, v46, v5
    buffer_store_dwordx4 v[88:91], v7, s[8:11], s30 offen offset:1536
    buffer_store_dwordx4 v[92:95], v7, s[8:11], s30 offen offset:1552
    s_nop 0
    s_waitcnt vmcnt(24)
    v_perm_b32 v80, v49, v48, v4
    v_perm_b32 v84, v49, v48, v5
    v_perm_b32 v81, v51, v50, v4
    v_perm_b32 v85, v51, v50, v5
    v_perm_b32 v82, v53, v52, v4
    v_perm_b32 v86, v53, v52, v5
    v_perm_b32 v83, v55, v54, v4
    v_perm_b32 v87, v55, v54, v5
    buffer_store_dwordx4 v[80:83], v7, s[8:11], s30 offen offset:2048
    buffer_store_dwordx4 v[84:87], v7, s[8:11], s30 offen offset:2064
    s_nop 0
    s_waitcnt vmcnt(16)
    v_perm_b32 v88, v57, v56, v4
    v_perm_b32 v92, v57, v56, v5
    v_perm_b32 v89, v59, v58, v4
    v_perm_b32 v93, v59, v58, v5
    v_perm_b32 v90, v61, v60, v4
    v_perm_b32 v94, v61, v60, v5
    v_perm_b32 v91, v63, v62, v4
    v_perm_b32 v95, v63, v62, v5
    buffer_store_dwordx4 v[88:91], v7, s[8:11], s30 offen offset:2560
    buffer_store_dwordx4 v[92:95], v7, s[8:11], s30 offen offset:2576
    s_nop 0
    s_waitcnt vmcnt(8)
    v_perm_b32 v80, v65, v64, v4
    v_perm_b32 v84, v65, v64, v5
    v_perm_b32 v81, v67, v66, v4
    v_perm_b32 v85, v67, v66, v5
    v_perm_b32 v82, v69, v68, v4
    v_perm_b32 v86, v69, v68, v5
    v_perm_b32 v83, v71, v70, v4
    v_perm_b32 v87, v71, v70, v5
    buffer_store_dwordx4 v[80:83], v7, s[8:11], s30 offen offset:3072
    buffer_store_dwordx4 v[84:87], v7, s[8:11], s30 offen offset:3088
    s_nop 0
    s_waitcnt vmcnt(0)
    v_perm_b32 v88, v73, v72, v4
    v_perm_b32 v92, v73, v72, v5
    v_perm_b32 v89, v75, v74, v4
    v_perm_b32 v93, v75, v74, v5
    v_perm_b32 v90, v77, v76, v4
    v_perm_b32 v94, v77, v76, v5
    v_perm_b32 v91, v79, v78, v4
    v_perm_b32 v95, v79, v78, v5
    buffer_store_dwordx4 v[88:91], v7, s[8:11], s30 offen offset:3584
    buffer_store_dwordx4 v[92:95], v7, s[8:11], s30 offen offset:3600
    s_nop 0
    s_branch prep_kernel_end
prep_kernel_r_pwa:
    s_load_dwordx2 s[24:25], s[0:1], 8
    s_lshr_b32 s21, s20, 1
    s_and_b32 s22, s20, 1
    v_and_b32 v1, 31, v0
    v_lshrrev_b32 v2, 5, v0
    s_mul_i32 s23, s21, 20
    v_add_u32 v3, 640, v1
    v_add_u32 v4, 1260, v1
    v_cmp_gt_u32 vcc, 20, v1
    s_nop 1
    v_cndmask_b32 v3, v4, v3, vcc
    v_add_u32 v4, 1292, v1
    v_subrev_u32 v5, 12, v1
    v_cmp_gt_u32 vcc, 8, v1
    s_nop 1
    v_cndmask_b32 v4, v5, v4, vcc
    s_cmp_eq_u32 s22, 0
    s_cselect_b64 vcc, -1, 0
    s_nop 1
    v_cndmask_b32 v3, v4, v3, vcc
    v_add_u32 v3, s23, v3
    v_lshlrev_b32 v3, 1, v3
    v_mul_u32_u24 v4, 30720, v2
    v_add_u32 v3, v3, v4
    s_mov_b32 s26, 0xfffff0ff
    s_cmp_eq_u32 s22, 0
    s_cselect_b32 s26, -1, s26
    s_mov_b32 s27, s26
    v_mov_b32 v16, 0
    v_mov_b32 v17, 0
    v_mov_b32 v18, 0
    v_mov_b32 v19, 0
    v_mov_b32 v20, 0
    v_mov_b32 v21, 0
    v_mov_b32 v22, 0
    v_mov_b32 v23, 0
    v_mov_b32 v24, 0
    v_mov_b32 v25, 0
    v_mov_b32 v26, 0
    v_mov_b32 v27, 0
    v_mov_b32 v28, 0
    v_mov_b32 v29, 0
    v_mov_b32 v30, 0
    v_mov_b32 v31, 0
    v_mov_b32 v32, 0
    v_mov_b32 v33, 0
    v_mov_b32 v34, 0
    v_mov_b32 v35, 0
    v_mov_b32 v36, 0
    v_mov_b32 v37, 0
    v_mov_b32 v38, 0
    v_mov_b32 v39, 0
    v_mov_b32 v40, 0
    v_mov_b32 v41, 0
    v_mov_b32 v42, 0
    v_mov_b32 v43, 0
    v_mov_b32 v44, 0
    v_mov_b32 v45, 0
    v_mov_b32 v46, 0
    v_mov_b32 v47, 0
    v_mov_b32 v48, 0
    v_mov_b32 v49, 0
    v_mov_b32 v50, 0
    v_mov_b32 v51, 0
    v_mov_b32 v52, 0
    v_mov_b32 v53, 0
    v_mov_b32 v54, 0
    v_mov_b32 v55, 0
    v_mov_b32 v56, 0
    v_mov_b32 v57, 0
    v_mov_b32 v58, 0
    v_mov_b32 v59, 0
    v_mov_b32 v60, 0
    v_mov_b32 v61, 0
    v_mov_b32 v62, 0
    v_mov_b32 v63, 0
    v_mov_b32 v64, 0
    v_mov_b32 v65, 0
    v_mov_b32 v66, 0
    v_mov_b32 v67, 0
    v_mov_b32 v68, 0
    v_mov_b32 v69, 0
    v_mov_b32 v70, 0
    v_mov_b32 v71, 0
    v_mov_b32 v72, 0
    v_mov_b32 v73, 0
    v_mov_b32 v74, 0
    v_mov_b32 v75, 0
    v_mov_b32 v76, 0
    v_mov_b32 v77, 0
    v_mov_b32 v78, 0
    v_mov_b32 v79, 0
    v_mov_b32 v80, 0
    v_mov_b32 v81, 0
    v_mov_b32 v82, 0
    v_mov_b32 v83, 0
    v_mov_b32 v84, 0
    v_mov_b32 v85, 0
    v_mov_b32 v86, 0
    v_mov_b32 v87, 0
    v_mov_b32 v88, 0
    v_mov_b32 v89, 0
    v_mov_b32 v90, 0
    v_mov_b32 v91, 0
    v_mov_b32 v92, 0
    v_mov_b32 v93, 0
    v_mov_b32 v94, 0
    v_mov_b32 v95, 0
    s_waitcnt lgkmcnt(0)
    s_mov_b32 s32, s24
    s_mov_b32 s33, s25
    s_mov_b32 s34, 2457600
    s_mov_b32 s35, 0x00020000
    s_mul_i32 s28, s13, 614400
    s_mov_b64 exec, s[26:27]
    s_add_u32 s29, s28, 0
    buffer_load_short_d16_hi v16, v3, s[32:35], s29 offen
    s_add_u32 s29, s28, 3840
    buffer_load_short_d16_hi v17, v3, s[32:35], s29 offen
    s_add_u32 s29, s28, 7680
    buffer_load_short_d16_hi v18, v3, s[32:35], s29 offen
    s_add_u32 s29, s28, 11520
    buffer_load_short_d16_hi v19, v3, s[32:35], s29 offen
    s_add_u32 s29, s28, 15360
    buffer_load_short_d16_hi v20, v3, s[32:35], s29 offen
    s_add_u32 s29, s28, 19200
    buffer_load_short_d16_hi v21, v3, s[32:35], s29 offen
    s_add_u32 s29, s28, 23040
    buffer_load_short_d16_hi v22, v3, s[32:35], s29 offen
    s_add_u32 s29, s28, 26880
    buffer_load_short_d16_hi v23, v3, s[32:35], s29 offen
    s_add_u32 s29, s28, 61440
    buffer_load_short_d16_hi v24, v3, s[32:35], s29 offen
    s_add_u32 s29, s28, 65280
    buffer_load_short_d16_hi v25, v3, s[32:35], s29 offen
    s_add_u32 s29, s28, 69120
    buffer_load_short_d16_hi v26, v3, s[32:35], s29 offen
    s_add_u32 s29, s28, 72960
    buffer_load_short_d16_hi v27, v3, s[32:35], s29 offen
    s_add_u32 s29, s28, 76800
    buffer_load_short_d16_hi v28, v3, s[32:35], s29 offen
    s_add_u32 s29, s28, 80640
    buffer_load_short_d16_hi v29, v3, s[32:35], s29 offen
    s_add_u32 s29, s28, 84480
    buffer_load_short_d16_hi v30, v3, s[32:35], s29 offen
    s_add_u32 s29, s28, 88320
    buffer_load_short_d16_hi v31, v3, s[32:35], s29 offen
    s_add_u32 s29, s28, 122880
    buffer_load_short_d16_hi v32, v3, s[32:35], s29 offen
    s_add_u32 s29, s28, 126720
    buffer_load_short_d16_hi v33, v3, s[32:35], s29 offen
    s_add_u32 s29, s28, 130560
    buffer_load_short_d16_hi v34, v3, s[32:35], s29 offen
    s_add_u32 s29, s28, 134400
    buffer_load_short_d16_hi v35, v3, s[32:35], s29 offen
    s_add_u32 s29, s28, 138240
    buffer_load_short_d16_hi v36, v3, s[32:35], s29 offen
    s_add_u32 s29, s28, 142080
    buffer_load_short_d16_hi v37, v3, s[32:35], s29 offen
    s_add_u32 s29, s28, 145920
    buffer_load_short_d16_hi v38, v3, s[32:35], s29 offen
    s_add_u32 s29, s28, 149760
    buffer_load_short_d16_hi v39, v3, s[32:35], s29 offen
    s_add_u32 s29, s28, 184320
    buffer_load_short_d16_hi v40, v3, s[32:35], s29 offen
    s_add_u32 s29, s28, 188160
    buffer_load_short_d16_hi v41, v3, s[32:35], s29 offen
    s_add_u32 s29, s28, 192000
    buffer_load_short_d16_hi v42, v3, s[32:35], s29 offen
    s_add_u32 s29, s28, 195840
    buffer_load_short_d16_hi v43, v3, s[32:35], s29 offen
    s_add_u32 s29, s28, 199680
    buffer_load_short_d16_hi v44, v3, s[32:35], s29 offen
    s_add_u32 s29, s28, 203520
    buffer_load_short_d16_hi v45, v3, s[32:35], s29 offen
    s_add_u32 s29, s28, 207360
    buffer_load_short_d16_hi v46, v3, s[32:35], s29 offen
    s_add_u32 s29, s28, 211200
    buffer_load_short_d16_hi v47, v3, s[32:35], s29 offen
    s_add_u32 s29, s28, 245760
    buffer_load_short_d16_hi v48, v3, s[32:35], s29 offen
    s_add_u32 s29, s28, 249600
    buffer_load_short_d16_hi v49, v3, s[32:35], s29 offen
    s_add_u32 s29, s28, 253440
    buffer_load_short_d16_hi v50, v3, s[32:35], s29 offen
    s_add_u32 s29, s28, 257280
    buffer_load_short_d16_hi v51, v3, s[32:35], s29 offen
    s_add_u32 s29, s28, 261120
    buffer_load_short_d16_hi v52, v3, s[32:35], s29 offen
    s_add_u32 s29, s28, 264960
    buffer_load_short_d16_hi v53, v3, s[32:35], s29 offen
    s_add_u32 s29, s28, 268800
    buffer_load_short_d16_hi v54, v3, s[32:35], s29 offen
    s_add_u32 s29, s28, 272640
    buffer_load_short_d16_hi v55, v3, s[32:35], s29 offen
    s_add_u32 s29, s28, 307200
    buffer_load_short_d16_hi v56, v3, s[32:35], s29 offen
    s_add_u32 s29, s28, 311040
    buffer_load_short_d16_hi v57, v3, s[32:35], s29 offen
    s_add_u32 s29, s28, 314880
    buffer_load_short_d16_hi v58, v3, s[32:35], s29 offen
    s_add_u32 s29, s28, 318720
    buffer_load_short_d16_hi v59, v3, s[32:35], s29 offen
    s_add_u32 s29, s28, 322560
    buffer_load_short_d16_hi v60, v3, s[32:35], s29 offen
    s_add_u32 s29, s28, 326400
    buffer_load_short_d16_hi v61, v3, s[32:35], s29 offen
    s_add_u32 s29, s28, 330240
    buffer_load_short_d16_hi v62, v3, s[32:35], s29 offen
    s_add_u32 s29, s28, 334080
    buffer_load_short_d16_hi v63, v3, s[32:35], s29 offen
    s_add_u32 s29, s28, 368640
    buffer_load_short_d16_hi v64, v3, s[32:35], s29 offen
    s_add_u32 s29, s28, 372480
    buffer_load_short_d16_hi v65, v3, s[32:35], s29 offen
    s_add_u32 s29, s28, 376320
    buffer_load_short_d16_hi v66, v3, s[32:35], s29 offen
    s_add_u32 s29, s28, 380160
    buffer_load_short_d16_hi v67, v3, s[32:35], s29 offen
    s_add_u32 s29, s28, 384000
    buffer_load_short_d16_hi v68, v3, s[32:35], s29 offen
    s_add_u32 s29, s28, 387840
    buffer_load_short_d16_hi v69, v3, s[32:35], s29 offen
    s_add_u32 s29, s28, 391680
    buffer_load_short_d16_hi v70, v3, s[32:35], s29 offen
    s_add_u32 s29, s28, 395520
    buffer_load_short_d16_hi v71, v3, s[32:35], s29 offen
    s_add_u32 s29, s28, 430080
    buffer_load_short_d16_hi v72, v3, s[32:35], s29 offen
    s_add_u32 s29, s28, 433920
    buffer_load_short_d16_hi v73, v3, s[32:35], s29 offen
    s_add_u32 s29, s28, 437760
    buffer_load_short_d16_hi v74, v3, s[32:35], s29 offen
    s_add_u32 s29, s28, 441600
    buffer_load_short_d16_hi v75, v3, s[32:35], s29 offen
    s_add_u32 s29, s28, 445440
    buffer_load_short_d16_hi v76, v3, s[32:35], s29 offen
    s_add_u32 s29, s28, 449280
    buffer_load_short_d16_hi v77, v3, s[32:35], s29 offen
    s_add_u32 s29, s28, 453120
    buffer_load_short_d16_hi v78, v3, s[32:35], s29 offen
    s_add_u32 s29, s28, 456960
    buffer_load_short_d16_hi v79, v3, s[32:35], s29 offen
    s_add_u32 s29, s28, 491520
    buffer_load_short_d16_hi v80, v3, s[32:35], s29 offen
    s_add_u32 s29, s28, 495360
    buffer_load_short_d16_hi v81, v3, s[32:35], s29 offen
    s_add_u32 s29, s28, 499200
    buffer_load_short_d16_hi v82, v3, s[32:35], s29 offen
    s_add_u32 s29, s28, 503040
    buffer_load_short_d16_hi v83, v3, s[32:35], s29 offen
    s_add_u32 s29, s28, 506880
    buffer_load_short_d16_hi v84, v3, s[32:35], s29 offen
    s_add_u32 s29, s28, 510720
    buffer_load_short_d16_hi v85, v3, s[32:35], s29 offen
    s_add_u32 s29, s28, 514560
    buffer_load_short_d16_hi v86, v3, s[32:35], s29 offen
    s_add_u32 s29, s28, 518400
    buffer_load_short_d16_hi v87, v3, s[32:35], s29 offen
    s_add_u32 s29, s28, 552960
    buffer_load_short_d16_hi v88, v3, s[32:35], s29 offen
    s_add_u32 s29, s28, 556800
    buffer_load_short_d16_hi v89, v3, s[32:35], s29 offen
    s_add_u32 s29, s28, 560640
    buffer_load_short_d16_hi v90, v3, s[32:35], s29 offen
    s_add_u32 s29, s28, 564480
    buffer_load_short_d16_hi v91, v3, s[32:35], s29 offen
    s_add_u32 s29, s28, 568320
    buffer_load_short_d16_hi v92, v3, s[32:35], s29 offen
    s_add_u32 s29, s28, 572160
    buffer_load_short_d16_hi v93, v3, s[32:35], s29 offen
    s_add_u32 s29, s28, 576000
    buffer_load_short_d16_hi v94, v3, s[32:35], s29 offen
    s_add_u32 s29, s28, 579840
    buffer_load_short_d16_hi v95, v3, s[32:35], s29 offen
    s_mov_b64 exec, -1
    s_waitcnt vmcnt(0)
    v_add_f32 v5, v16, v17
    v_add_f32 v5, v5, v18
    v_add_f32 v5, v5, v19
    v_add_f32 v5, v5, v20
    v_add_f32 v5, v5, v21
    v_add_f32 v5, v5, v22
    v_add_f32 v5, v5, v23
    v_add_f32 v5, v5, v24
    v_add_f32 v5, v5, v25
    v_add_f32 v5, v5, v26
    v_add_f32 v5, v5, v27
    v_add_f32 v5, v5, v28
    v_add_f32 v5, v5, v29
    v_add_f32 v5, v5, v30
    v_add_f32 v5, v5, v31
    v_add_f32 v5, v5, v32
    v_add_f32 v5, v5, v33
    v_add_f32 v5, v5, v34
    v_add_f32 v5, v5, v35
    v_add_f32 v5, v5, v36
    v_add_f32 v5, v5, v37
    v_add_f32 v5, v5, v38
    v_add_f32 v5, v5, v39
    v_add_f32 v5, v5, v40
    v_add_f32 v5, v5, v41
    v_add_f32 v5, v5, v42
    v_add_f32 v5, v5, v43
    v_add_f32 v5, v5, v44
    v_add_f32 v5, v5, v45
    v_add_f32 v5, v5, v46
    v_add_f32 v5, v5, v47
    v_add_f32 v5, v5, v48
    v_add_f32 v5, v5, v49
    v_add_f32 v5, v5, v50
    v_add_f32 v5, v5, v51
    v_add_f32 v5, v5, v52
    v_add_f32 v5, v5, v53
    v_add_f32 v5, v5, v54
    v_add_f32 v5, v5, v55
    v_add_f32 v5, v5, v56
    v_add_f32 v5, v5, v57
    v_add_f32 v5, v5, v58
    v_add_f32 v5, v5, v59
    v_add_f32 v5, v5, v60
    v_add_f32 v5, v5, v61
    v_add_f32 v5, v5, v62
    v_add_f32 v5, v5, v63
    v_add_f32 v5, v5, v64
    v_add_f32 v5, v5, v65
    v_add_f32 v5, v5, v66
    v_add_f32 v5, v5, v67
    v_add_f32 v5, v5, v68
    v_add_f32 v5, v5, v69
    v_add_f32 v5, v5, v70
    v_add_f32 v5, v5, v71
    v_add_f32 v5, v5, v72
    v_add_f32 v5, v5, v73
    v_add_f32 v5, v5, v74
    v_add_f32 v5, v5, v75
    v_add_f32 v5, v5, v76
    v_add_f32 v5, v5, v77
    v_add_f32 v5, v5, v78
    v_add_f32 v5, v5, v79
    v_add_f32 v5, v5, v80
    v_add_f32 v5, v5, v81
    v_add_f32 v5, v5, v82
    v_add_f32 v5, v5, v83
    v_add_f32 v5, v5, v84
    v_add_f32 v5, v5, v85
    v_add_f32 v5, v5, v86
    v_add_f32 v5, v5, v87
    v_add_f32 v5, v5, v88
    v_add_f32 v5, v5, v89
    v_add_f32 v5, v5, v90
    v_add_f32 v5, v5, v91
    v_add_f32 v5, v5, v92
    v_add_f32 v5, v5, v93
    v_add_f32 v5, v5, v94
    v_add_f32 v5, v5, v95
    v_mov_b32 v6, v5
    s_nop 1
    v_permlane32_swap_b32 v5, v6
    v_add_f32 v5, v5, v6
    s_lshl_b32 s29, s13, 8
    v_lshlrev_b32 v7, 2, v0
    v_add_u32 v8, s29, v7
    ds_write_b32 v8, v5
    s_waitcnt lgkmcnt(0)
    s_barrier
    ds_read_b32 v8, v7 offset:0
    ds_read_b32 v9, v7 offset:256
    ds_read_b32 v10, v7 offset:512
    ds_read_b32 v11, v7 offset:768
    s_waitcnt lgkmcnt(0)
    v_add_f32 v8, v8, v9
    v_add_f32 v10, v10, v11
    v_add_f32 v8, v8, v10
    v_mul_f32 v8, 0x3acccccd, v8
    v_sub_f32 v16, v16, v8
    v_sub_f32 v17, v17, v8
    v_sub_f32 v18, v18, v8
    v_sub_f32 v19, v19, v8
    v_sub_f32 v20, v20, v8
    v_sub_f32 v21, v21, v8
    v_sub_f32 v22, v22, v8
    v_sub_f32 v23, v23, v8
    v_sub_f32 v24, v24, v8
    v_sub_f32 v25, v25, v8
    v_sub_f32 v26, v26, v8
    v_sub_f32 v27, v27, v8
    v_sub_f32 v28, v28, v8
    v_sub_f32 v29, v29, v8
    v_sub_f32 v30, v30, v8
    v_sub_f32 v31, v31, v8
    v_sub_f32 v32, v32, v8
    v_sub_f32 v33, v33, v8
    v_sub_f32 v34, v34, v8
    v_sub_f32 v35, v35, v8
    v_sub_f32 v36, v36, v8
    v_sub_f32 v37, v37, v8
    v_sub_f32 v38, v38, v8
    v_sub_f32 v39, v39, v8
    v_sub_f32 v40, v40, v8
    v_sub_f32 v41, v41, v8
    v_sub_f32 v42, v42, v8
    v_sub_f32 v43, v43, v8
    v_sub_f32 v44, v44, v8
    v_sub_f32 v45, v45, v8
    v_sub_f32 v46, v46, v8
    v_sub_f32 v47, v47, v8
    v_sub_f32 v48, v48, v8
    v_sub_f32 v49, v49, v8
    v_sub_f32 v50, v50, v8
    v_sub_f32 v51, v51, v8
    v_sub_f32 v52, v52, v8
    v_sub_f32 v53, v53, v8
    v_sub_f32 v54, v54, v8
    v_sub_f32 v55, v55, v8
    v_sub_f32 v56, v56, v8
    v_sub_f32 v57, v57, v8
    v_sub_f32 v58, v58, v8
    v_sub_f32 v59, v59, v8
    v_sub_f32 v60, v60, v8
    v_sub_f32 v61, v61, v8
    v_sub_f32 v62, v62, v8
    v_sub_f32 v63, v63, v8
    v_sub_f32 v64, v64, v8
    v_sub_f32 v65, v65, v8
    v_sub_f32 v66, v66, v8
    v_sub_f32 v67, v67, v8
    v_sub_f32 v68, v68, v8
    v_sub_f32 v69, v69, v8
    v_sub_f32 v70, v70, v8
    v_sub_f32 v71, v71, v8
    v_sub_f32 v72, v72, v8
    v_sub_f32 v73, v73, v8
    v_sub_f32 v74, v74, v8
    v_sub_f32 v75, v75, v8
    v_sub_f32 v76, v76, v8
    v_sub_f32 v77, v77, v8
    v_sub_f32 v78, v78, v8
    v_sub_f32 v79, v79, v8
    v_sub_f32 v80, v80, v8
    v_sub_f32 v81, v81, v8
    v_sub_f32 v82, v82, v8
    v_sub_f32 v83, v83, v8
    v_sub_f32 v84, v84, v8
    v_sub_f32 v85, v85, v8
    v_sub_f32 v86, v86, v8
    v_sub_f32 v87, v87, v8
    v_sub_f32 v88, v88, v8
    v_sub_f32 v89, v89, v8
    v_sub_f32 v90, v90, v8
    v_sub_f32 v91, v91, v8
    v_sub_f32 v92, v92, v8
    v_sub_f32 v93, v93, v8
    v_sub_f32 v94, v94, v8
    v_sub_f32 v95, v95, v8
    s_mul_i32 s29, s21, 81920
    s_lshl_b32 s30, s22, 10
    s_add_u32 s29, s29, s30
    s_mul_i32 s30, s13, 20480
    s_add_u32 s29, s29, s30
    s_add_u32 s29, s29, 243269632
    v_lshlrev_b32 v7, 4, v0
    v_cvt_pk_bf16_f32 v100, v16, v17
    v_cvt_pk_bf16_f32 v101, v18, v19
    v_cvt_pk_bf16_f32 v102, v20, v21
    v_cvt_pk_bf16_f32 v103, v22, v23
    buffer_store_dwordx4 v[100:103], v7, s[8:11], s29 offen
    s_add_u32 s29, s29, 2048
    v_cvt_pk_bf16_f32 v104, v24, v25
    v_cvt_pk_bf16_f32 v105, v26, v27
    v_cvt_pk_bf16_f32 v106, v28, v29
    v_cvt_pk_bf16_f32 v107, v30, v31
    buffer_store_dwordx4 v[104:107], v7, s[8:11], s29 offen
    s_add_u32 s29, s29, 2048
    v_cvt_pk_bf16_f32 v100, v32, v33
    v_cvt_pk_bf16_f32 v101, v34, v35
    v_cvt_pk_bf16_f32 v102, v36, v37
    v_cvt_pk_bf16_f32 v103, v38, v39
    buffer_store_dwordx4 v[100:103], v7, s[8:11], s29 offen
    s_add_u32 s29, s29, 2048
    v_cvt_pk_bf16_f32 v104, v40, v41
    v_cvt_pk_bf16_f32 v105, v42, v43
    v_cvt_pk_bf16_f32 v106, v44, v45
    v_cvt_pk_bf16_f32 v107, v46, v47
    buffer_store_dwordx4 v[104:107], v7, s[8:11], s29 offen
    s_add_u32 s29, s29, 2048
    v_cvt_pk_bf16_f32 v100, v48, v49
    v_cvt_pk_bf16_f32 v101, v50, v51
    v_cvt_pk_bf16_f32 v102, v52, v53
    v_cvt_pk_bf16_f32 v103, v54, v55
    buffer_store_dwordx4 v[100:103], v7, s[8:11], s29 offen
    s_add_u32 s29, s29, 2048
    v_cvt_pk_bf16_f32 v104, v56, v57
    v_cvt_pk_bf16_f32 v105, v58, v59
    v_cvt_pk_bf16_f32 v106, v60, v61
    v_cvt_pk_bf16_f32 v107, v62, v63
    buffer_store_dwordx4 v[104:107], v7, s[8:11], s29 offen
    s_add_u32 s29, s29, 2048
    v_cvt_pk_bf16_f32 v100, v64, v65
    v_cvt_pk_bf16_f32 v101, v66, v67
    v_cvt_pk_bf16_f32 v102, v68, v69
    v_cvt_pk_bf16_f32 v103, v70, v71
    buffer_store_dwordx4 v[100:103], v7, s[8:11], s29 offen
    s_add_u32 s29, s29, 2048
    v_cvt_pk_bf16_f32 v104, v72, v73
    v_cvt_pk_bf16_f32 v105, v74, v75
    v_cvt_pk_bf16_f32 v106, v76, v77
    v_cvt_pk_bf16_f32 v107, v78, v79
    buffer_store_dwordx4 v[104:107], v7, s[8:11], s29 offen
    s_add_u32 s29, s29, 2048
    v_cvt_pk_bf16_f32 v100, v80, v81
    v_cvt_pk_bf16_f32 v101, v82, v83
    v_cvt_pk_bf16_f32 v102, v84, v85
    v_cvt_pk_bf16_f32 v103, v86, v87
    buffer_store_dwordx4 v[100:103], v7, s[8:11], s29 offen
    s_add_u32 s29, s29, 2048
    v_cvt_pk_bf16_f32 v104, v88, v89
    v_cvt_pk_bf16_f32 v105, v90, v91
    v_cvt_pk_bf16_f32 v106, v92, v93
    v_cvt_pk_bf16_f32 v107, v94, v95
    buffer_store_dwordx4 v[104:107], v7, s[8:11], s29 offen
    s_add_u32 s29, s29, 2048
    s_branch prep_kernel_end
prep_kernel_r_pwo:
    s_lshl_b32 s20, s20, 2
    s_add_u32 s20, s20, s13
    s_load_dwordx2 s[24:25], s[0:1], 16
    s_lshr_b32 s21, s20, 3
    s_and_b32 s22, s20, 7
    v_and_b32 v1, 31, v0
    v_lshrrev_b32 v2, 5, v0
    v_lshlrev_b32 v3, 1, v1
    v_mul_u32_u24 v4, 10240, v2
    v_add_u32 v3, v3, v4
    s_lshl_b32 s29, s21, 6
    s_mul_i32 s30, s22, 102400
    s_add_u32 s29, s29, s30
    s_waitcnt lgkmcnt(0)
    s_mov_b32 s32, s24
    s_mov_b32 s33, s25
    s_mov_b32 s34, 819200
    s_mov_b32 s35, 0x00020000
    s_add_u32 s30, s29, 0
    buffer_load_ushort v16, v3, s[32:35], s30 offen
    s_add_u32 s30, s29, 1280
    buffer_load_ushort v17, v3, s[32:35], s30 offen
    s_add_u32 s30, s29, 2560
    buffer_load_ushort v18, v3, s[32:35], s30 offen
    s_add_u32 s30, s29, 3840
    buffer_load_ushort v19, v3, s[32:35], s30 offen
    s_add_u32 s30, s29, 5120
    buffer_load_ushort v20, v3, s[32:35], s30 offen
    s_add_u32 s30, s29, 6400
    buffer_load_ushort v21, v3, s[32:35], s30 offen
    s_add_u32 s30, s29, 7680
    buffer_load_ushort v22, v3, s[32:35], s30 offen
    s_add_u32 s30, s29, 8960
    buffer_load_ushort v23, v3, s[32:35], s30 offen
    s_add_u32 s30, s29, 20480
    buffer_load_ushort v24, v3, s[32:35], s30 offen
    s_add_u32 s30, s29, 21760
    buffer_load_ushort v25, v3, s[32:35], s30 offen
    s_add_u32 s30, s29, 23040
    buffer_load_ushort v26, v3, s[32:35], s30 offen
    s_add_u32 s30, s29, 24320
    buffer_load_ushort v27, v3, s[32:35], s30 offen
    s_add_u32 s30, s29, 25600
    buffer_load_ushort v28, v3, s[32:35], s30 offen
    s_add_u32 s30, s29, 26880
    buffer_load_ushort v29, v3, s[32:35], s30 offen
    s_add_u32 s30, s29, 28160
    buffer_load_ushort v30, v3, s[32:35], s30 offen
    s_add_u32 s30, s29, 29440
    buffer_load_ushort v31, v3, s[32:35], s30 offen
    s_add_u32 s30, s29, 40960
    buffer_load_ushort v32, v3, s[32:35], s30 offen
    s_add_u32 s30, s29, 42240
    buffer_load_ushort v33, v3, s[32:35], s30 offen
    s_add_u32 s30, s29, 43520
    buffer_load_ushort v34, v3, s[32:35], s30 offen
    s_add_u32 s30, s29, 44800
    buffer_load_ushort v35, v3, s[32:35], s30 offen
    s_add_u32 s30, s29, 46080
    buffer_load_ushort v36, v3, s[32:35], s30 offen
    s_add_u32 s30, s29, 47360
    buffer_load_ushort v37, v3, s[32:35], s30 offen
    s_add_u32 s30, s29, 48640
    buffer_load_ushort v38, v3, s[32:35], s30 offen
    s_add_u32 s30, s29, 49920
    buffer_load_ushort v39, v3, s[32:35], s30 offen
    s_add_u32 s30, s29, 61440
    buffer_load_ushort v40, v3, s[32:35], s30 offen
    s_add_u32 s30, s29, 62720
    buffer_load_ushort v41, v3, s[32:35], s30 offen
    s_add_u32 s30, s29, 64000
    buffer_load_ushort v42, v3, s[32:35], s30 offen
    s_add_u32 s30, s29, 65280
    buffer_load_ushort v43, v3, s[32:35], s30 offen
    s_add_u32 s30, s29, 66560
    buffer_load_ushort v44, v3, s[32:35], s30 offen
    s_add_u32 s30, s29, 67840
    buffer_load_ushort v45, v3, s[32:35], s30 offen
    s_add_u32 s30, s29, 69120
    buffer_load_ushort v46, v3, s[32:35], s30 offen
    s_add_u32 s30, s29, 70400
    buffer_load_ushort v47, v3, s[32:35], s30 offen
    s_add_u32 s30, s29, 81920
    buffer_load_ushort v48, v3, s[32:35], s30 offen
    s_add_u32 s30, s29, 83200
    buffer_load_ushort v49, v3, s[32:35], s30 offen
    s_add_u32 s30, s29, 84480
    buffer_load_ushort v50, v3, s[32:35], s30 offen
    s_add_u32 s30, s29, 85760
    buffer_load_ushort v51, v3, s[32:35], s30 offen
    s_add_u32 s30, s29, 87040
    buffer_load_ushort v52, v3, s[32:35], s30 offen
    s_add_u32 s30, s29, 88320
    buffer_load_ushort v53, v3, s[32:35], s30 offen
    s_add_u32 s30, s29, 89600
    buffer_load_ushort v54, v3, s[32:35], s30 offen
    s_add_u32 s30, s29, 90880
    buffer_load_ushort v55, v3, s[32:35], s30 offen
    s_mul_i32 s29, s20, 5120
    s_add_u32 s29, s29, 246415360
    v_lshlrev_b32 v7, 4, v0
    s_waitcnt vmcnt(32)
    v_lshl_or_b32 v64, v17, 16, v16
    v_lshl_or_b32 v65, v19, 16, v18
    v_lshl_or_b32 v66, v21, 16, v20
    v_lshl_or_b32 v67, v23, 16, v22
    buffer_store_dwordx4 v[64:67], v7, s[8:11], s29 offen offset:0
    s_waitcnt vmcnt(25)
    v_lshl_or_b32 v68, v25, 16, v24
    v_lshl_or_b32 v69, v27, 16, v26
    v_lshl_or_b32 v70, v29, 16, v28
    v_lshl_or_b32 v71, v31, 16, v30
    buffer_store_dwordx4 v[68:71], v7, s[8:11], s29 offen offset:1024
    s_waitcnt vmcnt(18)
    v_lshl_or_b32 v72, v33, 16, v32
    v_lshl_or_b32 v73, v35, 16, v34
    v_lshl_or_b32 v74, v37, 16, v36
    v_lshl_or_b32 v75, v39, 16, v38
    buffer_store_dwordx4 v[72:75], v7, s[8:11], s29 offen offset:2048
    s_waitcnt vmcnt(11)
    v_lshl_or_b32 v76, v41, 16, v40
    v_lshl_or_b32 v77, v43, 16, v42
    v_lshl_or_b32 v78, v45, 16, v44
    v_lshl_or_b32 v79, v47, 16, v46
    buffer_store_dwordx4 v[76:79], v7, s[8:11], s29 offen offset:3072
    s_add_u32 s29, s29, 4096
    s_waitcnt vmcnt(4)
    v_lshl_or_b32 v80, v49, 16, v48
    v_lshl_or_b32 v81, v51, 16, v50
    v_lshl_or_b32 v82, v53, 16, v52
    v_lshl_or_b32 v83, v55, 16, v54
    buffer_store_dwordx4 v[80:83], v7, s[8:11], s29 offen offset:0
    s_branch prep_kernel_end
prep_kernel_end:
    s_endpgm
.section .rodata,"a"
.p2align 6
.amdhsa_kernel prep_kernel
  .amdhsa_next_free_vgpr 248
  .amdhsa_next_free_sgpr 64
  .amdhsa_accum_offset 248
  .amdhsa_group_segment_fixed_size 0
  .amdhsa_kernarg_size 104
  .amdhsa_user_sgpr_count 2
  .amdhsa_user_sgpr_kernarg_segment_ptr 1
  .amdhsa_system_sgpr_workgroup_id_x 1
.end_amdhsa_kernel
.text
.globl layerb2_kernel
.p2align 8
.type layerb2_kernel,@function
layerb2_kernel:
    s_mov_b32 s49, 1
    s_branch layerb1_kernel_body
    s_endpgm
.section .rodata,"a"
.p2align 6
.amdhsa_kernel layerb2_kernel
  .amdhsa_next_free_vgpr 512
  .amdhsa_next_free_sgpr 100
  .amdhsa_accum_offset 256
  .amdhsa_group_segment_fixed_size 0
  .amdhsa_kernarg_size 104
  .amdhsa_user_sgpr_count 2
  .amdhsa_user_sgpr_kernarg_segment_ptr 1
  .amdhsa_system_sgpr_workgroup_id_x 1
.end_amdhsa_kernel
.text
.globl layerb1_kernel
.p2align 8
.type layerb1_kernel,@function
layerb1_kernel:
    s_mov_b32 s49, 0
layerb1_kernel_body:
    s_cmp_ge_u32 s2, 256
    s_cbranch_scc1 layerb1_kernel_end0
    s_load_dwordx2 s[4:5], s[0:1], 96
    s_load_dwordx2 s[6:7], s[0:1], 80
    v_lshrrev_b32 v1, 6, v0
    v_and_b32 v0, 63, v0
    s_nop 0
    v_readfirstlane_b32 s13, v1
    s_mov_b32 s15, 400000
    s_waitcnt lgkmcnt(0)
    s_mov_b32 s8, s4
    s_mov_b32 s9, s5
    s_mov_b32 s10, 268435456
    s_mov_b32 s11, 0x00020000
    s_mul_i32 s48, s49, 65536
    s_add_u32 s48, s48, 10616832
    s_lshl_b32 s60, s49, 11
    s_add_u32 s60, s60, 10485760
    s_getreg_b32 s61, hwreg(HW_REG_XCC_ID)
    s_and_b32 s61, s61, 7
    s_cmp_lg_u32 s13, 0
    s_cbranch_scc1 layerb1_kernel_tk_p1
    s_lshl_b32 s63, s61, 8
    s_add_u32 s63, s63, s60
    s_mov_b64 exec, 1
    v_mov_b32 v230, 0
    v_mov_b32 v231, 1
    buffer_atomic_add v231, v230, s[8:11], s63 offen sc0 sc1
    s_mov_b64 exec, -1
layerb1_kernel_tk_p1:
    s_load_dwordx2 s[16:17], s[0:1], 0
    s_add_u32 s28, s4, 247463936
    s_addc_u32 s29, s5, 0
    s_waitcnt lgkmcnt(0)
    s_cmp_eq_u32 s49, 0
    s_cselect_b32 s16, s16, s28
    s_cselect_b32 s17, s17, s29
    s_mov_b32 s18, 2621440
    s_mov_b32 s19, 0x00020000
    s_and_b32 s28, s2, 7
    s_lshr_b32 s29, s2, 3
    s_and_b32 s30, s28, 3
    s_lshl_b32 s30, s30, 2
    s_and_b32 s31, s29, 3
    s_add_u32 s20, s30, s31
    s_lshr_b32 s30, s28, 2
    s_lshl_b32 s30, s30, 3
    s_lshr_b32 s31, s29, 2
    s_add_u32 s21, s30, s31
    s_lshr_b32 s22, s13, 1
    s_and_b32 s23, s13, 1
    s_lshl_b32 s26, s20, 1
    s_add_u32 s26, s26, s23
    s_mov_b32 s27, 0x3f803f80
    s_lshl_b32 s28, s21, 7
    s_lshl_b32 s29, s13, 5
    s_add_u32 s28, s28, s29
    s_mul_i32 s24, s28, 1280
    s_lshl_b32 s28, s20, 1
    s_add_u32 s28, s28, s22
    s_mul_i32 s25, s28, 81920
    s_lshl_b32 s29, s23, 12
    s_add_u32 s25, s25, s29
    s_add_u32 s25, s25, 243269632
    v_lshlrev_b32 v1, 4, v0
    v_lshrrev_b32 v16, 3, v0
    v_mul_u32_u24 v16, 1280, v16
    v_and_b32 v17, 7, v0
    v_lshrrev_b32 v18, 4, v0
    v_xor_b32 v19, v17, v18
    v_lshl_add_u32 v2, v19, 4, v16
    v_xor_b32 v19, 4, v19
    v_lshl_add_u32 v3, v19, 4, v16
    s_lshl_b32 s28, s13, 12
    s_mov_b32 m0, s28
    s_add_u32 s29, s24, 0
    buffer_load_dwordx4 v2, s[16:19], s29 offen offset:0 lds
    s_add_u32 s29, s29, 9216
    buffer_load_dwordx4 v3, s[16:19], s29 offen offset:1024 lds
    s_add_u32 s29, s29, 9216
    buffer_load_dwordx4 v2, s[16:19], s29 offen offset:2048 lds
    s_add_u32 s29, s29, 9216
    buffer_load_dwordx4 v3, s[16:19], s29 offen offset:3072 lds
    s_add_u32 s28, s28, 16384
    s_mov_b32 m0, s28
    s_add_u32 s29, s25, 0
    buffer_load_dwordx4 v1, s[8:11], s29 offen offset:0 lds
    buffer_load_dwordx4 v1, s[8:11], s29 offen offset:1024 lds
    buffer_load_dwordx4 v1, s[8:11], s29 offen offset:2048 lds
    buffer_load_dwordx4 v1, s[8:11], s29 offen offset:3072 lds
    s_lshl_b32 s28, s13, 12
    s_add_u32 s28, s28, 32768
    s_mov_b32 m0, s28
    s_add_u32 s29, s24, 128
    buffer_load_dwordx4 v2, s[16:19], s29 offen offset:0 lds
    s_add_u32 s29, s29, 9216
    buffer_load_dwordx4 v3, s[16:19], s29 offen offset:1024 lds
    s_add_u32 s29, s29, 9216
    buffer_load_dwordx4 v2, s[16:19], s29 offen offset:2048 lds
    s_add_u32 s29, s29, 9216
    buffer_load_dwordx4 v3, s[16:19], s29 offen offset:3072 lds
    s_add_u32 s28, s28, 16384
    s_mov_b32 m0, s28
    s_add_u32 s29, s25, 8192
    buffer_load_dwordx4 v1, s[8:11], s29 offen offset:0 lds
    buffer_load_dwordx4 v1, s[8:11], s29 offen offset:1024 lds
    buffer_load_dwordx4 v1, s[8:11], s29 offen offset:2048 lds
    buffer_load_dwordx4 v1, s[8:11], s29 offen offset:3072 lds
    s_lshl_b32 s28, s13, 12
    s_add_u32 s28, s28, 65536
    s_mov_b32 m0, s28
    s_add_u32 s29, s24, 256
    buffer_load_dwordx4 v2, s[16:19], s29 offen offset:0 lds
    s_add_u32 s29, s29, 9216
    buffer_load_dwordx4 v3, s[16:19], s29 offen offset:1024 lds
    s_add_u32 s29, s29, 9216
    buffer_load_dwordx4 v2, s[16:19], s29 offen offset:2048 lds
    s_add_u32 s29, s29, 9216
    buffer_load_dwordx4 v3, s[16:19], s29 offen offset:3072 lds
    s_add_u32 s28, s28, 16384
    s_mov_b32 m0, s28
    s_add_u32 s29, s25, 16384
    buffer_load_dwordx4 v1, s[8:11], s29 offen offset:0 lds
    buffer_load_dwordx4 v1, s[8:11], s29 offen offset:1024 lds
    buffer_load_dwordx4 v1, s[8:11], s29 offen offset:2048 lds
    buffer_load_dwordx4 v1, s[8:11], s29 offen offset:3072 lds
    s_cmp_lg_u32 s13, 0
    s_cbranch_scc1 layerb1_kernel_tk_wait
    s_waitcnt vmcnt(24)
    s_nop 0
    v_readfirstlane_b32 s62, v231
    s_cmp_lt_u32 s62, 32
    s_cbranch_scc1 layerb1_kernel_tk_pub
    v_lshlrev_b32 v230, 8, v0
    v_and_b32 v230, 0x7ff, v230
    s_mov_b32 s63, s60
layerb1_kernel_tk_poll:
    buffer_load_dword v231, v230, s[8:11], s63 offen sc1
    s_waitcnt vmcnt(0)
    s_mov_b32 s64, 0
    v_readlane_b32 s65, v231, 0
    s_nop 0
    s_add_u32 s64, s64, s65
    v_readlane_b32 s66, v231, 1
    s_nop 0
    s_add_u32 s64, s64, s66
    v_readlane_b32 s67, v231, 2
    s_nop 0
    s_add_u32 s64, s64, s67
    v_readlane_b32 s68, v231, 3
    s_nop 0
    s_add_u32 s64, s64, s68
    v_readlane_b32 s69, v231, 4
    s_nop 0
    s_add_u32 s64, s64, s69
    v_readlane_b32 s70, v231, 5
    s_nop 0
    s_add_u32 s64, s64, s70
    v_readlane_b32 s71, v231, 6
    s_nop 0
    s_add_u32 s64, s64, s71
    v_readlane_b32 s72, v231, 7
    s_nop 0
    s_add_u32 s64, s64, s72
    s_sub_u32 s15, s15, 1
    s_cbranch_scc1 layerb1_kernel_bail
    s_cmp_lt_u32 s64, 256
    s_cbranch_scc1 layerb1_kernel_tk_poll
    s_sub_u32 s62, s62, 32
    s_max_u32 s64, s65, 32
    s_sub_u32 s64, s64, 32
    s_cmp_gt_u32 s61, 0
    s_cselect_b32 s64, s64, 0
    s_add_u32 s62, s62, s64
    s_max_u32 s64, s66, 32
    s_sub_u32 s64, s64, 32
    s_cmp_gt_u32 s61, 1
    s_cselect_b32 s64, s64, 0
    s_add_u32 s62, s62, s64
    s_max_u32 s64, s67, 32
    s_sub_u32 s64, s64, 32
    s_cmp_gt_u32 s61, 2
    s_cselect_b32 s64, s64, 0
    s_add_u32 s62, s62, s64
    s_max_u32 s64, s68, 32
    s_sub_u32 s64, s64, 32
    s_cmp_gt_u32 s61, 3
    s_cselect_b32 s64, s64, 0
    s_add_u32 s62, s62, s64
    s_max_u32 s64, s69, 32
    s_sub_u32 s64, s64, 32
    s_cmp_gt_u32 s61, 4
    s_cselect_b32 s64, s64, 0
    s_add_u32 s62, s62, s64
    s_max_u32 s64, s70, 32
    s_sub_u32 s64, s64, 32
    s_cmp_gt_u32 s61, 5
    s_cselect_b32 s64, s64, 0
    s_add_u32 s62, s62, s64
    s_max_u32 s64, s71, 32
    s_sub_u32 s64, s64, 32
    s_cmp_gt_u32 s61, 6
    s_cselect_b32 s64, s64, 0
    s_add_u32 s62, s62, s64
    s_min_u32 s64, s65, 32
    s_sub_u32 s63, 32, s64
    s_cmp_lt_u32 s62, s63
    s_cbranch_scc0 layerb1_kernel_tk_n0
    s_mov_b32 s61, 0
    s_add_u32 s62, s62, s64
    s_branch layerb1_kernel_tk_pub
layerb1_kernel_tk_n0:
    s_sub_u32 s62, s62, s63
    s_min_u32 s64, s66, 32
    s_sub_u32 s63, 32, s64
    s_cmp_lt_u32 s62, s63
    s_cbranch_scc0 layerb1_kernel_tk_n1
    s_mov_b32 s61, 1
    s_add_u32 s62, s62, s64
    s_branch layerb1_kernel_tk_pub
layerb1_kernel_tk_n1:
    s_sub_u32 s62, s62, s63
    s_min_u32 s64, s67, 32
    s_sub_u32 s63, 32, s64
    s_cmp_lt_u32 s62, s63
    s_cbranch_scc0 layerb1_kernel_tk_n2
    s_mov_b32 s61, 2
    s_add_u32 s62, s62, s64
    s_branch layerb1_kernel_tk_pub
layerb1_kernel_tk_n2:
    s_sub_u32 s62, s62, s63
    s_min_u32 s64, s68, 32
    s_sub_u32 s63, 32, s64
    s_cmp_lt_u32 s62, s63
    s_cbranch_scc0 layerb1_kernel_tk_n3
    s_mov_b32 s61, 3
    s_add_u32 s62, s62, s64
    s_branch layerb1_kernel_tk_pub
layerb1_kernel_tk_n3:
    s_sub_u32 s62, s62, s63
    s_min_u32 s64, s69, 32
    s_sub_u32 s63, 32, s64
    s_cmp_lt_u32 s62, s63
    s_cbranch_scc0 layerb1_kernel_tk_n4
    s_mov_b32 s61, 4
    s_add_u32 s62, s62, s64
    s_branch layerb1_kernel_tk_pub
layerb1_kernel_tk_n4:
    s_sub_u32 s62, s62, s63
    s_min_u32 s64, s70, 32
    s_sub_u32 s63, 32, s64
    s_cmp_lt_u32 s62, s63
    s_cbranch_scc0 layerb1_kernel_tk_n5
    s_mov_b32 s61, 5
    s_add_u32 s62, s62, s64
    s_branch layerb1_kernel_tk_pub
layerb1_kernel_tk_n5:
    s_sub_u32 s62, s62, s63
    s_min_u32 s64, s71, 32
    s_sub_u32 s63, 32, s64
    s_cmp_lt_u32 s62, s63
    s_cbranch_scc0 layerb1_kernel_tk_n6
    s_mov_b32 s61, 6
    s_add_u32 s62, s62, s64
    s_branch layerb1_kernel_tk_pub
layerb1_kernel_tk_n6:
    s_sub_u32 s62, s62, s63
    s_min_u32 s64, s72, 32
    s_sub_u32 s63, 32, s64
    s_cmp_lt_u32 s62, s63
    s_cbranch_scc0 layerb1_kernel_tk_n7
    s_mov_b32 s61, 7
    s_add_u32 s62, s62, s64
    s_branch layerb1_kernel_tk_pub
layerb1_kernel_tk_n7:
    s_sub_u32 s62, s62, s63
    s_branch layerb1_kernel_bail
layerb1_kernel_tk_pub:
    s_lshl_b32 s63, s61, 8
    s_or_b32 s63, s63, s62
    v_mov_b32 v230, 131136
    v_mov_b32 v231, s63
    ds_write_b32 v230, v231
    s_waitcnt lgkmcnt(0)
layerb1_kernel_tk_wait:
    s_barrier
    v_mov_b32 v230, 131136
    ds_read_b32 v231, v230
    s_waitcnt lgkmcnt(0)
    v_readfirstlane_b32 s63, v231
    s_lshr_b32 s61, s63, 8
    s_and_b32 s62, s63, 255
    s_mov_b32 s98, s61
    s_mov_b32 s99, s62
    v_lshlrev_b32 v240, 4, v0
    v_mov_b32 v241, v240
    s_mov_b32 s50, 0x3020100
    s_mov_b32 s51, 0x7060504
    s_mov_b32 s52, 0xb0a0908
    s_mov_b32 s53, 0xf0e0d0c
    s_mov_b32 s54, 0x13121110
    s_mov_b32 s55, 0x17161514
    s_mov_b32 s56, 0x1b1a1918
    s_mov_b32 s57, 0x1f1e1d1c
    s_mov_b32 s40, 2048
    s_cmp_eq_u32 s98, 0
    s_cbranch_scc1 layerb1_kernel_pf_p
    s_cmp_ge_u32 s98, 4
    s_cbranch_scc1 layerb1_kernel_pf_g
    s_sub_u32 s60, s98, 1
    s_cmp_ge_u32 s99, 27
    s_cbranch_scc1 layerb1_kernel_pf_sp
    s_mul_i32 s61, s60, 27
    s_add_u32 s61, s61, s99
    s_cmp_ge_u32 s61, 80
    s_cbranch_scc1 layerb1_kernel_pf_no
    s_mul_i32 s61, s61, 327680
    s_mul_i32 s62, s13, 81920
    s_add_u32 s61, s61, s62
    s_add_u32 s58, s61, 27262976
    s_add_u32 s59, s58, 1024
    s_branch layerb1_kernel_pf_done
layerb1_kernel_pf_sp:
    s_mul_i32 s61, s60, 5
    s_add_u32 s61, s61, s99
    s_sub_u32 s61, s61, 27
    s_cmp_lt_u32 s61, 5
    s_cbranch_scc0 layerb1_kernel_pf_no
    s_lshl_b32 s61, s61, 2
    s_add_u32 s61, s61, s13
    s_mul_i32 s61, s61, 40960
    s_add_u32 s58, s61, 246415360
    s_add_u32 s59, s58, 1024
    s_branch layerb1_kernel_pf_done
layerb1_kernel_pf_no:
    s_mov_b32 s58, 27262976
    s_mov_b32 s59, 27262976
    s_mov_b32 s40, 0
    s_branch layerb1_kernel_pf_done
layerb1_kernel_pf_p:
    s_mul_i32 s61, s99, 491520
    s_mul_i32 s62, s13, 122880
    s_add_u32 s61, s61, s62
    s_add_u32 s58, s61, 11534336
    s_add_u32 s59, s58, 1024
    s_cmp_lg_u32 s13, 0
    s_cbranch_scc1 layerb1_kernel_pf_pw0
    s_mov_b32 s50, 0x1140a00
    s_mov_b32 s51, 0x5030c15
    s_mov_b32 s52, 0x100e0907
    s_mov_b32 s53, 0x1b191712
    s_mov_b32 s54, 0x201e1d1c
    s_mov_b32 s55, 0x25242221
    s_mov_b32 s56, 0x2a292826
    s_mov_b32 s57, 0x2f2d2c2b
    s_branch layerb1_kernel_pf_done
layerb1_kernel_pf_pw0:
    s_cmp_lg_u32 s13, 1
    s_cbranch_scc1 layerb1_kernel_pf_pw1
    s_mov_b32 s50, 0x4170d03
    s_mov_b32 s51, 0x2000f18
    s_mov_b32 s52, 0x100b0907
    s_mov_b32 s53, 0x1b161412
    s_mov_b32 s54, 0x201e1d1c
    s_mov_b32 s55, 0x25242221
    s_mov_b32 s56, 0x2a292826
    s_mov_b32 s57, 0x2f2d2c2b
    s_branch layerb1_kernel_pf_done
layerb1_kernel_pf_pw1:
    s_cmp_lg_u32 s13, 2
    s_cbranch_scc1 layerb1_kernel_pf_pw2
    s_mov_b32 s50, 0x71a1006
    s_mov_b32 s51, 0x503011b
    s_mov_b32 s52, 0xf0d0b09
    s_mov_b32 s53, 0x19171513
    s_mov_b32 s54, 0x201e1d1c
    s_mov_b32 s55, 0x25242221
    s_mov_b32 s56, 0x2a292826
    s_mov_b32 s57, 0x2f2d2c2b
    s_branch layerb1_kernel_pf_done
layerb1_kernel_pf_pw2:
    s_mov_b32 s50, 0x91c1208
    s_mov_b32 s51, 0x503011d
    s_mov_b32 s52, 0xf0d0b07
    s_mov_b32 s53, 0x19171511
    s_mov_b32 s54, 0x201e1b1a
    s_mov_b32 s55, 0x25242221
    s_mov_b32 s56, 0x2a292826
    s_mov_b32 s57, 0x2f2d2c2b
    s_branch layerb1_kernel_pf_done
layerb1_kernel_pf_g:
    s_sub_u32 s60, s98, 4
    s_lshl_b32 s60, s60, 5
    s_add_u32 s60, s60, s99
    s_mov_b32 s40, 512
    v_and_b32 v230, 31, v0
    v_lshrrev_b32 v231, 5, v0
    s_cmp_ge_u32 s60, 80
    s_cbranch_scc1 layerb1_kernel_pf_qk
    v_lshrrev_b32 v232, 3, v230
    v_and_b32 v233, 7, v230
    v_mul_u32_u24 v234, 20480, v232
    v_lshl_add_u32 v234, v233, 4, v234
    v_lshl_add_u32 v240, v231, 8, v234
    s_mul_i32 s61, s60, 327680
    s_mul_i32 s62, s13, 81920
    s_add_u32 s61, s61, s62
    s_add_u32 s58, s61, 27262976
    v_mov_b32 v241, v240
    s_add_u32 s59, s58, 128
    s_branch layerb1_kernel_pf_done
layerb1_kernel_pf_qk:
    s_sub_u32 s61, s60, 80
    s_cmp_ge_u32 s61, 24
    s_cselect_b32 s62, 1, 0
    s_cselect_b32 s63, 24, 0
    s_sub_u32 s61, s61, s63
    s_lshl_b32 s61, s61, 3
    s_lshl_b32 s63, s13, 1
    s_add_u32 s61, s61, s63
    s_add_u32 s63, s61, 0
    s_mul_i32 s64, s63, 171
    s_lshr_b32 s64, s64, 10
    s_mul_i32 s65, s64, 6
    s_sub_u32 s65, s63, s65
    s_lshl_b32 s65, s65, 5
    v_add_u32 v232, s65, v230
    v_and_b32 v233, 0xc1, v232
    v_and_b32 v234, 8, v232
    v_lshl_or_b32 v233, v234, 2, v233
    v_and_b32 v234, 32, v232
    v_lshrrev_b32 v234, 1, v234
    v_or_b32 v233, v233, v234
    v_and_b32 v234, 2, v232
    v_lshl_or_b32 v233, v234, 2, v233
    v_and_b32 v234, 16, v232
    v_lshrrev_b32 v234, 2, v234
    v_or_b32 v233, v233, v234
    v_and_b32 v234, 4, v232
    v_lshrrev_b32 v234, 1, v234
    v_or_b32 v233, v233, v234
    s_cmp_eq_u32 s62, 1
    s_cselect_b64 vcc, -1, 0
    s_nop 1
    v_cndmask_b32 v232, v232, v233, vcc
    v_lshrrev_b32 v234, 4, v232
    v_and_b32 v235, 3, v234
    v_mul_u32_u24 v235, 6, v235
    v_lshrrev_b32 v234, 2, v234
    v_add_u32 v234, v234, v235
    v_mul_u32_u24 v234, 20480, v234
    v_and_b32 v235, 15, v232
    v_lshl_add_u32 v233, v235, 4, v234
    v_lshl_add_u32 v240, v231, 8, v233
    s_xor_b32 s65, s62, 1
    s_mul_i32 s65, s65, 61440
    s_mul_i32 s66, s64, 491520
    s_add_u32 s65, s65, s66
    s_add_u32 s58, s65, 11534336
    s_add_u32 s63, s61, 1
    s_mul_i32 s64, s63, 171
    s_lshr_b32 s64, s64, 10
    s_mul_i32 s65, s64, 6
    s_sub_u32 s65, s63, s65
    s_lshl_b32 s65, s65, 5
    v_add_u32 v232, s65, v230
    v_and_b32 v233, 0xc1, v232
    v_and_b32 v234, 8, v232
    v_lshl_or_b32 v233, v234, 2, v233
    v_and_b32 v234, 32, v232
    v_lshrrev_b32 v234, 1, v234
    v_or_b32 v233, v233, v234
    v_and_b32 v234, 2, v232
    v_lshl_or_b32 v233, v234, 2, v233
    v_and_b32 v234, 16, v232
    v_lshrrev_b32 v234, 2, v234
    v_or_b32 v233, v233, v234
    v_and_b32 v234, 4, v232
    v_lshrrev_b32 v234, 1, v234
    v_or_b32 v233, v233, v234
    s_cmp_eq_u32 s62, 1
    s_cselect_b64 vcc, -1, 0
    s_nop 1
    v_cndmask_b32 v232, v232, v233, vcc
    v_lshrrev_b32 v234, 4, v232
    v_and_b32 v235, 3, v234
    v_mul_u32_u24 v235, 6, v235
    v_lshrrev_b32 v234, 2, v234
    v_add_u32 v234, v234, v235
    v_mul_u32_u24 v234, 20480, v234
    v_and_b32 v235, 15, v232
    v_lshl_add_u32 v233, v235, 4, v234
    v_lshl_add_u32 v241, v231, 8, v233
    s_xor_b32 s65, s62, 1
    s_mul_i32 s65, s65, 61440
    s_mul_i32 s66, s64, 491520
    s_add_u32 s65, s65, s66
    s_add_u32 s59, s65, 11534336
layerb1_kernel_pf_done:
    s_bfe_u32 s41, s50, 524288
    s_mul_i32 s41, s41, s40
    s_add_u32 s42, s58, s41
    s_add_u32 s43, s59, s41
    buffer_load_dwordx4 a[0:3], v240, s[8:11], s42 offen
    buffer_load_dwordx4 a[4:7], v241, s[8:11], s43 offen
    s_bfe_u32 s41, s50, 524296
    s_mul_i32 s41, s41, s40
    s_add_u32 s42, s58, s41
    s_add_u32 s43, s59, s41
    buffer_load_dwordx4 a[8:11], v240, s[8:11], s42 offen
    buffer_load_dwordx4 a[12:15], v241, s[8:11], s43 offen
    s_bfe_u32 s41, s50, 524304
    s_mul_i32 s41, s41, s40
    s_add_u32 s42, s58, s41
    s_add_u32 s43, s59, s41
    buffer_load_dwordx4 a[16:19], v240, s[8:11], s42 offen
    buffer_load_dwordx4 a[20:23], v241, s[8:11], s43 offen
    s_bfe_u32 s41, s50, 524312
    s_mul_i32 s41, s41, s40
    s_add_u32 s42, s58, s41
    s_add_u32 s43, s59, s41
    buffer_load_dwordx4 a[24:27], v240, s[8:11], s42 offen
    buffer_load_dwordx4 a[28:31], v241, s[8:11], s43 offen
    s_bfe_u32 s41, s51, 524288
    s_mul_i32 s41, s41, s40
    s_add_u32 s42, s58, s41
    s_add_u32 s43, s59, s41
    buffer_load_dwordx4 a[32:35], v240, s[8:11], s42 offen
    buffer_load_dwordx4 a[36:39], v241, s[8:11], s43 offen
    s_bfe_u32 s41, s51, 524296
    s_mul_i32 s41, s41, s40
    s_add_u32 s42, s58, s41
    s_add_u32 s43, s59, s41
    buffer_load_dwordx4 a[40:43], v240, s[8:11], s42 offen
    buffer_load_dwordx4 a[44:47], v241, s[8:11], s43 offen
    s_bfe_u32 s41, s51, 524304
    s_mul_i32 s41, s41, s40
    s_add_u32 s42, s58, s41
    s_add_u32 s43, s59, s41
    buffer_load_dwordx4 a[48:51], v240, s[8:11], s42 offen
    buffer_load_dwordx4 a[52:55], v241, s[8:11], s43 offen
    v_and_b32 v16, 31, v0
    v_lshrrev_b32 v17, 5, v0
    v_lshrrev_b32 v18, 1, v16
    v_and_b32 v18, 7, v18
    v_xor_b32 v18, v18, v17
    v_lshlrev_b32 v18, 4, v18
    v_lshl_add_u32 v18, v16, 7, v18
    s_lshl_b32 s28, s22, 13
    v_add_u32 v18, s28, v18
    v_xor_b32 v6, 0, v18
    v_add_u32 v10, 65536, v6
    v_xor_b32 v7, 32, v18
    v_add_u32 v11, 65536, v7
    v_xor_b32 v8, 64, v18
    v_add_u32 v12, 65536, v8
    v_xor_b32 v9, 96, v18
    v_add_u32 v13, 65536, v9
    s_lshl_b32 s28, s23, 13
    s_add_u32 s28, s28, 16384
    v_add_u32 v4, s28, v1
    v_add_u32 v5, 65536, v4
    v_mov_b32 v20, 0
    v_mov_b32 v21, 0
    v_mov_b32 v22, 0
    v_mov_b32 v23, 0
    s_waitcnt vmcnt(30)
    s_barrier
    ds_read_b128 v[32:35], v6 offset:0
    ds_read_b128 v[36:39], v6 offset:4096
    ds_read_b128 v[40:43], v4 offset:0
    ds_read_b128 v[44:47], v4 offset:1024
    s_cmp_eq_u32 s23, 1
    s_cbranch_scc1 layerb1_kernel_af_h1
    s_waitcnt lgkmcnt(0)
    v_mfma_f32_32x32x16_bf16 v[64:79], v[32:35], v[40:43], 0
    v_dot2c_f32_bf16 v20, s27, v32
    v_dot2c_f32_bf16 v22, v32, v32
    v_mfma_f32_32x32x16_bf16 v[96:111], v[32:35], v[44:47], 0
    ds_read_b128 v[48:51], v7 offset:0
    v_dot2c_f32_bf16 v21, s27, v33
    v_mfma_f32_32x32x16_bf16 v[128:143], v[44:47], v[32:35], 0
    ds_read_b128 v[52:55], v7 offset:4096
    v_dot2c_f32_bf16 v23, v33, v33
    v_mfma_f32_32x32x16_bf16 v[80:95], v[36:39], v[40:43], 0
    ds_read_b128 v[56:59], v4 offset:2048
    v_dot2c_f32_bf16 v20, s27, v34
    v_dot2c_f32_bf16 v22, v34, v34
    v_mfma_f32_32x32x16_bf16 v[112:127], v[36:39], v[44:47], 0
    ds_read_b128 v[60:63], v4 offset:3072
    v_dot2c_f32_bf16 v21, s27, v35
    v_mfma_f32_32x32x16_bf16 v[144:159], v[44:47], v[36:39], 0
    v_dot2c_f32_bf16 v23, v35, v35
    s_waitcnt lgkmcnt(0)
    v_mfma_f32_32x32x16_bf16 v[64:79], v[48:51], v[56:59], v[64:79]
    v_dot2c_f32_bf16 v20, s27, v48
    v_dot2c_f32_bf16 v22, v48, v48
    v_mfma_f32_32x32x16_bf16 v[96:111], v[48:51], v[60:63], v[96:111]
    ds_read_b128 v[32:35], v8 offset:0
    v_dot2c_f32_bf16 v21, s27, v49
    v_mfma_f32_32x32x16_bf16 v[128:143], v[60:63], v[48:51], v[128:143]
    ds_read_b128 v[36:39], v8 offset:4096
    v_dot2c_f32_bf16 v23, v49, v49
    v_mfma_f32_32x32x16_bf16 v[80:95], v[52:55], v[56:59], v[80:95]
    ds_read_b128 v[40:43], v4 offset:4096
    v_dot2c_f32_bf16 v20, s27, v50
    v_dot2c_f32_bf16 v22, v50, v50
    v_mfma_f32_32x32x16_bf16 v[112:127], v[52:55], v[60:63], v[112:127]
    ds_read_b128 v[44:47], v4 offset:5120
    v_dot2c_f32_bf16 v21, s27, v51
    v_mfma_f32_32x32x16_bf16 v[144:159], v[60:63], v[52:55], v[144:159]
    v_dot2c_f32_bf16 v23, v51, v51
    s_waitcnt lgkmcnt(0)
    v_mfma_f32_32x32x16_bf16 v[64:79], v[32:35], v[40:43], v[64:79]
    v_dot2c_f32_bf16 v20, s27, v32
    v_dot2c_f32_bf16 v22, v32, v32
    v_mfma_f32_32x32x16_bf16 v[96:111], v[32:35], v[44:47], v[96:111]
    ds_read_b128 v[48:51], v9 offset:0
    v_dot2c_f32_bf16 v21, s27, v33
    v_mfma_f32_32x32x16_bf16 v[128:143], v[44:47], v[32:35], v[128:143]
    ds_read_b128 v[52:55], v9 offset:4096
    v_dot2c_f32_bf16 v23, v33, v33
    v_mfma_f32_32x32x16_bf16 v[80:95], v[36:39], v[40:43], v[80:95]
    ds_read_b128 v[56:59], v4 offset:6144
    v_dot2c_f32_bf16 v20, s27, v34
    v_dot2c_f32_bf16 v22, v34, v34
    v_mfma_f32_32x32x16_bf16 v[112:127], v[36:39], v[44:47], v[112:127]
    ds_read_b128 v[60:63], v4 offset:7168
    v_dot2c_f32_bf16 v21, s27, v35
    v_mfma_f32_32x32x16_bf16 v[144:159], v[44:47], v[36:39], v[144:159]
    v_dot2c_f32_bf16 v23, v35, v35
    s_waitcnt vmcnt(22)
    s_barrier
    s_waitcnt lgkmcnt(0)
    v_mfma_f32_32x32x16_bf16 v[64:79], v[48:51], v[56:59], v[64:79]
    v_dot2c_f32_bf16 v20, s27, v48
    v_dot2c_f32_bf16 v22, v48, v48
    s_lshl_b32 s28, s13, 12
    s_add_u32 s28, s28, 98304
    s_mov_b32 m0, s28
    s_add_u32 s29, s24, 384
    buffer_load_dwordx4 v2, s[16:19], s29 offen offset:0 lds
    v_mfma_f32_32x32x16_bf16 v[96:111], v[48:51], v[60:63], v[96:111]
    ds_read_b128 v[32:35], v6 offset:32768
    v_dot2c_f32_bf16 v21, s27, v49
    s_add_u32 s29, s29, 9216
    buffer_load_dwordx4 v3, s[16:19], s29 offen offset:1024 lds
    v_mfma_f32_32x32x16_bf16 v[128:143], v[60:63], v[48:51], v[128:143]
    ds_read_b128 v[36:39], v6 offset:36864
    v_dot2c_f32_bf16 v23, v49, v49
    s_add_u32 s29, s29, 9216
    buffer_load_dwordx4 v2, s[16:19], s29 offen offset:2048 lds
    v_mfma_f32_32x32x16_bf16 v[80:95], v[52:55], v[56:59], v[80:95]
    ds_read_b128 v[40:43], v4 offset:32768
    v_dot2c_f32_bf16 v20, s27, v50
    v_dot2c_f32_bf16 v22, v50, v50
    s_add_u32 s29, s29, 9216
    buffer_load_dwordx4 v3, s[16:19], s29 offen offset:3072 lds
    v_mfma_f32_32x32x16_bf16 v[112:127], v[52:55], v[60:63], v[112:127]
    ds_read_b128 v[44:47], v4 offset:33792
    v_dot2c_f32_bf16 v21, s27, v51
    s_add_u32 s28, s28, 16384
    s_mov_b32 m0, s28
    s_add_u32 s29, s25, 24576
    buffer_load_dwordx4 v1, s[8:11], s29 offen offset:0 lds
    v_mfma_f32_32x32x16_bf16 v[144:159], v[60:63], v[52:55], v[144:159]
    v_dot2c_f32_bf16 v23, v51, v51
    buffer_load_dwordx4 v1, s[8:11], s29 offen offset:1024 lds
    s_waitcnt lgkmcnt(0)
    v_mfma_f32_32x32x16_bf16 v[64:79], v[32:35], v[40:43], v[64:79]
    v_dot2c_f32_bf16 v20, s27, v32
    v_dot2c_f32_bf16 v22, v32, v32
    buffer_load_dwordx4 v1, s[8:11], s29 offen offset:2048 lds
    v_mfma_f32_32x32x16_bf16 v[96:111], v[32:35], v[44:47], v[96:111]
    ds_read_b128 v[48:51], v7 offset:32768
    v_dot2c_f32_bf16 v21, s27, v33
    buffer_load_dwordx4 v1, s[8:11], s29 offen offset:3072 lds
    v_mfma_f32_32x32x16_bf16 v[128:143], v[44:47], v[32:35], v[128:143]
    ds_read_b128 v[52:55], v7 offset:36864
    v_dot2c_f32_bf16 v23, v33, v33
    s_bfe_u32 s41, s51, 524312
    s_mul_i32 s41, s41, s40
    s_add_u32 s42, s58, s41
    s_add_u32 s43, s59, s41
    buffer_load_dwordx4 a[56:59], v240, s[8:11], s42 offen
    v_mfma_f32_32x32x16_bf16 v[80:95], v[36:39], v[40:43], v[80:95]
    ds_read_b128 v[56:59], v4 offset:34816
    v_dot2c_f32_bf16 v20, s27, v34
    v_dot2c_f32_bf16 v22, v34, v34
    buffer_load_dwordx4 a[60:63], v241, s[8:11], s43 offen
    v_mfma_f32_32x32x16_bf16 v[112:127], v[36:39], v[44:47], v[112:127]
    ds_read_b128 v[60:63], v4 offset:35840
    v_dot2c_f32_bf16 v21, s27, v35
    s_bfe_u32 s41, s52, 524288
    s_mul_i32 s41, s41, s40
    s_add_u32 s42, s58, s41
    s_add_u32 s43, s59, s41
    buffer_load_dwordx4 a[64:67], v240, s[8:11], s42 offen
    v_mfma_f32_32x32x16_bf16 v[144:159], v[44:47], v[36:39], v[144:159]
    v_dot2c_f32_bf16 v23, v35, v35
    buffer_load_dwordx4 a[68:71], v241, s[8:11], s43 offen
    s_waitcnt lgkmcnt(0)
    v_mfma_f32_32x32x16_bf16 v[64:79], v[48:51], v[56:59], v[64:79]
    v_dot2c_f32_bf16 v20, s27, v48
    v_dot2c_f32_bf16 v22, v48, v48
    v_mfma_f32_32x32x16_bf16 v[96:111], v[48:51], v[60:63], v[96:111]
    ds_read_b128 v[32:35], v8 offset:32768
    v_dot2c_f32_bf16 v21, s27, v49
    v_mfma_f32_32x32x16_bf16 v[128:143], v[60:63], v[48:51], v[128:143]
    ds_read_b128 v[36:39], v8 offset:36864
    v_dot2c_f32_bf16 v23, v49, v49
    v_mfma_f32_32x32x16_bf16 v[80:95], v[52:55], v[56:59], v[80:95]
    ds_read_b128 v[40:43], v4 offset:36864
    v_dot2c_f32_bf16 v20, s27, v50
    v_dot2c_f32_bf16 v22, v50, v50
    v_mfma_f32_32x32x16_bf16 v[112:127], v[52:55], v[60:63], v[112:127]
    ds_read_b128 v[44:47], v4 offset:37888
    v_dot2c_f32_bf16 v21, s27, v51
    v_mfma_f32_32x32x16_bf16 v[144:159], v[60:63], v[52:55], v[144:159]
    v_dot2c_f32_bf16 v23, v51, v51
    s_waitcnt lgkmcnt(0)
    v_mfma_f32_32x32x16_bf16 v[64:79], v[32:35], v[40:43], v[64:79]
    v_dot2c_f32_bf16 v20, s27, v32
    v_dot2c_f32_bf16 v22, v32, v32
    v_mfma_f32_32x32x16_bf16 v[96:111], v[32:35], v[44:47], v[96:111]
    ds_read_b128 v[48:51], v9 offset:32768
    v_dot2c_f32_bf16 v21, s27, v33
    v_mfma_f32_32x32x16_bf16 v[128:143], v[44:47], v[32:35], v[128:143]
    ds_read_b128 v[52:55], v9 offset:36864
    v_dot2c_f32_bf16 v23, v33, v33
    v_mfma_f32_32x32x16_bf16 v[80:95], v[36:39], v[40:43], v[80:95]
    ds_read_b128 v[56:59], v4 offset:38912
    v_dot2c_f32_bf16 v20, s27, v34
    v_dot2c_f32_bf16 v22, v34, v34
    v_mfma_f32_32x32x16_bf16 v[112:127], v[36:39], v[44:47], v[112:127]
    ds_read_b128 v[60:63], v4 offset:39936
    v_dot2c_f32_bf16 v21, s27, v35
    v_mfma_f32_32x32x16_bf16 v[144:159], v[44:47], v[36:39], v[144:159]
    v_dot2c_f32_bf16 v23, v35, v35
    s_waitcnt vmcnt(26)
    s_barrier
    s_waitcnt lgkmcnt(0)
    v_mfma_f32_32x32x16_bf16 v[64:79], v[48:51], v[56:59], v[64:79]
    v_dot2c_f32_bf16 v20, s27, v48
    v_dot2c_f32_bf16 v22, v48, v48
    s_lshl_b32 s28, s13, 12
    s_mov_b32 m0, s28
    s_add_u32 s29, s24, 512
    buffer_load_dwordx4 v2, s[16:19], s29 offen offset:0 lds
    v_mfma_f32_32x32x16_bf16 v[96:111], v[48:51], v[60:63], v[96:111]
    ds_read_b128 v[32:35], v10 offset:0
    v_dot2c_f32_bf16 v21, s27, v49
    s_add_u32 s29, s29, 9216
    buffer_load_dwordx4 v3, s[16:19], s29 offen offset:1024 lds
    v_mfma_f32_32x32x16_bf16 v[128:143], v[60:63], v[48:51], v[128:143]
    ds_read_b128 v[36:39], v10 offset:4096
    v_dot2c_f32_bf16 v23, v49, v49
    s_add_u32 s29, s29, 9216
    buffer_load_dwordx4 v2, s[16:19], s29 offen offset:2048 lds
    v_mfma_f32_32x32x16_bf16 v[80:95], v[52:55], v[56:59], v[80:95]
    ds_read_b128 v[40:43], v5 offset:0
    v_dot2c_f32_bf16 v20, s27, v50
    v_dot2c_f32_bf16 v22, v50, v50
    s_add_u32 s29, s29, 9216
    buffer_load_dwordx4 v3, s[16:19], s29 offen offset:3072 lds
    v_mfma_f32_32x32x16_bf16 v[112:127], v[52:55], v[60:63], v[112:127]
    ds_read_b128 v[44:47], v5 offset:1024
    v_dot2c_f32_bf16 v21, s27, v51
    s_add_u32 s28, s28, 16384
    s_mov_b32 m0, s28
    s_add_u32 s29, s25, 32768
    buffer_load_dwordx4 v1, s[8:11], s29 offen offset:0 lds
    v_mfma_f32_32x32x16_bf16 v[144:159], v[60:63], v[52:55], v[144:159]
    v_dot2c_f32_bf16 v23, v51, v51
    buffer_load_dwordx4 v1, s[8:11], s29 offen offset:1024 lds
    s_waitcnt lgkmcnt(0)
    v_mfma_f32_32x32x16_bf16 v[64:79], v[32:35], v[40:43], v[64:79]
    v_dot2c_f32_bf16 v20, s27, v32
    v_dot2c_f32_bf16 v22, v32, v32
    buffer_load_dwordx4 v1, s[8:11], s29 offen offset:2048 lds
    v_mfma_f32_32x32x16_bf16 v[96:111], v[32:35], v[44:47], v[96:111]
    ds_read_b128 v[48:51], v11 offset:0
    v_dot2c_f32_bf16 v21, s27, v33
    buffer_load_dwordx4 v1, s[8:11], s29 offen offset:3072 lds
    v_mfma_f32_32x32x16_bf16 v[128:143], v[44:47], v[32:35], v[128:143]
    ds_read_b128 v[52:55], v11 offset:4096
    v_dot2c_f32_bf16 v23, v33, v33
    s_bfe_u32 s41, s52, 524296
    s_mul_i32 s41, s41, s40
    s_add_u32 s42, s58, s41
    s_add_u32 s43, s59, s41
    buffer_load_dwordx4 a[72:75], v240, s[8:11], s42 offen
    v_mfma_f32_32x32x16_bf16 v[80:95], v[36:39], v[40:43], v[80:95]
    ds_read_b128 v[56:59], v5 offset:2048
    v_dot2c_f32_bf16 v20, s27, v34
    v_dot2c_f32_bf16 v22, v34, v34
    buffer_load_dwordx4 a[76:79], v241, s[8:11], s43 offen
    v_mfma_f32_32x32x16_bf16 v[112:127], v[36:39], v[44:47], v[112:127]
    ds_read_b128 v[60:63], v5 offset:3072
    v_dot2c_f32_bf16 v21, s27, v35
    s_bfe_u32 s41, s52, 524304
    s_mul_i32 s41, s41, s40
    s_add_u32 s42, s58, s41
    s_add_u32 s43, s59, s41
    buffer_load_dwordx4 a[80:83], v240, s[8:11], s42 offen
    v_mfma_f32_32x32x16_bf16 v[144:159], v[44:47], v[36:39], v[144:159]
    v_dot2c_f32_bf16 v23, v35, v35
    buffer_load_dwordx4 a[84:87], v241, s[8:11], s43 offen
    s_waitcnt lgkmcnt(0)
    v_mfma_f32_32x32x16_bf16 v[64:79], v[48:51], v[56:59], v[64:79]
    v_dot2c_f32_bf16 v20, s27, v48
    v_dot2c_f32_bf16 v22, v48, v48
    v_mfma_f32_32x32x16_bf16 v[96:111], v[48:51], v[60:63], v[96:111]
    ds_read_b128 v[32:35], v12 offset:0
    v_dot2c_f32_bf16 v21, s27, v49
    v_mfma_f32_32x32x16_bf16 v[128:143], v[60:63], v[48:51], v[128:143]
    ds_read_b128 v[36:39], v12 offset:4096
    v_dot2c_f32_bf16 v23, v49, v49
    v_mfma_f32_32x32x16_bf16 v[80:95], v[52:55], v[56:59], v[80:95]
    ds_read_b128 v[40:43], v5 offset:4096
    v_dot2c_f32_bf16 v20, s27, v50
    v_dot2c_f32_bf16 v22, v50, v50
    v_mfma_f32_32x32x16_bf16 v[112:127], v[52:55], v[60:63], v[112:127]
    ds_read_b128 v[44:47], v5 offset:5120
    v_dot2c_f32_bf16 v21, s27, v51
    v_mfma_f32_32x32x16_bf16 v[144:159], v[60:63], v[52:55], v[144:159]
    v_dot2c_f32_bf16 v23, v51, v51
    s_waitcnt lgkmcnt(0)
    v_mfma_f32_32x32x16_bf16 v[64:79], v[32:35], v[40:43], v[64:79]
    v_dot2c_f32_bf16 v20, s27, v32
    v_dot2c_f32_bf16 v22, v32, v32
    v_mfma_f32_32x32x16_bf16 v[96:111], v[32:35], v[44:47], v[96:111]
    ds_read_b128 v[48:51], v13 offset:0
    v_dot2c_f32_bf16 v21, s27, v33
    v_mfma_f32_32x32x16_bf16 v[128:143], v[44:47], v[32:35], v[128:143]
    ds_read_b128 v[52:55], v13 offset:4096
    v_dot2c_f32_bf16 v23, v33, v33
    v_mfma_f32_32x32x16_bf16 v[80:95], v[36:39], v[40:43], v[80:95]
    ds_read_b128 v[56:59], v5 offset:6144
    v_dot2c_f32_bf16 v20, s27, v34
    v_dot2c_f32_bf16 v22, v34, v34
    v_mfma_f32_32x32x16_bf16 v[112:127], v[36:39], v[44:47], v[112:127]
    ds_read_b128 v[60:63], v5 offset:7168
    v_dot2c_f32_bf16 v21, s27, v35
    v_mfma_f32_32x32x16_bf16 v[144:159], v[44:47], v[36:39], v[144:159]
    v_dot2c_f32_bf16 v23, v35, v35
    s_waitcnt vmcnt(16)
    s_barrier
    s_waitcnt lgkmcnt(0)
    v_mfma_f32_32x32x16_bf16 v[64:79], v[48:51], v[56:59], v[64:79]
    v_dot2c_f32_bf16 v20, s27, v48
    v_dot2c_f32_bf16 v22, v48, v48
    s_lshl_b32 s28, s13, 12
    s_add_u32 s28, s28, 32768
    s_mov_b32 m0, s28
    s_add_u32 s29, s24, 640
    buffer_load_dwordx4 v2, s[16:19], s29 offen offset:0 lds
    v_mfma_f32_32x32x16_bf16 v[96:111], v[48:51], v[60:63], v[96:111]
    ds_read_b128 v[32:35], v10 offset:32768
    v_dot2c_f32_bf16 v21, s27, v49
    s_add_u32 s29, s29, 9216
    buffer_load_dwordx4 v3, s[16:19], s29 offen offset:1024 lds
    v_mfma_f32_32x32x16_bf16 v[128:143], v[60:63], v[48:51], v[128:143]
    ds_read_b128 v[36:39], v10 offset:36864
    v_dot2c_f32_bf16 v23, v49, v49
    s_add_u32 s29, s29, 9216
    buffer_load_dwordx4 v2, s[16:19], s29 offen offset:2048 lds
    v_mfma_f32_32x32x16_bf16 v[80:95], v[52:55], v[56:59], v[80:95]
    ds_read_b128 v[40:43], v5 offset:32768
    v_dot2c_f32_bf16 v20, s27, v50
    v_dot2c_f32_bf16 v22, v50, v50
    s_add_u32 s29, s29, 9216
    buffer_load_dwordx4 v3, s[16:19], s29 offen offset:3072 lds
    v_mfma_f32_32x32x16_bf16 v[112:127], v[52:55], v[60:63], v[112:127]
    ds_read_b128 v[44:47], v5 offset:33792
    v_dot2c_f32_bf16 v21, s27, v51
    s_add_u32 s28, s28, 16384
    s_mov_b32 m0, s28
    s_add_u32 s29, s25, 40960
    buffer_load_dwordx4 v1, s[8:11], s29 offen offset:0 lds
    v_mfma_f32_32x32x16_bf16 v[144:159], v[60:63], v[52:55], v[144:159]
    v_dot2c_f32_bf16 v23, v51, v51
    buffer_load_dwordx4 v1, s[8:11], s29 offen offset:1024 lds
    s_waitcnt lgkmcnt(0)
    v_mfma_f32_32x32x16_bf16 v[64:79], v[32:35], v[40:43], v[64:79]
    v_dot2c_f32_bf16 v20, s27, v32
    v_dot2c_f32_bf16 v22, v32, v32
    buffer_load_dwordx4 v1, s[8:11], s29 offen offset:2048 lds
    v_mfma_f32_32x32x16_bf16 v[96:111], v[32:35], v[44:47], v[96:111]
    ds_read_b128 v[48:51], v11 offset:32768
    v_dot2c_f32_bf16 v21, s27, v33
    buffer_load_dwordx4 v1, s[8:11], s29 offen offset:3072 lds
    v_mfma_f32_32x32x16_bf16 v[128:143], v[44:47], v[32:35], v[128:143]
    ds_read_b128 v[52:55], v11 offset:36864
    v_dot2c_f32_bf16 v23, v33, v33
    s_bfe_u32 s41, s52, 524312
    s_mul_i32 s41, s41, s40
    s_add_u32 s42, s58, s41
    s_add_u32 s43, s59, s41
    buffer_load_dwordx4 a[88:91], v240, s[8:11], s42 offen
    v_mfma_f32_32x32x16_bf16 v[80:95], v[36:39], v[40:43], v[80:95]
    ds_read_b128 v[56:59], v5 offset:34816
    v_dot2c_f32_bf16 v20, s27, v34
    v_dot2c_f32_bf16 v22, v34, v34
    buffer_load_dwordx4 a[92:95], v241, s[8:11], s43 offen
    v_mfma_f32_32x32x16_bf16 v[112:127], v[36:39], v[44:47], v[112:127]
    ds_read_b128 v[60:63], v5 offset:35840
    v_dot2c_f32_bf16 v21, s27, v35
    s_bfe_u32 s41, s53, 524288
    s_mul_i32 s41, s41, s40
    s_add_u32 s42, s58, s41
    s_add_u32 s43, s59, s41
    buffer_load_dwordx4 a[96:99], v240, s[8:11], s42 offen
    v_mfma_f32_32x32x16_bf16 v[144:159], v[44:47], v[36:39], v[144:159]
    v_dot2c_f32_bf16 v23, v35, v35
    buffer_load_dwordx4 a[100:103], v241, s[8:11], s43 offen
    s_waitcnt lgkmcnt(0)
    v_mfma_f32_32x32x16_bf16 v[64:79], v[48:51], v[56:59], v[64:79]
    v_dot2c_f32_bf16 v20, s27, v48
    v_dot2c_f32_bf16 v22, v48, v48
    v_mfma_f32_32x32x16_bf16 v[96:111], v[48:51], v[60:63], v[96:111]
    ds_read_b128 v[32:35], v12 offset:32768
    v_dot2c_f32_bf16 v21, s27, v49
    v_mfma_f32_32x32x16_bf16 v[128:143], v[60:63], v[48:51], v[128:143]
    ds_read_b128 v[36:39], v12 offset:36864
    v_dot2c_f32_bf16 v23, v49, v49
    v_mfma_f32_32x32x16_bf16 v[80:95], v[52:55], v[56:59], v[80:95]
    ds_read_b128 v[40:43], v5 offset:36864
    v_dot2c_f32_bf16 v20, s27, v50
    v_dot2c_f32_bf16 v22, v50, v50
    v_mfma_f32_32x32x16_bf16 v[112:127], v[52:55], v[60:63], v[112:127]
    ds_read_b128 v[44:47], v5 offset:37888
    v_dot2c_f32_bf16 v21, s27, v51
    v_mfma_f32_32x32x16_bf16 v[144:159], v[60:63], v[52:55], v[144:159]
    v_dot2c_f32_bf16 v23, v51, v51
    s_waitcnt lgkmcnt(0)
    v_mfma_f32_32x32x16_bf16 v[64:79], v[32:35], v[40:43], v[64:79]
    v_dot2c_f32_bf16 v20, s27, v32
    v_dot2c_f32_bf16 v22, v32, v32
    v_mfma_f32_32x32x16_bf16 v[96:111], v[32:35], v[44:47], v[96:111]
    ds_read_b128 v[48:51], v13 offset:32768
    v_dot2c_f32_bf16 v21, s27, v33
    v_mfma_f32_32x32x16_bf16 v[128:143], v[44:47], v[32:35], v[128:143]
    ds_read_b128 v[52:55], v13 offset:36864
    v_dot2c_f32_bf16 v23, v33, v33
    v_mfma_f32_32x32x16_bf16 v[80:95], v[36:39], v[40:43], v[80:95]
    ds_read_b128 v[56:59], v5 offset:38912
    v_dot2c_f32_bf16 v20, s27, v34
    v_dot2c_f32_bf16 v22, v34, v34
    v_mfma_f32_32x32x16_bf16 v[112:127], v[36:39], v[44:47], v[112:127]
    ds_read_b128 v[60:63], v5 offset:39936
    v_dot2c_f32_bf16 v21, s27, v35
    v_mfma_f32_32x32x16_bf16 v[144:159], v[44:47], v[36:39], v[144:159]
    v_dot2c_f32_bf16 v23, v35, v35
    s_waitcnt vmcnt(16)
    s_barrier
    s_waitcnt lgkmcnt(0)
    v_mfma_f32_32x32x16_bf16 v[64:79], v[48:51], v[56:59], v[64:79]
    v_dot2c_f32_bf16 v20, s27, v48
    v_dot2c_f32_bf16 v22, v48, v48
    s_lshl_b32 s28, s13, 12
    s_add_u32 s28, s28, 65536
    s_mov_b32 m0, s28
    s_add_u32 s29, s24, 768
    buffer_load_dwordx4 v2, s[16:19], s29 offen offset:0 lds
    v_mfma_f32_32x32x16_bf16 v[96:111], v[48:51], v[60:63], v[96:111]
    ds_read_b128 v[32:35], v6 offset:0
    v_dot2c_f32_bf16 v21, s27, v49
    s_add_u32 s29, s29, 9216
    buffer_load_dwordx4 v3, s[16:19], s29 offen offset:1024 lds
    v_mfma_f32_32x32x16_bf16 v[128:143], v[60:63], v[48:51], v[128:143]
    ds_read_b128 v[36:39], v6 offset:4096
    v_dot2c_f32_bf16 v23, v49, v49
    s_add_u32 s29, s29, 9216
    buffer_load_dwordx4 v2, s[16:19], s29 offen offset:2048 lds
    v_mfma_f32_32x32x16_bf16 v[80:95], v[52:55], v[56:59], v[80:95]
    ds_read_b128 v[40:43], v4 offset:0
    v_dot2c_f32_bf16 v20, s27, v50
    v_dot2c_f32_bf16 v22, v50, v50
    s_add_u32 s29, s29, 9216
    buffer_load_dwordx4 v3, s[16:19], s29 offen offset:3072 lds
    v_mfma_f32_32x32x16_bf16 v[112:127], v[52:55], v[60:63], v[112:127]
    ds_read_b128 v[44:47], v4 offset:1024
    v_dot2c_f32_bf16 v21, s27, v51
    s_add_u32 s28, s28, 16384
    s_mov_b32 m0, s28
    s_add_u32 s29, s25, 49152
    buffer_load_dwordx4 v1, s[8:11], s29 offen offset:0 lds
    v_mfma_f32_32x32x16_bf16 v[144:159], v[60:63], v[52:55], v[144:159]
    v_dot2c_f32_bf16 v23, v51, v51
    buffer_load_dwordx4 v1, s[8:11], s29 offen offset:1024 lds
    s_waitcnt lgkmcnt(0)
    v_mfma_f32_32x32x16_bf16 v[64:79], v[32:35], v[40:43], v[64:79]
    v_dot2c_f32_bf16 v20, s27, v32
    v_dot2c_f32_bf16 v22, v32, v32
    buffer_load_dwordx4 v1, s[8:11], s29 offen offset:2048 lds
    v_mfma_f32_32x32x16_bf16 v[96:111], v[32:35], v[44:47], v[96:111]
    ds_read_b128 v[48:51], v7 offset:0
    v_dot2c_f32_bf16 v21, s27, v33
    buffer_load_dwordx4 v1, s[8:11], s29 offen offset:3072 lds
    v_mfma_f32_32x32x16_bf16 v[128:143], v[44:47], v[32:35], v[128:143]
    ds_read_b128 v[52:55], v7 offset:4096
    v_dot2c_f32_bf16 v23, v33, v33
    s_bfe_u32 s41, s53, 524296
    s_mul_i32 s41, s41, s40
    s_add_u32 s42, s58, s41
    s_add_u32 s43, s59, s41
    buffer_load_dwordx4 a[104:107], v240, s[8:11], s42 offen
    v_mfma_f32_32x32x16_bf16 v[80:95], v[36:39], v[40:43], v[80:95]
    ds_read_b128 v[56:59], v4 offset:2048
    v_dot2c_f32_bf16 v20, s27, v34
    v_dot2c_f32_bf16 v22, v34, v34
    buffer_load_dwordx4 a[108:111], v241, s[8:11], s43 offen
    v_mfma_f32_32x32x16_bf16 v[112:127], v[36:39], v[44:47], v[112:127]
    ds_read_b128 v[60:63], v4 offset:3072
    v_dot2c_f32_bf16 v21, s27, v35
    s_bfe_u32 s41, s53, 524304
    s_mul_i32 s41, s41, s40
    s_add_u32 s42, s58, s41
    s_add_u32 s43, s59, s41
    buffer_load_dwordx4 a[112:115], v240, s[8:11], s42 offen
    v_mfma_f32_32x32x16_bf16 v[144:159], v[44:47], v[36:39], v[144:159]
    v_dot2c_f32_bf16 v23, v35, v35
    buffer_load_dwordx4 a[116:119], v241, s[8:11], s43 offen
    s_waitcnt lgkmcnt(0)
    v_mfma_f32_32x32x16_bf16 v[64:79], v[48:51], v[56:59], v[64:79]
    v_dot2c_f32_bf16 v20, s27, v48
    v_dot2c_f32_bf16 v22, v48, v48
    v_mfma_f32_32x32x16_bf16 v[96:111], v[48:51], v[60:63], v[96:111]
    ds_read_b128 v[32:35], v8 offset:0
    v_dot2c_f32_bf16 v21, s27, v49
    v_mfma_f32_32x32x16_bf16 v[128:143], v[60:63], v[48:51], v[128:143]
    ds_read_b128 v[36:39], v8 offset:4096
    v_dot2c_f32_bf16 v23, v49, v49
    v_mfma_f32_32x32x16_bf16 v[80:95], v[52:55], v[56:59], v[80:95]
    ds_read_b128 v[40:43], v4 offset:4096
    v_dot2c_f32_bf16 v20, s27, v50
    v_dot2c_f32_bf16 v22, v50, v50
    v_mfma_f32_32x32x16_bf16 v[112:127], v[52:55], v[60:63], v[112:127]
    ds_read_b128 v[44:47], v4 offset:5120
    v_dot2c_f32_bf16 v21, s27, v51
    v_mfma_f32_32x32x16_bf16 v[144:159], v[60:63], v[52:55], v[144:159]
    v_dot2c_f32_bf16 v23, v51, v51
    s_waitcnt lgkmcnt(0)
    v_mfma_f32_32x32x16_bf16 v[64:79], v[32:35], v[40:43], v[64:79]
    v_dot2c_f32_bf16 v20, s27, v32
    v_dot2c_f32_bf16 v22, v32, v32
    v_mfma_f32_32x32x16_bf16 v[96:111], v[32:35], v[44:47], v[96:111]
    ds_read_b128 v[48:51], v9 offset:0
    v_dot2c_f32_bf16 v21, s27, v33
    v_mfma_f32_32x32x16_bf16 v[128:143], v[44:47], v[32:35], v[128:143]
    ds_read_b128 v[52:55], v9 offset:4096
    v_dot2c_f32_bf16 v23, v33, v33
    v_mfma_f32_32x32x16_bf16 v[80:95], v[36:39], v[40:43], v[80:95]
    ds_read_b128 v[56:59], v4 offset:6144
    v_dot2c_f32_bf16 v20, s27, v34
    v_dot2c_f32_bf16 v22, v34, v34
    v_mfma_f32_32x32x16_bf16 v[112:127], v[36:39], v[44:47], v[112:127]
    ds_read_b128 v[60:63], v4 offset:7168
    v_dot2c_f32_bf16 v21, s27, v35
    v_mfma_f32_32x32x16_bf16 v[144:159], v[44:47], v[36:39], v[144:159]
    v_dot2c_f32_bf16 v23, v35, v35
    s_waitcnt vmcnt(16)
    s_barrier
    s_waitcnt lgkmcnt(0)
    v_mfma_f32_32x32x16_bf16 v[64:79], v[48:51], v[56:59], v[64:79]
    v_dot2c_f32_bf16 v20, s27, v48
    v_dot2c_f32_bf16 v22, v48, v48
    s_lshl_b32 s28, s13, 12
    s_add_u32 s28, s28, 98304
    s_mov_b32 m0, s28
    s_add_u32 s29, s24, 896
    buffer_load_dwordx4 v2, s[16:19], s29 offen offset:0 lds
    v_mfma_f32_32x32x16_bf16 v[96:111], v[48:51], v[60:63], v[96:111]
    ds_read_b128 v[32:35], v6 offset:32768
    v_dot2c_f32_bf16 v21, s27, v49
    s_add_u32 s29, s29, 9216
    buffer_load_dwordx4 v3, s[16:19], s29 offen offset:1024 lds
    v_mfma_f32_32x32x16_bf16 v[128:143], v[60:63], v[48:51], v[128:143]
    ds_read_b128 v[36:39], v6 offset:36864
    v_dot2c_f32_bf16 v23, v49, v49
    s_add_u32 s29, s29, 9216
    buffer_load_dwordx4 v2, s[16:19], s29 offen offset:2048 lds
    v_mfma_f32_32x32x16_bf16 v[80:95], v[52:55], v[56:59], v[80:95]
    ds_read_b128 v[40:43], v4 offset:32768
    v_dot2c_f32_bf16 v20, s27, v50
    v_dot2c_f32_bf16 v22, v50, v50
    s_add_u32 s29, s29, 9216
    buffer_load_dwordx4 v3, s[16:19], s29 offen offset:3072 lds
    v_mfma_f32_32x32x16_bf16 v[112:127], v[52:55], v[60:63], v[112:127]
    ds_read_b128 v[44:47], v4 offset:33792
    v_dot2c_f32_bf16 v21, s27, v51
    s_add_u32 s28, s28, 16384
    s_mov_b32 m0, s28
    s_add_u32 s29, s25, 57344
    buffer_load_dwordx4 v1, s[8:11], s29 offen offset:0 lds
    v_mfma_f32_32x32x16_bf16 v[144:159], v[60:63], v[52:55], v[144:159]
    v_dot2c_f32_bf16 v23, v51, v51
    buffer_load_dwordx4 v1, s[8:11], s29 offen offset:1024 lds
    s_waitcnt lgkmcnt(0)
    v_mfma_f32_32x32x16_bf16 v[64:79], v[32:35], v[40:43], v[64:79]
    v_dot2c_f32_bf16 v20, s27, v32
    v_dot2c_f32_bf16 v22, v32, v32
    buffer_load_dwordx4 v1, s[8:11], s29 offen offset:2048 lds
    v_mfma_f32_32x32x16_bf16 v[96:111], v[32:35], v[44:47], v[96:111]
    ds_read_b128 v[48:51], v7 offset:32768
    v_dot2c_f32_bf16 v21, s27, v33
    buffer_load_dwordx4 v1, s[8:11], s29 offen offset:3072 lds
    v_mfma_f32_32x32x16_bf16 v[128:143], v[44:47], v[32:35], v[128:143]
    ds_read_b128 v[52:55], v7 offset:36864
    v_dot2c_f32_bf16 v23, v33, v33
    s_bfe_u32 s41, s53, 524312
    s_mul_i32 s41, s41, s40
    s_add_u32 s42, s58, s41
    s_add_u32 s43, s59, s41
    buffer_load_dwordx4 a[120:123], v240, s[8:11], s42 offen
    v_mfma_f32_32x32x16_bf16 v[80:95], v[36:39], v[40:43], v[80:95]
    ds_read_b128 v[56:59], v4 offset:34816
    v_dot2c_f32_bf16 v20, s27, v34
    v_dot2c_f32_bf16 v22, v34, v34
    buffer_load_dwordx4 a[124:127], v241, s[8:11], s43 offen
    v_mfma_f32_32x32x16_bf16 v[112:127], v[36:39], v[44:47], v[112:127]
    ds_read_b128 v[60:63], v4 offset:35840
    v_dot2c_f32_bf16 v21, s27, v35
    s_bfe_u32 s41, s54, 524288
    s_mul_i32 s41, s41, s40
    s_add_u32 s42, s58, s41
    s_add_u32 s43, s59, s41
    buffer_load_dwordx4 a[128:131], v240, s[8:11], s42 offen
    v_mfma_f32_32x32x16_bf16 v[144:159], v[44:47], v[36:39], v[144:159]
    v_dot2c_f32_bf16 v23, v35, v35
    buffer_load_dwordx4 a[132:135], v241, s[8:11], s43 offen
    s_waitcnt lgkmcnt(0)
    v_mfma_f32_32x32x16_bf16 v[64:79], v[48:51], v[56:59], v[64:79]
    v_dot2c_f32_bf16 v20, s27, v48
    v_dot2c_f32_bf16 v22, v48, v48
    v_mfma_f32_32x32x16_bf16 v[96:111], v[48:51], v[60:63], v[96:111]
    ds_read_b128 v[32:35], v8 offset:32768
    v_dot2c_f32_bf16 v21, s27, v49
    v_mfma_f32_32x32x16_bf16 v[128:143], v[60:63], v[48:51], v[128:143]
    ds_read_b128 v[36:39], v8 offset:36864
    v_dot2c_f32_bf16 v23, v49, v49
    v_mfma_f32_32x32x16_bf16 v[80:95], v[52:55], v[56:59], v[80:95]
    ds_read_b128 v[40:43], v4 offset:36864
    v_dot2c_f32_bf16 v20, s27, v50
    v_dot2c_f32_bf16 v22, v50, v50
    v_mfma_f32_32x32x16_bf16 v[112:127], v[52:55], v[60:63], v[112:127]
    ds_read_b128 v[44:47], v4 offset:37888
    v_dot2c_f32_bf16 v21, s27, v51
    v_mfma_f32_32x32x16_bf16 v[144:159], v[60:63], v[52:55], v[144:159]
    v_dot2c_f32_bf16 v23, v51, v51
    s_waitcnt lgkmcnt(0)
    v_mfma_f32_32x32x16_bf16 v[64:79], v[32:35], v[40:43], v[64:79]
    v_dot2c_f32_bf16 v20, s27, v32
    v_dot2c_f32_bf16 v22, v32, v32
    v_mfma_f32_32x32x16_bf16 v[96:111], v[32:35], v[44:47], v[96:111]
    ds_read_b128 v[48:51], v9 offset:32768
    v_dot2c_f32_bf16 v21, s27, v33
    v_mfma_f32_32x32x16_bf16 v[128:143], v[44:47], v[32:35], v[128:143]
    ds_read_b128 v[52:55], v9 offset:36864
    v_dot2c_f32_bf16 v23, v33, v33
    v_mfma_f32_32x32x16_bf16 v[80:95], v[36:39], v[40:43], v[80:95]
    ds_read_b128 v[56:59], v4 offset:38912
    v_dot2c_f32_bf16 v20, s27, v34
    v_dot2c_f32_bf16 v22, v34, v34
    v_mfma_f32_32x32x16_bf16 v[112:127], v[36:39], v[44:47], v[112:127]
    ds_read_b128 v[60:63], v4 offset:39936
    v_dot2c_f32_bf16 v21, s27, v35
    v_mfma_f32_32x32x16_bf16 v[144:159], v[44:47], v[36:39], v[144:159]
    v_dot2c_f32_bf16 v23, v35, v35
    s_waitcnt vmcnt(16)
    s_barrier
    s_waitcnt lgkmcnt(0)
    v_mfma_f32_32x32x16_bf16 v[64:79], v[48:51], v[56:59], v[64:79]
    v_dot2c_f32_bf16 v20, s27, v48
    v_dot2c_f32_bf16 v22, v48, v48
    s_lshl_b32 s28, s13, 12
    s_mov_b32 m0, s28
    s_add_u32 s29, s24, 1024
    buffer_load_dwordx4 v2, s[16:19], s29 offen offset:0 lds
    v_mfma_f32_32x32x16_bf16 v[96:111], v[48:51], v[60:63], v[96:111]
    ds_read_b128 v[32:35], v10 offset:0
    v_dot2c_f32_bf16 v21, s27, v49
    s_add_u32 s29, s29, 9216
    buffer_load_dwordx4 v3, s[16:19], s29 offen offset:1024 lds
    v_mfma_f32_32x32x16_bf16 v[128:143], v[60:63], v[48:51], v[128:143]
    ds_read_b128 v[36:39], v10 offset:4096
    v_dot2c_f32_bf16 v23, v49, v49
    s_add_u32 s29, s29, 9216
    buffer_load_dwordx4 v2, s[16:19], s29 offen offset:2048 lds
    v_mfma_f32_32x32x16_bf16 v[80:95], v[52:55], v[56:59], v[80:95]
    ds_read_b128 v[40:43], v5 offset:0
    v_dot2c_f32_bf16 v20, s27, v50
    v_dot2c_f32_bf16 v22, v50, v50
    s_add_u32 s29, s29, 9216
    buffer_load_dwordx4 v3, s[16:19], s29 offen offset:3072 lds
    v_mfma_f32_32x32x16_bf16 v[112:127], v[52:55], v[60:63], v[112:127]
    ds_read_b128 v[44:47], v5 offset:1024
    v_dot2c_f32_bf16 v21, s27, v51
    s_add_u32 s28, s28, 16384
    s_mov_b32 m0, s28
    s_add_u32 s29, s25, 65536
    buffer_load_dwordx4 v1, s[8:11], s29 offen offset:0 lds
    v_mfma_f32_32x32x16_bf16 v[144:159], v[60:63], v[52:55], v[144:159]
    v_dot2c_f32_bf16 v23, v51, v51
    buffer_load_dwordx4 v1, s[8:11], s29 offen offset:1024 lds
    s_waitcnt lgkmcnt(0)
    v_mfma_f32_32x32x16_bf16 v[64:79], v[32:35], v[40:43], v[64:79]
    v_dot2c_f32_bf16 v20, s27, v32
    v_dot2c_f32_bf16 v22, v32, v32
    buffer_load_dwordx4 v1, s[8:11], s29 offen offset:2048 lds
    v_mfma_f32_32x32x16_bf16 v[96:111], v[32:35], v[44:47], v[96:111]
    ds_read_b128 v[48:51], v11 offset:0
    v_dot2c_f32_bf16 v21, s27, v33
    buffer_load_dwordx4 v1, s[8:11], s29 offen offset:3072 lds
    v_mfma_f32_32x32x16_bf16 v[128:143], v[44:47], v[32:35], v[128:143]
    ds_read_b128 v[52:55], v11 offset:4096
    v_dot2c_f32_bf16 v23, v33, v33
    s_bfe_u32 s41, s54, 524296
    s_mul_i32 s41, s41, s40
    s_add_u32 s42, s58, s41
    s_add_u32 s43, s59, s41
    buffer_load_dwordx4 a[136:139], v240, s[8:11], s42 offen
    v_mfma_f32_32x32x16_bf16 v[80:95], v[36:39], v[40:43], v[80:95]
    ds_read_b128 v[56:59], v5 offset:2048
    v_dot2c_f32_bf16 v20, s27, v34
    v_dot2c_f32_bf16 v22, v34, v34
    buffer_load_dwordx4 a[140:143], v241, s[8:11], s43 offen
    v_mfma_f32_32x32x16_bf16 v[112:127], v[36:39], v[44:47], v[112:127]
    ds_read_b128 v[60:63], v5 offset:3072
    v_dot2c_f32_bf16 v21, s27, v35
    s_bfe_u32 s41, s54, 524304
    s_mul_i32 s41, s41, s40
    s_add_u32 s42, s58, s41
    s_add_u32 s43, s59, s41
    buffer_load_dwordx4 a[144:147], v240, s[8:11], s42 offen
    v_mfma_f32_32x32x16_bf16 v[144:159], v[44:47], v[36:39], v[144:159]
    v_dot2c_f32_bf16 v23, v35, v35
    buffer_load_dwordx4 a[148:151], v241, s[8:11], s43 offen
    s_waitcnt lgkmcnt(0)
    v_mfma_f32_32x32x16_bf16 v[64:79], v[48:51], v[56:59], v[64:79]
    v_dot2c_f32_bf16 v20, s27, v48
    v_dot2c_f32_bf16 v22, v48, v48
    v_mfma_f32_32x32x16_bf16 v[96:111], v[48:51], v[60:63], v[96:111]
    ds_read_b128 v[32:35], v12 offset:0
    v_dot2c_f32_bf16 v21, s27, v49
    v_mfma_f32_32x32x16_bf16 v[128:143], v[60:63], v[48:51], v[128:143]
    ds_read_b128 v[36:39], v12 offset:4096
    v_dot2c_f32_bf16 v23, v49, v49
    v_mfma_f32_32x32x16_bf16 v[80:95], v[52:55], v[56:59], v[80:95]
    ds_read_b128 v[40:43], v5 offset:4096
    v_dot2c_f32_bf16 v20, s27, v50
    v_dot2c_f32_bf16 v22, v50, v50
    v_mfma_f32_32x32x16_bf16 v[112:127], v[52:55], v[60:63], v[112:127]
    ds_read_b128 v[44:47], v5 offset:5120
    v_dot2c_f32_bf16 v21, s27, v51
    v_mfma_f32_32x32x16_bf16 v[144:159], v[60:63], v[52:55], v[144:159]
    v_dot2c_f32_bf16 v23, v51, v51
    s_waitcnt lgkmcnt(0)
    v_mfma_f32_32x32x16_bf16 v[64:79], v[32:35], v[40:43], v[64:79]
    v_dot2c_f32_bf16 v20, s27, v32
    v_dot2c_f32_bf16 v22, v32, v32
    v_mfma_f32_32x32x16_bf16 v[96:111], v[32:35], v[44:47], v[96:111]
    ds_read_b128 v[48:51], v13 offset:0
    v_dot2c_f32_bf16 v21, s27, v33
    v_mfma_f32_32x32x16_bf16 v[128:143], v[44:47], v[32:35], v[128:143]
    ds_read_b128 v[52:55], v13 offset:4096
    v_dot2c_f32_bf16 v23, v33, v33
    v_mfma_f32_32x32x16_bf16 v[80:95], v[36:39], v[40:43], v[80:95]
    ds_read_b128 v[56:59], v5 offset:6144
    v_dot2c_f32_bf16 v20, s27, v34
    v_dot2c_f32_bf16 v22, v34, v34
    v_mfma_f32_32x32x16_bf16 v[112:127], v[36:39], v[44:47], v[112:127]
    ds_read_b128 v[60:63], v5 offset:7168
    v_dot2c_f32_bf16 v21, s27, v35
    v_mfma_f32_32x32x16_bf16 v[144:159], v[44:47], v[36:39], v[144:159]
    v_dot2c_f32_bf16 v23, v35, v35
    s_waitcnt vmcnt(16)
    s_barrier
    s_waitcnt lgkmcnt(0)
    v_mfma_f32_32x32x16_bf16 v[64:79], v[48:51], v[56:59], v[64:79]
    v_dot2c_f32_bf16 v20, s27, v48
    v_dot2c_f32_bf16 v22, v48, v48
    s_lshl_b32 s28, s13, 12
    s_add_u32 s28, s28, 32768
    s_mov_b32 m0, s28
    s_add_u32 s29, s24, 1152
    buffer_load_dwordx4 v2, s[16:19], s29 offen offset:0 lds
    v_mfma_f32_32x32x16_bf16 v[96:111], v[48:51], v[60:63], v[96:111]
    ds_read_b128 v[32:35], v10 offset:32768
    v_dot2c_f32_bf16 v21, s27, v49
    s_add_u32 s29, s29, 9216
    buffer_load_dwordx4 v3, s[16:19], s29 offen offset:1024 lds
    v_mfma_f32_32x32x16_bf16 v[128:143], v[60:63], v[48:51], v[128:143]
    ds_read_b128 v[36:39], v10 offset:36864
    v_dot2c_f32_bf16 v23, v49, v49
    s_add_u32 s29, s29, 9216
    buffer_load_dwordx4 v2, s[16:19], s29 offen offset:2048 lds
    v_mfma_f32_32x32x16_bf16 v[80:95], v[52:55], v[56:59], v[80:95]
    ds_read_b128 v[40:43], v5 offset:32768
    v_dot2c_f32_bf16 v20, s27, v50
    v_dot2c_f32_bf16 v22, v50, v50
    s_add_u32 s29, s29, 9216
    buffer_load_dwordx4 v3, s[16:19], s29 offen offset:3072 lds
    v_mfma_f32_32x32x16_bf16 v[112:127], v[52:55], v[60:63], v[112:127]
    ds_read_b128 v[44:47], v5 offset:33792
    v_dot2c_f32_bf16 v21, s27, v51
    s_add_u32 s28, s28, 16384
    s_mov_b32 m0, s28
    s_add_u32 s29, s25, 73728
    buffer_load_dwordx4 v1, s[8:11], s29 offen offset:0 lds
    v_mfma_f32_32x32x16_bf16 v[144:159], v[60:63], v[52:55], v[144:159]
    v_dot2c_f32_bf16 v23, v51, v51
    buffer_load_dwordx4 v1, s[8:11], s29 offen offset:1024 lds
    s_waitcnt lgkmcnt(0)
    v_mfma_f32_32x32x16_bf16 v[64:79], v[32:35], v[40:43], v[64:79]
    v_dot2c_f32_bf16 v20, s27, v32
    v_dot2c_f32_bf16 v22, v32, v32
    buffer_load_dwordx4 v1, s[8:11], s29 offen offset:2048 lds
    v_mfma_f32_32x32x16_bf16 v[96:111], v[32:35], v[44:47], v[96:111]
    ds_read_b128 v[48:51], v11 offset:32768
    v_dot2c_f32_bf16 v21, s27, v33
    buffer_load_dwordx4 v1, s[8:11], s29 offen offset:3072 lds
    v_mfma_f32_32x32x16_bf16 v[128:143], v[44:47], v[32:35], v[128:143]
    ds_read_b128 v[52:55], v11 offset:36864
    v_dot2c_f32_bf16 v23, v33, v33
    s_bfe_u32 s41, s54, 524312
    s_mul_i32 s41, s41, s40
    s_add_u32 s42, s58, s41
    s_add_u32 s43, s59, s41
    buffer_load_dwordx4 a[152:155], v240, s[8:11], s42 offen
    v_mfma_f32_32x32x16_bf16 v[80:95], v[36:39], v[40:43], v[80:95]
    ds_read_b128 v[56:59], v5 offset:34816
    v_dot2c_f32_bf16 v20, s27, v34
    v_dot2c_f32_bf16 v22, v34, v34
    buffer_load_dwordx4 a[156:159], v241, s[8:11], s43 offen
    v_mfma_f32_32x32x16_bf16 v[112:127], v[36:39], v[44:47], v[112:127]
    ds_read_b128 v[60:63], v5 offset:35840
    v_dot2c_f32_bf16 v21, s27, v35
    s_bfe_u32 s41, s55, 524288
    s_mul_i32 s41, s41, s40
    s_add_u32 s42, s58, s41
    s_add_u32 s43, s59, s41
    buffer_load_dwordx4 a[160:163], v240, s[8:11], s42 offen
    v_mfma_f32_32x32x16_bf16 v[144:159], v[44:47], v[36:39], v[144:159]
    v_dot2c_f32_bf16 v23, v35, v35
    buffer_load_dwordx4 a[164:167], v241, s[8:11], s43 offen
    s_waitcnt lgkmcnt(0)
    v_mfma_f32_32x32x16_bf16 v[64:79], v[48:51], v[56:59], v[64:79]
    v_dot2c_f32_bf16 v20, s27, v48
    v_dot2c_f32_bf16 v22, v48, v48
    v_mfma_f32_32x32x16_bf16 v[96:111], v[48:51], v[60:63], v[96:111]
    ds_read_b128 v[32:35], v12 offset:32768
    v_dot2c_f32_bf16 v21, s27, v49
    v_mfma_f32_32x32x16_bf16 v[128:143], v[60:63], v[48:51], v[128:143]
    ds_read_b128 v[36:39], v12 offset:36864
    v_dot2c_f32_bf16 v23, v49, v49
    v_mfma_f32_32x32x16_bf16 v[80:95], v[52:55], v[56:59], v[80:95]
    ds_read_b128 v[40:43], v5 offset:36864
    v_dot2c_f32_bf16 v20, s27, v50
    v_dot2c_f32_bf16 v22, v50, v50
    v_mfma_f32_32x32x16_bf16 v[112:127], v[52:55], v[60:63], v[112:127]
    ds_read_b128 v[44:47], v5 offset:37888
    v_dot2c_f32_bf16 v21, s27, v51
    v_mfma_f32_32x32x16_bf16 v[144:159], v[60:63], v[52:55], v[144:159]
    v_dot2c_f32_bf16 v23, v51, v51
    s_waitcnt lgkmcnt(0)
    v_mfma_f32_32x32x16_bf16 v[64:79], v[32:35], v[40:43], v[64:79]
    v_dot2c_f32_bf16 v20, s27, v32
    v_dot2c_f32_bf16 v22, v32, v32
    v_mfma_f32_32x32x16_bf16 v[96:111], v[32:35], v[44:47], v[96:111]
    ds_read_b128 v[48:51], v13 offset:32768
    v_dot2c_f32_bf16 v21, s27, v33
    v_mfma_f32_32x32x16_bf16 v[128:143], v[44:47], v[32:35], v[128:143]
    ds_read_b128 v[52:55], v13 offset:36864
    v_dot2c_f32_bf16 v23, v33, v33
    v_mfma_f32_32x32x16_bf16 v[80:95], v[36:39], v[40:43], v[80:95]
    ds_read_b128 v[56:59], v5 offset:38912
    v_dot2c_f32_bf16 v20, s27, v34
    v_dot2c_f32_bf16 v22, v34, v34
    v_mfma_f32_32x32x16_bf16 v[112:127], v[36:39], v[44:47], v[112:127]
    ds_read_b128 v[60:63], v5 offset:39936
    v_dot2c_f32_bf16 v21, s27, v35
    v_mfma_f32_32x32x16_bf16 v[144:159], v[44:47], v[36:39], v[144:159]
    v_dot2c_f32_bf16 v23, v35, v35
    s_waitcnt vmcnt(16)
    s_barrier
    s_waitcnt lgkmcnt(0)
    v_mfma_f32_32x32x16_bf16 v[64:79], v[48:51], v[56:59], v[64:79]
    v_dot2c_f32_bf16 v20, s27, v48
    v_dot2c_f32_bf16 v22, v48, v48
    s_bfe_u32 s41, s55, 524296
    s_mul_i32 s41, s41, s40
    s_add_u32 s42, s58, s41
    s_add_u32 s43, s59, s41
    buffer_load_dwordx4 a[168:171], v240, s[8:11], s42 offen
    v_mfma_f32_32x32x16_bf16 v[96:111], v[48:51], v[60:63], v[96:111]
    ds_read_b128 v[32:35], v6 offset:0
    v_dot2c_f32_bf16 v21, s27, v49
    buffer_load_dwordx4 a[172:175], v241, s[8:11], s43 offen
    v_mfma_f32_32x32x16_bf16 v[128:143], v[60:63], v[48:51], v[128:143]
    ds_read_b128 v[36:39], v6 offset:4096
    v_dot2c_f32_bf16 v23, v49, v49
    s_bfe_u32 s41, s55, 524304
    s_mul_i32 s41, s41, s40
    s_add_u32 s42, s58, s41
    s_add_u32 s43, s59, s41
    buffer_load_dwordx4 a[176:179], v240, s[8:11], s42 offen
    v_mfma_f32_32x32x16_bf16 v[80:95], v[52:55], v[56:59], v[80:95]
    ds_read_b128 v[40:43], v4 offset:0
    v_dot2c_f32_bf16 v20, s27, v50
    v_dot2c_f32_bf16 v22, v50, v50
    buffer_load_dwordx4 a[180:183], v241, s[8:11], s43 offen
    v_mfma_f32_32x32x16_bf16 v[112:127], v[52:55], v[60:63], v[112:127]
    ds_read_b128 v[44:47], v4 offset:1024
    v_dot2c_f32_bf16 v21, s27, v51
    s_bfe_u32 s41, s55, 524312
    s_mul_i32 s41, s41, s40
    s_add_u32 s42, s58, s41
    s_add_u32 s43, s59, s41
    buffer_load_dwordx4 a[184:187], v240, s[8:11], s42 offen
    v_mfma_f32_32x32x16_bf16 v[144:159], v[60:63], v[52:55], v[144:159]
    v_dot2c_f32_bf16 v23, v51, v51
    buffer_load_dwordx4 a[188:191], v241, s[8:11], s43 offen
    s_waitcnt lgkmcnt(0)
    v_mfma_f32_32x32x16_bf16 v[64:79], v[32:35], v[40:43], v[64:79]
    v_dot2c_f32_bf16 v20, s27, v32
    v_dot2c_f32_bf16 v22, v32, v32
    s_bfe_u32 s41, s56, 524288
    s_mul_i32 s41, s41, s40
    s_add_u32 s42, s58, s41
    s_add_u32 s43, s59, s41
    buffer_load_dwordx4 a[192:195], v240, s[8:11], s42 offen
    v_mfma_f32_32x32x16_bf16 v[96:111], v[32:35], v[44:47], v[96:111]
    ds_read_b128 v[48:51], v7 offset:0
    v_dot2c_f32_bf16 v21, s27, v33
    buffer_load_dwordx4 a[196:199], v241, s[8:11], s43 offen
    v_mfma_f32_32x32x16_bf16 v[128:143], v[44:47], v[32:35], v[128:143]
    ds_read_b128 v[52:55], v7 offset:4096
    v_dot2c_f32_bf16 v23, v33, v33
    v_mfma_f32_32x32x16_bf16 v[80:95], v[36:39], v[40:43], v[80:95]
    ds_read_b128 v[56:59], v4 offset:2048
    v_dot2c_f32_bf16 v20, s27, v34
    v_dot2c_f32_bf16 v22, v34, v34
    v_mfma_f32_32x32x16_bf16 v[112:127], v[36:39], v[44:47], v[112:127]
    ds_read_b128 v[60:63], v4 offset:3072
    v_dot2c_f32_bf16 v21, s27, v35
    v_mfma_f32_32x32x16_bf16 v[144:159], v[44:47], v[36:39], v[144:159]
    v_dot2c_f32_bf16 v23, v35, v35
    s_waitcnt lgkmcnt(0)
    v_mfma_f32_32x32x16_bf16 v[64:79], v[48:51], v[56:59], v[64:79]
    v_dot2c_f32_bf16 v20, s27, v48
    v_dot2c_f32_bf16 v22, v48, v48
    v_mfma_f32_32x32x16_bf16 v[96:111], v[48:51], v[60:63], v[96:111]
    ds_read_b128 v[32:35], v8 offset:0
    v_dot2c_f32_bf16 v21, s27, v49
    v_mfma_f32_32x32x16_bf16 v[128:143], v[60:63], v[48:51], v[128:143]
    ds_read_b128 v[36:39], v8 offset:4096
    v_dot2c_f32_bf16 v23, v49, v49
    v_mfma_f32_32x32x16_bf16 v[80:95], v[52:55], v[56:59], v[80:95]
    ds_read_b128 v[40:43], v4 offset:4096
    v_dot2c_f32_bf16 v20, s27, v50
    v_dot2c_f32_bf16 v22, v50, v50
    v_mfma_f32_32x32x16_bf16 v[112:127], v[52:55], v[60:63], v[112:127]
    ds_read_b128 v[44:47], v4 offset:5120
    v_dot2c_f32_bf16 v21, s27, v51
    v_mfma_f32_32x32x16_bf16 v[144:159], v[60:63], v[52:55], v[144:159]
    v_dot2c_f32_bf16 v23, v51, v51
    s_waitcnt lgkmcnt(0)
    v_mfma_f32_32x32x16_bf16 v[64:79], v[32:35], v[40:43], v[64:79]
    v_dot2c_f32_bf16 v20, s27, v32
    v_dot2c_f32_bf16 v22, v32, v32
    v_mfma_f32_32x32x16_bf16 v[96:111], v[32:35], v[44:47], v[96:111]
    ds_read_b128 v[48:51], v9 offset:0
    v_dot2c_f32_bf16 v21, s27, v33
    v_mfma_f32_32x32x16_bf16 v[128:143], v[44:47], v[32:35], v[128:143]
    ds_read_b128 v[52:55], v9 offset:4096
    v_dot2c_f32_bf16 v23, v33, v33
    v_mfma_f32_32x32x16_bf16 v[80:95], v[36:39], v[40:43], v[80:95]
    ds_read_b128 v[56:59], v4 offset:6144
    v_dot2c_f32_bf16 v20, s27, v34
    v_dot2c_f32_bf16 v22, v34, v34
    v_mfma_f32_32x32x16_bf16 v[112:127], v[36:39], v[44:47], v[112:127]
    ds_read_b128 v[60:63], v4 offset:7168
    v_dot2c_f32_bf16 v21, s27, v35
    v_mfma_f32_32x32x16_bf16 v[144:159], v[44:47], v[36:39], v[144:159]
    v_dot2c_f32_bf16 v23, v35, v35
    s_waitcnt vmcnt(12)
    s_barrier
    s_waitcnt lgkmcnt(0)
    v_mfma_f32_32x32x16_bf16 v[64:79], v[48:51], v[56:59], v[64:79]
    v_dot2c_f32_bf16 v20, s27, v48
    v_dot2c_f32_bf16 v22, v48, v48
    s_bfe_u32 s41, s56, 524296
    s_mul_i32 s41, s41, s40
    s_add_u32 s42, s58, s41
    s_add_u32 s43, s59, s41
    buffer_load_dwordx4 a[200:203], v240, s[8:11], s42 offen
    v_mfma_f32_32x32x16_bf16 v[96:111], v[48:51], v[60:63], v[96:111]
    ds_read_b128 v[32:35], v6 offset:32768
    v_dot2c_f32_bf16 v21, s27, v49
    buffer_load_dwordx4 a[204:207], v241, s[8:11], s43 offen
    v_mfma_f32_32x32x16_bf16 v[128:143], v[60:63], v[48:51], v[128:143]
    ds_read_b128 v[36:39], v6 offset:36864
    v_dot2c_f32_bf16 v23, v49, v49
    s_bfe_u32 s41, s56, 524304
    s_mul_i32 s41, s41, s40
    s_add_u32 s42, s58, s41
    s_add_u32 s43, s59, s41
    buffer_load_dwordx4 a[208:211], v240, s[8:11], s42 offen
    v_mfma_f32_32x32x16_bf16 v[80:95], v[52:55], v[56:59], v[80:95]
    ds_read_b128 v[40:43], v4 offset:32768
    v_dot2c_f32_bf16 v20, s27, v50
    v_dot2c_f32_bf16 v22, v50, v50
    buffer_load_dwordx4 a[212:215], v241, s[8:11], s43 offen
    v_mfma_f32_32x32x16_bf16 v[112:127], v[52:55], v[60:63], v[112:127]
    ds_read_b128 v[44:47], v4 offset:33792
    v_dot2c_f32_bf16 v21, s27, v51
    s_bfe_u32 s41, s56, 524312
    s_mul_i32 s41, s41, s40
    s_add_u32 s42, s58, s41
    s_add_u32 s43, s59, s41
    buffer_load_dwordx4 a[216:219], v240, s[8:11], s42 offen
    v_mfma_f32_32x32x16_bf16 v[144:159], v[60:63], v[52:55], v[144:159]
    v_dot2c_f32_bf16 v23, v51, v51
    buffer_load_dwordx4 a[220:223], v241, s[8:11], s43 offen
    s_waitcnt lgkmcnt(0)
    v_mfma_f32_32x32x16_bf16 v[64:79], v[32:35], v[40:43], v[64:79]
    v_dot2c_f32_bf16 v20, s27, v32
    v_dot2c_f32_bf16 v22, v32, v32
    s_bfe_u32 s41, s57, 524288
    s_mul_i32 s41, s41, s40
    s_add_u32 s42, s58, s41
    s_add_u32 s43, s59, s41
    buffer_load_dwordx4 a[224:227], v240, s[8:11], s42 offen
    v_mfma_f32_32x32x16_bf16 v[96:111], v[32:35], v[44:47], v[96:111]
    ds_read_b128 v[48:51], v7 offset:32768
    v_dot2c_f32_bf16 v21, s27, v33
    buffer_load_dwordx4 a[228:231], v241, s[8:11], s43 offen
    v_mfma_f32_32x32x16_bf16 v[128:143], v[44:47], v[32:35], v[128:143]
    ds_read_b128 v[52:55], v7 offset:36864
    v_dot2c_f32_bf16 v23, v33, v33
    v_mfma_f32_32x32x16_bf16 v[80:95], v[36:39], v[40:43], v[80:95]
    ds_read_b128 v[56:59], v4 offset:34816
    v_dot2c_f32_bf16 v20, s27, v34
    v_dot2c_f32_bf16 v22, v34, v34
    v_mfma_f32_32x32x16_bf16 v[112:127], v[36:39], v[44:47], v[112:127]
    ds_read_b128 v[60:63], v4 offset:35840
    v_dot2c_f32_bf16 v21, s27, v35
    v_mfma_f32_32x32x16_bf16 v[144:159], v[44:47], v[36:39], v[144:159]
    v_dot2c_f32_bf16 v23, v35, v35
    s_waitcnt lgkmcnt(0)
    v_mfma_f32_32x32x16_bf16 v[64:79], v[48:51], v[56:59], v[64:79]
    v_dot2c_f32_bf16 v20, s27, v48
    v_dot2c_f32_bf16 v22, v48, v48
    v_mfma_f32_32x32x16_bf16 v[96:111], v[48:51], v[60:63], v[96:111]
    ds_read_b128 v[32:35], v8 offset:32768
    v_dot2c_f32_bf16 v21, s27, v49
    v_mfma_f32_32x32x16_bf16 v[128:143], v[60:63], v[48:51], v[128:143]
    ds_read_b128 v[36:39], v8 offset:36864
    v_dot2c_f32_bf16 v23, v49, v49
    v_mfma_f32_32x32x16_bf16 v[80:95], v[52:55], v[56:59], v[80:95]
    ds_read_b128 v[40:43], v4 offset:36864
    v_dot2c_f32_bf16 v20, s27, v50
    v_dot2c_f32_bf16 v22, v50, v50
    v_mfma_f32_32x32x16_bf16 v[112:127], v[52:55], v[60:63], v[112:127]
    ds_read_b128 v[44:47], v4 offset:37888
    v_dot2c_f32_bf16 v21, s27, v51
    v_mfma_f32_32x32x16_bf16 v[144:159], v[60:63], v[52:55], v[144:159]
    v_dot2c_f32_bf16 v23, v51, v51
    s_waitcnt lgkmcnt(0)
    v_mfma_f32_32x32x16_bf16 v[64:79], v[32:35], v[40:43], v[64:79]
    v_dot2c_f32_bf16 v20, s27, v32
    v_dot2c_f32_bf16 v22, v32, v32
    v_mfma_f32_32x32x16_bf16 v[96:111], v[32:35], v[44:47], v[96:111]
    ds_read_b128 v[48:51], v9 offset:32768
    v_dot2c_f32_bf16 v21, s27, v33
    v_mfma_f32_32x32x16_bf16 v[128:143], v[44:47], v[32:35], v[128:143]
    ds_read_b128 v[52:55], v9 offset:36864
    v_dot2c_f32_bf16 v23, v33, v33
    v_mfma_f32_32x32x16_bf16 v[80:95], v[36:39], v[40:43], v[80:95]
    ds_read_b128 v[56:59], v4 offset:38912
    v_dot2c_f32_bf16 v20, s27, v34
    v_dot2c_f32_bf16 v22, v34, v34
    v_mfma_f32_32x32x16_bf16 v[112:127], v[36:39], v[44:47], v[112:127]
    ds_read_b128 v[60:63], v4 offset:39936
    v_dot2c_f32_bf16 v21, s27, v35
    v_mfma_f32_32x32x16_bf16 v[144:159], v[44:47], v[36:39], v[144:159]
    v_dot2c_f32_bf16 v23, v35, v35
    s_waitcnt lgkmcnt(0)
    v_mfma_f32_32x32x16_bf16 v[64:79], v[48:51], v[56:59], v[64:79]
    v_dot2c_f32_bf16 v20, s27, v48
    v_dot2c_f32_bf16 v22, v48, v48
    s_bfe_u32 s41, s57, 524296
    s_mul_i32 s41, s41, s40
    s_add_u32 s42, s58, s41
    s_add_u32 s43, s59, s41
    buffer_load_dwordx4 a[232:235], v240, s[8:11], s42 offen
    v_mfma_f32_32x32x16_bf16 v[96:111], v[48:51], v[60:63], v[96:111]
    v_dot2c_f32_bf16 v21, s27, v49
    buffer_load_dwordx4 a[236:239], v241, s[8:11], s43 offen
    v_mfma_f32_32x32x16_bf16 v[128:143], v[60:63], v[48:51], v[128:143]
    v_dot2c_f32_bf16 v23, v49, v49
    s_bfe_u32 s41, s57, 524304
    s_mul_i32 s41, s41, s40
    s_add_u32 s42, s58, s41
    s_add_u32 s43, s59, s41
    buffer_load_dwordx4 a[240:243], v240, s[8:11], s42 offen
    v_mfma_f32_32x32x16_bf16 v[80:95], v[52:55], v[56:59], v[80:95]
    v_dot2c_f32_bf16 v20, s27, v50
    v_dot2c_f32_bf16 v22, v50, v50
    buffer_load_dwordx4 a[244:247], v241, s[8:11], s43 offen
    v_mfma_f32_32x32x16_bf16 v[112:127], v[52:55], v[60:63], v[112:127]
    v_dot2c_f32_bf16 v21, s27, v51
    s_bfe_u32 s41, s57, 524312
    s_mul_i32 s41, s41, s40
    s_add_u32 s42, s58, s41
    s_add_u32 s43, s59, s41
    buffer_load_dwordx4 a[248:251], v240, s[8:11], s42 offen
    v_mfma_f32_32x32x16_bf16 v[144:159], v[60:63], v[52:55], v[144:159]
    v_dot2c_f32_bf16 v23, v51, v51
    buffer_load_dwordx4 a[252:255], v241, s[8:11], s43 offen
    s_branch layerb1_kernel_af_epi
layerb1_kernel_af_h1:
    s_waitcnt lgkmcnt(0)
    v_mfma_f32_32x32x16_bf16 v[64:79], v[32:35], v[40:43], 0
    v_dot2c_f32_bf16 v20, s27, v36
    v_dot2c_f32_bf16 v22, v36, v36
    v_mfma_f32_32x32x16_bf16 v[96:111], v[32:35], v[44:47], 0
    ds_read_b128 v[48:51], v7 offset:0
    v_dot2c_f32_bf16 v21, s27, v37
    v_mfma_f32_32x32x16_bf16 v[128:143], v[44:47], v[32:35], 0
    ds_read_b128 v[52:55], v7 offset:4096
    v_dot2c_f32_bf16 v23, v37, v37
    v_mfma_f32_32x32x16_bf16 v[80:95], v[36:39], v[40:43], 0
    ds_read_b128 v[56:59], v4 offset:2048
    v_dot2c_f32_bf16 v20, s27, v38
    v_dot2c_f32_bf16 v22, v38, v38
    v_mfma_f32_32x32x16_bf16 v[112:127], v[36:39], v[44:47], 0
    ds_read_b128 v[60:63], v4 offset:3072
    v_dot2c_f32_bf16 v21, s27, v39
    v_mfma_f32_32x32x16_bf16 v[144:159], v[44:47], v[36:39], 0
    v_dot2c_f32_bf16 v23, v39, v39
    s_waitcnt lgkmcnt(0)
    v_mfma_f32_32x32x16_bf16 v[64:79], v[48:51], v[56:59], v[64:79]
    v_dot2c_f32_bf16 v20, s27, v52
    v_dot2c_f32_bf16 v22, v52, v52
    v_mfma_f32_32x32x16_bf16 v[96:111], v[48:51], v[60:63], v[96:111]
    ds_read_b128 v[32:35], v8 offset:0
    v_dot2c_f32_bf16 v21, s27, v53
    v_mfma_f32_32x32x16_bf16 v[128:143], v[60:63], v[48:51], v[128:143]
    ds_read_b128 v[36:39], v8 offset:4096
    v_dot2c_f32_bf16 v23, v53, v53
    v_mfma_f32_32x32x16_bf16 v[80:95], v[52:55], v[56:59], v[80:95]
    ds_read_b128 v[40:43], v4 offset:4096
    v_dot2c_f32_bf16 v20, s27, v54
    v_dot2c_f32_bf16 v22, v54, v54
    v_mfma_f32_32x32x16_bf16 v[112:127], v[52:55], v[60:63], v[112:127]
    ds_read_b128 v[44:47], v4 offset:5120
    v_dot2c_f32_bf16 v21, s27, v55
    v_mfma_f32_32x32x16_bf16 v[144:159], v[60:63], v[52:55], v[144:159]
    v_dot2c_f32_bf16 v23, v55, v55
    s_waitcnt lgkmcnt(0)
    v_mfma_f32_32x32x16_bf16 v[64:79], v[32:35], v[40:43], v[64:79]
    v_dot2c_f32_bf16 v20, s27, v36
    v_dot2c_f32_bf16 v22, v36, v36
    v_mfma_f32_32x32x16_bf16 v[96:111], v[32:35], v[44:47], v[96:111]
    ds_read_b128 v[48:51], v9 offset:0
    v_dot2c_f32_bf16 v21, s27, v37
    v_mfma_f32_32x32x16_bf16 v[128:143], v[44:47], v[32:35], v[128:143]
    ds_read_b128 v[52:55], v9 offset:4096
    v_dot2c_f32_bf16 v23, v37, v37
    v_mfma_f32_32x32x16_bf16 v[80:95], v[36:39], v[40:43], v[80:95]
    ds_read_b128 v[56:59], v4 offset:6144
    v_dot2c_f32_bf16 v20, s27, v38
    v_dot2c_f32_bf16 v22, v38, v38
    v_mfma_f32_32x32x16_bf16 v[112:127], v[36:39], v[44:47], v[112:127]
    ds_read_b128 v[60:63], v4 offset:7168
    v_dot2c_f32_bf16 v21, s27, v39
    v_mfma_f32_32x32x16_bf16 v[144:159], v[44:47], v[36:39], v[144:159]
    v_dot2c_f32_bf16 v23, v39, v39
    s_waitcnt vmcnt(22)
    s_barrier
    s_waitcnt lgkmcnt(0)
    v_mfma_f32_32x32x16_bf16 v[64:79], v[48:51], v[56:59], v[64:79]
    v_dot2c_f32_bf16 v20, s27, v52
    v_dot2c_f32_bf16 v22, v52, v52
    s_lshl_b32 s28, s13, 12
    s_add_u32 s28, s28, 98304
    s_mov_b32 m0, s28
    s_add_u32 s29, s24, 384
    buffer_load_dwordx4 v2, s[16:19], s29 offen offset:0 lds
    v_mfma_f32_32x32x16_bf16 v[96:111], v[48:51], v[60:63], v[96:111]
    ds_read_b128 v[32:35], v6 offset:32768
    v_dot2c_f32_bf16 v21, s27, v53
    s_add_u32 s29, s29, 9216
    buffer_load_dwordx4 v3, s[16:19], s29 offen offset:1024 lds
    v_mfma_f32_32x32x16_bf16 v[128:143], v[60:63], v[48:51], v[128:143]
    ds_read_b128 v[36:39], v6 offset:36864
    v_dot2c_f32_bf16 v23, v53, v53
    s_add_u32 s29, s29, 9216
    buffer_load_dwordx4 v2, s[16:19], s29 offen offset:2048 lds
    v_mfma_f32_32x32x16_bf16 v[80:95], v[52:55], v[56:59], v[80:95]
    ds_read_b128 v[40:43], v4 offset:32768
    v_dot2c_f32_bf16 v20, s27, v54
    v_dot2c_f32_bf16 v22, v54, v54
    s_add_u32 s29, s29, 9216
    buffer_load_dwordx4 v3, s[16:19], s29 offen offset:3072 lds
    v_mfma_f32_32x32x16_bf16 v[112:127], v[52:55], v[60:63], v[112:127]
    ds_read_b128 v[44:47], v4 offset:33792
    v_dot2c_f32_bf16 v21, s27, v55
    s_add_u32 s28, s28, 16384
    s_mov_b32 m0, s28
    s_add_u32 s29, s25, 24576
    buffer_load_dwordx4 v1, s[8:11], s29 offen offset:0 lds
    v_mfma_f32_32x32x16_bf16 v[144:159], v[60:63], v[52:55], v[144:159]
    v_dot2c_f32_bf16 v23, v55, v55
    buffer_load_dwordx4 v1, s[8:11], s29 offen offset:1024 lds
    s_waitcnt lgkmcnt(0)
    v_mfma_f32_32x32x16_bf16 v[64:79], v[32:35], v[40:43], v[64:79]
    v_dot2c_f32_bf16 v20, s27, v36
    v_dot2c_f32_bf16 v22, v36, v36
    buffer_load_dwordx4 v1, s[8:11], s29 offen offset:2048 lds
    v_mfma_f32_32x32x16_bf16 v[96:111], v[32:35], v[44:47], v[96:111]
    ds_read_b128 v[48:51], v7 offset:32768
    v_dot2c_f32_bf16 v21, s27, v37
    buffer_load_dwordx4 v1, s[8:11], s29 offen offset:3072 lds
    v_mfma_f32_32x32x16_bf16 v[128:143], v[44:47], v[32:35], v[128:143]
    ds_read_b128 v[52:55], v7 offset:36864
    v_dot2c_f32_bf16 v23, v37, v37
    s_bfe_u32 s41, s51, 524312
    s_mul_i32 s41, s41, s40
    s_add_u32 s42, s58, s41
    s_add_u32 s43, s59, s41
    buffer_load_dwordx4 a[56:59], v240, s[8:11], s42 offen
    v_mfma_f32_32x32x16_bf16 v[80:95], v[36:39], v[40:43], v[80:95]
    ds_read_b128 v[56:59], v4 offset:34816
    v_dot2c_f32_bf16 v20, s27, v38
    v_dot2c_f32_bf16 v22, v38, v38
    buffer_load_dwordx4 a[60:63], v241, s[8:11], s43 offen
    v_mfma_f32_32x32x16_bf16 v[112:127], v[36:39], v[44:47], v[112:127]
    ds_read_b128 v[60:63], v4 offset:35840
    v_dot2c_f32_bf16 v21, s27, v39
    s_bfe_u32 s41, s52, 524288
    s_mul_i32 s41, s41, s40
    s_add_u32 s42, s58, s41
    s_add_u32 s43, s59, s41
    buffer_load_dwordx4 a[64:67], v240, s[8:11], s42 offen
    v_mfma_f32_32x32x16_bf16 v[144:159], v[44:47], v[36:39], v[144:159]
    v_dot2c_f32_bf16 v23, v39, v39
    buffer_load_dwordx4 a[68:71], v241, s[8:11], s43 offen
    s_waitcnt lgkmcnt(0)
    v_mfma_f32_32x32x16_bf16 v[64:79], v[48:51], v[56:59], v[64:79]
    v_dot2c_f32_bf16 v20, s27, v52
    v_dot2c_f32_bf16 v22, v52, v52
    v_mfma_f32_32x32x16_bf16 v[96:111], v[48:51], v[60:63], v[96:111]
    ds_read_b128 v[32:35], v8 offset:32768
    v_dot2c_f32_bf16 v21, s27, v53
    v_mfma_f32_32x32x16_bf16 v[128:143], v[60:63], v[48:51], v[128:143]
    ds_read_b128 v[36:39], v8 offset:36864
    v_dot2c_f32_bf16 v23, v53, v53
    v_mfma_f32_32x32x16_bf16 v[80:95], v[52:55], v[56:59], v[80:95]
    ds_read_b128 v[40:43], v4 offset:36864
    v_dot2c_f32_bf16 v20, s27, v54
    v_dot2c_f32_bf16 v22, v54, v54
    v_mfma_f32_32x32x16_bf16 v[112:127], v[52:55], v[60:63], v[112:127]
    ds_read_b128 v[44:47], v4 offset:37888
    v_dot2c_f32_bf16 v21, s27, v55
    v_mfma_f32_32x32x16_bf16 v[144:159], v[60:63], v[52:55], v[144:159]
    v_dot2c_f32_bf16 v23, v55, v55
    s_waitcnt lgkmcnt(0)
    v_mfma_f32_32x32x16_bf16 v[64:79], v[32:35], v[40:43], v[64:79]
    v_dot2c_f32_bf16 v20, s27, v36
    v_dot2c_f32_bf16 v22, v36, v36
    v_mfma_f32_32x32x16_bf16 v[96:111], v[32:35], v[44:47], v[96:111]
    ds_read_b128 v[48:51], v9 offset:32768
    v_dot2c_f32_bf16 v21, s27, v37
    v_mfma_f32_32x32x16_bf16 v[128:143], v[44:47], v[32:35], v[128:143]
    ds_read_b128 v[52:55], v9 offset:36864
    v_dot2c_f32_bf16 v23, v37, v37
    v_mfma_f32_32x32x16_bf16 v[80:95], v[36:39], v[40:43], v[80:95]
    ds_read_b128 v[56:59], v4 offset:38912
    v_dot2c_f32_bf16 v20, s27, v38
    v_dot2c_f32_bf16 v22, v38, v38
    v_mfma_f32_32x32x16_bf16 v[112:127], v[36:39], v[44:47], v[112:127]
    ds_read_b128 v[60:63], v4 offset:39936
    v_dot2c_f32_bf16 v21, s27, v39
    v_mfma_f32_32x32x16_bf16 v[144:159], v[44:47], v[36:39], v[144:159]
    v_dot2c_f32_bf16 v23, v39, v39
    s_waitcnt vmcnt(26)
    s_barrier
    s_waitcnt lgkmcnt(0)
    v_mfma_f32_32x32x16_bf16 v[64:79], v[48:51], v[56:59], v[64:79]
    v_dot2c_f32_bf16 v20, s27, v52
    v_dot2c_f32_bf16 v22, v52, v52
    s_lshl_b32 s28, s13, 12
    s_mov_b32 m0, s28
    s_add_u32 s29, s24, 512
    buffer_load_dwordx4 v2, s[16:19], s29 offen offset:0 lds
    v_mfma_f32_32x32x16_bf16 v[96:111], v[48:51], v[60:63], v[96:111]
    ds_read_b128 v[32:35], v10 offset:0
    v_dot2c_f32_bf16 v21, s27, v53
    s_add_u32 s29, s29, 9216
    buffer_load_dwordx4 v3, s[16:19], s29 offen offset:1024 lds
    v_mfma_f32_32x32x16_bf16 v[128:143], v[60:63], v[48:51], v[128:143]
    ds_read_b128 v[36:39], v10 offset:4096
    v_dot2c_f32_bf16 v23, v53, v53
    s_add_u32 s29, s29, 9216
    buffer_load_dwordx4 v2, s[16:19], s29 offen offset:2048 lds
    v_mfma_f32_32x32x16_bf16 v[80:95], v[52:55], v[56:59], v[80:95]
    ds_read_b128 v[40:43], v5 offset:0
    v_dot2c_f32_bf16 v20, s27, v54
    v_dot2c_f32_bf16 v22, v54, v54
    s_add_u32 s29, s29, 9216
    buffer_load_dwordx4 v3, s[16:19], s29 offen offset:3072 lds
    v_mfma_f32_32x32x16_bf16 v[112:127], v[52:55], v[60:63], v[112:127]
    ds_read_b128 v[44:47], v5 offset:1024
    v_dot2c_f32_bf16 v21, s27, v55
    s_add_u32 s28, s28, 16384
    s_mov_b32 m0, s28
    s_add_u32 s29, s25, 32768
    buffer_load_dwordx4 v1, s[8:11], s29 offen offset:0 lds
    v_mfma_f32_32x32x16_bf16 v[144:159], v[60:63], v[52:55], v[144:159]
    v_dot2c_f32_bf16 v23, v55, v55
    buffer_load_dwordx4 v1, s[8:11], s29 offen offset:1024 lds
    s_waitcnt lgkmcnt(0)
    v_mfma_f32_32x32x16_bf16 v[64:79], v[32:35], v[40:43], v[64:79]
    v_dot2c_f32_bf16 v20, s27, v36
    v_dot2c_f32_bf16 v22, v36, v36
    buffer_load_dwordx4 v1, s[8:11], s29 offen offset:2048 lds
    v_mfma_f32_32x32x16_bf16 v[96:111], v[32:35], v[44:47], v[96:111]
    ds_read_b128 v[48:51], v11 offset:0
    v_dot2c_f32_bf16 v21, s27, v37
    buffer_load_dwordx4 v1, s[8:11], s29 offen offset:3072 lds
    v_mfma_f32_32x32x16_bf16 v[128:143], v[44:47], v[32:35], v[128:143]
    ds_read_b128 v[52:55], v11 offset:4096
    v_dot2c_f32_bf16 v23, v37, v37
    s_bfe_u32 s41, s52, 524296
    s_mul_i32 s41, s41, s40
    s_add_u32 s42, s58, s41
    s_add_u32 s43, s59, s41
    buffer_load_dwordx4 a[72:75], v240, s[8:11], s42 offen
    v_mfma_f32_32x32x16_bf16 v[80:95], v[36:39], v[40:43], v[80:95]
    ds_read_b128 v[56:59], v5 offset:2048
    v_dot2c_f32_bf16 v20, s27, v38
    v_dot2c_f32_bf16 v22, v38, v38
    buffer_load_dwordx4 a[76:79], v241, s[8:11], s43 offen
    v_mfma_f32_32x32x16_bf16 v[112:127], v[36:39], v[44:47], v[112:127]
    ds_read_b128 v[60:63], v5 offset:3072
    v_dot2c_f32_bf16 v21, s27, v39
    s_bfe_u32 s41, s52, 524304
    s_mul_i32 s41, s41, s40
    s_add_u32 s42, s58, s41
    s_add_u32 s43, s59, s41
    buffer_load_dwordx4 a[80:83], v240, s[8:11], s42 offen
    v_mfma_f32_32x32x16_bf16 v[144:159], v[44:47], v[36:39], v[144:159]
    v_dot2c_f32_bf16 v23, v39, v39
    buffer_load_dwordx4 a[84:87], v241, s[8:11], s43 offen
    s_waitcnt lgkmcnt(0)
    v_mfma_f32_32x32x16_bf16 v[64:79], v[48:51], v[56:59], v[64:79]
    v_dot2c_f32_bf16 v20, s27, v52
    v_dot2c_f32_bf16 v22, v52, v52
    v_mfma_f32_32x32x16_bf16 v[96:111], v[48:51], v[60:63], v[96:111]
    ds_read_b128 v[32:35], v12 offset:0
    v_dot2c_f32_bf16 v21, s27, v53
    v_mfma_f32_32x32x16_bf16 v[128:143], v[60:63], v[48:51], v[128:143]
    ds_read_b128 v[36:39], v12 offset:4096
    v_dot2c_f32_bf16 v23, v53, v53
    v_mfma_f32_32x32x16_bf16 v[80:95], v[52:55], v[56:59], v[80:95]
    ds_read_b128 v[40:43], v5 offset:4096
    v_dot2c_f32_bf16 v20, s27, v54
    v_dot2c_f32_bf16 v22, v54, v54
    v_mfma_f32_32x32x16_bf16 v[112:127], v[52:55], v[60:63], v[112:127]
    ds_read_b128 v[44:47], v5 offset:5120
    v_dot2c_f32_bf16 v21, s27, v55
    v_mfma_f32_32x32x16_bf16 v[144:159], v[60:63], v[52:55], v[144:159]
    v_dot2c_f32_bf16 v23, v55, v55
    s_waitcnt lgkmcnt(0)
    v_mfma_f32_32x32x16_bf16 v[64:79], v[32:35], v[40:43], v[64:79]
    v_dot2c_f32_bf16 v20, s27, v36
    v_dot2c_f32_bf16 v22, v36, v36
    v_mfma_f32_32x32x16_bf16 v[96:111], v[32:35], v[44:47], v[96:111]
    ds_read_b128 v[48:51], v13 offset:0
    v_dot2c_f32_bf16 v21, s27, v37
    v_mfma_f32_32x32x16_bf16 v[128:143], v[44:47], v[32:35], v[128:143]
    ds_read_b128 v[52:55], v13 offset:4096
    v_dot2c_f32_bf16 v23, v37, v37
    v_mfma_f32_32x32x16_bf16 v[80:95], v[36:39], v[40:43], v[80:95]
    ds_read_b128 v[56:59], v5 offset:6144
    v_dot2c_f32_bf16 v20, s27, v38
    v_dot2c_f32_bf16 v22, v38, v38
    v_mfma_f32_32x32x16_bf16 v[112:127], v[36:39], v[44:47], v[112:127]
    ds_read_b128 v[60:63], v5 offset:7168
    v_dot2c_f32_bf16 v21, s27, v39
    v_mfma_f32_32x32x16_bf16 v[144:159], v[44:47], v[36:39], v[144:159]
    v_dot2c_f32_bf16 v23, v39, v39
    s_waitcnt vmcnt(16)
    s_barrier
    s_waitcnt lgkmcnt(0)
    v_mfma_f32_32x32x16_bf16 v[64:79], v[48:51], v[56:59], v[64:79]
    v_dot2c_f32_bf16 v20, s27, v52
    v_dot2c_f32_bf16 v22, v52, v52
    s_lshl_b32 s28, s13, 12
    s_add_u32 s28, s28, 32768
    s_mov_b32 m0, s28
    s_add_u32 s29, s24, 640
    buffer_load_dwordx4 v2, s[16:19], s29 offen offset:0 lds
    v_mfma_f32_32x32x16_bf16 v[96:111], v[48:51], v[60:63], v[96:111]
    ds_read_b128 v[32:35], v10 offset:32768
    v_dot2c_f32_bf16 v21, s27, v53
    s_add_u32 s29, s29, 9216
    buffer_load_dwordx4 v3, s[16:19], s29 offen offset:1024 lds
    v_mfma_f32_32x32x16_bf16 v[128:143], v[60:63], v[48:51], v[128:143]
    ds_read_b128 v[36:39], v10 offset:36864
    v_dot2c_f32_bf16 v23, v53, v53
    s_add_u32 s29, s29, 9216
    buffer_load_dwordx4 v2, s[16:19], s29 offen offset:2048 lds
    v_mfma_f32_32x32x16_bf16 v[80:95], v[52:55], v[56:59], v[80:95]
    ds_read_b128 v[40:43], v5 offset:32768
    v_dot2c_f32_bf16 v20, s27, v54
    v_dot2c_f32_bf16 v22, v54, v54
    s_add_u32 s29, s29, 9216
    buffer_load_dwordx4 v3, s[16:19], s29 offen offset:3072 lds
    v_mfma_f32_32x32x16_bf16 v[112:127], v[52:55], v[60:63], v[112:127]
    ds_read_b128 v[44:47], v5 offset:33792
    v_dot2c_f32_bf16 v21, s27, v55
    s_add_u32 s28, s28, 16384
    s_mov_b32 m0, s28
    s_add_u32 s29, s25, 40960
    buffer_load_dwordx4 v1, s[8:11], s29 offen offset:0 lds
    v_mfma_f32_32x32x16_bf16 v[144:159], v[60:63], v[52:55], v[144:159]
    v_dot2c_f32_bf16 v23, v55, v55
    buffer_load_dwordx4 v1, s[8:11], s29 offen offset:1024 lds
    s_waitcnt lgkmcnt(0)
    v_mfma_f32_32x32x16_bf16 v[64:79], v[32:35], v[40:43], v[64:79]
    v_dot2c_f32_bf16 v20, s27, v36
    v_dot2c_f32_bf16 v22, v36, v36
    buffer_load_dwordx4 v1, s[8:11], s29 offen offset:2048 lds
    v_mfma_f32_32x32x16_bf16 v[96:111], v[32:35], v[44:47], v[96:111]
    ds_read_b128 v[48:51], v11 offset:32768
    v_dot2c_f32_bf16 v21, s27, v37
    buffer_load_dwordx4 v1, s[8:11], s29 offen offset:3072 lds
    v_mfma_f32_32x32x16_bf16 v[128:143], v[44:47], v[32:35], v[128:143]
    ds_read_b128 v[52:55], v11 offset:36864
    v_dot2c_f32_bf16 v23, v37, v37
    s_bfe_u32 s41, s52, 524312
    s_mul_i32 s41, s41, s40
    s_add_u32 s42, s58, s41
    s_add_u32 s43, s59, s41
    buffer_load_dwordx4 a[88:91], v240, s[8:11], s42 offen
    v_mfma_f32_32x32x16_bf16 v[80:95], v[36:39], v[40:43], v[80:95]
    ds_read_b128 v[56:59], v5 offset:34816
    v_dot2c_f32_bf16 v20, s27, v38
    v_dot2c_f32_bf16 v22, v38, v38
    buffer_load_dwordx4 a[92:95], v241, s[8:11], s43 offen
    v_mfma_f32_32x32x16_bf16 v[112:127], v[36:39], v[44:47], v[112:127]
    ds_read_b128 v[60:63], v5 offset:35840
    v_dot2c_f32_bf16 v21, s27, v39
    s_bfe_u32 s41, s53, 524288
    s_mul_i32 s41, s41, s40
    s_add_u32 s42, s58, s41
    s_add_u32 s43, s59, s41
    buffer_load_dwordx4 a[96:99], v240, s[8:11], s42 offen
    v_mfma_f32_32x32x16_bf16 v[144:159], v[44:47], v[36:39], v[144:159]
    v_dot2c_f32_bf16 v23, v39, v39
    buffer_load_dwordx4 a[100:103], v241, s[8:11], s43 offen
    s_waitcnt lgkmcnt(0)
    v_mfma_f32_32x32x16_bf16 v[64:79], v[48:51], v[56:59], v[64:79]
    v_dot2c_f32_bf16 v20, s27, v52
    v_dot2c_f32_bf16 v22, v52, v52
    v_mfma_f32_32x32x16_bf16 v[96:111], v[48:51], v[60:63], v[96:111]
    ds_read_b128 v[32:35], v12 offset:32768
    v_dot2c_f32_bf16 v21, s27, v53
    v_mfma_f32_32x32x16_bf16 v[128:143], v[60:63], v[48:51], v[128:143]
    ds_read_b128 v[36:39], v12 offset:36864
    v_dot2c_f32_bf16 v23, v53, v53
    v_mfma_f32_32x32x16_bf16 v[80:95], v[52:55], v[56:59], v[80:95]
    ds_read_b128 v[40:43], v5 offset:36864
    v_dot2c_f32_bf16 v20, s27, v54
    v_dot2c_f32_bf16 v22, v54, v54
    v_mfma_f32_32x32x16_bf16 v[112:127], v[52:55], v[60:63], v[112:127]
    ds_read_b128 v[44:47], v5 offset:37888
    v_dot2c_f32_bf16 v21, s27, v55
    v_mfma_f32_32x32x16_bf16 v[144:159], v[60:63], v[52:55], v[144:159]
    v_dot2c_f32_bf16 v23, v55, v55
    s_waitcnt lgkmcnt(0)
    v_mfma_f32_32x32x16_bf16 v[64:79], v[32:35], v[40:43], v[64:79]
    v_dot2c_f32_bf16 v20, s27, v36
    v_dot2c_f32_bf16 v22, v36, v36
    v_mfma_f32_32x32x16_bf16 v[96:111], v[32:35], v[44:47], v[96:111]
    ds_read_b128 v[48:51], v13 offset:32768
    v_dot2c_f32_bf16 v21, s27, v37
    v_mfma_f32_32x32x16_bf16 v[128:143], v[44:47], v[32:35], v[128:143]
    ds_read_b128 v[52:55], v13 offset:36864
    v_dot2c_f32_bf16 v23, v37, v37
    v_mfma_f32_32x32x16_bf16 v[80:95], v[36:39], v[40:43], v[80:95]
    ds_read_b128 v[56:59], v5 offset:38912
    v_dot2c_f32_bf16 v20, s27, v38
    v_dot2c_f32_bf16 v22, v38, v38
    v_mfma_f32_32x32x16_bf16 v[112:127], v[36:39], v[44:47], v[112:127]
    ds_read_b128 v[60:63], v5 offset:39936
    v_dot2c_f32_bf16 v21, s27, v39
    v_mfma_f32_32x32x16_bf16 v[144:159], v[44:47], v[36:39], v[144:159]
    v_dot2c_f32_bf16 v23, v39, v39
    s_waitcnt vmcnt(16)
    s_barrier
    s_waitcnt lgkmcnt(0)
    v_mfma_f32_32x32x16_bf16 v[64:79], v[48:51], v[56:59], v[64:79]
    v_dot2c_f32_bf16 v20, s27, v52
    v_dot2c_f32_bf16 v22, v52, v52
    s_lshl_b32 s28, s13, 12
    s_add_u32 s28, s28, 65536
    s_mov_b32 m0, s28
    s_add_u32 s29, s24, 768
    buffer_load_dwordx4 v2, s[16:19], s29 offen offset:0 lds
    v_mfma_f32_32x32x16_bf16 v[96:111], v[48:51], v[60:63], v[96:111]
    ds_read_b128 v[32:35], v6 offset:0
    v_dot2c_f32_bf16 v21, s27, v53
    s_add_u32 s29, s29, 9216
    buffer_load_dwordx4 v3, s[16:19], s29 offen offset:1024 lds
    v_mfma_f32_32x32x16_bf16 v[128:143], v[60:63], v[48:51], v[128:143]
    ds_read_b128 v[36:39], v6 offset:4096
    v_dot2c_f32_bf16 v23, v53, v53
    s_add_u32 s29, s29, 9216
    buffer_load_dwordx4 v2, s[16:19], s29 offen offset:2048 lds
    v_mfma_f32_32x32x16_bf16 v[80:95], v[52:55], v[56:59], v[80:95]
    ds_read_b128 v[40:43], v4 offset:0
    v_dot2c_f32_bf16 v20, s27, v54
    v_dot2c_f32_bf16 v22, v54, v54
    s_add_u32 s29, s29, 9216
    buffer_load_dwordx4 v3, s[16:19], s29 offen offset:3072 lds
    v_mfma_f32_32x32x16_bf16 v[112:127], v[52:55], v[60:63], v[112:127]
    ds_read_b128 v[44:47], v4 offset:1024
    v_dot2c_f32_bf16 v21, s27, v55
    s_add_u32 s28, s28, 16384
    s_mov_b32 m0, s28
    s_add_u32 s29, s25, 49152
    buffer_load_dwordx4 v1, s[8:11], s29 offen offset:0 lds
    v_mfma_f32_32x32x16_bf16 v[144:159], v[60:63], v[52:55], v[144:159]
    v_dot2c_f32_bf16 v23, v55, v55
    buffer_load_dwordx4 v1, s[8:11], s29 offen offset:1024 lds
    s_waitcnt lgkmcnt(0)
    v_mfma_f32_32x32x16_bf16 v[64:79], v[32:35], v[40:43], v[64:79]
    v_dot2c_f32_bf16 v20, s27, v36
    v_dot2c_f32_bf16 v22, v36, v36
    buffer_load_dwordx4 v1, s[8:11], s29 offen offset:2048 lds
    v_mfma_f32_32x32x16_bf16 v[96:111], v[32:35], v[44:47], v[96:111]
    ds_read_b128 v[48:51], v7 offset:0
    v_dot2c_f32_bf16 v21, s27, v37
    buffer_load_dwordx4 v1, s[8:11], s29 offen offset:3072 lds
    v_mfma_f32_32x32x16_bf16 v[128:143], v[44:47], v[32:35], v[128:143]
    ds_read_b128 v[52:55], v7 offset:4096
    v_dot2c_f32_bf16 v23, v37, v37
    s_bfe_u32 s41, s53, 524296
    s_mul_i32 s41, s41, s40
    s_add_u32 s42, s58, s41
    s_add_u32 s43, s59, s41
    buffer_load_dwordx4 a[104:107], v240, s[8:11], s42 offen
    v_mfma_f32_32x32x16_bf16 v[80:95], v[36:39], v[40:43], v[80:95]
    ds_read_b128 v[56:59], v4 offset:2048
    v_dot2c_f32_bf16 v20, s27, v38
    v_dot2c_f32_bf16 v22, v38, v38
    buffer_load_dwordx4 a[108:111], v241, s[8:11], s43 offen
    v_mfma_f32_32x32x16_bf16 v[112:127], v[36:39], v[44:47], v[112:127]
    ds_read_b128 v[60:63], v4 offset:3072
    v_dot2c_f32_bf16 v21, s27, v39
    s_bfe_u32 s41, s53, 524304
    s_mul_i32 s41, s41, s40
    s_add_u32 s42, s58, s41
    s_add_u32 s43, s59, s41
    buffer_load_dwordx4 a[112:115], v240, s[8:11], s42 offen
    v_mfma_f32_32x32x16_bf16 v[144:159], v[44:47], v[36:39], v[144:159]
    v_dot2c_f32_bf16 v23, v39, v39
    buffer_load_dwordx4 a[116:119], v241, s[8:11], s43 offen
    s_waitcnt lgkmcnt(0)
    v_mfma_f32_32x32x16_bf16 v[64:79], v[48:51], v[56:59], v[64:79]
    v_dot2c_f32_bf16 v20, s27, v52
    v_dot2c_f32_bf16 v22, v52, v52
    v_mfma_f32_32x32x16_bf16 v[96:111], v[48:51], v[60:63], v[96:111]
    ds_read_b128 v[32:35], v8 offset:0
    v_dot2c_f32_bf16 v21, s27, v53
    v_mfma_f32_32x32x16_bf16 v[128:143], v[60:63], v[48:51], v[128:143]
    ds_read_b128 v[36:39], v8 offset:4096
    v_dot2c_f32_bf16 v23, v53, v53
    v_mfma_f32_32x32x16_bf16 v[80:95], v[52:55], v[56:59], v[80:95]
    ds_read_b128 v[40:43], v4 offset:4096
    v_dot2c_f32_bf16 v20, s27, v54
    v_dot2c_f32_bf16 v22, v54, v54
    v_mfma_f32_32x32x16_bf16 v[112:127], v[52:55], v[60:63], v[112:127]
    ds_read_b128 v[44:47], v4 offset:5120
    v_dot2c_f32_bf16 v21, s27, v55
    v_mfma_f32_32x32x16_bf16 v[144:159], v[60:63], v[52:55], v[144:159]
    v_dot2c_f32_bf16 v23, v55, v55
    s_waitcnt lgkmcnt(0)
    v_mfma_f32_32x32x16_bf16 v[64:79], v[32:35], v[40:43], v[64:79]
    v_dot2c_f32_bf16 v20, s27, v36
    v_dot2c_f32_bf16 v22, v36, v36
    v_mfma_f32_32x32x16_bf16 v[96:111], v[32:35], v[44:47], v[96:111]
    ds_read_b128 v[48:51], v9 offset:0
    v_dot2c_f32_bf16 v21, s27, v37
    v_mfma_f32_32x32x16_bf16 v[128:143], v[44:47], v[32:35], v[128:143]
    ds_read_b128 v[52:55], v9 offset:4096
    v_dot2c_f32_bf16 v23, v37, v37
    v_mfma_f32_32x32x16_bf16 v[80:95], v[36:39], v[40:43], v[80:95]
    ds_read_b128 v[56:59], v4 offset:6144
    v_dot2c_f32_bf16 v20, s27, v38
    v_dot2c_f32_bf16 v22, v38, v38
    v_mfma_f32_32x32x16_bf16 v[112:127], v[36:39], v[44:47], v[112:127]
    ds_read_b128 v[60:63], v4 offset:7168
    v_dot2c_f32_bf16 v21, s27, v39
    v_mfma_f32_32x32x16_bf16 v[144:159], v[44:47], v[36:39], v[144:159]
    v_dot2c_f32_bf16 v23, v39, v39
    s_waitcnt vmcnt(16)
    s_barrier
    s_waitcnt lgkmcnt(0)
    v_mfma_f32_32x32x16_bf16 v[64:79], v[48:51], v[56:59], v[64:79]
    v_dot2c_f32_bf16 v20, s27, v52
    v_dot2c_f32_bf16 v22, v52, v52
    s_lshl_b32 s28, s13, 12
    s_add_u32 s28, s28, 98304
    s_mov_b32 m0, s28
    s_add_u32 s29, s24, 896
    buffer_load_dwordx4 v2, s[16:19], s29 offen offset:0 lds
    v_mfma_f32_32x32x16_bf16 v[96:111], v[48:51], v[60:63], v[96:111]
    ds_read_b128 v[32:35], v6 offset:32768
    v_dot2c_f32_bf16 v21, s27, v53
    s_add_u32 s29, s29, 9216
    buffer_load_dwordx4 v3, s[16:19], s29 offen offset:1024 lds
    v_mfma_f32_32x32x16_bf16 v[128:143], v[60:63], v[48:51], v[128:143]
    ds_read_b128 v[36:39], v6 offset:36864
    v_dot2c_f32_bf16 v23, v53, v53
    s_add_u32 s29, s29, 9216
    buffer_load_dwordx4 v2, s[16:19], s29 offen offset:2048 lds
    v_mfma_f32_32x32x16_bf16 v[80:95], v[52:55], v[56:59], v[80:95]
    ds_read_b128 v[40:43], v4 offset:32768
    v_dot2c_f32_bf16 v20, s27, v54
    v_dot2c_f32_bf16 v22, v54, v54
    s_add_u32 s29, s29, 9216
    buffer_load_dwordx4 v3, s[16:19], s29 offen offset:3072 lds
    v_mfma_f32_32x32x16_bf16 v[112:127], v[52:55], v[60:63], v[112:127]
    ds_read_b128 v[44:47], v4 offset:33792
    v_dot2c_f32_bf16 v21, s27, v55
    s_add_u32 s28, s28, 16384
    s_mov_b32 m0, s28
    s_add_u32 s29, s25, 57344
    buffer_load_dwordx4 v1, s[8:11], s29 offen offset:0 lds
    v_mfma_f32_32x32x16_bf16 v[144:159], v[60:63], v[52:55], v[144:159]
    v_dot2c_f32_bf16 v23, v55, v55
    buffer_load_dwordx4 v1, s[8:11], s29 offen offset:1024 lds
    s_waitcnt lgkmcnt(0)
    v_mfma_f32_32x32x16_bf16 v[64:79], v[32:35], v[40:43], v[64:79]
    v_dot2c_f32_bf16 v20, s27, v36
    v_dot2c_f32_bf16 v22, v36, v36
    buffer_load_dwordx4 v1, s[8:11], s29 offen offset:2048 lds
    v_mfma_f32_32x32x16_bf16 v[96:111], v[32:35], v[44:47], v[96:111]
    ds_read_b128 v[48:51], v7 offset:32768
    v_dot2c_f32_bf16 v21, s27, v37
    buffer_load_dwordx4 v1, s[8:11], s29 offen offset:3072 lds
    v_mfma_f32_32x32x16_bf16 v[128:143], v[44:47], v[32:35], v[128:143]
    ds_read_b128 v[52:55], v7 offset:36864
    v_dot2c_f32_bf16 v23, v37, v37
    s_bfe_u32 s41, s53, 524312
    s_mul_i32 s41, s41, s40
    s_add_u32 s42, s58, s41
    s_add_u32 s43, s59, s41
    buffer_load_dwordx4 a[120:123], v240, s[8:11], s42 offen
    v_mfma_f32_32x32x16_bf16 v[80:95], v[36:39], v[40:43], v[80:95]
    ds_read_b128 v[56:59], v4 offset:34816
    v_dot2c_f32_bf16 v20, s27, v38
    v_dot2c_f32_bf16 v22, v38, v38
    buffer_load_dwordx4 a[124:127], v241, s[8:11], s43 offen
    v_mfma_f32_32x32x16_bf16 v[112:127], v[36:39], v[44:47], v[112:127]
    ds_read_b128 v[60:63], v4 offset:35840
    v_dot2c_f32_bf16 v21, s27, v39
    s_bfe_u32 s41, s54, 524288
    s_mul_i32 s41, s41, s40
    s_add_u32 s42, s58, s41
    s_add_u32 s43, s59, s41
    buffer_load_dwordx4 a[128:131], v240, s[8:11], s42 offen
    v_mfma_f32_32x32x16_bf16 v[144:159], v[44:47], v[36:39], v[144:159]
    v_dot2c_f32_bf16 v23, v39, v39
    buffer_load_dwordx4 a[132:135], v241, s[8:11], s43 offen
    s_waitcnt lgkmcnt(0)
    v_mfma_f32_32x32x16_bf16 v[64:79], v[48:51], v[56:59], v[64:79]
    v_dot2c_f32_bf16 v20, s27, v52
    v_dot2c_f32_bf16 v22, v52, v52
    v_mfma_f32_32x32x16_bf16 v[96:111], v[48:51], v[60:63], v[96:111]
    ds_read_b128 v[32:35], v8 offset:32768
    v_dot2c_f32_bf16 v21, s27, v53
    v_mfma_f32_32x32x16_bf16 v[128:143], v[60:63], v[48:51], v[128:143]
    ds_read_b128 v[36:39], v8 offset:36864
    v_dot2c_f32_bf16 v23, v53, v53
    v_mfma_f32_32x32x16_bf16 v[80:95], v[52:55], v[56:59], v[80:95]
    ds_read_b128 v[40:43], v4 offset:36864
    v_dot2c_f32_bf16 v20, s27, v54
    v_dot2c_f32_bf16 v22, v54, v54
    v_mfma_f32_32x32x16_bf16 v[112:127], v[52:55], v[60:63], v[112:127]
    ds_read_b128 v[44:47], v4 offset:37888
    v_dot2c_f32_bf16 v21, s27, v55
    v_mfma_f32_32x32x16_bf16 v[144:159], v[60:63], v[52:55], v[144:159]
    v_dot2c_f32_bf16 v23, v55, v55
    s_waitcnt lgkmcnt(0)
    v_mfma_f32_32x32x16_bf16 v[64:79], v[32:35], v[40:43], v[64:79]
    v_dot2c_f32_bf16 v20, s27, v36
    v_dot2c_f32_bf16 v22, v36, v36
    v_mfma_f32_32x32x16_bf16 v[96:111], v[32:35], v[44:47], v[96:111]
    ds_read_b128 v[48:51], v9 offset:32768
    v_dot2c_f32_bf16 v21, s27, v37
    v_mfma_f32_32x32x16_bf16 v[128:143], v[44:47], v[32:35], v[128:143]
    ds_read_b128 v[52:55], v9 offset:36864
    v_dot2c_f32_bf16 v23, v37, v37
    v_mfma_f32_32x32x16_bf16 v[80:95], v[36:39], v[40:43], v[80:95]
    ds_read_b128 v[56:59], v4 offset:38912
    v_dot2c_f32_bf16 v20, s27, v38
    v_dot2c_f32_bf16 v22, v38, v38
    v_mfma_f32_32x32x16_bf16 v[112:127], v[36:39], v[44:47], v[112:127]
    ds_read_b128 v[60:63], v4 offset:39936
    v_dot2c_f32_bf16 v21, s27, v39
    v_mfma_f32_32x32x16_bf16 v[144:159], v[44:47], v[36:39], v[144:159]
    v_dot2c_f32_bf16 v23, v39, v39
    s_waitcnt vmcnt(16)
    s_barrier
    s_waitcnt lgkmcnt(0)
    v_mfma_f32_32x32x16_bf16 v[64:79], v[48:51], v[56:59], v[64:79]
    v_dot2c_f32_bf16 v20, s27, v52
    v_dot2c_f32_bf16 v22, v52, v52
    s_lshl_b32 s28, s13, 12
    s_mov_b32 m0, s28
    s_add_u32 s29, s24, 1024
    buffer_load_dwordx4 v2, s[16:19], s29 offen offset:0 lds
    v_mfma_f32_32x32x16_bf16 v[96:111], v[48:51], v[60:63], v[96:111]
    ds_read_b128 v[32:35], v10 offset:0
    v_dot2c_f32_bf16 v21, s27, v53
    s_add_u32 s29, s29, 9216
    buffer_load_dwordx4 v3, s[16:19], s29 offen offset:1024 lds
    v_mfma_f32_32x32x16_bf16 v[128:143], v[60:63], v[48:51], v[128:143]
    ds_read_b128 v[36:39], v10 offset:4096
    v_dot2c_f32_bf16 v23, v53, v53
    s_add_u32 s29, s29, 9216
    buffer_load_dwordx4 v2, s[16:19], s29 offen offset:2048 lds
    v_mfma_f32_32x32x16_bf16 v[80:95], v[52:55], v[56:59], v[80:95]
    ds_read_b128 v[40:43], v5 offset:0
    v_dot2c_f32_bf16 v20, s27, v54
    v_dot2c_f32_bf16 v22, v54, v54
    s_add_u32 s29, s29, 9216
    buffer_load_dwordx4 v3, s[16:19], s29 offen offset:3072 lds
    v_mfma_f32_32x32x16_bf16 v[112:127], v[52:55], v[60:63], v[112:127]
    ds_read_b128 v[44:47], v5 offset:1024
    v_dot2c_f32_bf16 v21, s27, v55
    s_add_u32 s28, s28, 16384
    s_mov_b32 m0, s28
    s_add_u32 s29, s25, 65536
    buffer_load_dwordx4 v1, s[8:11], s29 offen offset:0 lds
    v_mfma_f32_32x32x16_bf16 v[144:159], v[60:63], v[52:55], v[144:159]
    v_dot2c_f32_bf16 v23, v55, v55
    buffer_load_dwordx4 v1, s[8:11], s29 offen offset:1024 lds
    s_waitcnt lgkmcnt(0)
    v_mfma_f32_32x32x16_bf16 v[64:79], v[32:35], v[40:43], v[64:79]
    v_dot2c_f32_bf16 v20, s27, v36
    v_dot2c_f32_bf16 v22, v36, v36
    buffer_load_dwordx4 v1, s[8:11], s29 offen offset:2048 lds
    v_mfma_f32_32x32x16_bf16 v[96:111], v[32:35], v[44:47], v[96:111]
    ds_read_b128 v[48:51], v11 offset:0
    v_dot2c_f32_bf16 v21, s27, v37
    buffer_load_dwordx4 v1, s[8:11], s29 offen offset:3072 lds
    v_mfma_f32_32x32x16_bf16 v[128:143], v[44:47], v[32:35], v[128:143]
    ds_read_b128 v[52:55], v11 offset:4096
    v_dot2c_f32_bf16 v23, v37, v37
    s_bfe_u32 s41, s54, 524296
    s_mul_i32 s41, s41, s40
    s_add_u32 s42, s58, s41
    s_add_u32 s43, s59, s41
    buffer_load_dwordx4 a[136:139], v240, s[8:11], s42 offen
    v_mfma_f32_32x32x16_bf16 v[80:95], v[36:39], v[40:43], v[80:95]
    ds_read_b128 v[56:59], v5 offset:2048
    v_dot2c_f32_bf16 v20, s27, v38
    v_dot2c_f32_bf16 v22, v38, v38
    buffer_load_dwordx4 a[140:143], v241, s[8:11], s43 offen
    v_mfma_f32_32x32x16_bf16 v[112:127], v[36:39], v[44:47], v[112:127]
    ds_read_b128 v[60:63], v5 offset:3072
    v_dot2c_f32_bf16 v21, s27, v39
    s_bfe_u32 s41, s54, 524304
    s_mul_i32 s41, s41, s40
    s_add_u32 s42, s58, s41
    s_add_u32 s43, s59, s41
    buffer_load_dwordx4 a[144:147], v240, s[8:11], s42 offen
    v_mfma_f32_32x32x16_bf16 v[144:159], v[44:47], v[36:39], v[144:159]
    v_dot2c_f32_bf16 v23, v39, v39
    buffer_load_dwordx4 a[148:151], v241, s[8:11], s43 offen
    s_waitcnt lgkmcnt(0)
    v_mfma_f32_32x32x16_bf16 v[64:79], v[48:51], v[56:59], v[64:79]
    v_dot2c_f32_bf16 v20, s27, v52
    v_dot2c_f32_bf16 v22, v52, v52
    v_mfma_f32_32x32x16_bf16 v[96:111], v[48:51], v[60:63], v[96:111]
    ds_read_b128 v[32:35], v12 offset:0
    v_dot2c_f32_bf16 v21, s27, v53
    v_mfma_f32_32x32x16_bf16 v[128:143], v[60:63], v[48:51], v[128:143]
    ds_read_b128 v[36:39], v12 offset:4096
    v_dot2c_f32_bf16 v23, v53, v53
    v_mfma_f32_32x32x16_bf16 v[80:95], v[52:55], v[56:59], v[80:95]
    ds_read_b128 v[40:43], v5 offset:4096
    v_dot2c_f32_bf16 v20, s27, v54
    v_dot2c_f32_bf16 v22, v54, v54
    v_mfma_f32_32x32x16_bf16 v[112:127], v[52:55], v[60:63], v[112:127]
    ds_read_b128 v[44:47], v5 offset:5120
    v_dot2c_f32_bf16 v21, s27, v55
    v_mfma_f32_32x32x16_bf16 v[144:159], v[60:63], v[52:55], v[144:159]
    v_dot2c_f32_bf16 v23, v55, v55
    s_waitcnt lgkmcnt(0)
    v_mfma_f32_32x32x16_bf16 v[64:79], v[32:35], v[40:43], v[64:79]
    v_dot2c_f32_bf16 v20, s27, v36
    v_dot2c_f32_bf16 v22, v36, v36
    v_mfma_f32_32x32x16_bf16 v[96:111], v[32:35], v[44:47], v[96:111]
    ds_read_b128 v[48:51], v13 offset:0
    v_dot2c_f32_bf16 v21, s27, v37
    v_mfma_f32_32x32x16_bf16 v[128:143], v[44:47], v[32:35], v[128:143]
    ds_read_b128 v[52:55], v13 offset:4096
    v_dot2c_f32_bf16 v23, v37, v37
    v_mfma_f32_32x32x16_bf16 v[80:95], v[36:39], v[40:43], v[80:95]
    ds_read_b128 v[56:59], v5 offset:6144
    v_dot2c_f32_bf16 v20, s27, v38
    v_dot2c_f32_bf16 v22, v38, v38
    v_mfma_f32_32x32x16_bf16 v[112:127], v[36:39], v[44:47], v[112:127]
    ds_read_b128 v[60:63], v5 offset:7168
    v_dot2c_f32_bf16 v21, s27, v39
    v_mfma_f32_32x32x16_bf16 v[144:159], v[44:47], v[36:39], v[144:159]
    v_dot2c_f32_bf16 v23, v39, v39
    s_waitcnt vmcnt(16)
    s_barrier
    s_waitcnt lgkmcnt(0)
    v_mfma_f32_32x32x16_bf16 v[64:79], v[48:51], v[56:59], v[64:79]
    v_dot2c_f32_bf16 v20, s27, v52
    v_dot2c_f32_bf16 v22, v52, v52
    s_lshl_b32 s28, s13, 12
    s_add_u32 s28, s28, 32768
    s_mov_b32 m0, s28
    s_add_u32 s29, s24, 1152
    buffer_load_dwordx4 v2, s[16:19], s29 offen offset:0 lds
    v_mfma_f32_32x32x16_bf16 v[96:111], v[48:51], v[60:63], v[96:111]
    ds_read_b128 v[32:35], v10 offset:32768
    v_dot2c_f32_bf16 v21, s27, v53
    s_add_u32 s29, s29, 9216
    buffer_load_dwordx4 v3, s[16:19], s29 offen offset:1024 lds
    v_mfma_f32_32x32x16_bf16 v[128:143], v[60:63], v[48:51], v[128:143]
    ds_read_b128 v[36:39], v10 offset:36864
    v_dot2c_f32_bf16 v23, v53, v53
    s_add_u32 s29, s29, 9216
    buffer_load_dwordx4 v2, s[16:19], s29 offen offset:2048 lds
    v_mfma_f32_32x32x16_bf16 v[80:95], v[52:55], v[56:59], v[80:95]
    ds_read_b128 v[40:43], v5 offset:32768
    v_dot2c_f32_bf16 v20, s27, v54
    v_dot2c_f32_bf16 v22, v54, v54
    s_add_u32 s29, s29, 9216
    buffer_load_dwordx4 v3, s[16:19], s29 offen offset:3072 lds
    v_mfma_f32_32x32x16_bf16 v[112:127], v[52:55], v[60:63], v[112:127]
    ds_read_b128 v[44:47], v5 offset:33792
    v_dot2c_f32_bf16 v21, s27, v55
    s_add_u32 s28, s28, 16384
    s_mov_b32 m0, s28
    s_add_u32 s29, s25, 73728
    buffer_load_dwordx4 v1, s[8:11], s29 offen offset:0 lds
    v_mfma_f32_32x32x16_bf16 v[144:159], v[60:63], v[52:55], v[144:159]
    v_dot2c_f32_bf16 v23, v55, v55
    buffer_load_dwordx4 v1, s[8:11], s29 offen offset:1024 lds
    s_waitcnt lgkmcnt(0)
    v_mfma_f32_32x32x16_bf16 v[64:79], v[32:35], v[40:43], v[64:79]
    v_dot2c_f32_bf16 v20, s27, v36
    v_dot2c_f32_bf16 v22, v36, v36
    buffer_load_dwordx4 v1, s[8:11], s29 offen offset:2048 lds
    v_mfma_f32_32x32x16_bf16 v[96:111], v[32:35], v[44:47], v[96:111]
    ds_read_b128 v[48:51], v11 offset:32768
    v_dot2c_f32_bf16 v21, s27, v37
    buffer_load_dwordx4 v1, s[8:11], s29 offen offset:3072 lds
    v_mfma_f32_32x32x16_bf16 v[128:143], v[44:47], v[32:35], v[128:143]
    ds_read_b128 v[52:55], v11 offset:36864
    v_dot2c_f32_bf16 v23, v37, v37
    s_bfe_u32 s41, s54, 524312
    s_mul_i32 s41, s41, s40
    s_add_u32 s42, s58, s41
    s_add_u32 s43, s59, s41
    buffer_load_dwordx4 a[152:155], v240, s[8:11], s42 offen
    v_mfma_f32_32x32x16_bf16 v[80:95], v[36:39], v[40:43], v[80:95]
    ds_read_b128 v[56:59], v5 offset:34816
    v_dot2c_f32_bf16 v20, s27, v38
    v_dot2c_f32_bf16 v22, v38, v38
    buffer_load_dwordx4 a[156:159], v241, s[8:11], s43 offen
    v_mfma_f32_32x32x16_bf16 v[112:127], v[36:39], v[44:47], v[112:127]
    ds_read_b128 v[60:63], v5 offset:35840
    v_dot2c_f32_bf16 v21, s27, v39
    s_bfe_u32 s41, s55, 524288
    s_mul_i32 s41, s41, s40
    s_add_u32 s42, s58, s41
    s_add_u32 s43, s59, s41
    buffer_load_dwordx4 a[160:163], v240, s[8:11], s42 offen
    v_mfma_f32_32x32x16_bf16 v[144:159], v[44:47], v[36:39], v[144:159]
    v_dot2c_f32_bf16 v23, v39, v39
    buffer_load_dwordx4 a[164:167], v241, s[8:11], s43 offen
    s_waitcnt lgkmcnt(0)
    v_mfma_f32_32x32x16_bf16 v[64:79], v[48:51], v[56:59], v[64:79]
    v_dot2c_f32_bf16 v20, s27, v52
    v_dot2c_f32_bf16 v22, v52, v52
    v_mfma_f32_32x32x16_bf16 v[96:111], v[48:51], v[60:63], v[96:111]
    ds_read_b128 v[32:35], v12 offset:32768
    v_dot2c_f32_bf16 v21, s27, v53
    v_mfma_f32_32x32x16_bf16 v[128:143], v[60:63], v[48:51], v[128:143]
    ds_read_b128 v[36:39], v12 offset:36864
    v_dot2c_f32_bf16 v23, v53, v53
    v_mfma_f32_32x32x16_bf16 v[80:95], v[52:55], v[56:59], v[80:95]
    ds_read_b128 v[40:43], v5 offset:36864
    v_dot2c_f32_bf16 v20, s27, v54
    v_dot2c_f32_bf16 v22, v54, v54
    v_mfma_f32_32x32x16_bf16 v[112:127], v[52:55], v[60:63], v[112:127]
    ds_read_b128 v[44:47], v5 offset:37888
    v_dot2c_f32_bf16 v21, s27, v55
    v_mfma_f32_32x32x16_bf16 v[144:159], v[60:63], v[52:55], v[144:159]
    v_dot2c_f32_bf16 v23, v55, v55
    s_waitcnt lgkmcnt(0)
    v_mfma_f32_32x32x16_bf16 v[64:79], v[32:35], v[40:43], v[64:79]
    v_dot2c_f32_bf16 v20, s27, v36
    v_dot2c_f32_bf16 v22, v36, v36
    v_mfma_f32_32x32x16_bf16 v[96:111], v[32:35], v[44:47], v[96:111]
    ds_read_b128 v[48:51], v13 offset:32768
    v_dot2c_f32_bf16 v21, s27, v37
    v_mfma_f32_32x32x16_bf16 v[128:143], v[44:47], v[32:35], v[128:143]
    ds_read_b128 v[52:55], v13 offset:36864
    v_dot2c_f32_bf16 v23, v37, v37
    v_mfma_f32_32x32x16_bf16 v[80:95], v[36:39], v[40:43], v[80:95]
    ds_read_b128 v[56:59], v5 offset:38912
    v_dot2c_f32_bf16 v20, s27, v38
    v_dot2c_f32_bf16 v22, v38, v38
    v_mfma_f32_32x32x16_bf16 v[112:127], v[36:39], v[44:47], v[112:127]
    ds_read_b128 v[60:63], v5 offset:39936
    v_dot2c_f32_bf16 v21, s27, v39
    v_mfma_f32_32x32x16_bf16 v[144:159], v[44:47], v[36:39], v[144:159]
    v_dot2c_f32_bf16 v23, v39, v39
    s_waitcnt vmcnt(16)
    s_barrier
    s_waitcnt lgkmcnt(0)
    v_mfma_f32_32x32x16_bf16 v[64:79], v[48:51], v[56:59], v[64:79]
    v_dot2c_f32_bf16 v20, s27, v52
    v_dot2c_f32_bf16 v22, v52, v52
    s_bfe_u32 s41, s55, 524296
    s_mul_i32 s41, s41, s40
    s_add_u32 s42, s58, s41
    s_add_u32 s43, s59, s41
    buffer_load_dwordx4 a[168:171], v240, s[8:11], s42 offen
    v_mfma_f32_32x32x16_bf16 v[96:111], v[48:51], v[60:63], v[96:111]
    ds_read_b128 v[32:35], v6 offset:0
    v_dot2c_f32_bf16 v21, s27, v53
    buffer_load_dwordx4 a[172:175], v241, s[8:11], s43 offen
    v_mfma_f32_32x32x16_bf16 v[128:143], v[60:63], v[48:51], v[128:143]
    ds_read_b128 v[36:39], v6 offset:4096
    v_dot2c_f32_bf16 v23, v53, v53
    s_bfe_u32 s41, s55, 524304
    s_mul_i32 s41, s41, s40
    s_add_u32 s42, s58, s41
    s_add_u32 s43, s59, s41
    buffer_load_dwordx4 a[176:179], v240, s[8:11], s42 offen
    v_mfma_f32_32x32x16_bf16 v[80:95], v[52:55], v[56:59], v[80:95]
    ds_read_b128 v[40:43], v4 offset:0
    v_dot2c_f32_bf16 v20, s27, v54
    v_dot2c_f32_bf16 v22, v54, v54
    buffer_load_dwordx4 a[180:183], v241, s[8:11], s43 offen
    v_mfma_f32_32x32x16_bf16 v[112:127], v[52:55], v[60:63], v[112:127]
    ds_read_b128 v[44:47], v4 offset:1024
    v_dot2c_f32_bf16 v21, s27, v55
    s_bfe_u32 s41, s55, 524312
    s_mul_i32 s41, s41, s40
    s_add_u32 s42, s58, s41
    s_add_u32 s43, s59, s41
    buffer_load_dwordx4 a[184:187], v240, s[8:11], s42 offen
    v_mfma_f32_32x32x16_bf16 v[144:159], v[60:63], v[52:55], v[144:159]
    v_dot2c_f32_bf16 v23, v55, v55
    buffer_load_dwordx4 a[188:191], v241, s[8:11], s43 offen
    s_waitcnt lgkmcnt(0)
    v_mfma_f32_32x32x16_bf16 v[64:79], v[32:35], v[40:43], v[64:79]
    v_dot2c_f32_bf16 v20, s27, v36
    v_dot2c_f32_bf16 v22, v36, v36
    s_bfe_u32 s41, s56, 524288
    s_mul_i32 s41, s41, s40
    s_add_u32 s42, s58, s41
    s_add_u32 s43, s59, s41
    buffer_load_dwordx4 a[192:195], v240, s[8:11], s42 offen
    v_mfma_f32_32x32x16_bf16 v[96:111], v[32:35], v[44:47], v[96:111]
    ds_read_b128 v[48:51], v7 offset:0
    v_dot2c_f32_bf16 v21, s27, v37
    buffer_load_dwordx4 a[196:199], v241, s[8:11], s43 offen
    v_mfma_f32_32x32x16_bf16 v[128:143], v[44:47], v[32:35], v[128:143]
    ds_read_b128 v[52:55], v7 offset:4096
    v_dot2c_f32_bf16 v23, v37, v37
    v_mfma_f32_32x32x16_bf16 v[80:95], v[36:39], v[40:43], v[80:95]
    ds_read_b128 v[56:59], v4 offset:2048
    v_dot2c_f32_bf16 v20, s27, v38
    v_dot2c_f32_bf16 v22, v38, v38
    v_mfma_f32_32x32x16_bf16 v[112:127], v[36:39], v[44:47], v[112:127]
    ds_read_b128 v[60:63], v4 offset:3072
    v_dot2c_f32_bf16 v21, s27, v39
    v_mfma_f32_32x32x16_bf16 v[144:159], v[44:47], v[36:39], v[144:159]
    v_dot2c_f32_bf16 v23, v39, v39
    s_waitcnt lgkmcnt(0)
    v_mfma_f32_32x32x16_bf16 v[64:79], v[48:51], v[56:59], v[64:79]
    v_dot2c_f32_bf16 v20, s27, v52
    v_dot2c_f32_bf16 v22, v52, v52
    v_mfma_f32_32x32x16_bf16 v[96:111], v[48:51], v[60:63], v[96:111]
    ds_read_b128 v[32:35], v8 offset:0
    v_dot2c_f32_bf16 v21, s27, v53
    v_mfma_f32_32x32x16_bf16 v[128:143], v[60:63], v[48:51], v[128:143]
    ds_read_b128 v[36:39], v8 offset:4096
    v_dot2c_f32_bf16 v23, v53, v53
    v_mfma_f32_32x32x16_bf16 v[80:95], v[52:55], v[56:59], v[80:95]
    ds_read_b128 v[40:43], v4 offset:4096
    v_dot2c_f32_bf16 v20, s27, v54
    v_dot2c_f32_bf16 v22, v54, v54
    v_mfma_f32_32x32x16_bf16 v[112:127], v[52:55], v[60:63], v[112:127]
    ds_read_b128 v[44:47], v4 offset:5120
    v_dot2c_f32_bf16 v21, s27, v55
    v_mfma_f32_32x32x16_bf16 v[144:159], v[60:63], v[52:55], v[144:159]
    v_dot2c_f32_bf16 v23, v55, v55
    s_waitcnt lgkmcnt(0)
    v_mfma_f32_32x32x16_bf16 v[64:79], v[32:35], v[40:43], v[64:79]
    v_dot2c_f32_bf16 v20, s27, v36
    v_dot2c_f32_bf16 v22, v36, v36
    v_mfma_f32_32x32x16_bf16 v[96:111], v[32:35], v[44:47], v[96:111]
    ds_read_b128 v[48:51], v9 offset:0
    v_dot2c_f32_bf16 v21, s27, v37
    v_mfma_f32_32x32x16_bf16 v[128:143], v[44:47], v[32:35], v[128:143]
    ds_read_b128 v[52:55], v9 offset:4096
    v_dot2c_f32_bf16 v23, v37, v37
    v_mfma_f32_32x32x16_bf16 v[80:95], v[36:39], v[40:43], v[80:95]
    ds_read_b128 v[56:59], v4 offset:6144
    v_dot2c_f32_bf16 v20, s27, v38
    v_dot2c_f32_bf16 v22, v38, v38
    v_mfma_f32_32x32x16_bf16 v[112:127], v[36:39], v[44:47], v[112:127]
    ds_read_b128 v[60:63], v4 offset:7168
    v_dot2c_f32_bf16 v21, s27, v39
    v_mfma_f32_32x32x16_bf16 v[144:159], v[44:47], v[36:39], v[144:159]
    v_dot2c_f32_bf16 v23, v39, v39
    s_waitcnt vmcnt(12)
    s_barrier
    s_waitcnt lgkmcnt(0)
    v_mfma_f32_32x32x16_bf16 v[64:79], v[48:51], v[56:59], v[64:79]
    v_dot2c_f32_bf16 v20, s27, v52
    v_dot2c_f32_bf16 v22, v52, v52
    s_bfe_u32 s41, s56, 524296
    s_mul_i32 s41, s41, s40
    s_add_u32 s42, s58, s41
    s_add_u32 s43, s59, s41
    buffer_load_dwordx4 a[200:203], v240, s[8:11], s42 offen
    v_mfma_f32_32x32x16_bf16 v[96:111], v[48:51], v[60:63], v[96:111]
    ds_read_b128 v[32:35], v6 offset:32768
    v_dot2c_f32_bf16 v21, s27, v53
    buffer_load_dwordx4 a[204:207], v241, s[8:11], s43 offen
    v_mfma_f32_32x32x16_bf16 v[128:143], v[60:63], v[48:51], v[128:143]
    ds_read_b128 v[36:39], v6 offset:36864
    v_dot2c_f32_bf16 v23, v53, v53
    s_bfe_u32 s41, s56, 524304
    s_mul_i32 s41, s41, s40
    s_add_u32 s42, s58, s41
    s_add_u32 s43, s59, s41
    buffer_load_dwordx4 a[208:211], v240, s[8:11], s42 offen
    v_mfma_f32_32x32x16_bf16 v[80:95], v[52:55], v[56:59], v[80:95]
    ds_read_b128 v[40:43], v4 offset:32768
    v_dot2c_f32_bf16 v20, s27, v54
    v_dot2c_f32_bf16 v22, v54, v54
    buffer_load_dwordx4 a[212:215], v241, s[8:11], s43 offen
    v_mfma_f32_32x32x16_bf16 v[112:127], v[52:55], v[60:63], v[112:127]
    ds_read_b128 v[44:47], v4 offset:33792
    v_dot2c_f32_bf16 v21, s27, v55
    s_bfe_u32 s41, s56, 524312
    s_mul_i32 s41, s41, s40
    s_add_u32 s42, s58, s41
    s_add_u32 s43, s59, s41
    buffer_load_dwordx4 a[216:219], v240, s[8:11], s42 offen
    v_mfma_f32_32x32x16_bf16 v[144:159], v[60:63], v[52:55], v[144:159]
    v_dot2c_f32_bf16 v23, v55, v55
    buffer_load_dwordx4 a[220:223], v241, s[8:11], s43 offen
    s_waitcnt lgkmcnt(0)
    v_mfma_f32_32x32x16_bf16 v[64:79], v[32:35], v[40:43], v[64:79]
    v_dot2c_f32_bf16 v20, s27, v36
    v_dot2c_f32_bf16 v22, v36, v36
    s_bfe_u32 s41, s57, 524288
    s_mul_i32 s41, s41, s40
    s_add_u32 s42, s58, s41
    s_add_u32 s43, s59, s41
    buffer_load_dwordx4 a[224:227], v240, s[8:11], s42 offen
    v_mfma_f32_32x32x16_bf16 v[96:111], v[32:35], v[44:47], v[96:111]
    ds_read_b128 v[48:51], v7 offset:32768
    v_dot2c_f32_bf16 v21, s27, v37
    buffer_load_dwordx4 a[228:231], v241, s[8:11], s43 offen
    v_mfma_f32_32x32x16_bf16 v[128:143], v[44:47], v[32:35], v[128:143]
    ds_read_b128 v[52:55], v7 offset:36864
    v_dot2c_f32_bf16 v23, v37, v37
    v_mfma_f32_32x32x16_bf16 v[80:95], v[36:39], v[40:43], v[80:95]
    ds_read_b128 v[56:59], v4 offset:34816
    v_dot2c_f32_bf16 v20, s27, v38
    v_dot2c_f32_bf16 v22, v38, v38
    v_mfma_f32_32x32x16_bf16 v[112:127], v[36:39], v[44:47], v[112:127]
    ds_read_b128 v[60:63], v4 offset:35840
    v_dot2c_f32_bf16 v21, s27, v39
    v_mfma_f32_32x32x16_bf16 v[144:159], v[44:47], v[36:39], v[144:159]
    v_dot2c_f32_bf16 v23, v39, v39
    s_waitcnt lgkmcnt(0)
    v_mfma_f32_32x32x16_bf16 v[64:79], v[48:51], v[56:59], v[64:79]
    v_dot2c_f32_bf16 v20, s27, v52
    v_dot2c_f32_bf16 v22, v52, v52
    v_mfma_f32_32x32x16_bf16 v[96:111], v[48:51], v[60:63], v[96:111]
    ds_read_b128 v[32:35], v8 offset:32768
    v_dot2c_f32_bf16 v21, s27, v53
    v_mfma_f32_32x32x16_bf16 v[128:143], v[60:63], v[48:51], v[128:143]
    ds_read_b128 v[36:39], v8 offset:36864
    v_dot2c_f32_bf16 v23, v53, v53
    v_mfma_f32_32x32x16_bf16 v[80:95], v[52:55], v[56:59], v[80:95]
    ds_read_b128 v[40:43], v4 offset:36864
    v_dot2c_f32_bf16 v20, s27, v54
    v_dot2c_f32_bf16 v22, v54, v54
    v_mfma_f32_32x32x16_bf16 v[112:127], v[52:55], v[60:63], v[112:127]
    ds_read_b128 v[44:47], v4 offset:37888
    v_dot2c_f32_bf16 v21, s27, v55
    v_mfma_f32_32x32x16_bf16 v[144:159], v[60:63], v[52:55], v[144:159]
    v_dot2c_f32_bf16 v23, v55, v55
    s_waitcnt lgkmcnt(0)
    v_mfma_f32_32x32x16_bf16 v[64:79], v[32:35], v[40:43], v[64:79]
    v_dot2c_f32_bf16 v20, s27, v36
    v_dot2c_f32_bf16 v22, v36, v36
    v_mfma_f32_32x32x16_bf16 v[96:111], v[32:35], v[44:47], v[96:111]
    ds_read_b128 v[48:51], v9 offset:32768
    v_dot2c_f32_bf16 v21, s27, v37
    v_mfma_f32_32x32x16_bf16 v[128:143], v[44:47], v[32:35], v[128:143]
    ds_read_b128 v[52:55], v9 offset:36864
    v_dot2c_f32_bf16 v23, v37, v37
    v_mfma_f32_32x32x16_bf16 v[80:95], v[36:39], v[40:43], v[80:95]
    ds_read_b128 v[56:59], v4 offset:38912
    v_dot2c_f32_bf16 v20, s27, v38
    v_dot2c_f32_bf16 v22, v38, v38
    v_mfma_f32_32x32x16_bf16 v[112:127], v[36:39], v[44:47], v[112:127]
    ds_read_b128 v[60:63], v4 offset:39936
    v_dot2c_f32_bf16 v21, s27, v39
    v_mfma_f32_32x32x16_bf16 v[144:159], v[44:47], v[36:39], v[144:159]
    v_dot2c_f32_bf16 v23, v39, v39
    s_waitcnt lgkmcnt(0)
    v_mfma_f32_32x32x16_bf16 v[64:79], v[48:51], v[56:59], v[64:79]
    v_dot2c_f32_bf16 v20, s27, v52
    v_dot2c_f32_bf16 v22, v52, v52
    s_bfe_u32 s41, s57, 524296
    s_mul_i32 s41, s41, s40
    s_add_u32 s42, s58, s41
    s_add_u32 s43, s59, s41
    buffer_load_dwordx4 a[232:235], v240, s[8:11], s42 offen
    v_mfma_f32_32x32x16_bf16 v[96:111], v[48:51], v[60:63], v[96:111]
    v_dot2c_f32_bf16 v21, s27, v53
    buffer_load_dwordx4 a[236:239], v241, s[8:11], s43 offen
    v_mfma_f32_32x32x16_bf16 v[128:143], v[60:63], v[48:51], v[128:143]
    v_dot2c_f32_bf16 v23, v53, v53
    s_bfe_u32 s41, s57, 524304
    s_mul_i32 s41, s41, s40
    s_add_u32 s42, s58, s41
    s_add_u32 s43, s59, s41
    buffer_load_dwordx4 a[240:243], v240, s[8:11], s42 offen
    v_mfma_f32_32x32x16_bf16 v[80:95], v[52:55], v[56:59], v[80:95]
    v_dot2c_f32_bf16 v20, s27, v54
    v_dot2c_f32_bf16 v22, v54, v54
    buffer_load_dwordx4 a[244:247], v241, s[8:11], s43 offen
    v_mfma_f32_32x32x16_bf16 v[112:127], v[52:55], v[60:63], v[112:127]
    v_dot2c_f32_bf16 v21, s27, v55
    s_bfe_u32 s41, s57, 524312
    s_mul_i32 s41, s41, s40
    s_add_u32 s42, s58, s41
    s_add_u32 s43, s59, s41
    buffer_load_dwordx4 a[248:251], v240, s[8:11], s42 offen
    v_mfma_f32_32x32x16_bf16 v[144:159], v[60:63], v[52:55], v[144:159]
    v_dot2c_f32_bf16 v23, v55, v55
    buffer_load_dwordx4 a[252:255], v241, s[8:11], s43 offen
layerb1_kernel_af_epi:
    s_nop 2
    v_add_f32 v20, v20, v21
    v_add_f32 v22, v22, v23
    v_mov_b32 v21, v20
    v_mov_b32 v23, v22
    s_nop 1
    v_permlane32_swap_b32 v20, v21
    v_permlane32_swap_b32 v22, v23
    v_add_f32 v20, v20, v21
    v_add_f32 v22, v22, v23
    v_mul_f32 v20, 0x3acccccd, v20
    v_mul_f32 v21, v20, v20
    v_mul_f32 v22, 0x3acccccd, v22
    v_sub_f32 v22, v22, v21
    v_max_f32 v22, 0, v22
    v_add_f32 v22, 0x3727c5ac, v22
    v_rsq_f32 v22, v22
    v_and_b32 v16, 31, v0
    s_lshl_b32 s28, s13, 7
    s_add_u32 s28, s28, 65536
    v_lshl_add_u32 v17, v16, 2, s28
    ds_write_b32 v17, v22
    s_waitcnt lgkmcnt(0)
    s_barrier
    s_lshl_b32 s28, s22, 8
    s_add_u32 s28, s28, 65536
    v_lshl_add_u32 v17, v16, 2, s28
    v_lshrrev_b32 v18, 5, v0
    v_lshlrev_b32 v18, 4, v18
    v_add_u32 v18, s28, v18
    ds_read_b32 v224, v17 offset:0
    ds_read_b128 v[192:195], v18 offset:0
    ds_read_b128 v[196:199], v18 offset:32
    ds_read_b128 v[200:203], v18 offset:64
    ds_read_b128 v[204:207], v18 offset:96
    ds_read_b32 v225, v17 offset:128
    ds_read_b128 v[208:211], v18 offset:128
    ds_read_b128 v[212:215], v18 offset:160
    ds_read_b128 v[216:219], v18 offset:192
    ds_read_b128 v[220:223], v18 offset:224
    v_and_b32 v16, 31, v0
    v_mov_b32 v228, 0x358637bd
    v_cmp_gt_u32 vcc, 20, v16
    s_mov_b64 s[30:31], vcc
    s_nop 0
    v_cndmask_b32 v226, 0, v228, vcc
    v_cmp_eq_u32 vcc, 8, v16
    s_nop 1
    v_cndmask_b32 v227, 0, 1.0, vcc
    s_waitcnt lgkmcnt(0)
    v_fma_f32 v64, v64, v192, v226
    v_mul_f32 v48, 0x3fb8aa3b, v64
    v_exp_f32 v48, v48 clamp
    v_max_f32 v49, v64, v228
    v_fma_f32 v96, v96, v192, v227
    v_add_f32 v48, v48, v49
    v_cndmask_b32 v64, v64, v48, s[30:31]
    v_fma_f32 v65, v65, v193, v226
    v_mul_f32 v50, 0x3fb8aa3b, v65
    v_exp_f32 v50, v50 clamp
    v_max_f32 v51, v65, v228
    v_fma_f32 v97, v97, v193, v227
    v_add_f32 v50, v50, v51
    v_cndmask_b32 v65, v65, v50, s[30:31]
    v_fma_f32 v66, v66, v194, v226
    v_mul_f32 v52, 0x3fb8aa3b, v66
    v_exp_f32 v52, v52 clamp
    v_max_f32 v53, v66, v228
    v_fma_f32 v98, v98, v194, v227
    v_add_f32 v52, v52, v53
    v_cndmask_b32 v66, v66, v52, s[30:31]
    v_fma_f32 v67, v67, v195, v226
    v_mul_f32 v54, 0x3fb8aa3b, v67
    v_exp_f32 v54, v54 clamp
    v_max_f32 v55, v67, v228
    v_fma_f32 v99, v99, v195, v227
    v_add_f32 v54, v54, v55
    v_cndmask_b32 v67, v67, v54, s[30:31]
    v_fma_f32 v68, v68, v196, v226
    v_mul_f32 v48, 0x3fb8aa3b, v68
    v_exp_f32 v48, v48 clamp
    v_max_f32 v49, v68, v228
    v_fma_f32 v100, v100, v196, v227
    v_add_f32 v48, v48, v49
    v_cndmask_b32 v68, v68, v48, s[30:31]
    v_fma_f32 v69, v69, v197, v226
    v_mul_f32 v50, 0x3fb8aa3b, v69
    v_exp_f32 v50, v50 clamp
    v_max_f32 v51, v69, v228
    v_fma_f32 v101, v101, v197, v227
    v_add_f32 v50, v50, v51
    v_cndmask_b32 v69, v69, v50, s[30:31]
    v_fma_f32 v70, v70, v198, v226
    v_mul_f32 v52, 0x3fb8aa3b, v70
    v_exp_f32 v52, v52 clamp
    v_max_f32 v53, v70, v228
    v_fma_f32 v102, v102, v198, v227
    v_add_f32 v52, v52, v53
    v_cndmask_b32 v70, v70, v52, s[30:31]
    v_fma_f32 v71, v71, v199, v226
    v_mul_f32 v54, 0x3fb8aa3b, v71
    v_exp_f32 v54, v54 clamp
    v_max_f32 v55, v71, v228
    v_fma_f32 v103, v103, v199, v227
    v_add_f32 v54, v54, v55
    v_cndmask_b32 v71, v71, v54, s[30:31]
    v_fma_f32 v72, v72, v200, v226
    v_mul_f32 v48, 0x3fb8aa3b, v72
    v_exp_f32 v48, v48 clamp
    v_max_f32 v49, v72, v228
    v_fma_f32 v104, v104, v200, v227
    v_add_f32 v48, v48, v49
    v_cndmask_b32 v72, v72, v48, s[30:31]
    v_fma_f32 v73, v73, v201, v226
    v_mul_f32 v50, 0x3fb8aa3b, v73
    v_exp_f32 v50, v50 clamp
    v_max_f32 v51, v73, v228
    v_fma_f32 v105, v105, v201, v227
    v_add_f32 v50, v50, v51
    v_cndmask_b32 v73, v73, v50, s[30:31]
    v_fma_f32 v74, v74, v202, v226
    v_mul_f32 v52, 0x3fb8aa3b, v74
    v_exp_f32 v52, v52 clamp
    v_max_f32 v53, v74, v228
    v_fma_f32 v106, v106, v202, v227
    v_add_f32 v52, v52, v53
    v_cndmask_b32 v74, v74, v52, s[30:31]
    v_fma_f32 v75, v75, v203, v226
    v_mul_f32 v54, 0x3fb8aa3b, v75
    v_exp_f32 v54, v54 clamp
    v_max_f32 v55, v75, v228
    v_fma_f32 v107, v107, v203, v227
    v_add_f32 v54, v54, v55
    v_cndmask_b32 v75, v75, v54, s[30:31]
    v_fma_f32 v76, v76, v204, v226
    v_mul_f32 v48, 0x3fb8aa3b, v76
    v_exp_f32 v48, v48 clamp
    v_max_f32 v49, v76, v228
    v_fma_f32 v108, v108, v204, v227
    v_add_f32 v48, v48, v49
    v_cndmask_b32 v76, v76, v48, s[30:31]
    v_fma_f32 v77, v77, v205, v226
    v_mul_f32 v50, 0x3fb8aa3b, v77
    v_exp_f32 v50, v50 clamp
    v_max_f32 v51, v77, v228
    v_fma_f32 v109, v109, v205, v227
    v_add_f32 v50, v50, v51
    v_cndmask_b32 v77, v77, v50, s[30:31]
    v_fma_f32 v78, v78, v206, v226
    v_mul_f32 v52, 0x3fb8aa3b, v78
    v_exp_f32 v52, v52 clamp
    v_max_f32 v53, v78, v228
    v_fma_f32 v110, v110, v206, v227
    v_add_f32 v52, v52, v53
    v_cndmask_b32 v78, v78, v52, s[30:31]
    v_fma_f32 v79, v79, v207, v226
    v_mul_f32 v54, 0x3fb8aa3b, v79
    v_exp_f32 v54, v54 clamp
    v_max_f32 v55, v79, v228
    v_fma_f32 v111, v111, v207, v227
    v_add_f32 v54, v54, v55
    v_cndmask_b32 v79, v79, v54, s[30:31]
    v_cvt_pk_bf16_f32 v32, v64, v65
    v_cvt_pk_bf16_f32 v40, v96, v97
    v_cvt_pk_bf16_f32 v33, v66, v67
    v_cvt_pk_bf16_f32 v41, v98, v99
    v_cvt_pk_bf16_f32 v34, v68, v69
    v_cvt_pk_bf16_f32 v42, v100, v101
    v_cvt_pk_bf16_f32 v35, v70, v71
    v_cvt_pk_bf16_f32 v43, v102, v103
    v_cvt_pk_bf16_f32 v36, v72, v73
    v_cvt_pk_bf16_f32 v44, v104, v105
    v_cvt_pk_bf16_f32 v37, v74, v75
    v_cvt_pk_bf16_f32 v45, v106, v107
    v_cvt_pk_bf16_f32 v38, v76, v77
    v_cvt_pk_bf16_f32 v46, v108, v109
    v_cvt_pk_bf16_f32 v39, v78, v79
    v_cvt_pk_bf16_f32 v47, v110, v111
    s_nop 1
    v_mfma_f32_32x32x16_bf16 v[160:175], v[32:35], v[32:35], 0
    v_mfma_f32_32x32x16_bf16 v[176:191], v[40:43], v[32:35], 0
    v_mfma_f32_32x32x16_bf16 v[160:175], v[36:39], v[36:39], v[160:175]
    v_mfma_f32_32x32x16_bf16 v[176:191], v[44:47], v[36:39], v[176:191]
    v_fma_f32 v80, v80, v208, v226
    v_mul_f32 v48, 0x3fb8aa3b, v80
    v_exp_f32 v48, v48 clamp
    v_max_f32 v49, v80, v228
    v_fma_f32 v112, v112, v208, v227
    v_add_f32 v48, v48, v49
    v_cndmask_b32 v80, v80, v48, s[30:31]
    v_fma_f32 v81, v81, v209, v226
    v_mul_f32 v50, 0x3fb8aa3b, v81
    v_exp_f32 v50, v50 clamp
    v_max_f32 v51, v81, v228
    v_fma_f32 v113, v113, v209, v227
    v_add_f32 v50, v50, v51
    v_cndmask_b32 v81, v81, v50, s[30:31]
    v_fma_f32 v82, v82, v210, v226
    v_mul_f32 v52, 0x3fb8aa3b, v82
    v_exp_f32 v52, v52 clamp
    v_max_f32 v53, v82, v228
    v_fma_f32 v114, v114, v210, v227
    v_add_f32 v52, v52, v53
    v_cndmask_b32 v82, v82, v52, s[30:31]
    v_fma_f32 v83, v83, v211, v226
    v_mul_f32 v54, 0x3fb8aa3b, v83
    v_exp_f32 v54, v54 clamp
    v_max_f32 v55, v83, v228
    v_fma_f32 v115, v115, v211, v227
    v_add_f32 v54, v54, v55
    v_cndmask_b32 v83, v83, v54, s[30:31]
    v_fma_f32 v84, v84, v212, v226
    v_mul_f32 v48, 0x3fb8aa3b, v84
    v_exp_f32 v48, v48 clamp
    v_max_f32 v49, v84, v228
    v_fma_f32 v116, v116, v212, v227
    v_add_f32 v48, v48, v49
    v_cndmask_b32 v84, v84, v48, s[30:31]
    v_fma_f32 v85, v85, v213, v226
    v_mul_f32 v50, 0x3fb8aa3b, v85
    v_exp_f32 v50, v50 clamp
    v_max_f32 v51, v85, v228
    v_fma_f32 v117, v117, v213, v227
    v_add_f32 v50, v50, v51
    v_cndmask_b32 v85, v85, v50, s[30:31]
    v_fma_f32 v86, v86, v214, v226
    v_mul_f32 v52, 0x3fb8aa3b, v86
    v_exp_f32 v52, v52 clamp
    v_max_f32 v53, v86, v228
    v_fma_f32 v118, v118, v214, v227
    v_add_f32 v52, v52, v53
    v_cndmask_b32 v86, v86, v52, s[30:31]
    v_fma_f32 v87, v87, v215, v226
    v_mul_f32 v54, 0x3fb8aa3b, v87
    v_exp_f32 v54, v54 clamp
    v_max_f32 v55, v87, v228
    v_fma_f32 v119, v119, v215, v227
    v_add_f32 v54, v54, v55
    v_cndmask_b32 v87, v87, v54, s[30:31]
    v_fma_f32 v88, v88, v216, v226
    v_mul_f32 v48, 0x3fb8aa3b, v88
    v_exp_f32 v48, v48 clamp
    v_max_f32 v49, v88, v228
    v_fma_f32 v120, v120, v216, v227
    v_add_f32 v48, v48, v49
    v_cndmask_b32 v88, v88, v48, s[30:31]
    v_fma_f32 v89, v89, v217, v226
    v_mul_f32 v50, 0x3fb8aa3b, v89
    v_exp_f32 v50, v50 clamp
    v_max_f32 v51, v89, v228
    v_fma_f32 v121, v121, v217, v227
    v_add_f32 v50, v50, v51
    v_cndmask_b32 v89, v89, v50, s[30:31]
    v_fma_f32 v90, v90, v218, v226
    v_mul_f32 v52, 0x3fb8aa3b, v90
    v_exp_f32 v52, v52 clamp
    v_max_f32 v53, v90, v228
    v_fma_f32 v122, v122, v218, v227
    v_add_f32 v52, v52, v53
    v_cndmask_b32 v90, v90, v52, s[30:31]
    v_fma_f32 v91, v91, v219, v226
    v_mul_f32 v54, 0x3fb8aa3b, v91
    v_exp_f32 v54, v54 clamp
    v_max_f32 v55, v91, v228
    v_fma_f32 v123, v123, v219, v227
    v_add_f32 v54, v54, v55
    v_cndmask_b32 v91, v91, v54, s[30:31]
    v_fma_f32 v92, v92, v220, v226
    v_mul_f32 v48, 0x3fb8aa3b, v92
    v_exp_f32 v48, v48 clamp
    v_max_f32 v49, v92, v228
    v_fma_f32 v124, v124, v220, v227
    v_add_f32 v48, v48, v49
    v_cndmask_b32 v92, v92, v48, s[30:31]
    v_fma_f32 v93, v93, v221, v226
    v_mul_f32 v50, 0x3fb8aa3b, v93
    v_exp_f32 v50, v50 clamp
    v_max_f32 v51, v93, v228
    v_fma_f32 v125, v125, v221, v227
    v_add_f32 v50, v50, v51
    v_cndmask_b32 v93, v93, v50, s[30:31]
    v_fma_f32 v94, v94, v222, v226
    v_mul_f32 v52, 0x3fb8aa3b, v94
    v_exp_f32 v52, v52 clamp
    v_max_f32 v53, v94, v228
    v_fma_f32 v126, v126, v222, v227
    v_add_f32 v52, v52, v53
    v_cndmask_b32 v94, v94, v52, s[30:31]
    v_fma_f32 v95, v95, v223, v226
    v_mul_f32 v54, 0x3fb8aa3b, v95
    v_exp_f32 v54, v54 clamp
    v_max_f32 v55, v95, v228
    v_fma_f32 v127, v127, v223, v227
    v_add_f32 v54, v54, v55
    v_cndmask_b32 v95, v95, v54, s[30:31]
    v_cvt_pk_bf16_f32 v32, v80, v81
    v_cvt_pk_bf16_f32 v40, v112, v113
    v_cvt_pk_bf16_f32 v33, v82, v83
    v_cvt_pk_bf16_f32 v41, v114, v115
    v_cvt_pk_bf16_f32 v34, v84, v85
    v_cvt_pk_bf16_f32 v42, v116, v117
    v_cvt_pk_bf16_f32 v35, v86, v87
    v_cvt_pk_bf16_f32 v43, v118, v119
    v_cvt_pk_bf16_f32 v36, v88, v89
    v_cvt_pk_bf16_f32 v44, v120, v121
    v_cvt_pk_bf16_f32 v37, v90, v91
    v_cvt_pk_bf16_f32 v45, v122, v123
    v_cvt_pk_bf16_f32 v38, v92, v93
    v_cvt_pk_bf16_f32 v46, v124, v125
    v_cvt_pk_bf16_f32 v39, v94, v95
    v_cvt_pk_bf16_f32 v47, v126, v127
    s_nop 1
    v_mfma_f32_32x32x16_bf16 v[160:175], v[32:35], v[32:35], v[160:175]
    v_mfma_f32_32x32x16_bf16 v[176:191], v[40:43], v[32:35], v[176:191]
    v_mfma_f32_32x32x16_bf16 v[160:175], v[36:39], v[36:39], v[160:175]
    v_mfma_f32_32x32x16_bf16 v[176:191], v[44:47], v[36:39], v[176:191]
    v_fma_f32 v132, v132, v224, v228
    v_mul_f32 v48, 0x3fb8aa3b, v132
    v_exp_f32 v48, v48 clamp
    v_max_f32 v49, v132, v228
    v_add_f32 v132, v48, v49
    v_fma_f32 v133, v133, v224, v228
    v_mul_f32 v50, 0x3fb8aa3b, v133
    v_exp_f32 v50, v50 clamp
    v_max_f32 v51, v133, v228
    v_add_f32 v133, v50, v51
    v_fma_f32 v134, v134, v224, v228
    v_mul_f32 v52, 0x3fb8aa3b, v134
    v_exp_f32 v52, v52 clamp
    v_max_f32 v53, v134, v228
    v_add_f32 v134, v52, v53
    v_fma_f32 v135, v135, v224, v228
    v_mul_f32 v54, 0x3fb8aa3b, v135
    v_exp_f32 v54, v54 clamp
    v_max_f32 v55, v135, v228
    v_add_f32 v135, v54, v55
    v_fma_f32 v136, v136, v224, v228
    v_mul_f32 v48, 0x3fb8aa3b, v136
    v_exp_f32 v48, v48 clamp
    v_max_f32 v49, v136, v228
    v_add_f32 v136, v48, v49
    v_fma_f32 v137, v137, v224, v228
    v_mul_f32 v50, 0x3fb8aa3b, v137
    v_exp_f32 v50, v50 clamp
    v_max_f32 v51, v137, v228
    v_add_f32 v137, v50, v51
    v_fma_f32 v138, v138, v224, v228
    v_mul_f32 v52, 0x3fb8aa3b, v138
    v_exp_f32 v52, v52 clamp
    v_max_f32 v53, v138, v228
    v_add_f32 v138, v52, v53
    v_fma_f32 v139, v139, v224, v228
    v_mul_f32 v54, 0x3fb8aa3b, v139
    v_exp_f32 v54, v54 clamp
    v_max_f32 v55, v139, v228
    v_add_f32 v139, v54, v55
    v_fma_f32 v140, v140, v224, v228
    v_mul_f32 v48, 0x3fb8aa3b, v140
    v_exp_f32 v48, v48 clamp
    v_max_f32 v49, v140, v228
    v_add_f32 v140, v48, v49
    v_fma_f32 v141, v141, v224, v228
    v_mul_f32 v50, 0x3fb8aa3b, v141
    v_exp_f32 v50, v50 clamp
    v_max_f32 v51, v141, v228
    v_add_f32 v141, v50, v51
    v_fma_f32 v142, v142, v224, v228
    v_mul_f32 v52, 0x3fb8aa3b, v142
    v_exp_f32 v52, v52 clamp
    v_max_f32 v53, v142, v228
    v_add_f32 v142, v52, v53
    v_fma_f32 v143, v143, v224, v228
    v_mul_f32 v54, 0x3fb8aa3b, v143
    v_exp_f32 v54, v54 clamp
    v_max_f32 v55, v143, v228
    v_add_f32 v143, v54, v55
    v_cvt_pk_bf16_f32 v130, v132, v133
    v_cvt_pk_bf16_f32 v131, v134, v135
    v_cvt_pk_bf16_f32 v132, v136, v137
    v_cvt_pk_bf16_f32 v133, v138, v139
    v_cvt_pk_bf16_f32 v134, v140, v141
    v_cvt_pk_bf16_f32 v135, v142, v143
    v_mov_b32 v128, 0
    v_mov_b32 v129, 0
    s_lshl_b32 s28, s13, 13
    s_add_u32 s28, s28, 66560
    v_add_u32 v17, s28, v1
    ds_write_b128 v17, v[160:163] offset:0
    ds_write_b128 v17, v[164:167] offset:1024
    ds_write_b128 v17, v[168:171] offset:2048
    ds_write_b128 v17, v[172:175] offset:3072
    ds_write_b128 v17, v[176:179] offset:4096
    ds_write_b128 v17, v[180:183] offset:5120
    ds_write_b128 v17, v[184:187] offset:6144
    ds_write_b128 v17, v[188:191] offset:7168
    s_lshl_b32 s28, s13, 6
    v_add_u32 v32, s28, v0
    v_cmp_le_u32 vcc, 105, v32
    s_nop 1
    v_cndmask_b32 v33, 0, 1, vcc
    v_mul_u32_u24 v34, 105, v33
    v_sub_u32 v34, v32, v34
    v_mul_u32_u24 v35, 13108, v34
    v_lshrrev_b32 v35, 16, v35
    v_mul_u32_u24 v36, 5, v35
    v_sub_u32 v36, v34, v36
    v_add_u32 v37, 20, v35
    v_subrev_u32 v38, 12, v35
    v_cmp_gt_u32 vcc, 12, v35
    s_nop 1
    v_cndmask_b32 v37, v38, v37, vcc
    v_cndmask_b32 v38, 1, 0, vcc
    v_lshlrev_b32 v38, 12, v38
    v_lshl_add_u32 v38, v33, 13, v38
    v_lshrrev_b32 v39, 3, v37
    v_lshl_add_u32 v38, v39, 10, v38
    v_bfe_u32 v39, v37, 2, 1
    v_lshlrev_b32 v39, 5, v39
    v_lshl_add_u32 v39, v36, 2, v39
    v_lshl_add_u32 v38, v39, 4, v38
    v_and_b32 v39, 3, v37
    v_lshl_add_u32 v38, v39, 2, v38
    v_min_u32 v38, 16320, v38
    v_add_u32 v38, 66560, v38
    s_waitcnt lgkmcnt(0)
    s_barrier
    ds_read_b32 v40, v38 offset:0
    ds_read_b32 v41, v38 offset:16
    ds_read_b32 v42, v38 offset:32
    ds_read_b32 v43, v38 offset:48
    ds_read_b32 v44, v38 offset:16384
    ds_read_b32 v45, v38 offset:16400
    ds_read_b32 v46, v38 offset:16416
    ds_read_b32 v47, v38 offset:16432
    s_lshl_b32 s28, s20, 4
    s_add_u32 s28, s28, s21
    s_lshl_b32 s28, s28, 12
    s_mul_i32 s39, s49, 1048576
    s_add_u32 s39, s39, 232783872
    s_add_u32 s28, s28, s39
    v_lshlrev_b32 v39, 4, v32
    v_cmp_gt_u32 vcc, 210, v32
    s_mov_b64 s[32:33], vcc
    s_waitcnt lgkmcnt(0)
    v_add_f32 v40, v40, v44
    v_add_f32 v41, v41, v45
    v_add_f32 v42, v42, v46
    v_add_f32 v43, v43, v47
    s_mov_b64 exec, s[32:33]
    buffer_store_dwordx4 v[40:43], v39, s[8:11], s28 offen sc1
    s_mov_b64 exec, -1
    v_fma_f32 v148, v148, v225, v228
    v_mul_f32 v48, 0x3fb8aa3b, v148
    v_exp_f32 v48, v48 clamp
    v_max_f32 v49, v148, v228
    v_add_f32 v148, v48, v49
    v_fma_f32 v149, v149, v225, v228
    v_mul_f32 v50, 0x3fb8aa3b, v149
    v_exp_f32 v50, v50 clamp
    v_max_f32 v51, v149, v228
    v_add_f32 v149, v50, v51
    v_fma_f32 v150, v150, v225, v228
    v_mul_f32 v52, 0x3fb8aa3b, v150
    v_exp_f32 v52, v52 clamp
    v_max_f32 v53, v150, v228
    v_add_f32 v150, v52, v53
    v_fma_f32 v151, v151, v225, v228
    v_mul_f32 v54, 0x3fb8aa3b, v151
    v_exp_f32 v54, v54 clamp
    v_max_f32 v55, v151, v228
    v_add_f32 v151, v54, v55
    v_fma_f32 v152, v152, v225, v228
    v_mul_f32 v48, 0x3fb8aa3b, v152
    v_exp_f32 v48, v48 clamp
    v_max_f32 v49, v152, v228
    v_add_f32 v152, v48, v49
    v_fma_f32 v153, v153, v225, v228
    v_mul_f32 v50, 0x3fb8aa3b, v153
    v_exp_f32 v50, v50 clamp
    v_max_f32 v51, v153, v228
    v_add_f32 v153, v50, v51
    v_fma_f32 v154, v154, v225, v228
    v_mul_f32 v52, 0x3fb8aa3b, v154
    v_exp_f32 v52, v52 clamp
    v_max_f32 v53, v154, v228
    v_add_f32 v154, v52, v53
    v_fma_f32 v155, v155, v225, v228
    v_mul_f32 v54, 0x3fb8aa3b, v155
    v_exp_f32 v54, v54 clamp
    v_max_f32 v55, v155, v228
    v_add_f32 v155, v54, v55
    v_fma_f32 v156, v156, v225, v228
    v_mul_f32 v48, 0x3fb8aa3b, v156
    v_exp_f32 v48, v48 clamp
    v_max_f32 v49, v156, v228
    v_add_f32 v156, v48, v49
    v_fma_f32 v157, v157, v225, v228
    v_mul_f32 v50, 0x3fb8aa3b, v157
    v_exp_f32 v50, v50 clamp
    v_max_f32 v51, v157, v228
    v_add_f32 v157, v50, v51
    v_fma_f32 v158, v158, v225, v228
    v_mul_f32 v52, 0x3fb8aa3b, v158
    v_exp_f32 v52, v52 clamp
    v_max_f32 v53, v158, v228
    v_add_f32 v158, v52, v53
    v_fma_f32 v159, v159, v225, v228
    v_mul_f32 v54, 0x3fb8aa3b, v159
    v_exp_f32 v54, v54 clamp
    v_max_f32 v55, v159, v228
    v_add_f32 v159, v54, v55
    v_cvt_pk_bf16_f32 v146, v148, v149
    v_cvt_pk_bf16_f32 v147, v150, v151
    v_cvt_pk_bf16_f32 v148, v152, v153
    v_cvt_pk_bf16_f32 v149, v154, v155
    v_cvt_pk_bf16_f32 v150, v156, v157
    v_cvt_pk_bf16_f32 v151, v158, v159
    v_mov_b32 v144, 0
    v_mov_b32 v145, 0
    s_mul_i32 s29, s26, 5
    v_lshrrev_b32 v17, 5, v0
    v_add_u32 v17, s29, v17
    v_lshrrev_b32 v18, 1, v17
    v_lshlrev_b32 v18, 9, v18
    v_and_b32 v17, 1, v17
    v_lshl_add_u32 v18, v17, 3, v18
    v_and_b32 v16, 31, v0
    v_lshl_add_u32 v14, v16, 4, v18
    v_mul_u32_u24 v15, 80, v16
    v_lshrrev_b32 v17, 5, v0
    v_lshl_add_u32 v15, v17, 4, v15
    s_mul_i32 s29, s23, 1680
    s_add_u32 s29, s29, 48
    v_add_u32 v15, s29, v15
    v_mov_b32 v48, 0
    v_mov_b32 v49, 0
    v_mov_b32 v50, 0
    v_mov_b32 v51, 0
    v_mov_b32 v52, 0
    v_mov_b32 v53, 0
    v_mov_b32 v54, 0
    v_mov_b32 v55, 0
    v_mov_b32 v56, 0
    v_mov_b32 v57, 0
    v_mov_b32 v58, 0
    v_mov_b32 v59, 0
    s_waitcnt vmcnt(0)
    s_barrier
    s_cmp_lg_u32 s13, 0
    s_cbranch_scc1 layerb1_kernel_af_go
    s_lshl_b32 s29, s20, 7
    s_add_u32 s29, s29, s48
    s_add_u32 s29, s29, 32768
    s_lshl_b32 s30, s21, 2
    v_mov_b32 v16, s30
    v_mov_b32 v17, 1
    s_mov_b64 exec, 1
    buffer_store_dword v17, v16, s[8:11], s29 offen sc1
    s_mov_b64 exec, 0xffff
    v_lshlrev_b32 v16, 2, v0
    s_mov_b32 s31, 400000
layerb1_kernel_af_poll:
    buffer_load_dword v17, v16, s[8:11], s29 offen sc1
    s_waitcnt vmcnt(0)
    v_cmp_eq_u32 vcc, 0, v17
    s_sub_u32 s31, s31, 1
    s_cbranch_scc1 layerb1_kernel_af_fail
    s_cbranch_vccnz layerb1_kernel_af_poll
    s_branch layerb1_kernel_af_ok
layerb1_kernel_af_fail:
    s_load_dwordx2 s[34:35], s[0:1], 88
    s_waitcnt lgkmcnt(0)
    s_mov_b32 s36, s34
    s_mov_b32 s37, s35
    s_mov_b32 s38, 256
    s_mov_b32 s39, 0x00020000
    s_mov_b64 exec, 1
    v_mov_b32 v16, 0
    v_mov_b32 v17, 0xdead
    buffer_store_dword v17, v16, s[36:39], 0 offen
layerb1_kernel_af_ok:
    s_mov_b64 exec, -1
layerb1_kernel_af_go:
    s_barrier
    s_lshl_b32 s28, s20, 16
    s_add_u32 s28, s28, s39
    s_mov_b64 exec, s[32:33]
    buffer_load_dwordx4 v[160:163], v39, s[8:11], s28 offen sc1
    s_add_u32 s28, s28, 4096
    buffer_load_dwordx4 v[164:167], v39, s[8:11], s28 offen sc1
    s_add_u32 s28, s28, 4096
    buffer_load_dwordx4 v[168:171], v39, s[8:11], s28 offen sc1
    s_add_u32 s28, s28, 4096
    buffer_load_dwordx4 v[172:175], v39, s[8:11], s28 offen sc1
    s_add_u32 s28, s28, 4096
    buffer_load_dwordx4 v[176:179], v39, s[8:11], s28 offen sc1
    s_add_u32 s28, s28, 4096
    buffer_load_dwordx4 v[180:183], v39, s[8:11], s28 offen sc1
    s_add_u32 s28, s28, 4096
    buffer_load_dwordx4 v[184:187], v39, s[8:11], s28 offen sc1
    s_add_u32 s28, s28, 4096
    buffer_load_dwordx4 v[188:191], v39, s[8:11], s28 offen sc1
    s_add_u32 s28, s28, 4096
    buffer_load_dwordx4 v[192:195], v39, s[8:11], s28 offen sc1
    s_add_u32 s28, s28, 4096
    buffer_load_dwordx4 v[196:199], v39, s[8:11], s28 offen sc1
    s_add_u32 s28, s28, 4096
    buffer_load_dwordx4 v[200:203], v39, s[8:11], s28 offen sc1
    s_add_u32 s28, s28, 4096
    buffer_load_dwordx4 v[204:207], v39, s[8:11], s28 offen sc1
    s_add_u32 s28, s28, 4096
    buffer_load_dwordx4 v[208:211], v39, s[8:11], s28 offen sc1
    s_add_u32 s28, s28, 4096
    buffer_load_dwordx4 v[212:215], v39, s[8:11], s28 offen sc1
    s_add_u32 s28, s28, 4096
    buffer_load_dwordx4 v[216:219], v39, s[8:11], s28 offen sc1
    s_add_u32 s28, s28, 4096
    buffer_load_dwordx4 v[220:223], v39, s[8:11], s28 offen sc1
    s_mov_b64 exec, -1
    s_waitcnt vmcnt(14)
    v_add_f32 v160, v160, v164
    v_add_f32 v161, v161, v165
    v_add_f32 v162, v162, v166
    v_add_f32 v163, v163, v167
    s_waitcnt vmcnt(12)
    v_add_f32 v168, v168, v172
    v_add_f32 v169, v169, v173
    v_add_f32 v170, v170, v174
    v_add_f32 v171, v171, v175
    s_waitcnt vmcnt(10)
    v_add_f32 v176, v176, v180
    v_add_f32 v177, v177, v181
    v_add_f32 v178, v178, v182
    v_add_f32 v179, v179, v183
    s_waitcnt vmcnt(8)
    v_add_f32 v184, v184, v188
    v_add_f32 v185, v185, v189
    v_add_f32 v186, v186, v190
    v_add_f32 v187, v187, v191
    s_waitcnt vmcnt(6)
    v_add_f32 v192, v192, v196
    v_add_f32 v193, v193, v197
    v_add_f32 v194, v194, v198
    v_add_f32 v195, v195, v199
    s_waitcnt vmcnt(4)
    v_add_f32 v200, v200, v204
    v_add_f32 v201, v201, v205
    v_add_f32 v202, v202, v206
    v_add_f32 v203, v203, v207
    s_waitcnt vmcnt(2)
    v_add_f32 v208, v208, v212
    v_add_f32 v209, v209, v213
    v_add_f32 v210, v210, v214
    v_add_f32 v211, v211, v215
    s_waitcnt vmcnt(0)
    v_add_f32 v216, v216, v220
    v_add_f32 v217, v217, v221
    v_add_f32 v218, v218, v222
    v_add_f32 v219, v219, v223
    v_add_f32 v160, v160, v168
    v_add_f32 v161, v161, v169
    v_add_f32 v162, v162, v170
    v_add_f32 v163, v163, v171
    v_add_f32 v176, v176, v184
    v_add_f32 v177, v177, v185
    v_add_f32 v178, v178, v186
    v_add_f32 v179, v179, v187
    v_add_f32 v192, v192, v200
    v_add_f32 v193, v193, v201
    v_add_f32 v194, v194, v202
    v_add_f32 v195, v195, v203
    v_add_f32 v208, v208, v216
    v_add_f32 v209, v209, v217
    v_add_f32 v210, v210, v218
    v_add_f32 v211, v211, v219
    v_add_f32 v160, v160, v176
    v_add_f32 v161, v161, v177
    v_add_f32 v162, v162, v178
    v_add_f32 v163, v163, v179
    v_add_f32 v192, v192, v208
    v_add_f32 v193, v193, v209
    v_add_f32 v194, v194, v210
    v_add_f32 v195, v195, v211
    v_add_f32 v160, v160, v192
    v_add_f32 v161, v161, v193
    v_add_f32 v162, v162, v194
    v_add_f32 v163, v163, v195
    v_add_u32 v39, 64, v39
    s_mov_b64 exec, s[32:33]
    ds_write_b128 v39, v[160:163]
    s_mov_b64 exec, -1
    s_waitcnt lgkmcnt(0)
    s_barrier
    s_mov_b32 exec_lo, 0x1fffff
    s_mov_b32 exec_hi, 0x1fffff
    ds_read_b128 v[52:55], v15 offset:32
    ds_read_b128 v[56:59], v15 offset:64
    s_mov_b32 exec_lo, 0
    ds_read_b128 v[48:51], v15
    s_mov_b64 exec, -1
    v_mov_b32 v32, 0
    v_mov_b32 v33, 0
    s_waitcnt lgkmcnt(0)
    v_cvt_pk_bf16_f32 v34, v48, v49
    v_cvt_pk_bf16_f32 v35, v50, v51
    v_cvt_pk_bf16_f32 v36, v52, v53
    v_cvt_pk_bf16_f32 v37, v54, v55
    v_cvt_pk_bf16_f32 v38, v56, v57
    v_cvt_pk_bf16_f32 v39, v58, v59
    s_nop 1
    v_mfma_f32_32x32x16_bf16 v[64:79], v[32:35], v[128:131], 0
    v_mfma_f32_32x32x16_bf16 v[64:79], v[36:39], v[132:135], v[64:79]
    v_mfma_f32_32x32x16_bf16 v[80:95], v[32:35], v[144:147], 0
    v_mfma_f32_32x32x16_bf16 v[80:95], v[36:39], v[148:151], v[80:95]
    s_lshl_b32 s28, s21, 2
    s_lshl_b32 s29, s22, 1
    s_add_u32 s28, s28, s29
    s_mul_i32 s28, s28, 40960
    s_add_u32 s28, s28, 229638144
    s_nop 7
    s_nop 3
    v_add_f32 v40, 0x358637bd, v72
    v_mov_b32 v41, v40
    s_nop 1
    v_permlane32_swap_b32 v40, v41
    v_rcp_f32 v41, v41
    s_nop 0
    v_mul_f32 v64, v64, v41
    v_mul_f32 v65, v65, v41
    v_mul_f32 v66, v66, v41
    v_mul_f32 v67, v67, v41
    v_mul_f32 v68, v68, v41
    v_mul_f32 v69, v69, v41
    v_mul_f32 v70, v70, v41
    v_mul_f32 v71, v71, v41
    v_mul_f32 v72, v72, v41
    v_mul_f32 v73, v73, v41
    v_mul_f32 v74, v74, v41
    v_mul_f32 v75, v75, v41
    v_cvt_pk_bf16_f32 v42, v64, v65
    v_cvt_pk_bf16_f32 v43, v66, v67
    v_cvt_pk_bf16_f32 v44, v68, v69
    v_cvt_pk_bf16_f32 v45, v70, v71
    v_cvt_pk_bf16_f32 v46, v72, v73
    v_cvt_pk_bf16_f32 v47, v74, v75
    buffer_store_dwordx2 v[42:43], v14, s[8:11], s28 offen offset:0 sc1
    buffer_store_dwordx2 v[44:45], v14, s[8:11], s28 offen offset:512 sc1
    s_mov_b32 exec_hi, 0
    buffer_store_dwordx2 v[46:47], v14, s[8:11], s28 offen offset:1024 sc1
    s_mov_b32 exec_hi, -1
    s_add_u32 s28, s28, 40960
    s_nop 7
    v_add_f32 v40, 0x358637bd, v88
    v_mov_b32 v41, v40
    s_nop 1
    v_permlane32_swap_b32 v40, v41
    v_rcp_f32 v41, v41
    s_nop 0
    v_mul_f32 v80, v80, v41
    v_mul_f32 v81, v81, v41
    v_mul_f32 v82, v82, v41
    v_mul_f32 v83, v83, v41
    v_mul_f32 v84, v84, v41
    v_mul_f32 v85, v85, v41
    v_mul_f32 v86, v86, v41
    v_mul_f32 v87, v87, v41
    v_mul_f32 v88, v88, v41
    v_mul_f32 v89, v89, v41
    v_mul_f32 v90, v90, v41
    v_mul_f32 v91, v91, v41
    v_cvt_pk_bf16_f32 v48, v80, v81
    v_cvt_pk_bf16_f32 v49, v82, v83
    v_cvt_pk_bf16_f32 v50, v84, v85
    v_cvt_pk_bf16_f32 v51, v86, v87
    v_cvt_pk_bf16_f32 v52, v88, v89
    v_cvt_pk_bf16_f32 v53, v90, v91
    buffer_store_dwordx2 v[48:49], v14, s[8:11], s28 offen offset:0 sc1
    buffer_store_dwordx2 v[50:51], v14, s[8:11], s28 offen offset:512 sc1
    s_mov_b32 exec_hi, 0
    buffer_store_dwordx2 v[52:53], v14, s[8:11], s28 offen offset:1024 sc1
    s_mov_b32 exec_hi, -1
    s_waitcnt vmcnt(0)
    s_barrier
    s_cmp_lg_u32 s13, 0
    s_cbranch_scc1 layerb1_kernel_af_pub
    s_lshl_b32 s28, s21, 4
    s_add_u32 s28, s28, s20
    s_lshl_b32 s28, s28, 2
    s_add_u32 s28, s28, s48
    s_add_u32 s28, s28, 49152
    v_mov_b32 v16, 0
    v_mov_b32 v17, 1
    s_mov_b64 exec, 1
    buffer_store_dword v17, v16, s[8:11], s28 offen sc1
    s_mov_b64 exec, -1
layerb1_kernel_af_pub:
    s_add_u32 s22, s4, 247463936
    s_addc_u32 s23, s5, 0
    s_cmp_eq_u32 s49, 0
    s_cselect_b32 s84, s22, s6
    s_cselect_b32 s85, s23, s7
    s_mov_b32 s86, 2621440
    s_mov_b32 s87, 0x00020000
    s_mov_b32 s20, s98
    s_mov_b32 s21, s99
    s_sub_u32 s22, 0, s4
    s_and_b32 s22, s22, 0x1fffff
    s_lshl_b32 s23, s49, 3
    s_add_u32 s23, s23, 10551296
    s_buffer_load_dwordx2 s[24:25], s[8:11], s23
    s_waitcnt lgkmcnt(0)
    s_and_b32 s24, s24, 8192
    s_and_b32 s25, s25, 8192
    s_lshl_b32 s82, s24, 1
    s_sub_u32 s82, 8192, s82
    s_lshl_b32 s83, s25, 1
    s_sub_u32 s83, 8192, s83
    s_mul_i32 s23, s49, 4194304
    s_add_u32 s22, s22, s23
    s_add_u32 s16, s22, s24
    s_add_u32 s17, s22, s25
    s_add_u32 s17, s17, 2097152
    s_mov_b32 s40, 0x01010101
    s_mov_b32 s41, 0x01010101
    s_mov_b32 s42, 0x00010001
    s_mov_b32 s43, 0
    v_lshlrev_b32 v1, 4, v0
    v_and_b32 v16, 8, v0
    v_cmp_eq_u32 vcc, 0, v16
    v_mov_b32 v17, 0xeeeeeeee
    v_mov_b32 v18, 0x44444444
    v_cndmask_b32 v2, v17, v18, vcc
    s_cmp_eq_u32 s20, 0
    s_cbranch_scc0 layerb1_kernel_notp
    s_mov_b32 s12, s21
    s_cmp_eq_u32 s13, 0
    s_cbranch_scc1 layerb1_kernel_p0_start
    s_cmp_eq_u32 s13, 1
    s_cbranch_scc1 layerb1_kernel_p1_start
    s_cmp_eq_u32 s13, 2
    s_cbranch_scc1 layerb1_kernel_p2_start
    s_cmp_eq_u32 s13, 3
    s_cbranch_scc1 layerb1_kernel_p3_start
layerb1_kernel_notp:
    s_cmp_ge_u32 s20, 4
    s_cbranch_scc1 layerb1_kernel_proj
    s_cmp_ge_u32 s21, 27
    s_cbranch_scc1 layerb1_kernel_spare
    s_sub_u32 s22, s20, 1
    s_mul_i32 s22, s22, 27
    s_add_u32 s12, s22, s21
    s_cmp_ge_u32 s12, 80
    s_cbranch_scc1 layerb1_kernel_spare
    s_cmp_eq_u32 s13, 0
    s_cbranch_scc1 layerb1_kernel_y0_start
    s_cmp_eq_u32 s13, 1
    s_cbranch_scc1 layerb1_kernel_y1_start
    s_cmp_eq_u32 s13, 2
    s_cbranch_scc1 layerb1_kernel_y2_start
    s_cmp_eq_u32 s13, 3
    s_cbranch_scc1 layerb1_kernel_y3_start
    s_branch layerb1_kernel_end
layerb1_kernel_p0_start:
    v_lshrrev_b32 v16, 4, v0
    v_and_b32 v17, 15, v0
    v_and_b32 v18, 2, v0
    v_cmp_eq_u32 vcc, 0, v18
    v_mov_b32 v18, 0xeeeeeeee
    v_mov_b32 v19, 0x44444444
    v_cndmask_b32 v2, v18, v19, vcc
    v_lshrrev_b32 v20, 2, v17
    v_lshlrev_b32 v20, 1, v20
    v_and_b32 v21, 1, v17
    v_add_u32 v20, v20, v21
    v_bfe_u32 v21, v17, 1, 1
    v_lshl_add_u32 v18, v16, 1, v21
    v_lshlrev_b32 v18, 7, v18
    v_lshl_add_u32 v12, v20, 4, v18
    v_mul_u32_u24 v18, 400, v20
    v_lshl_add_u32 v18, v16, 5, v18
    v_lshl_add_u32 v18, v21, 4, v18
    v_add_u32 v4, 141312, v18
    v_mul_u32_u24 v18, 800, v16
    v_lshl_add_u32 v18, v17, 1, v18
    v_add_u32 v3, 141312, v18
    v_and_b32 v18, 7, v0
    v_mul_u32_u24 v18, 400, v18
    v_lshl_add_u32 v18, v16, 5, v18
    v_add_u32 v5, 144512, v18
    v_lshlrev_b32 v18, 3, v0
    v_add_u32 v6, 147712, v18
    v_lshlrev_b32 v18, 4, v16
    v_bfe_u32 v19, v17, 1, 2
    v_lshl_add_u32 v18, v19, 2, v18
    s_lshl_b32 s20, s12, 7
    s_add_u32 s20, s20, 0
    v_add_u32 v18, s20, v18
    v_lshrrev_b32 v19, 3, v17
    v_add_u32 v19, 1, v19
    v_lshrrev_b32 v20, 1, v19
    v_lshlrev_b32 v20, 14, v20
    v_and_b32 v19, 1, v19
    v_lshl_add_u32 v19, v19, 12, v20
    v_add_u32 v19, v19, v18
    v_mov_b32 v20, 0x7ffffff0
    v_and_b32 v21, 1, v0
    v_cmp_eq_u32 vcc, 0, v21
    s_nop 1
    v_cndmask_b32 v7, v20, v19, vcc
    v_and_b32 v21, 0x29, v0
    v_cmp_eq_u32 vcc, 0, v21
    s_nop 1
    v_cndmask_b32 v8, v20, v18, vcc
    v_lshlrev_b32 v18, 4, v17
    v_lshl_add_u32 v18, v16, 10, v18
    v_add_u32 v9, 0, v18
    v_add_u32 v18, 0, v0
    v_mul_u32_u24 v19, 2731, v18
    v_lshrrev_b32 v19, 16, v19
    v_mul_u32_u24 v20, 24, v19
    v_sub_u32 v20, v18, v20
    v_mul_u32_u24 v21, 400, v19
    v_lshl_add_u32 v21, v20, 4, v21
    v_add_u32 v10, 144512, v21
    v_lshlrev_b32 v21, 4, v19
    v_lshl_add_u32 v11, v20, 7, v21
    v_add_u32 v13, 0, v1
    v_add_u32 v14, 131072, v1
    s_mul_i32 s44, s12, 12288
    s_add_u32 s44, s44, 53477376
    s_mul_i32 s45, s12, 3072
    s_add_u32 s45, s45, 208666624
    s_mul_i32 s20, s12, 6
    s_add_u32 s21, s20, 5
    s_lshr_b32 s20, s20, 3
    s_lshr_b32 s21, s21, 3
    s_add_u32 s20, s20, 80
    s_add_u32 s21, s21, 80
    s_lshl_b32 s20, s20, 7
    s_lshl_b32 s21, s21, 7
    v_mov_b32 v255, s21
    v_mov_b32 v253, s20
    v_cmp_eq_u32 vcc, 0, v0
    s_nop 1
    v_cndmask_b32 v255, v255, v253, vcc
    s_mov_b32 s47, 0
    s_mul_i32 s20, s12, 491520
    s_add_u32 s20, s20, 11534336
    s_add_u32 s21, s20, 22528
    buffer_load_dwordx4 v[16:19], v1, s[8:11], s21 offen offset:0
    buffer_load_dwordx4 v[20:23], v1, s[8:11], s21 offen offset:1024
    s_add_u32 s21, s20, 4096
    buffer_load_dwordx4 v[24:27], v1, s[8:11], s21 offen offset:0
    buffer_load_dwordx4 v[28:31], v1, s[8:11], s21 offen offset:1024
    s_add_u32 s21, s20, 45056
    buffer_load_dwordx4 v[32:35], v1, s[8:11], s21 offen offset:0
    buffer_load_dwordx4 v[36:39], v1, s[8:11], s21 offen offset:1024
    s_add_u32 s21, s20, 8192
    buffer_load_dwordx4 v[40:43], v1, s[8:11], s21 offen offset:0
    buffer_load_dwordx4 v[44:47], v1, s[8:11], s21 offen offset:1024
    s_add_u32 s21, s20, 12288
    buffer_load_dwordx4 v[48:51], v1, s[8:11], s21 offen offset:0
    buffer_load_dwordx4 v[52:55], v1, s[8:11], s21 offen offset:1024
    s_add_u32 s21, s20, 16384
    buffer_load_dwordx4 v[56:59], v1, s[8:11], s21 offen offset:0
    buffer_load_dwordx4 v[60:63], v1, s[8:11], s21 offen offset:1024
    s_add_u32 s21, s20, 26624
    buffer_load_dwordx4 v[64:67], v1, s[8:11], s21 offen offset:0
    buffer_load_dwordx4 v[68:71], v1, s[8:11], s21 offen offset:1024
    s_add_u32 s21, s20, 30720
    buffer_load_dwordx4 v[72:75], v1, s[8:11], s21 offen offset:0
    buffer_load_dwordx4 v[76:79], v1, s[8:11], s21 offen offset:1024
    s_add_u32 s21, s20, 34816
    buffer_load_dwordx4 v[80:83], v1, s[8:11], s21 offen offset:0
    buffer_load_dwordx4 v[84:87], v1, s[8:11], s21 offen offset:1024
    s_add_u32 s21, s20, 38912
    buffer_load_dwordx4 v[88:91], v1, s[8:11], s21 offen offset:0
    buffer_load_dwordx4 v[92:95], v1, s[8:11], s21 offen offset:1024
    s_add_u32 s21, s20, 49152
    buffer_load_dwordx4 v[96:99], v1, s[8:11], s21 offen offset:0
    buffer_load_dwordx4 v[100:103], v1, s[8:11], s21 offen offset:1024
    s_add_u32 s21, s20, 53248
    buffer_load_dwordx4 v[104:107], v1, s[8:11], s21 offen offset:0
    buffer_load_dwordx4 v[108:111], v1, s[8:11], s21 offen offset:1024
    s_add_u32 s21, s20, 63488
    buffer_load_dwordx4 v[112:115], v1, s[8:11], s21 offen offset:0
    buffer_load_dwordx4 v[116:119], v1, s[8:11], s21 offen offset:1024
    s_add_u32 s21, s20, 71680
    buffer_load_dwordx4 v[120:123], v1, s[8:11], s21 offen offset:0
    buffer_load_dwordx4 v[124:127], v1, s[8:11], s21 offen offset:1024
    s_add_u32 s21, s20, 79872
    buffer_load_dwordx4 v[128:131], v1, s[8:11], s21 offen offset:0
    buffer_load_dwordx4 v[132:135], v1, s[8:11], s21 offen offset:1024
    s_add_u32 s21, s20, 94208
    buffer_load_dwordx4 v[136:139], v1, s[8:11], s21 offen offset:0
    buffer_load_dwordx4 v[140:143], v1, s[8:11], s21 offen offset:1024
    s_add_u32 s21, s20, 98304
    buffer_load_dwordx4 v[156:159], v1, s[8:11], s21 offen offset:0
    buffer_load_dwordx4 v[160:163], v1, s[8:11], s21 offen offset:1024
    s_add_u32 s21, s20, 100352
    buffer_load_dwordx4 v[164:167], v1, s[8:11], s21 offen offset:0
    buffer_load_dwordx4 v[168:171], v1, s[8:11], s21 offen offset:1024
    s_add_u32 s21, s20, 102400
    buffer_load_dwordx4 v[172:175], v1, s[8:11], s21 offen offset:0
    buffer_load_dwordx4 v[176:179], v1, s[8:11], s21 offen offset:1024
    s_add_u32 s21, s20, 104448
    buffer_load_dwordx4 v[180:183], v1, s[8:11], s21 offen offset:0
    buffer_load_dwordx4 v[184:187], v1, s[8:11], s21 offen offset:1024
    s_add_u32 s21, s20, 106496
    buffer_load_dwordx4 v[188:191], v1, s[8:11], s21 offen offset:0
    buffer_load_dwordx4 v[192:195], v1, s[8:11], s21 offen offset:1024
    s_add_u32 s21, s20, 108544
    buffer_load_dwordx4 v[196:199], v1, s[8:11], s21 offen offset:0
    buffer_load_dwordx4 v[200:203], v1, s[8:11], s21 offen offset:1024
    s_add_u32 s21, s20, 110592
    buffer_load_dwordx4 v[204:207], v1, s[8:11], s21 offen offset:0
    buffer_load_dwordx4 v[208:211], v1, s[8:11], s21 offen offset:1024
    s_add_u32 s21, s20, 112640
    buffer_load_dwordx4 v[212:215], v1, s[8:11], s21 offen offset:0
    buffer_load_dwordx4 v[216:219], v1, s[8:11], s21 offen offset:1024
    s_add_u32 s21, s20, 114688
    buffer_load_dwordx4 v[220:223], v1, s[8:11], s21 offen offset:0
    buffer_load_dwordx4 v[224:227], v1, s[8:11], s21 offen offset:1024
    s_add_u32 s21, s20, 116736
    buffer_load_dwordx4 v[228:231], v1, s[8:11], s21 offen offset:0
    buffer_load_dwordx4 v[232:235], v1, s[8:11], s21 offen offset:1024
    s_add_u32 s21, s20, 118784
    buffer_load_dwordx4 v[236:239], v1, s[8:11], s21 offen offset:0
    buffer_load_dwordx4 v[240:243], v1, s[8:11], s21 offen offset:1024
    s_add_u32 s21, s20, 120832
    buffer_load_dwordx4 v[244:247], v1, s[8:11], s21 offen offset:0
    buffer_load_dwordx4 v[248:251], v1, s[8:11], s21 offen offset:1024
    s_waitcnt vmcnt(24)
    ds_write_b128 v13, v[16:19] offset:0
    ds_write_b128 v13, v[20:23] offset:1024
    ds_write_b128 v13, v[24:27] offset:2048
    ds_write_b128 v13, v[28:31] offset:3072
    ds_write_b128 v13, v[32:35] offset:4096
    ds_write_b128 v13, v[36:39] offset:5120
    ds_write_b128 v13, v[40:43] offset:6144
    ds_write_b128 v13, v[44:47] offset:7168
    ds_write_b128 v13, v[48:51] offset:8192
    ds_write_b128 v13, v[52:55] offset:9216
    ds_write_b128 v13, v[56:59] offset:10240
    ds_write_b128 v13, v[60:63] offset:11264
    ds_write_b128 v13, v[64:67] offset:12288
    ds_write_b128 v13, v[68:71] offset:13312
    ds_write_b128 v13, v[72:75] offset:14336
    ds_write_b128 v13, v[76:79] offset:15360
    ds_write_b128 v13, v[80:83] offset:16384
    ds_write_b128 v13, v[84:87] offset:17408
    ds_write_b128 v13, v[88:91] offset:18432
    ds_write_b128 v13, v[92:95] offset:19456
    ds_write_b128 v13, v[96:99] offset:20480
    ds_write_b128 v13, v[100:103] offset:21504
    ds_write_b128 v13, v[104:107] offset:22528
    ds_write_b128 v13, v[108:111] offset:23552
    ds_write_b128 v13, v[112:115] offset:24576
    ds_write_b128 v13, v[116:119] offset:25600
    ds_write_b128 v13, v[120:123] offset:26624
    ds_write_b128 v13, v[124:127] offset:27648
    ds_write_b128 v13, v[128:131] offset:28672
    ds_write_b128 v13, v[132:135] offset:29696
    ds_write_b128 v13, v[136:139] offset:30720
    ds_write_b128 v13, v[140:143] offset:31744
    s_waitcnt lgkmcnt(0)
    s_mov_b32 s14, 0
    s_cmp_gt_u32 s47, s14
    s_cbranch_scc1 layerb1_kernel_p0_gw1_ok
layerb1_kernel_p0_gw1_lp:
    buffer_load_dword v253, v255, s[8:11], s48 offen sc1
    s_waitcnt vmcnt(0)
    v_readlane_b32 s47, v253, 0
    v_readlane_b32 s29, v253, 1
    s_nop 0
    s_min_u32 s47, s47, s29
    s_sub_u32 s15, s15, 1
    s_cbranch_scc1 layerb1_kernel_bail
    s_cmp_gt_u32 s47, s14
    s_cbranch_scc0 layerb1_kernel_p0_gw1_lp
layerb1_kernel_p0_gw1_ok:
    s_mul_i32 s20, s14, 393216
    s_add_u32 s20, s20, s44
    s_add_u32 s21, s20, 0
    buffer_load_dwordx4 v[100:103], v9, s[8:11], s21 offen offset:0 sc1
    buffer_load_dwordx4 v[104:107], v9, s[8:11], s21 offen offset:512 sc1
    s_add_u32 s21, s20, 4096
    buffer_load_dwordx4 v[108:111], v9, s[8:11], s21 offen offset:0 sc1
    buffer_load_dwordx4 v[112:115], v9, s[8:11], s21 offen offset:512 sc1
    s_add_u32 s21, s20, 8192
    buffer_load_dwordx4 v[116:119], v9, s[8:11], s21 offen offset:0 sc1
    buffer_load_dwordx4 v[120:123], v9, s[8:11], s21 offen offset:512 sc1
    v_mov_b32 v56, 0
    v_mov_b32 v57, 0
    v_mov_b32 v58, 0
    v_mov_b32 v59, 0
    v_mov_b32 v60, 0
    v_mov_b32 v61, 0
    v_mov_b32 v62, 0
    v_mov_b32 v63, 0
    v_mov_b32 v64, 0
    v_mov_b32 v65, 0
    v_mov_b32 v66, 0
    v_mov_b32 v67, 0
    v_mov_b32 v68, 0
    v_mov_b32 v69, 0
    v_mov_b32 v70, 0
    v_mov_b32 v71, 0
    v_mov_b32 v72, 0
    v_mov_b32 v73, 0
    v_mov_b32 v74, 0
    v_mov_b32 v75, 0
    v_mov_b32 v76, 0
    v_mov_b32 v77, 0
    v_mov_b32 v78, 0
    v_mov_b32 v79, 0
    v_mov_b32 v80, 0
    v_mov_b32 v81, 0
    v_mov_b32 v82, 0
    v_mov_b32 v83, 0
    v_mov_b32 v84, 0
    v_mov_b32 v85, 0
    v_mov_b32 v86, 0
    v_mov_b32 v87, 0
    ds_read_b128 v[124:127], v13 offset:0
    ds_read_b128 v[128:131], v13 offset:1024
    ds_read_b128 v[132:135], v13 offset:2048
    ds_read_b128 v[136:139], v13 offset:3072
    ds_read_b128 v[140:143], v13 offset:4096
    ds_read_b128 v[144:147], v13 offset:5120
    ds_read_b128 v[148:151], v13 offset:6144
    ds_read_b128 v[152:155], v13 offset:7168
    s_waitcnt lgkmcnt(0)
layerb1_kernel_p0_step:
    s_cmp_lt_u32 s14, 32
    s_cselect_b32 s18, s16, s17
    s_and_b32 s20, s14, 31
    s_lshl_b32 s20, s20, 16
    s_add_u32 s18, s18, s20
    s_add_u32 s22, s18, 36864
    s_add_u32 s23, s18, 37888
    s_add_u32 s24, s18, 38912
layerb1_kernel_p0_poll:
    buffer_load_dwordx4 v[16:19], v12, s[8:11], s22 offen sc1
    buffer_load_dwordx4 v[20:23], v12, s[8:11], s23 offen sc1
    buffer_load_dwordx4 v[24:27], v12, s[8:11], s24 offen sc1
    s_waitcnt vmcnt(0)
    ds_write_b128 v14, v[16:19] offset:0
    ds_write_b128 v14, v[20:23] offset:1024
    ds_write_b128 v14, v[24:27] offset:2048
    v_max3_u32 v88, v16, v17, v18
    v_max3_u32 v88, v88, v19, v20
    v_max3_u32 v88, v88, v21, v22
    v_max3_u32 v88, v88, v23, v24
    v_max3_u32 v88, v88, v25, v26
    v_max_u32 v88, v88, v27
    v_cmp_eq_u32 vcc, -1, v88
    s_sub_u32 s15, s15, 1
    s_cbranch_scc1 layerb1_kernel_bail
    s_cbranch_vccnz layerb1_kernel_p0_poll
    v_smfmac_f32_16x16x64_bf16 v[56:59], v[16:19], a[0:7], v2
    v_smfmac_f32_16x16x64_bf16 v[60:63], v[16:19], a[8:15], v2
    s_waitcnt lgkmcnt(0)
    s_barrier
    ds_read_b128 v[28:31], v14 offset:3072
    ds_read_b128 v[32:35], v14 offset:4096
    ds_read_b128 v[36:39], v14 offset:5120
    v_smfmac_f32_16x16x64_bf16 v[64:67], v[16:19], a[16:23], v2
    ds_read_b128 v[40:43], v14 offset:6144
    ds_read_b128 v[44:47], v14 offset:7168
    v_smfmac_f32_16x16x64_bf16 v[56:59], v[20:23], a[24:31], v2
    ds_read_b128 v[48:51], v14 offset:8192
    ds_read_b128 v[52:55], v14 offset:9216
    v_smfmac_f32_16x16x64_bf16 v[60:63], v[20:23], v[124:131], v2
    ds_read_b128 v[124:127], v13 offset:8192
    ds_read_b128 v[128:131], v13 offset:9216
    v_smfmac_f32_16x16x64_bf16 v[64:67], v[20:23], a[32:39], v2
    v_smfmac_f32_16x16x64_bf16 v[56:59], v[24:27], v[132:139], v2
    ds_read_b128 v[132:135], v13 offset:10240
    ds_read_b128 v[136:139], v13 offset:11264
    v_smfmac_f32_16x16x64_bf16 v[60:63], v[24:27], a[40:47], v2
    v_smfmac_f32_16x16x64_bf16 v[64:67], v[24:27], v[140:147], v2
    ds_read_b128 v[140:143], v13 offset:12288
    ds_read_b128 v[144:147], v13 offset:13312
    s_waitcnt lgkmcnt(12)
    v_smfmac_f32_16x16x64_bf16 v[56:59], v[28:31], a[48:55], v2
    s_waitcnt lgkmcnt(11)
    v_smfmac_f32_16x16x64_bf16 v[56:59], v[32:35], v[148:155], v2
    ds_read_b128 v[148:151], v13 offset:14336
    ds_read_b128 v[152:155], v13 offset:15360
    s_waitcnt lgkmcnt(12)
    v_smfmac_f32_16x16x64_bf16 v[56:59], v[36:39], a[56:63], v2
    s_waitcnt lgkmcnt(11)
    s_waitcnt lgkmcnt(6)
    v_smfmac_f32_16x16x64_bf16 v[56:59], v[40:43], v[124:131], v2
    ds_read_b128 v[124:127], v13 offset:16384
    ds_read_b128 v[128:131], v13 offset:17408
    v_smfmac_f32_16x16x64_bf16 v[56:59], v[44:47], a[64:71], v2
    s_waitcnt lgkmcnt(6)
    v_smfmac_f32_16x16x64_bf16 v[56:59], v[48:51], v[132:139], v2
    ds_read_b128 v[132:135], v13 offset:18432
    ds_read_b128 v[136:139], v13 offset:19456
    v_smfmac_f32_16x16x64_bf16 v[56:59], v[52:55], a[72:79], v2
    s_waitcnt lgkmcnt(6)
    v_smfmac_f32_16x16x64_bf16 v[60:63], v[28:31], v[140:147], v2
    ds_read_b128 v[140:143], v13 offset:20480
    ds_read_b128 v[144:147], v13 offset:21504
    v_smfmac_f32_16x16x64_bf16 v[60:63], v[32:35], a[80:87], v2
    v_add_f32 v56, v56, v58
    v_add_f32 v57, v57, v59
    s_waitcnt lgkmcnt(6)
    v_smfmac_f32_16x16x64_bf16 v[60:63], v[36:39], v[148:155], v2
    ds_read_b128 v[148:151], v13 offset:22528
    ds_read_b128 v[152:155], v13 offset:23552
    v_smfmac_f32_16x16x64_bf16 v[60:63], v[40:43], a[88:95], v2
    v_cvt_pk_bf16_f32 v56, v56, v57
    ds_write_b16 v3, v56 offset:0
    s_waitcnt lgkmcnt(7)
    v_smfmac_f32_16x16x64_bf16 v[60:63], v[44:47], v[124:131], v2
    ds_read_b128 v[124:127], v13 offset:24576
    ds_read_b128 v[128:131], v13 offset:25600
    v_smfmac_f32_16x16x64_bf16 v[60:63], v[48:51], a[96:103], v2
    ds_write_b16_d16_hi v3, v56 offset:400
    s_waitcnt lgkmcnt(8)
    v_smfmac_f32_16x16x64_bf16 v[60:63], v[52:55], v[132:139], v2
    ds_read_b128 v[132:135], v13 offset:26624
    ds_read_b128 v[136:139], v13 offset:27648
    v_smfmac_f32_16x16x64_bf16 v[64:67], v[28:31], a[104:111], v2
    s_waitcnt lgkmcnt(8)
    v_smfmac_f32_16x16x64_bf16 v[64:67], v[32:35], v[140:147], v2
    ds_read_b128 v[140:143], v13 offset:28672
    ds_read_b128 v[144:147], v13 offset:29696
    v_smfmac_f32_16x16x64_bf16 v[64:67], v[36:39], a[112:119], v2
    v_add_f32 v60, v60, v62
    v_add_f32 v61, v61, v63
    s_waitcnt lgkmcnt(8)
    v_smfmac_f32_16x16x64_bf16 v[64:67], v[40:43], v[148:155], v2
    ds_read_b128 v[148:151], v13 offset:30720
    ds_read_b128 v[152:155], v13 offset:31744
    v_smfmac_f32_16x16x64_bf16 v[64:67], v[44:47], a[120:127], v2
    v_cvt_pk_bf16_f32 v60, v60, v61
    ds_write_b16 v3, v60 offset:128
    v_smfmac_f32_16x16x64_bf16 v[64:67], v[48:51], a[128:135], v2
    ds_write_b16_d16_hi v3, v60 offset:528
    v_smfmac_f32_16x16x64_bf16 v[64:67], v[52:55], a[136:143], v2
    v_smfmac_f32_16x16x64_bf16 v[68:71], v[16:19], a[144:151], v2
    s_waitcnt lgkmcnt(9)
    v_smfmac_f32_16x16x64_bf16 v[68:71], v[20:23], v[124:131], v2
    v_add_f32 v64, v64, v66
    v_add_f32 v65, v65, v67
    v_smfmac_f32_16x16x64_bf16 v[68:71], v[24:27], a[152:159], v2
    v_cvt_pk_bf16_f32 v64, v64, v65
    ds_write_b16 v3, v64 offset:256
    v_smfmac_f32_16x16x64_bf16 v[68:71], v[28:31], a[160:167], v2
    ds_write_b16_d16_hi v3, v64 offset:656
    v_smfmac_f32_16x16x64_bf16 v[68:71], v[32:35], a[168:175], v2
    s_waitcnt lgkmcnt(8)
    v_smfmac_f32_16x16x64_bf16 v[68:71], v[36:39], v[132:139], v2
    v_smfmac_f32_16x16x64_bf16 v[68:71], v[40:43], a[176:183], v2
    s_waitcnt lgkmcnt(0)
    s_barrier
    ds_read_b128 v[88:91], v4 offset:0
    v_smfmac_f32_16x16x64_bf16 v[68:71], v[44:47], a[184:191], v2
    ds_read_b128 v[92:95], v4 offset:128
    ds_read_b128 v[96:99], v4 offset:256
    v_smfmac_f32_16x16x64_bf16 v[68:71], v[48:51], a[192:199], v2
    v_smfmac_f32_16x16x64_bf16 v[68:71], v[52:55], v[140:147], v2
    v_smfmac_f32_16x16x64_bf16 v[72:75], v[16:19], a[200:207], v2
    v_smfmac_f32_16x16x64_bf16 v[72:75], v[20:23], a[208:215], v2
    v_add_f32 v68, v68, v70
    v_add_f32 v69, v69, v71
    v_smfmac_f32_16x16x64_bf16 v[72:75], v[24:27], a[216:223], v2
    v_cvt_pk_bf16_f32 v68, v68, v69
    ds_write_b16 v3, v68 offset:3200
    s_waitcnt lgkmcnt(1)
    v_smfmac_f32_16x16x64_bf16 v[80:83], v[88:91], v[100:107], v2
    v_smfmac_f32_16x16x64_bf16 v[80:83], v[92:95], v[108:115], v2
    v_smfmac_f32_16x16x64_bf16 v[80:83], v[96:99], v[116:123], v2
    v_smfmac_f32_16x16x64_bf16 v[72:75], v[28:31], a[224:231], v2
    ds_write_b16_d16_hi v3, v68 offset:3600
    v_smfmac_f32_16x16x64_bf16 v[72:75], v[32:35], a[232:239], v2
    v_add_f32 v56, v80, v82
    v_mul_f32 v56, 0x3dd53b95, v56
    v_smfmac_f32_16x16x64_bf16 v[72:75], v[36:39], a[240:247], v2
    v_max_f32_dpp v58, v56, v56 row_ror:8 row_mask:0xf bank_mask:0xf
    v_smfmac_f32_16x16x64_bf16 v[72:75], v[40:43], v[148:155], v2
    v_max_f32_dpp v58, v58, v58 row_ror:4 row_mask:0xf bank_mask:0xf
    v_smfmac_f32_16x16x64_bf16 v[72:75], v[44:47], a[248:255], v2
    v_max_f32_dpp v58, v58, v58 row_ror:2 row_mask:0xf bank_mask:0xf
    v_smfmac_f32_16x16x64_bf16 v[72:75], v[48:51], v[156:163], v2
    v_max_f32_dpp v58, v58, v58 row_ror:1 row_mask:0xf bank_mask:0xf
    v_smfmac_f32_16x16x64_bf16 v[72:75], v[52:55], v[164:171], v2
    v_sub_f32 v60, v56, v58
    v_exp_f32 v60, v60
    v_smfmac_f32_16x16x64_bf16 v[76:79], v[16:19], v[172:179], v2
    v_add_f32_dpp v59, v60, v60 row_ror:8 row_mask:0xf bank_mask:0xf
    v_smfmac_f32_16x16x64_bf16 v[76:79], v[20:23], v[180:187], v2
    v_add_f32_dpp v59, v59, v59 row_ror:4 row_mask:0xf bank_mask:0xf
    v_add_f32 v72, v72, v74
    v_smfmac_f32_16x16x64_bf16 v[76:79], v[24:27], v[188:195], v2
    v_add_f32_dpp v59, v59, v59 row_ror:2 row_mask:0xf bank_mask:0xf
    v_add_f32 v73, v73, v75
    v_smfmac_f32_16x16x64_bf16 v[76:79], v[28:31], v[196:203], v2
    v_add_f32_dpp v59, v59, v59 row_ror:1 row_mask:0xf bank_mask:0xf
    v_cvt_pk_bf16_f32 v72, v72, v73
    v_smfmac_f32_16x16x64_bf16 v[76:79], v[32:35], v[204:211], v2
    ds_write_b64 v6, v[58:59] offset:0
    ds_write_b16 v3, v72 offset:3328
    v_smfmac_f32_16x16x64_bf16 v[76:79], v[36:39], v[212:219], v2
    ds_write_b16_d16_hi v3, v72 offset:3728
    v_smfmac_f32_16x16x64_bf16 v[76:79], v[40:43], v[220:227], v2
    s_waitcnt lgkmcnt(0)
    s_barrier
    ds_read_b128 v[100:103], v5 offset:0
    ds_read_b128 v[104:107], v5 offset:16
    v_smfmac_f32_16x16x64_bf16 v[76:79], v[44:47], v[228:235], v2
    ds_read_b128 v[108:111], v5 offset:128
    ds_read_b128 v[112:115], v5 offset:144
    v_smfmac_f32_16x16x64_bf16 v[76:79], v[48:51], v[236:243], v2
    v_smfmac_f32_16x16x64_bf16 v[76:79], v[52:55], v[244:251], v2
    s_waitcnt lgkmcnt(2)
    v_smfmac_f32_16x16x64_bf16 v[84:87], v[88:91], v[100:107], v2
    s_waitcnt lgkmcnt(0)
    v_smfmac_f32_16x16x64_bf16 v[84:87], v[92:95], v[108:115], v2
    v_add_f32 v76, v76, v78
    v_add_f32 v77, v77, v79
    v_cvt_pk_bf16_f32 v76, v76, v77
    ds_write_b16 v3, v76 offset:3456
    ds_write_b16_d16_hi v3, v76 offset:3856
    s_waitcnt lgkmcnt(0)
    s_barrier
    ds_read_b128 v[116:119], v5 offset:256
    ds_read_b128 v[120:123], v5 offset:272
    ds_read_b64 v[16:17], v6 offset:512
    s_waitcnt lgkmcnt(1)
    v_smfmac_f32_16x16x64_bf16 v[84:87], v[96:99], v[116:123], v2
    s_waitcnt lgkmcnt(0)
    v_max_f32 v18, v58, v16
    v_sub_f32 v19, v58, v18
    v_sub_f32 v20, v16, v18
    v_exp_f32 v19, v19
    v_exp_f32 v20, v20
    s_nop 0
    v_mul_f32 v21, v59, v19
    v_mul_f32 v60, v60, v19
    v_fmac_f32 v21, v17, v20
    v_add_f32 v22, v84, v86
    v_mul_f32 v22, 0x3dd53b95, v22
    v_max_f32 v23, v22, v18
    s_nop 0
    v_max_f32_dpp v24, v22, v23 row_ror:4 row_mask:0xf bank_mask:0xf
    s_nop 1
    v_max_f32_dpp v24, v24, v24 row_ror:2 row_mask:0xf bank_mask:0xf
    s_nop 1
    v_max_f32_dpp v24, v24, v24 row_ror:1 row_mask:0xf bank_mask:0xf
    v_sub_f32 v25, v22, v24
    v_sub_f32 v26, v18, v24
    v_exp_f32 v25, v25
    v_exp_f32 v26, v26
    s_nop 0
    v_add_f32_dpp v23, v25, v25 row_ror:4 row_mask:0xf bank_mask:0xf
    v_mul_f32 v60, v60, v26
    s_nop 0
    v_add_f32_dpp v23, v23, v23 row_ror:2 row_mask:0xf bank_mask:0xf
    s_nop 1
    v_add_f32_dpp v23, v23, v23 row_ror:1 row_mask:0xf bank_mask:0xf
    v_fmac_f32 v23, v26, v21
    v_rcp_f32 v27, v23
    s_nop 0
    v_mul_f32 v60, v60, v27
    v_mul_f32 v25, v25, v27
    s_nop 0
    v_mov_b32_dpp v19, v60 quad_perm:[1,0,3,2] row_mask:0xf bank_mask:0xf
    v_mov_b32_dpp v20, v25 quad_perm:[1,0,3,2] row_mask:0xf bank_mask:0xf
    v_cvt_pk_bf16_f32 v60, v60, v19
    v_cvt_pk_bf16_f32 v25, v25, v20
    buffer_store_dword v60, v7, s[8:11], s18 offen sc1
    buffer_store_dword v25, v8, s[8:11], s18 offen sc1
    ds_read_b128 v[40:43], v10
    s_add_u32 s28, s14, 1
    s_min_u32 s28, s28, 63
    s_cmp_gt_u32 s47, s28
    s_cbranch_scc1 layerb1_kernel_p0_gw2_ok
layerb1_kernel_p0_gw2_lp:
    buffer_load_dword v253, v255, s[8:11], s48 offen sc1
    s_waitcnt vmcnt(0)
    v_readlane_b32 s47, v253, 0
    v_readlane_b32 s29, v253, 1
    s_nop 0
    s_min_u32 s47, s47, s29
    s_sub_u32 s15, s15, 1
    s_cbranch_scc1 layerb1_kernel_bail
    s_cmp_gt_u32 s47, s28
    s_cbranch_scc0 layerb1_kernel_p0_gw2_lp
layerb1_kernel_p0_gw2_ok:
    s_mul_i32 s20, s28, 393216
    s_add_u32 s20, s20, s44
    s_add_u32 s21, s20, 0
    buffer_load_dwordx4 v[100:103], v9, s[8:11], s21 offen offset:0 sc1
    buffer_load_dwordx4 v[104:107], v9, s[8:11], s21 offen offset:512 sc1
    s_add_u32 s21, s20, 4096
    buffer_load_dwordx4 v[108:111], v9, s[8:11], s21 offen offset:0 sc1
    buffer_load_dwordx4 v[112:115], v9, s[8:11], s21 offen offset:512 sc1
    s_add_u32 s21, s20, 8192
    buffer_load_dwordx4 v[116:119], v9, s[8:11], s21 offen offset:0 sc1
    buffer_load_dwordx4 v[120:123], v9, s[8:11], s21 offen offset:512 sc1
    v_mov_b32 v56, 0
    v_mov_b32 v57, 0
    v_mov_b32 v58, 0
    v_mov_b32 v59, 0
    v_mov_b32 v60, 0
    v_mov_b32 v61, 0
    v_mov_b32 v62, 0
    v_mov_b32 v63, 0
    v_mov_b32 v64, 0
    v_mov_b32 v65, 0
    v_mov_b32 v66, 0
    v_mov_b32 v67, 0
    v_mov_b32 v68, 0
    v_mov_b32 v69, 0
    v_mov_b32 v70, 0
    v_mov_b32 v71, 0
    v_mov_b32 v72, 0
    v_mov_b32 v73, 0
    v_mov_b32 v74, 0
    v_mov_b32 v75, 0
    v_mov_b32 v76, 0
    v_mov_b32 v77, 0
    v_mov_b32 v78, 0
    v_mov_b32 v79, 0
    v_mov_b32 v80, 0
    v_mov_b32 v81, 0
    v_mov_b32 v82, 0
    v_mov_b32 v83, 0
    v_mov_b32 v84, 0
    v_mov_b32 v85, 0
    v_mov_b32 v86, 0
    v_mov_b32 v87, 0
    s_waitcnt lgkmcnt(0)
    s_mul_i32 s20, s14, 98304
    s_add_u32 s20, s20, s45
    buffer_store_dwordx4 v[40:43], v11, s[8:11], s20 offen sc1
    ds_read_b128 v[124:127], v13 offset:0
    ds_read_b128 v[128:131], v13 offset:1024
    ds_read_b128 v[132:135], v13 offset:2048
    ds_read_b128 v[136:139], v13 offset:3072
    ds_read_b128 v[140:143], v13 offset:4096
    ds_read_b128 v[144:147], v13 offset:5120
    ds_read_b128 v[148:151], v13 offset:6144
    ds_read_b128 v[152:155], v13 offset:7168
    s_waitcnt lgkmcnt(0)
    s_add_u32 s14, s14, 1
    s_cmp_lt_u32 s14, 64
    s_cbranch_scc1 layerb1_kernel_p0_step
    s_waitcnt vmcnt(0)
    s_barrier
    s_branch layerb1_kernel_end
layerb1_kernel_p1_start:
    v_lshrrev_b32 v16, 4, v0
    v_and_b32 v17, 15, v0
    v_and_b32 v18, 2, v0
    v_cmp_eq_u32 vcc, 0, v18
    v_mov_b32 v18, 0xeeeeeeee
    v_mov_b32 v19, 0x44444444
    v_cndmask_b32 v2, v18, v19, vcc
    v_lshrrev_b32 v20, 2, v17
    v_lshlrev_b32 v20, 1, v20
    v_and_b32 v21, 1, v17
    v_add_u32 v20, v20, v21
    v_bfe_u32 v21, v17, 1, 1
    v_lshl_add_u32 v18, v16, 1, v21
    v_lshlrev_b32 v18, 7, v18
    v_lshl_add_u32 v12, v20, 4, v18
    v_mul_u32_u24 v18, 400, v20
    v_lshl_add_u32 v18, v16, 5, v18
    v_lshl_add_u32 v18, v21, 4, v18
    v_add_u32 v4, 141312, v18
    v_mul_u32_u24 v18, 800, v16
    v_lshl_add_u32 v18, v17, 1, v18
    v_add_u32 v3, 141344, v18
    v_and_b32 v18, 7, v0
    v_mul_u32_u24 v18, 400, v18
    v_lshl_add_u32 v18, v16, 5, v18
    v_add_u32 v5, 144512, v18
    v_lshlrev_b32 v18, 3, v0
    v_add_u32 v6, 147712, v18
    v_lshlrev_b32 v18, 4, v16
    v_bfe_u32 v19, v17, 1, 2
    v_lshl_add_u32 v18, v19, 2, v18
    s_lshl_b32 s20, s12, 7
    s_add_u32 s20, s20, 0
    v_add_u32 v18, s20, v18
    v_lshrrev_b32 v19, 3, v17
    v_add_u32 v19, 3, v19
    v_lshrrev_b32 v20, 1, v19
    v_lshlrev_b32 v20, 14, v20
    v_and_b32 v19, 1, v19
    v_lshl_add_u32 v19, v19, 12, v20
    v_add_u32 v19, v19, v18
    v_mov_b32 v20, 0x7ffffff0
    v_and_b32 v21, 1, v0
    v_cmp_eq_u32 vcc, 0, v21
    s_nop 1
    v_cndmask_b32 v7, v20, v19, vcc
    v_and_b32 v21, 0x29, v0
    v_cmp_eq_u32 vcc, 32, v21
    s_nop 1
    v_cndmask_b32 v8, v20, v18, vcc
    v_lshlrev_b32 v18, 4, v17
    v_lshl_add_u32 v18, v16, 10, v18
    v_add_u32 v9, 256, v18
    v_add_u32 v18, 64, v0
    v_mul_u32_u24 v19, 2731, v18
    v_lshrrev_b32 v19, 16, v19
    v_mul_u32_u24 v20, 24, v19
    v_sub_u32 v20, v18, v20
    v_mul_u32_u24 v21, 400, v19
    v_lshl_add_u32 v21, v20, 4, v21
    v_add_u32 v10, 144512, v21
    v_lshlrev_b32 v21, 4, v19
    v_lshl_add_u32 v11, v20, 7, v21
    v_add_u32 v13, 32768, v1
    v_add_u32 v14, 131072, v1
    s_mul_i32 s44, s12, 12288
    s_add_u32 s44, s44, 53477376
    s_mul_i32 s45, s12, 3072
    s_add_u32 s45, s45, 208666624
    s_mul_i32 s20, s12, 6
    s_add_u32 s21, s20, 5
    s_lshr_b32 s20, s20, 3
    s_lshr_b32 s21, s21, 3
    s_add_u32 s20, s20, 80
    s_add_u32 s21, s21, 80
    s_lshl_b32 s20, s20, 7
    s_lshl_b32 s21, s21, 7
    v_mov_b32 v255, s21
    v_mov_b32 v253, s20
    v_cmp_eq_u32 vcc, 0, v0
    s_nop 1
    v_cndmask_b32 v255, v255, v253, vcc
    s_mov_b32 s47, 0
    s_mul_i32 s20, s12, 491520
    s_add_u32 s20, s20, 11657216
    s_add_u32 s21, s20, 28672
    buffer_load_dwordx4 v[16:19], v1, s[8:11], s21 offen offset:0
    buffer_load_dwordx4 v[20:23], v1, s[8:11], s21 offen offset:1024
    s_add_u32 s21, s20, 10240
    buffer_load_dwordx4 v[24:27], v1, s[8:11], s21 offen offset:0
    buffer_load_dwordx4 v[28:31], v1, s[8:11], s21 offen offset:1024
    s_add_u32 s21, s20, 51200
    buffer_load_dwordx4 v[32:35], v1, s[8:11], s21 offen offset:0
    buffer_load_dwordx4 v[36:39], v1, s[8:11], s21 offen offset:1024
    s_add_u32 s21, s20, 2048
    buffer_load_dwordx4 v[40:43], v1, s[8:11], s21 offen offset:0
    buffer_load_dwordx4 v[44:47], v1, s[8:11], s21 offen offset:1024
    s_add_u32 s21, s20, 12288
    buffer_load_dwordx4 v[48:51], v1, s[8:11], s21 offen offset:0
    buffer_load_dwordx4 v[52:55], v1, s[8:11], s21 offen offset:1024
    s_add_u32 s21, s20, 16384
    buffer_load_dwordx4 v[56:59], v1, s[8:11], s21 offen offset:0
    buffer_load_dwordx4 v[60:63], v1, s[8:11], s21 offen offset:1024
    s_add_u32 s21, s20, 20480
    buffer_load_dwordx4 v[64:67], v1, s[8:11], s21 offen offset:0
    buffer_load_dwordx4 v[68:71], v1, s[8:11], s21 offen offset:1024
    s_add_u32 s21, s20, 24576
    buffer_load_dwordx4 v[72:75], v1, s[8:11], s21 offen offset:0
    buffer_load_dwordx4 v[76:79], v1, s[8:11], s21 offen offset:1024
    s_add_u32 s21, s20, 34816
    buffer_load_dwordx4 v[80:83], v1, s[8:11], s21 offen offset:0
    buffer_load_dwordx4 v[84:87], v1, s[8:11], s21 offen offset:1024
    s_add_u32 s21, s20, 38912
    buffer_load_dwordx4 v[88:91], v1, s[8:11], s21 offen offset:0
    buffer_load_dwordx4 v[92:95], v1, s[8:11], s21 offen offset:1024
    s_add_u32 s21, s20, 43008
    buffer_load_dwordx4 v[96:99], v1, s[8:11], s21 offen offset:0
    buffer_load_dwordx4 v[100:103], v1, s[8:11], s21 offen offset:1024
    s_add_u32 s21, s20, 53248
    buffer_load_dwordx4 v[104:107], v1, s[8:11], s21 offen offset:0
    buffer_load_dwordx4 v[108:111], v1, s[8:11], s21 offen offset:1024
    s_add_u32 s21, s20, 63488
    buffer_load_dwordx4 v[112:115], v1, s[8:11], s21 offen offset:0
    buffer_load_dwordx4 v[116:119], v1, s[8:11], s21 offen offset:1024
    s_add_u32 s21, s20, 71680
    buffer_load_dwordx4 v[120:123], v1, s[8:11], s21 offen offset:0
    buffer_load_dwordx4 v[124:127], v1, s[8:11], s21 offen offset:1024
    s_add_u32 s21, s20, 79872
    buffer_load_dwordx4 v[128:131], v1, s[8:11], s21 offen offset:0
    buffer_load_dwordx4 v[132:135], v1, s[8:11], s21 offen offset:1024
    s_add_u32 s21, s20, 94208
    buffer_load_dwordx4 v[136:139], v1, s[8:11], s21 offen offset:0
    buffer_load_dwordx4 v[140:143], v1, s[8:11], s21 offen offset:1024
    s_add_u32 s21, s20, 98304
    buffer_load_dwordx4 v[156:159], v1, s[8:11], s21 offen offset:0
    buffer_load_dwordx4 v[160:163], v1, s[8:11], s21 offen offset:1024
    s_add_u32 s21, s20, 100352
    buffer_load_dwordx4 v[164:167], v1, s[8:11], s21 offen offset:0
    buffer_load_dwordx4 v[168:171], v1, s[8:11], s21 offen offset:1024
    s_add_u32 s21, s20, 102400
    buffer_load_dwordx4 v[172:175], v1, s[8:11], s21 offen offset:0
    buffer_load_dwordx4 v[176:179], v1, s[8:11], s21 offen offset:1024
    s_add_u32 s21, s20, 104448
    buffer_load_dwordx4 v[180:183], v1, s[8:11], s21 offen offset:0
    buffer_load_dwordx4 v[184:187], v1, s[8:11], s21 offen offset:1024
    s_add_u32 s21, s20, 106496
    buffer_load_dwordx4 v[188:191], v1, s[8:11], s21 offen offset:0
    buffer_load_dwordx4 v[192:195], v1, s[8:11], s21 offen offset:1024
    s_add_u32 s21, s20, 108544
    buffer_load_dwordx4 v[196:199], v1, s[8:11], s21 offen offset:0
    buffer_load_dwordx4 v[200:203], v1, s[8:11], s21 offen offset:1024
    s_add_u32 s21, s20, 110592
    buffer_load_dwordx4 v[204:207], v1, s[8:11], s21 offen offset:0
    buffer_load_dwordx4 v[208:211], v1, s[8:11], s21 offen offset:1024
    s_add_u32 s21, s20, 112640
    buffer_load_dwordx4 v[212:215], v1, s[8:11], s21 offen offset:0
    buffer_load_dwordx4 v[216:219], v1, s[8:11], s21 offen offset:1024
    s_add_u32 s21, s20, 114688
    buffer_load_dwordx4 v[220:223], v1, s[8:11], s21 offen offset:0
    buffer_load_dwordx4 v[224:227], v1, s[8:11], s21 offen offset:1024
    s_add_u32 s21, s20, 116736
    buffer_load_dwordx4 v[228:231], v1, s[8:11], s21 offen offset:0
    buffer_load_dwordx4 v[232:235], v1, s[8:11], s21 offen offset:1024
    s_add_u32 s21, s20, 118784
    buffer_load_dwordx4 v[236:239], v1, s[8:11], s21 offen offset:0
    buffer_load_dwordx4 v[240:243], v1, s[8:11], s21 offen offset:1024
    s_add_u32 s21, s20, 120832
    buffer_load_dwordx4 v[244:247], v1, s[8:11], s21 offen offset:0
    buffer_load_dwordx4 v[248:251], v1, s[8:11], s21 offen offset:1024
    s_waitcnt vmcnt(24)
    ds_write_b128 v13, v[16:19] offset:0
    ds_write_b128 v13, v[20:23] offset:1024
    ds_write_b128 v13, v[24:27] offset:2048
    ds_write_b128 v13, v[28:31] offset:3072
    ds_write_b128 v13, v[32:35] offset:4096
    ds_write_b128 v13, v[36:39] offset:5120
    ds_write_b128 v13, v[40:43] offset:6144
    ds_write_b128 v13, v[44:47] offset:7168
    ds_write_b128 v13, v[48:51] offset:8192
    ds_write_b128 v13, v[52:55] offset:9216
    ds_write_b128 v13, v[56:59] offset:10240
    ds_write_b128 v13, v[60:63] offset:11264
    ds_write_b128 v13, v[64:67] offset:12288
    ds_write_b128 v13, v[68:71] offset:13312
    ds_write_b128 v13, v[72:75] offset:14336
    ds_write_b128 v13, v[76:79] offset:15360
    ds_write_b128 v13, v[80:83] offset:16384
    ds_write_b128 v13, v[84:87] offset:17408
    ds_write_b128 v13, v[88:91] offset:18432
    ds_write_b128 v13, v[92:95] offset:19456
    ds_write_b128 v13, v[96:99] offset:20480
    ds_write_b128 v13, v[100:103] offset:21504
    ds_write_b128 v13, v[104:107] offset:22528
    ds_write_b128 v13, v[108:111] offset:23552
    ds_write_b128 v13, v[112:115] offset:24576
    ds_write_b128 v13, v[116:119] offset:25600
    ds_write_b128 v13, v[120:123] offset:26624
    ds_write_b128 v13, v[124:127] offset:27648
    ds_write_b128 v13, v[128:131] offset:28672
    ds_write_b128 v13, v[132:135] offset:29696
    ds_write_b128 v13, v[136:139] offset:30720
    ds_write_b128 v13, v[140:143] offset:31744
    s_waitcnt lgkmcnt(0)
    s_mov_b32 s14, 0
    s_cmp_gt_u32 s47, s14
    s_cbranch_scc1 layerb1_kernel_p1_gw1_ok
layerb1_kernel_p1_gw1_lp:
    buffer_load_dword v253, v255, s[8:11], s48 offen sc1
    s_waitcnt vmcnt(0)
    v_readlane_b32 s47, v253, 0
    v_readlane_b32 s29, v253, 1
    s_nop 0
    s_min_u32 s47, s47, s29
    s_sub_u32 s15, s15, 1
    s_cbranch_scc1 layerb1_kernel_bail
    s_cmp_gt_u32 s47, s14
    s_cbranch_scc0 layerb1_kernel_p1_gw1_lp
layerb1_kernel_p1_gw1_ok:
    s_mul_i32 s20, s14, 393216
    s_add_u32 s20, s20, s44
    s_add_u32 s21, s20, 0
    buffer_load_dwordx4 v[100:103], v9, s[8:11], s21 offen offset:0 sc1
    buffer_load_dwordx4 v[104:107], v9, s[8:11], s21 offen offset:512 sc1
    s_add_u32 s21, s20, 4096
    buffer_load_dwordx4 v[108:111], v9, s[8:11], s21 offen offset:0 sc1
    buffer_load_dwordx4 v[112:115], v9, s[8:11], s21 offen offset:512 sc1
    s_add_u32 s21, s20, 8192
    buffer_load_dwordx4 v[116:119], v9, s[8:11], s21 offen offset:0 sc1
    buffer_load_dwordx4 v[120:123], v9, s[8:11], s21 offen offset:512 sc1
    v_mov_b32 v56, 0
    v_mov_b32 v57, 0
    v_mov_b32 v58, 0
    v_mov_b32 v59, 0
    v_mov_b32 v60, 0
    v_mov_b32 v61, 0
    v_mov_b32 v62, 0
    v_mov_b32 v63, 0
    v_mov_b32 v64, 0
    v_mov_b32 v65, 0
    v_mov_b32 v66, 0
    v_mov_b32 v67, 0
    v_mov_b32 v68, 0
    v_mov_b32 v69, 0
    v_mov_b32 v70, 0
    v_mov_b32 v71, 0
    v_mov_b32 v72, 0
    v_mov_b32 v73, 0
    v_mov_b32 v74, 0
    v_mov_b32 v75, 0
    v_mov_b32 v76, 0
    v_mov_b32 v77, 0
    v_mov_b32 v78, 0
    v_mov_b32 v79, 0
    v_mov_b32 v80, 0
    v_mov_b32 v81, 0
    v_mov_b32 v82, 0
    v_mov_b32 v83, 0
    v_mov_b32 v84, 0
    v_mov_b32 v85, 0
    v_mov_b32 v86, 0
    v_mov_b32 v87, 0
    ds_read_b128 v[124:127], v13 offset:0
    ds_read_b128 v[128:131], v13 offset:1024
    ds_read_b128 v[132:135], v13 offset:2048
    ds_read_b128 v[136:139], v13 offset:3072
    ds_read_b128 v[140:143], v13 offset:4096
    ds_read_b128 v[144:147], v13 offset:5120
    ds_read_b128 v[148:151], v13 offset:6144
    ds_read_b128 v[152:155], v13 offset:7168
    s_waitcnt lgkmcnt(0)
layerb1_kernel_p1_step:
    s_cmp_lt_u32 s14, 32
    s_cselect_b32 s18, s16, s17
    s_and_b32 s20, s14, 31
    s_lshl_b32 s20, s20, 16
    s_add_u32 s18, s18, s20
    s_add_u32 s22, s18, 39936
    s_add_u32 s23, s18, 49152
    s_add_u32 s24, s18, 50176
layerb1_kernel_p1_poll:
    buffer_load_dwordx4 v[28:31], v12, s[8:11], s22 offen sc1
    buffer_load_dwordx4 v[32:35], v12, s[8:11], s23 offen sc1
    buffer_load_dwordx4 v[36:39], v12, s[8:11], s24 offen sc1
    s_waitcnt vmcnt(0)
    ds_write_b128 v14, v[28:31] offset:3072
    ds_write_b128 v14, v[32:35] offset:4096
    ds_write_b128 v14, v[36:39] offset:5120
    v_max3_u32 v88, v28, v29, v30
    v_max3_u32 v88, v88, v31, v32
    v_max3_u32 v88, v88, v33, v34
    v_max3_u32 v88, v88, v35, v36
    v_max3_u32 v88, v88, v37, v38
    v_max_u32 v88, v88, v39
    v_cmp_eq_u32 vcc, -1, v88
    s_sub_u32 s15, s15, 1
    s_cbranch_scc1 layerb1_kernel_bail
    s_cbranch_vccnz layerb1_kernel_p1_poll
    v_smfmac_f32_16x16x64_bf16 v[56:59], v[28:31], a[0:7], v2
    v_smfmac_f32_16x16x64_bf16 v[60:63], v[28:31], a[8:15], v2
    s_waitcnt lgkmcnt(0)
    s_barrier
    ds_read_b128 v[16:19], v14 offset:0
    ds_read_b128 v[20:23], v14 offset:1024
    ds_read_b128 v[24:27], v14 offset:2048
    v_smfmac_f32_16x16x64_bf16 v[64:67], v[28:31], a[16:23], v2
    ds_read_b128 v[40:43], v14 offset:6144
    ds_read_b128 v[44:47], v14 offset:7168
    v_smfmac_f32_16x16x64_bf16 v[56:59], v[32:35], a[24:31], v2
    ds_read_b128 v[48:51], v14 offset:8192
    ds_read_b128 v[52:55], v14 offset:9216
    v_smfmac_f32_16x16x64_bf16 v[60:63], v[32:35], v[124:131], v2
    ds_read_b128 v[124:127], v13 offset:8192
    ds_read_b128 v[128:131], v13 offset:9216
    v_smfmac_f32_16x16x64_bf16 v[64:67], v[32:35], a[32:39], v2
    v_smfmac_f32_16x16x64_bf16 v[56:59], v[36:39], v[132:139], v2
    ds_read_b128 v[132:135], v13 offset:10240
    ds_read_b128 v[136:139], v13 offset:11264
    v_smfmac_f32_16x16x64_bf16 v[60:63], v[36:39], a[40:47], v2
    v_smfmac_f32_16x16x64_bf16 v[64:67], v[36:39], v[140:147], v2
    ds_read_b128 v[140:143], v13 offset:12288
    ds_read_b128 v[144:147], v13 offset:13312
    s_waitcnt lgkmcnt(12)
    v_smfmac_f32_16x16x64_bf16 v[56:59], v[16:19], a[48:55], v2
    s_waitcnt lgkmcnt(11)
    v_smfmac_f32_16x16x64_bf16 v[56:59], v[20:23], v[148:155], v2
    ds_read_b128 v[148:151], v13 offset:14336
    ds_read_b128 v[152:155], v13 offset:15360
    s_waitcnt lgkmcnt(12)
    v_smfmac_f32_16x16x64_bf16 v[56:59], v[24:27], a[56:63], v2
    s_waitcnt lgkmcnt(11)
    s_waitcnt lgkmcnt(6)
    v_smfmac_f32_16x16x64_bf16 v[56:59], v[40:43], v[124:131], v2
    ds_read_b128 v[124:127], v13 offset:16384
    ds_read_b128 v[128:131], v13 offset:17408
    v_smfmac_f32_16x16x64_bf16 v[56:59], v[44:47], a[64:71], v2
    s_waitcnt lgkmcnt(6)
    v_smfmac_f32_16x16x64_bf16 v[56:59], v[48:51], v[132:139], v2
    ds_read_b128 v[132:135], v13 offset:18432
    ds_read_b128 v[136:139], v13 offset:19456
    v_smfmac_f32_16x16x64_bf16 v[56:59], v[52:55], a[72:79], v2
    s_waitcnt lgkmcnt(6)
    v_smfmac_f32_16x16x64_bf16 v[60:63], v[16:19], v[140:147], v2
    ds_read_b128 v[140:143], v13 offset:20480
    ds_read_b128 v[144:147], v13 offset:21504
    v_smfmac_f32_16x16x64_bf16 v[60:63], v[20:23], a[80:87], v2
    v_add_f32 v56, v56, v58
    v_add_f32 v57, v57, v59
    s_waitcnt lgkmcnt(6)
    v_smfmac_f32_16x16x64_bf16 v[60:63], v[24:27], v[148:155], v2
    ds_read_b128 v[148:151], v13 offset:22528
    ds_read_b128 v[152:155], v13 offset:23552
    v_smfmac_f32_16x16x64_bf16 v[60:63], v[40:43], a[88:95], v2
    v_cvt_pk_bf16_f32 v56, v56, v57
    ds_write_b16 v3, v56 offset:0
    s_waitcnt lgkmcnt(7)
    v_smfmac_f32_16x16x64_bf16 v[60:63], v[44:47], v[124:131], v2
    ds_read_b128 v[124:127], v13 offset:24576
    ds_read_b128 v[128:131], v13 offset:25600
    v_smfmac_f32_16x16x64_bf16 v[60:63], v[48:51], a[96:103], v2
    ds_write_b16_d16_hi v3, v56 offset:400
    s_waitcnt lgkmcnt(8)
    v_smfmac_f32_16x16x64_bf16 v[60:63], v[52:55], v[132:139], v2
    ds_read_b128 v[132:135], v13 offset:26624
    ds_read_b128 v[136:139], v13 offset:27648
    v_smfmac_f32_16x16x64_bf16 v[64:67], v[16:19], a[104:111], v2
    s_waitcnt lgkmcnt(8)
    v_smfmac_f32_16x16x64_bf16 v[64:67], v[20:23], v[140:147], v2
    ds_read_b128 v[140:143], v13 offset:28672
    ds_read_b128 v[144:147], v13 offset:29696
    v_smfmac_f32_16x16x64_bf16 v[64:67], v[24:27], a[112:119], v2
    v_add_f32 v60, v60, v62
    v_add_f32 v61, v61, v63
    s_waitcnt lgkmcnt(8)
    v_smfmac_f32_16x16x64_bf16 v[64:67], v[40:43], v[148:155], v2
    ds_read_b128 v[148:151], v13 offset:30720
    ds_read_b128 v[152:155], v13 offset:31744
    v_smfmac_f32_16x16x64_bf16 v[64:67], v[44:47], a[120:127], v2
    v_cvt_pk_bf16_f32 v60, v60, v61
    ds_write_b16 v3, v60 offset:128
    v_smfmac_f32_16x16x64_bf16 v[64:67], v[48:51], a[128:135], v2
    ds_write_b16_d16_hi v3, v60 offset:528
    v_smfmac_f32_16x16x64_bf16 v[64:67], v[52:55], a[136:143], v2
    v_smfmac_f32_16x16x64_bf16 v[68:71], v[16:19], a[144:151], v2
    s_waitcnt lgkmcnt(9)
    v_smfmac_f32_16x16x64_bf16 v[68:71], v[20:23], v[124:131], v2
    v_add_f32 v64, v64, v66
    v_add_f32 v65, v65, v67
    v_smfmac_f32_16x16x64_bf16 v[68:71], v[24:27], a[152:159], v2
    v_cvt_pk_bf16_f32 v64, v64, v65
    ds_write_b16 v3, v64 offset:256
    v_smfmac_f32_16x16x64_bf16 v[68:71], v[28:31], a[160:167], v2
    ds_write_b16_d16_hi v3, v64 offset:656
    v_smfmac_f32_16x16x64_bf16 v[68:71], v[32:35], a[168:175], v2
    s_waitcnt lgkmcnt(8)
    v_smfmac_f32_16x16x64_bf16 v[68:71], v[36:39], v[132:139], v2
    v_smfmac_f32_16x16x64_bf16 v[68:71], v[40:43], a[176:183], v2
    s_waitcnt lgkmcnt(0)
    s_barrier
    ds_read_b128 v[88:91], v4 offset:0
    v_smfmac_f32_16x16x64_bf16 v[68:71], v[44:47], a[184:191], v2
    ds_read_b128 v[92:95], v4 offset:128
    ds_read_b128 v[96:99], v4 offset:256
    v_smfmac_f32_16x16x64_bf16 v[68:71], v[48:51], a[192:199], v2
    v_smfmac_f32_16x16x64_bf16 v[68:71], v[52:55], v[140:147], v2
    v_smfmac_f32_16x16x64_bf16 v[72:75], v[16:19], a[200:207], v2
    v_smfmac_f32_16x16x64_bf16 v[72:75], v[20:23], a[208:215], v2
    v_add_f32 v68, v68, v70
    v_add_f32 v69, v69, v71
    v_smfmac_f32_16x16x64_bf16 v[72:75], v[24:27], a[216:223], v2
    v_cvt_pk_bf16_f32 v68, v68, v69
    ds_write_b16 v3, v68 offset:3200
    s_waitcnt lgkmcnt(1)
    v_smfmac_f32_16x16x64_bf16 v[80:83], v[88:91], v[100:107], v2
    v_smfmac_f32_16x16x64_bf16 v[80:83], v[92:95], v[108:115], v2
    v_smfmac_f32_16x16x64_bf16 v[80:83], v[96:99], v[116:123], v2
    v_smfmac_f32_16x16x64_bf16 v[72:75], v[28:31], a[224:231], v2
    ds_write_b16_d16_hi v3, v68 offset:3600
    v_smfmac_f32_16x16x64_bf16 v[72:75], v[32:35], a[232:239], v2
    v_add_f32 v56, v80, v82
    v_mul_f32 v56, 0x3dd53b95, v56
    v_smfmac_f32_16x16x64_bf16 v[72:75], v[36:39], a[240:247], v2
    v_max_f32_dpp v58, v56, v56 row_ror:8 row_mask:0xf bank_mask:0xf
    v_smfmac_f32_16x16x64_bf16 v[72:75], v[40:43], v[148:155], v2
    v_max_f32_dpp v58, v58, v58 row_ror:4 row_mask:0xf bank_mask:0xf
    v_smfmac_f32_16x16x64_bf16 v[72:75], v[44:47], a[248:255], v2
    v_max_f32_dpp v58, v58, v58 row_ror:2 row_mask:0xf bank_mask:0xf
    v_smfmac_f32_16x16x64_bf16 v[72:75], v[48:51], v[156:163], v2
    v_max_f32_dpp v58, v58, v58 row_ror:1 row_mask:0xf bank_mask:0xf
    v_smfmac_f32_16x16x64_bf16 v[72:75], v[52:55], v[164:171], v2
    v_sub_f32 v60, v56, v58
    v_exp_f32 v60, v60
    v_smfmac_f32_16x16x64_bf16 v[76:79], v[16:19], v[172:179], v2
    v_add_f32_dpp v59, v60, v60 row_ror:8 row_mask:0xf bank_mask:0xf
    v_smfmac_f32_16x16x64_bf16 v[76:79], v[20:23], v[180:187], v2
    v_add_f32_dpp v59, v59, v59 row_ror:4 row_mask:0xf bank_mask:0xf
    v_add_f32 v72, v72, v74
    v_smfmac_f32_16x16x64_bf16 v[76:79], v[24:27], v[188:195], v2
    v_add_f32_dpp v59, v59, v59 row_ror:2 row_mask:0xf bank_mask:0xf
    v_add_f32 v73, v73, v75
    v_smfmac_f32_16x16x64_bf16 v[76:79], v[28:31], v[196:203], v2
    v_add_f32_dpp v59, v59, v59 row_ror:1 row_mask:0xf bank_mask:0xf
    v_cvt_pk_bf16_f32 v72, v72, v73
    v_smfmac_f32_16x16x64_bf16 v[76:79], v[32:35], v[204:211], v2
    ds_write_b64 v6, v[58:59] offset:512
    ds_write_b16 v3, v72 offset:3328
    v_smfmac_f32_16x16x64_bf16 v[76:79], v[36:39], v[212:219], v2
    ds_write_b16_d16_hi v3, v72 offset:3728
    v_smfmac_f32_16x16x64_bf16 v[76:79], v[40:43], v[220:227], v2
    s_waitcnt lgkmcnt(0)
    s_barrier
    ds_read_b128 v[100:103], v5 offset:0
    ds_read_b128 v[104:107], v5 offset:16
    v_smfmac_f32_16x16x64_bf16 v[76:79], v[44:47], v[228:235], v2
    ds_read_b128 v[108:111], v5 offset:128
    ds_read_b128 v[112:115], v5 offset:144
    v_smfmac_f32_16x16x64_bf16 v[76:79], v[48:51], v[236:243], v2
    v_smfmac_f32_16x16x64_bf16 v[76:79], v[52:55], v[244:251], v2
    s_waitcnt lgkmcnt(2)
    v_smfmac_f32_16x16x64_bf16 v[84:87], v[88:91], v[100:107], v2
    s_waitcnt lgkmcnt(0)
    v_smfmac_f32_16x16x64_bf16 v[84:87], v[92:95], v[108:115], v2
    v_add_f32 v76, v76, v78
    v_add_f32 v77, v77, v79
    v_cvt_pk_bf16_f32 v76, v76, v77
    ds_write_b16 v3, v76 offset:3456
    ds_write_b16_d16_hi v3, v76 offset:3856
    s_waitcnt lgkmcnt(0)
    s_barrier
    ds_read_b128 v[116:119], v5 offset:256
    ds_read_b128 v[120:123], v5 offset:272
    ds_read_b64 v[16:17], v6 offset:0
    s_waitcnt lgkmcnt(1)
    v_smfmac_f32_16x16x64_bf16 v[84:87], v[96:99], v[116:123], v2
    s_waitcnt lgkmcnt(0)
    v_max_f32 v18, v58, v16
    v_sub_f32 v19, v58, v18
    v_sub_f32 v20, v16, v18
    v_exp_f32 v19, v19
    v_exp_f32 v20, v20
    s_nop 0
    v_mul_f32 v21, v59, v19
    v_mul_f32 v60, v60, v19
    v_fmac_f32 v21, v17, v20
    v_add_f32 v22, v84, v86
    v_mul_f32 v22, 0x3dd53b95, v22
    v_max_f32 v23, v22, v18
    s_nop 0
    v_max_f32_dpp v24, v22, v23 row_ror:4 row_mask:0xf bank_mask:0xf
    s_nop 1
    v_max_f32_dpp v24, v24, v24 row_ror:2 row_mask:0xf bank_mask:0xf
    s_nop 1
    v_max_f32_dpp v24, v24, v24 row_ror:1 row_mask:0xf bank_mask:0xf
    v_sub_f32 v25, v22, v24
    v_sub_f32 v26, v18, v24
    v_exp_f32 v25, v25
    v_exp_f32 v26, v26
    s_nop 0
    v_add_f32_dpp v23, v25, v25 row_ror:4 row_mask:0xf bank_mask:0xf
    v_mul_f32 v60, v60, v26
    s_nop 0
    v_add_f32_dpp v23, v23, v23 row_ror:2 row_mask:0xf bank_mask:0xf
    s_nop 1
    v_add_f32_dpp v23, v23, v23 row_ror:1 row_mask:0xf bank_mask:0xf
    v_fmac_f32 v23, v26, v21
    v_rcp_f32 v27, v23
    s_nop 0
    v_mul_f32 v60, v60, v27
    v_mul_f32 v25, v25, v27
    s_nop 0
    v_mov_b32_dpp v19, v60 quad_perm:[1,0,3,2] row_mask:0xf bank_mask:0xf
    v_mov_b32_dpp v20, v25 quad_perm:[1,0,3,2] row_mask:0xf bank_mask:0xf
    v_cvt_pk_bf16_f32 v60, v60, v19
    v_cvt_pk_bf16_f32 v25, v25, v20
    buffer_store_dword v60, v7, s[8:11], s18 offen sc1
    buffer_store_dword v25, v8, s[8:11], s18 offen sc1
    ds_read_b128 v[40:43], v10
    s_add_u32 s28, s14, 1
    s_min_u32 s28, s28, 63
    s_cmp_gt_u32 s47, s28
    s_cbranch_scc1 layerb1_kernel_p1_gw2_ok
layerb1_kernel_p1_gw2_lp:
    buffer_load_dword v253, v255, s[8:11], s48 offen sc1
    s_waitcnt vmcnt(0)
    v_readlane_b32 s47, v253, 0
    v_readlane_b32 s29, v253, 1
    s_nop 0
    s_min_u32 s47, s47, s29
    s_sub_u32 s15, s15, 1
    s_cbranch_scc1 layerb1_kernel_bail
    s_cmp_gt_u32 s47, s28
    s_cbranch_scc0 layerb1_kernel_p1_gw2_lp
layerb1_kernel_p1_gw2_ok:
    s_mul_i32 s20, s28, 393216
    s_add_u32 s20, s20, s44
    s_add_u32 s21, s20, 0
    buffer_load_dwordx4 v[100:103], v9, s[8:11], s21 offen offset:0 sc1
    buffer_load_dwordx4 v[104:107], v9, s[8:11], s21 offen offset:512 sc1
    s_add_u32 s21, s20, 4096
    buffer_load_dwordx4 v[108:111], v9, s[8:11], s21 offen offset:0 sc1
    buffer_load_dwordx4 v[112:115], v9, s[8:11], s21 offen offset:512 sc1
    s_add_u32 s21, s20, 8192
    buffer_load_dwordx4 v[116:119], v9, s[8:11], s21 offen offset:0 sc1
    buffer_load_dwordx4 v[120:123], v9, s[8:11], s21 offen offset:512 sc1
    v_mov_b32 v56, 0
    v_mov_b32 v57, 0
    v_mov_b32 v58, 0
    v_mov_b32 v59, 0
    v_mov_b32 v60, 0
    v_mov_b32 v61, 0
    v_mov_b32 v62, 0
    v_mov_b32 v63, 0
    v_mov_b32 v64, 0
    v_mov_b32 v65, 0
    v_mov_b32 v66, 0
    v_mov_b32 v67, 0
    v_mov_b32 v68, 0
    v_mov_b32 v69, 0
    v_mov_b32 v70, 0
    v_mov_b32 v71, 0
    v_mov_b32 v72, 0
    v_mov_b32 v73, 0
    v_mov_b32 v74, 0
    v_mov_b32 v75, 0
    v_mov_b32 v76, 0
    v_mov_b32 v77, 0
    v_mov_b32 v78, 0
    v_mov_b32 v79, 0
    v_mov_b32 v80, 0
    v_mov_b32 v81, 0
    v_mov_b32 v82, 0
    v_mov_b32 v83, 0
    v_mov_b32 v84, 0
    v_mov_b32 v85, 0
    v_mov_b32 v86, 0
    v_mov_b32 v87, 0
    s_waitcnt lgkmcnt(0)
    s_mul_i32 s20, s14, 98304
    s_add_u32 s20, s20, s45
    buffer_store_dwordx4 v[40:43], v11, s[8:11], s20 offen sc1
    ds_read_b128 v[124:127], v13 offset:0
    ds_read_b128 v[128:131], v13 offset:1024
    ds_read_b128 v[132:135], v13 offset:2048
    ds_read_b128 v[136:139], v13 offset:3072
    ds_read_b128 v[140:143], v13 offset:4096
    ds_read_b128 v[144:147], v13 offset:5120
    ds_read_b128 v[148:151], v13 offset:6144
    ds_read_b128 v[152:155], v13 offset:7168
    s_waitcnt lgkmcnt(0)
    s_add_u32 s14, s14, 1
    s_cmp_lt_u32 s14, 64
    s_cbranch_scc1 layerb1_kernel_p1_step
    s_waitcnt vmcnt(0)
    s_barrier
    s_branch layerb1_kernel_end
layerb1_kernel_p2_start:
    v_lshrrev_b32 v16, 4, v0
    v_and_b32 v17, 15, v0
    v_and_b32 v18, 2, v0
    v_cmp_eq_u32 vcc, 0, v18
    v_mov_b32 v18, 0xeeeeeeee
    v_mov_b32 v19, 0x44444444
    v_cndmask_b32 v2, v18, v19, vcc
    v_lshrrev_b32 v20, 2, v17
    v_lshlrev_b32 v20, 1, v20
    v_and_b32 v21, 1, v17
    v_add_u32 v20, v20, v21
    v_bfe_u32 v21, v17, 1, 1
    v_lshl_add_u32 v18, v16, 1, v21
    v_lshlrev_b32 v18, 7, v18
    v_lshl_add_u32 v12, v20, 4, v18
    v_mul_u32_u24 v18, 400, v20
    v_lshl_add_u32 v18, v16, 5, v18
    v_lshl_add_u32 v18, v21, 4, v18
    v_add_u32 v4, 141312, v18
    v_mul_u32_u24 v18, 800, v16
    v_lshl_add_u32 v18, v17, 1, v18
    v_add_u32 v3, 141376, v18
    v_and_b32 v18, 7, v0
    v_mul_u32_u24 v18, 400, v18
    v_lshl_add_u32 v18, v16, 5, v18
    v_add_u32 v5, 144512, v18
    v_lshlrev_b32 v18, 3, v0
    v_add_u32 v6, 147712, v18
    v_lshlrev_b32 v18, 4, v16
    v_bfe_u32 v19, v17, 1, 2
    v_lshl_add_u32 v18, v19, 2, v18
    s_lshl_b32 s20, s12, 7
    s_add_u32 s20, s20, 64
    v_add_u32 v18, s20, v18
    v_lshrrev_b32 v19, 3, v17
    v_add_u32 v19, 1, v19
    v_lshrrev_b32 v20, 1, v19
    v_lshlrev_b32 v20, 14, v20
    v_and_b32 v19, 1, v19
    v_lshl_add_u32 v19, v19, 12, v20
    v_add_u32 v19, v19, v18
    v_mov_b32 v20, 0x7ffffff0
    v_and_b32 v21, 1, v0
    v_cmp_eq_u32 vcc, 0, v21
    s_nop 1
    v_cndmask_b32 v7, v20, v19, vcc
    v_and_b32 v21, 0x29, v0
    v_cmp_eq_u32 vcc, 0, v21
    s_nop 1
    v_cndmask_b32 v8, v20, v18, vcc
    v_lshlrev_b32 v18, 4, v17
    v_lshl_add_u32 v18, v16, 10, v18
    v_add_u32 v9, 0, v18
    v_add_u32 v18, 128, v0
    v_mul_u32_u24 v19, 2731, v18
    v_lshrrev_b32 v19, 16, v19
    v_mul_u32_u24 v20, 24, v19
    v_sub_u32 v20, v18, v20
    v_mul_u32_u24 v21, 400, v19
    v_lshl_add_u32 v21, v20, 4, v21
    v_add_u32 v10, 144512, v21
    v_lshlrev_b32 v21, 4, v19
    v_lshl_add_u32 v11, v20, 7, v21
    v_add_u32 v13, 65536, v1
    v_add_u32 v14, 131072, v1
    s_mul_i32 s44, s12, 12288
    s_add_u32 s44, s44, 53477376
    s_mul_i32 s45, s12, 3072
    s_add_u32 s45, s45, 208666624
    s_mul_i32 s20, s12, 6
    s_add_u32 s21, s20, 5
    s_lshr_b32 s20, s20, 3
    s_lshr_b32 s21, s21, 3
    s_add_u32 s20, s20, 80
    s_add_u32 s21, s21, 80
    s_lshl_b32 s20, s20, 7
    s_lshl_b32 s21, s21, 7
    v_mov_b32 v255, s21
    v_mov_b32 v253, s20
    v_cmp_eq_u32 vcc, 0, v0
    s_nop 1
    v_cndmask_b32 v255, v255, v253, vcc
    s_mov_b32 s47, 0
    s_mul_i32 s20, s12, 491520
    s_add_u32 s20, s20, 11780096
    s_add_u32 s21, s20, 34816
    buffer_load_dwordx4 v[16:19], v1, s[8:11], s21 offen offset:0
    buffer_load_dwordx4 v[20:23], v1, s[8:11], s21 offen offset:1024
    s_add_u32 s21, s20, 0
    buffer_load_dwordx4 v[24:27], v1, s[8:11], s21 offen offset:0
    buffer_load_dwordx4 v[28:31], v1, s[8:11], s21 offen offset:1024
    s_add_u32 s21, s20, 4096
    buffer_load_dwordx4 v[32:35], v1, s[8:11], s21 offen offset:0
    buffer_load_dwordx4 v[36:39], v1, s[8:11], s21 offen offset:1024
    s_add_u32 s21, s20, 8192
    buffer_load_dwordx4 v[40:43], v1, s[8:11], s21 offen offset:0
    buffer_load_dwordx4 v[44:47], v1, s[8:11], s21 offen offset:1024
    s_add_u32 s21, s20, 16384
    buffer_load_dwordx4 v[48:51], v1, s[8:11], s21 offen offset:0
    buffer_load_dwordx4 v[52:55], v1, s[8:11], s21 offen offset:1024
    s_add_u32 s21, s20, 20480
    buffer_load_dwordx4 v[56:59], v1, s[8:11], s21 offen offset:0
    buffer_load_dwordx4 v[60:63], v1, s[8:11], s21 offen offset:1024
    s_add_u32 s21, s20, 24576
    buffer_load_dwordx4 v[64:67], v1, s[8:11], s21 offen offset:0
    buffer_load_dwordx4 v[68:71], v1, s[8:11], s21 offen offset:1024
    s_add_u32 s21, s20, 28672
    buffer_load_dwordx4 v[72:75], v1, s[8:11], s21 offen offset:0
    buffer_load_dwordx4 v[76:79], v1, s[8:11], s21 offen offset:1024
    s_add_u32 s21, s20, 36864
    buffer_load_dwordx4 v[80:83], v1, s[8:11], s21 offen offset:0
    buffer_load_dwordx4 v[84:87], v1, s[8:11], s21 offen offset:1024
    s_add_u32 s21, s20, 40960
    buffer_load_dwordx4 v[88:91], v1, s[8:11], s21 offen offset:0
    buffer_load_dwordx4 v[92:95], v1, s[8:11], s21 offen offset:1024
    s_add_u32 s21, s20, 45056
    buffer_load_dwordx4 v[96:99], v1, s[8:11], s21 offen offset:0
    buffer_load_dwordx4 v[100:103], v1, s[8:11], s21 offen offset:1024
    s_add_u32 s21, s20, 49152
    buffer_load_dwordx4 v[104:107], v1, s[8:11], s21 offen offset:0
    buffer_load_dwordx4 v[108:111], v1, s[8:11], s21 offen offset:1024
    s_add_u32 s21, s20, 63488
    buffer_load_dwordx4 v[112:115], v1, s[8:11], s21 offen offset:0
    buffer_load_dwordx4 v[116:119], v1, s[8:11], s21 offen offset:1024
    s_add_u32 s21, s20, 71680
    buffer_load_dwordx4 v[120:123], v1, s[8:11], s21 offen offset:0
    buffer_load_dwordx4 v[124:127], v1, s[8:11], s21 offen offset:1024
    s_add_u32 s21, s20, 79872
    buffer_load_dwordx4 v[128:131], v1, s[8:11], s21 offen offset:0
    buffer_load_dwordx4 v[132:135], v1, s[8:11], s21 offen offset:1024
    s_add_u32 s21, s20, 94208
    buffer_load_dwordx4 v[136:139], v1, s[8:11], s21 offen offset:0
    buffer_load_dwordx4 v[140:143], v1, s[8:11], s21 offen offset:1024
    s_add_u32 s21, s20, 98304
    buffer_load_dwordx4 v[156:159], v1, s[8:11], s21 offen offset:0
    buffer_load_dwordx4 v[160:163], v1, s[8:11], s21 offen offset:1024
    s_add_u32 s21, s20, 100352
    buffer_load_dwordx4 v[164:167], v1, s[8:11], s21 offen offset:0
    buffer_load_dwordx4 v[168:171], v1, s[8:11], s21 offen offset:1024
    s_add_u32 s21, s20, 102400
    buffer_load_dwordx4 v[172:175], v1, s[8:11], s21 offen offset:0
    buffer_load_dwordx4 v[176:179], v1, s[8:11], s21 offen offset:1024
    s_add_u32 s21, s20, 104448
    buffer_load_dwordx4 v[180:183], v1, s[8:11], s21 offen offset:0
    buffer_load_dwordx4 v[184:187], v1, s[8:11], s21 offen offset:1024
    s_add_u32 s21, s20, 106496
    buffer_load_dwordx4 v[188:191], v1, s[8:11], s21 offen offset:0
    buffer_load_dwordx4 v[192:195], v1, s[8:11], s21 offen offset:1024
    s_add_u32 s21, s20, 108544
    buffer_load_dwordx4 v[196:199], v1, s[8:11], s21 offen offset:0
    buffer_load_dwordx4 v[200:203], v1, s[8:11], s21 offen offset:1024
    s_add_u32 s21, s20, 110592
    buffer_load_dwordx4 v[204:207], v1, s[8:11], s21 offen offset:0
    buffer_load_dwordx4 v[208:211], v1, s[8:11], s21 offen offset:1024
    s_add_u32 s21, s20, 112640
    buffer_load_dwordx4 v[212:215], v1, s[8:11], s21 offen offset:0
    buffer_load_dwordx4 v[216:219], v1, s[8:11], s21 offen offset:1024
    s_add_u32 s21, s20, 114688
    buffer_load_dwordx4 v[220:223], v1, s[8:11], s21 offen offset:0
    buffer_load_dwordx4 v[224:227], v1, s[8:11], s21 offen offset:1024
    s_add_u32 s21, s20, 116736
    buffer_load_dwordx4 v[228:231], v1, s[8:11], s21 offen offset:0
    buffer_load_dwordx4 v[232:235], v1, s[8:11], s21 offen offset:1024
    s_add_u32 s21, s20, 118784
    buffer_load_dwordx4 v[236:239], v1, s[8:11], s21 offen offset:0
    buffer_load_dwordx4 v[240:243], v1, s[8:11], s21 offen offset:1024
    s_add_u32 s21, s20, 120832
    buffer_load_dwordx4 v[244:247], v1, s[8:11], s21 offen offset:0
    buffer_load_dwordx4 v[248:251], v1, s[8:11], s21 offen offset:1024
    s_waitcnt vmcnt(24)
    ds_write_b128 v13, v[16:19] offset:0
    ds_write_b128 v13, v[20:23] offset:1024
    ds_write_b128 v13, v[24:27] offset:2048
    ds_write_b128 v13, v[28:31] offset:3072
    ds_write_b128 v13, v[32:35] offset:4096
    ds_write_b128 v13, v[36:39] offset:5120
    ds_write_b128 v13, v[40:43] offset:6144
    ds_write_b128 v13, v[44:47] offset:7168
    ds_write_b128 v13, v[48:51] offset:8192
    ds_write_b128 v13, v[52:55] offset:9216
    ds_write_b128 v13, v[56:59] offset:10240
    ds_write_b128 v13, v[60:63] offset:11264
    ds_write_b128 v13, v[64:67] offset:12288
    ds_write_b128 v13, v[68:71] offset:13312
    ds_write_b128 v13, v[72:75] offset:14336
    ds_write_b128 v13, v[76:79] offset:15360
    ds_write_b128 v13, v[80:83] offset:16384
    ds_write_b128 v13, v[84:87] offset:17408
    ds_write_b128 v13, v[88:91] offset:18432
    ds_write_b128 v13, v[92:95] offset:19456
    ds_write_b128 v13, v[96:99] offset:20480
    ds_write_b128 v13, v[100:103] offset:21504
    ds_write_b128 v13, v[104:107] offset:22528
    ds_write_b128 v13, v[108:111] offset:23552
    ds_write_b128 v13, v[112:115] offset:24576
    ds_write_b128 v13, v[116:119] offset:25600
    ds_write_b128 v13, v[120:123] offset:26624
    ds_write_b128 v13, v[124:127] offset:27648
    ds_write_b128 v13, v[128:131] offset:28672
    ds_write_b128 v13, v[132:135] offset:29696
    ds_write_b128 v13, v[136:139] offset:30720
    ds_write_b128 v13, v[140:143] offset:31744
    s_waitcnt lgkmcnt(0)
    s_mov_b32 s14, 0
    s_cmp_gt_u32 s47, s14
    s_cbranch_scc1 layerb1_kernel_p2_gw1_ok
layerb1_kernel_p2_gw1_lp:
    buffer_load_dword v253, v255, s[8:11], s48 offen sc1
    s_waitcnt vmcnt(0)
    v_readlane_b32 s47, v253, 0
    v_readlane_b32 s29, v253, 1
    s_nop 0
    s_min_u32 s47, s47, s29
    s_sub_u32 s15, s15, 1
    s_cbranch_scc1 layerb1_kernel_bail
    s_cmp_gt_u32 s47, s14
    s_cbranch_scc0 layerb1_kernel_p2_gw1_lp
layerb1_kernel_p2_gw1_ok:
    s_mul_i32 s20, s14, 393216
    s_add_u32 s20, s20, s44
    s_add_u32 s21, s20, 0
    buffer_load_dwordx4 v[100:103], v9, s[8:11], s21 offen offset:0 sc1
    buffer_load_dwordx4 v[104:107], v9, s[8:11], s21 offen offset:512 sc1
    s_add_u32 s21, s20, 4096
    buffer_load_dwordx4 v[108:111], v9, s[8:11], s21 offen offset:0 sc1
    buffer_load_dwordx4 v[112:115], v9, s[8:11], s21 offen offset:512 sc1
    s_add_u32 s21, s20, 8192
    buffer_load_dwordx4 v[116:119], v9, s[8:11], s21 offen offset:0 sc1
    buffer_load_dwordx4 v[120:123], v9, s[8:11], s21 offen offset:512 sc1
    v_mov_b32 v56, 0
    v_mov_b32 v57, 0
    v_mov_b32 v58, 0
    v_mov_b32 v59, 0
    v_mov_b32 v60, 0
    v_mov_b32 v61, 0
    v_mov_b32 v62, 0
    v_mov_b32 v63, 0
    v_mov_b32 v64, 0
    v_mov_b32 v65, 0
    v_mov_b32 v66, 0
    v_mov_b32 v67, 0
    v_mov_b32 v68, 0
    v_mov_b32 v69, 0
    v_mov_b32 v70, 0
    v_mov_b32 v71, 0
    v_mov_b32 v72, 0
    v_mov_b32 v73, 0
    v_mov_b32 v74, 0
    v_mov_b32 v75, 0
    v_mov_b32 v76, 0
    v_mov_b32 v77, 0
    v_mov_b32 v78, 0
    v_mov_b32 v79, 0
    v_mov_b32 v80, 0
    v_mov_b32 v81, 0
    v_mov_b32 v82, 0
    v_mov_b32 v83, 0
    v_mov_b32 v84, 0
    v_mov_b32 v85, 0
    v_mov_b32 v86, 0
    v_mov_b32 v87, 0
    ds_read_b128 v[124:127], v13 offset:0
    ds_read_b128 v[128:131], v13 offset:1024
    ds_read_b128 v[132:135], v13 offset:2048
    ds_read_b128 v[136:139], v13 offset:3072
    ds_read_b128 v[140:143], v13 offset:4096
    ds_read_b128 v[144:147], v13 offset:5120
    ds_read_b128 v[148:151], v13 offset:6144
    ds_read_b128 v[152:155], v13 offset:7168
    s_waitcnt lgkmcnt(0)
layerb1_kernel_p2_step:
    s_cmp_lt_u32 s14, 32
    s_cselect_b32 s18, s16, s17
    s_and_b32 s20, s14, 31
    s_lshl_b32 s20, s20, 16
    s_add_u32 s18, s18, s20
    s_add_u32 s22, s18, 51200
    s_add_u32 s23, s18, 52224
layerb1_kernel_p2_poll:
    buffer_load_dwordx4 v[40:43], v12, s[8:11], s22 offen sc1
    buffer_load_dwordx4 v[44:47], v12, s[8:11], s23 offen sc1
    s_waitcnt vmcnt(0)
    ds_write_b128 v14, v[40:43] offset:6144
    ds_write_b128 v14, v[44:47] offset:7168
    v_max3_u32 v88, v40, v41, v42
    v_max3_u32 v88, v88, v43, v44
    v_max3_u32 v88, v88, v45, v46
    v_max_u32 v88, v88, v47
    v_cmp_eq_u32 vcc, -1, v88
    s_sub_u32 s15, s15, 1
    s_cbranch_scc1 layerb1_kernel_bail
    s_cbranch_vccnz layerb1_kernel_p2_poll
    v_smfmac_f32_16x16x64_bf16 v[56:59], v[40:43], a[0:7], v2
    v_smfmac_f32_16x16x64_bf16 v[60:63], v[40:43], a[8:15], v2
    s_waitcnt lgkmcnt(0)
    s_barrier
    ds_read_b128 v[16:19], v14 offset:0
    ds_read_b128 v[20:23], v14 offset:1024
    ds_read_b128 v[24:27], v14 offset:2048
    v_smfmac_f32_16x16x64_bf16 v[64:67], v[40:43], a[16:23], v2
    ds_read_b128 v[28:31], v14 offset:3072
    ds_read_b128 v[32:35], v14 offset:4096
    v_smfmac_f32_16x16x64_bf16 v[56:59], v[44:47], a[24:31], v2
    ds_read_b128 v[36:39], v14 offset:5120
    ds_read_b128 v[48:51], v14 offset:8192
    v_smfmac_f32_16x16x64_bf16 v[60:63], v[44:47], v[124:131], v2
    ds_read_b128 v[52:55], v14 offset:9216
    ds_read_b128 v[124:127], v13 offset:8192
    v_smfmac_f32_16x16x64_bf16 v[64:67], v[44:47], a[32:39], v2
    ds_read_b128 v[128:131], v13 offset:9216
    s_waitcnt lgkmcnt(9)
    v_smfmac_f32_16x16x64_bf16 v[56:59], v[16:19], v[132:139], v2
    ds_read_b128 v[132:135], v13 offset:10240
    ds_read_b128 v[136:139], v13 offset:11264
    s_waitcnt lgkmcnt(10)
    v_smfmac_f32_16x16x64_bf16 v[56:59], v[20:23], a[40:47], v2
    s_waitcnt lgkmcnt(9)
    v_smfmac_f32_16x16x64_bf16 v[56:59], v[24:27], v[140:147], v2
    ds_read_b128 v[140:143], v13 offset:12288
    ds_read_b128 v[144:147], v13 offset:13312
    s_waitcnt lgkmcnt(10)
    v_smfmac_f32_16x16x64_bf16 v[56:59], v[28:31], a[48:55], v2
    s_waitcnt lgkmcnt(9)
    v_smfmac_f32_16x16x64_bf16 v[56:59], v[32:35], v[148:155], v2
    ds_read_b128 v[148:151], v13 offset:14336
    ds_read_b128 v[152:155], v13 offset:15360
    s_waitcnt lgkmcnt(10)
    v_smfmac_f32_16x16x64_bf16 v[56:59], v[36:39], a[56:63], v2
    s_waitcnt lgkmcnt(9)
    s_waitcnt lgkmcnt(6)
    v_smfmac_f32_16x16x64_bf16 v[56:59], v[48:51], v[124:131], v2
    ds_read_b128 v[124:127], v13 offset:16384
    ds_read_b128 v[128:131], v13 offset:17408
    v_smfmac_f32_16x16x64_bf16 v[56:59], v[52:55], a[64:71], v2
    s_waitcnt lgkmcnt(6)
    v_smfmac_f32_16x16x64_bf16 v[60:63], v[16:19], v[132:139], v2
    ds_read_b128 v[132:135], v13 offset:18432
    ds_read_b128 v[136:139], v13 offset:19456
    v_smfmac_f32_16x16x64_bf16 v[60:63], v[20:23], a[72:79], v2
    v_add_f32 v56, v56, v58
    v_add_f32 v57, v57, v59
    s_waitcnt lgkmcnt(6)
    v_smfmac_f32_16x16x64_bf16 v[60:63], v[24:27], v[140:147], v2
    ds_read_b128 v[140:143], v13 offset:20480
    ds_read_b128 v[144:147], v13 offset:21504
    v_smfmac_f32_16x16x64_bf16 v[60:63], v[28:31], a[80:87], v2
    v_cvt_pk_bf16_f32 v56, v56, v57
    ds_write_b16 v3, v56 offset:0
    s_waitcnt lgkmcnt(7)
    v_smfmac_f32_16x16x64_bf16 v[60:63], v[32:35], v[148:155], v2
    ds_read_b128 v[148:151], v13 offset:22528
    ds_read_b128 v[152:155], v13 offset:23552
    v_smfmac_f32_16x16x64_bf16 v[60:63], v[36:39], a[88:95], v2
    ds_write_b16_d16_hi v3, v56 offset:400
    s_waitcnt lgkmcnt(8)
    v_smfmac_f32_16x16x64_bf16 v[60:63], v[48:51], v[124:131], v2
    ds_read_b128 v[124:127], v13 offset:24576
    ds_read_b128 v[128:131], v13 offset:25600
    v_smfmac_f32_16x16x64_bf16 v[60:63], v[52:55], a[96:103], v2
    s_waitcnt lgkmcnt(8)
    v_smfmac_f32_16x16x64_bf16 v[64:67], v[16:19], v[132:139], v2
    ds_read_b128 v[132:135], v13 offset:26624
    ds_read_b128 v[136:139], v13 offset:27648
    v_smfmac_f32_16x16x64_bf16 v[64:67], v[20:23], a[104:111], v2
    v_add_f32 v60, v60, v62
    v_add_f32 v61, v61, v63
    s_waitcnt lgkmcnt(8)
    v_smfmac_f32_16x16x64_bf16 v[64:67], v[24:27], v[140:147], v2
    ds_read_b128 v[140:143], v13 offset:28672
    ds_read_b128 v[144:147], v13 offset:29696
    v_smfmac_f32_16x16x64_bf16 v[64:67], v[28:31], a[112:119], v2
    v_cvt_pk_bf16_f32 v60, v60, v61
    ds_write_b16 v3, v60 offset:128
    s_waitcnt lgkmcnt(8)
    v_smfmac_f32_16x16x64_bf16 v[64:67], v[32:35], v[148:155], v2
    ds_read_b128 v[148:151], v13 offset:30720
    ds_read_b128 v[152:155], v13 offset:31744
    v_smfmac_f32_16x16x64_bf16 v[64:67], v[36:39], a[120:127], v2
    ds_write_b16_d16_hi v3, v60 offset:528
    v_smfmac_f32_16x16x64_bf16 v[64:67], v[48:51], a[128:135], v2
    v_smfmac_f32_16x16x64_bf16 v[64:67], v[52:55], a[136:143], v2
    v_smfmac_f32_16x16x64_bf16 v[68:71], v[16:19], a[144:151], v2
    s_waitcnt lgkmcnt(8)
    v_smfmac_f32_16x16x64_bf16 v[68:71], v[20:23], v[124:131], v2
    v_add_f32 v64, v64, v66
    v_add_f32 v65, v65, v67
    v_smfmac_f32_16x16x64_bf16 v[68:71], v[24:27], a[152:159], v2
    v_cvt_pk_bf16_f32 v64, v64, v65
    ds_write_b16 v3, v64 offset:256
    v_smfmac_f32_16x16x64_bf16 v[68:71], v[28:31], a[160:167], v2
    ds_write_b16_d16_hi v3, v64 offset:656
    v_smfmac_f32_16x16x64_bf16 v[68:71], v[32:35], a[168:175], v2
    s_waitcnt lgkmcnt(8)
    v_smfmac_f32_16x16x64_bf16 v[68:71], v[36:39], v[132:139], v2
    v_smfmac_f32_16x16x64_bf16 v[68:71], v[40:43], a[176:183], v2
    s_waitcnt lgkmcnt(0)
    s_barrier
    ds_read_b128 v[88:91], v4 offset:0
    v_smfmac_f32_16x16x64_bf16 v[68:71], v[44:47], a[184:191], v2
    ds_read_b128 v[92:95], v4 offset:128
    ds_read_b128 v[96:99], v4 offset:256
    v_smfmac_f32_16x16x64_bf16 v[68:71], v[48:51], a[192:199], v2
    v_smfmac_f32_16x16x64_bf16 v[68:71], v[52:55], v[140:147], v2
    v_smfmac_f32_16x16x64_bf16 v[72:75], v[16:19], a[200:207], v2
    v_smfmac_f32_16x16x64_bf16 v[72:75], v[20:23], a[208:215], v2
    v_add_f32 v68, v68, v70
    v_add_f32 v69, v69, v71
    v_smfmac_f32_16x16x64_bf16 v[72:75], v[24:27], a[216:223], v2
    v_cvt_pk_bf16_f32 v68, v68, v69
    ds_write_b16 v3, v68 offset:3200
    s_waitcnt lgkmcnt(1)
    v_smfmac_f32_16x16x64_bf16 v[80:83], v[88:91], v[100:107], v2
    v_smfmac_f32_16x16x64_bf16 v[80:83], v[92:95], v[108:115], v2
    v_smfmac_f32_16x16x64_bf16 v[80:83], v[96:99], v[116:123], v2
    v_smfmac_f32_16x16x64_bf16 v[72:75], v[28:31], a[224:231], v2
    ds_write_b16_d16_hi v3, v68 offset:3600
    v_smfmac_f32_16x16x64_bf16 v[72:75], v[32:35], a[232:239], v2
    v_add_f32 v56, v81, v83
    v_mul_f32 v56, 0x3dd53b95, v56
    v_smfmac_f32_16x16x64_bf16 v[72:75], v[36:39], a[240:247], v2
    v_max_f32_dpp v58, v56, v56 row_ror:8 row_mask:0xf bank_mask:0xf
    v_smfmac_f32_16x16x64_bf16 v[72:75], v[40:43], v[148:155], v2
    v_max_f32_dpp v58, v58, v58 row_ror:4 row_mask:0xf bank_mask:0xf
    v_smfmac_f32_16x16x64_bf16 v[72:75], v[44:47], a[248:255], v2
    v_max_f32_dpp v58, v58, v58 row_ror:2 row_mask:0xf bank_mask:0xf
    v_smfmac_f32_16x16x64_bf16 v[72:75], v[48:51], v[156:163], v2
    v_max_f32_dpp v58, v58, v58 row_ror:1 row_mask:0xf bank_mask:0xf
    v_smfmac_f32_16x16x64_bf16 v[72:75], v[52:55], v[164:171], v2
    v_sub_f32 v60, v56, v58
    v_exp_f32 v60, v60
    v_smfmac_f32_16x16x64_bf16 v[76:79], v[16:19], v[172:179], v2
    v_add_f32_dpp v59, v60, v60 row_ror:8 row_mask:0xf bank_mask:0xf
    v_smfmac_f32_16x16x64_bf16 v[76:79], v[20:23], v[180:187], v2
    v_add_f32_dpp v59, v59, v59 row_ror:4 row_mask:0xf bank_mask:0xf
    v_add_f32 v72, v72, v74
    v_smfmac_f32_16x16x64_bf16 v[76:79], v[24:27], v[188:195], v2
    v_add_f32_dpp v59, v59, v59 row_ror:2 row_mask:0xf bank_mask:0xf
    v_add_f32 v73, v73, v75
    v_smfmac_f32_16x16x64_bf16 v[76:79], v[28:31], v[196:203], v2
    v_add_f32_dpp v59, v59, v59 row_ror:1 row_mask:0xf bank_mask:0xf
    v_cvt_pk_bf16_f32 v72, v72, v73
    v_smfmac_f32_16x16x64_bf16 v[76:79], v[32:35], v[204:211], v2
    ds_write_b64 v6, v[58:59] offset:1024
    ds_write_b16 v3, v72 offset:3328
    v_smfmac_f32_16x16x64_bf16 v[76:79], v[36:39], v[212:219], v2
    ds_write_b16_d16_hi v3, v72 offset:3728
    v_smfmac_f32_16x16x64_bf16 v[76:79], v[40:43], v[220:227], v2
    s_waitcnt lgkmcnt(0)
    s_barrier
    ds_read_b128 v[100:103], v5 offset:0
    ds_read_b128 v[104:107], v5 offset:16
    v_smfmac_f32_16x16x64_bf16 v[76:79], v[44:47], v[228:235], v2
    ds_read_b128 v[108:111], v5 offset:128
    ds_read_b128 v[112:115], v5 offset:144
    v_smfmac_f32_16x16x64_bf16 v[76:79], v[48:51], v[236:243], v2
    v_smfmac_f32_16x16x64_bf16 v[76:79], v[52:55], v[244:251], v2
    s_waitcnt lgkmcnt(2)
    v_smfmac_f32_16x16x64_bf16 v[84:87], v[88:91], v[100:107], v2
    s_waitcnt lgkmcnt(0)
    v_smfmac_f32_16x16x64_bf16 v[84:87], v[92:95], v[108:115], v2
    v_add_f32 v76, v76, v78
    v_add_f32 v77, v77, v79
    v_cvt_pk_bf16_f32 v76, v76, v77
    ds_write_b16 v3, v76 offset:3456
    ds_write_b16_d16_hi v3, v76 offset:3856
    s_waitcnt lgkmcnt(0)
    s_barrier
    ds_read_b128 v[116:119], v5 offset:256
    ds_read_b128 v[120:123], v5 offset:272
    ds_read_b64 v[16:17], v6 offset:1536
    s_waitcnt lgkmcnt(1)
    v_smfmac_f32_16x16x64_bf16 v[84:87], v[96:99], v[116:123], v2
    s_waitcnt lgkmcnt(0)
    v_max_f32 v18, v58, v16
    v_sub_f32 v19, v58, v18
    v_sub_f32 v20, v16, v18
    v_exp_f32 v19, v19
    v_exp_f32 v20, v20
    s_nop 0
    v_mul_f32 v21, v59, v19
    v_mul_f32 v60, v60, v19
    v_fmac_f32 v21, v17, v20
    v_add_f32 v22, v85, v87
    v_mul_f32 v22, 0x3dd53b95, v22
    v_max_f32 v23, v22, v18
    s_nop 0
    v_max_f32_dpp v24, v22, v23 row_ror:4 row_mask:0xf bank_mask:0xf
    s_nop 1
    v_max_f32_dpp v24, v24, v24 row_ror:2 row_mask:0xf bank_mask:0xf
    s_nop 1
    v_max_f32_dpp v24, v24, v24 row_ror:1 row_mask:0xf bank_mask:0xf
    v_sub_f32 v25, v22, v24
    v_sub_f32 v26, v18, v24
    v_exp_f32 v25, v25
    v_exp_f32 v26, v26
    s_nop 0
    v_add_f32_dpp v23, v25, v25 row_ror:4 row_mask:0xf bank_mask:0xf
    v_mul_f32 v60, v60, v26
    s_nop 0
    v_add_f32_dpp v23, v23, v23 row_ror:2 row_mask:0xf bank_mask:0xf
    s_nop 1
    v_add_f32_dpp v23, v23, v23 row_ror:1 row_mask:0xf bank_mask:0xf
    v_fmac_f32 v23, v26, v21
    v_rcp_f32 v27, v23
    s_nop 0
    v_mul_f32 v60, v60, v27
    v_mul_f32 v25, v25, v27
    s_nop 0
    v_mov_b32_dpp v19, v60 quad_perm:[1,0,3,2] row_mask:0xf bank_mask:0xf
    v_mov_b32_dpp v20, v25 quad_perm:[1,0,3,2] row_mask:0xf bank_mask:0xf
    v_cvt_pk_bf16_f32 v60, v60, v19
    v_cvt_pk_bf16_f32 v25, v25, v20
    buffer_store_dword v60, v7, s[8:11], s18 offen sc1
    buffer_store_dword v25, v8, s[8:11], s18 offen sc1
    ds_read_b128 v[40:43], v10
    s_add_u32 s28, s14, 1
    s_min_u32 s28, s28, 63
    s_cmp_gt_u32 s47, s28
    s_cbranch_scc1 layerb1_kernel_p2_gw2_ok
layerb1_kernel_p2_gw2_lp:
    buffer_load_dword v253, v255, s[8:11], s48 offen sc1
    s_waitcnt vmcnt(0)
    v_readlane_b32 s47, v253, 0
    v_readlane_b32 s29, v253, 1
    s_nop 0
    s_min_u32 s47, s47, s29
    s_sub_u32 s15, s15, 1
    s_cbranch_scc1 layerb1_kernel_bail
    s_cmp_gt_u32 s47, s28
    s_cbranch_scc0 layerb1_kernel_p2_gw2_lp
layerb1_kernel_p2_gw2_ok:
    s_mul_i32 s20, s28, 393216
    s_add_u32 s20, s20, s44
    s_add_u32 s21, s20, 0
    buffer_load_dwordx4 v[100:103], v9, s[8:11], s21 offen offset:0 sc1
    buffer_load_dwordx4 v[104:107], v9, s[8:11], s21 offen offset:512 sc1
    s_add_u32 s21, s20, 4096
    buffer_load_dwordx4 v[108:111], v9, s[8:11], s21 offen offset:0 sc1
    buffer_load_dwordx4 v[112:115], v9, s[8:11], s21 offen offset:512 sc1
    s_add_u32 s21, s20, 8192
    buffer_load_dwordx4 v[116:119], v9, s[8:11], s21 offen offset:0 sc1
    buffer_load_dwordx4 v[120:123], v9, s[8:11], s21 offen offset:512 sc1
    v_mov_b32 v56, 0
    v_mov_b32 v57, 0
    v_mov_b32 v58, 0
    v_mov_b32 v59, 0
    v_mov_b32 v60, 0
    v_mov_b32 v61, 0
    v_mov_b32 v62, 0
    v_mov_b32 v63, 0
    v_mov_b32 v64, 0
    v_mov_b32 v65, 0
    v_mov_b32 v66, 0
    v_mov_b32 v67, 0
    v_mov_b32 v68, 0
    v_mov_b32 v69, 0
    v_mov_b32 v70, 0
    v_mov_b32 v71, 0
    v_mov_b32 v72, 0
    v_mov_b32 v73, 0
    v_mov_b32 v74, 0
    v_mov_b32 v75, 0
    v_mov_b32 v76, 0
    v_mov_b32 v77, 0
    v_mov_b32 v78, 0
    v_mov_b32 v79, 0
    v_mov_b32 v80, 0
    v_mov_b32 v81, 0
    v_mov_b32 v82, 0
    v_mov_b32 v83, 0
    v_mov_b32 v84, 0
    v_mov_b32 v85, 0
    v_mov_b32 v86, 0
    v_mov_b32 v87, 0
    s_waitcnt lgkmcnt(0)
    s_mul_i32 s20, s14, 98304
    s_add_u32 s20, s20, s45
    buffer_store_dwordx4 v[40:43], v11, s[8:11], s20 offen sc1
    ds_read_b128 v[124:127], v13 offset:0
    ds_read_b128 v[128:131], v13 offset:1024
    ds_read_b128 v[132:135], v13 offset:2048
    ds_read_b128 v[136:139], v13 offset:3072
    ds_read_b128 v[140:143], v13 offset:4096
    ds_read_b128 v[144:147], v13 offset:5120
    ds_read_b128 v[148:151], v13 offset:6144
    ds_read_b128 v[152:155], v13 offset:7168
    s_waitcnt lgkmcnt(0)
    s_add_u32 s14, s14, 1
    s_cmp_lt_u32 s14, 64
    s_cbranch_scc1 layerb1_kernel_p2_step
    s_waitcnt vmcnt(0)
    s_barrier
    s_branch layerb1_kernel_end
layerb1_kernel_p3_start:
    v_lshrrev_b32 v16, 4, v0
    v_and_b32 v17, 15, v0
    v_and_b32 v18, 2, v0
    v_cmp_eq_u32 vcc, 0, v18
    v_mov_b32 v18, 0xeeeeeeee
    v_mov_b32 v19, 0x44444444
    v_cndmask_b32 v2, v18, v19, vcc
    v_lshrrev_b32 v20, 2, v17
    v_lshlrev_b32 v20, 1, v20
    v_and_b32 v21, 1, v17
    v_add_u32 v20, v20, v21
    v_bfe_u32 v21, v17, 1, 1
    v_lshl_add_u32 v18, v16, 1, v21
    v_lshlrev_b32 v18, 7, v18
    v_lshl_add_u32 v12, v20, 4, v18
    v_mul_u32_u24 v18, 400, v20
    v_lshl_add_u32 v18, v16, 5, v18
    v_lshl_add_u32 v18, v21, 4, v18
    v_add_u32 v4, 141312, v18
    v_mul_u32_u24 v18, 800, v16
    v_lshl_add_u32 v18, v17, 1, v18
    v_add_u32 v3, 141408, v18
    v_and_b32 v18, 7, v0
    v_mul_u32_u24 v18, 400, v18
    v_lshl_add_u32 v18, v16, 5, v18
    v_add_u32 v5, 144512, v18
    v_lshlrev_b32 v18, 3, v0
    v_add_u32 v6, 147712, v18
    v_lshlrev_b32 v18, 4, v16
    v_bfe_u32 v19, v17, 1, 2
    v_lshl_add_u32 v18, v19, 2, v18
    s_lshl_b32 s20, s12, 7
    s_add_u32 s20, s20, 64
    v_add_u32 v18, s20, v18
    v_lshrrev_b32 v19, 3, v17
    v_add_u32 v19, 3, v19
    v_lshrrev_b32 v20, 1, v19
    v_lshlrev_b32 v20, 14, v20
    v_and_b32 v19, 1, v19
    v_lshl_add_u32 v19, v19, 12, v20
    v_add_u32 v19, v19, v18
    v_mov_b32 v20, 0x7ffffff0
    v_and_b32 v21, 1, v0
    v_cmp_eq_u32 vcc, 0, v21
    s_nop 1
    v_cndmask_b32 v7, v20, v19, vcc
    v_and_b32 v21, 0x29, v0
    v_cmp_eq_u32 vcc, 32, v21
    s_nop 1
    v_cndmask_b32 v8, v20, v18, vcc
    v_lshlrev_b32 v18, 4, v17
    v_lshl_add_u32 v18, v16, 10, v18
    v_add_u32 v9, 256, v18
    v_add_u32 v18, 192, v0
    v_mul_u32_u24 v19, 2731, v18
    v_lshrrev_b32 v19, 16, v19
    v_mul_u32_u24 v20, 24, v19
    v_sub_u32 v20, v18, v20
    v_mul_u32_u24 v21, 400, v19
    v_lshl_add_u32 v21, v20, 4, v21
    v_add_u32 v10, 144512, v21
    v_lshlrev_b32 v21, 4, v19
    v_lshl_add_u32 v11, v20, 7, v21
    v_add_u32 v13, 98304, v1
    v_add_u32 v14, 131072, v1
    s_mul_i32 s44, s12, 12288
    s_add_u32 s44, s44, 53477376
    s_mul_i32 s45, s12, 3072
    s_add_u32 s45, s45, 208666624
    s_mul_i32 s20, s12, 6
    s_add_u32 s21, s20, 5
    s_lshr_b32 s20, s20, 3
    s_lshr_b32 s21, s21, 3
    s_add_u32 s20, s20, 80
    s_add_u32 s21, s21, 80
    s_lshl_b32 s20, s20, 7
    s_lshl_b32 s21, s21, 7
    v_mov_b32 v255, s21
    v_mov_b32 v253, s20
    v_cmp_eq_u32 vcc, 0, v0
    s_nop 1
    v_cndmask_b32 v255, v255, v253, vcc
    s_mov_b32 s47, 0
    s_mul_i32 s20, s12, 491520
    s_add_u32 s20, s20, 11902976
    s_add_u32 s21, s20, 38912
    buffer_load_dwordx4 v[16:19], v1, s[8:11], s21 offen offset:0
    buffer_load_dwordx4 v[20:23], v1, s[8:11], s21 offen offset:1024
    s_add_u32 s21, s20, 0
    buffer_load_dwordx4 v[24:27], v1, s[8:11], s21 offen offset:0
    buffer_load_dwordx4 v[28:31], v1, s[8:11], s21 offen offset:1024
    s_add_u32 s21, s20, 4096
    buffer_load_dwordx4 v[32:35], v1, s[8:11], s21 offen offset:0
    buffer_load_dwordx4 v[36:39], v1, s[8:11], s21 offen offset:1024
    s_add_u32 s21, s20, 8192
    buffer_load_dwordx4 v[40:43], v1, s[8:11], s21 offen offset:0
    buffer_load_dwordx4 v[44:47], v1, s[8:11], s21 offen offset:1024
    s_add_u32 s21, s20, 12288
    buffer_load_dwordx4 v[48:51], v1, s[8:11], s21 offen offset:0
    buffer_load_dwordx4 v[52:55], v1, s[8:11], s21 offen offset:1024
    s_add_u32 s21, s20, 20480
    buffer_load_dwordx4 v[56:59], v1, s[8:11], s21 offen offset:0
    buffer_load_dwordx4 v[60:63], v1, s[8:11], s21 offen offset:1024
    s_add_u32 s21, s20, 24576
    buffer_load_dwordx4 v[64:67], v1, s[8:11], s21 offen offset:0
    buffer_load_dwordx4 v[68:71], v1, s[8:11], s21 offen offset:1024
    s_add_u32 s21, s20, 28672
    buffer_load_dwordx4 v[72:75], v1, s[8:11], s21 offen offset:0
    buffer_load_dwordx4 v[76:79], v1, s[8:11], s21 offen offset:1024
    s_add_u32 s21, s20, 32768
    buffer_load_dwordx4 v[80:83], v1, s[8:11], s21 offen offset:0
    buffer_load_dwordx4 v[84:87], v1, s[8:11], s21 offen offset:1024
    s_add_u32 s21, s20, 40960
    buffer_load_dwordx4 v[88:91], v1, s[8:11], s21 offen offset:0
    buffer_load_dwordx4 v[92:95], v1, s[8:11], s21 offen offset:1024
    s_add_u32 s21, s20, 45056
    buffer_load_dwordx4 v[96:99], v1, s[8:11], s21 offen offset:0
    buffer_load_dwordx4 v[100:103], v1, s[8:11], s21 offen offset:1024
    s_add_u32 s21, s20, 49152
    buffer_load_dwordx4 v[104:107], v1, s[8:11], s21 offen offset:0
    buffer_load_dwordx4 v[108:111], v1, s[8:11], s21 offen offset:1024
    s_add_u32 s21, s20, 63488
    buffer_load_dwordx4 v[112:115], v1, s[8:11], s21 offen offset:0
    buffer_load_dwordx4 v[116:119], v1, s[8:11], s21 offen offset:1024
    s_add_u32 s21, s20, 71680
    buffer_load_dwordx4 v[120:123], v1, s[8:11], s21 offen offset:0
    buffer_load_dwordx4 v[124:127], v1, s[8:11], s21 offen offset:1024
    s_add_u32 s21, s20, 79872
    buffer_load_dwordx4 v[128:131], v1, s[8:11], s21 offen offset:0
    buffer_load_dwordx4 v[132:135], v1, s[8:11], s21 offen offset:1024
    s_add_u32 s21, s20, 94208
    buffer_load_dwordx4 v[136:139], v1, s[8:11], s21 offen offset:0
    buffer_load_dwordx4 v[140:143], v1, s[8:11], s21 offen offset:1024
    s_add_u32 s21, s20, 98304
    buffer_load_dwordx4 v[156:159], v1, s[8:11], s21 offen offset:0
    buffer_load_dwordx4 v[160:163], v1, s[8:11], s21 offen offset:1024
    s_add_u32 s21, s20, 100352
    buffer_load_dwordx4 v[164:167], v1, s[8:11], s21 offen offset:0
    buffer_load_dwordx4 v[168:171], v1, s[8:11], s21 offen offset:1024
    s_add_u32 s21, s20, 102400
    buffer_load_dwordx4 v[172:175], v1, s[8:11], s21 offen offset:0
    buffer_load_dwordx4 v[176:179], v1, s[8:11], s21 offen offset:1024
    s_add_u32 s21, s20, 104448
    buffer_load_dwordx4 v[180:183], v1, s[8:11], s21 offen offset:0
    buffer_load_dwordx4 v[184:187], v1, s[8:11], s21 offen offset:1024
    s_add_u32 s21, s20, 106496
    buffer_load_dwordx4 v[188:191], v1, s[8:11], s21 offen offset:0
    buffer_load_dwordx4 v[192:195], v1, s[8:11], s21 offen offset:1024
    s_add_u32 s21, s20, 108544
    buffer_load_dwordx4 v[196:199], v1, s[8:11], s21 offen offset:0
    buffer_load_dwordx4 v[200:203], v1, s[8:11], s21 offen offset:1024
    s_add_u32 s21, s20, 110592
    buffer_load_dwordx4 v[204:207], v1, s[8:11], s21 offen offset:0
    buffer_load_dwordx4 v[208:211], v1, s[8:11], s21 offen offset:1024
    s_add_u32 s21, s20, 112640
    buffer_load_dwordx4 v[212:215], v1, s[8:11], s21 offen offset:0
    buffer_load_dwordx4 v[216:219], v1, s[8:11], s21 offen offset:1024
    s_add_u32 s21, s20, 114688
    buffer_load_dwordx4 v[220:223], v1, s[8:11], s21 offen offset:0
    buffer_load_dwordx4 v[224:227], v1, s[8:11], s21 offen offset:1024
    s_add_u32 s21, s20, 116736
    buffer_load_dwordx4 v[228:231], v1, s[8:11], s21 offen offset:0
    buffer_load_dwordx4 v[232:235], v1, s[8:11], s21 offen offset:1024
    s_add_u32 s21, s20, 118784
    buffer_load_dwordx4 v[236:239], v1, s[8:11], s21 offen offset:0
    buffer_load_dwordx4 v[240:243], v1, s[8:11], s21 offen offset:1024
    s_add_u32 s21, s20, 120832
    buffer_load_dwordx4 v[244:247], v1, s[8:11], s21 offen offset:0
    buffer_load_dwordx4 v[248:251], v1, s[8:11], s21 offen offset:1024
    s_waitcnt vmcnt(24)
    ds_write_b128 v13, v[16:19] offset:0
    ds_write_b128 v13, v[20:23] offset:1024
    ds_write_b128 v13, v[24:27] offset:2048
    ds_write_b128 v13, v[28:31] offset:3072
    ds_write_b128 v13, v[32:35] offset:4096
    ds_write_b128 v13, v[36:39] offset:5120
    ds_write_b128 v13, v[40:43] offset:6144
    ds_write_b128 v13, v[44:47] offset:7168
    ds_write_b128 v13, v[48:51] offset:8192
    ds_write_b128 v13, v[52:55] offset:9216
    ds_write_b128 v13, v[56:59] offset:10240
    ds_write_b128 v13, v[60:63] offset:11264
    ds_write_b128 v13, v[64:67] offset:12288
    ds_write_b128 v13, v[68:71] offset:13312
    ds_write_b128 v13, v[72:75] offset:14336
    ds_write_b128 v13, v[76:79] offset:15360
    ds_write_b128 v13, v[80:83] offset:16384
    ds_write_b128 v13, v[84:87] offset:17408
    ds_write_b128 v13, v[88:91] offset:18432
    ds_write_b128 v13, v[92:95] offset:19456
    ds_write_b128 v13, v[96:99] offset:20480
    ds_write_b128 v13, v[100:103] offset:21504
    ds_write_b128 v13, v[104:107] offset:22528
    ds_write_b128 v13, v[108:111] offset:23552
    ds_write_b128 v13, v[112:115] offset:24576
    ds_write_b128 v13, v[116:119] offset:25600
    ds_write_b128 v13, v[120:123] offset:26624
    ds_write_b128 v13, v[124:127] offset:27648
    ds_write_b128 v13, v[128:131] offset:28672
    ds_write_b128 v13, v[132:135] offset:29696
    ds_write_b128 v13, v[136:139] offset:30720
    ds_write_b128 v13, v[140:143] offset:31744
    s_waitcnt lgkmcnt(0)
    s_mov_b32 s14, 0
    s_cmp_gt_u32 s47, s14
    s_cbranch_scc1 layerb1_kernel_p3_gw1_ok
layerb1_kernel_p3_gw1_lp:
    buffer_load_dword v253, v255, s[8:11], s48 offen sc1
    s_waitcnt vmcnt(0)
    v_readlane_b32 s47, v253, 0
    v_readlane_b32 s29, v253, 1
    s_nop 0
    s_min_u32 s47, s47, s29
    s_sub_u32 s15, s15, 1
    s_cbranch_scc1 layerb1_kernel_bail
    s_cmp_gt_u32 s47, s14
    s_cbranch_scc0 layerb1_kernel_p3_gw1_lp
layerb1_kernel_p3_gw1_ok:
    s_mul_i32 s20, s14, 393216
    s_add_u32 s20, s20, s44
    s_add_u32 s21, s20, 0
    buffer_load_dwordx4 v[100:103], v9, s[8:11], s21 offen offset:0 sc1
    buffer_load_dwordx4 v[104:107], v9, s[8:11], s21 offen offset:512 sc1
    s_add_u32 s21, s20, 4096
    buffer_load_dwordx4 v[108:111], v9, s[8:11], s21 offen offset:0 sc1
    buffer_load_dwordx4 v[112:115], v9, s[8:11], s21 offen offset:512 sc1
    s_add_u32 s21, s20, 8192
    buffer_load_dwordx4 v[116:119], v9, s[8:11], s21 offen offset:0 sc1
    buffer_load_dwordx4 v[120:123], v9, s[8:11], s21 offen offset:512 sc1
    v_mov_b32 v56, 0
    v_mov_b32 v57, 0
    v_mov_b32 v58, 0
    v_mov_b32 v59, 0
    v_mov_b32 v60, 0
    v_mov_b32 v61, 0
    v_mov_b32 v62, 0
    v_mov_b32 v63, 0
    v_mov_b32 v64, 0
    v_mov_b32 v65, 0
    v_mov_b32 v66, 0
    v_mov_b32 v67, 0
    v_mov_b32 v68, 0
    v_mov_b32 v69, 0
    v_mov_b32 v70, 0
    v_mov_b32 v71, 0
    v_mov_b32 v72, 0
    v_mov_b32 v73, 0
    v_mov_b32 v74, 0
    v_mov_b32 v75, 0
    v_mov_b32 v76, 0
    v_mov_b32 v77, 0
    v_mov_b32 v78, 0
    v_mov_b32 v79, 0
    v_mov_b32 v80, 0
    v_mov_b32 v81, 0
    v_mov_b32 v82, 0
    v_mov_b32 v83, 0
    v_mov_b32 v84, 0
    v_mov_b32 v85, 0
    v_mov_b32 v86, 0
    v_mov_b32 v87, 0
    ds_read_b128 v[124:127], v13 offset:0
    ds_read_b128 v[128:131], v13 offset:1024
    ds_read_b128 v[132:135], v13 offset:2048
    ds_read_b128 v[136:139], v13 offset:3072
    ds_read_b128 v[140:143], v13 offset:4096
    ds_read_b128 v[144:147], v13 offset:5120
    ds_read_b128 v[148:151], v13 offset:6144
    ds_read_b128 v[152:155], v13 offset:7168
    s_waitcnt lgkmcnt(0)
layerb1_kernel_p3_step:
    s_cmp_lt_u32 s14, 32
    s_cselect_b32 s18, s16, s17
    s_and_b32 s20, s14, 31
    s_lshl_b32 s20, s20, 16
    s_add_u32 s18, s18, s20
    s_add_u32 s22, s18, 53248
    s_add_u32 s23, s18, 54272
layerb1_kernel_p3_poll:
    buffer_load_dwordx4 v[48:51], v12, s[8:11], s22 offen sc1
    buffer_load_dwordx4 v[52:55], v12, s[8:11], s23 offen sc1
    s_waitcnt vmcnt(0)
    ds_write_b128 v14, v[48:51] offset:8192
    ds_write_b128 v14, v[52:55] offset:9216
    v_max3_u32 v88, v48, v49, v50
    v_max3_u32 v88, v88, v51, v52
    v_max3_u32 v88, v88, v53, v54
    v_max_u32 v88, v88, v55
    v_cmp_eq_u32 vcc, -1, v88
    s_sub_u32 s15, s15, 1
    s_cbranch_scc1 layerb1_kernel_bail
    s_cbranch_vccnz layerb1_kernel_p3_poll
    v_smfmac_f32_16x16x64_bf16 v[56:59], v[48:51], a[0:7], v2
    v_smfmac_f32_16x16x64_bf16 v[60:63], v[48:51], a[8:15], v2
    s_waitcnt lgkmcnt(0)
    s_barrier
    ds_read_b128 v[16:19], v14 offset:0
    ds_read_b128 v[20:23], v14 offset:1024
    ds_read_b128 v[24:27], v14 offset:2048
    v_smfmac_f32_16x16x64_bf16 v[64:67], v[48:51], a[16:23], v2
    ds_read_b128 v[28:31], v14 offset:3072
    ds_read_b128 v[32:35], v14 offset:4096
    v_smfmac_f32_16x16x64_bf16 v[56:59], v[52:55], a[24:31], v2
    ds_read_b128 v[36:39], v14 offset:5120
    ds_read_b128 v[40:43], v14 offset:6144
    v_smfmac_f32_16x16x64_bf16 v[60:63], v[52:55], v[124:131], v2
    ds_read_b128 v[44:47], v14 offset:7168
    ds_read_b128 v[124:127], v13 offset:8192
    v_smfmac_f32_16x16x64_bf16 v[64:67], v[52:55], a[32:39], v2
    ds_read_b128 v[128:131], v13 offset:9216
    s_waitcnt lgkmcnt(9)
    v_smfmac_f32_16x16x64_bf16 v[56:59], v[16:19], v[132:139], v2
    ds_read_b128 v[132:135], v13 offset:10240
    ds_read_b128 v[136:139], v13 offset:11264
    s_waitcnt lgkmcnt(10)
    v_smfmac_f32_16x16x64_bf16 v[56:59], v[20:23], a[40:47], v2
    s_waitcnt lgkmcnt(9)
    v_smfmac_f32_16x16x64_bf16 v[56:59], v[24:27], v[140:147], v2
    ds_read_b128 v[140:143], v13 offset:12288
    ds_read_b128 v[144:147], v13 offset:13312
    s_waitcnt lgkmcnt(10)
    v_smfmac_f32_16x16x64_bf16 v[56:59], v[28:31], a[48:55], v2
    s_waitcnt lgkmcnt(9)
    v_smfmac_f32_16x16x64_bf16 v[56:59], v[32:35], v[148:155], v2
    ds_read_b128 v[148:151], v13 offset:14336
    ds_read_b128 v[152:155], v13 offset:15360
    s_waitcnt lgkmcnt(10)
    v_smfmac_f32_16x16x64_bf16 v[56:59], v[36:39], a[56:63], v2
    s_waitcnt lgkmcnt(9)
    s_waitcnt lgkmcnt(6)
    v_smfmac_f32_16x16x64_bf16 v[56:59], v[40:43], v[124:131], v2
    ds_read_b128 v[124:127], v13 offset:16384
    ds_read_b128 v[128:131], v13 offset:17408
    v_smfmac_f32_16x16x64_bf16 v[56:59], v[44:47], a[64:71], v2
    s_waitcnt lgkmcnt(6)
    v_smfmac_f32_16x16x64_bf16 v[60:63], v[16:19], v[132:139], v2
    ds_read_b128 v[132:135], v13 offset:18432
    ds_read_b128 v[136:139], v13 offset:19456
    v_smfmac_f32_16x16x64_bf16 v[60:63], v[20:23], a[72:79], v2
    v_add_f32 v56, v56, v58
    v_add_f32 v57, v57, v59
    s_waitcnt lgkmcnt(6)
    v_smfmac_f32_16x16x64_bf16 v[60:63], v[24:27], v[140:147], v2
    ds_read_b128 v[140:143], v13 offset:20480
    ds_read_b128 v[144:147], v13 offset:21504
    v_smfmac_f32_16x16x64_bf16 v[60:63], v[28:31], a[80:87], v2
    v_cvt_pk_bf16_f32 v56, v56, v57
    ds_write_b16 v3, v56 offset:0
    s_waitcnt lgkmcnt(7)
    v_smfmac_f32_16x16x64_bf16 v[60:63], v[32:35], v[148:155], v2
    ds_read_b128 v[148:151], v13 offset:22528
    ds_read_b128 v[152:155], v13 offset:23552
    v_smfmac_f32_16x16x64_bf16 v[60:63], v[36:39], a[88:95], v2
    ds_write_b16_d16_hi v3, v56 offset:400
    s_waitcnt lgkmcnt(8)
    v_smfmac_f32_16x16x64_bf16 v[60:63], v[40:43], v[124:131], v2
    ds_read_b128 v[124:127], v13 offset:24576
    ds_read_b128 v[128:131], v13 offset:25600
    v_smfmac_f32_16x16x64_bf16 v[60:63], v[44:47], a[96:103], v2
    s_waitcnt lgkmcnt(8)
    v_smfmac_f32_16x16x64_bf16 v[64:67], v[16:19], v[132:139], v2
    ds_read_b128 v[132:135], v13 offset:26624
    ds_read_b128 v[136:139], v13 offset:27648
    v_smfmac_f32_16x16x64_bf16 v[64:67], v[20:23], a[104:111], v2
    v_add_f32 v60, v60, v62
    v_add_f32 v61, v61, v63
    s_waitcnt lgkmcnt(8)
    v_smfmac_f32_16x16x64_bf16 v[64:67], v[24:27], v[140:147], v2
    ds_read_b128 v[140:143], v13 offset:28672
    ds_read_b128 v[144:147], v13 offset:29696
    v_smfmac_f32_16x16x64_bf16 v[64:67], v[28:31], a[112:119], v2
    v_cvt_pk_bf16_f32 v60, v60, v61
    ds_write_b16 v3, v60 offset:128
    s_waitcnt lgkmcnt(8)
    v_smfmac_f32_16x16x64_bf16 v[64:67], v[32:35], v[148:155], v2
    ds_read_b128 v[148:151], v13 offset:30720
    ds_read_b128 v[152:155], v13 offset:31744
    v_smfmac_f32_16x16x64_bf16 v[64:67], v[36:39], a[120:127], v2
    ds_write_b16_d16_hi v3, v60 offset:528
    v_smfmac_f32_16x16x64_bf16 v[64:67], v[40:43], a[128:135], v2
    v_smfmac_f32_16x16x64_bf16 v[64:67], v[44:47], a[136:143], v2
    v_smfmac_f32_16x16x64_bf16 v[68:71], v[16:19], a[144:151], v2
    s_waitcnt lgkmcnt(8)
    v_smfmac_f32_16x16x64_bf16 v[68:71], v[20:23], v[124:131], v2
    v_add_f32 v64, v64, v66
    v_add_f32 v65, v65, v67
    v_smfmac_f32_16x16x64_bf16 v[68:71], v[24:27], a[152:159], v2
    v_cvt_pk_bf16_f32 v64, v64, v65
    ds_write_b16 v3, v64 offset:256
    v_smfmac_f32_16x16x64_bf16 v[68:71], v[28:31], a[160:167], v2
    ds_write_b16_d16_hi v3, v64 offset:656
    v_smfmac_f32_16x16x64_bf16 v[68:71], v[32:35], a[168:175], v2
    s_waitcnt lgkmcnt(8)
    v_smfmac_f32_16x16x64_bf16 v[68:71], v[36:39], v[132:139], v2
    v_smfmac_f32_16x16x64_bf16 v[68:71], v[40:43], a[176:183], v2
    s_waitcnt lgkmcnt(0)
    s_barrier
    ds_read_b128 v[88:91], v4 offset:0
    v_smfmac_f32_16x16x64_bf16 v[68:71], v[44:47], a[184:191], v2
    ds_read_b128 v[92:95], v4 offset:128
    ds_read_b128 v[96:99], v4 offset:256
    v_smfmac_f32_16x16x64_bf16 v[68:71], v[48:51], a[192:199], v2
    v_smfmac_f32_16x16x64_bf16 v[68:71], v[52:55], v[140:147], v2
    v_smfmac_f32_16x16x64_bf16 v[72:75], v[16:19], a[200:207], v2
    v_smfmac_f32_16x16x64_bf16 v[72:75], v[20:23], a[208:215], v2
    v_add_f32 v68, v68, v70
    v_add_f32 v69, v69, v71
    v_smfmac_f32_16x16x64_bf16 v[72:75], v[24:27], a[216:223], v2
    v_cvt_pk_bf16_f32 v68, v68, v69
    ds_write_b16 v3, v68 offset:3200
    s_waitcnt lgkmcnt(1)
    v_smfmac_f32_16x16x64_bf16 v[80:83], v[88:91], v[100:107], v2
    v_smfmac_f32_16x16x64_bf16 v[80:83], v[92:95], v[108:115], v2
    v_smfmac_f32_16x16x64_bf16 v[80:83], v[96:99], v[116:123], v2
    v_smfmac_f32_16x16x64_bf16 v[72:75], v[28:31], a[224:231], v2
    ds_write_b16_d16_hi v3, v68 offset:3600
    v_smfmac_f32_16x16x64_bf16 v[72:75], v[32:35], a[232:239], v2
    v_add_f32 v56, v81, v83
    v_mul_f32 v56, 0x3dd53b95, v56
    v_smfmac_f32_16x16x64_bf16 v[72:75], v[36:39], a[240:247], v2
    v_max_f32_dpp v58, v56, v56 row_ror:8 row_mask:0xf bank_mask:0xf
    v_smfmac_f32_16x16x64_bf16 v[72:75], v[40:43], v[148:155], v2
    v_max_f32_dpp v58, v58, v58 row_ror:4 row_mask:0xf bank_mask:0xf
    v_smfmac_f32_16x16x64_bf16 v[72:75], v[44:47], a[248:255], v2
    v_max_f32_dpp v58, v58, v58 row_ror:2 row_mask:0xf bank_mask:0xf
    v_smfmac_f32_16x16x64_bf16 v[72:75], v[48:51], v[156:163], v2
    v_max_f32_dpp v58, v58, v58 row_ror:1 row_mask:0xf bank_mask:0xf
    v_smfmac_f32_16x16x64_bf16 v[72:75], v[52:55], v[164:171], v2
    v_sub_f32 v60, v56, v58
    v_exp_f32 v60, v60
    v_smfmac_f32_16x16x64_bf16 v[76:79], v[16:19], v[172:179], v2
    v_add_f32_dpp v59, v60, v60 row_ror:8 row_mask:0xf bank_mask:0xf
    v_smfmac_f32_16x16x64_bf16 v[76:79], v[20:23], v[180:187], v2
    v_add_f32_dpp v59, v59, v59 row_ror:4 row_mask:0xf bank_mask:0xf
    v_add_f32 v72, v72, v74
    v_smfmac_f32_16x16x64_bf16 v[76:79], v[24:27], v[188:195], v2
    v_add_f32_dpp v59, v59, v59 row_ror:2 row_mask:0xf bank_mask:0xf
    v_add_f32 v73, v73, v75
    v_smfmac_f32_16x16x64_bf16 v[76:79], v[28:31], v[196:203], v2
    v_add_f32_dpp v59, v59, v59 row_ror:1 row_mask:0xf bank_mask:0xf
    v_cvt_pk_bf16_f32 v72, v72, v73
    v_smfmac_f32_16x16x64_bf16 v[76:79], v[32:35], v[204:211], v2
    ds_write_b64 v6, v[58:59] offset:1536
    ds_write_b16 v3, v72 offset:3328
    v_smfmac_f32_16x16x64_bf16 v[76:79], v[36:39], v[212:219], v2
    ds_write_b16_d16_hi v3, v72 offset:3728
    v_smfmac_f32_16x16x64_bf16 v[76:79], v[40:43], v[220:227], v2
    s_waitcnt lgkmcnt(0)
    s_barrier
    ds_read_b128 v[100:103], v5 offset:0
    ds_read_b128 v[104:107], v5 offset:16
    v_smfmac_f32_16x16x64_bf16 v[76:79], v[44:47], v[228:235], v2
    ds_read_b128 v[108:111], v5 offset:128
    ds_read_b128 v[112:115], v5 offset:144
    v_smfmac_f32_16x16x64_bf16 v[76:79], v[48:51], v[236:243], v2
    v_smfmac_f32_16x16x64_bf16 v[76:79], v[52:55], v[244:251], v2
    s_waitcnt lgkmcnt(2)
    v_smfmac_f32_16x16x64_bf16 v[84:87], v[88:91], v[100:107], v2
    s_waitcnt lgkmcnt(0)
    v_smfmac_f32_16x16x64_bf16 v[84:87], v[92:95], v[108:115], v2
    v_add_f32 v76, v76, v78
    v_add_f32 v77, v77, v79
    v_cvt_pk_bf16_f32 v76, v76, v77
    ds_write_b16 v3, v76 offset:3456
    ds_write_b16_d16_hi v3, v76 offset:3856
    s_waitcnt lgkmcnt(0)
    s_barrier
    ds_read_b128 v[116:119], v5 offset:256
    ds_read_b128 v[120:123], v5 offset:272
    ds_read_b64 v[16:17], v6 offset:1024
    s_waitcnt lgkmcnt(1)
    v_smfmac_f32_16x16x64_bf16 v[84:87], v[96:99], v[116:123], v2
    s_waitcnt lgkmcnt(0)
    v_max_f32 v18, v58, v16
    v_sub_f32 v19, v58, v18
    v_sub_f32 v20, v16, v18
    v_exp_f32 v19, v19
    v_exp_f32 v20, v20
    s_nop 0
    v_mul_f32 v21, v59, v19
    v_mul_f32 v60, v60, v19
    v_fmac_f32 v21, v17, v20
    v_add_f32 v22, v85, v87
    v_mul_f32 v22, 0x3dd53b95, v22
    v_max_f32 v23, v22, v18
    s_nop 0
    v_max_f32_dpp v24, v22, v23 row_ror:4 row_mask:0xf bank_mask:0xf
    s_nop 1
    v_max_f32_dpp v24, v24, v24 row_ror:2 row_mask:0xf bank_mask:0xf
    s_nop 1
    v_max_f32_dpp v24, v24, v24 row_ror:1 row_mask:0xf bank_mask:0xf
    v_sub_f32 v25, v22, v24
    v_sub_f32 v26, v18, v24
    v_exp_f32 v25, v25
    v_exp_f32 v26, v26
    s_nop 0
    v_add_f32_dpp v23, v25, v25 row_ror:4 row_mask:0xf bank_mask:0xf
    v_mul_f32 v60, v60, v26
    s_nop 0
    v_add_f32_dpp v23, v23, v23 row_ror:2 row_mask:0xf bank_mask:0xf
    s_nop 1
    v_add_f32_dpp v23, v23, v23 row_ror:1 row_mask:0xf bank_mask:0xf
    v_fmac_f32 v23, v26, v21
    v_rcp_f32 v27, v23
    s_nop 0
    v_mul_f32 v60, v60, v27
    v_mul_f32 v25, v25, v27
    s_nop 0
    v_mov_b32_dpp v19, v60 quad_perm:[1,0,3,2] row_mask:0xf bank_mask:0xf
    v_mov_b32_dpp v20, v25 quad_perm:[1,0,3,2] row_mask:0xf bank_mask:0xf
    v_cvt_pk_bf16_f32 v60, v60, v19
    v_cvt_pk_bf16_f32 v25, v25, v20
    buffer_store_dword v60, v7, s[8:11], s18 offen sc1
    buffer_store_dword v25, v8, s[8:11], s18 offen sc1
    s_add_u32 s28, s14, 1
    s_min_u32 s28, s28, 63
    s_cmp_gt_u32 s47, s28
    s_cbranch_scc1 layerb1_kernel_p3_gw2_ok
layerb1_kernel_p3_gw2_lp:
    buffer_load_dword v253, v255, s[8:11], s48 offen sc1
    s_waitcnt vmcnt(0)
    v_readlane_b32 s47, v253, 0
    v_readlane_b32 s29, v253, 1
    s_nop 0
    s_min_u32 s47, s47, s29
    s_sub_u32 s15, s15, 1
    s_cbranch_scc1 layerb1_kernel_bail
    s_cmp_gt_u32 s47, s28
    s_cbranch_scc0 layerb1_kernel_p3_gw2_lp
layerb1_kernel_p3_gw2_ok:
    s_mul_i32 s20, s28, 393216
    s_add_u32 s20, s20, s44
    s_add_u32 s21, s20, 0
    buffer_load_dwordx4 v[100:103], v9, s[8:11], s21 offen offset:0 sc1
    buffer_load_dwordx4 v[104:107], v9, s[8:11], s21 offen offset:512 sc1
    s_add_u32 s21, s20, 4096
    buffer_load_dwordx4 v[108:111], v9, s[8:11], s21 offen offset:0 sc1
    buffer_load_dwordx4 v[112:115], v9, s[8:11], s21 offen offset:512 sc1
    s_add_u32 s21, s20, 8192
    buffer_load_dwordx4 v[116:119], v9, s[8:11], s21 offen offset:0 sc1
    buffer_load_dwordx4 v[120:123], v9, s[8:11], s21 offen offset:512 sc1
    v_mov_b32 v56, 0
    v_mov_b32 v57, 0
    v_mov_b32 v58, 0
    v_mov_b32 v59, 0
    v_mov_b32 v60, 0
    v_mov_b32 v61, 0
    v_mov_b32 v62, 0
    v_mov_b32 v63, 0
    v_mov_b32 v64, 0
    v_mov_b32 v65, 0
    v_mov_b32 v66, 0
    v_mov_b32 v67, 0
    v_mov_b32 v68, 0
    v_mov_b32 v69, 0
    v_mov_b32 v70, 0
    v_mov_b32 v71, 0
    v_mov_b32 v72, 0
    v_mov_b32 v73, 0
    v_mov_b32 v74, 0
    v_mov_b32 v75, 0
    v_mov_b32 v76, 0
    v_mov_b32 v77, 0
    v_mov_b32 v78, 0
    v_mov_b32 v79, 0
    v_mov_b32 v80, 0
    v_mov_b32 v81, 0
    v_mov_b32 v82, 0
    v_mov_b32 v83, 0
    v_mov_b32 v84, 0
    v_mov_b32 v85, 0
    v_mov_b32 v86, 0
    v_mov_b32 v87, 0
    s_lshl_b32 s20, s12, 7
    s_add_u32 s20, s20, 16384
    s_mov_b64 exec, 1
    v_mov_b32 v253, s20
    v_mov_b32 v254, s14
    buffer_store_dword v254, v253, s[8:11], s48 offen sc1
    s_mov_b64 exec, -1
    ds_read_b128 v[124:127], v13 offset:0
    ds_read_b128 v[128:131], v13 offset:1024
    ds_read_b128 v[132:135], v13 offset:2048
    ds_read_b128 v[136:139], v13 offset:3072
    ds_read_b128 v[140:143], v13 offset:4096
    ds_read_b128 v[144:147], v13 offset:5120
    ds_read_b128 v[148:151], v13 offset:6144
    ds_read_b128 v[152:155], v13 offset:7168
    s_waitcnt lgkmcnt(0)
    s_add_u32 s14, s14, 1
    s_cmp_lt_u32 s14, 64
    s_cbranch_scc1 layerb1_kernel_p3_step
    s_waitcnt vmcnt(0)
    s_barrier
    s_lshl_b32 s20, s12, 7
    s_add_u32 s20, s20, 16384
    s_mov_b64 exec, 1
    v_mov_b32 v253, s20
    v_mov_b32 v254, s14
    buffer_store_dword v254, v253, s[8:11], s48 offen sc1
    s_mov_b64 exec, -1
    s_branch layerb1_kernel_end
layerb1_kernel_y0_start:
    v_lshrrev_b32 v16, 4, v0
    v_and_b32 v17, 7, v0
    v_lshrrev_b32 v18, 3, v0
    v_and_b32 v18, 1, v18
    v_lshl_add_u32 v19, v18, 2, v16
    v_add_u32 v19, 0, v19
    v_mul_u32_u24 v20, 640, v19
    v_lshl_add_u32 v4, v17, 4, v20
    v_and_b32 v20, 1, v17
    v_lshlrev_b32 v20, 2, v20
    v_lshrrev_b32 v21, 1, v17
    v_add_u32 v20, v20, v21
    v_lshlrev_b32 v20, 4, v20
    v_lshl_add_u32 v5, v19, 7, v20
    v_add_u32 v3, 0, v1
    v_lshrrev_b32 v20, 1, v17
    v_lshlrev_b32 v20, 7, v20
    v_and_b32 v21, 1, v17
    v_lshl_add_u32 v20, v21, 2, v20
    v_add_u32 v10, 0, v20
    v_lshlrev_b32 v20, 8, v18
    v_lshl_add_u32 v20, v17, 5, v20
    v_and_b32 v21, 1, v16
    v_lshl_add_u32 v20, v21, 4, v20
    v_add_u32 v20, 10240, v20
    v_add_u32 v21, 12288, v1
    v_lshrrev_b32 v22, 1, v16
    v_cmp_eq_u32 vcc, v22, v18
    s_nop 1
    v_cndmask_b32 v6, v21, v20, vcc
    v_lshrrev_b32 v20, 3, v0
    v_lshlrev_b32 v20, 2, v20
    v_lshl_add_u32 v20, v17, 5, v20
    v_add_u32 v7, 10240, v20
    s_lshl_b32 s20, s12, 7
    s_add_u32 s20, s20, 20480
    s_lshr_b32 s21, s20, 13
    s_lshl_b32 s21, s21, 14
    s_and_b32 s20, s20, 8191
    s_add_u32 s20, s20, s21
    v_lshrrev_b32 v20, 3, v0
    v_lshlrev_b32 v20, 4, v20
    v_add_u32 v8, s20, v20
    s_mul_i32 s46, s12, 20480
    s_add_u32 s46, s46, 103809024
    s_mul_i32 s20, s12, 327680
    s_add_u32 s20, s20, 27262976
    s_add_u32 s21, s20, 65536
    buffer_load_dwordx4 v[176:179], v1, s[8:11], s21 offen offset:0
    buffer_load_dwordx4 v[180:183], v1, s[8:11], s21 offen offset:1024
    s_add_u32 s21, s20, 67584
    buffer_load_dwordx4 v[184:187], v1, s[8:11], s21 offen offset:0
    buffer_load_dwordx4 v[188:191], v1, s[8:11], s21 offen offset:1024
    s_add_u32 s21, s20, 69632
    buffer_load_dwordx4 v[192:195], v1, s[8:11], s21 offen offset:0
    buffer_load_dwordx4 v[196:199], v1, s[8:11], s21 offen offset:1024
    s_add_u32 s21, s20, 71680
    buffer_load_dwordx4 v[200:203], v1, s[8:11], s21 offen offset:0
    buffer_load_dwordx4 v[204:207], v1, s[8:11], s21 offen offset:1024
    s_add_u32 s21, s20, 73728
    buffer_load_dwordx4 v[208:211], v1, s[8:11], s21 offen offset:0
    buffer_load_dwordx4 v[212:215], v1, s[8:11], s21 offen offset:1024
    s_add_u32 s21, s20, 75776
    buffer_load_dwordx4 v[216:219], v1, s[8:11], s21 offen offset:0
    buffer_load_dwordx4 v[220:223], v1, s[8:11], s21 offen offset:1024
    s_add_u32 s21, s20, 77824
    buffer_load_dwordx4 v[224:227], v1, s[8:11], s21 offen offset:0
    buffer_load_dwordx4 v[228:231], v1, s[8:11], s21 offen offset:1024
    s_add_u32 s21, s20, 79872
    buffer_load_dwordx4 v[232:235], v1, s[8:11], s21 offen offset:0
    buffer_load_dwordx4 v[236:239], v1, s[8:11], s21 offen offset:1024
    s_mov_b32 s14, 0
    s_lshl_b32 s20, s12, 7
    v_mov_b32 v9, s20
    s_mov_b32 s47, 0
layerb1_kernel_y0_step:
    s_cmp_lt_u32 s14, 32
    s_cselect_b32 s18, s16, s17
    s_and_b32 s20, s14, 31
    s_lshl_b32 s20, s20, 16
    s_add_u32 s18, s18, s20
    s_mul_i32 s28, s14, 1638400
    s_add_u32 s28, s28, s46
    v_mov_b32 v56, 0
    v_mov_b32 v57, 0
    v_mov_b32 v58, 0
    v_mov_b32 v59, 0
    v_mov_b32 v60, 0
    v_mov_b32 v61, 0
    v_mov_b32 v62, 0
    v_mov_b32 v63, 0
    v_mov_b32 v64, 0
    v_mov_b32 v65, 0
    v_mov_b32 v66, 0
    v_mov_b32 v67, 0
    v_mov_b32 v68, 0
    v_mov_b32 v69, 0
    v_mov_b32 v70, 0
    v_mov_b32 v71, 0
    s_add_u32 s22, s18, 36864
    s_add_u32 s23, s18, 37888
    s_add_u32 s24, s18, 38912
layerb1_kernel_y0_poll:
    buffer_load_dwordx4 v[16:19], v1, s[8:11], s22 offen sc1
    buffer_load_dwordx4 v[20:23], v1, s[8:11], s23 offen sc1
    buffer_load_dwordx4 v[24:27], v1, s[8:11], s24 offen sc1
    s_waitcnt vmcnt(0)
    ds_write_b128 v3, v[16:19] offset:0
    ds_write_b128 v3, v[20:23] offset:1024
    ds_write_b128 v3, v[24:27] offset:2048
    v_max3_u32 v116, v16, v17, v18
    v_max3_u32 v116, v116, v19, v20
    v_max3_u32 v116, v116, v21, v22
    v_max3_u32 v116, v116, v23, v24
    v_max3_u32 v116, v116, v25, v26
    v_max_u32 v116, v116, v27
    v_cmp_eq_u32 vcc, -1, v116
    s_sub_u32 s15, s15, 1
    s_cbranch_scc1 layerb1_kernel_bail
    s_cbranch_vccnz layerb1_kernel_y0_poll
    s_waitcnt lgkmcnt(0)
    s_barrier
    ds_read_b128 v[28:31], v3 offset:3072
    ds_read_b128 v[32:35], v3 offset:4096
    ds_read_b128 v[36:39], v3 offset:5120
    ds_read_b128 v[40:43], v3 offset:6144
    ds_read_b128 v[44:47], v3 offset:7168
    ds_read_b128 v[48:51], v3 offset:8192
    ds_read_b128 v[52:55], v3 offset:9216
    s_cmp_gt_u32 s47, s14
    s_cbranch_scc1 layerb1_kernel_y0_gw_ok
layerb1_kernel_y0_gw_lp:
    buffer_load_dword v116, v9, s[8:11], s48 offen sc1
    s_waitcnt vmcnt(0)
    v_readlane_b32 s47, v116, 0
    s_nop 0
    s_sub_u32 s15, s15, 1
    s_cbranch_scc1 layerb1_kernel_bail
    s_cmp_gt_u32 s47, s14
    s_cbranch_scc0 layerb1_kernel_y0_gw_lp
layerb1_kernel_y0_gw_ok:
    buffer_load_dwordx4 v[76:79], v4, s[8:11], s28 offen offset:128 sc1
    buffer_load_dwordx4 v[80:83], v4, s[8:11], s28 offen offset:256 sc1
    buffer_load_dwordx4 v[84:87], v4, s[8:11], s28 offen offset:384 sc1
    buffer_load_dwordx4 v[88:91], v4, s[8:11], s28 offen offset:512 sc1
    v_smfmac_f32_16x16x64_bf16 v[56:59], v[16:19], a[0:7], v2
    v_smfmac_f32_16x16x64_bf16 v[60:63], v[16:19], a[80:87], v2
    v_smfmac_f32_16x16x64_bf16 v[64:67], v[16:19], a[160:167], v2
    v_smfmac_f32_16x16x64_bf16 v[68:71], v[16:19], a[240:247], v2
    v_smfmac_f32_16x16x64_bf16 v[56:59], v[20:23], a[8:15], v2
    v_smfmac_f32_16x16x64_bf16 v[60:63], v[20:23], a[88:95], v2
    v_smfmac_f32_16x16x64_bf16 v[64:67], v[20:23], a[168:175], v2
    v_smfmac_f32_16x16x64_bf16 v[68:71], v[20:23], a[248:255], v2
    v_smfmac_f32_16x16x64_bf16 v[56:59], v[24:27], a[16:23], v2
    v_smfmac_f32_16x16x64_bf16 v[60:63], v[24:27], a[96:103], v2
    v_smfmac_f32_16x16x64_bf16 v[64:67], v[24:27], a[176:183], v2
    v_smfmac_f32_16x16x64_bf16 v[68:71], v[24:27], v[176:183], v2
    s_waitcnt lgkmcnt(6)
    v_smfmac_f32_16x16x64_bf16 v[56:59], v[28:31], a[24:31], v2
    v_smfmac_f32_16x16x64_bf16 v[60:63], v[28:31], a[104:111], v2
    v_smfmac_f32_16x16x64_bf16 v[64:67], v[28:31], a[184:191], v2
    v_smfmac_f32_16x16x64_bf16 v[68:71], v[28:31], v[184:191], v2
    s_waitcnt lgkmcnt(5)
    v_smfmac_f32_16x16x64_bf16 v[56:59], v[32:35], a[32:39], v2
    v_smfmac_f32_16x16x64_bf16 v[60:63], v[32:35], a[112:119], v2
    v_smfmac_f32_16x16x64_bf16 v[64:67], v[32:35], a[192:199], v2
    v_smfmac_f32_16x16x64_bf16 v[68:71], v[32:35], v[192:199], v2
    s_waitcnt lgkmcnt(4)
    v_smfmac_f32_16x16x64_bf16 v[56:59], v[36:39], a[40:47], v2
    v_smfmac_f32_16x16x64_bf16 v[60:63], v[36:39], a[120:127], v2
    v_smfmac_f32_16x16x64_bf16 v[64:67], v[36:39], a[200:207], v2
    v_smfmac_f32_16x16x64_bf16 v[68:71], v[36:39], v[200:207], v2
    s_waitcnt lgkmcnt(3)
    v_smfmac_f32_16x16x64_bf16 v[56:59], v[40:43], a[48:55], v2
    v_smfmac_f32_16x16x64_bf16 v[60:63], v[40:43], a[128:135], v2
    v_smfmac_f32_16x16x64_bf16 v[64:67], v[40:43], a[208:215], v2
    v_smfmac_f32_16x16x64_bf16 v[68:71], v[40:43], v[208:215], v2
    s_waitcnt lgkmcnt(2)
    v_smfmac_f32_16x16x64_bf16 v[56:59], v[44:47], a[56:63], v2
    v_smfmac_f32_16x16x64_bf16 v[60:63], v[44:47], a[136:143], v2
    v_smfmac_f32_16x16x64_bf16 v[64:67], v[44:47], a[216:223], v2
    v_smfmac_f32_16x16x64_bf16 v[68:71], v[44:47], v[216:223], v2
    s_waitcnt lgkmcnt(1)
    v_smfmac_f32_16x16x64_bf16 v[56:59], v[48:51], a[64:71], v2
    v_smfmac_f32_16x16x64_bf16 v[60:63], v[48:51], a[144:151], v2
    v_smfmac_f32_16x16x64_bf16 v[64:67], v[48:51], a[224:231], v2
    v_smfmac_f32_16x16x64_bf16 v[68:71], v[48:51], v[224:231], v2
    s_waitcnt lgkmcnt(0)
    v_smfmac_f32_16x16x64_bf16 v[56:59], v[52:55], a[72:79], v2
    v_smfmac_f32_16x16x64_bf16 v[60:63], v[52:55], a[152:159], v2
    v_smfmac_f32_16x16x64_bf16 v[64:67], v[52:55], a[232:239], v2
    v_smfmac_f32_16x16x64_bf16 v[68:71], v[52:55], v[232:239], v2
    s_nop 7
    v_permlane32_swap_b32 v56, v64
    v_permlane32_swap_b32 v60, v68
    v_permlane32_swap_b32 v57, v65
    v_permlane32_swap_b32 v61, v69
    v_permlane32_swap_b32 v58, v66
    v_permlane32_swap_b32 v62, v70
    v_permlane32_swap_b32 v59, v67
    v_permlane32_swap_b32 v63, v71
    v_add_f32 v56, v56, v64
    v_add_f32 v60, v60, v68
    v_add_f32 v57, v57, v65
    v_add_f32 v61, v61, v69
    v_add_f32 v58, v58, v66
    v_add_f32 v62, v62, v70
    v_add_f32 v59, v59, v67
    v_add_f32 v63, v63, v71
    s_nop 1
    v_permlane16_swap_b32 v56, v60
    v_permlane16_swap_b32 v57, v61
    v_permlane16_swap_b32 v58, v62
    v_permlane16_swap_b32 v59, v63
    s_nop 1
    v_cvt_pk_bf16_f32 v72, v56, v57
    v_cvt_pk_bf16_f32 v73, v58, v59
    v_cvt_pk_bf16_f32 v74, v60, v61
    v_cvt_pk_bf16_f32 v75, v62, v63
    buffer_store_dwordx4 v[72:75], v4, s[8:11], s28 offen sc1
    s_cmp_eq_u32 s14, 63
    s_cbranch_scc1 layerb1_kernel_y0_last
    s_add_u32 s30, s18, 0
    s_add_u32 s31, s18, 4096
    s_add_u32 s32, s18, 16384
    s_add_u32 s33, s18, 20480
    s_add_u32 s34, s18, 32768
    s_add_u32 s29, s14, 1
    s_cmp_lt_u32 s29, 32
    s_cselect_b32 s19, s16, s17
    s_and_b32 s20, s29, 31
    s_lshl_b32 s20, s20, 16
    s_add_u32 s19, s19, s20
layerb1_kernel_y0_ppoll:
    buffer_load_dwordx4 v[92:95], v5, s[8:11], s30 offen sc1
    buffer_load_dwordx4 v[96:99], v5, s[8:11], s31 offen sc1
    buffer_load_dwordx4 v[100:103], v5, s[8:11], s32 offen sc1
    buffer_load_dwordx4 v[104:107], v5, s[8:11], s33 offen sc1
    buffer_load_dwordx4 v[108:111], v5, s[8:11], s34 offen sc1
    s_waitcnt vmcnt(0)
    v_mfma_f32_16x16x32_bf16 v[112:115], v[92:95], v[72:75], 0
    v_mfma_f32_16x16x32_bf16 v[112:115], v[96:99], v[76:79], v[112:115]
    v_mfma_f32_16x16x32_bf16 v[112:115], v[100:103], v[80:83], v[112:115]
    v_mfma_f32_16x16x32_bf16 v[112:115], v[104:107], v[84:87], v[112:115]
    v_mfma_f32_16x16x32_bf16 v[112:115], v[108:111], v[88:91], v[112:115]
    v_max3_u32 v116, v92, v93, v94
    v_max3_u32 v116, v116, v95, v96
    v_max3_u32 v116, v116, v97, v98
    v_max3_u32 v116, v116, v99, v100
    v_max3_u32 v116, v116, v101, v102
    v_max3_u32 v116, v116, v103, v104
    v_max3_u32 v116, v116, v105, v106
    v_max3_u32 v116, v116, v107, v108
    v_max3_u32 v116, v116, v109, v110
    v_max_u32 v116, v116, v111
    v_cmp_eq_u32 vcc, -1, v116
    s_sub_u32 s15, s15, 1
    s_cbranch_scc1 layerb1_kernel_bail
    s_cbranch_vccnz layerb1_kernel_y0_ppoll
    ds_write_b128 v6, v[112:115]
    s_waitcnt lgkmcnt(0)
    s_barrier
    ds_read2st64_b32 v[116:117], v7 offset0:0 offset1:1
    ds_read2st64_b32 v[118:119], v7 offset0:2 offset1:3
    ds_read2st64_b32 v[120:121], v7 offset0:4 offset1:5
    ds_read2st64_b32 v[122:123], v7 offset0:6 offset1:7
    s_waitcnt lgkmcnt(2)
    v_add_f32 v116, v116, v117
    v_add_f32 v118, v118, v119
    s_waitcnt lgkmcnt(0)
    v_add_f32 v120, v120, v121
    v_add_f32 v122, v122, v123
    v_add_f32 v116, v116, v118
    v_add_f32 v120, v120, v122
    v_add_f32 v116, v116, v120
    s_nop 1
    v_mov_b32_dpp v117, v116 quad_perm:[1,0,3,2] row_mask:0xf bank_mask:0xf
    v_cvt_pk_bf16_f32 v124, v116, v117
    s_nop 1
    v_mov_b32_dpp v125, v124 row_shl:2 row_mask:0xf bank_mask:0xf
    v_mov_b32_dpp v126, v124 row_shl:4 row_mask:0xf bank_mask:0xf
    v_mov_b32_dpp v127, v124 row_shl:6 row_mask:0xf bank_mask:0xf
    s_mov_b64 exec, s[40:41]
    buffer_store_dwordx4 v[124:127], v8, s[8:11], s19 offen sc1
    s_mov_b64 exec, -1
    s_lshl_b32 s20, s12, 7
    s_add_u32 s20, s20, 20480
    s_mov_b64 exec, 1
    v_mov_b32 v116, s20
    v_mov_b32 v117, s29
    buffer_store_dword v117, v116, s[8:11], s48 offen sc1
    s_mov_b64 exec, -1
    s_waitcnt vmcnt(0)
    s_barrier
    s_add_u32 s14, s14, 1
    s_branch layerb1_kernel_y0_step
layerb1_kernel_y0_last:
    s_waitcnt vmcnt(0)
    s_barrier
    s_lshl_b32 s20, s12, 7
    s_add_u32 s20, s20, 20480
    s_mov_b32 s29, 64
    s_mov_b64 exec, 1
    v_mov_b32 v116, s20
    v_mov_b32 v117, s29
    buffer_store_dword v117, v116, s[8:11], s48 offen sc1
    s_mov_b64 exec, -1
    s_branch layerb1_kernel_end
layerb1_kernel_y1_start:
    v_lshrrev_b32 v16, 4, v0
    v_and_b32 v17, 7, v0
    v_lshrrev_b32 v18, 3, v0
    v_and_b32 v18, 1, v18
    v_lshl_add_u32 v19, v18, 2, v16
    v_add_u32 v19, 8, v19
    v_mul_u32_u24 v20, 640, v19
    v_lshl_add_u32 v4, v17, 4, v20
    v_and_b32 v20, 1, v17
    v_lshlrev_b32 v20, 2, v20
    v_lshrrev_b32 v21, 1, v17
    v_add_u32 v20, v20, v21
    v_lshlrev_b32 v20, 4, v20
    v_lshl_add_u32 v5, v19, 7, v20
    v_add_u32 v3, 0, v1
    v_lshrrev_b32 v20, 1, v17
    v_lshlrev_b32 v20, 7, v20
    v_and_b32 v21, 1, v17
    v_lshl_add_u32 v20, v21, 2, v20
    v_add_u32 v10, 512, v20
    v_lshlrev_b32 v20, 8, v18
    v_lshl_add_u32 v20, v17, 5, v20
    v_and_b32 v21, 1, v16
    v_lshl_add_u32 v20, v21, 4, v20
    v_add_u32 v20, 10752, v20
    v_add_u32 v21, 12288, v1
    v_lshrrev_b32 v22, 1, v16
    v_cmp_eq_u32 vcc, v22, v18
    s_nop 1
    v_cndmask_b32 v6, v21, v20, vcc
    v_lshrrev_b32 v20, 3, v0
    v_lshlrev_b32 v20, 2, v20
    v_lshl_add_u32 v20, v17, 5, v20
    v_add_u32 v7, 10240, v20
    s_lshl_b32 s20, s12, 7
    s_add_u32 s20, s20, 20480
    s_lshr_b32 s21, s20, 13
    s_lshl_b32 s21, s21, 14
    s_and_b32 s20, s20, 8191
    s_add_u32 s20, s20, s21
    v_lshrrev_b32 v20, 3, v0
    v_lshlrev_b32 v20, 4, v20
    v_add_u32 v8, s20, v20
    s_mul_i32 s46, s12, 20480
    s_add_u32 s46, s46, 103809024
    s_mul_i32 s20, s12, 327680
    s_add_u32 s20, s20, 27344896
    s_add_u32 s21, s20, 65536
    buffer_load_dwordx4 v[176:179], v1, s[8:11], s21 offen offset:0
    buffer_load_dwordx4 v[180:183], v1, s[8:11], s21 offen offset:1024
    s_add_u32 s21, s20, 67584
    buffer_load_dwordx4 v[184:187], v1, s[8:11], s21 offen offset:0
    buffer_load_dwordx4 v[188:191], v1, s[8:11], s21 offen offset:1024
    s_add_u32 s21, s20, 69632
    buffer_load_dwordx4 v[192:195], v1, s[8:11], s21 offen offset:0
    buffer_load_dwordx4 v[196:199], v1, s[8:11], s21 offen offset:1024
    s_add_u32 s21, s20, 71680
    buffer_load_dwordx4 v[200:203], v1, s[8:11], s21 offen offset:0
    buffer_load_dwordx4 v[204:207], v1, s[8:11], s21 offen offset:1024
    s_add_u32 s21, s20, 73728
    buffer_load_dwordx4 v[208:211], v1, s[8:11], s21 offen offset:0
    buffer_load_dwordx4 v[212:215], v1, s[8:11], s21 offen offset:1024
    s_add_u32 s21, s20, 75776
    buffer_load_dwordx4 v[216:219], v1, s[8:11], s21 offen offset:0
    buffer_load_dwordx4 v[220:223], v1, s[8:11], s21 offen offset:1024
    s_add_u32 s21, s20, 77824
    buffer_load_dwordx4 v[224:227], v1, s[8:11], s21 offen offset:0
    buffer_load_dwordx4 v[228:231], v1, s[8:11], s21 offen offset:1024
    s_add_u32 s21, s20, 79872
    buffer_load_dwordx4 v[232:235], v1, s[8:11], s21 offen offset:0
    buffer_load_dwordx4 v[236:239], v1, s[8:11], s21 offen offset:1024
    s_mov_b32 s14, 0
    s_lshl_b32 s20, s12, 7
    v_mov_b32 v9, s20
    s_mov_b32 s47, 0
layerb1_kernel_y1_step:
    s_cmp_lt_u32 s14, 32
    s_cselect_b32 s18, s16, s17
    s_and_b32 s20, s14, 31
    s_lshl_b32 s20, s20, 16
    s_add_u32 s18, s18, s20
    s_mul_i32 s28, s14, 1638400
    s_add_u32 s28, s28, s46
    v_mov_b32 v56, 0
    v_mov_b32 v57, 0
    v_mov_b32 v58, 0
    v_mov_b32 v59, 0
    v_mov_b32 v60, 0
    v_mov_b32 v61, 0
    v_mov_b32 v62, 0
    v_mov_b32 v63, 0
    v_mov_b32 v64, 0
    v_mov_b32 v65, 0
    v_mov_b32 v66, 0
    v_mov_b32 v67, 0
    v_mov_b32 v68, 0
    v_mov_b32 v69, 0
    v_mov_b32 v70, 0
    v_mov_b32 v71, 0
    s_add_u32 s22, s18, 39936
    s_add_u32 s23, s18, 49152
    s_add_u32 s24, s18, 50176
layerb1_kernel_y1_poll:
    buffer_load_dwordx4 v[28:31], v1, s[8:11], s22 offen sc1
    buffer_load_dwordx4 v[32:35], v1, s[8:11], s23 offen sc1
    buffer_load_dwordx4 v[36:39], v1, s[8:11], s24 offen sc1
    s_waitcnt vmcnt(0)
    ds_write_b128 v3, v[28:31] offset:3072
    ds_write_b128 v3, v[32:35] offset:4096
    ds_write_b128 v3, v[36:39] offset:5120
    v_max3_u32 v116, v28, v29, v30
    v_max3_u32 v116, v116, v31, v32
    v_max3_u32 v116, v116, v33, v34
    v_max3_u32 v116, v116, v35, v36
    v_max3_u32 v116, v116, v37, v38
    v_max_u32 v116, v116, v39
    v_cmp_eq_u32 vcc, -1, v116
    s_sub_u32 s15, s15, 1
    s_cbranch_scc1 layerb1_kernel_bail
    s_cbranch_vccnz layerb1_kernel_y1_poll
    s_waitcnt lgkmcnt(0)
    s_barrier
    ds_read_b128 v[16:19], v3 offset:0
    ds_read_b128 v[20:23], v3 offset:1024
    ds_read_b128 v[24:27], v3 offset:2048
    ds_read_b128 v[40:43], v3 offset:6144
    ds_read_b128 v[44:47], v3 offset:7168
    ds_read_b128 v[48:51], v3 offset:8192
    ds_read_b128 v[52:55], v3 offset:9216
    s_cmp_gt_u32 s47, s14
    s_cbranch_scc1 layerb1_kernel_y1_gw_ok
layerb1_kernel_y1_gw_lp:
    buffer_load_dword v116, v9, s[8:11], s48 offen sc1
    s_waitcnt vmcnt(0)
    v_readlane_b32 s47, v116, 0
    s_nop 0
    s_sub_u32 s15, s15, 1
    s_cbranch_scc1 layerb1_kernel_bail
    s_cmp_gt_u32 s47, s14
    s_cbranch_scc0 layerb1_kernel_y1_gw_lp
layerb1_kernel_y1_gw_ok:
    buffer_load_dwordx4 v[76:79], v4, s[8:11], s28 offen offset:128 sc1
    buffer_load_dwordx4 v[80:83], v4, s[8:11], s28 offen offset:256 sc1
    buffer_load_dwordx4 v[84:87], v4, s[8:11], s28 offen offset:384 sc1
    buffer_load_dwordx4 v[88:91], v4, s[8:11], s28 offen offset:512 sc1
    v_smfmac_f32_16x16x64_bf16 v[56:59], v[28:31], a[24:31], v2
    v_smfmac_f32_16x16x64_bf16 v[60:63], v[28:31], a[104:111], v2
    v_smfmac_f32_16x16x64_bf16 v[64:67], v[28:31], a[184:191], v2
    v_smfmac_f32_16x16x64_bf16 v[68:71], v[28:31], v[184:191], v2
    v_smfmac_f32_16x16x64_bf16 v[56:59], v[32:35], a[32:39], v2
    v_smfmac_f32_16x16x64_bf16 v[60:63], v[32:35], a[112:119], v2
    v_smfmac_f32_16x16x64_bf16 v[64:67], v[32:35], a[192:199], v2
    v_smfmac_f32_16x16x64_bf16 v[68:71], v[32:35], v[192:199], v2
    v_smfmac_f32_16x16x64_bf16 v[56:59], v[36:39], a[40:47], v2
    v_smfmac_f32_16x16x64_bf16 v[60:63], v[36:39], a[120:127], v2
    v_smfmac_f32_16x16x64_bf16 v[64:67], v[36:39], a[200:207], v2
    v_smfmac_f32_16x16x64_bf16 v[68:71], v[36:39], v[200:207], v2
    s_waitcnt lgkmcnt(6)
    v_smfmac_f32_16x16x64_bf16 v[56:59], v[16:19], a[0:7], v2
    v_smfmac_f32_16x16x64_bf16 v[60:63], v[16:19], a[80:87], v2
    v_smfmac_f32_16x16x64_bf16 v[64:67], v[16:19], a[160:167], v2
    v_smfmac_f32_16x16x64_bf16 v[68:71], v[16:19], a[240:247], v2
    s_waitcnt lgkmcnt(5)
    v_smfmac_f32_16x16x64_bf16 v[56:59], v[20:23], a[8:15], v2
    v_smfmac_f32_16x16x64_bf16 v[60:63], v[20:23], a[88:95], v2
    v_smfmac_f32_16x16x64_bf16 v[64:67], v[20:23], a[168:175], v2
    v_smfmac_f32_16x16x64_bf16 v[68:71], v[20:23], a[248:255], v2
    s_waitcnt lgkmcnt(4)
    v_smfmac_f32_16x16x64_bf16 v[56:59], v[24:27], a[16:23], v2
    v_smfmac_f32_16x16x64_bf16 v[60:63], v[24:27], a[96:103], v2
    v_smfmac_f32_16x16x64_bf16 v[64:67], v[24:27], a[176:183], v2
    v_smfmac_f32_16x16x64_bf16 v[68:71], v[24:27], v[176:183], v2
    s_waitcnt lgkmcnt(3)
    v_smfmac_f32_16x16x64_bf16 v[56:59], v[40:43], a[48:55], v2
    v_smfmac_f32_16x16x64_bf16 v[60:63], v[40:43], a[128:135], v2
    v_smfmac_f32_16x16x64_bf16 v[64:67], v[40:43], a[208:215], v2
    v_smfmac_f32_16x16x64_bf16 v[68:71], v[40:43], v[208:215], v2
    s_waitcnt lgkmcnt(2)
    v_smfmac_f32_16x16x64_bf16 v[56:59], v[44:47], a[56:63], v2
    v_smfmac_f32_16x16x64_bf16 v[60:63], v[44:47], a[136:143], v2
    v_smfmac_f32_16x16x64_bf16 v[64:67], v[44:47], a[216:223], v2
    v_smfmac_f32_16x16x64_bf16 v[68:71], v[44:47], v[216:223], v2
    s_waitcnt lgkmcnt(1)
    v_smfmac_f32_16x16x64_bf16 v[56:59], v[48:51], a[64:71], v2
    v_smfmac_f32_16x16x64_bf16 v[60:63], v[48:51], a[144:151], v2
    v_smfmac_f32_16x16x64_bf16 v[64:67], v[48:51], a[224:231], v2
    v_smfmac_f32_16x16x64_bf16 v[68:71], v[48:51], v[224:231], v2
    s_waitcnt lgkmcnt(0)
    v_smfmac_f32_16x16x64_bf16 v[56:59], v[52:55], a[72:79], v2
    v_smfmac_f32_16x16x64_bf16 v[60:63], v[52:55], a[152:159], v2
    v_smfmac_f32_16x16x64_bf16 v[64:67], v[52:55], a[232:239], v2
    v_smfmac_f32_16x16x64_bf16 v[68:71], v[52:55], v[232:239], v2
    s_nop 7
    v_permlane32_swap_b32 v56, v64
    v_permlane32_swap_b32 v60, v68
    v_permlane32_swap_b32 v57, v65
    v_permlane32_swap_b32 v61, v69
    v_permlane32_swap_b32 v58, v66
    v_permlane32_swap_b32 v62, v70
    v_permlane32_swap_b32 v59, v67
    v_permlane32_swap_b32 v63, v71
    v_add_f32 v56, v56, v64
    v_add_f32 v60, v60, v68
    v_add_f32 v57, v57, v65
    v_add_f32 v61, v61, v69
    v_add_f32 v58, v58, v66
    v_add_f32 v62, v62, v70
    v_add_f32 v59, v59, v67
    v_add_f32 v63, v63, v71
    s_nop 1
    v_permlane16_swap_b32 v56, v60
    v_permlane16_swap_b32 v57, v61
    v_permlane16_swap_b32 v58, v62
    v_permlane16_swap_b32 v59, v63
    s_nop 1
    v_cvt_pk_bf16_f32 v72, v56, v57
    v_cvt_pk_bf16_f32 v73, v58, v59
    v_cvt_pk_bf16_f32 v74, v60, v61
    v_cvt_pk_bf16_f32 v75, v62, v63
    buffer_store_dwordx4 v[72:75], v4, s[8:11], s28 offen sc1
    s_cmp_eq_u32 s14, 63
    s_cbranch_scc1 layerb1_kernel_y1_last
    s_add_u32 s30, s18, 0
    s_add_u32 s31, s18, 4096
    s_add_u32 s32, s18, 16384
    s_add_u32 s33, s18, 20480
    s_add_u32 s34, s18, 32768
    s_add_u32 s29, s14, 1
    s_cmp_lt_u32 s29, 32
    s_cselect_b32 s19, s16, s17
    s_and_b32 s20, s29, 31
    s_lshl_b32 s20, s20, 16
    s_add_u32 s19, s19, s20
layerb1_kernel_y1_ppoll:
    buffer_load_dwordx4 v[92:95], v5, s[8:11], s30 offen sc1
    buffer_load_dwordx4 v[96:99], v5, s[8:11], s31 offen sc1
    buffer_load_dwordx4 v[100:103], v5, s[8:11], s32 offen sc1
    buffer_load_dwordx4 v[104:107], v5, s[8:11], s33 offen sc1
    buffer_load_dwordx4 v[108:111], v5, s[8:11], s34 offen sc1
    s_waitcnt vmcnt(0)
    v_mfma_f32_16x16x32_bf16 v[112:115], v[92:95], v[72:75], 0
    v_mfma_f32_16x16x32_bf16 v[112:115], v[96:99], v[76:79], v[112:115]
    v_mfma_f32_16x16x32_bf16 v[112:115], v[100:103], v[80:83], v[112:115]
    v_mfma_f32_16x16x32_bf16 v[112:115], v[104:107], v[84:87], v[112:115]
    v_mfma_f32_16x16x32_bf16 v[112:115], v[108:111], v[88:91], v[112:115]
    v_max3_u32 v116, v92, v93, v94
    v_max3_u32 v116, v116, v95, v96
    v_max3_u32 v116, v116, v97, v98
    v_max3_u32 v116, v116, v99, v100
    v_max3_u32 v116, v116, v101, v102
    v_max3_u32 v116, v116, v103, v104
    v_max3_u32 v116, v116, v105, v106
    v_max3_u32 v116, v116, v107, v108
    v_max3_u32 v116, v116, v109, v110
    v_max_u32 v116, v116, v111
    v_cmp_eq_u32 vcc, -1, v116
    s_sub_u32 s15, s15, 1
    s_cbranch_scc1 layerb1_kernel_bail
    s_cbranch_vccnz layerb1_kernel_y1_ppoll
    ds_write_b128 v6, v[112:115]
    s_waitcnt lgkmcnt(0)
    s_barrier
    s_barrier
    s_add_u32 s14, s14, 1
    s_branch layerb1_kernel_y1_step
layerb1_kernel_y1_last:
    s_waitcnt vmcnt(0)
    s_barrier
    s_branch layerb1_kernel_end
layerb1_kernel_y2_start:
    v_lshrrev_b32 v16, 4, v0
    v_and_b32 v17, 7, v0
    v_lshrrev_b32 v18, 3, v0
    v_and_b32 v18, 1, v18
    v_lshl_add_u32 v19, v18, 2, v16
    v_add_u32 v19, 16, v19
    v_mul_u32_u24 v20, 640, v19
    v_lshl_add_u32 v4, v17, 4, v20
    v_and_b32 v20, 1, v17
    v_lshlrev_b32 v20, 2, v20
    v_lshrrev_b32 v21, 1, v17
    v_add_u32 v20, v20, v21
    v_lshlrev_b32 v20, 4, v20
    v_lshl_add_u32 v5, v19, 7, v20
    v_add_u32 v3, 0, v1
    v_lshrrev_b32 v20, 1, v17
    v_lshlrev_b32 v20, 7, v20
    v_and_b32 v21, 1, v17
    v_lshl_add_u32 v20, v21, 2, v20
    v_add_u32 v10, 1024, v20
    v_lshlrev_b32 v20, 8, v18
    v_lshl_add_u32 v20, v17, 5, v20
    v_and_b32 v21, 1, v16
    v_lshl_add_u32 v20, v21, 4, v20
    v_add_u32 v20, 11264, v20
    v_add_u32 v21, 12288, v1
    v_lshrrev_b32 v22, 1, v16
    v_cmp_eq_u32 vcc, v22, v18
    s_nop 1
    v_cndmask_b32 v6, v21, v20, vcc
    v_lshrrev_b32 v20, 3, v0
    v_lshlrev_b32 v20, 2, v20
    v_lshl_add_u32 v20, v17, 5, v20
    v_add_u32 v7, 10240, v20
    s_lshl_b32 s20, s12, 7
    s_add_u32 s20, s20, 20480
    s_lshr_b32 s21, s20, 13
    s_lshl_b32 s21, s21, 14
    s_and_b32 s20, s20, 8191
    s_add_u32 s20, s20, s21
    v_lshrrev_b32 v20, 3, v0
    v_lshlrev_b32 v20, 4, v20
    v_add_u32 v8, s20, v20
    s_mul_i32 s46, s12, 20480
    s_add_u32 s46, s46, 103809024
    s_mul_i32 s20, s12, 327680
    s_add_u32 s20, s20, 27426816
    s_add_u32 s21, s20, 65536
    buffer_load_dwordx4 v[176:179], v1, s[8:11], s21 offen offset:0
    buffer_load_dwordx4 v[180:183], v1, s[8:11], s21 offen offset:1024
    s_add_u32 s21, s20, 67584
    buffer_load_dwordx4 v[184:187], v1, s[8:11], s21 offen offset:0
    buffer_load_dwordx4 v[188:191], v1, s[8:11], s21 offen offset:1024
    s_add_u32 s21, s20, 69632
    buffer_load_dwordx4 v[192:195], v1, s[8:11], s21 offen offset:0
    buffer_load_dwordx4 v[196:199], v1, s[8:11], s21 offen offset:1024
    s_add_u32 s21, s20, 71680
    buffer_load_dwordx4 v[200:203], v1, s[8:11], s21 offen offset:0
    buffer_load_dwordx4 v[204:207], v1, s[8:11], s21 offen offset:1024
    s_add_u32 s21, s20, 73728
    buffer_load_dwordx4 v[208:211], v1, s[8:11], s21 offen offset:0
    buffer_load_dwordx4 v[212:215], v1, s[8:11], s21 offen offset:1024
    s_add_u32 s21, s20, 75776
    buffer_load_dwordx4 v[216:219], v1, s[8:11], s21 offen offset:0
    buffer_load_dwordx4 v[220:223], v1, s[8:11], s21 offen offset:1024
    s_add_u32 s21, s20, 77824
    buffer_load_dwordx4 v[224:227], v1, s[8:11], s21 offen offset:0
    buffer_load_dwordx4 v[228:231], v1, s[8:11], s21 offen offset:1024
    s_add_u32 s21, s20, 79872
    buffer_load_dwordx4 v[232:235], v1, s[8:11], s21 offen offset:0
    buffer_load_dwordx4 v[236:239], v1, s[8:11], s21 offen offset:1024
    s_mov_b32 s14, 0
    s_lshl_b32 s20, s12, 7
    v_mov_b32 v9, s20
    s_mov_b32 s47, 0
layerb1_kernel_y2_step:
    s_cmp_lt_u32 s14, 32
    s_cselect_b32 s18, s16, s17
    s_and_b32 s20, s14, 31
    s_lshl_b32 s20, s20, 16
    s_add_u32 s18, s18, s20
    s_mul_i32 s28, s14, 1638400
    s_add_u32 s28, s28, s46
    v_mov_b32 v56, 0
    v_mov_b32 v57, 0
    v_mov_b32 v58, 0
    v_mov_b32 v59, 0
    v_mov_b32 v60, 0
    v_mov_b32 v61, 0
    v_mov_b32 v62, 0
    v_mov_b32 v63, 0
    v_mov_b32 v64, 0
    v_mov_b32 v65, 0
    v_mov_b32 v66, 0
    v_mov_b32 v67, 0
    v_mov_b32 v68, 0
    v_mov_b32 v69, 0
    v_mov_b32 v70, 0
    v_mov_b32 v71, 0
    s_add_u32 s22, s18, 51200
    s_add_u32 s23, s18, 52224
layerb1_kernel_y2_poll:
    buffer_load_dwordx4 v[40:43], v1, s[8:11], s22 offen sc1
    buffer_load_dwordx4 v[44:47], v1, s[8:11], s23 offen sc1
    s_waitcnt vmcnt(0)
    ds_write_b128 v3, v[40:43] offset:6144
    ds_write_b128 v3, v[44:47] offset:7168
    v_max3_u32 v116, v40, v41, v42
    v_max3_u32 v116, v116, v43, v44
    v_max3_u32 v116, v116, v45, v46
    v_max_u32 v116, v116, v47
    v_cmp_eq_u32 vcc, -1, v116
    s_sub_u32 s15, s15, 1
    s_cbranch_scc1 layerb1_kernel_bail
    s_cbranch_vccnz layerb1_kernel_y2_poll
    s_waitcnt lgkmcnt(0)
    s_barrier
    ds_read_b128 v[16:19], v3 offset:0
    ds_read_b128 v[20:23], v3 offset:1024
    ds_read_b128 v[24:27], v3 offset:2048
    ds_read_b128 v[28:31], v3 offset:3072
    ds_read_b128 v[32:35], v3 offset:4096
    ds_read_b128 v[36:39], v3 offset:5120
    ds_read_b128 v[48:51], v3 offset:8192
    ds_read_b128 v[52:55], v3 offset:9216
    s_cmp_gt_u32 s47, s14
    s_cbranch_scc1 layerb1_kernel_y2_gw_ok
layerb1_kernel_y2_gw_lp:
    buffer_load_dword v116, v9, s[8:11], s48 offen sc1
    s_waitcnt vmcnt(0)
    v_readlane_b32 s47, v116, 0
    s_nop 0
    s_sub_u32 s15, s15, 1
    s_cbranch_scc1 layerb1_kernel_bail
    s_cmp_gt_u32 s47, s14
    s_cbranch_scc0 layerb1_kernel_y2_gw_lp
layerb1_kernel_y2_gw_ok:
    buffer_load_dwordx4 v[76:79], v4, s[8:11], s28 offen offset:128 sc1
    buffer_load_dwordx4 v[80:83], v4, s[8:11], s28 offen offset:256 sc1
    buffer_load_dwordx4 v[84:87], v4, s[8:11], s28 offen offset:384 sc1
    buffer_load_dwordx4 v[88:91], v4, s[8:11], s28 offen offset:512 sc1
    v_smfmac_f32_16x16x64_bf16 v[56:59], v[40:43], a[48:55], v2
    v_smfmac_f32_16x16x64_bf16 v[60:63], v[40:43], a[128:135], v2
    v_smfmac_f32_16x16x64_bf16 v[64:67], v[40:43], a[208:215], v2
    v_smfmac_f32_16x16x64_bf16 v[68:71], v[40:43], v[208:215], v2
    v_smfmac_f32_16x16x64_bf16 v[56:59], v[44:47], a[56:63], v2
    v_smfmac_f32_16x16x64_bf16 v[60:63], v[44:47], a[136:143], v2
    v_smfmac_f32_16x16x64_bf16 v[64:67], v[44:47], a[216:223], v2
    v_smfmac_f32_16x16x64_bf16 v[68:71], v[44:47], v[216:223], v2
    s_waitcnt lgkmcnt(7)
    v_smfmac_f32_16x16x64_bf16 v[56:59], v[16:19], a[0:7], v2
    v_smfmac_f32_16x16x64_bf16 v[60:63], v[16:19], a[80:87], v2
    v_smfmac_f32_16x16x64_bf16 v[64:67], v[16:19], a[160:167], v2
    v_smfmac_f32_16x16x64_bf16 v[68:71], v[16:19], a[240:247], v2
    s_waitcnt lgkmcnt(6)
    v_smfmac_f32_16x16x64_bf16 v[56:59], v[20:23], a[8:15], v2
    v_smfmac_f32_16x16x64_bf16 v[60:63], v[20:23], a[88:95], v2
    v_smfmac_f32_16x16x64_bf16 v[64:67], v[20:23], a[168:175], v2
    v_smfmac_f32_16x16x64_bf16 v[68:71], v[20:23], a[248:255], v2
    s_waitcnt lgkmcnt(5)
    v_smfmac_f32_16x16x64_bf16 v[56:59], v[24:27], a[16:23], v2
    v_smfmac_f32_16x16x64_bf16 v[60:63], v[24:27], a[96:103], v2
    v_smfmac_f32_16x16x64_bf16 v[64:67], v[24:27], a[176:183], v2
    v_smfmac_f32_16x16x64_bf16 v[68:71], v[24:27], v[176:183], v2
    s_waitcnt lgkmcnt(4)
    v_smfmac_f32_16x16x64_bf16 v[56:59], v[28:31], a[24:31], v2
    v_smfmac_f32_16x16x64_bf16 v[60:63], v[28:31], a[104:111], v2
    v_smfmac_f32_16x16x64_bf16 v[64:67], v[28:31], a[184:191], v2
    v_smfmac_f32_16x16x64_bf16 v[68:71], v[28:31], v[184:191], v2
    s_waitcnt lgkmcnt(3)
    v_smfmac_f32_16x16x64_bf16 v[56:59], v[32:35], a[32:39], v2
    v_smfmac_f32_16x16x64_bf16 v[60:63], v[32:35], a[112:119], v2
    v_smfmac_f32_16x16x64_bf16 v[64:67], v[32:35], a[192:199], v2
    v_smfmac_f32_16x16x64_bf16 v[68:71], v[32:35], v[192:199], v2
    s_waitcnt lgkmcnt(2)
    v_smfmac_f32_16x16x64_bf16 v[56:59], v[36:39], a[40:47], v2
    v_smfmac_f32_16x16x64_bf16 v[60:63], v[36:39], a[120:127], v2
    v_smfmac_f32_16x16x64_bf16 v[64:67], v[36:39], a[200:207], v2
    v_smfmac_f32_16x16x64_bf16 v[68:71], v[36:39], v[200:207], v2
    s_waitcnt lgkmcnt(1)
    v_smfmac_f32_16x16x64_bf16 v[56:59], v[48:51], a[64:71], v2
    v_smfmac_f32_16x16x64_bf16 v[60:63], v[48:51], a[144:151], v2
    v_smfmac_f32_16x16x64_bf16 v[64:67], v[48:51], a[224:231], v2
    v_smfmac_f32_16x16x64_bf16 v[68:71], v[48:51], v[224:231], v2
    s_waitcnt lgkmcnt(0)
    v_smfmac_f32_16x16x64_bf16 v[56:59], v[52:55], a[72:79], v2
    v_smfmac_f32_16x16x64_bf16 v[60:63], v[52:55], a[152:159], v2
    v_smfmac_f32_16x16x64_bf16 v[64:67], v[52:55], a[232:239], v2
    v_smfmac_f32_16x16x64_bf16 v[68:71], v[52:55], v[232:239], v2
    s_nop 7
    v_permlane32_swap_b32 v56, v64
    v_permlane32_swap_b32 v60, v68
    v_permlane32_swap_b32 v57, v65
    v_permlane32_swap_b32 v61, v69
    v_permlane32_swap_b32 v58, v66
    v_permlane32_swap_b32 v62, v70
    v_permlane32_swap_b32 v59, v67
    v_permlane32_swap_b32 v63, v71
    v_add_f32 v56, v56, v64
    v_add_f32 v60, v60, v68
    v_add_f32 v57, v57, v65
    v_add_f32 v61, v61, v69
    v_add_f32 v58, v58, v66
    v_add_f32 v62, v62, v70
    v_add_f32 v59, v59, v67
    v_add_f32 v63, v63, v71
    s_nop 1
    v_permlane16_swap_b32 v56, v60
    v_permlane16_swap_b32 v57, v61
    v_permlane16_swap_b32 v58, v62
    v_permlane16_swap_b32 v59, v63
    s_nop 1
    v_cvt_pk_bf16_f32 v72, v56, v57
    v_cvt_pk_bf16_f32 v73, v58, v59
    v_cvt_pk_bf16_f32 v74, v60, v61
    v_cvt_pk_bf16_f32 v75, v62, v63
    buffer_store_dwordx4 v[72:75], v4, s[8:11], s28 offen sc1
    s_cmp_eq_u32 s14, 63
    s_cbranch_scc1 layerb1_kernel_y2_last
    s_add_u32 s30, s18, 0
    s_add_u32 s31, s18, 4096
    s_add_u32 s32, s18, 16384
    s_add_u32 s33, s18, 20480
    s_add_u32 s34, s18, 32768
    s_add_u32 s29, s14, 1
    s_cmp_lt_u32 s29, 32
    s_cselect_b32 s19, s16, s17
    s_and_b32 s20, s29, 31
    s_lshl_b32 s20, s20, 16
    s_add_u32 s19, s19, s20
layerb1_kernel_y2_ppoll:
    buffer_load_dwordx4 v[92:95], v5, s[8:11], s30 offen sc1
    buffer_load_dwordx4 v[96:99], v5, s[8:11], s31 offen sc1
    buffer_load_dwordx4 v[100:103], v5, s[8:11], s32 offen sc1
    buffer_load_dwordx4 v[104:107], v5, s[8:11], s33 offen sc1
    buffer_load_dwordx4 v[108:111], v5, s[8:11], s34 offen sc1
    s_waitcnt vmcnt(0)
    v_mfma_f32_16x16x32_bf16 v[112:115], v[92:95], v[72:75], 0
    v_mfma_f32_16x16x32_bf16 v[112:115], v[96:99], v[76:79], v[112:115]
    v_mfma_f32_16x16x32_bf16 v[112:115], v[100:103], v[80:83], v[112:115]
    v_mfma_f32_16x16x32_bf16 v[112:115], v[104:107], v[84:87], v[112:115]
    v_mfma_f32_16x16x32_bf16 v[112:115], v[108:111], v[88:91], v[112:115]
    v_max3_u32 v116, v92, v93, v94
    v_max3_u32 v116, v116, v95, v96
    v_max3_u32 v116, v116, v97, v98
    v_max3_u32 v116, v116, v99, v100
    v_max3_u32 v116, v116, v101, v102
    v_max3_u32 v116, v116, v103, v104
    v_max3_u32 v116, v116, v105, v106
    v_max3_u32 v116, v116, v107, v108
    v_max3_u32 v116, v116, v109, v110
    v_max_u32 v116, v116, v111
    v_cmp_eq_u32 vcc, -1, v116
    s_sub_u32 s15, s15, 1
    s_cbranch_scc1 layerb1_kernel_bail
    s_cbranch_vccnz layerb1_kernel_y2_ppoll
    ds_write_b128 v6, v[112:115]
    s_waitcnt lgkmcnt(0)
    s_barrier
    s_barrier
    s_add_u32 s14, s14, 1
    s_branch layerb1_kernel_y2_step
layerb1_kernel_y2_last:
    s_waitcnt vmcnt(0)
    s_barrier
    s_branch layerb1_kernel_end
layerb1_kernel_y3_start:
    v_lshrrev_b32 v16, 4, v0
    v_and_b32 v17, 7, v0
    v_lshrrev_b32 v18, 3, v0
    v_and_b32 v18, 1, v18
    v_lshl_add_u32 v19, v18, 2, v16
    v_add_u32 v19, 24, v19
    v_mul_u32_u24 v20, 640, v19
    v_lshl_add_u32 v4, v17, 4, v20
    v_and_b32 v20, 1, v17
    v_lshlrev_b32 v20, 2, v20
    v_lshrrev_b32 v21, 1, v17
    v_add_u32 v20, v20, v21
    v_lshlrev_b32 v20, 4, v20
    v_lshl_add_u32 v5, v19, 7, v20
    v_add_u32 v3, 0, v1
    v_lshrrev_b32 v20, 1, v17
    v_lshlrev_b32 v20, 7, v20
    v_and_b32 v21, 1, v17
    v_lshl_add_u32 v20, v21, 2, v20
    v_add_u32 v10, 1536, v20
    v_lshlrev_b32 v20, 8, v18
    v_lshl_add_u32 v20, v17, 5, v20
    v_and_b32 v21, 1, v16
    v_lshl_add_u32 v20, v21, 4, v20
    v_add_u32 v20, 11776, v20
    v_add_u32 v21, 12288, v1
    v_lshrrev_b32 v22, 1, v16
    v_cmp_eq_u32 vcc, v22, v18
    s_nop 1
    v_cndmask_b32 v6, v21, v20, vcc
    v_lshrrev_b32 v20, 3, v0
    v_lshlrev_b32 v20, 2, v20
    v_lshl_add_u32 v20, v17, 5, v20
    v_add_u32 v7, 10240, v20
    s_lshl_b32 s20, s12, 7
    s_add_u32 s20, s20, 20480
    s_lshr_b32 s21, s20, 13
    s_lshl_b32 s21, s21, 14
    s_and_b32 s20, s20, 8191
    s_add_u32 s20, s20, s21
    v_lshrrev_b32 v20, 3, v0
    v_lshlrev_b32 v20, 4, v20
    v_add_u32 v8, s20, v20
    s_mul_i32 s46, s12, 20480
    s_add_u32 s46, s46, 103809024
    s_mul_i32 s20, s12, 327680
    s_add_u32 s20, s20, 27508736
    s_add_u32 s21, s20, 65536
    buffer_load_dwordx4 v[176:179], v1, s[8:11], s21 offen offset:0
    buffer_load_dwordx4 v[180:183], v1, s[8:11], s21 offen offset:1024
    s_add_u32 s21, s20, 67584
    buffer_load_dwordx4 v[184:187], v1, s[8:11], s21 offen offset:0
    buffer_load_dwordx4 v[188:191], v1, s[8:11], s21 offen offset:1024
    s_add_u32 s21, s20, 69632
    buffer_load_dwordx4 v[192:195], v1, s[8:11], s21 offen offset:0
    buffer_load_dwordx4 v[196:199], v1, s[8:11], s21 offen offset:1024
    s_add_u32 s21, s20, 71680
    buffer_load_dwordx4 v[200:203], v1, s[8:11], s21 offen offset:0
    buffer_load_dwordx4 v[204:207], v1, s[8:11], s21 offen offset:1024
    s_add_u32 s21, s20, 73728
    buffer_load_dwordx4 v[208:211], v1, s[8:11], s21 offen offset:0
    buffer_load_dwordx4 v[212:215], v1, s[8:11], s21 offen offset:1024
    s_add_u32 s21, s20, 75776
    buffer_load_dwordx4 v[216:219], v1, s[8:11], s21 offen offset:0
    buffer_load_dwordx4 v[220:223], v1, s[8:11], s21 offen offset:1024
    s_add_u32 s21, s20, 77824
    buffer_load_dwordx4 v[224:227], v1, s[8:11], s21 offen offset:0
    buffer_load_dwordx4 v[228:231], v1, s[8:11], s21 offen offset:1024
    s_add_u32 s21, s20, 79872
    buffer_load_dwordx4 v[232:235], v1, s[8:11], s21 offen offset:0
    buffer_load_dwordx4 v[236:239], v1, s[8:11], s21 offen offset:1024
    s_mov_b32 s14, 0
    s_lshl_b32 s20, s12, 7
    v_mov_b32 v9, s20
    s_mov_b32 s47, 0
layerb1_kernel_y3_step:
    s_cmp_lt_u32 s14, 32
    s_cselect_b32 s18, s16, s17
    s_and_b32 s20, s14, 31
    s_lshl_b32 s20, s20, 16
    s_add_u32 s18, s18, s20
    s_mul_i32 s28, s14, 1638400
    s_add_u32 s28, s28, s46
    v_mov_b32 v56, 0
    v_mov_b32 v57, 0
    v_mov_b32 v58, 0
    v_mov_b32 v59, 0
    v_mov_b32 v60, 0
    v_mov_b32 v61, 0
    v_mov_b32 v62, 0
    v_mov_b32 v63, 0
    v_mov_b32 v64, 0
    v_mov_b32 v65, 0
    v_mov_b32 v66, 0
    v_mov_b32 v67, 0
    v_mov_b32 v68, 0
    v_mov_b32 v69, 0
    v_mov_b32 v70, 0
    v_mov_b32 v71, 0
    s_add_u32 s22, s18, 53248
    s_add_u32 s23, s18, 54272
layerb1_kernel_y3_poll:
    buffer_load_dwordx4 v[48:51], v1, s[8:11], s22 offen sc1
    buffer_load_dwordx4 v[52:55], v1, s[8:11], s23 offen sc1
    s_waitcnt vmcnt(0)
    ds_write_b128 v3, v[48:51] offset:8192
    ds_write_b128 v3, v[52:55] offset:9216
    v_max3_u32 v116, v48, v49, v50
    v_max3_u32 v116, v116, v51, v52
    v_max3_u32 v116, v116, v53, v54
    v_max_u32 v116, v116, v55
    v_cmp_eq_u32 vcc, -1, v116
    s_sub_u32 s15, s15, 1
    s_cbranch_scc1 layerb1_kernel_bail
    s_cbranch_vccnz layerb1_kernel_y3_poll
    s_waitcnt lgkmcnt(0)
    s_barrier
    ds_read_b128 v[16:19], v3 offset:0
    ds_read_b128 v[20:23], v3 offset:1024
    ds_read_b128 v[24:27], v3 offset:2048
    ds_read_b128 v[28:31], v3 offset:3072
    ds_read_b128 v[32:35], v3 offset:4096
    ds_read_b128 v[36:39], v3 offset:5120
    ds_read_b128 v[40:43], v3 offset:6144
    ds_read_b128 v[44:47], v3 offset:7168
    s_cmp_gt_u32 s47, s14
    s_cbranch_scc1 layerb1_kernel_y3_gw_ok
layerb1_kernel_y3_gw_lp:
    buffer_load_dword v116, v9, s[8:11], s48 offen sc1
    s_waitcnt vmcnt(0)
    v_readlane_b32 s47, v116, 0
    s_nop 0
    s_sub_u32 s15, s15, 1
    s_cbranch_scc1 layerb1_kernel_bail
    s_cmp_gt_u32 s47, s14
    s_cbranch_scc0 layerb1_kernel_y3_gw_lp
layerb1_kernel_y3_gw_ok:
    buffer_load_dwordx4 v[76:79], v4, s[8:11], s28 offen offset:128 sc1
    buffer_load_dwordx4 v[80:83], v4, s[8:11], s28 offen offset:256 sc1
    buffer_load_dwordx4 v[84:87], v4, s[8:11], s28 offen offset:384 sc1
    buffer_load_dwordx4 v[88:91], v4, s[8:11], s28 offen offset:512 sc1
    v_smfmac_f32_16x16x64_bf16 v[56:59], v[48:51], a[64:71], v2
    v_smfmac_f32_16x16x64_bf16 v[60:63], v[48:51], a[144:151], v2
    v_smfmac_f32_16x16x64_bf16 v[64:67], v[48:51], a[224:231], v2
    v_smfmac_f32_16x16x64_bf16 v[68:71], v[48:51], v[224:231], v2
    v_smfmac_f32_16x16x64_bf16 v[56:59], v[52:55], a[72:79], v2
    v_smfmac_f32_16x16x64_bf16 v[60:63], v[52:55], a[152:159], v2
    v_smfmac_f32_16x16x64_bf16 v[64:67], v[52:55], a[232:239], v2
    v_smfmac_f32_16x16x64_bf16 v[68:71], v[52:55], v[232:239], v2
    s_waitcnt lgkmcnt(7)
    v_smfmac_f32_16x16x64_bf16 v[56:59], v[16:19], a[0:7], v2
    v_smfmac_f32_16x16x64_bf16 v[60:63], v[16:19], a[80:87], v2
    v_smfmac_f32_16x16x64_bf16 v[64:67], v[16:19], a[160:167], v2
    v_smfmac_f32_16x16x64_bf16 v[68:71], v[16:19], a[240:247], v2
    s_waitcnt lgkmcnt(6)
    v_smfmac_f32_16x16x64_bf16 v[56:59], v[20:23], a[8:15], v2
    v_smfmac_f32_16x16x64_bf16 v[60:63], v[20:23], a[88:95], v2
    v_smfmac_f32_16x16x64_bf16 v[64:67], v[20:23], a[168:175], v2
    v_smfmac_f32_16x16x64_bf16 v[68:71], v[20:23], a[248:255], v2
    s_waitcnt lgkmcnt(5)
    v_smfmac_f32_16x16x64_bf16 v[56:59], v[24:27], a[16:23], v2
    v_smfmac_f32_16x16x64_bf16 v[60:63], v[24:27], a[96:103], v2
    v_smfmac_f32_16x16x64_bf16 v[64:67], v[24:27], a[176:183], v2
    v_smfmac_f32_16x16x64_bf16 v[68:71], v[24:27], v[176:183], v2
    s_waitcnt lgkmcnt(4)
    v_smfmac_f32_16x16x64_bf16 v[56:59], v[28:31], a[24:31], v2
    v_smfmac_f32_16x16x64_bf16 v[60:63], v[28:31], a[104:111], v2
    v_smfmac_f32_16x16x64_bf16 v[64:67], v[28:31], a[184:191], v2
    v_smfmac_f32_16x16x64_bf16 v[68:71], v[28:31], v[184:191], v2
    s_waitcnt lgkmcnt(3)
    v_smfmac_f32_16x16x64_bf16 v[56:59], v[32:35], a[32:39], v2
    v_smfmac_f32_16x16x64_bf16 v[60:63], v[32:35], a[112:119], v2
    v_smfmac_f32_16x16x64_bf16 v[64:67], v[32:35], a[192:199], v2
    v_smfmac_f32_16x16x64_bf16 v[68:71], v[32:35], v[192:199], v2
    s_waitcnt lgkmcnt(2)
    v_smfmac_f32_16x16x64_bf16 v[56:59], v[36:39], a[40:47], v2
    v_smfmac_f32_16x16x64_bf16 v[60:63], v[36:39], a[120:127], v2
    v_smfmac_f32_16x16x64_bf16 v[64:67], v[36:39], a[200:207], v2
    v_smfmac_f32_16x16x64_bf16 v[68:71], v[36:39], v[200:207], v2
    s_waitcnt lgkmcnt(1)
    v_smfmac_f32_16x16x64_bf16 v[56:59], v[40:43], a[48:55], v2
    v_smfmac_f32_16x16x64_bf16 v[60:63], v[40:43], a[128:135], v2
    v_smfmac_f32_16x16x64_bf16 v[64:67], v[40:43], a[208:215], v2
    v_smfmac_f32_16x16x64_bf16 v[68:71], v[40:43], v[208:215], v2
    s_waitcnt lgkmcnt(0)
    v_smfmac_f32_16x16x64_bf16 v[56:59], v[44:47], a[56:63], v2
    v_smfmac_f32_16x16x64_bf16 v[60:63], v[44:47], a[136:143], v2
    v_smfmac_f32_16x16x64_bf16 v[64:67], v[44:47], a[216:223], v2
    v_smfmac_f32_16x16x64_bf16 v[68:71], v[44:47], v[216:223], v2
    s_nop 7
    v_permlane32_swap_b32 v56, v64
    v_permlane32_swap_b32 v60, v68
    v_permlane32_swap_b32 v57, v65
    v_permlane32_swap_b32 v61, v69
    v_permlane32_swap_b32 v58, v66
    v_permlane32_swap_b32 v62, v70
    v_permlane32_swap_b32 v59, v67
    v_permlane32_swap_b32 v63, v71
    v_add_f32 v56, v56, v64
    v_add_f32 v60, v60, v68
    v_add_f32 v57, v57, v65
    v_add_f32 v61, v61, v69
    v_add_f32 v58, v58, v66
    v_add_f32 v62, v62, v70
    v_add_f32 v59, v59, v67
    v_add_f32 v63, v63, v71
    s_nop 1
    v_permlane16_swap_b32 v56, v60
    v_permlane16_swap_b32 v57, v61
    v_permlane16_swap_b32 v58, v62
    v_permlane16_swap_b32 v59, v63
    s_nop 1
    v_cvt_pk_bf16_f32 v72, v56, v57
    v_cvt_pk_bf16_f32 v73, v58, v59
    v_cvt_pk_bf16_f32 v74, v60, v61
    v_cvt_pk_bf16_f32 v75, v62, v63
    buffer_store_dwordx4 v[72:75], v4, s[8:11], s28 offen sc1
    s_cmp_eq_u32 s14, 63
    s_cbranch_scc1 layerb1_kernel_y3_last
    s_add_u32 s30, s18, 0
    s_add_u32 s31, s18, 4096
    s_add_u32 s32, s18, 16384
    s_add_u32 s33, s18, 20480
    s_add_u32 s34, s18, 32768
    s_add_u32 s29, s14, 1
    s_cmp_lt_u32 s29, 32
    s_cselect_b32 s19, s16, s17
    s_and_b32 s20, s29, 31
    s_lshl_b32 s20, s20, 16
    s_add_u32 s19, s19, s20
layerb1_kernel_y3_ppoll:
    buffer_load_dwordx4 v[92:95], v5, s[8:11], s30 offen sc1
    buffer_load_dwordx4 v[96:99], v5, s[8:11], s31 offen sc1
    buffer_load_dwordx4 v[100:103], v5, s[8:11], s32 offen sc1
    buffer_load_dwordx4 v[104:107], v5, s[8:11], s33 offen sc1
    buffer_load_dwordx4 v[108:111], v5, s[8:11], s34 offen sc1
    s_waitcnt vmcnt(0)
    v_mfma_f32_16x16x32_bf16 v[112:115], v[92:95], v[72:75], 0
    v_mfma_f32_16x16x32_bf16 v[112:115], v[96:99], v[76:79], v[112:115]
    v_mfma_f32_16x16x32_bf16 v[112:115], v[100:103], v[80:83], v[112:115]
    v_mfma_f32_16x16x32_bf16 v[112:115], v[104:107], v[84:87], v[112:115]
    v_mfma_f32_16x16x32_bf16 v[112:115], v[108:111], v[88:91], v[112:115]
    v_max3_u32 v116, v92, v93, v94
    v_max3_u32 v116, v116, v95, v96
    v_max3_u32 v116, v116, v97, v98
    v_max3_u32 v116, v116, v99, v100
    v_max3_u32 v116, v116, v101, v102
    v_max3_u32 v116, v116, v103, v104
    v_max3_u32 v116, v116, v105, v106
    v_max3_u32 v116, v116, v107, v108
    v_max3_u32 v116, v116, v109, v110
    v_max_u32 v116, v116, v111
    v_cmp_eq_u32 vcc, -1, v116
    s_sub_u32 s15, s15, 1
    s_cbranch_scc1 layerb1_kernel_bail
    s_cbranch_vccnz layerb1_kernel_y3_ppoll
    ds_write_b128 v6, v[112:115]
    s_waitcnt lgkmcnt(0)
    s_barrier
    s_barrier
    s_add_u32 s14, s14, 1
    s_branch layerb1_kernel_y3_step
layerb1_kernel_y3_last:
    s_waitcnt vmcnt(0)
    s_barrier
    s_branch layerb1_kernel_end
layerb1_kernel_proj:
    s_sub_u32 s22, s20, 4
    s_lshl_b32 s22, s22, 5
    s_add_u32 s12, s22, s21
    s_mov_b32 s14, 0
    s_mov_b32 s15, 64
    v_lshlrev_b32 v1, 4, v0
    v_and_b32 v8, 31, v0
    v_lshrrev_b32 v9, 5, v0
    s_cmp_ge_u32 s12, 80
    s_cbranch_scc1 layerb1_kernel_g_qk
    v_lshrrev_b32 v10, 3, v8
    v_and_b32 v11, 7, v8
    v_mul_u32_u24 v12, 20480, v10
    v_lshl_add_u32 v12, v11, 4, v12
    v_lshl_add_u32 v4, v9, 8, v12
    s_mul_i32 s24, s12, 327680
    s_mul_i32 s25, s13, 81920
    s_add_u32 s24, s24, s25
    s_add_u32 s24, s24, 27262976
    s_add_u32 s24, s24, 3584
    s_add_u32 s24, s24, 3584
    s_add_u32 s24, s24, 3584
    s_add_u32 s24, s24, 3584
    buffer_load_dwordx4 v[192:195], v4, s[8:11], s24 offen offset:2048
    buffer_load_dwordx4 v[196:199], v4, s[8:11], s24 offen offset:2176
    buffer_load_dwordx4 v[200:203], v4, s[8:11], s24 offen offset:2560
    buffer_load_dwordx4 v[204:207], v4, s[8:11], s24 offen offset:2688
    buffer_load_dwordx4 v[208:211], v4, s[8:11], s24 offen offset:3072
    buffer_load_dwordx4 v[212:215], v4, s[8:11], s24 offen offset:3200
    s_add_u32 s24, s24, 3584
    buffer_load_dwordx4 v[216:219], v4, s[8:11], s24 offen offset:0
    buffer_load_dwordx4 v[220:223], v4, s[8:11], s24 offen offset:128
    buffer_load_dwordx4 v[224:227], v4, s[8:11], s24 offen offset:512
    buffer_load_dwordx4 v[228:231], v4, s[8:11], s24 offen offset:640
    buffer_load_dwordx4 v[232:235], v4, s[8:11], s24 offen offset:1024
    buffer_load_dwordx4 v[236:239], v4, s[8:11], s24 offen offset:1152
    buffer_load_dwordx4 v[240:243], v4, s[8:11], s24 offen offset:1536
    buffer_load_dwordx4 v[244:247], v4, s[8:11], s24 offen offset:1664
    buffer_load_dwordx4 v[248:251], v4, s[8:11], s24 offen offset:2048
    buffer_load_dwordx4 v[252:255], v4, s[8:11], s24 offen offset:2176
    s_lshl_b32 s25, s13, 3
    v_add_u32 v10, s25, v10
    v_mul_u32_u24 v10, 640, v10
    v_lshl_add_u32 v10, v9, 7, v10
    v_lshl_add_u32 v10, v11, 4, v10
    v_add_u32 v3, 128, v10
    s_mul_i32 s17, s12, 20480
    s_mul_i32 s25, s14, 1638400
    s_add_u32 s17, s17, s25
    s_add_u32 s17, s17, 103809024
    s_mov_b32 s20, 1638400
    s_mul_i32 s19, s13, 10240
    s_add_u32 s19, s19, 220200960
    s_mov_b32 s22, 0
    s_mov_b32 s56, 0
    s_mov_b32 s58, 400000
    s_add_u32 s57, s48, 45056
    s_cmp_lg_u32 s13, 0
    s_cbranch_scc1 layerb1_kernel_gu_lw1
    s_min_u32 s28, s14, 63
    s_cmp_gt_u32 s56, s28
    s_cbranch_scc1 layerb1_kernel_gu_lw1
layerb1_kernel_gu_lp1:
    buffer_load_dwordx4 v[124:127], v1, s[8:11], s57 offen sc1
    s_waitcnt vmcnt(0)
    v_min_u32 v124, v124, v125
    v_min_u32 v126, v126, v127
    v_min_u32 v124, v124, v126
    v_cmp_eq_u32 vcc, 0, v124
    s_nop 1
    s_ff1_i32_b64 s56, vcc
    s_min_u32 s56, s56, 64
    s_sub_u32 s58, s58, 1
    s_cbranch_scc1 layerb1_kernel_bail
    s_cmp_gt_u32 s56, s28
    s_cbranch_scc0 layerb1_kernel_gu_lp1
layerb1_kernel_gu_lw1:
    s_barrier
    s_min_u32 s24, s14, 63
    s_mul_i32 s24, s24, 40960
    s_add_u32 s24, s24, s19
    s_mul_i32 s25, s13, 10240
    s_add_u32 s25, s25, s22
    s_mov_b32 m0, s25
    s_nop 0
    buffer_load_dwordx4 v1, s[8:11], s24 offen offset:0 sc1 lds
    buffer_load_dwordx4 v1, s[8:11], s24 offen offset:1024 sc1 lds
    buffer_load_dwordx4 v1, s[8:11], s24 offen offset:2048 sc1 lds
    buffer_load_dwordx4 v1, s[8:11], s24 offen offset:3072 sc1 lds
    s_add_u32 s24, s24, 4096
    s_add_u32 s25, s25, 4096
    s_mov_b32 m0, s25
    s_nop 0
    buffer_load_dwordx4 v1, s[8:11], s24 offen offset:0 sc1 lds
    buffer_load_dwordx4 v1, s[8:11], s24 offen offset:1024 sc1 lds
    buffer_load_dwordx4 v1, s[8:11], s24 offen offset:2048 sc1 lds
    buffer_load_dwordx4 v1, s[8:11], s24 offen offset:3072 sc1 lds
    s_add_u32 s24, s24, 4096
    s_add_u32 s25, s25, 4096
    s_mov_b32 m0, s25
    s_nop 0
    buffer_load_dwordx4 v1, s[8:11], s24 offen offset:0 sc1 lds
    buffer_load_dwordx4 v1, s[8:11], s24 offen offset:1024 sc1 lds
    s_mov_b32 s22, 40960
    s_mov_b32 s16, 0
    s_waitcnt vmcnt(0)
    s_barrier
    v_mov_b32 v2, v1
    ds_read_b128 v[8:11], v2 offset:0
    ds_read_b128 v[12:15], v2 offset:1024
    ds_read_b128 v[16:19], v2 offset:2048
    ds_read_b128 v[20:23], v2 offset:3072
    ds_read_b128 v[24:27], v2 offset:4096
    ds_read_b128 v[28:31], v2 offset:5120
layerb1_kernel_gu_solo:
    ds_read_b128 v[32:35], v2 offset:6144
    s_waitcnt lgkmcnt(6)
    v_mfma_f32_32x32x16_bf16 v[40:55], v[8:11], a[0:3], 0
    v_mfma_f32_32x32x16_bf16 v[56:71], v[8:11], a[4:7], 0
    ds_read_b128 v[36:39], v2 offset:7168
    s_waitcnt lgkmcnt(6)
    v_mfma_f32_32x32x16_bf16 v[40:55], v[12:15], a[8:11], v[40:55]
    v_mfma_f32_32x32x16_bf16 v[56:71], v[12:15], a[12:15], v[56:71]
    ds_read_b128 v[8:11], v2 offset:8192
    s_waitcnt lgkmcnt(6)
    v_mfma_f32_32x32x16_bf16 v[40:55], v[16:19], a[16:19], v[40:55]
    v_mfma_f32_32x32x16_bf16 v[56:71], v[16:19], a[20:23], v[56:71]
    ds_read_b128 v[12:15], v2 offset:9216
    s_waitcnt lgkmcnt(6)
    v_mfma_f32_32x32x16_bf16 v[40:55], v[20:23], a[24:27], v[40:55]
    v_mfma_f32_32x32x16_bf16 v[56:71], v[20:23], a[28:31], v[56:71]
    ds_read_b128 v[16:19], v2 offset:10240
    s_waitcnt lgkmcnt(6)
    v_mfma_f32_32x32x16_bf16 v[40:55], v[24:27], a[32:35], v[40:55]
    v_mfma_f32_32x32x16_bf16 v[56:71], v[24:27], a[36:39], v[56:71]
    ds_read_b128 v[20:23], v2 offset:11264
    s_waitcnt lgkmcnt(6)
    v_mfma_f32_32x32x16_bf16 v[40:55], v[28:31], a[40:43], v[40:55]
    v_mfma_f32_32x32x16_bf16 v[56:71], v[28:31], a[44:47], v[56:71]
    ds_read_b128 v[24:27], v2 offset:12288
    s_waitcnt lgkmcnt(6)
    v_mfma_f32_32x32x16_bf16 v[40:55], v[32:35], a[48:51], v[40:55]
    v_mfma_f32_32x32x16_bf16 v[56:71], v[32:35], a[52:55], v[56:71]
    ds_read_b128 v[28:31], v2 offset:13312
    s_waitcnt lgkmcnt(6)
    v_mfma_f32_32x32x16_bf16 v[40:55], v[36:39], a[56:59], v[40:55]
    v_mfma_f32_32x32x16_bf16 v[56:71], v[36:39], a[60:63], v[56:71]
    ds_read_b128 v[32:35], v2 offset:14336
    s_waitcnt lgkmcnt(6)
    v_mfma_f32_32x32x16_bf16 v[40:55], v[8:11], a[64:67], v[40:55]
    v_mfma_f32_32x32x16_bf16 v[56:71], v[8:11], a[68:71], v[56:71]
    ds_read_b128 v[36:39], v2 offset:15360
    s_waitcnt lgkmcnt(6)
    v_mfma_f32_32x32x16_bf16 v[40:55], v[12:15], a[72:75], v[40:55]
    v_mfma_f32_32x32x16_bf16 v[56:71], v[12:15], a[76:79], v[56:71]
    ds_read_b128 v[8:11], v2 offset:16384
    s_waitcnt lgkmcnt(6)
    v_mfma_f32_32x32x16_bf16 v[40:55], v[16:19], a[80:83], v[40:55]
    v_mfma_f32_32x32x16_bf16 v[56:71], v[16:19], a[84:87], v[56:71]
    ds_read_b128 v[12:15], v2 offset:17408
    s_waitcnt lgkmcnt(6)
    v_mfma_f32_32x32x16_bf16 v[40:55], v[20:23], a[88:91], v[40:55]
    v_mfma_f32_32x32x16_bf16 v[56:71], v[20:23], a[92:95], v[56:71]
    ds_read_b128 v[16:19], v2 offset:18432
    s_waitcnt lgkmcnt(6)
    v_mfma_f32_32x32x16_bf16 v[40:55], v[24:27], a[96:99], v[40:55]
    v_mfma_f32_32x32x16_bf16 v[56:71], v[24:27], a[100:103], v[56:71]
    ds_read_b128 v[20:23], v2 offset:19456
    s_waitcnt lgkmcnt(6)
    v_mfma_f32_32x32x16_bf16 v[40:55], v[28:31], a[104:107], v[40:55]
    v_mfma_f32_32x32x16_bf16 v[56:71], v[28:31], a[108:111], v[56:71]
    ds_read_b128 v[24:27], v2 offset:20480
    s_waitcnt lgkmcnt(6)
    v_mfma_f32_32x32x16_bf16 v[40:55], v[32:35], a[112:115], v[40:55]
    v_mfma_f32_32x32x16_bf16 v[56:71], v[32:35], a[116:119], v[56:71]
    ds_read_b128 v[28:31], v2 offset:21504
    s_waitcnt lgkmcnt(6)
    v_mfma_f32_32x32x16_bf16 v[40:55], v[36:39], a[120:123], v[40:55]
    v_mfma_f32_32x32x16_bf16 v[56:71], v[36:39], a[124:127], v[56:71]
    ds_read_b128 v[32:35], v2 offset:22528
    s_waitcnt lgkmcnt(6)
    v_mfma_f32_32x32x16_bf16 v[40:55], v[8:11], a[128:131], v[40:55]
    v_mfma_f32_32x32x16_bf16 v[56:71], v[8:11], a[132:135], v[56:71]
    ds_read_b128 v[36:39], v2 offset:23552
    s_waitcnt lgkmcnt(6)
    v_mfma_f32_32x32x16_bf16 v[40:55], v[12:15], a[136:139], v[40:55]
    v_mfma_f32_32x32x16_bf16 v[56:71], v[12:15], a[140:143], v[56:71]
    ds_read_b128 v[8:11], v2 offset:24576
    s_waitcnt lgkmcnt(6)
    v_mfma_f32_32x32x16_bf16 v[40:55], v[16:19], a[144:147], v[40:55]
    v_mfma_f32_32x32x16_bf16 v[56:71], v[16:19], a[148:151], v[56:71]
    ds_read_b128 v[12:15], v2 offset:25600
    s_waitcnt lgkmcnt(6)
    v_mfma_f32_32x32x16_bf16 v[40:55], v[20:23], a[152:155], v[40:55]
    v_mfma_f32_32x32x16_bf16 v[56:71], v[20:23], a[156:159], v[56:71]
    ds_read_b128 v[16:19], v2 offset:26624
    s_waitcnt lgkmcnt(6)
    v_mfma_f32_32x32x16_bf16 v[40:55], v[24:27], a[160:163], v[40:55]
    v_mfma_f32_32x32x16_bf16 v[56:71], v[24:27], a[164:167], v[56:71]
    ds_read_b128 v[20:23], v2 offset:27648
    s_waitcnt lgkmcnt(6)
    v_mfma_f32_32x32x16_bf16 v[40:55], v[28:31], a[168:171], v[40:55]
    v_mfma_f32_32x32x16_bf16 v[56:71], v[28:31], a[172:175], v[56:71]
    ds_read_b128 v[24:27], v2 offset:28672
    s_waitcnt lgkmcnt(6)
    v_mfma_f32_32x32x16_bf16 v[40:55], v[32:35], a[176:179], v[40:55]
    v_mfma_f32_32x32x16_bf16 v[56:71], v[32:35], a[180:183], v[56:71]
    ds_read_b128 v[28:31], v2 offset:29696
    s_waitcnt lgkmcnt(6)
    v_mfma_f32_32x32x16_bf16 v[40:55], v[36:39], a[184:187], v[40:55]
    v_mfma_f32_32x32x16_bf16 v[56:71], v[36:39], a[188:191], v[56:71]
    ds_read_b128 v[32:35], v2 offset:30720
    s_waitcnt lgkmcnt(6)
    v_mfma_f32_32x32x16_bf16 v[40:55], v[8:11], a[192:195], v[40:55]
    v_mfma_f32_32x32x16_bf16 v[56:71], v[8:11], a[196:199], v[56:71]
    ds_read_b128 v[36:39], v2 offset:31744
    s_waitcnt lgkmcnt(6)
    v_mfma_f32_32x32x16_bf16 v[40:55], v[12:15], a[200:203], v[40:55]
    v_mfma_f32_32x32x16_bf16 v[56:71], v[12:15], a[204:207], v[56:71]
    ds_read_b128 v[8:11], v2 offset:32768
    s_waitcnt lgkmcnt(6)
    v_mfma_f32_32x32x16_bf16 v[40:55], v[16:19], a[208:211], v[40:55]
    v_mfma_f32_32x32x16_bf16 v[56:71], v[16:19], a[212:215], v[56:71]
    ds_read_b128 v[12:15], v2 offset:33792
    s_waitcnt lgkmcnt(6)
    v_mfma_f32_32x32x16_bf16 v[40:55], v[20:23], a[216:219], v[40:55]
    v_mfma_f32_32x32x16_bf16 v[56:71], v[20:23], a[220:223], v[56:71]
    ds_read_b128 v[16:19], v2 offset:34816
    s_waitcnt lgkmcnt(6)
    v_mfma_f32_32x32x16_bf16 v[40:55], v[24:27], a[224:227], v[40:55]
    v_mfma_f32_32x32x16_bf16 v[56:71], v[24:27], a[228:231], v[56:71]
    ds_read_b128 v[20:23], v2 offset:35840
    s_waitcnt lgkmcnt(6)
    v_mfma_f32_32x32x16_bf16 v[40:55], v[28:31], a[232:235], v[40:55]
    v_mfma_f32_32x32x16_bf16 v[56:71], v[28:31], a[236:239], v[56:71]
    ds_read_b128 v[24:27], v2 offset:36864
    s_waitcnt lgkmcnt(6)
    buffer_load_dwordx4 v[124:127], v1, s[8:11], s57 offen sc1
    v_mfma_f32_32x32x16_bf16 v[40:55], v[32:35], a[240:243], v[40:55]
    v_mfma_f32_32x32x16_bf16 v[56:71], v[32:35], a[244:247], v[56:71]
    ds_read_b128 v[28:31], v2 offset:37888
    s_waitcnt lgkmcnt(6)
    v_mfma_f32_32x32x16_bf16 v[40:55], v[36:39], a[248:251], v[40:55]
    v_mfma_f32_32x32x16_bf16 v[56:71], v[36:39], a[252:255], v[56:71]
    ds_read_b128 v[32:35], v2 offset:38912
    s_waitcnt lgkmcnt(6)
    v_mfma_f32_32x32x16_bf16 v[40:55], v[8:11], v[192:195], v[40:55]
    v_mfma_f32_32x32x16_bf16 v[56:71], v[8:11], v[196:199], v[56:71]
    ds_read_b128 v[36:39], v2 offset:39936
    s_waitcnt lgkmcnt(6)
    v_mfma_f32_32x32x16_bf16 v[40:55], v[12:15], v[200:203], v[40:55]
    v_mfma_f32_32x32x16_bf16 v[56:71], v[12:15], v[204:207], v[56:71]
    s_waitcnt lgkmcnt(5)
    v_mfma_f32_32x32x16_bf16 v[40:55], v[16:19], v[208:211], v[40:55]
    v_mfma_f32_32x32x16_bf16 v[56:71], v[16:19], v[212:215], v[56:71]
    s_waitcnt lgkmcnt(4)
    v_mfma_f32_32x32x16_bf16 v[40:55], v[20:23], v[216:219], v[40:55]
    v_mfma_f32_32x32x16_bf16 v[56:71], v[20:23], v[220:223], v[56:71]
    s_waitcnt lgkmcnt(3)
    v_mfma_f32_32x32x16_bf16 v[40:55], v[24:27], v[224:227], v[40:55]
    v_mfma_f32_32x32x16_bf16 v[56:71], v[24:27], v[228:231], v[56:71]
    s_waitcnt lgkmcnt(2)
    v_mfma_f32_32x32x16_bf16 v[40:55], v[28:31], v[232:235], v[40:55]
    v_mfma_f32_32x32x16_bf16 v[56:71], v[28:31], v[236:239], v[56:71]
    s_waitcnt lgkmcnt(1)
    v_mfma_f32_32x32x16_bf16 v[40:55], v[32:35], v[240:243], v[40:55]
    v_mfma_f32_32x32x16_bf16 v[56:71], v[32:35], v[244:247], v[56:71]
    s_waitcnt lgkmcnt(0)
    v_mfma_f32_32x32x16_bf16 v[40:55], v[36:39], v[248:251], v[40:55]
    v_mfma_f32_32x32x16_bf16 v[56:71], v[36:39], v[252:255], v[56:71]
    s_add_u32 s14, s14, 1
    s_nop 7
    s_nop 7
    v_cvt_pk_bf16_f32 v104, v40, v41
    v_cvt_pk_bf16_f32 v105, v42, v43
    v_cvt_pk_bf16_f32 v106, v44, v45
    v_cvt_pk_bf16_f32 v107, v46, v47
    s_nop 1
    v_permlane32_swap_b32 v104, v106
    v_permlane32_swap_b32 v105, v107
    buffer_store_dwordx4 v[104:107], v3, s[8:11], s17 offen offset:0 sc1
    v_cvt_pk_bf16_f32 v108, v48, v49
    v_cvt_pk_bf16_f32 v109, v50, v51
    v_cvt_pk_bf16_f32 v110, v52, v53
    v_cvt_pk_bf16_f32 v111, v54, v55
    s_nop 1
    v_permlane32_swap_b32 v108, v110
    v_permlane32_swap_b32 v109, v111
    buffer_store_dwordx4 v[108:111], v3, s[8:11], s17 offen offset:256 sc1
    v_cvt_pk_bf16_f32 v112, v56, v57
    v_cvt_pk_bf16_f32 v113, v58, v59
    v_cvt_pk_bf16_f32 v114, v60, v61
    v_cvt_pk_bf16_f32 v115, v62, v63
    s_nop 1
    v_permlane32_swap_b32 v112, v114
    v_permlane32_swap_b32 v113, v115
    buffer_store_dwordx4 v[112:115], v3, s[8:11], s17 offen offset:2560 sc1
    v_cvt_pk_bf16_f32 v116, v64, v65
    v_cvt_pk_bf16_f32 v117, v66, v67
    v_cvt_pk_bf16_f32 v118, v68, v69
    v_cvt_pk_bf16_f32 v119, v70, v71
    s_nop 1
    v_permlane32_swap_b32 v116, v118
    v_permlane32_swap_b32 v117, v119
    buffer_store_dwordx4 v[116:119], v3, s[8:11], s17 offen offset:2816 sc1
    s_add_u32 s17, s17, s20
    s_add_u32 s18, s18, s20
    s_waitcnt vmcnt(0)
    s_barrier
    s_cmp_lg_u32 s13, 0
    s_cbranch_scc1 layerb1_kernel_gu_fl2
    s_mov_b64 exec, 1
    s_lshl_b32 s26, s12, 7
    v_mov_b32 v7, s26
    v_mov_b32 v120, s14
    buffer_store_dword v120, v7, s[8:11], s48 offen sc1
    s_mov_b64 exec, -1
layerb1_kernel_gu_fl2:
layerb1_kernel_gu_spoll:
    v_min_u32 v124, v124, v125
    v_min_u32 v126, v126, v127
    v_min_u32 v124, v124, v126
    v_cmp_eq_u32 vcc, 0, v124
    s_nop 1
    s_ff1_i32_b64 s56, vcc
    s_min_u32 s56, s56, 64
    s_cmp_gt_u32 s56, s14
    s_cbranch_scc1 layerb1_kernel_gu_sok
    s_sub_u32 s58, s58, 1
    s_cbranch_scc1 layerb1_kernel_bail
    buffer_load_dwordx4 v[124:127], v1, s[8:11], s57 offen sc1
    s_waitcnt vmcnt(0)
    s_branch layerb1_kernel_gu_spoll
layerb1_kernel_gu_sok:
    s_min_u32 s24, s14, 63
    s_mul_i32 s24, s24, 40960
    s_add_u32 s24, s24, s19
    s_mul_i32 s25, s13, 10240
    s_add_u32 s25, s25, s22
    s_mov_b32 m0, s25
    s_nop 0
    buffer_load_dwordx4 v1, s[8:11], s24 offen offset:0 sc1 lds
    buffer_load_dwordx4 v1, s[8:11], s24 offen offset:1024 sc1 lds
    buffer_load_dwordx4 v1, s[8:11], s24 offen offset:2048 sc1 lds
    buffer_load_dwordx4 v1, s[8:11], s24 offen offset:3072 sc1 lds
    s_add_u32 s24, s24, 4096
    s_add_u32 s25, s25, 4096
    s_mov_b32 m0, s25
    s_nop 0
    buffer_load_dwordx4 v1, s[8:11], s24 offen offset:0 sc1 lds
    buffer_load_dwordx4 v1, s[8:11], s24 offen offset:1024 sc1 lds
    buffer_load_dwordx4 v1, s[8:11], s24 offen offset:2048 sc1 lds
    buffer_load_dwordx4 v1, s[8:11], s24 offen offset:3072 sc1 lds
    s_add_u32 s24, s24, 4096
    s_add_u32 s25, s25, 4096
    s_mov_b32 m0, s25
    s_nop 0
    buffer_load_dwordx4 v1, s[8:11], s24 offen offset:0 sc1 lds
    buffer_load_dwordx4 v1, s[8:11], s24 offen offset:1024 sc1 lds
    s_mov_b32 s16, s22
    s_add_u32 s22, s22, 40960
    s_cmp_eq_u32 s22, 122880
    s_cselect_b32 s22, 0, s22
    v_add_u32 v2, s16, v1
    s_waitcnt vmcnt(0)
    s_barrier
    ds_read_b128 v[8:11], v2 offset:0
    ds_read_b128 v[12:15], v2 offset:1024
    ds_read_b128 v[16:19], v2 offset:2048
    ds_read_b128 v[20:23], v2 offset:3072
    ds_read_b128 v[24:27], v2 offset:4096
    ds_read_b128 v[28:31], v2 offset:5120
    s_cmp_lt_u32 s14, 3
    s_cbranch_scc1 layerb1_kernel_gu_solo
    ds_read_b128 v[32:35], v2 offset:6144
    s_waitcnt lgkmcnt(6)
    v_mfma_f32_32x32x16_bf16 v[72:87], v[8:11], a[0:3], 0
    v_mfma_f32_32x32x16_bf16 v[88:103], v[8:11], a[4:7], 0
    ds_read_b128 v[36:39], v2 offset:7168
    s_waitcnt lgkmcnt(6)
    v_mfma_f32_32x32x16_bf16 v[72:87], v[12:15], a[8:11], v[72:87]
    v_mfma_f32_32x32x16_bf16 v[88:103], v[12:15], a[12:15], v[88:103]
    ds_read_b128 v[8:11], v2 offset:8192
    s_waitcnt lgkmcnt(6)
    v_mfma_f32_32x32x16_bf16 v[72:87], v[16:19], a[16:19], v[72:87]
    v_mfma_f32_32x32x16_bf16 v[88:103], v[16:19], a[20:23], v[88:103]
    s_add_u32 s23, s14, 1
    s_cmp_lg_u32 s13, 0
    s_cbranch_scc1 layerb1_kernel_gu_lw3
    s_min_u32 s28, s23, 63
    s_cmp_gt_u32 s56, s28
    s_cbranch_scc1 layerb1_kernel_gu_lw3
layerb1_kernel_gu_lp3:
    buffer_load_dwordx4 v[124:127], v1, s[8:11], s57 offen sc1
    s_waitcnt vmcnt(0)
    v_min_u32 v124, v124, v125
    v_min_u32 v126, v126, v127
    v_min_u32 v124, v124, v126
    v_cmp_eq_u32 vcc, 0, v124
    s_nop 1
    s_ff1_i32_b64 s56, vcc
    s_min_u32 s56, s56, 64
    s_sub_u32 s58, s58, 1
    s_cbranch_scc1 layerb1_kernel_bail
    s_cmp_gt_u32 s56, s28
    s_cbranch_scc0 layerb1_kernel_gu_lp3
layerb1_kernel_gu_lw3:
    s_barrier
    s_min_u32 s24, s23, 63
    s_mul_i32 s24, s24, 40960
    s_add_u32 s24, s24, s19
    s_mul_i32 s25, s13, 10240
    s_add_u32 s25, s25, s22
    s_add_u32 s22, s22, 40960
    s_cmp_eq_u32 s22, 122880
    s_cselect_b32 s22, 0, s22
    ds_read_b128 v[12:15], v2 offset:9216
    s_waitcnt lgkmcnt(6)
    v_mfma_f32_32x32x16_bf16 v[72:87], v[20:23], a[24:27], v[72:87]
    s_mov_b32 m0, s25
    s_nop 0
    buffer_load_dwordx4 v1, s[8:11], s24 offen offset:0 sc1 lds
    v_mfma_f32_32x32x16_bf16 v[88:103], v[20:23], a[28:31], v[88:103]
    ds_read_b128 v[16:19], v2 offset:10240
    s_waitcnt lgkmcnt(6)
    v_mfma_f32_32x32x16_bf16 v[72:87], v[24:27], a[32:35], v[72:87]
    buffer_load_dwordx4 v1, s[8:11], s24 offen offset:1024 sc1 lds
    v_mfma_f32_32x32x16_bf16 v[88:103], v[24:27], a[36:39], v[88:103]
    ds_read_b128 v[20:23], v2 offset:11264
    s_waitcnt lgkmcnt(6)
    v_mfma_f32_32x32x16_bf16 v[72:87], v[28:31], a[40:43], v[72:87]
    buffer_load_dwordx4 v1, s[8:11], s24 offen offset:2048 sc1 lds
    v_mfma_f32_32x32x16_bf16 v[88:103], v[28:31], a[44:47], v[88:103]
    ds_read_b128 v[24:27], v2 offset:12288
    s_waitcnt lgkmcnt(6)
    v_mfma_f32_32x32x16_bf16 v[72:87], v[32:35], a[48:51], v[72:87]
    buffer_load_dwordx4 v1, s[8:11], s24 offen offset:3072 sc1 lds
    v_mfma_f32_32x32x16_bf16 v[88:103], v[32:35], a[52:55], v[88:103]
    ds_read_b128 v[28:31], v2 offset:13312
    s_waitcnt lgkmcnt(6)
    v_mfma_f32_32x32x16_bf16 v[72:87], v[36:39], a[56:59], v[72:87]
    s_add_u32 s24, s24, 4096
    s_add_u32 s25, s25, 4096
    s_mov_b32 m0, s25
    s_nop 0
    buffer_load_dwordx4 v1, s[8:11], s24 offen offset:0 sc1 lds
    v_mfma_f32_32x32x16_bf16 v[88:103], v[36:39], a[60:63], v[88:103]
    ds_read_b128 v[32:35], v2 offset:14336
    s_waitcnt lgkmcnt(6)
    v_mfma_f32_32x32x16_bf16 v[72:87], v[8:11], a[64:67], v[72:87]
    buffer_load_dwordx4 v1, s[8:11], s24 offen offset:1024 sc1 lds
    v_mfma_f32_32x32x16_bf16 v[88:103], v[8:11], a[68:71], v[88:103]
    ds_read_b128 v[36:39], v2 offset:15360
    s_waitcnt lgkmcnt(6)
    v_mfma_f32_32x32x16_bf16 v[72:87], v[12:15], a[72:75], v[72:87]
    buffer_load_dwordx4 v1, s[8:11], s24 offen offset:2048 sc1 lds
    v_mfma_f32_32x32x16_bf16 v[88:103], v[12:15], a[76:79], v[88:103]
    ds_read_b128 v[8:11], v2 offset:16384
    s_waitcnt lgkmcnt(6)
    v_mfma_f32_32x32x16_bf16 v[72:87], v[16:19], a[80:83], v[72:87]
    buffer_load_dwordx4 v1, s[8:11], s24 offen offset:3072 sc1 lds
    v_mfma_f32_32x32x16_bf16 v[88:103], v[16:19], a[84:87], v[88:103]
    ds_read_b128 v[12:15], v2 offset:17408
    s_waitcnt lgkmcnt(6)
    v_mfma_f32_32x32x16_bf16 v[72:87], v[20:23], a[88:91], v[72:87]
    s_add_u32 s24, s24, 4096
    s_add_u32 s25, s25, 4096
    s_mov_b32 m0, s25
    s_nop 0
    buffer_load_dwordx4 v1, s[8:11], s24 offen offset:0 sc1 lds
    v_mfma_f32_32x32x16_bf16 v[88:103], v[20:23], a[92:95], v[88:103]
    ds_read_b128 v[16:19], v2 offset:18432
    s_waitcnt lgkmcnt(6)
    v_mfma_f32_32x32x16_bf16 v[72:87], v[24:27], a[96:99], v[72:87]
    buffer_load_dwordx4 v1, s[8:11], s24 offen offset:1024 sc1 lds
    v_mfma_f32_32x32x16_bf16 v[88:103], v[24:27], a[100:103], v[88:103]
    ds_read_b128 v[20:23], v2 offset:19456
    s_waitcnt lgkmcnt(6)
    v_mfma_f32_32x32x16_bf16 v[72:87], v[28:31], a[104:107], v[72:87]
    v_mfma_f32_32x32x16_bf16 v[88:103], v[28:31], a[108:111], v[88:103]
    ds_read_b128 v[24:27], v2 offset:20480
    s_waitcnt lgkmcnt(6)
    v_mfma_f32_32x32x16_bf16 v[72:87], v[32:35], a[112:115], v[72:87]
    v_mfma_f32_32x32x16_bf16 v[88:103], v[32:35], a[116:119], v[88:103]
    ds_read_b128 v[28:31], v2 offset:21504
    s_waitcnt lgkmcnt(6)
    v_mfma_f32_32x32x16_bf16 v[72:87], v[36:39], a[120:123], v[72:87]
    v_mfma_f32_32x32x16_bf16 v[88:103], v[36:39], a[124:127], v[88:103]
    ds_read_b128 v[32:35], v2 offset:22528
    s_waitcnt lgkmcnt(6)
    v_mfma_f32_32x32x16_bf16 v[72:87], v[8:11], a[128:131], v[72:87]
    v_mfma_f32_32x32x16_bf16 v[88:103], v[8:11], a[132:135], v[88:103]
    ds_read_b128 v[36:39], v2 offset:23552
    s_waitcnt lgkmcnt(6)
    v_mfma_f32_32x32x16_bf16 v[72:87], v[12:15], a[136:139], v[72:87]
    v_mfma_f32_32x32x16_bf16 v[88:103], v[12:15], a[140:143], v[88:103]
    ds_read_b128 v[8:11], v2 offset:24576
    s_waitcnt lgkmcnt(6)
    v_mfma_f32_32x32x16_bf16 v[72:87], v[16:19], a[144:147], v[72:87]
    v_mfma_f32_32x32x16_bf16 v[88:103], v[16:19], a[148:151], v[88:103]
    ds_read_b128 v[12:15], v2 offset:25600
    s_waitcnt lgkmcnt(6)
    v_mfma_f32_32x32x16_bf16 v[72:87], v[20:23], a[152:155], v[72:87]
    v_mfma_f32_32x32x16_bf16 v[88:103], v[20:23], a[156:159], v[88:103]
    ds_read_b128 v[16:19], v2 offset:26624
    s_waitcnt lgkmcnt(6)
    v_mfma_f32_32x32x16_bf16 v[72:87], v[24:27], a[160:163], v[72:87]
    v_mfma_f32_32x32x16_bf16 v[88:103], v[24:27], a[164:167], v[88:103]
    ds_read_b128 v[20:23], v2 offset:27648
    s_waitcnt lgkmcnt(6)
    v_mfma_f32_32x32x16_bf16 v[72:87], v[28:31], a[168:171], v[72:87]
    v_mfma_f32_32x32x16_bf16 v[88:103], v[28:31], a[172:175], v[88:103]
    ds_read_b128 v[24:27], v2 offset:28672
    s_waitcnt lgkmcnt(6)
    v_mfma_f32_32x32x16_bf16 v[72:87], v[32:35], a[176:179], v[72:87]
    v_mfma_f32_32x32x16_bf16 v[88:103], v[32:35], a[180:183], v[88:103]
    ds_read_b128 v[28:31], v2 offset:29696
    s_waitcnt lgkmcnt(6)
    v_mfma_f32_32x32x16_bf16 v[72:87], v[36:39], a[184:187], v[72:87]
    v_mfma_f32_32x32x16_bf16 v[88:103], v[36:39], a[188:191], v[88:103]
    ds_read_b128 v[32:35], v2 offset:30720
    s_waitcnt lgkmcnt(6)
    v_mfma_f32_32x32x16_bf16 v[72:87], v[8:11], a[192:195], v[72:87]
    v_mfma_f32_32x32x16_bf16 v[88:103], v[8:11], a[196:199], v[88:103]
    ds_read_b128 v[36:39], v2 offset:31744
    s_waitcnt lgkmcnt(6)
    v_mfma_f32_32x32x16_bf16 v[72:87], v[12:15], a[200:203], v[72:87]
    v_mfma_f32_32x32x16_bf16 v[88:103], v[12:15], a[204:207], v[88:103]
    ds_read_b128 v[8:11], v2 offset:32768
    s_waitcnt lgkmcnt(6)
    v_mfma_f32_32x32x16_bf16 v[72:87], v[16:19], a[208:211], v[72:87]
    v_mfma_f32_32x32x16_bf16 v[88:103], v[16:19], a[212:215], v[88:103]
    ds_read_b128 v[12:15], v2 offset:33792
    s_waitcnt lgkmcnt(6)
    v_mfma_f32_32x32x16_bf16 v[72:87], v[20:23], a[216:219], v[72:87]
    v_mfma_f32_32x32x16_bf16 v[88:103], v[20:23], a[220:223], v[88:103]
    ds_read_b128 v[16:19], v2 offset:34816
    s_waitcnt lgkmcnt(6)
    v_mfma_f32_32x32x16_bf16 v[72:87], v[24:27], a[224:227], v[72:87]
    v_mfma_f32_32x32x16_bf16 v[88:103], v[24:27], a[228:231], v[88:103]
    s_add_u32 s23, s14, 2
    s_cmp_lg_u32 s13, 0
    s_cbranch_scc1 layerb1_kernel_gu_lw4
    s_min_u32 s28, s23, 63
    s_cmp_gt_u32 s56, s28
    s_cbranch_scc1 layerb1_kernel_gu_lw4
layerb1_kernel_gu_lp4:
    buffer_load_dwordx4 v[124:127], v1, s[8:11], s57 offen sc1
    s_waitcnt vmcnt(0)
    v_min_u32 v124, v124, v125
    v_min_u32 v126, v126, v127
    v_min_u32 v124, v124, v126
    v_cmp_eq_u32 vcc, 0, v124
    s_nop 1
    s_ff1_i32_b64 s56, vcc
    s_min_u32 s56, s56, 64
    s_sub_u32 s58, s58, 1
    s_cbranch_scc1 layerb1_kernel_bail
    s_cmp_gt_u32 s56, s28
    s_cbranch_scc0 layerb1_kernel_gu_lp4
layerb1_kernel_gu_lw4:
    s_waitcnt vmcnt(0)
    s_barrier
    s_add_u32 s21, s16, 40960
    s_cmp_eq_u32 s21, 122880
    s_cselect_b32 s21, 0, s21
    s_add_u32 s23, s14, 2
    s_min_u32 s24, s23, 63
    s_mul_i32 s24, s24, 40960
    s_add_u32 s24, s24, s19
    s_mul_i32 s25, s13, 10240
    s_add_u32 s25, s25, s22
    s_add_u32 s22, s22, 40960
    s_cmp_eq_u32 s22, 122880
    s_cselect_b32 s22, 0, s22
    ds_read_b128 v[20:23], v2 offset:35840
    s_waitcnt lgkmcnt(6)
    v_mfma_f32_32x32x16_bf16 v[72:87], v[28:31], a[232:235], v[72:87]
    s_mov_b32 m0, s25
    s_nop 0
    buffer_load_dwordx4 v1, s[8:11], s24 offen offset:0 sc1 lds
    v_mfma_f32_32x32x16_bf16 v[88:103], v[28:31], a[236:239], v[88:103]
    ds_read_b128 v[24:27], v2 offset:36864
    s_waitcnt lgkmcnt(6)
    v_mfma_f32_32x32x16_bf16 v[72:87], v[32:35], a[240:243], v[72:87]
    buffer_load_dwordx4 v1, s[8:11], s24 offen offset:1024 sc1 lds
    v_mfma_f32_32x32x16_bf16 v[88:103], v[32:35], a[244:247], v[88:103]
    ds_read_b128 v[28:31], v2 offset:37888
    s_waitcnt lgkmcnt(6)
    v_mfma_f32_32x32x16_bf16 v[72:87], v[36:39], a[248:251], v[72:87]
    buffer_load_dwordx4 v1, s[8:11], s24 offen offset:2048 sc1 lds
    v_mfma_f32_32x32x16_bf16 v[88:103], v[36:39], a[252:255], v[88:103]
    ds_read_b128 v[32:35], v2 offset:38912
    s_waitcnt lgkmcnt(6)
    v_mfma_f32_32x32x16_bf16 v[72:87], v[8:11], v[192:195], v[72:87]
    buffer_load_dwordx4 v1, s[8:11], s24 offen offset:3072 sc1 lds
    v_mfma_f32_32x32x16_bf16 v[88:103], v[8:11], v[196:199], v[88:103]
    ds_read_b128 v[36:39], v2 offset:39936
    s_waitcnt lgkmcnt(6)
    v_mfma_f32_32x32x16_bf16 v[72:87], v[12:15], v[200:203], v[72:87]
    s_add_u32 s24, s24, 4096
    s_add_u32 s25, s25, 4096
    s_mov_b32 m0, s25
    s_nop 0
    buffer_load_dwordx4 v1, s[8:11], s24 offen offset:0 sc1 lds
    v_mfma_f32_32x32x16_bf16 v[88:103], v[12:15], v[204:207], v[88:103]
    v_add_u32 v6, s21, v1
    ds_read_b128 v[8:11], v6 offset:0
    s_waitcnt lgkmcnt(6)
    v_mfma_f32_32x32x16_bf16 v[72:87], v[16:19], v[208:211], v[72:87]
    buffer_load_dwordx4 v1, s[8:11], s24 offen offset:1024 sc1 lds
    v_mfma_f32_32x32x16_bf16 v[88:103], v[16:19], v[212:215], v[88:103]
    ds_read_b128 v[12:15], v6 offset:1024
    s_waitcnt lgkmcnt(6)
    v_mfma_f32_32x32x16_bf16 v[72:87], v[20:23], v[216:219], v[72:87]
    buffer_load_dwordx4 v1, s[8:11], s24 offen offset:2048 sc1 lds
    v_mfma_f32_32x32x16_bf16 v[88:103], v[20:23], v[220:223], v[88:103]
    ds_read_b128 v[16:19], v6 offset:2048
    s_waitcnt lgkmcnt(6)
    v_mfma_f32_32x32x16_bf16 v[72:87], v[24:27], v[224:227], v[72:87]
    buffer_load_dwordx4 v1, s[8:11], s24 offen offset:3072 sc1 lds
    v_mfma_f32_32x32x16_bf16 v[88:103], v[24:27], v[228:231], v[88:103]
    ds_read_b128 v[20:23], v6 offset:3072
    s_waitcnt lgkmcnt(6)
    v_mfma_f32_32x32x16_bf16 v[72:87], v[28:31], v[232:235], v[72:87]
    s_add_u32 s24, s24, 4096
    s_add_u32 s25, s25, 4096
    s_mov_b32 m0, s25
    s_nop 0
    buffer_load_dwordx4 v1, s[8:11], s24 offen offset:0 sc1 lds
    v_mfma_f32_32x32x16_bf16 v[88:103], v[28:31], v[236:239], v[88:103]
    ds_read_b128 v[24:27], v6 offset:4096
    s_waitcnt lgkmcnt(6)
    v_mfma_f32_32x32x16_bf16 v[72:87], v[32:35], v[240:243], v[72:87]
    buffer_load_dwordx4 v1, s[8:11], s24 offen offset:1024 sc1 lds
    v_mfma_f32_32x32x16_bf16 v[88:103], v[32:35], v[244:247], v[88:103]
    ds_read_b128 v[28:31], v6 offset:5120
    s_waitcnt lgkmcnt(6)
    v_mfma_f32_32x32x16_bf16 v[72:87], v[36:39], v[248:251], v[72:87]
    v_mfma_f32_32x32x16_bf16 v[88:103], v[36:39], v[252:255], v[88:103]
    v_mov_b32 v2, v6
    s_mov_b32 s16, s21
    s_add_u32 s14, s14, 1
layerb1_kernel_gu_loop:
    ds_read_b128 v[32:35], v2 offset:6144
    s_waitcnt lgkmcnt(6)
    v_mfma_f32_32x32x16_bf16 v[40:55], v[8:11], a[0:3], 0
    v_mfma_f32_32x32x16_bf16 v[56:71], v[8:11], a[4:7], 0
    ds_read_b128 v[36:39], v2 offset:7168
    s_waitcnt lgkmcnt(6)
    v_mfma_f32_32x32x16_bf16 v[40:55], v[12:15], a[8:11], v[40:55]
    v_mfma_f32_32x32x16_bf16 v[56:71], v[12:15], a[12:15], v[56:71]
    ds_read_b128 v[8:11], v2 offset:8192
    s_waitcnt lgkmcnt(6)
    v_mfma_f32_32x32x16_bf16 v[40:55], v[16:19], a[16:19], v[40:55]
    v_cvt_pk_bf16_f32 v104, v72, v73
    v_mfma_f32_32x32x16_bf16 v[56:71], v[16:19], a[20:23], v[56:71]
    v_cvt_pk_bf16_f32 v105, v74, v75
    ds_read_b128 v[12:15], v2 offset:9216
    s_waitcnt lgkmcnt(6)
    v_mfma_f32_32x32x16_bf16 v[40:55], v[20:23], a[24:27], v[40:55]
    v_cvt_pk_bf16_f32 v106, v76, v77
    v_mfma_f32_32x32x16_bf16 v[56:71], v[20:23], a[28:31], v[56:71]
    v_cvt_pk_bf16_f32 v107, v78, v79
    ds_read_b128 v[16:19], v2 offset:10240
    s_waitcnt lgkmcnt(6)
    v_mfma_f32_32x32x16_bf16 v[40:55], v[24:27], a[32:35], v[40:55]
    s_nop 1
    v_mfma_f32_32x32x16_bf16 v[56:71], v[24:27], a[36:39], v[56:71]
    v_permlane32_swap_b32 v104, v106
    ds_read_b128 v[20:23], v2 offset:11264
    s_waitcnt lgkmcnt(6)
    v_mfma_f32_32x32x16_bf16 v[40:55], v[28:31], a[40:43], v[40:55]
    v_permlane32_swap_b32 v105, v107
    v_mfma_f32_32x32x16_bf16 v[56:71], v[28:31], a[44:47], v[56:71]
    buffer_store_dwordx4 v[104:107], v3, s[8:11], s17 offen offset:0 sc1
    ds_read_b128 v[24:27], v2 offset:12288
    s_waitcnt lgkmcnt(6)
    v_mfma_f32_32x32x16_bf16 v[40:55], v[32:35], a[48:51], v[40:55]
    v_cvt_pk_bf16_f32 v108, v80, v81
    v_mfma_f32_32x32x16_bf16 v[56:71], v[32:35], a[52:55], v[56:71]
    v_cvt_pk_bf16_f32 v109, v82, v83
    ds_read_b128 v[28:31], v2 offset:13312
    s_waitcnt lgkmcnt(6)
    v_mfma_f32_32x32x16_bf16 v[40:55], v[36:39], a[56:59], v[40:55]
    v_cvt_pk_bf16_f32 v110, v84, v85
    v_mfma_f32_32x32x16_bf16 v[56:71], v[36:39], a[60:63], v[56:71]
    v_cvt_pk_bf16_f32 v111, v86, v87
    ds_read_b128 v[32:35], v2 offset:14336
    s_waitcnt lgkmcnt(6)
    v_mfma_f32_32x32x16_bf16 v[40:55], v[8:11], a[64:67], v[40:55]
    s_nop 1
    v_mfma_f32_32x32x16_bf16 v[56:71], v[8:11], a[68:71], v[56:71]
    v_permlane32_swap_b32 v108, v110
    ds_read_b128 v[36:39], v2 offset:15360
    s_waitcnt lgkmcnt(6)
    v_mfma_f32_32x32x16_bf16 v[40:55], v[12:15], a[72:75], v[40:55]
    v_permlane32_swap_b32 v109, v111
    v_mfma_f32_32x32x16_bf16 v[56:71], v[12:15], a[76:79], v[56:71]
    buffer_store_dwordx4 v[108:111], v3, s[8:11], s17 offen offset:256 sc1
    ds_read_b128 v[8:11], v2 offset:16384
    s_waitcnt lgkmcnt(6)
    v_mfma_f32_32x32x16_bf16 v[40:55], v[16:19], a[80:83], v[40:55]
    v_cvt_pk_bf16_f32 v112, v88, v89
    v_mfma_f32_32x32x16_bf16 v[56:71], v[16:19], a[84:87], v[56:71]
    v_cvt_pk_bf16_f32 v113, v90, v91
    ds_read_b128 v[12:15], v2 offset:17408
    s_waitcnt lgkmcnt(6)
    v_mfma_f32_32x32x16_bf16 v[40:55], v[20:23], a[88:91], v[40:55]
    v_cvt_pk_bf16_f32 v114, v92, v93
    v_mfma_f32_32x32x16_bf16 v[56:71], v[20:23], a[92:95], v[56:71]
    v_cvt_pk_bf16_f32 v115, v94, v95
    ds_read_b128 v[16:19], v2 offset:18432
    s_waitcnt lgkmcnt(6)
    v_mfma_f32_32x32x16_bf16 v[40:55], v[24:27], a[96:99], v[40:55]
    s_nop 1
    v_mfma_f32_32x32x16_bf16 v[56:71], v[24:27], a[100:103], v[56:71]
    v_permlane32_swap_b32 v112, v114
    ds_read_b128 v[20:23], v2 offset:19456
    s_waitcnt lgkmcnt(6)
    v_mfma_f32_32x32x16_bf16 v[40:55], v[28:31], a[104:107], v[40:55]
    v_permlane32_swap_b32 v113, v115
    v_mfma_f32_32x32x16_bf16 v[56:71], v[28:31], a[108:111], v[56:71]
    buffer_store_dwordx4 v[112:115], v3, s[8:11], s17 offen offset:2560 sc1
    ds_read_b128 v[24:27], v2 offset:20480
    s_waitcnt lgkmcnt(6)
    v_mfma_f32_32x32x16_bf16 v[40:55], v[32:35], a[112:115], v[40:55]
    v_cvt_pk_bf16_f32 v116, v96, v97
    v_mfma_f32_32x32x16_bf16 v[56:71], v[32:35], a[116:119], v[56:71]
    v_cvt_pk_bf16_f32 v117, v98, v99
    ds_read_b128 v[28:31], v2 offset:21504
    s_waitcnt lgkmcnt(6)
    v_mfma_f32_32x32x16_bf16 v[40:55], v[36:39], a[120:123], v[40:55]
    v_cvt_pk_bf16_f32 v118, v100, v101
    v_mfma_f32_32x32x16_bf16 v[56:71], v[36:39], a[124:127], v[56:71]
    v_cvt_pk_bf16_f32 v119, v102, v103
    ds_read_b128 v[32:35], v2 offset:22528
    s_waitcnt lgkmcnt(6)
    v_mfma_f32_32x32x16_bf16 v[40:55], v[8:11], a[128:131], v[40:55]
    s_nop 1
    v_mfma_f32_32x32x16_bf16 v[56:71], v[8:11], a[132:135], v[56:71]
    v_permlane32_swap_b32 v116, v118
    ds_read_b128 v[36:39], v2 offset:23552
    s_waitcnt lgkmcnt(6)
    v_mfma_f32_32x32x16_bf16 v[40:55], v[12:15], a[136:139], v[40:55]
    v_permlane32_swap_b32 v117, v119
    v_mfma_f32_32x32x16_bf16 v[56:71], v[12:15], a[140:143], v[56:71]
    buffer_store_dwordx4 v[116:119], v3, s[8:11], s17 offen offset:2816 sc1
    ds_read_b128 v[8:11], v2 offset:24576
    s_waitcnt lgkmcnt(6)
    v_mfma_f32_32x32x16_bf16 v[40:55], v[16:19], a[144:147], v[40:55]
    s_add_u32 s17, s17, s20
    v_mfma_f32_32x32x16_bf16 v[56:71], v[16:19], a[148:151], v[56:71]
    s_add_u32 s18, s18, s20
    ds_read_b128 v[12:15], v2 offset:25600
    s_waitcnt lgkmcnt(6)
    v_mfma_f32_32x32x16_bf16 v[40:55], v[20:23], a[152:155], v[40:55]
    v_mfma_f32_32x32x16_bf16 v[56:71], v[20:23], a[156:159], v[56:71]
    ds_read_b128 v[16:19], v2 offset:26624
    s_waitcnt lgkmcnt(6)
    v_mfma_f32_32x32x16_bf16 v[40:55], v[24:27], a[160:163], v[40:55]
    v_mfma_f32_32x32x16_bf16 v[56:71], v[24:27], a[164:167], v[56:71]
    ds_read_b128 v[20:23], v2 offset:27648
    s_waitcnt lgkmcnt(6)
    v_mfma_f32_32x32x16_bf16 v[40:55], v[28:31], a[168:171], v[40:55]
    v_mfma_f32_32x32x16_bf16 v[56:71], v[28:31], a[172:175], v[56:71]
    ds_read_b128 v[24:27], v2 offset:28672
    s_waitcnt lgkmcnt(6)
    v_mfma_f32_32x32x16_bf16 v[40:55], v[32:35], a[176:179], v[40:55]
    v_mfma_f32_32x32x16_bf16 v[56:71], v[32:35], a[180:183], v[56:71]
    ds_read_b128 v[28:31], v2 offset:29696
    s_waitcnt lgkmcnt(6)
    v_mfma_f32_32x32x16_bf16 v[40:55], v[36:39], a[184:187], v[40:55]
    v_mfma_f32_32x32x16_bf16 v[56:71], v[36:39], a[188:191], v[56:71]
    ds_read_b128 v[32:35], v2 offset:30720
    s_waitcnt lgkmcnt(6)
    v_mfma_f32_32x32x16_bf16 v[40:55], v[8:11], a[192:195], v[40:55]
    v_mfma_f32_32x32x16_bf16 v[56:71], v[8:11], a[196:199], v[56:71]
    ds_read_b128 v[36:39], v2 offset:31744
    s_waitcnt lgkmcnt(6)
    v_mfma_f32_32x32x16_bf16 v[40:55], v[12:15], a[200:203], v[40:55]
    v_mfma_f32_32x32x16_bf16 v[56:71], v[12:15], a[204:207], v[56:71]
    ds_read_b128 v[8:11], v2 offset:32768
    s_waitcnt lgkmcnt(6)
    v_mfma_f32_32x32x16_bf16 v[40:55], v[16:19], a[208:211], v[40:55]
    v_mfma_f32_32x32x16_bf16 v[56:71], v[16:19], a[212:215], v[56:71]
    ds_read_b128 v[12:15], v2 offset:33792
    s_waitcnt lgkmcnt(6)
    v_mfma_f32_32x32x16_bf16 v[40:55], v[20:23], a[216:219], v[40:55]
    v_mfma_f32_32x32x16_bf16 v[56:71], v[20:23], a[220:223], v[56:71]
    ds_read_b128 v[16:19], v2 offset:34816
    s_waitcnt lgkmcnt(6)
    v_mfma_f32_32x32x16_bf16 v[40:55], v[24:27], a[224:227], v[40:55]
    v_mfma_f32_32x32x16_bf16 v[56:71], v[24:27], a[228:231], v[56:71]
    s_add_u32 s23, s14, 2
    s_cmp_lg_u32 s13, 0
    s_cbranch_scc1 layerb1_kernel_gu_lw5
    s_min_u32 s28, s23, 63
    s_cmp_gt_u32 s56, s28
    s_cbranch_scc1 layerb1_kernel_gu_lw5
layerb1_kernel_gu_lp5:
    buffer_load_dwordx4 v[124:127], v1, s[8:11], s57 offen sc1
    s_waitcnt vmcnt(0)
    v_min_u32 v124, v124, v125
    v_min_u32 v126, v126, v127
    v_min_u32 v124, v124, v126
    v_cmp_eq_u32 vcc, 0, v124
    s_nop 1
    s_ff1_i32_b64 s56, vcc
    s_min_u32 s56, s56, 64
    s_sub_u32 s58, s58, 1
    s_cbranch_scc1 layerb1_kernel_bail
    s_cmp_gt_u32 s56, s28
    s_cbranch_scc0 layerb1_kernel_gu_lp5
layerb1_kernel_gu_lw5:
    s_cmp_gt_u32 s14, 5
    s_cbranch_scc1 layerb1_kernel_gu_dr6
    s_waitcnt vmcnt(0)
    s_mov_b32 s27, s14
    s_branch layerb1_kernel_gu_dq6
layerb1_kernel_gu_dr6:
    s_waitcnt vmcnt(4)
    s_sub_u32 s27, s14, 1
layerb1_kernel_gu_dq6:
    s_barrier
    s_cmp_lg_u32 s13, 0
    s_cbranch_scc1 layerb1_kernel_gu_fl7
    s_mov_b64 exec, 1
    s_lshl_b32 s26, s12, 7
    v_mov_b32 v7, s26
    v_mov_b32 v120, s27
    buffer_store_dword v120, v7, s[8:11], s48 offen sc1
    s_mov_b64 exec, -1
layerb1_kernel_gu_fl7:
    s_add_u32 s21, s16, 40960
    s_cmp_eq_u32 s21, 122880
    s_cselect_b32 s21, 0, s21
    s_add_u32 s23, s14, 2
    s_min_u32 s24, s23, 63
    s_mul_i32 s24, s24, 40960
    s_add_u32 s24, s24, s19
    s_mul_i32 s25, s13, 10240
    s_add_u32 s25, s25, s22
    s_add_u32 s22, s22, 40960
    s_cmp_eq_u32 s22, 122880
    s_cselect_b32 s22, 0, s22
    ds_read_b128 v[20:23], v2 offset:35840
    s_waitcnt lgkmcnt(6)
    v_mfma_f32_32x32x16_bf16 v[40:55], v[28:31], a[232:235], v[40:55]
    s_mov_b32 m0, s25
    s_nop 0
    buffer_load_dwordx4 v1, s[8:11], s24 offen offset:0 sc1 lds
    v_mfma_f32_32x32x16_bf16 v[56:71], v[28:31], a[236:239], v[56:71]
    ds_read_b128 v[24:27], v2 offset:36864
    s_waitcnt lgkmcnt(6)
    v_mfma_f32_32x32x16_bf16 v[40:55], v[32:35], a[240:243], v[40:55]
    buffer_load_dwordx4 v1, s[8:11], s24 offen offset:1024 sc1 lds
    v_mfma_f32_32x32x16_bf16 v[56:71], v[32:35], a[244:247], v[56:71]
    ds_read_b128 v[28:31], v2 offset:37888
    s_waitcnt lgkmcnt(6)
    v_mfma_f32_32x32x16_bf16 v[40:55], v[36:39], a[248:251], v[40:55]
    buffer_load_dwordx4 v1, s[8:11], s24 offen offset:2048 sc1 lds
    v_mfma_f32_32x32x16_bf16 v[56:71], v[36:39], a[252:255], v[56:71]
    ds_read_b128 v[32:35], v2 offset:38912
    s_waitcnt lgkmcnt(6)
    v_mfma_f32_32x32x16_bf16 v[40:55], v[8:11], v[192:195], v[40:55]
    buffer_load_dwordx4 v1, s[8:11], s24 offen offset:3072 sc1 lds
    v_mfma_f32_32x32x16_bf16 v[56:71], v[8:11], v[196:199], v[56:71]
    ds_read_b128 v[36:39], v2 offset:39936
    s_waitcnt lgkmcnt(6)
    v_mfma_f32_32x32x16_bf16 v[40:55], v[12:15], v[200:203], v[40:55]
    s_add_u32 s24, s24, 4096
    s_add_u32 s25, s25, 4096
    s_mov_b32 m0, s25
    s_nop 0
    buffer_load_dwordx4 v1, s[8:11], s24 offen offset:0 sc1 lds
    v_mfma_f32_32x32x16_bf16 v[56:71], v[12:15], v[204:207], v[56:71]
    v_add_u32 v6, s21, v1
    ds_read_b128 v[8:11], v6 offset:0
    s_waitcnt lgkmcnt(6)
    v_mfma_f32_32x32x16_bf16 v[40:55], v[16:19], v[208:211], v[40:55]
    buffer_load_dwordx4 v1, s[8:11], s24 offen offset:1024 sc1 lds
    v_mfma_f32_32x32x16_bf16 v[56:71], v[16:19], v[212:215], v[56:71]
    ds_read_b128 v[12:15], v6 offset:1024
    s_waitcnt lgkmcnt(6)
    v_mfma_f32_32x32x16_bf16 v[40:55], v[20:23], v[216:219], v[40:55]
    buffer_load_dwordx4 v1, s[8:11], s24 offen offset:2048 sc1 lds
    v_mfma_f32_32x32x16_bf16 v[56:71], v[20:23], v[220:223], v[56:71]
    ds_read_b128 v[16:19], v6 offset:2048
    s_waitcnt lgkmcnt(6)
    v_mfma_f32_32x32x16_bf16 v[40:55], v[24:27], v[224:227], v[40:55]
    buffer_load_dwordx4 v1, s[8:11], s24 offen offset:3072 sc1 lds
    v_mfma_f32_32x32x16_bf16 v[56:71], v[24:27], v[228:231], v[56:71]
    ds_read_b128 v[20:23], v6 offset:3072
    s_waitcnt lgkmcnt(6)
    v_mfma_f32_32x32x16_bf16 v[40:55], v[28:31], v[232:235], v[40:55]
    s_add_u32 s24, s24, 4096
    s_add_u32 s25, s25, 4096
    s_mov_b32 m0, s25
    s_nop 0
    buffer_load_dwordx4 v1, s[8:11], s24 offen offset:0 sc1 lds
    v_mfma_f32_32x32x16_bf16 v[56:71], v[28:31], v[236:239], v[56:71]
    ds_read_b128 v[24:27], v6 offset:4096
    s_waitcnt lgkmcnt(6)
    v_mfma_f32_32x32x16_bf16 v[40:55], v[32:35], v[240:243], v[40:55]
    buffer_load_dwordx4 v1, s[8:11], s24 offen offset:1024 sc1 lds
    v_mfma_f32_32x32x16_bf16 v[56:71], v[32:35], v[244:247], v[56:71]
    ds_read_b128 v[28:31], v6 offset:5120
    s_waitcnt lgkmcnt(6)
    v_mfma_f32_32x32x16_bf16 v[40:55], v[36:39], v[248:251], v[40:55]
    v_mfma_f32_32x32x16_bf16 v[56:71], v[36:39], v[252:255], v[56:71]
    v_mov_b32 v2, v6
    s_mov_b32 s16, s21
    s_add_u32 s14, s14, 1
    s_cmp_ge_u32 s14, s15
    s_cbranch_scc1 layerb1_kernel_gu_fin0
    ds_read_b128 v[32:35], v2 offset:6144
    s_waitcnt lgkmcnt(6)
    v_mfma_f32_32x32x16_bf16 v[72:87], v[8:11], a[0:3], 0
    v_mfma_f32_32x32x16_bf16 v[88:103], v[8:11], a[4:7], 0
    ds_read_b128 v[36:39], v2 offset:7168
    s_waitcnt lgkmcnt(6)
    v_mfma_f32_32x32x16_bf16 v[72:87], v[12:15], a[8:11], v[72:87]
    v_mfma_f32_32x32x16_bf16 v[88:103], v[12:15], a[12:15], v[88:103]
    ds_read_b128 v[8:11], v2 offset:8192
    s_waitcnt lgkmcnt(6)
    v_mfma_f32_32x32x16_bf16 v[72:87], v[16:19], a[16:19], v[72:87]
    v_cvt_pk_bf16_f32 v104, v40, v41
    v_mfma_f32_32x32x16_bf16 v[88:103], v[16:19], a[20:23], v[88:103]
    v_cvt_pk_bf16_f32 v105, v42, v43
    ds_read_b128 v[12:15], v2 offset:9216
    s_waitcnt lgkmcnt(6)
    v_mfma_f32_32x32x16_bf16 v[72:87], v[20:23], a[24:27], v[72:87]
    v_cvt_pk_bf16_f32 v106, v44, v45
    v_mfma_f32_32x32x16_bf16 v[88:103], v[20:23], a[28:31], v[88:103]
    v_cvt_pk_bf16_f32 v107, v46, v47
    ds_read_b128 v[16:19], v2 offset:10240
    s_waitcnt lgkmcnt(6)
    v_mfma_f32_32x32x16_bf16 v[72:87], v[24:27], a[32:35], v[72:87]
    s_nop 1
    v_mfma_f32_32x32x16_bf16 v[88:103], v[24:27], a[36:39], v[88:103]
    v_permlane32_swap_b32 v104, v106
    ds_read_b128 v[20:23], v2 offset:11264
    s_waitcnt lgkmcnt(6)
    v_mfma_f32_32x32x16_bf16 v[72:87], v[28:31], a[40:43], v[72:87]
    v_permlane32_swap_b32 v105, v107
    v_mfma_f32_32x32x16_bf16 v[88:103], v[28:31], a[44:47], v[88:103]
    buffer_store_dwordx4 v[104:107], v3, s[8:11], s17 offen offset:0 sc1
    ds_read_b128 v[24:27], v2 offset:12288
    s_waitcnt lgkmcnt(6)
    v_mfma_f32_32x32x16_bf16 v[72:87], v[32:35], a[48:51], v[72:87]
    v_cvt_pk_bf16_f32 v108, v48, v49
    v_mfma_f32_32x32x16_bf16 v[88:103], v[32:35], a[52:55], v[88:103]
    v_cvt_pk_bf16_f32 v109, v50, v51
    ds_read_b128 v[28:31], v2 offset:13312
    s_waitcnt lgkmcnt(6)
    v_mfma_f32_32x32x16_bf16 v[72:87], v[36:39], a[56:59], v[72:87]
    v_cvt_pk_bf16_f32 v110, v52, v53
    v_mfma_f32_32x32x16_bf16 v[88:103], v[36:39], a[60:63], v[88:103]
    v_cvt_pk_bf16_f32 v111, v54, v55
    ds_read_b128 v[32:35], v2 offset:14336
    s_waitcnt lgkmcnt(6)
    v_mfma_f32_32x32x16_bf16 v[72:87], v[8:11], a[64:67], v[72:87]
    s_nop 1
    v_mfma_f32_32x32x16_bf16 v[88:103], v[8:11], a[68:71], v[88:103]
    v_permlane32_swap_b32 v108, v110
    ds_read_b128 v[36:39], v2 offset:15360
    s_waitcnt lgkmcnt(6)
    v_mfma_f32_32x32x16_bf16 v[72:87], v[12:15], a[72:75], v[72:87]
    v_permlane32_swap_b32 v109, v111
    v_mfma_f32_32x32x16_bf16 v[88:103], v[12:15], a[76:79], v[88:103]
    buffer_store_dwordx4 v[108:111], v3, s[8:11], s17 offen offset:256 sc1
    ds_read_b128 v[8:11], v2 offset:16384
    s_waitcnt lgkmcnt(6)
    v_mfma_f32_32x32x16_bf16 v[72:87], v[16:19], a[80:83], v[72:87]
    v_cvt_pk_bf16_f32 v112, v56, v57
    v_mfma_f32_32x32x16_bf16 v[88:103], v[16:19], a[84:87], v[88:103]
    v_cvt_pk_bf16_f32 v113, v58, v59
    ds_read_b128 v[12:15], v2 offset:17408
    s_waitcnt lgkmcnt(6)
    v_mfma_f32_32x32x16_bf16 v[72:87], v[20:23], a[88:91], v[72:87]
    v_cvt_pk_bf16_f32 v114, v60, v61
    v_mfma_f32_32x32x16_bf16 v[88:103], v[20:23], a[92:95], v[88:103]
    v_cvt_pk_bf16_f32 v115, v62, v63
    ds_read_b128 v[16:19], v2 offset:18432
    s_waitcnt lgkmcnt(6)
    v_mfma_f32_32x32x16_bf16 v[72:87], v[24:27], a[96:99], v[72:87]
    s_nop 1
    v_mfma_f32_32x32x16_bf16 v[88:103], v[24:27], a[100:103], v[88:103]
    v_permlane32_swap_b32 v112, v114
    ds_read_b128 v[20:23], v2 offset:19456
    s_waitcnt lgkmcnt(6)
    v_mfma_f32_32x32x16_bf16 v[72:87], v[28:31], a[104:107], v[72:87]
    v_permlane32_swap_b32 v113, v115
    v_mfma_f32_32x32x16_bf16 v[88:103], v[28:31], a[108:111], v[88:103]
    buffer_store_dwordx4 v[112:115], v3, s[8:11], s17 offen offset:2560 sc1
    ds_read_b128 v[24:27], v2 offset:20480
    s_waitcnt lgkmcnt(6)
    v_mfma_f32_32x32x16_bf16 v[72:87], v[32:35], a[112:115], v[72:87]
    v_cvt_pk_bf16_f32 v116, v64, v65
    v_mfma_f32_32x32x16_bf16 v[88:103], v[32:35], a[116:119], v[88:103]
    v_cvt_pk_bf16_f32 v117, v66, v67
    ds_read_b128 v[28:31], v2 offset:21504
    s_waitcnt lgkmcnt(6)
    v_mfma_f32_32x32x16_bf16 v[72:87], v[36:39], a[120:123], v[72:87]
    v_cvt_pk_bf16_f32 v118, v68, v69
    v_mfma_f32_32x32x16_bf16 v[88:103], v[36:39], a[124:127], v[88:103]
    v_cvt_pk_bf16_f32 v119, v70, v71
    ds_read_b128 v[32:35], v2 offset:22528
    s_waitcnt lgkmcnt(6)
    v_mfma_f32_32x32x16_bf16 v[72:87], v[8:11], a[128:131], v[72:87]
    s_nop 1
    v_mfma_f32_32x32x16_bf16 v[88:103], v[8:11], a[132:135], v[88:103]
    v_permlane32_swap_b32 v116, v118
    ds_read_b128 v[36:39], v2 offset:23552
    s_waitcnt lgkmcnt(6)
    v_mfma_f32_32x32x16_bf16 v[72:87], v[12:15], a[136:139], v[72:87]
    v_permlane32_swap_b32 v117, v119
    v_mfma_f32_32x32x16_bf16 v[88:103], v[12:15], a[140:143], v[88:103]
    buffer_store_dwordx4 v[116:119], v3, s[8:11], s17 offen offset:2816 sc1
    ds_read_b128 v[8:11], v2 offset:24576
    s_waitcnt lgkmcnt(6)
    v_mfma_f32_32x32x16_bf16 v[72:87], v[16:19], a[144:147], v[72:87]
    s_add_u32 s17, s17, s20
    v_mfma_f32_32x32x16_bf16 v[88:103], v[16:19], a[148:151], v[88:103]
    s_add_u32 s18, s18, s20
    ds_read_b128 v[12:15], v2 offset:25600
    s_waitcnt lgkmcnt(6)
    v_mfma_f32_32x32x16_bf16 v[72:87], v[20:23], a[152:155], v[72:87]
    v_mfma_f32_32x32x16_bf16 v[88:103], v[20:23], a[156:159], v[88:103]
    ds_read_b128 v[16:19], v2 offset:26624
    s_waitcnt lgkmcnt(6)
    v_mfma_f32_32x32x16_bf16 v[72:87], v[24:27], a[160:163], v[72:87]
    v_mfma_f32_32x32x16_bf16 v[88:103], v[24:27], a[164:167], v[88:103]
    ds_read_b128 v[20:23], v2 offset:27648
    s_waitcnt lgkmcnt(6)
    v_mfma_f32_32x32x16_bf16 v[72:87], v[28:31], a[168:171], v[72:87]
    v_mfma_f32_32x32x16_bf16 v[88:103], v[28:31], a[172:175], v[88:103]
    ds_read_b128 v[24:27], v2 offset:28672
    s_waitcnt lgkmcnt(6)
    v_mfma_f32_32x32x16_bf16 v[72:87], v[32:35], a[176:179], v[72:87]
    v_mfma_f32_32x32x16_bf16 v[88:103], v[32:35], a[180:183], v[88:103]
    ds_read_b128 v[28:31], v2 offset:29696
    s_waitcnt lgkmcnt(6)
    v_mfma_f32_32x32x16_bf16 v[72:87], v[36:39], a[184:187], v[72:87]
    v_mfma_f32_32x32x16_bf16 v[88:103], v[36:39], a[188:191], v[88:103]
    ds_read_b128 v[32:35], v2 offset:30720
    s_waitcnt lgkmcnt(6)
    v_mfma_f32_32x32x16_bf16 v[72:87], v[8:11], a[192:195], v[72:87]
    v_mfma_f32_32x32x16_bf16 v[88:103], v[8:11], a[196:199], v[88:103]
    ds_read_b128 v[36:39], v2 offset:31744
    s_waitcnt lgkmcnt(6)
    v_mfma_f32_32x32x16_bf16 v[72:87], v[12:15], a[200:203], v[72:87]
    v_mfma_f32_32x32x16_bf16 v[88:103], v[12:15], a[204:207], v[88:103]
    ds_read_b128 v[8:11], v2 offset:32768
    s_waitcnt lgkmcnt(6)
    v_mfma_f32_32x32x16_bf16 v[72:87], v[16:19], a[208:211], v[72:87]
    v_mfma_f32_32x32x16_bf16 v[88:103], v[16:19], a[212:215], v[88:103]
    ds_read_b128 v[12:15], v2 offset:33792
    s_waitcnt lgkmcnt(6)
    v_mfma_f32_32x32x16_bf16 v[72:87], v[20:23], a[216:219], v[72:87]
    v_mfma_f32_32x32x16_bf16 v[88:103], v[20:23], a[220:223], v[88:103]
    ds_read_b128 v[16:19], v2 offset:34816
    s_waitcnt lgkmcnt(6)
    v_mfma_f32_32x32x16_bf16 v[72:87], v[24:27], a[224:227], v[72:87]
    v_mfma_f32_32x32x16_bf16 v[88:103], v[24:27], a[228:231], v[88:103]
    s_add_u32 s23, s14, 2
    s_cmp_lg_u32 s13, 0
    s_cbranch_scc1 layerb1_kernel_gu_lw8
    s_min_u32 s28, s23, 63
    s_cmp_gt_u32 s56, s28
    s_cbranch_scc1 layerb1_kernel_gu_lw8
layerb1_kernel_gu_lp8:
    buffer_load_dwordx4 v[124:127], v1, s[8:11], s57 offen sc1
    s_waitcnt vmcnt(0)
    v_min_u32 v124, v124, v125
    v_min_u32 v126, v126, v127
    v_min_u32 v124, v124, v126
    v_cmp_eq_u32 vcc, 0, v124
    s_nop 1
    s_ff1_i32_b64 s56, vcc
    s_min_u32 s56, s56, 64
    s_sub_u32 s58, s58, 1
    s_cbranch_scc1 layerb1_kernel_bail
    s_cmp_gt_u32 s56, s28
    s_cbranch_scc0 layerb1_kernel_gu_lp8
layerb1_kernel_gu_lw8:
    s_cmp_gt_u32 s14, 5
    s_cbranch_scc1 layerb1_kernel_gu_dr9
    s_waitcnt vmcnt(0)
    s_mov_b32 s27, s14
    s_branch layerb1_kernel_gu_dq9
layerb1_kernel_gu_dr9:
    s_waitcnt vmcnt(4)
    s_sub_u32 s27, s14, 1
layerb1_kernel_gu_dq9:
    s_barrier
    s_cmp_lg_u32 s13, 0
    s_cbranch_scc1 layerb1_kernel_gu_fl10
    s_mov_b64 exec, 1
    s_lshl_b32 s26, s12, 7
    v_mov_b32 v7, s26
    v_mov_b32 v120, s27
    buffer_store_dword v120, v7, s[8:11], s48 offen sc1
    s_mov_b64 exec, -1
layerb1_kernel_gu_fl10:
    s_add_u32 s21, s16, 40960
    s_cmp_eq_u32 s21, 122880
    s_cselect_b32 s21, 0, s21
    s_add_u32 s23, s14, 2
    s_min_u32 s24, s23, 63
    s_mul_i32 s24, s24, 40960
    s_add_u32 s24, s24, s19
    s_mul_i32 s25, s13, 10240
    s_add_u32 s25, s25, s22
    s_add_u32 s22, s22, 40960
    s_cmp_eq_u32 s22, 122880
    s_cselect_b32 s22, 0, s22
    ds_read_b128 v[20:23], v2 offset:35840
    s_waitcnt lgkmcnt(6)
    v_mfma_f32_32x32x16_bf16 v[72:87], v[28:31], a[232:235], v[72:87]
    s_mov_b32 m0, s25
    s_nop 0
    buffer_load_dwordx4 v1, s[8:11], s24 offen offset:0 sc1 lds
    v_mfma_f32_32x32x16_bf16 v[88:103], v[28:31], a[236:239], v[88:103]
    ds_read_b128 v[24:27], v2 offset:36864
    s_waitcnt lgkmcnt(6)
    v_mfma_f32_32x32x16_bf16 v[72:87], v[32:35], a[240:243], v[72:87]
    buffer_load_dwordx4 v1, s[8:11], s24 offen offset:1024 sc1 lds
    v_mfma_f32_32x32x16_bf16 v[88:103], v[32:35], a[244:247], v[88:103]
    ds_read_b128 v[28:31], v2 offset:37888
    s_waitcnt lgkmcnt(6)
    v_mfma_f32_32x32x16_bf16 v[72:87], v[36:39], a[248:251], v[72:87]
    buffer_load_dwordx4 v1, s[8:11], s24 offen offset:2048 sc1 lds
    v_mfma_f32_32x32x16_bf16 v[88:103], v[36:39], a[252:255], v[88:103]
    ds_read_b128 v[32:35], v2 offset:38912
    s_waitcnt lgkmcnt(6)
    v_mfma_f32_32x32x16_bf16 v[72:87], v[8:11], v[192:195], v[72:87]
    buffer_load_dwordx4 v1, s[8:11], s24 offen offset:3072 sc1 lds
    v_mfma_f32_32x32x16_bf16 v[88:103], v[8:11], v[196:199], v[88:103]
    ds_read_b128 v[36:39], v2 offset:39936
    s_waitcnt lgkmcnt(6)
    v_mfma_f32_32x32x16_bf16 v[72:87], v[12:15], v[200:203], v[72:87]
    s_add_u32 s24, s24, 4096
    s_add_u32 s25, s25, 4096
    s_mov_b32 m0, s25
    s_nop 0
    buffer_load_dwordx4 v1, s[8:11], s24 offen offset:0 sc1 lds
    v_mfma_f32_32x32x16_bf16 v[88:103], v[12:15], v[204:207], v[88:103]
    v_add_u32 v6, s21, v1
    ds_read_b128 v[8:11], v6 offset:0
    s_waitcnt lgkmcnt(6)
    v_mfma_f32_32x32x16_bf16 v[72:87], v[16:19], v[208:211], v[72:87]
    buffer_load_dwordx4 v1, s[8:11], s24 offen offset:1024 sc1 lds
    v_mfma_f32_32x32x16_bf16 v[88:103], v[16:19], v[212:215], v[88:103]
    ds_read_b128 v[12:15], v6 offset:1024
    s_waitcnt lgkmcnt(6)
    v_mfma_f32_32x32x16_bf16 v[72:87], v[20:23], v[216:219], v[72:87]
    buffer_load_dwordx4 v1, s[8:11], s24 offen offset:2048 sc1 lds
    v_mfma_f32_32x32x16_bf16 v[88:103], v[20:23], v[220:223], v[88:103]
    ds_read_b128 v[16:19], v6 offset:2048
    s_waitcnt lgkmcnt(6)
    v_mfma_f32_32x32x16_bf16 v[72:87], v[24:27], v[224:227], v[72:87]
    buffer_load_dwordx4 v1, s[8:11], s24 offen offset:3072 sc1 lds
    v_mfma_f32_32x32x16_bf16 v[88:103], v[24:27], v[228:231], v[88:103]
    ds_read_b128 v[20:23], v6 offset:3072
    s_waitcnt lgkmcnt(6)
    v_mfma_f32_32x32x16_bf16 v[72:87], v[28:31], v[232:235], v[72:87]
    s_add_u32 s24, s24, 4096
    s_add_u32 s25, s25, 4096
    s_mov_b32 m0, s25
    s_nop 0
    buffer_load_dwordx4 v1, s[8:11], s24 offen offset:0 sc1 lds
    v_mfma_f32_32x32x16_bf16 v[88:103], v[28:31], v[236:239], v[88:103]
    ds_read_b128 v[24:27], v6 offset:4096
    s_waitcnt lgkmcnt(6)
    v_mfma_f32_32x32x16_bf16 v[72:87], v[32:35], v[240:243], v[72:87]
    buffer_load_dwordx4 v1, s[8:11], s24 offen offset:1024 sc1 lds
    v_mfma_f32_32x32x16_bf16 v[88:103], v[32:35], v[244:247], v[88:103]
    ds_read_b128 v[28:31], v6 offset:5120
    s_waitcnt lgkmcnt(6)
    v_mfma_f32_32x32x16_bf16 v[72:87], v[36:39], v[248:251], v[72:87]
    v_mfma_f32_32x32x16_bf16 v[88:103], v[36:39], v[252:255], v[88:103]
    v_mov_b32 v2, v6
    s_mov_b32 s16, s21
    s_add_u32 s14, s14, 1
    s_cmp_lt_u32 s14, s15
    s_cbranch_scc1 layerb1_kernel_gu_loop
    s_branch layerb1_kernel_gu_fin1
layerb1_kernel_gu_fin0:
    s_nop 7
    s_nop 7
    v_cvt_pk_bf16_f32 v104, v40, v41
    v_cvt_pk_bf16_f32 v105, v42, v43
    v_cvt_pk_bf16_f32 v106, v44, v45
    v_cvt_pk_bf16_f32 v107, v46, v47
    s_nop 1
    v_permlane32_swap_b32 v104, v106
    v_permlane32_swap_b32 v105, v107
    buffer_store_dwordx4 v[104:107], v3, s[8:11], s17 offen offset:0 sc1
    v_cvt_pk_bf16_f32 v108, v48, v49
    v_cvt_pk_bf16_f32 v109, v50, v51
    v_cvt_pk_bf16_f32 v110, v52, v53
    v_cvt_pk_bf16_f32 v111, v54, v55
    s_nop 1
    v_permlane32_swap_b32 v108, v110
    v_permlane32_swap_b32 v109, v111
    buffer_store_dwordx4 v[108:111], v3, s[8:11], s17 offen offset:256 sc1
    v_cvt_pk_bf16_f32 v112, v56, v57
    v_cvt_pk_bf16_f32 v113, v58, v59
    v_cvt_pk_bf16_f32 v114, v60, v61
    v_cvt_pk_bf16_f32 v115, v62, v63
    s_nop 1
    v_permlane32_swap_b32 v112, v114
    v_permlane32_swap_b32 v113, v115
    buffer_store_dwordx4 v[112:115], v3, s[8:11], s17 offen offset:2560 sc1
    v_cvt_pk_bf16_f32 v116, v64, v65
    v_cvt_pk_bf16_f32 v117, v66, v67
    v_cvt_pk_bf16_f32 v118, v68, v69
    v_cvt_pk_bf16_f32 v119, v70, v71
    s_nop 1
    v_permlane32_swap_b32 v116, v118
    v_permlane32_swap_b32 v117, v119
    buffer_store_dwordx4 v[116:119], v3, s[8:11], s17 offen offset:2816 sc1
    s_add_u32 s17, s17, s20
    s_add_u32 s18, s18, s20
    s_branch layerb1_kernel_gu_done
layerb1_kernel_gu_fin1:
    s_nop 7
    s_nop 7
    v_cvt_pk_bf16_f32 v104, v72, v73
    v_cvt_pk_bf16_f32 v105, v74, v75
    v_cvt_pk_bf16_f32 v106, v76, v77
    v_cvt_pk_bf16_f32 v107, v78, v79
    s_nop 1
    v_permlane32_swap_b32 v104, v106
    v_permlane32_swap_b32 v105, v107
    buffer_store_dwordx4 v[104:107], v3, s[8:11], s17 offen offset:0 sc1
    v_cvt_pk_bf16_f32 v108, v80, v81
    v_cvt_pk_bf16_f32 v109, v82, v83
    v_cvt_pk_bf16_f32 v110, v84, v85
    v_cvt_pk_bf16_f32 v111, v86, v87
    s_nop 1
    v_permlane32_swap_b32 v108, v110
    v_permlane32_swap_b32 v109, v111
    buffer_store_dwordx4 v[108:111], v3, s[8:11], s17 offen offset:256 sc1
    v_cvt_pk_bf16_f32 v112, v88, v89
    v_cvt_pk_bf16_f32 v113, v90, v91
    v_cvt_pk_bf16_f32 v114, v92, v93
    v_cvt_pk_bf16_f32 v115, v94, v95
    s_nop 1
    v_permlane32_swap_b32 v112, v114
    v_permlane32_swap_b32 v113, v115
    buffer_store_dwordx4 v[112:115], v3, s[8:11], s17 offen offset:2560 sc1
    v_cvt_pk_bf16_f32 v116, v96, v97
    v_cvt_pk_bf16_f32 v117, v98, v99
    v_cvt_pk_bf16_f32 v118, v100, v101
    v_cvt_pk_bf16_f32 v119, v102, v103
    s_nop 1
    v_permlane32_swap_b32 v116, v118
    v_permlane32_swap_b32 v117, v119
    buffer_store_dwordx4 v[116:119], v3, s[8:11], s17 offen offset:2816 sc1
    s_add_u32 s17, s17, s20
    s_add_u32 s18, s18, s20
layerb1_kernel_gu_done:
    s_waitcnt vmcnt(0) lgkmcnt(0)
    s_barrier
    s_cmp_lg_u32 s13, 0
    s_cbranch_scc1 layerb1_kernel_gu_fl11
    s_mov_b64 exec, 1
    s_lshl_b32 s26, s12, 7
    v_mov_b32 v7, s26
    v_mov_b32 v120, s14
    buffer_store_dword v120, v7, s[8:11], s48 offen sc1
    s_mov_b64 exec, -1
layerb1_kernel_gu_fl11:
    s_branch layerb1_kernel_g_done
layerb1_kernel_g_qk:
    s_sub_u32 s26, s12, 80
    s_cmp_ge_u32 s26, 24
    s_cselect_b32 s27, 1, 0
    s_cselect_b32 s28, 24, 0
    s_sub_u32 s26, s26, s28
    s_lshl_b32 s26, s26, 3
    s_lshl_b32 s28, s13, 1
    s_add_u32 s26, s26, s28
    s_add_u32 s28, s26, 0
    s_mul_i32 s29, s28, 171
    s_lshr_b32 s29, s29, 10
    s_mul_i32 s30, s29, 6
    s_sub_u32 s30, s28, s30
    s_mul_i32 s31, s29, 12288
    s_lshl_b32 s32, s30, 11
    s_add_u32 s31, s31, s32
    s_mul_i32 s32, s14, 393216
    s_add_u32 s31, s31, s32
    s_mul_i32 s32, s27, 25165824
    s_add_u32 s31, s31, s32
    s_add_u32 s17, s31, 53477376
    s_lshl_b32 s30, s30, 5
    v_add_u32 v10, s30, v8
    v_and_b32 v11, 0xc1, v10
    v_and_b32 v12, 8, v10
    v_lshl_or_b32 v11, v12, 2, v11
    v_and_b32 v12, 32, v10
    v_lshrrev_b32 v12, 1, v12
    v_or_b32 v11, v11, v12
    v_and_b32 v12, 2, v10
    v_lshl_or_b32 v11, v12, 2, v11
    v_and_b32 v12, 16, v10
    v_lshrrev_b32 v12, 2, v12
    v_or_b32 v11, v11, v12
    v_and_b32 v12, 4, v10
    v_lshrrev_b32 v12, 1, v12
    v_or_b32 v11, v11, v12
    s_cmp_eq_u32 s27, 1
    s_cselect_b64 vcc, -1, 0
    s_nop 1
    v_cndmask_b32 v10, v10, v11, vcc
    v_lshrrev_b32 v12, 4, v10
    v_and_b32 v13, 3, v12
    v_mul_u32_u24 v13, 6, v13
    v_lshrrev_b32 v12, 2, v12
    v_add_u32 v12, v12, v13
    v_mul_u32_u24 v12, 20480, v12
    v_and_b32 v13, 15, v10
    v_lshl_add_u32 v11, v13, 4, v12
    v_lshl_add_u32 v4, v9, 8, v11
    s_xor_b32 s30, s27, 1
    s_mul_i32 s30, s30, 61440
    s_mul_i32 s31, s29, 491520
    s_add_u32 s30, s30, s31
    s_add_u32 s34, s30, 11534336
    s_add_u32 s28, s26, 1
    s_mul_i32 s29, s28, 171
    s_lshr_b32 s29, s29, 10
    s_mul_i32 s30, s29, 6
    s_sub_u32 s30, s28, s30
    s_mul_i32 s31, s29, 12288
    s_lshl_b32 s32, s30, 11
    s_add_u32 s31, s31, s32
    s_mul_i32 s32, s14, 393216
    s_add_u32 s31, s31, s32
    s_mul_i32 s32, s27, 25165824
    s_add_u32 s31, s31, s32
    s_add_u32 s18, s31, 53477376
    s_lshl_b32 s30, s30, 5
    v_add_u32 v10, s30, v8
    v_and_b32 v11, 0xc1, v10
    v_and_b32 v12, 8, v10
    v_lshl_or_b32 v11, v12, 2, v11
    v_and_b32 v12, 32, v10
    v_lshrrev_b32 v12, 1, v12
    v_or_b32 v11, v11, v12
    v_and_b32 v12, 2, v10
    v_lshl_or_b32 v11, v12, 2, v11
    v_and_b32 v12, 16, v10
    v_lshrrev_b32 v12, 2, v12
    v_or_b32 v11, v11, v12
    v_and_b32 v12, 4, v10
    v_lshrrev_b32 v12, 1, v12
    v_or_b32 v11, v11, v12
    s_cmp_eq_u32 s27, 1
    s_cselect_b64 vcc, -1, 0
    s_nop 1
    v_cndmask_b32 v10, v10, v11, vcc
    v_lshrrev_b32 v12, 4, v10
    v_and_b32 v13, 3, v12
    v_mul_u32_u24 v13, 6, v13
    v_lshrrev_b32 v12, 2, v12
    v_add_u32 v12, v12, v13
    v_mul_u32_u24 v12, 20480, v12
    v_and_b32 v13, 15, v10
    v_lshl_add_u32 v11, v13, 4, v12
    v_lshl_add_u32 v5, v9, 8, v11
    s_xor_b32 s30, s27, 1
    s_mul_i32 s30, s30, 61440
    s_mul_i32 s31, s29, 491520
    s_add_u32 s30, s30, s31
    s_add_u32 s35, s30, 11534336
    s_add_u32 s34, s34, 4096
    s_add_u32 s35, s35, 4096
    s_add_u32 s34, s34, 4096
    s_add_u32 s35, s35, 4096
    s_add_u32 s34, s34, 4096
    s_add_u32 s35, s35, 4096
    s_add_u32 s34, s34, 4096
    s_add_u32 s35, s35, 4096
    buffer_load_dwordx4 v[192:195], v4, s[8:11], s34 offen offset:0
    buffer_load_dwordx4 v[196:199], v5, s[8:11], s35 offen offset:0
    buffer_load_dwordx4 v[200:203], v4, s[8:11], s34 offen offset:512
    buffer_load_dwordx4 v[204:207], v5, s[8:11], s35 offen offset:512
    buffer_load_dwordx4 v[208:211], v4, s[8:11], s34 offen offset:1024
    buffer_load_dwordx4 v[212:215], v5, s[8:11], s35 offen offset:1024
    buffer_load_dwordx4 v[216:219], v4, s[8:11], s34 offen offset:1536
    buffer_load_dwordx4 v[220:223], v5, s[8:11], s35 offen offset:1536
    buffer_load_dwordx4 v[224:227], v4, s[8:11], s34 offen offset:2048
    buffer_load_dwordx4 v[228:231], v5, s[8:11], s35 offen offset:2048
    buffer_load_dwordx4 v[232:235], v4, s[8:11], s34 offen offset:2560
    buffer_load_dwordx4 v[236:239], v5, s[8:11], s35 offen offset:2560
    buffer_load_dwordx4 v[240:243], v4, s[8:11], s34 offen offset:3072
    buffer_load_dwordx4 v[244:247], v5, s[8:11], s35 offen offset:3072
    buffer_load_dwordx4 v[248:251], v4, s[8:11], s34 offen offset:3584
    buffer_load_dwordx4 v[252:255], v5, s[8:11], s35 offen offset:3584
    v_mov_b32 v3, v1
    s_mov_b32 s20, 393216
    s_mul_i32 s19, s13, 10240
    s_add_u32 s19, s19, 220200960
    s_mov_b32 s22, 0
    s_mov_b32 s56, 0
    s_mov_b32 s58, 400000
    s_add_u32 s57, s48, 45056
    s_cmp_lg_u32 s13, 0
    s_cbranch_scc1 layerb1_kernel_gk_lw1
    s_min_u32 s28, s14, 63
    s_cmp_gt_u32 s56, s28
    s_cbranch_scc1 layerb1_kernel_gk_lw1
layerb1_kernel_gk_lp1:
    buffer_load_dwordx4 v[124:127], v1, s[8:11], s57 offen sc1
    s_waitcnt vmcnt(0)
    v_min_u32 v124, v124, v125
    v_min_u32 v126, v126, v127
    v_min_u32 v124, v124, v126
    v_cmp_eq_u32 vcc, 0, v124
    s_nop 1
    s_ff1_i32_b64 s56, vcc
    s_min_u32 s56, s56, 64
    s_sub_u32 s58, s58, 1
    s_cbranch_scc1 layerb1_kernel_bail
    s_cmp_gt_u32 s56, s28
    s_cbranch_scc0 layerb1_kernel_gk_lp1
layerb1_kernel_gk_lw1:
    s_barrier
    s_min_u32 s24, s14, 63
    s_mul_i32 s24, s24, 40960
    s_add_u32 s24, s24, s19
    s_mul_i32 s25, s13, 10240
    s_add_u32 s25, s25, s22
    s_mov_b32 m0, s25
    s_nop 0
    buffer_load_dwordx4 v1, s[8:11], s24 offen offset:0 sc1 lds
    buffer_load_dwordx4 v1, s[8:11], s24 offen offset:1024 sc1 lds
    buffer_load_dwordx4 v1, s[8:11], s24 offen offset:2048 sc1 lds
    buffer_load_dwordx4 v1, s[8:11], s24 offen offset:3072 sc1 lds
    s_add_u32 s24, s24, 4096
    s_add_u32 s25, s25, 4096
    s_mov_b32 m0, s25
    s_nop 0
    buffer_load_dwordx4 v1, s[8:11], s24 offen offset:0 sc1 lds
    buffer_load_dwordx4 v1, s[8:11], s24 offen offset:1024 sc1 lds
    buffer_load_dwordx4 v1, s[8:11], s24 offen offset:2048 sc1 lds
    buffer_load_dwordx4 v1, s[8:11], s24 offen offset:3072 sc1 lds
    s_add_u32 s24, s24, 4096
    s_add_u32 s25, s25, 4096
    s_mov_b32 m0, s25
    s_nop 0
    buffer_load_dwordx4 v1, s[8:11], s24 offen offset:0 sc1 lds
    buffer_load_dwordx4 v1, s[8:11], s24 offen offset:1024 sc1 lds
    s_mov_b32 s22, 40960
    s_mov_b32 s16, 0
    s_waitcnt vmcnt(0)
    s_barrier
    v_mov_b32 v2, v1
    ds_read_b128 v[8:11], v2 offset:0
    ds_read_b128 v[12:15], v2 offset:1024
    ds_read_b128 v[16:19], v2 offset:2048
    ds_read_b128 v[20:23], v2 offset:3072
    ds_read_b128 v[24:27], v2 offset:4096
    ds_read_b128 v[28:31], v2 offset:5120
layerb1_kernel_gk_solo:
    ds_read_b128 v[32:35], v2 offset:6144
    s_waitcnt lgkmcnt(6)
    v_mfma_f32_32x32x16_bf16 v[40:55], a[0:3], v[8:11], 0
    v_mfma_f32_32x32x16_bf16 v[56:71], a[4:7], v[8:11], 0
    ds_read_b128 v[36:39], v2 offset:7168
    s_waitcnt lgkmcnt(6)
    v_mfma_f32_32x32x16_bf16 v[40:55], a[8:11], v[12:15], v[40:55]
    v_mfma_f32_32x32x16_bf16 v[56:71], a[12:15], v[12:15], v[56:71]
    ds_read_b128 v[8:11], v2 offset:8192
    s_waitcnt lgkmcnt(6)
    v_mfma_f32_32x32x16_bf16 v[40:55], a[16:19], v[16:19], v[40:55]
    v_mfma_f32_32x32x16_bf16 v[56:71], a[20:23], v[16:19], v[56:71]
    ds_read_b128 v[12:15], v2 offset:9216
    s_waitcnt lgkmcnt(6)
    v_mfma_f32_32x32x16_bf16 v[40:55], a[24:27], v[20:23], v[40:55]
    v_mfma_f32_32x32x16_bf16 v[56:71], a[28:31], v[20:23], v[56:71]
    ds_read_b128 v[16:19], v2 offset:10240
    s_waitcnt lgkmcnt(6)
    v_mfma_f32_32x32x16_bf16 v[40:55], a[32:35], v[24:27], v[40:55]
    v_mfma_f32_32x32x16_bf16 v[56:71], a[36:39], v[24:27], v[56:71]
    ds_read_b128 v[20:23], v2 offset:11264
    s_waitcnt lgkmcnt(6)
    v_mfma_f32_32x32x16_bf16 v[40:55], a[40:43], v[28:31], v[40:55]
    v_mfma_f32_32x32x16_bf16 v[56:71], a[44:47], v[28:31], v[56:71]
    ds_read_b128 v[24:27], v2 offset:12288
    s_waitcnt lgkmcnt(6)
    v_mfma_f32_32x32x16_bf16 v[40:55], a[48:51], v[32:35], v[40:55]
    v_mfma_f32_32x32x16_bf16 v[56:71], a[52:55], v[32:35], v[56:71]
    ds_read_b128 v[28:31], v2 offset:13312
    s_waitcnt lgkmcnt(6)
    v_mfma_f32_32x32x16_bf16 v[40:55], a[56:59], v[36:39], v[40:55]
    v_mfma_f32_32x32x16_bf16 v[56:71], a[60:63], v[36:39], v[56:71]
    ds_read_b128 v[32:35], v2 offset:14336
    s_waitcnt lgkmcnt(6)
    v_mfma_f32_32x32x16_bf16 v[40:55], a[64:67], v[8:11], v[40:55]
    v_mfma_f32_32x32x16_bf16 v[56:71], a[68:71], v[8:11], v[56:71]
    ds_read_b128 v[36:39], v2 offset:15360
    s_waitcnt lgkmcnt(6)
    v_mfma_f32_32x32x16_bf16 v[40:55], a[72:75], v[12:15], v[40:55]
    v_mfma_f32_32x32x16_bf16 v[56:71], a[76:79], v[12:15], v[56:71]
    ds_read_b128 v[8:11], v2 offset:16384
    s_waitcnt lgkmcnt(6)
    v_mfma_f32_32x32x16_bf16 v[40:55], a[80:83], v[16:19], v[40:55]
    v_mfma_f32_32x32x16_bf16 v[56:71], a[84:87], v[16:19], v[56:71]
    ds_read_b128 v[12:15], v2 offset:17408
    s_waitcnt lgkmcnt(6)
    v_mfma_f32_32x32x16_bf16 v[40:55], a[88:91], v[20:23], v[40:55]
    v_mfma_f32_32x32x16_bf16 v[56:71], a[92:95], v[20:23], v[56:71]
    ds_read_b128 v[16:19], v2 offset:18432
    s_waitcnt lgkmcnt(6)
    v_mfma_f32_32x32x16_bf16 v[40:55], a[96:99], v[24:27], v[40:55]
    v_mfma_f32_32x32x16_bf16 v[56:71], a[100:103], v[24:27], v[56:71]
    ds_read_b128 v[20:23], v2 offset:19456
    s_waitcnt lgkmcnt(6)
    v_mfma_f32_32x32x16_bf16 v[40:55], a[104:107], v[28:31], v[40:55]
    v_mfma_f32_32x32x16_bf16 v[56:71], a[108:111], v[28:31], v[56:71]
    ds_read_b128 v[24:27], v2 offset:20480
    s_waitcnt lgkmcnt(6)
    v_mfma_f32_32x32x16_bf16 v[40:55], a[112:115], v[32:35], v[40:55]
    v_mfma_f32_32x32x16_bf16 v[56:71], a[116:119], v[32:35], v[56:71]
    ds_read_b128 v[28:31], v2 offset:21504
    s_waitcnt lgkmcnt(6)
    v_mfma_f32_32x32x16_bf16 v[40:55], a[120:123], v[36:39], v[40:55]
    v_mfma_f32_32x32x16_bf16 v[56:71], a[124:127], v[36:39], v[56:71]
    ds_read_b128 v[32:35], v2 offset:22528
    s_waitcnt lgkmcnt(6)
    v_mfma_f32_32x32x16_bf16 v[40:55], a[128:131], v[8:11], v[40:55]
    v_mfma_f32_32x32x16_bf16 v[56:71], a[132:135], v[8:11], v[56:71]
    ds_read_b128 v[36:39], v2 offset:23552
    s_waitcnt lgkmcnt(6)
    v_mfma_f32_32x32x16_bf16 v[40:55], a[136:139], v[12:15], v[40:55]
    v_mfma_f32_32x32x16_bf16 v[56:71], a[140:143], v[12:15], v[56:71]
    ds_read_b128 v[8:11], v2 offset:24576
    s_waitcnt lgkmcnt(6)
    v_mfma_f32_32x32x16_bf16 v[40:55], a[144:147], v[16:19], v[40:55]
    v_mfma_f32_32x32x16_bf16 v[56:71], a[148:151], v[16:19], v[56:71]
    ds_read_b128 v[12:15], v2 offset:25600
    s_waitcnt lgkmcnt(6)
    v_mfma_f32_32x32x16_bf16 v[40:55], a[152:155], v[20:23], v[40:55]
    v_mfma_f32_32x32x16_bf16 v[56:71], a[156:159], v[20:23], v[56:71]
    ds_read_b128 v[16:19], v2 offset:26624
    s_waitcnt lgkmcnt(6)
    v_mfma_f32_32x32x16_bf16 v[40:55], a[160:163], v[24:27], v[40:55]
    v_mfma_f32_32x32x16_bf16 v[56:71], a[164:167], v[24:27], v[56:71]
    ds_read_b128 v[20:23], v2 offset:27648
    s_waitcnt lgkmcnt(6)
    v_mfma_f32_32x32x16_bf16 v[40:55], a[168:171], v[28:31], v[40:55]
    v_mfma_f32_32x32x16_bf16 v[56:71], a[172:175], v[28:31], v[56:71]
    ds_read_b128 v[24:27], v2 offset:28672
    s_waitcnt lgkmcnt(6)
    v_mfma_f32_32x32x16_bf16 v[40:55], a[176:179], v[32:35], v[40:55]
    v_mfma_f32_32x32x16_bf16 v[56:71], a[180:183], v[32:35], v[56:71]
    ds_read_b128 v[28:31], v2 offset:29696
    s_waitcnt lgkmcnt(6)
    v_mfma_f32_32x32x16_bf16 v[40:55], a[184:187], v[36:39], v[40:55]
    v_mfma_f32_32x32x16_bf16 v[56:71], a[188:191], v[36:39], v[56:71]
    ds_read_b128 v[32:35], v2 offset:30720
    s_waitcnt lgkmcnt(6)
    v_mfma_f32_32x32x16_bf16 v[40:55], a[192:195], v[8:11], v[40:55]
    v_mfma_f32_32x32x16_bf16 v[56:71], a[196:199], v[8:11], v[56:71]
    ds_read_b128 v[36:39], v2 offset:31744
    s_waitcnt lgkmcnt(6)
    v_mfma_f32_32x32x16_bf16 v[40:55], a[200:203], v[12:15], v[40:55]
    v_mfma_f32_32x32x16_bf16 v[56:71], a[204:207], v[12:15], v[56:71]
    ds_read_b128 v[8:11], v2 offset:32768
    s_waitcnt lgkmcnt(6)
    v_mfma_f32_32x32x16_bf16 v[40:55], a[208:211], v[16:19], v[40:55]
    v_mfma_f32_32x32x16_bf16 v[56:71], a[212:215], v[16:19], v[56:71]
    ds_read_b128 v[12:15], v2 offset:33792
    s_waitcnt lgkmcnt(6)
    v_mfma_f32_32x32x16_bf16 v[40:55], a[216:219], v[20:23], v[40:55]
    v_mfma_f32_32x32x16_bf16 v[56:71], a[220:223], v[20:23], v[56:71]
    ds_read_b128 v[16:19], v2 offset:34816
    s_waitcnt lgkmcnt(6)
    v_mfma_f32_32x32x16_bf16 v[40:55], a[224:227], v[24:27], v[40:55]
    v_mfma_f32_32x32x16_bf16 v[56:71], a[228:231], v[24:27], v[56:71]
    ds_read_b128 v[20:23], v2 offset:35840
    s_waitcnt lgkmcnt(6)
    v_mfma_f32_32x32x16_bf16 v[40:55], a[232:235], v[28:31], v[40:55]
    v_mfma_f32_32x32x16_bf16 v[56:71], a[236:239], v[28:31], v[56:71]
    ds_read_b128 v[24:27], v2 offset:36864
    s_waitcnt lgkmcnt(6)
    buffer_load_dwordx4 v[124:127], v1, s[8:11], s57 offen sc1
    v_mfma_f32_32x32x16_bf16 v[40:55], a[240:243], v[32:35], v[40:55]
    v_mfma_f32_32x32x16_bf16 v[56:71], a[244:247], v[32:35], v[56:71]
    ds_read_b128 v[28:31], v2 offset:37888
    s_waitcnt lgkmcnt(6)
    v_mfma_f32_32x32x16_bf16 v[40:55], a[248:251], v[36:39], v[40:55]
    v_mfma_f32_32x32x16_bf16 v[56:71], a[252:255], v[36:39], v[56:71]
    ds_read_b128 v[32:35], v2 offset:38912
    s_waitcnt lgkmcnt(6)
    v_mfma_f32_32x32x16_bf16 v[40:55], v[192:195], v[8:11], v[40:55]
    v_mfma_f32_32x32x16_bf16 v[56:71], v[196:199], v[8:11], v[56:71]
    ds_read_b128 v[36:39], v2 offset:39936
    s_waitcnt lgkmcnt(6)
    v_mfma_f32_32x32x16_bf16 v[40:55], v[200:203], v[12:15], v[40:55]
    v_mfma_f32_32x32x16_bf16 v[56:71], v[204:207], v[12:15], v[56:71]
    s_waitcnt lgkmcnt(5)
    v_mfma_f32_32x32x16_bf16 v[40:55], v[208:211], v[16:19], v[40:55]
    v_mfma_f32_32x32x16_bf16 v[56:71], v[212:215], v[16:19], v[56:71]
    s_waitcnt lgkmcnt(4)
    v_mfma_f32_32x32x16_bf16 v[40:55], v[216:219], v[20:23], v[40:55]
    v_mfma_f32_32x32x16_bf16 v[56:71], v[220:223], v[20:23], v[56:71]
    s_waitcnt lgkmcnt(3)
    v_mfma_f32_32x32x16_bf16 v[40:55], v[224:227], v[24:27], v[40:55]
    v_mfma_f32_32x32x16_bf16 v[56:71], v[228:231], v[24:27], v[56:71]
    s_waitcnt lgkmcnt(2)
    v_mfma_f32_32x32x16_bf16 v[40:55], v[232:235], v[28:31], v[40:55]
    v_mfma_f32_32x32x16_bf16 v[56:71], v[236:239], v[28:31], v[56:71]
    s_waitcnt lgkmcnt(1)
    v_mfma_f32_32x32x16_bf16 v[40:55], v[240:243], v[32:35], v[40:55]
    v_mfma_f32_32x32x16_bf16 v[56:71], v[244:247], v[32:35], v[56:71]
    s_waitcnt lgkmcnt(0)
    v_mfma_f32_32x32x16_bf16 v[40:55], v[248:251], v[36:39], v[40:55]
    v_mfma_f32_32x32x16_bf16 v[56:71], v[252:255], v[36:39], v[56:71]
    s_add_u32 s14, s14, 1
    s_nop 7
    s_nop 7
    v_cvt_pk_bf16_f32 v104, v40, v41
    v_cvt_pk_bf16_f32 v105, v42, v43
    v_cvt_pk_bf16_f32 v106, v44, v45
    v_cvt_pk_bf16_f32 v107, v46, v47
    s_nop 1
    v_permlane32_swap_b32 v104, v106
    v_permlane32_swap_b32 v105, v107
    buffer_store_dwordx4 v[104:107], v3, s[8:11], s17 offen offset:0 sc1
    v_cvt_pk_bf16_f32 v108, v48, v49
    v_cvt_pk_bf16_f32 v109, v50, v51
    v_cvt_pk_bf16_f32 v110, v52, v53
    v_cvt_pk_bf16_f32 v111, v54, v55
    s_nop 1
    v_permlane32_swap_b32 v108, v110
    v_permlane32_swap_b32 v109, v111
    buffer_store_dwordx4 v[108:111], v3, s[8:11], s17 offen offset:1024 sc1
    v_cvt_pk_bf16_f32 v112, v56, v57
    v_cvt_pk_bf16_f32 v113, v58, v59
    v_cvt_pk_bf16_f32 v114, v60, v61
    v_cvt_pk_bf16_f32 v115, v62, v63
    s_nop 1
    v_permlane32_swap_b32 v112, v114
    v_permlane32_swap_b32 v113, v115
    buffer_store_dwordx4 v[112:115], v3, s[8:11], s18 offen offset:0 sc1
    v_cvt_pk_bf16_f32 v116, v64, v65
    v_cvt_pk_bf16_f32 v117, v66, v67
    v_cvt_pk_bf16_f32 v118, v68, v69
    v_cvt_pk_bf16_f32 v119, v70, v71
    s_nop 1
    v_permlane32_swap_b32 v116, v118
    v_permlane32_swap_b32 v117, v119
    buffer_store_dwordx4 v[116:119], v3, s[8:11], s18 offen offset:1024 sc1
    s_add_u32 s17, s17, s20
    s_add_u32 s18, s18, s20
    s_waitcnt vmcnt(0)
    s_barrier
    s_cmp_lg_u32 s13, 0
    s_cbranch_scc1 layerb1_kernel_gk_fl2
    s_mov_b64 exec, 1
    s_lshl_b32 s26, s12, 7
    v_mov_b32 v7, s26
    v_mov_b32 v120, s14
    buffer_store_dword v120, v7, s[8:11], s48 offen sc1
    s_mov_b64 exec, -1
layerb1_kernel_gk_fl2:
layerb1_kernel_gk_spoll:
    v_min_u32 v124, v124, v125
    v_min_u32 v126, v126, v127
    v_min_u32 v124, v124, v126
    v_cmp_eq_u32 vcc, 0, v124
    s_nop 1
    s_ff1_i32_b64 s56, vcc
    s_min_u32 s56, s56, 64
    s_cmp_gt_u32 s56, s14
    s_cbranch_scc1 layerb1_kernel_gk_sok
    s_sub_u32 s58, s58, 1
    s_cbranch_scc1 layerb1_kernel_bail
    buffer_load_dwordx4 v[124:127], v1, s[8:11], s57 offen sc1
    s_waitcnt vmcnt(0)
    s_branch layerb1_kernel_gk_spoll
layerb1_kernel_gk_sok:
    s_min_u32 s24, s14, 63
    s_mul_i32 s24, s24, 40960
    s_add_u32 s24, s24, s19
    s_mul_i32 s25, s13, 10240
    s_add_u32 s25, s25, s22
    s_mov_b32 m0, s25
    s_nop 0
    buffer_load_dwordx4 v1, s[8:11], s24 offen offset:0 sc1 lds
    buffer_load_dwordx4 v1, s[8:11], s24 offen offset:1024 sc1 lds
    buffer_load_dwordx4 v1, s[8:11], s24 offen offset:2048 sc1 lds
    buffer_load_dwordx4 v1, s[8:11], s24 offen offset:3072 sc1 lds
    s_add_u32 s24, s24, 4096
    s_add_u32 s25, s25, 4096
    s_mov_b32 m0, s25
    s_nop 0
    buffer_load_dwordx4 v1, s[8:11], s24 offen offset:0 sc1 lds
    buffer_load_dwordx4 v1, s[8:11], s24 offen offset:1024 sc1 lds
    buffer_load_dwordx4 v1, s[8:11], s24 offen offset:2048 sc1 lds
    buffer_load_dwordx4 v1, s[8:11], s24 offen offset:3072 sc1 lds
    s_add_u32 s24, s24, 4096
    s_add_u32 s25, s25, 4096
    s_mov_b32 m0, s25
    s_nop 0
    buffer_load_dwordx4 v1, s[8:11], s24 offen offset:0 sc1 lds
    buffer_load_dwordx4 v1, s[8:11], s24 offen offset:1024 sc1 lds
    s_mov_b32 s16, s22
    s_add_u32 s22, s22, 40960
    s_cmp_eq_u32 s22, 122880
    s_cselect_b32 s22, 0, s22
    v_add_u32 v2, s16, v1
    s_waitcnt vmcnt(0)
    s_barrier
    ds_read_b128 v[8:11], v2 offset:0
    ds_read_b128 v[12:15], v2 offset:1024
    ds_read_b128 v[16:19], v2 offset:2048
    ds_read_b128 v[20:23], v2 offset:3072
    ds_read_b128 v[24:27], v2 offset:4096
    ds_read_b128 v[28:31], v2 offset:5120
    s_cmp_lt_u32 s14, 3
    s_cbranch_scc1 layerb1_kernel_gk_solo
    ds_read_b128 v[32:35], v2 offset:6144
    s_waitcnt lgkmcnt(6)
    v_mfma_f32_32x32x16_bf16 v[72:87], a[0:3], v[8:11], 0
    v_mfma_f32_32x32x16_bf16 v[88:103], a[4:7], v[8:11], 0
    ds_read_b128 v[36:39], v2 offset:7168
    s_waitcnt lgkmcnt(6)
    v_mfma_f32_32x32x16_bf16 v[72:87], a[8:11], v[12:15], v[72:87]
    v_mfma_f32_32x32x16_bf16 v[88:103], a[12:15], v[12:15], v[88:103]
    ds_read_b128 v[8:11], v2 offset:8192
    s_waitcnt lgkmcnt(6)
    v_mfma_f32_32x32x16_bf16 v[72:87], a[16:19], v[16:19], v[72:87]
    v_mfma_f32_32x32x16_bf16 v[88:103], a[20:23], v[16:19], v[88:103]
    s_add_u32 s23, s14, 1
    s_cmp_lg_u32 s13, 0
    s_cbranch_scc1 layerb1_kernel_gk_lw3
    s_min_u32 s28, s23, 63
    s_cmp_gt_u32 s56, s28
    s_cbranch_scc1 layerb1_kernel_gk_lw3
layerb1_kernel_gk_lp3:
    buffer_load_dwordx4 v[124:127], v1, s[8:11], s57 offen sc1
    s_waitcnt vmcnt(0)
    v_min_u32 v124, v124, v125
    v_min_u32 v126, v126, v127
    v_min_u32 v124, v124, v126
    v_cmp_eq_u32 vcc, 0, v124
    s_nop 1
    s_ff1_i32_b64 s56, vcc
    s_min_u32 s56, s56, 64
    s_sub_u32 s58, s58, 1
    s_cbranch_scc1 layerb1_kernel_bail
    s_cmp_gt_u32 s56, s28
    s_cbranch_scc0 layerb1_kernel_gk_lp3
layerb1_kernel_gk_lw3:
    s_barrier
    s_min_u32 s24, s23, 63
    s_mul_i32 s24, s24, 40960
    s_add_u32 s24, s24, s19
    s_mul_i32 s25, s13, 10240
    s_add_u32 s25, s25, s22
    s_add_u32 s22, s22, 40960
    s_cmp_eq_u32 s22, 122880
    s_cselect_b32 s22, 0, s22
    ds_read_b128 v[12:15], v2 offset:9216
    s_waitcnt lgkmcnt(6)
    v_mfma_f32_32x32x16_bf16 v[72:87], a[24:27], v[20:23], v[72:87]
    s_mov_b32 m0, s25
    s_nop 0
    buffer_load_dwordx4 v1, s[8:11], s24 offen offset:0 sc1 lds
    v_mfma_f32_32x32x16_bf16 v[88:103], a[28:31], v[20:23], v[88:103]
    ds_read_b128 v[16:19], v2 offset:10240
    s_waitcnt lgkmcnt(6)
    v_mfma_f32_32x32x16_bf16 v[72:87], a[32:35], v[24:27], v[72:87]
    buffer_load_dwordx4 v1, s[8:11], s24 offen offset:1024 sc1 lds
    v_mfma_f32_32x32x16_bf16 v[88:103], a[36:39], v[24:27], v[88:103]
    ds_read_b128 v[20:23], v2 offset:11264
    s_waitcnt lgkmcnt(6)
    v_mfma_f32_32x32x16_bf16 v[72:87], a[40:43], v[28:31], v[72:87]
    buffer_load_dwordx4 v1, s[8:11], s24 offen offset:2048 sc1 lds
    v_mfma_f32_32x32x16_bf16 v[88:103], a[44:47], v[28:31], v[88:103]
    ds_read_b128 v[24:27], v2 offset:12288
    s_waitcnt lgkmcnt(6)
    v_mfma_f32_32x32x16_bf16 v[72:87], a[48:51], v[32:35], v[72:87]
    buffer_load_dwordx4 v1, s[8:11], s24 offen offset:3072 sc1 lds
    v_mfma_f32_32x32x16_bf16 v[88:103], a[52:55], v[32:35], v[88:103]
    ds_read_b128 v[28:31], v2 offset:13312
    s_waitcnt lgkmcnt(6)
    v_mfma_f32_32x32x16_bf16 v[72:87], a[56:59], v[36:39], v[72:87]
    s_add_u32 s24, s24, 4096
    s_add_u32 s25, s25, 4096
    s_mov_b32 m0, s25
    s_nop 0
    buffer_load_dwordx4 v1, s[8:11], s24 offen offset:0 sc1 lds
    v_mfma_f32_32x32x16_bf16 v[88:103], a[60:63], v[36:39], v[88:103]
    ds_read_b128 v[32:35], v2 offset:14336
    s_waitcnt lgkmcnt(6)
    v_mfma_f32_32x32x16_bf16 v[72:87], a[64:67], v[8:11], v[72:87]
    buffer_load_dwordx4 v1, s[8:11], s24 offen offset:1024 sc1 lds
    v_mfma_f32_32x32x16_bf16 v[88:103], a[68:71], v[8:11], v[88:103]
    ds_read_b128 v[36:39], v2 offset:15360
    s_waitcnt lgkmcnt(6)
    v_mfma_f32_32x32x16_bf16 v[72:87], a[72:75], v[12:15], v[72:87]
    buffer_load_dwordx4 v1, s[8:11], s24 offen offset:2048 sc1 lds
    v_mfma_f32_32x32x16_bf16 v[88:103], a[76:79], v[12:15], v[88:103]
    ds_read_b128 v[8:11], v2 offset:16384
    s_waitcnt lgkmcnt(6)
    v_mfma_f32_32x32x16_bf16 v[72:87], a[80:83], v[16:19], v[72:87]
    buffer_load_dwordx4 v1, s[8:11], s24 offen offset:3072 sc1 lds
    v_mfma_f32_32x32x16_bf16 v[88:103], a[84:87], v[16:19], v[88:103]
    ds_read_b128 v[12:15], v2 offset:17408
    s_waitcnt lgkmcnt(6)
    v_mfma_f32_32x32x16_bf16 v[72:87], a[88:91], v[20:23], v[72:87]
    s_add_u32 s24, s24, 4096
    s_add_u32 s25, s25, 4096
    s_mov_b32 m0, s25
    s_nop 0
    buffer_load_dwordx4 v1, s[8:11], s24 offen offset:0 sc1 lds
    v_mfma_f32_32x32x16_bf16 v[88:103], a[92:95], v[20:23], v[88:103]
    ds_read_b128 v[16:19], v2 offset:18432
    s_waitcnt lgkmcnt(6)
    v_mfma_f32_32x32x16_bf16 v[72:87], a[96:99], v[24:27], v[72:87]
    buffer_load_dwordx4 v1, s[8:11], s24 offen offset:1024 sc1 lds
    v_mfma_f32_32x32x16_bf16 v[88:103], a[100:103], v[24:27], v[88:103]
    ds_read_b128 v[20:23], v2 offset:19456
    s_waitcnt lgkmcnt(6)
    v_mfma_f32_32x32x16_bf16 v[72:87], a[104:107], v[28:31], v[72:87]
    v_mfma_f32_32x32x16_bf16 v[88:103], a[108:111], v[28:31], v[88:103]
    ds_read_b128 v[24:27], v2 offset:20480
    s_waitcnt lgkmcnt(6)
    v_mfma_f32_32x32x16_bf16 v[72:87], a[112:115], v[32:35], v[72:87]
    v_mfma_f32_32x32x16_bf16 v[88:103], a[116:119], v[32:35], v[88:103]
    ds_read_b128 v[28:31], v2 offset:21504
    s_waitcnt lgkmcnt(6)
    v_mfma_f32_32x32x16_bf16 v[72:87], a[120:123], v[36:39], v[72:87]
    v_mfma_f32_32x32x16_bf16 v[88:103], a[124:127], v[36:39], v[88:103]
    ds_read_b128 v[32:35], v2 offset:22528
    s_waitcnt lgkmcnt(6)
    v_mfma_f32_32x32x16_bf16 v[72:87], a[128:131], v[8:11], v[72:87]
    v_mfma_f32_32x32x16_bf16 v[88:103], a[132:135], v[8:11], v[88:103]
    ds_read_b128 v[36:39], v2 offset:23552
    s_waitcnt lgkmcnt(6)
    v_mfma_f32_32x32x16_bf16 v[72:87], a[136:139], v[12:15], v[72:87]
    v_mfma_f32_32x32x16_bf16 v[88:103], a[140:143], v[12:15], v[88:103]
    ds_read_b128 v[8:11], v2 offset:24576
    s_waitcnt lgkmcnt(6)
    v_mfma_f32_32x32x16_bf16 v[72:87], a[144:147], v[16:19], v[72:87]
    v_mfma_f32_32x32x16_bf16 v[88:103], a[148:151], v[16:19], v[88:103]
    ds_read_b128 v[12:15], v2 offset:25600
    s_waitcnt lgkmcnt(6)
    v_mfma_f32_32x32x16_bf16 v[72:87], a[152:155], v[20:23], v[72:87]
    v_mfma_f32_32x32x16_bf16 v[88:103], a[156:159], v[20:23], v[88:103]
    ds_read_b128 v[16:19], v2 offset:26624
    s_waitcnt lgkmcnt(6)
    v_mfma_f32_32x32x16_bf16 v[72:87], a[160:163], v[24:27], v[72:87]
    v_mfma_f32_32x32x16_bf16 v[88:103], a[164:167], v[24:27], v[88:103]
    ds_read_b128 v[20:23], v2 offset:27648
    s_waitcnt lgkmcnt(6)
    v_mfma_f32_32x32x16_bf16 v[72:87], a[168:171], v[28:31], v[72:87]
    v_mfma_f32_32x32x16_bf16 v[88:103], a[172:175], v[28:31], v[88:103]
    ds_read_b128 v[24:27], v2 offset:28672
    s_waitcnt lgkmcnt(6)
    v_mfma_f32_32x32x16_bf16 v[72:87], a[176:179], v[32:35], v[72:87]
    v_mfma_f32_32x32x16_bf16 v[88:103], a[180:183], v[32:35], v[88:103]
    ds_read_b128 v[28:31], v2 offset:29696
    s_waitcnt lgkmcnt(6)
    v_mfma_f32_32x32x16_bf16 v[72:87], a[184:187], v[36:39], v[72:87]
    v_mfma_f32_32x32x16_bf16 v[88:103], a[188:191], v[36:39], v[88:103]
    ds_read_b128 v[32:35], v2 offset:30720
    s_waitcnt lgkmcnt(6)
    v_mfma_f32_32x32x16_bf16 v[72:87], a[192:195], v[8:11], v[72:87]
    v_mfma_f32_32x32x16_bf16 v[88:103], a[196:199], v[8:11], v[88:103]
    ds_read_b128 v[36:39], v2 offset:31744
    s_waitcnt lgkmcnt(6)
    v_mfma_f32_32x32x16_bf16 v[72:87], a[200:203], v[12:15], v[72:87]
    v_mfma_f32_32x32x16_bf16 v[88:103], a[204:207], v[12:15], v[88:103]
    ds_read_b128 v[8:11], v2 offset:32768
    s_waitcnt lgkmcnt(6)
    v_mfma_f32_32x32x16_bf16 v[72:87], a[208:211], v[16:19], v[72:87]
    v_mfma_f32_32x32x16_bf16 v[88:103], a[212:215], v[16:19], v[88:103]
    ds_read_b128 v[12:15], v2 offset:33792
    s_waitcnt lgkmcnt(6)
    v_mfma_f32_32x32x16_bf16 v[72:87], a[216:219], v[20:23], v[72:87]
    v_mfma_f32_32x32x16_bf16 v[88:103], a[220:223], v[20:23], v[88:103]
    ds_read_b128 v[16:19], v2 offset:34816
    s_waitcnt lgkmcnt(6)
    v_mfma_f32_32x32x16_bf16 v[72:87], a[224:227], v[24:27], v[72:87]
    v_mfma_f32_32x32x16_bf16 v[88:103], a[228:231], v[24:27], v[88:103]
    s_add_u32 s23, s14, 2
    s_cmp_lg_u32 s13, 0
    s_cbranch_scc1 layerb1_kernel_gk_lw4
    s_min_u32 s28, s23, 63
    s_cmp_gt_u32 s56, s28
    s_cbranch_scc1 layerb1_kernel_gk_lw4
layerb1_kernel_gk_lp4:
    buffer_load_dwordx4 v[124:127], v1, s[8:11], s57 offen sc1
    s_waitcnt vmcnt(0)
    v_min_u32 v124, v124, v125
    v_min_u32 v126, v126, v127
    v_min_u32 v124, v124, v126
    v_cmp_eq_u32 vcc, 0, v124
    s_nop 1
    s_ff1_i32_b64 s56, vcc
    s_min_u32 s56, s56, 64
    s_sub_u32 s58, s58, 1
    s_cbranch_scc1 layerb1_kernel_bail
    s_cmp_gt_u32 s56, s28
    s_cbranch_scc0 layerb1_kernel_gk_lp4
layerb1_kernel_gk_lw4:
    s_waitcnt vmcnt(0)
    s_barrier
    s_add_u32 s21, s16, 40960
    s_cmp_eq_u32 s21, 122880
    s_cselect_b32 s21, 0, s21
    s_add_u32 s23, s14, 2
    s_min_u32 s24, s23, 63
    s_mul_i32 s24, s24, 40960
    s_add_u32 s24, s24, s19
    s_mul_i32 s25, s13, 10240
    s_add_u32 s25, s25, s22
    s_add_u32 s22, s22, 40960
    s_cmp_eq_u32 s22, 122880
    s_cselect_b32 s22, 0, s22
    ds_read_b128 v[20:23], v2 offset:35840
    s_waitcnt lgkmcnt(6)
    v_mfma_f32_32x32x16_bf16 v[72:87], a[232:235], v[28:31], v[72:87]
    s_mov_b32 m0, s25
    s_nop 0
    buffer_load_dwordx4 v1, s[8:11], s24 offen offset:0 sc1 lds
    v_mfma_f32_32x32x16_bf16 v[88:103], a[236:239], v[28:31], v[88:103]
    ds_read_b128 v[24:27], v2 offset:36864
    s_waitcnt lgkmcnt(6)
    v_mfma_f32_32x32x16_bf16 v[72:87], a[240:243], v[32:35], v[72:87]
    buffer_load_dwordx4 v1, s[8:11], s24 offen offset:1024 sc1 lds
    v_mfma_f32_32x32x16_bf16 v[88:103], a[244:247], v[32:35], v[88:103]
    ds_read_b128 v[28:31], v2 offset:37888
    s_waitcnt lgkmcnt(6)
    v_mfma_f32_32x32x16_bf16 v[72:87], a[248:251], v[36:39], v[72:87]
    buffer_load_dwordx4 v1, s[8:11], s24 offen offset:2048 sc1 lds
    v_mfma_f32_32x32x16_bf16 v[88:103], a[252:255], v[36:39], v[88:103]
    ds_read_b128 v[32:35], v2 offset:38912
    s_waitcnt lgkmcnt(6)
    v_mfma_f32_32x32x16_bf16 v[72:87], v[192:195], v[8:11], v[72:87]
    buffer_load_dwordx4 v1, s[8:11], s24 offen offset:3072 sc1 lds
    v_mfma_f32_32x32x16_bf16 v[88:103], v[196:199], v[8:11], v[88:103]
    ds_read_b128 v[36:39], v2 offset:39936
    s_waitcnt lgkmcnt(6)
    v_mfma_f32_32x32x16_bf16 v[72:87], v[200:203], v[12:15], v[72:87]
    s_add_u32 s24, s24, 4096
    s_add_u32 s25, s25, 4096
    s_mov_b32 m0, s25
    s_nop 0
    buffer_load_dwordx4 v1, s[8:11], s24 offen offset:0 sc1 lds
    v_mfma_f32_32x32x16_bf16 v[88:103], v[204:207], v[12:15], v[88:103]
    v_add_u32 v6, s21, v1
    ds_read_b128 v[8:11], v6 offset:0
    s_waitcnt lgkmcnt(6)
    v_mfma_f32_32x32x16_bf16 v[72:87], v[208:211], v[16:19], v[72:87]
    buffer_load_dwordx4 v1, s[8:11], s24 offen offset:1024 sc1 lds
    v_mfma_f32_32x32x16_bf16 v[88:103], v[212:215], v[16:19], v[88:103]
    ds_read_b128 v[12:15], v6 offset:1024
    s_waitcnt lgkmcnt(6)
    v_mfma_f32_32x32x16_bf16 v[72:87], v[216:219], v[20:23], v[72:87]
    buffer_load_dwordx4 v1, s[8:11], s24 offen offset:2048 sc1 lds
    v_mfma_f32_32x32x16_bf16 v[88:103], v[220:223], v[20:23], v[88:103]
    ds_read_b128 v[16:19], v6 offset:2048
    s_waitcnt lgkmcnt(6)
    v_mfma_f32_32x32x16_bf16 v[72:87], v[224:227], v[24:27], v[72:87]
    buffer_load_dwordx4 v1, s[8:11], s24 offen offset:3072 sc1 lds
    v_mfma_f32_32x32x16_bf16 v[88:103], v[228:231], v[24:27], v[88:103]
    ds_read_b128 v[20:23], v6 offset:3072
    s_waitcnt lgkmcnt(6)
    v_mfma_f32_32x32x16_bf16 v[72:87], v[232:235], v[28:31], v[72:87]
    s_add_u32 s24, s24, 4096
    s_add_u32 s25, s25, 4096
    s_mov_b32 m0, s25
    s_nop 0
    buffer_load_dwordx4 v1, s[8:11], s24 offen offset:0 sc1 lds
    v_mfma_f32_32x32x16_bf16 v[88:103], v[236:239], v[28:31], v[88:103]
    ds_read_b128 v[24:27], v6 offset:4096
    s_waitcnt lgkmcnt(6)
    v_mfma_f32_32x32x16_bf16 v[72:87], v[240:243], v[32:35], v[72:87]
    buffer_load_dwordx4 v1, s[8:11], s24 offen offset:1024 sc1 lds
    v_mfma_f32_32x32x16_bf16 v[88:103], v[244:247], v[32:35], v[88:103]
    ds_read_b128 v[28:31], v6 offset:5120
    s_waitcnt lgkmcnt(6)
    v_mfma_f32_32x32x16_bf16 v[72:87], v[248:251], v[36:39], v[72:87]
    v_mfma_f32_32x32x16_bf16 v[88:103], v[252:255], v[36:39], v[88:103]
    v_mov_b32 v2, v6
    s_mov_b32 s16, s21
    s_add_u32 s14, s14, 1
layerb1_kernel_gk_loop:
    ds_read_b128 v[32:35], v2 offset:6144
    s_waitcnt lgkmcnt(6)
    v_mfma_f32_32x32x16_bf16 v[40:55], a[0:3], v[8:11], 0
    v_mfma_f32_32x32x16_bf16 v[56:71], a[4:7], v[8:11], 0
    ds_read_b128 v[36:39], v2 offset:7168
    s_waitcnt lgkmcnt(6)
    v_mfma_f32_32x32x16_bf16 v[40:55], a[8:11], v[12:15], v[40:55]
    v_mfma_f32_32x32x16_bf16 v[56:71], a[12:15], v[12:15], v[56:71]
    ds_read_b128 v[8:11], v2 offset:8192
    s_waitcnt lgkmcnt(6)
    v_mfma_f32_32x32x16_bf16 v[40:55], a[16:19], v[16:19], v[40:55]
    v_cvt_pk_bf16_f32 v104, v72, v73
    v_mfma_f32_32x32x16_bf16 v[56:71], a[20:23], v[16:19], v[56:71]
    v_cvt_pk_bf16_f32 v105, v74, v75
    ds_read_b128 v[12:15], v2 offset:9216
    s_waitcnt lgkmcnt(6)
    v_mfma_f32_32x32x16_bf16 v[40:55], a[24:27], v[20:23], v[40:55]
    v_cvt_pk_bf16_f32 v106, v76, v77
    v_mfma_f32_32x32x16_bf16 v[56:71], a[28:31], v[20:23], v[56:71]
    v_cvt_pk_bf16_f32 v107, v78, v79
    ds_read_b128 v[16:19], v2 offset:10240
    s_waitcnt lgkmcnt(6)
    v_mfma_f32_32x32x16_bf16 v[40:55], a[32:35], v[24:27], v[40:55]
    s_nop 1
    v_mfma_f32_32x32x16_bf16 v[56:71], a[36:39], v[24:27], v[56:71]
    v_permlane32_swap_b32 v104, v106
    ds_read_b128 v[20:23], v2 offset:11264
    s_waitcnt lgkmcnt(6)
    v_mfma_f32_32x32x16_bf16 v[40:55], a[40:43], v[28:31], v[40:55]
    v_permlane32_swap_b32 v105, v107
    v_mfma_f32_32x32x16_bf16 v[56:71], a[44:47], v[28:31], v[56:71]
    buffer_store_dwordx4 v[104:107], v3, s[8:11], s17 offen offset:0 sc1
    ds_read_b128 v[24:27], v2 offset:12288
    s_waitcnt lgkmcnt(6)
    v_mfma_f32_32x32x16_bf16 v[40:55], a[48:51], v[32:35], v[40:55]
    v_cvt_pk_bf16_f32 v108, v80, v81
    v_mfma_f32_32x32x16_bf16 v[56:71], a[52:55], v[32:35], v[56:71]
    v_cvt_pk_bf16_f32 v109, v82, v83
    ds_read_b128 v[28:31], v2 offset:13312
    s_waitcnt lgkmcnt(6)
    v_mfma_f32_32x32x16_bf16 v[40:55], a[56:59], v[36:39], v[40:55]
    v_cvt_pk_bf16_f32 v110, v84, v85
    v_mfma_f32_32x32x16_bf16 v[56:71], a[60:63], v[36:39], v[56:71]
    v_cvt_pk_bf16_f32 v111, v86, v87
    ds_read_b128 v[32:35], v2 offset:14336
    s_waitcnt lgkmcnt(6)
    v_mfma_f32_32x32x16_bf16 v[40:55], a[64:67], v[8:11], v[40:55]
    s_nop 1
    v_mfma_f32_32x32x16_bf16 v[56:71], a[68:71], v[8:11], v[56:71]
    v_permlane32_swap_b32 v108, v110
    ds_read_b128 v[36:39], v2 offset:15360
    s_waitcnt lgkmcnt(6)
    v_mfma_f32_32x32x16_bf16 v[40:55], a[72:75], v[12:15], v[40:55]
    v_permlane32_swap_b32 v109, v111
    v_mfma_f32_32x32x16_bf16 v[56:71], a[76:79], v[12:15], v[56:71]
    buffer_store_dwordx4 v[108:111], v3, s[8:11], s17 offen offset:1024 sc1
    ds_read_b128 v[8:11], v2 offset:16384
    s_waitcnt lgkmcnt(6)
    v_mfma_f32_32x32x16_bf16 v[40:55], a[80:83], v[16:19], v[40:55]
    v_cvt_pk_bf16_f32 v112, v88, v89
    v_mfma_f32_32x32x16_bf16 v[56:71], a[84:87], v[16:19], v[56:71]
    v_cvt_pk_bf16_f32 v113, v90, v91
    ds_read_b128 v[12:15], v2 offset:17408
    s_waitcnt lgkmcnt(6)
    v_mfma_f32_32x32x16_bf16 v[40:55], a[88:91], v[20:23], v[40:55]
    v_cvt_pk_bf16_f32 v114, v92, v93
    v_mfma_f32_32x32x16_bf16 v[56:71], a[92:95], v[20:23], v[56:71]
    v_cvt_pk_bf16_f32 v115, v94, v95
    ds_read_b128 v[16:19], v2 offset:18432
    s_waitcnt lgkmcnt(6)
    v_mfma_f32_32x32x16_bf16 v[40:55], a[96:99], v[24:27], v[40:55]
    s_nop 1
    v_mfma_f32_32x32x16_bf16 v[56:71], a[100:103], v[24:27], v[56:71]
    v_permlane32_swap_b32 v112, v114
    ds_read_b128 v[20:23], v2 offset:19456
    s_waitcnt lgkmcnt(6)
    v_mfma_f32_32x32x16_bf16 v[40:55], a[104:107], v[28:31], v[40:55]
    v_permlane32_swap_b32 v113, v115
    v_mfma_f32_32x32x16_bf16 v[56:71], a[108:111], v[28:31], v[56:71]
    buffer_store_dwordx4 v[112:115], v3, s[8:11], s18 offen offset:0 sc1
    ds_read_b128 v[24:27], v2 offset:20480
    s_waitcnt lgkmcnt(6)
    v_mfma_f32_32x32x16_bf16 v[40:55], a[112:115], v[32:35], v[40:55]
    v_cvt_pk_bf16_f32 v116, v96, v97
    v_mfma_f32_32x32x16_bf16 v[56:71], a[116:119], v[32:35], v[56:71]
    v_cvt_pk_bf16_f32 v117, v98, v99
    ds_read_b128 v[28:31], v2 offset:21504
    s_waitcnt lgkmcnt(6)
    v_mfma_f32_32x32x16_bf16 v[40:55], a[120:123], v[36:39], v[40:55]
    v_cvt_pk_bf16_f32 v118, v100, v101
    v_mfma_f32_32x32x16_bf16 v[56:71], a[124:127], v[36:39], v[56:71]
    v_cvt_pk_bf16_f32 v119, v102, v103
    ds_read_b128 v[32:35], v2 offset:22528
    s_waitcnt lgkmcnt(6)
    v_mfma_f32_32x32x16_bf16 v[40:55], a[128:131], v[8:11], v[40:55]
    s_nop 1
    v_mfma_f32_32x32x16_bf16 v[56:71], a[132:135], v[8:11], v[56:71]
    v_permlane32_swap_b32 v116, v118
    ds_read_b128 v[36:39], v2 offset:23552
    s_waitcnt lgkmcnt(6)
    v_mfma_f32_32x32x16_bf16 v[40:55], a[136:139], v[12:15], v[40:55]
    v_permlane32_swap_b32 v117, v119
    v_mfma_f32_32x32x16_bf16 v[56:71], a[140:143], v[12:15], v[56:71]
    buffer_store_dwordx4 v[116:119], v3, s[8:11], s18 offen offset:1024 sc1
    ds_read_b128 v[8:11], v2 offset:24576
    s_waitcnt lgkmcnt(6)
    v_mfma_f32_32x32x16_bf16 v[40:55], a[144:147], v[16:19], v[40:55]
    s_add_u32 s17, s17, s20
    v_mfma_f32_32x32x16_bf16 v[56:71], a[148:151], v[16:19], v[56:71]
    s_add_u32 s18, s18, s20
    ds_read_b128 v[12:15], v2 offset:25600
    s_waitcnt lgkmcnt(6)
    v_mfma_f32_32x32x16_bf16 v[40:55], a[152:155], v[20:23], v[40:55]
    v_mfma_f32_32x32x16_bf16 v[56:71], a[156:159], v[20:23], v[56:71]
    ds_read_b128 v[16:19], v2 offset:26624
    s_waitcnt lgkmcnt(6)
    v_mfma_f32_32x32x16_bf16 v[40:55], a[160:163], v[24:27], v[40:55]
    v_mfma_f32_32x32x16_bf16 v[56:71], a[164:167], v[24:27], v[56:71]
    ds_read_b128 v[20:23], v2 offset:27648
    s_waitcnt lgkmcnt(6)
    v_mfma_f32_32x32x16_bf16 v[40:55], a[168:171], v[28:31], v[40:55]
    v_mfma_f32_32x32x16_bf16 v[56:71], a[172:175], v[28:31], v[56:71]
    ds_read_b128 v[24:27], v2 offset:28672
    s_waitcnt lgkmcnt(6)
    v_mfma_f32_32x32x16_bf16 v[40:55], a[176:179], v[32:35], v[40:55]
    v_mfma_f32_32x32x16_bf16 v[56:71], a[180:183], v[32:35], v[56:71]
    ds_read_b128 v[28:31], v2 offset:29696
    s_waitcnt lgkmcnt(6)
    v_mfma_f32_32x32x16_bf16 v[40:55], a[184:187], v[36:39], v[40:55]
    v_mfma_f32_32x32x16_bf16 v[56:71], a[188:191], v[36:39], v[56:71]
    ds_read_b128 v[32:35], v2 offset:30720
    s_waitcnt lgkmcnt(6)
    v_mfma_f32_32x32x16_bf16 v[40:55], a[192:195], v[8:11], v[40:55]
    v_mfma_f32_32x32x16_bf16 v[56:71], a[196:199], v[8:11], v[56:71]
    ds_read_b128 v[36:39], v2 offset:31744
    s_waitcnt lgkmcnt(6)
    v_mfma_f32_32x32x16_bf16 v[40:55], a[200:203], v[12:15], v[40:55]
    v_mfma_f32_32x32x16_bf16 v[56:71], a[204:207], v[12:15], v[56:71]
    ds_read_b128 v[8:11], v2 offset:32768
    s_waitcnt lgkmcnt(6)
    v_mfma_f32_32x32x16_bf16 v[40:55], a[208:211], v[16:19], v[40:55]
    v_mfma_f32_32x32x16_bf16 v[56:71], a[212:215], v[16:19], v[56:71]
    ds_read_b128 v[12:15], v2 offset:33792
    s_waitcnt lgkmcnt(6)
    v_mfma_f32_32x32x16_bf16 v[40:55], a[216:219], v[20:23], v[40:55]
    v_mfma_f32_32x32x16_bf16 v[56:71], a[220:223], v[20:23], v[56:71]
    ds_read_b128 v[16:19], v2 offset:34816
    s_waitcnt lgkmcnt(6)
    v_mfma_f32_32x32x16_bf16 v[40:55], a[224:227], v[24:27], v[40:55]
    v_mfma_f32_32x32x16_bf16 v[56:71], a[228:231], v[24:27], v[56:71]
    s_add_u32 s23, s14, 2
    s_cmp_lg_u32 s13, 0
    s_cbranch_scc1 layerb1_kernel_gk_lw5
    s_min_u32 s28, s23, 63
    s_cmp_gt_u32 s56, s28
    s_cbranch_scc1 layerb1_kernel_gk_lw5
layerb1_kernel_gk_lp5:
    buffer_load_dwordx4 v[124:127], v1, s[8:11], s57 offen sc1
    s_waitcnt vmcnt(0)
    v_min_u32 v124, v124, v125
    v_min_u32 v126, v126, v127
    v_min_u32 v124, v124, v126
    v_cmp_eq_u32 vcc, 0, v124
    s_nop 1
    s_ff1_i32_b64 s56, vcc
    s_min_u32 s56, s56, 64
    s_sub_u32 s58, s58, 1
    s_cbranch_scc1 layerb1_kernel_bail
    s_cmp_gt_u32 s56, s28
    s_cbranch_scc0 layerb1_kernel_gk_lp5
layerb1_kernel_gk_lw5:
    s_cmp_gt_u32 s14, 5
    s_cbranch_scc1 layerb1_kernel_gk_dr6
    s_waitcnt vmcnt(0)
    s_mov_b32 s27, s14
    s_branch layerb1_kernel_gk_dq6
layerb1_kernel_gk_dr6:
    s_waitcnt vmcnt(4)
    s_sub_u32 s27, s14, 1
layerb1_kernel_gk_dq6:
    s_barrier
    s_cmp_lg_u32 s13, 0
    s_cbranch_scc1 layerb1_kernel_gk_fl7
    s_mov_b64 exec, 1
    s_lshl_b32 s26, s12, 7
    v_mov_b32 v7, s26
    v_mov_b32 v120, s27
    buffer_store_dword v120, v7, s[8:11], s48 offen sc1
    s_mov_b64 exec, -1
layerb1_kernel_gk_fl7:
    s_add_u32 s21, s16, 40960
    s_cmp_eq_u32 s21, 122880
    s_cselect_b32 s21, 0, s21
    s_add_u32 s23, s14, 2
    s_min_u32 s24, s23, 63
    s_mul_i32 s24, s24, 40960
    s_add_u32 s24, s24, s19
    s_mul_i32 s25, s13, 10240
    s_add_u32 s25, s25, s22
    s_add_u32 s22, s22, 40960
    s_cmp_eq_u32 s22, 122880
    s_cselect_b32 s22, 0, s22
    ds_read_b128 v[20:23], v2 offset:35840
    s_waitcnt lgkmcnt(6)
    v_mfma_f32_32x32x16_bf16 v[40:55], a[232:235], v[28:31], v[40:55]
    s_mov_b32 m0, s25
    s_nop 0
    buffer_load_dwordx4 v1, s[8:11], s24 offen offset:0 sc1 lds
    v_mfma_f32_32x32x16_bf16 v[56:71], a[236:239], v[28:31], v[56:71]
    ds_read_b128 v[24:27], v2 offset:36864
    s_waitcnt lgkmcnt(6)
    v_mfma_f32_32x32x16_bf16 v[40:55], a[240:243], v[32:35], v[40:55]
    buffer_load_dwordx4 v1, s[8:11], s24 offen offset:1024 sc1 lds
    v_mfma_f32_32x32x16_bf16 v[56:71], a[244:247], v[32:35], v[56:71]
    ds_read_b128 v[28:31], v2 offset:37888
    s_waitcnt lgkmcnt(6)
    v_mfma_f32_32x32x16_bf16 v[40:55], a[248:251], v[36:39], v[40:55]
    buffer_load_dwordx4 v1, s[8:11], s24 offen offset:2048 sc1 lds
    v_mfma_f32_32x32x16_bf16 v[56:71], a[252:255], v[36:39], v[56:71]
    ds_read_b128 v[32:35], v2 offset:38912
    s_waitcnt lgkmcnt(6)
    v_mfma_f32_32x32x16_bf16 v[40:55], v[192:195], v[8:11], v[40:55]
    buffer_load_dwordx4 v1, s[8:11], s24 offen offset:3072 sc1 lds
    v_mfma_f32_32x32x16_bf16 v[56:71], v[196:199], v[8:11], v[56:71]
    ds_read_b128 v[36:39], v2 offset:39936
    s_waitcnt lgkmcnt(6)
    v_mfma_f32_32x32x16_bf16 v[40:55], v[200:203], v[12:15], v[40:55]
    s_add_u32 s24, s24, 4096
    s_add_u32 s25, s25, 4096
    s_mov_b32 m0, s25
    s_nop 0
    buffer_load_dwordx4 v1, s[8:11], s24 offen offset:0 sc1 lds
    v_mfma_f32_32x32x16_bf16 v[56:71], v[204:207], v[12:15], v[56:71]
    v_add_u32 v6, s21, v1
    ds_read_b128 v[8:11], v6 offset:0
    s_waitcnt lgkmcnt(6)
    v_mfma_f32_32x32x16_bf16 v[40:55], v[208:211], v[16:19], v[40:55]
    buffer_load_dwordx4 v1, s[8:11], s24 offen offset:1024 sc1 lds
    v_mfma_f32_32x32x16_bf16 v[56:71], v[212:215], v[16:19], v[56:71]
    ds_read_b128 v[12:15], v6 offset:1024
    s_waitcnt lgkmcnt(6)
    v_mfma_f32_32x32x16_bf16 v[40:55], v[216:219], v[20:23], v[40:55]
    buffer_load_dwordx4 v1, s[8:11], s24 offen offset:2048 sc1 lds
    v_mfma_f32_32x32x16_bf16 v[56:71], v[220:223], v[20:23], v[56:71]
    ds_read_b128 v[16:19], v6 offset:2048
    s_waitcnt lgkmcnt(6)
    v_mfma_f32_32x32x16_bf16 v[40:55], v[224:227], v[24:27], v[40:55]
    buffer_load_dwordx4 v1, s[8:11], s24 offen offset:3072 sc1 lds
    v_mfma_f32_32x32x16_bf16 v[56:71], v[228:231], v[24:27], v[56:71]
    ds_read_b128 v[20:23], v6 offset:3072
    s_waitcnt lgkmcnt(6)
    v_mfma_f32_32x32x16_bf16 v[40:55], v[232:235], v[28:31], v[40:55]
    s_add_u32 s24, s24, 4096
    s_add_u32 s25, s25, 4096
    s_mov_b32 m0, s25
    s_nop 0
    buffer_load_dwordx4 v1, s[8:11], s24 offen offset:0 sc1 lds
    v_mfma_f32_32x32x16_bf16 v[56:71], v[236:239], v[28:31], v[56:71]
    ds_read_b128 v[24:27], v6 offset:4096
    s_waitcnt lgkmcnt(6)
    v_mfma_f32_32x32x16_bf16 v[40:55], v[240:243], v[32:35], v[40:55]
    buffer_load_dwordx4 v1, s[8:11], s24 offen offset:1024 sc1 lds
    v_mfma_f32_32x32x16_bf16 v[56:71], v[244:247], v[32:35], v[56:71]
    ds_read_b128 v[28:31], v6 offset:5120
    s_waitcnt lgkmcnt(6)
    v_mfma_f32_32x32x16_bf16 v[40:55], v[248:251], v[36:39], v[40:55]
    v_mfma_f32_32x32x16_bf16 v[56:71], v[252:255], v[36:39], v[56:71]
    v_mov_b32 v2, v6
    s_mov_b32 s16, s21
    s_add_u32 s14, s14, 1
    s_cmp_ge_u32 s14, s15
    s_cbranch_scc1 layerb1_kernel_gk_fin0
    ds_read_b128 v[32:35], v2 offset:6144
    s_waitcnt lgkmcnt(6)
    v_mfma_f32_32x32x16_bf16 v[72:87], a[0:3], v[8:11], 0
    v_mfma_f32_32x32x16_bf16 v[88:103], a[4:7], v[8:11], 0
    ds_read_b128 v[36:39], v2 offset:7168
    s_waitcnt lgkmcnt(6)
    v_mfma_f32_32x32x16_bf16 v[72:87], a[8:11], v[12:15], v[72:87]
    v_mfma_f32_32x32x16_bf16 v[88:103], a[12:15], v[12:15], v[88:103]
    ds_read_b128 v[8:11], v2 offset:8192
    s_waitcnt lgkmcnt(6)
    v_mfma_f32_32x32x16_bf16 v[72:87], a[16:19], v[16:19], v[72:87]
    v_cvt_pk_bf16_f32 v104, v40, v41
    v_mfma_f32_32x32x16_bf16 v[88:103], a[20:23], v[16:19], v[88:103]
    v_cvt_pk_bf16_f32 v105, v42, v43
    ds_read_b128 v[12:15], v2 offset:9216
    s_waitcnt lgkmcnt(6)
    v_mfma_f32_32x32x16_bf16 v[72:87], a[24:27], v[20:23], v[72:87]
    v_cvt_pk_bf16_f32 v106, v44, v45
    v_mfma_f32_32x32x16_bf16 v[88:103], a[28:31], v[20:23], v[88:103]
    v_cvt_pk_bf16_f32 v107, v46, v47
    ds_read_b128 v[16:19], v2 offset:10240
    s_waitcnt lgkmcnt(6)
    v_mfma_f32_32x32x16_bf16 v[72:87], a[32:35], v[24:27], v[72:87]
    s_nop 1
    v_mfma_f32_32x32x16_bf16 v[88:103], a[36:39], v[24:27], v[88:103]
    v_permlane32_swap_b32 v104, v106
    ds_read_b128 v[20:23], v2 offset:11264
    s_waitcnt lgkmcnt(6)
    v_mfma_f32_32x32x16_bf16 v[72:87], a[40:43], v[28:31], v[72:87]
    v_permlane32_swap_b32 v105, v107
    v_mfma_f32_32x32x16_bf16 v[88:103], a[44:47], v[28:31], v[88:103]
    buffer_store_dwordx4 v[104:107], v3, s[8:11], s17 offen offset:0 sc1
    ds_read_b128 v[24:27], v2 offset:12288
    s_waitcnt lgkmcnt(6)
    v_mfma_f32_32x32x16_bf16 v[72:87], a[48:51], v[32:35], v[72:87]
    v_cvt_pk_bf16_f32 v108, v48, v49
    v_mfma_f32_32x32x16_bf16 v[88:103], a[52:55], v[32:35], v[88:103]
    v_cvt_pk_bf16_f32 v109, v50, v51
    ds_read_b128 v[28:31], v2 offset:13312
    s_waitcnt lgkmcnt(6)
    v_mfma_f32_32x32x16_bf16 v[72:87], a[56:59], v[36:39], v[72:87]
    v_cvt_pk_bf16_f32 v110, v52, v53
    v_mfma_f32_32x32x16_bf16 v[88:103], a[60:63], v[36:39], v[88:103]
    v_cvt_pk_bf16_f32 v111, v54, v55
    ds_read_b128 v[32:35], v2 offset:14336
    s_waitcnt lgkmcnt(6)
    v_mfma_f32_32x32x16_bf16 v[72:87], a[64:67], v[8:11], v[72:87]
    s_nop 1
    v_mfma_f32_32x32x16_bf16 v[88:103], a[68:71], v[8:11], v[88:103]
    v_permlane32_swap_b32 v108, v110
    ds_read_b128 v[36:39], v2 offset:15360
    s_waitcnt lgkmcnt(6)
    v_mfma_f32_32x32x16_bf16 v[72:87], a[72:75], v[12:15], v[72:87]
    v_permlane32_swap_b32 v109, v111
    v_mfma_f32_32x32x16_bf16 v[88:103], a[76:79], v[12:15], v[88:103]
    buffer_store_dwordx4 v[108:111], v3, s[8:11], s17 offen offset:1024 sc1
    ds_read_b128 v[8:11], v2 offset:16384
    s_waitcnt lgkmcnt(6)
    v_mfma_f32_32x32x16_bf16 v[72:87], a[80:83], v[16:19], v[72:87]
    v_cvt_pk_bf16_f32 v112, v56, v57
    v_mfma_f32_32x32x16_bf16 v[88:103], a[84:87], v[16:19], v[88:103]
    v_cvt_pk_bf16_f32 v113, v58, v59
    ds_read_b128 v[12:15], v2 offset:17408
    s_waitcnt lgkmcnt(6)
    v_mfma_f32_32x32x16_bf16 v[72:87], a[88:91], v[20:23], v[72:87]
    v_cvt_pk_bf16_f32 v114, v60, v61
    v_mfma_f32_32x32x16_bf16 v[88:103], a[92:95], v[20:23], v[88:103]
    v_cvt_pk_bf16_f32 v115, v62, v63
    ds_read_b128 v[16:19], v2 offset:18432
    s_waitcnt lgkmcnt(6)
    v_mfma_f32_32x32x16_bf16 v[72:87], a[96:99], v[24:27], v[72:87]
    s_nop 1
    v_mfma_f32_32x32x16_bf16 v[88:103], a[100:103], v[24:27], v[88:103]
    v_permlane32_swap_b32 v112, v114
    ds_read_b128 v[20:23], v2 offset:19456
    s_waitcnt lgkmcnt(6)
    v_mfma_f32_32x32x16_bf16 v[72:87], a[104:107], v[28:31], v[72:87]
    v_permlane32_swap_b32 v113, v115
    v_mfma_f32_32x32x16_bf16 v[88:103], a[108:111], v[28:31], v[88:103]
    buffer_store_dwordx4 v[112:115], v3, s[8:11], s18 offen offset:0 sc1
    ds_read_b128 v[24:27], v2 offset:20480
    s_waitcnt lgkmcnt(6)
    v_mfma_f32_32x32x16_bf16 v[72:87], a[112:115], v[32:35], v[72:87]
    v_cvt_pk_bf16_f32 v116, v64, v65
    v_mfma_f32_32x32x16_bf16 v[88:103], a[116:119], v[32:35], v[88:103]
    v_cvt_pk_bf16_f32 v117, v66, v67
    ds_read_b128 v[28:31], v2 offset:21504
    s_waitcnt lgkmcnt(6)
    v_mfma_f32_32x32x16_bf16 v[72:87], a[120:123], v[36:39], v[72:87]
    v_cvt_pk_bf16_f32 v118, v68, v69
    v_mfma_f32_32x32x16_bf16 v[88:103], a[124:127], v[36:39], v[88:103]
    v_cvt_pk_bf16_f32 v119, v70, v71
    ds_read_b128 v[32:35], v2 offset:22528
    s_waitcnt lgkmcnt(6)
    v_mfma_f32_32x32x16_bf16 v[72:87], a[128:131], v[8:11], v[72:87]
    s_nop 1
    v_mfma_f32_32x32x16_bf16 v[88:103], a[132:135], v[8:11], v[88:103]
    v_permlane32_swap_b32 v116, v118
    ds_read_b128 v[36:39], v2 offset:23552
    s_waitcnt lgkmcnt(6)
    v_mfma_f32_32x32x16_bf16 v[72:87], a[136:139], v[12:15], v[72:87]
    v_permlane32_swap_b32 v117, v119
    v_mfma_f32_32x32x16_bf16 v[88:103], a[140:143], v[12:15], v[88:103]
    buffer_store_dwordx4 v[116:119], v3, s[8:11], s18 offen offset:1024 sc1
    ds_read_b128 v[8:11], v2 offset:24576
    s_waitcnt lgkmcnt(6)
    v_mfma_f32_32x32x16_bf16 v[72:87], a[144:147], v[16:19], v[72:87]
    s_add_u32 s17, s17, s20
    v_mfma_f32_32x32x16_bf16 v[88:103], a[148:151], v[16:19], v[88:103]
    s_add_u32 s18, s18, s20
    ds_read_b128 v[12:15], v2 offset:25600
    s_waitcnt lgkmcnt(6)
    v_mfma_f32_32x32x16_bf16 v[72:87], a[152:155], v[20:23], v[72:87]
    v_mfma_f32_32x32x16_bf16 v[88:103], a[156:159], v[20:23], v[88:103]
    ds_read_b128 v[16:19], v2 offset:26624
    s_waitcnt lgkmcnt(6)
    v_mfma_f32_32x32x16_bf16 v[72:87], a[160:163], v[24:27], v[72:87]
    v_mfma_f32_32x32x16_bf16 v[88:103], a[164:167], v[24:27], v[88:103]
    ds_read_b128 v[20:23], v2 offset:27648
    s_waitcnt lgkmcnt(6)
    v_mfma_f32_32x32x16_bf16 v[72:87], a[168:171], v[28:31], v[72:87]
    v_mfma_f32_32x32x16_bf16 v[88:103], a[172:175], v[28:31], v[88:103]
    ds_read_b128 v[24:27], v2 offset:28672
    s_waitcnt lgkmcnt(6)
    v_mfma_f32_32x32x16_bf16 v[72:87], a[176:179], v[32:35], v[72:87]
    v_mfma_f32_32x32x16_bf16 v[88:103], a[180:183], v[32:35], v[88:103]
    ds_read_b128 v[28:31], v2 offset:29696
    s_waitcnt lgkmcnt(6)
    v_mfma_f32_32x32x16_bf16 v[72:87], a[184:187], v[36:39], v[72:87]
    v_mfma_f32_32x32x16_bf16 v[88:103], a[188:191], v[36:39], v[88:103]
    ds_read_b128 v[32:35], v2 offset:30720
    s_waitcnt lgkmcnt(6)
    v_mfma_f32_32x32x16_bf16 v[72:87], a[192:195], v[8:11], v[72:87]
    v_mfma_f32_32x32x16_bf16 v[88:103], a[196:199], v[8:11], v[88:103]
    ds_read_b128 v[36:39], v2 offset:31744
    s_waitcnt lgkmcnt(6)
    v_mfma_f32_32x32x16_bf16 v[72:87], a[200:203], v[12:15], v[72:87]
    v_mfma_f32_32x32x16_bf16 v[88:103], a[204:207], v[12:15], v[88:103]
    ds_read_b128 v[8:11], v2 offset:32768
    s_waitcnt lgkmcnt(6)
    v_mfma_f32_32x32x16_bf16 v[72:87], a[208:211], v[16:19], v[72:87]
    v_mfma_f32_32x32x16_bf16 v[88:103], a[212:215], v[16:19], v[88:103]
    ds_read_b128 v[12:15], v2 offset:33792
    s_waitcnt lgkmcnt(6)
    v_mfma_f32_32x32x16_bf16 v[72:87], a[216:219], v[20:23], v[72:87]
    v_mfma_f32_32x32x16_bf16 v[88:103], a[220:223], v[20:23], v[88:103]
    ds_read_b128 v[16:19], v2 offset:34816
    s_waitcnt lgkmcnt(6)
    v_mfma_f32_32x32x16_bf16 v[72:87], a[224:227], v[24:27], v[72:87]
    v_mfma_f32_32x32x16_bf16 v[88:103], a[228:231], v[24:27], v[88:103]
    s_add_u32 s23, s14, 2
    s_cmp_lg_u32 s13, 0
    s_cbranch_scc1 layerb1_kernel_gk_lw8
    s_min_u32 s28, s23, 63
    s_cmp_gt_u32 s56, s28
    s_cbranch_scc1 layerb1_kernel_gk_lw8
layerb1_kernel_gk_lp8:
    buffer_load_dwordx4 v[124:127], v1, s[8:11], s57 offen sc1
    s_waitcnt vmcnt(0)
    v_min_u32 v124, v124, v125
    v_min_u32 v126, v126, v127
    v_min_u32 v124, v124, v126
    v_cmp_eq_u32 vcc, 0, v124
    s_nop 1
    s_ff1_i32_b64 s56, vcc
    s_min_u32 s56, s56, 64
    s_sub_u32 s58, s58, 1
    s_cbranch_scc1 layerb1_kernel_bail
    s_cmp_gt_u32 s56, s28
    s_cbranch_scc0 layerb1_kernel_gk_lp8
layerb1_kernel_gk_lw8:
    s_cmp_gt_u32 s14, 5
    s_cbranch_scc1 layerb1_kernel_gk_dr9
    s_waitcnt vmcnt(0)
    s_mov_b32 s27, s14
    s_branch layerb1_kernel_gk_dq9
layerb1_kernel_gk_dr9:
    s_waitcnt vmcnt(4)
    s_sub_u32 s27, s14, 1
layerb1_kernel_gk_dq9:
    s_barrier
    s_cmp_lg_u32 s13, 0
    s_cbranch_scc1 layerb1_kernel_gk_fl10
    s_mov_b64 exec, 1
    s_lshl_b32 s26, s12, 7
    v_mov_b32 v7, s26
    v_mov_b32 v120, s27
    buffer_store_dword v120, v7, s[8:11], s48 offen sc1
    s_mov_b64 exec, -1
layerb1_kernel_gk_fl10:
    s_add_u32 s21, s16, 40960
    s_cmp_eq_u32 s21, 122880
    s_cselect_b32 s21, 0, s21
    s_add_u32 s23, s14, 2
    s_min_u32 s24, s23, 63
    s_mul_i32 s24, s24, 40960
    s_add_u32 s24, s24, s19
    s_mul_i32 s25, s13, 10240
    s_add_u32 s25, s25, s22
    s_add_u32 s22, s22, 40960
    s_cmp_eq_u32 s22, 122880
    s_cselect_b32 s22, 0, s22
    ds_read_b128 v[20:23], v2 offset:35840
    s_waitcnt lgkmcnt(6)
    v_mfma_f32_32x32x16_bf16 v[72:87], a[232:235], v[28:31], v[72:87]
    s_mov_b32 m0, s25
    s_nop 0
    buffer_load_dwordx4 v1, s[8:11], s24 offen offset:0 sc1 lds
    v_mfma_f32_32x32x16_bf16 v[88:103], a[236:239], v[28:31], v[88:103]
    ds_read_b128 v[24:27], v2 offset:36864
    s_waitcnt lgkmcnt(6)
    v_mfma_f32_32x32x16_bf16 v[72:87], a[240:243], v[32:35], v[72:87]
    buffer_load_dwordx4 v1, s[8:11], s24 offen offset:1024 sc1 lds
    v_mfma_f32_32x32x16_bf16 v[88:103], a[244:247], v[32:35], v[88:103]
    ds_read_b128 v[28:31], v2 offset:37888
    s_waitcnt lgkmcnt(6)
    v_mfma_f32_32x32x16_bf16 v[72:87], a[248:251], v[36:39], v[72:87]
    buffer_load_dwordx4 v1, s[8:11], s24 offen offset:2048 sc1 lds
    v_mfma_f32_32x32x16_bf16 v[88:103], a[252:255], v[36:39], v[88:103]
    ds_read_b128 v[32:35], v2 offset:38912
    s_waitcnt lgkmcnt(6)
    v_mfma_f32_32x32x16_bf16 v[72:87], v[192:195], v[8:11], v[72:87]
    buffer_load_dwordx4 v1, s[8:11], s24 offen offset:3072 sc1 lds
    v_mfma_f32_32x32x16_bf16 v[88:103], v[196:199], v[8:11], v[88:103]
    ds_read_b128 v[36:39], v2 offset:39936
    s_waitcnt lgkmcnt(6)
    v_mfma_f32_32x32x16_bf16 v[72:87], v[200:203], v[12:15], v[72:87]
    s_add_u32 s24, s24, 4096
    s_add_u32 s25, s25, 4096
    s_mov_b32 m0, s25
    s_nop 0
    buffer_load_dwordx4 v1, s[8:11], s24 offen offset:0 sc1 lds
    v_mfma_f32_32x32x16_bf16 v[88:103], v[204:207], v[12:15], v[88:103]
    v_add_u32 v6, s21, v1
    ds_read_b128 v[8:11], v6 offset:0
    s_waitcnt lgkmcnt(6)
    v_mfma_f32_32x32x16_bf16 v[72:87], v[208:211], v[16:19], v[72:87]
    buffer_load_dwordx4 v1, s[8:11], s24 offen offset:1024 sc1 lds
    v_mfma_f32_32x32x16_bf16 v[88:103], v[212:215], v[16:19], v[88:103]
    ds_read_b128 v[12:15], v6 offset:1024
    s_waitcnt lgkmcnt(6)
    v_mfma_f32_32x32x16_bf16 v[72:87], v[216:219], v[20:23], v[72:87]
    buffer_load_dwordx4 v1, s[8:11], s24 offen offset:2048 sc1 lds
    v_mfma_f32_32x32x16_bf16 v[88:103], v[220:223], v[20:23], v[88:103]
    ds_read_b128 v[16:19], v6 offset:2048
    s_waitcnt lgkmcnt(6)
    v_mfma_f32_32x32x16_bf16 v[72:87], v[224:227], v[24:27], v[72:87]
    buffer_load_dwordx4 v1, s[8:11], s24 offen offset:3072 sc1 lds
    v_mfma_f32_32x32x16_bf16 v[88:103], v[228:231], v[24:27], v[88:103]
    ds_read_b128 v[20:23], v6 offset:3072
    s_waitcnt lgkmcnt(6)
    v_mfma_f32_32x32x16_bf16 v[72:87], v[232:235], v[28:31], v[72:87]
    s_add_u32 s24, s24, 4096
    s_add_u32 s25, s25, 4096
    s_mov_b32 m0, s25
    s_nop 0
    buffer_load_dwordx4 v1, s[8:11], s24 offen offset:0 sc1 lds
    v_mfma_f32_32x32x16_bf16 v[88:103], v[236:239], v[28:31], v[88:103]
    ds_read_b128 v[24:27], v6 offset:4096
    s_waitcnt lgkmcnt(6)
    v_mfma_f32_32x32x16_bf16 v[72:87], v[240:243], v[32:35], v[72:87]
    buffer_load_dwordx4 v1, s[8:11], s24 offen offset:1024 sc1 lds
    v_mfma_f32_32x32x16_bf16 v[88:103], v[244:247], v[32:35], v[88:103]
    ds_read_b128 v[28:31], v6 offset:5120
    s_waitcnt lgkmcnt(6)
    v_mfma_f32_32x32x16_bf16 v[72:87], v[248:251], v[36:39], v[72:87]
    v_mfma_f32_32x32x16_bf16 v[88:103], v[252:255], v[36:39], v[88:103]
    v_mov_b32 v2, v6
    s_mov_b32 s16, s21
    s_add_u32 s14, s14, 1
    s_cmp_lt_u32 s14, s15
    s_cbranch_scc1 layerb1_kernel_gk_loop
    s_branch layerb1_kernel_gk_fin1
layerb1_kernel_gk_fin0:
    s_nop 7
    s_nop 7
    v_cvt_pk_bf16_f32 v104, v40, v41
    v_cvt_pk_bf16_f32 v105, v42, v43
    v_cvt_pk_bf16_f32 v106, v44, v45
    v_cvt_pk_bf16_f32 v107, v46, v47
    s_nop 1
    v_permlane32_swap_b32 v104, v106
    v_permlane32_swap_b32 v105, v107
    buffer_store_dwordx4 v[104:107], v3, s[8:11], s17 offen offset:0 sc1
    v_cvt_pk_bf16_f32 v108, v48, v49
    v_cvt_pk_bf16_f32 v109, v50, v51
    v_cvt_pk_bf16_f32 v110, v52, v53
    v_cvt_pk_bf16_f32 v111, v54, v55
    s_nop 1
    v_permlane32_swap_b32 v108, v110
    v_permlane32_swap_b32 v109, v111
    buffer_store_dwordx4 v[108:111], v3, s[8:11], s17 offen offset:1024 sc1
    v_cvt_pk_bf16_f32 v112, v56, v57
    v_cvt_pk_bf16_f32 v113, v58, v59
    v_cvt_pk_bf16_f32 v114, v60, v61
    v_cvt_pk_bf16_f32 v115, v62, v63
    s_nop 1
    v_permlane32_swap_b32 v112, v114
    v_permlane32_swap_b32 v113, v115
    buffer_store_dwordx4 v[112:115], v3, s[8:11], s18 offen offset:0 sc1
    v_cvt_pk_bf16_f32 v116, v64, v65
    v_cvt_pk_bf16_f32 v117, v66, v67
    v_cvt_pk_bf16_f32 v118, v68, v69
    v_cvt_pk_bf16_f32 v119, v70, v71
    s_nop 1
    v_permlane32_swap_b32 v116, v118
    v_permlane32_swap_b32 v117, v119
    buffer_store_dwordx4 v[116:119], v3, s[8:11], s18 offen offset:1024 sc1
    s_add_u32 s17, s17, s20
    s_add_u32 s18, s18, s20
    s_branch layerb1_kernel_gk_done
layerb1_kernel_gk_fin1:
    s_nop 7
    s_nop 7
    v_cvt_pk_bf16_f32 v104, v72, v73
    v_cvt_pk_bf16_f32 v105, v74, v75
    v_cvt_pk_bf16_f32 v106, v76, v77
    v_cvt_pk_bf16_f32 v107, v78, v79
    s_nop 1
    v_permlane32_swap_b32 v104, v106
    v_permlane32_swap_b32 v105, v107
    buffer_store_dwordx4 v[104:107], v3, s[8:11], s17 offen offset:0 sc1
    v_cvt_pk_bf16_f32 v108, v80, v81
    v_cvt_pk_bf16_f32 v109, v82, v83
    v_cvt_pk_bf16_f32 v110, v84, v85
    v_cvt_pk_bf16_f32 v111, v86, v87
    s_nop 1
    v_permlane32_swap_b32 v108, v110
    v_permlane32_swap_b32 v109, v111
    buffer_store_dwordx4 v[108:111], v3, s[8:11], s17 offen offset:1024 sc1
    v_cvt_pk_bf16_f32 v112, v88, v89
    v_cvt_pk_bf16_f32 v113, v90, v91
    v_cvt_pk_bf16_f32 v114, v92, v93
    v_cvt_pk_bf16_f32 v115, v94, v95
    s_nop 1
    v_permlane32_swap_b32 v112, v114
    v_permlane32_swap_b32 v113, v115
    buffer_store_dwordx4 v[112:115], v3, s[8:11], s18 offen offset:0 sc1
    v_cvt_pk_bf16_f32 v116, v96, v97
    v_cvt_pk_bf16_f32 v117, v98, v99
    v_cvt_pk_bf16_f32 v118, v100, v101
    v_cvt_pk_bf16_f32 v119, v102, v103
    s_nop 1
    v_permlane32_swap_b32 v116, v118
    v_permlane32_swap_b32 v117, v119
    buffer_store_dwordx4 v[116:119], v3, s[8:11], s18 offen offset:1024 sc1
    s_add_u32 s17, s17, s20
    s_add_u32 s18, s18, s20
layerb1_kernel_gk_done:
    s_waitcnt vmcnt(0) lgkmcnt(0)
    s_barrier
    s_cmp_lg_u32 s13, 0
    s_cbranch_scc1 layerb1_kernel_gk_fl11
    s_mov_b64 exec, 1
    s_lshl_b32 s26, s12, 7
    v_mov_b32 v7, s26
    v_mov_b32 v120, s14
    buffer_store_dword v120, v7, s[8:11], s48 offen sc1
    s_mov_b64 exec, -1
layerb1_kernel_gk_fl11:
layerb1_kernel_g_done:
    s_branch layerb1_kernel_w3
layerb1_kernel_spare:
    s_sub_u32 s22, s20, 1
    s_mul_i32 s22, s22, 5
    s_add_u32 s22, s22, s21
    s_sub_u32 s22, s22, 27
    s_cmp_ge_u32 s21, 27
    s_cselect_b32 s22, s22, 15
    s_cmp_lt_u32 s22, 5
    s_cbranch_scc1 layerb1_kernel_sp_ab
    s_cmp_lt_u32 s22, 9
    s_cbranch_scc1 layerb1_kernel_sp_ln
    s_cmp_eq_u32 s22, 9
    s_cbranch_scc0 layerb1_kernel_w3
    s_load_dwordx2 s[24:25], s[0:1], 32
    s_lshl_b32 s26, s13, 6
    v_add_u32 v1, s26, v0
    s_waitcnt lgkmcnt(0)
    s_mov_b32 s28, s24
    s_mov_b32 s29, s25
    s_mov_b32 s30, 10240
    s_mov_b32 s31, 0x00020000
    v_add_u32 v2, 0, v1
    v_and_b32 v3, 7, v2
    v_mul_u32_u24 v3, 1280, v3
    v_lshrrev_b32 v4, 3, v2
    v_lshl_add_u32 v3, v4, 4, v3
    v_lshlrev_b32 v5, 4, v2
    v_add_u32 v5, 20480, v5
    v_lshrrev_b32 v6, 13, v5
    v_lshlrev_b32 v6, 14, v6
    v_and_b32 v5, 8191, v5
    v_add_u32 v5, v5, v6
    v_cmp_gt_u32 vcc, 640, v2
    s_and_saveexec_b64 s[32:33], vcc
    s_cbranch_execz layerb1_kernel_m0s0
    buffer_load_dwordx4 v[8:11], v3, s[28:31], 0 offen
    s_waitcnt vmcnt(0)
    buffer_store_dwordx4 v[8:11], v5, s[8:11], s16 offen sc1
layerb1_kernel_m0s0:
    s_mov_b64 exec, s[32:33]
    v_add_u32 v2, 256, v1
    v_and_b32 v3, 7, v2
    v_mul_u32_u24 v3, 1280, v3
    v_lshrrev_b32 v4, 3, v2
    v_lshl_add_u32 v3, v4, 4, v3
    v_lshlrev_b32 v5, 4, v2
    v_add_u32 v5, 20480, v5
    v_lshrrev_b32 v6, 13, v5
    v_lshlrev_b32 v6, 14, v6
    v_and_b32 v5, 8191, v5
    v_add_u32 v5, v5, v6
    v_cmp_gt_u32 vcc, 640, v2
    s_and_saveexec_b64 s[32:33], vcc
    s_cbranch_execz layerb1_kernel_m0s1
    buffer_load_dwordx4 v[8:11], v3, s[28:31], 0 offen
    s_waitcnt vmcnt(0)
    buffer_store_dwordx4 v[8:11], v5, s[8:11], s16 offen sc1
layerb1_kernel_m0s1:
    s_mov_b64 exec, s[32:33]
    v_add_u32 v2, 512, v1
    v_and_b32 v3, 7, v2
    v_mul_u32_u24 v3, 1280, v3
    v_lshrrev_b32 v4, 3, v2
    v_lshl_add_u32 v3, v4, 4, v3
    v_lshlrev_b32 v5, 4, v2
    v_add_u32 v5, 20480, v5
    v_lshrrev_b32 v6, 13, v5
    v_lshlrev_b32 v6, 14, v6
    v_and_b32 v5, 8191, v5
    v_add_u32 v5, v5, v6
    v_cmp_gt_u32 vcc, 640, v2
    s_and_saveexec_b64 s[32:33], vcc
    s_cbranch_execz layerb1_kernel_m0s2
    buffer_load_dwordx4 v[8:11], v3, s[28:31], 0 offen
    s_waitcnt vmcnt(0)
    buffer_store_dwordx4 v[8:11], v5, s[8:11], s16 offen sc1
layerb1_kernel_m0s2:
    s_mov_b64 exec, s[32:33]
    s_waitcnt vmcnt(0)
    s_branch layerb1_kernel_w3
layerb1_kernel_sp_ab:
    s_mov_b32 s12, s22
    s_mov_b32 s14, 0
    s_mov_b32 s15, 64
    s_load_dwordx2 s[52:53], s[0:1], 0
    v_lshlrev_b32 v1, 4, v0
    s_lshl_b32 s21, s12, 2
    s_add_u32 s21, s21, s13
    s_add_u32 s24, s4, 247463936
    s_addc_u32 s25, s5, 0
    s_waitcnt lgkmcnt(0)
    s_cmp_eq_u32 s49, 0
    s_cselect_b32 s52, s52, s24
    s_cselect_b32 s53, s53, s25
    s_mov_b32 s54, 2621440
    s_mov_b32 s55, 0x00020000
    v_and_b32 v6, 31, v0
    v_lshrrev_b32 v7, 5, v0
    v_mul_u32_u24 v6, 1280, v6
    v_lshl_add_u32 v3, v7, 4, v6
    s_mul_i32 s19, s14, 40960
    s_lshl_b32 s24, s21, 6
    s_add_u32 s19, s19, s24
    s_lshl_b32 s20, s14, 7
    s_lshl_b32 s24, s21, 2
    s_add_u32 s20, s20, s24
    s_add_u32 s20, s20, 36864
    v_mov_b32 v5, 1
    v_mov_b32 v4, 0
    s_mul_i32 s18, s13, 10240
    s_add_u32 s18, s18, 229638144
    s_mov_b32 s17, 0
    buffer_load_dwordx4 v[96:99], v3, s[52:55], s19 offen offset:0
    buffer_load_dwordx4 v[100:103], v3, s[52:55], s19 offen offset:32
    s_mul_i32 s24, s21, 40960
    s_add_u32 s24, s24, 246415360
    s_add_u32 s24, s24, 4096
    s_add_u32 s24, s24, 4096
    s_add_u32 s24, s24, 4096
    s_add_u32 s24, s24, 4096
    s_add_u32 s24, s24, 4096
    s_add_u32 s24, s24, 4096
    s_add_u32 s24, s24, 4096
    s_add_u32 s24, s24, 4096
    s_add_u32 s24, s24, 4096
    s_mov_b32 s22, 0
    s_mov_b32 s30, 400000
    s_add_u32 s29, s48, 49152
    v_lshlrev_b32 v112, 3, v0
    s_cmp_lg_u32 s13, 0
    s_cbranch_scc1 layerb1_kernel_ab_ow1
    s_min_u32 s28, s14, 63
    s_cmp_gt_u32 s22, s28
    s_cbranch_scc1 layerb1_kernel_ab_ow1
layerb1_kernel_ab_op1:
    buffer_load_dwordx4 v[116:119], v1, s[8:11], s29 offen sc1
    s_waitcnt vmcnt(0)
    v_min_u32 v116, v116, v117
    v_min_u32 v118, v118, v119
    v_min_u32 v114, v116, v118
    v_cmp_eq_u32 vcc, 0, v114
    s_nop 1
    s_ff1_i32_b64 s22, vcc
    s_min_u32 s22, s22, 64
    s_and_b32 s22, s22, 0x7c
    s_sub_u32 s30, s30, 1
    s_cbranch_scc1 layerb1_kernel_bail
    s_cmp_gt_u32 s22, s28
    s_cbranch_scc0 layerb1_kernel_ab_op1
layerb1_kernel_ab_ow1:
    s_barrier
    s_min_u32 s24, s14, 63
    s_mul_i32 s24, s24, 40960
    s_add_u32 s24, s24, s18
    s_mul_i32 s25, s13, 10240
    s_add_u32 s25, s25, s17
    s_mov_b32 m0, s25
    s_nop 0
    buffer_load_dwordx4 v1, s[8:11], s24 offen offset:0 sc1 lds
    buffer_load_dwordx4 v1, s[8:11], s24 offen offset:1024 sc1 lds
    buffer_load_dwordx4 v1, s[8:11], s24 offen offset:2048 sc1 lds
    buffer_load_dwordx4 v1, s[8:11], s24 offen offset:3072 sc1 lds
    s_add_u32 s24, s24, 4096
    s_add_u32 s25, s25, 4096
    s_mov_b32 m0, s25
    s_nop 0
    buffer_load_dwordx4 v1, s[8:11], s24 offen offset:0 sc1 lds
    buffer_load_dwordx4 v1, s[8:11], s24 offen offset:1024 sc1 lds
    buffer_load_dwordx4 v1, s[8:11], s24 offen offset:2048 sc1 lds
    buffer_load_dwordx4 v1, s[8:11], s24 offen offset:3072 sc1 lds
    s_add_u32 s24, s24, 4096
    s_add_u32 s25, s25, 4096
    s_mov_b32 m0, s25
    s_nop 0
    buffer_load_dwordx4 v1, s[8:11], s24 offen offset:0 sc1 lds
    buffer_load_dwordx4 v1, s[8:11], s24 offen offset:1024 sc1 lds
    s_mov_b32 s17, 40960
    s_add_u32 s23, s14, 1
    s_cmp_lg_u32 s13, 0
    s_cbranch_scc1 layerb1_kernel_ab_ow2
    s_min_u32 s28, s23, 63
    s_cmp_gt_u32 s22, s28
    s_cbranch_scc1 layerb1_kernel_ab_ow2
layerb1_kernel_ab_op2:
    buffer_load_dwordx4 v[116:119], v1, s[8:11], s29 offen sc1
    s_waitcnt vmcnt(0)
    v_min_u32 v116, v116, v117
    v_min_u32 v118, v118, v119
    v_min_u32 v114, v116, v118
    v_cmp_eq_u32 vcc, 0, v114
    s_nop 1
    s_ff1_i32_b64 s22, vcc
    s_min_u32 s22, s22, 64
    s_and_b32 s22, s22, 0x7c
    s_sub_u32 s30, s30, 1
    s_cbranch_scc1 layerb1_kernel_bail
    s_cmp_gt_u32 s22, s28
    s_cbranch_scc0 layerb1_kernel_ab_op2
layerb1_kernel_ab_ow2:
    s_barrier
    s_min_u32 s24, s23, 63
    s_mul_i32 s24, s24, 40960
    s_add_u32 s24, s24, s18
    s_mul_i32 s25, s13, 10240
    s_add_u32 s25, s25, s17
    s_mov_b32 m0, s25
    s_nop 0
    buffer_load_dwordx4 v1, s[8:11], s24 offen offset:0 sc1 lds
    buffer_load_dwordx4 v1, s[8:11], s24 offen offset:1024 sc1 lds
    buffer_load_dwordx4 v1, s[8:11], s24 offen offset:2048 sc1 lds
    buffer_load_dwordx4 v1, s[8:11], s24 offen offset:3072 sc1 lds
    s_add_u32 s24, s24, 4096
    s_add_u32 s25, s25, 4096
    s_mov_b32 m0, s25
    s_nop 0
    buffer_load_dwordx4 v1, s[8:11], s24 offen offset:0 sc1 lds
    buffer_load_dwordx4 v1, s[8:11], s24 offen offset:1024 sc1 lds
    buffer_load_dwordx4 v1, s[8:11], s24 offen offset:2048 sc1 lds
    buffer_load_dwordx4 v1, s[8:11], s24 offen offset:3072 sc1 lds
    s_add_u32 s24, s24, 4096
    s_add_u32 s25, s25, 4096
    s_mov_b32 m0, s25
    s_nop 0
    buffer_load_dwordx4 v1, s[8:11], s24 offen offset:0 sc1 lds
    buffer_load_dwordx4 v1, s[8:11], s24 offen offset:1024 sc1 lds
    s_mov_b32 s17, 81920
    s_mov_b32 s16, 0
    s_waitcnt vmcnt(10)
    s_add_u32 s23, s14, 2
    s_cmp_lg_u32 s13, 0
    s_cbranch_scc1 layerb1_kernel_ab_ow3
    s_min_u32 s28, s23, 63
    s_cmp_gt_u32 s22, s28
    s_cbranch_scc1 layerb1_kernel_ab_ow3
layerb1_kernel_ab_op3:
    buffer_load_dwordx4 v[116:119], v1, s[8:11], s29 offen sc1
    s_waitcnt vmcnt(0)
    v_min_u32 v116, v116, v117
    v_min_u32 v118, v118, v119
    v_min_u32 v114, v116, v118
    v_cmp_eq_u32 vcc, 0, v114
    s_nop 1
    s_ff1_i32_b64 s22, vcc
    s_min_u32 s22, s22, 64
    s_and_b32 s22, s22, 0x7c
    s_sub_u32 s30, s30, 1
    s_cbranch_scc1 layerb1_kernel_bail
    s_cmp_gt_u32 s22, s28
    s_cbranch_scc0 layerb1_kernel_ab_op3
layerb1_kernel_ab_ow3:
    s_barrier
    v_add_u32 v2, s16, v1
    ds_read_b128 v[16:19], v2 offset:0
    ds_read_b128 v[20:23], v2 offset:1024
    ds_read_b128 v[24:27], v2 offset:2048
    ds_read_b128 v[28:31], v2 offset:3072
    ds_read_b128 v[32:35], v2 offset:4096
    ds_read_b128 v[36:39], v2 offset:5120
    s_add_u32 s27, s19, 40960
    s_cmp_ge_u32 s14, 63
    s_cselect_b32 s27, s19, s27
    buffer_load_dwordx4 v[104:107], v3, s[52:55], s27 offen offset:0
    buffer_load_dwordx4 v[108:111], v3, s[52:55], s27 offen offset:32
    s_add_u32 s23, s14, 2
    s_min_u32 s24, s23, 63
    s_mul_i32 s24, s24, 40960
    s_add_u32 s24, s24, s18
    s_mul_i32 s25, s13, 10240
    s_add_u32 s25, s25, s17
    s_add_u32 s17, s17, 40960
    s_cmp_eq_u32 s17, 122880
    s_cselect_b32 s17, 0, s17
    ds_read_b128 v[40:43], v2 offset:6144
    s_waitcnt lgkmcnt(6)
    v_mfma_f32_32x32x16_bf16 v[48:63], a[0:3], v[16:19], 0
    ds_read_b128 v[44:47], v2 offset:7168
    s_waitcnt lgkmcnt(6)
    v_mfma_f32_32x32x16_bf16 v[64:79], a[4:7], v[20:23], 0
    s_mov_b32 m0, s25
    s_nop 0
    buffer_load_dwordx4 v1, s[8:11], s24 offen offset:0 sc1 lds
    ds_read_b128 v[16:19], v2 offset:8192
    s_waitcnt lgkmcnt(6)
    v_mfma_f32_32x32x16_bf16 v[48:63], a[8:11], v[24:27], v[48:63]
    ds_read_b128 v[20:23], v2 offset:9216
    s_waitcnt lgkmcnt(6)
    v_mfma_f32_32x32x16_bf16 v[64:79], a[12:15], v[28:31], v[64:79]
    ds_read_b128 v[24:27], v2 offset:10240
    s_waitcnt lgkmcnt(6)
    v_mfma_f32_32x32x16_bf16 v[48:63], a[16:19], v[32:35], v[48:63]
    buffer_load_dwordx4 v1, s[8:11], s24 offen offset:1024 sc1 lds
    ds_read_b128 v[28:31], v2 offset:11264
    s_waitcnt lgkmcnt(6)
    v_mfma_f32_32x32x16_bf16 v[64:79], a[20:23], v[36:39], v[64:79]
    ds_read_b128 v[32:35], v2 offset:12288
    s_waitcnt lgkmcnt(6)
    v_mfma_f32_32x32x16_bf16 v[48:63], a[24:27], v[40:43], v[48:63]
    ds_read_b128 v[36:39], v2 offset:13312
    s_waitcnt lgkmcnt(6)
    v_mfma_f32_32x32x16_bf16 v[64:79], a[28:31], v[44:47], v[64:79]
    buffer_load_dwordx4 v1, s[8:11], s24 offen offset:2048 sc1 lds
    ds_read_b128 v[40:43], v2 offset:14336
    s_waitcnt lgkmcnt(6)
    v_mfma_f32_32x32x16_bf16 v[48:63], a[32:35], v[16:19], v[48:63]
    ds_read_b128 v[44:47], v2 offset:15360
    s_waitcnt lgkmcnt(6)
    v_mfma_f32_32x32x16_bf16 v[64:79], a[36:39], v[20:23], v[64:79]
    ds_read_b128 v[16:19], v2 offset:16384
    s_waitcnt lgkmcnt(6)
    v_mfma_f32_32x32x16_bf16 v[48:63], a[40:43], v[24:27], v[48:63]
    buffer_load_dwordx4 v1, s[8:11], s24 offen offset:3072 sc1 lds
    ds_read_b128 v[20:23], v2 offset:17408
    s_waitcnt lgkmcnt(6)
    v_mfma_f32_32x32x16_bf16 v[64:79], a[44:47], v[28:31], v[64:79]
    ds_read_b128 v[24:27], v2 offset:18432
    s_waitcnt lgkmcnt(6)
    v_mfma_f32_32x32x16_bf16 v[48:63], a[48:51], v[32:35], v[48:63]
    ds_read_b128 v[28:31], v2 offset:19456
    s_waitcnt lgkmcnt(6)
    v_mfma_f32_32x32x16_bf16 v[64:79], a[52:55], v[36:39], v[64:79]
    s_add_u32 s24, s24, 4096
    s_add_u32 s25, s25, 4096
    s_mov_b32 m0, s25
    s_nop 0
    buffer_load_dwordx4 v1, s[8:11], s24 offen offset:0 sc1 lds
    ds_read_b128 v[32:35], v2 offset:20480
    s_waitcnt lgkmcnt(6)
    v_mfma_f32_32x32x16_bf16 v[48:63], a[56:59], v[40:43], v[48:63]
    ds_read_b128 v[36:39], v2 offset:21504
    s_waitcnt lgkmcnt(6)
    v_mfma_f32_32x32x16_bf16 v[64:79], a[60:63], v[44:47], v[64:79]
    ds_read_b128 v[40:43], v2 offset:22528
    s_waitcnt lgkmcnt(6)
    v_mfma_f32_32x32x16_bf16 v[48:63], a[64:67], v[16:19], v[48:63]
    buffer_load_dwordx4 v1, s[8:11], s24 offen offset:1024 sc1 lds
    ds_read_b128 v[44:47], v2 offset:23552
    s_waitcnt lgkmcnt(6)
    v_mfma_f32_32x32x16_bf16 v[64:79], a[68:71], v[20:23], v[64:79]
    ds_read_b128 v[16:19], v2 offset:24576
    s_waitcnt lgkmcnt(6)
    v_mfma_f32_32x32x16_bf16 v[48:63], a[72:75], v[24:27], v[48:63]
    ds_read_b128 v[20:23], v2 offset:25600
    s_waitcnt lgkmcnt(6)
    v_mfma_f32_32x32x16_bf16 v[64:79], a[76:79], v[28:31], v[64:79]
    buffer_load_dwordx4 v1, s[8:11], s24 offen offset:2048 sc1 lds
    ds_read_b128 v[24:27], v2 offset:26624
    s_waitcnt lgkmcnt(6)
    v_mfma_f32_32x32x16_bf16 v[48:63], a[80:83], v[32:35], v[48:63]
    ds_read_b128 v[28:31], v2 offset:27648
    s_waitcnt lgkmcnt(6)
    v_mfma_f32_32x32x16_bf16 v[64:79], a[84:87], v[36:39], v[64:79]
    ds_read_b128 v[32:35], v2 offset:28672
    s_waitcnt lgkmcnt(6)
    v_mfma_f32_32x32x16_bf16 v[48:63], a[88:91], v[40:43], v[48:63]
    buffer_load_dwordx4 v1, s[8:11], s24 offen offset:3072 sc1 lds
    ds_read_b128 v[36:39], v2 offset:29696
    s_waitcnt lgkmcnt(6)
    v_mfma_f32_32x32x16_bf16 v[64:79], a[92:95], v[44:47], v[64:79]
    ds_read_b128 v[40:43], v2 offset:30720
    s_waitcnt lgkmcnt(6)
    v_mfma_f32_32x32x16_bf16 v[48:63], a[96:99], v[16:19], v[48:63]
    ds_read_b128 v[44:47], v2 offset:31744
    s_waitcnt lgkmcnt(6)
    v_mfma_f32_32x32x16_bf16 v[64:79], a[100:103], v[20:23], v[64:79]
    s_add_u32 s24, s24, 4096
    s_add_u32 s25, s25, 4096
    s_mov_b32 m0, s25
    s_nop 0
    buffer_load_dwordx4 v1, s[8:11], s24 offen offset:0 sc1 lds
    ds_read_b128 v[16:19], v2 offset:32768
    s_waitcnt lgkmcnt(6)
    v_mfma_f32_32x32x16_bf16 v[48:63], a[104:107], v[24:27], v[48:63]
    ds_read_b128 v[20:23], v2 offset:33792
    s_waitcnt lgkmcnt(6)
    v_mfma_f32_32x32x16_bf16 v[64:79], a[108:111], v[28:31], v[64:79]
    ds_read_b128 v[24:27], v2 offset:34816
    s_waitcnt lgkmcnt(6)
    v_mfma_f32_32x32x16_bf16 v[48:63], a[112:115], v[32:35], v[48:63]
    buffer_load_dwordx4 v1, s[8:11], s24 offen offset:1024 sc1 lds
    ds_read_b128 v[28:31], v2 offset:35840
    s_waitcnt lgkmcnt(6)
    v_mfma_f32_32x32x16_bf16 v[64:79], a[116:119], v[36:39], v[64:79]
    ds_read_b128 v[32:35], v2 offset:36864
    s_waitcnt lgkmcnt(6)
    v_mfma_f32_32x32x16_bf16 v[48:63], a[120:123], v[40:43], v[48:63]
    ds_read_b128 v[36:39], v2 offset:37888
    s_waitcnt lgkmcnt(6)
    v_mfma_f32_32x32x16_bf16 v[64:79], a[124:127], v[44:47], v[64:79]
    ds_read_b128 v[40:43], v2 offset:38912
    s_waitcnt lgkmcnt(6)
    v_mfma_f32_32x32x16_bf16 v[48:63], a[128:131], v[16:19], v[48:63]
    ds_read_b128 v[44:47], v2 offset:39936
    s_waitcnt lgkmcnt(6)
    v_mfma_f32_32x32x16_bf16 v[64:79], a[132:135], v[20:23], v[64:79]
    s_waitcnt lgkmcnt(5)
    v_mfma_f32_32x32x16_bf16 v[48:63], a[136:139], v[24:27], v[48:63]
    s_waitcnt lgkmcnt(4)
    v_mfma_f32_32x32x16_bf16 v[64:79], a[140:143], v[28:31], v[64:79]
    s_waitcnt lgkmcnt(3)
    v_mfma_f32_32x32x16_bf16 v[48:63], a[144:147], v[32:35], v[48:63]
    s_waitcnt lgkmcnt(2)
    v_mfma_f32_32x32x16_bf16 v[64:79], a[148:151], v[36:39], v[64:79]
    s_waitcnt lgkmcnt(1)
    v_mfma_f32_32x32x16_bf16 v[48:63], a[152:155], v[40:43], v[48:63]
    s_waitcnt lgkmcnt(0)
    v_mfma_f32_32x32x16_bf16 v[64:79], a[156:159], v[44:47], v[64:79]
    s_waitcnt vmcnt(12)
    s_nop 7
    s_nop 3
    v_add_f32 v48, v48, v64
    v_add_f32 v49, v49, v65
    v_add_f32 v50, v50, v66
    v_add_f32 v51, v51, v67
    v_add_f32 v52, v52, v68
    v_add_f32 v53, v53, v69
    v_add_f32 v54, v54, v70
    v_add_f32 v55, v55, v71
    v_add_f32 v56, v56, v72
    v_add_f32 v57, v57, v73
    v_add_f32 v58, v58, v74
    v_add_f32 v59, v59, v75
    v_add_f32 v60, v60, v76
    v_add_f32 v61, v61, v77
    v_add_f32 v62, v62, v78
    v_add_f32 v63, v63, v79
    s_add_u32 s26, s19, 226492416
    v_cvt_pk_bf16_f32 v80, v48, v49
    v_cvt_pk_bf16_f32 v81, v50, v51
    v_cvt_pk_bf16_f32 v82, v52, v53
    v_cvt_pk_bf16_f32 v83, v54, v55
    s_nop 1
    v_permlane32_swap_b32 v80, v82
    v_permlane32_swap_b32 v81, v83
    s_nop 1
    v_lshlrev_b32 v88, 16, v80
    v_and_b32 v89, 0xffff0000, v80
    v_lshlrev_b32 v90, 16, v96
    v_and_b32 v91, 0xffff0000, v96
    v_add_f32 v88, v88, v90
    v_add_f32 v89, v89, v91
    v_cvt_pk_bf16_f32 v80, v88, v89
    v_lshlrev_b32 v92, 16, v81
    v_and_b32 v93, 0xffff0000, v81
    v_lshlrev_b32 v94, 16, v97
    v_and_b32 v95, 0xffff0000, v97
    v_add_f32 v92, v92, v94
    v_add_f32 v93, v93, v95
    v_cvt_pk_bf16_f32 v81, v92, v93
    v_lshlrev_b32 v88, 16, v82
    v_and_b32 v89, 0xffff0000, v82
    v_lshlrev_b32 v90, 16, v98
    v_and_b32 v91, 0xffff0000, v98
    v_add_f32 v88, v88, v90
    v_add_f32 v89, v89, v91
    v_cvt_pk_bf16_f32 v82, v88, v89
    v_lshlrev_b32 v92, 16, v83
    v_and_b32 v93, 0xffff0000, v83
    v_lshlrev_b32 v94, 16, v99
    v_and_b32 v95, 0xffff0000, v99
    v_add_f32 v92, v92, v94
    v_add_f32 v93, v93, v95
    v_cvt_pk_bf16_f32 v83, v92, v93
    buffer_store_dwordx4 v[80:83], v3, s[8:11], s26 offen offset:0 sc1
    v_cvt_pk_bf16_f32 v84, v56, v57
    v_cvt_pk_bf16_f32 v85, v58, v59
    v_cvt_pk_bf16_f32 v86, v60, v61
    v_cvt_pk_bf16_f32 v87, v62, v63
    s_nop 1
    v_permlane32_swap_b32 v84, v86
    v_permlane32_swap_b32 v85, v87
    s_nop 1
    v_lshlrev_b32 v88, 16, v84
    v_and_b32 v89, 0xffff0000, v84
    v_lshlrev_b32 v90, 16, v100
    v_and_b32 v91, 0xffff0000, v100
    v_add_f32 v88, v88, v90
    v_add_f32 v89, v89, v91
    v_cvt_pk_bf16_f32 v84, v88, v89
    v_lshlrev_b32 v92, 16, v85
    v_and_b32 v93, 0xffff0000, v85
    v_lshlrev_b32 v94, 16, v101
    v_and_b32 v95, 0xffff0000, v101
    v_add_f32 v92, v92, v94
    v_add_f32 v93, v93, v95
    v_cvt_pk_bf16_f32 v85, v92, v93
    v_lshlrev_b32 v88, 16, v86
    v_and_b32 v89, 0xffff0000, v86
    v_lshlrev_b32 v90, 16, v102
    v_and_b32 v91, 0xffff0000, v102
    v_add_f32 v88, v88, v90
    v_add_f32 v89, v89, v91
    v_cvt_pk_bf16_f32 v86, v88, v89
    v_lshlrev_b32 v92, 16, v87
    v_and_b32 v93, 0xffff0000, v87
    v_lshlrev_b32 v94, 16, v103
    v_and_b32 v95, 0xffff0000, v103
    v_add_f32 v92, v92, v94
    v_add_f32 v93, v93, v95
    v_cvt_pk_bf16_f32 v87, v92, v93
    buffer_store_dwordx4 v[84:87], v3, s[8:11], s26 offen offset:32 sc1
    s_waitcnt vmcnt(0)
    s_mov_b64 exec, 1
    s_add_u32 s26, s48, s20
    buffer_store_dword v5, v4, s[8:11], s26 offen sc1
    s_mov_b64 exec, -1
    s_add_u32 s20, s20, 128
    s_add_u32 s19, s19, 40960
    s_add_u32 s16, s16, 40960
    s_cmp_eq_u32 s16, 122880
    s_cselect_b32 s16, 0, s16
    s_add_u32 s14, s14, 1
    s_cmp_ge_u32 s14, s15
    s_cbranch_scc1 layerb1_kernel_ab_fin
    s_add_u32 s23, s14, 2
    s_cmp_lg_u32 s13, 0
    s_cbranch_scc1 layerb1_kernel_ab_ow4
    s_min_u32 s28, s23, 63
    s_cmp_gt_u32 s22, s28
    s_cbranch_scc1 layerb1_kernel_ab_ow4
layerb1_kernel_ab_op4:
    buffer_load_dwordx4 v[116:119], v1, s[8:11], s29 offen sc1
    s_waitcnt vmcnt(0)
    v_min_u32 v116, v116, v117
    v_min_u32 v118, v118, v119
    v_min_u32 v114, v116, v118
    v_cmp_eq_u32 vcc, 0, v114
    s_nop 1
    s_ff1_i32_b64 s22, vcc
    s_min_u32 s22, s22, 64
    s_and_b32 s22, s22, 0x7c
    s_sub_u32 s30, s30, 1
    s_cbranch_scc1 layerb1_kernel_bail
    s_cmp_gt_u32 s22, s28
    s_cbranch_scc0 layerb1_kernel_ab_op4
layerb1_kernel_ab_ow4:
    s_barrier
    v_add_u32 v2, s16, v1
    ds_read_b128 v[16:19], v2 offset:0
    ds_read_b128 v[20:23], v2 offset:1024
    ds_read_b128 v[24:27], v2 offset:2048
    ds_read_b128 v[28:31], v2 offset:3072
    ds_read_b128 v[32:35], v2 offset:4096
    ds_read_b128 v[36:39], v2 offset:5120
    s_add_u32 s27, s19, 40960
    s_cmp_ge_u32 s14, 63
    s_cselect_b32 s27, s19, s27
    buffer_load_dwordx4 v[96:99], v3, s[52:55], s27 offen offset:0
    buffer_load_dwordx4 v[100:103], v3, s[52:55], s27 offen offset:32
    s_add_u32 s23, s14, 2
    s_min_u32 s24, s23, 63
    s_mul_i32 s24, s24, 40960
    s_add_u32 s24, s24, s18
    s_mul_i32 s25, s13, 10240
    s_add_u32 s25, s25, s17
    s_add_u32 s17, s17, 40960
    s_cmp_eq_u32 s17, 122880
    s_cselect_b32 s17, 0, s17
    ds_read_b128 v[40:43], v2 offset:6144
    s_waitcnt lgkmcnt(6)
    v_mfma_f32_32x32x16_bf16 v[48:63], a[0:3], v[16:19], 0
    ds_read_b128 v[44:47], v2 offset:7168
    s_waitcnt lgkmcnt(6)
    v_mfma_f32_32x32x16_bf16 v[64:79], a[4:7], v[20:23], 0
    s_mov_b32 m0, s25
    s_nop 0
    buffer_load_dwordx4 v1, s[8:11], s24 offen offset:0 sc1 lds
    ds_read_b128 v[16:19], v2 offset:8192
    s_waitcnt lgkmcnt(6)
    v_mfma_f32_32x32x16_bf16 v[48:63], a[8:11], v[24:27], v[48:63]
    ds_read_b128 v[20:23], v2 offset:9216
    s_waitcnt lgkmcnt(6)
    v_mfma_f32_32x32x16_bf16 v[64:79], a[12:15], v[28:31], v[64:79]
    ds_read_b128 v[24:27], v2 offset:10240
    s_waitcnt lgkmcnt(6)
    v_mfma_f32_32x32x16_bf16 v[48:63], a[16:19], v[32:35], v[48:63]
    buffer_load_dwordx4 v1, s[8:11], s24 offen offset:1024 sc1 lds
    ds_read_b128 v[28:31], v2 offset:11264
    s_waitcnt lgkmcnt(6)
    v_mfma_f32_32x32x16_bf16 v[64:79], a[20:23], v[36:39], v[64:79]
    ds_read_b128 v[32:35], v2 offset:12288
    s_waitcnt lgkmcnt(6)
    v_mfma_f32_32x32x16_bf16 v[48:63], a[24:27], v[40:43], v[48:63]
    ds_read_b128 v[36:39], v2 offset:13312
    s_waitcnt lgkmcnt(6)
    v_mfma_f32_32x32x16_bf16 v[64:79], a[28:31], v[44:47], v[64:79]
    buffer_load_dwordx4 v1, s[8:11], s24 offen offset:2048 sc1 lds
    ds_read_b128 v[40:43], v2 offset:14336
    s_waitcnt lgkmcnt(6)
    v_mfma_f32_32x32x16_bf16 v[48:63], a[32:35], v[16:19], v[48:63]
    ds_read_b128 v[44:47], v2 offset:15360
    s_waitcnt lgkmcnt(6)
    v_mfma_f32_32x32x16_bf16 v[64:79], a[36:39], v[20:23], v[64:79]
    ds_read_b128 v[16:19], v2 offset:16384
    s_waitcnt lgkmcnt(6)
    v_mfma_f32_32x32x16_bf16 v[48:63], a[40:43], v[24:27], v[48:63]
    buffer_load_dwordx4 v1, s[8:11], s24 offen offset:3072 sc1 lds
    ds_read_b128 v[20:23], v2 offset:17408
    s_waitcnt lgkmcnt(6)
    v_mfma_f32_32x32x16_bf16 v[64:79], a[44:47], v[28:31], v[64:79]
    ds_read_b128 v[24:27], v2 offset:18432
    s_waitcnt lgkmcnt(6)
    v_mfma_f32_32x32x16_bf16 v[48:63], a[48:51], v[32:35], v[48:63]
    ds_read_b128 v[28:31], v2 offset:19456
    s_waitcnt lgkmcnt(6)
    v_mfma_f32_32x32x16_bf16 v[64:79], a[52:55], v[36:39], v[64:79]
    s_add_u32 s24, s24, 4096
    s_add_u32 s25, s25, 4096
    s_mov_b32 m0, s25
    s_nop 0
    buffer_load_dwordx4 v1, s[8:11], s24 offen offset:0 sc1 lds
    ds_read_b128 v[32:35], v2 offset:20480
    s_waitcnt lgkmcnt(6)
    v_mfma_f32_32x32x16_bf16 v[48:63], a[56:59], v[40:43], v[48:63]
    ds_read_b128 v[36:39], v2 offset:21504
    s_waitcnt lgkmcnt(6)
    v_mfma_f32_32x32x16_bf16 v[64:79], a[60:63], v[44:47], v[64:79]
    ds_read_b128 v[40:43], v2 offset:22528
    s_waitcnt lgkmcnt(6)
    v_mfma_f32_32x32x16_bf16 v[48:63], a[64:67], v[16:19], v[48:63]
    buffer_load_dwordx4 v1, s[8:11], s24 offen offset:1024 sc1 lds
    ds_read_b128 v[44:47], v2 offset:23552
    s_waitcnt lgkmcnt(6)
    v_mfma_f32_32x32x16_bf16 v[64:79], a[68:71], v[20:23], v[64:79]
    ds_read_b128 v[16:19], v2 offset:24576
    s_waitcnt lgkmcnt(6)
    v_mfma_f32_32x32x16_bf16 v[48:63], a[72:75], v[24:27], v[48:63]
    ds_read_b128 v[20:23], v2 offset:25600
    s_waitcnt lgkmcnt(6)
    v_mfma_f32_32x32x16_bf16 v[64:79], a[76:79], v[28:31], v[64:79]
    buffer_load_dwordx4 v1, s[8:11], s24 offen offset:2048 sc1 lds
    ds_read_b128 v[24:27], v2 offset:26624
    s_waitcnt lgkmcnt(6)
    v_mfma_f32_32x32x16_bf16 v[48:63], a[80:83], v[32:35], v[48:63]
    ds_read_b128 v[28:31], v2 offset:27648
    s_waitcnt lgkmcnt(6)
    v_mfma_f32_32x32x16_bf16 v[64:79], a[84:87], v[36:39], v[64:79]
    ds_read_b128 v[32:35], v2 offset:28672
    s_waitcnt lgkmcnt(6)
    v_mfma_f32_32x32x16_bf16 v[48:63], a[88:91], v[40:43], v[48:63]
    buffer_load_dwordx4 v1, s[8:11], s24 offen offset:3072 sc1 lds
    ds_read_b128 v[36:39], v2 offset:29696
    s_waitcnt lgkmcnt(6)
    v_mfma_f32_32x32x16_bf16 v[64:79], a[92:95], v[44:47], v[64:79]
    ds_read_b128 v[40:43], v2 offset:30720
    s_waitcnt lgkmcnt(6)
    v_mfma_f32_32x32x16_bf16 v[48:63], a[96:99], v[16:19], v[48:63]
    ds_read_b128 v[44:47], v2 offset:31744
    s_waitcnt lgkmcnt(6)
    v_mfma_f32_32x32x16_bf16 v[64:79], a[100:103], v[20:23], v[64:79]
    s_add_u32 s24, s24, 4096
    s_add_u32 s25, s25, 4096
    s_mov_b32 m0, s25
    s_nop 0
    buffer_load_dwordx4 v1, s[8:11], s24 offen offset:0 sc1 lds
    ds_read_b128 v[16:19], v2 offset:32768
    s_waitcnt lgkmcnt(6)
    v_mfma_f32_32x32x16_bf16 v[48:63], a[104:107], v[24:27], v[48:63]
    ds_read_b128 v[20:23], v2 offset:33792
    s_waitcnt lgkmcnt(6)
    v_mfma_f32_32x32x16_bf16 v[64:79], a[108:111], v[28:31], v[64:79]
    ds_read_b128 v[24:27], v2 offset:34816
    s_waitcnt lgkmcnt(6)
    v_mfma_f32_32x32x16_bf16 v[48:63], a[112:115], v[32:35], v[48:63]
    buffer_load_dwordx4 v1, s[8:11], s24 offen offset:1024 sc1 lds
    ds_read_b128 v[28:31], v2 offset:35840
    s_waitcnt lgkmcnt(6)
    v_mfma_f32_32x32x16_bf16 v[64:79], a[116:119], v[36:39], v[64:79]
    ds_read_b128 v[32:35], v2 offset:36864
    s_waitcnt lgkmcnt(6)
    v_mfma_f32_32x32x16_bf16 v[48:63], a[120:123], v[40:43], v[48:63]
    ds_read_b128 v[36:39], v2 offset:37888
    s_waitcnt lgkmcnt(6)
    v_mfma_f32_32x32x16_bf16 v[64:79], a[124:127], v[44:47], v[64:79]
    ds_read_b128 v[40:43], v2 offset:38912
    s_waitcnt lgkmcnt(6)
    v_mfma_f32_32x32x16_bf16 v[48:63], a[128:131], v[16:19], v[48:63]
    ds_read_b128 v[44:47], v2 offset:39936
    s_waitcnt lgkmcnt(6)
    v_mfma_f32_32x32x16_bf16 v[64:79], a[132:135], v[20:23], v[64:79]
    s_waitcnt lgkmcnt(5)
    v_mfma_f32_32x32x16_bf16 v[48:63], a[136:139], v[24:27], v[48:63]
    s_waitcnt lgkmcnt(4)
    v_mfma_f32_32x32x16_bf16 v[64:79], a[140:143], v[28:31], v[64:79]
    s_waitcnt lgkmcnt(3)
    v_mfma_f32_32x32x16_bf16 v[48:63], a[144:147], v[32:35], v[48:63]
    s_waitcnt lgkmcnt(2)
    v_mfma_f32_32x32x16_bf16 v[64:79], a[148:151], v[36:39], v[64:79]
    s_waitcnt lgkmcnt(1)
    v_mfma_f32_32x32x16_bf16 v[48:63], a[152:155], v[40:43], v[48:63]
    s_waitcnt lgkmcnt(0)
    v_mfma_f32_32x32x16_bf16 v[64:79], a[156:159], v[44:47], v[64:79]
    s_waitcnt vmcnt(12)
    s_nop 7
    s_nop 3
    v_add_f32 v48, v48, v64
    v_add_f32 v49, v49, v65
    v_add_f32 v50, v50, v66
    v_add_f32 v51, v51, v67
    v_add_f32 v52, v52, v68
    v_add_f32 v53, v53, v69
    v_add_f32 v54, v54, v70
    v_add_f32 v55, v55, v71
    v_add_f32 v56, v56, v72
    v_add_f32 v57, v57, v73
    v_add_f32 v58, v58, v74
    v_add_f32 v59, v59, v75
    v_add_f32 v60, v60, v76
    v_add_f32 v61, v61, v77
    v_add_f32 v62, v62, v78
    v_add_f32 v63, v63, v79
    s_add_u32 s26, s19, 226492416
    v_cvt_pk_bf16_f32 v80, v48, v49
    v_cvt_pk_bf16_f32 v81, v50, v51
    v_cvt_pk_bf16_f32 v82, v52, v53
    v_cvt_pk_bf16_f32 v83, v54, v55
    s_nop 1
    v_permlane32_swap_b32 v80, v82
    v_permlane32_swap_b32 v81, v83
    s_nop 1
    v_lshlrev_b32 v88, 16, v80
    v_and_b32 v89, 0xffff0000, v80
    v_lshlrev_b32 v90, 16, v104
    v_and_b32 v91, 0xffff0000, v104
    v_add_f32 v88, v88, v90
    v_add_f32 v89, v89, v91
    v_cvt_pk_bf16_f32 v80, v88, v89
    v_lshlrev_b32 v92, 16, v81
    v_and_b32 v93, 0xffff0000, v81
    v_lshlrev_b32 v94, 16, v105
    v_and_b32 v95, 0xffff0000, v105
    v_add_f32 v92, v92, v94
    v_add_f32 v93, v93, v95
    v_cvt_pk_bf16_f32 v81, v92, v93
    v_lshlrev_b32 v88, 16, v82
    v_and_b32 v89, 0xffff0000, v82
    v_lshlrev_b32 v90, 16, v106
    v_and_b32 v91, 0xffff0000, v106
    v_add_f32 v88, v88, v90
    v_add_f32 v89, v89, v91
    v_cvt_pk_bf16_f32 v82, v88, v89
    v_lshlrev_b32 v92, 16, v83
    v_and_b32 v93, 0xffff0000, v83
    v_lshlrev_b32 v94, 16, v107
    v_and_b32 v95, 0xffff0000, v107
    v_add_f32 v92, v92, v94
    v_add_f32 v93, v93, v95
    v_cvt_pk_bf16_f32 v83, v92, v93
    buffer_store_dwordx4 v[80:83], v3, s[8:11], s26 offen offset:0 sc1
    v_cvt_pk_bf16_f32 v84, v56, v57
    v_cvt_pk_bf16_f32 v85, v58, v59
    v_cvt_pk_bf16_f32 v86, v60, v61
    v_cvt_pk_bf16_f32 v87, v62, v63
    s_nop 1
    v_permlane32_swap_b32 v84, v86
    v_permlane32_swap_b32 v85, v87
    s_nop 1
    v_lshlrev_b32 v88, 16, v84
    v_and_b32 v89, 0xffff0000, v84
    v_lshlrev_b32 v90, 16, v108
    v_and_b32 v91, 0xffff0000, v108
    v_add_f32 v88, v88, v90
    v_add_f32 v89, v89, v91
    v_cvt_pk_bf16_f32 v84, v88, v89
    v_lshlrev_b32 v92, 16, v85
    v_and_b32 v93, 0xffff0000, v85
    v_lshlrev_b32 v94, 16, v109
    v_and_b32 v95, 0xffff0000, v109
    v_add_f32 v92, v92, v94
    v_add_f32 v93, v93, v95
    v_cvt_pk_bf16_f32 v85, v92, v93
    v_lshlrev_b32 v88, 16, v86
    v_and_b32 v89, 0xffff0000, v86
    v_lshlrev_b32 v90, 16, v110
    v_and_b32 v91, 0xffff0000, v110
    v_add_f32 v88, v88, v90
    v_add_f32 v89, v89, v91
    v_cvt_pk_bf16_f32 v86, v88, v89
    v_lshlrev_b32 v92, 16, v87
    v_and_b32 v93, 0xffff0000, v87
    v_lshlrev_b32 v94, 16, v111
    v_and_b32 v95, 0xffff0000, v111
    v_add_f32 v92, v92, v94
    v_add_f32 v93, v93, v95
    v_cvt_pk_bf16_f32 v87, v92, v93
    buffer_store_dwordx4 v[84:87], v3, s[8:11], s26 offen offset:32 sc1
    s_waitcnt vmcnt(0)
    s_mov_b64 exec, 1
    s_add_u32 s26, s48, s20
    buffer_store_dword v5, v4, s[8:11], s26 offen sc1
    s_mov_b64 exec, -1
    s_add_u32 s20, s20, 128
    s_add_u32 s19, s19, 40960
    s_add_u32 s16, s16, 40960
    s_cmp_eq_u32 s16, 122880
    s_cselect_b32 s16, 0, s16
    s_add_u32 s14, s14, 1
    s_cmp_ge_u32 s14, s15
    s_cbranch_scc1 layerb1_kernel_ab_fin
    s_add_u32 s23, s14, 2
    s_cmp_lg_u32 s13, 0
    s_cbranch_scc1 layerb1_kernel_ab_ow5
    s_min_u32 s28, s23, 63
    s_cmp_gt_u32 s22, s28
    s_cbranch_scc1 layerb1_kernel_ab_ow5
layerb1_kernel_ab_op5:
    buffer_load_dwordx4 v[116:119], v1, s[8:11], s29 offen sc1
    s_waitcnt vmcnt(0)
    v_min_u32 v116, v116, v117
    v_min_u32 v118, v118, v119
    v_min_u32 v114, v116, v118
    v_cmp_eq_u32 vcc, 0, v114
    s_nop 1
    s_ff1_i32_b64 s22, vcc
    s_min_u32 s22, s22, 64
    s_and_b32 s22, s22, 0x7c
    s_sub_u32 s30, s30, 1
    s_cbranch_scc1 layerb1_kernel_bail
    s_cmp_gt_u32 s22, s28
    s_cbranch_scc0 layerb1_kernel_ab_op5
layerb1_kernel_ab_ow5:
    s_barrier
    v_add_u32 v2, s16, v1
    ds_read_b128 v[16:19], v2 offset:0
    ds_read_b128 v[20:23], v2 offset:1024
    ds_read_b128 v[24:27], v2 offset:2048
    ds_read_b128 v[28:31], v2 offset:3072
    ds_read_b128 v[32:35], v2 offset:4096
    ds_read_b128 v[36:39], v2 offset:5120
    s_add_u32 s27, s19, 40960
    s_cmp_ge_u32 s14, 63
    s_cselect_b32 s27, s19, s27
    buffer_load_dwordx4 v[104:107], v3, s[52:55], s27 offen offset:0
    buffer_load_dwordx4 v[108:111], v3, s[52:55], s27 offen offset:32
    s_add_u32 s23, s14, 2
    s_min_u32 s24, s23, 63
    s_mul_i32 s24, s24, 40960
    s_add_u32 s24, s24, s18
    s_mul_i32 s25, s13, 10240
    s_add_u32 s25, s25, s17
    s_add_u32 s17, s17, 40960
    s_cmp_eq_u32 s17, 122880
    s_cselect_b32 s17, 0, s17
    ds_read_b128 v[40:43], v2 offset:6144
    s_waitcnt lgkmcnt(6)
    v_mfma_f32_32x32x16_bf16 v[48:63], a[0:3], v[16:19], 0
    ds_read_b128 v[44:47], v2 offset:7168
    s_waitcnt lgkmcnt(6)
    v_mfma_f32_32x32x16_bf16 v[64:79], a[4:7], v[20:23], 0
    s_mov_b32 m0, s25
    s_nop 0
    buffer_load_dwordx4 v1, s[8:11], s24 offen offset:0 sc1 lds
    ds_read_b128 v[16:19], v2 offset:8192
    s_waitcnt lgkmcnt(6)
    v_mfma_f32_32x32x16_bf16 v[48:63], a[8:11], v[24:27], v[48:63]
    ds_read_b128 v[20:23], v2 offset:9216
    s_waitcnt lgkmcnt(6)
    v_mfma_f32_32x32x16_bf16 v[64:79], a[12:15], v[28:31], v[64:79]
    ds_read_b128 v[24:27], v2 offset:10240
    s_waitcnt lgkmcnt(6)
    v_mfma_f32_32x32x16_bf16 v[48:63], a[16:19], v[32:35], v[48:63]
    buffer_load_dwordx4 v1, s[8:11], s24 offen offset:1024 sc1 lds
    ds_read_b128 v[28:31], v2 offset:11264
    s_waitcnt lgkmcnt(6)
    v_mfma_f32_32x32x16_bf16 v[64:79], a[20:23], v[36:39], v[64:79]
    ds_read_b128 v[32:35], v2 offset:12288
    s_waitcnt lgkmcnt(6)
    v_mfma_f32_32x32x16_bf16 v[48:63], a[24:27], v[40:43], v[48:63]
    ds_read_b128 v[36:39], v2 offset:13312
    s_waitcnt lgkmcnt(6)
    v_mfma_f32_32x32x16_bf16 v[64:79], a[28:31], v[44:47], v[64:79]
    buffer_load_dwordx4 v1, s[8:11], s24 offen offset:2048 sc1 lds
    ds_read_b128 v[40:43], v2 offset:14336
    s_waitcnt lgkmcnt(6)
    v_mfma_f32_32x32x16_bf16 v[48:63], a[32:35], v[16:19], v[48:63]
    ds_read_b128 v[44:47], v2 offset:15360
    s_waitcnt lgkmcnt(6)
    v_mfma_f32_32x32x16_bf16 v[64:79], a[36:39], v[20:23], v[64:79]
    ds_read_b128 v[16:19], v2 offset:16384
    s_waitcnt lgkmcnt(6)
    v_mfma_f32_32x32x16_bf16 v[48:63], a[40:43], v[24:27], v[48:63]
    buffer_load_dwordx4 v1, s[8:11], s24 offen offset:3072 sc1 lds
    ds_read_b128 v[20:23], v2 offset:17408
    s_waitcnt lgkmcnt(6)
    v_mfma_f32_32x32x16_bf16 v[64:79], a[44:47], v[28:31], v[64:79]
    ds_read_b128 v[24:27], v2 offset:18432
    s_waitcnt lgkmcnt(6)
    v_mfma_f32_32x32x16_bf16 v[48:63], a[48:51], v[32:35], v[48:63]
    ds_read_b128 v[28:31], v2 offset:19456
    s_waitcnt lgkmcnt(6)
    v_mfma_f32_32x32x16_bf16 v[64:79], a[52:55], v[36:39], v[64:79]
    s_add_u32 s24, s24, 4096
    s_add_u32 s25, s25, 4096
    s_mov_b32 m0, s25
    s_nop 0
    buffer_load_dwordx4 v1, s[8:11], s24 offen offset:0 sc1 lds
    ds_read_b128 v[32:35], v2 offset:20480
    s_waitcnt lgkmcnt(6)
    v_mfma_f32_32x32x16_bf16 v[48:63], a[56:59], v[40:43], v[48:63]
    ds_read_b128 v[36:39], v2 offset:21504
    s_waitcnt lgkmcnt(6)
    v_mfma_f32_32x32x16_bf16 v[64:79], a[60:63], v[44:47], v[64:79]
    ds_read_b128 v[40:43], v2 offset:22528
    s_waitcnt lgkmcnt(6)
    v_mfma_f32_32x32x16_bf16 v[48:63], a[64:67], v[16:19], v[48:63]
    buffer_load_dwordx4 v1, s[8:11], s24 offen offset:1024 sc1 lds
    ds_read_b128 v[44:47], v2 offset:23552
    s_waitcnt lgkmcnt(6)
    v_mfma_f32_32x32x16_bf16 v[64:79], a[68:71], v[20:23], v[64:79]
    ds_read_b128 v[16:19], v2 offset:24576
    s_waitcnt lgkmcnt(6)
    v_mfma_f32_32x32x16_bf16 v[48:63], a[72:75], v[24:27], v[48:63]
    ds_read_b128 v[20:23], v2 offset:25600
    s_waitcnt lgkmcnt(6)
    v_mfma_f32_32x32x16_bf16 v[64:79], a[76:79], v[28:31], v[64:79]
    buffer_load_dwordx4 v1, s[8:11], s24 offen offset:2048 sc1 lds
    ds_read_b128 v[24:27], v2 offset:26624
    s_waitcnt lgkmcnt(6)
    v_mfma_f32_32x32x16_bf16 v[48:63], a[80:83], v[32:35], v[48:63]
    ds_read_b128 v[28:31], v2 offset:27648
    s_waitcnt lgkmcnt(6)
    v_mfma_f32_32x32x16_bf16 v[64:79], a[84:87], v[36:39], v[64:79]
    ds_read_b128 v[32:35], v2 offset:28672
    s_waitcnt lgkmcnt(6)
    v_mfma_f32_32x32x16_bf16 v[48:63], a[88:91], v[40:43], v[48:63]
    buffer_load_dwordx4 v1, s[8:11], s24 offen offset:3072 sc1 lds
    ds_read_b128 v[36:39], v2 offset:29696
    s_waitcnt lgkmcnt(6)
    v_mfma_f32_32x32x16_bf16 v[64:79], a[92:95], v[44:47], v[64:79]
    ds_read_b128 v[40:43], v2 offset:30720
    s_waitcnt lgkmcnt(6)
    v_mfma_f32_32x32x16_bf16 v[48:63], a[96:99], v[16:19], v[48:63]
    ds_read_b128 v[44:47], v2 offset:31744
    s_waitcnt lgkmcnt(6)
    v_mfma_f32_32x32x16_bf16 v[64:79], a[100:103], v[20:23], v[64:79]
    s_add_u32 s24, s24, 4096
    s_add_u32 s25, s25, 4096
    s_mov_b32 m0, s25
    s_nop 0
    buffer_load_dwordx4 v1, s[8:11], s24 offen offset:0 sc1 lds
    ds_read_b128 v[16:19], v2 offset:32768
    s_waitcnt lgkmcnt(6)
    v_mfma_f32_32x32x16_bf16 v[48:63], a[104:107], v[24:27], v[48:63]
    ds_read_b128 v[20:23], v2 offset:33792
    s_waitcnt lgkmcnt(6)
    v_mfma_f32_32x32x16_bf16 v[64:79], a[108:111], v[28:31], v[64:79]
    ds_read_b128 v[24:27], v2 offset:34816
    s_waitcnt lgkmcnt(6)
    v_mfma_f32_32x32x16_bf16 v[48:63], a[112:115], v[32:35], v[48:63]
    buffer_load_dwordx4 v1, s[8:11], s24 offen offset:1024 sc1 lds
    ds_read_b128 v[28:31], v2 offset:35840
    s_waitcnt lgkmcnt(6)
    v_mfma_f32_32x32x16_bf16 v[64:79], a[116:119], v[36:39], v[64:79]
    ds_read_b128 v[32:35], v2 offset:36864
    s_waitcnt lgkmcnt(6)
    v_mfma_f32_32x32x16_bf16 v[48:63], a[120:123], v[40:43], v[48:63]
    ds_read_b128 v[36:39], v2 offset:37888
    s_waitcnt lgkmcnt(6)
    v_mfma_f32_32x32x16_bf16 v[64:79], a[124:127], v[44:47], v[64:79]
    ds_read_b128 v[40:43], v2 offset:38912
    s_waitcnt lgkmcnt(6)
    v_mfma_f32_32x32x16_bf16 v[48:63], a[128:131], v[16:19], v[48:63]
    ds_read_b128 v[44:47], v2 offset:39936
    s_waitcnt lgkmcnt(6)
    v_mfma_f32_32x32x16_bf16 v[64:79], a[132:135], v[20:23], v[64:79]
    s_waitcnt lgkmcnt(5)
    v_mfma_f32_32x32x16_bf16 v[48:63], a[136:139], v[24:27], v[48:63]
    s_waitcnt lgkmcnt(4)
    v_mfma_f32_32x32x16_bf16 v[64:79], a[140:143], v[28:31], v[64:79]
    s_waitcnt lgkmcnt(3)
    v_mfma_f32_32x32x16_bf16 v[48:63], a[144:147], v[32:35], v[48:63]
    s_waitcnt lgkmcnt(2)
    v_mfma_f32_32x32x16_bf16 v[64:79], a[148:151], v[36:39], v[64:79]
    s_waitcnt lgkmcnt(1)
    v_mfma_f32_32x32x16_bf16 v[48:63], a[152:155], v[40:43], v[48:63]
    s_waitcnt lgkmcnt(0)
    v_mfma_f32_32x32x16_bf16 v[64:79], a[156:159], v[44:47], v[64:79]
    s_waitcnt vmcnt(12)
    s_nop 7
    s_nop 3
    v_add_f32 v48, v48, v64
    v_add_f32 v49, v49, v65
    v_add_f32 v50, v50, v66
    v_add_f32 v51, v51, v67
    v_add_f32 v52, v52, v68
    v_add_f32 v53, v53, v69
    v_add_f32 v54, v54, v70
    v_add_f32 v55, v55, v71
    v_add_f32 v56, v56, v72
    v_add_f32 v57, v57, v73
    v_add_f32 v58, v58, v74
    v_add_f32 v59, v59, v75
    v_add_f32 v60, v60, v76
    v_add_f32 v61, v61, v77
    v_add_f32 v62, v62, v78
    v_add_f32 v63, v63, v79
    s_add_u32 s26, s19, 226492416
    v_cvt_pk_bf16_f32 v80, v48, v49
    v_cvt_pk_bf16_f32 v81, v50, v51
    v_cvt_pk_bf16_f32 v82, v52, v53
    v_cvt_pk_bf16_f32 v83, v54, v55
    s_nop 1
    v_permlane32_swap_b32 v80, v82
    v_permlane32_swap_b32 v81, v83
    s_nop 1
    v_lshlrev_b32 v88, 16, v80
    v_and_b32 v89, 0xffff0000, v80
    v_lshlrev_b32 v90, 16, v96
    v_and_b32 v91, 0xffff0000, v96
    v_add_f32 v88, v88, v90
    v_add_f32 v89, v89, v91
    v_cvt_pk_bf16_f32 v80, v88, v89
    v_lshlrev_b32 v92, 16, v81
    v_and_b32 v93, 0xffff0000, v81
    v_lshlrev_b32 v94, 16, v97
    v_and_b32 v95, 0xffff0000, v97
    v_add_f32 v92, v92, v94
    v_add_f32 v93, v93, v95
    v_cvt_pk_bf16_f32 v81, v92, v93
    v_lshlrev_b32 v88, 16, v82
    v_and_b32 v89, 0xffff0000, v82
    v_lshlrev_b32 v90, 16, v98
    v_and_b32 v91, 0xffff0000, v98
    v_add_f32 v88, v88, v90
    v_add_f32 v89, v89, v91
    v_cvt_pk_bf16_f32 v82, v88, v89
    v_lshlrev_b32 v92, 16, v83
    v_and_b32 v93, 0xffff0000, v83
    v_lshlrev_b32 v94, 16, v99
    v_and_b32 v95, 0xffff0000, v99
    v_add_f32 v92, v92, v94
    v_add_f32 v93, v93, v95
    v_cvt_pk_bf16_f32 v83, v92, v93
    buffer_store_dwordx4 v[80:83], v3, s[8:11], s26 offen offset:0 sc1
    v_cvt_pk_bf16_f32 v84, v56, v57
    v_cvt_pk_bf16_f32 v85, v58, v59
    v_cvt_pk_bf16_f32 v86, v60, v61
    v_cvt_pk_bf16_f32 v87, v62, v63
    s_nop 1
    v_permlane32_swap_b32 v84, v86
    v_permlane32_swap_b32 v85, v87
    s_nop 1
    v_lshlrev_b32 v88, 16, v84
    v_and_b32 v89, 0xffff0000, v84
    v_lshlrev_b32 v90, 16, v100
    v_and_b32 v91, 0xffff0000, v100
    v_add_f32 v88, v88, v90
    v_add_f32 v89, v89, v91
    v_cvt_pk_bf16_f32 v84, v88, v89
    v_lshlrev_b32 v92, 16, v85
    v_and_b32 v93, 0xffff0000, v85
    v_lshlrev_b32 v94, 16, v101
    v_and_b32 v95, 0xffff0000, v101
    v_add_f32 v92, v92, v94
    v_add_f32 v93, v93, v95
    v_cvt_pk_bf16_f32 v85, v92, v93
    v_lshlrev_b32 v88, 16, v86
    v_and_b32 v89, 0xffff0000, v86
    v_lshlrev_b32 v90, 16, v102
    v_and_b32 v91, 0xffff0000, v102
    v_add_f32 v88, v88, v90
    v_add_f32 v89, v89, v91
    v_cvt_pk_bf16_f32 v86, v88, v89
    v_lshlrev_b32 v92, 16, v87
    v_and_b32 v93, 0xffff0000, v87
    v_lshlrev_b32 v94, 16, v103
    v_and_b32 v95, 0xffff0000, v103
    v_add_f32 v92, v92, v94
    v_add_f32 v93, v93, v95
    v_cvt_pk_bf16_f32 v87, v92, v93
    buffer_store_dwordx4 v[84:87], v3, s[8:11], s26 offen offset:32 sc1
    s_waitcnt vmcnt(0)
    s_mov_b64 exec, 1
    s_add_u32 s26, s48, s20
    buffer_store_dword v5, v4, s[8:11], s26 offen sc1
    s_mov_b64 exec, -1
    s_add_u32 s20, s20, 128
    s_add_u32 s19, s19, 40960
    s_add_u32 s16, s16, 40960
    s_cmp_eq_u32 s16, 122880
    s_cselect_b32 s16, 0, s16
    s_add_u32 s14, s14, 1
    s_cmp_ge_u32 s14, s15
    s_cbranch_scc1 layerb1_kernel_ab_fin
    s_add_u32 s23, s14, 2
    s_cmp_lg_u32 s13, 0
    s_cbranch_scc1 layerb1_kernel_ab_ow6
    s_min_u32 s28, s23, 63
    s_cmp_gt_u32 s22, s28
    s_cbranch_scc1 layerb1_kernel_ab_ow6
layerb1_kernel_ab_op6:
    buffer_load_dwordx4 v[116:119], v1, s[8:11], s29 offen sc1
    s_waitcnt vmcnt(0)
    v_min_u32 v116, v116, v117
    v_min_u32 v118, v118, v119
    v_min_u32 v114, v116, v118
    v_cmp_eq_u32 vcc, 0, v114
    s_nop 1
    s_ff1_i32_b64 s22, vcc
    s_min_u32 s22, s22, 64
    s_and_b32 s22, s22, 0x7c
    s_sub_u32 s30, s30, 1
    s_cbranch_scc1 layerb1_kernel_bail
    s_cmp_gt_u32 s22, s28
    s_cbranch_scc0 layerb1_kernel_ab_op6
layerb1_kernel_ab_ow6:
    s_barrier
    v_add_u32 v2, s16, v1
    ds_read_b128 v[16:19], v2 offset:0
    ds_read_b128 v[20:23], v2 offset:1024
    ds_read_b128 v[24:27], v2 offset:2048
    ds_read_b128 v[28:31], v2 offset:3072
    ds_read_b128 v[32:35], v2 offset:4096
    ds_read_b128 v[36:39], v2 offset:5120
    s_add_u32 s27, s19, 40960
    s_cmp_ge_u32 s14, 63
    s_cselect_b32 s27, s19, s27
    buffer_load_dwordx4 v[96:99], v3, s[52:55], s27 offen offset:0
    buffer_load_dwordx4 v[100:103], v3, s[52:55], s27 offen offset:32
    s_add_u32 s23, s14, 2
    s_min_u32 s24, s23, 63
    s_mul_i32 s24, s24, 40960
    s_add_u32 s24, s24, s18
    s_mul_i32 s25, s13, 10240
    s_add_u32 s25, s25, s17
    s_add_u32 s17, s17, 40960
    s_cmp_eq_u32 s17, 122880
    s_cselect_b32 s17, 0, s17
    ds_read_b128 v[40:43], v2 offset:6144
    s_waitcnt lgkmcnt(6)
    v_mfma_f32_32x32x16_bf16 v[48:63], a[0:3], v[16:19], 0
    ds_read_b128 v[44:47], v2 offset:7168
    s_waitcnt lgkmcnt(6)
    v_mfma_f32_32x32x16_bf16 v[64:79], a[4:7], v[20:23], 0
    s_mov_b32 m0, s25
    s_nop 0
    buffer_load_dwordx4 v1, s[8:11], s24 offen offset:0 sc1 lds
    ds_read_b128 v[16:19], v2 offset:8192
    s_waitcnt lgkmcnt(6)
    v_mfma_f32_32x32x16_bf16 v[48:63], a[8:11], v[24:27], v[48:63]
    ds_read_b128 v[20:23], v2 offset:9216
    s_waitcnt lgkmcnt(6)
    v_mfma_f32_32x32x16_bf16 v[64:79], a[12:15], v[28:31], v[64:79]
    ds_read_b128 v[24:27], v2 offset:10240
    s_waitcnt lgkmcnt(6)
    v_mfma_f32_32x32x16_bf16 v[48:63], a[16:19], v[32:35], v[48:63]
    buffer_load_dwordx4 v1, s[8:11], s24 offen offset:1024 sc1 lds
    ds_read_b128 v[28:31], v2 offset:11264
    s_waitcnt lgkmcnt(6)
    v_mfma_f32_32x32x16_bf16 v[64:79], a[20:23], v[36:39], v[64:79]
    ds_read_b128 v[32:35], v2 offset:12288
    s_waitcnt lgkmcnt(6)
    v_mfma_f32_32x32x16_bf16 v[48:63], a[24:27], v[40:43], v[48:63]
    ds_read_b128 v[36:39], v2 offset:13312
    s_waitcnt lgkmcnt(6)
    v_mfma_f32_32x32x16_bf16 v[64:79], a[28:31], v[44:47], v[64:79]
    buffer_load_dwordx4 v1, s[8:11], s24 offen offset:2048 sc1 lds
    ds_read_b128 v[40:43], v2 offset:14336
    s_waitcnt lgkmcnt(6)
    v_mfma_f32_32x32x16_bf16 v[48:63], a[32:35], v[16:19], v[48:63]
    ds_read_b128 v[44:47], v2 offset:15360
    s_waitcnt lgkmcnt(6)
    v_mfma_f32_32x32x16_bf16 v[64:79], a[36:39], v[20:23], v[64:79]
    ds_read_b128 v[16:19], v2 offset:16384
    s_waitcnt lgkmcnt(6)
    v_mfma_f32_32x32x16_bf16 v[48:63], a[40:43], v[24:27], v[48:63]
    buffer_load_dwordx4 v1, s[8:11], s24 offen offset:3072 sc1 lds
    ds_read_b128 v[20:23], v2 offset:17408
    s_waitcnt lgkmcnt(6)
    v_mfma_f32_32x32x16_bf16 v[64:79], a[44:47], v[28:31], v[64:79]
    ds_read_b128 v[24:27], v2 offset:18432
    s_waitcnt lgkmcnt(6)
    v_mfma_f32_32x32x16_bf16 v[48:63], a[48:51], v[32:35], v[48:63]
    ds_read_b128 v[28:31], v2 offset:19456
    s_waitcnt lgkmcnt(6)
    v_mfma_f32_32x32x16_bf16 v[64:79], a[52:55], v[36:39], v[64:79]
    s_add_u32 s24, s24, 4096
    s_add_u32 s25, s25, 4096
    s_mov_b32 m0, s25
    s_nop 0
    buffer_load_dwordx4 v1, s[8:11], s24 offen offset:0 sc1 lds
    ds_read_b128 v[32:35], v2 offset:20480
    s_waitcnt lgkmcnt(6)
    v_mfma_f32_32x32x16_bf16 v[48:63], a[56:59], v[40:43], v[48:63]
    ds_read_b128 v[36:39], v2 offset:21504
    s_waitcnt lgkmcnt(6)
    v_mfma_f32_32x32x16_bf16 v[64:79], a[60:63], v[44:47], v[64:79]
    ds_read_b128 v[40:43], v2 offset:22528
    s_waitcnt lgkmcnt(6)
    v_mfma_f32_32x32x16_bf16 v[48:63], a[64:67], v[16:19], v[48:63]
    buffer_load_dwordx4 v1, s[8:11], s24 offen offset:1024 sc1 lds
    ds_read_b128 v[44:47], v2 offset:23552
    s_waitcnt lgkmcnt(6)
    v_mfma_f32_32x32x16_bf16 v[64:79], a[68:71], v[20:23], v[64:79]
    ds_read_b128 v[16:19], v2 offset:24576
    s_waitcnt lgkmcnt(6)
    v_mfma_f32_32x32x16_bf16 v[48:63], a[72:75], v[24:27], v[48:63]
    ds_read_b128 v[20:23], v2 offset:25600
    s_waitcnt lgkmcnt(6)
    v_mfma_f32_32x32x16_bf16 v[64:79], a[76:79], v[28:31], v[64:79]
    buffer_load_dwordx4 v1, s[8:11], s24 offen offset:2048 sc1 lds
    ds_read_b128 v[24:27], v2 offset:26624
    s_waitcnt lgkmcnt(6)
    v_mfma_f32_32x32x16_bf16 v[48:63], a[80:83], v[32:35], v[48:63]
    ds_read_b128 v[28:31], v2 offset:27648
    s_waitcnt lgkmcnt(6)
    v_mfma_f32_32x32x16_bf16 v[64:79], a[84:87], v[36:39], v[64:79]
    ds_read_b128 v[32:35], v2 offset:28672
    s_waitcnt lgkmcnt(6)
    v_mfma_f32_32x32x16_bf16 v[48:63], a[88:91], v[40:43], v[48:63]
    buffer_load_dwordx4 v1, s[8:11], s24 offen offset:3072 sc1 lds
    ds_read_b128 v[36:39], v2 offset:29696
    s_waitcnt lgkmcnt(6)
    v_mfma_f32_32x32x16_bf16 v[64:79], a[92:95], v[44:47], v[64:79]
    ds_read_b128 v[40:43], v2 offset:30720
    s_waitcnt lgkmcnt(6)
    v_mfma_f32_32x32x16_bf16 v[48:63], a[96:99], v[16:19], v[48:63]
    ds_read_b128 v[44:47], v2 offset:31744
    s_waitcnt lgkmcnt(6)
    v_mfma_f32_32x32x16_bf16 v[64:79], a[100:103], v[20:23], v[64:79]
    s_add_u32 s24, s24, 4096
    s_add_u32 s25, s25, 4096
    s_mov_b32 m0, s25
    s_nop 0
    buffer_load_dwordx4 v1, s[8:11], s24 offen offset:0 sc1 lds
    ds_read_b128 v[16:19], v2 offset:32768
    s_waitcnt lgkmcnt(6)
    v_mfma_f32_32x32x16_bf16 v[48:63], a[104:107], v[24:27], v[48:63]
    ds_read_b128 v[20:23], v2 offset:33792
    s_waitcnt lgkmcnt(6)
    v_mfma_f32_32x32x16_bf16 v[64:79], a[108:111], v[28:31], v[64:79]
    ds_read_b128 v[24:27], v2 offset:34816
    s_waitcnt lgkmcnt(6)
    v_mfma_f32_32x32x16_bf16 v[48:63], a[112:115], v[32:35], v[48:63]
    buffer_load_dwordx4 v1, s[8:11], s24 offen offset:1024 sc1 lds
    ds_read_b128 v[28:31], v2 offset:35840
    s_waitcnt lgkmcnt(6)
    v_mfma_f32_32x32x16_bf16 v[64:79], a[116:119], v[36:39], v[64:79]
    ds_read_b128 v[32:35], v2 offset:36864
    s_waitcnt lgkmcnt(6)
    v_mfma_f32_32x32x16_bf16 v[48:63], a[120:123], v[40:43], v[48:63]
    ds_read_b128 v[36:39], v2 offset:37888
    s_waitcnt lgkmcnt(6)
    v_mfma_f32_32x32x16_bf16 v[64:79], a[124:127], v[44:47], v[64:79]
    ds_read_b128 v[40:43], v2 offset:38912
    s_waitcnt lgkmcnt(6)
    v_mfma_f32_32x32x16_bf16 v[48:63], a[128:131], v[16:19], v[48:63]
    ds_read_b128 v[44:47], v2 offset:39936
    s_waitcnt lgkmcnt(6)
    v_mfma_f32_32x32x16_bf16 v[64:79], a[132:135], v[20:23], v[64:79]
    s_waitcnt lgkmcnt(5)
    v_mfma_f32_32x32x16_bf16 v[48:63], a[136:139], v[24:27], v[48:63]
    s_waitcnt lgkmcnt(4)
    v_mfma_f32_32x32x16_bf16 v[64:79], a[140:143], v[28:31], v[64:79]
    s_waitcnt lgkmcnt(3)
    v_mfma_f32_32x32x16_bf16 v[48:63], a[144:147], v[32:35], v[48:63]
    s_waitcnt lgkmcnt(2)
    v_mfma_f32_32x32x16_bf16 v[64:79], a[148:151], v[36:39], v[64:79]
    s_waitcnt lgkmcnt(1)
    v_mfma_f32_32x32x16_bf16 v[48:63], a[152:155], v[40:43], v[48:63]
    s_waitcnt lgkmcnt(0)
    v_mfma_f32_32x32x16_bf16 v[64:79], a[156:159], v[44:47], v[64:79]
    s_waitcnt vmcnt(12)
    s_nop 7
    s_nop 3
    v_add_f32 v48, v48, v64
    v_add_f32 v49, v49, v65
    v_add_f32 v50, v50, v66
    v_add_f32 v51, v51, v67
    v_add_f32 v52, v52, v68
    v_add_f32 v53, v53, v69
    v_add_f32 v54, v54, v70
    v_add_f32 v55, v55, v71
    v_add_f32 v56, v56, v72
    v_add_f32 v57, v57, v73
    v_add_f32 v58, v58, v74
    v_add_f32 v59, v59, v75
    v_add_f32 v60, v60, v76
    v_add_f32 v61, v61, v77
    v_add_f32 v62, v62, v78
    v_add_f32 v63, v63, v79
    s_add_u32 s26, s19, 226492416
    v_cvt_pk_bf16_f32 v80, v48, v49
    v_cvt_pk_bf16_f32 v81, v50, v51
    v_cvt_pk_bf16_f32 v82, v52, v53
    v_cvt_pk_bf16_f32 v83, v54, v55
    s_nop 1
    v_permlane32_swap_b32 v80, v82
    v_permlane32_swap_b32 v81, v83
    s_nop 1
    v_lshlrev_b32 v88, 16, v80
    v_and_b32 v89, 0xffff0000, v80
    v_lshlrev_b32 v90, 16, v104
    v_and_b32 v91, 0xffff0000, v104
    v_add_f32 v88, v88, v90
    v_add_f32 v89, v89, v91
    v_cvt_pk_bf16_f32 v80, v88, v89
    v_lshlrev_b32 v92, 16, v81
    v_and_b32 v93, 0xffff0000, v81
    v_lshlrev_b32 v94, 16, v105
    v_and_b32 v95, 0xffff0000, v105
    v_add_f32 v92, v92, v94
    v_add_f32 v93, v93, v95
    v_cvt_pk_bf16_f32 v81, v92, v93
    v_lshlrev_b32 v88, 16, v82
    v_and_b32 v89, 0xffff0000, v82
    v_lshlrev_b32 v90, 16, v106
    v_and_b32 v91, 0xffff0000, v106
    v_add_f32 v88, v88, v90
    v_add_f32 v89, v89, v91
    v_cvt_pk_bf16_f32 v82, v88, v89
    v_lshlrev_b32 v92, 16, v83
    v_and_b32 v93, 0xffff0000, v83
    v_lshlrev_b32 v94, 16, v107
    v_and_b32 v95, 0xffff0000, v107
    v_add_f32 v92, v92, v94
    v_add_f32 v93, v93, v95
    v_cvt_pk_bf16_f32 v83, v92, v93
    buffer_store_dwordx4 v[80:83], v3, s[8:11], s26 offen offset:0 sc1
    v_cvt_pk_bf16_f32 v84, v56, v57
    v_cvt_pk_bf16_f32 v85, v58, v59
    v_cvt_pk_bf16_f32 v86, v60, v61
    v_cvt_pk_bf16_f32 v87, v62, v63
    s_nop 1
    v_permlane32_swap_b32 v84, v86
    v_permlane32_swap_b32 v85, v87
    s_nop 1
    v_lshlrev_b32 v88, 16, v84
    v_and_b32 v89, 0xffff0000, v84
    v_lshlrev_b32 v90, 16, v108
    v_and_b32 v91, 0xffff0000, v108
    v_add_f32 v88, v88, v90
    v_add_f32 v89, v89, v91
    v_cvt_pk_bf16_f32 v84, v88, v89
    v_lshlrev_b32 v92, 16, v85
    v_and_b32 v93, 0xffff0000, v85
    v_lshlrev_b32 v94, 16, v109
    v_and_b32 v95, 0xffff0000, v109
    v_add_f32 v92, v92, v94
    v_add_f32 v93, v93, v95
    v_cvt_pk_bf16_f32 v85, v92, v93
    v_lshlrev_b32 v88, 16, v86
    v_and_b32 v89, 0xffff0000, v86
    v_lshlrev_b32 v90, 16, v110
    v_and_b32 v91, 0xffff0000, v110
    v_add_f32 v88, v88, v90
    v_add_f32 v89, v89, v91
    v_cvt_pk_bf16_f32 v86, v88, v89
    v_lshlrev_b32 v92, 16, v87
    v_and_b32 v93, 0xffff0000, v87
    v_lshlrev_b32 v94, 16, v111
    v_and_b32 v95, 0xffff0000, v111
    v_add_f32 v92, v92, v94
    v_add_f32 v93, v93, v95
    v_cvt_pk_bf16_f32 v87, v92, v93
    buffer_store_dwordx4 v[84:87], v3, s[8:11], s26 offen offset:32 sc1
    s_waitcnt vmcnt(0)
    s_mov_b64 exec, 1
    s_add_u32 s26, s48, s20
    buffer_store_dword v5, v4, s[8:11], s26 offen sc1
    s_mov_b64 exec, -1
    s_add_u32 s20, s20, 128
    s_add_u32 s19, s19, 40960
    s_add_u32 s16, s16, 40960
    s_cmp_eq_u32 s16, 122880
    s_cselect_b32 s16, 0, s16
    s_add_u32 s14, s14, 1
    s_cmp_ge_u32 s14, s15
    s_cbranch_scc1 layerb1_kernel_ab_fin
    s_add_u32 s23, s14, 2
    s_cmp_lg_u32 s13, 0
    s_cbranch_scc1 layerb1_kernel_ab_ow7
    s_min_u32 s28, s23, 63
    s_cmp_gt_u32 s22, s28
    s_cbranch_scc1 layerb1_kernel_ab_ow7
layerb1_kernel_ab_op7:
    buffer_load_dwordx4 v[116:119], v1, s[8:11], s29 offen sc1
    s_waitcnt vmcnt(0)
    v_min_u32 v116, v116, v117
    v_min_u32 v118, v118, v119
    v_min_u32 v114, v116, v118
    v_cmp_eq_u32 vcc, 0, v114
    s_nop 1
    s_ff1_i32_b64 s22, vcc
    s_min_u32 s22, s22, 64
    s_and_b32 s22, s22, 0x7c
    s_sub_u32 s30, s30, 1
    s_cbranch_scc1 layerb1_kernel_bail
    s_cmp_gt_u32 s22, s28
    s_cbranch_scc0 layerb1_kernel_ab_op7
layerb1_kernel_ab_ow7:
    s_barrier
    v_add_u32 v2, s16, v1
    ds_read_b128 v[16:19], v2 offset:0
    ds_read_b128 v[20:23], v2 offset:1024
    ds_read_b128 v[24:27], v2 offset:2048
    ds_read_b128 v[28:31], v2 offset:3072
    ds_read_b128 v[32:35], v2 offset:4096
    ds_read_b128 v[36:39], v2 offset:5120
    s_add_u32 s27, s19, 40960
    s_cmp_ge_u32 s14, 63
    s_cselect_b32 s27, s19, s27
    buffer_load_dwordx4 v[104:107], v3, s[52:55], s27 offen offset:0
    buffer_load_dwordx4 v[108:111], v3, s[52:55], s27 offen offset:32
    s_add_u32 s23, s14, 2
    s_min_u32 s24, s23, 63
    s_mul_i32 s24, s24, 40960
    s_add_u32 s24, s24, s18
    s_mul_i32 s25, s13, 10240
    s_add_u32 s25, s25, s17
    s_add_u32 s17, s17, 40960
    s_cmp_eq_u32 s17, 122880
    s_cselect_b32 s17, 0, s17
    ds_read_b128 v[40:43], v2 offset:6144
    s_waitcnt lgkmcnt(6)
    v_mfma_f32_32x32x16_bf16 v[48:63], a[0:3], v[16:19], 0
    ds_read_b128 v[44:47], v2 offset:7168
    s_waitcnt lgkmcnt(6)
    v_mfma_f32_32x32x16_bf16 v[64:79], a[4:7], v[20:23], 0
    s_mov_b32 m0, s25
    s_nop 0
    buffer_load_dwordx4 v1, s[8:11], s24 offen offset:0 sc1 lds
    ds_read_b128 v[16:19], v2 offset:8192
    s_waitcnt lgkmcnt(6)
    v_mfma_f32_32x32x16_bf16 v[48:63], a[8:11], v[24:27], v[48:63]
    ds_read_b128 v[20:23], v2 offset:9216
    s_waitcnt lgkmcnt(6)
    v_mfma_f32_32x32x16_bf16 v[64:79], a[12:15], v[28:31], v[64:79]
    ds_read_b128 v[24:27], v2 offset:10240
    s_waitcnt lgkmcnt(6)
    v_mfma_f32_32x32x16_bf16 v[48:63], a[16:19], v[32:35], v[48:63]
    buffer_load_dwordx4 v1, s[8:11], s24 offen offset:1024 sc1 lds
    ds_read_b128 v[28:31], v2 offset:11264
    s_waitcnt lgkmcnt(6)
    v_mfma_f32_32x32x16_bf16 v[64:79], a[20:23], v[36:39], v[64:79]
    ds_read_b128 v[32:35], v2 offset:12288
    s_waitcnt lgkmcnt(6)
    v_mfma_f32_32x32x16_bf16 v[48:63], a[24:27], v[40:43], v[48:63]
    ds_read_b128 v[36:39], v2 offset:13312
    s_waitcnt lgkmcnt(6)
    v_mfma_f32_32x32x16_bf16 v[64:79], a[28:31], v[44:47], v[64:79]
    buffer_load_dwordx4 v1, s[8:11], s24 offen offset:2048 sc1 lds
    ds_read_b128 v[40:43], v2 offset:14336
    s_waitcnt lgkmcnt(6)
    v_mfma_f32_32x32x16_bf16 v[48:63], a[32:35], v[16:19], v[48:63]
    ds_read_b128 v[44:47], v2 offset:15360
    s_waitcnt lgkmcnt(6)
    v_mfma_f32_32x32x16_bf16 v[64:79], a[36:39], v[20:23], v[64:79]
    ds_read_b128 v[16:19], v2 offset:16384
    s_waitcnt lgkmcnt(6)
    v_mfma_f32_32x32x16_bf16 v[48:63], a[40:43], v[24:27], v[48:63]
    buffer_load_dwordx4 v1, s[8:11], s24 offen offset:3072 sc1 lds
    ds_read_b128 v[20:23], v2 offset:17408
    s_waitcnt lgkmcnt(6)
    v_mfma_f32_32x32x16_bf16 v[64:79], a[44:47], v[28:31], v[64:79]
    ds_read_b128 v[24:27], v2 offset:18432
    s_waitcnt lgkmcnt(6)
    v_mfma_f32_32x32x16_bf16 v[48:63], a[48:51], v[32:35], v[48:63]
    ds_read_b128 v[28:31], v2 offset:19456
    s_waitcnt lgkmcnt(6)
    v_mfma_f32_32x32x16_bf16 v[64:79], a[52:55], v[36:39], v[64:79]
    s_add_u32 s24, s24, 4096
    s_add_u32 s25, s25, 4096
    s_mov_b32 m0, s25
    s_nop 0
    buffer_load_dwordx4 v1, s[8:11], s24 offen offset:0 sc1 lds
    ds_read_b128 v[32:35], v2 offset:20480
    s_waitcnt lgkmcnt(6)
    v_mfma_f32_32x32x16_bf16 v[48:63], a[56:59], v[40:43], v[48:63]
    ds_read_b128 v[36:39], v2 offset:21504
    s_waitcnt lgkmcnt(6)
    v_mfma_f32_32x32x16_bf16 v[64:79], a[60:63], v[44:47], v[64:79]
    ds_read_b128 v[40:43], v2 offset:22528
    s_waitcnt lgkmcnt(6)
    v_mfma_f32_32x32x16_bf16 v[48:63], a[64:67], v[16:19], v[48:63]
    buffer_load_dwordx4 v1, s[8:11], s24 offen offset:1024 sc1 lds
    ds_read_b128 v[44:47], v2 offset:23552
    s_waitcnt lgkmcnt(6)
    v_mfma_f32_32x32x16_bf16 v[64:79], a[68:71], v[20:23], v[64:79]
    ds_read_b128 v[16:19], v2 offset:24576
    s_waitcnt lgkmcnt(6)
    v_mfma_f32_32x32x16_bf16 v[48:63], a[72:75], v[24:27], v[48:63]
    ds_read_b128 v[20:23], v2 offset:25600
    s_waitcnt lgkmcnt(6)
    v_mfma_f32_32x32x16_bf16 v[64:79], a[76:79], v[28:31], v[64:79]
    buffer_load_dwordx4 v1, s[8:11], s24 offen offset:2048 sc1 lds
    ds_read_b128 v[24:27], v2 offset:26624
    s_waitcnt lgkmcnt(6)
    v_mfma_f32_32x32x16_bf16 v[48:63], a[80:83], v[32:35], v[48:63]
    ds_read_b128 v[28:31], v2 offset:27648
    s_waitcnt lgkmcnt(6)
    v_mfma_f32_32x32x16_bf16 v[64:79], a[84:87], v[36:39], v[64:79]
    ds_read_b128 v[32:35], v2 offset:28672
    s_waitcnt lgkmcnt(6)
    v_mfma_f32_32x32x16_bf16 v[48:63], a[88:91], v[40:43], v[48:63]
    buffer_load_dwordx4 v1, s[8:11], s24 offen offset:3072 sc1 lds
    ds_read_b128 v[36:39], v2 offset:29696
    s_waitcnt lgkmcnt(6)
    v_mfma_f32_32x32x16_bf16 v[64:79], a[92:95], v[44:47], v[64:79]
    ds_read_b128 v[40:43], v2 offset:30720
    s_waitcnt lgkmcnt(6)
    v_mfma_f32_32x32x16_bf16 v[48:63], a[96:99], v[16:19], v[48:63]
    ds_read_b128 v[44:47], v2 offset:31744
    s_waitcnt lgkmcnt(6)
    v_mfma_f32_32x32x16_bf16 v[64:79], a[100:103], v[20:23], v[64:79]
    s_add_u32 s24, s24, 4096
    s_add_u32 s25, s25, 4096
    s_mov_b32 m0, s25
    s_nop 0
    buffer_load_dwordx4 v1, s[8:11], s24 offen offset:0 sc1 lds
    ds_read_b128 v[16:19], v2 offset:32768
    s_waitcnt lgkmcnt(6)
    v_mfma_f32_32x32x16_bf16 v[48:63], a[104:107], v[24:27], v[48:63]
    ds_read_b128 v[20:23], v2 offset:33792
    s_waitcnt lgkmcnt(6)
    v_mfma_f32_32x32x16_bf16 v[64:79], a[108:111], v[28:31], v[64:79]
    ds_read_b128 v[24:27], v2 offset:34816
    s_waitcnt lgkmcnt(6)
    v_mfma_f32_32x32x16_bf16 v[48:63], a[112:115], v[32:35], v[48:63]
    buffer_load_dwordx4 v1, s[8:11], s24 offen offset:1024 sc1 lds
    ds_read_b128 v[28:31], v2 offset:35840
    s_waitcnt lgkmcnt(6)
    v_mfma_f32_32x32x16_bf16 v[64:79], a[116:119], v[36:39], v[64:79]
    ds_read_b128 v[32:35], v2 offset:36864
    s_waitcnt lgkmcnt(6)
    v_mfma_f32_32x32x16_bf16 v[48:63], a[120:123], v[40:43], v[48:63]
    ds_read_b128 v[36:39], v2 offset:37888
    s_waitcnt lgkmcnt(6)
    v_mfma_f32_32x32x16_bf16 v[64:79], a[124:127], v[44:47], v[64:79]
    ds_read_b128 v[40:43], v2 offset:38912
    s_waitcnt lgkmcnt(6)
    v_mfma_f32_32x32x16_bf16 v[48:63], a[128:131], v[16:19], v[48:63]
    ds_read_b128 v[44:47], v2 offset:39936
    s_waitcnt lgkmcnt(6)
    v_mfma_f32_32x32x16_bf16 v[64:79], a[132:135], v[20:23], v[64:79]
    s_waitcnt lgkmcnt(5)
    v_mfma_f32_32x32x16_bf16 v[48:63], a[136:139], v[24:27], v[48:63]
    s_waitcnt lgkmcnt(4)
    v_mfma_f32_32x32x16_bf16 v[64:79], a[140:143], v[28:31], v[64:79]
    s_waitcnt lgkmcnt(3)
    v_mfma_f32_32x32x16_bf16 v[48:63], a[144:147], v[32:35], v[48:63]
    s_waitcnt lgkmcnt(2)
    v_mfma_f32_32x32x16_bf16 v[64:79], a[148:151], v[36:39], v[64:79]
    s_waitcnt lgkmcnt(1)
    v_mfma_f32_32x32x16_bf16 v[48:63], a[152:155], v[40:43], v[48:63]
    s_waitcnt lgkmcnt(0)
    v_mfma_f32_32x32x16_bf16 v[64:79], a[156:159], v[44:47], v[64:79]
    s_waitcnt vmcnt(12)
    s_nop 7
    s_nop 3
    v_add_f32 v48, v48, v64
    v_add_f32 v49, v49, v65
    v_add_f32 v50, v50, v66
    v_add_f32 v51, v51, v67
    v_add_f32 v52, v52, v68
    v_add_f32 v53, v53, v69
    v_add_f32 v54, v54, v70
    v_add_f32 v55, v55, v71
    v_add_f32 v56, v56, v72
    v_add_f32 v57, v57, v73
    v_add_f32 v58, v58, v74
    v_add_f32 v59, v59, v75
    v_add_f32 v60, v60, v76
    v_add_f32 v61, v61, v77
    v_add_f32 v62, v62, v78
    v_add_f32 v63, v63, v79
    s_add_u32 s26, s19, 226492416
    v_cvt_pk_bf16_f32 v80, v48, v49
    v_cvt_pk_bf16_f32 v81, v50, v51
    v_cvt_pk_bf16_f32 v82, v52, v53
    v_cvt_pk_bf16_f32 v83, v54, v55
    s_nop 1
    v_permlane32_swap_b32 v80, v82
    v_permlane32_swap_b32 v81, v83
    s_nop 1
    v_lshlrev_b32 v88, 16, v80
    v_and_b32 v89, 0xffff0000, v80
    v_lshlrev_b32 v90, 16, v96
    v_and_b32 v91, 0xffff0000, v96
    v_add_f32 v88, v88, v90
    v_add_f32 v89, v89, v91
    v_cvt_pk_bf16_f32 v80, v88, v89
    v_lshlrev_b32 v92, 16, v81
    v_and_b32 v93, 0xffff0000, v81
    v_lshlrev_b32 v94, 16, v97
    v_and_b32 v95, 0xffff0000, v97
    v_add_f32 v92, v92, v94
    v_add_f32 v93, v93, v95
    v_cvt_pk_bf16_f32 v81, v92, v93
    v_lshlrev_b32 v88, 16, v82
    v_and_b32 v89, 0xffff0000, v82
    v_lshlrev_b32 v90, 16, v98
    v_and_b32 v91, 0xffff0000, v98
    v_add_f32 v88, v88, v90
    v_add_f32 v89, v89, v91
    v_cvt_pk_bf16_f32 v82, v88, v89
    v_lshlrev_b32 v92, 16, v83
    v_and_b32 v93, 0xffff0000, v83
    v_lshlrev_b32 v94, 16, v99
    v_and_b32 v95, 0xffff0000, v99
    v_add_f32 v92, v92, v94
    v_add_f32 v93, v93, v95
    v_cvt_pk_bf16_f32 v83, v92, v93
    buffer_store_dwordx4 v[80:83], v3, s[8:11], s26 offen offset:0 sc1
    v_cvt_pk_bf16_f32 v84, v56, v57
    v_cvt_pk_bf16_f32 v85, v58, v59
    v_cvt_pk_bf16_f32 v86, v60, v61
    v_cvt_pk_bf16_f32 v87, v62, v63
    s_nop 1
    v_permlane32_swap_b32 v84, v86
    v_permlane32_swap_b32 v85, v87
    s_nop 1
    v_lshlrev_b32 v88, 16, v84
    v_and_b32 v89, 0xffff0000, v84
    v_lshlrev_b32 v90, 16, v100
    v_and_b32 v91, 0xffff0000, v100
    v_add_f32 v88, v88, v90
    v_add_f32 v89, v89, v91
    v_cvt_pk_bf16_f32 v84, v88, v89
    v_lshlrev_b32 v92, 16, v85
    v_and_b32 v93, 0xffff0000, v85
    v_lshlrev_b32 v94, 16, v101
    v_and_b32 v95, 0xffff0000, v101
    v_add_f32 v92, v92, v94
    v_add_f32 v93, v93, v95
    v_cvt_pk_bf16_f32 v85, v92, v93
    v_lshlrev_b32 v88, 16, v86
    v_and_b32 v89, 0xffff0000, v86
    v_lshlrev_b32 v90, 16, v102
    v_and_b32 v91, 0xffff0000, v102
    v_add_f32 v88, v88, v90
    v_add_f32 v89, v89, v91
    v_cvt_pk_bf16_f32 v86, v88, v89
    v_lshlrev_b32 v92, 16, v87
    v_and_b32 v93, 0xffff0000, v87
    v_lshlrev_b32 v94, 16, v103
    v_and_b32 v95, 0xffff0000, v103
    v_add_f32 v92, v92, v94
    v_add_f32 v93, v93, v95
    v_cvt_pk_bf16_f32 v87, v92, v93
    buffer_store_dwordx4 v[84:87], v3, s[8:11], s26 offen offset:32 sc1
    s_waitcnt vmcnt(0)
    s_mov_b64 exec, 1
    s_add_u32 s26, s48, s20
    buffer_store_dword v5, v4, s[8:11], s26 offen sc1
    s_mov_b64 exec, -1
    s_add_u32 s20, s20, 128
    s_add_u32 s19, s19, 40960
    s_add_u32 s16, s16, 40960
    s_cmp_eq_u32 s16, 122880
    s_cselect_b32 s16, 0, s16
    s_add_u32 s14, s14, 1
    s_cmp_ge_u32 s14, s15
    s_cbranch_scc1 layerb1_kernel_ab_fin
    s_add_u32 s23, s14, 2
    s_cmp_lg_u32 s13, 0
    s_cbranch_scc1 layerb1_kernel_ab_ow8
    s_min_u32 s28, s23, 63
    s_cmp_gt_u32 s22, s28
    s_cbranch_scc1 layerb1_kernel_ab_ow8
layerb1_kernel_ab_op8:
    buffer_load_dwordx4 v[116:119], v1, s[8:11], s29 offen sc1
    s_waitcnt vmcnt(0)
    v_min_u32 v116, v116, v117
    v_min_u32 v118, v118, v119
    v_min_u32 v114, v116, v118
    v_cmp_eq_u32 vcc, 0, v114
    s_nop 1
    s_ff1_i32_b64 s22, vcc
    s_min_u32 s22, s22, 64
    s_and_b32 s22, s22, 0x7c
    s_sub_u32 s30, s30, 1
    s_cbranch_scc1 layerb1_kernel_bail
    s_cmp_gt_u32 s22, s28
    s_cbranch_scc0 layerb1_kernel_ab_op8
layerb1_kernel_ab_ow8:
    s_barrier
    v_add_u32 v2, s16, v1
    ds_read_b128 v[16:19], v2 offset:0
    ds_read_b128 v[20:23], v2 offset:1024
    ds_read_b128 v[24:27], v2 offset:2048
    ds_read_b128 v[28:31], v2 offset:3072
    ds_read_b128 v[32:35], v2 offset:4096
    ds_read_b128 v[36:39], v2 offset:5120
    s_add_u32 s27, s19, 40960
    s_cmp_ge_u32 s14, 63
    s_cselect_b32 s27, s19, s27
    buffer_load_dwordx4 v[96:99], v3, s[52:55], s27 offen offset:0
    buffer_load_dwordx4 v[100:103], v3, s[52:55], s27 offen offset:32
    s_add_u32 s23, s14, 2
    s_min_u32 s24, s23, 63
    s_mul_i32 s24, s24, 40960
    s_add_u32 s24, s24, s18
    s_mul_i32 s25, s13, 10240
    s_add_u32 s25, s25, s17
    s_add_u32 s17, s17, 40960
    s_cmp_eq_u32 s17, 122880
    s_cselect_b32 s17, 0, s17
    ds_read_b128 v[40:43], v2 offset:6144
    s_waitcnt lgkmcnt(6)
    v_mfma_f32_32x32x16_bf16 v[48:63], a[0:3], v[16:19], 0
    ds_read_b128 v[44:47], v2 offset:7168
    s_waitcnt lgkmcnt(6)
    v_mfma_f32_32x32x16_bf16 v[64:79], a[4:7], v[20:23], 0
    s_mov_b32 m0, s25
    s_nop 0
    buffer_load_dwordx4 v1, s[8:11], s24 offen offset:0 sc1 lds
    ds_read_b128 v[16:19], v2 offset:8192
    s_waitcnt lgkmcnt(6)
    v_mfma_f32_32x32x16_bf16 v[48:63], a[8:11], v[24:27], v[48:63]
    ds_read_b128 v[20:23], v2 offset:9216
    s_waitcnt lgkmcnt(6)
    v_mfma_f32_32x32x16_bf16 v[64:79], a[12:15], v[28:31], v[64:79]
    ds_read_b128 v[24:27], v2 offset:10240
    s_waitcnt lgkmcnt(6)
    v_mfma_f32_32x32x16_bf16 v[48:63], a[16:19], v[32:35], v[48:63]
    buffer_load_dwordx4 v1, s[8:11], s24 offen offset:1024 sc1 lds
    ds_read_b128 v[28:31], v2 offset:11264
    s_waitcnt lgkmcnt(6)
    v_mfma_f32_32x32x16_bf16 v[64:79], a[20:23], v[36:39], v[64:79]
    ds_read_b128 v[32:35], v2 offset:12288
    s_waitcnt lgkmcnt(6)
    v_mfma_f32_32x32x16_bf16 v[48:63], a[24:27], v[40:43], v[48:63]
    ds_read_b128 v[36:39], v2 offset:13312
    s_waitcnt lgkmcnt(6)
    v_mfma_f32_32x32x16_bf16 v[64:79], a[28:31], v[44:47], v[64:79]
    buffer_load_dwordx4 v1, s[8:11], s24 offen offset:2048 sc1 lds
    ds_read_b128 v[40:43], v2 offset:14336
    s_waitcnt lgkmcnt(6)
    v_mfma_f32_32x32x16_bf16 v[48:63], a[32:35], v[16:19], v[48:63]
    ds_read_b128 v[44:47], v2 offset:15360
    s_waitcnt lgkmcnt(6)
    v_mfma_f32_32x32x16_bf16 v[64:79], a[36:39], v[20:23], v[64:79]
    ds_read_b128 v[16:19], v2 offset:16384
    s_waitcnt lgkmcnt(6)
    v_mfma_f32_32x32x16_bf16 v[48:63], a[40:43], v[24:27], v[48:63]
    buffer_load_dwordx4 v1, s[8:11], s24 offen offset:3072 sc1 lds
    ds_read_b128 v[20:23], v2 offset:17408
    s_waitcnt lgkmcnt(6)
    v_mfma_f32_32x32x16_bf16 v[64:79], a[44:47], v[28:31], v[64:79]
    ds_read_b128 v[24:27], v2 offset:18432
    s_waitcnt lgkmcnt(6)
    v_mfma_f32_32x32x16_bf16 v[48:63], a[48:51], v[32:35], v[48:63]
    ds_read_b128 v[28:31], v2 offset:19456
    s_waitcnt lgkmcnt(6)
    v_mfma_f32_32x32x16_bf16 v[64:79], a[52:55], v[36:39], v[64:79]
    s_add_u32 s24, s24, 4096
    s_add_u32 s25, s25, 4096
    s_mov_b32 m0, s25
    s_nop 0
    buffer_load_dwordx4 v1, s[8:11], s24 offen offset:0 sc1 lds
    ds_read_b128 v[32:35], v2 offset:20480
    s_waitcnt lgkmcnt(6)
    v_mfma_f32_32x32x16_bf16 v[48:63], a[56:59], v[40:43], v[48:63]
    ds_read_b128 v[36:39], v2 offset:21504
    s_waitcnt lgkmcnt(6)
    v_mfma_f32_32x32x16_bf16 v[64:79], a[60:63], v[44:47], v[64:79]
    ds_read_b128 v[40:43], v2 offset:22528
    s_waitcnt lgkmcnt(6)
    v_mfma_f32_32x32x16_bf16 v[48:63], a[64:67], v[16:19], v[48:63]
    buffer_load_dwordx4 v1, s[8:11], s24 offen offset:1024 sc1 lds
    ds_read_b128 v[44:47], v2 offset:23552
    s_waitcnt lgkmcnt(6)
    v_mfma_f32_32x32x16_bf16 v[64:79], a[68:71], v[20:23], v[64:79]
    ds_read_b128 v[16:19], v2 offset:24576
    s_waitcnt lgkmcnt(6)
    v_mfma_f32_32x32x16_bf16 v[48:63], a[72:75], v[24:27], v[48:63]
    ds_read_b128 v[20:23], v2 offset:25600
    s_waitcnt lgkmcnt(6)
    v_mfma_f32_32x32x16_bf16 v[64:79], a[76:79], v[28:31], v[64:79]
    buffer_load_dwordx4 v1, s[8:11], s24 offen offset:2048 sc1 lds
    ds_read_b128 v[24:27], v2 offset:26624
    s_waitcnt lgkmcnt(6)
    v_mfma_f32_32x32x16_bf16 v[48:63], a[80:83], v[32:35], v[48:63]
    ds_read_b128 v[28:31], v2 offset:27648
    s_waitcnt lgkmcnt(6)
    v_mfma_f32_32x32x16_bf16 v[64:79], a[84:87], v[36:39], v[64:79]
    ds_read_b128 v[32:35], v2 offset:28672
    s_waitcnt lgkmcnt(6)
    v_mfma_f32_32x32x16_bf16 v[48:63], a[88:91], v[40:43], v[48:63]
    buffer_load_dwordx4 v1, s[8:11], s24 offen offset:3072 sc1 lds
    ds_read_b128 v[36:39], v2 offset:29696
    s_waitcnt lgkmcnt(6)
    v_mfma_f32_32x32x16_bf16 v[64:79], a[92:95], v[44:47], v[64:79]
    ds_read_b128 v[40:43], v2 offset:30720
    s_waitcnt lgkmcnt(6)
    v_mfma_f32_32x32x16_bf16 v[48:63], a[96:99], v[16:19], v[48:63]
    ds_read_b128 v[44:47], v2 offset:31744
    s_waitcnt lgkmcnt(6)
    v_mfma_f32_32x32x16_bf16 v[64:79], a[100:103], v[20:23], v[64:79]
    s_add_u32 s24, s24, 4096
    s_add_u32 s25, s25, 4096
    s_mov_b32 m0, s25
    s_nop 0
    buffer_load_dwordx4 v1, s[8:11], s24 offen offset:0 sc1 lds
    ds_read_b128 v[16:19], v2 offset:32768
    s_waitcnt lgkmcnt(6)
    v_mfma_f32_32x32x16_bf16 v[48:63], a[104:107], v[24:27], v[48:63]
    ds_read_b128 v[20:23], v2 offset:33792
    s_waitcnt lgkmcnt(6)
    v_mfma_f32_32x32x16_bf16 v[64:79], a[108:111], v[28:31], v[64:79]
    ds_read_b128 v[24:27], v2 offset:34816
    s_waitcnt lgkmcnt(6)
    v_mfma_f32_32x32x16_bf16 v[48:63], a[112:115], v[32:35], v[48:63]
    buffer_load_dwordx4 v1, s[8:11], s24 offen offset:1024 sc1 lds
    ds_read_b128 v[28:31], v2 offset:35840
    s_waitcnt lgkmcnt(6)
    v_mfma_f32_32x32x16_bf16 v[64:79], a[116:119], v[36:39], v[64:79]
    ds_read_b128 v[32:35], v2 offset:36864
    s_waitcnt lgkmcnt(6)
    v_mfma_f32_32x32x16_bf16 v[48:63], a[120:123], v[40:43], v[48:63]
    ds_read_b128 v[36:39], v2 offset:37888
    s_waitcnt lgkmcnt(6)
    v_mfma_f32_32x32x16_bf16 v[64:79], a[124:127], v[44:47], v[64:79]
    ds_read_b128 v[40:43], v2 offset:38912
    s_waitcnt lgkmcnt(6)
    v_mfma_f32_32x32x16_bf16 v[48:63], a[128:131], v[16:19], v[48:63]
    ds_read_b128 v[44:47], v2 offset:39936
    s_waitcnt lgkmcnt(6)
    v_mfma_f32_32x32x16_bf16 v[64:79], a[132:135], v[20:23], v[64:79]
    s_waitcnt lgkmcnt(5)
    v_mfma_f32_32x32x16_bf16 v[48:63], a[136:139], v[24:27], v[48:63]
    s_waitcnt lgkmcnt(4)
    v_mfma_f32_32x32x16_bf16 v[64:79], a[140:143], v[28:31], v[64:79]
    s_waitcnt lgkmcnt(3)
    v_mfma_f32_32x32x16_bf16 v[48:63], a[144:147], v[32:35], v[48:63]
    s_waitcnt lgkmcnt(2)
    v_mfma_f32_32x32x16_bf16 v[64:79], a[148:151], v[36:39], v[64:79]
    s_waitcnt lgkmcnt(1)
    v_mfma_f32_32x32x16_bf16 v[48:63], a[152:155], v[40:43], v[48:63]
    s_waitcnt lgkmcnt(0)
    v_mfma_f32_32x32x16_bf16 v[64:79], a[156:159], v[44:47], v[64:79]
    s_waitcnt vmcnt(12)
    s_nop 7
    s_nop 3
    v_add_f32 v48, v48, v64
    v_add_f32 v49, v49, v65
    v_add_f32 v50, v50, v66
    v_add_f32 v51, v51, v67
    v_add_f32 v52, v52, v68
    v_add_f32 v53, v53, v69
    v_add_f32 v54, v54, v70
    v_add_f32 v55, v55, v71
    v_add_f32 v56, v56, v72
    v_add_f32 v57, v57, v73
    v_add_f32 v58, v58, v74
    v_add_f32 v59, v59, v75
    v_add_f32 v60, v60, v76
    v_add_f32 v61, v61, v77
    v_add_f32 v62, v62, v78
    v_add_f32 v63, v63, v79
    s_add_u32 s26, s19, 226492416
    v_cvt_pk_bf16_f32 v80, v48, v49
    v_cvt_pk_bf16_f32 v81, v50, v51
    v_cvt_pk_bf16_f32 v82, v52, v53
    v_cvt_pk_bf16_f32 v83, v54, v55
    s_nop 1
    v_permlane32_swap_b32 v80, v82
    v_permlane32_swap_b32 v81, v83
    s_nop 1
    v_lshlrev_b32 v88, 16, v80
    v_and_b32 v89, 0xffff0000, v80
    v_lshlrev_b32 v90, 16, v104
    v_and_b32 v91, 0xffff0000, v104
    v_add_f32 v88, v88, v90
    v_add_f32 v89, v89, v91
    v_cvt_pk_bf16_f32 v80, v88, v89
    v_lshlrev_b32 v92, 16, v81
    v_and_b32 v93, 0xffff0000, v81
    v_lshlrev_b32 v94, 16, v105
    v_and_b32 v95, 0xffff0000, v105
    v_add_f32 v92, v92, v94
    v_add_f32 v93, v93, v95
    v_cvt_pk_bf16_f32 v81, v92, v93
    v_lshlrev_b32 v88, 16, v82
    v_and_b32 v89, 0xffff0000, v82
    v_lshlrev_b32 v90, 16, v106
    v_and_b32 v91, 0xffff0000, v106
    v_add_f32 v88, v88, v90
    v_add_f32 v89, v89, v91
    v_cvt_pk_bf16_f32 v82, v88, v89
    v_lshlrev_b32 v92, 16, v83
    v_and_b32 v93, 0xffff0000, v83
    v_lshlrev_b32 v94, 16, v107
    v_and_b32 v95, 0xffff0000, v107
    v_add_f32 v92, v92, v94
    v_add_f32 v93, v93, v95
    v_cvt_pk_bf16_f32 v83, v92, v93
    buffer_store_dwordx4 v[80:83], v3, s[8:11], s26 offen offset:0 sc1
    v_cvt_pk_bf16_f32 v84, v56, v57
    v_cvt_pk_bf16_f32 v85, v58, v59
    v_cvt_pk_bf16_f32 v86, v60, v61
    v_cvt_pk_bf16_f32 v87, v62, v63
    s_nop 1
    v_permlane32_swap_b32 v84, v86
    v_permlane32_swap_b32 v85, v87
    s_nop 1
    v_lshlrev_b32 v88, 16, v84
    v_and_b32 v89, 0xffff0000, v84
    v_lshlrev_b32 v90, 16, v108
    v_and_b32 v91, 0xffff0000, v108
    v_add_f32 v88, v88, v90
    v_add_f32 v89, v89, v91
    v_cvt_pk_bf16_f32 v84, v88, v89
    v_lshlrev_b32 v92, 16, v85
    v_and_b32 v93, 0xffff0000, v85
    v_lshlrev_b32 v94, 16, v109
    v_and_b32 v95, 0xffff0000, v109
    v_add_f32 v92, v92, v94
    v_add_f32 v93, v93, v95
    v_cvt_pk_bf16_f32 v85, v92, v93
    v_lshlrev_b32 v88, 16, v86
    v_and_b32 v89, 0xffff0000, v86
    v_lshlrev_b32 v90, 16, v110
    v_and_b32 v91, 0xffff0000, v110
    v_add_f32 v88, v88, v90
    v_add_f32 v89, v89, v91
    v_cvt_pk_bf16_f32 v86, v88, v89
    v_lshlrev_b32 v92, 16, v87
    v_and_b32 v93, 0xffff0000, v87
    v_lshlrev_b32 v94, 16, v111
    v_and_b32 v95, 0xffff0000, v111
    v_add_f32 v92, v92, v94
    v_add_f32 v93, v93, v95
    v_cvt_pk_bf16_f32 v87, v92, v93
    buffer_store_dwordx4 v[84:87], v3, s[8:11], s26 offen offset:32 sc1
    s_waitcnt vmcnt(0)
    s_mov_b64 exec, 1
    s_add_u32 s26, s48, s20
    buffer_store_dword v5, v4, s[8:11], s26 offen sc1
    s_mov_b64 exec, -1
    s_add_u32 s20, s20, 128
    s_add_u32 s19, s19, 40960
    s_add_u32 s16, s16, 40960
    s_cmp_eq_u32 s16, 122880
    s_cselect_b32 s16, 0, s16
    s_add_u32 s14, s14, 1
    s_cmp_ge_u32 s14, s15
    s_cbranch_scc1 layerb1_kernel_ab_fin
    s_sub_u32 s20, s20, 128
layerb1_kernel_ab_loop:
    s_add_u32 s23, s14, 2
    s_cmp_lg_u32 s13, 0
    s_cbranch_scc1 layerb1_kernel_ab_ow9
    s_min_u32 s28, s23, 63
    s_cmp_gt_u32 s22, s28
    s_cbranch_scc1 layerb1_kernel_ab_ow9
layerb1_kernel_ab_op9:
    buffer_load_dwordx4 v[116:119], v1, s[8:11], s29 offen sc1
    s_waitcnt vmcnt(0)
    v_min_u32 v116, v116, v117
    v_min_u32 v118, v118, v119
    v_min_u32 v114, v116, v118
    v_cmp_eq_u32 vcc, 0, v114
    s_nop 1
    s_ff1_i32_b64 s22, vcc
    s_min_u32 s22, s22, 64
    s_and_b32 s22, s22, 0x7c
    s_sub_u32 s30, s30, 1
    s_cbranch_scc1 layerb1_kernel_bail
    s_cmp_gt_u32 s22, s28
    s_cbranch_scc0 layerb1_kernel_ab_op9
layerb1_kernel_ab_ow9:
    s_barrier
    v_add_u32 v2, s16, v1
    ds_read_b128 v[16:19], v2 offset:0
    ds_read_b128 v[20:23], v2 offset:1024
    ds_read_b128 v[24:27], v2 offset:2048
    ds_read_b128 v[28:31], v2 offset:3072
    ds_read_b128 v[32:35], v2 offset:4096
    ds_read_b128 v[36:39], v2 offset:5120
    s_add_u32 s27, s19, 40960
    s_cmp_ge_u32 s14, 63
    s_cselect_b32 s27, s19, s27
    buffer_load_dwordx4 v[104:107], v3, s[52:55], s27 offen offset:0
    buffer_load_dwordx4 v[108:111], v3, s[52:55], s27 offen offset:32
    s_add_u32 s23, s14, 2
    s_min_u32 s24, s23, 63
    s_mul_i32 s24, s24, 40960
    s_add_u32 s24, s24, s18
    s_mul_i32 s25, s13, 10240
    s_add_u32 s25, s25, s17
    s_add_u32 s17, s17, 40960
    s_cmp_eq_u32 s17, 122880
    s_cselect_b32 s17, 0, s17
    ds_read_b128 v[40:43], v2 offset:6144
    s_waitcnt lgkmcnt(6)
    v_mfma_f32_32x32x16_bf16 v[48:63], a[0:3], v[16:19], 0
    ds_read_b128 v[44:47], v2 offset:7168
    s_waitcnt lgkmcnt(6)
    v_mfma_f32_32x32x16_bf16 v[64:79], a[4:7], v[20:23], 0
    s_mov_b32 m0, s25
    s_nop 0
    buffer_load_dwordx4 v1, s[8:11], s24 offen offset:0 sc1 lds
    ds_read_b128 v[16:19], v2 offset:8192
    s_waitcnt lgkmcnt(6)
    v_mfma_f32_32x32x16_bf16 v[48:63], a[8:11], v[24:27], v[48:63]
    ds_read_b128 v[20:23], v2 offset:9216
    s_waitcnt lgkmcnt(6)
    v_mfma_f32_32x32x16_bf16 v[64:79], a[12:15], v[28:31], v[64:79]
    ds_read_b128 v[24:27], v2 offset:10240
    s_waitcnt lgkmcnt(6)
    v_mfma_f32_32x32x16_bf16 v[48:63], a[16:19], v[32:35], v[48:63]
    buffer_load_dwordx4 v1, s[8:11], s24 offen offset:1024 sc1 lds
    ds_read_b128 v[28:31], v2 offset:11264
    s_waitcnt lgkmcnt(6)
    v_mfma_f32_32x32x16_bf16 v[64:79], a[20:23], v[36:39], v[64:79]
    ds_read_b128 v[32:35], v2 offset:12288
    s_waitcnt lgkmcnt(6)
    v_mfma_f32_32x32x16_bf16 v[48:63], a[24:27], v[40:43], v[48:63]
    ds_read_b128 v[36:39], v2 offset:13312
    s_waitcnt lgkmcnt(6)
    v_mfma_f32_32x32x16_bf16 v[64:79], a[28:31], v[44:47], v[64:79]
    buffer_load_dwordx4 v1, s[8:11], s24 offen offset:2048 sc1 lds
    ds_read_b128 v[40:43], v2 offset:14336
    s_waitcnt lgkmcnt(6)
    v_mfma_f32_32x32x16_bf16 v[48:63], a[32:35], v[16:19], v[48:63]
    ds_read_b128 v[44:47], v2 offset:15360
    s_waitcnt lgkmcnt(6)
    v_mfma_f32_32x32x16_bf16 v[64:79], a[36:39], v[20:23], v[64:79]
    ds_read_b128 v[16:19], v2 offset:16384
    s_waitcnt lgkmcnt(6)
    v_mfma_f32_32x32x16_bf16 v[48:63], a[40:43], v[24:27], v[48:63]
    buffer_load_dwordx4 v1, s[8:11], s24 offen offset:3072 sc1 lds
    ds_read_b128 v[20:23], v2 offset:17408
    s_waitcnt lgkmcnt(6)
    v_mfma_f32_32x32x16_bf16 v[64:79], a[44:47], v[28:31], v[64:79]
    ds_read_b128 v[24:27], v2 offset:18432
    s_waitcnt lgkmcnt(6)
    v_mfma_f32_32x32x16_bf16 v[48:63], a[48:51], v[32:35], v[48:63]
    ds_read_b128 v[28:31], v2 offset:19456
    s_waitcnt lgkmcnt(6)
    v_mfma_f32_32x32x16_bf16 v[64:79], a[52:55], v[36:39], v[64:79]
    s_add_u32 s24, s24, 4096
    s_add_u32 s25, s25, 4096
    s_mov_b32 m0, s25
    s_nop 0
    buffer_load_dwordx4 v1, s[8:11], s24 offen offset:0 sc1 lds
    ds_read_b128 v[32:35], v2 offset:20480
    s_waitcnt lgkmcnt(6)
    v_mfma_f32_32x32x16_bf16 v[48:63], a[56:59], v[40:43], v[48:63]
    ds_read_b128 v[36:39], v2 offset:21504
    s_waitcnt lgkmcnt(6)
    v_mfma_f32_32x32x16_bf16 v[64:79], a[60:63], v[44:47], v[64:79]
    ds_read_b128 v[40:43], v2 offset:22528
    s_waitcnt lgkmcnt(6)
    v_mfma_f32_32x32x16_bf16 v[48:63], a[64:67], v[16:19], v[48:63]
    buffer_load_dwordx4 v1, s[8:11], s24 offen offset:1024 sc1 lds
    ds_read_b128 v[44:47], v2 offset:23552
    s_waitcnt lgkmcnt(6)
    v_mfma_f32_32x32x16_bf16 v[64:79], a[68:71], v[20:23], v[64:79]
    ds_read_b128 v[16:19], v2 offset:24576
    s_waitcnt lgkmcnt(6)
    v_mfma_f32_32x32x16_bf16 v[48:63], a[72:75], v[24:27], v[48:63]
    ds_read_b128 v[20:23], v2 offset:25600
    s_waitcnt lgkmcnt(6)
    v_mfma_f32_32x32x16_bf16 v[64:79], a[76:79], v[28:31], v[64:79]
    buffer_load_dwordx4 v1, s[8:11], s24 offen offset:2048 sc1 lds
    ds_read_b128 v[24:27], v2 offset:26624
    s_waitcnt lgkmcnt(6)
    v_mfma_f32_32x32x16_bf16 v[48:63], a[80:83], v[32:35], v[48:63]
    ds_read_b128 v[28:31], v2 offset:27648
    s_waitcnt lgkmcnt(6)
    v_mfma_f32_32x32x16_bf16 v[64:79], a[84:87], v[36:39], v[64:79]
    ds_read_b128 v[32:35], v2 offset:28672
    s_waitcnt lgkmcnt(6)
    v_mfma_f32_32x32x16_bf16 v[48:63], a[88:91], v[40:43], v[48:63]
    buffer_load_dwordx4 v1, s[8:11], s24 offen offset:3072 sc1 lds
    ds_read_b128 v[36:39], v2 offset:29696
    s_waitcnt lgkmcnt(6)
    v_mfma_f32_32x32x16_bf16 v[64:79], a[92:95], v[44:47], v[64:79]
    ds_read_b128 v[40:43], v2 offset:30720
    s_waitcnt lgkmcnt(6)
    v_mfma_f32_32x32x16_bf16 v[48:63], a[96:99], v[16:19], v[48:63]
    ds_read_b128 v[44:47], v2 offset:31744
    s_waitcnt lgkmcnt(6)
    v_mfma_f32_32x32x16_bf16 v[64:79], a[100:103], v[20:23], v[64:79]
    s_add_u32 s24, s24, 4096
    s_add_u32 s25, s25, 4096
    s_mov_b32 m0, s25
    s_nop 0
    buffer_load_dwordx4 v1, s[8:11], s24 offen offset:0 sc1 lds
    ds_read_b128 v[16:19], v2 offset:32768
    s_waitcnt lgkmcnt(6)
    v_mfma_f32_32x32x16_bf16 v[48:63], a[104:107], v[24:27], v[48:63]
    ds_read_b128 v[20:23], v2 offset:33792
    s_waitcnt lgkmcnt(6)
    v_mfma_f32_32x32x16_bf16 v[64:79], a[108:111], v[28:31], v[64:79]
    ds_read_b128 v[24:27], v2 offset:34816
    s_waitcnt lgkmcnt(6)
    v_mfma_f32_32x32x16_bf16 v[48:63], a[112:115], v[32:35], v[48:63]
    buffer_load_dwordx4 v1, s[8:11], s24 offen offset:1024 sc1 lds
    ds_read_b128 v[28:31], v2 offset:35840
    s_waitcnt lgkmcnt(6)
    v_mfma_f32_32x32x16_bf16 v[64:79], a[116:119], v[36:39], v[64:79]
    ds_read_b128 v[32:35], v2 offset:36864
    s_waitcnt lgkmcnt(6)
    v_mfma_f32_32x32x16_bf16 v[48:63], a[120:123], v[40:43], v[48:63]
    ds_read_b128 v[36:39], v2 offset:37888
    s_waitcnt lgkmcnt(6)
    v_mfma_f32_32x32x16_bf16 v[64:79], a[124:127], v[44:47], v[64:79]
    ds_read_b128 v[40:43], v2 offset:38912
    s_waitcnt lgkmcnt(6)
    v_mfma_f32_32x32x16_bf16 v[48:63], a[128:131], v[16:19], v[48:63]
    ds_read_b128 v[44:47], v2 offset:39936
    s_waitcnt lgkmcnt(6)
    v_mfma_f32_32x32x16_bf16 v[64:79], a[132:135], v[20:23], v[64:79]
    s_waitcnt lgkmcnt(5)
    v_mfma_f32_32x32x16_bf16 v[48:63], a[136:139], v[24:27], v[48:63]
    s_waitcnt lgkmcnt(4)
    v_mfma_f32_32x32x16_bf16 v[64:79], a[140:143], v[28:31], v[64:79]
    s_waitcnt lgkmcnt(3)
    v_mfma_f32_32x32x16_bf16 v[48:63], a[144:147], v[32:35], v[48:63]
    s_waitcnt lgkmcnt(2)
    v_mfma_f32_32x32x16_bf16 v[64:79], a[148:151], v[36:39], v[64:79]
    s_waitcnt lgkmcnt(1)
    v_mfma_f32_32x32x16_bf16 v[48:63], a[152:155], v[40:43], v[48:63]
    s_waitcnt lgkmcnt(0)
    v_mfma_f32_32x32x16_bf16 v[64:79], a[156:159], v[44:47], v[64:79]
    s_waitcnt vmcnt(15)
    s_nop 7
    s_nop 3
    v_add_f32 v48, v48, v64
    v_add_f32 v49, v49, v65
    v_add_f32 v50, v50, v66
    v_add_f32 v51, v51, v67
    v_add_f32 v52, v52, v68
    v_add_f32 v53, v53, v69
    v_add_f32 v54, v54, v70
    v_add_f32 v55, v55, v71
    v_add_f32 v56, v56, v72
    v_add_f32 v57, v57, v73
    v_add_f32 v58, v58, v74
    v_add_f32 v59, v59, v75
    v_add_f32 v60, v60, v76
    v_add_f32 v61, v61, v77
    v_add_f32 v62, v62, v78
    v_add_f32 v63, v63, v79
    s_add_u32 s26, s19, 226492416
    v_cvt_pk_bf16_f32 v80, v48, v49
    v_cvt_pk_bf16_f32 v81, v50, v51
    v_cvt_pk_bf16_f32 v82, v52, v53
    v_cvt_pk_bf16_f32 v83, v54, v55
    s_nop 1
    v_permlane32_swap_b32 v80, v82
    v_permlane32_swap_b32 v81, v83
    s_nop 1
    v_lshlrev_b32 v88, 16, v80
    v_and_b32 v89, 0xffff0000, v80
    v_lshlrev_b32 v90, 16, v96
    v_and_b32 v91, 0xffff0000, v96
    v_add_f32 v88, v88, v90
    v_add_f32 v89, v89, v91
    v_cvt_pk_bf16_f32 v80, v88, v89
    v_lshlrev_b32 v92, 16, v81
    v_and_b32 v93, 0xffff0000, v81
    v_lshlrev_b32 v94, 16, v97
    v_and_b32 v95, 0xffff0000, v97
    v_add_f32 v92, v92, v94
    v_add_f32 v93, v93, v95
    v_cvt_pk_bf16_f32 v81, v92, v93
    v_lshlrev_b32 v88, 16, v82
    v_and_b32 v89, 0xffff0000, v82
    v_lshlrev_b32 v90, 16, v98
    v_and_b32 v91, 0xffff0000, v98
    v_add_f32 v88, v88, v90
    v_add_f32 v89, v89, v91
    v_cvt_pk_bf16_f32 v82, v88, v89
    v_lshlrev_b32 v92, 16, v83
    v_and_b32 v93, 0xffff0000, v83
    v_lshlrev_b32 v94, 16, v99
    v_and_b32 v95, 0xffff0000, v99
    v_add_f32 v92, v92, v94
    v_add_f32 v93, v93, v95
    v_cvt_pk_bf16_f32 v83, v92, v93
    buffer_store_dwordx4 v[80:83], v3, s[8:11], s26 offen offset:0 sc1
    v_cvt_pk_bf16_f32 v84, v56, v57
    v_cvt_pk_bf16_f32 v85, v58, v59
    v_cvt_pk_bf16_f32 v86, v60, v61
    v_cvt_pk_bf16_f32 v87, v62, v63
    s_nop 1
    v_permlane32_swap_b32 v84, v86
    v_permlane32_swap_b32 v85, v87
    s_nop 1
    v_lshlrev_b32 v88, 16, v84
    v_and_b32 v89, 0xffff0000, v84
    v_lshlrev_b32 v90, 16, v100
    v_and_b32 v91, 0xffff0000, v100
    v_add_f32 v88, v88, v90
    v_add_f32 v89, v89, v91
    v_cvt_pk_bf16_f32 v84, v88, v89
    v_lshlrev_b32 v92, 16, v85
    v_and_b32 v93, 0xffff0000, v85
    v_lshlrev_b32 v94, 16, v101
    v_and_b32 v95, 0xffff0000, v101
    v_add_f32 v92, v92, v94
    v_add_f32 v93, v93, v95
    v_cvt_pk_bf16_f32 v85, v92, v93
    v_lshlrev_b32 v88, 16, v86
    v_and_b32 v89, 0xffff0000, v86
    v_lshlrev_b32 v90, 16, v102
    v_and_b32 v91, 0xffff0000, v102
    v_add_f32 v88, v88, v90
    v_add_f32 v89, v89, v91
    v_cvt_pk_bf16_f32 v86, v88, v89
    v_lshlrev_b32 v92, 16, v87
    v_and_b32 v93, 0xffff0000, v87
    v_lshlrev_b32 v94, 16, v103
    v_and_b32 v95, 0xffff0000, v103
    v_add_f32 v92, v92, v94
    v_add_f32 v93, v93, v95
    v_cvt_pk_bf16_f32 v87, v92, v93
    buffer_store_dwordx4 v[84:87], v3, s[8:11], s26 offen offset:32 sc1
    s_waitcnt vmcnt(15)
    s_mov_b64 exec, 1
    s_add_u32 s26, s48, s20
    buffer_store_dword v5, v4, s[8:11], s26 offen sc1
    s_mov_b64 exec, -1
    s_add_u32 s20, s20, 128
    s_add_u32 s19, s19, 40960
    s_add_u32 s16, s16, 40960
    s_cmp_eq_u32 s16, 122880
    s_cselect_b32 s16, 0, s16
    s_add_u32 s14, s14, 1
    s_cmp_ge_u32 s14, s15
    s_cbranch_scc1 layerb1_kernel_ab_fin
    s_add_u32 s23, s14, 2
    s_cmp_lg_u32 s13, 0
    s_cbranch_scc1 layerb1_kernel_ab_ow10
    s_min_u32 s28, s23, 63
    s_cmp_gt_u32 s22, s28
    s_cbranch_scc1 layerb1_kernel_ab_ow10
layerb1_kernel_ab_op10:
    buffer_load_dwordx4 v[116:119], v1, s[8:11], s29 offen sc1
    s_waitcnt vmcnt(0)
    v_min_u32 v116, v116, v117
    v_min_u32 v118, v118, v119
    v_min_u32 v114, v116, v118
    v_cmp_eq_u32 vcc, 0, v114
    s_nop 1
    s_ff1_i32_b64 s22, vcc
    s_min_u32 s22, s22, 64
    s_and_b32 s22, s22, 0x7c
    s_sub_u32 s30, s30, 1
    s_cbranch_scc1 layerb1_kernel_bail
    s_cmp_gt_u32 s22, s28
    s_cbranch_scc0 layerb1_kernel_ab_op10
layerb1_kernel_ab_ow10:
    s_barrier
    v_add_u32 v2, s16, v1
    ds_read_b128 v[16:19], v2 offset:0
    ds_read_b128 v[20:23], v2 offset:1024
    ds_read_b128 v[24:27], v2 offset:2048
    ds_read_b128 v[28:31], v2 offset:3072
    ds_read_b128 v[32:35], v2 offset:4096
    ds_read_b128 v[36:39], v2 offset:5120
    s_add_u32 s27, s19, 40960
    s_cmp_ge_u32 s14, 63
    s_cselect_b32 s27, s19, s27
    buffer_load_dwordx4 v[96:99], v3, s[52:55], s27 offen offset:0
    buffer_load_dwordx4 v[100:103], v3, s[52:55], s27 offen offset:32
    s_add_u32 s23, s14, 2
    s_min_u32 s24, s23, 63
    s_mul_i32 s24, s24, 40960
    s_add_u32 s24, s24, s18
    s_mul_i32 s25, s13, 10240
    s_add_u32 s25, s25, s17
    s_add_u32 s17, s17, 40960
    s_cmp_eq_u32 s17, 122880
    s_cselect_b32 s17, 0, s17
    ds_read_b128 v[40:43], v2 offset:6144
    s_waitcnt lgkmcnt(6)
    v_mfma_f32_32x32x16_bf16 v[48:63], a[0:3], v[16:19], 0
    ds_read_b128 v[44:47], v2 offset:7168
    s_waitcnt lgkmcnt(6)
    v_mfma_f32_32x32x16_bf16 v[64:79], a[4:7], v[20:23], 0
    s_mov_b32 m0, s25
    s_nop 0
    buffer_load_dwordx4 v1, s[8:11], s24 offen offset:0 sc1 lds
    ds_read_b128 v[16:19], v2 offset:8192
    s_waitcnt lgkmcnt(6)
    v_mfma_f32_32x32x16_bf16 v[48:63], a[8:11], v[24:27], v[48:63]
    ds_read_b128 v[20:23], v2 offset:9216
    s_waitcnt lgkmcnt(6)
    v_mfma_f32_32x32x16_bf16 v[64:79], a[12:15], v[28:31], v[64:79]
    ds_read_b128 v[24:27], v2 offset:10240
    s_waitcnt lgkmcnt(6)
    v_mfma_f32_32x32x16_bf16 v[48:63], a[16:19], v[32:35], v[48:63]
    buffer_load_dwordx4 v1, s[8:11], s24 offen offset:1024 sc1 lds
    ds_read_b128 v[28:31], v2 offset:11264
    s_waitcnt lgkmcnt(6)
    v_mfma_f32_32x32x16_bf16 v[64:79], a[20:23], v[36:39], v[64:79]
    ds_read_b128 v[32:35], v2 offset:12288
    s_waitcnt lgkmcnt(6)
    v_mfma_f32_32x32x16_bf16 v[48:63], a[24:27], v[40:43], v[48:63]
    ds_read_b128 v[36:39], v2 offset:13312
    s_waitcnt lgkmcnt(6)
    v_mfma_f32_32x32x16_bf16 v[64:79], a[28:31], v[44:47], v[64:79]
    buffer_load_dwordx4 v1, s[8:11], s24 offen offset:2048 sc1 lds
    ds_read_b128 v[40:43], v2 offset:14336
    s_waitcnt lgkmcnt(6)
    v_mfma_f32_32x32x16_bf16 v[48:63], a[32:35], v[16:19], v[48:63]
    ds_read_b128 v[44:47], v2 offset:15360
    s_waitcnt lgkmcnt(6)
    v_mfma_f32_32x32x16_bf16 v[64:79], a[36:39], v[20:23], v[64:79]
    ds_read_b128 v[16:19], v2 offset:16384
    s_waitcnt lgkmcnt(6)
    v_mfma_f32_32x32x16_bf16 v[48:63], a[40:43], v[24:27], v[48:63]
    buffer_load_dwordx4 v1, s[8:11], s24 offen offset:3072 sc1 lds
    ds_read_b128 v[20:23], v2 offset:17408
    s_waitcnt lgkmcnt(6)
    v_mfma_f32_32x32x16_bf16 v[64:79], a[44:47], v[28:31], v[64:79]
    ds_read_b128 v[24:27], v2 offset:18432
    s_waitcnt lgkmcnt(6)
    v_mfma_f32_32x32x16_bf16 v[48:63], a[48:51], v[32:35], v[48:63]
    ds_read_b128 v[28:31], v2 offset:19456
    s_waitcnt lgkmcnt(6)
    v_mfma_f32_32x32x16_bf16 v[64:79], a[52:55], v[36:39], v[64:79]
    s_add_u32 s24, s24, 4096
    s_add_u32 s25, s25, 4096
    s_mov_b32 m0, s25
    s_nop 0
    buffer_load_dwordx4 v1, s[8:11], s24 offen offset:0 sc1 lds
    ds_read_b128 v[32:35], v2 offset:20480
    s_waitcnt lgkmcnt(6)
    v_mfma_f32_32x32x16_bf16 v[48:63], a[56:59], v[40:43], v[48:63]
    ds_read_b128 v[36:39], v2 offset:21504
    s_waitcnt lgkmcnt(6)
    v_mfma_f32_32x32x16_bf16 v[64:79], a[60:63], v[44:47], v[64:79]
    ds_read_b128 v[40:43], v2 offset:22528
    s_waitcnt lgkmcnt(6)
    v_mfma_f32_32x32x16_bf16 v[48:63], a[64:67], v[16:19], v[48:63]
    buffer_load_dwordx4 v1, s[8:11], s24 offen offset:1024 sc1 lds
    ds_read_b128 v[44:47], v2 offset:23552
    s_waitcnt lgkmcnt(6)
    v_mfma_f32_32x32x16_bf16 v[64:79], a[68:71], v[20:23], v[64:79]
    ds_read_b128 v[16:19], v2 offset:24576
    s_waitcnt lgkmcnt(6)
    v_mfma_f32_32x32x16_bf16 v[48:63], a[72:75], v[24:27], v[48:63]
    ds_read_b128 v[20:23], v2 offset:25600
    s_waitcnt lgkmcnt(6)
    v_mfma_f32_32x32x16_bf16 v[64:79], a[76:79], v[28:31], v[64:79]
    buffer_load_dwordx4 v1, s[8:11], s24 offen offset:2048 sc1 lds
    ds_read_b128 v[24:27], v2 offset:26624
    s_waitcnt lgkmcnt(6)
    v_mfma_f32_32x32x16_bf16 v[48:63], a[80:83], v[32:35], v[48:63]
    ds_read_b128 v[28:31], v2 offset:27648
    s_waitcnt lgkmcnt(6)
    v_mfma_f32_32x32x16_bf16 v[64:79], a[84:87], v[36:39], v[64:79]
    ds_read_b128 v[32:35], v2 offset:28672
    s_waitcnt lgkmcnt(6)
    v_mfma_f32_32x32x16_bf16 v[48:63], a[88:91], v[40:43], v[48:63]
    buffer_load_dwordx4 v1, s[8:11], s24 offen offset:3072 sc1 lds
    ds_read_b128 v[36:39], v2 offset:29696
    s_waitcnt lgkmcnt(6)
    v_mfma_f32_32x32x16_bf16 v[64:79], a[92:95], v[44:47], v[64:79]
    ds_read_b128 v[40:43], v2 offset:30720
    s_waitcnt lgkmcnt(6)
    v_mfma_f32_32x32x16_bf16 v[48:63], a[96:99], v[16:19], v[48:63]
    ds_read_b128 v[44:47], v2 offset:31744
    s_waitcnt lgkmcnt(6)
    v_mfma_f32_32x32x16_bf16 v[64:79], a[100:103], v[20:23], v[64:79]
    s_add_u32 s24, s24, 4096
    s_add_u32 s25, s25, 4096
    s_mov_b32 m0, s25
    s_nop 0
    buffer_load_dwordx4 v1, s[8:11], s24 offen offset:0 sc1 lds
    ds_read_b128 v[16:19], v2 offset:32768
    s_waitcnt lgkmcnt(6)
    v_mfma_f32_32x32x16_bf16 v[48:63], a[104:107], v[24:27], v[48:63]
    ds_read_b128 v[20:23], v2 offset:33792
    s_waitcnt lgkmcnt(6)
    v_mfma_f32_32x32x16_bf16 v[64:79], a[108:111], v[28:31], v[64:79]
    ds_read_b128 v[24:27], v2 offset:34816
    s_waitcnt lgkmcnt(6)
    v_mfma_f32_32x32x16_bf16 v[48:63], a[112:115], v[32:35], v[48:63]
    buffer_load_dwordx4 v1, s[8:11], s24 offen offset:1024 sc1 lds
    ds_read_b128 v[28:31], v2 offset:35840
    s_waitcnt lgkmcnt(6)
    v_mfma_f32_32x32x16_bf16 v[64:79], a[116:119], v[36:39], v[64:79]
    ds_read_b128 v[32:35], v2 offset:36864
    s_waitcnt lgkmcnt(6)
    v_mfma_f32_32x32x16_bf16 v[48:63], a[120:123], v[40:43], v[48:63]
    ds_read_b128 v[36:39], v2 offset:37888
    s_waitcnt lgkmcnt(6)
    v_mfma_f32_32x32x16_bf16 v[64:79], a[124:127], v[44:47], v[64:79]
    ds_read_b128 v[40:43], v2 offset:38912
    s_waitcnt lgkmcnt(6)
    v_mfma_f32_32x32x16_bf16 v[48:63], a[128:131], v[16:19], v[48:63]
    ds_read_b128 v[44:47], v2 offset:39936
    s_waitcnt lgkmcnt(6)
    v_mfma_f32_32x32x16_bf16 v[64:79], a[132:135], v[20:23], v[64:79]
    s_waitcnt lgkmcnt(5)
    v_mfma_f32_32x32x16_bf16 v[48:63], a[136:139], v[24:27], v[48:63]
    s_waitcnt lgkmcnt(4)
    v_mfma_f32_32x32x16_bf16 v[64:79], a[140:143], v[28:31], v[64:79]
    s_waitcnt lgkmcnt(3)
    v_mfma_f32_32x32x16_bf16 v[48:63], a[144:147], v[32:35], v[48:63]
    s_waitcnt lgkmcnt(2)
    v_mfma_f32_32x32x16_bf16 v[64:79], a[148:151], v[36:39], v[64:79]
    s_waitcnt lgkmcnt(1)
    v_mfma_f32_32x32x16_bf16 v[48:63], a[152:155], v[40:43], v[48:63]
    s_waitcnt lgkmcnt(0)
    v_mfma_f32_32x32x16_bf16 v[64:79], a[156:159], v[44:47], v[64:79]
    s_waitcnt vmcnt(15)
    s_nop 7
    s_nop 3
    v_add_f32 v48, v48, v64
    v_add_f32 v49, v49, v65
    v_add_f32 v50, v50, v66
    v_add_f32 v51, v51, v67
    v_add_f32 v52, v52, v68
    v_add_f32 v53, v53, v69
    v_add_f32 v54, v54, v70
    v_add_f32 v55, v55, v71
    v_add_f32 v56, v56, v72
    v_add_f32 v57, v57, v73
    v_add_f32 v58, v58, v74
    v_add_f32 v59, v59, v75
    v_add_f32 v60, v60, v76
    v_add_f32 v61, v61, v77
    v_add_f32 v62, v62, v78
    v_add_f32 v63, v63, v79
    s_add_u32 s26, s19, 226492416
    v_cvt_pk_bf16_f32 v80, v48, v49
    v_cvt_pk_bf16_f32 v81, v50, v51
    v_cvt_pk_bf16_f32 v82, v52, v53
    v_cvt_pk_bf16_f32 v83, v54, v55
    s_nop 1
    v_permlane32_swap_b32 v80, v82
    v_permlane32_swap_b32 v81, v83
    s_nop 1
    v_lshlrev_b32 v88, 16, v80
    v_and_b32 v89, 0xffff0000, v80
    v_lshlrev_b32 v90, 16, v104
    v_and_b32 v91, 0xffff0000, v104
    v_add_f32 v88, v88, v90
    v_add_f32 v89, v89, v91
    v_cvt_pk_bf16_f32 v80, v88, v89
    v_lshlrev_b32 v92, 16, v81
    v_and_b32 v93, 0xffff0000, v81
    v_lshlrev_b32 v94, 16, v105
    v_and_b32 v95, 0xffff0000, v105
    v_add_f32 v92, v92, v94
    v_add_f32 v93, v93, v95
    v_cvt_pk_bf16_f32 v81, v92, v93
    v_lshlrev_b32 v88, 16, v82
    v_and_b32 v89, 0xffff0000, v82
    v_lshlrev_b32 v90, 16, v106
    v_and_b32 v91, 0xffff0000, v106
    v_add_f32 v88, v88, v90
    v_add_f32 v89, v89, v91
    v_cvt_pk_bf16_f32 v82, v88, v89
    v_lshlrev_b32 v92, 16, v83
    v_and_b32 v93, 0xffff0000, v83
    v_lshlrev_b32 v94, 16, v107
    v_and_b32 v95, 0xffff0000, v107
    v_add_f32 v92, v92, v94
    v_add_f32 v93, v93, v95
    v_cvt_pk_bf16_f32 v83, v92, v93
    buffer_store_dwordx4 v[80:83], v3, s[8:11], s26 offen offset:0 sc1
    v_cvt_pk_bf16_f32 v84, v56, v57
    v_cvt_pk_bf16_f32 v85, v58, v59
    v_cvt_pk_bf16_f32 v86, v60, v61
    v_cvt_pk_bf16_f32 v87, v62, v63
    s_nop 1
    v_permlane32_swap_b32 v84, v86
    v_permlane32_swap_b32 v85, v87
    s_nop 1
    v_lshlrev_b32 v88, 16, v84
    v_and_b32 v89, 0xffff0000, v84
    v_lshlrev_b32 v90, 16, v108
    v_and_b32 v91, 0xffff0000, v108
    v_add_f32 v88, v88, v90
    v_add_f32 v89, v89, v91
    v_cvt_pk_bf16_f32 v84, v88, v89
    v_lshlrev_b32 v92, 16, v85
    v_and_b32 v93, 0xffff0000, v85
    v_lshlrev_b32 v94, 16, v109
    v_and_b32 v95, 0xffff0000, v109
    v_add_f32 v92, v92, v94
    v_add_f32 v93, v93, v95
    v_cvt_pk_bf16_f32 v85, v92, v93
    v_lshlrev_b32 v88, 16, v86
    v_and_b32 v89, 0xffff0000, v86
    v_lshlrev_b32 v90, 16, v110
    v_and_b32 v91, 0xffff0000, v110
    v_add_f32 v88, v88, v90
    v_add_f32 v89, v89, v91
    v_cvt_pk_bf16_f32 v86, v88, v89
    v_lshlrev_b32 v92, 16, v87
    v_and_b32 v93, 0xffff0000, v87
    v_lshlrev_b32 v94, 16, v111
    v_and_b32 v95, 0xffff0000, v111
    v_add_f32 v92, v92, v94
    v_add_f32 v93, v93, v95
    v_cvt_pk_bf16_f32 v87, v92, v93
    buffer_store_dwordx4 v[84:87], v3, s[8:11], s26 offen offset:32 sc1
    s_waitcnt vmcnt(15)
    s_mov_b64 exec, 1
    s_add_u32 s26, s48, s20
    buffer_store_dword v5, v4, s[8:11], s26 offen sc1
    s_mov_b64 exec, -1
    s_add_u32 s20, s20, 128
    s_add_u32 s19, s19, 40960
    s_add_u32 s16, s16, 40960
    s_cmp_eq_u32 s16, 122880
    s_cselect_b32 s16, 0, s16
    s_add_u32 s14, s14, 1
    s_cmp_lt_u32 s14, s15
    s_cbranch_scc1 layerb1_kernel_ab_loop
layerb1_kernel_ab_fin:
    s_waitcnt vmcnt(0) lgkmcnt(0)
    s_mov_b64 exec, 1
    s_add_u32 s26, s48, s20
    buffer_store_dword v5, v4, s[8:11], s26 offen sc1
    s_mov_b64 exec, -1
    s_add_u32 s20, s20, 128
    s_barrier
    s_branch layerb1_kernel_w3
layerb1_kernel_sp_ln:
    s_sub_u32 s12, s22, 5
    s_mov_b32 s14, s12
    s_mov_b32 s16, 0x3f803f80
    v_lshrrev_b32 v6, 3, v0
    v_and_b32 v7, 7, v0
    v_mul_u32_u24 v1, 1280, v6
    v_lshl_add_u32 v1, v7, 5, v1
    v_lshlrev_b32 v2, 10, v7
    v_lshl_add_u32 v2, v6, 4, v2
    v_lshlrev_b32 v3, 2, v0
    v_mov_b32 v4, 1
layerb1_kernel_ln_seg:
    s_lshl_b32 s17, s14, 7
    s_add_u32 s17, s17, s48
    s_add_u32 s17, s17, 36864
    s_mov_b64 exec, 0xfffff
layerb1_kernel_ln_poll:
    buffer_load_dword v5, v3, s[8:11], s17 offen sc1
    s_waitcnt vmcnt(0)
    v_cmp_eq_u32 vcc, 0, v5
    s_sub_u32 s15, s15, 1
    s_cbranch_scc1 layerb1_kernel_bail
    s_cbranch_vccnz layerb1_kernel_ln_poll
    s_mov_b64 exec, -1
    s_lshl_b32 s18, s14, 5
    s_lshl_b32 s19, s13, 3
    s_add_u32 s18, s18, s19
    s_mul_i32 s18, s18, 1280
    s_add_u32 s18, s18, 226492416
    buffer_load_dwordx4 v[16:19], v1, s[8:11], s18 offen offset:0 sc1
    buffer_load_dwordx4 v[20:23], v1, s[8:11], s18 offen offset:16 sc1
    buffer_load_dwordx4 v[24:27], v1, s[8:11], s18 offen offset:256 sc1
    buffer_load_dwordx4 v[28:31], v1, s[8:11], s18 offen offset:272 sc1
    buffer_load_dwordx4 v[32:35], v1, s[8:11], s18 offen offset:512 sc1
    buffer_load_dwordx4 v[36:39], v1, s[8:11], s18 offen offset:528 sc1
    buffer_load_dwordx4 v[40:43], v1, s[8:11], s18 offen offset:768 sc1
    buffer_load_dwordx4 v[44:47], v1, s[8:11], s18 offen offset:784 sc1
    buffer_load_dwordx4 v[48:51], v1, s[8:11], s18 offen offset:1024 sc1
    buffer_load_dwordx4 v[52:55], v1, s[8:11], s18 offen offset:1040 sc1
    v_mov_b32 v8, 0
    v_mov_b32 v9, 0
    v_mov_b32 v10, 0
    v_mov_b32 v11, 0
    s_waitcnt vmcnt(9)
    v_dot2c_f32_bf16 v8, s16, v16
    v_dot2c_f32_bf16 v10, v16, v16
    v_dot2c_f32_bf16 v9, s16, v17
    v_dot2c_f32_bf16 v11, v17, v17
    v_dot2c_f32_bf16 v8, s16, v18
    v_dot2c_f32_bf16 v10, v18, v18
    v_dot2c_f32_bf16 v9, s16, v19
    v_dot2c_f32_bf16 v11, v19, v19
    s_waitcnt vmcnt(8)
    v_dot2c_f32_bf16 v8, s16, v20
    v_dot2c_f32_bf16 v10, v20, v20
    v_dot2c_f32_bf16 v9, s16, v21
    v_dot2c_f32_bf16 v11, v21, v21
    v_dot2c_f32_bf16 v8, s16, v22
    v_dot2c_f32_bf16 v10, v22, v22
    v_dot2c_f32_bf16 v9, s16, v23
    v_dot2c_f32_bf16 v11, v23, v23
    s_waitcnt vmcnt(7)
    v_dot2c_f32_bf16 v8, s16, v24
    v_dot2c_f32_bf16 v10, v24, v24
    v_dot2c_f32_bf16 v9, s16, v25
    v_dot2c_f32_bf16 v11, v25, v25
    v_dot2c_f32_bf16 v8, s16, v26
    v_dot2c_f32_bf16 v10, v26, v26
    v_dot2c_f32_bf16 v9, s16, v27
    v_dot2c_f32_bf16 v11, v27, v27
    s_waitcnt vmcnt(6)
    v_dot2c_f32_bf16 v8, s16, v28
    v_dot2c_f32_bf16 v10, v28, v28
    v_dot2c_f32_bf16 v9, s16, v29
    v_dot2c_f32_bf16 v11, v29, v29
    v_dot2c_f32_bf16 v8, s16, v30
    v_dot2c_f32_bf16 v10, v30, v30
    v_dot2c_f32_bf16 v9, s16, v31
    v_dot2c_f32_bf16 v11, v31, v31
    s_waitcnt vmcnt(5)
    v_dot2c_f32_bf16 v8, s16, v32
    v_dot2c_f32_bf16 v10, v32, v32
    v_dot2c_f32_bf16 v9, s16, v33
    v_dot2c_f32_bf16 v11, v33, v33
    v_dot2c_f32_bf16 v8, s16, v34
    v_dot2c_f32_bf16 v10, v34, v34
    v_dot2c_f32_bf16 v9, s16, v35
    v_dot2c_f32_bf16 v11, v35, v35
    s_waitcnt vmcnt(4)
    v_dot2c_f32_bf16 v8, s16, v36
    v_dot2c_f32_bf16 v10, v36, v36
    v_dot2c_f32_bf16 v9, s16, v37
    v_dot2c_f32_bf16 v11, v37, v37
    v_dot2c_f32_bf16 v8, s16, v38
    v_dot2c_f32_bf16 v10, v38, v38
    v_dot2c_f32_bf16 v9, s16, v39
    v_dot2c_f32_bf16 v11, v39, v39
    s_waitcnt vmcnt(3)
    v_dot2c_f32_bf16 v8, s16, v40
    v_dot2c_f32_bf16 v10, v40, v40
    v_dot2c_f32_bf16 v9, s16, v41
    v_dot2c_f32_bf16 v11, v41, v41
    v_dot2c_f32_bf16 v8, s16, v42
    v_dot2c_f32_bf16 v10, v42, v42
    v_dot2c_f32_bf16 v9, s16, v43
    v_dot2c_f32_bf16 v11, v43, v43
    s_waitcnt vmcnt(2)
    v_dot2c_f32_bf16 v8, s16, v44
    v_dot2c_f32_bf16 v10, v44, v44
    v_dot2c_f32_bf16 v9, s16, v45
    v_dot2c_f32_bf16 v11, v45, v45
    v_dot2c_f32_bf16 v8, s16, v46
    v_dot2c_f32_bf16 v10, v46, v46
    v_dot2c_f32_bf16 v9, s16, v47
    v_dot2c_f32_bf16 v11, v47, v47
    s_waitcnt vmcnt(1)
    v_dot2c_f32_bf16 v8, s16, v48
    v_dot2c_f32_bf16 v10, v48, v48
    v_dot2c_f32_bf16 v9, s16, v49
    v_dot2c_f32_bf16 v11, v49, v49
    v_dot2c_f32_bf16 v8, s16, v50
    v_dot2c_f32_bf16 v10, v50, v50
    v_dot2c_f32_bf16 v9, s16, v51
    v_dot2c_f32_bf16 v11, v51, v51
    s_waitcnt vmcnt(0)
    v_dot2c_f32_bf16 v8, s16, v52
    v_dot2c_f32_bf16 v10, v52, v52
    v_dot2c_f32_bf16 v9, s16, v53
    v_dot2c_f32_bf16 v11, v53, v53
    v_dot2c_f32_bf16 v8, s16, v54
    v_dot2c_f32_bf16 v10, v54, v54
    v_dot2c_f32_bf16 v9, s16, v55
    v_dot2c_f32_bf16 v11, v55, v55
    s_nop 3
    v_add_f32 v8, v8, v9
    v_add_f32 v10, v10, v11
    s_nop 1
    v_add_f32_dpp v8, v8, v8 quad_perm:[1,0,3,2] row_mask:0xf bank_mask:0xf
    v_add_f32_dpp v10, v10, v10 quad_perm:[1,0,3,2] row_mask:0xf bank_mask:0xf
    s_nop 1
    v_add_f32_dpp v8, v8, v8 quad_perm:[2,3,0,1] row_mask:0xf bank_mask:0xf
    v_add_f32_dpp v10, v10, v10 quad_perm:[2,3,0,1] row_mask:0xf bank_mask:0xf
    s_nop 1
    v_add_f32_dpp v8, v8, v8 row_half_mirror row_mask:0xf bank_mask:0xf
    v_add_f32_dpp v10, v10, v10 row_half_mirror row_mask:0xf bank_mask:0xf
    v_mul_f32 v8, 0x3acccccd, v8
    v_mul_f32 v9, v8, v8
    v_mul_f32 v10, 0x3acccccd, v10
    v_sub_f32 v10, v10, v9
    v_max_f32 v10, 0, v10
    v_add_f32 v10, 0x3727c5ac, v10
    v_rsq_f32 v10, v10
    s_nop 0
    v_mul_f32 v8, v8, v10
    v_sub_f32 v8, 0, v8
    s_mul_i32 s18, s14, 40960
    s_lshl_b32 s19, s13, 7
    s_add_u32 s18, s18, s19
    s_add_u32 s18, s18, 220200960
    v_lshlrev_b32 v64, 16, v16
    v_and_b32 v65, 0xffff0000, v16
    v_fma_f32 v64, v64, v10, v8
    v_fma_f32 v65, v65, v10, v8
    v_cvt_pk_bf16_f32 v72, v64, v65
    v_lshlrev_b32 v66, 16, v17
    v_and_b32 v67, 0xffff0000, v17
    v_fma_f32 v66, v66, v10, v8
    v_fma_f32 v67, v67, v10, v8
    v_cvt_pk_bf16_f32 v74, v66, v67
    v_lshlrev_b32 v68, 16, v18
    v_and_b32 v69, 0xffff0000, v18
    v_fma_f32 v68, v68, v10, v8
    v_fma_f32 v69, v69, v10, v8
    v_cvt_pk_bf16_f32 v76, v68, v69
    v_lshlrev_b32 v70, 16, v19
    v_and_b32 v71, 0xffff0000, v19
    v_fma_f32 v70, v70, v10, v8
    v_fma_f32 v71, v71, v10, v8
    v_cvt_pk_bf16_f32 v78, v70, v71
    v_lshlrev_b32 v64, 16, v20
    v_and_b32 v65, 0xffff0000, v20
    v_fma_f32 v64, v64, v10, v8
    v_fma_f32 v65, v65, v10, v8
    v_cvt_pk_bf16_f32 v73, v64, v65
    v_lshlrev_b32 v66, 16, v21
    v_and_b32 v67, 0xffff0000, v21
    v_fma_f32 v66, v66, v10, v8
    v_fma_f32 v67, v67, v10, v8
    v_cvt_pk_bf16_f32 v75, v66, v67
    v_lshlrev_b32 v68, 16, v22
    v_and_b32 v69, 0xffff0000, v22
    v_fma_f32 v68, v68, v10, v8
    v_fma_f32 v69, v69, v10, v8
    v_cvt_pk_bf16_f32 v77, v68, v69
    v_lshlrev_b32 v70, 16, v23
    v_and_b32 v71, 0xffff0000, v23
    v_fma_f32 v70, v70, v10, v8
    v_fma_f32 v71, v71, v10, v8
    v_cvt_pk_bf16_f32 v79, v70, v71
    buffer_store_dwordx4 v[72:75], v2, s[8:11], s18 offen offset:0 sc1
    buffer_store_dwordx4 v[76:79], v2, s[8:11], s18 offen offset:512 sc1
    s_add_u32 s18, s18, 8192
    v_lshlrev_b32 v64, 16, v24
    v_and_b32 v65, 0xffff0000, v24
    v_fma_f32 v64, v64, v10, v8
    v_fma_f32 v65, v65, v10, v8
    v_cvt_pk_bf16_f32 v80, v64, v65
    v_lshlrev_b32 v66, 16, v25
    v_and_b32 v67, 0xffff0000, v25
    v_fma_f32 v66, v66, v10, v8
    v_fma_f32 v67, v67, v10, v8
    v_cvt_pk_bf16_f32 v82, v66, v67
    v_lshlrev_b32 v68, 16, v26
    v_and_b32 v69, 0xffff0000, v26
    v_fma_f32 v68, v68, v10, v8
    v_fma_f32 v69, v69, v10, v8
    v_cvt_pk_bf16_f32 v84, v68, v69
    v_lshlrev_b32 v70, 16, v27
    v_and_b32 v71, 0xffff0000, v27
    v_fma_f32 v70, v70, v10, v8
    v_fma_f32 v71, v71, v10, v8
    v_cvt_pk_bf16_f32 v86, v70, v71
    v_lshlrev_b32 v64, 16, v28
    v_and_b32 v65, 0xffff0000, v28
    v_fma_f32 v64, v64, v10, v8
    v_fma_f32 v65, v65, v10, v8
    v_cvt_pk_bf16_f32 v81, v64, v65
    v_lshlrev_b32 v66, 16, v29
    v_and_b32 v67, 0xffff0000, v29
    v_fma_f32 v66, v66, v10, v8
    v_fma_f32 v67, v67, v10, v8
    v_cvt_pk_bf16_f32 v83, v66, v67
    v_lshlrev_b32 v68, 16, v30
    v_and_b32 v69, 0xffff0000, v30
    v_fma_f32 v68, v68, v10, v8
    v_fma_f32 v69, v69, v10, v8
    v_cvt_pk_bf16_f32 v85, v68, v69
    v_lshlrev_b32 v70, 16, v31
    v_and_b32 v71, 0xffff0000, v31
    v_fma_f32 v70, v70, v10, v8
    v_fma_f32 v71, v71, v10, v8
    v_cvt_pk_bf16_f32 v87, v70, v71
    buffer_store_dwordx4 v[80:83], v2, s[8:11], s18 offen offset:0 sc1
    buffer_store_dwordx4 v[84:87], v2, s[8:11], s18 offen offset:512 sc1
    s_add_u32 s18, s18, 8192
    v_lshlrev_b32 v64, 16, v32
    v_and_b32 v65, 0xffff0000, v32
    v_fma_f32 v64, v64, v10, v8
    v_fma_f32 v65, v65, v10, v8
    v_cvt_pk_bf16_f32 v72, v64, v65
    v_lshlrev_b32 v66, 16, v33
    v_and_b32 v67, 0xffff0000, v33
    v_fma_f32 v66, v66, v10, v8
    v_fma_f32 v67, v67, v10, v8
    v_cvt_pk_bf16_f32 v74, v66, v67
    v_lshlrev_b32 v68, 16, v34
    v_and_b32 v69, 0xffff0000, v34
    v_fma_f32 v68, v68, v10, v8
    v_fma_f32 v69, v69, v10, v8
    v_cvt_pk_bf16_f32 v76, v68, v69
    v_lshlrev_b32 v70, 16, v35
    v_and_b32 v71, 0xffff0000, v35
    v_fma_f32 v70, v70, v10, v8
    v_fma_f32 v71, v71, v10, v8
    v_cvt_pk_bf16_f32 v78, v70, v71
    v_lshlrev_b32 v64, 16, v36
    v_and_b32 v65, 0xffff0000, v36
    v_fma_f32 v64, v64, v10, v8
    v_fma_f32 v65, v65, v10, v8
    v_cvt_pk_bf16_f32 v73, v64, v65
    v_lshlrev_b32 v66, 16, v37
    v_and_b32 v67, 0xffff0000, v37
    v_fma_f32 v66, v66, v10, v8
    v_fma_f32 v67, v67, v10, v8
    v_cvt_pk_bf16_f32 v75, v66, v67
    v_lshlrev_b32 v68, 16, v38
    v_and_b32 v69, 0xffff0000, v38
    v_fma_f32 v68, v68, v10, v8
    v_fma_f32 v69, v69, v10, v8
    v_cvt_pk_bf16_f32 v77, v68, v69
    v_lshlrev_b32 v70, 16, v39
    v_and_b32 v71, 0xffff0000, v39
    v_fma_f32 v70, v70, v10, v8
    v_fma_f32 v71, v71, v10, v8
    v_cvt_pk_bf16_f32 v79, v70, v71
    buffer_store_dwordx4 v[72:75], v2, s[8:11], s18 offen offset:0 sc1
    buffer_store_dwordx4 v[76:79], v2, s[8:11], s18 offen offset:512 sc1
    s_add_u32 s18, s18, 8192
    v_lshlrev_b32 v64, 16, v40
    v_and_b32 v65, 0xffff0000, v40
    v_fma_f32 v64, v64, v10, v8
    v_fma_f32 v65, v65, v10, v8
    v_cvt_pk_bf16_f32 v80, v64, v65
    v_lshlrev_b32 v66, 16, v41
    v_and_b32 v67, 0xffff0000, v41
    v_fma_f32 v66, v66, v10, v8
    v_fma_f32 v67, v67, v10, v8
    v_cvt_pk_bf16_f32 v82, v66, v67
    v_lshlrev_b32 v68, 16, v42
    v_and_b32 v69, 0xffff0000, v42
    v_fma_f32 v68, v68, v10, v8
    v_fma_f32 v69, v69, v10, v8
    v_cvt_pk_bf16_f32 v84, v68, v69
    v_lshlrev_b32 v70, 16, v43
    v_and_b32 v71, 0xffff0000, v43
    v_fma_f32 v70, v70, v10, v8
    v_fma_f32 v71, v71, v10, v8
    v_cvt_pk_bf16_f32 v86, v70, v71
    v_lshlrev_b32 v64, 16, v44
    v_and_b32 v65, 0xffff0000, v44
    v_fma_f32 v64, v64, v10, v8
    v_fma_f32 v65, v65, v10, v8
    v_cvt_pk_bf16_f32 v81, v64, v65
    v_lshlrev_b32 v66, 16, v45
    v_and_b32 v67, 0xffff0000, v45
    v_fma_f32 v66, v66, v10, v8
    v_fma_f32 v67, v67, v10, v8
    v_cvt_pk_bf16_f32 v83, v66, v67
    v_lshlrev_b32 v68, 16, v46
    v_and_b32 v69, 0xffff0000, v46
    v_fma_f32 v68, v68, v10, v8
    v_fma_f32 v69, v69, v10, v8
    v_cvt_pk_bf16_f32 v85, v68, v69
    v_lshlrev_b32 v70, 16, v47
    v_and_b32 v71, 0xffff0000, v47
    v_fma_f32 v70, v70, v10, v8
    v_fma_f32 v71, v71, v10, v8
    v_cvt_pk_bf16_f32 v87, v70, v71
    buffer_store_dwordx4 v[80:83], v2, s[8:11], s18 offen offset:0 sc1
    buffer_store_dwordx4 v[84:87], v2, s[8:11], s18 offen offset:512 sc1
    s_add_u32 s18, s18, 8192
    v_lshlrev_b32 v64, 16, v48
    v_and_b32 v65, 0xffff0000, v48
    v_fma_f32 v64, v64, v10, v8
    v_fma_f32 v65, v65, v10, v8
    v_cvt_pk_bf16_f32 v72, v64, v65
    v_lshlrev_b32 v66, 16, v49
    v_and_b32 v67, 0xffff0000, v49
    v_fma_f32 v66, v66, v10, v8
    v_fma_f32 v67, v67, v10, v8
    v_cvt_pk_bf16_f32 v74, v66, v67
    v_lshlrev_b32 v68, 16, v50
    v_and_b32 v69, 0xffff0000, v50
    v_fma_f32 v68, v68, v10, v8
    v_fma_f32 v69, v69, v10, v8
    v_cvt_pk_bf16_f32 v76, v68, v69
    v_lshlrev_b32 v70, 16, v51
    v_and_b32 v71, 0xffff0000, v51
    v_fma_f32 v70, v70, v10, v8
    v_fma_f32 v71, v71, v10, v8
    v_cvt_pk_bf16_f32 v78, v70, v71
    v_lshlrev_b32 v64, 16, v52
    v_and_b32 v65, 0xffff0000, v52
    v_fma_f32 v64, v64, v10, v8
    v_fma_f32 v65, v65, v10, v8
    v_cvt_pk_bf16_f32 v73, v64, v65
    v_lshlrev_b32 v66, 16, v53
    v_and_b32 v67, 0xffff0000, v53
    v_fma_f32 v66, v66, v10, v8
    v_fma_f32 v67, v67, v10, v8
    v_cvt_pk_bf16_f32 v75, v66, v67
    v_lshlrev_b32 v68, 16, v54
    v_and_b32 v69, 0xffff0000, v54
    v_fma_f32 v68, v68, v10, v8
    v_fma_f32 v69, v69, v10, v8
    v_cvt_pk_bf16_f32 v77, v68, v69
    v_lshlrev_b32 v70, 16, v55
    v_and_b32 v71, 0xffff0000, v55
    v_fma_f32 v70, v70, v10, v8
    v_fma_f32 v71, v71, v10, v8
    v_cvt_pk_bf16_f32 v79, v70, v71
    buffer_store_dwordx4 v[72:75], v2, s[8:11], s18 offen offset:0 sc1
    buffer_store_dwordx4 v[76:79], v2, s[8:11], s18 offen offset:512 sc1
    s_waitcnt vmcnt(0)
    s_lshl_b32 s17, s14, 4
    s_lshl_b32 s19, s13, 2
    s_add_u32 s17, s17, s19
    s_add_u32 s17, s17, s48
    s_add_u32 s17, s17, 45056
    v_mov_b32 v5, 0
    s_mov_b64 exec, 1
    buffer_store_dword v4, v5, s[8:11], s17 offen sc1
    s_mov_b64 exec, -1
    s_add_u32 s14, s14, 4
    s_cmp_lt_u32 s14, 64
    s_cbranch_scc1 layerb1_kernel_ln_seg
    s_waitcnt vmcnt(0)
    s_barrier
layerb1_kernel_w3:
    s_mov_b32 s15, 400000
layerb1_kernel_j_next:
    s_cmp_lg_u32 s13, 0
    s_cbranch_scc1 layerb1_kernel_j_rel
    s_mov_b64 exec, 1
    v_mov_b32 v2, 31744
    v_mov_b32 v3, 1
    buffer_atomic_add v3, v2, s[8:11], s48 offen sc0 sc1
    s_waitcnt vmcnt(0)
    s_mov_b64 exec, -1
    s_nop 0
    v_readfirstlane_b32 s38, v3
    s_cmp_ge_u32 s38, 1152
    s_cbranch_scc1 layerb1_kernel_j_pub
    s_mul_i32 s39, s38, 58255
    s_lshr_b32 s40, s39, 20
    s_mul_i32 s39, s40, 18
    s_sub_u32 s41, s38, s39
    s_add_u32 s42, s40, 1
    v_mov_b32 v4, s42
    s_cmp_ge_u32 s41, 8
    s_cbranch_scc1 layerb1_kernel_j_dep_b
    s_lshl_b32 s24, s41, 9
    s_add_u32 s24, s24, 16384
    v_lshlrev_b32 v2, 7, v0
    v_add_u32 v2, s24, v2
    s_mul_i32 s25, s41, 3
    s_add_u32 s25, s25, 104
    s_lshl_b32 s25, s25, 7
    v_writelane_b32 v2, s25, 4
    s_add_u32 s25, s25, 128
    v_writelane_b32 v2, s25, 5
    s_add_u32 s25, s25, 128
    v_writelane_b32 v2, s25, 6
    s_mov_b64 exec, 0x7f
    s_branch layerb1_kernel_j_poll
layerb1_kernel_j_dep_b:
    s_sub_u32 s24, s41, 8
    s_lshl_b32 s24, s24, 10
    s_add_u32 s24, s24, 20480
    v_lshlrev_b32 v2, 7, v0
    v_add_u32 v2, s24, v2
    s_lshl_b32 s25, s40, 4
    s_add_u32 s25, s25, 30720
    v_writelane_b32 v2, s25, 8
    s_mov_b32 s26, 8
    v_writelane_b32 v4, s26, 8
    s_mov_b64 exec, 0x1ff
layerb1_kernel_j_poll:
    buffer_load_dword v3, v2, s[8:11], s48 offen sc1
    s_waitcnt vmcnt(0)
    v_cmp_gt_u32 vcc, v4, v3
    s_sub_u32 s15, s15, 1
    s_cbranch_scc1 layerb1_kernel_j_giveup
    s_cbranch_vccnz layerb1_kernel_j_poll
    s_mov_b64 exec, -1
layerb1_kernel_j_pub:
    v_mov_b32 v2, 0
    v_mov_b32 v3, s38
    ds_write_b32 v2, v3 offset:32768
    s_waitcnt lgkmcnt(0)
layerb1_kernel_j_rel:
    s_barrier
    v_mov_b32 v2, 0
    ds_read_b32 v3, v2 offset:32768
    s_waitcnt lgkmcnt(0)
    v_readfirstlane_b32 s38, v3
    s_cmp_ge_u32 s38, 1152
    s_cbranch_scc1 layerb1_kernel_j_done
    s_mul_i32 s39, s38, 58255
    s_lshr_b32 s40, s39, 20
    s_mul_i32 s39, s40, 18
    s_sub_u32 s41, s38, s39
    s_cmp_ge_u32 s41, 8
    s_cbranch_scc1 layerb1_kernel_j_b
    s_lshl_b32 s41, s41, 2
    s_add_u32 s41, s41, s13
    v_lshlrev_b32 v1, 4, v0
    v_and_b32 v2, 31, v0
    v_lshrrev_b32 v3, 5, v0
    s_lshl_b32 s24, s40, 5
    s_add_u32 s24, s24, s41
    s_mul_i32 s25, s24, 12288
    s_add_u32 s26, s25, 78643200
    s_add_u32 s27, s25, 53477376
    s_mul_i32 s28, s24, 3072
    s_add_u32 s28, s28, 208666624
    v_and_b32 v4, 7, v0
    v_lshlrev_b32 v4, 4, v4
    v_lshl_add_u32 v4, v3, 7, v4
    buffer_load_dwordx4 v[16:19], v1, s[8:11], s26 offen offset:0 sc1
    buffer_load_dwordx4 v[64:67], v1, s[8:11], s27 offen offset:0 sc1
    buffer_load_dwordx4 v[112:115], v4, s[8:11], s28 offen offset:0 sc1
    buffer_load_dwordx4 v[20:23], v1, s[8:11], s26 offen offset:1024 sc1
    buffer_load_dwordx4 v[68:71], v1, s[8:11], s27 offen offset:1024 sc1
    buffer_load_dwordx4 v[116:119], v4, s[8:11], s28 offen offset:256 sc1
    buffer_load_dwordx4 v[24:27], v1, s[8:11], s26 offen offset:2048 sc1
    buffer_load_dwordx4 v[72:75], v1, s[8:11], s27 offen offset:2048 sc1
    buffer_load_dwordx4 v[120:123], v4, s[8:11], s28 offen offset:512 sc1
    buffer_load_dwordx4 v[28:31], v1, s[8:11], s26 offen offset:3072 sc1
    buffer_load_dwordx4 v[76:79], v1, s[8:11], s27 offen offset:3072 sc1
    buffer_load_dwordx4 v[124:127], v4, s[8:11], s28 offen offset:768 sc1
    s_add_u32 s26, s26, 4096
    s_add_u32 s27, s27, 4096
    buffer_load_dwordx4 v[32:35], v1, s[8:11], s26 offen offset:0 sc1
    buffer_load_dwordx4 v[80:83], v1, s[8:11], s27 offen offset:0 sc1
    buffer_load_dwordx4 v[128:131], v4, s[8:11], s28 offen offset:1024 sc1
    buffer_load_dwordx4 v[36:39], v1, s[8:11], s26 offen offset:1024 sc1
    buffer_load_dwordx4 v[84:87], v1, s[8:11], s27 offen offset:1024 sc1
    buffer_load_dwordx4 v[132:135], v4, s[8:11], s28 offen offset:1280 sc1
    buffer_load_dwordx4 v[40:43], v1, s[8:11], s26 offen offset:2048 sc1
    buffer_load_dwordx4 v[88:91], v1, s[8:11], s27 offen offset:2048 sc1
    buffer_load_dwordx4 v[136:139], v4, s[8:11], s28 offen offset:1536 sc1
    buffer_load_dwordx4 v[44:47], v1, s[8:11], s26 offen offset:3072 sc1
    buffer_load_dwordx4 v[92:95], v1, s[8:11], s27 offen offset:3072 sc1
    buffer_load_dwordx4 v[140:143], v4, s[8:11], s28 offen offset:1792 sc1
    s_add_u32 s26, s26, 4096
    s_add_u32 s27, s27, 4096
    buffer_load_dwordx4 v[48:51], v1, s[8:11], s26 offen offset:0 sc1
    buffer_load_dwordx4 v[96:99], v1, s[8:11], s27 offen offset:0 sc1
    buffer_load_dwordx4 v[144:147], v4, s[8:11], s28 offen offset:2048 sc1
    buffer_load_dwordx4 v[52:55], v1, s[8:11], s26 offen offset:1024 sc1
    buffer_load_dwordx4 v[100:103], v1, s[8:11], s27 offen offset:1024 sc1
    buffer_load_dwordx4 v[148:151], v4, s[8:11], s28 offen offset:2304 sc1
    buffer_load_dwordx4 v[56:59], v1, s[8:11], s26 offen offset:2048 sc1
    buffer_load_dwordx4 v[104:107], v1, s[8:11], s27 offen offset:2048 sc1
    buffer_load_dwordx4 v[152:155], v4, s[8:11], s28 offen offset:2560 sc1
    buffer_load_dwordx4 v[60:63], v1, s[8:11], s26 offen offset:3072 sc1
    buffer_load_dwordx4 v[108:111], v1, s[8:11], s27 offen offset:3072 sc1
    buffer_load_dwordx4 v[156:159], v4, s[8:11], s28 offen offset:2816 sc1
    v_lshlrev_b32 v5, 2, v3
    v_sub_u32 v5, v2, v5
    v_mov_b32 v6, 0xf149f2ca
    v_cmp_gt_i32 vcc, 0, v5
    s_nop 1
    v_cndmask_b32 v192, 0, v6, vcc
    v_cmp_gt_i32 vcc, 1, v5
    s_nop 1
    v_cndmask_b32 v193, 0, v6, vcc
    v_cmp_gt_i32 vcc, 2, v5
    s_nop 1
    v_cndmask_b32 v194, 0, v6, vcc
    v_cmp_gt_i32 vcc, 3, v5
    s_nop 1
    v_cndmask_b32 v195, 0, v6, vcc
    v_cmp_gt_i32 vcc, 8, v5
    s_nop 1
    v_cndmask_b32 v196, 0, v6, vcc
    v_cmp_gt_i32 vcc, 9, v5
    s_nop 1
    v_cndmask_b32 v197, 0, v6, vcc
    v_cmp_gt_i32 vcc, 10, v5
    s_nop 1
    v_cndmask_b32 v198, 0, v6, vcc
    v_cmp_gt_i32 vcc, 11, v5
    s_nop 1
    v_cndmask_b32 v199, 0, v6, vcc
    v_cmp_gt_i32 vcc, 16, v5
    s_nop 1
    v_cndmask_b32 v200, 0, v6, vcc
    v_cmp_gt_i32 vcc, 17, v5
    s_nop 1
    v_cndmask_b32 v201, 0, v6, vcc
    v_cmp_gt_i32 vcc, 18, v5
    s_nop 1
    v_cndmask_b32 v202, 0, v6, vcc
    v_cmp_gt_i32 vcc, 19, v5
    s_nop 1
    v_cndmask_b32 v203, 0, v6, vcc
    v_cmp_gt_i32 vcc, 24, v5
    s_nop 1
    v_cndmask_b32 v204, 0, v6, vcc
    v_cmp_gt_i32 vcc, 25, v5
    s_nop 1
    v_cndmask_b32 v205, 0, v6, vcc
    v_cmp_gt_i32 vcc, 26, v5
    s_nop 1
    v_cndmask_b32 v206, 0, v6, vcc
    v_cmp_gt_i32 vcc, 27, v5
    s_nop 1
    v_cndmask_b32 v207, 0, v6, vcc
    s_waitcnt vmcnt(33)
    v_mfma_f32_32x32x16_bf16 v[160:175], v[64:67], v[16:19], 0
    v_mfma_f32_32x32x16_bf16 v[176:191], v[112:115], v[16:19], 0
    s_waitcnt vmcnt(30)
    v_mfma_f32_32x32x16_bf16 v[160:175], v[68:71], v[20:23], v[160:175]
    v_mfma_f32_32x32x16_bf16 v[176:191], v[116:119], v[20:23], v[176:191]
    s_waitcnt vmcnt(27)
    v_mfma_f32_32x32x16_bf16 v[160:175], v[72:75], v[24:27], v[160:175]
    v_mfma_f32_32x32x16_bf16 v[176:191], v[120:123], v[24:27], v[176:191]
    s_waitcnt vmcnt(24)
    v_mfma_f32_32x32x16_bf16 v[160:175], v[76:79], v[28:31], v[160:175]
    v_mfma_f32_32x32x16_bf16 v[176:191], v[124:127], v[28:31], v[176:191]
    s_waitcnt vmcnt(21)
    v_mfma_f32_32x32x16_bf16 v[160:175], v[80:83], v[32:35], v[160:175]
    v_mfma_f32_32x32x16_bf16 v[176:191], v[128:131], v[32:35], v[176:191]
    s_waitcnt vmcnt(18)
    v_mfma_f32_32x32x16_bf16 v[160:175], v[84:87], v[36:39], v[160:175]
    v_mfma_f32_32x32x16_bf16 v[176:191], v[132:135], v[36:39], v[176:191]
    s_waitcnt vmcnt(15)
    v_mfma_f32_32x32x16_bf16 v[160:175], v[88:91], v[40:43], v[160:175]
    v_mfma_f32_32x32x16_bf16 v[176:191], v[136:139], v[40:43], v[176:191]
    s_waitcnt vmcnt(12)
    v_mfma_f32_32x32x16_bf16 v[160:175], v[92:95], v[44:47], v[160:175]
    v_mfma_f32_32x32x16_bf16 v[176:191], v[140:143], v[44:47], v[176:191]
    s_waitcnt vmcnt(9)
    v_mfma_f32_32x32x16_bf16 v[160:175], v[96:99], v[48:51], v[160:175]
    v_mfma_f32_32x32x16_bf16 v[176:191], v[144:147], v[48:51], v[176:191]
    s_waitcnt vmcnt(6)
    v_mfma_f32_32x32x16_bf16 v[160:175], v[100:103], v[52:55], v[160:175]
    v_mfma_f32_32x32x16_bf16 v[176:191], v[148:151], v[52:55], v[176:191]
    s_waitcnt vmcnt(3)
    v_mfma_f32_32x32x16_bf16 v[160:175], v[104:107], v[56:59], v[160:175]
    v_mfma_f32_32x32x16_bf16 v[176:191], v[152:155], v[56:59], v[176:191]
    s_waitcnt vmcnt(0)
    v_mfma_f32_32x32x16_bf16 v[160:175], v[108:111], v[60:63], v[160:175]
    v_mfma_f32_32x32x16_bf16 v[176:191], v[156:159], v[60:63], v[176:191]
    s_nop 7
    s_nop 7
    v_mov_b32 v7, 0x3dd53b95
    v_fma_f32 v160, v160, v7, v192
    v_fma_f32 v161, v161, v7, v193
    v_fma_f32 v162, v162, v7, v194
    v_fma_f32 v163, v163, v7, v195
    v_fma_f32 v164, v164, v7, v196
    v_fma_f32 v165, v165, v7, v197
    v_fma_f32 v166, v166, v7, v198
    v_fma_f32 v167, v167, v7, v199
    v_fma_f32 v168, v168, v7, v200
    v_fma_f32 v169, v169, v7, v201
    v_fma_f32 v170, v170, v7, v202
    v_fma_f32 v171, v171, v7, v203
    v_fma_f32 v172, v172, v7, v204
    v_fma_f32 v173, v173, v7, v205
    v_fma_f32 v174, v174, v7, v206
    v_fma_f32 v175, v175, v7, v207
    v_mul_f32 v176, v176, v7
    v_mul_f32 v177, v177, v7
    v_mul_f32 v178, v178, v7
    v_mul_f32 v179, v179, v7
    v_max3_f32 v208, v160, v161, v162
    v_max3_f32 v208, v208, v163, v164
    v_max3_f32 v208, v208, v165, v166
    v_max3_f32 v208, v208, v167, v168
    v_max3_f32 v208, v208, v169, v170
    v_max3_f32 v208, v208, v171, v172
    v_max3_f32 v208, v208, v173, v174
    v_max3_f32 v208, v208, v175, v176
    v_max3_f32 v208, v208, v177, v178
    v_max_f32 v208, v208, v179
    v_mov_b32 v209, v208
    s_nop 1
    v_permlane32_swap_b32 v208, v209
    v_max_f32 v208, v208, v209
    v_sub_f32 v160, v160, v208
    v_sub_f32 v161, v161, v208
    v_sub_f32 v162, v162, v208
    v_sub_f32 v163, v163, v208
    v_sub_f32 v164, v164, v208
    v_sub_f32 v165, v165, v208
    v_sub_f32 v166, v166, v208
    v_sub_f32 v167, v167, v208
    v_sub_f32 v168, v168, v208
    v_sub_f32 v169, v169, v208
    v_sub_f32 v170, v170, v208
    v_sub_f32 v171, v171, v208
    v_sub_f32 v172, v172, v208
    v_sub_f32 v173, v173, v208
    v_sub_f32 v174, v174, v208
    v_sub_f32 v175, v175, v208
    v_sub_f32 v176, v176, v208
    v_sub_f32 v177, v177, v208
    v_sub_f32 v178, v178, v208
    v_sub_f32 v179, v179, v208
    v_exp_f32 v160, v160
    v_exp_f32 v161, v161
    v_exp_f32 v162, v162
    v_exp_f32 v163, v163
    v_exp_f32 v164, v164
    v_exp_f32 v165, v165
    v_exp_f32 v166, v166
    v_exp_f32 v167, v167
    v_exp_f32 v168, v168
    v_exp_f32 v169, v169
    v_exp_f32 v170, v170
    v_exp_f32 v171, v171
    v_exp_f32 v172, v172
    v_exp_f32 v173, v173
    v_exp_f32 v174, v174
    v_exp_f32 v175, v175
    v_exp_f32 v176, v176
    v_exp_f32 v177, v177
    v_exp_f32 v178, v178
    v_exp_f32 v179, v179
    s_nop 0
    v_add_f32 v210, v160, v161
    v_add_f32 v210, v210, v162
    v_add_f32 v210, v210, v163
    v_add_f32 v210, v210, v164
    v_add_f32 v210, v210, v165
    v_add_f32 v210, v210, v166
    v_add_f32 v210, v210, v167
    v_add_f32 v210, v210, v168
    v_add_f32 v210, v210, v169
    v_add_f32 v210, v210, v170
    v_add_f32 v210, v210, v171
    v_add_f32 v210, v210, v172
    v_add_f32 v210, v210, v173
    v_add_f32 v210, v210, v174
    v_add_f32 v210, v210, v175
    v_add_f32 v210, v210, v176
    v_add_f32 v210, v210, v177
    v_add_f32 v210, v210, v178
    v_add_f32 v210, v210, v179
    v_mov_b32 v209, v210
    s_nop 1
    v_permlane32_swap_b32 v210, v209
    v_add_f32 v210, v210, v209
    v_rcp_f32 v210, v210
    s_nop 0
    v_mul_f32 v160, v160, v210
    v_mul_f32 v161, v161, v210
    v_mul_f32 v162, v162, v210
    v_mul_f32 v163, v163, v210
    v_mul_f32 v164, v164, v210
    v_mul_f32 v165, v165, v210
    v_mul_f32 v166, v166, v210
    v_mul_f32 v167, v167, v210
    v_mul_f32 v168, v168, v210
    v_mul_f32 v169, v169, v210
    v_mul_f32 v170, v170, v210
    v_mul_f32 v171, v171, v210
    v_mul_f32 v172, v172, v210
    v_mul_f32 v173, v173, v210
    v_mul_f32 v174, v174, v210
    v_mul_f32 v175, v175, v210
    v_mul_f32 v176, v176, v210
    v_mul_f32 v177, v177, v210
    v_mul_f32 v178, v178, v210
    v_mul_f32 v179, v179, v210
    s_mul_i32 s25, s40, 81920
    s_mul_i32 s26, s41, 2560
    s_add_u32 s25, s25, s26
    s_add_u32 s25, s25, 214958080
    v_cvt_pk_bf16_f32 v16, v160, v161
    v_cvt_pk_bf16_f32 v17, v162, v163
    v_cvt_pk_bf16_f32 v18, v164, v165
    v_cvt_pk_bf16_f32 v19, v166, v167
    s_nop 1
    v_permlane32_swap_b32 v16, v18
    v_permlane32_swap_b32 v17, v19
    buffer_store_dwordx4 v[16:19], v1, s[8:11], s25 offen offset:512 sc1
    v_cvt_pk_bf16_f32 v20, v168, v169
    v_cvt_pk_bf16_f32 v21, v170, v171
    v_cvt_pk_bf16_f32 v22, v172, v173
    v_cvt_pk_bf16_f32 v23, v174, v175
    s_nop 1
    v_permlane32_swap_b32 v20, v22
    v_permlane32_swap_b32 v21, v23
    buffer_store_dwordx4 v[20:23], v1, s[8:11], s25 offen offset:1536 sc1
    v_cvt_pk_bf16_f32 v24, v176, v177
    v_cvt_pk_bf16_f32 v25, v178, v179
    v_lshlrev_b32 v4, 4, v2
    v_lshl_add_u32 v4, v3, 3, v4
    buffer_store_dwordx2 v[24:25], v4, s[8:11], s25 offen sc1
    s_waitcnt vmcnt(0)
    s_barrier
    s_cmp_lg_u32 s13, 0
    s_cbranch_scc1 layerb1_kernel_j_next
    s_mov_b64 exec, 1
    s_lshl_b32 s24, s40, 4
    s_add_u32 s24, s24, 30720
    v_mov_b32 v2, s24
    v_mov_b32 v3, 1
    buffer_atomic_add v3, v2, s[8:11], s48 offen sc1
    s_mov_b64 exec, -1
    s_branch layerb1_kernel_j_next
layerb1_kernel_j_b:
    s_sub_u32 s41, s41, 8
    v_lshlrev_b32 v1, 4, v0
    v_and_b32 v2, 31, v0
    v_lshrrev_b32 v3, 5, v0
    v_lshrrev_b32 v4, 3, v2
    v_mul_u32_u24 v4, 20480, v4
    v_and_b32 v5, 7, v2
    v_lshl_add_u32 v4, v5, 4, v4
    v_lshl_add_u32 v4, v3, 7, v4
    s_mul_i32 s24, s40, 1638400
    s_mul_i32 s25, s41, 163840
    s_add_u32 s24, s24, s25
    s_mul_i32 s25, s13, 5120
    s_add_u32 s24, s24, s25
    s_add_u32 s24, s24, 103809024
    s_add_u32 s28, s24, 81920
    s_mul_i32 s25, s40, 81920
    s_mul_i32 s26, s13, 20480
    s_add_u32 s25, s25, s26
    s_add_u32 s25, s25, 214958080
    v_mul_u32_u24 v6, 1280, v2
    v_lshl_add_u32 v6, v3, 4, v6
    s_mul_i32 s26, s40, 40960
    s_lshl_b32 s27, s41, 7
    s_add_u32 s26, s26, s27
    s_lshl_b32 s27, s13, 5
    s_add_u32 s26, s26, s27
    s_add_u32 s27, s26, 226492416
    buffer_load_dwordx4 v[8:11], v6, s[8:11], s27 offen sc1
    buffer_load_dwordx4 a[160:163], v1, s[8:11], s25 offen offset:0 sc1
    buffer_load_dwordx4 a[0:3], v4, s[8:11], s24 offen offset:0 sc1
    buffer_load_dwordx4 a[80:83], v4, s[8:11], s28 offen offset:0 sc1
    buffer_load_dwordx4 a[164:167], v1, s[8:11], s25 offen offset:1024 sc1
    buffer_load_dwordx4 a[4:7], v4, s[8:11], s24 offen offset:256 sc1
    buffer_load_dwordx4 a[84:87], v4, s[8:11], s28 offen offset:256 sc1
    buffer_load_dwordx4 a[168:171], v1, s[8:11], s25 offen offset:2048 sc1
    buffer_load_dwordx4 a[8:11], v4, s[8:11], s24 offen offset:512 sc1
    buffer_load_dwordx4 a[88:91], v4, s[8:11], s28 offen offset:512 sc1
    buffer_load_dwordx4 a[172:175], v1, s[8:11], s25 offen offset:3072 sc1
    buffer_load_dwordx4 a[12:15], v4, s[8:11], s24 offen offset:768 sc1
    buffer_load_dwordx4 a[92:95], v4, s[8:11], s28 offen offset:768 sc1
    s_add_u32 s25, s25, 4096
    buffer_load_dwordx4 a[176:179], v1, s[8:11], s25 offen offset:0 sc1
    buffer_load_dwordx4 a[16:19], v4, s[8:11], s24 offen offset:1024 sc1
    buffer_load_dwordx4 a[96:99], v4, s[8:11], s28 offen offset:1024 sc1
    buffer_load_dwordx4 a[180:183], v1, s[8:11], s25 offen offset:1024 sc1
    buffer_load_dwordx4 a[20:23], v4, s[8:11], s24 offen offset:1280 sc1
    buffer_load_dwordx4 a[100:103], v4, s[8:11], s28 offen offset:1280 sc1
    buffer_load_dwordx4 a[184:187], v1, s[8:11], s25 offen offset:2048 sc1
    buffer_load_dwordx4 a[24:27], v4, s[8:11], s24 offen offset:1536 sc1
    buffer_load_dwordx4 a[104:107], v4, s[8:11], s28 offen offset:1536 sc1
    buffer_load_dwordx4 a[188:191], v1, s[8:11], s25 offen offset:3072 sc1
    buffer_load_dwordx4 a[28:31], v4, s[8:11], s24 offen offset:1792 sc1
    buffer_load_dwordx4 a[108:111], v4, s[8:11], s28 offen offset:1792 sc1
    s_add_u32 s25, s25, 4096
    buffer_load_dwordx4 a[192:195], v1, s[8:11], s25 offen offset:0 sc1
    buffer_load_dwordx4 a[32:35], v4, s[8:11], s24 offen offset:2048 sc1
    buffer_load_dwordx4 a[112:115], v4, s[8:11], s28 offen offset:2048 sc1
    buffer_load_dwordx4 a[196:199], v1, s[8:11], s25 offen offset:1024 sc1
    buffer_load_dwordx4 a[36:39], v4, s[8:11], s24 offen offset:2304 sc1
    buffer_load_dwordx4 a[116:119], v4, s[8:11], s28 offen offset:2304 sc1
    buffer_load_dwordx4 a[200:203], v1, s[8:11], s25 offen offset:2048 sc1
    buffer_load_dwordx4 a[40:43], v4, s[8:11], s24 offen offset:2560 sc1
    buffer_load_dwordx4 a[120:123], v4, s[8:11], s28 offen offset:2560 sc1
    buffer_load_dwordx4 a[204:207], v1, s[8:11], s25 offen offset:3072 sc1
    buffer_load_dwordx4 a[44:47], v4, s[8:11], s24 offen offset:2816 sc1
    buffer_load_dwordx4 a[124:127], v4, s[8:11], s28 offen offset:2816 sc1
    s_add_u32 s25, s25, 4096
    buffer_load_dwordx4 a[208:211], v1, s[8:11], s25 offen offset:0 sc1
    buffer_load_dwordx4 a[48:51], v4, s[8:11], s24 offen offset:3072 sc1
    buffer_load_dwordx4 a[128:131], v4, s[8:11], s28 offen offset:3072 sc1
    buffer_load_dwordx4 a[212:215], v1, s[8:11], s25 offen offset:1024 sc1
    buffer_load_dwordx4 a[52:55], v4, s[8:11], s24 offen offset:3328 sc1
    buffer_load_dwordx4 a[132:135], v4, s[8:11], s28 offen offset:3328 sc1
    buffer_load_dwordx4 a[216:219], v1, s[8:11], s25 offen offset:2048 sc1
    buffer_load_dwordx4 a[56:59], v4, s[8:11], s24 offen offset:3584 sc1
    buffer_load_dwordx4 a[136:139], v4, s[8:11], s28 offen offset:3584 sc1
    buffer_load_dwordx4 a[220:223], v1, s[8:11], s25 offen offset:3072 sc1
    buffer_load_dwordx4 a[60:63], v4, s[8:11], s24 offen offset:3840 sc1
    buffer_load_dwordx4 a[140:143], v4, s[8:11], s28 offen offset:3840 sc1
    s_add_u32 s25, s25, 4096
    s_add_u32 s24, s24, 4096
    s_add_u32 s28, s28, 4096
    buffer_load_dwordx4 a[224:227], v1, s[8:11], s25 offen offset:0 sc1
    buffer_load_dwordx4 a[64:67], v4, s[8:11], s24 offen offset:0 sc1
    buffer_load_dwordx4 a[144:147], v4, s[8:11], s28 offen offset:0 sc1
    buffer_load_dwordx4 a[228:231], v1, s[8:11], s25 offen offset:1024 sc1
    buffer_load_dwordx4 a[68:71], v4, s[8:11], s24 offen offset:256 sc1
    buffer_load_dwordx4 a[148:151], v4, s[8:11], s28 offen offset:256 sc1
    buffer_load_dwordx4 a[232:235], v1, s[8:11], s25 offen offset:2048 sc1
    buffer_load_dwordx4 a[72:75], v4, s[8:11], s24 offen offset:512 sc1
    buffer_load_dwordx4 a[152:155], v4, s[8:11], s28 offen offset:512 sc1
    buffer_load_dwordx4 a[236:239], v1, s[8:11], s25 offen offset:3072 sc1
    buffer_load_dwordx4 a[76:79], v4, s[8:11], s24 offen offset:768 sc1
    buffer_load_dwordx4 a[156:159], v4, s[8:11], s28 offen offset:768 sc1
    s_waitcnt vmcnt(57)
    v_mfma_f32_32x32x16_bf16 v[16:31], a[0:3], a[160:163], 0
    v_mfma_f32_32x32x16_bf16 v[32:47], a[80:83], a[160:163], 0
    s_waitcnt vmcnt(54)
    v_mfma_f32_32x32x16_bf16 v[16:31], a[4:7], a[164:167], v[16:31]
    v_mfma_f32_32x32x16_bf16 v[32:47], a[84:87], a[164:167], v[32:47]
    s_waitcnt vmcnt(51)
    v_mfma_f32_32x32x16_bf16 v[16:31], a[8:11], a[168:171], v[16:31]
    v_mfma_f32_32x32x16_bf16 v[32:47], a[88:91], a[168:171], v[32:47]
    s_waitcnt vmcnt(48)
    v_mfma_f32_32x32x16_bf16 v[16:31], a[12:15], a[172:175], v[16:31]
    v_mfma_f32_32x32x16_bf16 v[32:47], a[92:95], a[172:175], v[32:47]
    s_waitcnt vmcnt(45)
    v_mfma_f32_32x32x16_bf16 v[16:31], a[16:19], a[176:179], v[16:31]
    v_mfma_f32_32x32x16_bf16 v[32:47], a[96:99], a[176:179], v[32:47]
    s_waitcnt vmcnt(42)
    v_mfma_f32_32x32x16_bf16 v[16:31], a[20:23], a[180:183], v[16:31]
    v_mfma_f32_32x32x16_bf16 v[32:47], a[100:103], a[180:183], v[32:47]
    s_waitcnt vmcnt(39)
    v_mfma_f32_32x32x16_bf16 v[16:31], a[24:27], a[184:187], v[16:31]
    v_mfma_f32_32x32x16_bf16 v[32:47], a[104:107], a[184:187], v[32:47]
    s_waitcnt vmcnt(36)
    v_mfma_f32_32x32x16_bf16 v[16:31], a[28:31], a[188:191], v[16:31]
    v_mfma_f32_32x32x16_bf16 v[32:47], a[108:111], a[188:191], v[32:47]
    s_waitcnt vmcnt(33)
    v_mfma_f32_32x32x16_bf16 v[16:31], a[32:35], a[192:195], v[16:31]
    v_mfma_f32_32x32x16_bf16 v[32:47], a[112:115], a[192:195], v[32:47]
    s_waitcnt vmcnt(30)
    v_mfma_f32_32x32x16_bf16 v[16:31], a[36:39], a[196:199], v[16:31]
    v_mfma_f32_32x32x16_bf16 v[32:47], a[116:119], a[196:199], v[32:47]
    s_waitcnt vmcnt(27)
    v_mfma_f32_32x32x16_bf16 v[16:31], a[40:43], a[200:203], v[16:31]
    v_mfma_f32_32x32x16_bf16 v[32:47], a[120:123], a[200:203], v[32:47]
    s_waitcnt vmcnt(24)
    v_mfma_f32_32x32x16_bf16 v[16:31], a[44:47], a[204:207], v[16:31]
    v_mfma_f32_32x32x16_bf16 v[32:47], a[124:127], a[204:207], v[32:47]
    s_waitcnt vmcnt(21)
    v_mfma_f32_32x32x16_bf16 v[16:31], a[48:51], a[208:211], v[16:31]
    v_mfma_f32_32x32x16_bf16 v[32:47], a[128:131], a[208:211], v[32:47]
    s_waitcnt vmcnt(18)
    v_mfma_f32_32x32x16_bf16 v[16:31], a[52:55], a[212:215], v[16:31]
    v_mfma_f32_32x32x16_bf16 v[32:47], a[132:135], a[212:215], v[32:47]
    s_waitcnt vmcnt(15)
    v_mfma_f32_32x32x16_bf16 v[16:31], a[56:59], a[216:219], v[16:31]
    v_mfma_f32_32x32x16_bf16 v[32:47], a[136:139], a[216:219], v[32:47]
    s_waitcnt vmcnt(12)
    v_mfma_f32_32x32x16_bf16 v[16:31], a[60:63], a[220:223], v[16:31]
    v_mfma_f32_32x32x16_bf16 v[32:47], a[140:143], a[220:223], v[32:47]
    s_waitcnt vmcnt(9)
    v_mfma_f32_32x32x16_bf16 v[16:31], a[64:67], a[224:227], v[16:31]
    v_mfma_f32_32x32x16_bf16 v[32:47], a[144:147], a[224:227], v[32:47]
    s_waitcnt vmcnt(6)
    v_mfma_f32_32x32x16_bf16 v[16:31], a[68:71], a[228:231], v[16:31]
    v_mfma_f32_32x32x16_bf16 v[32:47], a[148:151], a[228:231], v[32:47]
    s_waitcnt vmcnt(3)
    v_mfma_f32_32x32x16_bf16 v[16:31], a[72:75], a[232:235], v[16:31]
    v_mfma_f32_32x32x16_bf16 v[32:47], a[152:155], a[232:235], v[32:47]
    s_waitcnt vmcnt(0)
    v_mfma_f32_32x32x16_bf16 v[16:31], a[76:79], a[236:239], v[16:31]
    v_mfma_f32_32x32x16_bf16 v[32:47], a[156:159], a[236:239], v[32:47]
    s_lshl_b32 s27, s13, 11
    v_add_u32 v7, s27, v1
    s_nop 7
    s_nop 7
    ds_write_b128 v7, v[16:19] offset:0
    ds_write_b128 v7, v[20:23] offset:1024
    ds_write_b128 v7, v[24:27] offset:8192
    ds_write_b128 v7, v[28:31] offset:9216
    ds_write_b128 v7, v[32:35] offset:16384
    ds_write_b128 v7, v[36:39] offset:17408
    ds_write_b128 v7, v[40:43] offset:24576
    ds_write_b128 v7, v[44:47] offset:25600
    s_waitcnt lgkmcnt(0)
    s_barrier
    s_lshl_b32 s27, s13, 13
    v_add_u32 v7, s27, v1
    ds_read_b128 v[48:51], v7 offset:0
    ds_read_b128 v[52:55], v7 offset:1024
    ds_read_b128 v[56:59], v7 offset:2048
    ds_read_b128 v[60:63], v7 offset:3072
    ds_read_b128 v[64:67], v7 offset:4096
    ds_read_b128 v[68:71], v7 offset:5120
    ds_read_b128 v[72:75], v7 offset:6144
    ds_read_b128 v[76:79], v7 offset:7168
    s_waitcnt lgkmcnt(4)
    v_add_f32 v48, v48, v56
    v_add_f32 v49, v49, v57
    v_add_f32 v50, v50, v58
    v_add_f32 v51, v51, v59
    v_add_f32 v52, v52, v60
    v_add_f32 v53, v53, v61
    v_add_f32 v54, v54, v62
    v_add_f32 v55, v55, v63
    s_waitcnt lgkmcnt(0)
    v_add_f32 v64, v64, v72
    v_add_f32 v65, v65, v73
    v_add_f32 v66, v66, v74
    v_add_f32 v67, v67, v75
    v_add_f32 v68, v68, v76
    v_add_f32 v69, v69, v77
    v_add_f32 v70, v70, v78
    v_add_f32 v71, v71, v79
    v_add_f32 v48, v48, v64
    v_add_f32 v49, v49, v65
    v_add_f32 v50, v50, v66
    v_add_f32 v51, v51, v67
    v_add_f32 v52, v52, v68
    v_add_f32 v53, v53, v69
    v_add_f32 v54, v54, v70
    v_add_f32 v55, v55, v71
    v_cvt_pk_bf16_f32 v16, v48, v49
    v_cvt_pk_bf16_f32 v17, v50, v51
    v_cvt_pk_bf16_f32 v18, v52, v53
    v_cvt_pk_bf16_f32 v19, v54, v55
    s_nop 1
    v_permlane32_swap_b32 v16, v18
    v_permlane32_swap_b32 v17, v19
    s_nop 1
    v_lshlrev_b32 v48, 16, v16
    v_and_b32 v49, 0xffff0000, v16
    v_lshlrev_b32 v50, 16, v8
    v_and_b32 v51, 0xffff0000, v8
    v_add_f32 v48, v48, v50
    v_add_f32 v49, v49, v51
    v_cvt_pk_bf16_f32 v16, v48, v49
    v_lshlrev_b32 v48, 16, v17
    v_and_b32 v49, 0xffff0000, v17
    v_lshlrev_b32 v50, 16, v9
    v_and_b32 v51, 0xffff0000, v9
    v_add_f32 v48, v48, v50
    v_add_f32 v49, v49, v51
    v_cvt_pk_bf16_f32 v17, v48, v49
    v_lshlrev_b32 v48, 16, v18
    v_and_b32 v49, 0xffff0000, v18
    v_lshlrev_b32 v50, 16, v10
    v_and_b32 v51, 0xffff0000, v10
    v_add_f32 v48, v48, v50
    v_add_f32 v49, v49, v51
    v_cvt_pk_bf16_f32 v18, v48, v49
    v_lshlrev_b32 v48, 16, v19
    v_and_b32 v49, 0xffff0000, v19
    v_lshlrev_b32 v50, 16, v11
    v_and_b32 v51, 0xffff0000, v11
    v_add_f32 v48, v48, v50
    v_add_f32 v49, v49, v51
    v_cvt_pk_bf16_f32 v19, v48, v49
    buffer_store_dwordx4 v[16:19], v6, s[84:87], s26 offen
    s_branch layerb1_kernel_j_next
layerb1_kernel_j_giveup:
    s_mov_b64 exec, -1
    v_mov_b32 v2, 0
    v_mov_b32 v3, -1
    ds_write_b32 v2, v3 offset:32768
    s_waitcnt lgkmcnt(0)
    s_barrier
    s_branch layerb1_kernel_bail
layerb1_kernel_j_done:
    s_branch layerb1_kernel_end
layerb1_kernel_bail:
    s_mov_b64 exec, 1
    s_load_dwordx2 s[6:7], s[0:1], 88
    s_waitcnt lgkmcnt(0)
    s_mov_b32 s24, s6
    s_mov_b32 s25, s7
    s_mov_b32 s26, 256
    s_mov_b32 s27, 0x00020000
    v_mov_b32 v1, 0xdead
    v_mov_b32 v2, s14
    v_mov_b32 v3, 0
    buffer_store_dword v1, v3, s[24:27], 0 offen
    buffer_store_dword v2, v3, s[24:27], 0 offen offset:4
layerb1_kernel_end:
layerb1_kernel_end0:
    s_endpgm
.section .rodata,"a"
.p2align 6
.amdhsa_kernel layerb1_kernel
  .amdhsa_next_free_vgpr 512
  .amdhsa_next_free_sgpr 100
  .amdhsa_accum_offset 256
  .amdhsa_group_segment_fixed_size 0
  .amdhsa_kernarg_size 104
  .amdhsa_user_sgpr_count 2
  .amdhsa_user_sgpr_kernarg_segment_ptr 1
  .amdhsa_system_sgpr_workgroup_id_x 1
.end_amdhsa_kernel
```

```asm
; @launch kernel=prep_kernel grid=(733,1,1) block=(256,1,1) lds=73728
; @launch kernel=layerb1_kernel grid=(256,1,1) block=(256,1,1) lds=149760
; @launch kernel=layerb2_kernel grid=(256,1,1) block=(256,1,1) lds=149760
.amdgcn_target "amdgcn-amd-amdhsa--gfx950"
.text
.globl prep_kernel
.p2align 8
.type prep_kernel,@function
prep_kernel:
    s_cmp_ge_u32 s2, 733
    s_cbranch_scc1 prep_kernel_end
    s_load_dwordx2 s[4:5], s[0:1], 96
    v_lshrrev_b32 v1, 6, v0
    v_and_b32 v0, 63, v0
    s_nop 0
    v_readfirstlane_b32 s13, v1
    s_waitcnt lgkmcnt(0)
    s_mov_b32 s8, s4
    s_mov_b32 s9, s5
    s_mov_b32 s10, 268435456
    s_mov_b32 s11, 0x00020000
    s_mov_b32 s20, s2
    s_cmp_lt_u32 s2, 4
    s_cbranch_scc1 prep_kernel_r_cal
    s_cmp_eq_u32 s2, 4
    s_cbranch_scc1 prep_kernel_r_zero
    s_sub_u32 s20, s2, 5
    s_cmp_lt_u32 s20, 64
    s_cbranch_scc1 prep_kernel_r_pwa
    s_sub_u32 s20, s20, 64
    s_cmp_lt_u32 s20, 40
    s_cbranch_scc1 prep_kernel_r_pwo
    s_sub_u32 s20, s20, 40
    s_cmp_lt_u32 s20, 320
    s_cbranch_scc1 prep_kernel_r_wvo
    s_sub_u32 s20, s20, 320
    s_cmp_lt_u32 s20, 240
    s_cbranch_scc1 prep_kernel_r_pwp
    s_sub_u32 s20, s20, 240
    s_sub_u32 s21, 0, s4
    s_and_b32 s21, s21, 0x1fffff
    s_mul_i32 s22, s20, 131072
    s_add_u32 s21, s21, s22
    s_lshl_b32 s22, s13, 10
    s_add_u32 s21, s21, s22
    v_lshlrev_b32 v1, 4, v0
    v_mov_b32 v4, -1
    v_mov_b32 v5, -1
    v_mov_b32 v6, -1
    v_mov_b32 v7, -1
    s_mov_b32 s22, 32
prep_kernel_clr_loop:
    buffer_store_dwordx4 v[4:7], v1, s[8:11], s21 offen
    s_add_u32 s21, s21, 4096
    s_sub_u32 s22, s22, 1
    s_cmp_lg_u32 s22, 0
    s_cbranch_scc1 prep_kernel_clr_loop
    s_branch prep_kernel_end
prep_kernel_r_cal:
    s_cmp_lg_u32 s13, 0
    s_cbranch_scc1 prep_kernel_end
    s_sub_u32 s22, 0, s4
    s_and_b32 s22, s22, 0x1fffff
    s_getreg_b32 s23, hwreg(HW_REG_XCC_ID)
    s_bfe_u32 s23, s23, 0x10002
    s_mov_b64 exec, 1
    v_mov_b32 v1, 0
    s_mul_i32 s24, s20, 2097152
    s_add_u32 s22, s22, s24
    s_add_u32 s22, s22, 2086912
    s_mov_b32 s30, -1
    s_mov_b32 s31, -1
    s_mov_b32 s25, 6
    v_mov_b32 v2, 0
prep_kernel_cal:
    s_and_b32 s24, s25, 15
    s_lshl_b32 s24, s24, 7
    s_add_u32 s24, s24, s22
    s_memtime s[26:27]
    s_waitcnt lgkmcnt(0)
    buffer_atomic_add v2, v1, s[8:11], s24 offen sc0 sc1
    s_waitcnt vmcnt(0)
    s_memtime s[28:29]
    v_mov_b32 v2, 0
    s_waitcnt lgkmcnt(0)
    s_sub_u32 s26, s28, s26
    s_min_u32 s30, s30, s26
    s_and_b32 s24, s25, 15
    s_lshl_b32 s24, s24, 7
    s_add_u32 s24, s24, s22
    s_add_u32 s24, s24, 8192
    s_memtime s[26:27]
    s_waitcnt lgkmcnt(0)
    buffer_atomic_add v2, v1, s[8:11], s24 offen sc0 sc1
    s_waitcnt vmcnt(0)
    s_memtime s[28:29]
    v_mov_b32 v2, 0
    s_waitcnt lgkmcnt(0)
    s_sub_u32 s26, s28, s26
    s_min_u32 s31, s31, s26
    s_sub_u32 s25, s25, 1
    s_cmp_lg_u32 s25, 0
    s_cbranch_scc1 prep_kernel_cal
    s_cmp_lt_u32 s31, s30
    s_cselect_b32 s24, 1, 0
    s_xor_b32 s24, s24, s23
    s_lshl_b32 s24, s24, 13
    v_mov_b32 v3, s24
    s_lshl_b32 s25, s20, 2
    s_add_u32 s25, s25, 10551296
    buffer_store_dword v3, v1, s[8:11], s25 offen
    s_lshl_b32 s26, s30, 16
    s_or_b32 s26, s26, s31
    v_mov_b32 v3, s26
    buffer_store_dword v3, v1, s[8:11], s25 offen offset:64
    s_branch prep_kernel_end
prep_kernel_r_zero:
    v_lshlrev_b32 v1, 4, v0
    v_mov_b32 v4, 0
    v_mov_b32 v5, 0
    v_mov_b32 v6, 0
    v_mov_b32 v7, 0
    s_lshl_b32 s21, s13, 10
    s_add_u32 s21, s21, 10485760
    buffer_store_dwordx4 v[4:7], v1, s[8:11], s21 offen
    s_lshl_b32 s21, s13, 15
    s_add_u32 s21, s21, 10616832
    buffer_store_dwordx4 v[4:7], v1, s[8:11], s21 offen offset:0
    buffer_store_dwordx4 v[4:7], v1, s[8:11], s21 offen offset:1024
    buffer_store_dwordx4 v[4:7], v1, s[8:11], s21 offen offset:2048
    buffer_store_dwordx4 v[4:7], v1, s[8:11], s21 offen offset:3072
    s_add_u32 s21, s21, 4096
    buffer_store_dwordx4 v[4:7], v1, s[8:11], s21 offen offset:0
    buffer_store_dwordx4 v[4:7], v1, s[8:11], s21 offen offset:1024
    buffer_store_dwordx4 v[4:7], v1, s[8:11], s21 offen offset:2048
    buffer_store_dwordx4 v[4:7], v1, s[8:11], s21 offen offset:3072
    s_add_u32 s21, s21, 4096
    buffer_store_dwordx4 v[4:7], v1, s[8:11], s21 offen offset:0
    buffer_store_dwordx4 v[4:7], v1, s[8:11], s21 offen offset:1024
    buffer_store_dwordx4 v[4:7], v1, s[8:11], s21 offen offset:2048
    buffer_store_dwordx4 v[4:7], v1, s[8:11], s21 offen offset:3072
    s_add_u32 s21, s21, 4096
    buffer_store_dwordx4 v[4:7], v1, s[8:11], s21 offen offset:0
    buffer_store_dwordx4 v[4:7], v1, s[8:11], s21 offen offset:1024
    buffer_store_dwordx4 v[4:7], v1, s[8:11], s21 offen offset:2048
    buffer_store_dwordx4 v[4:7], v1, s[8:11], s21 offen offset:3072
    s_add_u32 s21, s21, 4096
    buffer_store_dwordx4 v[4:7], v1, s[8:11], s21 offen offset:0
    buffer_store_dwordx4 v[4:7], v1, s[8:11], s21 offen offset:1024
    buffer_store_dwordx4 v[4:7], v1, s[8:11], s21 offen offset:2048
    buffer_store_dwordx4 v[4:7], v1, s[8:11], s21 offen offset:3072
    s_add_u32 s21, s21, 4096
    buffer_store_dwordx4 v[4:7], v1, s[8:11], s21 offen offset:0
    buffer_store_dwordx4 v[4:7], v1, s[8:11], s21 offen offset:1024
    buffer_store_dwordx4 v[4:7], v1, s[8:11], s21 offen offset:2048
    buffer_store_dwordx4 v[4:7], v1, s[8:11], s21 offen offset:3072
    s_add_u32 s21, s21, 4096
    buffer_store_dwordx4 v[4:7], v1, s[8:11], s21 offen offset:0
    buffer_store_dwordx4 v[4:7], v1, s[8:11], s21 offen offset:1024
    buffer_store_dwordx4 v[4:7], v1, s[8:11], s21 offen offset:2048
    buffer_store_dwordx4 v[4:7], v1, s[8:11], s21 offen offset:3072
    s_add_u32 s21, s21, 4096
    buffer_store_dwordx4 v[4:7], v1, s[8:11], s21 offen offset:0
    buffer_store_dwordx4 v[4:7], v1, s[8:11], s21 offen offset:1024
    buffer_store_dwordx4 v[4:7], v1, s[8:11], s21 offen offset:2048
    buffer_store_dwordx4 v[4:7], v1, s[8:11], s21 offen offset:3072
    s_add_u32 s21, s21, 4096
    s_lshl_b32 s21, s13, 15
    s_add_u32 s21, s21, 10747904
    buffer_store_dwordx4 v[4:7], v1, s[8:11], s21 offen offset:0
    buffer_store_dwordx4 v[4:7], v1, s[8:11], s21 offen offset:1024
    buffer_store_dwordx4 v[4:7], v1, s[8:11], s21 offen offset:2048
    buffer_store_dwordx4 v[4:7], v1, s[8:11], s21 offen offset:3072
    s_add_u32 s21, s21, 4096
    buffer_store_dwordx4 v[4:7], v1, s[8:11], s21 offen offset:0
    buffer_store_dwordx4 v[4:7], v1, s[8:11], s21 offen offset:1024
    buffer_store_dwordx4 v[4:7], v1, s[8:11], s21 offen offset:2048
    buffer_store_dwordx4 v[4:7], v1, s[8:11], s21 offen offset:3072
    s_add_u32 s21, s21, 4096
    buffer_store_dwordx4 v[4:7], v1, s[8:11], s21 offen offset:0
    buffer_store_dwordx4 v[4:7], v1, s[8:11], s21 offen offset:1024
    buffer_store_dwordx4 v[4:7], v1, s[8:11], s21 offen offset:2048
    buffer_store_dwordx4 v[4:7], v1, s[8:11], s21 offen offset:3072
    s_add_u32 s21, s21, 4096
    buffer_store_dwordx4 v[4:7], v1, s[8:11], s21 offen offset:0
    buffer_store_dwordx4 v[4:7], v1, s[8:11], s21 offen offset:1024
    buffer_store_dwordx4 v[4:7], v1, s[8:11], s21 offen offset:2048
    buffer_store_dwordx4 v[4:7], v1, s[8:11], s21 offen offset:3072
    s_add_u32 s21, s21, 4096
    buffer_store_dwordx4 v[4:7], v1, s[8:11], s21 offen offset:0
    buffer_store_dwordx4 v[4:7], v1, s[8:11], s21 offen offset:1024
    buffer_store_dwordx4 v[4:7], v1, s[8:11], s21 offen offset:2048
    buffer_store_dwordx4 v[4:7], v1, s[8:11], s21 offen offset:3072
    s_add_u32 s21, s21, 4096
    buffer_store_dwordx4 v[4:7], v1, s[8:11], s21 offen offset:0
    buffer_store_dwordx4 v[4:7], v1, s[8:11], s21 offen offset:1024
    buffer_store_dwordx4 v[4:7], v1, s[8:11], s21 offen offset:2048
    buffer_store_dwordx4 v[4:7], v1, s[8:11], s21 offen offset:3072
    s_add_u32 s21, s21, 4096
    buffer_store_dwordx4 v[4:7], v1, s[8:11], s21 offen offset:0
    buffer_store_dwordx4 v[4:7], v1, s[8:11], s21 offen offset:1024
    buffer_store_dwordx4 v[4:7], v1, s[8:11], s21 offen offset:2048
    buffer_store_dwordx4 v[4:7], v1, s[8:11], s21 offen offset:3072
    s_add_u32 s21, s21, 4096
    buffer_store_dwordx4 v[4:7], v1, s[8:11], s21 offen offset:0
    buffer_store_dwordx4 v[4:7], v1, s[8:11], s21 offen offset:1024
    buffer_store_dwordx4 v[4:7], v1, s[8:11], s21 offen offset:2048
    buffer_store_dwordx4 v[4:7], v1, s[8:11], s21 offen offset:3072
    s_add_u32 s21, s21, 4096
    s_branch prep_kernel_end
prep_kernel_r_wvo:
    s_load_dwordx2 s[24:25], s[0:1], 56
    s_load_dwordx2 s[26:27], s[0:1], 64
    s_mul_i32 s23, s20, 6554
    s_lshr_b32 s23, s23, 16
    s_mul_i32 s28, s23, 10
    s_sub_u32 s22, s20, s28
    s_and_b32 s21, s22, 1
    s_lshr_b32 s22, s22, 1
    s_waitcnt lgkmcnt(0)
    s_mov_b32 s32, s24
    s_mov_b32 s33, s25
    s_mov_b32 s34, 7864320
    s_mov_b32 s35, 0x00020000
    s_mov_b32 s36, s26
    s_mov_b32 s37, s27
    s_mov_b32 s38, 7864320
    s_mov_b32 s39, 0x00020000
    v_and_b32 v1, 31, v0
    v_lshrrev_b32 v2, 5, v0
    v_lshrrev_b32 v11, 3, v0
    v_mul_u32_u24 v3, 1280, v11
    v_bfe_u32 v12, v0, 4, 1
    v_lshlrev_b32 v12, 2, v12
    v_and_b32 v13, 7, v0
    v_xor_b32 v13, v13, v12
    v_lshl_add_u32 v3, v13, 4, v3
    s_mul_i32 s28, s23, 192
    s_mul_i32 s29, s13, 48
    s_add_u32 s28, s28, s29
    s_mul_i32 s28, s28, 1280
    s_mul_i32 s29, s21, 640
    s_add_u32 s28, s28, s29
    s_mul_i32 s29, s13, 6144
    v_bfe_u32 v11, v0, 2, 2
    v_lshl_add_u32 v12, v2, 3, v11
    v_lshlrev_b32 v12, 7, v12
    v_bfe_u32 v13, v0, 4, 1
    v_lshlrev_b32 v13, 1, v13
    v_bfe_u32 v14, v0, 1, 1
    v_add_u32 v13, v13, v14
    v_lshl_add_u32 v12, v13, 4, v12
    v_and_b32 v13, 1, v0
    v_lshl_add_u32 v12, v13, 3, v12
    v_bfe_u32 v13, v0, 3, 1
    v_lshl_add_u32 v4, v13, 6, v12
    v_xor_b32 v13, 1, v13
    v_lshl_add_u32 v5, v13, 6, v12
    v_lshrrev_b32 v6, 3, v1
    v_lshrrev_b32 v7, 2, v6
    v_lshlrev_b32 v7, 5, v7
    v_and_b32 v8, 2, v6
    v_lshl_add_u32 v7, v8, 3, v7
    v_and_b32 v8, 1, v6
    v_lshl_add_u32 v7, v8, 2, v7
    v_and_b32 v8, 7, v1
    v_and_b32 v9, 1, v8
    v_add_u32 v7, v7, v9
    v_and_b32 v9, 2, v8
    v_lshl_add_u32 v7, v9, 2, v7
    v_lshrrev_b32 v9, 2, v8
    v_lshl_add_u32 v7, v9, 1, v7
    v_mul_u32_u24 v7, 12288, v7
    v_lshl_add_u32 v7, v2, 4, v7
    s_lshl_b32 s30, s22, 2
    s_add_u32 s30, s30, s13
    s_mul_i32 s31, s30, 393216
    s_mul_i32 s40, s23, 384
    s_add_u32 s31, s31, s40
    v_lshrrev_b32 v10, 3, v1
    v_mul_u32_u24 v10, 20480, v10
    v_lshlrev_b32 v10, 4, v10
    v_and_b32 v11, 7, v1
    v_lshl_add_u32 v10, v11, 4, v10
    v_lshl_add_u32 v10, v2, 8, v10
    s_mul_i32 s41, s21, 13107200
    s_lshr_b32 s40, s23, 3
    s_mul_i32 s40, s40, 81920
    s_add_u32 s41, s41, s40
    s_and_b32 s40, s23, 3
    s_mul_i32 s40, s40, 20480
    s_add_u32 s41, s41, s40
    s_bfe_u32 s40, s23, 0x10002
    s_lshl_b32 s40, s40, 7
    s_add_u32 s41, s41, s40
    s_lshl_b32 s40, s30, 10
    s_add_u32 s41, s41, s40
    s_add_u32 s41, s41, 27262976
    buffer_load_dwordx4 v[16:19], v7, s[32:35], s31 offen offset:0
    buffer_load_dwordx4 v[20:23], v7, s[32:35], s31 offen offset:32
    buffer_load_dwordx4 v[24:27], v7, s[32:35], s31 offen offset:64
    buffer_load_dwordx4 v[28:31], v7, s[32:35], s31 offen offset:96
    buffer_load_dwordx4 v[32:35], v7, s[32:35], s31 offen offset:128
    buffer_load_dwordx4 v[36:39], v7, s[32:35], s31 offen offset:160
    buffer_load_dwordx4 v[40:43], v7, s[32:35], s31 offen offset:192
    buffer_load_dwordx4 v[44:47], v7, s[32:35], s31 offen offset:224
    buffer_load_dwordx4 v[48:51], v7, s[32:35], s31 offen offset:256
    buffer_load_dwordx4 v[52:55], v7, s[32:35], s31 offen offset:288
    buffer_load_dwordx4 v[56:59], v7, s[32:35], s31 offen offset:320
    buffer_load_dwordx4 v[60:63], v7, s[32:35], s31 offen offset:352
    s_add_u32 s42, s29, 0
    s_mov_b32 m0, s42
    s_add_u32 s43, s28, 0
    buffer_load_dwordx4 v3, s[36:39], s43 offen lds
    s_add_u32 s42, s29, 1024
    s_mov_b32 m0, s42
    s_add_u32 s43, s28, 10240
    buffer_load_dwordx4 v3, s[36:39], s43 offen lds
    s_add_u32 s42, s29, 2048
    s_mov_b32 m0, s42
    s_add_u32 s43, s28, 20480
    buffer_load_dwordx4 v3, s[36:39], s43 offen lds
    s_add_u32 s42, s29, 3072
    s_mov_b32 m0, s42
    s_add_u32 s43, s28, 30720
    buffer_load_dwordx4 v3, s[36:39], s43 offen lds
    s_add_u32 s42, s29, 4096
    s_mov_b32 m0, s42
    s_add_u32 s43, s28, 40960
    buffer_load_dwordx4 v3, s[36:39], s43 offen lds
    s_add_u32 s42, s29, 5120
    s_mov_b32 m0, s42
    s_add_u32 s43, s28, 51200
    buffer_load_dwordx4 v3, s[36:39], s43 offen lds
    s_add_u32 s42, s29, 24576
    s_mov_b32 m0, s42
    s_add_u32 s43, s28, 128
    buffer_load_dwordx4 v3, s[36:39], s43 offen lds
    s_add_u32 s42, s29, 25600
    s_mov_b32 m0, s42
    s_add_u32 s43, s28, 10368
    buffer_load_dwordx4 v3, s[36:39], s43 offen lds
    s_add_u32 s42, s29, 26624
    s_mov_b32 m0, s42
    s_add_u32 s43, s28, 20608
    buffer_load_dwordx4 v3, s[36:39], s43 offen lds
    s_add_u32 s42, s29, 27648
    s_mov_b32 m0, s42
    s_add_u32 s43, s28, 30848
    buffer_load_dwordx4 v3, s[36:39], s43 offen lds
    s_add_u32 s42, s29, 28672
    s_mov_b32 m0, s42
    s_add_u32 s43, s28, 41088
    buffer_load_dwordx4 v3, s[36:39], s43 offen lds
    s_add_u32 s42, s29, 29696
    s_mov_b32 m0, s42
    s_add_u32 s43, s28, 51328
    buffer_load_dwordx4 v3, s[36:39], s43 offen lds
    s_add_u32 s42, s29, 49152
    s_mov_b32 m0, s42
    s_add_u32 s43, s28, 256
    buffer_load_dwordx4 v3, s[36:39], s43 offen lds
    s_add_u32 s42, s29, 50176
    s_mov_b32 m0, s42
    s_add_u32 s43, s28, 10496
    buffer_load_dwordx4 v3, s[36:39], s43 offen lds
    s_add_u32 s42, s29, 51200
    s_mov_b32 m0, s42
    s_add_u32 s43, s28, 20736
    buffer_load_dwordx4 v3, s[36:39], s43 offen lds
    s_add_u32 s42, s29, 52224
    s_mov_b32 m0, s42
    s_add_u32 s43, s28, 30976
    buffer_load_dwordx4 v3, s[36:39], s43 offen lds
    s_add_u32 s42, s29, 53248
    s_mov_b32 m0, s42
    s_add_u32 s43, s28, 41216
    buffer_load_dwordx4 v3, s[36:39], s43 offen lds
    s_add_u32 s42, s29, 54272
    s_mov_b32 m0, s42
    s_add_u32 s43, s28, 51456
    buffer_load_dwordx4 v3, s[36:39], s43 offen lds
    v_add_u32 v200, 0, v4
    v_add_u32 v201, 0, v5
    v_add_u32 v202, 24576, v4
    v_add_u32 v203, 24576, v5
    v_add_u32 v204, 49152, v4
    v_add_u32 v205, 49152, v5
    s_waitcnt vmcnt(12)
    s_barrier
    ds_read_b64_tr_b16 v[64:65], v200 offset:0
    ds_read_b64_tr_b16 v[66:67], v200 offset:512
    ds_read_b64_tr_b16 v[68:69], v200 offset:2048
    ds_read_b64_tr_b16 v[70:71], v200 offset:2560
    ds_read_b64_tr_b16 v[72:73], v200 offset:4096
    ds_read_b64_tr_b16 v[74:75], v200 offset:4608
    ds_read_b64_tr_b16 v[76:77], v200 offset:6144
    ds_read_b64_tr_b16 v[78:79], v200 offset:6656
    ds_read_b64_tr_b16 v[80:81], v200 offset:8192
    ds_read_b64_tr_b16 v[82:83], v200 offset:8704
    ds_read_b64_tr_b16 v[84:85], v200 offset:10240
    ds_read_b64_tr_b16 v[86:87], v200 offset:10752
    s_waitcnt lgkmcnt(0)
    ds_read_b64_tr_b16 v[88:89], v200 offset:12288
    ds_read_b64_tr_b16 v[90:91], v200 offset:12800
    ds_read_b64_tr_b16 v[92:93], v200 offset:14336
    ds_read_b64_tr_b16 v[94:95], v200 offset:14848
    ds_read_b64_tr_b16 v[96:97], v200 offset:16384
    ds_read_b64_tr_b16 v[98:99], v200 offset:16896
    ds_read_b64_tr_b16 v[100:101], v200 offset:18432
    ds_read_b64_tr_b16 v[102:103], v200 offset:18944
    ds_read_b64_tr_b16 v[104:105], v200 offset:20480
    ds_read_b64_tr_b16 v[106:107], v200 offset:20992
    ds_read_b64_tr_b16 v[108:109], v200 offset:22528
    ds_read_b64_tr_b16 v[110:111], v200 offset:23040
    s_waitcnt lgkmcnt(0)
    v_mfma_f32_32x32x16_bf16 v[160:175], v[16:19], v[64:67], 0
    ds_read_b64_tr_b16 v[112:113], v201 offset:0
    ds_read_b64_tr_b16 v[114:115], v201 offset:512
    v_mfma_f32_32x32x16_bf16 v[160:175], v[20:23], v[68:71], v[160:175]
    ds_read_b64_tr_b16 v[116:117], v201 offset:2048
    ds_read_b64_tr_b16 v[118:119], v201 offset:2560
    v_mfma_f32_32x32x16_bf16 v[160:175], v[24:27], v[72:75], v[160:175]
    ds_read_b64_tr_b16 v[120:121], v201 offset:4096
    ds_read_b64_tr_b16 v[122:123], v201 offset:4608
    v_mfma_f32_32x32x16_bf16 v[160:175], v[28:31], v[76:79], v[160:175]
    ds_read_b64_tr_b16 v[124:125], v201 offset:6144
    ds_read_b64_tr_b16 v[126:127], v201 offset:6656
    v_mfma_f32_32x32x16_bf16 v[160:175], v[32:35], v[80:83], v[160:175]
    ds_read_b64_tr_b16 v[128:129], v201 offset:8192
    ds_read_b64_tr_b16 v[130:131], v201 offset:8704
    v_mfma_f32_32x32x16_bf16 v[160:175], v[36:39], v[84:87], v[160:175]
    ds_read_b64_tr_b16 v[132:133], v201 offset:10240
    ds_read_b64_tr_b16 v[134:135], v201 offset:10752
    v_mfma_f32_32x32x16_bf16 v[160:175], v[40:43], v[88:91], v[160:175]
    ds_read_b64_tr_b16 v[136:137], v201 offset:12288
    ds_read_b64_tr_b16 v[138:139], v201 offset:12800
    v_mfma_f32_32x32x16_bf16 v[160:175], v[44:47], v[92:95], v[160:175]
    ds_read_b64_tr_b16 v[140:141], v201 offset:14336
    ds_read_b64_tr_b16 v[142:143], v201 offset:14848
    v_mfma_f32_32x32x16_bf16 v[160:175], v[48:51], v[96:99], v[160:175]
    ds_read_b64_tr_b16 v[144:145], v201 offset:16384
    ds_read_b64_tr_b16 v[146:147], v201 offset:16896
    v_mfma_f32_32x32x16_bf16 v[160:175], v[52:55], v[100:103], v[160:175]
    ds_read_b64_tr_b16 v[148:149], v201 offset:18432
    ds_read_b64_tr_b16 v[150:151], v201 offset:18944
    v_mfma_f32_32x32x16_bf16 v[160:175], v[56:59], v[104:107], v[160:175]
    ds_read_b64_tr_b16 v[152:153], v201 offset:20480
    ds_read_b64_tr_b16 v[154:155], v201 offset:20992
    v_mfma_f32_32x32x16_bf16 v[160:175], v[60:63], v[108:111], v[160:175]
    ds_read_b64_tr_b16 v[156:157], v201 offset:22528
    ds_read_b64_tr_b16 v[158:159], v201 offset:23040
    s_waitcnt lgkmcnt(0)
    s_waitcnt vmcnt(6)
    s_barrier
    s_add_u32 s42, s29, 0
    s_mov_b32 m0, s42
    s_add_u32 s43, s28, 384
    buffer_load_dwordx4 v3, s[36:39], s43 offen lds
    s_add_u32 s42, s29, 1024
    s_mov_b32 m0, s42
    s_add_u32 s43, s28, 10624
    buffer_load_dwordx4 v3, s[36:39], s43 offen lds
    s_add_u32 s42, s29, 2048
    s_mov_b32 m0, s42
    s_add_u32 s43, s28, 20864
    buffer_load_dwordx4 v3, s[36:39], s43 offen lds
    s_add_u32 s42, s29, 3072
    s_mov_b32 m0, s42
    s_add_u32 s43, s28, 31104
    buffer_load_dwordx4 v3, s[36:39], s43 offen lds
    s_add_u32 s42, s29, 4096
    s_mov_b32 m0, s42
    s_add_u32 s43, s28, 41344
    buffer_load_dwordx4 v3, s[36:39], s43 offen lds
    s_add_u32 s42, s29, 5120
    s_mov_b32 m0, s42
    s_add_u32 s43, s28, 51584
    buffer_load_dwordx4 v3, s[36:39], s43 offen lds
    v_mfma_f32_32x32x16_bf16 v[176:191], v[16:19], v[112:115], 0
    ds_read_b64_tr_b16 v[64:65], v202 offset:0
    ds_read_b64_tr_b16 v[66:67], v202 offset:512
    v_mfma_f32_32x32x16_bf16 v[176:191], v[20:23], v[116:119], v[176:191]
    ds_read_b64_tr_b16 v[68:69], v202 offset:2048
    ds_read_b64_tr_b16 v[70:71], v202 offset:2560
    v_mfma_f32_32x32x16_bf16 v[176:191], v[24:27], v[120:123], v[176:191]
    ds_read_b64_tr_b16 v[72:73], v202 offset:4096
    ds_read_b64_tr_b16 v[74:75], v202 offset:4608
    s_add_u32 s42, s41, 0
    v_cvt_pk_bf16_f32 v192, v160, v161
    v_cvt_pk_bf16_f32 v193, v162, v163
    v_mfma_f32_32x32x16_bf16 v[176:191], v[28:31], v[124:127], v[176:191]
    ds_read_b64_tr_b16 v[76:77], v202 offset:6144
    ds_read_b64_tr_b16 v[78:79], v202 offset:6656
    v_cvt_pk_bf16_f32 v194, v164, v165
    v_cvt_pk_bf16_f32 v195, v166, v167
    s_nop 1
    v_mfma_f32_32x32x16_bf16 v[176:191], v[32:35], v[128:131], v[176:191]
    ds_read_b64_tr_b16 v[80:81], v202 offset:8192
    ds_read_b64_tr_b16 v[82:83], v202 offset:8704
    v_permlane32_swap_b32 v192, v194
    v_permlane32_swap_b32 v193, v195
    buffer_store_dwordx4 v[192:195], v10, s[8:11], s42 offen offset:0
    v_mfma_f32_32x32x16_bf16 v[176:191], v[36:39], v[132:135], v[176:191]
    ds_read_b64_tr_b16 v[84:85], v202 offset:10240
    ds_read_b64_tr_b16 v[86:87], v202 offset:10752
    v_cvt_pk_bf16_f32 v196, v168, v169
    v_cvt_pk_bf16_f32 v197, v170, v171
    v_cvt_pk_bf16_f32 v198, v172, v173
    v_mfma_f32_32x32x16_bf16 v[176:191], v[40:43], v[136:139], v[176:191]
    ds_read_b64_tr_b16 v[88:89], v202 offset:12288
    ds_read_b64_tr_b16 v[90:91], v202 offset:12800
    v_cvt_pk_bf16_f32 v199, v174, v175
    s_nop 1
    v_permlane32_swap_b32 v196, v198
    v_mfma_f32_32x32x16_bf16 v[176:191], v[44:47], v[140:143], v[176:191]
    ds_read_b64_tr_b16 v[92:93], v202 offset:14336
    ds_read_b64_tr_b16 v[94:95], v202 offset:14848
    v_permlane32_swap_b32 v197, v199
    buffer_store_dwordx4 v[196:199], v10, s[8:11], s42 offen offset:512
    v_mfma_f32_32x32x16_bf16 v[176:191], v[48:51], v[144:147], v[176:191]
    ds_read_b64_tr_b16 v[96:97], v202 offset:16384
    ds_read_b64_tr_b16 v[98:99], v202 offset:16896
    v_mfma_f32_32x32x16_bf16 v[176:191], v[52:55], v[148:151], v[176:191]
    ds_read_b64_tr_b16 v[100:101], v202 offset:18432
    ds_read_b64_tr_b16 v[102:103], v202 offset:18944
    v_mfma_f32_32x32x16_bf16 v[176:191], v[56:59], v[152:155], v[176:191]
    ds_read_b64_tr_b16 v[104:105], v202 offset:20480
    ds_read_b64_tr_b16 v[106:107], v202 offset:20992
    v_mfma_f32_32x32x16_bf16 v[176:191], v[60:63], v[156:159], v[176:191]
    ds_read_b64_tr_b16 v[108:109], v202 offset:22528
    ds_read_b64_tr_b16 v[110:111], v202 offset:23040
    s_waitcnt lgkmcnt(0)
    v_mfma_f32_32x32x16_bf16 v[160:175], v[16:19], v[64:67], 0
    ds_read_b64_tr_b16 v[112:113], v203 offset:0
    ds_read_b64_tr_b16 v[114:115], v203 offset:512
    v_mfma_f32_32x32x16_bf16 v[160:175], v[20:23], v[68:71], v[160:175]
    ds_read_b64_tr_b16 v[116:117], v203 offset:2048
    ds_read_b64_tr_b16 v[118:119], v203 offset:2560
    v_mfma_f32_32x32x16_bf16 v[160:175], v[24:27], v[72:75], v[160:175]
    ds_read_b64_tr_b16 v[120:121], v203 offset:4096
    ds_read_b64_tr_b16 v[122:123], v203 offset:4608
    s_add_u32 s42, s41, 1310720
    v_cvt_pk_bf16_f32 v192, v176, v177
    v_cvt_pk_bf16_f32 v193, v178, v179
    v_mfma_f32_32x32x16_bf16 v[160:175], v[28:31], v[76:79], v[160:175]
    ds_read_b64_tr_b16 v[124:125], v203 offset:6144
    ds_read_b64_tr_b16 v[126:127], v203 offset:6656
    v_cvt_pk_bf16_f32 v194, v180, v181
    v_cvt_pk_bf16_f32 v195, v182, v183
    s_nop 1
    v_mfma_f32_32x32x16_bf16 v[160:175], v[32:35], v[80:83], v[160:175]
    ds_read_b64_tr_b16 v[128:129], v203 offset:8192
    ds_read_b64_tr_b16 v[130:131], v203 offset:8704
    v_permlane32_swap_b32 v192, v194
    v_permlane32_swap_b32 v193, v195
    buffer_store_dwordx4 v[192:195], v10, s[8:11], s42 offen offset:0
    v_mfma_f32_32x32x16_bf16 v[160:175], v[36:39], v[84:87], v[160:175]
    ds_read_b64_tr_b16 v[132:133], v203 offset:10240
    ds_read_b64_tr_b16 v[134:135], v203 offset:10752
    v_cvt_pk_bf16_f32 v196, v184, v185
    v_cvt_pk_bf16_f32 v197, v186, v187
    v_cvt_pk_bf16_f32 v198, v188, v189
    v_mfma_f32_32x32x16_bf16 v[160:175], v[40:43], v[88:91], v[160:175]
    ds_read_b64_tr_b16 v[136:137], v203 offset:12288
    ds_read_b64_tr_b16 v[138:139], v203 offset:12800
    v_cvt_pk_bf16_f32 v199, v190, v191
    s_nop 1
    v_permlane32_swap_b32 v196, v198
    v_mfma_f32_32x32x16_bf16 v[160:175], v[44:47], v[92:95], v[160:175]
    ds_read_b64_tr_b16 v[140:141], v203 offset:14336
    ds_read_b64_tr_b16 v[142:143], v203 offset:14848
    v_permlane32_swap_b32 v197, v199
    buffer_store_dwordx4 v[196:199], v10, s[8:11], s42 offen offset:512
    v_mfma_f32_32x32x16_bf16 v[160:175], v[48:51], v[96:99], v[160:175]
    ds_read_b64_tr_b16 v[144:145], v203 offset:16384
    ds_read_b64_tr_b16 v[146:147], v203 offset:16896
    v_mfma_f32_32x32x16_bf16 v[160:175], v[52:55], v[100:103], v[160:175]
    ds_read_b64_tr_b16 v[148:149], v203 offset:18432
    ds_read_b64_tr_b16 v[150:151], v203 offset:18944
    v_mfma_f32_32x32x16_bf16 v[160:175], v[56:59], v[104:107], v[160:175]
    ds_read_b64_tr_b16 v[152:153], v203 offset:20480
    ds_read_b64_tr_b16 v[154:155], v203 offset:20992
    v_mfma_f32_32x32x16_bf16 v[160:175], v[60:63], v[108:111], v[160:175]
    ds_read_b64_tr_b16 v[156:157], v203 offset:22528
    ds_read_b64_tr_b16 v[158:159], v203 offset:23040
    s_waitcnt lgkmcnt(0)
    s_waitcnt vmcnt(10)
    s_barrier
    s_add_u32 s42, s29, 24576
    s_mov_b32 m0, s42
    s_add_u32 s43, s28, 512
    buffer_load_dwordx4 v3, s[36:39], s43 offen lds
    s_add_u32 s42, s29, 25600
    s_mov_b32 m0, s42
    s_add_u32 s43, s28, 10752
    buffer_load_dwordx4 v3, s[36:39], s43 offen lds
    s_add_u32 s42, s29, 26624
    s_mov_b32 m0, s42
    s_add_u32 s43, s28, 20992
    buffer_load_dwordx4 v3, s[36:39], s43 offen lds
    s_add_u32 s42, s29, 27648
    s_mov_b32 m0, s42
    s_add_u32 s43, s28, 31232
    buffer_load_dwordx4 v3, s[36:39], s43 offen lds
    s_add_u32 s42, s29, 28672
    s_mov_b32 m0, s42
    s_add_u32 s43, s28, 41472
    buffer_load_dwordx4 v3, s[36:39], s43 offen lds
    s_add_u32 s42, s29, 29696
    s_mov_b32 m0, s42
    s_add_u32 s43, s28, 51712
    buffer_load_dwordx4 v3, s[36:39], s43 offen lds
    v_mfma_f32_32x32x16_bf16 v[176:191], v[16:19], v[112:115], 0
    ds_read_b64_tr_b16 v[64:65], v204 offset:0
    ds_read_b64_tr_b16 v[66:67], v204 offset:512
    v_mfma_f32_32x32x16_bf16 v[176:191], v[20:23], v[116:119], v[176:191]
    ds_read_b64_tr_b16 v[68:69], v204 offset:2048
    ds_read_b64_tr_b16 v[70:71], v204 offset:2560
    v_mfma_f32_32x32x16_bf16 v[176:191], v[24:27], v[120:123], v[176:191]
    ds_read_b64_tr_b16 v[72:73], v204 offset:4096
    ds_read_b64_tr_b16 v[74:75], v204 offset:4608
    s_add_u32 s42, s41, 2621440
    v_cvt_pk_bf16_f32 v192, v160, v161
    v_cvt_pk_bf16_f32 v193, v162, v163
    v_mfma_f32_32x32x16_bf16 v[176:191], v[28:31], v[124:127], v[176:191]
    ds_read_b64_tr_b16 v[76:77], v204 offset:6144
    ds_read_b64_tr_b16 v[78:79], v204 offset:6656
    v_cvt_pk_bf16_f32 v194, v164, v165
    v_cvt_pk_bf16_f32 v195, v166, v167
    s_nop 1
    v_mfma_f32_32x32x16_bf16 v[176:191], v[32:35], v[128:131], v[176:191]
    ds_read_b64_tr_b16 v[80:81], v204 offset:8192
    ds_read_b64_tr_b16 v[82:83], v204 offset:8704
    v_permlane32_swap_b32 v192, v194
    v_permlane32_swap_b32 v193, v195
    buffer_store_dwordx4 v[192:195], v10, s[8:11], s42 offen offset:0
    v_mfma_f32_32x32x16_bf16 v[176:191], v[36:39], v[132:135], v[176:191]
    ds_read_b64_tr_b16 v[84:85], v204 offset:10240
    ds_read_b64_tr_b16 v[86:87], v204 offset:10752
    v_cvt_pk_bf16_f32 v196, v168, v169
    v_cvt_pk_bf16_f32 v197, v170, v171
    v_cvt_pk_bf16_f32 v198, v172, v173
    v_mfma_f32_32x32x16_bf16 v[176:191], v[40:43], v[136:139], v[176:191]
    ds_read_b64_tr_b16 v[88:89], v204 offset:12288
    ds_read_b64_tr_b16 v[90:91], v204 offset:12800
    v_cvt_pk_bf16_f32 v199, v174, v175
    s_nop 1
    v_permlane32_swap_b32 v196, v198
    v_mfma_f32_32x32x16_bf16 v[176:191], v[44:47], v[140:143], v[176:191]
    ds_read_b64_tr_b16 v[92:93], v204 offset:14336
    ds_read_b64_tr_b16 v[94:95], v204 offset:14848
    v_permlane32_swap_b32 v197, v199
    buffer_store_dwordx4 v[196:199], v10, s[8:11], s42 offen offset:512
    v_mfma_f32_32x32x16_bf16 v[176:191], v[48:51], v[144:147], v[176:191]
    ds_read_b64_tr_b16 v[96:97], v204 offset:16384
    ds_read_b64_tr_b16 v[98:99], v204 offset:16896
    v_mfma_f32_32x32x16_bf16 v[176:191], v[52:55], v[148:151], v[176:191]
    ds_read_b64_tr_b16 v[100:101], v204 offset:18432
    ds_read_b64_tr_b16 v[102:103], v204 offset:18944
    v_mfma_f32_32x32x16_bf16 v[176:191], v[56:59], v[152:155], v[176:191]
    ds_read_b64_tr_b16 v[104:105], v204 offset:20480
    ds_read_b64_tr_b16 v[106:107], v204 offset:20992
    v_mfma_f32_32x32x16_bf16 v[176:191], v[60:63], v[156:159], v[176:191]
    ds_read_b64_tr_b16 v[108:109], v204 offset:22528
    ds_read_b64_tr_b16 v[110:111], v204 offset:23040
    s_waitcnt lgkmcnt(0)
    v_mfma_f32_32x32x16_bf16 v[160:175], v[16:19], v[64:67], 0
    ds_read_b64_tr_b16 v[112:113], v205 offset:0
    ds_read_b64_tr_b16 v[114:115], v205 offset:512
    v_mfma_f32_32x32x16_bf16 v[160:175], v[20:23], v[68:71], v[160:175]
    ds_read_b64_tr_b16 v[116:117], v205 offset:2048
    ds_read_b64_tr_b16 v[118:119], v205 offset:2560
    v_mfma_f32_32x32x16_bf16 v[160:175], v[24:27], v[72:75], v[160:175]
    ds_read_b64_tr_b16 v[120:121], v205 offset:4096
    ds_read_b64_tr_b16 v[122:123], v205 offset:4608
    s_add_u32 s42, s41, 3932160
    v_cvt_pk_bf16_f32 v192, v176, v177
    v_cvt_pk_bf16_f32 v193, v178, v179
    v_mfma_f32_32x32x16_bf16 v[160:175], v[28:31], v[76:79], v[160:175]
    ds_read_b64_tr_b16 v[124:125], v205 offset:6144
    ds_read_b64_tr_b16 v[126:127], v205 offset:6656
    v_cvt_pk_bf16_f32 v194, v180, v181
    v_cvt_pk_bf16_f32 v195, v182, v183
    s_nop 1
    v_mfma_f32_32x32x16_bf16 v[160:175], v[32:35], v[80:83], v[160:175]
    ds_read_b64_tr_b16 v[128:129], v205 offset:8192
    ds_read_b64_tr_b16 v[130:131], v205 offset:8704
    v_permlane32_swap_b32 v192, v194
    v_permlane32_swap_b32 v193, v195
    buffer_store_dwordx4 v[192:195], v10, s[8:11], s42 offen offset:0
    v_mfma_f32_32x32x16_bf16 v[160:175], v[36:39], v[84:87], v[160:175]
    ds_read_b64_tr_b16 v[132:133], v205 offset:10240
    ds_read_b64_tr_b16 v[134:135], v205 offset:10752
    v_cvt_pk_bf16_f32 v196, v184, v185
    v_cvt_pk_bf16_f32 v197, v186, v187
    v_cvt_pk_bf16_f32 v198, v188, v189
    v_mfma_f32_32x32x16_bf16 v[160:175], v[40:43], v[88:91], v[160:175]
    ds_read_b64_tr_b16 v[136:137], v205 offset:12288
    ds_read_b64_tr_b16 v[138:139], v205 offset:12800
    v_cvt_pk_bf16_f32 v199, v190, v191
    s_nop 1
    v_permlane32_swap_b32 v196, v198
    v_mfma_f32_32x32x16_bf16 v[160:175], v[44:47], v[92:95], v[160:175]
    ds_read_b64_tr_b16 v[140:141], v205 offset:14336
    ds_read_b64_tr_b16 v[142:143], v205 offset:14848
    v_permlane32_swap_b32 v197, v199
    buffer_store_dwordx4 v[196:199], v10, s[8:11], s42 offen offset:512
    v_mfma_f32_32x32x16_bf16 v[160:175], v[48:51], v[96:99], v[160:175]
    ds_read_b64_tr_b16 v[144:145], v205 offset:16384
    ds_read_b64_tr_b16 v[146:147], v205 offset:16896
    v_mfma_f32_32x32x16_bf16 v[160:175], v[52:55], v[100:103], v[160:175]
    ds_read_b64_tr_b16 v[148:149], v205 offset:18432
    ds_read_b64_tr_b16 v[150:151], v205 offset:18944
    v_mfma_f32_32x32x16_bf16 v[160:175], v[56:59], v[104:107], v[160:175]
    ds_read_b64_tr_b16 v[152:153], v205 offset:20480
    ds_read_b64_tr_b16 v[154:155], v205 offset:20992
    v_mfma_f32_32x32x16_bf16 v[160:175], v[60:63], v[108:111], v[160:175]
    ds_read_b64_tr_b16 v[156:157], v205 offset:22528
    ds_read_b64_tr_b16 v[158:159], v205 offset:23040
    s_waitcnt lgkmcnt(0)
    s_waitcnt vmcnt(14)
    s_barrier
    v_mfma_f32_32x32x16_bf16 v[176:191], v[16:19], v[112:115], 0
    ds_read_b64_tr_b16 v[64:65], v200 offset:0
    ds_read_b64_tr_b16 v[66:67], v200 offset:512
    v_mfma_f32_32x32x16_bf16 v[176:191], v[20:23], v[116:119], v[176:191]
    ds_read_b64_tr_b16 v[68:69], v200 offset:2048
    ds_read_b64_tr_b16 v[70:71], v200 offset:2560
    v_mfma_f32_32x32x16_bf16 v[176:191], v[24:27], v[120:123], v[176:191]
    ds_read_b64_tr_b16 v[72:73], v200 offset:4096
    ds_read_b64_tr_b16 v[74:75], v200 offset:4608
    s_add_u32 s42, s41, 5242880
    v_cvt_pk_bf16_f32 v192, v160, v161
    v_cvt_pk_bf16_f32 v193, v162, v163
    v_mfma_f32_32x32x16_bf16 v[176:191], v[28:31], v[124:127], v[176:191]
    ds_read_b64_tr_b16 v[76:77], v200 offset:6144
    ds_read_b64_tr_b16 v[78:79], v200 offset:6656
    v_cvt_pk_bf16_f32 v194, v164, v165
    v_cvt_pk_bf16_f32 v195, v166, v167
    s_nop 1
    v_mfma_f32_32x32x16_bf16 v[176:191], v[32:35], v[128:131], v[176:191]
    ds_read_b64_tr_b16 v[80:81], v200 offset:8192
    ds_read_b64_tr_b16 v[82:83], v200 offset:8704
    v_permlane32_swap_b32 v192, v194
    v_permlane32_swap_b32 v193, v195
    buffer_store_dwordx4 v[192:195], v10, s[8:11], s42 offen offset:0
    v_mfma_f32_32x32x16_bf16 v[176:191], v[36:39], v[132:135], v[176:191]
    ds_read_b64_tr_b16 v[84:85], v200 offset:10240
    ds_read_b64_tr_b16 v[86:87], v200 offset:10752
    v_cvt_pk_bf16_f32 v196, v168, v169
    v_cvt_pk_bf16_f32 v197, v170, v171
    v_cvt_pk_bf16_f32 v198, v172, v173
    v_mfma_f32_32x32x16_bf16 v[176:191], v[40:43], v[136:139], v[176:191]
    ds_read_b64_tr_b16 v[88:89], v200 offset:12288
    ds_read_b64_tr_b16 v[90:91], v200 offset:12800
    v_cvt_pk_bf16_f32 v199, v174, v175
    s_nop 1
    v_permlane32_swap_b32 v196, v198
    v_mfma_f32_32x32x16_bf16 v[176:191], v[44:47], v[140:143], v[176:191]
    ds_read_b64_tr_b16 v[92:93], v200 offset:14336
    ds_read_b64_tr_b16 v[94:95], v200 offset:14848
    v_permlane32_swap_b32 v197, v199
    buffer_store_dwordx4 v[196:199], v10, s[8:11], s42 offen offset:512
    v_mfma_f32_32x32x16_bf16 v[176:191], v[48:51], v[144:147], v[176:191]
    ds_read_b64_tr_b16 v[96:97], v200 offset:16384
    ds_read_b64_tr_b16 v[98:99], v200 offset:16896
    v_mfma_f32_32x32x16_bf16 v[176:191], v[52:55], v[148:151], v[176:191]
    ds_read_b64_tr_b16 v[100:101], v200 offset:18432
    ds_read_b64_tr_b16 v[102:103], v200 offset:18944
    v_mfma_f32_32x32x16_bf16 v[176:191], v[56:59], v[152:155], v[176:191]
    ds_read_b64_tr_b16 v[104:105], v200 offset:20480
    ds_read_b64_tr_b16 v[106:107], v200 offset:20992
    v_mfma_f32_32x32x16_bf16 v[176:191], v[60:63], v[156:159], v[176:191]
    ds_read_b64_tr_b16 v[108:109], v200 offset:22528
    ds_read_b64_tr_b16 v[110:111], v200 offset:23040
    s_waitcnt lgkmcnt(0)
    v_mfma_f32_32x32x16_bf16 v[160:175], v[16:19], v[64:67], 0
    ds_read_b64_tr_b16 v[112:113], v201 offset:0
    ds_read_b64_tr_b16 v[114:115], v201 offset:512
    v_mfma_f32_32x32x16_bf16 v[160:175], v[20:23], v[68:71], v[160:175]
    ds_read_b64_tr_b16 v[116:117], v201 offset:2048
    ds_read_b64_tr_b16 v[118:119], v201 offset:2560
    v_mfma_f32_32x32x16_bf16 v[160:175], v[24:27], v[72:75], v[160:175]
    ds_read_b64_tr_b16 v[120:121], v201 offset:4096
    ds_read_b64_tr_b16 v[122:123], v201 offset:4608
    s_add_u32 s42, s41, 6553600
    v_cvt_pk_bf16_f32 v192, v176, v177
    v_cvt_pk_bf16_f32 v193, v178, v179
    v_mfma_f32_32x32x16_bf16 v[160:175], v[28:31], v[76:79], v[160:175]
    ds_read_b64_tr_b16 v[124:125], v201 offset:6144
    ds_read_b64_tr_b16 v[126:127], v201 offset:6656
    v_cvt_pk_bf16_f32 v194, v180, v181
    v_cvt_pk_bf16_f32 v195, v182, v183
    s_nop 1
    v_mfma_f32_32x32x16_bf16 v[160:175], v[32:35], v[80:83], v[160:175]
    ds_read_b64_tr_b16 v[128:129], v201 offset:8192
    ds_read_b64_tr_b16 v[130:131], v201 offset:8704
    v_permlane32_swap_b32 v192, v194
    v_permlane32_swap_b32 v193, v195
    buffer_store_dwordx4 v[192:195], v10, s[8:11], s42 offen offset:0
    v_mfma_f32_32x32x16_bf16 v[160:175], v[36:39], v[84:87], v[160:175]
    ds_read_b64_tr_b16 v[132:133], v201 offset:10240
    ds_read_b64_tr_b16 v[134:135], v201 offset:10752
    v_cvt_pk_bf16_f32 v196, v184, v185
    v_cvt_pk_bf16_f32 v197, v186, v187
    v_cvt_pk_bf16_f32 v198, v188, v189
    v_mfma_f32_32x32x16_bf16 v[160:175], v[40:43], v[88:91], v[160:175]
    ds_read_b64_tr_b16 v[136:137], v201 offset:12288
    ds_read_b64_tr_b16 v[138:139], v201 offset:12800
    v_cvt_pk_bf16_f32 v199, v190, v191
    s_nop 1
    v_permlane32_swap_b32 v196, v198
    v_mfma_f32_32x32x16_bf16 v[160:175], v[44:47], v[92:95], v[160:175]
    ds_read_b64_tr_b16 v[140:141], v201 offset:14336
    ds_read_b64_tr_b16 v[142:143], v201 offset:14848
    v_permlane32_swap_b32 v197, v199
    buffer_store_dwordx4 v[196:199], v10, s[8:11], s42 offen offset:512
    v_mfma_f32_32x32x16_bf16 v[160:175], v[48:51], v[96:99], v[160:175]
    ds_read_b64_tr_b16 v[144:145], v201 offset:16384
    ds_read_b64_tr_b16 v[146:147], v201 offset:16896
    v_mfma_f32_32x32x16_bf16 v[160:175], v[52:55], v[100:103], v[160:175]
    ds_read_b64_tr_b16 v[148:149], v201 offset:18432
    ds_read_b64_tr_b16 v[150:151], v201 offset:18944
    v_mfma_f32_32x32x16_bf16 v[160:175], v[56:59], v[104:107], v[160:175]
    ds_read_b64_tr_b16 v[152:153], v201 offset:20480
    ds_read_b64_tr_b16 v[154:155], v201 offset:20992
    v_mfma_f32_32x32x16_bf16 v[160:175], v[60:63], v[108:111], v[160:175]
    ds_read_b64_tr_b16 v[156:157], v201 offset:22528
    ds_read_b64_tr_b16 v[158:159], v201 offset:23040
    s_waitcnt lgkmcnt(0)
    s_waitcnt vmcnt(8)
    s_barrier
    v_mfma_f32_32x32x16_bf16 v[176:191], v[16:19], v[112:115], 0
    ds_read_b64_tr_b16 v[64:65], v202 offset:0
    ds_read_b64_tr_b16 v[66:67], v202 offset:512
    v_mfma_f32_32x32x16_bf16 v[176:191], v[20:23], v[116:119], v[176:191]
    ds_read_b64_tr_b16 v[68:69], v202 offset:2048
    ds_read_b64_tr_b16 v[70:71], v202 offset:2560
    v_mfma_f32_32x32x16_bf16 v[176:191], v[24:27], v[120:123], v[176:191]
    ds_read_b64_tr_b16 v[72:73], v202 offset:4096
    ds_read_b64_tr_b16 v[74:75], v202 offset:4608
    s_add_u32 s42, s41, 7864320
    v_cvt_pk_bf16_f32 v192, v160, v161
    v_cvt_pk_bf16_f32 v193, v162, v163
    v_mfma_f32_32x32x16_bf16 v[176:191], v[28:31], v[124:127], v[176:191]
    ds_read_b64_tr_b16 v[76:77], v202 offset:6144
    ds_read_b64_tr_b16 v[78:79], v202 offset:6656
    v_cvt_pk_bf16_f32 v194, v164, v165
    v_cvt_pk_bf16_f32 v195, v166, v167
    s_nop 1
    v_mfma_f32_32x32x16_bf16 v[176:191], v[32:35], v[128:131], v[176:191]
    ds_read_b64_tr_b16 v[80:81], v202 offset:8192
    ds_read_b64_tr_b16 v[82:83], v202 offset:8704
    v_permlane32_swap_b32 v192, v194
    v_permlane32_swap_b32 v193, v195
    buffer_store_dwordx4 v[192:195], v10, s[8:11], s42 offen offset:0
    v_mfma_f32_32x32x16_bf16 v[176:191], v[36:39], v[132:135], v[176:191]
    ds_read_b64_tr_b16 v[84:85], v202 offset:10240
    ds_read_b64_tr_b16 v[86:87], v202 offset:10752
    v_cvt_pk_bf16_f32 v196, v168, v169
    v_cvt_pk_bf16_f32 v197, v170, v171
    v_cvt_pk_bf16_f32 v198, v172, v173
    v_mfma_f32_32x32x16_bf16 v[176:191], v[40:43], v[136:139], v[176:191]
    ds_read_b64_tr_b16 v[88:89], v202 offset:12288
    ds_read_b64_tr_b16 v[90:91], v202 offset:12800
    v_cvt_pk_bf16_f32 v199, v174, v175
    s_nop 1
    v_permlane32_swap_b32 v196, v198
    v_mfma_f32_32x32x16_bf16 v[176:191], v[44:47], v[140:143], v[176:191]
    ds_read_b64_tr_b16 v[92:93], v202 offset:14336
    ds_read_b64_tr_b16 v[94:95], v202 offset:14848
    v_permlane32_swap_b32 v197, v199
    buffer_store_dwordx4 v[196:199], v10, s[8:11], s42 offen offset:512
    v_mfma_f32_32x32x16_bf16 v[176:191], v[48:51], v[144:147], v[176:191]
    ds_read_b64_tr_b16 v[96:97], v202 offset:16384
    ds_read_b64_tr_b16 v[98:99], v202 offset:16896
    v_mfma_f32_32x32x16_bf16 v[176:191], v[52:55], v[148:151], v[176:191]
    ds_read_b64_tr_b16 v[100:101], v202 offset:18432
    ds_read_b64_tr_b16 v[102:103], v202 offset:18944
    v_mfma_f32_32x32x16_bf16 v[176:191], v[56:59], v[152:155], v[176:191]
    ds_read_b64_tr_b16 v[104:105], v202 offset:20480
    ds_read_b64_tr_b16 v[106:107], v202 offset:20992
    v_mfma_f32_32x32x16_bf16 v[176:191], v[60:63], v[156:159], v[176:191]
    ds_read_b64_tr_b16 v[108:109], v202 offset:22528
    ds_read_b64_tr_b16 v[110:111], v202 offset:23040
    s_waitcnt lgkmcnt(0)
    v_mfma_f32_32x32x16_bf16 v[160:175], v[16:19], v[64:67], 0
    ds_read_b64_tr_b16 v[112:113], v203 offset:0
    ds_read_b64_tr_b16 v[114:115], v203 offset:512
    v_mfma_f32_32x32x16_bf16 v[160:175], v[20:23], v[68:71], v[160:175]
    ds_read_b64_tr_b16 v[116:117], v203 offset:2048
    ds_read_b64_tr_b16 v[118:119], v203 offset:2560
    v_mfma_f32_32x32x16_bf16 v[160:175], v[24:27], v[72:75], v[160:175]
    ds_read_b64_tr_b16 v[120:121], v203 offset:4096
    ds_read_b64_tr_b16 v[122:123], v203 offset:4608
    s_add_u32 s42, s41, 9175040
    v_cvt_pk_bf16_f32 v192, v176, v177
    v_cvt_pk_bf16_f32 v193, v178, v179
    v_mfma_f32_32x32x16_bf16 v[160:175], v[28:31], v[76:79], v[160:175]
    ds_read_b64_tr_b16 v[124:125], v203 offset:6144
    ds_read_b64_tr_b16 v[126:127], v203 offset:6656
    v_cvt_pk_bf16_f32 v194, v180, v181
    v_cvt_pk_bf16_f32 v195, v182, v183
    s_nop 1
    v_mfma_f32_32x32x16_bf16 v[160:175], v[32:35], v[80:83], v[160:175]
    ds_read_b64_tr_b16 v[128:129], v203 offset:8192
    ds_read_b64_tr_b16 v[130:131], v203 offset:8704
    v_permlane32_swap_b32 v192, v194
    v_permlane32_swap_b32 v193, v195
    buffer_store_dwordx4 v[192:195], v10, s[8:11], s42 offen offset:0
    v_mfma_f32_32x32x16_bf16 v[160:175], v[36:39], v[84:87], v[160:175]
    ds_read_b64_tr_b16 v[132:133], v203 offset:10240
    ds_read_b64_tr_b16 v[134:135], v203 offset:10752
    v_cvt_pk_bf16_f32 v196, v184, v185
    v_cvt_pk_bf16_f32 v197, v186, v187
    v_cvt_pk_bf16_f32 v198, v188, v189
    v_mfma_f32_32x32x16_bf16 v[160:175], v[40:43], v[88:91], v[160:175]
    ds_read_b64_tr_b16 v[136:137], v203 offset:12288
    ds_read_b64_tr_b16 v[138:139], v203 offset:12800
    v_cvt_pk_bf16_f32 v199, v190, v191
    s_nop 1
    v_permlane32_swap_b32 v196, v198
    v_mfma_f32_32x32x16_bf16 v[160:175], v[44:47], v[92:95], v[160:175]
    ds_read_b64_tr_b16 v[140:141], v203 offset:14336
    ds_read_b64_tr_b16 v[142:143], v203 offset:14848
    v_permlane32_swap_b32 v197, v199
    buffer_store_dwordx4 v[196:199], v10, s[8:11], s42 offen offset:512
    v_mfma_f32_32x32x16_bf16 v[160:175], v[48:51], v[96:99], v[160:175]
    ds_read_b64_tr_b16 v[144:145], v203 offset:16384
    ds_read_b64_tr_b16 v[146:147], v203 offset:16896
    v_mfma_f32_32x32x16_bf16 v[160:175], v[52:55], v[100:103], v[160:175]
    ds_read_b64_tr_b16 v[148:149], v203 offset:18432
    ds_read_b64_tr_b16 v[150:151], v203 offset:18944
    v_mfma_f32_32x32x16_bf16 v[160:175], v[56:59], v[104:107], v[160:175]
    ds_read_b64_tr_b16 v[152:153], v203 offset:20480
    ds_read_b64_tr_b16 v[154:155], v203 offset:20992
    v_mfma_f32_32x32x16_bf16 v[160:175], v[60:63], v[108:111], v[160:175]
    ds_read_b64_tr_b16 v[156:157], v203 offset:22528
    ds_read_b64_tr_b16 v[158:159], v203 offset:23040
    s_waitcnt lgkmcnt(0)
    s_barrier
    v_mfma_f32_32x32x16_bf16 v[176:191], v[16:19], v[112:115], 0
    v_mfma_f32_32x32x16_bf16 v[176:191], v[20:23], v[116:119], v[176:191]
    v_mfma_f32_32x32x16_bf16 v[176:191], v[24:27], v[120:123], v[176:191]
    s_add_u32 s42, s41, 10485760
    v_cvt_pk_bf16_f32 v192, v160, v161
    v_cvt_pk_bf16_f32 v193, v162, v163
    v_mfma_f32_32x32x16_bf16 v[176:191], v[28:31], v[124:127], v[176:191]
    v_cvt_pk_bf16_f32 v194, v164, v165
    v_cvt_pk_bf16_f32 v195, v166, v167
    s_nop 1
    v_mfma_f32_32x32x16_bf16 v[176:191], v[32:35], v[128:131], v[176:191]
    v_permlane32_swap_b32 v192, v194
    v_permlane32_swap_b32 v193, v195
    buffer_store_dwordx4 v[192:195], v10, s[8:11], s42 offen offset:0
    v_mfma_f32_32x32x16_bf16 v[176:191], v[36:39], v[132:135], v[176:191]
    v_cvt_pk_bf16_f32 v196, v168, v169
    v_cvt_pk_bf16_f32 v197, v170, v171
    v_cvt_pk_bf16_f32 v198, v172, v173
    v_mfma_f32_32x32x16_bf16 v[176:191], v[40:43], v[136:139], v[176:191]
    v_cvt_pk_bf16_f32 v199, v174, v175
    s_nop 1
    v_permlane32_swap_b32 v196, v198
    v_mfma_f32_32x32x16_bf16 v[176:191], v[44:47], v[140:143], v[176:191]
    v_permlane32_swap_b32 v197, v199
    buffer_store_dwordx4 v[196:199], v10, s[8:11], s42 offen offset:512
    v_mfma_f32_32x32x16_bf16 v[176:191], v[48:51], v[144:147], v[176:191]
    v_mfma_f32_32x32x16_bf16 v[176:191], v[52:55], v[148:151], v[176:191]
    v_mfma_f32_32x32x16_bf16 v[176:191], v[56:59], v[152:155], v[176:191]
    v_mfma_f32_32x32x16_bf16 v[176:191], v[60:63], v[156:159], v[176:191]
    s_nop 7
    s_nop 7
    s_nop 7
    s_add_u32 s42, s41, 11796480
    v_cvt_pk_bf16_f32 v192, v176, v177
    v_cvt_pk_bf16_f32 v193, v178, v179
    v_cvt_pk_bf16_f32 v194, v180, v181
    v_cvt_pk_bf16_f32 v195, v182, v183
    s_nop 1
    v_permlane32_swap_b32 v192, v194
    v_permlane32_swap_b32 v193, v195
    buffer_store_dwordx4 v[192:195], v10, s[8:11], s42 offen offset:0
    v_cvt_pk_bf16_f32 v196, v184, v185
    v_cvt_pk_bf16_f32 v197, v186, v187
    v_cvt_pk_bf16_f32 v198, v188, v189
    v_cvt_pk_bf16_f32 v199, v190, v191
    s_nop 1
    v_permlane32_swap_b32 v196, v198
    v_permlane32_swap_b32 v197, v199
    buffer_store_dwordx4 v[196:199], v10, s[8:11], s42 offen offset:512
    s_branch prep_kernel_end
prep_kernel_r_pwp:
    s_lshl_b32 s20, s20, 2
    s_add_u32 s20, s20, s13
    s_mul_i32 s21, s20, 13108
    s_lshr_b32 s21, s21, 16
    s_mul_i32 s22, s21, 5
    s_sub_u32 s22, s20, s22
    s_mul_i32 s23, s21, 21846
    s_lshr_b32 s23, s23, 16
    s_mul_i32 s28, s23, 3
    s_sub_u32 s21, s21, s28
    s_lshr_b32 s29, s23, 5
    s_and_b32 s23, s23, 31
    s_cmp_eq_u32 s29, 0
    s_cbranch_scc0 prep_kernel_pwp_k
    s_load_dwordx2 s[24:25], s[0:1], 40
    s_branch prep_kernel_pwp_go
prep_kernel_pwp_k:
    s_load_dwordx2 s[24:25], s[0:1], 48
prep_kernel_pwp_go:
    v_and_b32 v1, 31, v0
    v_lshrrev_b32 v2, 5, v0
    s_lshl_b32 s28, s21, 6
    v_lshlrev_b32 v3, 1, v1
    v_add_u32 v3, s28, v3
    v_and_b32 v4, 0xc1, v3
    v_and_b32 v5, 8, v3
    v_lshl_or_b32 v4, v5, 2, v4
    v_and_b32 v5, 32, v3
    v_lshrrev_b32 v5, 1, v5
    v_or_b32 v4, v4, v5
    v_and_b32 v5, 2, v3
    v_lshl_or_b32 v4, v5, 2, v4
    v_and_b32 v5, 16, v3
    v_lshrrev_b32 v5, 2, v5
    v_or_b32 v4, v4, v5
    v_and_b32 v5, 4, v3
    v_lshrrev_b32 v5, 1, v5
    v_or_b32 v4, v4, v5
    s_cmp_eq_u32 s29, 0
    s_cselect_b64 vcc, -1, 0
    s_nop 1
    v_cndmask_b32 v4, v4, v3, vcc
    v_lshrrev_b32 v5, 4, v3
    v_and_b32 v6, 3, v5
    v_mul_u32_u24 v6, 6, v6
    v_lshrrev_b32 v5, 2, v5
    v_add_u32 v5, v5, v6
    v_mul_u32_u24 v5, 20480, v5
    v_and_b32 v6, 15, v3
    v_lshl_add_u32 v7, v6, 4, v5
    s_mul_i32 s30, s29, 61440
    s_mul_i32 s31, s23, 491520
    s_add_u32 s30, s30, s31
    s_add_u32 s30, s30, 11534336
    s_lshl_b32 s31, s22, 4
    v_add_u32 v8, s31, v2
    s_waitcnt lgkmcnt(0)
    s_mov_b32 s32, s24
    s_mov_b32 s33, s25
    s_mov_b32 s34, 7864320
    s_mov_b32 s35, 0x00020000
    s_mul_i32 s28, s23, 384
    v_add_u32 v9, 0, v8
    v_lshrrev_b32 v10, 2, v9
    v_lshlrev_b32 v10, 5, v10
    v_and_b32 v11, 2, v9
    v_lshl_add_u32 v10, v11, 3, v10
    v_and_b32 v11, 1, v9
    v_lshl_add_u32 v10, v11, 2, v10
    v_mul_u32_u24 v10, 12288, v10
    v_lshl_add_u32 v10, v4, 1, v10
    s_add_u32 s31, s28, 0
    buffer_load_dword v16, v10, s[32:35], s31 offen
    s_add_u32 s31, s28, 12288
    buffer_load_dword v17, v10, s[32:35], s31 offen
    s_add_u32 s31, s28, 98304
    buffer_load_dword v18, v10, s[32:35], s31 offen
    s_add_u32 s31, s28, 110592
    buffer_load_dword v19, v10, s[32:35], s31 offen
    s_add_u32 s31, s28, 24576
    buffer_load_dword v20, v10, s[32:35], s31 offen
    s_add_u32 s31, s28, 36864
    buffer_load_dword v21, v10, s[32:35], s31 offen
    s_add_u32 s31, s28, 122880
    buffer_load_dword v22, v10, s[32:35], s31 offen
    s_add_u32 s31, s28, 135168
    buffer_load_dword v23, v10, s[32:35], s31 offen
    v_add_u32 v9, 2, v8
    v_lshrrev_b32 v10, 2, v9
    v_lshlrev_b32 v10, 5, v10
    v_and_b32 v11, 2, v9
    v_lshl_add_u32 v10, v11, 3, v10
    v_and_b32 v11, 1, v9
    v_lshl_add_u32 v10, v11, 2, v10
    v_mul_u32_u24 v10, 12288, v10
    v_lshl_add_u32 v10, v4, 1, v10
    s_add_u32 s31, s28, 0
    buffer_load_dword v24, v10, s[32:35], s31 offen
    s_add_u32 s31, s28, 12288
    buffer_load_dword v25, v10, s[32:35], s31 offen
    s_add_u32 s31, s28, 98304
    buffer_load_dword v26, v10, s[32:35], s31 offen
    s_add_u32 s31, s28, 110592
    buffer_load_dword v27, v10, s[32:35], s31 offen
    s_add_u32 s31, s28, 24576
    buffer_load_dword v28, v10, s[32:35], s31 offen
    s_add_u32 s31, s28, 36864
    buffer_load_dword v29, v10, s[32:35], s31 offen
    s_add_u32 s31, s28, 122880
    buffer_load_dword v30, v10, s[32:35], s31 offen
    s_add_u32 s31, s28, 135168
    buffer_load_dword v31, v10, s[32:35], s31 offen
    v_add_u32 v9, 4, v8
    v_lshrrev_b32 v10, 2, v9
    v_lshlrev_b32 v10, 5, v10
    v_and_b32 v11, 2, v9
    v_lshl_add_u32 v10, v11, 3, v10
    v_and_b32 v11, 1, v9
    v_lshl_add_u32 v10, v11, 2, v10
    v_mul_u32_u24 v10, 12288, v10
    v_lshl_add_u32 v10, v4, 1, v10
    s_add_u32 s31, s28, 0
    buffer_load_dword v32, v10, s[32:35], s31 offen
    s_add_u32 s31, s28, 12288
    buffer_load_dword v33, v10, s[32:35], s31 offen
    s_add_u32 s31, s28, 98304
    buffer_load_dword v34, v10, s[32:35], s31 offen
    s_add_u32 s31, s28, 110592
    buffer_load_dword v35, v10, s[32:35], s31 offen
    s_add_u32 s31, s28, 24576
    buffer_load_dword v36, v10, s[32:35], s31 offen
    s_add_u32 s31, s28, 36864
    buffer_load_dword v37, v10, s[32:35], s31 offen
    s_add_u32 s31, s28, 122880
    buffer_load_dword v38, v10, s[32:35], s31 offen
    s_add_u32 s31, s28, 135168
    buffer_load_dword v39, v10, s[32:35], s31 offen
    v_add_u32 v9, 6, v8
    v_lshrrev_b32 v10, 2, v9
    v_lshlrev_b32 v10, 5, v10
    v_and_b32 v11, 2, v9
    v_lshl_add_u32 v10, v11, 3, v10
    v_and_b32 v11, 1, v9
    v_lshl_add_u32 v10, v11, 2, v10
    v_mul_u32_u24 v10, 12288, v10
    v_lshl_add_u32 v10, v4, 1, v10
    s_add_u32 s31, s28, 0
    buffer_load_dword v40, v10, s[32:35], s31 offen
    s_add_u32 s31, s28, 12288
    buffer_load_dword v41, v10, s[32:35], s31 offen
    s_add_u32 s31, s28, 98304
    buffer_load_dword v42, v10, s[32:35], s31 offen
    s_add_u32 s31, s28, 110592
    buffer_load_dword v43, v10, s[32:35], s31 offen
    s_add_u32 s31, s28, 24576
    buffer_load_dword v44, v10, s[32:35], s31 offen
    s_add_u32 s31, s28, 36864
    buffer_load_dword v45, v10, s[32:35], s31 offen
    s_add_u32 s31, s28, 122880
    buffer_load_dword v46, v10, s[32:35], s31 offen
    s_add_u32 s31, s28, 135168
    buffer_load_dword v47, v10, s[32:35], s31 offen
    v_add_u32 v9, 8, v8
    v_lshrrev_b32 v10, 2, v9
    v_lshlrev_b32 v10, 5, v10
    v_and_b32 v11, 2, v9
    v_lshl_add_u32 v10, v11, 3, v10
    v_and_b32 v11, 1, v9
    v_lshl_add_u32 v10, v11, 2, v10
    v_mul_u32_u24 v10, 12288, v10
    v_lshl_add_u32 v10, v4, 1, v10
    s_add_u32 s31, s28, 0
    buffer_load_dword v48, v10, s[32:35], s31 offen
    s_add_u32 s31, s28, 12288
    buffer_load_dword v49, v10, s[32:35], s31 offen
    s_add_u32 s31, s28, 98304
    buffer_load_dword v50, v10, s[32:35], s31 offen
    s_add_u32 s31, s28, 110592
    buffer_load_dword v51, v10, s[32:35], s31 offen
    s_add_u32 s31, s28, 24576
    buffer_load_dword v52, v10, s[32:35], s31 offen
    s_add_u32 s31, s28, 36864
    buffer_load_dword v53, v10, s[32:35], s31 offen
    s_add_u32 s31, s28, 122880
    buffer_load_dword v54, v10, s[32:35], s31 offen
    s_add_u32 s31, s28, 135168
    buffer_load_dword v55, v10, s[32:35], s31 offen
    v_add_u32 v9, 10, v8
    v_lshrrev_b32 v10, 2, v9
    v_lshlrev_b32 v10, 5, v10
    v_and_b32 v11, 2, v9
    v_lshl_add_u32 v10, v11, 3, v10
    v_and_b32 v11, 1, v9
    v_lshl_add_u32 v10, v11, 2, v10
    v_mul_u32_u24 v10, 12288, v10
    v_lshl_add_u32 v10, v4, 1, v10
    s_add_u32 s31, s28, 0
    buffer_load_dword v56, v10, s[32:35], s31 offen
    s_add_u32 s31, s28, 12288
    buffer_load_dword v57, v10, s[32:35], s31 offen
    s_add_u32 s31, s28, 98304
    buffer_load_dword v58, v10, s[32:35], s31 offen
    s_add_u32 s31, s28, 110592
    buffer_load_dword v59, v10, s[32:35], s31 offen
    s_add_u32 s31, s28, 24576
    buffer_load_dword v60, v10, s[32:35], s31 offen
    s_add_u32 s31, s28, 36864
    buffer_load_dword v61, v10, s[32:35], s31 offen
    s_add_u32 s31, s28, 122880
    buffer_load_dword v62, v10, s[32:35], s31 offen
    s_add_u32 s31, s28, 135168
    buffer_load_dword v63, v10, s[32:35], s31 offen
    v_add_u32 v9, 12, v8
    v_lshrrev_b32 v10, 2, v9
    v_lshlrev_b32 v10, 5, v10
    v_and_b32 v11, 2, v9
    v_lshl_add_u32 v10, v11, 3, v10
    v_and_b32 v11, 1, v9
    v_lshl_add_u32 v10, v11, 2, v10
    v_mul_u32_u24 v10, 12288, v10
    v_lshl_add_u32 v10, v4, 1, v10
    s_add_u32 s31, s28, 0
    buffer_load_dword v64, v10, s[32:35], s31 offen
    s_add_u32 s31, s28, 12288
    buffer_load_dword v65, v10, s[32:35], s31 offen
    s_add_u32 s31, s28, 98304
    buffer_load_dword v66, v10, s[32:35], s31 offen
    s_add_u32 s31, s28, 110592
    buffer_load_dword v67, v10, s[32:35], s31 offen
    s_add_u32 s31, s28, 24576
    buffer_load_dword v68, v10, s[32:35], s31 offen
    s_add_u32 s31, s28, 36864
    buffer_load_dword v69, v10, s[32:35], s31 offen
    s_add_u32 s31, s28, 122880
    buffer_load_dword v70, v10, s[32:35], s31 offen
    s_add_u32 s31, s28, 135168
    buffer_load_dword v71, v10, s[32:35], s31 offen
    v_add_u32 v9, 14, v8
    v_lshrrev_b32 v10, 2, v9
    v_lshlrev_b32 v10, 5, v10
    v_and_b32 v11, 2, v9
    v_lshl_add_u32 v10, v11, 3, v10
    v_and_b32 v11, 1, v9
    v_lshl_add_u32 v10, v11, 2, v10
    v_mul_u32_u24 v10, 12288, v10
    v_lshl_add_u32 v10, v4, 1, v10
    s_add_u32 s31, s28, 0
    buffer_load_dword v72, v10, s[32:35], s31 offen
    s_add_u32 s31, s28, 12288
    buffer_load_dword v73, v10, s[32:35], s31 offen
    s_add_u32 s31, s28, 98304
    buffer_load_dword v74, v10, s[32:35], s31 offen
    s_add_u32 s31, s28, 110592
    buffer_load_dword v75, v10, s[32:35], s31 offen
    s_add_u32 s31, s28, 24576
    buffer_load_dword v76, v10, s[32:35], s31 offen
    s_add_u32 s31, s28, 36864
    buffer_load_dword v77, v10, s[32:35], s31 offen
    s_add_u32 s31, s28, 122880
    buffer_load_dword v78, v10, s[32:35], s31 offen
    s_add_u32 s31, s28, 135168
    buffer_load_dword v79, v10, s[32:35], s31 offen
    v_lshl_add_u32 v7, v8, 8, v7
    v_mov_b32 v4, 0x05040100
    v_mov_b32 v5, 0x07060302
    s_waitcnt vmcnt(56)
    v_perm_b32 v80, v17, v16, v4
    v_perm_b32 v84, v17, v16, v5
    v_perm_b32 v81, v19, v18, v4
    v_perm_b32 v85, v19, v18, v5
    v_perm_b32 v82, v21, v20, v4
    v_perm_b32 v86, v21, v20, v5
    v_perm_b32 v83, v23, v22, v4
    v_perm_b32 v87, v23, v22, v5
    buffer_store_dwordx4 v[80:83], v7, s[8:11], s30 offen offset:0
    buffer_store_dwordx4 v[84:87], v7, s[8:11], s30 offen offset:16
    s_waitcnt vmcnt(48)
    v_perm_b32 v88, v25, v24, v4
    v_perm_b32 v92, v25, v24, v5
    v_perm_b32 v89, v27, v26, v4
    v_perm_b32 v93, v27, v26, v5
    v_perm_b32 v90, v29, v28, v4
    v_perm_b32 v94, v29, v28, v5
    v_perm_b32 v91, v31, v30, v4
    v_perm_b32 v95, v31, v30, v5
    buffer_store_dwordx4 v[88:91], v7, s[8:11], s30 offen offset:512
    buffer_store_dwordx4 v[92:95], v7, s[8:11], s30 offen offset:528
    s_nop 0
    s_waitcnt vmcnt(40)
    v_perm_b32 v80, v33, v32, v4
    v_perm_b32 v84, v33, v32, v5
    v_perm_b32 v81, v35, v34, v4
    v_perm_b32 v85, v35, v34, v5
    v_perm_b32 v82, v37, v36, v4
    v_perm_b32 v86, v37, v36, v5
    v_perm_b32 v83, v39, v38, v4
    v_perm_b32 v87, v39, v38, v5
    buffer_store_dwordx4 v[80:83], v7, s[8:11], s30 offen offset:1024
    buffer_store_dwordx4 v[84:87], v7, s[8:11], s30 offen offset:1040
    s_nop 0
    s_waitcnt vmcnt(32)
    v_perm_b32 v88, v41, v40, v4
    v_perm_b32 v92, v41, v40, v5
    v_perm_b32 v89, v43, v42, v4
    v_perm_b32 v93, v43, v42, v5
    v_perm_b32 v90, v45, v44, v4
    v_perm_b32 v94, v45, v44, v5
    v_perm_b32 v91, v47, v46, v4
    v_perm_b32 v95, v47, v46, v5
    buffer_store_dwordx4 v[88:91], v7, s[8:11], s30 offen offset:1536
    buffer_store_dwordx4 v[92:95], v7, s[8:11], s30 offen offset:1552
    s_nop 0
    s_waitcnt vmcnt(24)
    v_perm_b32 v80, v49, v48, v4
    v_perm_b32 v84, v49, v48, v5
    v_perm_b32 v81, v51, v50, v4
    v_perm_b32 v85, v51, v50, v5
    v_perm_b32 v82, v53, v52, v4
    v_perm_b32 v86, v53, v52, v5
    v_perm_b32 v83, v55, v54, v4
    v_perm_b32 v87, v55, v54, v5
    buffer_store_dwordx4 v[80:83], v7, s[8:11], s30 offen offset:2048
    buffer_store_dwordx4 v[84:87], v7, s[8:11], s30 offen offset:2064
    s_nop 0
    s_waitcnt vmcnt(16)
    v_perm_b32 v88, v57, v56, v4
    v_perm_b32 v92, v57, v56, v5
    v_perm_b32 v89, v59, v58, v4
    v_perm_b32 v93, v59, v58, v5
    v_perm_b32 v90, v61, v60, v4
    v_perm_b32 v94, v61, v60, v5
    v_perm_b32 v91, v63, v62, v4
    v_perm_b32 v95, v63, v62, v5
    buffer_store_dwordx4 v[88:91], v7, s[8:11], s30 offen offset:2560
    buffer_store_dwordx4 v[92:95], v7, s[8:11], s30 offen offset:2576
    s_nop 0
    s_waitcnt vmcnt(8)
    v_perm_b32 v80, v65, v64, v4
    v_perm_b32 v84, v65, v64, v5
    v_perm_b32 v81, v67, v66, v4
    v_perm_b32 v85, v67, v66, v5
    v_perm_b32 v82, v69, v68, v4
    v_perm_b32 v86, v69, v68, v5
    v_perm_b32 v83, v71, v70, v4
    v_perm_b32 v87, v71, v70, v5
    buffer_store_dwordx4 v[80:83], v7, s[8:11], s30 offen offset:3072
    buffer_store_dwordx4 v[84:87], v7, s[8:11], s30 offen offset:3088
    s_nop 0
    s_waitcnt vmcnt(0)
    v_perm_b32 v88, v73, v72, v4
    v_perm_b32 v92, v73, v72, v5
    v_perm_b32 v89, v75, v74, v4
    v_perm_b32 v93, v75, v74, v5
    v_perm_b32 v90, v77, v76, v4
    v_perm_b32 v94, v77, v76, v5
    v_perm_b32 v91, v79, v78, v4
    v_perm_b32 v95, v79, v78, v5
    buffer_store_dwordx4 v[88:91], v7, s[8:11], s30 offen offset:3584
    buffer_store_dwordx4 v[92:95], v7, s[8:11], s30 offen offset:3600
    s_nop 0
    s_branch prep_kernel_end
prep_kernel_r_pwa:
    s_load_dwordx2 s[24:25], s[0:1], 8
    s_lshr_b32 s21, s20, 1
    s_and_b32 s22, s20, 1
    v_and_b32 v1, 31, v0
    v_lshrrev_b32 v2, 5, v0
    s_mul_i32 s23, s21, 20
    v_add_u32 v3, 640, v1
    v_add_u32 v4, 1260, v1
    v_cmp_gt_u32 vcc, 20, v1
    s_nop 1
    v_cndmask_b32 v3, v4, v3, vcc
    v_add_u32 v4, 1292, v1
    v_subrev_u32 v5, 12, v1
    v_cmp_gt_u32 vcc, 8, v1
    s_nop 1
    v_cndmask_b32 v4, v5, v4, vcc
    s_cmp_eq_u32 s22, 0
    s_cselect_b64 vcc, -1, 0
    s_nop 1
    v_cndmask_b32 v3, v4, v3, vcc
    v_add_u32 v3, s23, v3
    v_lshlrev_b32 v3, 1, v3
    v_mul_u32_u24 v4, 30720, v2
    v_add_u32 v3, v3, v4
    s_mov_b32 s26, 0xfffff0ff
    s_cmp_eq_u32 s22, 0
    s_cselect_b32 s26, -1, s26
    s_mov_b32 s27, s26
    v_mov_b32 v16, 0
    v_mov_b32 v17, 0
    v_mov_b32 v18, 0
    v_mov_b32 v19, 0
    v_mov_b32 v20, 0
    v_mov_b32 v21, 0
    v_mov_b32 v22, 0
    v_mov_b32 v23, 0
    v_mov_b32 v24, 0
    v_mov_b32 v25, 0
    v_mov_b32 v26, 0
    v_mov_b32 v27, 0
    v_mov_b32 v28, 0
    v_mov_b32 v29, 0
    v_mov_b32 v30, 0
    v_mov_b32 v31, 0
    v_mov_b32 v32, 0
    v_mov_b32 v33, 0
    v_mov_b32 v34, 0
    v_mov_b32 v35, 0
    v_mov_b32 v36, 0
    v_mov_b32 v37, 0
    v_mov_b32 v38, 0
    v_mov_b32 v39, 0
    v_mov_b32 v40, 0
    v_mov_b32 v41, 0
    v_mov_b32 v42, 0
    v_mov_b32 v43, 0
    v_mov_b32 v44, 0
    v_mov_b32 v45, 0
    v_mov_b32 v46, 0
    v_mov_b32 v47, 0
    v_mov_b32 v48, 0
    v_mov_b32 v49, 0
    v_mov_b32 v50, 0
    v_mov_b32 v51, 0
    v_mov_b32 v52, 0
    v_mov_b32 v53, 0
    v_mov_b32 v54, 0
    v_mov_b32 v55, 0
    v_mov_b32 v56, 0
    v_mov_b32 v57, 0
    v_mov_b32 v58, 0
    v_mov_b32 v59, 0
    v_mov_b32 v60, 0
    v_mov_b32 v61, 0
    v_mov_b32 v62, 0
    v_mov_b32 v63, 0
    v_mov_b32 v64, 0
    v_mov_b32 v65, 0
    v_mov_b32 v66, 0
    v_mov_b32 v67, 0
    v_mov_b32 v68, 0
    v_mov_b32 v69, 0
    v_mov_b32 v70, 0
    v_mov_b32 v71, 0
    v_mov_b32 v72, 0
    v_mov_b32 v73, 0
    v_mov_b32 v74, 0
    v_mov_b32 v75, 0
    v_mov_b32 v76, 0
    v_mov_b32 v77, 0
    v_mov_b32 v78, 0
    v_mov_b32 v79, 0
    v_mov_b32 v80, 0
    v_mov_b32 v81, 0
    v_mov_b32 v82, 0
    v_mov_b32 v83, 0
    v_mov_b32 v84, 0
    v_mov_b32 v85, 0
    v_mov_b32 v86, 0
    v_mov_b32 v87, 0
    v_mov_b32 v88, 0
    v_mov_b32 v89, 0
    v_mov_b32 v90, 0
    v_mov_b32 v91, 0
    v_mov_b32 v92, 0
    v_mov_b32 v93, 0
    v_mov_b32 v94, 0
    v_mov_b32 v95, 0
    s_waitcnt lgkmcnt(0)
    s_mov_b32 s32, s24
    s_mov_b32 s33, s25
    s_mov_b32 s34, 2457600
    s_mov_b32 s35, 0x00020000
    s_mul_i32 s28, s13, 614400
    s_mov_b64 exec, s[26:27]
    s_add_u32 s29, s28, 0
    buffer_load_short_d16_hi v16, v3, s[32:35], s29 offen
    s_add_u32 s29, s28, 3840
    buffer_load_short_d16_hi v17, v3, s[32:35], s29 offen
    s_add_u32 s29, s28, 7680
    buffer_load_short_d16_hi v18, v3, s[32:35], s29 offen
    s_add_u32 s29, s28, 11520
    buffer_load_short_d16_hi v19, v3, s[32:35], s29 offen
    s_add_u32 s29, s28, 15360
    buffer_load_short_d16_hi v20, v3, s[32:35], s29 offen
    s_add_u32 s29, s28, 19200
    buffer_load_short_d16_hi v21, v3, s[32:35], s29 offen
    s_add_u32 s29, s28, 23040
    buffer_load_short_d16_hi v22, v3, s[32:35], s29 offen
    s_add_u32 s29, s28, 26880
    buffer_load_short_d16_hi v23, v3, s[32:35], s29 offen
    s_add_u32 s29, s28, 61440
    buffer_load_short_d16_hi v24, v3, s[32:35], s29 offen
    s_add_u32 s29, s28, 65280
    buffer_load_short_d16_hi v25, v3, s[32:35], s29 offen
    s_add_u32 s29, s28, 69120
    buffer_load_short_d16_hi v26, v3, s[32:35], s29 offen
    s_add_u32 s29, s28, 72960
    buffer_load_short_d16_hi v27, v3, s[32:35], s29 offen
    s_add_u32 s29, s28, 76800
    buffer_load_short_d16_hi v28, v3, s[32:35], s29 offen
    s_add_u32 s29, s28, 80640
    buffer_load_short_d16_hi v29, v3, s[32:35], s29 offen
    s_add_u32 s29, s28, 84480
    buffer_load_short_d16_hi v30, v3, s[32:35], s29 offen
    s_add_u32 s29, s28, 88320
    buffer_load_short_d16_hi v31, v3, s[32:35], s29 offen
    s_add_u32 s29, s28, 122880
    buffer_load_short_d16_hi v32, v3, s[32:35], s29 offen
    s_add_u32 s29, s28, 126720
    buffer_load_short_d16_hi v33, v3, s[32:35], s29 offen
    s_add_u32 s29, s28, 130560
    buffer_load_short_d16_hi v34, v3, s[32:35], s29 offen
    s_add_u32 s29, s28, 134400
    buffer_load_short_d16_hi v35, v3, s[32:35], s29 offen
    s_add_u32 s29, s28, 138240
    buffer_load_short_d16_hi v36, v3, s[32:35], s29 offen
    s_add_u32 s29, s28, 142080
    buffer_load_short_d16_hi v37, v3, s[32:35], s29 offen
    s_add_u32 s29, s28, 145920
    buffer_load_short_d16_hi v38, v3, s[32:35], s29 offen
    s_add_u32 s29, s28, 149760
    buffer_load_short_d16_hi v39, v3, s[32:35], s29 offen
    s_add_u32 s29, s28, 184320
    buffer_load_short_d16_hi v40, v3, s[32:35], s29 offen
    s_add_u32 s29, s28, 188160
    buffer_load_short_d16_hi v41, v3, s[32:35], s29 offen
    s_add_u32 s29, s28, 192000
    buffer_load_short_d16_hi v42, v3, s[32:35], s29 offen
    s_add_u32 s29, s28, 195840
    buffer_load_short_d16_hi v43, v3, s[32:35], s29 offen
    s_add_u32 s29, s28, 199680
    buffer_load_short_d16_hi v44, v3, s[32:35], s29 offen
    s_add_u32 s29, s28, 203520
    buffer_load_short_d16_hi v45, v3, s[32:35], s29 offen
    s_add_u32 s29, s28, 207360
    buffer_load_short_d16_hi v46, v3, s[32:35], s29 offen
    s_add_u32 s29, s28, 211200
    buffer_load_short_d16_hi v47, v3, s[32:35], s29 offen
    s_add_u32 s29, s28, 245760
    buffer_load_short_d16_hi v48, v3, s[32:35], s29 offen
    s_add_u32 s29, s28, 249600
    buffer_load_short_d16_hi v49, v3, s[32:35], s29 offen
    s_add_u32 s29, s28, 253440
    buffer_load_short_d16_hi v50, v3, s[32:35], s29 offen
    s_add_u32 s29, s28, 257280
    buffer_load_short_d16_hi v51, v3, s[32:35], s29 offen
    s_add_u32 s29, s28, 261120
    buffer_load_short_d16_hi v52, v3, s[32:35], s29 offen
    s_add_u32 s29, s28, 264960
    buffer_load_short_d16_hi v53, v3, s[32:35], s29 offen
    s_add_u32 s29, s28, 268800
    buffer_load_short_d16_hi v54, v3, s[32:35], s29 offen
    s_add_u32 s29, s28, 272640
    buffer_load_short_d16_hi v55, v3, s[32:35], s29 offen
    s_add_u32 s29, s28, 307200
    buffer_load_short_d16_hi v56, v3, s[32:35], s29 offen
    s_add_u32 s29, s28, 311040
    buffer_load_short_d16_hi v57, v3, s[32:35], s29 offen
    s_add_u32 s29, s28, 314880
    buffer_load_short_d16_hi v58, v3, s[32:35], s29 offen
    s_add_u32 s29, s28, 318720
    buffer_load_short_d16_hi v59, v3, s[32:35], s29 offen
    s_add_u32 s29, s28, 322560
    buffer_load_short_d16_hi v60, v3, s[32:35], s29 offen
    s_add_u32 s29, s28, 326400
    buffer_load_short_d16_hi v61, v3, s[32:35], s29 offen
    s_add_u32 s29, s28, 330240
    buffer_load_short_d16_hi v62, v3, s[32:35], s29 offen
    s_add_u32 s29, s28, 334080
    buffer_load_short_d16_hi v63, v3, s[32:35], s29 offen
    s_add_u32 s29, s28, 368640
    buffer_load_short_d16_hi v64, v3, s[32:35], s29 offen
    s_add_u32 s29, s28, 372480
    buffer_load_short_d16_hi v65, v3, s[32:35], s29 offen
    s_add_u32 s29, s28, 376320
    buffer_load_short_d16_hi v66, v3, s[32:35], s29 offen
    s_add_u32 s29, s28, 380160
    buffer_load_short_d16_hi v67, v3, s[32:35], s29 offen
    s_add_u32 s29, s28, 384000
    buffer_load_short_d16_hi v68, v3, s[32:35], s29 offen
    s_add_u32 s29, s28, 387840
    buffer_load_short_d16_hi v69, v3, s[32:35], s29 offen
    s_add_u32 s29, s28, 391680
    buffer_load_short_d16_hi v70, v3, s[32:35], s29 offen
    s_add_u32 s29, s28, 395520
    buffer_load_short_d16_hi v71, v3, s[32:35], s29 offen
    s_add_u32 s29, s28, 430080
    buffer_load_short_d16_hi v72, v3, s[32:35], s29 offen
    s_add_u32 s29, s28, 433920
    buffer_load_short_d16_hi v73, v3, s[32:35], s29 offen
    s_add_u32 s29, s28, 437760
    buffer_load_short_d16_hi v74, v3, s[32:35], s29 offen
    s_add_u32 s29, s28, 441600
    buffer_load_short_d16_hi v75, v3, s[32:35], s29 offen
    s_add_u32 s29, s28, 445440
    buffer_load_short_d16_hi v76, v3, s[32:35], s29 offen
    s_add_u32 s29, s28, 449280
    buffer_load_short_d16_hi v77, v3, s[32:35], s29 offen
    s_add_u32 s29, s28, 453120
    buffer_load_short_d16_hi v78, v3, s[32:35], s29 offen
    s_add_u32 s29, s28, 456960
    buffer_load_short_d16_hi v79, v3, s[32:35], s29 offen
    s_add_u32 s29, s28, 491520
    buffer_load_short_d16_hi v80, v3, s[32:35], s29 offen
    s_add_u32 s29, s28, 495360
    buffer_load_short_d16_hi v81, v3, s[32:35], s29 offen
    s_add_u32 s29, s28, 499200
    buffer_load_short_d16_hi v82, v3, s[32:35], s29 offen
    s_add_u32 s29, s28, 503040
    buffer_load_short_d16_hi v83, v3, s[32:35], s29 offen
    s_add_u32 s29, s28, 506880
    buffer_load_short_d16_hi v84, v3, s[32:35], s29 offen
    s_add_u32 s29, s28, 510720
    buffer_load_short_d16_hi v85, v3, s[32:35], s29 offen
    s_add_u32 s29, s28, 514560
    buffer_load_short_d16_hi v86, v3, s[32:35], s29 offen
    s_add_u32 s29, s28, 518400
    buffer_load_short_d16_hi v87, v3, s[32:35], s29 offen
    s_add_u32 s29, s28, 552960
    buffer_load_short_d16_hi v88, v3, s[32:35], s29 offen
    s_add_u32 s29, s28, 556800
    buffer_load_short_d16_hi v89, v3, s[32:35], s29 offen
    s_add_u32 s29, s28, 560640
    buffer_load_short_d16_hi v90, v3, s[32:35], s29 offen
    s_add_u32 s29, s28, 564480
    buffer_load_short_d16_hi v91, v3, s[32:35], s29 offen
    s_add_u32 s29, s28, 568320
    buffer_load_short_d16_hi v92, v3, s[32:35], s29 offen
    s_add_u32 s29, s28, 572160
    buffer_load_short_d16_hi v93, v3, s[32:35], s29 offen
    s_add_u32 s29, s28, 576000
    buffer_load_short_d16_hi v94, v3, s[32:35], s29 offen
    s_add_u32 s29, s28, 579840
    buffer_load_short_d16_hi v95, v3, s[32:35], s29 offen
    s_mov_b64 exec, -1
    s_waitcnt vmcnt(0)
    v_add_f32 v5, v16, v17
    v_add_f32 v5, v5, v18
    v_add_f32 v5, v5, v19
    v_add_f32 v5, v5, v20
    v_add_f32 v5, v5, v21
    v_add_f32 v5, v5, v22
    v_add_f32 v5, v5, v23
    v_add_f32 v5, v5, v24
    v_add_f32 v5, v5, v25
    v_add_f32 v5, v5, v26
    v_add_f32 v5, v5, v27
    v_add_f32 v5, v5, v28
    v_add_f32 v5, v5, v29
    v_add_f32 v5, v5, v30
    v_add_f32 v5, v5, v31
    v_add_f32 v5, v5, v32
    v_add_f32 v5, v5, v33
    v_add_f32 v5, v5, v34
    v_add_f32 v5, v5, v35
    v_add_f32 v5, v5, v36
    v_add_f32 v5, v5, v37
    v_add_f32 v5, v5, v38
    v_add_f32 v5, v5, v39
    v_add_f32 v5, v5, v40
    v_add_f32 v5, v5, v41
    v_add_f32 v5, v5, v42
    v_add_f32 v5, v5, v43
    v_add_f32 v5, v5, v44
    v_add_f32 v5, v5, v45
    v_add_f32 v5, v5, v46
    v_add_f32 v5, v5, v47
    v_add_f32 v5, v5, v48
    v_add_f32 v5, v5, v49
    v_add_f32 v5, v5, v50
    v_add_f32 v5, v5, v51
    v_add_f32 v5, v5, v52
    v_add_f32 v5, v5, v53
    v_add_f32 v5, v5, v54
    v_add_f32 v5, v5, v55
    v_add_f32 v5, v5, v56
    v_add_f32 v5, v5, v57
    v_add_f32 v5, v5, v58
    v_add_f32 v5, v5, v59
    v_add_f32 v5, v5, v60
    v_add_f32 v5, v5, v61
    v_add_f32 v5, v5, v62
    v_add_f32 v5, v5, v63
    v_add_f32 v5, v5, v64
    v_add_f32 v5, v5, v65
    v_add_f32 v5, v5, v66
    v_add_f32 v5, v5, v67
    v_add_f32 v5, v5, v68
    v_add_f32 v5, v5, v69
    v_add_f32 v5, v5, v70
    v_add_f32 v5, v5, v71
    v_add_f32 v5, v5, v72
    v_add_f32 v5, v5, v73
    v_add_f32 v5, v5, v74
    v_add_f32 v5, v5, v75
    v_add_f32 v5, v5, v76
    v_add_f32 v5, v5, v77
    v_add_f32 v5, v5, v78
    v_add_f32 v5, v5, v79
    v_add_f32 v5, v5, v80
    v_add_f32 v5, v5, v81
    v_add_f32 v5, v5, v82
    v_add_f32 v5, v5, v83
    v_add_f32 v5, v5, v84
    v_add_f32 v5, v5, v85
    v_add_f32 v5, v5, v86
    v_add_f32 v5, v5, v87
    v_add_f32 v5, v5, v88
    v_add_f32 v5, v5, v89
    v_add_f32 v5, v5, v90
    v_add_f32 v5, v5, v91
    v_add_f32 v5, v5, v92
    v_add_f32 v5, v5, v93
    v_add_f32 v5, v5, v94
    v_add_f32 v5, v5, v95
    v_mov_b32 v6, v5
    s_nop 1
    v_permlane32_swap_b32 v5, v6
    v_add_f32 v5, v5, v6
    s_lshl_b32 s29, s13, 8
    v_lshlrev_b32 v7, 2, v0
    v_add_u32 v8, s29, v7
    ds_write_b32 v8, v5
    s_waitcnt lgkmcnt(0)
    s_barrier
    ds_read_b32 v8, v7 offset:0
    ds_read_b32 v9, v7 offset:256
    ds_read_b32 v10, v7 offset:512
    ds_read_b32 v11, v7 offset:768
    s_waitcnt lgkmcnt(0)
    v_add_f32 v8, v8, v9
    v_add_f32 v10, v10, v11
    v_add_f32 v8, v8, v10
    v_mul_f32 v8, 0x3acccccd, v8
    v_sub_f32 v16, v16, v8
    v_sub_f32 v17, v17, v8
    v_sub_f32 v18, v18, v8
    v_sub_f32 v19, v19, v8
    v_sub_f32 v20, v20, v8
    v_sub_f32 v21, v21, v8
    v_sub_f32 v22, v22, v8
    v_sub_f32 v23, v23, v8
    v_sub_f32 v24, v24, v8
    v_sub_f32 v25, v25, v8
    v_sub_f32 v26, v26, v8
    v_sub_f32 v27, v27, v8
    v_sub_f32 v28, v28, v8
    v_sub_f32 v29, v29, v8
    v_sub_f32 v30, v30, v8
    v_sub_f32 v31, v31, v8
    v_sub_f32 v32, v32, v8
    v_sub_f32 v33, v33, v8
    v_sub_f32 v34, v34, v8
    v_sub_f32 v35, v35, v8
    v_sub_f32 v36, v36, v8
    v_sub_f32 v37, v37, v8
    v_sub_f32 v38, v38, v8
    v_sub_f32 v39, v39, v8
    v_sub_f32 v40, v40, v8
    v_sub_f32 v41, v41, v8
    v_sub_f32 v42, v42, v8
    v_sub_f32 v43, v43, v8
    v_sub_f32 v44, v44, v8
    v_sub_f32 v45, v45, v8
    v_sub_f32 v46, v46, v8
    v_sub_f32 v47, v47, v8
    v_sub_f32 v48, v48, v8
    v_sub_f32 v49, v49, v8
    v_sub_f32 v50, v50, v8
    v_sub_f32 v51, v51, v8
    v_sub_f32 v52, v52, v8
    v_sub_f32 v53, v53, v8
    v_sub_f32 v54, v54, v8
    v_sub_f32 v55, v55, v8
    v_sub_f32 v56, v56, v8
    v_sub_f32 v57, v57, v8
    v_sub_f32 v58, v58, v8
    v_sub_f32 v59, v59, v8
    v_sub_f32 v60, v60, v8
    v_sub_f32 v61, v61, v8
    v_sub_f32 v62, v62, v8
    v_sub_f32 v63, v63, v8
    v_sub_f32 v64, v64, v8
    v_sub_f32 v65, v65, v8
    v_sub_f32 v66, v66, v8
    v_sub_f32 v67, v67, v8
    v_sub_f32 v68, v68, v8
    v_sub_f32 v69, v69, v8
    v_sub_f32 v70, v70, v8
    v_sub_f32 v71, v71, v8
    v_sub_f32 v72, v72, v8
    v_sub_f32 v73, v73, v8
    v_sub_f32 v74, v74, v8
    v_sub_f32 v75, v75, v8
    v_sub_f32 v76, v76, v8
    v_sub_f32 v77, v77, v8
    v_sub_f32 v78, v78, v8
    v_sub_f32 v79, v79, v8
    v_sub_f32 v80, v80, v8
    v_sub_f32 v81, v81, v8
    v_sub_f32 v82, v82, v8
    v_sub_f32 v83, v83, v8
    v_sub_f32 v84, v84, v8
    v_sub_f32 v85, v85, v8
    v_sub_f32 v86, v86, v8
    v_sub_f32 v87, v87, v8
    v_sub_f32 v88, v88, v8
    v_sub_f32 v89, v89, v8
    v_sub_f32 v90, v90, v8
    v_sub_f32 v91, v91, v8
    v_sub_f32 v92, v92, v8
    v_sub_f32 v93, v93, v8
    v_sub_f32 v94, v94, v8
    v_sub_f32 v95, v95, v8
    s_mul_i32 s29, s21, 81920
    s_lshl_b32 s30, s22, 10
    s_add_u32 s29, s29, s30
    s_mul_i32 s30, s13, 20480
    s_add_u32 s29, s29, s30
    s_add_u32 s29, s29, 243269632
    v_lshlrev_b32 v7, 4, v0
    v_cvt_pk_bf16_f32 v100, v16, v17
    v_cvt_pk_bf16_f32 v101, v18, v19
    v_cvt_pk_bf16_f32 v102, v20, v21
    v_cvt_pk_bf16_f32 v103, v22, v23
    buffer_store_dwordx4 v[100:103], v7, s[8:11], s29 offen
    s_add_u32 s29, s29, 2048
    v_cvt_pk_bf16_f32 v104, v24, v25
    v_cvt_pk_bf16_f32 v105, v26, v27
    v_cvt_pk_bf16_f32 v106, v28, v29
    v_cvt_pk_bf16_f32 v107, v30, v31
    buffer_store_dwordx4 v[104:107], v7, s[8:11], s29 offen
    s_add_u32 s29, s29, 2048
    v_cvt_pk_bf16_f32 v100, v32, v33
    v_cvt_pk_bf16_f32 v101, v34, v35
    v_cvt_pk_bf16_f32 v102, v36, v37
    v_cvt_pk_bf16_f32 v103, v38, v39
    buffer_store_dwordx4 v[100:103], v7, s[8:11], s29 offen
    s_add_u32 s29, s29, 2048
    v_cvt_pk_bf16_f32 v104, v40, v41
    v_cvt_pk_bf16_f32 v105, v42, v43
    v_cvt_pk_bf16_f32 v106, v44, v45
    v_cvt_pk_bf16_f32 v107, v46, v47
    buffer_store_dwordx4 v[104:107], v7, s[8:11], s29 offen
    s_add_u32 s29, s29, 2048
    v_cvt_pk_bf16_f32 v100, v48, v49
    v_cvt_pk_bf16_f32 v101, v50, v51
    v_cvt_pk_bf16_f32 v102, v52, v53
    v_cvt_pk_bf16_f32 v103, v54, v55
    buffer_store_dwordx4 v[100:103], v7, s[8:11], s29 offen
    s_add_u32 s29, s29, 2048
    v_cvt_pk_bf16_f32 v104, v56, v57
    v_cvt_pk_bf16_f32 v105, v58, v59
    v_cvt_pk_bf16_f32 v106, v60, v61
    v_cvt_pk_bf16_f32 v107, v62, v63
    buffer_store_dwordx4 v[104:107], v7, s[8:11], s29 offen
    s_add_u32 s29, s29, 2048
    v_cvt_pk_bf16_f32 v100, v64, v65
    v_cvt_pk_bf16_f32 v101, v66, v67
    v_cvt_pk_bf16_f32 v102, v68, v69
    v_cvt_pk_bf16_f32 v103, v70, v71
    buffer_store_dwordx4 v[100:103], v7, s[8:11], s29 offen
    s_add_u32 s29, s29, 2048
    v_cvt_pk_bf16_f32 v104, v72, v73
    v_cvt_pk_bf16_f32 v105, v74, v75
    v_cvt_pk_bf16_f32 v106, v76, v77
    v_cvt_pk_bf16_f32 v107, v78, v79
    buffer_store_dwordx4 v[104:107], v7, s[8:11], s29 offen
    s_add_u32 s29, s29, 2048
    v_cvt_pk_bf16_f32 v100, v80, v81
    v_cvt_pk_bf16_f32 v101, v82, v83
    v_cvt_pk_bf16_f32 v102, v84, v85
    v_cvt_pk_bf16_f32 v103, v86, v87
    buffer_store_dwordx4 v[100:103], v7, s[8:11], s29 offen
    s_add_u32 s29, s29, 2048
    v_cvt_pk_bf16_f32 v104, v88, v89
    v_cvt_pk_bf16_f32 v105, v90, v91
    v_cvt_pk_bf16_f32 v106, v92, v93
    v_cvt_pk_bf16_f32 v107, v94, v95
    buffer_store_dwordx4 v[104:107], v7, s[8:11], s29 offen
    s_add_u32 s29, s29, 2048
    s_branch prep_kernel_end
prep_kernel_r_pwo:
    s_lshl_b32 s20, s20, 2
    s_add_u32 s20, s20, s13
    s_load_dwordx2 s[24:25], s[0:1], 16
    s_lshr_b32 s21, s20, 3
    s_and_b32 s22, s20, 7
    v_and_b32 v1, 31, v0
    v_lshrrev_b32 v2, 5, v0
    v_lshlrev_b32 v3, 1, v1
    v_mul_u32_u24 v4, 10240, v2
    v_add_u32 v3, v3, v4
    s_lshl_b32 s29, s21, 6
    s_mul_i32 s30, s22, 102400
    s_add_u32 s29, s29, s30
    s_waitcnt lgkmcnt(0)
    s_mov_b32 s32, s24
    s_mov_b32 s33, s25
    s_mov_b32 s34, 819200
    s_mov_b32 s35, 0x00020000
    s_add_u32 s30, s29, 0
    buffer_load_ushort v16, v3, s[32:35], s30 offen
    s_add_u32 s30, s29, 1280
    buffer_load_ushort v17, v3, s[32:35], s30 offen
    s_add_u32 s30, s29, 2560
    buffer_load_ushort v18, v3, s[32:35], s30 offen
    s_add_u32 s30, s29, 3840
    buffer_load_ushort v19, v3, s[32:35], s30 offen
    s_add_u32 s30, s29, 5120
    buffer_load_ushort v20, v3, s[32:35], s30 offen
    s_add_u32 s30, s29, 6400
    buffer_load_ushort v21, v3, s[32:35], s30 offen
    s_add_u32 s30, s29, 7680
    buffer_load_ushort v22, v3, s[32:35], s30 offen
    s_add_u32 s30, s29, 8960
    buffer_load_ushort v23, v3, s[32:35], s30 offen
    s_add_u32 s30, s29, 20480
    buffer_load_ushort v24, v3, s[32:35], s30 offen
    s_add_u32 s30, s29, 21760
    buffer_load_ushort v25, v3, s[32:35], s30 offen
    s_add_u32 s30, s29, 23040
    buffer_load_ushort v26, v3, s[32:35], s30 offen
    s_add_u32 s30, s29, 24320
    buffer_load_ushort v27, v3, s[32:35], s30 offen
    s_add_u32 s30, s29, 25600
    buffer_load_ushort v28, v3, s[32:35], s30 offen
    s_add_u32 s30, s29, 26880
    buffer_load_ushort v29, v3, s[32:35], s30 offen
    s_add_u32 s30, s29, 28160
    buffer_load_ushort v30, v3, s[32:35], s30 offen
    s_add_u32 s30, s29, 29440
    buffer_load_ushort v31, v3, s[32:35], s30 offen
    s_add_u32 s30, s29, 40960
    buffer_load_ushort v32, v3, s[32:35], s30 offen
    s_add_u32 s30, s29, 42240
    buffer_load_ushort v33, v3, s[32:35], s30 offen
    s_add_u32 s30, s29, 43520
    buffer_load_ushort v34, v3, s[32:35], s30 offen
    s_add_u32 s30, s29, 44800
    buffer_load_ushort v35, v3, s[32:35], s30 offen
    s_add_u32 s30, s29, 46080
    buffer_load_ushort v36, v3, s[32:35], s30 offen
    s_add_u32 s30, s29, 47360
    buffer_load_ushort v37, v3, s[32:35], s30 offen
    s_add_u32 s30, s29, 48640
    buffer_load_ushort v38, v3, s[32:35], s30 offen
    s_add_u32 s30, s29, 49920
    buffer_load_ushort v39, v3, s[32:35], s30 offen
    s_add_u32 s30, s29, 61440
    buffer_load_ushort v40, v3, s[32:35], s30 offen
    s_add_u32 s30, s29, 62720
    buffer_load_ushort v41, v3, s[32:35], s30 offen
    s_add_u32 s30, s29, 64000
    buffer_load_ushort v42, v3, s[32:35], s30 offen
    s_add_u32 s30, s29, 65280
    buffer_load_ushort v43, v3, s[32:35], s30 offen
    s_add_u32 s30, s29, 66560
    buffer_load_ushort v44, v3, s[32:35], s30 offen
    s_add_u32 s30, s29, 67840
    buffer_load_ushort v45, v3, s[32:35], s30 offen
    s_add_u32 s30, s29, 69120
    buffer_load_ushort v46, v3, s[32:35], s30 offen
    s_add_u32 s30, s29, 70400
    buffer_load_ushort v47, v3, s[32:35], s30 offen
    s_add_u32 s30, s29, 81920
    buffer_load_ushort v48, v3, s[32:35], s30 offen
    s_add_u32 s30, s29, 83200
    buffer_load_ushort v49, v3, s[32:35], s30 offen
    s_add_u32 s30, s29, 84480
    buffer_load_ushort v50, v3, s[32:35], s30 offen
    s_add_u32 s30, s29, 85760
    buffer_load_ushort v51, v3, s[32:35], s30 offen
    s_add_u32 s30, s29, 87040
    buffer_load_ushort v52, v3, s[32:35], s30 offen
    s_add_u32 s30, s29, 88320
    buffer_load_ushort v53, v3, s[32:35], s30 offen
    s_add_u32 s30, s29, 89600
    buffer_load_ushort v54, v3, s[32:35], s30 offen
    s_add_u32 s30, s29, 90880
    buffer_load_ushort v55, v3, s[32:35], s30 offen
    s_mul_i32 s29, s20, 5120
    s_add_u32 s29, s29, 246415360
    v_lshlrev_b32 v7, 4, v0
    s_waitcnt vmcnt(32)
    v_lshl_or_b32 v64, v17, 16, v16
    v_lshl_or_b32 v65, v19, 16, v18
    v_lshl_or_b32 v66, v21, 16, v20
    v_lshl_or_b32 v67, v23, 16, v22
    buffer_store_dwordx4 v[64:67], v7, s[8:11], s29 offen offset:0
    s_waitcnt vmcnt(25)
    v_lshl_or_b32 v68, v25, 16, v24
    v_lshl_or_b32 v69, v27, 16, v26
    v_lshl_or_b32 v70, v29, 16, v28
    v_lshl_or_b32 v71, v31, 16, v30
    buffer_store_dwordx4 v[68:71], v7, s[8:11], s29 offen offset:1024
    s_waitcnt vmcnt(18)
    v_lshl_or_b32 v72, v33, 16, v32
    v_lshl_or_b32 v73, v35, 16, v34
    v_lshl_or_b32 v74, v37, 16, v36
    v_lshl_or_b32 v75, v39, 16, v38
    buffer_store_dwordx4 v[72:75], v7, s[8:11], s29 offen offset:2048
    s_waitcnt vmcnt(11)
    v_lshl_or_b32 v76, v41, 16, v40
    v_lshl_or_b32 v77, v43, 16, v42
    v_lshl_or_b32 v78, v45, 16, v44
    v_lshl_or_b32 v79, v47, 16, v46
    buffer_store_dwordx4 v[76:79], v7, s[8:11], s29 offen offset:3072
    s_add_u32 s29, s29, 4096
    s_waitcnt vmcnt(4)
    v_lshl_or_b32 v80, v49, 16, v48
    v_lshl_or_b32 v81, v51, 16, v50
    v_lshl_or_b32 v82, v53, 16, v52
    v_lshl_or_b32 v83, v55, 16, v54
    buffer_store_dwordx4 v[80:83], v7, s[8:11], s29 offen offset:0
    s_branch prep_kernel_end
prep_kernel_end:
    s_endpgm
.section .rodata,"a"
.p2align 6
.amdhsa_kernel prep_kernel
  .amdhsa_next_free_vgpr 248
  .amdhsa_next_free_sgpr 64
  .amdhsa_accum_offset 248
  .amdhsa_group_segment_fixed_size 0
  .amdhsa_kernarg_size 104
  .amdhsa_user_sgpr_count 2
  .amdhsa_user_sgpr_kernarg_segment_ptr 1
  .amdhsa_system_sgpr_workgroup_id_x 1
.end_amdhsa_kernel
.text
.globl layerb2_kernel
.p2align 8
.type layerb2_kernel,@function
layerb2_kernel:
    s_mov_b32 s49, 1
    s_branch layerb1_kernel_body
    s_endpgm
.section .rodata,"a"
.p2align 6
.amdhsa_kernel layerb2_kernel
  .amdhsa_next_free_vgpr 512
  .amdhsa_next_free_sgpr 100
  .amdhsa_accum_offset 256
  .amdhsa_group_segment_fixed_size 0
  .amdhsa_kernarg_size 104
  .amdhsa_user_sgpr_count 2
  .amdhsa_user_sgpr_kernarg_segment_ptr 1
  .amdhsa_system_sgpr_workgroup_id_x 1
.end_amdhsa_kernel
.text
.globl layerb1_kernel
.p2align 8
.type layerb1_kernel,@function
layerb1_kernel:
    s_mov_b32 s49, 0
layerb1_kernel_body:
    s_cmp_ge_u32 s2, 256
    s_cbranch_scc1 layerb1_kernel_end0
    s_load_dwordx2 s[4:5], s[0:1], 96
    s_load_dwordx2 s[6:7], s[0:1], 80
    v_lshrrev_b32 v1, 6, v0
    v_and_b32 v0, 63, v0
    s_nop 0
    v_readfirstlane_b32 s13, v1
    s_mov_b32 s15, 400000
    s_waitcnt lgkmcnt(0)
    s_mov_b32 s8, s4
    s_mov_b32 s9, s5
    s_mov_b32 s10, 268435456
    s_mov_b32 s11, 0x00020000
    s_mul_i32 s48, s49, 65536
    s_add_u32 s48, s48, 10616832
    s_lshl_b32 s60, s49, 11
    s_add_u32 s60, s60, 10485760
    s_getreg_b32 s61, hwreg(HW_REG_XCC_ID)
    s_and_b32 s61, s61, 7
    s_cmp_lg_u32 s13, 0
    s_cbranch_scc1 layerb1_kernel_tk_p1
    s_lshl_b32 s63, s61, 8
    s_add_u32 s63, s63, s60
    s_mov_b64 exec, 1
    v_mov_b32 v230, 0
    v_mov_b32 v231, 1
    buffer_atomic_add v231, v230, s[8:11], s63 offen sc0 sc1
    s_mov_b64 exec, -1
layerb1_kernel_tk_p1:
    s_load_dwordx2 s[16:17], s[0:1], 0
    s_add_u32 s28, s4, 247463936
    s_addc_u32 s29, s5, 0
    s_waitcnt lgkmcnt(0)
    s_cmp_eq_u32 s49, 0
    s_cselect_b32 s16, s16, s28
    s_cselect_b32 s17, s17, s29
    s_mov_b32 s18, 2621440
    s_mov_b32 s19, 0x00020000
    s_and_b32 s28, s2, 7
    s_lshr_b32 s29, s2, 3
    s_and_b32 s30, s28, 3
    s_lshl_b32 s30, s30, 2
    s_and_b32 s31, s29, 3
    s_add_u32 s20, s30, s31
    s_lshr_b32 s30, s28, 2
    s_lshl_b32 s30, s30, 3
    s_lshr_b32 s31, s29, 2
    s_add_u32 s21, s30, s31
    s_lshr_b32 s22, s13, 1
    s_and_b32 s23, s13, 1
    s_lshl_b32 s26, s20, 1
    s_add_u32 s26, s26, s23
    s_mov_b32 s27, 0x3f803f80
    s_lshl_b32 s28, s21, 7
    s_lshl_b32 s29, s13, 5
    s_add_u32 s28, s28, s29
    s_mul_i32 s24, s28, 1280
    s_lshl_b32 s28, s20, 1
    s_add_u32 s28, s28, s22
    s_mul_i32 s25, s28, 81920
    s_lshl_b32 s29, s23, 12
    s_add_u32 s25, s25, s29
    s_add_u32 s25, s25, 243269632
    v_lshlrev_b32 v1, 4, v0
    v_lshrrev_b32 v16, 3, v0
    v_mul_u32_u24 v16, 1280, v16
    v_and_b32 v17, 7, v0
    v_lshrrev_b32 v18, 4, v0
    v_xor_b32 v19, v17, v18
    v_lshl_add_u32 v2, v19, 4, v16
    v_xor_b32 v19, 4, v19
    v_lshl_add_u32 v3, v19, 4, v16
    s_lshl_b32 s28, s13, 12
    s_mov_b32 m0, s28
    s_add_u32 s29, s24, 0
    buffer_load_dwordx4 v2, s[16:19], s29 offen offset:0 lds
    s_add_u32 s29, s29, 9216
    buffer_load_dwordx4 v3, s[16:19], s29 offen offset:1024 lds
    s_add_u32 s29, s29, 9216
    buffer_load_dwordx4 v2, s[16:19], s29 offen offset:2048 lds
    s_add_u32 s29, s29, 9216
    buffer_load_dwordx4 v3, s[16:19], s29 offen offset:3072 lds
    s_add_u32 s28, s28, 16384
    s_mov_b32 m0, s28
    s_add_u32 s29, s25, 0
    buffer_load_dwordx4 v1, s[8:11], s29 offen offset:0 lds
    buffer_load_dwordx4 v1, s[8:11], s29 offen offset:1024 lds
    buffer_load_dwordx4 v1, s[8:11], s29 offen offset:2048 lds
    buffer_load_dwordx4 v1, s[8:11], s29 offen offset:3072 lds
    s_lshl_b32 s28, s13, 12
    s_add_u32 s28, s28, 32768
    s_mov_b32 m0, s28
    s_add_u32 s29, s24, 128
    buffer_load_dwordx4 v2, s[16:19], s29 offen offset:0 lds
    s_add_u32 s29, s29, 9216
    buffer_load_dwordx4 v3, s[16:19], s29 offen offset:1024 lds
    s_add_u32 s29, s29, 9216
    buffer_load_dwordx4 v2, s[16:19], s29 offen offset:2048 lds
    s_add_u32 s29, s29, 9216
    buffer_load_dwordx4 v3, s[16:19], s29 offen offset:3072 lds
    s_add_u32 s28, s28, 16384
    s_mov_b32 m0, s28
    s_add_u32 s29, s25, 8192
    buffer_load_dwordx4 v1, s[8:11], s29 offen offset:0 lds
    buffer_load_dwordx4 v1, s[8:11], s29 offen offset:1024 lds
    buffer_load_dwordx4 v1, s[8:11], s29 offen offset:2048 lds
    buffer_load_dwordx4 v1, s[8:11], s29 offen offset:3072 lds
    s_lshl_b32 s28, s13, 12
    s_add_u32 s28, s28, 65536
    s_mov_b32 m0, s28
    s_add_u32 s29, s24, 256
    buffer_load_dwordx4 v2, s[16:19], s29 offen offset:0 lds
    s_add_u32 s29, s29, 9216
    buffer_load_dwordx4 v3, s[16:19], s29 offen offset:1024 lds
    s_add_u32 s29, s29, 9216
    buffer_load_dwordx4 v2, s[16:19], s29 offen offset:2048 lds
    s_add_u32 s29, s29, 9216
    buffer_load_dwordx4 v3, s[16:19], s29 offen offset:3072 lds
    s_add_u32 s28, s28, 16384
    s_mov_b32 m0, s28
    s_add_u32 s29, s25, 16384
    buffer_load_dwordx4 v1, s[8:11], s29 offen offset:0 lds
    buffer_load_dwordx4 v1, s[8:11], s29 offen offset:1024 lds
    buffer_load_dwordx4 v1, s[8:11], s29 offen offset:2048 lds
    buffer_load_dwordx4 v1, s[8:11], s29 offen offset:3072 lds
    s_cmp_lg_u32 s13, 0
    s_cbranch_scc1 layerb1_kernel_tk_wait
    s_waitcnt vmcnt(24)
    s_nop 0
    v_readfirstlane_b32 s62, v231
    s_cmp_lt_u32 s62, 32
    s_cbranch_scc1 layerb1_kernel_tk_pub
    v_lshlrev_b32 v230, 8, v0
    v_and_b32 v230, 0x7ff, v230
    s_mov_b32 s63, s60
layerb1_kernel_tk_poll:
    buffer_load_dword v231, v230, s[8:11], s63 offen sc1
    s_waitcnt vmcnt(0)
    s_mov_b32 s64, 0
    v_readlane_b32 s65, v231, 0
    s_nop 0
    s_add_u32 s64, s64, s65
    v_readlane_b32 s66, v231, 1
    s_nop 0
    s_add_u32 s64, s64, s66
    v_readlane_b32 s67, v231, 2
    s_nop 0
    s_add_u32 s64, s64, s67
    v_readlane_b32 s68, v231, 3
    s_nop 0
    s_add_u32 s64, s64, s68
    v_readlane_b32 s69, v231, 4
    s_nop 0
    s_add_u32 s64, s64, s69
    v_readlane_b32 s70, v231, 5
    s_nop 0
    s_add_u32 s64, s64, s70
    v_readlane_b32 s71, v231, 6
    s_nop 0
    s_add_u32 s64, s64, s71
    v_readlane_b32 s72, v231, 7
    s_nop 0
    s_add_u32 s64, s64, s72
    s_sub_u32 s15, s15, 1
    s_cbranch_scc1 layerb1_kernel_bail
    s_cmp_lt_u32 s64, 256
    s_cbranch_scc1 layerb1_kernel_tk_poll
    s_sub_u32 s62, s62, 32
    s_max_u32 s64, s65, 32
    s_sub_u32 s64, s64, 32
    s_cmp_gt_u32 s61, 0
    s_cselect_b32 s64, s64, 0
    s_add_u32 s62, s62, s64
    s_max_u32 s64, s66, 32
    s_sub_u32 s64, s64, 32
    s_cmp_gt_u32 s61, 1
    s_cselect_b32 s64, s64, 0
    s_add_u32 s62, s62, s64
    s_max_u32 s64, s67, 32
    s_sub_u32 s64, s64, 32
    s_cmp_gt_u32 s61, 2
    s_cselect_b32 s64, s64, 0
    s_add_u32 s62, s62, s64
    s_max_u32 s64, s68, 32
    s_sub_u32 s64, s64, 32
    s_cmp_gt_u32 s61, 3
    s_cselect_b32 s64, s64, 0
    s_add_u32 s62, s62, s64
    s_max_u32 s64, s69, 32
    s_sub_u32 s64, s64, 32
    s_cmp_gt_u32 s61, 4
    s_cselect_b32 s64, s64, 0
    s_add_u32 s62, s62, s64
    s_max_u32 s64, s70, 32
    s_sub_u32 s64, s64, 32
    s_cmp_gt_u32 s61, 5
    s_cselect_b32 s64, s64, 0
    s_add_u32 s62, s62, s64
    s_max_u32 s64, s71, 32
    s_sub_u32 s64, s64, 32
    s_cmp_gt_u32 s61, 6
    s_cselect_b32 s64, s64, 0
    s_add_u32 s62, s62, s64
    s_min_u32 s64, s65, 32
    s_sub_u32 s63, 32, s64
    s_cmp_lt_u32 s62, s63
    s_cbranch_scc0 layerb1_kernel_tk_n0
    s_mov_b32 s61, 0
    s_add_u32 s62, s62, s64
    s_branch layerb1_kernel_tk_pub
layerb1_kernel_tk_n0:
    s_sub_u32 s62, s62, s63
    s_min_u32 s64, s66, 32
    s_sub_u32 s63, 32, s64
    s_cmp_lt_u32 s62, s63
    s_cbranch_scc0 layerb1_kernel_tk_n1
    s_mov_b32 s61, 1
    s_add_u32 s62, s62, s64
    s_branch layerb1_kernel_tk_pub
layerb1_kernel_tk_n1:
    s_sub_u32 s62, s62, s63
    s_min_u32 s64, s67, 32
    s_sub_u32 s63, 32, s64
    s_cmp_lt_u32 s62, s63
    s_cbranch_scc0 layerb1_kernel_tk_n2
    s_mov_b32 s61, 2
    s_add_u32 s62, s62, s64
    s_branch layerb1_kernel_tk_pub
layerb1_kernel_tk_n2:
    s_sub_u32 s62, s62, s63
    s_min_u32 s64, s68, 32
    s_sub_u32 s63, 32, s64
    s_cmp_lt_u32 s62, s63
    s_cbranch_scc0 layerb1_kernel_tk_n3
    s_mov_b32 s61, 3
    s_add_u32 s62, s62, s64
    s_branch layerb1_kernel_tk_pub
layerb1_kernel_tk_n3:
    s_sub_u32 s62, s62, s63
    s_min_u32 s64, s69, 32
    s_sub_u32 s63, 32, s64
    s_cmp_lt_u32 s62, s63
    s_cbranch_scc0 layerb1_kernel_tk_n4
    s_mov_b32 s61, 4
    s_add_u32 s62, s62, s64
    s_branch layerb1_kernel_tk_pub
layerb1_kernel_tk_n4:
    s_sub_u32 s62, s62, s63
    s_min_u32 s64, s70, 32
    s_sub_u32 s63, 32, s64
    s_cmp_lt_u32 s62, s63
    s_cbranch_scc0 layerb1_kernel_tk_n5
    s_mov_b32 s61, 5
    s_add_u32 s62, s62, s64
    s_branch layerb1_kernel_tk_pub
layerb1_kernel_tk_n5:
    s_sub_u32 s62, s62, s63
    s_min_u32 s64, s71, 32
    s_sub_u32 s63, 32, s64
    s_cmp_lt_u32 s62, s63
    s_cbranch_scc0 layerb1_kernel_tk_n6
    s_mov_b32 s61, 6
    s_add_u32 s62, s62, s64
    s_branch layerb1_kernel_tk_pub
layerb1_kernel_tk_n6:
    s_sub_u32 s62, s62, s63
    s_min_u32 s64, s72, 32
    s_sub_u32 s63, 32, s64
    s_cmp_lt_u32 s62, s63
    s_cbranch_scc0 layerb1_kernel_tk_n7
    s_mov_b32 s61, 7
    s_add_u32 s62, s62, s64
    s_branch layerb1_kernel_tk_pub
layerb1_kernel_tk_n7:
    s_sub_u32 s62, s62, s63
    s_branch layerb1_kernel_bail
layerb1_kernel_tk_pub:
    s_lshl_b32 s63, s61, 8
    s_or_b32 s63, s63, s62
    v_mov_b32 v230, 131136
    v_mov_b32 v231, s63
    ds_write_b32 v230, v231
    s_waitcnt lgkmcnt(0)
layerb1_kernel_tk_wait:
    s_barrier
    v_mov_b32 v230, 131136
    ds_read_b32 v231, v230
    s_waitcnt lgkmcnt(0)
    v_readfirstlane_b32 s63, v231
    s_lshr_b32 s61, s63, 8
    s_and_b32 s62, s63, 255
    s_mov_b32 s98, s61
    s_mov_b32 s99, s62
    v_lshlrev_b32 v240, 4, v0
    v_mov_b32 v241, v240
    s_mov_b32 s50, 0x3020100
    s_mov_b32 s51, 0x7060504
    s_mov_b32 s52, 0xb0a0908
    s_mov_b32 s53, 0xf0e0d0c
    s_mov_b32 s54, 0x13121110
    s_mov_b32 s55, 0x17161514
    s_mov_b32 s56, 0x1b1a1918
    s_mov_b32 s57, 0x1f1e1d1c
    s_mov_b32 s40, 2048
    s_cmp_eq_u32 s98, 0
    s_cbranch_scc1 layerb1_kernel_pf_p
    s_cmp_ge_u32 s98, 4
    s_cbranch_scc1 layerb1_kernel_pf_g
    s_sub_u32 s60, s98, 1
    s_cmp_ge_u32 s99, 27
    s_cbranch_scc1 layerb1_kernel_pf_sp
    s_mul_i32 s61, s60, 27
    s_add_u32 s61, s61, s99
    s_cmp_ge_u32 s61, 80
    s_cbranch_scc1 layerb1_kernel_pf_no
    s_mul_i32 s61, s61, 327680
    s_mul_i32 s62, s13, 81920
    s_add_u32 s61, s61, s62
    s_add_u32 s58, s61, 27262976
    s_add_u32 s59, s58, 1024
    s_branch layerb1_kernel_pf_done
layerb1_kernel_pf_sp:
    s_mul_i32 s61, s60, 5
    s_add_u32 s61, s61, s99
    s_sub_u32 s61, s61, 27
    s_cmp_lt_u32 s61, 5
    s_cbranch_scc0 layerb1_kernel_pf_no
    s_lshl_b32 s61, s61, 2
    s_add_u32 s61, s61, s13
    s_mul_i32 s61, s61, 40960
    s_add_u32 s58, s61, 246415360
    s_add_u32 s59, s58, 1024
    s_branch layerb1_kernel_pf_done
layerb1_kernel_pf_no:
    s_mov_b32 s58, 27262976
    s_mov_b32 s59, 27262976
    s_mov_b32 s40, 0
    s_branch layerb1_kernel_pf_done
layerb1_kernel_pf_p:
    s_mul_i32 s61, s99, 491520
    s_mul_i32 s62, s13, 122880
    s_add_u32 s61, s61, s62
    s_add_u32 s58, s61, 11534336
    s_add_u32 s59, s58, 1024
    s_cmp_lg_u32 s13, 0
    s_cbranch_scc1 layerb1_kernel_pf_pw0
    s_mov_b32 s50, 0xb140a00
    s_mov_b32 s51, 0x1e160215
    s_mov_b32 s52, 0x605041f
    s_mov_b32 s53, 0xf0d0908
    s_mov_b32 s54, 0x17131110
    s_mov_b32 s55, 0x1c1b1a18
    s_mov_b32 s56, 0x25232221
    s_mov_b32 s57, 0x2c2b2726
    s_branch layerb1_kernel_pf_done
layerb1_kernel_pf_pw0:
    s_cmp_lg_u32 s13, 1
    s_cbranch_scc1 layerb1_kernel_pf_pw1
    s_mov_b32 s50, 0xe170d03
    s_mov_b32 s51, 0x21190518
    s_mov_b32 s52, 0x6020122
    s_mov_b32 s53, 0xc0a0908
    s_mov_b32 s54, 0x14131110
    s_mov_b32 s55, 0x1c1b1a15
    s_mov_b32 s56, 0x25201f1e
    s_mov_b32 s57, 0x29282726
    s_branch layerb1_kernel_pf_done
layerb1_kernel_pf_pw1:
    s_cmp_lg_u32 s13, 2
    s_cbranch_scc1 layerb1_kernel_pf_pw2
    s_mov_b32 s50, 0x111a1006
    s_mov_b32 s51, 0x2f2e241b
    s_mov_b32 s52, 0x3020138
    s_mov_b32 s53, 0xb090805
    s_mov_b32 s54, 0x120f0d0c
    s_mov_b32 s55, 0x17161513
    s_mov_b32 s56, 0x1f1d1c19
    s_mov_b32 s57, 0x26232120
    s_branch layerb1_kernel_pf_done
layerb1_kernel_pf_pw2:
    s_mov_b32 s50, 0x131c1208
    s_mov_b32 s51, 0x3130261d
    s_mov_b32 s52, 0x302013a
    s_mov_b32 s53, 0xb070605
    s_mov_b32 s54, 0x100f0d0c
    s_mov_b32 s55, 0x17161511
    s_mov_b32 s56, 0x1f1b1a19
    s_mov_b32 s57, 0x24232120
    s_branch layerb1_kernel_pf_done
layerb1_kernel_pf_g:
    s_sub_u32 s60, s98, 4
    s_lshl_b32 s60, s60, 5
    s_add_u32 s60, s60, s99
    s_mov_b32 s40, 512
    v_and_b32 v230, 31, v0
    v_lshrrev_b32 v231, 5, v0
    s_cmp_ge_u32 s60, 80
    s_cbranch_scc1 layerb1_kernel_pf_qk
    v_lshrrev_b32 v232, 3, v230
    v_and_b32 v233, 7, v230
    v_mul_u32_u24 v234, 20480, v232
    v_lshl_add_u32 v234, v233, 4, v234
    v_lshl_add_u32 v240, v231, 8, v234
    s_mul_i32 s61, s60, 327680
    s_mul_i32 s62, s13, 81920
    s_add_u32 s61, s61, s62
    s_add_u32 s58, s61, 27262976
    v_mov_b32 v241, v240
    s_add_u32 s59, s58, 128
    s_branch layerb1_kernel_pf_done
layerb1_kernel_pf_qk:
    s_sub_u32 s61, s60, 80
    s_cmp_ge_u32 s61, 24
    s_cselect_b32 s62, 1, 0
    s_cselect_b32 s63, 24, 0
    s_sub_u32 s61, s61, s63
    s_lshl_b32 s61, s61, 3
    s_lshl_b32 s63, s13, 1
    s_add_u32 s61, s61, s63
    s_add_u32 s63, s61, 0
    s_mul_i32 s64, s63, 171
    s_lshr_b32 s64, s64, 10
    s_mul_i32 s65, s64, 6
    s_sub_u32 s65, s63, s65
    s_lshl_b32 s65, s65, 5
    v_add_u32 v232, s65, v230
    v_and_b32 v233, 0xc1, v232
    v_and_b32 v234, 8, v232
    v_lshl_or_b32 v233, v234, 2, v233
    v_and_b32 v234, 32, v232
    v_lshrrev_b32 v234, 1, v234
    v_or_b32 v233, v233, v234
    v_and_b32 v234, 2, v232
    v_lshl_or_b32 v233, v234, 2, v233
    v_and_b32 v234, 16, v232
    v_lshrrev_b32 v234, 2, v234
    v_or_b32 v233, v233, v234
    v_and_b32 v234, 4, v232
    v_lshrrev_b32 v234, 1, v234
    v_or_b32 v233, v233, v234
    s_cmp_eq_u32 s62, 1
    s_cselect_b64 vcc, -1, 0
    s_nop 1
    v_cndmask_b32 v232, v232, v233, vcc
    v_lshrrev_b32 v234, 4, v232
    v_and_b32 v235, 3, v234
    v_mul_u32_u24 v235, 6, v235
    v_lshrrev_b32 v234, 2, v234
    v_add_u32 v234, v234, v235
    v_mul_u32_u24 v234, 20480, v234
    v_and_b32 v235, 15, v232
    v_lshl_add_u32 v233, v235, 4, v234
    v_lshl_add_u32 v240, v231, 8, v233
    s_xor_b32 s65, s62, 1
    s_mul_i32 s65, s65, 61440
    s_mul_i32 s66, s64, 491520
    s_add_u32 s65, s65, s66
    s_add_u32 s58, s65, 11534336
    s_add_u32 s63, s61, 1
    s_mul_i32 s64, s63, 171
    s_lshr_b32 s64, s64, 10
    s_mul_i32 s65, s64, 6
    s_sub_u32 s65, s63, s65
    s_lshl_b32 s65, s65, 5
    v_add_u32 v232, s65, v230
    v_and_b32 v233, 0xc1, v232
    v_and_b32 v234, 8, v232
    v_lshl_or_b32 v233, v234, 2, v233
    v_and_b32 v234, 32, v232
    v_lshrrev_b32 v234, 1, v234
    v_or_b32 v233, v233, v234
    v_and_b32 v234, 2, v232
    v_lshl_or_b32 v233, v234, 2, v233
    v_and_b32 v234, 16, v232
    v_lshrrev_b32 v234, 2, v234
    v_or_b32 v233, v233, v234
    v_and_b32 v234, 4, v232
    v_lshrrev_b32 v234, 1, v234
    v_or_b32 v233, v233, v234
    s_cmp_eq_u32 s62, 1
    s_cselect_b64 vcc, -1, 0
    s_nop 1
    v_cndmask_b32 v232, v232, v233, vcc
    v_lshrrev_b32 v234, 4, v232
    v_and_b32 v235, 3, v234
    v_mul_u32_u24 v235, 6, v235
    v_lshrrev_b32 v234, 2, v234
    v_add_u32 v234, v234, v235
    v_mul_u32_u24 v234, 20480, v234
    v_and_b32 v235, 15, v232
    v_lshl_add_u32 v233, v235, 4, v234
    v_lshl_add_u32 v241, v231, 8, v233
    s_xor_b32 s65, s62, 1
    s_mul_i32 s65, s65, 61440
    s_mul_i32 s66, s64, 491520
    s_add_u32 s65, s65, s66
    s_add_u32 s59, s65, 11534336
layerb1_kernel_pf_done:
    s_bfe_u32 s41, s50, 524288
    s_mul_i32 s41, s41, s40
    s_add_u32 s42, s58, s41
    s_add_u32 s43, s59, s41
    buffer_load_dwordx4 a[0:3], v240, s[8:11], s42 offen
    buffer_load_dwordx4 a[4:7], v241, s[8:11], s43 offen
    s_bfe_u32 s41, s50, 524296
    s_mul_i32 s41, s41, s40
    s_add_u32 s42, s58, s41
    s_add_u32 s43, s59, s41
    buffer_load_dwordx4 a[8:11], v240, s[8:11], s42 offen
    buffer_load_dwordx4 a[12:15], v241, s[8:11], s43 offen
    s_bfe_u32 s41, s50, 524304
    s_mul_i32 s41, s41, s40
    s_add_u32 s42, s58, s41
    s_add_u32 s43, s59, s41
    buffer_load_dwordx4 a[16:19], v240, s[8:11], s42 offen
    buffer_load_dwordx4 a[20:23], v241, s[8:11], s43 offen
    s_bfe_u32 s41, s50, 524312
    s_mul_i32 s41, s41, s40
    s_add_u32 s42, s58, s41
    s_add_u32 s43, s59, s41
    buffer_load_dwordx4 a[24:27], v240, s[8:11], s42 offen
    buffer_load_dwordx4 a[28:31], v241, s[8:11], s43 offen
    s_bfe_u32 s41, s51, 524288
    s_mul_i32 s41, s41, s40
    s_add_u32 s42, s58, s41
    s_add_u32 s43, s59, s41
    buffer_load_dwordx4 a[32:35], v240, s[8:11], s42 offen
    buffer_load_dwordx4 a[36:39], v241, s[8:11], s43 offen
    s_bfe_u32 s41, s51, 524296
    s_mul_i32 s41, s41, s40
    s_add_u32 s42, s58, s41
    s_add_u32 s43, s59, s41
    buffer_load_dwordx4 a[40:43], v240, s[8:11], s42 offen
    buffer_load_dwordx4 a[44:47], v241, s[8:11], s43 offen
    s_bfe_u32 s41, s51, 524304
    s_mul_i32 s41, s41, s40
    s_add_u32 s42, s58, s41
    s_add_u32 s43, s59, s41
    buffer_load_dwordx4 a[48:51], v240, s[8:11], s42 offen
    buffer_load_dwordx4 a[52:55], v241, s[8:11], s43 offen
    v_and_b32 v16, 31, v0
    v_lshrrev_b32 v17, 5, v0
    v_lshrrev_b32 v18, 1, v16
    v_and_b32 v18, 7, v18
    v_xor_b32 v18, v18, v17
    v_lshlrev_b32 v18, 4, v18
    v_lshl_add_u32 v18, v16, 7, v18
    s_lshl_b32 s28, s22, 13
    v_add_u32 v18, s28, v18
    v_xor_b32 v6, 0, v18
    v_add_u32 v10, 65536, v6
    v_xor_b32 v7, 32, v18
    v_add_u32 v11, 65536, v7
    v_xor_b32 v8, 64, v18
    v_add_u32 v12, 65536, v8
    v_xor_b32 v9, 96, v18
    v_add_u32 v13, 65536, v9
    s_lshl_b32 s28, s23, 13
    s_add_u32 s28, s28, 16384
    v_add_u32 v4, s28, v1
    v_add_u32 v5, 65536, v4
    v_mov_b32 v20, 0
    v_mov_b32 v21, 0
    v_mov_b32 v22, 0
    v_mov_b32 v23, 0
    s_waitcnt vmcnt(30)
    s_barrier
    ds_read_b128 v[32:35], v6 offset:0
    ds_read_b128 v[36:39], v6 offset:4096
    ds_read_b128 v[40:43], v4 offset:0
    ds_read_b128 v[44:47], v4 offset:1024
    s_cmp_eq_u32 s23, 1
    s_cbranch_scc1 layerb1_kernel_af_h1
    s_waitcnt lgkmcnt(0)
    v_mfma_f32_32x32x16_bf16 v[64:79], v[32:35], v[40:43], 0
    v_dot2c_f32_bf16 v20, s27, v32
    v_dot2c_f32_bf16 v22, v32, v32
    v_mfma_f32_32x32x16_bf16 v[96:111], v[32:35], v[44:47], 0
    ds_read_b128 v[48:51], v7 offset:0
    v_dot2c_f32_bf16 v21, s27, v33
    v_mfma_f32_32x32x16_bf16 v[128:143], v[44:47], v[32:35], 0
    ds_read_b128 v[52:55], v7 offset:4096
    v_dot2c_f32_bf16 v23, v33, v33
    v_mfma_f32_32x32x16_bf16 v[80:95], v[36:39], v[40:43], 0
    ds_read_b128 v[56:59], v4 offset:2048
    v_dot2c_f32_bf16 v20, s27, v34
    v_dot2c_f32_bf16 v22, v34, v34
    v_mfma_f32_32x32x16_bf16 v[112:127], v[36:39], v[44:47], 0
    ds_read_b128 v[60:63], v4 offset:3072
    v_dot2c_f32_bf16 v21, s27, v35
    v_mfma_f32_32x32x16_bf16 v[144:159], v[44:47], v[36:39], 0
    v_dot2c_f32_bf16 v23, v35, v35
    s_waitcnt lgkmcnt(0)
    v_mfma_f32_32x32x16_bf16 v[64:79], v[48:51], v[56:59], v[64:79]
    v_dot2c_f32_bf16 v20, s27, v48
    v_dot2c_f32_bf16 v22, v48, v48
    v_mfma_f32_32x32x16_bf16 v[96:111], v[48:51], v[60:63], v[96:111]
    ds_read_b128 v[32:35], v8 offset:0
    v_dot2c_f32_bf16 v21, s27, v49
    v_mfma_f32_32x32x16_bf16 v[128:143], v[60:63], v[48:51], v[128:143]
    ds_read_b128 v[36:39], v8 offset:4096
    v_dot2c_f32_bf16 v23, v49, v49
    v_mfma_f32_32x32x16_bf16 v[80:95], v[52:55], v[56:59], v[80:95]
    ds_read_b128 v[40:43], v4 offset:4096
    v_dot2c_f32_bf16 v20, s27, v50
    v_dot2c_f32_bf16 v22, v50, v50
    v_mfma_f32_32x32x16_bf16 v[112:127], v[52:55], v[60:63], v[112:127]
    ds_read_b128 v[44:47], v4 offset:5120
    v_dot2c_f32_bf16 v21, s27, v51
    v_mfma_f32_32x32x16_bf16 v[144:159], v[60:63], v[52:55], v[144:159]
    v_dot2c_f32_bf16 v23, v51, v51
    s_waitcnt lgkmcnt(0)
    v_mfma_f32_32x32x16_bf16 v[64:79], v[32:35], v[40:43], v[64:79]
    v_dot2c_f32_bf16 v20, s27, v32
    v_dot2c_f32_bf16 v22, v32, v32
    v_mfma_f32_32x32x16_bf16 v[96:111], v[32:35], v[44:47], v[96:111]
    ds_read_b128 v[48:51], v9 offset:0
    v_dot2c_f32_bf16 v21, s27, v33
    v_mfma_f32_32x32x16_bf16 v[128:143], v[44:47], v[32:35], v[128:143]
    ds_read_b128 v[52:55], v9 offset:4096
    v_dot2c_f32_bf16 v23, v33, v33
    v_mfma_f32_32x32x16_bf16 v[80:95], v[36:39], v[40:43], v[80:95]
    ds_read_b128 v[56:59], v4 offset:6144
    v_dot2c_f32_bf16 v20, s27, v34
    v_dot2c_f32_bf16 v22, v34, v34
    v_mfma_f32_32x32x16_bf16 v[112:127], v[36:39], v[44:47], v[112:127]
    ds_read_b128 v[60:63], v4 offset:7168
    v_dot2c_f32_bf16 v21, s27, v35
    v_mfma_f32_32x32x16_bf16 v[144:159], v[44:47], v[36:39], v[144:159]
    v_dot2c_f32_bf16 v23, v35, v35
    s_waitcnt vmcnt(22)
    s_barrier
    s_waitcnt lgkmcnt(0)
    v_mfma_f32_32x32x16_bf16 v[64:79], v[48:51], v[56:59], v[64:79]
    v_dot2c_f32_bf16 v20, s27, v48
    v_dot2c_f32_bf16 v22, v48, v48
    s_lshl_b32 s28, s13, 12
    s_add_u32 s28, s28, 98304
    s_mov_b32 m0, s28
    s_add_u32 s29, s24, 384
    buffer_load_dwordx4 v2, s[16:19], s29 offen offset:0 lds
    v_mfma_f32_32x32x16_bf16 v[96:111], v[48:51], v[60:63], v[96:111]
    ds_read_b128 v[32:35], v6 offset:32768
    v_dot2c_f32_bf16 v21, s27, v49
    s_add_u32 s29, s29, 9216
    buffer_load_dwordx4 v3, s[16:19], s29 offen offset:1024 lds
    v_mfma_f32_32x32x16_bf16 v[128:143], v[60:63], v[48:51], v[128:143]
    ds_read_b128 v[36:39], v6 offset:36864
    v_dot2c_f32_bf16 v23, v49, v49
    s_add_u32 s29, s29, 9216
    buffer_load_dwordx4 v2, s[16:19], s29 offen offset:2048 lds
    v_mfma_f32_32x32x16_bf16 v[80:95], v[52:55], v[56:59], v[80:95]
    ds_read_b128 v[40:43], v4 offset:32768
    v_dot2c_f32_bf16 v20, s27, v50
    v_dot2c_f32_bf16 v22, v50, v50
    s_add_u32 s29, s29, 9216
    buffer_load_dwordx4 v3, s[16:19], s29 offen offset:3072 lds
    v_mfma_f32_32x32x16_bf16 v[112:127], v[52:55], v[60:63], v[112:127]
    ds_read_b128 v[44:47], v4 offset:33792
    v_dot2c_f32_bf16 v21, s27, v51
    s_add_u32 s28, s28, 16384
    s_mov_b32 m0, s28
    s_add_u32 s29, s25, 24576
    buffer_load_dwordx4 v1, s[8:11], s29 offen offset:0 lds
    v_mfma_f32_32x32x16_bf16 v[144:159], v[60:63], v[52:55], v[144:159]
    v_dot2c_f32_bf16 v23, v51, v51
    buffer_load_dwordx4 v1, s[8:11], s29 offen offset:1024 lds
    s_waitcnt lgkmcnt(0)
    v_mfma_f32_32x32x16_bf16 v[64:79], v[32:35], v[40:43], v[64:79]
    v_dot2c_f32_bf16 v20, s27, v32
    v_dot2c_f32_bf16 v22, v32, v32
    buffer_load_dwordx4 v1, s[8:11], s29 offen offset:2048 lds
    v_mfma_f32_32x32x16_bf16 v[96:111], v[32:35], v[44:47], v[96:111]
    ds_read_b128 v[48:51], v7 offset:32768
    v_dot2c_f32_bf16 v21, s27, v33
    buffer_load_dwordx4 v1, s[8:11], s29 offen offset:3072 lds
    v_mfma_f32_32x32x16_bf16 v[128:143], v[44:47], v[32:35], v[128:143]
    ds_read_b128 v[52:55], v7 offset:36864
    v_dot2c_f32_bf16 v23, v33, v33
    s_bfe_u32 s41, s51, 524312
    s_mul_i32 s41, s41, s40
    s_add_u32 s42, s58, s41
    s_add_u32 s43, s59, s41
    buffer_load_dwordx4 a[56:59], v240, s[8:11], s42 offen
    v_mfma_f32_32x32x16_bf16 v[80:95], v[36:39], v[40:43], v[80:95]
    ds_read_b128 v[56:59], v4 offset:34816
    v_dot2c_f32_bf16 v20, s27, v34
    v_dot2c_f32_bf16 v22, v34, v34
    buffer_load_dwordx4 a[60:63], v241, s[8:11], s43 offen
    v_mfma_f32_32x32x16_bf16 v[112:127], v[36:39], v[44:47], v[112:127]
    ds_read_b128 v[60:63], v4 offset:35840
    v_dot2c_f32_bf16 v21, s27, v35
    s_bfe_u32 s41, s52, 524288
    s_mul_i32 s41, s41, s40
    s_add_u32 s42, s58, s41
    s_add_u32 s43, s59, s41
    buffer_load_dwordx4 a[64:67], v240, s[8:11], s42 offen
    v_mfma_f32_32x32x16_bf16 v[144:159], v[44:47], v[36:39], v[144:159]
    v_dot2c_f32_bf16 v23, v35, v35
    buffer_load_dwordx4 a[68:71], v241, s[8:11], s43 offen
    s_waitcnt lgkmcnt(0)
    v_mfma_f32_32x32x16_bf16 v[64:79], v[48:51], v[56:59], v[64:79]
    v_dot2c_f32_bf16 v20, s27, v48
    v_dot2c_f32_bf16 v22, v48, v48
    v_mfma_f32_32x32x16_bf16 v[96:111], v[48:51], v[60:63], v[96:111]
    ds_read_b128 v[32:35], v8 offset:32768
    v_dot2c_f32_bf16 v21, s27, v49
    v_mfma_f32_32x32x16_bf16 v[128:143], v[60:63], v[48:51], v[128:143]
    ds_read_b128 v[36:39], v8 offset:36864
    v_dot2c_f32_bf16 v23, v49, v49
    v_mfma_f32_32x32x16_bf16 v[80:95], v[52:55], v[56:59], v[80:95]
    ds_read_b128 v[40:43], v4 offset:36864
    v_dot2c_f32_bf16 v20, s27, v50
    v_dot2c_f32_bf16 v22, v50, v50
    v_mfma_f32_32x32x16_bf16 v[112:127], v[52:55], v[60:63], v[112:127]
    ds_read_b128 v[44:47], v4 offset:37888
    v_dot2c_f32_bf16 v21, s27, v51
    v_mfma_f32_32x32x16_bf16 v[144:159], v[60:63], v[52:55], v[144:159]
    v_dot2c_f32_bf16 v23, v51, v51
    s_waitcnt lgkmcnt(0)
    v_mfma_f32_32x32x16_bf16 v[64:79], v[32:35], v[40:43], v[64:79]
    v_dot2c_f32_bf16 v20, s27, v32
    v_dot2c_f32_bf16 v22, v32, v32
    v_mfma_f32_32x32x16_bf16 v[96:111], v[32:35], v[44:47], v[96:111]
    ds_read_b128 v[48:51], v9 offset:32768
    v_dot2c_f32_bf16 v21, s27, v33
    v_mfma_f32_32x32x16_bf16 v[128:143], v[44:47], v[32:35], v[128:143]
    ds_read_b128 v[52:55], v9 offset:36864
    v_dot2c_f32_bf16 v23, v33, v33
    v_mfma_f32_32x32x16_bf16 v[80:95], v[36:39], v[40:43], v[80:95]
    ds_read_b128 v[56:59], v4 offset:38912
    v_dot2c_f32_bf16 v20, s27, v34
    v_dot2c_f32_bf16 v22, v34, v34
    v_mfma_f32_32x32x16_bf16 v[112:127], v[36:39], v[44:47], v[112:127]
    ds_read_b128 v[60:63], v4 offset:39936
    v_dot2c_f32_bf16 v21, s27, v35
    v_mfma_f32_32x32x16_bf16 v[144:159], v[44:47], v[36:39], v[144:159]
    v_dot2c_f32_bf16 v23, v35, v35
    s_waitcnt vmcnt(26)
    s_barrier
    s_waitcnt lgkmcnt(0)
    v_mfma_f32_32x32x16_bf16 v[64:79], v[48:51], v[56:59], v[64:79]
    v_dot2c_f32_bf16 v20, s27, v48
    v_dot2c_f32_bf16 v22, v48, v48
    s_lshl_b32 s28, s13, 12
    s_mov_b32 m0, s28
    s_add_u32 s29, s24, 512
    buffer_load_dwordx4 v2, s[16:19], s29 offen offset:0 lds
    v_mfma_f32_32x32x16_bf16 v[96:111], v[48:51], v[60:63], v[96:111]
    ds_read_b128 v[32:35], v10 offset:0
    v_dot2c_f32_bf16 v21, s27, v49
    s_add_u32 s29, s29, 9216
    buffer_load_dwordx4 v3, s[16:19], s29 offen offset:1024 lds
    v_mfma_f32_32x32x16_bf16 v[128:143], v[60:63], v[48:51], v[128:143]
    ds_read_b128 v[36:39], v10 offset:4096
    v_dot2c_f32_bf16 v23, v49, v49
    s_add_u32 s29, s29, 9216
    buffer_load_dwordx4 v2, s[16:19], s29 offen offset:2048 lds
    v_mfma_f32_32x32x16_bf16 v[80:95], v[52:55], v[56:59], v[80:95]
    ds_read_b128 v[40:43], v5 offset:0
    v_dot2c_f32_bf16 v20, s27, v50
    v_dot2c_f32_bf16 v22, v50, v50
    s_add_u32 s29, s29, 9216
    buffer_load_dwordx4 v3, s[16:19], s29 offen offset:3072 lds
    v_mfma_f32_32x32x16_bf16 v[112:127], v[52:55], v[60:63], v[112:127]
    ds_read_b128 v[44:47], v5 offset:1024
    v_dot2c_f32_bf16 v21, s27, v51
    s_add_u32 s28, s28, 16384
    s_mov_b32 m0, s28
    s_add_u32 s29, s25, 32768
    buffer_load_dwordx4 v1, s[8:11], s29 offen offset:0 lds
    v_mfma_f32_32x32x16_bf16 v[144:159], v[60:63], v[52:55], v[144:159]
    v_dot2c_f32_bf16 v23, v51, v51
    buffer_load_dwordx4 v1, s[8:11], s29 offen offset:1024 lds
    s_waitcnt lgkmcnt(0)
    v_mfma_f32_32x32x16_bf16 v[64:79], v[32:35], v[40:43], v[64:79]
    v_dot2c_f32_bf16 v20, s27, v32
    v_dot2c_f32_bf16 v22, v32, v32
    buffer_load_dwordx4 v1, s[8:11], s29 offen offset:2048 lds
    v_mfma_f32_32x32x16_bf16 v[96:111], v[32:35], v[44:47], v[96:111]
    ds_read_b128 v[48:51], v11 offset:0
    v_dot2c_f32_bf16 v21, s27, v33
    buffer_load_dwordx4 v1, s[8:11], s29 offen offset:3072 lds
    v_mfma_f32_32x32x16_bf16 v[128:143], v[44:47], v[32:35], v[128:143]
    ds_read_b128 v[52:55], v11 offset:4096
    v_dot2c_f32_bf16 v23, v33, v33
    s_bfe_u32 s41, s52, 524296
    s_mul_i32 s41, s41, s40
    s_add_u32 s42, s58, s41
    s_add_u32 s43, s59, s41
    buffer_load_dwordx4 a[72:75], v240, s[8:11], s42 offen
    v_mfma_f32_32x32x16_bf16 v[80:95], v[36:39], v[40:43], v[80:95]
    ds_read_b128 v[56:59], v5 offset:2048
    v_dot2c_f32_bf16 v20, s27, v34
    v_dot2c_f32_bf16 v22, v34, v34
    buffer_load_dwordx4 a[76:79], v241, s[8:11], s43 offen
    v_mfma_f32_32x32x16_bf16 v[112:127], v[36:39], v[44:47], v[112:127]
    ds_read_b128 v[60:63], v5 offset:3072
    v_dot2c_f32_bf16 v21, s27, v35
    s_bfe_u32 s41, s52, 524304
    s_mul_i32 s41, s41, s40
    s_add_u32 s42, s58, s41
    s_add_u32 s43, s59, s41
    buffer_load_dwordx4 a[80:83], v240, s[8:11], s42 offen
    v_mfma_f32_32x32x16_bf16 v[144:159], v[44:47], v[36:39], v[144:159]
    v_dot2c_f32_bf16 v23, v35, v35
    buffer_load_dwordx4 a[84:87], v241, s[8:11], s43 offen
    s_waitcnt lgkmcnt(0)
    v_mfma_f32_32x32x16_bf16 v[64:79], v[48:51], v[56:59], v[64:79]
    v_dot2c_f32_bf16 v20, s27, v48
    v_dot2c_f32_bf16 v22, v48, v48
    v_mfma_f32_32x32x16_bf16 v[96:111], v[48:51], v[60:63], v[96:111]
    ds_read_b128 v[32:35], v12 offset:0
    v_dot2c_f32_bf16 v21, s27, v49
    v_mfma_f32_32x32x16_bf16 v[128:143], v[60:63], v[48:51], v[128:143]
    ds_read_b128 v[36:39], v12 offset:4096
    v_dot2c_f32_bf16 v23, v49, v49
    v_mfma_f32_32x32x16_bf16 v[80:95], v[52:55], v[56:59], v[80:95]
    ds_read_b128 v[40:43], v5 offset:4096
    v_dot2c_f32_bf16 v20, s27, v50
    v_dot2c_f32_bf16 v22, v50, v50
    v_mfma_f32_32x32x16_bf16 v[112:127], v[52:55], v[60:63], v[112:127]
    ds_read_b128 v[44:47], v5 offset:5120
    v_dot2c_f32_bf16 v21, s27, v51
    v_mfma_f32_32x32x16_bf16 v[144:159], v[60:63], v[52:55], v[144:159]
    v_dot2c_f32_bf16 v23, v51, v51
    s_waitcnt lgkmcnt(0)
    v_mfma_f32_32x32x16_bf16 v[64:79], v[32:35], v[40:43], v[64:79]
    v_dot2c_f32_bf16 v20, s27, v32
    v_dot2c_f32_bf16 v22, v32, v32
    v_mfma_f32_32x32x16_bf16 v[96:111], v[32:35], v[44:47], v[96:111]
    ds_read_b128 v[48:51], v13 offset:0
    v_dot2c_f32_bf16 v21, s27, v33
    v_mfma_f32_32x32x16_bf16 v[128:143], v[44:47], v[32:35], v[128:143]
    ds_read_b128 v[52:55], v13 offset:4096
    v_dot2c_f32_bf16 v23, v33, v33
    v_mfma_f32_32x32x16_bf16 v[80:95], v[36:39], v[40:43], v[80:95]
    ds_read_b128 v[56:59], v5 offset:6144
    v_dot2c_f32_bf16 v20, s27, v34
    v_dot2c_f32_bf16 v22, v34, v34
    v_mfma_f32_32x32x16_bf16 v[112:127], v[36:39], v[44:47], v[112:127]
    ds_read_b128 v[60:63], v5 offset:7168
    v_dot2c_f32_bf16 v21, s27, v35
    v_mfma_f32_32x32x16_bf16 v[144:159], v[44:47], v[36:39], v[144:159]
    v_dot2c_f32_bf16 v23, v35, v35
    s_waitcnt vmcnt(16)
    s_barrier
    s_waitcnt lgkmcnt(0)
    v_mfma_f32_32x32x16_bf16 v[64:79], v[48:51], v[56:59], v[64:79]
    v_dot2c_f32_bf16 v20, s27, v48
    v_dot2c_f32_bf16 v22, v48, v48
    s_lshl_b32 s28, s13, 12
    s_add_u32 s28, s28, 32768
    s_mov_b32 m0, s28
    s_add_u32 s29, s24, 640
    buffer_load_dwordx4 v2, s[16:19], s29 offen offset:0 lds
    v_mfma_f32_32x32x16_bf16 v[96:111], v[48:51], v[60:63], v[96:111]
    ds_read_b128 v[32:35], v10 offset:32768
    v_dot2c_f32_bf16 v21, s27, v49
    s_add_u32 s29, s29, 9216
    buffer_load_dwordx4 v3, s[16:19], s29 offen offset:1024 lds
    v_mfma_f32_32x32x16_bf16 v[128:143], v[60:63], v[48:51], v[128:143]
    ds_read_b128 v[36:39], v10 offset:36864
    v_dot2c_f32_bf16 v23, v49, v49
    s_add_u32 s29, s29, 9216
    buffer_load_dwordx4 v2, s[16:19], s29 offen offset:2048 lds
    v_mfma_f32_32x32x16_bf16 v[80:95], v[52:55], v[56:59], v[80:95]
    ds_read_b128 v[40:43], v5 offset:32768
    v_dot2c_f32_bf16 v20, s27, v50
    v_dot2c_f32_bf16 v22, v50, v50
    s_add_u32 s29, s29, 9216
    buffer_load_dwordx4 v3, s[16:19], s29 offen offset:3072 lds
    v_mfma_f32_32x32x16_bf16 v[112:127], v[52:55], v[60:63], v[112:127]
    ds_read_b128 v[44:47], v5 offset:33792
    v_dot2c_f32_bf16 v21, s27, v51
    s_add_u32 s28, s28, 16384
    s_mov_b32 m0, s28
    s_add_u32 s29, s25, 40960
    buffer_load_dwordx4 v1, s[8:11], s29 offen offset:0 lds
    v_mfma_f32_32x32x16_bf16 v[144:159], v[60:63], v[52:55], v[144:159]
    v_dot2c_f32_bf16 v23, v51, v51
    buffer_load_dwordx4 v1, s[8:11], s29 offen offset:1024 lds
    s_waitcnt lgkmcnt(0)
    v_mfma_f32_32x32x16_bf16 v[64:79], v[32:35], v[40:43], v[64:79]
    v_dot2c_f32_bf16 v20, s27, v32
    v_dot2c_f32_bf16 v22, v32, v32
    buffer_load_dwordx4 v1, s[8:11], s29 offen offset:2048 lds
    v_mfma_f32_32x32x16_bf16 v[96:111], v[32:35], v[44:47], v[96:111]
    ds_read_b128 v[48:51], v11 offset:32768
    v_dot2c_f32_bf16 v21, s27, v33
    buffer_load_dwordx4 v1, s[8:11], s29 offen offset:3072 lds
    v_mfma_f32_32x32x16_bf16 v[128:143], v[44:47], v[32:35], v[128:143]
    ds_read_b128 v[52:55], v11 offset:36864
    v_dot2c_f32_bf16 v23, v33, v33
    s_bfe_u32 s41, s52, 524312
    s_mul_i32 s41, s41, s40
    s_add_u32 s42, s58, s41
    s_add_u32 s43, s59, s41
    buffer_load_dwordx4 a[88:91], v240, s[8:11], s42 offen
    v_mfma_f32_32x32x16_bf16 v[80:95], v[36:39], v[40:43], v[80:95]
    ds_read_b128 v[56:59], v5 offset:34816
    v_dot2c_f32_bf16 v20, s27, v34
    v_dot2c_f32_bf16 v22, v34, v34
    buffer_load_dwordx4 a[92:95], v241, s[8:11], s43 offen
    v_mfma_f32_32x32x16_bf16 v[112:127], v[36:39], v[44:47], v[112:127]
    ds_read_b128 v[60:63], v5 offset:35840
    v_dot2c_f32_bf16 v21, s27, v35
    s_bfe_u32 s41, s53, 524288
    s_mul_i32 s41, s41, s40
    s_add_u32 s42, s58, s41
    s_add_u32 s43, s59, s41
    buffer_load_dwordx4 a[96:99], v240, s[8:11], s42 offen
    v_mfma_f32_32x32x16_bf16 v[144:159], v[44:47], v[36:39], v[144:159]
    v_dot2c_f32_bf16 v23, v35, v35
    buffer_load_dwordx4 a[100:103], v241, s[8:11], s43 offen
    s_waitcnt lgkmcnt(0)
    v_mfma_f32_32x32x16_bf16 v[64:79], v[48:51], v[56:59], v[64:79]
    v_dot2c_f32_bf16 v20, s27, v48
    v_dot2c_f32_bf16 v22, v48, v48
    v_mfma_f32_32x32x16_bf16 v[96:111], v[48:51], v[60:63], v[96:111]
    ds_read_b128 v[32:35], v12 offset:32768
    v_dot2c_f32_bf16 v21, s27, v49
    v_mfma_f32_32x32x16_bf16 v[128:143], v[60:63], v[48:51], v[128:143]
    ds_read_b128 v[36:39], v12 offset:36864
    v_dot2c_f32_bf16 v23, v49, v49
    v_mfma_f32_32x32x16_bf16 v[80:95], v[52:55], v[56:59], v[80:95]
    ds_read_b128 v[40:43], v5 offset:36864
    v_dot2c_f32_bf16 v20, s27, v50
    v_dot2c_f32_bf16 v22, v50, v50
    v_mfma_f32_32x32x16_bf16 v[112:127], v[52:55], v[60:63], v[112:127]
    ds_read_b128 v[44:47], v5 offset:37888
    v_dot2c_f32_bf16 v21, s27, v51
    v_mfma_f32_32x32x16_bf16 v[144:159], v[60:63], v[52:55], v[144:159]
    v_dot2c_f32_bf16 v23, v51, v51
    s_waitcnt lgkmcnt(0)
    v_mfma_f32_32x32x16_bf16 v[64:79], v[32:35], v[40:43], v[64:79]
    v_dot2c_f32_bf16 v20, s27, v32
    v_dot2c_f32_bf16 v22, v32, v32
    v_mfma_f32_32x32x16_bf16 v[96:111], v[32:35], v[44:47], v[96:111]
    ds_read_b128 v[48:51], v13 offset:32768
    v_dot2c_f32_bf16 v21, s27, v33
    v_mfma_f32_32x32x16_bf16 v[128:143], v[44:47], v[32:35], v[128:143]
    ds_read_b128 v[52:55], v13 offset:36864
    v_dot2c_f32_bf16 v23, v33, v33
    v_mfma_f32_32x32x16_bf16 v[80:95], v[36:39], v[40:43], v[80:95]
    ds_read_b128 v[56:59], v5 offset:38912
    v_dot2c_f32_bf16 v20, s27, v34
    v_dot2c_f32_bf16 v22, v34, v34
    v_mfma_f32_32x32x16_bf16 v[112:127], v[36:39], v[44:47], v[112:127]
    ds_read_b128 v[60:63], v5 offset:39936
    v_dot2c_f32_bf16 v21, s27, v35
    v_mfma_f32_32x32x16_bf16 v[144:159], v[44:47], v[36:39], v[144:159]
    v_dot2c_f32_bf16 v23, v35, v35
    s_waitcnt vmcnt(16)
    s_barrier
    s_waitcnt lgkmcnt(0)
    v_mfma_f32_32x32x16_bf16 v[64:79], v[48:51], v[56:59], v[64:79]
    v_dot2c_f32_bf16 v20, s27, v48
    v_dot2c_f32_bf16 v22, v48, v48
    s_lshl_b32 s28, s13, 12
    s_add_u32 s28, s28, 65536
    s_mov_b32 m0, s28
    s_add_u32 s29, s24, 768
    buffer_load_dwordx4 v2, s[16:19], s29 offen offset:0 lds
    v_mfma_f32_32x32x16_bf16 v[96:111], v[48:51], v[60:63], v[96:111]
    ds_read_b128 v[32:35], v6 offset:0
    v_dot2c_f32_bf16 v21, s27, v49
    s_add_u32 s29, s29, 9216
    buffer_load_dwordx4 v3, s[16:19], s29 offen offset:1024 lds
    v_mfma_f32_32x32x16_bf16 v[128:143], v[60:63], v[48:51], v[128:143]
    ds_read_b128 v[36:39], v6 offset:4096
    v_dot2c_f32_bf16 v23, v49, v49
    s_add_u32 s29, s29, 9216
    buffer_load_dwordx4 v2, s[16:19], s29 offen offset:2048 lds
    v_mfma_f32_32x32x16_bf16 v[80:95], v[52:55], v[56:59], v[80:95]
    ds_read_b128 v[40:43], v4 offset:0
    v_dot2c_f32_bf16 v20, s27, v50
    v_dot2c_f32_bf16 v22, v50, v50
    s_add_u32 s29, s29, 9216
    buffer_load_dwordx4 v3, s[16:19], s29 offen offset:3072 lds
    v_mfma_f32_32x32x16_bf16 v[112:127], v[52:55], v[60:63], v[112:127]
    ds_read_b128 v[44:47], v4 offset:1024
    v_dot2c_f32_bf16 v21, s27, v51
    s_add_u32 s28, s28, 16384
    s_mov_b32 m0, s28
    s_add_u32 s29, s25, 49152
    buffer_load_dwordx4 v1, s[8:11], s29 offen offset:0 lds
    v_mfma_f32_32x32x16_bf16 v[144:159], v[60:63], v[52:55], v[144:159]
    v_dot2c_f32_bf16 v23, v51, v51
    buffer_load_dwordx4 v1, s[8:11], s29 offen offset:1024 lds
    s_waitcnt lgkmcnt(0)
    v_mfma_f32_32x32x16_bf16 v[64:79], v[32:35], v[40:43], v[64:79]
    v_dot2c_f32_bf16 v20, s27, v32
    v_dot2c_f32_bf16 v22, v32, v32
    buffer_load_dwordx4 v1, s[8:11], s29 offen offset:2048 lds
    v_mfma_f32_32x32x16_bf16 v[96:111], v[32:35], v[44:47], v[96:111]
    ds_read_b128 v[48:51], v7 offset:0
    v_dot2c_f32_bf16 v21, s27, v33
    buffer_load_dwordx4 v1, s[8:11], s29 offen offset:3072 lds
    v_mfma_f32_32x32x16_bf16 v[128:143], v[44:47], v[32:35], v[128:143]
    ds_read_b128 v[52:55], v7 offset:4096
    v_dot2c_f32_bf16 v23, v33, v33
    s_bfe_u32 s41, s53, 524296
    s_mul_i32 s41, s41, s40
    s_add_u32 s42, s58, s41
    s_add_u32 s43, s59, s41
    buffer_load_dwordx4 a[104:107], v240, s[8:11], s42 offen
    v_mfma_f32_32x32x16_bf16 v[80:95], v[36:39], v[40:43], v[80:95]
    ds_read_b128 v[56:59], v4 offset:2048
    v_dot2c_f32_bf16 v20, s27, v34
    v_dot2c_f32_bf16 v22, v34, v34
    buffer_load_dwordx4 a[108:111], v241, s[8:11], s43 offen
    v_mfma_f32_32x32x16_bf16 v[112:127], v[36:39], v[44:47], v[112:127]
    ds_read_b128 v[60:63], v4 offset:3072
    v_dot2c_f32_bf16 v21, s27, v35
    s_bfe_u32 s41, s53, 524304
    s_mul_i32 s41, s41, s40
    s_add_u32 s42, s58, s41
    s_add_u32 s43, s59, s41
    buffer_load_dwordx4 a[112:115], v240, s[8:11], s42 offen
    v_mfma_f32_32x32x16_bf16 v[144:159], v[44:47], v[36:39], v[144:159]
    v_dot2c_f32_bf16 v23, v35, v35
    buffer_load_dwordx4 a[116:119], v241, s[8:11], s43 offen
    s_waitcnt lgkmcnt(0)
    v_mfma_f32_32x32x16_bf16 v[64:79], v[48:51], v[56:59], v[64:79]
    v_dot2c_f32_bf16 v20, s27, v48
    v_dot2c_f32_bf16 v22, v48, v48
    v_mfma_f32_32x32x16_bf16 v[96:111], v[48:51], v[60:63], v[96:111]
    ds_read_b128 v[32:35], v8 offset:0
    v_dot2c_f32_bf16 v21, s27, v49
    v_mfma_f32_32x32x16_bf16 v[128:143], v[60:63], v[48:51], v[128:143]
    ds_read_b128 v[36:39], v8 offset:4096
    v_dot2c_f32_bf16 v23, v49, v49
    v_mfma_f32_32x32x16_bf16 v[80:95], v[52:55], v[56:59], v[80:95]
    ds_read_b128 v[40:43], v4 offset:4096
    v_dot2c_f32_bf16 v20, s27, v50
    v_dot2c_f32_bf16 v22, v50, v50
    v_mfma_f32_32x32x16_bf16 v[112:127], v[52:55], v[60:63], v[112:127]
    ds_read_b128 v[44:47], v4 offset:5120
    v_dot2c_f32_bf16 v21, s27, v51
    v_mfma_f32_32x32x16_bf16 v[144:159], v[60:63], v[52:55], v[144:159]
    v_dot2c_f32_bf16 v23, v51, v51
    s_waitcnt lgkmcnt(0)
    v_mfma_f32_32x32x16_bf16 v[64:79], v[32:35], v[40:43], v[64:79]
    v_dot2c_f32_bf16 v20, s27, v32
    v_dot2c_f32_bf16 v22, v32, v32
    v_mfma_f32_32x32x16_bf16 v[96:111], v[32:35], v[44:47], v[96:111]
    ds_read_b128 v[48:51], v9 offset:0
    v_dot2c_f32_bf16 v21, s27, v33
    v_mfma_f32_32x32x16_bf16 v[128:143], v[44:47], v[32:35], v[128:143]
    ds_read_b128 v[52:55], v9 offset:4096
    v_dot2c_f32_bf16 v23, v33, v33
    v_mfma_f32_32x32x16_bf16 v[80:95], v[36:39], v[40:43], v[80:95]
    ds_read_b128 v[56:59], v4 offset:6144
    v_dot2c_f32_bf16 v20, s27, v34
    v_dot2c_f32_bf16 v22, v34, v34
    v_mfma_f32_32x32x16_bf16 v[112:127], v[36:39], v[44:47], v[112:127]
    ds_read_b128 v[60:63], v4 offset:7168
    v_dot2c_f32_bf16 v21, s27, v35
    v_mfma_f32_32x32x16_bf16 v[144:159], v[44:47], v[36:39], v[144:159]
    v_dot2c_f32_bf16 v23, v35, v35
    s_waitcnt vmcnt(16)
    s_barrier
    s_waitcnt lgkmcnt(0)
    v_mfma_f32_32x32x16_bf16 v[64:79], v[48:51], v[56:59], v[64:79]
    v_dot2c_f32_bf16 v20, s27, v48
    v_dot2c_f32_bf16 v22, v48, v48
    s_lshl_b32 s28, s13, 12
    s_add_u32 s28, s28, 98304
    s_mov_b32 m0, s28
    s_add_u32 s29, s24, 896
    buffer_load_dwordx4 v2, s[16:19], s29 offen offset:0 lds
    v_mfma_f32_32x32x16_bf16 v[96:111], v[48:51], v[60:63], v[96:111]
    ds_read_b128 v[32:35], v6 offset:32768
    v_dot2c_f32_bf16 v21, s27, v49
    s_add_u32 s29, s29, 9216
    buffer_load_dwordx4 v3, s[16:19], s29 offen offset:1024 lds
    v_mfma_f32_32x32x16_bf16 v[128:143], v[60:63], v[48:51], v[128:143]
    ds_read_b128 v[36:39], v6 offset:36864
    v_dot2c_f32_bf16 v23, v49, v49
    s_add_u32 s29, s29, 9216
    buffer_load_dwordx4 v2, s[16:19], s29 offen offset:2048 lds
    v_mfma_f32_32x32x16_bf16 v[80:95], v[52:55], v[56:59], v[80:95]
    ds_read_b128 v[40:43], v4 offset:32768
    v_dot2c_f32_bf16 v20, s27, v50
    v_dot2c_f32_bf16 v22, v50, v50
    s_add_u32 s29, s29, 9216
    buffer_load_dwordx4 v3, s[16:19], s29 offen offset:3072 lds
    v_mfma_f32_32x32x16_bf16 v[112:127], v[52:55], v[60:63], v[112:127]
    ds_read_b128 v[44:47], v4 offset:33792
    v_dot2c_f32_bf16 v21, s27, v51
    s_add_u32 s28, s28, 16384
    s_mov_b32 m0, s28
    s_add_u32 s29, s25, 57344
    buffer_load_dwordx4 v1, s[8:11], s29 offen offset:0 lds
    v_mfma_f32_32x32x16_bf16 v[144:159], v[60:63], v[52:55], v[144:159]
    v_dot2c_f32_bf16 v23, v51, v51
    buffer_load_dwordx4 v1, s[8:11], s29 offen offset:1024 lds
    s_waitcnt lgkmcnt(0)
    v_mfma_f32_32x32x16_bf16 v[64:79], v[32:35], v[40:43], v[64:79]
    v_dot2c_f32_bf16 v20, s27, v32
    v_dot2c_f32_bf16 v22, v32, v32
    buffer_load_dwordx4 v1, s[8:11], s29 offen offset:2048 lds
    v_mfma_f32_32x32x16_bf16 v[96:111], v[32:35], v[44:47], v[96:111]
    ds_read_b128 v[48:51], v7 offset:32768
    v_dot2c_f32_bf16 v21, s27, v33
    buffer_load_dwordx4 v1, s[8:11], s29 offen offset:3072 lds
    v_mfma_f32_32x32x16_bf16 v[128:143], v[44:47], v[32:35], v[128:143]
    ds_read_b128 v[52:55], v7 offset:36864
    v_dot2c_f32_bf16 v23, v33, v33
    s_bfe_u32 s41, s53, 524312
    s_mul_i32 s41, s41, s40
    s_add_u32 s42, s58, s41
    s_add_u32 s43, s59, s41
    buffer_load_dwordx4 a[120:123], v240, s[8:11], s42 offen
    v_mfma_f32_32x32x16_bf16 v[80:95], v[36:39], v[40:43], v[80:95]
    ds_read_b128 v[56:59], v4 offset:34816
    v_dot2c_f32_bf16 v20, s27, v34
    v_dot2c_f32_bf16 v22, v34, v34
    buffer_load_dwordx4 a[124:127], v241, s[8:11], s43 offen
    v_mfma_f32_32x32x16_bf16 v[112:127], v[36:39], v[44:47], v[112:127]
    ds_read_b128 v[60:63], v4 offset:35840
    v_dot2c_f32_bf16 v21, s27, v35
    s_bfe_u32 s41, s54, 524288
    s_mul_i32 s41, s41, s40
    s_add_u32 s42, s58, s41
    s_add_u32 s43, s59, s41
    buffer_load_dwordx4 a[128:131], v240, s[8:11], s42 offen
    v_mfma_f32_32x32x16_bf16 v[144:159], v[44:47], v[36:39], v[144:159]
    v_dot2c_f32_bf16 v23, v35, v35
    buffer_load_dwordx4 a[132:135], v241, s[8:11], s43 offen
    s_waitcnt lgkmcnt(0)
    v_mfma_f32_32x32x16_bf16 v[64:79], v[48:51], v[56:59], v[64:79]
    v_dot2c_f32_bf16 v20, s27, v48
    v_dot2c_f32_bf16 v22, v48, v48
    v_mfma_f32_32x32x16_bf16 v[96:111], v[48:51], v[60:63], v[96:111]
    ds_read_b128 v[32:35], v8 offset:32768
    v_dot2c_f32_bf16 v21, s27, v49
    v_mfma_f32_32x32x16_bf16 v[128:143], v[60:63], v[48:51], v[128:143]
    ds_read_b128 v[36:39], v8 offset:36864
    v_dot2c_f32_bf16 v23, v49, v49
    v_mfma_f32_32x32x16_bf16 v[80:95], v[52:55], v[56:59], v[80:95]
    ds_read_b128 v[40:43], v4 offset:36864
    v_dot2c_f32_bf16 v20, s27, v50
    v_dot2c_f32_bf16 v22, v50, v50
    v_mfma_f32_32x32x16_bf16 v[112:127], v[52:55], v[60:63], v[112:127]
    ds_read_b128 v[44:47], v4 offset:37888
    v_dot2c_f32_bf16 v21, s27, v51
    v_mfma_f32_32x32x16_bf16 v[144:159], v[60:63], v[52:55], v[144:159]
    v_dot2c_f32_bf16 v23, v51, v51
    s_waitcnt lgkmcnt(0)
    v_mfma_f32_32x32x16_bf16 v[64:79], v[32:35], v[40:43], v[64:79]
    v_dot2c_f32_bf16 v20, s27, v32
    v_dot2c_f32_bf16 v22, v32, v32
    v_mfma_f32_32x32x16_bf16 v[96:111], v[32:35], v[44:47], v[96:111]
    ds_read_b128 v[48:51], v9 offset:32768
    v_dot2c_f32_bf16 v21, s27, v33
    v_mfma_f32_32x32x16_bf16 v[128:143], v[44:47], v[32:35], v[128:143]
    ds_read_b128 v[52:55], v9 offset:36864
    v_dot2c_f32_bf16 v23, v33, v33
    v_mfma_f32_32x32x16_bf16 v[80:95], v[36:39], v[40:43], v[80:95]
    ds_read_b128 v[56:59], v4 offset:38912
    v_dot2c_f32_bf16 v20, s27, v34
    v_dot2c_f32_bf16 v22, v34, v34
    v_mfma_f32_32x32x16_bf16 v[112:127], v[36:39], v[44:47], v[112:127]
    ds_read_b128 v[60:63], v4 offset:39936
    v_dot2c_f32_bf16 v21, s27, v35
    v_mfma_f32_32x32x16_bf16 v[144:159], v[44:47], v[36:39], v[144:159]
    v_dot2c_f32_bf16 v23, v35, v35
    s_waitcnt vmcnt(16)
    s_barrier
    s_waitcnt lgkmcnt(0)
    v_mfma_f32_32x32x16_bf16 v[64:79], v[48:51], v[56:59], v[64:79]
    v_dot2c_f32_bf16 v20, s27, v48
    v_dot2c_f32_bf16 v22, v48, v48
    s_lshl_b32 s28, s13, 12
    s_mov_b32 m0, s28
    s_add_u32 s29, s24, 1024
    buffer_load_dwordx4 v2, s[16:19], s29 offen offset:0 lds
    v_mfma_f32_32x32x16_bf16 v[96:111], v[48:51], v[60:63], v[96:111]
    ds_read_b128 v[32:35], v10 offset:0
    v_dot2c_f32_bf16 v21, s27, v49
    s_add_u32 s29, s29, 9216
    buffer_load_dwordx4 v3, s[16:19], s29 offen offset:1024 lds
    v_mfma_f32_32x32x16_bf16 v[128:143], v[60:63], v[48:51], v[128:143]
    ds_read_b128 v[36:39], v10 offset:4096
    v_dot2c_f32_bf16 v23, v49, v49
    s_add_u32 s29, s29, 9216
    buffer_load_dwordx4 v2, s[16:19], s29 offen offset:2048 lds
    v_mfma_f32_32x32x16_bf16 v[80:95], v[52:55], v[56:59], v[80:95]
    ds_read_b128 v[40:43], v5 offset:0
    v_dot2c_f32_bf16 v20, s27, v50
    v_dot2c_f32_bf16 v22, v50, v50
    s_add_u32 s29, s29, 9216
    buffer_load_dwordx4 v3, s[16:19], s29 offen offset:3072 lds
    v_mfma_f32_32x32x16_bf16 v[112:127], v[52:55], v[60:63], v[112:127]
    ds_read_b128 v[44:47], v5 offset:1024
    v_dot2c_f32_bf16 v21, s27, v51
    s_add_u32 s28, s28, 16384
    s_mov_b32 m0, s28
    s_add_u32 s29, s25, 65536
    buffer_load_dwordx4 v1, s[8:11], s29 offen offset:0 lds
    v_mfma_f32_32x32x16_bf16 v[144:159], v[60:63], v[52:55], v[144:159]
    v_dot2c_f32_bf16 v23, v51, v51
    buffer_load_dwordx4 v1, s[8:11], s29 offen offset:1024 lds
    s_waitcnt lgkmcnt(0)
    v_mfma_f32_32x32x16_bf16 v[64:79], v[32:35], v[40:43], v[64:79]
    v_dot2c_f32_bf16 v20, s27, v32
    v_dot2c_f32_bf16 v22, v32, v32
    buffer_load_dwordx4 v1, s[8:11], s29 offen offset:2048 lds
    v_mfma_f32_32x32x16_bf16 v[96:111], v[32:35], v[44:47], v[96:111]
    ds_read_b128 v[48:51], v11 offset:0
    v_dot2c_f32_bf16 v21, s27, v33
    buffer_load_dwordx4 v1, s[8:11], s29 offen offset:3072 lds
    v_mfma_f32_32x32x16_bf16 v[128:143], v[44:47], v[32:35], v[128:143]
    ds_read_b128 v[52:55], v11 offset:4096
    v_dot2c_f32_bf16 v23, v33, v33
    s_bfe_u32 s41, s54, 524296
    s_mul_i32 s41, s41, s40
    s_add_u32 s42, s58, s41
    s_add_u32 s43, s59, s41
    buffer_load_dwordx4 a[136:139], v240, s[8:11], s42 offen
    v_mfma_f32_32x32x16_bf16 v[80:95], v[36:39], v[40:43], v[80:95]
    ds_read_b128 v[56:59], v5 offset:2048
    v_dot2c_f32_bf16 v20, s27, v34
    v_dot2c_f32_bf16 v22, v34, v34
    buffer_load_dwordx4 a[140:143], v241, s[8:11], s43 offen
    v_mfma_f32_32x32x16_bf16 v[112:127], v[36:39], v[44:47], v[112:127]
    ds_read_b128 v[60:63], v5 offset:3072
    v_dot2c_f32_bf16 v21, s27, v35
    s_bfe_u32 s41, s54, 524304
    s_mul_i32 s41, s41, s40
    s_add_u32 s42, s58, s41
    s_add_u32 s43, s59, s41
    buffer_load_dwordx4 a[144:147], v240, s[8:11], s42 offen
    v_mfma_f32_32x32x16_bf16 v[144:159], v[44:47], v[36:39], v[144:159]
    v_dot2c_f32_bf16 v23, v35, v35
    buffer_load_dwordx4 a[148:151], v241, s[8:11], s43 offen
    s_waitcnt lgkmcnt(0)
    v_mfma_f32_32x32x16_bf16 v[64:79], v[48:51], v[56:59], v[64:79]
    v_dot2c_f32_bf16 v20, s27, v48
    v_dot2c_f32_bf16 v22, v48, v48
    v_mfma_f32_32x32x16_bf16 v[96:111], v[48:51], v[60:63], v[96:111]
    ds_read_b128 v[32:35], v12 offset:0
    v_dot2c_f32_bf16 v21, s27, v49
    v_mfma_f32_32x32x16_bf16 v[128:143], v[60:63], v[48:51], v[128:143]
    ds_read_b128 v[36:39], v12 offset:4096
    v_dot2c_f32_bf16 v23, v49, v49
    v_mfma_f32_32x32x16_bf16 v[80:95], v[52:55], v[56:59], v[80:95]
    ds_read_b128 v[40:43], v5 offset:4096
    v_dot2c_f32_bf16 v20, s27, v50
    v_dot2c_f32_bf16 v22, v50, v50
    v_mfma_f32_32x32x16_bf16 v[112:127], v[52:55], v[60:63], v[112:127]
    ds_read_b128 v[44:47], v5 offset:5120
    v_dot2c_f32_bf16 v21, s27, v51
    v_mfma_f32_32x32x16_bf16 v[144:159], v[60:63], v[52:55], v[144:159]
    v_dot2c_f32_bf16 v23, v51, v51
    s_waitcnt lgkmcnt(0)
    v_mfma_f32_32x32x16_bf16 v[64:79], v[32:35], v[40:43], v[64:79]
    v_dot2c_f32_bf16 v20, s27, v32
    v_dot2c_f32_bf16 v22, v32, v32
    v_mfma_f32_32x32x16_bf16 v[96:111], v[32:35], v[44:47], v[96:111]
    ds_read_b128 v[48:51], v13 offset:0
    v_dot2c_f32_bf16 v21, s27, v33
    v_mfma_f32_32x32x16_bf16 v[128:143], v[44:47], v[32:35], v[128:143]
    ds_read_b128 v[52:55], v13 offset:4096
    v_dot2c_f32_bf16 v23, v33, v33
    v_mfma_f32_32x32x16_bf16 v[80:95], v[36:39], v[40:43], v[80:95]
    ds_read_b128 v[56:59], v5 offset:6144
    v_dot2c_f32_bf16 v20, s27, v34
    v_dot2c_f32_bf16 v22, v34, v34
    v_mfma_f32_32x32x16_bf16 v[112:127], v[36:39], v[44:47], v[112:127]
    ds_read_b128 v[60:63], v5 offset:7168
    v_dot2c_f32_bf16 v21, s27, v35
    v_mfma_f32_32x32x16_bf16 v[144:159], v[44:47], v[36:39], v[144:159]
    v_dot2c_f32_bf16 v23, v35, v35
    s_waitcnt vmcnt(16)
    s_barrier
    s_waitcnt lgkmcnt(0)
    v_mfma_f32_32x32x16_bf16 v[64:79], v[48:51], v[56:59], v[64:79]
    v_dot2c_f32_bf16 v20, s27, v48
    v_dot2c_f32_bf16 v22, v48, v48
    s_lshl_b32 s28, s13, 12
    s_add_u32 s28, s28, 32768
    s_mov_b32 m0, s28
    s_add_u32 s29, s24, 1152
    buffer_load_dwordx4 v2, s[16:19], s29 offen offset:0 lds
    v_mfma_f32_32x32x16_bf16 v[96:111], v[48:51], v[60:63], v[96:111]
    ds_read_b128 v[32:35], v10 offset:32768
    v_dot2c_f32_bf16 v21, s27, v49
    s_add_u32 s29, s29, 9216
    buffer_load_dwordx4 v3, s[16:19], s29 offen offset:1024 lds
    v_mfma_f32_32x32x16_bf16 v[128:143], v[60:63], v[48:51], v[128:143]
    ds_read_b128 v[36:39], v10 offset:36864
    v_dot2c_f32_bf16 v23, v49, v49
    s_add_u32 s29, s29, 9216
    buffer_load_dwordx4 v2, s[16:19], s29 offen offset:2048 lds
    v_mfma_f32_32x32x16_bf16 v[80:95], v[52:55], v[56:59], v[80:95]
    ds_read_b128 v[40:43], v5 offset:32768
    v_dot2c_f32_bf16 v20, s27, v50
    v_dot2c_f32_bf16 v22, v50, v50
    s_add_u32 s29, s29, 9216
    buffer_load_dwordx4 v3, s[16:19], s29 offen offset:3072 lds
    v_mfma_f32_32x32x16_bf16 v[112:127], v[52:55], v[60:63], v[112:127]
    ds_read_b128 v[44:47], v5 offset:33792
    v_dot2c_f32_bf16 v21, s27, v51
    s_add_u32 s28, s28, 16384
    s_mov_b32 m0, s28
    s_add_u32 s29, s25, 73728
    buffer_load_dwordx4 v1, s[8:11], s29 offen offset:0 lds
    v_mfma_f32_32x32x16_bf16 v[144:159], v[60:63], v[52:55], v[144:159]
    v_dot2c_f32_bf16 v23, v51, v51
    buffer_load_dwordx4 v1, s[8:11], s29 offen offset:1024 lds
    s_waitcnt lgkmcnt(0)
    v_mfma_f32_32x32x16_bf16 v[64:79], v[32:35], v[40:43], v[64:79]
    v_dot2c_f32_bf16 v20, s27, v32
    v_dot2c_f32_bf16 v22, v32, v32
    buffer_load_dwordx4 v1, s[8:11], s29 offen offset:2048 lds
    v_mfma_f32_32x32x16_bf16 v[96:111], v[32:35], v[44:47], v[96:111]
    ds_read_b128 v[48:51], v11 offset:32768
    v_dot2c_f32_bf16 v21, s27, v33
    buffer_load_dwordx4 v1, s[8:11], s29 offen offset:3072 lds
    v_mfma_f32_32x32x16_bf16 v[128:143], v[44:47], v[32:35], v[128:143]
    ds_read_b128 v[52:55], v11 offset:36864
    v_dot2c_f32_bf16 v23, v33, v33
    s_bfe_u32 s41, s54, 524312
    s_mul_i32 s41, s41, s40
    s_add_u32 s42, s58, s41
    s_add_u32 s43, s59, s41
    buffer_load_dwordx4 a[152:155], v240, s[8:11], s42 offen
    v_mfma_f32_32x32x16_bf16 v[80:95], v[36:39], v[40:43], v[80:95]
    ds_read_b128 v[56:59], v5 offset:34816
    v_dot2c_f32_bf16 v20, s27, v34
    v_dot2c_f32_bf16 v22, v34, v34
    buffer_load_dwordx4 a[156:159], v241, s[8:11], s43 offen
    v_mfma_f32_32x32x16_bf16 v[112:127], v[36:39], v[44:47], v[112:127]
    ds_read_b128 v[60:63], v5 offset:35840
    v_dot2c_f32_bf16 v21, s27, v35
    s_bfe_u32 s41, s55, 524288
    s_mul_i32 s41, s41, s40
    s_add_u32 s42, s58, s41
    s_add_u32 s43, s59, s41
    buffer_load_dwordx4 a[160:163], v240, s[8:11], s42 offen
    v_mfma_f32_32x32x16_bf16 v[144:159], v[44:47], v[36:39], v[144:159]
    v_dot2c_f32_bf16 v23, v35, v35
    buffer_load_dwordx4 a[164:167], v241, s[8:11], s43 offen
    s_waitcnt lgkmcnt(0)
    v_mfma_f32_32x32x16_bf16 v[64:79], v[48:51], v[56:59], v[64:79]
    v_dot2c_f32_bf16 v20, s27, v48
    v_dot2c_f32_bf16 v22, v48, v48
    v_mfma_f32_32x32x16_bf16 v[96:111], v[48:51], v[60:63], v[96:111]
    ds_read_b128 v[32:35], v12 offset:32768
    v_dot2c_f32_bf16 v21, s27, v49
    v_mfma_f32_32x32x16_bf16 v[128:143], v[60:63], v[48:51], v[128:143]
    ds_read_b128 v[36:39], v12 offset:36864
    v_dot2c_f32_bf16 v23, v49, v49
    v_mfma_f32_32x32x16_bf16 v[80:95], v[52:55], v[56:59], v[80:95]
    ds_read_b128 v[40:43], v5 offset:36864
    v_dot2c_f32_bf16 v20, s27, v50
    v_dot2c_f32_bf16 v22, v50, v50
    v_mfma_f32_32x32x16_bf16 v[112:127], v[52:55], v[60:63], v[112:127]
    ds_read_b128 v[44:47], v5 offset:37888
    v_dot2c_f32_bf16 v21, s27, v51
    v_mfma_f32_32x32x16_bf16 v[144:159], v[60:63], v[52:55], v[144:159]
    v_dot2c_f32_bf16 v23, v51, v51
    s_waitcnt lgkmcnt(0)
    v_mfma_f32_32x32x16_bf16 v[64:79], v[32:35], v[40:43], v[64:79]
    v_dot2c_f32_bf16 v20, s27, v32
    v_dot2c_f32_bf16 v22, v32, v32
    v_mfma_f32_32x32x16_bf16 v[96:111], v[32:35], v[44:47], v[96:111]
    ds_read_b128 v[48:51], v13 offset:32768
    v_dot2c_f32_bf16 v21, s27, v33
    v_mfma_f32_32x32x16_bf16 v[128:143], v[44:47], v[32:35], v[128:143]
    ds_read_b128 v[52:55], v13 offset:36864
    v_dot2c_f32_bf16 v23, v33, v33
    v_mfma_f32_32x32x16_bf16 v[80:95], v[36:39], v[40:43], v[80:95]
    ds_read_b128 v[56:59], v5 offset:38912
    v_dot2c_f32_bf16 v20, s27, v34
    v_dot2c_f32_bf16 v22, v34, v34
    v_mfma_f32_32x32x16_bf16 v[112:127], v[36:39], v[44:47], v[112:127]
    ds_read_b128 v[60:63], v5 offset:39936
    v_dot2c_f32_bf16 v21, s27, v35
    v_mfma_f32_32x32x16_bf16 v[144:159], v[44:47], v[36:39], v[144:159]
    v_dot2c_f32_bf16 v23, v35, v35
    s_waitcnt vmcnt(16)
    s_barrier
    s_waitcnt lgkmcnt(0)
    v_mfma_f32_32x32x16_bf16 v[64:79], v[48:51], v[56:59], v[64:79]
    v_dot2c_f32_bf16 v20, s27, v48
    v_dot2c_f32_bf16 v22, v48, v48
    s_bfe_u32 s41, s55, 524296
    s_mul_i32 s41, s41, s40
    s_add_u32 s42, s58, s41
    s_add_u32 s43, s59, s41
    buffer_load_dwordx4 a[168:171], v240, s[8:11], s42 offen
    v_mfma_f32_32x32x16_bf16 v[96:111], v[48:51], v[60:63], v[96:111]
    ds_read_b128 v[32:35], v6 offset:0
    v_dot2c_f32_bf16 v21, s27, v49
    buffer_load_dwordx4 a[172:175], v241, s[8:11], s43 offen
    v_mfma_f32_32x32x16_bf16 v[128:143], v[60:63], v[48:51], v[128:143]
    ds_read_b128 v[36:39], v6 offset:4096
    v_dot2c_f32_bf16 v23, v49, v49
    s_bfe_u32 s41, s55, 524304
    s_mul_i32 s41, s41, s40
    s_add_u32 s42, s58, s41
    s_add_u32 s43, s59, s41
    buffer_load_dwordx4 a[176:179], v240, s[8:11], s42 offen
    v_mfma_f32_32x32x16_bf16 v[80:95], v[52:55], v[56:59], v[80:95]
    ds_read_b128 v[40:43], v4 offset:0
    v_dot2c_f32_bf16 v20, s27, v50
    v_dot2c_f32_bf16 v22, v50, v50
    buffer_load_dwordx4 a[180:183], v241, s[8:11], s43 offen
    v_mfma_f32_32x32x16_bf16 v[112:127], v[52:55], v[60:63], v[112:127]
    ds_read_b128 v[44:47], v4 offset:1024
    v_dot2c_f32_bf16 v21, s27, v51
    s_bfe_u32 s41, s55, 524312
    s_mul_i32 s41, s41, s40
    s_add_u32 s42, s58, s41
    s_add_u32 s43, s59, s41
    buffer_load_dwordx4 a[184:187], v240, s[8:11], s42 offen
    v_mfma_f32_32x32x16_bf16 v[144:159], v[60:63], v[52:55], v[144:159]
    v_dot2c_f32_bf16 v23, v51, v51
    buffer_load_dwordx4 a[188:191], v241, s[8:11], s43 offen
    s_waitcnt lgkmcnt(0)
    v_mfma_f32_32x32x16_bf16 v[64:79], v[32:35], v[40:43], v[64:79]
    v_dot2c_f32_bf16 v20, s27, v32
    v_dot2c_f32_bf16 v22, v32, v32
    s_bfe_u32 s41, s56, 524288
    s_mul_i32 s41, s41, s40
    s_add_u32 s42, s58, s41
    s_add_u32 s43, s59, s41
    buffer_load_dwordx4 a[192:195], v240, s[8:11], s42 offen
    v_mfma_f32_32x32x16_bf16 v[96:111], v[32:35], v[44:47], v[96:111]
    ds_read_b128 v[48:51], v7 offset:0
    v_dot2c_f32_bf16 v21, s27, v33
    buffer_load_dwordx4 a[196:199], v241, s[8:11], s43 offen
    v_mfma_f32_32x32x16_bf16 v[128:143], v[44:47], v[32:35], v[128:143]
    ds_read_b128 v[52:55], v7 offset:4096
    v_dot2c_f32_bf16 v23, v33, v33
    v_mfma_f32_32x32x16_bf16 v[80:95], v[36:39], v[40:43], v[80:95]
    ds_read_b128 v[56:59], v4 offset:2048
    v_dot2c_f32_bf16 v20, s27, v34
    v_dot2c_f32_bf16 v22, v34, v34
    v_mfma_f32_32x32x16_bf16 v[112:127], v[36:39], v[44:47], v[112:127]
    ds_read_b128 v[60:63], v4 offset:3072
    v_dot2c_f32_bf16 v21, s27, v35
    v_mfma_f32_32x32x16_bf16 v[144:159], v[44:47], v[36:39], v[144:159]
    v_dot2c_f32_bf16 v23, v35, v35
    s_waitcnt lgkmcnt(0)
    v_mfma_f32_32x32x16_bf16 v[64:79], v[48:51], v[56:59], v[64:79]
    v_dot2c_f32_bf16 v20, s27, v48
    v_dot2c_f32_bf16 v22, v48, v48
    v_mfma_f32_32x32x16_bf16 v[96:111], v[48:51], v[60:63], v[96:111]
    ds_read_b128 v[32:35], v8 offset:0
    v_dot2c_f32_bf16 v21, s27, v49
    v_mfma_f32_32x32x16_bf16 v[128:143], v[60:63], v[48:51], v[128:143]
    ds_read_b128 v[36:39], v8 offset:4096
    v_dot2c_f32_bf16 v23, v49, v49
    v_mfma_f32_32x32x16_bf16 v[80:95], v[52:55], v[56:59], v[80:95]
    ds_read_b128 v[40:43], v4 offset:4096
    v_dot2c_f32_bf16 v20, s27, v50
    v_dot2c_f32_bf16 v22, v50, v50
    v_mfma_f32_32x32x16_bf16 v[112:127], v[52:55], v[60:63], v[112:127]
    ds_read_b128 v[44:47], v4 offset:5120
    v_dot2c_f32_bf16 v21, s27, v51
    v_mfma_f32_32x32x16_bf16 v[144:159], v[60:63], v[52:55], v[144:159]
    v_dot2c_f32_bf16 v23, v51, v51
    s_waitcnt lgkmcnt(0)
    v_mfma_f32_32x32x16_bf16 v[64:79], v[32:35], v[40:43], v[64:79]
    v_dot2c_f32_bf16 v20, s27, v32
    v_dot2c_f32_bf16 v22, v32, v32
    v_mfma_f32_32x32x16_bf16 v[96:111], v[32:35], v[44:47], v[96:111]
    ds_read_b128 v[48:51], v9 offset:0
    v_dot2c_f32_bf16 v21, s27, v33
    v_mfma_f32_32x32x16_bf16 v[128:143], v[44:47], v[32:35], v[128:143]
    ds_read_b128 v[52:55], v9 offset:4096
    v_dot2c_f32_bf16 v23, v33, v33
    v_mfma_f32_32x32x16_bf16 v[80:95], v[36:39], v[40:43], v[80:95]
    ds_read_b128 v[56:59], v4 offset:6144
    v_dot2c_f32_bf16 v20, s27, v34
    v_dot2c_f32_bf16 v22, v34, v34
    v_mfma_f32_32x32x16_bf16 v[112:127], v[36:39], v[44:47], v[112:127]
    ds_read_b128 v[60:63], v4 offset:7168
    v_dot2c_f32_bf16 v21, s27, v35
    v_mfma_f32_32x32x16_bf16 v[144:159], v[44:47], v[36:39], v[144:159]
    v_dot2c_f32_bf16 v23, v35, v35
    s_waitcnt vmcnt(12)
    s_barrier
    s_waitcnt lgkmcnt(0)
    v_mfma_f32_32x32x16_bf16 v[64:79], v[48:51], v[56:59], v[64:79]
    v_dot2c_f32_bf16 v20, s27, v48
    v_dot2c_f32_bf16 v22, v48, v48
    s_bfe_u32 s41, s56, 524296
    s_mul_i32 s41, s41, s40
    s_add_u32 s42, s58, s41
    s_add_u32 s43, s59, s41
    buffer_load_dwordx4 a[200:203], v240, s[8:11], s42 offen
    v_mfma_f32_32x32x16_bf16 v[96:111], v[48:51], v[60:63], v[96:111]
    ds_read_b128 v[32:35], v6 offset:32768
    v_dot2c_f32_bf16 v21, s27, v49
    buffer_load_dwordx4 a[204:207], v241, s[8:11], s43 offen
    v_mfma_f32_32x32x16_bf16 v[128:143], v[60:63], v[48:51], v[128:143]
    ds_read_b128 v[36:39], v6 offset:36864
    v_dot2c_f32_bf16 v23, v49, v49
    s_bfe_u32 s41, s56, 524304
    s_mul_i32 s41, s41, s40
    s_add_u32 s42, s58, s41
    s_add_u32 s43, s59, s41
    buffer_load_dwordx4 a[208:211], v240, s[8:11], s42 offen
    v_mfma_f32_32x32x16_bf16 v[80:95], v[52:55], v[56:59], v[80:95]
    ds_read_b128 v[40:43], v4 offset:32768
    v_dot2c_f32_bf16 v20, s27, v50
    v_dot2c_f32_bf16 v22, v50, v50
    buffer_load_dwordx4 a[212:215], v241, s[8:11], s43 offen
    v_mfma_f32_32x32x16_bf16 v[112:127], v[52:55], v[60:63], v[112:127]
    ds_read_b128 v[44:47], v4 offset:33792
    v_dot2c_f32_bf16 v21, s27, v51
    s_bfe_u32 s41, s56, 524312
    s_mul_i32 s41, s41, s40
    s_add_u32 s42, s58, s41
    s_add_u32 s43, s59, s41
    buffer_load_dwordx4 a[216:219], v240, s[8:11], s42 offen
    v_mfma_f32_32x32x16_bf16 v[144:159], v[60:63], v[52:55], v[144:159]
    v_dot2c_f32_bf16 v23, v51, v51
    buffer_load_dwordx4 a[220:223], v241, s[8:11], s43 offen
    s_waitcnt lgkmcnt(0)
    v_mfma_f32_32x32x16_bf16 v[64:79], v[32:35], v[40:43], v[64:79]
    v_dot2c_f32_bf16 v20, s27, v32
    v_dot2c_f32_bf16 v22, v32, v32
    s_bfe_u32 s41, s57, 524288
    s_mul_i32 s41, s41, s40
    s_add_u32 s42, s58, s41
    s_add_u32 s43, s59, s41
    buffer_load_dwordx4 a[224:227], v240, s[8:11], s42 offen
    v_mfma_f32_32x32x16_bf16 v[96:111], v[32:35], v[44:47], v[96:111]
    ds_read_b128 v[48:51], v7 offset:32768
    v_dot2c_f32_bf16 v21, s27, v33
    buffer_load_dwordx4 a[228:231], v241, s[8:11], s43 offen
    v_mfma_f32_32x32x16_bf16 v[128:143], v[44:47], v[32:35], v[128:143]
    ds_read_b128 v[52:55], v7 offset:36864
    v_dot2c_f32_bf16 v23, v33, v33
    v_mfma_f32_32x32x16_bf16 v[80:95], v[36:39], v[40:43], v[80:95]
    ds_read_b128 v[56:59], v4 offset:34816
    v_dot2c_f32_bf16 v20, s27, v34
    v_dot2c_f32_bf16 v22, v34, v34
    v_mfma_f32_32x32x16_bf16 v[112:127], v[36:39], v[44:47], v[112:127]
    ds_read_b128 v[60:63], v4 offset:35840
    v_dot2c_f32_bf16 v21, s27, v35
    v_mfma_f32_32x32x16_bf16 v[144:159], v[44:47], v[36:39], v[144:159]
    v_dot2c_f32_bf16 v23, v35, v35
    s_waitcnt lgkmcnt(0)
    v_mfma_f32_32x32x16_bf16 v[64:79], v[48:51], v[56:59], v[64:79]
    v_dot2c_f32_bf16 v20, s27, v48
    v_dot2c_f32_bf16 v22, v48, v48
    v_mfma_f32_32x32x16_bf16 v[96:111], v[48:51], v[60:63], v[96:111]
    ds_read_b128 v[32:35], v8 offset:32768
    v_dot2c_f32_bf16 v21, s27, v49
    v_mfma_f32_32x32x16_bf16 v[128:143], v[60:63], v[48:51], v[128:143]
    ds_read_b128 v[36:39], v8 offset:36864
    v_dot2c_f32_bf16 v23, v49, v49
    v_mfma_f32_32x32x16_bf16 v[80:95], v[52:55], v[56:59], v[80:95]
    ds_read_b128 v[40:43], v4 offset:36864
    v_dot2c_f32_bf16 v20, s27, v50
    v_dot2c_f32_bf16 v22, v50, v50
    v_mfma_f32_32x32x16_bf16 v[112:127], v[52:55], v[60:63], v[112:127]
    ds_read_b128 v[44:47], v4 offset:37888
    v_dot2c_f32_bf16 v21, s27, v51
    v_mfma_f32_32x32x16_bf16 v[144:159], v[60:63], v[52:55], v[144:159]
    v_dot2c_f32_bf16 v23, v51, v51
    s_waitcnt lgkmcnt(0)
    v_mfma_f32_32x32x16_bf16 v[64:79], v[32:35], v[40:43], v[64:79]
    v_dot2c_f32_bf16 v20, s27, v32
    v_dot2c_f32_bf16 v22, v32, v32
    v_mfma_f32_32x32x16_bf16 v[96:111], v[32:35], v[44:47], v[96:111]
    ds_read_b128 v[48:51], v9 offset:32768
    v_dot2c_f32_bf16 v21, s27, v33
    v_mfma_f32_32x32x16_bf16 v[128:143], v[44:47], v[32:35], v[128:143]
    ds_read_b128 v[52:55], v9 offset:36864
    v_dot2c_f32_bf16 v23, v33, v33
    v_mfma_f32_32x32x16_bf16 v[80:95], v[36:39], v[40:43], v[80:95]
    ds_read_b128 v[56:59], v4 offset:38912
    v_dot2c_f32_bf16 v20, s27, v34
    v_dot2c_f32_bf16 v22, v34, v34
    v_mfma_f32_32x32x16_bf16 v[112:127], v[36:39], v[44:47], v[112:127]
    ds_read_b128 v[60:63], v4 offset:39936
    v_dot2c_f32_bf16 v21, s27, v35
    v_mfma_f32_32x32x16_bf16 v[144:159], v[44:47], v[36:39], v[144:159]
    v_dot2c_f32_bf16 v23, v35, v35
    s_waitcnt lgkmcnt(0)
    v_mfma_f32_32x32x16_bf16 v[64:79], v[48:51], v[56:59], v[64:79]
    v_dot2c_f32_bf16 v20, s27, v48
    v_dot2c_f32_bf16 v22, v48, v48
    s_bfe_u32 s41, s57, 524296
    s_mul_i32 s41, s41, s40
    s_add_u32 s42, s58, s41
    s_add_u32 s43, s59, s41
    buffer_load_dwordx4 a[232:235], v240, s[8:11], s42 offen
    v_mfma_f32_32x32x16_bf16 v[96:111], v[48:51], v[60:63], v[96:111]
    v_dot2c_f32_bf16 v21, s27, v49
    buffer_load_dwordx4 a[236:239], v241, s[8:11], s43 offen
    v_mfma_f32_32x32x16_bf16 v[128:143], v[60:63], v[48:51], v[128:143]
    v_dot2c_f32_bf16 v23, v49, v49
    s_bfe_u32 s41, s57, 524304
    s_mul_i32 s41, s41, s40
    s_add_u32 s42, s58, s41
    s_add_u32 s43, s59, s41
    buffer_load_dwordx4 a[240:243], v240, s[8:11], s42 offen
    v_mfma_f32_32x32x16_bf16 v[80:95], v[52:55], v[56:59], v[80:95]
    v_dot2c_f32_bf16 v20, s27, v50
    v_dot2c_f32_bf16 v22, v50, v50
    buffer_load_dwordx4 a[244:247], v241, s[8:11], s43 offen
    v_mfma_f32_32x32x16_bf16 v[112:127], v[52:55], v[60:63], v[112:127]
    v_dot2c_f32_bf16 v21, s27, v51
    s_bfe_u32 s41, s57, 524312
    s_mul_i32 s41, s41, s40
    s_add_u32 s42, s58, s41
    s_add_u32 s43, s59, s41
    buffer_load_dwordx4 a[248:251], v240, s[8:11], s42 offen
    v_mfma_f32_32x32x16_bf16 v[144:159], v[60:63], v[52:55], v[144:159]
    v_dot2c_f32_bf16 v23, v51, v51
    buffer_load_dwordx4 a[252:255], v241, s[8:11], s43 offen
    s_branch layerb1_kernel_af_epi
layerb1_kernel_af_h1:
    s_waitcnt lgkmcnt(0)
    v_mfma_f32_32x32x16_bf16 v[64:79], v[32:35], v[40:43], 0
    v_dot2c_f32_bf16 v20, s27, v36
    v_dot2c_f32_bf16 v22, v36, v36
    v_mfma_f32_32x32x16_bf16 v[96:111], v[32:35], v[44:47], 0
    ds_read_b128 v[48:51], v7 offset:0
    v_dot2c_f32_bf16 v21, s27, v37
    v_mfma_f32_32x32x16_bf16 v[128:143], v[44:47], v[32:35], 0
    ds_read_b128 v[52:55], v7 offset:4096
    v_dot2c_f32_bf16 v23, v37, v37
    v_mfma_f32_32x32x16_bf16 v[80:95], v[36:39], v[40:43], 0
    ds_read_b128 v[56:59], v4 offset:2048
    v_dot2c_f32_bf16 v20, s27, v38
    v_dot2c_f32_bf16 v22, v38, v38
    v_mfma_f32_32x32x16_bf16 v[112:127], v[36:39], v[44:47], 0
    ds_read_b128 v[60:63], v4 offset:3072
    v_dot2c_f32_bf16 v21, s27, v39
    v_mfma_f32_32x32x16_bf16 v[144:159], v[44:47], v[36:39], 0
    v_dot2c_f32_bf16 v23, v39, v39
    s_waitcnt lgkmcnt(0)
    v_mfma_f32_32x32x16_bf16 v[64:79], v[48:51], v[56:59], v[64:79]
    v_dot2c_f32_bf16 v20, s27, v52
    v_dot2c_f32_bf16 v22, v52, v52
    v_mfma_f32_32x32x16_bf16 v[96:111], v[48:51], v[60:63], v[96:111]
    ds_read_b128 v[32:35], v8 offset:0
    v_dot2c_f32_bf16 v21, s27, v53
    v_mfma_f32_32x32x16_bf16 v[128:143], v[60:63], v[48:51], v[128:143]
    ds_read_b128 v[36:39], v8 offset:4096
    v_dot2c_f32_bf16 v23, v53, v53
    v_mfma_f32_32x32x16_bf16 v[80:95], v[52:55], v[56:59], v[80:95]
    ds_read_b128 v[40:43], v4 offset:4096
    v_dot2c_f32_bf16 v20, s27, v54
    v_dot2c_f32_bf16 v22, v54, v54
    v_mfma_f32_32x32x16_bf16 v[112:127], v[52:55], v[60:63], v[112:127]
    ds_read_b128 v[44:47], v4 offset:5120
    v_dot2c_f32_bf16 v21, s27, v55
    v_mfma_f32_32x32x16_bf16 v[144:159], v[60:63], v[52:55], v[144:159]
    v_dot2c_f32_bf16 v23, v55, v55
    s_waitcnt lgkmcnt(0)
    v_mfma_f32_32x32x16_bf16 v[64:79], v[32:35], v[40:43], v[64:79]
    v_dot2c_f32_bf16 v20, s27, v36
    v_dot2c_f32_bf16 v22, v36, v36
    v_mfma_f32_32x32x16_bf16 v[96:111], v[32:35], v[44:47], v[96:111]
    ds_read_b128 v[48:51], v9 offset:0
    v_dot2c_f32_bf16 v21, s27, v37
    v_mfma_f32_32x32x16_bf16 v[128:143], v[44:47], v[32:35], v[128:143]
    ds_read_b128 v[52:55], v9 offset:4096
    v_dot2c_f32_bf16 v23, v37, v37
    v_mfma_f32_32x32x16_bf16 v[80:95], v[36:39], v[40:43], v[80:95]
    ds_read_b128 v[56:59], v4 offset:6144
    v_dot2c_f32_bf16 v20, s27, v38
    v_dot2c_f32_bf16 v22, v38, v38
    v_mfma_f32_32x32x16_bf16 v[112:127], v[36:39], v[44:47], v[112:127]
    ds_read_b128 v[60:63], v4 offset:7168
    v_dot2c_f32_bf16 v21, s27, v39
    v_mfma_f32_32x32x16_bf16 v[144:159], v[44:47], v[36:39], v[144:159]
    v_dot2c_f32_bf16 v23, v39, v39
    s_waitcnt vmcnt(22)
    s_barrier
    s_waitcnt lgkmcnt(0)
    v_mfma_f32_32x32x16_bf16 v[64:79], v[48:51], v[56:59], v[64:79]
    v_dot2c_f32_bf16 v20, s27, v52
    v_dot2c_f32_bf16 v22, v52, v52
    s_lshl_b32 s28, s13, 12
    s_add_u32 s28, s28, 98304
    s_mov_b32 m0, s28
    s_add_u32 s29, s24, 384
    buffer_load_dwordx4 v2, s[16:19], s29 offen offset:0 lds
    v_mfma_f32_32x32x16_bf16 v[96:111], v[48:51], v[60:63], v[96:111]
    ds_read_b128 v[32:35], v6 offset:32768
    v_dot2c_f32_bf16 v21, s27, v53
    s_add_u32 s29, s29, 9216
    buffer_load_dwordx4 v3, s[16:19], s29 offen offset:1024 lds
    v_mfma_f32_32x32x16_bf16 v[128:143], v[60:63], v[48:51], v[128:143]
    ds_read_b128 v[36:39], v6 offset:36864
    v_dot2c_f32_bf16 v23, v53, v53
    s_add_u32 s29, s29, 9216
    buffer_load_dwordx4 v2, s[16:19], s29 offen offset:2048 lds
    v_mfma_f32_32x32x16_bf16 v[80:95], v[52:55], v[56:59], v[80:95]
    ds_read_b128 v[40:43], v4 offset:32768
    v_dot2c_f32_bf16 v20, s27, v54
    v_dot2c_f32_bf16 v22, v54, v54
    s_add_u32 s29, s29, 9216
    buffer_load_dwordx4 v3, s[16:19], s29 offen offset:3072 lds
    v_mfma_f32_32x32x16_bf16 v[112:127], v[52:55], v[60:63], v[112:127]
    ds_read_b128 v[44:47], v4 offset:33792
    v_dot2c_f32_bf16 v21, s27, v55
    s_add_u32 s28, s28, 16384
    s_mov_b32 m0, s28
    s_add_u32 s29, s25, 24576
    buffer_load_dwordx4 v1, s[8:11], s29 offen offset:0 lds
    v_mfma_f32_32x32x16_bf16 v[144:159], v[60:63], v[52:55], v[144:159]
    v_dot2c_f32_bf16 v23, v55, v55
    buffer_load_dwordx4 v1, s[8:11], s29 offen offset:1024 lds
    s_waitcnt lgkmcnt(0)
    v_mfma_f32_32x32x16_bf16 v[64:79], v[32:35], v[40:43], v[64:79]
    v_dot2c_f32_bf16 v20, s27, v36
    v_dot2c_f32_bf16 v22, v36, v36
    buffer_load_dwordx4 v1, s[8:11], s29 offen offset:2048 lds
    v_mfma_f32_32x32x16_bf16 v[96:111], v[32:35], v[44:47], v[96:111]
    ds_read_b128 v[48:51], v7 offset:32768
    v_dot2c_f32_bf16 v21, s27, v37
    buffer_load_dwordx4 v1, s[8:11], s29 offen offset:3072 lds
    v_mfma_f32_32x32x16_bf16 v[128:143], v[44:47], v[32:35], v[128:143]
    ds_read_b128 v[52:55], v7 offset:36864
    v_dot2c_f32_bf16 v23, v37, v37
    s_bfe_u32 s41, s51, 524312
    s_mul_i32 s41, s41, s40
    s_add_u32 s42, s58, s41
    s_add_u32 s43, s59, s41
    buffer_load_dwordx4 a[56:59], v240, s[8:11], s42 offen
    v_mfma_f32_32x32x16_bf16 v[80:95], v[36:39], v[40:43], v[80:95]
    ds_read_b128 v[56:59], v4 offset:34816
    v_dot2c_f32_bf16 v20, s27, v38
    v_dot2c_f32_bf16 v22, v38, v38
    buffer_load_dwordx4 a[60:63], v241, s[8:11], s43 offen
    v_mfma_f32_32x32x16_bf16 v[112:127], v[36:39], v[44:47], v[112:127]
    ds_read_b128 v[60:63], v4 offset:35840
    v_dot2c_f32_bf16 v21, s27, v39
    s_bfe_u32 s41, s52, 524288
    s_mul_i32 s41, s41, s40
    s_add_u32 s42, s58, s41
    s_add_u32 s43, s59, s41
    buffer_load_dwordx4 a[64:67], v240, s[8:11], s42 offen
    v_mfma_f32_32x32x16_bf16 v[144:159], v[44:47], v[36:39], v[144:159]
    v_dot2c_f32_bf16 v23, v39, v39
    buffer_load_dwordx4 a[68:71], v241, s[8:11], s43 offen
    s_waitcnt lgkmcnt(0)
    v_mfma_f32_32x32x16_bf16 v[64:79], v[48:51], v[56:59], v[64:79]
    v_dot2c_f32_bf16 v20, s27, v52
    v_dot2c_f32_bf16 v22, v52, v52
    v_mfma_f32_32x32x16_bf16 v[96:111], v[48:51], v[60:63], v[96:111]
    ds_read_b128 v[32:35], v8 offset:32768
    v_dot2c_f32_bf16 v21, s27, v53
    v_mfma_f32_32x32x16_bf16 v[128:143], v[60:63], v[48:51], v[128:143]
    ds_read_b128 v[36:39], v8 offset:36864
    v_dot2c_f32_bf16 v23, v53, v53
    v_mfma_f32_32x32x16_bf16 v[80:95], v[52:55], v[56:59], v[80:95]
    ds_read_b128 v[40:43], v4 offset:36864
    v_dot2c_f32_bf16 v20, s27, v54
    v_dot2c_f32_bf16 v22, v54, v54
    v_mfma_f32_32x32x16_bf16 v[112:127], v[52:55], v[60:63], v[112:127]
    ds_read_b128 v[44:47], v4 offset:37888
    v_dot2c_f32_bf16 v21, s27, v55
    v_mfma_f32_32x32x16_bf16 v[144:159], v[60:63], v[52:55], v[144:159]
    v_dot2c_f32_bf16 v23, v55, v55
    s_waitcnt lgkmcnt(0)
    v_mfma_f32_32x32x16_bf16 v[64:79], v[32:35], v[40:43], v[64:79]
    v_dot2c_f32_bf16 v20, s27, v36
    v_dot2c_f32_bf16 v22, v36, v36
    v_mfma_f32_32x32x16_bf16 v[96:111], v[32:35], v[44:47], v[96:111]
    ds_read_b128 v[48:51], v9 offset:32768
    v_dot2c_f32_bf16 v21, s27, v37
    v_mfma_f32_32x32x16_bf16 v[128:143], v[44:47], v[32:35], v[128:143]
    ds_read_b128 v[52:55], v9 offset:36864
    v_dot2c_f32_bf16 v23, v37, v37
    v_mfma_f32_32x32x16_bf16 v[80:95], v[36:39], v[40:43], v[80:95]
    ds_read_b128 v[56:59], v4 offset:38912
    v_dot2c_f32_bf16 v20, s27, v38
    v_dot2c_f32_bf16 v22, v38, v38
    v_mfma_f32_32x32x16_bf16 v[112:127], v[36:39], v[44:47], v[112:127]
    ds_read_b128 v[60:63], v4 offset:39936
    v_dot2c_f32_bf16 v21, s27, v39
    v_mfma_f32_32x32x16_bf16 v[144:159], v[44:47], v[36:39], v[144:159]
    v_dot2c_f32_bf16 v23, v39, v39
    s_waitcnt vmcnt(26)
    s_barrier
    s_waitcnt lgkmcnt(0)
    v_mfma_f32_32x32x16_bf16 v[64:79], v[48:51], v[56:59], v[64:79]
    v_dot2c_f32_bf16 v20, s27, v52
    v_dot2c_f32_bf16 v22, v52, v52
    s_lshl_b32 s28, s13, 12
    s_mov_b32 m0, s28
    s_add_u32 s29, s24, 512
    buffer_load_dwordx4 v2, s[16:19], s29 offen offset:0 lds
    v_mfma_f32_32x32x16_bf16 v[96:111], v[48:51], v[60:63], v[96:111]
    ds_read_b128 v[32:35], v10 offset:0
    v_dot2c_f32_bf16 v21, s27, v53
    s_add_u32 s29, s29, 9216
    buffer_load_dwordx4 v3, s[16:19], s29 offen offset:1024 lds
    v_mfma_f32_32x32x16_bf16 v[128:143], v[60:63], v[48:51], v[128:143]
    ds_read_b128 v[36:39], v10 offset:4096
    v_dot2c_f32_bf16 v23, v53, v53
    s_add_u32 s29, s29, 9216
    buffer_load_dwordx4 v2, s[16:19], s29 offen offset:2048 lds
    v_mfma_f32_32x32x16_bf16 v[80:95], v[52:55], v[56:59], v[80:95]
    ds_read_b128 v[40:43], v5 offset:0
    v_dot2c_f32_bf16 v20, s27, v54
    v_dot2c_f32_bf16 v22, v54, v54
    s_add_u32 s29, s29, 9216
    buffer_load_dwordx4 v3, s[16:19], s29 offen offset:3072 lds
    v_mfma_f32_32x32x16_bf16 v[112:127], v[52:55], v[60:63], v[112:127]
    ds_read_b128 v[44:47], v5 offset:1024
    v_dot2c_f32_bf16 v21, s27, v55
    s_add_u32 s28, s28, 16384
    s_mov_b32 m0, s28
    s_add_u32 s29, s25, 32768
    buffer_load_dwordx4 v1, s[8:11], s29 offen offset:0 lds
    v_mfma_f32_32x32x16_bf16 v[144:159], v[60:63], v[52:55], v[144:159]
    v_dot2c_f32_bf16 v23, v55, v55
    buffer_load_dwordx4 v1, s[8:11], s29 offen offset:1024 lds
    s_waitcnt lgkmcnt(0)
    v_mfma_f32_32x32x16_bf16 v[64:79], v[32:35], v[40:43], v[64:79]
    v_dot2c_f32_bf16 v20, s27, v36
    v_dot2c_f32_bf16 v22, v36, v36
    buffer_load_dwordx4 v1, s[8:11], s29 offen offset:2048 lds
    v_mfma_f32_32x32x16_bf16 v[96:111], v[32:35], v[44:47], v[96:111]
    ds_read_b128 v[48:51], v11 offset:0
    v_dot2c_f32_bf16 v21, s27, v37
    buffer_load_dwordx4 v1, s[8:11], s29 offen offset:3072 lds
    v_mfma_f32_32x32x16_bf16 v[128:143], v[44:47], v[32:35], v[128:143]
    ds_read_b128 v[52:55], v11 offset:4096
    v_dot2c_f32_bf16 v23, v37, v37
    s_bfe_u32 s41, s52, 524296
    s_mul_i32 s41, s41, s40
    s_add_u32 s42, s58, s41
    s_add_u32 s43, s59, s41
    buffer_load_dwordx4 a[72:75], v240, s[8:11], s42 offen
    v_mfma_f32_32x32x16_bf16 v[80:95], v[36:39], v[40:43], v[80:95]
    ds_read_b128 v[56:59], v5 offset:2048
    v_dot2c_f32_bf16 v20, s27, v38
    v_dot2c_f32_bf16 v22, v38, v38
    buffer_load_dwordx4 a[76:79], v241, s[8:11], s43 offen
    v_mfma_f32_32x32x16_bf16 v[112:127], v[36:39], v[44:47], v[112:127]
    ds_read_b128 v[60:63], v5 offset:3072
    v_dot2c_f32_bf16 v21, s27, v39
    s_bfe_u32 s41, s52, 524304
    s_mul_i32 s41, s41, s40
    s_add_u32 s42, s58, s41
    s_add_u32 s43, s59, s41
    buffer_load_dwordx4 a[80:83], v240, s[8:11], s42 offen
    v_mfma_f32_32x32x16_bf16 v[144:159], v[44:47], v[36:39], v[144:159]
    v_dot2c_f32_bf16 v23, v39, v39
    buffer_load_dwordx4 a[84:87], v241, s[8:11], s43 offen
    s_waitcnt lgkmcnt(0)
    v_mfma_f32_32x32x16_bf16 v[64:79], v[48:51], v[56:59], v[64:79]
    v_dot2c_f32_bf16 v20, s27, v52
    v_dot2c_f32_bf16 v22, v52, v52
    v_mfma_f32_32x32x16_bf16 v[96:111], v[48:51], v[60:63], v[96:111]
    ds_read_b128 v[32:35], v12 offset:0
    v_dot2c_f32_bf16 v21, s27, v53
    v_mfma_f32_32x32x16_bf16 v[128:143], v[60:63], v[48:51], v[128:143]
    ds_read_b128 v[36:39], v12 offset:4096
    v_dot2c_f32_bf16 v23, v53, v53
    v_mfma_f32_32x32x16_bf16 v[80:95], v[52:55], v[56:59], v[80:95]
    ds_read_b128 v[40:43], v5 offset:4096
    v_dot2c_f32_bf16 v20, s27, v54
    v_dot2c_f32_bf16 v22, v54, v54
    v_mfma_f32_32x32x16_bf16 v[112:127], v[52:55], v[60:63], v[112:127]
    ds_read_b128 v[44:47], v5 offset:5120
    v_dot2c_f32_bf16 v21, s27, v55
    v_mfma_f32_32x32x16_bf16 v[144:159], v[60:63], v[52:55], v[144:159]
    v_dot2c_f32_bf16 v23, v55, v55
    s_waitcnt lgkmcnt(0)
    v_mfma_f32_32x32x16_bf16 v[64:79], v[32:35], v[40:43], v[64:79]
    v_dot2c_f32_bf16 v20, s27, v36
    v_dot2c_f32_bf16 v22, v36, v36
    v_mfma_f32_32x32x16_bf16 v[96:111], v[32:35], v[44:47], v[96:111]
    ds_read_b128 v[48:51], v13 offset:0
    v_dot2c_f32_bf16 v21, s27, v37
    v_mfma_f32_32x32x16_bf16 v[128:143], v[44:47], v[32:35], v[128:143]
    ds_read_b128 v[52:55], v13 offset:4096
    v_dot2c_f32_bf16 v23, v37, v37
    v_mfma_f32_32x32x16_bf16 v[80:95], v[36:39], v[40:43], v[80:95]
    ds_read_b128 v[56:59], v5 offset:6144
    v_dot2c_f32_bf16 v20, s27, v38
    v_dot2c_f32_bf16 v22, v38, v38
    v_mfma_f32_32x32x16_bf16 v[112:127], v[36:39], v[44:47], v[112:127]
    ds_read_b128 v[60:63], v5 offset:7168
    v_dot2c_f32_bf16 v21, s27, v39
    v_mfma_f32_32x32x16_bf16 v[144:159], v[44:47], v[36:39], v[144:159]
    v_dot2c_f32_bf16 v23, v39, v39
    s_waitcnt vmcnt(16)
    s_barrier
    s_waitcnt lgkmcnt(0)
    v_mfma_f32_32x32x16_bf16 v[64:79], v[48:51], v[56:59], v[64:79]
    v_dot2c_f32_bf16 v20, s27, v52
    v_dot2c_f32_bf16 v22, v52, v52
    s_lshl_b32 s28, s13, 12
    s_add_u32 s28, s28, 32768
    s_mov_b32 m0, s28
    s_add_u32 s29, s24, 640
    buffer_load_dwordx4 v2, s[16:19], s29 offen offset:0 lds
    v_mfma_f32_32x32x16_bf16 v[96:111], v[48:51], v[60:63], v[96:111]
    ds_read_b128 v[32:35], v10 offset:32768
    v_dot2c_f32_bf16 v21, s27, v53
    s_add_u32 s29, s29, 9216
    buffer_load_dwordx4 v3, s[16:19], s29 offen offset:1024 lds
    v_mfma_f32_32x32x16_bf16 v[128:143], v[60:63], v[48:51], v[128:143]
    ds_read_b128 v[36:39], v10 offset:36864
    v_dot2c_f32_bf16 v23, v53, v53
    s_add_u32 s29, s29, 9216
    buffer_load_dwordx4 v2, s[16:19], s29 offen offset:2048 lds
    v_mfma_f32_32x32x16_bf16 v[80:95], v[52:55], v[56:59], v[80:95]
    ds_read_b128 v[40:43], v5 offset:32768
    v_dot2c_f32_bf16 v20, s27, v54
    v_dot2c_f32_bf16 v22, v54, v54
    s_add_u32 s29, s29, 9216
    buffer_load_dwordx4 v3, s[16:19], s29 offen offset:3072 lds
    v_mfma_f32_32x32x16_bf16 v[112:127], v[52:55], v[60:63], v[112:127]
    ds_read_b128 v[44:47], v5 offset:33792
    v_dot2c_f32_bf16 v21, s27, v55
    s_add_u32 s28, s28, 16384
    s_mov_b32 m0, s28
    s_add_u32 s29, s25, 40960
    buffer_load_dwordx4 v1, s[8:11], s29 offen offset:0 lds
    v_mfma_f32_32x32x16_bf16 v[144:159], v[60:63], v[52:55], v[144:159]
    v_dot2c_f32_bf16 v23, v55, v55
    buffer_load_dwordx4 v1, s[8:11], s29 offen offset:1024 lds
    s_waitcnt lgkmcnt(0)
    v_mfma_f32_32x32x16_bf16 v[64:79], v[32:35], v[40:43], v[64:79]
    v_dot2c_f32_bf16 v20, s27, v36
    v_dot2c_f32_bf16 v22, v36, v36
    buffer_load_dwordx4 v1, s[8:11], s29 offen offset:2048 lds
    v_mfma_f32_32x32x16_bf16 v[96:111], v[32:35], v[44:47], v[96:111]
    ds_read_b128 v[48:51], v11 offset:32768
    v_dot2c_f32_bf16 v21, s27, v37
    buffer_load_dwordx4 v1, s[8:11], s29 offen offset:3072 lds
    v_mfma_f32_32x32x16_bf16 v[128:143], v[44:47], v[32:35], v[128:143]
    ds_read_b128 v[52:55], v11 offset:36864
    v_dot2c_f32_bf16 v23, v37, v37
    s_bfe_u32 s41, s52, 524312
    s_mul_i32 s41, s41, s40
    s_add_u32 s42, s58, s41
    s_add_u32 s43, s59, s41
    buffer_load_dwordx4 a[88:91], v240, s[8:11], s42 offen
    v_mfma_f32_32x32x16_bf16 v[80:95], v[36:39], v[40:43], v[80:95]
    ds_read_b128 v[56:59], v5 offset:34816
    v_dot2c_f32_bf16 v20, s27, v38
    v_dot2c_f32_bf16 v22, v38, v38
    buffer_load_dwordx4 a[92:95], v241, s[8:11], s43 offen
    v_mfma_f32_32x32x16_bf16 v[112:127], v[36:39], v[44:47], v[112:127]
    ds_read_b128 v[60:63], v5 offset:35840
    v_dot2c_f32_bf16 v21, s27, v39
    s_bfe_u32 s41, s53, 524288
    s_mul_i32 s41, s41, s40
    s_add_u32 s42, s58, s41
    s_add_u32 s43, s59, s41
    buffer_load_dwordx4 a[96:99], v240, s[8:11], s42 offen
    v_mfma_f32_32x32x16_bf16 v[144:159], v[44:47], v[36:39], v[144:159]
    v_dot2c_f32_bf16 v23, v39, v39
    buffer_load_dwordx4 a[100:103], v241, s[8:11], s43 offen
    s_waitcnt lgkmcnt(0)
    v_mfma_f32_32x32x16_bf16 v[64:79], v[48:51], v[56:59], v[64:79]
    v_dot2c_f32_bf16 v20, s27, v52
    v_dot2c_f32_bf16 v22, v52, v52
    v_mfma_f32_32x32x16_bf16 v[96:111], v[48:51], v[60:63], v[96:111]
    ds_read_b128 v[32:35], v12 offset:32768
    v_dot2c_f32_bf16 v21, s27, v53
    v_mfma_f32_32x32x16_bf16 v[128:143], v[60:63], v[48:51], v[128:143]
    ds_read_b128 v[36:39], v12 offset:36864
    v_dot2c_f32_bf16 v23, v53, v53
    v_mfma_f32_32x32x16_bf16 v[80:95], v[52:55], v[56:59], v[80:95]
    ds_read_b128 v[40:43], v5 offset:36864
    v_dot2c_f32_bf16 v20, s27, v54
    v_dot2c_f32_bf16 v22, v54, v54
    v_mfma_f32_32x32x16_bf16 v[112:127], v[52:55], v[60:63], v[112:127]
    ds_read_b128 v[44:47], v5 offset:37888
    v_dot2c_f32_bf16 v21, s27, v55
    v_mfma_f32_32x32x16_bf16 v[144:159], v[60:63], v[52:55], v[144:159]
    v_dot2c_f32_bf16 v23, v55, v55
    s_waitcnt lgkmcnt(0)
    v_mfma_f32_32x32x16_bf16 v[64:79], v[32:35], v[40:43], v[64:79]
    v_dot2c_f32_bf16 v20, s27, v36
    v_dot2c_f32_bf16 v22, v36, v36
    v_mfma_f32_32x32x16_bf16 v[96:111], v[32:35], v[44:47], v[96:111]
    ds_read_b128 v[48:51], v13 offset:32768
    v_dot2c_f32_bf16 v21, s27, v37
    v_mfma_f32_32x32x16_bf16 v[128:143], v[44:47], v[32:35], v[128:143]
    ds_read_b128 v[52:55], v13 offset:36864
    v_dot2c_f32_bf16 v23, v37, v37
    v_mfma_f32_32x32x16_bf16 v[80:95], v[36:39], v[40:43], v[80:95]
    ds_read_b128 v[56:59], v5 offset:38912
    v_dot2c_f32_bf16 v20, s27, v38
    v_dot2c_f32_bf16 v22, v38, v38
    v_mfma_f32_32x32x16_bf16 v[112:127], v[36:39], v[44:47], v[112:127]
    ds_read_b128 v[60:63], v5 offset:39936
    v_dot2c_f32_bf16 v21, s27, v39
    v_mfma_f32_32x32x16_bf16 v[144:159], v[44:47], v[36:39], v[144:159]
    v_dot2c_f32_bf16 v23, v39, v39
    s_waitcnt vmcnt(16)
    s_barrier
    s_waitcnt lgkmcnt(0)
    v_mfma_f32_32x32x16_bf16 v[64:79], v[48:51], v[56:59], v[64:79]
    v_dot2c_f32_bf16 v20, s27, v52
    v_dot2c_f32_bf16 v22, v52, v52
    s_lshl_b32 s28, s13, 12
    s_add_u32 s28, s28, 65536
    s_mov_b32 m0, s28
    s_add_u32 s29, s24, 768
    buffer_load_dwordx4 v2, s[16:19], s29 offen offset:0 lds
    v_mfma_f32_32x32x16_bf16 v[96:111], v[48:51], v[60:63], v[96:111]
    ds_read_b128 v[32:35], v6 offset:0
    v_dot2c_f32_bf16 v21, s27, v53
    s_add_u32 s29, s29, 9216
    buffer_load_dwordx4 v3, s[16:19], s29 offen offset:1024 lds
    v_mfma_f32_32x32x16_bf16 v[128:143], v[60:63], v[48:51], v[128:143]
    ds_read_b128 v[36:39], v6 offset:4096
    v_dot2c_f32_bf16 v23, v53, v53
    s_add_u32 s29, s29, 9216
    buffer_load_dwordx4 v2, s[16:19], s29 offen offset:2048 lds
    v_mfma_f32_32x32x16_bf16 v[80:95], v[52:55], v[56:59], v[80:95]
    ds_read_b128 v[40:43], v4 offset:0
    v_dot2c_f32_bf16 v20, s27, v54
    v_dot2c_f32_bf16 v22, v54, v54
    s_add_u32 s29, s29, 9216
    buffer_load_dwordx4 v3, s[16:19], s29 offen offset:3072 lds
    v_mfma_f32_32x32x16_bf16 v[112:127], v[52:55], v[60:63], v[112:127]
    ds_read_b128 v[44:47], v4 offset:1024
    v_dot2c_f32_bf16 v21, s27, v55
    s_add_u32 s28, s28, 16384
    s_mov_b32 m0, s28
    s_add_u32 s29, s25, 49152
    buffer_load_dwordx4 v1, s[8:11], s29 offen offset:0 lds
    v_mfma_f32_32x32x16_bf16 v[144:159], v[60:63], v[52:55], v[144:159]
    v_dot2c_f32_bf16 v23, v55, v55
    buffer_load_dwordx4 v1, s[8:11], s29 offen offset:1024 lds
    s_waitcnt lgkmcnt(0)
    v_mfma_f32_32x32x16_bf16 v[64:79], v[32:35], v[40:43], v[64:79]
    v_dot2c_f32_bf16 v20, s27, v36
    v_dot2c_f32_bf16 v22, v36, v36
    buffer_load_dwordx4 v1, s[8:11], s29 offen offset:2048 lds
    v_mfma_f32_32x32x16_bf16 v[96:111], v[32:35], v[44:47], v[96:111]
    ds_read_b128 v[48:51], v7 offset:0
    v_dot2c_f32_bf16 v21, s27, v37
    buffer_load_dwordx4 v1, s[8:11], s29 offen offset:3072 lds
    v_mfma_f32_32x32x16_bf16 v[128:143], v[44:47], v[32:35], v[128:143]
    ds_read_b128 v[52:55], v7 offset:4096
    v_dot2c_f32_bf16 v23, v37, v37
    s_bfe_u32 s41, s53, 524296
    s_mul_i32 s41, s41, s40
    s_add_u32 s42, s58, s41
    s_add_u32 s43, s59, s41
    buffer_load_dwordx4 a[104:107], v240, s[8:11], s42 offen
    v_mfma_f32_32x32x16_bf16 v[80:95], v[36:39], v[40:43], v[80:95]
    ds_read_b128 v[56:59], v4 offset:2048
    v_dot2c_f32_bf16 v20, s27, v38
    v_dot2c_f32_bf16 v22, v38, v38
    buffer_load_dwordx4 a[108:111], v241, s[8:11], s43 offen
    v_mfma_f32_32x32x16_bf16 v[112:127], v[36:39], v[44:47], v[112:127]
    ds_read_b128 v[60:63], v4 offset:3072
    v_dot2c_f32_bf16 v21, s27, v39
    s_bfe_u32 s41, s53, 524304
    s_mul_i32 s41, s41, s40
    s_add_u32 s42, s58, s41
    s_add_u32 s43, s59, s41
    buffer_load_dwordx4 a[112:115], v240, s[8:11], s42 offen
    v_mfma_f32_32x32x16_bf16 v[144:159], v[44:47], v[36:39], v[144:159]
    v_dot2c_f32_bf16 v23, v39, v39
    buffer_load_dwordx4 a[116:119], v241, s[8:11], s43 offen
    s_waitcnt lgkmcnt(0)
    v_mfma_f32_32x32x16_bf16 v[64:79], v[48:51], v[56:59], v[64:79]
    v_dot2c_f32_bf16 v20, s27, v52
    v_dot2c_f32_bf16 v22, v52, v52
    v_mfma_f32_32x32x16_bf16 v[96:111], v[48:51], v[60:63], v[96:111]
    ds_read_b128 v[32:35], v8 offset:0
    v_dot2c_f32_bf16 v21, s27, v53
    v_mfma_f32_32x32x16_bf16 v[128:143], v[60:63], v[48:51], v[128:143]
    ds_read_b128 v[36:39], v8 offset:4096
    v_dot2c_f32_bf16 v23, v53, v53
    v_mfma_f32_32x32x16_bf16 v[80:95], v[52:55], v[56:59], v[80:95]
    ds_read_b128 v[40:43], v4 offset:4096
    v_dot2c_f32_bf16 v20, s27, v54
    v_dot2c_f32_bf16 v22, v54, v54
    v_mfma_f32_32x32x16_bf16 v[112:127], v[52:55], v[60:63], v[112:127]
    ds_read_b128 v[44:47], v4 offset:5120
    v_dot2c_f32_bf16 v21, s27, v55
    v_mfma_f32_32x32x16_bf16 v[144:159], v[60:63], v[52:55], v[144:159]
    v_dot2c_f32_bf16 v23, v55, v55
    s_waitcnt lgkmcnt(0)
    v_mfma_f32_32x32x16_bf16 v[64:79], v[32:35], v[40:43], v[64:79]
    v_dot2c_f32_bf16 v20, s27, v36
    v_dot2c_f32_bf16 v22, v36, v36
    v_mfma_f32_32x32x16_bf16 v[96:111], v[32:35], v[44:47], v[96:111]
    ds_read_b128 v[48:51], v9 offset:0
    v_dot2c_f32_bf16 v21, s27, v37
    v_mfma_f32_32x32x16_bf16 v[128:143], v[44:47], v[32:35], v[128:143]
    ds_read_b128 v[52:55], v9 offset:4096
    v_dot2c_f32_bf16 v23, v37, v37
    v_mfma_f32_32x32x16_bf16 v[80:95], v[36:39], v[40:43], v[80:95]
    ds_read_b128 v[56:59], v4 offset:6144
    v_dot2c_f32_bf16 v20, s27, v38
    v_dot2c_f32_bf16 v22, v38, v38
    v_mfma_f32_32x32x16_bf16 v[112:127], v[36:39], v[44:47], v[112:127]
    ds_read_b128 v[60:63], v4 offset:7168
    v_dot2c_f32_bf16 v21, s27, v39
    v_mfma_f32_32x32x16_bf16 v[144:159], v[44:47], v[36:39], v[144:159]
    v_dot2c_f32_bf16 v23, v39, v39
    s_waitcnt vmcnt(16)
    s_barrier
    s_waitcnt lgkmcnt(0)
    v_mfma_f32_32x32x16_bf16 v[64:79], v[48:51], v[56:59], v[64:79]
    v_dot2c_f32_bf16 v20, s27, v52
    v_dot2c_f32_bf16 v22, v52, v52
    s_lshl_b32 s28, s13, 12
    s_add_u32 s28, s28, 98304
    s_mov_b32 m0, s28
    s_add_u32 s29, s24, 896
    buffer_load_dwordx4 v2, s[16:19], s29 offen offset:0 lds
    v_mfma_f32_32x32x16_bf16 v[96:111], v[48:51], v[60:63], v[96:111]
    ds_read_b128 v[32:35], v6 offset:32768
    v_dot2c_f32_bf16 v21, s27, v53
    s_add_u32 s29, s29, 9216
    buffer_load_dwordx4 v3, s[16:19], s29 offen offset:1024 lds
    v_mfma_f32_32x32x16_bf16 v[128:143], v[60:63], v[48:51], v[128:143]
    ds_read_b128 v[36:39], v6 offset:36864
    v_dot2c_f32_bf16 v23, v53, v53
    s_add_u32 s29, s29, 9216
    buffer_load_dwordx4 v2, s[16:19], s29 offen offset:2048 lds
    v_mfma_f32_32x32x16_bf16 v[80:95], v[52:55], v[56:59], v[80:95]
    ds_read_b128 v[40:43], v4 offset:32768
    v_dot2c_f32_bf16 v20, s27, v54
    v_dot2c_f32_bf16 v22, v54, v54
    s_add_u32 s29, s29, 9216
    buffer_load_dwordx4 v3, s[16:19], s29 offen offset:3072 lds
    v_mfma_f32_32x32x16_bf16 v[112:127], v[52:55], v[60:63], v[112:127]
    ds_read_b128 v[44:47], v4 offset:33792
    v_dot2c_f32_bf16 v21, s27, v55
    s_add_u32 s28, s28, 16384
    s_mov_b32 m0, s28
    s_add_u32 s29, s25, 57344
    buffer_load_dwordx4 v1, s[8:11], s29 offen offset:0 lds
    v_mfma_f32_32x32x16_bf16 v[144:159], v[60:63], v[52:55], v[144:159]
    v_dot2c_f32_bf16 v23, v55, v55
    buffer_load_dwordx4 v1, s[8:11], s29 offen offset:1024 lds
    s_waitcnt lgkmcnt(0)
    v_mfma_f32_32x32x16_bf16 v[64:79], v[32:35], v[40:43], v[64:79]
    v_dot2c_f32_bf16 v20, s27, v36
    v_dot2c_f32_bf16 v22, v36, v36
    buffer_load_dwordx4 v1, s[8:11], s29 offen offset:2048 lds
    v_mfma_f32_32x32x16_bf16 v[96:111], v[32:35], v[44:47], v[96:111]
    ds_read_b128 v[48:51], v7 offset:32768
    v_dot2c_f32_bf16 v21, s27, v37
    buffer_load_dwordx4 v1, s[8:11], s29 offen offset:3072 lds
    v_mfma_f32_32x32x16_bf16 v[128:143], v[44:47], v[32:35], v[128:143]
    ds_read_b128 v[52:55], v7 offset:36864
    v_dot2c_f32_bf16 v23, v37, v37
    s_bfe_u32 s41, s53, 524312
    s_mul_i32 s41, s41, s40
    s_add_u32 s42, s58, s41
    s_add_u32 s43, s59, s41
    buffer_load_dwordx4 a[120:123], v240, s[8:11], s42 offen
    v_mfma_f32_32x32x16_bf16 v[80:95], v[36:39], v[40:43], v[80:95]
    ds_read_b128 v[56:59], v4 offset:34816
    v_dot2c_f32_bf16 v20, s27, v38
    v_dot2c_f32_bf16 v22, v38, v38
    buffer_load_dwordx4 a[124:127], v241, s[8:11], s43 offen
    v_mfma_f32_32x32x16_bf16 v[112:127], v[36:39], v[44:47], v[112:127]
    ds_read_b128 v[60:63], v4 offset:35840
    v_dot2c_f32_bf16 v21, s27, v39
    s_bfe_u32 s41, s54, 524288
    s_mul_i32 s41, s41, s40
    s_add_u32 s42, s58, s41
    s_add_u32 s43, s59, s41
    buffer_load_dwordx4 a[128:131], v240, s[8:11], s42 offen
    v_mfma_f32_32x32x16_bf16 v[144:159], v[44:47], v[36:39], v[144:159]
    v_dot2c_f32_bf16 v23, v39, v39
    buffer_load_dwordx4 a[132:135], v241, s[8:11], s43 offen
    s_waitcnt lgkmcnt(0)
    v_mfma_f32_32x32x16_bf16 v[64:79], v[48:51], v[56:59], v[64:79]
    v_dot2c_f32_bf16 v20, s27, v52
    v_dot2c_f32_bf16 v22, v52, v52
    v_mfma_f32_32x32x16_bf16 v[96:111], v[48:51], v[60:63], v[96:111]
    ds_read_b128 v[32:35], v8 offset:32768
    v_dot2c_f32_bf16 v21, s27, v53
    v_mfma_f32_32x32x16_bf16 v[128:143], v[60:63], v[48:51], v[128:143]
    ds_read_b128 v[36:39], v8 offset:36864
    v_dot2c_f32_bf16 v23, v53, v53
    v_mfma_f32_32x32x16_bf16 v[80:95], v[52:55], v[56:59], v[80:95]
    ds_read_b128 v[40:43], v4 offset:36864
    v_dot2c_f32_bf16 v20, s27, v54
    v_dot2c_f32_bf16 v22, v54, v54
    v_mfma_f32_32x32x16_bf16 v[112:127], v[52:55], v[60:63], v[112:127]
    ds_read_b128 v[44:47], v4 offset:37888
    v_dot2c_f32_bf16 v21, s27, v55
    v_mfma_f32_32x32x16_bf16 v[144:159], v[60:63], v[52:55], v[144:159]
    v_dot2c_f32_bf16 v23, v55, v55
    s_waitcnt lgkmcnt(0)
    v_mfma_f32_32x32x16_bf16 v[64:79], v[32:35], v[40:43], v[64:79]
    v_dot2c_f32_bf16 v20, s27, v36
    v_dot2c_f32_bf16 v22, v36, v36
    v_mfma_f32_32x32x16_bf16 v[96:111], v[32:35], v[44:47], v[96:111]
    ds_read_b128 v[48:51], v9 offset:32768
    v_dot2c_f32_bf16 v21, s27, v37
    v_mfma_f32_32x32x16_bf16 v[128:143], v[44:47], v[32:35], v[128:143]
    ds_read_b128 v[52:55], v9 offset:36864
    v_dot2c_f32_bf16 v23, v37, v37
    v_mfma_f32_32x32x16_bf16 v[80:95], v[36:39], v[40:43], v[80:95]
    ds_read_b128 v[56:59], v4 offset:38912
    v_dot2c_f32_bf16 v20, s27, v38
    v_dot2c_f32_bf16 v22, v38, v38
    v_mfma_f32_32x32x16_bf16 v[112:127], v[36:39], v[44:47], v[112:127]
    ds_read_b128 v[60:63], v4 offset:39936
    v_dot2c_f32_bf16 v21, s27, v39
    v_mfma_f32_32x32x16_bf16 v[144:159], v[44:47], v[36:39], v[144:159]
    v_dot2c_f32_bf16 v23, v39, v39
    s_waitcnt vmcnt(16)
    s_barrier
    s_waitcnt lgkmcnt(0)
    v_mfma_f32_32x32x16_bf16 v[64:79], v[48:51], v[56:59], v[64:79]
    v_dot2c_f32_bf16 v20, s27, v52
    v_dot2c_f32_bf16 v22, v52, v52
    s_lshl_b32 s28, s13, 12
    s_mov_b32 m0, s28
    s_add_u32 s29, s24, 1024
    buffer_load_dwordx4 v2, s[16:19], s29 offen offset:0 lds
    v_mfma_f32_32x32x16_bf16 v[96:111], v[48:51], v[60:63], v[96:111]
    ds_read_b128 v[32:35], v10 offset:0
    v_dot2c_f32_bf16 v21, s27, v53
    s_add_u32 s29, s29, 9216
    buffer_load_dwordx4 v3, s[16:19], s29 offen offset:1024 lds
    v_mfma_f32_32x32x16_bf16 v[128:143], v[60:63], v[48:51], v[128:143]
    ds_read_b128 v[36:39], v10 offset:4096
    v_dot2c_f32_bf16 v23, v53, v53
    s_add_u32 s29, s29, 9216
    buffer_load_dwordx4 v2, s[16:19], s29 offen offset:2048 lds
    v_mfma_f32_32x32x16_bf16 v[80:95], v[52:55], v[56:59], v[80:95]
    ds_read_b128 v[40:43], v5 offset:0
    v_dot2c_f32_bf16 v20, s27, v54
    v_dot2c_f32_bf16 v22, v54, v54
    s_add_u32 s29, s29, 9216
    buffer_load_dwordx4 v3, s[16:19], s29 offen offset:3072 lds
    v_mfma_f32_32x32x16_bf16 v[112:127], v[52:55], v[60:63], v[112:127]
    ds_read_b128 v[44:47], v5 offset:1024
    v_dot2c_f32_bf16 v21, s27, v55
    s_add_u32 s28, s28, 16384
    s_mov_b32 m0, s28
    s_add_u32 s29, s25, 65536
    buffer_load_dwordx4 v1, s[8:11], s29 offen offset:0 lds
    v_mfma_f32_32x32x16_bf16 v[144:159], v[60:63], v[52:55], v[144:159]
    v_dot2c_f32_bf16 v23, v55, v55
    buffer_load_dwordx4 v1, s[8:11], s29 offen offset:1024 lds
    s_waitcnt lgkmcnt(0)
    v_mfma_f32_32x32x16_bf16 v[64:79], v[32:35], v[40:43], v[64:79]
    v_dot2c_f32_bf16 v20, s27, v36
    v_dot2c_f32_bf16 v22, v36, v36
    buffer_load_dwordx4 v1, s[8:11], s29 offen offset:2048 lds
    v_mfma_f32_32x32x16_bf16 v[96:111], v[32:35], v[44:47], v[96:111]
    ds_read_b128 v[48:51], v11 offset:0
    v_dot2c_f32_bf16 v21, s27, v37
    buffer_load_dwordx4 v1, s[8:11], s29 offen offset:3072 lds
    v_mfma_f32_32x32x16_bf16 v[128:143], v[44:47], v[32:35], v[128:143]
    ds_read_b128 v[52:55], v11 offset:4096
    v_dot2c_f32_bf16 v23, v37, v37
    s_bfe_u32 s41, s54, 524296
    s_mul_i32 s41, s41, s40
    s_add_u32 s42, s58, s41
    s_add_u32 s43, s59, s41
    buffer_load_dwordx4 a[136:139], v240, s[8:11], s42 offen
    v_mfma_f32_32x32x16_bf16 v[80:95], v[36:39], v[40:43], v[80:95]
    ds_read_b128 v[56:59], v5 offset:2048
    v_dot2c_f32_bf16 v20, s27, v38
    v_dot2c_f32_bf16 v22, v38, v38
    buffer_load_dwordx4 a[140:143], v241, s[8:11], s43 offen
    v_mfma_f32_32x32x16_bf16 v[112:127], v[36:39], v[44:47], v[112:127]
    ds_read_b128 v[60:63], v5 offset:3072
    v_dot2c_f32_bf16 v21, s27, v39
    s_bfe_u32 s41, s54, 524304
    s_mul_i32 s41, s41, s40
    s_add_u32 s42, s58, s41
    s_add_u32 s43, s59, s41
    buffer_load_dwordx4 a[144:147], v240, s[8:11], s42 offen
    v_mfma_f32_32x32x16_bf16 v[144:159], v[44:47], v[36:39], v[144:159]
    v_dot2c_f32_bf16 v23, v39, v39
    buffer_load_dwordx4 a[148:151], v241, s[8:11], s43 offen
    s_waitcnt lgkmcnt(0)
    v_mfma_f32_32x32x16_bf16 v[64:79], v[48:51], v[56:59], v[64:79]
    v_dot2c_f32_bf16 v20, s27, v52
    v_dot2c_f32_bf16 v22, v52, v52
    v_mfma_f32_32x32x16_bf16 v[96:111], v[48:51], v[60:63], v[96:111]
    ds_read_b128 v[32:35], v12 offset:0
    v_dot2c_f32_bf16 v21, s27, v53
    v_mfma_f32_32x32x16_bf16 v[128:143], v[60:63], v[48:51], v[128:143]
    ds_read_b128 v[36:39], v12 offset:4096
    v_dot2c_f32_bf16 v23, v53, v53
    v_mfma_f32_32x32x16_bf16 v[80:95], v[52:55], v[56:59], v[80:95]
    ds_read_b128 v[40:43], v5 offset:4096
    v_dot2c_f32_bf16 v20, s27, v54
    v_dot2c_f32_bf16 v22, v54, v54
    v_mfma_f32_32x32x16_bf16 v[112:127], v[52:55], v[60:63], v[112:127]
    ds_read_b128 v[44:47], v5 offset:5120
    v_dot2c_f32_bf16 v21, s27, v55
    v_mfma_f32_32x32x16_bf16 v[144:159], v[60:63], v[52:55], v[144:159]
    v_dot2c_f32_bf16 v23, v55, v55
    s_waitcnt lgkmcnt(0)
    v_mfma_f32_32x32x16_bf16 v[64:79], v[32:35], v[40:43], v[64:79]
    v_dot2c_f32_bf16 v20, s27, v36
    v_dot2c_f32_bf16 v22, v36, v36
    v_mfma_f32_32x32x16_bf16 v[96:111], v[32:35], v[44:47], v[96:111]
    ds_read_b128 v[48:51], v13 offset:0
    v_dot2c_f32_bf16 v21, s27, v37
    v_mfma_f32_32x32x16_bf16 v[128:143], v[44:47], v[32:35], v[128:143]
    ds_read_b128 v[52:55], v13 offset:4096
    v_dot2c_f32_bf16 v23, v37, v37
    v_mfma_f32_32x32x16_bf16 v[80:95], v[36:39], v[40:43], v[80:95]
    ds_read_b128 v[56:59], v5 offset:6144
    v_dot2c_f32_bf16 v20, s27, v38
    v_dot2c_f32_bf16 v22, v38, v38
    v_mfma_f32_32x32x16_bf16 v[112:127], v[36:39], v[44:47], v[112:127]
    ds_read_b128 v[60:63], v5 offset:7168
    v_dot2c_f32_bf16 v21, s27, v39
    v_mfma_f32_32x32x16_bf16 v[144:159], v[44:47], v[36:39], v[144:159]
    v_dot2c_f32_bf16 v23, v39, v39
    s_waitcnt vmcnt(16)
    s_barrier
    s_waitcnt lgkmcnt(0)
    v_mfma_f32_32x32x16_bf16 v[64:79], v[48:51], v[56:59], v[64:79]
    v_dot2c_f32_bf16 v20, s27, v52
    v_dot2c_f32_bf16 v22, v52, v52
    s_lshl_b32 s28, s13, 12
    s_add_u32 s28, s28, 32768
    s_mov_b32 m0, s28
    s_add_u32 s29, s24, 1152
    buffer_load_dwordx4 v2, s[16:19], s29 offen offset:0 lds
    v_mfma_f32_32x32x16_bf16 v[96:111], v[48:51], v[60:63], v[96:111]
    ds_read_b128 v[32:35], v10 offset:32768
    v_dot2c_f32_bf16 v21, s27, v53
    s_add_u32 s29, s29, 9216
    buffer_load_dwordx4 v3, s[16:19], s29 offen offset:1024 lds
    v_mfma_f32_32x32x16_bf16 v[128:143], v[60:63], v[48:51], v[128:143]
    ds_read_b128 v[36:39], v10 offset:36864
    v_dot2c_f32_bf16 v23, v53, v53
    s_add_u32 s29, s29, 9216
    buffer_load_dwordx4 v2, s[16:19], s29 offen offset:2048 lds
    v_mfma_f32_32x32x16_bf16 v[80:95], v[52:55], v[56:59], v[80:95]
    ds_read_b128 v[40:43], v5 offset:32768
    v_dot2c_f32_bf16 v20, s27, v54
    v_dot2c_f32_bf16 v22, v54, v54
    s_add_u32 s29, s29, 9216
    buffer_load_dwordx4 v3, s[16:19], s29 offen offset:3072 lds
    v_mfma_f32_32x32x16_bf16 v[112:127], v[52:55], v[60:63], v[112:127]
    ds_read_b128 v[44:47], v5 offset:33792
    v_dot2c_f32_bf16 v21, s27, v55
    s_add_u32 s28, s28, 16384
    s_mov_b32 m0, s28
    s_add_u32 s29, s25, 73728
    buffer_load_dwordx4 v1, s[8:11], s29 offen offset:0 lds
    v_mfma_f32_32x32x16_bf16 v[144:159], v[60:63], v[52:55], v[144:159]
    v_dot2c_f32_bf16 v23, v55, v55
    buffer_load_dwordx4 v1, s[8:11], s29 offen offset:1024 lds
    s_waitcnt lgkmcnt(0)
    v_mfma_f32_32x32x16_bf16 v[64:79], v[32:35], v[40:43], v[64:79]
    v_dot2c_f32_bf16 v20, s27, v36
    v_dot2c_f32_bf16 v22, v36, v36
    buffer_load_dwordx4 v1, s[8:11], s29 offen offset:2048 lds
    v_mfma_f32_32x32x16_bf16 v[96:111], v[32:35], v[44:47], v[96:111]
    ds_read_b128 v[48:51], v11 offset:32768
    v_dot2c_f32_bf16 v21, s27, v37
    buffer_load_dwordx4 v1, s[8:11], s29 offen offset:3072 lds
    v_mfma_f32_32x32x16_bf16 v[128:143], v[44:47], v[32:35], v[128:143]
    ds_read_b128 v[52:55], v11 offset:36864
    v_dot2c_f32_bf16 v23, v37, v37
    s_bfe_u32 s41, s54, 524312
    s_mul_i32 s41, s41, s40
    s_add_u32 s42, s58, s41
    s_add_u32 s43, s59, s41
    buffer_load_dwordx4 a[152:155], v240, s[8:11], s42 offen
    v_mfma_f32_32x32x16_bf16 v[80:95], v[36:39], v[40:43], v[80:95]
    ds_read_b128 v[56:59], v5 offset:34816
    v_dot2c_f32_bf16 v20, s27, v38
    v_dot2c_f32_bf16 v22, v38, v38
    buffer_load_dwordx4 a[156:159], v241, s[8:11], s43 offen
    v_mfma_f32_32x32x16_bf16 v[112:127], v[36:39], v[44:47], v[112:127]
    ds_read_b128 v[60:63], v5 offset:35840
    v_dot2c_f32_bf16 v21, s27, v39
    s_bfe_u32 s41, s55, 524288
    s_mul_i32 s41, s41, s40
    s_add_u32 s42, s58, s41
    s_add_u32 s43, s59, s41
    buffer_load_dwordx4 a[160:163], v240, s[8:11], s42 offen
    v_mfma_f32_32x32x16_bf16 v[144:159], v[44:47], v[36:39], v[144:159]
    v_dot2c_f32_bf16 v23, v39, v39
    buffer_load_dwordx4 a[164:167], v241, s[8:11], s43 offen
    s_waitcnt lgkmcnt(0)
    v_mfma_f32_32x32x16_bf16 v[64:79], v[48:51], v[56:59], v[64:79]
    v_dot2c_f32_bf16 v20, s27, v52
    v_dot2c_f32_bf16 v22, v52, v52
    v_mfma_f32_32x32x16_bf16 v[96:111], v[48:51], v[60:63], v[96:111]
    ds_read_b128 v[32:35], v12 offset:32768
    v_dot2c_f32_bf16 v21, s27, v53
    v_mfma_f32_32x32x16_bf16 v[128:143], v[60:63], v[48:51], v[128:143]
    ds_read_b128 v[36:39], v12 offset:36864
    v_dot2c_f32_bf16 v23, v53, v53
    v_mfma_f32_32x32x16_bf16 v[80:95], v[52:55], v[56:59], v[80:95]
    ds_read_b128 v[40:43], v5 offset:36864
    v_dot2c_f32_bf16 v20, s27, v54
    v_dot2c_f32_bf16 v22, v54, v54
    v_mfma_f32_32x32x16_bf16 v[112:127], v[52:55], v[60:63], v[112:127]
    ds_read_b128 v[44:47], v5 offset:37888
    v_dot2c_f32_bf16 v21, s27, v55
    v_mfma_f32_32x32x16_bf16 v[144:159], v[60:63], v[52:55], v[144:159]
    v_dot2c_f32_bf16 v23, v55, v55
    s_waitcnt lgkmcnt(0)
    v_mfma_f32_32x32x16_bf16 v[64:79], v[32:35], v[40:43], v[64:79]
    v_dot2c_f32_bf16 v20, s27, v36
    v_dot2c_f32_bf16 v22, v36, v36
    v_mfma_f32_32x32x16_bf16 v[96:111], v[32:35], v[44:47], v[96:111]
    ds_read_b128 v[48:51], v13 offset:32768
    v_dot2c_f32_bf16 v21, s27, v37
    v_mfma_f32_32x32x16_bf16 v[128:143], v[44:47], v[32:35], v[128:143]
    ds_read_b128 v[52:55], v13 offset:36864
    v_dot2c_f32_bf16 v23, v37, v37
    v_mfma_f32_32x32x16_bf16 v[80:95], v[36:39], v[40:43], v[80:95]
    ds_read_b128 v[56:59], v5 offset:38912
    v_dot2c_f32_bf16 v20, s27, v38
    v_dot2c_f32_bf16 v22, v38, v38
    v_mfma_f32_32x32x16_bf16 v[112:127], v[36:39], v[44:47], v[112:127]
    ds_read_b128 v[60:63], v5 offset:39936
    v_dot2c_f32_bf16 v21, s27, v39
    v_mfma_f32_32x32x16_bf16 v[144:159], v[44:47], v[36:39], v[144:159]
    v_dot2c_f32_bf16 v23, v39, v39
    s_waitcnt vmcnt(16)
    s_barrier
    s_waitcnt lgkmcnt(0)
    v_mfma_f32_32x32x16_bf16 v[64:79], v[48:51], v[56:59], v[64:79]
    v_dot2c_f32_bf16 v20, s27, v52
    v_dot2c_f32_bf16 v22, v52, v52
    s_bfe_u32 s41, s55, 524296
    s_mul_i32 s41, s41, s40
    s_add_u32 s42, s58, s41
    s_add_u32 s43, s59, s41
    buffer_load_dwordx4 a[168:171], v240, s[8:11], s42 offen
    v_mfma_f32_32x32x16_bf16 v[96:111], v[48:51], v[60:63], v[96:111]
    ds_read_b128 v[32:35], v6 offset:0
    v_dot2c_f32_bf16 v21, s27, v53
    buffer_load_dwordx4 a[172:175], v241, s[8:11], s43 offen
    v_mfma_f32_32x32x16_bf16 v[128:143], v[60:63], v[48:51], v[128:143]
    ds_read_b128 v[36:39], v6 offset:4096
    v_dot2c_f32_bf16 v23, v53, v53
    s_bfe_u32 s41, s55, 524304
    s_mul_i32 s41, s41, s40
    s_add_u32 s42, s58, s41
    s_add_u32 s43, s59, s41
    buffer_load_dwordx4 a[176:179], v240, s[8:11], s42 offen
    v_mfma_f32_32x32x16_bf16 v[80:95], v[52:55], v[56:59], v[80:95]
    ds_read_b128 v[40:43], v4 offset:0
    v_dot2c_f32_bf16 v20, s27, v54
    v_dot2c_f32_bf16 v22, v54, v54
    buffer_load_dwordx4 a[180:183], v241, s[8:11], s43 offen
    v_mfma_f32_32x32x16_bf16 v[112:127], v[52:55], v[60:63], v[112:127]
    ds_read_b128 v[44:47], v4 offset:1024
    v_dot2c_f32_bf16 v21, s27, v55
    s_bfe_u32 s41, s55, 524312
    s_mul_i32 s41, s41, s40
    s_add_u32 s42, s58, s41
    s_add_u32 s43, s59, s41
    buffer_load_dwordx4 a[184:187], v240, s[8:11], s42 offen
    v_mfma_f32_32x32x16_bf16 v[144:159], v[60:63], v[52:55], v[144:159]
    v_dot2c_f32_bf16 v23, v55, v55
    buffer_load_dwordx4 a[188:191], v241, s[8:11], s43 offen
    s_waitcnt lgkmcnt(0)
    v_mfma_f32_32x32x16_bf16 v[64:79], v[32:35], v[40:43], v[64:79]
    v_dot2c_f32_bf16 v20, s27, v36
    v_dot2c_f32_bf16 v22, v36, v36
    s_bfe_u32 s41, s56, 524288
    s_mul_i32 s41, s41, s40
    s_add_u32 s42, s58, s41
    s_add_u32 s43, s59, s41
    buffer_load_dwordx4 a[192:195], v240, s[8:11], s42 offen
    v_mfma_f32_32x32x16_bf16 v[96:111], v[32:35], v[44:47], v[96:111]
    ds_read_b128 v[48:51], v7 offset:0
    v_dot2c_f32_bf16 v21, s27, v37
    buffer_load_dwordx4 a[196:199], v241, s[8:11], s43 offen
    v_mfma_f32_32x32x16_bf16 v[128:143], v[44:47], v[32:35], v[128:143]
    ds_read_b128 v[52:55], v7 offset:4096
    v_dot2c_f32_bf16 v23, v37, v37
    v_mfma_f32_32x32x16_bf16 v[80:95], v[36:39], v[40:43], v[80:95]
    ds_read_b128 v[56:59], v4 offset:2048
    v_dot2c_f32_bf16 v20, s27, v38
    v_dot2c_f32_bf16 v22, v38, v38
    v_mfma_f32_32x32x16_bf16 v[112:127], v[36:39], v[44:47], v[112:127]
    ds_read_b128 v[60:63], v4 offset:3072
    v_dot2c_f32_bf16 v21, s27, v39
    v_mfma_f32_32x32x16_bf16 v[144:159], v[44:47], v[36:39], v[144:159]
    v_dot2c_f32_bf16 v23, v39, v39
    s_waitcnt lgkmcnt(0)
    v_mfma_f32_32x32x16_bf16 v[64:79], v[48:51], v[56:59], v[64:79]
    v_dot2c_f32_bf16 v20, s27, v52
    v_dot2c_f32_bf16 v22, v52, v52
    v_mfma_f32_32x32x16_bf16 v[96:111], v[48:51], v[60:63], v[96:111]
    ds_read_b128 v[32:35], v8 offset:0
    v_dot2c_f32_bf16 v21, s27, v53
    v_mfma_f32_32x32x16_bf16 v[128:143], v[60:63], v[48:51], v[128:143]
    ds_read_b128 v[36:39], v8 offset:4096
    v_dot2c_f32_bf16 v23, v53, v53
    v_mfma_f32_32x32x16_bf16 v[80:95], v[52:55], v[56:59], v[80:95]
    ds_read_b128 v[40:43], v4 offset:4096
    v_dot2c_f32_bf16 v20, s27, v54
    v_dot2c_f32_bf16 v22, v54, v54
    v_mfma_f32_32x32x16_bf16 v[112:127], v[52:55], v[60:63], v[112:127]
    ds_read_b128 v[44:47], v4 offset:5120
    v_dot2c_f32_bf16 v21, s27, v55
    v_mfma_f32_32x32x16_bf16 v[144:159], v[60:63], v[52:55], v[144:159]
    v_dot2c_f32_bf16 v23, v55, v55
    s_waitcnt lgkmcnt(0)
    v_mfma_f32_32x32x16_bf16 v[64:79], v[32:35], v[40:43], v[64:79]
    v_dot2c_f32_bf16 v20, s27, v36
    v_dot2c_f32_bf16 v22, v36, v36
    v_mfma_f32_32x32x16_bf16 v[96:111], v[32:35], v[44:47], v[96:111]
    ds_read_b128 v[48:51], v9 offset:0
    v_dot2c_f32_bf16 v21, s27, v37
    v_mfma_f32_32x32x16_bf16 v[128:143], v[44:47], v[32:35], v[128:143]
    ds_read_b128 v[52:55], v9 offset:4096
    v_dot2c_f32_bf16 v23, v37, v37
    v_mfma_f32_32x32x16_bf16 v[80:95], v[36:39], v[40:43], v[80:95]
    ds_read_b128 v[56:59], v4 offset:6144
    v_dot2c_f32_bf16 v20, s27, v38
    v_dot2c_f32_bf16 v22, v38, v38
    v_mfma_f32_32x32x16_bf16 v[112:127], v[36:39], v[44:47], v[112:127]
    ds_read_b128 v[60:63], v4 offset:7168
    v_dot2c_f32_bf16 v21, s27, v39
    v_mfma_f32_32x32x16_bf16 v[144:159], v[44:47], v[36:39], v[144:159]
    v_dot2c_f32_bf16 v23, v39, v39
    s_waitcnt vmcnt(12)
    s_barrier
    s_waitcnt lgkmcnt(0)
    v_mfma_f32_32x32x16_bf16 v[64:79], v[48:51], v[56:59], v[64:79]
    v_dot2c_f32_bf16 v20, s27, v52
    v_dot2c_f32_bf16 v22, v52, v52
    s_bfe_u32 s41, s56, 524296
    s_mul_i32 s41, s41, s40
    s_add_u32 s42, s58, s41
    s_add_u32 s43, s59, s41
    buffer_load_dwordx4 a[200:203], v240, s[8:11], s42 offen
    v_mfma_f32_32x32x16_bf16 v[96:111], v[48:51], v[60:63], v[96:111]
    ds_read_b128 v[32:35], v6 offset:32768
    v_dot2c_f32_bf16 v21, s27, v53
    buffer_load_dwordx4 a[204:207], v241, s[8:11], s43 offen
    v_mfma_f32_32x32x16_bf16 v[128:143], v[60:63], v[48:51], v[128:143]
    ds_read_b128 v[36:39], v6 offset:36864
    v_dot2c_f32_bf16 v23, v53, v53
    s_bfe_u32 s41, s56, 524304
    s_mul_i32 s41, s41, s40
    s_add_u32 s42, s58, s41
    s_add_u32 s43, s59, s41
    buffer_load_dwordx4 a[208:211], v240, s[8:11], s42 offen
    v_mfma_f32_32x32x16_bf16 v[80:95], v[52:55], v[56:59], v[80:95]
    ds_read_b128 v[40:43], v4 offset:32768
    v_dot2c_f32_bf16 v20, s27, v54
    v_dot2c_f32_bf16 v22, v54, v54
    buffer_load_dwordx4 a[212:215], v241, s[8:11], s43 offen
    v_mfma_f32_32x32x16_bf16 v[112:127], v[52:55], v[60:63], v[112:127]
    ds_read_b128 v[44:47], v4 offset:33792
    v_dot2c_f32_bf16 v21, s27, v55
    s_bfe_u32 s41, s56, 524312
    s_mul_i32 s41, s41, s40
    s_add_u32 s42, s58, s41
    s_add_u32 s43, s59, s41
    buffer_load_dwordx4 a[216:219], v240, s[8:11], s42 offen
    v_mfma_f32_32x32x16_bf16 v[144:159], v[60:63], v[52:55], v[144:159]
    v_dot2c_f32_bf16 v23, v55, v55
    buffer_load_dwordx4 a[220:223], v241, s[8:11], s43 offen
    s_waitcnt lgkmcnt(0)
    v_mfma_f32_32x32x16_bf16 v[64:79], v[32:35], v[40:43], v[64:79]
    v_dot2c_f32_bf16 v20, s27, v36
    v_dot2c_f32_bf16 v22, v36, v36
    s_bfe_u32 s41, s57, 524288
    s_mul_i32 s41, s41, s40
    s_add_u32 s42, s58, s41
    s_add_u32 s43, s59, s41
    buffer_load_dwordx4 a[224:227], v240, s[8:11], s42 offen
    v_mfma_f32_32x32x16_bf16 v[96:111], v[32:35], v[44:47], v[96:111]
    ds_read_b128 v[48:51], v7 offset:32768
    v_dot2c_f32_bf16 v21, s27, v37
    buffer_load_dwordx4 a[228:231], v241, s[8:11], s43 offen
    v_mfma_f32_32x32x16_bf16 v[128:143], v[44:47], v[32:35], v[128:143]
    ds_read_b128 v[52:55], v7 offset:36864
    v_dot2c_f32_bf16 v23, v37, v37
    v_mfma_f32_32x32x16_bf16 v[80:95], v[36:39], v[40:43], v[80:95]
    ds_read_b128 v[56:59], v4 offset:34816
    v_dot2c_f32_bf16 v20, s27, v38
    v_dot2c_f32_bf16 v22, v38, v38
    v_mfma_f32_32x32x16_bf16 v[112:127], v[36:39], v[44:47], v[112:127]
    ds_read_b128 v[60:63], v4 offset:35840
    v_dot2c_f32_bf16 v21, s27, v39
    v_mfma_f32_32x32x16_bf16 v[144:159], v[44:47], v[36:39], v[144:159]
    v_dot2c_f32_bf16 v23, v39, v39
    s_waitcnt lgkmcnt(0)
    v_mfma_f32_32x32x16_bf16 v[64:79], v[48:51], v[56:59], v[64:79]
    v_dot2c_f32_bf16 v20, s27, v52
    v_dot2c_f32_bf16 v22, v52, v52
    v_mfma_f32_32x32x16_bf16 v[96:111], v[48:51], v[60:63], v[96:111]
    ds_read_b128 v[32:35], v8 offset:32768
    v_dot2c_f32_bf16 v21, s27, v53
    v_mfma_f32_32x32x16_bf16 v[128:143], v[60:63], v[48:51], v[128:143]
    ds_read_b128 v[36:39], v8 offset:36864
    v_dot2c_f32_bf16 v23, v53, v53
    v_mfma_f32_32x32x16_bf16 v[80:95], v[52:55], v[56:59], v[80:95]
    ds_read_b128 v[40:43], v4 offset:36864
    v_dot2c_f32_bf16 v20, s27, v54
    v_dot2c_f32_bf16 v22, v54, v54
    v_mfma_f32_32x32x16_bf16 v[112:127], v[52:55], v[60:63], v[112:127]
    ds_read_b128 v[44:47], v4 offset:37888
    v_dot2c_f32_bf16 v21, s27, v55
    v_mfma_f32_32x32x16_bf16 v[144:159], v[60:63], v[52:55], v[144:159]
    v_dot2c_f32_bf16 v23, v55, v55
    s_waitcnt lgkmcnt(0)
    v_mfma_f32_32x32x16_bf16 v[64:79], v[32:35], v[40:43], v[64:79]
    v_dot2c_f32_bf16 v20, s27, v36
    v_dot2c_f32_bf16 v22, v36, v36
    v_mfma_f32_32x32x16_bf16 v[96:111], v[32:35], v[44:47], v[96:111]
    ds_read_b128 v[48:51], v9 offset:32768
    v_dot2c_f32_bf16 v21, s27, v37
    v_mfma_f32_32x32x16_bf16 v[128:143], v[44:47], v[32:35], v[128:143]
    ds_read_b128 v[52:55], v9 offset:36864
    v_dot2c_f32_bf16 v23, v37, v37
    v_mfma_f32_32x32x16_bf16 v[80:95], v[36:39], v[40:43], v[80:95]
    ds_read_b128 v[56:59], v4 offset:38912
    v_dot2c_f32_bf16 v20, s27, v38
    v_dot2c_f32_bf16 v22, v38, v38
    v_mfma_f32_32x32x16_bf16 v[112:127], v[36:39], v[44:47], v[112:127]
    ds_read_b128 v[60:63], v4 offset:39936
    v_dot2c_f32_bf16 v21, s27, v39
    v_mfma_f32_32x32x16_bf16 v[144:159], v[44:47], v[36:39], v[144:159]
    v_dot2c_f32_bf16 v23, v39, v39
    s_waitcnt lgkmcnt(0)
    v_mfma_f32_32x32x16_bf16 v[64:79], v[48:51], v[56:59], v[64:79]
    v_dot2c_f32_bf16 v20, s27, v52
    v_dot2c_f32_bf16 v22, v52, v52
    s_bfe_u32 s41, s57, 524296
    s_mul_i32 s41, s41, s40
    s_add_u32 s42, s58, s41
    s_add_u32 s43, s59, s41
    buffer_load_dwordx4 a[232:235], v240, s[8:11], s42 offen
    v_mfma_f32_32x32x16_bf16 v[96:111], v[48:51], v[60:63], v[96:111]
    v_dot2c_f32_bf16 v21, s27, v53
    buffer_load_dwordx4 a[236:239], v241, s[8:11], s43 offen
    v_mfma_f32_32x32x16_bf16 v[128:143], v[60:63], v[48:51], v[128:143]
    v_dot2c_f32_bf16 v23, v53, v53
    s_bfe_u32 s41, s57, 524304
    s_mul_i32 s41, s41, s40
    s_add_u32 s42, s58, s41
    s_add_u32 s43, s59, s41
    buffer_load_dwordx4 a[240:243], v240, s[8:11], s42 offen
    v_mfma_f32_32x32x16_bf16 v[80:95], v[52:55], v[56:59], v[80:95]
    v_dot2c_f32_bf16 v20, s27, v54
    v_dot2c_f32_bf16 v22, v54, v54
    buffer_load_dwordx4 a[244:247], v241, s[8:11], s43 offen
    v_mfma_f32_32x32x16_bf16 v[112:127], v[52:55], v[60:63], v[112:127]
    v_dot2c_f32_bf16 v21, s27, v55
    s_bfe_u32 s41, s57, 524312
    s_mul_i32 s41, s41, s40
    s_add_u32 s42, s58, s41
    s_add_u32 s43, s59, s41
    buffer_load_dwordx4 a[248:251], v240, s[8:11], s42 offen
    v_mfma_f32_32x32x16_bf16 v[144:159], v[60:63], v[52:55], v[144:159]
    v_dot2c_f32_bf16 v23, v55, v55
    buffer_load_dwordx4 a[252:255], v241, s[8:11], s43 offen
layerb1_kernel_af_epi:
    s_nop 2
    v_add_f32 v20, v20, v21
    v_add_f32 v22, v22, v23
    v_mov_b32 v21, v20
    v_mov_b32 v23, v22
    s_nop 1
    v_permlane32_swap_b32 v20, v21
    v_permlane32_swap_b32 v22, v23
    v_add_f32 v20, v20, v21
    v_add_f32 v22, v22, v23
    v_mul_f32 v20, 0x3acccccd, v20
    v_mul_f32 v21, v20, v20
    v_mul_f32 v22, 0x3acccccd, v22
    v_sub_f32 v22, v22, v21
    v_max_f32 v22, 0, v22
    v_add_f32 v22, 0x3727c5ac, v22
    v_rsq_f32 v22, v22
    v_and_b32 v16, 31, v0
    s_lshl_b32 s28, s13, 7
    s_add_u32 s28, s28, 65536
    v_lshl_add_u32 v17, v16, 2, s28
    ds_write_b32 v17, v22
    s_waitcnt lgkmcnt(0)
    s_barrier
    s_lshl_b32 s28, s22, 8
    s_add_u32 s28, s28, 65536
    v_lshl_add_u32 v17, v16, 2, s28
    v_lshrrev_b32 v18, 5, v0
    v_lshlrev_b32 v18, 4, v18
    v_add_u32 v18, s28, v18
    ds_read_b32 v224, v17 offset:0
    ds_read_b128 v[192:195], v18 offset:0
    ds_read_b128 v[196:199], v18 offset:32
    ds_read_b128 v[200:203], v18 offset:64
    ds_read_b128 v[204:207], v18 offset:96
    ds_read_b32 v225, v17 offset:128
    ds_read_b128 v[208:211], v18 offset:128
    ds_read_b128 v[212:215], v18 offset:160
    ds_read_b128 v[216:219], v18 offset:192
    ds_read_b128 v[220:223], v18 offset:224
    v_and_b32 v16, 31, v0
    v_mov_b32 v228, 0x358637bd
    v_cmp_gt_u32 vcc, 20, v16
    s_mov_b64 s[30:31], vcc
    s_nop 0
    v_cndmask_b32 v226, 0, v228, vcc
    v_cmp_eq_u32 vcc, 8, v16
    s_nop 1
    v_cndmask_b32 v227, 0, 1.0, vcc
    s_waitcnt lgkmcnt(0)
    v_fma_f32 v64, v64, v192, v226
    v_mul_f32 v48, 0x3fb8aa3b, v64
    v_exp_f32 v48, v48 clamp
    v_max_f32 v49, v64, v228
    v_fma_f32 v96, v96, v192, v227
    v_add_f32 v48, v48, v49
    v_cndmask_b32 v64, v64, v48, s[30:31]
    v_fma_f32 v65, v65, v193, v226
    v_mul_f32 v50, 0x3fb8aa3b, v65
    v_exp_f32 v50, v50 clamp
    v_max_f32 v51, v65, v228
    v_fma_f32 v97, v97, v193, v227
    v_add_f32 v50, v50, v51
    v_cndmask_b32 v65, v65, v50, s[30:31]
    v_fma_f32 v66, v66, v194, v226
    v_mul_f32 v52, 0x3fb8aa3b, v66
    v_exp_f32 v52, v52 clamp
    v_max_f32 v53, v66, v228
    v_fma_f32 v98, v98, v194, v227
    v_add_f32 v52, v52, v53
    v_cndmask_b32 v66, v66, v52, s[30:31]
    v_fma_f32 v67, v67, v195, v226
    v_mul_f32 v54, 0x3fb8aa3b, v67
    v_exp_f32 v54, v54 clamp
    v_max_f32 v55, v67, v228
    v_fma_f32 v99, v99, v195, v227
    v_add_f32 v54, v54, v55
    v_cndmask_b32 v67, v67, v54, s[30:31]
    v_fma_f32 v68, v68, v196, v226
    v_mul_f32 v48, 0x3fb8aa3b, v68
    v_exp_f32 v48, v48 clamp
    v_max_f32 v49, v68, v228
    v_fma_f32 v100, v100, v196, v227
    v_add_f32 v48, v48, v49
    v_cndmask_b32 v68, v68, v48, s[30:31]
    v_fma_f32 v69, v69, v197, v226
    v_mul_f32 v50, 0x3fb8aa3b, v69
    v_exp_f32 v50, v50 clamp
    v_max_f32 v51, v69, v228
    v_fma_f32 v101, v101, v197, v227
    v_add_f32 v50, v50, v51
    v_cndmask_b32 v69, v69, v50, s[30:31]
    v_fma_f32 v70, v70, v198, v226
    v_mul_f32 v52, 0x3fb8aa3b, v70
    v_exp_f32 v52, v52 clamp
    v_max_f32 v53, v70, v228
    v_fma_f32 v102, v102, v198, v227
    v_add_f32 v52, v52, v53
    v_cndmask_b32 v70, v70, v52, s[30:31]
    v_fma_f32 v71, v71, v199, v226
    v_mul_f32 v54, 0x3fb8aa3b, v71
    v_exp_f32 v54, v54 clamp
    v_max_f32 v55, v71, v228
    v_fma_f32 v103, v103, v199, v227
    v_add_f32 v54, v54, v55
    v_cndmask_b32 v71, v71, v54, s[30:31]
    v_fma_f32 v72, v72, v200, v226
    v_mul_f32 v48, 0x3fb8aa3b, v72
    v_exp_f32 v48, v48 clamp
    v_max_f32 v49, v72, v228
    v_fma_f32 v104, v104, v200, v227
    v_add_f32 v48, v48, v49
    v_cndmask_b32 v72, v72, v48, s[30:31]
    v_fma_f32 v73, v73, v201, v226
    v_mul_f32 v50, 0x3fb8aa3b, v73
    v_exp_f32 v50, v50 clamp
    v_max_f32 v51, v73, v228
    v_fma_f32 v105, v105, v201, v227
    v_add_f32 v50, v50, v51
    v_cndmask_b32 v73, v73, v50, s[30:31]
    v_fma_f32 v74, v74, v202, v226
    v_mul_f32 v52, 0x3fb8aa3b, v74
    v_exp_f32 v52, v52 clamp
    v_max_f32 v53, v74, v228
    v_fma_f32 v106, v106, v202, v227
    v_add_f32 v52, v52, v53
    v_cndmask_b32 v74, v74, v52, s[30:31]
    v_fma_f32 v75, v75, v203, v226
    v_mul_f32 v54, 0x3fb8aa3b, v75
    v_exp_f32 v54, v54 clamp
    v_max_f32 v55, v75, v228
    v_fma_f32 v107, v107, v203, v227
    v_add_f32 v54, v54, v55
    v_cndmask_b32 v75, v75, v54, s[30:31]
    v_fma_f32 v76, v76, v204, v226
    v_mul_f32 v48, 0x3fb8aa3b, v76
    v_exp_f32 v48, v48 clamp
    v_max_f32 v49, v76, v228
    v_fma_f32 v108, v108, v204, v227
    v_add_f32 v48, v48, v49
    v_cndmask_b32 v76, v76, v48, s[30:31]
    v_fma_f32 v77, v77, v205, v226
    v_mul_f32 v50, 0x3fb8aa3b, v77
    v_exp_f32 v50, v50 clamp
    v_max_f32 v51, v77, v228
    v_fma_f32 v109, v109, v205, v227
    v_add_f32 v50, v50, v51
    v_cndmask_b32 v77, v77, v50, s[30:31]
    v_fma_f32 v78, v78, v206, v226
    v_mul_f32 v52, 0x3fb8aa3b, v78
    v_exp_f32 v52, v52 clamp
    v_max_f32 v53, v78, v228
    v_fma_f32 v110, v110, v206, v227
    v_add_f32 v52, v52, v53
    v_cndmask_b32 v78, v78, v52, s[30:31]
    v_fma_f32 v79, v79, v207, v226
    v_mul_f32 v54, 0x3fb8aa3b, v79
    v_exp_f32 v54, v54 clamp
    v_max_f32 v55, v79, v228
    v_fma_f32 v111, v111, v207, v227
    v_add_f32 v54, v54, v55
    v_cndmask_b32 v79, v79, v54, s[30:31]
    v_cvt_pk_bf16_f32 v32, v64, v65
    v_cvt_pk_bf16_f32 v40, v96, v97
    v_cvt_pk_bf16_f32 v33, v66, v67
    v_cvt_pk_bf16_f32 v41, v98, v99
    v_cvt_pk_bf16_f32 v34, v68, v69
    v_cvt_pk_bf16_f32 v42, v100, v101
    v_cvt_pk_bf16_f32 v35, v70, v71
    v_cvt_pk_bf16_f32 v43, v102, v103
    v_cvt_pk_bf16_f32 v36, v72, v73
    v_cvt_pk_bf16_f32 v44, v104, v105
    v_cvt_pk_bf16_f32 v37, v74, v75
    v_cvt_pk_bf16_f32 v45, v106, v107
    v_cvt_pk_bf16_f32 v38, v76, v77
    v_cvt_pk_bf16_f32 v46, v108, v109
    v_cvt_pk_bf16_f32 v39, v78, v79
    v_cvt_pk_bf16_f32 v47, v110, v111
    s_nop 1
    v_mfma_f32_32x32x16_bf16 v[160:175], v[32:35], v[32:35], 0
    v_mfma_f32_32x32x16_bf16 v[176:191], v[40:43], v[32:35], 0
    v_mfma_f32_32x32x16_bf16 v[160:175], v[36:39], v[36:39], v[160:175]
    v_mfma_f32_32x32x16_bf16 v[176:191], v[44:47], v[36:39], v[176:191]
    v_fma_f32 v80, v80, v208, v226
    v_mul_f32 v48, 0x3fb8aa3b, v80
    v_exp_f32 v48, v48 clamp
    v_max_f32 v49, v80, v228
    v_fma_f32 v112, v112, v208, v227
    v_add_f32 v48, v48, v49
    v_cndmask_b32 v80, v80, v48, s[30:31]
    v_fma_f32 v81, v81, v209, v226
    v_mul_f32 v50, 0x3fb8aa3b, v81
    v_exp_f32 v50, v50 clamp
    v_max_f32 v51, v81, v228
    v_fma_f32 v113, v113, v209, v227
    v_add_f32 v50, v50, v51
    v_cndmask_b32 v81, v81, v50, s[30:31]
    v_fma_f32 v82, v82, v210, v226
    v_mul_f32 v52, 0x3fb8aa3b, v82
    v_exp_f32 v52, v52 clamp
    v_max_f32 v53, v82, v228
    v_fma_f32 v114, v114, v210, v227
    v_add_f32 v52, v52, v53
    v_cndmask_b32 v82, v82, v52, s[30:31]
    v_fma_f32 v83, v83, v211, v226
    v_mul_f32 v54, 0x3fb8aa3b, v83
    v_exp_f32 v54, v54 clamp
    v_max_f32 v55, v83, v228
    v_fma_f32 v115, v115, v211, v227
    v_add_f32 v54, v54, v55
    v_cndmask_b32 v83, v83, v54, s[30:31]
    v_fma_f32 v84, v84, v212, v226
    v_mul_f32 v48, 0x3fb8aa3b, v84
    v_exp_f32 v48, v48 clamp
    v_max_f32 v49, v84, v228
    v_fma_f32 v116, v116, v212, v227
    v_add_f32 v48, v48, v49
    v_cndmask_b32 v84, v84, v48, s[30:31]
    v_fma_f32 v85, v85, v213, v226
    v_mul_f32 v50, 0x3fb8aa3b, v85
    v_exp_f32 v50, v50 clamp
    v_max_f32 v51, v85, v228
    v_fma_f32 v117, v117, v213, v227
    v_add_f32 v50, v50, v51
    v_cndmask_b32 v85, v85, v50, s[30:31]
    v_fma_f32 v86, v86, v214, v226
    v_mul_f32 v52, 0x3fb8aa3b, v86
    v_exp_f32 v52, v52 clamp
    v_max_f32 v53, v86, v228
    v_fma_f32 v118, v118, v214, v227
    v_add_f32 v52, v52, v53
    v_cndmask_b32 v86, v86, v52, s[30:31]
    v_fma_f32 v87, v87, v215, v226
    v_mul_f32 v54, 0x3fb8aa3b, v87
    v_exp_f32 v54, v54 clamp
    v_max_f32 v55, v87, v228
    v_fma_f32 v119, v119, v215, v227
    v_add_f32 v54, v54, v55
    v_cndmask_b32 v87, v87, v54, s[30:31]
    v_fma_f32 v88, v88, v216, v226
    v_mul_f32 v48, 0x3fb8aa3b, v88
    v_exp_f32 v48, v48 clamp
    v_max_f32 v49, v88, v228
    v_fma_f32 v120, v120, v216, v227
    v_add_f32 v48, v48, v49
    v_cndmask_b32 v88, v88, v48, s[30:31]
    v_fma_f32 v89, v89, v217, v226
    v_mul_f32 v50, 0x3fb8aa3b, v89
    v_exp_f32 v50, v50 clamp
    v_max_f32 v51, v89, v228
    v_fma_f32 v121, v121, v217, v227
    v_add_f32 v50, v50, v51
    v_cndmask_b32 v89, v89, v50, s[30:31]
    v_fma_f32 v90, v90, v218, v226
    v_mul_f32 v52, 0x3fb8aa3b, v90
    v_exp_f32 v52, v52 clamp
    v_max_f32 v53, v90, v228
    v_fma_f32 v122, v122, v218, v227
    v_add_f32 v52, v52, v53
    v_cndmask_b32 v90, v90, v52, s[30:31]
    v_fma_f32 v91, v91, v219, v226
    v_mul_f32 v54, 0x3fb8aa3b, v91
    v_exp_f32 v54, v54 clamp
    v_max_f32 v55, v91, v228
    v_fma_f32 v123, v123, v219, v227
    v_add_f32 v54, v54, v55
    v_cndmask_b32 v91, v91, v54, s[30:31]
    v_fma_f32 v92, v92, v220, v226
    v_mul_f32 v48, 0x3fb8aa3b, v92
    v_exp_f32 v48, v48 clamp
    v_max_f32 v49, v92, v228
    v_fma_f32 v124, v124, v220, v227
    v_add_f32 v48, v48, v49
    v_cndmask_b32 v92, v92, v48, s[30:31]
    v_fma_f32 v93, v93, v221, v226
    v_mul_f32 v50, 0x3fb8aa3b, v93
    v_exp_f32 v50, v50 clamp
    v_max_f32 v51, v93, v228
    v_fma_f32 v125, v125, v221, v227
    v_add_f32 v50, v50, v51
    v_cndmask_b32 v93, v93, v50, s[30:31]
    v_fma_f32 v94, v94, v222, v226
    v_mul_f32 v52, 0x3fb8aa3b, v94
    v_exp_f32 v52, v52 clamp
    v_max_f32 v53, v94, v228
    v_fma_f32 v126, v126, v222, v227
    v_add_f32 v52, v52, v53
    v_cndmask_b32 v94, v94, v52, s[30:31]
    v_fma_f32 v95, v95, v223, v226
    v_mul_f32 v54, 0x3fb8aa3b, v95
    v_exp_f32 v54, v54 clamp
    v_max_f32 v55, v95, v228
    v_fma_f32 v127, v127, v223, v227
    v_add_f32 v54, v54, v55
    v_cndmask_b32 v95, v95, v54, s[30:31]
    v_cvt_pk_bf16_f32 v32, v80, v81
    v_cvt_pk_bf16_f32 v40, v112, v113
    v_cvt_pk_bf16_f32 v33, v82, v83
    v_cvt_pk_bf16_f32 v41, v114, v115
    v_cvt_pk_bf16_f32 v34, v84, v85
    v_cvt_pk_bf16_f32 v42, v116, v117
    v_cvt_pk_bf16_f32 v35, v86, v87
    v_cvt_pk_bf16_f32 v43, v118, v119
    v_cvt_pk_bf16_f32 v36, v88, v89
    v_cvt_pk_bf16_f32 v44, v120, v121
    v_cvt_pk_bf16_f32 v37, v90, v91
    v_cvt_pk_bf16_f32 v45, v122, v123
    v_cvt_pk_bf16_f32 v38, v92, v93
    v_cvt_pk_bf16_f32 v46, v124, v125
    v_cvt_pk_bf16_f32 v39, v94, v95
    v_cvt_pk_bf16_f32 v47, v126, v127
    s_nop 1
    v_mfma_f32_32x32x16_bf16 v[160:175], v[32:35], v[32:35], v[160:175]
    v_mfma_f32_32x32x16_bf16 v[176:191], v[40:43], v[32:35], v[176:191]
    v_mfma_f32_32x32x16_bf16 v[160:175], v[36:39], v[36:39], v[160:175]
    v_mfma_f32_32x32x16_bf16 v[176:191], v[44:47], v[36:39], v[176:191]
    v_fma_f32 v132, v132, v224, v228
    v_mul_f32 v48, 0x3fb8aa3b, v132
    v_exp_f32 v48, v48 clamp
    v_max_f32 v49, v132, v228
    v_add_f32 v132, v48, v49
    v_fma_f32 v133, v133, v224, v228
    v_mul_f32 v50, 0x3fb8aa3b, v133
    v_exp_f32 v50, v50 clamp
    v_max_f32 v51, v133, v228
    v_add_f32 v133, v50, v51
    v_fma_f32 v134, v134, v224, v228
    v_mul_f32 v52, 0x3fb8aa3b, v134
    v_exp_f32 v52, v52 clamp
    v_max_f32 v53, v134, v228
    v_add_f32 v134, v52, v53
    v_fma_f32 v135, v135, v224, v228
    v_mul_f32 v54, 0x3fb8aa3b, v135
    v_exp_f32 v54, v54 clamp
    v_max_f32 v55, v135, v228
    v_add_f32 v135, v54, v55
    v_fma_f32 v136, v136, v224, v228
    v_mul_f32 v48, 0x3fb8aa3b, v136
    v_exp_f32 v48, v48 clamp
    v_max_f32 v49, v136, v228
    v_add_f32 v136, v48, v49
    v_fma_f32 v137, v137, v224, v228
    v_mul_f32 v50, 0x3fb8aa3b, v137
    v_exp_f32 v50, v50 clamp
    v_max_f32 v51, v137, v228
    v_add_f32 v137, v50, v51
    v_fma_f32 v138, v138, v224, v228
    v_mul_f32 v52, 0x3fb8aa3b, v138
    v_exp_f32 v52, v52 clamp
    v_max_f32 v53, v138, v228
    v_add_f32 v138, v52, v53
    v_fma_f32 v139, v139, v224, v228
    v_mul_f32 v54, 0x3fb8aa3b, v139
    v_exp_f32 v54, v54 clamp
    v_max_f32 v55, v139, v228
    v_add_f32 v139, v54, v55
    v_fma_f32 v140, v140, v224, v228
    v_mul_f32 v48, 0x3fb8aa3b, v140
    v_exp_f32 v48, v48 clamp
    v_max_f32 v49, v140, v228
    v_add_f32 v140, v48, v49
    v_fma_f32 v141, v141, v224, v228
    v_mul_f32 v50, 0x3fb8aa3b, v141
    v_exp_f32 v50, v50 clamp
    v_max_f32 v51, v141, v228
    v_add_f32 v141, v50, v51
    v_fma_f32 v142, v142, v224, v228
    v_mul_f32 v52, 0x3fb8aa3b, v142
    v_exp_f32 v52, v52 clamp
    v_max_f32 v53, v142, v228
    v_add_f32 v142, v52, v53
    v_fma_f32 v143, v143, v224, v228
    v_mul_f32 v54, 0x3fb8aa3b, v143
    v_exp_f32 v54, v54 clamp
    v_max_f32 v55, v143, v228
    v_add_f32 v143, v54, v55
    v_cvt_pk_bf16_f32 v130, v132, v133
    v_cvt_pk_bf16_f32 v131, v134, v135
    v_cvt_pk_bf16_f32 v132, v136, v137
    v_cvt_pk_bf16_f32 v133, v138, v139
    v_cvt_pk_bf16_f32 v134, v140, v141
    v_cvt_pk_bf16_f32 v135, v142, v143
    v_mov_b32 v128, 0
    v_mov_b32 v129, 0
    s_lshl_b32 s28, s13, 13
    s_add_u32 s28, s28, 66560
    v_add_u32 v17, s28, v1
    ds_write_b128 v17, v[160:163] offset:0
    ds_write_b128 v17, v[164:167] offset:1024
    ds_write_b128 v17, v[168:171] offset:2048
    ds_write_b128 v17, v[172:175] offset:3072
    ds_write_b128 v17, v[176:179] offset:4096
    ds_write_b128 v17, v[180:183] offset:5120
    ds_write_b128 v17, v[184:187] offset:6144
    ds_write_b128 v17, v[188:191] offset:7168
    s_lshl_b32 s28, s13, 6
    v_add_u32 v32, s28, v0
    v_cmp_le_u32 vcc, 105, v32
    s_nop 1
    v_cndmask_b32 v33, 0, 1, vcc
    v_mul_u32_u24 v34, 105, v33
    v_sub_u32 v34, v32, v34
    v_mul_u32_u24 v35, 13108, v34
    v_lshrrev_b32 v35, 16, v35
    v_mul_u32_u24 v36, 5, v35
    v_sub_u32 v36, v34, v36
    v_add_u32 v37, 20, v35
    v_subrev_u32 v38, 12, v35
    v_cmp_gt_u32 vcc, 12, v35
    s_nop 1
    v_cndmask_b32 v37, v38, v37, vcc
    v_cndmask_b32 v38, 1, 0, vcc
    v_lshlrev_b32 v38, 12, v38
    v_lshl_add_u32 v38, v33, 13, v38
    v_lshrrev_b32 v39, 3, v37
    v_lshl_add_u32 v38, v39, 10, v38
    v_bfe_u32 v39, v37, 2, 1
    v_lshlrev_b32 v39, 5, v39
    v_lshl_add_u32 v39, v36, 2, v39
    v_lshl_add_u32 v38, v39, 4, v38
    v_and_b32 v39, 3, v37
    v_lshl_add_u32 v38, v39, 2, v38
    v_min_u32 v38, 16320, v38
    v_add_u32 v38, 66560, v38
    s_waitcnt lgkmcnt(0)
    s_barrier
    ds_read_b32 v40, v38 offset:0
    ds_read_b32 v41, v38 offset:16
    ds_read_b32 v42, v38 offset:32
    ds_read_b32 v43, v38 offset:48
    ds_read_b32 v44, v38 offset:16384
    ds_read_b32 v45, v38 offset:16400
    ds_read_b32 v46, v38 offset:16416
    ds_read_b32 v47, v38 offset:16432
    s_lshl_b32 s28, s20, 4
    s_add_u32 s28, s28, s21
    s_lshl_b32 s28, s28, 12
    s_mul_i32 s39, s49, 1048576
    s_add_u32 s39, s39, 232783872
    s_add_u32 s28, s28, s39
    v_lshlrev_b32 v39, 4, v32
    v_cmp_gt_u32 vcc, 210, v32
    s_mov_b64 s[32:33], vcc
    s_waitcnt lgkmcnt(0)
    v_add_f32 v40, v40, v44
    v_add_f32 v41, v41, v45
    v_add_f32 v42, v42, v46
    v_add_f32 v43, v43, v47
    s_mov_b64 exec, s[32:33]
    buffer_store_dwordx4 v[40:43], v39, s[8:11], s28 offen sc1
    s_mov_b64 exec, -1
    v_fma_f32 v148, v148, v225, v228
    v_mul_f32 v48, 0x3fb8aa3b, v148
    v_exp_f32 v48, v48 clamp
    v_max_f32 v49, v148, v228
    v_add_f32 v148, v48, v49
    v_fma_f32 v149, v149, v225, v228
    v_mul_f32 v50, 0x3fb8aa3b, v149
    v_exp_f32 v50, v50 clamp
    v_max_f32 v51, v149, v228
    v_add_f32 v149, v50, v51
    v_fma_f32 v150, v150, v225, v228
    v_mul_f32 v52, 0x3fb8aa3b, v150
    v_exp_f32 v52, v52 clamp
    v_max_f32 v53, v150, v228
    v_add_f32 v150, v52, v53
    v_fma_f32 v151, v151, v225, v228
    v_mul_f32 v54, 0x3fb8aa3b, v151
    v_exp_f32 v54, v54 clamp
    v_max_f32 v55, v151, v228
    v_add_f32 v151, v54, v55
    v_fma_f32 v152, v152, v225, v228
    v_mul_f32 v48, 0x3fb8aa3b, v152
    v_exp_f32 v48, v48 clamp
    v_max_f32 v49, v152, v228
    v_add_f32 v152, v48, v49
    v_fma_f32 v153, v153, v225, v228
    v_mul_f32 v50, 0x3fb8aa3b, v153
    v_exp_f32 v50, v50 clamp
    v_max_f32 v51, v153, v228
    v_add_f32 v153, v50, v51
    v_fma_f32 v154, v154, v225, v228
    v_mul_f32 v52, 0x3fb8aa3b, v154
    v_exp_f32 v52, v52 clamp
    v_max_f32 v53, v154, v228
    v_add_f32 v154, v52, v53
    v_fma_f32 v155, v155, v225, v228
    v_mul_f32 v54, 0x3fb8aa3b, v155
    v_exp_f32 v54, v54 clamp
    v_max_f32 v55, v155, v228
    v_add_f32 v155, v54, v55
    v_fma_f32 v156, v156, v225, v228
    v_mul_f32 v48, 0x3fb8aa3b, v156
    v_exp_f32 v48, v48 clamp
    v_max_f32 v49, v156, v228
    v_add_f32 v156, v48, v49
    v_fma_f32 v157, v157, v225, v228
    v_mul_f32 v50, 0x3fb8aa3b, v157
    v_exp_f32 v50, v50 clamp
    v_max_f32 v51, v157, v228
    v_add_f32 v157, v50, v51
    v_fma_f32 v158, v158, v225, v228
    v_mul_f32 v52, 0x3fb8aa3b, v158
    v_exp_f32 v52, v52 clamp
    v_max_f32 v53, v158, v228
    v_add_f32 v158, v52, v53
    v_fma_f32 v159, v159, v225, v228
    v_mul_f32 v54, 0x3fb8aa3b, v159
    v_exp_f32 v54, v54 clamp
    v_max_f32 v55, v159, v228
    v_add_f32 v159, v54, v55
    v_cvt_pk_bf16_f32 v146, v148, v149
    v_cvt_pk_bf16_f32 v147, v150, v151
    v_cvt_pk_bf16_f32 v148, v152, v153
    v_cvt_pk_bf16_f32 v149, v154, v155
    v_cvt_pk_bf16_f32 v150, v156, v157
    v_cvt_pk_bf16_f32 v151, v158, v159
    v_mov_b32 v144, 0
    v_mov_b32 v145, 0
    s_mul_i32 s29, s26, 5
    v_lshrrev_b32 v17, 5, v0
    v_add_u32 v17, s29, v17
    v_lshrrev_b32 v18, 1, v17
    v_lshlrev_b32 v18, 9, v18
    v_and_b32 v17, 1, v17
    v_lshl_add_u32 v18, v17, 3, v18
    v_and_b32 v16, 31, v0
    v_lshl_add_u32 v14, v16, 4, v18
    v_mul_u32_u24 v15, 80, v16
    v_lshrrev_b32 v17, 5, v0
    v_lshl_add_u32 v15, v17, 4, v15
    s_mul_i32 s29, s23, 1680
    s_add_u32 s29, s29, 48
    v_add_u32 v15, s29, v15
    v_mov_b32 v48, 0
    v_mov_b32 v49, 0
    v_mov_b32 v50, 0
    v_mov_b32 v51, 0
    v_mov_b32 v52, 0
    v_mov_b32 v53, 0
    v_mov_b32 v54, 0
    v_mov_b32 v55, 0
    v_mov_b32 v56, 0
    v_mov_b32 v57, 0
    v_mov_b32 v58, 0
    v_mov_b32 v59, 0
    s_waitcnt vmcnt(0)
    s_barrier
    s_cmp_lg_u32 s13, 0
    s_cbranch_scc1 layerb1_kernel_af_go
    s_lshl_b32 s29, s20, 7
    s_add_u32 s29, s29, s48
    s_add_u32 s29, s29, 32768
    s_lshl_b32 s30, s21, 2
    v_mov_b32 v16, s30
    v_mov_b32 v17, 1
    s_mov_b64 exec, 1
    buffer_store_dword v17, v16, s[8:11], s29 offen sc1
    s_mov_b64 exec, 0xffff
    v_lshlrev_b32 v16, 2, v0
    s_mov_b32 s31, 400000
layerb1_kernel_af_poll:
    buffer_load_dword v17, v16, s[8:11], s29 offen sc1
    s_waitcnt vmcnt(0)
    v_cmp_eq_u32 vcc, 0, v17
    s_sub_u32 s31, s31, 1
    s_cbranch_scc1 layerb1_kernel_af_fail
    s_cbranch_vccnz layerb1_kernel_af_poll
    s_branch layerb1_kernel_af_ok
layerb1_kernel_af_fail:
    s_load_dwordx2 s[34:35], s[0:1], 88
    s_waitcnt lgkmcnt(0)
    s_mov_b32 s36, s34
    s_mov_b32 s37, s35
    s_mov_b32 s38, 256
    s_mov_b32 s39, 0x00020000
    s_mov_b64 exec, 1
    v_mov_b32 v16, 0
    v_mov_b32 v17, 0xdead
    buffer_store_dword v17, v16, s[36:39], 0 offen
layerb1_kernel_af_ok:
    s_mov_b64 exec, -1
layerb1_kernel_af_go:
    s_barrier
    s_lshl_b32 s28, s20, 16
    s_add_u32 s28, s28, s39
    s_mov_b64 exec, s[32:33]
    buffer_load_dwordx4 v[160:163], v39, s[8:11], s28 offen sc1
    s_add_u32 s28, s28, 4096
    buffer_load_dwordx4 v[164:167], v39, s[8:11], s28 offen sc1
    s_add_u32 s28, s28, 4096
    buffer_load_dwordx4 v[168:171], v39, s[8:11], s28 offen sc1
    s_add_u32 s28, s28, 4096
    buffer_load_dwordx4 v[172:175], v39, s[8:11], s28 offen sc1
    s_add_u32 s28, s28, 4096
    buffer_load_dwordx4 v[176:179], v39, s[8:11], s28 offen sc1
    s_add_u32 s28, s28, 4096
    buffer_load_dwordx4 v[180:183], v39, s[8:11], s28 offen sc1
    s_add_u32 s28, s28, 4096
    buffer_load_dwordx4 v[184:187], v39, s[8:11], s28 offen sc1
    s_add_u32 s28, s28, 4096
    buffer_load_dwordx4 v[188:191], v39, s[8:11], s28 offen sc1
    s_add_u32 s28, s28, 4096
    buffer_load_dwordx4 v[192:195], v39, s[8:11], s28 offen sc1
    s_add_u32 s28, s28, 4096
    buffer_load_dwordx4 v[196:199], v39, s[8:11], s28 offen sc1
    s_add_u32 s28, s28, 4096
    buffer_load_dwordx4 v[200:203], v39, s[8:11], s28 offen sc1
    s_add_u32 s28, s28, 4096
    buffer_load_dwordx4 v[204:207], v39, s[8:11], s28 offen sc1
    s_add_u32 s28, s28, 4096
    buffer_load_dwordx4 v[208:211], v39, s[8:11], s28 offen sc1
    s_add_u32 s28, s28, 4096
    buffer_load_dwordx4 v[212:215], v39, s[8:11], s28 offen sc1
    s_add_u32 s28, s28, 4096
    buffer_load_dwordx4 v[216:219], v39, s[8:11], s28 offen sc1
    s_add_u32 s28, s28, 4096
    buffer_load_dwordx4 v[220:223], v39, s[8:11], s28 offen sc1
    s_mov_b64 exec, -1
    s_waitcnt vmcnt(14)
    v_add_f32 v160, v160, v164
    v_add_f32 v161, v161, v165
    v_add_f32 v162, v162, v166
    v_add_f32 v163, v163, v167
    s_waitcnt vmcnt(12)
    v_add_f32 v168, v168, v172
    v_add_f32 v169, v169, v173
    v_add_f32 v170, v170, v174
    v_add_f32 v171, v171, v175
    s_waitcnt vmcnt(10)
    v_add_f32 v176, v176, v180
    v_add_f32 v177, v177, v181
    v_add_f32 v178, v178, v182
    v_add_f32 v179, v179, v183
    s_waitcnt vmcnt(8)
    v_add_f32 v184, v184, v188
    v_add_f32 v185, v185, v189
    v_add_f32 v186, v186, v190
    v_add_f32 v187, v187, v191
    s_waitcnt vmcnt(6)
    v_add_f32 v192, v192, v196
    v_add_f32 v193, v193, v197
    v_add_f32 v194, v194, v198
    v_add_f32 v195, v195, v199
    s_waitcnt vmcnt(4)
    v_add_f32 v200, v200, v204
    v_add_f32 v201, v201, v205
    v_add_f32 v202, v202, v206
    v_add_f32 v203, v203, v207
    s_waitcnt vmcnt(2)
    v_add_f32 v208, v208, v212
    v_add_f32 v209, v209, v213
    v_add_f32 v210, v210, v214
    v_add_f32 v211, v211, v215
    s_waitcnt vmcnt(0)
    v_add_f32 v216, v216, v220
    v_add_f32 v217, v217, v221
    v_add_f32 v218, v218, v222
    v_add_f32 v219, v219, v223
    v_add_f32 v160, v160, v168
    v_add_f32 v161, v161, v169
    v_add_f32 v162, v162, v170
    v_add_f32 v163, v163, v171
    v_add_f32 v176, v176, v184
    v_add_f32 v177, v177, v185
    v_add_f32 v178, v178, v186
    v_add_f32 v179, v179, v187
    v_add_f32 v192, v192, v200
    v_add_f32 v193, v193, v201
    v_add_f32 v194, v194, v202
    v_add_f32 v195, v195, v203
    v_add_f32 v208, v208, v216
    v_add_f32 v209, v209, v217
    v_add_f32 v210, v210, v218
    v_add_f32 v211, v211, v219
    v_add_f32 v160, v160, v176
    v_add_f32 v161, v161, v177
    v_add_f32 v162, v162, v178
    v_add_f32 v163, v163, v179
    v_add_f32 v192, v192, v208
    v_add_f32 v193, v193, v209
    v_add_f32 v194, v194, v210
    v_add_f32 v195, v195, v211
    v_add_f32 v160, v160, v192
    v_add_f32 v161, v161, v193
    v_add_f32 v162, v162, v194
    v_add_f32 v163, v163, v195
    v_add_u32 v39, 64, v39
    s_mov_b64 exec, s[32:33]
    ds_write_b128 v39, v[160:163]
    s_mov_b64 exec, -1
    s_waitcnt lgkmcnt(0)
    s_barrier
    s_mov_b32 exec_lo, 0x1fffff
    s_mov_b32 exec_hi, 0x1fffff
    ds_read_b128 v[52:55], v15 offset:32
    ds_read_b128 v[56:59], v15 offset:64
    s_mov_b32 exec_lo, 0
    ds_read_b128 v[48:51], v15
    s_mov_b64 exec, -1
    v_mov_b32 v32, 0
    v_mov_b32 v33, 0
    s_waitcnt lgkmcnt(0)
    v_cvt_pk_bf16_f32 v34, v48, v49
    v_cvt_pk_bf16_f32 v35, v50, v51
    v_cvt_pk_bf16_f32 v36, v52, v53
    v_cvt_pk_bf16_f32 v37, v54, v55
    v_cvt_pk_bf16_f32 v38, v56, v57
    v_cvt_pk_bf16_f32 v39, v58, v59
    s_nop 1
    v_mfma_f32_32x32x16_bf16 v[64:79], v[32:35], v[128:131], 0
    v_mfma_f32_32x32x16_bf16 v[64:79], v[36:39], v[132:135], v[64:79]
    v_mfma_f32_32x32x16_bf16 v[80:95], v[32:35], v[144:147], 0
    v_mfma_f32_32x32x16_bf16 v[80:95], v[36:39], v[148:151], v[80:95]
    s_lshl_b32 s28, s21, 2
    s_lshl_b32 s29, s22, 1
    s_add_u32 s28, s28, s29
    s_mul_i32 s28, s28, 40960
    s_add_u32 s28, s28, 229638144
    s_nop 7
    s_nop 3
    v_add_f32 v40, 0x358637bd, v72
    v_mov_b32 v41, v40
    s_nop 1
    v_permlane32_swap_b32 v40, v41
    v_rcp_f32 v41, v41
    s_nop 0
    v_mul_f32 v64, v64, v41
    v_mul_f32 v65, v65, v41
    v_mul_f32 v66, v66, v41
    v_mul_f32 v67, v67, v41
    v_mul_f32 v68, v68, v41
    v_mul_f32 v69, v69, v41
    v_mul_f32 v70, v70, v41
    v_mul_f32 v71, v71, v41
    v_mul_f32 v72, v72, v41
    v_mul_f32 v73, v73, v41
    v_mul_f32 v74, v74, v41
    v_mul_f32 v75, v75, v41
    v_cvt_pk_bf16_f32 v42, v64, v65
    v_cvt_pk_bf16_f32 v43, v66, v67
    v_cvt_pk_bf16_f32 v44, v68, v69
    v_cvt_pk_bf16_f32 v45, v70, v71
    v_cvt_pk_bf16_f32 v46, v72, v73
    v_cvt_pk_bf16_f32 v47, v74, v75
    buffer_store_dwordx2 v[42:43], v14, s[8:11], s28 offen offset:0 sc1
    buffer_store_dwordx2 v[44:45], v14, s[8:11], s28 offen offset:512 sc1
    s_mov_b32 exec_hi, 0
    buffer_store_dwordx2 v[46:47], v14, s[8:11], s28 offen offset:1024 sc1
    s_mov_b32 exec_hi, -1
    s_add_u32 s28, s28, 40960
    s_nop 7
    v_add_f32 v40, 0x358637bd, v88
    v_mov_b32 v41, v40
    s_nop 1
    v_permlane32_swap_b32 v40, v41
    v_rcp_f32 v41, v41
    s_nop 0
    v_mul_f32 v80, v80, v41
    v_mul_f32 v81, v81, v41
    v_mul_f32 v82, v82, v41
    v_mul_f32 v83, v83, v41
    v_mul_f32 v84, v84, v41
    v_mul_f32 v85, v85, v41
    v_mul_f32 v86, v86, v41
    v_mul_f32 v87, v87, v41
    v_mul_f32 v88, v88, v41
    v_mul_f32 v89, v89, v41
    v_mul_f32 v90, v90, v41
    v_mul_f32 v91, v91, v41
    v_cvt_pk_bf16_f32 v48, v80, v81
    v_cvt_pk_bf16_f32 v49, v82, v83
    v_cvt_pk_bf16_f32 v50, v84, v85
    v_cvt_pk_bf16_f32 v51, v86, v87
    v_cvt_pk_bf16_f32 v52, v88, v89
    v_cvt_pk_bf16_f32 v53, v90, v91
    buffer_store_dwordx2 v[48:49], v14, s[8:11], s28 offen offset:0 sc1
    buffer_store_dwordx2 v[50:51], v14, s[8:11], s28 offen offset:512 sc1
    s_mov_b32 exec_hi, 0
    buffer_store_dwordx2 v[52:53], v14, s[8:11], s28 offen offset:1024 sc1
    s_mov_b32 exec_hi, -1
    s_waitcnt vmcnt(0)
    s_barrier
    s_cmp_lg_u32 s13, 0
    s_cbranch_scc1 layerb1_kernel_af_pub
    s_lshl_b32 s28, s21, 4
    s_add_u32 s28, s28, s20
    s_lshl_b32 s28, s28, 2
    s_add_u32 s28, s28, s48
    s_add_u32 s28, s28, 49152
    v_mov_b32 v16, 0
    v_mov_b32 v17, 1
    s_mov_b64 exec, 1
    buffer_store_dword v17, v16, s[8:11], s28 offen sc1
    s_mov_b64 exec, -1
layerb1_kernel_af_pub:
    s_add_u32 s22, s4, 247463936
    s_addc_u32 s23, s5, 0
    s_cmp_eq_u32 s49, 0
    s_cselect_b32 s84, s22, s6
    s_cselect_b32 s85, s23, s7
    s_mov_b32 s86, 2621440
    s_mov_b32 s87, 0x00020000
    s_mov_b32 s20, s98
    s_mov_b32 s21, s99
    s_sub_u32 s22, 0, s4
    s_and_b32 s22, s22, 0x1fffff
    s_lshl_b32 s23, s49, 3
    s_add_u32 s23, s23, 10551296
    s_buffer_load_dwordx2 s[24:25], s[8:11], s23
    s_waitcnt lgkmcnt(0)
    s_and_b32 s24, s24, 8192
    s_and_b32 s25, s25, 8192
    s_lshl_b32 s82, s24, 1
    s_sub_u32 s82, 8192, s82
    s_lshl_b32 s83, s25, 1
    s_sub_u32 s83, 8192, s83
    s_mul_i32 s23, s49, 4194304
    s_add_u32 s22, s22, s23
    s_add_u32 s16, s22, s24
    s_add_u32 s17, s22, s25
    s_add_u32 s17, s17, 2097152
    s_mov_b32 s40, 0x01010101
    s_mov_b32 s41, 0x01010101
    s_mov_b32 s42, 0x00010001
    s_mov_b32 s43, 0
    v_lshlrev_b32 v1, 4, v0
    v_and_b32 v16, 8, v0
    v_cmp_eq_u32 vcc, 0, v16
    v_mov_b32 v17, 0xeeeeeeee
    v_mov_b32 v18, 0x44444444
    v_cndmask_b32 v2, v17, v18, vcc
    s_cmp_eq_u32 s20, 0
    s_cbranch_scc0 layerb1_kernel_notp
    s_mov_b32 s12, s21
    s_cmp_eq_u32 s13, 0
    s_cbranch_scc1 layerb1_kernel_p0_start
    s_cmp_eq_u32 s13, 1
    s_cbranch_scc1 layerb1_kernel_p1_start
    s_cmp_eq_u32 s13, 2
    s_cbranch_scc1 layerb1_kernel_p2_start
    s_cmp_eq_u32 s13, 3
    s_cbranch_scc1 layerb1_kernel_p3_start
layerb1_kernel_notp:
    s_cmp_ge_u32 s20, 4
    s_cbranch_scc1 layerb1_kernel_proj
    s_cmp_ge_u32 s21, 27
    s_cbranch_scc1 layerb1_kernel_spare
    s_sub_u32 s22, s20, 1
    s_mul_i32 s22, s22, 27
    s_add_u32 s12, s22, s21
    s_cmp_ge_u32 s12, 80
    s_cbranch_scc1 layerb1_kernel_spare
    s_cmp_eq_u32 s13, 0
    s_cbranch_scc1 layerb1_kernel_y0_start
    s_cmp_eq_u32 s13, 1
    s_cbranch_scc1 layerb1_kernel_y1_start
    s_cmp_eq_u32 s13, 2
    s_cbranch_scc1 layerb1_kernel_y2_start
    s_cmp_eq_u32 s13, 3
    s_cbranch_scc1 layerb1_kernel_y3_start
    s_branch layerb1_kernel_end
layerb1_kernel_p0_start:
    v_lshrrev_b32 v16, 4, v0
    v_and_b32 v17, 15, v0
    v_and_b32 v18, 2, v0
    v_cmp_eq_u32 vcc, 0, v18
    v_mov_b32 v18, 0xeeeeeeee
    v_mov_b32 v19, 0x44444444
    v_cndmask_b32 v2, v18, v19, vcc
    v_lshrrev_b32 v20, 2, v17
    v_lshlrev_b32 v20, 1, v20
    v_and_b32 v21, 1, v17
    v_add_u32 v20, v20, v21
    v_bfe_u32 v21, v17, 1, 1
    v_lshl_add_u32 v18, v16, 1, v21
    v_lshlrev_b32 v18, 7, v18
    v_lshl_add_u32 v12, v20, 4, v18
    v_mul_u32_u24 v18, 400, v20
    v_lshl_add_u32 v18, v16, 5, v18
    v_lshl_add_u32 v18, v21, 4, v18
    v_add_u32 v4, 141312, v18
    v_mul_u32_u24 v18, 800, v16
    v_lshl_add_u32 v18, v17, 1, v18
    v_add_u32 v3, 141312, v18
    v_and_b32 v18, 7, v0
    v_mul_u32_u24 v18, 400, v18
    v_lshl_add_u32 v18, v16, 5, v18
    v_add_u32 v5, 144512, v18
    v_lshlrev_b32 v18, 3, v0
    v_add_u32 v6, 147712, v18
    v_lshlrev_b32 v18, 4, v16
    v_bfe_u32 v19, v17, 1, 2
    v_lshl_add_u32 v18, v19, 2, v18
    s_lshl_b32 s20, s12, 7
    s_add_u32 s20, s20, 0
    v_add_u32 v18, s20, v18
    v_lshrrev_b32 v19, 3, v17
    v_add_u32 v19, 1, v19
    v_lshrrev_b32 v20, 1, v19
    v_lshlrev_b32 v20, 14, v20
    v_and_b32 v19, 1, v19
    v_lshl_add_u32 v19, v19, 12, v20
    v_add_u32 v19, v19, v18
    v_mov_b32 v20, 0x7ffffff0
    v_and_b32 v21, 7, v0
    v_cmp_eq_u32 vcc, 4, v21
    v_subrev_u32 v21, 8, v18
    s_nop 0
    v_cndmask_b32 v7, v19, v21, vcc
    v_and_b32 v21, 0x29, v0
    v_cmp_eq_u32 vcc, 0, v21
    s_nop 1
    v_cndmask_b32 v8, v20, v18, vcc
    v_lshlrev_b32 v18, 4, v17
    v_lshl_add_u32 v18, v16, 10, v18
    v_add_u32 v9, 0, v18
    v_add_u32 v18, 0, v0
    v_mul_u32_u24 v19, 2731, v18
    v_lshrrev_b32 v19, 16, v19
    v_mul_u32_u24 v20, 24, v19
    v_sub_u32 v20, v18, v20
    v_mul_u32_u24 v21, 400, v19
    v_lshl_add_u32 v21, v20, 4, v21
    v_add_u32 v10, 144512, v21
    v_lshlrev_b32 v21, 4, v19
    v_lshl_add_u32 v11, v20, 7, v21
    v_add_u32 v13, 0, v1
    v_add_u32 v14, 131072, v1
    s_mul_i32 s44, s12, 12288
    s_add_u32 s44, s44, 53477376
    s_mul_i32 s45, s12, 3072
    s_add_u32 s45, s45, 208666624
    s_mul_i32 s20, s12, 6
    s_add_u32 s21, s20, 5
    s_lshr_b32 s20, s20, 3
    s_lshr_b32 s21, s21, 3
    s_add_u32 s20, s20, 80
    s_add_u32 s21, s21, 80
    s_lshl_b32 s20, s20, 7
    s_lshl_b32 s21, s21, 7
    v_mov_b32 v255, s21
    v_mov_b32 v253, s20
    v_cmp_eq_u32 vcc, 0, v0
    s_nop 1
    v_cndmask_b32 v255, v255, v253, vcc
    s_mov_b32 s47, 0
    s_mul_i32 s20, s12, 491520
    s_add_u32 s20, s20, 11534336
    s_add_u32 s21, s20, 2048
    buffer_load_dwordx4 v[16:19], v1, s[8:11], s21 offen offset:0
    buffer_load_dwordx4 v[20:23], v1, s[8:11], s21 offen offset:1024
    s_add_u32 s21, s20, 24576
    buffer_load_dwordx4 v[24:27], v1, s[8:11], s21 offen offset:0
    buffer_load_dwordx4 v[28:31], v1, s[8:11], s21 offen offset:1024
    s_add_u32 s21, s20, 6144
    buffer_load_dwordx4 v[32:35], v1, s[8:11], s21 offen offset:0
    buffer_load_dwordx4 v[36:39], v1, s[8:11], s21 offen offset:1024
    s_add_u32 s21, s20, 14336
    buffer_load_dwordx4 v[40:43], v1, s[8:11], s21 offen offset:0
    buffer_load_dwordx4 v[44:47], v1, s[8:11], s21 offen offset:1024
    s_add_u32 s21, s20, 28672
    buffer_load_dwordx4 v[48:51], v1, s[8:11], s21 offen offset:0
    buffer_load_dwordx4 v[52:55], v1, s[8:11], s21 offen offset:1024
    s_add_u32 s21, s20, 36864
    buffer_load_dwordx4 v[56:59], v1, s[8:11], s21 offen offset:0
    buffer_load_dwordx4 v[60:63], v1, s[8:11], s21 offen offset:1024
    s_add_u32 s21, s20, 51200
    buffer_load_dwordx4 v[64:67], v1, s[8:11], s21 offen offset:0
    buffer_load_dwordx4 v[68:71], v1, s[8:11], s21 offen offset:1024
    s_add_u32 s21, s20, 59392
    buffer_load_dwordx4 v[72:75], v1, s[8:11], s21 offen offset:0
    buffer_load_dwordx4 v[76:79], v1, s[8:11], s21 offen offset:1024
    s_add_u32 s21, s20, 73728
    buffer_load_dwordx4 v[80:83], v1, s[8:11], s21 offen offset:0
    buffer_load_dwordx4 v[84:87], v1, s[8:11], s21 offen offset:1024
    s_add_u32 s21, s20, 65536
    buffer_load_dwordx4 v[88:91], v1, s[8:11], s21 offen offset:0
    buffer_load_dwordx4 v[92:95], v1, s[8:11], s21 offen offset:1024
    s_add_u32 s21, s20, 94208
    buffer_load_dwordx4 v[96:99], v1, s[8:11], s21 offen offset:0
    buffer_load_dwordx4 v[100:103], v1, s[8:11], s21 offen offset:1024
    s_add_u32 s21, s20, 81920
    buffer_load_dwordx4 v[104:107], v1, s[8:11], s21 offen offset:0
    buffer_load_dwordx4 v[108:111], v1, s[8:11], s21 offen offset:1024
    s_add_u32 s21, s20, 108544
    buffer_load_dwordx4 v[112:115], v1, s[8:11], s21 offen offset:0
    buffer_load_dwordx4 v[116:119], v1, s[8:11], s21 offen offset:1024
    s_add_u32 s21, s20, 114688
    buffer_load_dwordx4 v[120:123], v1, s[8:11], s21 offen offset:0
    buffer_load_dwordx4 v[124:127], v1, s[8:11], s21 offen offset:1024
    s_add_u32 s21, s20, 120832
    buffer_load_dwordx4 v[128:131], v1, s[8:11], s21 offen offset:0
    buffer_load_dwordx4 v[132:135], v1, s[8:11], s21 offen offset:1024
    s_add_u32 s21, s20, 104448
    buffer_load_dwordx4 v[136:139], v1, s[8:11], s21 offen offset:0
    buffer_load_dwordx4 v[140:143], v1, s[8:11], s21 offen offset:1024
    s_add_u32 s21, s20, 92160
    buffer_load_dwordx4 v[156:159], v1, s[8:11], s21 offen offset:0
    buffer_load_dwordx4 v[160:163], v1, s[8:11], s21 offen offset:1024
    s_add_u32 s21, s20, 96256
    buffer_load_dwordx4 v[164:167], v1, s[8:11], s21 offen offset:0
    buffer_load_dwordx4 v[168:171], v1, s[8:11], s21 offen offset:1024
    s_add_u32 s21, s20, 98304
    buffer_load_dwordx4 v[172:175], v1, s[8:11], s21 offen offset:0
    buffer_load_dwordx4 v[176:179], v1, s[8:11], s21 offen offset:1024
    s_add_u32 s21, s20, 100352
    buffer_load_dwordx4 v[180:183], v1, s[8:11], s21 offen offset:0
    buffer_load_dwordx4 v[184:187], v1, s[8:11], s21 offen offset:1024
    s_add_u32 s21, s20, 83968
    buffer_load_dwordx4 v[188:191], v1, s[8:11], s21 offen offset:0
    buffer_load_dwordx4 v[192:195], v1, s[8:11], s21 offen offset:1024
    s_add_u32 s21, s20, 86016
    buffer_load_dwordx4 v[196:199], v1, s[8:11], s21 offen offset:0
    buffer_load_dwordx4 v[200:203], v1, s[8:11], s21 offen offset:1024
    s_add_u32 s21, s20, 110592
    buffer_load_dwordx4 v[204:207], v1, s[8:11], s21 offen offset:0
    buffer_load_dwordx4 v[208:211], v1, s[8:11], s21 offen offset:1024
    s_add_u32 s21, s20, 112640
    buffer_load_dwordx4 v[212:215], v1, s[8:11], s21 offen offset:0
    buffer_load_dwordx4 v[216:219], v1, s[8:11], s21 offen offset:1024
    s_add_u32 s21, s20, 116736
    buffer_load_dwordx4 v[220:223], v1, s[8:11], s21 offen offset:0
    buffer_load_dwordx4 v[224:227], v1, s[8:11], s21 offen offset:1024
    s_add_u32 s21, s20, 118784
    buffer_load_dwordx4 v[228:231], v1, s[8:11], s21 offen offset:0
    buffer_load_dwordx4 v[232:235], v1, s[8:11], s21 offen offset:1024
    s_add_u32 s21, s20, 102400
    buffer_load_dwordx4 v[236:239], v1, s[8:11], s21 offen offset:0
    buffer_load_dwordx4 v[240:243], v1, s[8:11], s21 offen offset:1024
    s_add_u32 s21, s20, 106496
    buffer_load_dwordx4 v[244:247], v1, s[8:11], s21 offen offset:0
    buffer_load_dwordx4 v[248:251], v1, s[8:11], s21 offen offset:1024
    s_waitcnt vmcnt(24)
    ds_write_b128 v13, v[16:19] offset:0
    ds_write_b128 v13, v[20:23] offset:1024
    ds_write_b128 v13, v[24:27] offset:2048
    ds_write_b128 v13, v[28:31] offset:3072
    ds_write_b128 v13, v[32:35] offset:4096
    ds_write_b128 v13, v[36:39] offset:5120
    ds_write_b128 v13, v[40:43] offset:6144
    ds_write_b128 v13, v[44:47] offset:7168
    ds_write_b128 v13, v[48:51] offset:8192
    ds_write_b128 v13, v[52:55] offset:9216
    ds_write_b128 v13, v[56:59] offset:10240
    ds_write_b128 v13, v[60:63] offset:11264
    ds_write_b128 v13, v[64:67] offset:12288
    ds_write_b128 v13, v[68:71] offset:13312
    ds_write_b128 v13, v[72:75] offset:14336
    ds_write_b128 v13, v[76:79] offset:15360
    ds_write_b128 v13, v[80:83] offset:16384
    ds_write_b128 v13, v[84:87] offset:17408
    ds_write_b128 v13, v[88:91] offset:18432
    ds_write_b128 v13, v[92:95] offset:19456
    ds_write_b128 v13, v[96:99] offset:20480
    ds_write_b128 v13, v[100:103] offset:21504
    ds_write_b128 v13, v[104:107] offset:22528
    ds_write_b128 v13, v[108:111] offset:23552
    ds_write_b128 v13, v[112:115] offset:24576
    ds_write_b128 v13, v[116:119] offset:25600
    ds_write_b128 v13, v[120:123] offset:26624
    ds_write_b128 v13, v[124:127] offset:27648
    ds_write_b128 v13, v[128:131] offset:28672
    ds_write_b128 v13, v[132:135] offset:29696
    ds_write_b128 v13, v[136:139] offset:30720
    ds_write_b128 v13, v[140:143] offset:31744
    s_waitcnt lgkmcnt(0)
    s_mov_b32 s14, 0
    s_cmp_gt_u32 s47, s14
    s_cbranch_scc1 layerb1_kernel_p0_gw1_ok
layerb1_kernel_p0_gw1_lp:
    buffer_load_dword v253, v255, s[8:11], s48 offen sc1
    s_waitcnt vmcnt(0)
    v_readlane_b32 s47, v253, 0
    v_readlane_b32 s29, v253, 1
    s_nop 0
    s_min_u32 s47, s47, s29
    s_sub_u32 s15, s15, 1
    s_cbranch_scc1 layerb1_kernel_bail
    s_cmp_gt_u32 s47, s14
    s_cbranch_scc0 layerb1_kernel_p0_gw1_lp
layerb1_kernel_p0_gw1_ok:
    s_mul_i32 s20, s14, 393216
    s_add_u32 s20, s20, s44
    s_add_u32 s21, s20, 0
    buffer_load_dwordx4 v[100:103], v9, s[8:11], s21 offen offset:0 sc1
    buffer_load_dwordx4 v[104:107], v9, s[8:11], s21 offen offset:512 sc1
    s_add_u32 s21, s20, 4096
    buffer_load_dwordx4 v[108:111], v9, s[8:11], s21 offen offset:0 sc1
    buffer_load_dwordx4 v[112:115], v9, s[8:11], s21 offen offset:512 sc1
    s_add_u32 s21, s20, 8192
    buffer_load_dwordx4 v[116:119], v9, s[8:11], s21 offen offset:0 sc1
    buffer_load_dwordx4 v[120:123], v9, s[8:11], s21 offen offset:512 sc1
    v_mov_b32 v56, 0
    v_mov_b32 v57, 0
    v_mov_b32 v58, 0
    v_mov_b32 v59, 0
    v_mov_b32 v60, 0
    v_mov_b32 v61, 0
    v_mov_b32 v62, 0
    v_mov_b32 v63, 0
    v_mov_b32 v64, 0
    v_mov_b32 v65, 0
    v_mov_b32 v66, 0
    v_mov_b32 v67, 0
    v_mov_b32 v68, 0
    v_mov_b32 v69, 0
    v_mov_b32 v70, 0
    v_mov_b32 v71, 0
    v_mov_b32 v72, 0
    v_mov_b32 v73, 0
    v_mov_b32 v74, 0
    v_mov_b32 v75, 0
    v_mov_b32 v76, 0
    v_mov_b32 v77, 0
    v_mov_b32 v78, 0
    v_mov_b32 v79, 0
    v_mov_b32 v80, 0
    v_mov_b32 v81, 0
    v_mov_b32 v82, 0
    v_mov_b32 v83, 0
    v_mov_b32 v84, 0
    v_mov_b32 v85, 0
    v_mov_b32 v86, 0
    v_mov_b32 v87, 0
    ds_read_b128 v[124:127], v13 offset:0
    ds_read_b128 v[128:131], v13 offset:1024
    ds_read_b128 v[132:135], v13 offset:2048
    ds_read_b128 v[136:139], v13 offset:3072
    ds_read_b128 v[140:143], v13 offset:4096
    ds_read_b128 v[144:147], v13 offset:5120
    ds_read_b128 v[148:151], v13 offset:6144
    ds_read_b128 v[152:155], v13 offset:7168
    s_waitcnt lgkmcnt(0)
layerb1_kernel_p0_step:
    s_cmp_lt_u32 s14, 32
    s_cselect_b32 s18, s16, s17
    s_and_b32 s20, s14, 31
    s_lshl_b32 s20, s20, 16
    s_add_u32 s18, s18, s20
    s_add_u32 s22, s18, 36864
    s_add_u32 s23, s18, 37888
    s_add_u32 s24, s18, 38912
layerb1_kernel_p0_poll:
    buffer_load_dwordx4 v[16:19], v12, s[8:11], s22 offen sc1
    buffer_load_dwordx4 v[20:23], v12, s[8:11], s23 offen sc1
    buffer_load_dwordx4 v[24:27], v12, s[8:11], s24 offen sc1
    s_waitcnt vmcnt(0)
    ds_write_b128 v14, v[16:19] offset:0
    ds_write_b128 v14, v[20:23] offset:1024
    ds_write_b128 v14, v[24:27] offset:2048
    v_max3_u32 v88, v16, v17, v18
    v_max3_u32 v88, v88, v19, v20
    v_max3_u32 v88, v88, v21, v22
    v_max3_u32 v88, v88, v23, v24
    v_max3_u32 v88, v88, v25, v26
    v_max_u32 v88, v88, v27
    v_cmp_eq_u32 vcc, -1, v88
    s_sub_u32 s15, s15, 1
    s_cbranch_scc1 layerb1_kernel_bail
    s_cbranch_vccnz layerb1_kernel_p0_poll
    v_smfmac_f32_16x16x64_bf16 v[56:59], v[16:19], a[0:7], v2
    v_smfmac_f32_16x16x64_bf16 v[60:63], v[16:19], a[8:15], v2
    v_smfmac_f32_16x16x64_bf16 v[64:67], v[16:19], a[16:23], v2
    v_smfmac_f32_16x16x64_bf16 v[56:59], v[20:23], v[124:131], v2
    ds_read_b128 v[124:127], v13 offset:8192
    v_smfmac_f32_16x16x64_bf16 v[60:63], v[20:23], a[24:31], v2
    s_waitcnt lgkmcnt(1)
    s_barrier
    v_smfmac_f32_16x16x64_bf16 v[64:67], v[20:23], a[32:39], v2
    ds_read_b128 v[28:31], v14 offset:3072
    v_smfmac_f32_16x16x64_bf16 v[56:59], v[24:27], a[40:47], v2
    ds_read_b128 v[32:35], v14 offset:4096
    v_smfmac_f32_16x16x64_bf16 v[60:63], v[24:27], v[132:139], v2
    ds_read_b128 v[36:39], v14 offset:5120
    v_smfmac_f32_16x16x64_bf16 v[64:67], v[24:27], a[48:55], v2
    ds_read_b128 v[40:43], v14 offset:6144
    v_smfmac_f32_16x16x64_bf16 v[68:71], v[16:19], a[56:63], v2
    ds_read_b128 v[44:47], v14 offset:7168
    v_smfmac_f32_16x16x64_bf16 v[68:71], v[20:23], a[64:71], v2
    s_waitcnt lgkmcnt(4)
    ds_read_b128 v[48:51], v14 offset:8192
    v_smfmac_f32_16x16x64_bf16 v[56:59], v[28:31], v[140:147], v2
    s_waitcnt lgkmcnt(4)
    ds_read_b128 v[52:55], v14 offset:9216
    v_smfmac_f32_16x16x64_bf16 v[56:59], v[32:35], a[72:79], v2
    s_waitcnt lgkmcnt(4)
    ds_read_b128 v[128:131], v13 offset:9216
    v_smfmac_f32_16x16x64_bf16 v[56:59], v[36:39], a[80:87], v2
    s_waitcnt lgkmcnt(4)
    ds_read_b128 v[132:135], v13 offset:10240
    v_smfmac_f32_16x16x64_bf16 v[56:59], v[40:43], a[88:95], v2
    s_waitcnt lgkmcnt(4)
    ds_read_b128 v[136:139], v13 offset:11264
    v_smfmac_f32_16x16x64_bf16 v[56:59], v[44:47], v[148:155], v2
    s_waitcnt lgkmcnt(4)
    ds_read_b128 v[140:143], v13 offset:12288
    v_smfmac_f32_16x16x64_bf16 v[56:59], v[48:51], a[96:103], v2
    s_waitcnt lgkmcnt(4)
    ds_read_b128 v[144:147], v13 offset:13312
    v_smfmac_f32_16x16x64_bf16 v[56:59], v[52:55], a[104:111], v2
    ds_read_b128 v[148:151], v13 offset:14336
    v_smfmac_f32_16x16x64_bf16 v[60:63], v[28:31], a[112:119], v2
    s_waitcnt lgkmcnt(5)
    ds_read_b128 v[152:155], v13 offset:15360
    v_smfmac_f32_16x16x64_bf16 v[60:63], v[32:35], v[124:131], v2
    ds_read_b128 v[124:127], v13 offset:16384
    v_add_f32 v56, v56, v58
    v_smfmac_f32_16x16x64_bf16 v[60:63], v[36:39], a[120:127], v2
    ds_read_b128 v[128:131], v13 offset:17408
    v_add_f32 v57, v57, v59
    v_smfmac_f32_16x16x64_bf16 v[60:63], v[40:43], a[128:135], v2
    v_cvt_pk_bf16_f32 v56, v56, v57
    v_smfmac_f32_16x16x64_bf16 v[60:63], v[44:47], a[136:143], v2
    s_waitcnt lgkmcnt(6)
    ds_write_b16 v3, v56 offset:0
    v_smfmac_f32_16x16x64_bf16 v[60:63], v[48:51], v[132:139], v2
    ds_write_b16_d16_hi v3, v56 offset:400
    v_smfmac_f32_16x16x64_bf16 v[60:63], v[52:55], a[144:151], v2
    ds_read_b128 v[132:135], v13 offset:18432
    v_smfmac_f32_16x16x64_bf16 v[64:67], v[28:31], a[152:159], v2
    ds_read_b128 v[136:139], v13 offset:19456
    v_smfmac_f32_16x16x64_bf16 v[64:67], v[32:35], a[160:167], v2
    s_waitcnt lgkmcnt(8)
    v_add_f32 v60, v60, v62
    v_smfmac_f32_16x16x64_bf16 v[64:67], v[36:39], v[140:147], v2
    ds_read_b128 v[140:143], v13 offset:20480
    v_add_f32 v61, v61, v63
    v_smfmac_f32_16x16x64_bf16 v[64:67], v[40:43], a[168:175], v2
    ds_read_b128 v[144:147], v13 offset:21504
    v_cvt_pk_bf16_f32 v60, v60, v61
    v_smfmac_f32_16x16x64_bf16 v[64:67], v[44:47], a[176:183], v2
    ds_write_b16 v3, v60 offset:128
    v_smfmac_f32_16x16x64_bf16 v[64:67], v[48:51], a[184:191], v2
    s_waitcnt lgkmcnt(9)
    ds_write_b16_d16_hi v3, v60 offset:528
    v_smfmac_f32_16x16x64_bf16 v[64:67], v[52:55], v[148:155], v2
    ds_read_b128 v[148:151], v13 offset:22528
    v_smfmac_f32_16x16x64_bf16 v[68:71], v[28:31], a[192:199], v2
    ds_read_b128 v[152:155], v13 offset:23552
    v_smfmac_f32_16x16x64_bf16 v[68:71], v[32:35], a[200:207], v2
    v_add_f32 v64, v64, v66
    v_smfmac_f32_16x16x64_bf16 v[68:71], v[36:39], a[208:215], v2
    s_waitcnt lgkmcnt(10)
    v_add_f32 v65, v65, v67
    v_smfmac_f32_16x16x64_bf16 v[68:71], v[40:43], v[124:131], v2
    ds_read_b128 v[124:127], v13 offset:24576
    v_cvt_pk_bf16_f32 v64, v64, v65
    v_smfmac_f32_16x16x64_bf16 v[68:71], v[44:47], a[216:223], v2
    ds_write_b16 v3, v64 offset:256
    v_smfmac_f32_16x16x64_bf16 v[68:71], v[48:51], a[224:231], v2
    ds_write_b16_d16_hi v3, v64 offset:656
    v_smfmac_f32_16x16x64_bf16 v[68:71], v[52:55], a[232:239], v2
    s_waitcnt lgkmcnt(9)
    ds_read_b128 v[128:131], v13 offset:25600
    v_smfmac_f32_16x16x64_bf16 v[68:71], v[24:27], v[132:139], v2
    ds_read_b128 v[132:135], v13 offset:26624
    v_smfmac_f32_16x16x64_bf16 v[72:75], v[28:31], a[240:247], v2
    ds_read_b128 v[136:139], v13 offset:27648
    v_smfmac_f32_16x16x64_bf16 v[72:75], v[32:35], a[248:255], v2
    v_add_f32 v68, v68, v70
    v_smfmac_f32_16x16x64_bf16 v[72:75], v[36:39], v[156:163], v2
    s_waitcnt lgkmcnt(10)
    v_add_f32 v69, v69, v71
    v_smfmac_f32_16x16x64_bf16 v[72:75], v[40:43], v[140:147], v2
    ds_read_b128 v[140:143], v13 offset:28672
    v_cvt_pk_bf16_f32 v68, v68, v69
    v_smfmac_f32_16x16x64_bf16 v[72:75], v[44:47], v[164:171], v2
    s_waitcnt lgkmcnt(4)
    s_barrier
    v_smfmac_f32_16x16x64_bf16 v[72:75], v[48:51], v[172:179], v2
    ds_read_b128 v[88:91], v4 offset:0
    v_smfmac_f32_16x16x64_bf16 v[72:75], v[52:55], v[180:187], v2
    ds_read_b128 v[92:95], v4 offset:128
    v_smfmac_f32_16x16x64_bf16 v[72:75], v[16:19], v[148:155], v2
    ds_read_b128 v[96:99], v4 offset:256
    v_smfmac_f32_16x16x64_bf16 v[72:75], v[20:23], v[188:195], v2
    ds_write_b16 v3, v68 offset:3200
    v_smfmac_f32_16x16x64_bf16 v[72:75], v[24:27], v[196:203], v2
    s_waitcnt lgkmcnt(7)
    ds_write_b16_d16_hi v3, v68 offset:3600
    v_smfmac_f32_16x16x64_bf16 v[76:79], v[28:31], v[124:131], v2
    s_waitcnt lgkmcnt(4)
    ds_read_b128 v[144:147], v13 offset:29696
    v_smfmac_f32_16x16x64_bf16 v[80:83], v[88:91], v[100:107], v2
    s_waitcnt lgkmcnt(4)
    ds_read_b128 v[148:151], v13 offset:30720
    v_add_f32 v72, v72, v74
    v_smfmac_f32_16x16x64_bf16 v[80:83], v[92:95], v[108:115], v2
    s_waitcnt lgkmcnt(4)
    ds_read_b128 v[152:155], v13 offset:31744
    v_add_f32 v73, v73, v75
    v_smfmac_f32_16x16x64_bf16 v[80:83], v[96:99], v[116:123], v2
    v_cvt_pk_bf16_f32 v72, v72, v73
    v_smfmac_f32_16x16x64_bf16 v[76:79], v[32:35], v[204:211], v2
    ds_write_b16 v3, v72 offset:3328
    v_smfmac_f32_16x16x64_bf16 v[76:79], v[36:39], v[212:219], v2
    ds_write_b16_d16_hi v3, v72 offset:3728
    v_smfmac_f32_16x16x64_bf16 v[76:79], v[40:43], v[132:139], v2
    v_add_f32 v56, v80, v82
    v_smfmac_f32_16x16x64_bf16 v[76:79], v[44:47], v[220:227], v2
    v_mul_f32 v56, 0x3dd53b95, v56
    v_smfmac_f32_16x16x64_bf16 v[76:79], v[48:51], v[228:235], v2
    s_waitcnt lgkmcnt(4)
    v_max_f32_dpp v58, v56, v56 row_ror:8 row_mask:0xf bank_mask:0xf
    v_smfmac_f32_16x16x64_bf16 v[76:79], v[52:55], v[140:147], v2
    s_waitcnt lgkmcnt(0)
    s_barrier
    v_max_f32_dpp v58, v58, v58 row_ror:4 row_mask:0xf bank_mask:0xf
    v_smfmac_f32_16x16x64_bf16 v[76:79], v[16:19], v[236:243], v2
    ds_read_b128 v[100:103], v5 offset:0
    v_max_f32_dpp v58, v58, v58 row_ror:2 row_mask:0xf bank_mask:0xf
    v_smfmac_f32_16x16x64_bf16 v[76:79], v[20:23], v[148:155], v2
    ds_read_b128 v[104:107], v5 offset:16
    v_max_f32_dpp v58, v58, v58 row_ror:1 row_mask:0xf bank_mask:0xf
    v_smfmac_f32_16x16x64_bf16 v[76:79], v[24:27], v[244:251], v2
    ds_read_b128 v[108:111], v5 offset:128
    v_sub_f32 v60, v56, v58
    ds_read_b128 v[112:115], v5 offset:144
    v_exp_f32 v60, v60
    s_nop 1
    v_add_f32_dpp v59, v60, v60 row_ror:8 row_mask:0xf bank_mask:0xf
    s_nop 1
    v_add_f32_dpp v59, v59, v59 row_ror:4 row_mask:0xf bank_mask:0xf
    s_nop 1
    v_add_f32_dpp v59, v59, v59 row_ror:2 row_mask:0xf bank_mask:0xf
    s_nop 1
    v_add_f32_dpp v59, v59, v59 row_ror:1 row_mask:0xf bank_mask:0xf
    v_add_f32 v76, v76, v78
    v_add_f32 v77, v77, v79
    v_cvt_pk_bf16_f32 v76, v76, v77
    ds_write_b16 v3, v76 offset:3456
    ds_write_b16_d16_hi v3, v76 offset:3856
    ds_write_b64 v6, v[58:59] offset:0
    s_waitcnt lgkmcnt(5)
    v_smfmac_f32_16x16x64_bf16 v[84:87], v[88:91], v[100:107], v2
    s_waitcnt lgkmcnt(3)
    v_smfmac_f32_16x16x64_bf16 v[84:87], v[92:95], v[108:115], v2
    s_waitcnt lgkmcnt(0)
    s_barrier
    ds_read_b128 v[116:119], v5 offset:256
    ds_read_b128 v[120:123], v5 offset:272
    ds_read_b64 v[16:17], v6 offset:512
    s_waitcnt lgkmcnt(1)
    v_smfmac_f32_16x16x64_bf16 v[84:87], v[96:99], v[116:123], v2
    s_waitcnt lgkmcnt(0)
    v_max_f32 v18, v58, v16
    v_sub_f32 v19, v58, v18
    v_sub_f32 v20, v16, v18
    v_exp_f32 v19, v19
    v_exp_f32 v20, v20
    s_nop 0
    v_mul_f32 v21, v59, v19
    v_mul_f32 v60, v60, v19
    v_fmac_f32 v21, v17, v20
    v_add_f32 v22, v84, v86
    v_mul_f32 v22, 0x3dd53b95, v22
    v_max_f32 v23, v22, v18
    s_nop 0
    v_max_f32_dpp v24, v22, v23 row_ror:4 row_mask:0xf bank_mask:0xf
    s_nop 1
    v_max_f32_dpp v24, v24, v24 row_ror:2 row_mask:0xf bank_mask:0xf
    s_nop 1
    v_max_f32_dpp v24, v24, v24 row_ror:1 row_mask:0xf bank_mask:0xf
    v_sub_f32 v25, v22, v24
    v_sub_f32 v26, v18, v24
    v_exp_f32 v25, v25
    v_exp_f32 v26, v26
    s_nop 0
    v_add_f32_dpp v23, v25, v25 row_ror:4 row_mask:0xf bank_mask:0xf
    v_mul_f32 v60, v60, v26
    s_nop 0
    v_add_f32_dpp v23, v23, v23 row_ror:2 row_mask:0xf bank_mask:0xf
    s_nop 1
    v_add_f32_dpp v23, v23, v23 row_ror:1 row_mask:0xf bank_mask:0xf
    v_fmac_f32 v23, v26, v21
    v_rcp_f32 v27, v23
    s_nop 0
    v_mul_f32 v60, v60, v27
    v_mul_f32 v25, v25, v27
    s_nop 0
    v_mov_b32_dpp v19, v60 quad_perm:[1,0,3,2] row_mask:0xf bank_mask:0xf
    v_mov_b32_dpp v20, v25 quad_perm:[1,0,3,2] row_mask:0xf bank_mask:0xf
    v_cvt_pk_bf16_f32 v28, v60, v19
    v_cvt_pk_bf16_f32 v25, v25, v20
    s_nop 0
    v_mov_b32_dpp v29, v28 row_shl:2 row_mask:0xf bank_mask:0xf
    v_mov_b32_dpp v30, v28 row_shl:4 row_mask:0xf bank_mask:0xf
    v_mov_b32_dpp v31, v28 row_shl:6 row_mask:0xf bank_mask:0xf
    v_mov_b32_dpp v28, v25 row_shr:4 row_mask:0xf bank_mask:0x2
    v_mov_b32_dpp v29, v25 row_shr:2 row_mask:0xf bank_mask:0x2
    v_mov_b32_dpp v30, v25 quad_perm:[0,1,2,3] row_mask:0xf bank_mask:0x2
    v_mov_b32_dpp v31, v25 row_shl:2 row_mask:0xf bank_mask:0x2
    s_mov_b32 exec_lo, 0x1110111
    s_mov_b32 exec_hi, 0x1010101
    buffer_store_dwordx4 v[28:31], v7, s[8:11], s18 offen sc1
    s_mov_b64 exec, -1
    ds_read_b128 v[40:43], v10
    s_add_u32 s28, s14, 1
    s_min_u32 s28, s28, 63
    s_cmp_gt_u32 s47, s28
    s_cbranch_scc1 layerb1_kernel_p0_gw2_ok
layerb1_kernel_p0_gw2_lp:
    buffer_load_dword v253, v255, s[8:11], s48 offen sc1
    s_waitcnt vmcnt(0)
    v_readlane_b32 s47, v253, 0
    v_readlane_b32 s29, v253, 1
    s_nop 0
    s_min_u32 s47, s47, s29
    s_sub_u32 s15, s15, 1
    s_cbranch_scc1 layerb1_kernel_bail
    s_cmp_gt_u32 s47, s28
    s_cbranch_scc0 layerb1_kernel_p0_gw2_lp
layerb1_kernel_p0_gw2_ok:
    s_mul_i32 s20, s28, 393216
    s_add_u32 s20, s20, s44
    s_add_u32 s21, s20, 0
    buffer_load_dwordx4 v[100:103], v9, s[8:11], s21 offen offset:0 sc1
    buffer_load_dwordx4 v[104:107], v9, s[8:11], s21 offen offset:512 sc1
    s_add_u32 s21, s20, 4096
    buffer_load_dwordx4 v[108:111], v9, s[8:11], s21 offen offset:0 sc1
    buffer_load_dwordx4 v[112:115], v9, s[8:11], s21 offen offset:512 sc1
    s_add_u32 s21, s20, 8192
    buffer_load_dwordx4 v[116:119], v9, s[8:11], s21 offen offset:0 sc1
    buffer_load_dwordx4 v[120:123], v9, s[8:11], s21 offen offset:512 sc1
    v_mov_b32 v56, 0
    v_mov_b32 v57, 0
    v_mov_b32 v58, 0
    v_mov_b32 v59, 0
    v_mov_b32 v60, 0
    v_mov_b32 v61, 0
    v_mov_b32 v62, 0
    v_mov_b32 v63, 0
    v_mov_b32 v64, 0
    v_mov_b32 v65, 0
    v_mov_b32 v66, 0
    v_mov_b32 v67, 0
    v_mov_b32 v68, 0
    v_mov_b32 v69, 0
    v_mov_b32 v70, 0
    v_mov_b32 v71, 0
    v_mov_b32 v72, 0
    v_mov_b32 v73, 0
    v_mov_b32 v74, 0
    v_mov_b32 v75, 0
    v_mov_b32 v76, 0
    v_mov_b32 v77, 0
    v_mov_b32 v78, 0
    v_mov_b32 v79, 0
    v_mov_b32 v80, 0
    v_mov_b32 v81, 0
    v_mov_b32 v82, 0
    v_mov_b32 v83, 0
    v_mov_b32 v84, 0
    v_mov_b32 v85, 0
    v_mov_b32 v86, 0
    v_mov_b32 v87, 0
    s_waitcnt lgkmcnt(0)
    s_mul_i32 s20, s14, 98304
    s_add_u32 s20, s20, s45
    buffer_store_dwordx4 v[40:43], v11, s[8:11], s20 offen sc1
    ds_read_b128 v[124:127], v13 offset:0
    ds_read_b128 v[128:131], v13 offset:1024
    ds_read_b128 v[132:135], v13 offset:2048
    ds_read_b128 v[136:139], v13 offset:3072
    ds_read_b128 v[140:143], v13 offset:4096
    ds_read_b128 v[144:147], v13 offset:5120
    ds_read_b128 v[148:151], v13 offset:6144
    ds_read_b128 v[152:155], v13 offset:7168
    s_waitcnt lgkmcnt(0)
    s_add_u32 s14, s14, 1
    s_cmp_lt_u32 s14, 64
    s_cbranch_scc1 layerb1_kernel_p0_step
    s_waitcnt vmcnt(0)
    s_barrier
    s_branch layerb1_kernel_end
layerb1_kernel_p1_start:
    v_lshrrev_b32 v16, 4, v0
    v_and_b32 v17, 15, v0
    v_and_b32 v18, 2, v0
    v_cmp_eq_u32 vcc, 0, v18
    v_mov_b32 v18, 0xeeeeeeee
    v_mov_b32 v19, 0x44444444
    v_cndmask_b32 v2, v18, v19, vcc
    v_lshrrev_b32 v20, 2, v17
    v_lshlrev_b32 v20, 1, v20
    v_and_b32 v21, 1, v17
    v_add_u32 v20, v20, v21
    v_bfe_u32 v21, v17, 1, 1
    v_lshl_add_u32 v18, v16, 1, v21
    v_lshlrev_b32 v18, 7, v18
    v_lshl_add_u32 v12, v20, 4, v18
    v_mul_u32_u24 v18, 400, v20
    v_lshl_add_u32 v18, v16, 5, v18
    v_lshl_add_u32 v18, v21, 4, v18
    v_add_u32 v4, 141312, v18
    v_mul_u32_u24 v18, 800, v16
    v_lshl_add_u32 v18, v17, 1, v18
    v_add_u32 v3, 141344, v18
    v_and_b32 v18, 7, v0
    v_mul_u32_u24 v18, 400, v18
    v_lshl_add_u32 v18, v16, 5, v18
    v_add_u32 v5, 144512, v18
    v_lshlrev_b32 v18, 3, v0
    v_add_u32 v6, 147712, v18
    v_lshlrev_b32 v18, 4, v16
    v_bfe_u32 v19, v17, 1, 2
    v_lshl_add_u32 v18, v19, 2, v18
    s_lshl_b32 s20, s12, 7
    s_add_u32 s20, s20, 0
    v_add_u32 v18, s20, v18
    v_lshrrev_b32 v19, 3, v17
    v_add_u32 v19, 3, v19
    v_lshrrev_b32 v20, 1, v19
    v_lshlrev_b32 v20, 14, v20
    v_and_b32 v19, 1, v19
    v_lshl_add_u32 v19, v19, 12, v20
    v_add_u32 v19, v19, v18
    v_mov_b32 v20, 0x7ffffff0
    v_and_b32 v21, 7, v0
    v_cmp_eq_u32 vcc, 4, v21
    v_subrev_u32 v21, 8, v18
    s_nop 0
    v_cndmask_b32 v7, v19, v21, vcc
    v_and_b32 v21, 0x29, v0
    v_cmp_eq_u32 vcc, 32, v21
    s_nop 1
    v_cndmask_b32 v8, v20, v18, vcc
    v_lshlrev_b32 v18, 4, v17
    v_lshl_add_u32 v18, v16, 10, v18
    v_add_u32 v9, 256, v18
    v_add_u32 v18, 64, v0
    v_mul_u32_u24 v19, 2731, v18
    v_lshrrev_b32 v19, 16, v19
    v_mul_u32_u24 v20, 24, v19
    v_sub_u32 v20, v18, v20
    v_mul_u32_u24 v21, 400, v19
    v_lshl_add_u32 v21, v20, 4, v21
    v_add_u32 v10, 144512, v21
    v_lshlrev_b32 v21, 4, v19
    v_lshl_add_u32 v11, v20, 7, v21
    v_add_u32 v13, 32768, v1
    v_add_u32 v14, 131072, v1
    s_mul_i32 s44, s12, 12288
    s_add_u32 s44, s44, 53477376
    s_mul_i32 s45, s12, 3072
    s_add_u32 s45, s45, 208666624
    s_mul_i32 s20, s12, 6
    s_add_u32 s21, s20, 5
    s_lshr_b32 s20, s20, 3
    s_lshr_b32 s21, s21, 3
    s_add_u32 s20, s20, 80
    s_add_u32 s21, s21, 80
    s_lshl_b32 s20, s20, 7
    s_lshl_b32 s21, s21, 7
    v_mov_b32 v255, s21
    v_mov_b32 v253, s20
    v_cmp_eq_u32 vcc, 0, v0
    s_nop 1
    v_cndmask_b32 v255, v255, v253, vcc
    s_mov_b32 s47, 0
    s_mul_i32 s20, s12, 491520
    s_add_u32 s20, s20, 11657216
    s_add_u32 s21, s20, 8192
    buffer_load_dwordx4 v[16:19], v1, s[8:11], s21 offen offset:0
    buffer_load_dwordx4 v[20:23], v1, s[8:11], s21 offen offset:1024
    s_add_u32 s21, s20, 30720
    buffer_load_dwordx4 v[24:27], v1, s[8:11], s21 offen offset:0
    buffer_load_dwordx4 v[28:31], v1, s[8:11], s21 offen offset:1024
    s_add_u32 s21, s20, 0
    buffer_load_dwordx4 v[32:35], v1, s[8:11], s21 offen offset:0
    buffer_load_dwordx4 v[36:39], v1, s[8:11], s21 offen offset:1024
    s_add_u32 s21, s20, 14336
    buffer_load_dwordx4 v[40:43], v1, s[8:11], s21 offen offset:0
    buffer_load_dwordx4 v[44:47], v1, s[8:11], s21 offen offset:1024
    s_add_u32 s21, s20, 22528
    buffer_load_dwordx4 v[48:51], v1, s[8:11], s21 offen offset:0
    buffer_load_dwordx4 v[52:55], v1, s[8:11], s21 offen offset:1024
    s_add_u32 s21, s20, 36864
    buffer_load_dwordx4 v[56:59], v1, s[8:11], s21 offen offset:0
    buffer_load_dwordx4 v[60:63], v1, s[8:11], s21 offen offset:1024
    s_add_u32 s21, s20, 45056
    buffer_load_dwordx4 v[64:67], v1, s[8:11], s21 offen offset:0
    buffer_load_dwordx4 v[68:71], v1, s[8:11], s21 offen offset:1024
    s_add_u32 s21, s20, 59392
    buffer_load_dwordx4 v[72:75], v1, s[8:11], s21 offen offset:0
    buffer_load_dwordx4 v[76:79], v1, s[8:11], s21 offen offset:1024
    s_add_u32 s21, s20, 73728
    buffer_load_dwordx4 v[80:83], v1, s[8:11], s21 offen offset:0
    buffer_load_dwordx4 v[84:87], v1, s[8:11], s21 offen offset:1024
    s_add_u32 s21, s20, 71680
    buffer_load_dwordx4 v[88:91], v1, s[8:11], s21 offen offset:0
    buffer_load_dwordx4 v[92:95], v1, s[8:11], s21 offen offset:1024
    s_add_u32 s21, s20, 94208
    buffer_load_dwordx4 v[96:99], v1, s[8:11], s21 offen offset:0
    buffer_load_dwordx4 v[100:103], v1, s[8:11], s21 offen offset:1024
    s_add_u32 s21, s20, 88064
    buffer_load_dwordx4 v[104:107], v1, s[8:11], s21 offen offset:0
    buffer_load_dwordx4 v[108:111], v1, s[8:11], s21 offen offset:1024
    s_add_u32 s21, s20, 102400
    buffer_load_dwordx4 v[112:115], v1, s[8:11], s21 offen offset:0
    buffer_load_dwordx4 v[116:119], v1, s[8:11], s21 offen offset:1024
    s_add_u32 s21, s20, 114688
    buffer_load_dwordx4 v[120:123], v1, s[8:11], s21 offen offset:0
    buffer_load_dwordx4 v[124:127], v1, s[8:11], s21 offen offset:1024
    s_add_u32 s21, s20, 120832
    buffer_load_dwordx4 v[128:131], v1, s[8:11], s21 offen offset:0
    buffer_load_dwordx4 v[132:135], v1, s[8:11], s21 offen offset:1024
    s_add_u32 s21, s20, 110592
    buffer_load_dwordx4 v[136:139], v1, s[8:11], s21 offen offset:0
    buffer_load_dwordx4 v[140:143], v1, s[8:11], s21 offen offset:1024
    s_add_u32 s21, s20, 86016
    buffer_load_dwordx4 v[156:159], v1, s[8:11], s21 offen offset:0
    buffer_load_dwordx4 v[160:163], v1, s[8:11], s21 offen offset:1024
    s_add_u32 s21, s20, 96256
    buffer_load_dwordx4 v[164:167], v1, s[8:11], s21 offen offset:0
    buffer_load_dwordx4 v[168:171], v1, s[8:11], s21 offen offset:1024
    s_add_u32 s21, s20, 98304
    buffer_load_dwordx4 v[172:175], v1, s[8:11], s21 offen offset:0
    buffer_load_dwordx4 v[176:179], v1, s[8:11], s21 offen offset:1024
    s_add_u32 s21, s20, 100352
    buffer_load_dwordx4 v[180:183], v1, s[8:11], s21 offen offset:0
    buffer_load_dwordx4 v[184:187], v1, s[8:11], s21 offen offset:1024
    s_add_u32 s21, s20, 90112
    buffer_load_dwordx4 v[188:191], v1, s[8:11], s21 offen offset:0
    buffer_load_dwordx4 v[192:195], v1, s[8:11], s21 offen offset:1024
    s_add_u32 s21, s20, 92160
    buffer_load_dwordx4 v[196:199], v1, s[8:11], s21 offen offset:0
    buffer_load_dwordx4 v[200:203], v1, s[8:11], s21 offen offset:1024
    s_add_u32 s21, s20, 104448
    buffer_load_dwordx4 v[204:207], v1, s[8:11], s21 offen offset:0
    buffer_load_dwordx4 v[208:211], v1, s[8:11], s21 offen offset:1024
    s_add_u32 s21, s20, 106496
    buffer_load_dwordx4 v[212:215], v1, s[8:11], s21 offen offset:0
    buffer_load_dwordx4 v[216:219], v1, s[8:11], s21 offen offset:1024
    s_add_u32 s21, s20, 116736
    buffer_load_dwordx4 v[220:223], v1, s[8:11], s21 offen offset:0
    buffer_load_dwordx4 v[224:227], v1, s[8:11], s21 offen offset:1024
    s_add_u32 s21, s20, 118784
    buffer_load_dwordx4 v[228:231], v1, s[8:11], s21 offen offset:0
    buffer_load_dwordx4 v[232:235], v1, s[8:11], s21 offen offset:1024
    s_add_u32 s21, s20, 108544
    buffer_load_dwordx4 v[236:239], v1, s[8:11], s21 offen offset:0
    buffer_load_dwordx4 v[240:243], v1, s[8:11], s21 offen offset:1024
    s_add_u32 s21, s20, 112640
    buffer_load_dwordx4 v[244:247], v1, s[8:11], s21 offen offset:0
    buffer_load_dwordx4 v[248:251], v1, s[8:11], s21 offen offset:1024
    s_waitcnt vmcnt(24)
    ds_write_b128 v13, v[16:19] offset:0
    ds_write_b128 v13, v[20:23] offset:1024
    ds_write_b128 v13, v[24:27] offset:2048
    ds_write_b128 v13, v[28:31] offset:3072
    ds_write_b128 v13, v[32:35] offset:4096
    ds_write_b128 v13, v[36:39] offset:5120
    ds_write_b128 v13, v[40:43] offset:6144
    ds_write_b128 v13, v[44:47] offset:7168
    ds_write_b128 v13, v[48:51] offset:8192
    ds_write_b128 v13, v[52:55] offset:9216
    ds_write_b128 v13, v[56:59] offset:10240
    ds_write_b128 v13, v[60:63] offset:11264
    ds_write_b128 v13, v[64:67] offset:12288
    ds_write_b128 v13, v[68:71] offset:13312
    ds_write_b128 v13, v[72:75] offset:14336
    ds_write_b128 v13, v[76:79] offset:15360
    ds_write_b128 v13, v[80:83] offset:16384
    ds_write_b128 v13, v[84:87] offset:17408
    ds_write_b128 v13, v[88:91] offset:18432
    ds_write_b128 v13, v[92:95] offset:19456
    ds_write_b128 v13, v[96:99] offset:20480
    ds_write_b128 v13, v[100:103] offset:21504
    ds_write_b128 v13, v[104:107] offset:22528
    ds_write_b128 v13, v[108:111] offset:23552
    ds_write_b128 v13, v[112:115] offset:24576
    ds_write_b128 v13, v[116:119] offset:25600
    ds_write_b128 v13, v[120:123] offset:26624
    ds_write_b128 v13, v[124:127] offset:27648
    ds_write_b128 v13, v[128:131] offset:28672
    ds_write_b128 v13, v[132:135] offset:29696
    ds_write_b128 v13, v[136:139] offset:30720
    ds_write_b128 v13, v[140:143] offset:31744
    s_waitcnt lgkmcnt(0)
    s_mov_b32 s14, 0
    s_cmp_gt_u32 s47, s14
    s_cbranch_scc1 layerb1_kernel_p1_gw1_ok
layerb1_kernel_p1_gw1_lp:
    buffer_load_dword v253, v255, s[8:11], s48 offen sc1
    s_waitcnt vmcnt(0)
    v_readlane_b32 s47, v253, 0
    v_readlane_b32 s29, v253, 1
    s_nop 0
    s_min_u32 s47, s47, s29
    s_sub_u32 s15, s15, 1
    s_cbranch_scc1 layerb1_kernel_bail
    s_cmp_gt_u32 s47, s14
    s_cbranch_scc0 layerb1_kernel_p1_gw1_lp
layerb1_kernel_p1_gw1_ok:
    s_mul_i32 s20, s14, 393216
    s_add_u32 s20, s20, s44
    s_add_u32 s21, s20, 0
    buffer_load_dwordx4 v[100:103], v9, s[8:11], s21 offen offset:0 sc1
    buffer_load_dwordx4 v[104:107], v9, s[8:11], s21 offen offset:512 sc1
    s_add_u32 s21, s20, 4096
    buffer_load_dwordx4 v[108:111], v9, s[8:11], s21 offen offset:0 sc1
    buffer_load_dwordx4 v[112:115], v9, s[8:11], s21 offen offset:512 sc1
    s_add_u32 s21, s20, 8192
    buffer_load_dwordx4 v[116:119], v9, s[8:11], s21 offen offset:0 sc1
    buffer_load_dwordx4 v[120:123], v9, s[8:11], s21 offen offset:512 sc1
    v_mov_b32 v56, 0
    v_mov_b32 v57, 0
    v_mov_b32 v58, 0
    v_mov_b32 v59, 0
    v_mov_b32 v60, 0
    v_mov_b32 v61, 0
    v_mov_b32 v62, 0
    v_mov_b32 v63, 0
    v_mov_b32 v64, 0
    v_mov_b32 v65, 0
    v_mov_b32 v66, 0
    v_mov_b32 v67, 0
    v_mov_b32 v68, 0
    v_mov_b32 v69, 0
    v_mov_b32 v70, 0
    v_mov_b32 v71, 0
    v_mov_b32 v72, 0
    v_mov_b32 v73, 0
    v_mov_b32 v74, 0
    v_mov_b32 v75, 0
    v_mov_b32 v76, 0
    v_mov_b32 v77, 0
    v_mov_b32 v78, 0
    v_mov_b32 v79, 0
    v_mov_b32 v80, 0
    v_mov_b32 v81, 0
    v_mov_b32 v82, 0
    v_mov_b32 v83, 0
    v_mov_b32 v84, 0
    v_mov_b32 v85, 0
    v_mov_b32 v86, 0
    v_mov_b32 v87, 0
    ds_read_b128 v[124:127], v13 offset:0
    ds_read_b128 v[128:131], v13 offset:1024
    ds_read_b128 v[132:135], v13 offset:2048
    ds_read_b128 v[136:139], v13 offset:3072
    ds_read_b128 v[140:143], v13 offset:4096
    ds_read_b128 v[144:147], v13 offset:5120
    ds_read_b128 v[148:151], v13 offset:6144
    ds_read_b128 v[152:155], v13 offset:7168
    s_waitcnt lgkmcnt(0)
layerb1_kernel_p1_step:
    s_cmp_lt_u32 s14, 32
    s_cselect_b32 s18, s16, s17
    s_and_b32 s20, s14, 31
    s_lshl_b32 s20, s20, 16
    s_add_u32 s18, s18, s20
    s_add_u32 s22, s18, 39936
    s_add_u32 s23, s18, 49152
    s_add_u32 s24, s18, 50176
layerb1_kernel_p1_poll:
    buffer_load_dwordx4 v[28:31], v12, s[8:11], s22 offen sc1
    buffer_load_dwordx4 v[32:35], v12, s[8:11], s23 offen sc1
    buffer_load_dwordx4 v[36:39], v12, s[8:11], s24 offen sc1
    s_waitcnt vmcnt(0)
    ds_write_b128 v14, v[28:31] offset:3072
    ds_write_b128 v14, v[32:35] offset:4096
    ds_write_b128 v14, v[36:39] offset:5120
    v_max3_u32 v88, v28, v29, v30
    v_max3_u32 v88, v88, v31, v32
    v_max3_u32 v88, v88, v33, v34
    v_max3_u32 v88, v88, v35, v36
    v_max3_u32 v88, v88, v37, v38
    v_max_u32 v88, v88, v39
    v_cmp_eq_u32 vcc, -1, v88
    s_sub_u32 s15, s15, 1
    s_cbranch_scc1 layerb1_kernel_bail
    s_cbranch_vccnz layerb1_kernel_p1_poll
    v_smfmac_f32_16x16x64_bf16 v[56:59], v[28:31], a[0:7], v2
    v_smfmac_f32_16x16x64_bf16 v[60:63], v[28:31], a[8:15], v2
    v_smfmac_f32_16x16x64_bf16 v[64:67], v[28:31], a[16:23], v2
    v_smfmac_f32_16x16x64_bf16 v[56:59], v[32:35], v[124:131], v2
    ds_read_b128 v[124:127], v13 offset:8192
    v_smfmac_f32_16x16x64_bf16 v[60:63], v[32:35], a[24:31], v2
    s_waitcnt lgkmcnt(1)
    s_barrier
    v_smfmac_f32_16x16x64_bf16 v[64:67], v[32:35], a[32:39], v2
    ds_read_b128 v[16:19], v14 offset:0
    v_smfmac_f32_16x16x64_bf16 v[56:59], v[36:39], a[40:47], v2
    ds_read_b128 v[20:23], v14 offset:1024
    v_smfmac_f32_16x16x64_bf16 v[60:63], v[36:39], v[132:139], v2
    ds_read_b128 v[24:27], v14 offset:2048
    v_smfmac_f32_16x16x64_bf16 v[64:67], v[36:39], a[48:55], v2
    ds_read_b128 v[40:43], v14 offset:6144
    v_smfmac_f32_16x16x64_bf16 v[68:71], v[28:31], a[56:63], v2
    ds_read_b128 v[44:47], v14 offset:7168
    v_smfmac_f32_16x16x64_bf16 v[68:71], v[32:35], a[64:71], v2
    s_waitcnt lgkmcnt(4)
    ds_read_b128 v[48:51], v14 offset:8192
    v_smfmac_f32_16x16x64_bf16 v[56:59], v[16:19], v[140:147], v2
    s_waitcnt lgkmcnt(4)
    ds_read_b128 v[52:55], v14 offset:9216
    v_smfmac_f32_16x16x64_bf16 v[56:59], v[20:23], a[72:79], v2
    s_waitcnt lgkmcnt(4)
    ds_read_b128 v[128:131], v13 offset:9216
    v_smfmac_f32_16x16x64_bf16 v[56:59], v[24:27], a[80:87], v2
    s_waitcnt lgkmcnt(4)
    ds_read_b128 v[132:135], v13 offset:10240
    v_smfmac_f32_16x16x64_bf16 v[56:59], v[40:43], a[88:95], v2
    s_waitcnt lgkmcnt(4)
    ds_read_b128 v[136:139], v13 offset:11264
    v_smfmac_f32_16x16x64_bf16 v[56:59], v[44:47], v[148:155], v2
    s_waitcnt lgkmcnt(4)
    ds_read_b128 v[140:143], v13 offset:12288
    v_smfmac_f32_16x16x64_bf16 v[56:59], v[48:51], a[96:103], v2
    s_waitcnt lgkmcnt(4)
    ds_read_b128 v[144:147], v13 offset:13312
    v_smfmac_f32_16x16x64_bf16 v[56:59], v[52:55], a[104:111], v2
    ds_read_b128 v[148:151], v13 offset:14336
    v_smfmac_f32_16x16x64_bf16 v[60:63], v[16:19], a[112:119], v2
    s_waitcnt lgkmcnt(5)
    ds_read_b128 v[152:155], v13 offset:15360
    v_smfmac_f32_16x16x64_bf16 v[60:63], v[20:23], v[124:131], v2
    ds_read_b128 v[124:127], v13 offset:16384
    v_add_f32 v56, v56, v58
    v_smfmac_f32_16x16x64_bf16 v[60:63], v[24:27], a[120:127], v2
    ds_read_b128 v[128:131], v13 offset:17408
    v_add_f32 v57, v57, v59
    v_smfmac_f32_16x16x64_bf16 v[60:63], v[40:43], a[128:135], v2
    v_cvt_pk_bf16_f32 v56, v56, v57
    v_smfmac_f32_16x16x64_bf16 v[60:63], v[44:47], a[136:143], v2
    s_waitcnt lgkmcnt(6)
    ds_write_b16 v3, v56 offset:0
    v_smfmac_f32_16x16x64_bf16 v[60:63], v[48:51], v[132:139], v2
    ds_write_b16_d16_hi v3, v56 offset:400
    v_smfmac_f32_16x16x64_bf16 v[60:63], v[52:55], a[144:151], v2
    ds_read_b128 v[132:135], v13 offset:18432
    v_smfmac_f32_16x16x64_bf16 v[64:67], v[16:19], a[152:159], v2
    ds_read_b128 v[136:139], v13 offset:19456
    v_smfmac_f32_16x16x64_bf16 v[64:67], v[20:23], a[160:167], v2
    s_waitcnt lgkmcnt(8)
    v_add_f32 v60, v60, v62
    v_smfmac_f32_16x16x64_bf16 v[64:67], v[24:27], v[140:147], v2
    ds_read_b128 v[140:143], v13 offset:20480
    v_add_f32 v61, v61, v63
    v_smfmac_f32_16x16x64_bf16 v[64:67], v[40:43], a[168:175], v2
    ds_read_b128 v[144:147], v13 offset:21504
    v_cvt_pk_bf16_f32 v60, v60, v61
    v_smfmac_f32_16x16x64_bf16 v[64:67], v[44:47], a[176:183], v2
    ds_write_b16 v3, v60 offset:128
    v_smfmac_f32_16x16x64_bf16 v[64:67], v[48:51], a[184:191], v2
    s_waitcnt lgkmcnt(9)
    ds_write_b16_d16_hi v3, v60 offset:528
    v_smfmac_f32_16x16x64_bf16 v[64:67], v[52:55], v[148:155], v2
    ds_read_b128 v[148:151], v13 offset:22528
    v_smfmac_f32_16x16x64_bf16 v[68:71], v[16:19], a[192:199], v2
    ds_read_b128 v[152:155], v13 offset:23552
    v_smfmac_f32_16x16x64_bf16 v[68:71], v[20:23], a[200:207], v2
    v_add_f32 v64, v64, v66
    v_smfmac_f32_16x16x64_bf16 v[68:71], v[24:27], a[208:215], v2
    s_waitcnt lgkmcnt(10)
    v_add_f32 v65, v65, v67
    v_smfmac_f32_16x16x64_bf16 v[68:71], v[40:43], v[124:131], v2
    ds_read_b128 v[124:127], v13 offset:24576
    v_cvt_pk_bf16_f32 v64, v64, v65
    v_smfmac_f32_16x16x64_bf16 v[68:71], v[44:47], a[216:223], v2
    ds_write_b16 v3, v64 offset:256
    v_smfmac_f32_16x16x64_bf16 v[68:71], v[48:51], a[224:231], v2
    ds_write_b16_d16_hi v3, v64 offset:656
    v_smfmac_f32_16x16x64_bf16 v[68:71], v[52:55], a[232:239], v2
    s_waitcnt lgkmcnt(9)
    ds_read_b128 v[128:131], v13 offset:25600
    v_smfmac_f32_16x16x64_bf16 v[68:71], v[36:39], v[132:139], v2
    ds_read_b128 v[132:135], v13 offset:26624
    v_smfmac_f32_16x16x64_bf16 v[72:75], v[16:19], a[240:247], v2
    ds_read_b128 v[136:139], v13 offset:27648
    v_smfmac_f32_16x16x64_bf16 v[72:75], v[20:23], a[248:255], v2
    v_add_f32 v68, v68, v70
    v_smfmac_f32_16x16x64_bf16 v[72:75], v[24:27], v[156:163], v2
    s_waitcnt lgkmcnt(10)
    v_add_f32 v69, v69, v71
    v_smfmac_f32_16x16x64_bf16 v[72:75], v[40:43], v[140:147], v2
    ds_read_b128 v[140:143], v13 offset:28672
    v_cvt_pk_bf16_f32 v68, v68, v69
    v_smfmac_f32_16x16x64_bf16 v[72:75], v[44:47], v[164:171], v2
    s_waitcnt lgkmcnt(4)
    s_barrier
    v_smfmac_f32_16x16x64_bf16 v[72:75], v[48:51], v[172:179], v2
    ds_read_b128 v[88:91], v4 offset:0
    v_smfmac_f32_16x16x64_bf16 v[72:75], v[52:55], v[180:187], v2
    ds_read_b128 v[92:95], v4 offset:128
    v_smfmac_f32_16x16x64_bf16 v[72:75], v[28:31], v[148:155], v2
    ds_read_b128 v[96:99], v4 offset:256
    v_smfmac_f32_16x16x64_bf16 v[72:75], v[32:35], v[188:195], v2
    ds_write_b16 v3, v68 offset:3200
    v_smfmac_f32_16x16x64_bf16 v[72:75], v[36:39], v[196:203], v2
    s_waitcnt lgkmcnt(7)
    ds_write_b16_d16_hi v3, v68 offset:3600
    v_smfmac_f32_16x16x64_bf16 v[76:79], v[16:19], v[124:131], v2
    s_waitcnt lgkmcnt(4)
    ds_read_b128 v[144:147], v13 offset:29696
    v_smfmac_f32_16x16x64_bf16 v[80:83], v[88:91], v[100:107], v2
    s_waitcnt lgkmcnt(4)
    ds_read_b128 v[148:151], v13 offset:30720
    v_add_f32 v72, v72, v74
    v_smfmac_f32_16x16x64_bf16 v[80:83], v[92:95], v[108:115], v2
    s_waitcnt lgkmcnt(4)
    ds_read_b128 v[152:155], v13 offset:31744
    v_add_f32 v73, v73, v75
    v_smfmac_f32_16x16x64_bf16 v[80:83], v[96:99], v[116:123], v2
    v_cvt_pk_bf16_f32 v72, v72, v73
    v_smfmac_f32_16x16x64_bf16 v[76:79], v[20:23], v[204:211], v2
    ds_write_b16 v3, v72 offset:3328
    v_smfmac_f32_16x16x64_bf16 v[76:79], v[24:27], v[212:219], v2
    ds_write_b16_d16_hi v3, v72 offset:3728
    v_smfmac_f32_16x16x64_bf16 v[76:79], v[40:43], v[132:139], v2
    v_add_f32 v56, v80, v82
    v_smfmac_f32_16x16x64_bf16 v[76:79], v[44:47], v[220:227], v2
    v_mul_f32 v56, 0x3dd53b95, v56
    v_smfmac_f32_16x16x64_bf16 v[76:79], v[48:51], v[228:235], v2
    s_waitcnt lgkmcnt(4)
    v_max_f32_dpp v58, v56, v56 row_ror:8 row_mask:0xf bank_mask:0xf
    v_smfmac_f32_16x16x64_bf16 v[76:79], v[52:55], v[140:147], v2
    s_waitcnt lgkmcnt(0)
    s_barrier
    v_max_f32_dpp v58, v58, v58 row_ror:4 row_mask:0xf bank_mask:0xf
    v_smfmac_f32_16x16x64_bf16 v[76:79], v[28:31], v[236:243], v2
    ds_read_b128 v[100:103], v5 offset:0
    v_max_f32_dpp v58, v58, v58 row_ror:2 row_mask:0xf bank_mask:0xf
    v_smfmac_f32_16x16x64_bf16 v[76:79], v[32:35], v[148:155], v2
    ds_read_b128 v[104:107], v5 offset:16
    v_max_f32_dpp v58, v58, v58 row_ror:1 row_mask:0xf bank_mask:0xf
    v_smfmac_f32_16x16x64_bf16 v[76:79], v[36:39], v[244:251], v2
    ds_read_b128 v[108:111], v5 offset:128
    v_sub_f32 v60, v56, v58
    ds_read_b128 v[112:115], v5 offset:144
    v_exp_f32 v60, v60
    s_nop 1
    v_add_f32_dpp v59, v60, v60 row_ror:8 row_mask:0xf bank_mask:0xf
    s_nop 1
    v_add_f32_dpp v59, v59, v59 row_ror:4 row_mask:0xf bank_mask:0xf
    s_nop 1
    v_add_f32_dpp v59, v59, v59 row_ror:2 row_mask:0xf bank_mask:0xf
    s_nop 1
    v_add_f32_dpp v59, v59, v59 row_ror:1 row_mask:0xf bank_mask:0xf
    v_add_f32 v76, v76, v78
    v_add_f32 v77, v77, v79
    v_cvt_pk_bf16_f32 v76, v76, v77
    ds_write_b16 v3, v76 offset:3456
    ds_write_b16_d16_hi v3, v76 offset:3856
    ds_write_b64 v6, v[58:59] offset:512
    s_waitcnt lgkmcnt(5)
    v_smfmac_f32_16x16x64_bf16 v[84:87], v[88:91], v[100:107], v2
    s_waitcnt lgkmcnt(3)
    v_smfmac_f32_16x16x64_bf16 v[84:87], v[92:95], v[108:115], v2
    s_waitcnt lgkmcnt(0)
    s_barrier
    ds_read_b128 v[116:119], v5 offset:256
    ds_read_b128 v[120:123], v5 offset:272
    ds_read_b64 v[16:17], v6 offset:0
    s_waitcnt lgkmcnt(1)
    v_smfmac_f32_16x16x64_bf16 v[84:87], v[96:99], v[116:123], v2
    s_waitcnt lgkmcnt(0)
    v_max_f32 v18, v58, v16
    v_sub_f32 v19, v58, v18
    v_sub_f32 v20, v16, v18
    v_exp_f32 v19, v19
    v_exp_f32 v20, v20
    s_nop 0
    v_mul_f32 v21, v59, v19
    v_mul_f32 v60, v60, v19
    v_fmac_f32 v21, v17, v20
    v_add_f32 v22, v84, v86
    v_mul_f32 v22, 0x3dd53b95, v22
    v_max_f32 v23, v22, v18
    s_nop 0
    v_max_f32_dpp v24, v22, v23 row_ror:4 row_mask:0xf bank_mask:0xf
    s_nop 1
    v_max_f32_dpp v24, v24, v24 row_ror:2 row_mask:0xf bank_mask:0xf
    s_nop 1
    v_max_f32_dpp v24, v24, v24 row_ror:1 row_mask:0xf bank_mask:0xf
    v_sub_f32 v25, v22, v24
    v_sub_f32 v26, v18, v24
    v_exp_f32 v25, v25
    v_exp_f32 v26, v26
    s_nop 0
    v_add_f32_dpp v23, v25, v25 row_ror:4 row_mask:0xf bank_mask:0xf
    v_mul_f32 v60, v60, v26
    s_nop 0
    v_add_f32_dpp v23, v23, v23 row_ror:2 row_mask:0xf bank_mask:0xf
    s_nop 1
    v_add_f32_dpp v23, v23, v23 row_ror:1 row_mask:0xf bank_mask:0xf
    v_fmac_f32 v23, v26, v21
    v_rcp_f32 v27, v23
    s_nop 0
    v_mul_f32 v60, v60, v27
    v_mul_f32 v25, v25, v27
    s_nop 0
    v_mov_b32_dpp v19, v60 quad_perm:[1,0,3,2] row_mask:0xf bank_mask:0xf
    v_mov_b32_dpp v20, v25 quad_perm:[1,0,3,2] row_mask:0xf bank_mask:0xf
    v_cvt_pk_bf16_f32 v28, v60, v19
    v_cvt_pk_bf16_f32 v25, v25, v20
    s_nop 0
    v_mov_b32_dpp v29, v28 row_shl:2 row_mask:0xf bank_mask:0xf
    v_mov_b32_dpp v30, v28 row_shl:4 row_mask:0xf bank_mask:0xf
    v_mov_b32_dpp v31, v28 row_shl:6 row_mask:0xf bank_mask:0xf
    v_mov_b32_dpp v28, v25 row_shr:4 row_mask:0xf bank_mask:0x2
    v_mov_b32_dpp v29, v25 row_shr:2 row_mask:0xf bank_mask:0x2
    v_mov_b32_dpp v30, v25 quad_perm:[0,1,2,3] row_mask:0xf bank_mask:0x2
    v_mov_b32_dpp v31, v25 row_shl:2 row_mask:0xf bank_mask:0x2
    s_mov_b32 exec_lo, 0x1010101
    s_mov_b32 exec_hi, 0x1110111
    buffer_store_dwordx4 v[28:31], v7, s[8:11], s18 offen sc1
    s_mov_b64 exec, -1
    ds_read_b128 v[40:43], v10
    s_add_u32 s28, s14, 1
    s_min_u32 s28, s28, 63
    s_cmp_gt_u32 s47, s28
    s_cbranch_scc1 layerb1_kernel_p1_gw2_ok
layerb1_kernel_p1_gw2_lp:
    buffer_load_dword v253, v255, s[8:11], s48 offen sc1
    s_waitcnt vmcnt(0)
    v_readlane_b32 s47, v253, 0
    v_readlane_b32 s29, v253, 1
    s_nop 0
    s_min_u32 s47, s47, s29
    s_sub_u32 s15, s15, 1
    s_cbranch_scc1 layerb1_kernel_bail
    s_cmp_gt_u32 s47, s28
    s_cbranch_scc0 layerb1_kernel_p1_gw2_lp
layerb1_kernel_p1_gw2_ok:
    s_mul_i32 s20, s28, 393216
    s_add_u32 s20, s20, s44
    s_add_u32 s21, s20, 0
    buffer_load_dwordx4 v[100:103], v9, s[8:11], s21 offen offset:0 sc1
    buffer_load_dwordx4 v[104:107], v9, s[8:11], s21 offen offset:512 sc1
    s_add_u32 s21, s20, 4096
    buffer_load_dwordx4 v[108:111], v9, s[8:11], s21 offen offset:0 sc1
    buffer_load_dwordx4 v[112:115], v9, s[8:11], s21 offen offset:512 sc1
    s_add_u32 s21, s20, 8192
    buffer_load_dwordx4 v[116:119], v9, s[8:11], s21 offen offset:0 sc1
    buffer_load_dwordx4 v[120:123], v9, s[8:11], s21 offen offset:512 sc1
    v_mov_b32 v56, 0
    v_mov_b32 v57, 0
    v_mov_b32 v58, 0
    v_mov_b32 v59, 0
    v_mov_b32 v60, 0
    v_mov_b32 v61, 0
    v_mov_b32 v62, 0
    v_mov_b32 v63, 0
    v_mov_b32 v64, 0
    v_mov_b32 v65, 0
    v_mov_b32 v66, 0
    v_mov_b32 v67, 0
    v_mov_b32 v68, 0
    v_mov_b32 v69, 0
    v_mov_b32 v70, 0
    v_mov_b32 v71, 0
    v_mov_b32 v72, 0
    v_mov_b32 v73, 0
    v_mov_b32 v74, 0
    v_mov_b32 v75, 0
    v_mov_b32 v76, 0
    v_mov_b32 v77, 0
    v_mov_b32 v78, 0
    v_mov_b32 v79, 0
    v_mov_b32 v80, 0
    v_mov_b32 v81, 0
    v_mov_b32 v82, 0
    v_mov_b32 v83, 0
    v_mov_b32 v84, 0
    v_mov_b32 v85, 0
    v_mov_b32 v86, 0
    v_mov_b32 v87, 0
    s_waitcnt lgkmcnt(0)
    s_mul_i32 s20, s14, 98304
    s_add_u32 s20, s20, s45
    buffer_store_dwordx4 v[40:43], v11, s[8:11], s20 offen sc1
    ds_read_b128 v[124:127], v13 offset:0
    ds_read_b128 v[128:131], v13 offset:1024
    ds_read_b128 v[132:135], v13 offset:2048
    ds_read_b128 v[136:139], v13 offset:3072
    ds_read_b128 v[140:143], v13 offset:4096
    ds_read_b128 v[144:147], v13 offset:5120
    ds_read_b128 v[148:151], v13 offset:6144
    ds_read_b128 v[152:155], v13 offset:7168
    s_waitcnt lgkmcnt(0)
    s_add_u32 s14, s14, 1
    s_cmp_lt_u32 s14, 64
    s_cbranch_scc1 layerb1_kernel_p1_step
    s_waitcnt vmcnt(0)
    s_barrier
    s_branch layerb1_kernel_end
layerb1_kernel_p2_start:
    v_lshrrev_b32 v16, 4, v0
    v_and_b32 v17, 15, v0
    v_and_b32 v18, 2, v0
    v_cmp_eq_u32 vcc, 0, v18
    v_mov_b32 v18, 0xeeeeeeee
    v_mov_b32 v19, 0x44444444
    v_cndmask_b32 v2, v18, v19, vcc
    v_lshrrev_b32 v20, 2, v17
    v_lshlrev_b32 v20, 1, v20
    v_and_b32 v21, 1, v17
    v_add_u32 v20, v20, v21
    v_bfe_u32 v21, v17, 1, 1
    v_lshl_add_u32 v18, v16, 1, v21
    v_lshlrev_b32 v18, 7, v18
    v_lshl_add_u32 v12, v20, 4, v18
    v_mul_u32_u24 v18, 400, v20
    v_lshl_add_u32 v18, v16, 5, v18
    v_lshl_add_u32 v18, v21, 4, v18
    v_add_u32 v4, 141312, v18
    v_mul_u32_u24 v18, 800, v16
    v_lshl_add_u32 v18, v17, 1, v18
    v_add_u32 v3, 141376, v18
    v_and_b32 v18, 7, v0
    v_mul_u32_u24 v18, 400, v18
    v_lshl_add_u32 v18, v16, 5, v18
    v_add_u32 v5, 144512, v18
    v_lshlrev_b32 v18, 3, v0
    v_add_u32 v6, 147712, v18
    v_lshlrev_b32 v18, 4, v16
    v_bfe_u32 v19, v17, 1, 2
    v_lshl_add_u32 v18, v19, 2, v18
    s_lshl_b32 s20, s12, 7
    s_add_u32 s20, s20, 64
    v_add_u32 v18, s20, v18
    v_lshrrev_b32 v19, 3, v17
    v_add_u32 v19, 1, v19
    v_lshrrev_b32 v20, 1, v19
    v_lshlrev_b32 v20, 14, v20
    v_and_b32 v19, 1, v19
    v_lshl_add_u32 v19, v19, 12, v20
    v_add_u32 v19, v19, v18
    v_mov_b32 v20, 0x7ffffff0
    v_and_b32 v21, 7, v0
    v_cmp_eq_u32 vcc, 4, v21
    v_subrev_u32 v21, 8, v18
    s_nop 0
    v_cndmask_b32 v7, v19, v21, vcc
    v_and_b32 v21, 0x29, v0
    v_cmp_eq_u32 vcc, 0, v21
    s_nop 1
    v_cndmask_b32 v8, v20, v18, vcc
    v_lshlrev_b32 v18, 4, v17
    v_lshl_add_u32 v18, v16, 10, v18
    v_add_u32 v9, 0, v18
    v_add_u32 v18, 128, v0
    v_mul_u32_u24 v19, 2731, v18
    v_lshrrev_b32 v19, 16, v19
    v_mul_u32_u24 v20, 24, v19
    v_sub_u32 v20, v18, v20
    v_mul_u32_u24 v21, 400, v19
    v_lshl_add_u32 v21, v20, 4, v21
    v_add_u32 v10, 144512, v21
    v_lshlrev_b32 v21, 4, v19
    v_lshl_add_u32 v11, v20, 7, v21
    v_add_u32 v13, 65536, v1
    v_add_u32 v14, 131072, v1
    s_mul_i32 s44, s12, 12288
    s_add_u32 s44, s44, 53477376
    s_mul_i32 s45, s12, 3072
    s_add_u32 s45, s45, 208666624
    s_mul_i32 s20, s12, 6
    s_add_u32 s21, s20, 5
    s_lshr_b32 s20, s20, 3
    s_lshr_b32 s21, s21, 3
    s_add_u32 s20, s20, 80
    s_add_u32 s21, s21, 80
    s_lshl_b32 s20, s20, 7
    s_lshl_b32 s21, s21, 7
    v_mov_b32 v255, s21
    v_mov_b32 v253, s20
    v_cmp_eq_u32 vcc, 0, v0
    s_nop 1
    v_cndmask_b32 v255, v255, v253, vcc
    s_mov_b32 s47, 0
    s_mul_i32 s20, s12, 491520
    s_add_u32 s20, s20, 11780096
    s_add_u32 s21, s20, 14336
    buffer_load_dwordx4 v[16:19], v1, s[8:11], s21 offen offset:0
    buffer_load_dwordx4 v[20:23], v1, s[8:11], s21 offen offset:1024
    s_add_u32 s21, s20, 75776
    buffer_load_dwordx4 v[24:27], v1, s[8:11], s21 offen offset:0
    buffer_load_dwordx4 v[28:31], v1, s[8:11], s21 offen offset:1024
    s_add_u32 s21, s20, 0
    buffer_load_dwordx4 v[32:35], v1, s[8:11], s21 offen offset:0
    buffer_load_dwordx4 v[36:39], v1, s[8:11], s21 offen offset:1024
    s_add_u32 s21, s20, 8192
    buffer_load_dwordx4 v[40:43], v1, s[8:11], s21 offen offset:0
    buffer_load_dwordx4 v[44:47], v1, s[8:11], s21 offen offset:1024
    s_add_u32 s21, s20, 20480
    buffer_load_dwordx4 v[48:51], v1, s[8:11], s21 offen offset:0
    buffer_load_dwordx4 v[52:55], v1, s[8:11], s21 offen offset:1024
    s_add_u32 s21, s20, 28672
    buffer_load_dwordx4 v[56:59], v1, s[8:11], s21 offen offset:0
    buffer_load_dwordx4 v[60:63], v1, s[8:11], s21 offen offset:1024
    s_add_u32 s21, s20, 40960
    buffer_load_dwordx4 v[64:67], v1, s[8:11], s21 offen offset:0
    buffer_load_dwordx4 v[68:71], v1, s[8:11], s21 offen offset:1024
    s_add_u32 s21, s20, 49152
    buffer_load_dwordx4 v[72:75], v1, s[8:11], s21 offen offset:0
    buffer_load_dwordx4 v[76:79], v1, s[8:11], s21 offen offset:1024
    s_add_u32 s21, s20, 61440
    buffer_load_dwordx4 v[80:83], v1, s[8:11], s21 offen offset:0
    buffer_load_dwordx4 v[84:87], v1, s[8:11], s21 offen offset:1024
    s_add_u32 s21, s20, 69632
    buffer_load_dwordx4 v[88:91], v1, s[8:11], s21 offen offset:0
    buffer_load_dwordx4 v[92:95], v1, s[8:11], s21 offen offset:1024
    s_add_u32 s21, s20, 81920
    buffer_load_dwordx4 v[96:99], v1, s[8:11], s21 offen offset:0
    buffer_load_dwordx4 v[100:103], v1, s[8:11], s21 offen offset:1024
    s_add_u32 s21, s20, 90112
    buffer_load_dwordx4 v[104:107], v1, s[8:11], s21 offen offset:0
    buffer_load_dwordx4 v[108:111], v1, s[8:11], s21 offen offset:1024
    s_add_u32 s21, s20, 100352
    buffer_load_dwordx4 v[112:115], v1, s[8:11], s21 offen offset:0
    buffer_load_dwordx4 v[116:119], v1, s[8:11], s21 offen offset:1024
    s_add_u32 s21, s20, 106496
    buffer_load_dwordx4 v[120:123], v1, s[8:11], s21 offen offset:0
    buffer_load_dwordx4 v[124:127], v1, s[8:11], s21 offen offset:1024
    s_add_u32 s21, s20, 112640
    buffer_load_dwordx4 v[128:131], v1, s[8:11], s21 offen offset:0
    buffer_load_dwordx4 v[132:135], v1, s[8:11], s21 offen offset:1024
    s_add_u32 s21, s20, 120832
    buffer_load_dwordx4 v[136:139], v1, s[8:11], s21 offen offset:0
    buffer_load_dwordx4 v[140:143], v1, s[8:11], s21 offen offset:1024
    s_add_u32 s21, s20, 79872
    buffer_load_dwordx4 v[156:159], v1, s[8:11], s21 offen offset:0
    buffer_load_dwordx4 v[160:163], v1, s[8:11], s21 offen offset:1024
    s_add_u32 s21, s20, 83968
    buffer_load_dwordx4 v[164:167], v1, s[8:11], s21 offen offset:0
    buffer_load_dwordx4 v[168:171], v1, s[8:11], s21 offen offset:1024
    s_add_u32 s21, s20, 86016
    buffer_load_dwordx4 v[172:175], v1, s[8:11], s21 offen offset:0
    buffer_load_dwordx4 v[176:179], v1, s[8:11], s21 offen offset:1024
    s_add_u32 s21, s20, 88064
    buffer_load_dwordx4 v[180:183], v1, s[8:11], s21 offen offset:0
    buffer_load_dwordx4 v[184:187], v1, s[8:11], s21 offen offset:1024
    s_add_u32 s21, s20, 92160
    buffer_load_dwordx4 v[188:191], v1, s[8:11], s21 offen offset:0
    buffer_load_dwordx4 v[192:195], v1, s[8:11], s21 offen offset:1024
    s_add_u32 s21, s20, 98304
    buffer_load_dwordx4 v[196:199], v1, s[8:11], s21 offen offset:0
    buffer_load_dwordx4 v[200:203], v1, s[8:11], s21 offen offset:1024
    s_add_u32 s21, s20, 102400
    buffer_load_dwordx4 v[204:207], v1, s[8:11], s21 offen offset:0
    buffer_load_dwordx4 v[208:211], v1, s[8:11], s21 offen offset:1024
    s_add_u32 s21, s20, 104448
    buffer_load_dwordx4 v[212:215], v1, s[8:11], s21 offen offset:0
    buffer_load_dwordx4 v[216:219], v1, s[8:11], s21 offen offset:1024
    s_add_u32 s21, s20, 108544
    buffer_load_dwordx4 v[220:223], v1, s[8:11], s21 offen offset:0
    buffer_load_dwordx4 v[224:227], v1, s[8:11], s21 offen offset:1024
    s_add_u32 s21, s20, 110592
    buffer_load_dwordx4 v[228:231], v1, s[8:11], s21 offen offset:0
    buffer_load_dwordx4 v[232:235], v1, s[8:11], s21 offen offset:1024
    s_add_u32 s21, s20, 118784
    buffer_load_dwordx4 v[236:239], v1, s[8:11], s21 offen offset:0
    buffer_load_dwordx4 v[240:243], v1, s[8:11], s21 offen offset:1024
    s_add_u32 s21, s20, 116736
    buffer_load_dwordx4 v[244:247], v1, s[8:11], s21 offen offset:0
    buffer_load_dwordx4 v[248:251], v1, s[8:11], s21 offen offset:1024
    s_waitcnt vmcnt(24)
    ds_write_b128 v13, v[16:19] offset:0
    ds_write_b128 v13, v[20:23] offset:1024
    ds_write_b128 v13, v[24:27] offset:2048
    ds_write_b128 v13, v[28:31] offset:3072
    ds_write_b128 v13, v[32:35] offset:4096
    ds_write_b128 v13, v[36:39] offset:5120
    ds_write_b128 v13, v[40:43] offset:6144
    ds_write_b128 v13, v[44:47] offset:7168
    ds_write_b128 v13, v[48:51] offset:8192
    ds_write_b128 v13, v[52:55] offset:9216
    ds_write_b128 v13, v[56:59] offset:10240
    ds_write_b128 v13, v[60:63] offset:11264
    ds_write_b128 v13, v[64:67] offset:12288
    ds_write_b128 v13, v[68:71] offset:13312
    ds_write_b128 v13, v[72:75] offset:14336
    ds_write_b128 v13, v[76:79] offset:15360
    ds_write_b128 v13, v[80:83] offset:16384
    ds_write_b128 v13, v[84:87] offset:17408
    ds_write_b128 v13, v[88:91] offset:18432
    ds_write_b128 v13, v[92:95] offset:19456
    ds_write_b128 v13, v[96:99] offset:20480
    ds_write_b128 v13, v[100:103] offset:21504
    ds_write_b128 v13, v[104:107] offset:22528
    ds_write_b128 v13, v[108:111] offset:23552
    ds_write_b128 v13, v[112:115] offset:24576
    ds_write_b128 v13, v[116:119] offset:25600
    ds_write_b128 v13, v[120:123] offset:26624
    ds_write_b128 v13, v[124:127] offset:27648
    ds_write_b128 v13, v[128:131] offset:28672
    ds_write_b128 v13, v[132:135] offset:29696
    ds_write_b128 v13, v[136:139] offset:30720
    ds_write_b128 v13, v[140:143] offset:31744
    s_waitcnt lgkmcnt(0)
    s_mov_b32 s14, 0
    s_cmp_gt_u32 s47, s14
    s_cbranch_scc1 layerb1_kernel_p2_gw1_ok
layerb1_kernel_p2_gw1_lp:
    buffer_load_dword v253, v255, s[8:11], s48 offen sc1
    s_waitcnt vmcnt(0)
    v_readlane_b32 s47, v253, 0
    v_readlane_b32 s29, v253, 1
    s_nop 0
    s_min_u32 s47, s47, s29
    s_sub_u32 s15, s15, 1
    s_cbranch_scc1 layerb1_kernel_bail
    s_cmp_gt_u32 s47, s14
    s_cbranch_scc0 layerb1_kernel_p2_gw1_lp
layerb1_kernel_p2_gw1_ok:
    s_mul_i32 s20, s14, 393216
    s_add_u32 s20, s20, s44
    s_add_u32 s21, s20, 0
    buffer_load_dwordx4 v[100:103], v9, s[8:11], s21 offen offset:0 sc1
    buffer_load_dwordx4 v[104:107], v9, s[8:11], s21 offen offset:512 sc1
    s_add_u32 s21, s20, 4096
    buffer_load_dwordx4 v[108:111], v9, s[8:11], s21 offen offset:0 sc1
    buffer_load_dwordx4 v[112:115], v9, s[8:11], s21 offen offset:512 sc1
    s_add_u32 s21, s20, 8192
    buffer_load_dwordx4 v[116:119], v9, s[8:11], s21 offen offset:0 sc1
    buffer_load_dwordx4 v[120:123], v9, s[8:11], s21 offen offset:512 sc1
    v_mov_b32 v56, 0
    v_mov_b32 v57, 0
    v_mov_b32 v58, 0
    v_mov_b32 v59, 0
    v_mov_b32 v60, 0
    v_mov_b32 v61, 0
    v_mov_b32 v62, 0
    v_mov_b32 v63, 0
    v_mov_b32 v64, 0
    v_mov_b32 v65, 0
    v_mov_b32 v66, 0
    v_mov_b32 v67, 0
    v_mov_b32 v68, 0
    v_mov_b32 v69, 0
    v_mov_b32 v70, 0
    v_mov_b32 v71, 0
    v_mov_b32 v72, 0
    v_mov_b32 v73, 0
    v_mov_b32 v74, 0
    v_mov_b32 v75, 0
    v_mov_b32 v76, 0
    v_mov_b32 v77, 0
    v_mov_b32 v78, 0
    v_mov_b32 v79, 0
    v_mov_b32 v80, 0
    v_mov_b32 v81, 0
    v_mov_b32 v82, 0
    v_mov_b32 v83, 0
    v_mov_b32 v84, 0
    v_mov_b32 v85, 0
    v_mov_b32 v86, 0
    v_mov_b32 v87, 0
    ds_read_b128 v[124:127], v13 offset:0
    ds_read_b128 v[128:131], v13 offset:1024
    ds_read_b128 v[132:135], v13 offset:2048
    ds_read_b128 v[136:139], v13 offset:3072
    ds_read_b128 v[140:143], v13 offset:4096
    ds_read_b128 v[144:147], v13 offset:5120
    ds_read_b128 v[148:151], v13 offset:6144
    ds_read_b128 v[152:155], v13 offset:7168
    s_waitcnt lgkmcnt(0)
layerb1_kernel_p2_step:
    s_cmp_lt_u32 s14, 32
    s_cselect_b32 s18, s16, s17
    s_and_b32 s20, s14, 31
    s_lshl_b32 s20, s20, 16
    s_add_u32 s18, s18, s20
    s_add_u32 s22, s18, 51200
    s_add_u32 s23, s18, 52224
layerb1_kernel_p2_poll:
    buffer_load_dwordx4 v[40:43], v12, s[8:11], s22 offen sc1
    buffer_load_dwordx4 v[44:47], v12, s[8:11], s23 offen sc1
    s_waitcnt vmcnt(0)
    ds_write_b128 v14, v[40:43] offset:6144
    ds_write_b128 v14, v[44:47] offset:7168
    v_max3_u32 v88, v40, v41, v42
    v_max3_u32 v88, v88, v43, v44
    v_max3_u32 v88, v88, v45, v46
    v_max_u32 v88, v88, v47
    v_cmp_eq_u32 vcc, -1, v88
    s_sub_u32 s15, s15, 1
    s_cbranch_scc1 layerb1_kernel_bail
    s_cbranch_vccnz layerb1_kernel_p2_poll
    v_smfmac_f32_16x16x64_bf16 v[56:59], v[40:43], a[0:7], v2
    v_smfmac_f32_16x16x64_bf16 v[60:63], v[40:43], a[8:15], v2
    v_smfmac_f32_16x16x64_bf16 v[64:67], v[40:43], a[16:23], v2
    v_smfmac_f32_16x16x64_bf16 v[56:59], v[44:47], v[124:131], v2
    ds_read_b128 v[124:127], v13 offset:8192
    v_smfmac_f32_16x16x64_bf16 v[60:63], v[44:47], a[24:31], v2
    s_waitcnt lgkmcnt(1)
    s_barrier
    v_smfmac_f32_16x16x64_bf16 v[64:67], v[44:47], a[32:39], v2
    ds_read_b128 v[16:19], v14 offset:0
    v_smfmac_f32_16x16x64_bf16 v[68:71], v[40:43], a[40:47], v2
    ds_read_b128 v[20:23], v14 offset:1024
    v_smfmac_f32_16x16x64_bf16 v[68:71], v[44:47], v[132:139], v2
    ds_read_b128 v[24:27], v14 offset:2048
    v_smfmac_f32_16x16x64_bf16 v[72:75], v[40:43], a[48:55], v2
    ds_read_b128 v[28:31], v14 offset:3072
    v_smfmac_f32_16x16x64_bf16 v[72:75], v[44:47], a[56:63], v2
    ds_read_b128 v[32:35], v14 offset:4096
    v_smfmac_f32_16x16x64_bf16 v[76:79], v[40:43], a[64:71], v2
    s_waitcnt lgkmcnt(4)
    ds_read_b128 v[36:39], v14 offset:5120
    v_smfmac_f32_16x16x64_bf16 v[56:59], v[16:19], v[140:147], v2
    s_waitcnt lgkmcnt(4)
    ds_read_b128 v[48:51], v14 offset:8192
    v_smfmac_f32_16x16x64_bf16 v[56:59], v[20:23], a[72:79], v2
    s_waitcnt lgkmcnt(4)
    ds_read_b128 v[52:55], v14 offset:9216
    v_smfmac_f32_16x16x64_bf16 v[56:59], v[24:27], a[80:87], v2
    s_waitcnt lgkmcnt(4)
    ds_read_b128 v[128:131], v13 offset:9216
    v_smfmac_f32_16x16x64_bf16 v[56:59], v[28:31], a[88:95], v2
    s_waitcnt lgkmcnt(4)
    ds_read_b128 v[132:135], v13 offset:10240
    v_smfmac_f32_16x16x64_bf16 v[56:59], v[32:35], v[148:155], v2
    s_waitcnt lgkmcnt(4)
    ds_read_b128 v[136:139], v13 offset:11264
    v_smfmac_f32_16x16x64_bf16 v[56:59], v[36:39], a[96:103], v2
    s_waitcnt lgkmcnt(4)
    ds_read_b128 v[140:143], v13 offset:12288
    v_smfmac_f32_16x16x64_bf16 v[56:59], v[48:51], a[104:111], v2
    s_waitcnt lgkmcnt(4)
    ds_read_b128 v[144:147], v13 offset:13312
    v_smfmac_f32_16x16x64_bf16 v[56:59], v[52:55], a[112:119], v2
    s_waitcnt lgkmcnt(4)
    ds_read_b128 v[148:151], v13 offset:14336
    v_smfmac_f32_16x16x64_bf16 v[60:63], v[16:19], v[124:131], v2
    ds_read_b128 v[152:155], v13 offset:15360
    v_smfmac_f32_16x16x64_bf16 v[60:63], v[20:23], a[120:127], v2
    ds_read_b128 v[124:127], v13 offset:16384
    v_add_f32 v56, v56, v58
    v_smfmac_f32_16x16x64_bf16 v[60:63], v[24:27], a[128:135], v2
    ds_read_b128 v[128:131], v13 offset:17408
    v_add_f32 v57, v57, v59
    v_smfmac_f32_16x16x64_bf16 v[60:63], v[28:31], a[136:143], v2
    s_waitcnt lgkmcnt(6)
    v_cvt_pk_bf16_f32 v56, v56, v57
    v_smfmac_f32_16x16x64_bf16 v[60:63], v[32:35], v[132:139], v2
    ds_write_b16 v3, v56 offset:0
    v_smfmac_f32_16x16x64_bf16 v[60:63], v[36:39], a[144:151], v2
    ds_write_b16_d16_hi v3, v56 offset:400
    v_smfmac_f32_16x16x64_bf16 v[60:63], v[48:51], a[152:159], v2
    ds_read_b128 v[132:135], v13 offset:18432
    v_smfmac_f32_16x16x64_bf16 v[60:63], v[52:55], a[160:167], v2
    s_waitcnt lgkmcnt(7)
    ds_read_b128 v[136:139], v13 offset:19456
    v_smfmac_f32_16x16x64_bf16 v[64:67], v[16:19], v[140:147], v2
    ds_read_b128 v[140:143], v13 offset:20480
    v_smfmac_f32_16x16x64_bf16 v[64:67], v[20:23], a[168:175], v2
    ds_read_b128 v[144:147], v13 offset:21504
    v_add_f32 v60, v60, v62
    v_smfmac_f32_16x16x64_bf16 v[64:67], v[24:27], a[176:183], v2
    v_add_f32 v61, v61, v63
    v_smfmac_f32_16x16x64_bf16 v[64:67], v[28:31], a[184:191], v2
    s_waitcnt lgkmcnt(8)
    v_cvt_pk_bf16_f32 v60, v60, v61
    v_smfmac_f32_16x16x64_bf16 v[64:67], v[32:35], v[148:155], v2
    ds_write_b16 v3, v60 offset:128
    v_smfmac_f32_16x16x64_bf16 v[64:67], v[36:39], a[192:199], v2
    ds_write_b16_d16_hi v3, v60 offset:528
    v_smfmac_f32_16x16x64_bf16 v[64:67], v[48:51], a[200:207], v2
    ds_read_b128 v[148:151], v13 offset:22528
    v_smfmac_f32_16x16x64_bf16 v[64:67], v[52:55], a[208:215], v2
    s_waitcnt lgkmcnt(9)
    ds_read_b128 v[152:155], v13 offset:23552
    v_smfmac_f32_16x16x64_bf16 v[68:71], v[16:19], v[124:131], v2
    ds_read_b128 v[124:127], v13 offset:24576
    v_smfmac_f32_16x16x64_bf16 v[68:71], v[20:23], a[216:223], v2
    ds_read_b128 v[128:131], v13 offset:25600
    v_add_f32 v64, v64, v66
    v_smfmac_f32_16x16x64_bf16 v[68:71], v[24:27], a[224:231], v2
    v_add_f32 v65, v65, v67
    v_smfmac_f32_16x16x64_bf16 v[68:71], v[28:31], a[232:239], v2
    s_waitcnt lgkmcnt(8)
    v_cvt_pk_bf16_f32 v64, v64, v65
    v_smfmac_f32_16x16x64_bf16 v[68:71], v[32:35], v[132:139], v2
    ds_write_b16 v3, v64 offset:256
    v_smfmac_f32_16x16x64_bf16 v[68:71], v[36:39], a[240:247], v2
    ds_write_b16_d16_hi v3, v64 offset:656
    v_smfmac_f32_16x16x64_bf16 v[68:71], v[48:51], a[248:255], v2
    ds_read_b128 v[132:135], v13 offset:26624
    v_smfmac_f32_16x16x64_bf16 v[68:71], v[52:55], v[156:163], v2
    s_waitcnt lgkmcnt(9)
    ds_read_b128 v[136:139], v13 offset:27648
    v_smfmac_f32_16x16x64_bf16 v[72:75], v[16:19], v[140:147], v2
    ds_read_b128 v[140:143], v13 offset:28672
    v_smfmac_f32_16x16x64_bf16 v[72:75], v[20:23], v[164:171], v2
    s_waitcnt lgkmcnt(3)
    s_barrier
    v_add_f32 v68, v68, v70
    v_smfmac_f32_16x16x64_bf16 v[72:75], v[24:27], v[172:179], v2
    ds_read_b128 v[88:91], v4 offset:0
    v_add_f32 v69, v69, v71
    v_smfmac_f32_16x16x64_bf16 v[72:75], v[28:31], v[180:187], v2
    ds_read_b128 v[92:95], v4 offset:128
    v_cvt_pk_bf16_f32 v68, v68, v69
    v_smfmac_f32_16x16x64_bf16 v[72:75], v[32:35], v[148:155], v2
    ds_read_b128 v[96:99], v4 offset:256
    v_smfmac_f32_16x16x64_bf16 v[72:75], v[36:39], v[188:195], v2
    ds_write_b16 v3, v68 offset:3200
    v_smfmac_f32_16x16x64_bf16 v[72:75], v[48:51], v[196:203], v2
    ds_write_b16_d16_hi v3, v68 offset:3600
    v_smfmac_f32_16x16x64_bf16 v[72:75], v[52:55], v[124:131], v2
    s_waitcnt lgkmcnt(4)
    ds_read_b128 v[144:147], v13 offset:29696
    v_smfmac_f32_16x16x64_bf16 v[80:83], v[88:91], v[100:107], v2
    s_waitcnt lgkmcnt(4)
    ds_read_b128 v[148:151], v13 offset:30720
    v_smfmac_f32_16x16x64_bf16 v[80:83], v[92:95], v[108:115], v2
    s_waitcnt lgkmcnt(4)
    ds_read_b128 v[152:155], v13 offset:31744
    v_add_f32 v72, v72, v74
    v_smfmac_f32_16x16x64_bf16 v[80:83], v[96:99], v[116:123], v2
    v_add_f32 v73, v73, v75
    v_smfmac_f32_16x16x64_bf16 v[76:79], v[16:19], v[204:211], v2
    v_cvt_pk_bf16_f32 v72, v72, v73
    v_smfmac_f32_16x16x64_bf16 v[76:79], v[20:23], v[212:219], v2
    ds_write_b16 v3, v72 offset:3328
    v_smfmac_f32_16x16x64_bf16 v[76:79], v[24:27], v[132:139], v2
    ds_write_b16_d16_hi v3, v72 offset:3728
    v_smfmac_f32_16x16x64_bf16 v[76:79], v[28:31], v[220:227], v2
    v_add_f32 v56, v81, v83
    v_smfmac_f32_16x16x64_bf16 v[76:79], v[32:35], v[228:235], v2
    s_waitcnt lgkmcnt(4)
    v_mul_f32 v56, 0x3dd53b95, v56
    v_smfmac_f32_16x16x64_bf16 v[76:79], v[36:39], v[140:147], v2
    s_waitcnt lgkmcnt(0)
    s_barrier
    v_max_f32_dpp v58, v56, v56 row_ror:8 row_mask:0xf bank_mask:0xf
    v_smfmac_f32_16x16x64_bf16 v[76:79], v[48:51], v[236:243], v2
    ds_read_b128 v[100:103], v5 offset:0
    v_max_f32_dpp v58, v58, v58 row_ror:4 row_mask:0xf bank_mask:0xf
    v_smfmac_f32_16x16x64_bf16 v[76:79], v[52:55], v[148:155], v2
    ds_read_b128 v[104:107], v5 offset:16
    v_max_f32_dpp v58, v58, v58 row_ror:2 row_mask:0xf bank_mask:0xf
    v_smfmac_f32_16x16x64_bf16 v[76:79], v[44:47], v[244:251], v2
    ds_read_b128 v[108:111], v5 offset:128
    v_max_f32_dpp v58, v58, v58 row_ror:1 row_mask:0xf bank_mask:0xf
    ds_read_b128 v[112:115], v5 offset:144
    v_sub_f32 v60, v56, v58
    s_nop 1
    v_exp_f32 v60, v60
    s_nop 1
    v_add_f32_dpp v59, v60, v60 row_ror:8 row_mask:0xf bank_mask:0xf
    s_nop 1
    v_add_f32_dpp v59, v59, v59 row_ror:4 row_mask:0xf bank_mask:0xf
    s_nop 1
    v_add_f32_dpp v59, v59, v59 row_ror:2 row_mask:0xf bank_mask:0xf
    s_nop 1
    v_add_f32_dpp v59, v59, v59 row_ror:1 row_mask:0xf bank_mask:0xf
    v_add_f32 v76, v76, v78
    v_add_f32 v77, v77, v79
    v_cvt_pk_bf16_f32 v76, v76, v77
    ds_write_b16 v3, v76 offset:3456
    ds_write_b16_d16_hi v3, v76 offset:3856
    ds_write_b64 v6, v[58:59] offset:1024
    s_waitcnt lgkmcnt(5)
    v_smfmac_f32_16x16x64_bf16 v[84:87], v[88:91], v[100:107], v2
    s_waitcnt lgkmcnt(3)
    v_smfmac_f32_16x16x64_bf16 v[84:87], v[92:95], v[108:115], v2
    s_waitcnt lgkmcnt(0)
    s_barrier
    ds_read_b128 v[116:119], v5 offset:256
    ds_read_b128 v[120:123], v5 offset:272
    ds_read_b64 v[16:17], v6 offset:1536
    s_waitcnt lgkmcnt(1)
    v_smfmac_f32_16x16x64_bf16 v[84:87], v[96:99], v[116:123], v2
    s_waitcnt lgkmcnt(0)
    v_max_f32 v18, v58, v16
    v_sub_f32 v19, v58, v18
    v_sub_f32 v20, v16, v18
    v_exp_f32 v19, v19
    v_exp_f32 v20, v20
    s_nop 0
    v_mul_f32 v21, v59, v19
    v_mul_f32 v60, v60, v19
    v_fmac_f32 v21, v17, v20
    v_add_f32 v22, v85, v87
    v_mul_f32 v22, 0x3dd53b95, v22
    v_max_f32 v23, v22, v18
    s_nop 0
    v_max_f32_dpp v24, v22, v23 row_ror:4 row_mask:0xf bank_mask:0xf
    s_nop 1
    v_max_f32_dpp v24, v24, v24 row_ror:2 row_mask:0xf bank_mask:0xf
    s_nop 1
    v_max_f32_dpp v24, v24, v24 row_ror:1 row_mask:0xf bank_mask:0xf
    v_sub_f32 v25, v22, v24
    v_sub_f32 v26, v18, v24
    v_exp_f32 v25, v25
    v_exp_f32 v26, v26
    s_nop 0
    v_add_f32_dpp v23, v25, v25 row_ror:4 row_mask:0xf bank_mask:0xf
    v_mul_f32 v60, v60, v26
    s_nop 0
    v_add_f32_dpp v23, v23, v23 row_ror:2 row_mask:0xf bank_mask:0xf
    s_nop 1
    v_add_f32_dpp v23, v23, v23 row_ror:1 row_mask:0xf bank_mask:0xf
    v_fmac_f32 v23, v26, v21
    v_rcp_f32 v27, v23
    s_nop 0
    v_mul_f32 v60, v60, v27
    v_mul_f32 v25, v25, v27
    s_nop 0
    v_mov_b32_dpp v19, v60 quad_perm:[1,0,3,2] row_mask:0xf bank_mask:0xf
    v_mov_b32_dpp v20, v25 quad_perm:[1,0,3,2] row_mask:0xf bank_mask:0xf
    v_cvt_pk_bf16_f32 v28, v60, v19
    v_cvt_pk_bf16_f32 v25, v25, v20
    s_nop 0
    v_mov_b32_dpp v29, v28 row_shl:2 row_mask:0xf bank_mask:0xf
    v_mov_b32_dpp v30, v28 row_shl:4 row_mask:0xf bank_mask:0xf
    v_mov_b32_dpp v31, v28 row_shl:6 row_mask:0xf bank_mask:0xf
    v_mov_b32_dpp v28, v25 row_shr:4 row_mask:0xf bank_mask:0x2
    v_mov_b32_dpp v29, v25 row_shr:2 row_mask:0xf bank_mask:0x2
    v_mov_b32_dpp v30, v25 quad_perm:[0,1,2,3] row_mask:0xf bank_mask:0x2
    v_mov_b32_dpp v31, v25 row_shl:2 row_mask:0xf bank_mask:0x2
    s_mov_b32 exec_lo, 0x1110111
    s_mov_b32 exec_hi, 0x1010101
    buffer_store_dwordx4 v[28:31], v7, s[8:11], s18 offen sc1
    s_mov_b64 exec, -1
    ds_read_b128 v[40:43], v10
    s_add_u32 s28, s14, 1
    s_min_u32 s28, s28, 63
    s_cmp_gt_u32 s47, s28
    s_cbranch_scc1 layerb1_kernel_p2_gw2_ok
layerb1_kernel_p2_gw2_lp:
    buffer_load_dword v253, v255, s[8:11], s48 offen sc1
    s_waitcnt vmcnt(0)
    v_readlane_b32 s47, v253, 0
    v_readlane_b32 s29, v253, 1
    s_nop 0
    s_min_u32 s47, s47, s29
    s_sub_u32 s15, s15, 1
    s_cbranch_scc1 layerb1_kernel_bail
    s_cmp_gt_u32 s47, s28
    s_cbranch_scc0 layerb1_kernel_p2_gw2_lp
layerb1_kernel_p2_gw2_ok:
    s_mul_i32 s20, s28, 393216
    s_add_u32 s20, s20, s44
    s_add_u32 s21, s20, 0
    buffer_load_dwordx4 v[100:103], v9, s[8:11], s21 offen offset:0 sc1
    buffer_load_dwordx4 v[104:107], v9, s[8:11], s21 offen offset:512 sc1
    s_add_u32 s21, s20, 4096
    buffer_load_dwordx4 v[108:111], v9, s[8:11], s21 offen offset:0 sc1
    buffer_load_dwordx4 v[112:115], v9, s[8:11], s21 offen offset:512 sc1
    s_add_u32 s21, s20, 8192
    buffer_load_dwordx4 v[116:119], v9, s[8:11], s21 offen offset:0 sc1
    buffer_load_dwordx4 v[120:123], v9, s[8:11], s21 offen offset:512 sc1
    v_mov_b32 v56, 0
    v_mov_b32 v57, 0
    v_mov_b32 v58, 0
    v_mov_b32 v59, 0
    v_mov_b32 v60, 0
    v_mov_b32 v61, 0
    v_mov_b32 v62, 0
    v_mov_b32 v63, 0
    v_mov_b32 v64, 0
    v_mov_b32 v65, 0
    v_mov_b32 v66, 0
    v_mov_b32 v67, 0
    v_mov_b32 v68, 0
    v_mov_b32 v69, 0
    v_mov_b32 v70, 0
    v_mov_b32 v71, 0
    v_mov_b32 v72, 0
    v_mov_b32 v73, 0
    v_mov_b32 v74, 0
    v_mov_b32 v75, 0
    v_mov_b32 v76, 0
    v_mov_b32 v77, 0
    v_mov_b32 v78, 0
    v_mov_b32 v79, 0
    v_mov_b32 v80, 0
    v_mov_b32 v81, 0
    v_mov_b32 v82, 0
    v_mov_b32 v83, 0
    v_mov_b32 v84, 0
    v_mov_b32 v85, 0
    v_mov_b32 v86, 0
    v_mov_b32 v87, 0
    s_waitcnt lgkmcnt(0)
    s_mul_i32 s20, s14, 98304
    s_add_u32 s20, s20, s45
    buffer_store_dwordx4 v[40:43], v11, s[8:11], s20 offen sc1
    ds_read_b128 v[124:127], v13 offset:0
    ds_read_b128 v[128:131], v13 offset:1024
    ds_read_b128 v[132:135], v13 offset:2048
    ds_read_b128 v[136:139], v13 offset:3072
    ds_read_b128 v[140:143], v13 offset:4096
    ds_read_b128 v[144:147], v13 offset:5120
    ds_read_b128 v[148:151], v13 offset:6144
    ds_read_b128 v[152:155], v13 offset:7168
    s_waitcnt lgkmcnt(0)
    s_add_u32 s14, s14, 1
    s_cmp_lt_u32 s14, 64
    s_cbranch_scc1 layerb1_kernel_p2_step
    s_waitcnt vmcnt(0)
    s_barrier
    s_branch layerb1_kernel_end
layerb1_kernel_p3_start:
    v_lshrrev_b32 v16, 4, v0
    v_and_b32 v17, 15, v0
    v_and_b32 v18, 2, v0
    v_cmp_eq_u32 vcc, 0, v18
    v_mov_b32 v18, 0xeeeeeeee
    v_mov_b32 v19, 0x44444444
    v_cndmask_b32 v2, v18, v19, vcc
    v_lshrrev_b32 v20, 2, v17
    v_lshlrev_b32 v20, 1, v20
    v_and_b32 v21, 1, v17
    v_add_u32 v20, v20, v21
    v_bfe_u32 v21, v17, 1, 1
    v_lshl_add_u32 v18, v16, 1, v21
    v_lshlrev_b32 v18, 7, v18
    v_lshl_add_u32 v12, v20, 4, v18
    v_mul_u32_u24 v18, 400, v20
    v_lshl_add_u32 v18, v16, 5, v18
    v_lshl_add_u32 v18, v21, 4, v18
    v_add_u32 v4, 141312, v18
    v_mul_u32_u24 v18, 800, v16
    v_lshl_add_u32 v18, v17, 1, v18
    v_add_u32 v3, 141408, v18
    v_and_b32 v18, 7, v0
    v_mul_u32_u24 v18, 400, v18
    v_lshl_add_u32 v18, v16, 5, v18
    v_add_u32 v5, 144512, v18
    v_lshlrev_b32 v18, 3, v0
    v_add_u32 v6, 147712, v18
    v_lshlrev_b32 v18, 4, v16
    v_bfe_u32 v19, v17, 1, 2
    v_lshl_add_u32 v18, v19, 2, v18
    s_lshl_b32 s20, s12, 7
    s_add_u32 s20, s20, 64
    v_add_u32 v18, s20, v18
    v_lshrrev_b32 v19, 3, v17
    v_add_u32 v19, 3, v19
    v_lshrrev_b32 v20, 1, v19
    v_lshlrev_b32 v20, 14, v20
    v_and_b32 v19, 1, v19
    v_lshl_add_u32 v19, v19, 12, v20
    v_add_u32 v19, v19, v18
    v_mov_b32 v20, 0x7ffffff0
    v_and_b32 v21, 7, v0
    v_cmp_eq_u32 vcc, 4, v21
    v_subrev_u32 v21, 8, v18
    s_nop 0
    v_cndmask_b32 v7, v19, v21, vcc
    v_and_b32 v21, 0x29, v0
    v_cmp_eq_u32 vcc, 32, v21
    s_nop 1
    v_cndmask_b32 v8, v20, v18, vcc
    v_lshlrev_b32 v18, 4, v17
    v_lshl_add_u32 v18, v16, 10, v18
    v_add_u32 v9, 256, v18
    v_add_u32 v18, 192, v0
    v_mul_u32_u24 v19, 2731, v18
    v_lshrrev_b32 v19, 16, v19
    v_mul_u32_u24 v20, 24, v19
    v_sub_u32 v20, v18, v20
    v_mul_u32_u24 v21, 400, v19
    v_lshl_add_u32 v21, v20, 4, v21
    v_add_u32 v10, 144512, v21
    v_lshlrev_b32 v21, 4, v19
    v_lshl_add_u32 v11, v20, 7, v21
    v_add_u32 v13, 98304, v1
    v_add_u32 v14, 131072, v1
    s_mul_i32 s44, s12, 12288
    s_add_u32 s44, s44, 53477376
    s_mul_i32 s45, s12, 3072
    s_add_u32 s45, s45, 208666624
    s_mul_i32 s20, s12, 6
    s_add_u32 s21, s20, 5
    s_lshr_b32 s20, s20, 3
    s_lshr_b32 s21, s21, 3
    s_add_u32 s20, s20, 80
    s_add_u32 s21, s21, 80
    s_lshl_b32 s20, s20, 7
    s_lshl_b32 s21, s21, 7
    v_mov_b32 v255, s21
    v_mov_b32 v253, s20
    v_cmp_eq_u32 vcc, 0, v0
    s_nop 1
    v_cndmask_b32 v255, v255, v253, vcc
    s_mov_b32 s47, 0
    s_mul_i32 s20, s12, 491520
    s_add_u32 s20, s20, 11902976
    s_add_u32 s21, s20, 18432
    buffer_load_dwordx4 v[16:19], v1, s[8:11], s21 offen offset:0
    buffer_load_dwordx4 v[20:23], v1, s[8:11], s21 offen offset:1024
    s_add_u32 s21, s20, 79872
    buffer_load_dwordx4 v[24:27], v1, s[8:11], s21 offen offset:0
    buffer_load_dwordx4 v[28:31], v1, s[8:11], s21 offen offset:1024
    s_add_u32 s21, s20, 0
    buffer_load_dwordx4 v[32:35], v1, s[8:11], s21 offen offset:0
    buffer_load_dwordx4 v[36:39], v1, s[8:11], s21 offen offset:1024
    s_add_u32 s21, s20, 8192
    buffer_load_dwordx4 v[40:43], v1, s[8:11], s21 offen offset:0
    buffer_load_dwordx4 v[44:47], v1, s[8:11], s21 offen offset:1024
    s_add_u32 s21, s20, 20480
    buffer_load_dwordx4 v[48:51], v1, s[8:11], s21 offen offset:0
    buffer_load_dwordx4 v[52:55], v1, s[8:11], s21 offen offset:1024
    s_add_u32 s21, s20, 28672
    buffer_load_dwordx4 v[56:59], v1, s[8:11], s21 offen offset:0
    buffer_load_dwordx4 v[60:63], v1, s[8:11], s21 offen offset:1024
    s_add_u32 s21, s20, 40960
    buffer_load_dwordx4 v[64:67], v1, s[8:11], s21 offen offset:0
    buffer_load_dwordx4 v[68:71], v1, s[8:11], s21 offen offset:1024
    s_add_u32 s21, s20, 49152
    buffer_load_dwordx4 v[72:75], v1, s[8:11], s21 offen offset:0
    buffer_load_dwordx4 v[76:79], v1, s[8:11], s21 offen offset:1024
    s_add_u32 s21, s20, 61440
    buffer_load_dwordx4 v[80:83], v1, s[8:11], s21 offen offset:0
    buffer_load_dwordx4 v[84:87], v1, s[8:11], s21 offen offset:1024
    s_add_u32 s21, s20, 69632
    buffer_load_dwordx4 v[88:91], v1, s[8:11], s21 offen offset:0
    buffer_load_dwordx4 v[92:95], v1, s[8:11], s21 offen offset:1024
    s_add_u32 s21, s20, 81920
    buffer_load_dwordx4 v[96:99], v1, s[8:11], s21 offen offset:0
    buffer_load_dwordx4 v[100:103], v1, s[8:11], s21 offen offset:1024
    s_add_u32 s21, s20, 90112
    buffer_load_dwordx4 v[104:107], v1, s[8:11], s21 offen offset:0
    buffer_load_dwordx4 v[108:111], v1, s[8:11], s21 offen offset:1024
    s_add_u32 s21, s20, 96256
    buffer_load_dwordx4 v[112:115], v1, s[8:11], s21 offen offset:0
    buffer_load_dwordx4 v[116:119], v1, s[8:11], s21 offen offset:1024
    s_add_u32 s21, s20, 106496
    buffer_load_dwordx4 v[120:123], v1, s[8:11], s21 offen offset:0
    buffer_load_dwordx4 v[124:127], v1, s[8:11], s21 offen offset:1024
    s_add_u32 s21, s20, 112640
    buffer_load_dwordx4 v[128:131], v1, s[8:11], s21 offen offset:0
    buffer_load_dwordx4 v[132:135], v1, s[8:11], s21 offen offset:1024
    s_add_u32 s21, s20, 116736
    buffer_load_dwordx4 v[136:139], v1, s[8:11], s21 offen offset:0
    buffer_load_dwordx4 v[140:143], v1, s[8:11], s21 offen offset:1024
    s_add_u32 s21, s20, 75776
    buffer_load_dwordx4 v[156:159], v1, s[8:11], s21 offen offset:0
    buffer_load_dwordx4 v[160:163], v1, s[8:11], s21 offen offset:1024
    s_add_u32 s21, s20, 83968
    buffer_load_dwordx4 v[164:167], v1, s[8:11], s21 offen offset:0
    buffer_load_dwordx4 v[168:171], v1, s[8:11], s21 offen offset:1024
    s_add_u32 s21, s20, 86016
    buffer_load_dwordx4 v[172:175], v1, s[8:11], s21 offen offset:0
    buffer_load_dwordx4 v[176:179], v1, s[8:11], s21 offen offset:1024
    s_add_u32 s21, s20, 88064
    buffer_load_dwordx4 v[180:183], v1, s[8:11], s21 offen offset:0
    buffer_load_dwordx4 v[184:187], v1, s[8:11], s21 offen offset:1024
    s_add_u32 s21, s20, 92160
    buffer_load_dwordx4 v[188:191], v1, s[8:11], s21 offen offset:0
    buffer_load_dwordx4 v[192:195], v1, s[8:11], s21 offen offset:1024
    s_add_u32 s21, s20, 94208
    buffer_load_dwordx4 v[196:199], v1, s[8:11], s21 offen offset:0
    buffer_load_dwordx4 v[200:203], v1, s[8:11], s21 offen offset:1024
    s_add_u32 s21, s20, 102400
    buffer_load_dwordx4 v[204:207], v1, s[8:11], s21 offen offset:0
    buffer_load_dwordx4 v[208:211], v1, s[8:11], s21 offen offset:1024
    s_add_u32 s21, s20, 104448
    buffer_load_dwordx4 v[212:215], v1, s[8:11], s21 offen offset:0
    buffer_load_dwordx4 v[216:219], v1, s[8:11], s21 offen offset:1024
    s_add_u32 s21, s20, 108544
    buffer_load_dwordx4 v[220:223], v1, s[8:11], s21 offen offset:0
    buffer_load_dwordx4 v[224:227], v1, s[8:11], s21 offen offset:1024
    s_add_u32 s21, s20, 110592
    buffer_load_dwordx4 v[228:231], v1, s[8:11], s21 offen offset:0
    buffer_load_dwordx4 v[232:235], v1, s[8:11], s21 offen offset:1024
    s_add_u32 s21, s20, 114688
    buffer_load_dwordx4 v[236:239], v1, s[8:11], s21 offen offset:0
    buffer_load_dwordx4 v[240:243], v1, s[8:11], s21 offen offset:1024
    s_add_u32 s21, s20, 120832
    buffer_load_dwordx4 v[244:247], v1, s[8:11], s21 offen offset:0
    buffer_load_dwordx4 v[248:251], v1, s[8:11], s21 offen offset:1024
    s_waitcnt vmcnt(24)
    ds_write_b128 v13, v[16:19] offset:0
    ds_write_b128 v13, v[20:23] offset:1024
    ds_write_b128 v13, v[24:27] offset:2048
    ds_write_b128 v13, v[28:31] offset:3072
    ds_write_b128 v13, v[32:35] offset:4096
    ds_write_b128 v13, v[36:39] offset:5120
    ds_write_b128 v13, v[40:43] offset:6144
    ds_write_b128 v13, v[44:47] offset:7168
    ds_write_b128 v13, v[48:51] offset:8192
    ds_write_b128 v13, v[52:55] offset:9216
    ds_write_b128 v13, v[56:59] offset:10240
    ds_write_b128 v13, v[60:63] offset:11264
    ds_write_b128 v13, v[64:67] offset:12288
    ds_write_b128 v13, v[68:71] offset:13312
    ds_write_b128 v13, v[72:75] offset:14336
    ds_write_b128 v13, v[76:79] offset:15360
    ds_write_b128 v13, v[80:83] offset:16384
    ds_write_b128 v13, v[84:87] offset:17408
    ds_write_b128 v13, v[88:91] offset:18432
    ds_write_b128 v13, v[92:95] offset:19456
    ds_write_b128 v13, v[96:99] offset:20480
    ds_write_b128 v13, v[100:103] offset:21504
    ds_write_b128 v13, v[104:107] offset:22528
    ds_write_b128 v13, v[108:111] offset:23552
    ds_write_b128 v13, v[112:115] offset:24576
    ds_write_b128 v13, v[116:119] offset:25600
    ds_write_b128 v13, v[120:123] offset:26624
    ds_write_b128 v13, v[124:127] offset:27648
    ds_write_b128 v13, v[128:131] offset:28672
    ds_write_b128 v13, v[132:135] offset:29696
    ds_write_b128 v13, v[136:139] offset:30720
    ds_write_b128 v13, v[140:143] offset:31744
    s_waitcnt lgkmcnt(0)
    s_mov_b32 s14, 0
    s_cmp_gt_u32 s47, s14
    s_cbranch_scc1 layerb1_kernel_p3_gw1_ok
layerb1_kernel_p3_gw1_lp:
    buffer_load_dword v253, v255, s[8:11], s48 offen sc1
    s_waitcnt vmcnt(0)
    v_readlane_b32 s47, v253, 0
    v_readlane_b32 s29, v253, 1
    s_nop 0
    s_min_u32 s47, s47, s29
    s_sub_u32 s15, s15, 1
    s_cbranch_scc1 layerb1_kernel_bail
    s_cmp_gt_u32 s47, s14
    s_cbranch_scc0 layerb1_kernel_p3_gw1_lp
layerb1_kernel_p3_gw1_ok:
    s_mul_i32 s20, s14, 393216
    s_add_u32 s20, s20, s44
    s_add_u32 s21, s20, 0
    buffer_load_dwordx4 v[100:103], v9, s[8:11], s21 offen offset:0 sc1
    buffer_load_dwordx4 v[104:107], v9, s[8:11], s21 offen offset:512 sc1
    s_add_u32 s21, s20, 4096
    buffer_load_dwordx4 v[108:111], v9, s[8:11], s21 offen offset:0 sc1
    buffer_load_dwordx4 v[112:115], v9, s[8:11], s21 offen offset:512 sc1
    s_add_u32 s21, s20, 8192
    buffer_load_dwordx4 v[116:119], v9, s[8:11], s21 offen offset:0 sc1
    buffer_load_dwordx4 v[120:123], v9, s[8:11], s21 offen offset:512 sc1
    v_mov_b32 v56, 0
    v_mov_b32 v57, 0
    v_mov_b32 v58, 0
    v_mov_b32 v59, 0
    v_mov_b32 v60, 0
    v_mov_b32 v61, 0
    v_mov_b32 v62, 0
    v_mov_b32 v63, 0
    v_mov_b32 v64, 0
    v_mov_b32 v65, 0
    v_mov_b32 v66, 0
    v_mov_b32 v67, 0
    v_mov_b32 v68, 0
    v_mov_b32 v69, 0
    v_mov_b32 v70, 0
    v_mov_b32 v71, 0
    v_mov_b32 v72, 0
    v_mov_b32 v73, 0
    v_mov_b32 v74, 0
    v_mov_b32 v75, 0
    v_mov_b32 v76, 0
    v_mov_b32 v77, 0
    v_mov_b32 v78, 0
    v_mov_b32 v79, 0
    v_mov_b32 v80, 0
    v_mov_b32 v81, 0
    v_mov_b32 v82, 0
    v_mov_b32 v83, 0
    v_mov_b32 v84, 0
    v_mov_b32 v85, 0
    v_mov_b32 v86, 0
    v_mov_b32 v87, 0
    ds_read_b128 v[124:127], v13 offset:0
    ds_read_b128 v[128:131], v13 offset:1024
    ds_read_b128 v[132:135], v13 offset:2048
    ds_read_b128 v[136:139], v13 offset:3072
    ds_read_b128 v[140:143], v13 offset:4096
    ds_read_b128 v[144:147], v13 offset:5120
    ds_read_b128 v[148:151], v13 offset:6144
    ds_read_b128 v[152:155], v13 offset:7168
    s_waitcnt lgkmcnt(0)
layerb1_kernel_p3_step:
    s_cmp_lt_u32 s14, 32
    s_cselect_b32 s18, s16, s17
    s_and_b32 s20, s14, 31
    s_lshl_b32 s20, s20, 16
    s_add_u32 s18, s18, s20
    s_add_u32 s22, s18, 53248
    s_add_u32 s23, s18, 54272
layerb1_kernel_p3_poll:
    buffer_load_dwordx4 v[48:51], v12, s[8:11], s22 offen sc1
    buffer_load_dwordx4 v[52:55], v12, s[8:11], s23 offen sc1
    s_waitcnt vmcnt(0)
    ds_write_b128 v14, v[48:51] offset:8192
    ds_write_b128 v14, v[52:55] offset:9216
    v_max3_u32 v88, v48, v49, v50
    v_max3_u32 v88, v88, v51, v52
    v_max3_u32 v88, v88, v53, v54
    v_max_u32 v88, v88, v55
    v_cmp_eq_u32 vcc, -1, v88
    s_sub_u32 s15, s15, 1
    s_cbranch_scc1 layerb1_kernel_bail
    s_cbranch_vccnz layerb1_kernel_p3_poll
    v_smfmac_f32_16x16x64_bf16 v[56:59], v[48:51], a[0:7], v2
    v_smfmac_f32_16x16x64_bf16 v[60:63], v[48:51], a[8:15], v2
    v_smfmac_f32_16x16x64_bf16 v[64:67], v[48:51], a[16:23], v2
    v_smfmac_f32_16x16x64_bf16 v[56:59], v[52:55], v[124:131], v2
    ds_read_b128 v[124:127], v13 offset:8192
    v_smfmac_f32_16x16x64_bf16 v[60:63], v[52:55], a[24:31], v2
    s_waitcnt lgkmcnt(1)
    s_barrier
    v_smfmac_f32_16x16x64_bf16 v[64:67], v[52:55], a[32:39], v2
    ds_read_b128 v[16:19], v14 offset:0
    v_smfmac_f32_16x16x64_bf16 v[68:71], v[48:51], a[40:47], v2
    ds_read_b128 v[20:23], v14 offset:1024
    v_smfmac_f32_16x16x64_bf16 v[68:71], v[52:55], v[132:139], v2
    ds_read_b128 v[24:27], v14 offset:2048
    v_smfmac_f32_16x16x64_bf16 v[72:75], v[48:51], a[48:55], v2
    ds_read_b128 v[28:31], v14 offset:3072
    v_smfmac_f32_16x16x64_bf16 v[72:75], v[52:55], a[56:63], v2
    ds_read_b128 v[32:35], v14 offset:4096
    v_smfmac_f32_16x16x64_bf16 v[76:79], v[48:51], a[64:71], v2
    s_waitcnt lgkmcnt(4)
    ds_read_b128 v[36:39], v14 offset:5120
    v_smfmac_f32_16x16x64_bf16 v[56:59], v[16:19], v[140:147], v2
    s_waitcnt lgkmcnt(4)
    ds_read_b128 v[40:43], v14 offset:6144
    v_smfmac_f32_16x16x64_bf16 v[56:59], v[20:23], a[72:79], v2
    s_waitcnt lgkmcnt(4)
    ds_read_b128 v[44:47], v14 offset:7168
    v_smfmac_f32_16x16x64_bf16 v[56:59], v[24:27], a[80:87], v2
    s_waitcnt lgkmcnt(4)
    ds_read_b128 v[128:131], v13 offset:9216
    v_smfmac_f32_16x16x64_bf16 v[56:59], v[28:31], a[88:95], v2
    s_waitcnt lgkmcnt(4)
    ds_read_b128 v[132:135], v13 offset:10240
    v_smfmac_f32_16x16x64_bf16 v[56:59], v[32:35], v[148:155], v2
    s_waitcnt lgkmcnt(4)
    ds_read_b128 v[136:139], v13 offset:11264
    v_smfmac_f32_16x16x64_bf16 v[56:59], v[36:39], a[96:103], v2
    s_waitcnt lgkmcnt(4)
    ds_read_b128 v[140:143], v13 offset:12288
    v_smfmac_f32_16x16x64_bf16 v[56:59], v[40:43], a[104:111], v2
    s_waitcnt lgkmcnt(4)
    ds_read_b128 v[144:147], v13 offset:13312
    v_smfmac_f32_16x16x64_bf16 v[56:59], v[44:47], a[112:119], v2
    s_waitcnt lgkmcnt(4)
    ds_read_b128 v[148:151], v13 offset:14336
    v_smfmac_f32_16x16x64_bf16 v[60:63], v[16:19], v[124:131], v2
    ds_read_b128 v[152:155], v13 offset:15360
    v_smfmac_f32_16x16x64_bf16 v[60:63], v[20:23], a[120:127], v2
    ds_read_b128 v[124:127], v13 offset:16384
    v_add_f32 v56, v56, v58
    v_smfmac_f32_16x16x64_bf16 v[60:63], v[24:27], a[128:135], v2
    ds_read_b128 v[128:131], v13 offset:17408
    v_add_f32 v57, v57, v59
    v_smfmac_f32_16x16x64_bf16 v[60:63], v[28:31], a[136:143], v2
    s_waitcnt lgkmcnt(6)
    v_cvt_pk_bf16_f32 v56, v56, v57
    v_smfmac_f32_16x16x64_bf16 v[60:63], v[32:35], v[132:139], v2
    ds_write_b16 v3, v56 offset:0
    v_smfmac_f32_16x16x64_bf16 v[60:63], v[36:39], a[144:151], v2
    ds_write_b16_d16_hi v3, v56 offset:400
    v_smfmac_f32_16x16x64_bf16 v[60:63], v[40:43], a[152:159], v2
    ds_read_b128 v[132:135], v13 offset:18432
    v_smfmac_f32_16x16x64_bf16 v[60:63], v[44:47], a[160:167], v2
    s_waitcnt lgkmcnt(7)
    ds_read_b128 v[136:139], v13 offset:19456
    v_smfmac_f32_16x16x64_bf16 v[64:67], v[16:19], v[140:147], v2
    ds_read_b128 v[140:143], v13 offset:20480
    v_smfmac_f32_16x16x64_bf16 v[64:67], v[20:23], a[168:175], v2
    ds_read_b128 v[144:147], v13 offset:21504
    v_add_f32 v60, v60, v62
    v_smfmac_f32_16x16x64_bf16 v[64:67], v[24:27], a[176:183], v2
    v_add_f32 v61, v61, v63
    v_smfmac_f32_16x16x64_bf16 v[64:67], v[28:31], a[184:191], v2
    s_waitcnt lgkmcnt(8)
    v_cvt_pk_bf16_f32 v60, v60, v61
    v_smfmac_f32_16x16x64_bf16 v[64:67], v[32:35], v[148:155], v2
    ds_write_b16 v3, v60 offset:128
    v_smfmac_f32_16x16x64_bf16 v[64:67], v[36:39], a[192:199], v2
    ds_write_b16_d16_hi v3, v60 offset:528
    v_smfmac_f32_16x16x64_bf16 v[64:67], v[40:43], a[200:207], v2
    ds_read_b128 v[148:151], v13 offset:22528
    v_smfmac_f32_16x16x64_bf16 v[64:67], v[44:47], a[208:215], v2
    s_waitcnt lgkmcnt(9)
    ds_read_b128 v[152:155], v13 offset:23552
    v_smfmac_f32_16x16x64_bf16 v[68:71], v[16:19], v[124:131], v2
    ds_read_b128 v[124:127], v13 offset:24576
    v_smfmac_f32_16x16x64_bf16 v[68:71], v[20:23], a[216:223], v2
    ds_read_b128 v[128:131], v13 offset:25600
    v_add_f32 v64, v64, v66
    v_smfmac_f32_16x16x64_bf16 v[68:71], v[24:27], a[224:231], v2
    v_add_f32 v65, v65, v67
    v_smfmac_f32_16x16x64_bf16 v[68:71], v[28:31], a[232:239], v2
    s_waitcnt lgkmcnt(8)
    v_cvt_pk_bf16_f32 v64, v64, v65
    v_smfmac_f32_16x16x64_bf16 v[68:71], v[32:35], v[132:139], v2
    ds_write_b16 v3, v64 offset:256
    v_smfmac_f32_16x16x64_bf16 v[68:71], v[36:39], a[240:247], v2
    ds_write_b16_d16_hi v3, v64 offset:656
    v_smfmac_f32_16x16x64_bf16 v[68:71], v[40:43], a[248:255], v2
    ds_read_b128 v[132:135], v13 offset:26624
    v_smfmac_f32_16x16x64_bf16 v[68:71], v[44:47], v[156:163], v2
    s_waitcnt lgkmcnt(9)
    ds_read_b128 v[136:139], v13 offset:27648
    v_smfmac_f32_16x16x64_bf16 v[72:75], v[16:19], v[140:147], v2
    ds_read_b128 v[140:143], v13 offset:28672
    v_smfmac_f32_16x16x64_bf16 v[72:75], v[20:23], v[164:171], v2
    s_waitcnt lgkmcnt(3)
    s_barrier
    v_add_f32 v68, v68, v70
    v_smfmac_f32_16x16x64_bf16 v[72:75], v[24:27], v[172:179], v2
    ds_read_b128 v[88:91], v4 offset:0
    v_add_f32 v69, v69, v71
    v_smfmac_f32_16x16x64_bf16 v[72:75], v[28:31], v[180:187], v2
    ds_read_b128 v[92:95], v4 offset:128
    v_cvt_pk_bf16_f32 v68, v68, v69
    v_smfmac_f32_16x16x64_bf16 v[72:75], v[32:35], v[148:155], v2
    ds_read_b128 v[96:99], v4 offset:256
    v_smfmac_f32_16x16x64_bf16 v[72:75], v[36:39], v[188:195], v2
    ds_write_b16 v3, v68 offset:3200
    v_smfmac_f32_16x16x64_bf16 v[72:75], v[40:43], v[196:203], v2
    ds_write_b16_d16_hi v3, v68 offset:3600
    v_smfmac_f32_16x16x64_bf16 v[72:75], v[44:47], v[124:131], v2
    s_waitcnt lgkmcnt(4)
    ds_read_b128 v[144:147], v13 offset:29696
    v_smfmac_f32_16x16x64_bf16 v[80:83], v[88:91], v[100:107], v2
    s_waitcnt lgkmcnt(4)
    ds_read_b128 v[148:151], v13 offset:30720
    v_smfmac_f32_16x16x64_bf16 v[80:83], v[92:95], v[108:115], v2
    s_waitcnt lgkmcnt(4)
    ds_read_b128 v[152:155], v13 offset:31744
    v_add_f32 v72, v72, v74
    v_smfmac_f32_16x16x64_bf16 v[80:83], v[96:99], v[116:123], v2
    v_add_f32 v73, v73, v75
    v_smfmac_f32_16x16x64_bf16 v[76:79], v[16:19], v[204:211], v2
    v_cvt_pk_bf16_f32 v72, v72, v73
    v_smfmac_f32_16x16x64_bf16 v[76:79], v[20:23], v[212:219], v2
    ds_write_b16 v3, v72 offset:3328
    v_smfmac_f32_16x16x64_bf16 v[76:79], v[24:27], v[132:139], v2
    ds_write_b16_d16_hi v3, v72 offset:3728
    v_smfmac_f32_16x16x64_bf16 v[76:79], v[28:31], v[220:227], v2
    v_add_f32 v56, v81, v83
    v_smfmac_f32_16x16x64_bf16 v[76:79], v[32:35], v[228:235], v2
    s_waitcnt lgkmcnt(4)
    v_mul_f32 v56, 0x3dd53b95, v56
    v_smfmac_f32_16x16x64_bf16 v[76:79], v[36:39], v[140:147], v2
    s_waitcnt lgkmcnt(0)
    s_barrier
    v_max_f32_dpp v58, v56, v56 row_ror:8 row_mask:0xf bank_mask:0xf
    v_smfmac_f32_16x16x64_bf16 v[76:79], v[40:43], v[236:243], v2
    ds_read_b128 v[100:103], v5 offset:0
    v_max_f32_dpp v58, v58, v58 row_ror:4 row_mask:0xf bank_mask:0xf
    v_smfmac_f32_16x16x64_bf16 v[76:79], v[44:47], v[148:155], v2
    ds_read_b128 v[104:107], v5 offset:16
    v_max_f32_dpp v58, v58, v58 row_ror:2 row_mask:0xf bank_mask:0xf
    v_smfmac_f32_16x16x64_bf16 v[76:79], v[52:55], v[244:251], v2
    ds_read_b128 v[108:111], v5 offset:128
    v_max_f32_dpp v58, v58, v58 row_ror:1 row_mask:0xf bank_mask:0xf
    ds_read_b128 v[112:115], v5 offset:144
    v_sub_f32 v60, v56, v58
    s_nop 1
    v_exp_f32 v60, v60
    s_nop 1
    v_add_f32_dpp v59, v60, v60 row_ror:8 row_mask:0xf bank_mask:0xf
    s_nop 1
    v_add_f32_dpp v59, v59, v59 row_ror:4 row_mask:0xf bank_mask:0xf
    s_nop 1
    v_add_f32_dpp v59, v59, v59 row_ror:2 row_mask:0xf bank_mask:0xf
    s_nop 1
    v_add_f32_dpp v59, v59, v59 row_ror:1 row_mask:0xf bank_mask:0xf
    v_add_f32 v76, v76, v78
    v_add_f32 v77, v77, v79
    v_cvt_pk_bf16_f32 v76, v76, v77
    ds_write_b16 v3, v76 offset:3456
    ds_write_b16_d16_hi v3, v76 offset:3856
    ds_write_b64 v6, v[58:59] offset:1536
    s_waitcnt lgkmcnt(5)
    v_smfmac_f32_16x16x64_bf16 v[84:87], v[88:91], v[100:107], v2
    s_waitcnt lgkmcnt(3)
    v_smfmac_f32_16x16x64_bf16 v[84:87], v[92:95], v[108:115], v2
    s_waitcnt lgkmcnt(0)
    s_barrier
    ds_read_b128 v[116:119], v5 offset:256
    ds_read_b128 v[120:123], v5 offset:272
    ds_read_b64 v[16:17], v6 offset:1024
    s_waitcnt lgkmcnt(1)
    v_smfmac_f32_16x16x64_bf16 v[84:87], v[96:99], v[116:123], v2
    s_waitcnt lgkmcnt(0)
    v_max_f32 v18, v58, v16
    v_sub_f32 v19, v58, v18
    v_sub_f32 v20, v16, v18
    v_exp_f32 v19, v19
    v_exp_f32 v20, v20
    s_nop 0
    v_mul_f32 v21, v59, v19
    v_mul_f32 v60, v60, v19
    v_fmac_f32 v21, v17, v20
    v_add_f32 v22, v85, v87
    v_mul_f32 v22, 0x3dd53b95, v22
    v_max_f32 v23, v22, v18
    s_nop 0
    v_max_f32_dpp v24, v22, v23 row_ror:4 row_mask:0xf bank_mask:0xf
    s_nop 1
    v_max_f32_dpp v24, v24, v24 row_ror:2 row_mask:0xf bank_mask:0xf
    s_nop 1
    v_max_f32_dpp v24, v24, v24 row_ror:1 row_mask:0xf bank_mask:0xf
    v_sub_f32 v25, v22, v24
    v_sub_f32 v26, v18, v24
    v_exp_f32 v25, v25
    v_exp_f32 v26, v26
    s_nop 0
    v_add_f32_dpp v23, v25, v25 row_ror:4 row_mask:0xf bank_mask:0xf
    v_mul_f32 v60, v60, v26
    s_nop 0
    v_add_f32_dpp v23, v23, v23 row_ror:2 row_mask:0xf bank_mask:0xf
    s_nop 1
    v_add_f32_dpp v23, v23, v23 row_ror:1 row_mask:0xf bank_mask:0xf
    v_fmac_f32 v23, v26, v21
    v_rcp_f32 v27, v23
    s_nop 0
    v_mul_f32 v60, v60, v27
    v_mul_f32 v25, v25, v27
    s_nop 0
    v_mov_b32_dpp v19, v60 quad_perm:[1,0,3,2] row_mask:0xf bank_mask:0xf
    v_mov_b32_dpp v20, v25 quad_perm:[1,0,3,2] row_mask:0xf bank_mask:0xf
    v_cvt_pk_bf16_f32 v28, v60, v19
    v_cvt_pk_bf16_f32 v25, v25, v20
    s_nop 0
    v_mov_b32_dpp v29, v28 row_shl:2 row_mask:0xf bank_mask:0xf
    v_mov_b32_dpp v30, v28 row_shl:4 row_mask:0xf bank_mask:0xf
    v_mov_b32_dpp v31, v28 row_shl:6 row_mask:0xf bank_mask:0xf
    v_mov_b32_dpp v28, v25 row_shr:4 row_mask:0xf bank_mask:0x2
    v_mov_b32_dpp v29, v25 row_shr:2 row_mask:0xf bank_mask:0x2
    v_mov_b32_dpp v30, v25 quad_perm:[0,1,2,3] row_mask:0xf bank_mask:0x2
    v_mov_b32_dpp v31, v25 row_shl:2 row_mask:0xf bank_mask:0x2
    s_mov_b32 exec_lo, 0x1010101
    s_mov_b32 exec_hi, 0x1110111
    buffer_store_dwordx4 v[28:31], v7, s[8:11], s18 offen sc1
    s_mov_b64 exec, -1
    s_add_u32 s28, s14, 1
    s_min_u32 s28, s28, 63
    s_cmp_gt_u32 s47, s28
    s_cbranch_scc1 layerb1_kernel_p3_gw2_ok
layerb1_kernel_p3_gw2_lp:
    buffer_load_dword v253, v255, s[8:11], s48 offen sc1
    s_waitcnt vmcnt(0)
    v_readlane_b32 s47, v253, 0
    v_readlane_b32 s29, v253, 1
    s_nop 0
    s_min_u32 s47, s47, s29
    s_sub_u32 s15, s15, 1
    s_cbranch_scc1 layerb1_kernel_bail
    s_cmp_gt_u32 s47, s28
    s_cbranch_scc0 layerb1_kernel_p3_gw2_lp
layerb1_kernel_p3_gw2_ok:
    s_mul_i32 s20, s28, 393216
    s_add_u32 s20, s20, s44
    s_add_u32 s21, s20, 0
    buffer_load_dwordx4 v[100:103], v9, s[8:11], s21 offen offset:0 sc1
    buffer_load_dwordx4 v[104:107], v9, s[8:11], s21 offen offset:512 sc1
    s_add_u32 s21, s20, 4096
    buffer_load_dwordx4 v[108:111], v9, s[8:11], s21 offen offset:0 sc1
    buffer_load_dwordx4 v[112:115], v9, s[8:11], s21 offen offset:512 sc1
    s_add_u32 s21, s20, 8192
    buffer_load_dwordx4 v[116:119], v9, s[8:11], s21 offen offset:0 sc1
    buffer_load_dwordx4 v[120:123], v9, s[8:11], s21 offen offset:512 sc1
    v_mov_b32 v56, 0
    v_mov_b32 v57, 0
    v_mov_b32 v58, 0
    v_mov_b32 v59, 0
    v_mov_b32 v60, 0
    v_mov_b32 v61, 0
    v_mov_b32 v62, 0
    v_mov_b32 v63, 0
    v_mov_b32 v64, 0
    v_mov_b32 v65, 0
    v_mov_b32 v66, 0
    v_mov_b32 v67, 0
    v_mov_b32 v68, 0
    v_mov_b32 v69, 0
    v_mov_b32 v70, 0
    v_mov_b32 v71, 0
    v_mov_b32 v72, 0
    v_mov_b32 v73, 0
    v_mov_b32 v74, 0
    v_mov_b32 v75, 0
    v_mov_b32 v76, 0
    v_mov_b32 v77, 0
    v_mov_b32 v78, 0
    v_mov_b32 v79, 0
    v_mov_b32 v80, 0
    v_mov_b32 v81, 0
    v_mov_b32 v82, 0
    v_mov_b32 v83, 0
    v_mov_b32 v84, 0
    v_mov_b32 v85, 0
    v_mov_b32 v86, 0
    v_mov_b32 v87, 0
    s_lshl_b32 s20, s12, 7
    s_add_u32 s20, s20, 16384
    s_mov_b64 exec, 1
    v_mov_b32 v253, s20
    v_mov_b32 v254, s14
    buffer_store_dword v254, v253, s[8:11], s48 offen sc1
    s_mov_b64 exec, -1
    ds_read_b128 v[124:127], v13 offset:0
    ds_read_b128 v[128:131], v13 offset:1024
    ds_read_b128 v[132:135], v13 offset:2048
    ds_read_b128 v[136:139], v13 offset:3072
    ds_read_b128 v[140:143], v13 offset:4096
    ds_read_b128 v[144:147], v13 offset:5120
    ds_read_b128 v[148:151], v13 offset:6144
    ds_read_b128 v[152:155], v13 offset:7168
    s_waitcnt lgkmcnt(0)
    s_add_u32 s14, s14, 1
    s_cmp_lt_u32 s14, 64
    s_cbranch_scc1 layerb1_kernel_p3_step
    s_waitcnt vmcnt(0)
    s_barrier
    s_lshl_b32 s20, s12, 7
    s_add_u32 s20, s20, 16384
    s_mov_b64 exec, 1
    v_mov_b32 v253, s20
    v_mov_b32 v254, s14
    buffer_store_dword v254, v253, s[8:11], s48 offen sc1
    s_mov_b64 exec, -1
    s_branch layerb1_kernel_end
layerb1_kernel_y0_start:
    v_lshrrev_b32 v16, 4, v0
    v_and_b32 v17, 7, v0
    v_lshrrev_b32 v18, 3, v0
    v_and_b32 v18, 1, v18
    v_lshl_add_u32 v19, v18, 2, v16
    v_add_u32 v19, 0, v19
    v_mul_u32_u24 v20, 640, v19
    v_lshl_add_u32 v4, v17, 4, v20
    v_and_b32 v20, 1, v17
    v_lshlrev_b32 v20, 2, v20
    v_lshrrev_b32 v21, 1, v17
    v_add_u32 v20, v20, v21
    v_lshlrev_b32 v20, 4, v20
    v_lshl_add_u32 v5, v19, 7, v20
    v_add_u32 v3, 0, v1
    v_lshrrev_b32 v20, 1, v17
    v_lshlrev_b32 v20, 7, v20
    v_and_b32 v21, 1, v17
    v_lshl_add_u32 v20, v21, 2, v20
    v_add_u32 v10, 0, v20
    v_lshlrev_b32 v20, 8, v18
    v_lshl_add_u32 v20, v17, 5, v20
    v_and_b32 v21, 1, v16
    v_lshl_add_u32 v20, v21, 4, v20
    v_add_u32 v20, 10240, v20
    v_add_u32 v21, 12288, v1
    v_lshrrev_b32 v22, 1, v16
    v_cmp_eq_u32 vcc, v22, v18
    s_nop 1
    v_cndmask_b32 v6, v21, v20, vcc
    v_lshrrev_b32 v20, 3, v0
    v_lshlrev_b32 v20, 2, v20
    v_lshl_add_u32 v20, v17, 5, v20
    v_add_u32 v7, 10240, v20
    s_lshl_b32 s20, s12, 7
    s_add_u32 s20, s20, 20480
    s_lshr_b32 s21, s20, 13
    s_lshl_b32 s21, s21, 14
    s_and_b32 s20, s20, 8191
    s_add_u32 s20, s20, s21
    v_lshrrev_b32 v20, 3, v0
    v_lshlrev_b32 v20, 4, v20
    v_add_u32 v8, s20, v20
    s_mul_i32 s46, s12, 20480
    s_add_u32 s46, s46, 103809024
    s_mul_i32 s20, s12, 327680
    s_add_u32 s20, s20, 27262976
    s_add_u32 s21, s20, 65536
    buffer_load_dwordx4 v[176:179], v1, s[8:11], s21 offen offset:0
    buffer_load_dwordx4 v[180:183], v1, s[8:11], s21 offen offset:1024
    s_add_u32 s21, s20, 67584
    buffer_load_dwordx4 v[184:187], v1, s[8:11], s21 offen offset:0
    buffer_load_dwordx4 v[188:191], v1, s[8:11], s21 offen offset:1024
    s_add_u32 s21, s20, 69632
    buffer_load_dwordx4 v[192:195], v1, s[8:11], s21 offen offset:0
    buffer_load_dwordx4 v[196:199], v1, s[8:11], s21 offen offset:1024
    s_add_u32 s21, s20, 71680
    buffer_load_dwordx4 v[200:203], v1, s[8:11], s21 offen offset:0
    buffer_load_dwordx4 v[204:207], v1, s[8:11], s21 offen offset:1024
    s_add_u32 s21, s20, 73728
    buffer_load_dwordx4 v[208:211], v1, s[8:11], s21 offen offset:0
    buffer_load_dwordx4 v[212:215], v1, s[8:11], s21 offen offset:1024
    s_add_u32 s21, s20, 75776
    buffer_load_dwordx4 v[216:219], v1, s[8:11], s21 offen offset:0
    buffer_load_dwordx4 v[220:223], v1, s[8:11], s21 offen offset:1024
    s_add_u32 s21, s20, 77824
    buffer_load_dwordx4 v[224:227], v1, s[8:11], s21 offen offset:0
    buffer_load_dwordx4 v[228:231], v1, s[8:11], s21 offen offset:1024
    s_add_u32 s21, s20, 79872
    buffer_load_dwordx4 v[232:235], v1, s[8:11], s21 offen offset:0
    buffer_load_dwordx4 v[236:239], v1, s[8:11], s21 offen offset:1024
    s_mov_b32 s14, 0
    s_lshl_b32 s20, s12, 7
    v_mov_b32 v9, s20
    s_mov_b32 s47, 0
layerb1_kernel_y0_step:
    s_cmp_lt_u32 s14, 32
    s_cselect_b32 s18, s16, s17
    s_and_b32 s20, s14, 31
    s_lshl_b32 s20, s20, 16
    s_add_u32 s18, s18, s20
    s_mul_i32 s28, s14, 1638400
    s_add_u32 s28, s28, s46
    v_mov_b32 v56, 0
    v_mov_b32 v57, 0
    v_mov_b32 v58, 0
    v_mov_b32 v59, 0
    v_mov_b32 v60, 0
    v_mov_b32 v61, 0
    v_mov_b32 v62, 0
    v_mov_b32 v63, 0
    v_mov_b32 v64, 0
    v_mov_b32 v65, 0
    v_mov_b32 v66, 0
    v_mov_b32 v67, 0
    v_mov_b32 v68, 0
    v_mov_b32 v69, 0
    v_mov_b32 v70, 0
    v_mov_b32 v71, 0
    s_add_u32 s22, s18, 36864
    s_add_u32 s23, s18, 37888
    s_add_u32 s24, s18, 38912
layerb1_kernel_y0_poll:
    buffer_load_dwordx4 v[16:19], v1, s[8:11], s22 offen sc1
    buffer_load_dwordx4 v[20:23], v1, s[8:11], s23 offen sc1
    buffer_load_dwordx4 v[24:27], v1, s[8:11], s24 offen sc1
    s_waitcnt vmcnt(0)
    ds_write_b128 v3, v[16:19] offset:0
    ds_write_b128 v3, v[20:23] offset:1024
    ds_write_b128 v3, v[24:27] offset:2048
    v_max3_u32 v116, v16, v17, v18
    v_max3_u32 v116, v116, v19, v20
    v_max3_u32 v116, v116, v21, v22
    v_max3_u32 v116, v116, v23, v24
    v_max3_u32 v116, v116, v25, v26
    v_max_u32 v116, v116, v27
    v_cmp_eq_u32 vcc, -1, v116
    s_sub_u32 s15, s15, 1
    s_cbranch_scc1 layerb1_kernel_bail
    s_cbranch_vccnz layerb1_kernel_y0_poll
    s_waitcnt lgkmcnt(0)
    s_barrier
    ds_read_b128 v[28:31], v3 offset:3072
    ds_read_b128 v[32:35], v3 offset:4096
    ds_read_b128 v[36:39], v3 offset:5120
    ds_read_b128 v[40:43], v3 offset:6144
    ds_read_b128 v[44:47], v3 offset:7168
    ds_read_b128 v[48:51], v3 offset:8192
    ds_read_b128 v[52:55], v3 offset:9216
    s_cmp_gt_u32 s47, s14
    s_cbranch_scc1 layerb1_kernel_y0_gw_ok
layerb1_kernel_y0_gw_lp:
    buffer_load_dword v116, v9, s[8:11], s48 offen sc1
    s_waitcnt vmcnt(0)
    v_readlane_b32 s47, v116, 0
    s_nop 0
    s_sub_u32 s15, s15, 1
    s_cbranch_scc1 layerb1_kernel_bail
    s_cmp_gt_u32 s47, s14
    s_cbranch_scc0 layerb1_kernel_y0_gw_lp
layerb1_kernel_y0_gw_ok:
    buffer_load_dwordx4 v[76:79], v4, s[8:11], s28 offen offset:128 sc1
    buffer_load_dwordx4 v[80:83], v4, s[8:11], s28 offen offset:256 sc1
    buffer_load_dwordx4 v[84:87], v4, s[8:11], s28 offen offset:384 sc1
    buffer_load_dwordx4 v[88:91], v4, s[8:11], s28 offen offset:512 sc1
    v_smfmac_f32_16x16x64_bf16 v[56:59], v[16:19], a[0:7], v2
    v_smfmac_f32_16x16x64_bf16 v[60:63], v[16:19], a[80:87], v2
    v_smfmac_f32_16x16x64_bf16 v[64:67], v[16:19], a[160:167], v2
    v_smfmac_f32_16x16x64_bf16 v[68:71], v[16:19], a[240:247], v2
    v_smfmac_f32_16x16x64_bf16 v[56:59], v[20:23], a[8:15], v2
    v_smfmac_f32_16x16x64_bf16 v[60:63], v[20:23], a[88:95], v2
    v_smfmac_f32_16x16x64_bf16 v[64:67], v[20:23], a[168:175], v2
    v_smfmac_f32_16x16x64_bf16 v[68:71], v[20:23], a[248:255], v2
    v_smfmac_f32_16x16x64_bf16 v[56:59], v[24:27], a[16:23], v2
    v_smfmac_f32_16x16x64_bf16 v[60:63], v[24:27], a[96:103], v2
    v_smfmac_f32_16x16x64_bf16 v[64:67], v[24:27], a[176:183], v2
    v_smfmac_f32_16x16x64_bf16 v[68:71], v[24:27], v[176:183], v2
    s_waitcnt lgkmcnt(6)
    v_smfmac_f32_16x16x64_bf16 v[56:59], v[28:31], a[24:31], v2
    v_smfmac_f32_16x16x64_bf16 v[60:63], v[28:31], a[104:111], v2
    v_smfmac_f32_16x16x64_bf16 v[64:67], v[28:31], a[184:191], v2
    v_smfmac_f32_16x16x64_bf16 v[68:71], v[28:31], v[184:191], v2
    s_waitcnt lgkmcnt(5)
    v_smfmac_f32_16x16x64_bf16 v[56:59], v[32:35], a[32:39], v2
    v_smfmac_f32_16x16x64_bf16 v[60:63], v[32:35], a[112:119], v2
    v_smfmac_f32_16x16x64_bf16 v[64:67], v[32:35], a[192:199], v2
    v_smfmac_f32_16x16x64_bf16 v[68:71], v[32:35], v[192:199], v2
    s_waitcnt lgkmcnt(4)
    v_smfmac_f32_16x16x64_bf16 v[56:59], v[36:39], a[40:47], v2
    v_smfmac_f32_16x16x64_bf16 v[60:63], v[36:39], a[120:127], v2
    v_smfmac_f32_16x16x64_bf16 v[64:67], v[36:39], a[200:207], v2
    v_smfmac_f32_16x16x64_bf16 v[68:71], v[36:39], v[200:207], v2
    s_waitcnt lgkmcnt(3)
    v_smfmac_f32_16x16x64_bf16 v[56:59], v[40:43], a[48:55], v2
    v_smfmac_f32_16x16x64_bf16 v[60:63], v[40:43], a[128:135], v2
    v_smfmac_f32_16x16x64_bf16 v[64:67], v[40:43], a[208:215], v2
    v_smfmac_f32_16x16x64_bf16 v[68:71], v[40:43], v[208:215], v2
    s_waitcnt lgkmcnt(2)
    v_smfmac_f32_16x16x64_bf16 v[56:59], v[44:47], a[56:63], v2
    v_smfmac_f32_16x16x64_bf16 v[60:63], v[44:47], a[136:143], v2
    v_smfmac_f32_16x16x64_bf16 v[64:67], v[44:47], a[216:223], v2
    v_smfmac_f32_16x16x64_bf16 v[68:71], v[44:47], v[216:223], v2
    s_waitcnt lgkmcnt(1)
    v_smfmac_f32_16x16x64_bf16 v[56:59], v[48:51], a[64:71], v2
    v_smfmac_f32_16x16x64_bf16 v[60:63], v[48:51], a[144:151], v2
    v_smfmac_f32_16x16x64_bf16 v[64:67], v[48:51], a[224:231], v2
    v_smfmac_f32_16x16x64_bf16 v[68:71], v[48:51], v[224:231], v2
    s_waitcnt lgkmcnt(0)
    v_smfmac_f32_16x16x64_bf16 v[56:59], v[52:55], a[72:79], v2
    v_smfmac_f32_16x16x64_bf16 v[60:63], v[52:55], a[152:159], v2
    v_smfmac_f32_16x16x64_bf16 v[64:67], v[52:55], a[232:239], v2
    v_smfmac_f32_16x16x64_bf16 v[68:71], v[52:55], v[232:239], v2
    s_nop 7
    v_permlane32_swap_b32 v56, v64
    v_permlane32_swap_b32 v60, v68
    v_permlane32_swap_b32 v57, v65
    v_permlane32_swap_b32 v61, v69
    v_permlane32_swap_b32 v58, v66
    v_permlane32_swap_b32 v62, v70
    v_permlane32_swap_b32 v59, v67
    v_permlane32_swap_b32 v63, v71
    v_add_f32 v56, v56, v64
    v_add_f32 v60, v60, v68
    v_add_f32 v57, v57, v65
    v_add_f32 v61, v61, v69
    v_add_f32 v58, v58, v66
    v_add_f32 v62, v62, v70
    v_add_f32 v59, v59, v67
    v_add_f32 v63, v63, v71
    s_nop 1
    v_permlane16_swap_b32 v56, v60
    v_permlane16_swap_b32 v57, v61
    v_permlane16_swap_b32 v58, v62
    v_permlane16_swap_b32 v59, v63
    s_nop 1
    v_cvt_pk_bf16_f32 v72, v56, v57
    v_cvt_pk_bf16_f32 v73, v58, v59
    v_cvt_pk_bf16_f32 v74, v60, v61
    v_cvt_pk_bf16_f32 v75, v62, v63
    buffer_store_dwordx4 v[72:75], v4, s[8:11], s28 offen sc1
    s_cmp_eq_u32 s14, 63
    s_cbranch_scc1 layerb1_kernel_y0_last
    s_add_u32 s30, s18, 0
    s_add_u32 s31, s18, 4096
    s_add_u32 s32, s18, 16384
    s_add_u32 s33, s18, 20480
    s_add_u32 s34, s18, 32768
    s_add_u32 s29, s14, 1
    s_cmp_lt_u32 s29, 32
    s_cselect_b32 s19, s16, s17
    s_and_b32 s20, s29, 31
    s_lshl_b32 s20, s20, 16
    s_add_u32 s19, s19, s20
layerb1_kernel_y0_ppoll:
    buffer_load_dwordx4 v[92:95], v5, s[8:11], s30 offen sc1
    buffer_load_dwordx4 v[96:99], v5, s[8:11], s31 offen sc1
    buffer_load_dwordx4 v[100:103], v5, s[8:11], s32 offen sc1
    buffer_load_dwordx4 v[104:107], v5, s[8:11], s33 offen sc1
    buffer_load_dwordx4 v[108:111], v5, s[8:11], s34 offen sc1
    s_waitcnt vmcnt(0)
    v_mfma_f32_16x16x32_bf16 v[112:115], v[92:95], v[72:75], 0
    v_mfma_f32_16x16x32_bf16 v[112:115], v[96:99], v[76:79], v[112:115]
    v_mfma_f32_16x16x32_bf16 v[112:115], v[100:103], v[80:83], v[112:115]
    v_mfma_f32_16x16x32_bf16 v[112:115], v[104:107], v[84:87], v[112:115]
    v_mfma_f32_16x16x32_bf16 v[112:115], v[108:111], v[88:91], v[112:115]
    v_max3_u32 v116, v92, v93, v94
    v_max3_u32 v116, v116, v95, v96
    v_max3_u32 v116, v116, v97, v98
    v_max3_u32 v116, v116, v99, v100
    v_max3_u32 v116, v116, v101, v102
    v_max3_u32 v116, v116, v103, v104
    v_max3_u32 v116, v116, v105, v106
    v_max3_u32 v116, v116, v107, v108
    v_max3_u32 v116, v116, v109, v110
    v_max_u32 v116, v116, v111
    v_cmp_eq_u32 vcc, -1, v116
    s_sub_u32 s15, s15, 1
    s_cbranch_scc1 layerb1_kernel_bail
    s_cbranch_vccnz layerb1_kernel_y0_ppoll
    ds_write_b128 v6, v[112:115]
    s_waitcnt lgkmcnt(0)
    s_barrier
    ds_read2st64_b32 v[116:117], v7 offset0:0 offset1:1
    ds_read2st64_b32 v[118:119], v7 offset0:2 offset1:3
    ds_read2st64_b32 v[120:121], v7 offset0:4 offset1:5
    ds_read2st64_b32 v[122:123], v7 offset0:6 offset1:7
    s_waitcnt lgkmcnt(2)
    v_add_f32 v116, v116, v117
    v_add_f32 v118, v118, v119
    s_waitcnt lgkmcnt(0)
    v_add_f32 v120, v120, v121
    v_add_f32 v122, v122, v123
    v_add_f32 v116, v116, v118
    v_add_f32 v120, v120, v122
    v_add_f32 v116, v116, v120
    s_nop 1
    v_mov_b32_dpp v117, v116 quad_perm:[1,0,3,2] row_mask:0xf bank_mask:0xf
    v_cvt_pk_bf16_f32 v124, v116, v117
    s_nop 1
    v_mov_b32_dpp v125, v124 row_shl:2 row_mask:0xf bank_mask:0xf
    v_mov_b32_dpp v126, v124 row_shl:4 row_mask:0xf bank_mask:0xf
    v_mov_b32_dpp v127, v124 row_shl:6 row_mask:0xf bank_mask:0xf
    s_mov_b64 exec, s[40:41]
    buffer_store_dwordx4 v[124:127], v8, s[8:11], s19 offen sc1
    s_mov_b64 exec, -1
    s_lshl_b32 s20, s12, 7
    s_add_u32 s20, s20, 20480
    s_mov_b64 exec, 1
    v_mov_b32 v116, s20
    v_mov_b32 v117, s29
    buffer_store_dword v117, v116, s[8:11], s48 offen sc1
    s_mov_b64 exec, -1
    s_waitcnt vmcnt(0)
    s_barrier
    s_add_u32 s14, s14, 1
    s_branch layerb1_kernel_y0_step
layerb1_kernel_y0_last:
    s_waitcnt vmcnt(0)
    s_barrier
    s_lshl_b32 s20, s12, 7
    s_add_u32 s20, s20, 20480
    s_mov_b32 s29, 64
    s_mov_b64 exec, 1
    v_mov_b32 v116, s20
    v_mov_b32 v117, s29
    buffer_store_dword v117, v116, s[8:11], s48 offen sc1
    s_mov_b64 exec, -1
    s_branch layerb1_kernel_end
layerb1_kernel_y1_start:
    v_lshrrev_b32 v16, 4, v0
    v_and_b32 v17, 7, v0
    v_lshrrev_b32 v18, 3, v0
    v_and_b32 v18, 1, v18
    v_lshl_add_u32 v19, v18, 2, v16
    v_add_u32 v19, 8, v19
    v_mul_u32_u24 v20, 640, v19
    v_lshl_add_u32 v4, v17, 4, v20
    v_and_b32 v20, 1, v17
    v_lshlrev_b32 v20, 2, v20
    v_lshrrev_b32 v21, 1, v17
    v_add_u32 v20, v20, v21
    v_lshlrev_b32 v20, 4, v20
    v_lshl_add_u32 v5, v19, 7, v20
    v_add_u32 v3, 0, v1
    v_lshrrev_b32 v20, 1, v17
    v_lshlrev_b32 v20, 7, v20
    v_and_b32 v21, 1, v17
    v_lshl_add_u32 v20, v21, 2, v20
    v_add_u32 v10, 512, v20
    v_lshlrev_b32 v20, 8, v18
    v_lshl_add_u32 v20, v17, 5, v20
    v_and_b32 v21, 1, v16
    v_lshl_add_u32 v20, v21, 4, v20
    v_add_u32 v20, 10752, v20
    v_add_u32 v21, 12288, v1
    v_lshrrev_b32 v22, 1, v16
    v_cmp_eq_u32 vcc, v22, v18
    s_nop 1
    v_cndmask_b32 v6, v21, v20, vcc
    v_lshrrev_b32 v20, 3, v0
    v_lshlrev_b32 v20, 2, v20
    v_lshl_add_u32 v20, v17, 5, v20
    v_add_u32 v7, 10240, v20
    s_lshl_b32 s20, s12, 7
    s_add_u32 s20, s20, 20480
    s_lshr_b32 s21, s20, 13
    s_lshl_b32 s21, s21, 14
    s_and_b32 s20, s20, 8191
    s_add_u32 s20, s20, s21
    v_lshrrev_b32 v20, 3, v0
    v_lshlrev_b32 v20, 4, v20
    v_add_u32 v8, s20, v20
    s_mul_i32 s46, s12, 20480
    s_add_u32 s46, s46, 103809024
    s_mul_i32 s20, s12, 327680
    s_add_u32 s20, s20, 27344896
    s_add_u32 s21, s20, 65536
    buffer_load_dwordx4 v[176:179], v1, s[8:11], s21 offen offset:0
    buffer_load_dwordx4 v[180:183], v1, s[8:11], s21 offen offset:1024
    s_add_u32 s21, s20, 67584
    buffer_load_dwordx4 v[184:187], v1, s[8:11], s21 offen offset:0
    buffer_load_dwordx4 v[188:191], v1, s[8:11], s21 offen offset:1024
    s_add_u32 s21, s20, 69632
    buffer_load_dwordx4 v[192:195], v1, s[8:11], s21 offen offset:0
    buffer_load_dwordx4 v[196:199], v1, s[8:11], s21 offen offset:1024
    s_add_u32 s21, s20, 71680
    buffer_load_dwordx4 v[200:203], v1, s[8:11], s21 offen offset:0
    buffer_load_dwordx4 v[204:207], v1, s[8:11], s21 offen offset:1024
    s_add_u32 s21, s20, 73728
    buffer_load_dwordx4 v[208:211], v1, s[8:11], s21 offen offset:0
    buffer_load_dwordx4 v[212:215], v1, s[8:11], s21 offen offset:1024
    s_add_u32 s21, s20, 75776
    buffer_load_dwordx4 v[216:219], v1, s[8:11], s21 offen offset:0
    buffer_load_dwordx4 v[220:223], v1, s[8:11], s21 offen offset:1024
    s_add_u32 s21, s20, 77824
    buffer_load_dwordx4 v[224:227], v1, s[8:11], s21 offen offset:0
    buffer_load_dwordx4 v[228:231], v1, s[8:11], s21 offen offset:1024
    s_add_u32 s21, s20, 79872
    buffer_load_dwordx4 v[232:235], v1, s[8:11], s21 offen offset:0
    buffer_load_dwordx4 v[236:239], v1, s[8:11], s21 offen offset:1024
    s_mov_b32 s14, 0
    s_lshl_b32 s20, s12, 7
    v_mov_b32 v9, s20
    s_mov_b32 s47, 0
layerb1_kernel_y1_step:
    s_cmp_lt_u32 s14, 32
    s_cselect_b32 s18, s16, s17
    s_and_b32 s20, s14, 31
    s_lshl_b32 s20, s20, 16
    s_add_u32 s18, s18, s20
    s_mul_i32 s28, s14, 1638400
    s_add_u32 s28, s28, s46
    v_mov_b32 v56, 0
    v_mov_b32 v57, 0
    v_mov_b32 v58, 0
    v_mov_b32 v59, 0
    v_mov_b32 v60, 0
    v_mov_b32 v61, 0
    v_mov_b32 v62, 0
    v_mov_b32 v63, 0
    v_mov_b32 v64, 0
    v_mov_b32 v65, 0
    v_mov_b32 v66, 0
    v_mov_b32 v67, 0
    v_mov_b32 v68, 0
    v_mov_b32 v69, 0
    v_mov_b32 v70, 0
    v_mov_b32 v71, 0
    s_add_u32 s22, s18, 39936
    s_add_u32 s23, s18, 49152
    s_add_u32 s24, s18, 50176
layerb1_kernel_y1_poll:
    buffer_load_dwordx4 v[28:31], v1, s[8:11], s22 offen sc1
    buffer_load_dwordx4 v[32:35], v1, s[8:11], s23 offen sc1
    buffer_load_dwordx4 v[36:39], v1, s[8:11], s24 offen sc1
    s_waitcnt vmcnt(0)
    ds_write_b128 v3, v[28:31] offset:3072
    ds_write_b128 v3, v[32:35] offset:4096
    ds_write_b128 v3, v[36:39] offset:5120
    v_max3_u32 v116, v28, v29, v30
    v_max3_u32 v116, v116, v31, v32
    v_max3_u32 v116, v116, v33, v34
    v_max3_u32 v116, v116, v35, v36
    v_max3_u32 v116, v116, v37, v38
    v_max_u32 v116, v116, v39
    v_cmp_eq_u32 vcc, -1, v116
    s_sub_u32 s15, s15, 1
    s_cbranch_scc1 layerb1_kernel_bail
    s_cbranch_vccnz layerb1_kernel_y1_poll
    s_waitcnt lgkmcnt(0)
    s_barrier
    ds_read_b128 v[16:19], v3 offset:0
    ds_read_b128 v[20:23], v3 offset:1024
    ds_read_b128 v[24:27], v3 offset:2048
    ds_read_b128 v[40:43], v3 offset:6144
    ds_read_b128 v[44:47], v3 offset:7168
    ds_read_b128 v[48:51], v3 offset:8192
    ds_read_b128 v[52:55], v3 offset:9216
    s_cmp_gt_u32 s47, s14
    s_cbranch_scc1 layerb1_kernel_y1_gw_ok
layerb1_kernel_y1_gw_lp:
    buffer_load_dword v116, v9, s[8:11], s48 offen sc1
    s_waitcnt vmcnt(0)
    v_readlane_b32 s47, v116, 0
    s_nop 0
    s_sub_u32 s15, s15, 1
    s_cbranch_scc1 layerb1_kernel_bail
    s_cmp_gt_u32 s47, s14
    s_cbranch_scc0 layerb1_kernel_y1_gw_lp
layerb1_kernel_y1_gw_ok:
    buffer_load_dwordx4 v[76:79], v4, s[8:11], s28 offen offset:128 sc1
    buffer_load_dwordx4 v[80:83], v4, s[8:11], s28 offen offset:256 sc1
    buffer_load_dwordx4 v[84:87], v4, s[8:11], s28 offen offset:384 sc1
    buffer_load_dwordx4 v[88:91], v4, s[8:11], s28 offen offset:512 sc1
    v_smfmac_f32_16x16x64_bf16 v[56:59], v[28:31], a[24:31], v2
    v_smfmac_f32_16x16x64_bf16 v[60:63], v[28:31], a[104:111], v2
    v_smfmac_f32_16x16x64_bf16 v[64:67], v[28:31], a[184:191], v2
    v_smfmac_f32_16x16x64_bf16 v[68:71], v[28:31], v[184:191], v2
    v_smfmac_f32_16x16x64_bf16 v[56:59], v[32:35], a[32:39], v2
    v_smfmac_f32_16x16x64_bf16 v[60:63], v[32:35], a[112:119], v2
    v_smfmac_f32_16x16x64_bf16 v[64:67], v[32:35], a[192:199], v2
    v_smfmac_f32_16x16x64_bf16 v[68:71], v[32:35], v[192:199], v2
    v_smfmac_f32_16x16x64_bf16 v[56:59], v[36:39], a[40:47], v2
    v_smfmac_f32_16x16x64_bf16 v[60:63], v[36:39], a[120:127], v2
    v_smfmac_f32_16x16x64_bf16 v[64:67], v[36:39], a[200:207], v2
    v_smfmac_f32_16x16x64_bf16 v[68:71], v[36:39], v[200:207], v2
    s_waitcnt lgkmcnt(6)
    v_smfmac_f32_16x16x64_bf16 v[56:59], v[16:19], a[0:7], v2
    v_smfmac_f32_16x16x64_bf16 v[60:63], v[16:19], a[80:87], v2
    v_smfmac_f32_16x16x64_bf16 v[64:67], v[16:19], a[160:167], v2
    v_smfmac_f32_16x16x64_bf16 v[68:71], v[16:19], a[240:247], v2
    s_waitcnt lgkmcnt(5)
    v_smfmac_f32_16x16x64_bf16 v[56:59], v[20:23], a[8:15], v2
    v_smfmac_f32_16x16x64_bf16 v[60:63], v[20:23], a[88:95], v2
    v_smfmac_f32_16x16x64_bf16 v[64:67], v[20:23], a[168:175], v2
    v_smfmac_f32_16x16x64_bf16 v[68:71], v[20:23], a[248:255], v2
    s_waitcnt lgkmcnt(4)
    v_smfmac_f32_16x16x64_bf16 v[56:59], v[24:27], a[16:23], v2
    v_smfmac_f32_16x16x64_bf16 v[60:63], v[24:27], a[96:103], v2
    v_smfmac_f32_16x16x64_bf16 v[64:67], v[24:27], a[176:183], v2
    v_smfmac_f32_16x16x64_bf16 v[68:71], v[24:27], v[176:183], v2
    s_waitcnt lgkmcnt(3)
    v_smfmac_f32_16x16x64_bf16 v[56:59], v[40:43], a[48:55], v2
    v_smfmac_f32_16x16x64_bf16 v[60:63], v[40:43], a[128:135], v2
    v_smfmac_f32_16x16x64_bf16 v[64:67], v[40:43], a[208:215], v2
    v_smfmac_f32_16x16x64_bf16 v[68:71], v[40:43], v[208:215], v2
    s_waitcnt lgkmcnt(2)
    v_smfmac_f32_16x16x64_bf16 v[56:59], v[44:47], a[56:63], v2
    v_smfmac_f32_16x16x64_bf16 v[60:63], v[44:47], a[136:143], v2
    v_smfmac_f32_16x16x64_bf16 v[64:67], v[44:47], a[216:223], v2
    v_smfmac_f32_16x16x64_bf16 v[68:71], v[44:47], v[216:223], v2
    s_waitcnt lgkmcnt(1)
    v_smfmac_f32_16x16x64_bf16 v[56:59], v[48:51], a[64:71], v2
    v_smfmac_f32_16x16x64_bf16 v[60:63], v[48:51], a[144:151], v2
    v_smfmac_f32_16x16x64_bf16 v[64:67], v[48:51], a[224:231], v2
    v_smfmac_f32_16x16x64_bf16 v[68:71], v[48:51], v[224:231], v2
    s_waitcnt lgkmcnt(0)
    v_smfmac_f32_16x16x64_bf16 v[56:59], v[52:55], a[72:79], v2
    v_smfmac_f32_16x16x64_bf16 v[60:63], v[52:55], a[152:159], v2
    v_smfmac_f32_16x16x64_bf16 v[64:67], v[52:55], a[232:239], v2
    v_smfmac_f32_16x16x64_bf16 v[68:71], v[52:55], v[232:239], v2
    s_nop 7
    v_permlane32_swap_b32 v56, v64
    v_permlane32_swap_b32 v60, v68
    v_permlane32_swap_b32 v57, v65
    v_permlane32_swap_b32 v61, v69
    v_permlane32_swap_b32 v58, v66
    v_permlane32_swap_b32 v62, v70
    v_permlane32_swap_b32 v59, v67
    v_permlane32_swap_b32 v63, v71
    v_add_f32 v56, v56, v64
    v_add_f32 v60, v60, v68
    v_add_f32 v57, v57, v65
    v_add_f32 v61, v61, v69
    v_add_f32 v58, v58, v66
    v_add_f32 v62, v62, v70
    v_add_f32 v59, v59, v67
    v_add_f32 v63, v63, v71
    s_nop 1
    v_permlane16_swap_b32 v56, v60
    v_permlane16_swap_b32 v57, v61
    v_permlane16_swap_b32 v58, v62
    v_permlane16_swap_b32 v59, v63
    s_nop 1
    v_cvt_pk_bf16_f32 v72, v56, v57
    v_cvt_pk_bf16_f32 v73, v58, v59
    v_cvt_pk_bf16_f32 v74, v60, v61
    v_cvt_pk_bf16_f32 v75, v62, v63
    buffer_store_dwordx4 v[72:75], v4, s[8:11], s28 offen sc1
    s_cmp_eq_u32 s14, 63
    s_cbranch_scc1 layerb1_kernel_y1_last
    s_add_u32 s30, s18, 0
    s_add_u32 s31, s18, 4096
    s_add_u32 s32, s18, 16384
    s_add_u32 s33, s18, 20480
    s_add_u32 s34, s18, 32768
    s_add_u32 s29, s14, 1
    s_cmp_lt_u32 s29, 32
    s_cselect_b32 s19, s16, s17
    s_and_b32 s20, s29, 31
    s_lshl_b32 s20, s20, 16
    s_add_u32 s19, s19, s20
layerb1_kernel_y1_ppoll:
    buffer_load_dwordx4 v[92:95], v5, s[8:11], s30 offen sc1
    buffer_load_dwordx4 v[96:99], v5, s[8:11], s31 offen sc1
    buffer_load_dwordx4 v[100:103], v5, s[8:11], s32 offen sc1
    buffer_load_dwordx4 v[104:107], v5, s[8:11], s33 offen sc1
    buffer_load_dwordx4 v[108:111], v5, s[8:11], s34 offen sc1
    s_waitcnt vmcnt(0)
    v_mfma_f32_16x16x32_bf16 v[112:115], v[92:95], v[72:75], 0
    v_mfma_f32_16x16x32_bf16 v[112:115], v[96:99], v[76:79], v[112:115]
    v_mfma_f32_16x16x32_bf16 v[112:115], v[100:103], v[80:83], v[112:115]
    v_mfma_f32_16x16x32_bf16 v[112:115], v[104:107], v[84:87], v[112:115]
    v_mfma_f32_16x16x32_bf16 v[112:115], v[108:111], v[88:91], v[112:115]
    v_max3_u32 v116, v92, v93, v94
    v_max3_u32 v116, v116, v95, v96
    v_max3_u32 v116, v116, v97, v98
    v_max3_u32 v116, v116, v99, v100
    v_max3_u32 v116, v116, v101, v102
    v_max3_u32 v116, v116, v103, v104
    v_max3_u32 v116, v116, v105, v106
    v_max3_u32 v116, v116, v107, v108
    v_max3_u32 v116, v116, v109, v110
    v_max_u32 v116, v116, v111
    v_cmp_eq_u32 vcc, -1, v116
    s_sub_u32 s15, s15, 1
    s_cbranch_scc1 layerb1_kernel_bail
    s_cbranch_vccnz layerb1_kernel_y1_ppoll
    ds_write_b128 v6, v[112:115]
    s_waitcnt lgkmcnt(0)
    s_barrier
    s_barrier
    s_add_u32 s14, s14, 1
    s_branch layerb1_kernel_y1_step
layerb1_kernel_y1_last:
    s_waitcnt vmcnt(0)
    s_barrier
    s_branch layerb1_kernel_end
layerb1_kernel_y2_start:
    v_lshrrev_b32 v16, 4, v0
    v_and_b32 v17, 7, v0
    v_lshrrev_b32 v18, 3, v0
    v_and_b32 v18, 1, v18
    v_lshl_add_u32 v19, v18, 2, v16
    v_add_u32 v19, 16, v19
    v_mul_u32_u24 v20, 640, v19
    v_lshl_add_u32 v4, v17, 4, v20
    v_and_b32 v20, 1, v17
    v_lshlrev_b32 v20, 2, v20
    v_lshrrev_b32 v21, 1, v17
    v_add_u32 v20, v20, v21
    v_lshlrev_b32 v20, 4, v20
    v_lshl_add_u32 v5, v19, 7, v20
    v_add_u32 v3, 0, v1
    v_lshrrev_b32 v20, 1, v17
    v_lshlrev_b32 v20, 7, v20
    v_and_b32 v21, 1, v17
    v_lshl_add_u32 v20, v21, 2, v20
    v_add_u32 v10, 1024, v20
    v_lshlrev_b32 v20, 8, v18
    v_lshl_add_u32 v20, v17, 5, v20
    v_and_b32 v21, 1, v16
    v_lshl_add_u32 v20, v21, 4, v20
    v_add_u32 v20, 11264, v20
    v_add_u32 v21, 12288, v1
    v_lshrrev_b32 v22, 1, v16
    v_cmp_eq_u32 vcc, v22, v18
    s_nop 1
    v_cndmask_b32 v6, v21, v20, vcc
    v_lshrrev_b32 v20, 3, v0
    v_lshlrev_b32 v20, 2, v20
    v_lshl_add_u32 v20, v17, 5, v20
    v_add_u32 v7, 10240, v20
    s_lshl_b32 s20, s12, 7
    s_add_u32 s20, s20, 20480
    s_lshr_b32 s21, s20, 13
    s_lshl_b32 s21, s21, 14
    s_and_b32 s20, s20, 8191
    s_add_u32 s20, s20, s21
    v_lshrrev_b32 v20, 3, v0
    v_lshlrev_b32 v20, 4, v20
    v_add_u32 v8, s20, v20
    s_mul_i32 s46, s12, 20480
    s_add_u32 s46, s46, 103809024
    s_mul_i32 s20, s12, 327680
    s_add_u32 s20, s20, 27426816
    s_add_u32 s21, s20, 65536
    buffer_load_dwordx4 v[176:179], v1, s[8:11], s21 offen offset:0
    buffer_load_dwordx4 v[180:183], v1, s[8:11], s21 offen offset:1024
    s_add_u32 s21, s20, 67584
    buffer_load_dwordx4 v[184:187], v1, s[8:11], s21 offen offset:0
    buffer_load_dwordx4 v[188:191], v1, s[8:11], s21 offen offset:1024
    s_add_u32 s21, s20, 69632
    buffer_load_dwordx4 v[192:195], v1, s[8:11], s21 offen offset:0
    buffer_load_dwordx4 v[196:199], v1, s[8:11], s21 offen offset:1024
    s_add_u32 s21, s20, 71680
    buffer_load_dwordx4 v[200:203], v1, s[8:11], s21 offen offset:0
    buffer_load_dwordx4 v[204:207], v1, s[8:11], s21 offen offset:1024
    s_add_u32 s21, s20, 73728
    buffer_load_dwordx4 v[208:211], v1, s[8:11], s21 offen offset:0
    buffer_load_dwordx4 v[212:215], v1, s[8:11], s21 offen offset:1024
    s_add_u32 s21, s20, 75776
    buffer_load_dwordx4 v[216:219], v1, s[8:11], s21 offen offset:0
    buffer_load_dwordx4 v[220:223], v1, s[8:11], s21 offen offset:1024
    s_add_u32 s21, s20, 77824
    buffer_load_dwordx4 v[224:227], v1, s[8:11], s21 offen offset:0
    buffer_load_dwordx4 v[228:231], v1, s[8:11], s21 offen offset:1024
    s_add_u32 s21, s20, 79872
    buffer_load_dwordx4 v[232:235], v1, s[8:11], s21 offen offset:0
    buffer_load_dwordx4 v[236:239], v1, s[8:11], s21 offen offset:1024
    s_mov_b32 s14, 0
    s_lshl_b32 s20, s12, 7
    v_mov_b32 v9, s20
    s_mov_b32 s47, 0
layerb1_kernel_y2_step:
    s_cmp_lt_u32 s14, 32
    s_cselect_b32 s18, s16, s17
    s_and_b32 s20, s14, 31
    s_lshl_b32 s20, s20, 16
    s_add_u32 s18, s18, s20
    s_mul_i32 s28, s14, 1638400
    s_add_u32 s28, s28, s46
    v_mov_b32 v56, 0
    v_mov_b32 v57, 0
    v_mov_b32 v58, 0
    v_mov_b32 v59, 0
    v_mov_b32 v60, 0
    v_mov_b32 v61, 0
    v_mov_b32 v62, 0
    v_mov_b32 v63, 0
    v_mov_b32 v64, 0
    v_mov_b32 v65, 0
    v_mov_b32 v66, 0
    v_mov_b32 v67, 0
    v_mov_b32 v68, 0
    v_mov_b32 v69, 0
    v_mov_b32 v70, 0
    v_mov_b32 v71, 0
    s_add_u32 s22, s18, 51200
    s_add_u32 s23, s18, 52224
layerb1_kernel_y2_poll:
    buffer_load_dwordx4 v[40:43], v1, s[8:11], s22 offen sc1
    buffer_load_dwordx4 v[44:47], v1, s[8:11], s23 offen sc1
    s_waitcnt vmcnt(0)
    ds_write_b128 v3, v[40:43] offset:6144
    ds_write_b128 v3, v[44:47] offset:7168
    v_max3_u32 v116, v40, v41, v42
    v_max3_u32 v116, v116, v43, v44
    v_max3_u32 v116, v116, v45, v46
    v_max_u32 v116, v116, v47
    v_cmp_eq_u32 vcc, -1, v116
    s_sub_u32 s15, s15, 1
    s_cbranch_scc1 layerb1_kernel_bail
    s_cbranch_vccnz layerb1_kernel_y2_poll
    s_waitcnt lgkmcnt(0)
    s_barrier
    ds_read_b128 v[16:19], v3 offset:0
    ds_read_b128 v[20:23], v3 offset:1024
    ds_read_b128 v[24:27], v3 offset:2048
    ds_read_b128 v[28:31], v3 offset:3072
    ds_read_b128 v[32:35], v3 offset:4096
    ds_read_b128 v[36:39], v3 offset:5120
    ds_read_b128 v[48:51], v3 offset:8192
    ds_read_b128 v[52:55], v3 offset:9216
    s_cmp_gt_u32 s47, s14
    s_cbranch_scc1 layerb1_kernel_y2_gw_ok
layerb1_kernel_y2_gw_lp:
    buffer_load_dword v116, v9, s[8:11], s48 offen sc1
    s_waitcnt vmcnt(0)
    v_readlane_b32 s47, v116, 0
    s_nop 0
    s_sub_u32 s15, s15, 1
    s_cbranch_scc1 layerb1_kernel_bail
    s_cmp_gt_u32 s47, s14
    s_cbranch_scc0 layerb1_kernel_y2_gw_lp
layerb1_kernel_y2_gw_ok:
    buffer_load_dwordx4 v[76:79], v4, s[8:11], s28 offen offset:128 sc1
    buffer_load_dwordx4 v[80:83], v4, s[8:11], s28 offen offset:256 sc1
    buffer_load_dwordx4 v[84:87], v4, s[8:11], s28 offen offset:384 sc1
    buffer_load_dwordx4 v[88:91], v4, s[8:11], s28 offen offset:512 sc1
    v_smfmac_f32_16x16x64_bf16 v[56:59], v[40:43], a[48:55], v2
    v_smfmac_f32_16x16x64_bf16 v[60:63], v[40:43], a[128:135], v2
    v_smfmac_f32_16x16x64_bf16 v[64:67], v[40:43], a[208:215], v2
    v_smfmac_f32_16x16x64_bf16 v[68:71], v[40:43], v[208:215], v2
    v_smfmac_f32_16x16x64_bf16 v[56:59], v[44:47], a[56:63], v2
    v_smfmac_f32_16x16x64_bf16 v[60:63], v[44:47], a[136:143], v2
    v_smfmac_f32_16x16x64_bf16 v[64:67], v[44:47], a[216:223], v2
    v_smfmac_f32_16x16x64_bf16 v[68:71], v[44:47], v[216:223], v2
    s_waitcnt lgkmcnt(7)
    v_smfmac_f32_16x16x64_bf16 v[56:59], v[16:19], a[0:7], v2
    v_smfmac_f32_16x16x64_bf16 v[60:63], v[16:19], a[80:87], v2
    v_smfmac_f32_16x16x64_bf16 v[64:67], v[16:19], a[160:167], v2
    v_smfmac_f32_16x16x64_bf16 v[68:71], v[16:19], a[240:247], v2
    s_waitcnt lgkmcnt(6)
    v_smfmac_f32_16x16x64_bf16 v[56:59], v[20:23], a[8:15], v2
    v_smfmac_f32_16x16x64_bf16 v[60:63], v[20:23], a[88:95], v2
    v_smfmac_f32_16x16x64_bf16 v[64:67], v[20:23], a[168:175], v2
    v_smfmac_f32_16x16x64_bf16 v[68:71], v[20:23], a[248:255], v2
    s_waitcnt lgkmcnt(5)
    v_smfmac_f32_16x16x64_bf16 v[56:59], v[24:27], a[16:23], v2
    v_smfmac_f32_16x16x64_bf16 v[60:63], v[24:27], a[96:103], v2
    v_smfmac_f32_16x16x64_bf16 v[64:67], v[24:27], a[176:183], v2
    v_smfmac_f32_16x16x64_bf16 v[68:71], v[24:27], v[176:183], v2
    s_waitcnt lgkmcnt(4)
    v_smfmac_f32_16x16x64_bf16 v[56:59], v[28:31], a[24:31], v2
    v_smfmac_f32_16x16x64_bf16 v[60:63], v[28:31], a[104:111], v2
    v_smfmac_f32_16x16x64_bf16 v[64:67], v[28:31], a[184:191], v2
    v_smfmac_f32_16x16x64_bf16 v[68:71], v[28:31], v[184:191], v2
    s_waitcnt lgkmcnt(3)
    v_smfmac_f32_16x16x64_bf16 v[56:59], v[32:35], a[32:39], v2
    v_smfmac_f32_16x16x64_bf16 v[60:63], v[32:35], a[112:119], v2
    v_smfmac_f32_16x16x64_bf16 v[64:67], v[32:35], a[192:199], v2
    v_smfmac_f32_16x16x64_bf16 v[68:71], v[32:35], v[192:199], v2
    s_waitcnt lgkmcnt(2)
    v_smfmac_f32_16x16x64_bf16 v[56:59], v[36:39], a[40:47], v2
    v_smfmac_f32_16x16x64_bf16 v[60:63], v[36:39], a[120:127], v2
    v_smfmac_f32_16x16x64_bf16 v[64:67], v[36:39], a[200:207], v2
    v_smfmac_f32_16x16x64_bf16 v[68:71], v[36:39], v[200:207], v2
    s_waitcnt lgkmcnt(1)
    v_smfmac_f32_16x16x64_bf16 v[56:59], v[48:51], a[64:71], v2
    v_smfmac_f32_16x16x64_bf16 v[60:63], v[48:51], a[144:151], v2
    v_smfmac_f32_16x16x64_bf16 v[64:67], v[48:51], a[224:231], v2
    v_smfmac_f32_16x16x64_bf16 v[68:71], v[48:51], v[224:231], v2
    s_waitcnt lgkmcnt(0)
    v_smfmac_f32_16x16x64_bf16 v[56:59], v[52:55], a[72:79], v2
    v_smfmac_f32_16x16x64_bf16 v[60:63], v[52:55], a[152:159], v2
    v_smfmac_f32_16x16x64_bf16 v[64:67], v[52:55], a[232:239], v2
    v_smfmac_f32_16x16x64_bf16 v[68:71], v[52:55], v[232:239], v2
    s_nop 7
    v_permlane32_swap_b32 v56, v64
    v_permlane32_swap_b32 v60, v68
    v_permlane32_swap_b32 v57, v65
    v_permlane32_swap_b32 v61, v69
    v_permlane32_swap_b32 v58, v66
    v_permlane32_swap_b32 v62, v70
    v_permlane32_swap_b32 v59, v67
    v_permlane32_swap_b32 v63, v71
    v_add_f32 v56, v56, v64
    v_add_f32 v60, v60, v68
    v_add_f32 v57, v57, v65
    v_add_f32 v61, v61, v69
    v_add_f32 v58, v58, v66
    v_add_f32 v62, v62, v70
    v_add_f32 v59, v59, v67
    v_add_f32 v63, v63, v71
    s_nop 1
    v_permlane16_swap_b32 v56, v60
    v_permlane16_swap_b32 v57, v61
    v_permlane16_swap_b32 v58, v62
    v_permlane16_swap_b32 v59, v63
    s_nop 1
    v_cvt_pk_bf16_f32 v72, v56, v57
    v_cvt_pk_bf16_f32 v73, v58, v59
    v_cvt_pk_bf16_f32 v74, v60, v61
    v_cvt_pk_bf16_f32 v75, v62, v63
    buffer_store_dwordx4 v[72:75], v4, s[8:11], s28 offen sc1
    s_cmp_eq_u32 s14, 63
    s_cbranch_scc1 layerb1_kernel_y2_last
    s_add_u32 s30, s18, 0
    s_add_u32 s31, s18, 4096
    s_add_u32 s32, s18, 16384
    s_add_u32 s33, s18, 20480
    s_add_u32 s34, s18, 32768
    s_add_u32 s29, s14, 1
    s_cmp_lt_u32 s29, 32
    s_cselect_b32 s19, s16, s17
    s_and_b32 s20, s29, 31
    s_lshl_b32 s20, s20, 16
    s_add_u32 s19, s19, s20
layerb1_kernel_y2_ppoll:
    buffer_load_dwordx4 v[92:95], v5, s[8:11], s30 offen sc1
    buffer_load_dwordx4 v[96:99], v5, s[8:11], s31 offen sc1
    buffer_load_dwordx4 v[100:103], v5, s[8:11], s32 offen sc1
    buffer_load_dwordx4 v[104:107], v5, s[8:11], s33 offen sc1
    buffer_load_dwordx4 v[108:111], v5, s[8:11], s34 offen sc1
    s_waitcnt vmcnt(0)
    v_mfma_f32_16x16x32_bf16 v[112:115], v[92:95], v[72:75], 0
    v_mfma_f32_16x16x32_bf16 v[112:115], v[96:99], v[76:79], v[112:115]
    v_mfma_f32_16x16x32_bf16 v[112:115], v[100:103], v[80:83], v[112:115]
    v_mfma_f32_16x16x32_bf16 v[112:115], v[104:107], v[84:87], v[112:115]
    v_mfma_f32_16x16x32_bf16 v[112:115], v[108:111], v[88:91], v[112:115]
    v_max3_u32 v116, v92, v93, v94
    v_max3_u32 v116, v116, v95, v96
    v_max3_u32 v116, v116, v97, v98
    v_max3_u32 v116, v116, v99, v100
    v_max3_u32 v116, v116, v101, v102
    v_max3_u32 v116, v116, v103, v104
    v_max3_u32 v116, v116, v105, v106
    v_max3_u32 v116, v116, v107, v108
    v_max3_u32 v116, v116, v109, v110
    v_max_u32 v116, v116, v111
    v_cmp_eq_u32 vcc, -1, v116
    s_sub_u32 s15, s15, 1
    s_cbranch_scc1 layerb1_kernel_bail
    s_cbranch_vccnz layerb1_kernel_y2_ppoll
    ds_write_b128 v6, v[112:115]
    s_waitcnt lgkmcnt(0)
    s_barrier
    s_barrier
    s_add_u32 s14, s14, 1
    s_branch layerb1_kernel_y2_step
layerb1_kernel_y2_last:
    s_waitcnt vmcnt(0)
    s_barrier
    s_branch layerb1_kernel_end
layerb1_kernel_y3_start:
    v_lshrrev_b32 v16, 4, v0
    v_and_b32 v17, 7, v0
    v_lshrrev_b32 v18, 3, v0
    v_and_b32 v18, 1, v18
    v_lshl_add_u32 v19, v18, 2, v16
    v_add_u32 v19, 24, v19
    v_mul_u32_u24 v20, 640, v19
    v_lshl_add_u32 v4, v17, 4, v20
    v_and_b32 v20, 1, v17
    v_lshlrev_b32 v20, 2, v20
    v_lshrrev_b32 v21, 1, v17
    v_add_u32 v20, v20, v21
    v_lshlrev_b32 v20, 4, v20
    v_lshl_add_u32 v5, v19, 7, v20
    v_add_u32 v3, 0, v1
    v_lshrrev_b32 v20, 1, v17
    v_lshlrev_b32 v20, 7, v20
    v_and_b32 v21, 1, v17
    v_lshl_add_u32 v20, v21, 2, v20
    v_add_u32 v10, 1536, v20
    v_lshlrev_b32 v20, 8, v18
    v_lshl_add_u32 v20, v17, 5, v20
    v_and_b32 v21, 1, v16
    v_lshl_add_u32 v20, v21, 4, v20
    v_add_u32 v20, 11776, v20
    v_add_u32 v21, 12288, v1
    v_lshrrev_b32 v22, 1, v16
    v_cmp_eq_u32 vcc, v22, v18
    s_nop 1
    v_cndmask_b32 v6, v21, v20, vcc
    v_lshrrev_b32 v20, 3, v0
    v_lshlrev_b32 v20, 2, v20
    v_lshl_add_u32 v20, v17, 5, v20
    v_add_u32 v7, 10240, v20
    s_lshl_b32 s20, s12, 7
    s_add_u32 s20, s20, 20480
    s_lshr_b32 s21, s20, 13
    s_lshl_b32 s21, s21, 14
    s_and_b32 s20, s20, 8191
    s_add_u32 s20, s20, s21
    v_lshrrev_b32 v20, 3, v0
    v_lshlrev_b32 v20, 4, v20
    v_add_u32 v8, s20, v20
    s_mul_i32 s46, s12, 20480
    s_add_u32 s46, s46, 103809024
    s_mul_i32 s20, s12, 327680
    s_add_u32 s20, s20, 27508736
    s_add_u32 s21, s20, 65536
    buffer_load_dwordx4 v[176:179], v1, s[8:11], s21 offen offset:0
    buffer_load_dwordx4 v[180:183], v1, s[8:11], s21 offen offset:1024
    s_add_u32 s21, s20, 67584
    buffer_load_dwordx4 v[184:187], v1, s[8:11], s21 offen offset:0
    buffer_load_dwordx4 v[188:191], v1, s[8:11], s21 offen offset:1024
    s_add_u32 s21, s20, 69632
    buffer_load_dwordx4 v[192:195], v1, s[8:11], s21 offen offset:0
    buffer_load_dwordx4 v[196:199], v1, s[8:11], s21 offen offset:1024
    s_add_u32 s21, s20, 71680
    buffer_load_dwordx4 v[200:203], v1, s[8:11], s21 offen offset:0
    buffer_load_dwordx4 v[204:207], v1, s[8:11], s21 offen offset:1024
    s_add_u32 s21, s20, 73728
    buffer_load_dwordx4 v[208:211], v1, s[8:11], s21 offen offset:0
    buffer_load_dwordx4 v[212:215], v1, s[8:11], s21 offen offset:1024
    s_add_u32 s21, s20, 75776
    buffer_load_dwordx4 v[216:219], v1, s[8:11], s21 offen offset:0
    buffer_load_dwordx4 v[220:223], v1, s[8:11], s21 offen offset:1024
    s_add_u32 s21, s20, 77824
    buffer_load_dwordx4 v[224:227], v1, s[8:11], s21 offen offset:0
    buffer_load_dwordx4 v[228:231], v1, s[8:11], s21 offen offset:1024
    s_add_u32 s21, s20, 79872
    buffer_load_dwordx4 v[232:235], v1, s[8:11], s21 offen offset:0
    buffer_load_dwordx4 v[236:239], v1, s[8:11], s21 offen offset:1024
    s_mov_b32 s14, 0
    s_lshl_b32 s20, s12, 7
    v_mov_b32 v9, s20
    s_mov_b32 s47, 0
layerb1_kernel_y3_step:
    s_cmp_lt_u32 s14, 32
    s_cselect_b32 s18, s16, s17
    s_and_b32 s20, s14, 31
    s_lshl_b32 s20, s20, 16
    s_add_u32 s18, s18, s20
    s_mul_i32 s28, s14, 1638400
    s_add_u32 s28, s28, s46
    v_mov_b32 v56, 0
    v_mov_b32 v57, 0
    v_mov_b32 v58, 0
    v_mov_b32 v59, 0
    v_mov_b32 v60, 0
    v_mov_b32 v61, 0
    v_mov_b32 v62, 0
    v_mov_b32 v63, 0
    v_mov_b32 v64, 0
    v_mov_b32 v65, 0
    v_mov_b32 v66, 0
    v_mov_b32 v67, 0
    v_mov_b32 v68, 0
    v_mov_b32 v69, 0
    v_mov_b32 v70, 0
    v_mov_b32 v71, 0
    s_add_u32 s22, s18, 53248
    s_add_u32 s23, s18, 54272
layerb1_kernel_y3_poll:
    buffer_load_dwordx4 v[48:51], v1, s[8:11], s22 offen sc1
    buffer_load_dwordx4 v[52:55], v1, s[8:11], s23 offen sc1
    s_waitcnt vmcnt(0)
    ds_write_b128 v3, v[48:51] offset:8192
    ds_write_b128 v3, v[52:55] offset:9216
    v_max3_u32 v116, v48, v49, v50
    v_max3_u32 v116, v116, v51, v52
    v_max3_u32 v116, v116, v53, v54
    v_max_u32 v116, v116, v55
    v_cmp_eq_u32 vcc, -1, v116
    s_sub_u32 s15, s15, 1
    s_cbranch_scc1 layerb1_kernel_bail
    s_cbranch_vccnz layerb1_kernel_y3_poll
    s_waitcnt lgkmcnt(0)
    s_barrier
    ds_read_b128 v[16:19], v3 offset:0
    ds_read_b128 v[20:23], v3 offset:1024
    ds_read_b128 v[24:27], v3 offset:2048
    ds_read_b128 v[28:31], v3 offset:3072
    ds_read_b128 v[32:35], v3 offset:4096
    ds_read_b128 v[36:39], v3 offset:5120
    ds_read_b128 v[40:43], v3 offset:6144
    ds_read_b128 v[44:47], v3 offset:7168
    s_cmp_gt_u32 s47, s14
    s_cbranch_scc1 layerb1_kernel_y3_gw_ok
layerb1_kernel_y3_gw_lp:
    buffer_load_dword v116, v9, s[8:11], s48 offen sc1
    s_waitcnt vmcnt(0)
    v_readlane_b32 s47, v116, 0
    s_nop 0
    s_sub_u32 s15, s15, 1
    s_cbranch_scc1 layerb1_kernel_bail
    s_cmp_gt_u32 s47, s14
    s_cbranch_scc0 layerb1_kernel_y3_gw_lp
layerb1_kernel_y3_gw_ok:
    buffer_load_dwordx4 v[76:79], v4, s[8:11], s28 offen offset:128 sc1
    buffer_load_dwordx4 v[80:83], v4, s[8:11], s28 offen offset:256 sc1
    buffer_load_dwordx4 v[84:87], v4, s[8:11], s28 offen offset:384 sc1
    buffer_load_dwordx4 v[88:91], v4, s[8:11], s28 offen offset:512 sc1
    v_smfmac_f32_16x16x64_bf16 v[56:59], v[48:51], a[64:71], v2
    v_smfmac_f32_16x16x64_bf16 v[60:63], v[48:51], a[144:151], v2
    v_smfmac_f32_16x16x64_bf16 v[64:67], v[48:51], a[224:231], v2
    v_smfmac_f32_16x16x64_bf16 v[68:71], v[48:51], v[224:231], v2
    v_smfmac_f32_16x16x64_bf16 v[56:59], v[52:55], a[72:79], v2
    v_smfmac_f32_16x16x64_bf16 v[60:63], v[52:55], a[152:159], v2
    v_smfmac_f32_16x16x64_bf16 v[64:67], v[52:55], a[232:239], v2
    v_smfmac_f32_16x16x64_bf16 v[68:71], v[52:55], v[232:239], v2
    s_waitcnt lgkmcnt(7)
    v_smfmac_f32_16x16x64_bf16 v[56:59], v[16:19], a[0:7], v2
    v_smfmac_f32_16x16x64_bf16 v[60:63], v[16:19], a[80:87], v2
    v_smfmac_f32_16x16x64_bf16 v[64:67], v[16:19], a[160:167], v2
    v_smfmac_f32_16x16x64_bf16 v[68:71], v[16:19], a[240:247], v2
    s_waitcnt lgkmcnt(6)
    v_smfmac_f32_16x16x64_bf16 v[56:59], v[20:23], a[8:15], v2
    v_smfmac_f32_16x16x64_bf16 v[60:63], v[20:23], a[88:95], v2
    v_smfmac_f32_16x16x64_bf16 v[64:67], v[20:23], a[168:175], v2
    v_smfmac_f32_16x16x64_bf16 v[68:71], v[20:23], a[248:255], v2
    s_waitcnt lgkmcnt(5)
    v_smfmac_f32_16x16x64_bf16 v[56:59], v[24:27], a[16:23], v2
    v_smfmac_f32_16x16x64_bf16 v[60:63], v[24:27], a[96:103], v2
    v_smfmac_f32_16x16x64_bf16 v[64:67], v[24:27], a[176:183], v2
    v_smfmac_f32_16x16x64_bf16 v[68:71], v[24:27], v[176:183], v2
    s_waitcnt lgkmcnt(4)
    v_smfmac_f32_16x16x64_bf16 v[56:59], v[28:31], a[24:31], v2
    v_smfmac_f32_16x16x64_bf16 v[60:63], v[28:31], a[104:111], v2
    v_smfmac_f32_16x16x64_bf16 v[64:67], v[28:31], a[184:191], v2
    v_smfmac_f32_16x16x64_bf16 v[68:71], v[28:31], v[184:191], v2
    s_waitcnt lgkmcnt(3)
    v_smfmac_f32_16x16x64_bf16 v[56:59], v[32:35], a[32:39], v2
    v_smfmac_f32_16x16x64_bf16 v[60:63], v[32:35], a[112:119], v2
    v_smfmac_f32_16x16x64_bf16 v[64:67], v[32:35], a[192:199], v2
    v_smfmac_f32_16x16x64_bf16 v[68:71], v[32:35], v[192:199], v2
    s_waitcnt lgkmcnt(2)
    v_smfmac_f32_16x16x64_bf16 v[56:59], v[36:39], a[40:47], v2
    v_smfmac_f32_16x16x64_bf16 v[60:63], v[36:39], a[120:127], v2
    v_smfmac_f32_16x16x64_bf16 v[64:67], v[36:39], a[200:207], v2
    v_smfmac_f32_16x16x64_bf16 v[68:71], v[36:39], v[200:207], v2
    s_waitcnt lgkmcnt(1)
    v_smfmac_f32_16x16x64_bf16 v[56:59], v[40:43], a[48:55], v2
    v_smfmac_f32_16x16x64_bf16 v[60:63], v[40:43], a[128:135], v2
    v_smfmac_f32_16x16x64_bf16 v[64:67], v[40:43], a[208:215], v2
    v_smfmac_f32_16x16x64_bf16 v[68:71], v[40:43], v[208:215], v2
    s_waitcnt lgkmcnt(0)
    v_smfmac_f32_16x16x64_bf16 v[56:59], v[44:47], a[56:63], v2
    v_smfmac_f32_16x16x64_bf16 v[60:63], v[44:47], a[136:143], v2
    v_smfmac_f32_16x16x64_bf16 v[64:67], v[44:47], a[216:223], v2
    v_smfmac_f32_16x16x64_bf16 v[68:71], v[44:47], v[216:223], v2
    s_nop 7
    v_permlane32_swap_b32 v56, v64
    v_permlane32_swap_b32 v60, v68
    v_permlane32_swap_b32 v57, v65
    v_permlane32_swap_b32 v61, v69
    v_permlane32_swap_b32 v58, v66
    v_permlane32_swap_b32 v62, v70
    v_permlane32_swap_b32 v59, v67
    v_permlane32_swap_b32 v63, v71
    v_add_f32 v56, v56, v64
    v_add_f32 v60, v60, v68
    v_add_f32 v57, v57, v65
    v_add_f32 v61, v61, v69
    v_add_f32 v58, v58, v66
    v_add_f32 v62, v62, v70
    v_add_f32 v59, v59, v67
    v_add_f32 v63, v63, v71
    s_nop 1
    v_permlane16_swap_b32 v56, v60
    v_permlane16_swap_b32 v57, v61
    v_permlane16_swap_b32 v58, v62
    v_permlane16_swap_b32 v59, v63
    s_nop 1
    v_cvt_pk_bf16_f32 v72, v56, v57
    v_cvt_pk_bf16_f32 v73, v58, v59
    v_cvt_pk_bf16_f32 v74, v60, v61
    v_cvt_pk_bf16_f32 v75, v62, v63
    buffer_store_dwordx4 v[72:75], v4, s[8:11], s28 offen sc1
    s_cmp_eq_u32 s14, 63
    s_cbranch_scc1 layerb1_kernel_y3_last
    s_add_u32 s30, s18, 0
    s_add_u32 s31, s18, 4096
    s_add_u32 s32, s18, 16384
    s_add_u32 s33, s18, 20480
    s_add_u32 s34, s18, 32768
    s_add_u32 s29, s14, 1
    s_cmp_lt_u32 s29, 32
    s_cselect_b32 s19, s16, s17
    s_and_b32 s20, s29, 31
    s_lshl_b32 s20, s20, 16
    s_add_u32 s19, s19, s20
layerb1_kernel_y3_ppoll:
    buffer_load_dwordx4 v[92:95], v5, s[8:11], s30 offen sc1
    buffer_load_dwordx4 v[96:99], v5, s[8:11], s31 offen sc1
    buffer_load_dwordx4 v[100:103], v5, s[8:11], s32 offen sc1
    buffer_load_dwordx4 v[104:107], v5, s[8:11], s33 offen sc1
    buffer_load_dwordx4 v[108:111], v5, s[8:11], s34 offen sc1
    s_waitcnt vmcnt(0)
    v_mfma_f32_16x16x32_bf16 v[112:115], v[92:95], v[72:75], 0
    v_mfma_f32_16x16x32_bf16 v[112:115], v[96:99], v[76:79], v[112:115]
    v_mfma_f32_16x16x32_bf16 v[112:115], v[100:103], v[80:83], v[112:115]
    v_mfma_f32_16x16x32_bf16 v[112:115], v[104:107], v[84:87], v[112:115]
    v_mfma_f32_16x16x32_bf16 v[112:115], v[108:111], v[88:91], v[112:115]
    v_max3_u32 v116, v92, v93, v94
    v_max3_u32 v116, v116, v95, v96
    v_max3_u32 v116, v116, v97, v98
    v_max3_u32 v116, v116, v99, v100
    v_max3_u32 v116, v116, v101, v102
    v_max3_u32 v116, v116, v103, v104
    v_max3_u32 v116, v116, v105, v106
    v_max3_u32 v116, v116, v107, v108
    v_max3_u32 v116, v116, v109, v110
    v_max_u32 v116, v116, v111
    v_cmp_eq_u32 vcc, -1, v116
    s_sub_u32 s15, s15, 1
    s_cbranch_scc1 layerb1_kernel_bail
    s_cbranch_vccnz layerb1_kernel_y3_ppoll
    ds_write_b128 v6, v[112:115]
    s_waitcnt lgkmcnt(0)
    s_barrier
    s_barrier
    s_add_u32 s14, s14, 1
    s_branch layerb1_kernel_y3_step
layerb1_kernel_y3_last:
    s_waitcnt vmcnt(0)
    s_barrier
    s_branch layerb1_kernel_end
layerb1_kernel_proj:
    s_sub_u32 s22, s20, 4
    s_lshl_b32 s22, s22, 5
    s_add_u32 s12, s22, s21
    s_mov_b32 s14, 0
    s_mov_b32 s15, 64
    v_lshlrev_b32 v1, 4, v0
    v_and_b32 v8, 31, v0
    v_lshrrev_b32 v9, 5, v0
    s_cmp_ge_u32 s12, 80
    s_cbranch_scc1 layerb1_kernel_g_qk
    v_lshrrev_b32 v10, 3, v8
    v_and_b32 v11, 7, v8
    v_mul_u32_u24 v12, 20480, v10
    v_lshl_add_u32 v12, v11, 4, v12
    v_lshl_add_u32 v4, v9, 8, v12
    s_mul_i32 s24, s12, 327680
    s_mul_i32 s25, s13, 81920
    s_add_u32 s24, s24, s25
    s_add_u32 s24, s24, 27262976
    s_add_u32 s24, s24, 3584
    s_add_u32 s24, s24, 3584
    s_add_u32 s24, s24, 3584
    s_add_u32 s24, s24, 3584
    buffer_load_dwordx4 v[192:195], v4, s[8:11], s24 offen offset:2048
    buffer_load_dwordx4 v[196:199], v4, s[8:11], s24 offen offset:2176
    buffer_load_dwordx4 v[200:203], v4, s[8:11], s24 offen offset:2560
    buffer_load_dwordx4 v[204:207], v4, s[8:11], s24 offen offset:2688
    buffer_load_dwordx4 v[208:211], v4, s[8:11], s24 offen offset:3072
    buffer_load_dwordx4 v[212:215], v4, s[8:11], s24 offen offset:3200
    s_add_u32 s24, s24, 3584
    buffer_load_dwordx4 v[216:219], v4, s[8:11], s24 offen offset:0
    buffer_load_dwordx4 v[220:223], v4, s[8:11], s24 offen offset:128
    buffer_load_dwordx4 v[224:227], v4, s[8:11], s24 offen offset:512
    buffer_load_dwordx4 v[228:231], v4, s[8:11], s24 offen offset:640
    buffer_load_dwordx4 v[232:235], v4, s[8:11], s24 offen offset:1024
    buffer_load_dwordx4 v[236:239], v4, s[8:11], s24 offen offset:1152
    buffer_load_dwordx4 v[240:243], v4, s[8:11], s24 offen offset:1536
    buffer_load_dwordx4 v[244:247], v4, s[8:11], s24 offen offset:1664
    buffer_load_dwordx4 v[248:251], v4, s[8:11], s24 offen offset:2048
    buffer_load_dwordx4 v[252:255], v4, s[8:11], s24 offen offset:2176
    s_lshl_b32 s25, s13, 3
    v_add_u32 v10, s25, v10
    v_mul_u32_u24 v10, 640, v10
    v_lshl_add_u32 v10, v9, 7, v10
    v_lshl_add_u32 v10, v11, 4, v10
    v_add_u32 v3, 128, v10
    s_mul_i32 s17, s12, 20480
    s_mul_i32 s25, s14, 1638400
    s_add_u32 s17, s17, s25
    s_add_u32 s17, s17, 103809024
    s_mov_b32 s20, 1638400
    s_mul_i32 s19, s13, 10240
    s_add_u32 s19, s19, 220200960
    s_mov_b32 s22, 0
    s_mov_b32 s56, 0
    s_mov_b32 s58, 400000
    s_add_u32 s57, s48, 45056
    s_cmp_lg_u32 s13, 0
    s_cbranch_scc1 layerb1_kernel_gu_lw1
    s_min_u32 s28, s14, 63
    s_cmp_gt_u32 s56, s28
    s_cbranch_scc1 layerb1_kernel_gu_lw1
layerb1_kernel_gu_lp1:
    buffer_load_dwordx4 v[124:127], v1, s[8:11], s57 offen sc1
    s_waitcnt vmcnt(0)
    v_min_u32 v124, v124, v125
    v_min_u32 v126, v126, v127
    v_min_u32 v124, v124, v126
    v_cmp_eq_u32 vcc, 0, v124
    s_nop 1
    s_ff1_i32_b64 s56, vcc
    s_min_u32 s56, s56, 64
    s_sub_u32 s58, s58, 1
    s_cbranch_scc1 layerb1_kernel_bail
    s_cmp_gt_u32 s56, s28
    s_cbranch_scc0 layerb1_kernel_gu_lp1
layerb1_kernel_gu_lw1:
    s_barrier
    s_min_u32 s24, s14, 63
    s_mul_i32 s24, s24, 40960
    s_add_u32 s24, s24, s19
    s_mul_i32 s25, s13, 10240
    s_add_u32 s25, s25, s22
    s_mov_b32 m0, s25
    s_nop 0
    buffer_load_dwordx4 v1, s[8:11], s24 offen offset:0 sc1 lds
    buffer_load_dwordx4 v1, s[8:11], s24 offen offset:1024 sc1 lds
    buffer_load_dwordx4 v1, s[8:11], s24 offen offset:2048 sc1 lds
    buffer_load_dwordx4 v1, s[8:11], s24 offen offset:3072 sc1 lds
    s_add_u32 s24, s24, 4096
    s_add_u32 s25, s25, 4096
    s_mov_b32 m0, s25
    s_nop 0
    buffer_load_dwordx4 v1, s[8:11], s24 offen offset:0 sc1 lds
    buffer_load_dwordx4 v1, s[8:11], s24 offen offset:1024 sc1 lds
    buffer_load_dwordx4 v1, s[8:11], s24 offen offset:2048 sc1 lds
    buffer_load_dwordx4 v1, s[8:11], s24 offen offset:3072 sc1 lds
    s_add_u32 s24, s24, 4096
    s_add_u32 s25, s25, 4096
    s_mov_b32 m0, s25
    s_nop 0
    buffer_load_dwordx4 v1, s[8:11], s24 offen offset:0 sc1 lds
    buffer_load_dwordx4 v1, s[8:11], s24 offen offset:1024 sc1 lds
    s_mov_b32 s22, 40960
    s_mov_b32 s16, 0
    s_waitcnt vmcnt(0)
    s_barrier
    v_mov_b32 v2, v1
    ds_read_b128 v[8:11], v2 offset:0
    ds_read_b128 v[12:15], v2 offset:1024
    ds_read_b128 v[16:19], v2 offset:2048
    ds_read_b128 v[20:23], v2 offset:3072
    ds_read_b128 v[24:27], v2 offset:4096
    ds_read_b128 v[28:31], v2 offset:5120
layerb1_kernel_gu_solo:
    ds_read_b128 v[32:35], v2 offset:6144
    s_waitcnt lgkmcnt(6)
    v_mfma_f32_32x32x16_bf16 v[40:55], v[8:11], a[0:3], 0
    v_mfma_f32_32x32x16_bf16 v[56:71], v[8:11], a[4:7], 0
    ds_read_b128 v[36:39], v2 offset:7168
    s_waitcnt lgkmcnt(6)
    v_mfma_f32_32x32x16_bf16 v[40:55], v[12:15], a[8:11], v[40:55]
    v_mfma_f32_32x32x16_bf16 v[56:71], v[12:15], a[12:15], v[56:71]
    ds_read_b128 v[8:11], v2 offset:8192
    s_waitcnt lgkmcnt(6)
    v_mfma_f32_32x32x16_bf16 v[40:55], v[16:19], a[16:19], v[40:55]
    v_mfma_f32_32x32x16_bf16 v[56:71], v[16:19], a[20:23], v[56:71]
    ds_read_b128 v[12:15], v2 offset:9216
    s_waitcnt lgkmcnt(6)
    v_mfma_f32_32x32x16_bf16 v[40:55], v[20:23], a[24:27], v[40:55]
    v_mfma_f32_32x32x16_bf16 v[56:71], v[20:23], a[28:31], v[56:71]
    ds_read_b128 v[16:19], v2 offset:10240
    s_waitcnt lgkmcnt(6)
    v_mfma_f32_32x32x16_bf16 v[40:55], v[24:27], a[32:35], v[40:55]
    v_mfma_f32_32x32x16_bf16 v[56:71], v[24:27], a[36:39], v[56:71]
    ds_read_b128 v[20:23], v2 offset:11264
    s_waitcnt lgkmcnt(6)
    v_mfma_f32_32x32x16_bf16 v[40:55], v[28:31], a[40:43], v[40:55]
    v_mfma_f32_32x32x16_bf16 v[56:71], v[28:31], a[44:47], v[56:71]
    ds_read_b128 v[24:27], v2 offset:12288
    s_waitcnt lgkmcnt(6)
    v_mfma_f32_32x32x16_bf16 v[40:55], v[32:35], a[48:51], v[40:55]
    v_mfma_f32_32x32x16_bf16 v[56:71], v[32:35], a[52:55], v[56:71]
    ds_read_b128 v[28:31], v2 offset:13312
    s_waitcnt lgkmcnt(6)
    v_mfma_f32_32x32x16_bf16 v[40:55], v[36:39], a[56:59], v[40:55]
    v_mfma_f32_32x32x16_bf16 v[56:71], v[36:39], a[60:63], v[56:71]
    ds_read_b128 v[32:35], v2 offset:14336
    s_waitcnt lgkmcnt(6)
    v_mfma_f32_32x32x16_bf16 v[40:55], v[8:11], a[64:67], v[40:55]
    v_mfma_f32_32x32x16_bf16 v[56:71], v[8:11], a[68:71], v[56:71]
    ds_read_b128 v[36:39], v2 offset:15360
    s_waitcnt lgkmcnt(6)
    v_mfma_f32_32x32x16_bf16 v[40:55], v[12:15], a[72:75], v[40:55]
    v_mfma_f32_32x32x16_bf16 v[56:71], v[12:15], a[76:79], v[56:71]
    ds_read_b128 v[8:11], v2 offset:16384
    s_waitcnt lgkmcnt(6)
    v_mfma_f32_32x32x16_bf16 v[40:55], v[16:19], a[80:83], v[40:55]
    v_mfma_f32_32x32x16_bf16 v[56:71], v[16:19], a[84:87], v[56:71]
    ds_read_b128 v[12:15], v2 offset:17408
    s_waitcnt lgkmcnt(6)
    v_mfma_f32_32x32x16_bf16 v[40:55], v[20:23], a[88:91], v[40:55]
    v_mfma_f32_32x32x16_bf16 v[56:71], v[20:23], a[92:95], v[56:71]
    ds_read_b128 v[16:19], v2 offset:18432
    s_waitcnt lgkmcnt(6)
    v_mfma_f32_32x32x16_bf16 v[40:55], v[24:27], a[96:99], v[40:55]
    v_mfma_f32_32x32x16_bf16 v[56:71], v[24:27], a[100:103], v[56:71]
    ds_read_b128 v[20:23], v2 offset:19456
    s_waitcnt lgkmcnt(6)
    v_mfma_f32_32x32x16_bf16 v[40:55], v[28:31], a[104:107], v[40:55]
    v_mfma_f32_32x32x16_bf16 v[56:71], v[28:31], a[108:111], v[56:71]
    ds_read_b128 v[24:27], v2 offset:20480
    s_waitcnt lgkmcnt(6)
    v_mfma_f32_32x32x16_bf16 v[40:55], v[32:35], a[112:115], v[40:55]
    v_mfma_f32_32x32x16_bf16 v[56:71], v[32:35], a[116:119], v[56:71]
    ds_read_b128 v[28:31], v2 offset:21504
    s_waitcnt lgkmcnt(6)
    v_mfma_f32_32x32x16_bf16 v[40:55], v[36:39], a[120:123], v[40:55]
    v_mfma_f32_32x32x16_bf16 v[56:71], v[36:39], a[124:127], v[56:71]
    ds_read_b128 v[32:35], v2 offset:22528
    s_waitcnt lgkmcnt(6)
    v_mfma_f32_32x32x16_bf16 v[40:55], v[8:11], a[128:131], v[40:55]
    v_mfma_f32_32x32x16_bf16 v[56:71], v[8:11], a[132:135], v[56:71]
    ds_read_b128 v[36:39], v2 offset:23552
    s_waitcnt lgkmcnt(6)
    v_mfma_f32_32x32x16_bf16 v[40:55], v[12:15], a[136:139], v[40:55]
    v_mfma_f32_32x32x16_bf16 v[56:71], v[12:15], a[140:143], v[56:71]
    ds_read_b128 v[8:11], v2 offset:24576
    s_waitcnt lgkmcnt(6)
    v_mfma_f32_32x32x16_bf16 v[40:55], v[16:19], a[144:147], v[40:55]
    v_mfma_f32_32x32x16_bf16 v[56:71], v[16:19], a[148:151], v[56:71]
    ds_read_b128 v[12:15], v2 offset:25600
    s_waitcnt lgkmcnt(6)
    v_mfma_f32_32x32x16_bf16 v[40:55], v[20:23], a[152:155], v[40:55]
    v_mfma_f32_32x32x16_bf16 v[56:71], v[20:23], a[156:159], v[56:71]
    ds_read_b128 v[16:19], v2 offset:26624
    s_waitcnt lgkmcnt(6)
    v_mfma_f32_32x32x16_bf16 v[40:55], v[24:27], a[160:163], v[40:55]
    v_mfma_f32_32x32x16_bf16 v[56:71], v[24:27], a[164:167], v[56:71]
    ds_read_b128 v[20:23], v2 offset:27648
    s_waitcnt lgkmcnt(6)
    v_mfma_f32_32x32x16_bf16 v[40:55], v[28:31], a[168:171], v[40:55]
    v_mfma_f32_32x32x16_bf16 v[56:71], v[28:31], a[172:175], v[56:71]
    ds_read_b128 v[24:27], v2 offset:28672
    s_waitcnt lgkmcnt(6)
    v_mfma_f32_32x32x16_bf16 v[40:55], v[32:35], a[176:179], v[40:55]
    v_mfma_f32_32x32x16_bf16 v[56:71], v[32:35], a[180:183], v[56:71]
    ds_read_b128 v[28:31], v2 offset:29696
    s_waitcnt lgkmcnt(6)
    v_mfma_f32_32x32x16_bf16 v[40:55], v[36:39], a[184:187], v[40:55]
    v_mfma_f32_32x32x16_bf16 v[56:71], v[36:39], a[188:191], v[56:71]
    ds_read_b128 v[32:35], v2 offset:30720
    s_waitcnt lgkmcnt(6)
    v_mfma_f32_32x32x16_bf16 v[40:55], v[8:11], a[192:195], v[40:55]
    v_mfma_f32_32x32x16_bf16 v[56:71], v[8:11], a[196:199], v[56:71]
    ds_read_b128 v[36:39], v2 offset:31744
    s_waitcnt lgkmcnt(6)
    v_mfma_f32_32x32x16_bf16 v[40:55], v[12:15], a[200:203], v[40:55]
    v_mfma_f32_32x32x16_bf16 v[56:71], v[12:15], a[204:207], v[56:71]
    ds_read_b128 v[8:11], v2 offset:32768
    s_waitcnt lgkmcnt(6)
    v_mfma_f32_32x32x16_bf16 v[40:55], v[16:19], a[208:211], v[40:55]
    v_mfma_f32_32x32x16_bf16 v[56:71], v[16:19], a[212:215], v[56:71]
    ds_read_b128 v[12:15], v2 offset:33792
    s_waitcnt lgkmcnt(6)
    v_mfma_f32_32x32x16_bf16 v[40:55], v[20:23], a[216:219], v[40:55]
    v_mfma_f32_32x32x16_bf16 v[56:71], v[20:23], a[220:223], v[56:71]
    ds_read_b128 v[16:19], v2 offset:34816
    s_waitcnt lgkmcnt(6)
    v_mfma_f32_32x32x16_bf16 v[40:55], v[24:27], a[224:227], v[40:55]
    v_mfma_f32_32x32x16_bf16 v[56:71], v[24:27], a[228:231], v[56:71]
    ds_read_b128 v[20:23], v2 offset:35840
    s_waitcnt lgkmcnt(6)
    v_mfma_f32_32x32x16_bf16 v[40:55], v[28:31], a[232:235], v[40:55]
    v_mfma_f32_32x32x16_bf16 v[56:71], v[28:31], a[236:239], v[56:71]
    ds_read_b128 v[24:27], v2 offset:36864
    s_waitcnt lgkmcnt(6)
    buffer_load_dwordx4 v[124:127], v1, s[8:11], s57 offen sc1
    v_mfma_f32_32x32x16_bf16 v[40:55], v[32:35], a[240:243], v[40:55]
    v_mfma_f32_32x32x16_bf16 v[56:71], v[32:35], a[244:247], v[56:71]
    ds_read_b128 v[28:31], v2 offset:37888
    s_waitcnt lgkmcnt(6)
    v_mfma_f32_32x32x16_bf16 v[40:55], v[36:39], a[248:251], v[40:55]
    v_mfma_f32_32x32x16_bf16 v[56:71], v[36:39], a[252:255], v[56:71]
    ds_read_b128 v[32:35], v2 offset:38912
    s_waitcnt lgkmcnt(6)
    v_mfma_f32_32x32x16_bf16 v[40:55], v[8:11], v[192:195], v[40:55]
    v_mfma_f32_32x32x16_bf16 v[56:71], v[8:11], v[196:199], v[56:71]
    ds_read_b128 v[36:39], v2 offset:39936
    s_waitcnt lgkmcnt(6)
    v_mfma_f32_32x32x16_bf16 v[40:55], v[12:15], v[200:203], v[40:55]
    v_mfma_f32_32x32x16_bf16 v[56:71], v[12:15], v[204:207], v[56:71]
    s_waitcnt lgkmcnt(5)
    v_mfma_f32_32x32x16_bf16 v[40:55], v[16:19], v[208:211], v[40:55]
    v_mfma_f32_32x32x16_bf16 v[56:71], v[16:19], v[212:215], v[56:71]
    s_waitcnt lgkmcnt(4)
    v_mfma_f32_32x32x16_bf16 v[40:55], v[20:23], v[216:219], v[40:55]
    v_mfma_f32_32x32x16_bf16 v[56:71], v[20:23], v[220:223], v[56:71]
    s_waitcnt lgkmcnt(3)
    v_mfma_f32_32x32x16_bf16 v[40:55], v[24:27], v[224:227], v[40:55]
    v_mfma_f32_32x32x16_bf16 v[56:71], v[24:27], v[228:231], v[56:71]
    s_waitcnt lgkmcnt(2)
    v_mfma_f32_32x32x16_bf16 v[40:55], v[28:31], v[232:235], v[40:55]
    v_mfma_f32_32x32x16_bf16 v[56:71], v[28:31], v[236:239], v[56:71]
    s_waitcnt lgkmcnt(1)
    v_mfma_f32_32x32x16_bf16 v[40:55], v[32:35], v[240:243], v[40:55]
    v_mfma_f32_32x32x16_bf16 v[56:71], v[32:35], v[244:247], v[56:71]
    s_waitcnt lgkmcnt(0)
    v_mfma_f32_32x32x16_bf16 v[40:55], v[36:39], v[248:251], v[40:55]
    v_mfma_f32_32x32x16_bf16 v[56:71], v[36:39], v[252:255], v[56:71]
    s_add_u32 s14, s14, 1
    s_nop 7
    s_nop 7
    v_cvt_pk_bf16_f32 v104, v40, v41
    v_cvt_pk_bf16_f32 v105, v42, v43
    v_cvt_pk_bf16_f32 v106, v44, v45
    v_cvt_pk_bf16_f32 v107, v46, v47
    s_nop 1
    v_permlane32_swap_b32 v104, v106
    v_permlane32_swap_b32 v105, v107
    buffer_store_dwordx4 v[104:107], v3, s[8:11], s17 offen offset:0 sc1
    v_cvt_pk_bf16_f32 v108, v48, v49
    v_cvt_pk_bf16_f32 v109, v50, v51
    v_cvt_pk_bf16_f32 v110, v52, v53
    v_cvt_pk_bf16_f32 v111, v54, v55
    s_nop 1
    v_permlane32_swap_b32 v108, v110
    v_permlane32_swap_b32 v109, v111
    buffer_store_dwordx4 v[108:111], v3, s[8:11], s17 offen offset:256 sc1
    v_cvt_pk_bf16_f32 v112, v56, v57
    v_cvt_pk_bf16_f32 v113, v58, v59
    v_cvt_pk_bf16_f32 v114, v60, v61
    v_cvt_pk_bf16_f32 v115, v62, v63
    s_nop 1
    v_permlane32_swap_b32 v112, v114
    v_permlane32_swap_b32 v113, v115
    buffer_store_dwordx4 v[112:115], v3, s[8:11], s17 offen offset:2560 sc1
    v_cvt_pk_bf16_f32 v116, v64, v65
    v_cvt_pk_bf16_f32 v117, v66, v67
    v_cvt_pk_bf16_f32 v118, v68, v69
    v_cvt_pk_bf16_f32 v119, v70, v71
    s_nop 1
    v_permlane32_swap_b32 v116, v118
    v_permlane32_swap_b32 v117, v119
    buffer_store_dwordx4 v[116:119], v3, s[8:11], s17 offen offset:2816 sc1
    s_add_u32 s17, s17, s20
    s_add_u32 s18, s18, s20
    s_waitcnt vmcnt(0)
    s_barrier
    s_cmp_lg_u32 s13, 0
    s_cbranch_scc1 layerb1_kernel_gu_fl2
    s_mov_b64 exec, 1
    s_lshl_b32 s26, s12, 7
    v_mov_b32 v7, s26
    v_mov_b32 v120, s14
    buffer_store_dword v120, v7, s[8:11], s48 offen sc1
    s_mov_b64 exec, -1
layerb1_kernel_gu_fl2:
layerb1_kernel_gu_spoll:
    v_min_u32 v124, v124, v125
    v_min_u32 v126, v126, v127
    v_min_u32 v124, v124, v126
    v_cmp_eq_u32 vcc, 0, v124
    s_nop 1
    s_ff1_i32_b64 s56, vcc
    s_min_u32 s56, s56, 64
    s_cmp_gt_u32 s56, s14
    s_cbranch_scc1 layerb1_kernel_gu_sok
    s_sub_u32 s58, s58, 1
    s_cbranch_scc1 layerb1_kernel_bail
    buffer_load_dwordx4 v[124:127], v1, s[8:11], s57 offen sc1
    s_waitcnt vmcnt(0)
    s_branch layerb1_kernel_gu_spoll
layerb1_kernel_gu_sok:
    s_min_u32 s24, s14, 63
    s_mul_i32 s24, s24, 40960
    s_add_u32 s24, s24, s19
    s_mul_i32 s25, s13, 10240
    s_add_u32 s25, s25, s22
    s_mov_b32 m0, s25
    s_nop 0
    buffer_load_dwordx4 v1, s[8:11], s24 offen offset:0 sc1 lds
    buffer_load_dwordx4 v1, s[8:11], s24 offen offset:1024 sc1 lds
    buffer_load_dwordx4 v1, s[8:11], s24 offen offset:2048 sc1 lds
    buffer_load_dwordx4 v1, s[8:11], s24 offen offset:3072 sc1 lds
    s_add_u32 s24, s24, 4096
    s_add_u32 s25, s25, 4096
    s_mov_b32 m0, s25
    s_nop 0
    buffer_load_dwordx4 v1, s[8:11], s24 offen offset:0 sc1 lds
    buffer_load_dwordx4 v1, s[8:11], s24 offen offset:1024 sc1 lds
    buffer_load_dwordx4 v1, s[8:11], s24 offen offset:2048 sc1 lds
    buffer_load_dwordx4 v1, s[8:11], s24 offen offset:3072 sc1 lds
    s_add_u32 s24, s24, 4096
    s_add_u32 s25, s25, 4096
    s_mov_b32 m0, s25
    s_nop 0
    buffer_load_dwordx4 v1, s[8:11], s24 offen offset:0 sc1 lds
    buffer_load_dwordx4 v1, s[8:11], s24 offen offset:1024 sc1 lds
    s_mov_b32 s16, s22
    s_add_u32 s22, s22, 40960
    s_cmp_eq_u32 s22, 122880
    s_cselect_b32 s22, 0, s22
    v_add_u32 v2, s16, v1
    s_waitcnt vmcnt(0)
    s_barrier
    ds_read_b128 v[8:11], v2 offset:0
    ds_read_b128 v[12:15], v2 offset:1024
    ds_read_b128 v[16:19], v2 offset:2048
    ds_read_b128 v[20:23], v2 offset:3072
    ds_read_b128 v[24:27], v2 offset:4096
    ds_read_b128 v[28:31], v2 offset:5120
    s_cmp_lt_u32 s14, 3
    s_cbranch_scc1 layerb1_kernel_gu_solo
    ds_read_b128 v[32:35], v2 offset:6144
    s_waitcnt lgkmcnt(6)
    v_mfma_f32_32x32x16_bf16 v[72:87], v[8:11], a[0:3], 0
    v_mfma_f32_32x32x16_bf16 v[88:103], v[8:11], a[4:7], 0
    ds_read_b128 v[36:39], v2 offset:7168
    s_waitcnt lgkmcnt(6)
    v_mfma_f32_32x32x16_bf16 v[72:87], v[12:15], a[8:11], v[72:87]
    v_mfma_f32_32x32x16_bf16 v[88:103], v[12:15], a[12:15], v[88:103]
    ds_read_b128 v[8:11], v2 offset:8192
    s_waitcnt lgkmcnt(6)
    v_mfma_f32_32x32x16_bf16 v[72:87], v[16:19], a[16:19], v[72:87]
    v_mfma_f32_32x32x16_bf16 v[88:103], v[16:19], a[20:23], v[88:103]
    s_add_u32 s23, s14, 1
    s_cmp_lg_u32 s13, 0
    s_cbranch_scc1 layerb1_kernel_gu_lw3
    s_min_u32 s28, s23, 63
    s_cmp_gt_u32 s56, s28
    s_cbranch_scc1 layerb1_kernel_gu_lw3
layerb1_kernel_gu_lp3:
    buffer_load_dwordx4 v[124:127], v1, s[8:11], s57 offen sc1
    s_waitcnt vmcnt(0)
    v_min_u32 v124, v124, v125
    v_min_u32 v126, v126, v127
    v_min_u32 v124, v124, v126
    v_cmp_eq_u32 vcc, 0, v124
    s_nop 1
    s_ff1_i32_b64 s56, vcc
    s_min_u32 s56, s56, 64
    s_sub_u32 s58, s58, 1
    s_cbranch_scc1 layerb1_kernel_bail
    s_cmp_gt_u32 s56, s28
    s_cbranch_scc0 layerb1_kernel_gu_lp3
layerb1_kernel_gu_lw3:
    s_barrier
    s_min_u32 s24, s23, 63
    s_mul_i32 s24, s24, 40960
    s_add_u32 s24, s24, s19
    s_mul_i32 s25, s13, 10240
    s_add_u32 s25, s25, s22
    s_add_u32 s22, s22, 40960
    s_cmp_eq_u32 s22, 122880
    s_cselect_b32 s22, 0, s22
    ds_read_b128 v[12:15], v2 offset:9216
    s_waitcnt lgkmcnt(6)
    v_mfma_f32_32x32x16_bf16 v[72:87], v[20:23], a[24:27], v[72:87]
    s_mov_b32 m0, s25
    s_nop 0
    buffer_load_dwordx4 v1, s[8:11], s24 offen offset:0 sc1 lds
    v_mfma_f32_32x32x16_bf16 v[88:103], v[20:23], a[28:31], v[88:103]
    ds_read_b128 v[16:19], v2 offset:10240
    s_waitcnt lgkmcnt(6)
    v_mfma_f32_32x32x16_bf16 v[72:87], v[24:27], a[32:35], v[72:87]
    buffer_load_dwordx4 v1, s[8:11], s24 offen offset:1024 sc1 lds
    v_mfma_f32_32x32x16_bf16 v[88:103], v[24:27], a[36:39], v[88:103]
    ds_read_b128 v[20:23], v2 offset:11264
    s_waitcnt lgkmcnt(6)
    v_mfma_f32_32x32x16_bf16 v[72:87], v[28:31], a[40:43], v[72:87]
    buffer_load_dwordx4 v1, s[8:11], s24 offen offset:2048 sc1 lds
    v_mfma_f32_32x32x16_bf16 v[88:103], v[28:31], a[44:47], v[88:103]
    ds_read_b128 v[24:27], v2 offset:12288
    s_waitcnt lgkmcnt(6)
    v_mfma_f32_32x32x16_bf16 v[72:87], v[32:35], a[48:51], v[72:87]
    buffer_load_dwordx4 v1, s[8:11], s24 offen offset:3072 sc1 lds
    v_mfma_f32_32x32x16_bf16 v[88:103], v[32:35], a[52:55], v[88:103]
    ds_read_b128 v[28:31], v2 offset:13312
    s_waitcnt lgkmcnt(6)
    v_mfma_f32_32x32x16_bf16 v[72:87], v[36:39], a[56:59], v[72:87]
    s_add_u32 s24, s24, 4096
    s_add_u32 s25, s25, 4096
    s_mov_b32 m0, s25
    s_nop 0
    buffer_load_dwordx4 v1, s[8:11], s24 offen offset:0 sc1 lds
    v_mfma_f32_32x32x16_bf16 v[88:103], v[36:39], a[60:63], v[88:103]
    ds_read_b128 v[32:35], v2 offset:14336
    s_waitcnt lgkmcnt(6)
    v_mfma_f32_32x32x16_bf16 v[72:87], v[8:11], a[64:67], v[72:87]
    buffer_load_dwordx4 v1, s[8:11], s24 offen offset:1024 sc1 lds
    v_mfma_f32_32x32x16_bf16 v[88:103], v[8:11], a[68:71], v[88:103]
    ds_read_b128 v[36:39], v2 offset:15360
    s_waitcnt lgkmcnt(6)
    v_mfma_f32_32x32x16_bf16 v[72:87], v[12:15], a[72:75], v[72:87]
    buffer_load_dwordx4 v1, s[8:11], s24 offen offset:2048 sc1 lds
    v_mfma_f32_32x32x16_bf16 v[88:103], v[12:15], a[76:79], v[88:103]
    ds_read_b128 v[8:11], v2 offset:16384
    s_waitcnt lgkmcnt(6)
    v_mfma_f32_32x32x16_bf16 v[72:87], v[16:19], a[80:83], v[72:87]
    buffer_load_dwordx4 v1, s[8:11], s24 offen offset:3072 sc1 lds
    v_mfma_f32_32x32x16_bf16 v[88:103], v[16:19], a[84:87], v[88:103]
    ds_read_b128 v[12:15], v2 offset:17408
    s_waitcnt lgkmcnt(6)
    v_mfma_f32_32x32x16_bf16 v[72:87], v[20:23], a[88:91], v[72:87]
    s_add_u32 s24, s24, 4096
    s_add_u32 s25, s25, 4096
    s_mov_b32 m0, s25
    s_nop 0
    buffer_load_dwordx4 v1, s[8:11], s24 offen offset:0 sc1 lds
    v_mfma_f32_32x32x16_bf16 v[88:103], v[20:23], a[92:95], v[88:103]
    ds_read_b128 v[16:19], v2 offset:18432
    s_waitcnt lgkmcnt(6)
    v_mfma_f32_32x32x16_bf16 v[72:87], v[24:27], a[96:99], v[72:87]
    buffer_load_dwordx4 v1, s[8:11], s24 offen offset:1024 sc1 lds
    v_mfma_f32_32x32x16_bf16 v[88:103], v[24:27], a[100:103], v[88:103]
    ds_read_b128 v[20:23], v2 offset:19456
    s_waitcnt lgkmcnt(6)
    v_mfma_f32_32x32x16_bf16 v[72:87], v[28:31], a[104:107], v[72:87]
    v_mfma_f32_32x32x16_bf16 v[88:103], v[28:31], a[108:111], v[88:103]
    ds_read_b128 v[24:27], v2 offset:20480
    s_waitcnt lgkmcnt(6)
    v_mfma_f32_32x32x16_bf16 v[72:87], v[32:35], a[112:115], v[72:87]
    v_mfma_f32_32x32x16_bf16 v[88:103], v[32:35], a[116:119], v[88:103]
    ds_read_b128 v[28:31], v2 offset:21504
    s_waitcnt lgkmcnt(6)
    v_mfma_f32_32x32x16_bf16 v[72:87], v[36:39], a[120:123], v[72:87]
    v_mfma_f32_32x32x16_bf16 v[88:103], v[36:39], a[124:127], v[88:103]
    ds_read_b128 v[32:35], v2 offset:22528
    s_waitcnt lgkmcnt(6)
    v_mfma_f32_32x32x16_bf16 v[72:87], v[8:11], a[128:131], v[72:87]
    v_mfma_f32_32x32x16_bf16 v[88:103], v[8:11], a[132:135], v[88:103]
    ds_read_b128 v[36:39], v2 offset:23552
    s_waitcnt lgkmcnt(6)
    v_mfma_f32_32x32x16_bf16 v[72:87], v[12:15], a[136:139], v[72:87]
    v_mfma_f32_32x32x16_bf16 v[88:103], v[12:15], a[140:143], v[88:103]
    ds_read_b128 v[8:11], v2 offset:24576
    s_waitcnt lgkmcnt(6)
    v_mfma_f32_32x32x16_bf16 v[72:87], v[16:19], a[144:147], v[72:87]
    v_mfma_f32_32x32x16_bf16 v[88:103], v[16:19], a[148:151], v[88:103]
    ds_read_b128 v[12:15], v2 offset:25600
    s_waitcnt lgkmcnt(6)
    v_mfma_f32_32x32x16_bf16 v[72:87], v[20:23], a[152:155], v[72:87]
    v_mfma_f32_32x32x16_bf16 v[88:103], v[20:23], a[156:159], v[88:103]
    ds_read_b128 v[16:19], v2 offset:26624
    s_waitcnt lgkmcnt(6)
    v_mfma_f32_32x32x16_bf16 v[72:87], v[24:27], a[160:163], v[72:87]
    v_mfma_f32_32x32x16_bf16 v[88:103], v[24:27], a[164:167], v[88:103]
    ds_read_b128 v[20:23], v2 offset:27648
    s_waitcnt lgkmcnt(6)
    v_mfma_f32_32x32x16_bf16 v[72:87], v[28:31], a[168:171], v[72:87]
    v_mfma_f32_32x32x16_bf16 v[88:103], v[28:31], a[172:175], v[88:103]
    ds_read_b128 v[24:27], v2 offset:28672
    s_waitcnt lgkmcnt(6)
    v_mfma_f32_32x32x16_bf16 v[72:87], v[32:35], a[176:179], v[72:87]
    v_mfma_f32_32x32x16_bf16 v[88:103], v[32:35], a[180:183], v[88:103]
    ds_read_b128 v[28:31], v2 offset:29696
    s_waitcnt lgkmcnt(6)
    v_mfma_f32_32x32x16_bf16 v[72:87], v[36:39], a[184:187], v[72:87]
    v_mfma_f32_32x32x16_bf16 v[88:103], v[36:39], a[188:191], v[88:103]
    ds_read_b128 v[32:35], v2 offset:30720
    s_waitcnt lgkmcnt(6)
    v_mfma_f32_32x32x16_bf16 v[72:87], v[8:11], a[192:195], v[72:87]
    v_mfma_f32_32x32x16_bf16 v[88:103], v[8:11], a[196:199], v[88:103]
    ds_read_b128 v[36:39], v2 offset:31744
    s_waitcnt lgkmcnt(6)
    v_mfma_f32_32x32x16_bf16 v[72:87], v[12:15], a[200:203], v[72:87]
    v_mfma_f32_32x32x16_bf16 v[88:103], v[12:15], a[204:207], v[88:103]
    ds_read_b128 v[8:11], v2 offset:32768
    s_waitcnt lgkmcnt(6)
    v_mfma_f32_32x32x16_bf16 v[72:87], v[16:19], a[208:211], v[72:87]
    v_mfma_f32_32x32x16_bf16 v[88:103], v[16:19], a[212:215], v[88:103]
    ds_read_b128 v[12:15], v2 offset:33792
    s_waitcnt lgkmcnt(6)
    v_mfma_f32_32x32x16_bf16 v[72:87], v[20:23], a[216:219], v[72:87]
    v_mfma_f32_32x32x16_bf16 v[88:103], v[20:23], a[220:223], v[88:103]
    ds_read_b128 v[16:19], v2 offset:34816
    s_waitcnt lgkmcnt(6)
    v_mfma_f32_32x32x16_bf16 v[72:87], v[24:27], a[224:227], v[72:87]
    v_mfma_f32_32x32x16_bf16 v[88:103], v[24:27], a[228:231], v[88:103]
    s_add_u32 s23, s14, 2
    s_cmp_lg_u32 s13, 0
    s_cbranch_scc1 layerb1_kernel_gu_lw4
    s_min_u32 s28, s23, 63
    s_cmp_gt_u32 s56, s28
    s_cbranch_scc1 layerb1_kernel_gu_lw4
layerb1_kernel_gu_lp4:
    buffer_load_dwordx4 v[124:127], v1, s[8:11], s57 offen sc1
    s_waitcnt vmcnt(0)
    v_min_u32 v124, v124, v125
    v_min_u32 v126, v126, v127
    v_min_u32 v124, v124, v126
    v_cmp_eq_u32 vcc, 0, v124
    s_nop 1
    s_ff1_i32_b64 s56, vcc
    s_min_u32 s56, s56, 64
    s_sub_u32 s58, s58, 1
    s_cbranch_scc1 layerb1_kernel_bail
    s_cmp_gt_u32 s56, s28
    s_cbranch_scc0 layerb1_kernel_gu_lp4
layerb1_kernel_gu_lw4:
    s_waitcnt vmcnt(0)
    s_barrier
    s_add_u32 s21, s16, 40960
    s_cmp_eq_u32 s21, 122880
    s_cselect_b32 s21, 0, s21
    s_add_u32 s23, s14, 2
    s_min_u32 s24, s23, 63
    s_mul_i32 s24, s24, 40960
    s_add_u32 s24, s24, s19
    s_mul_i32 s25, s13, 10240
    s_add_u32 s25, s25, s22
    s_add_u32 s22, s22, 40960
    s_cmp_eq_u32 s22, 122880
    s_cselect_b32 s22, 0, s22
    ds_read_b128 v[20:23], v2 offset:35840
    s_waitcnt lgkmcnt(6)
    v_mfma_f32_32x32x16_bf16 v[72:87], v[28:31], a[232:235], v[72:87]
    s_mov_b32 m0, s25
    s_nop 0
    buffer_load_dwordx4 v1, s[8:11], s24 offen offset:0 sc1 lds
    v_mfma_f32_32x32x16_bf16 v[88:103], v[28:31], a[236:239], v[88:103]
    ds_read_b128 v[24:27], v2 offset:36864
    s_waitcnt lgkmcnt(6)
    v_mfma_f32_32x32x16_bf16 v[72:87], v[32:35], a[240:243], v[72:87]
    buffer_load_dwordx4 v1, s[8:11], s24 offen offset:1024 sc1 lds
    v_mfma_f32_32x32x16_bf16 v[88:103], v[32:35], a[244:247], v[88:103]
    ds_read_b128 v[28:31], v2 offset:37888
    s_waitcnt lgkmcnt(6)
    v_mfma_f32_32x32x16_bf16 v[72:87], v[36:39], a[248:251], v[72:87]
    buffer_load_dwordx4 v1, s[8:11], s24 offen offset:2048 sc1 lds
    v_mfma_f32_32x32x16_bf16 v[88:103], v[36:39], a[252:255], v[88:103]
    ds_read_b128 v[32:35], v2 offset:38912
    s_waitcnt lgkmcnt(6)
    v_mfma_f32_32x32x16_bf16 v[72:87], v[8:11], v[192:195], v[72:87]
    buffer_load_dwordx4 v1, s[8:11], s24 offen offset:3072 sc1 lds
    v_mfma_f32_32x32x16_bf16 v[88:103], v[8:11], v[196:199], v[88:103]
    ds_read_b128 v[36:39], v2 offset:39936
    s_waitcnt lgkmcnt(6)
    v_mfma_f32_32x32x16_bf16 v[72:87], v[12:15], v[200:203], v[72:87]
    s_add_u32 s24, s24, 4096
    s_add_u32 s25, s25, 4096
    s_mov_b32 m0, s25
    s_nop 0
    buffer_load_dwordx4 v1, s[8:11], s24 offen offset:0 sc1 lds
    v_mfma_f32_32x32x16_bf16 v[88:103], v[12:15], v[204:207], v[88:103]
    v_add_u32 v6, s21, v1
    ds_read_b128 v[8:11], v6 offset:0
    s_waitcnt lgkmcnt(6)
    v_mfma_f32_32x32x16_bf16 v[72:87], v[16:19], v[208:211], v[72:87]
    buffer_load_dwordx4 v1, s[8:11], s24 offen offset:1024 sc1 lds
    v_mfma_f32_32x32x16_bf16 v[88:103], v[16:19], v[212:215], v[88:103]
    ds_read_b128 v[12:15], v6 offset:1024
    s_waitcnt lgkmcnt(6)
    v_mfma_f32_32x32x16_bf16 v[72:87], v[20:23], v[216:219], v[72:87]
    buffer_load_dwordx4 v1, s[8:11], s24 offen offset:2048 sc1 lds
    v_mfma_f32_32x32x16_bf16 v[88:103], v[20:23], v[220:223], v[88:103]
    ds_read_b128 v[16:19], v6 offset:2048
    s_waitcnt lgkmcnt(6)
    v_mfma_f32_32x32x16_bf16 v[72:87], v[24:27], v[224:227], v[72:87]
    buffer_load_dwordx4 v1, s[8:11], s24 offen offset:3072 sc1 lds
    v_mfma_f32_32x32x16_bf16 v[88:103], v[24:27], v[228:231], v[88:103]
    ds_read_b128 v[20:23], v6 offset:3072
    s_waitcnt lgkmcnt(6)
    v_mfma_f32_32x32x16_bf16 v[72:87], v[28:31], v[232:235], v[72:87]
    s_add_u32 s24, s24, 4096
    s_add_u32 s25, s25, 4096
    s_mov_b32 m0, s25
    s_nop 0
    buffer_load_dwordx4 v1, s[8:11], s24 offen offset:0 sc1 lds
    v_mfma_f32_32x32x16_bf16 v[88:103], v[28:31], v[236:239], v[88:103]
    ds_read_b128 v[24:27], v6 offset:4096
    s_waitcnt lgkmcnt(6)
    v_mfma_f32_32x32x16_bf16 v[72:87], v[32:35], v[240:243], v[72:87]
    buffer_load_dwordx4 v1, s[8:11], s24 offen offset:1024 sc1 lds
    v_mfma_f32_32x32x16_bf16 v[88:103], v[32:35], v[244:247], v[88:103]
    ds_read_b128 v[28:31], v6 offset:5120
    s_waitcnt lgkmcnt(6)
    v_mfma_f32_32x32x16_bf16 v[72:87], v[36:39], v[248:251], v[72:87]
    v_mfma_f32_32x32x16_bf16 v[88:103], v[36:39], v[252:255], v[88:103]
    v_mov_b32 v2, v6
    s_mov_b32 s16, s21
    s_add_u32 s14, s14, 1
layerb1_kernel_gu_loop:
    ds_read_b128 v[32:35], v2 offset:6144
    s_waitcnt lgkmcnt(6)
    v_mfma_f32_32x32x16_bf16 v[40:55], v[8:11], a[0:3], 0
    v_mfma_f32_32x32x16_bf16 v[56:71], v[8:11], a[4:7], 0
    ds_read_b128 v[36:39], v2 offset:7168
    s_waitcnt lgkmcnt(6)
    v_mfma_f32_32x32x16_bf16 v[40:55], v[12:15], a[8:11], v[40:55]
    v_mfma_f32_32x32x16_bf16 v[56:71], v[12:15], a[12:15], v[56:71]
    ds_read_b128 v[8:11], v2 offset:8192
    s_waitcnt lgkmcnt(6)
    v_mfma_f32_32x32x16_bf16 v[40:55], v[16:19], a[16:19], v[40:55]
    v_cvt_pk_bf16_f32 v104, v72, v73
    v_mfma_f32_32x32x16_bf16 v[56:71], v[16:19], a[20:23], v[56:71]
    v_cvt_pk_bf16_f32 v105, v74, v75
    ds_read_b128 v[12:15], v2 offset:9216
    s_waitcnt lgkmcnt(6)
    v_mfma_f32_32x32x16_bf16 v[40:55], v[20:23], a[24:27], v[40:55]
    v_cvt_pk_bf16_f32 v106, v76, v77
    v_mfma_f32_32x32x16_bf16 v[56:71], v[20:23], a[28:31], v[56:71]
    v_cvt_pk_bf16_f32 v107, v78, v79
    ds_read_b128 v[16:19], v2 offset:10240
    s_waitcnt lgkmcnt(6)
    v_mfma_f32_32x32x16_bf16 v[40:55], v[24:27], a[32:35], v[40:55]
    s_nop 1
    v_mfma_f32_32x32x16_bf16 v[56:71], v[24:27], a[36:39], v[56:71]
    v_permlane32_swap_b32 v104, v106
    ds_read_b128 v[20:23], v2 offset:11264
    s_waitcnt lgkmcnt(6)
    v_mfma_f32_32x32x16_bf16 v[40:55], v[28:31], a[40:43], v[40:55]
    v_permlane32_swap_b32 v105, v107
    v_mfma_f32_32x32x16_bf16 v[56:71], v[28:31], a[44:47], v[56:71]
    buffer_store_dwordx4 v[104:107], v3, s[8:11], s17 offen offset:0 sc1
    ds_read_b128 v[24:27], v2 offset:12288
    s_waitcnt lgkmcnt(6)
    v_mfma_f32_32x32x16_bf16 v[40:55], v[32:35], a[48:51], v[40:55]
    v_cvt_pk_bf16_f32 v108, v80, v81
    v_mfma_f32_32x32x16_bf16 v[56:71], v[32:35], a[52:55], v[56:71]
    v_cvt_pk_bf16_f32 v109, v82, v83
    ds_read_b128 v[28:31], v2 offset:13312
    s_waitcnt lgkmcnt(6)
    v_mfma_f32_32x32x16_bf16 v[40:55], v[36:39], a[56:59], v[40:55]
    v_cvt_pk_bf16_f32 v110, v84, v85
    v_mfma_f32_32x32x16_bf16 v[56:71], v[36:39], a[60:63], v[56:71]
    v_cvt_pk_bf16_f32 v111, v86, v87
    ds_read_b128 v[32:35], v2 offset:14336
    s_waitcnt lgkmcnt(6)
    v_mfma_f32_32x32x16_bf16 v[40:55], v[8:11], a[64:67], v[40:55]
    s_nop 1
    v_mfma_f32_32x32x16_bf16 v[56:71], v[8:11], a[68:71], v[56:71]
    v_permlane32_swap_b32 v108, v110
    ds_read_b128 v[36:39], v2 offset:15360
    s_waitcnt lgkmcnt(6)
    v_mfma_f32_32x32x16_bf16 v[40:55], v[12:15], a[72:75], v[40:55]
    v_permlane32_swap_b32 v109, v111
    v_mfma_f32_32x32x16_bf16 v[56:71], v[12:15], a[76:79], v[56:71]
    buffer_store_dwordx4 v[108:111], v3, s[8:11], s17 offen offset:256 sc1
    ds_read_b128 v[8:11], v2 offset:16384
    s_waitcnt lgkmcnt(6)
    v_mfma_f32_32x32x16_bf16 v[40:55], v[16:19], a[80:83], v[40:55]
    v_cvt_pk_bf16_f32 v112, v88, v89
    v_mfma_f32_32x32x16_bf16 v[56:71], v[16:19], a[84:87], v[56:71]
    v_cvt_pk_bf16_f32 v113, v90, v91
    ds_read_b128 v[12:15], v2 offset:17408
    s_waitcnt lgkmcnt(6)
    v_mfma_f32_32x32x16_bf16 v[40:55], v[20:23], a[88:91], v[40:55]
    v_cvt_pk_bf16_f32 v114, v92, v93
    v_mfma_f32_32x32x16_bf16 v[56:71], v[20:23], a[92:95], v[56:71]
    v_cvt_pk_bf16_f32 v115, v94, v95
    ds_read_b128 v[16:19], v2 offset:18432
    s_waitcnt lgkmcnt(6)
    v_mfma_f32_32x32x16_bf16 v[40:55], v[24:27], a[96:99], v[40:55]
    s_nop 1
    v_mfma_f32_32x32x16_bf16 v[56:71], v[24:27], a[100:103], v[56:71]
    v_permlane32_swap_b32 v112, v114
    ds_read_b128 v[20:23], v2 offset:19456
    s_waitcnt lgkmcnt(6)
    v_mfma_f32_32x32x16_bf16 v[40:55], v[28:31], a[104:107], v[40:55]
    v_permlane32_swap_b32 v113, v115
    v_mfma_f32_32x32x16_bf16 v[56:71], v[28:31], a[108:111], v[56:71]
    buffer_store_dwordx4 v[112:115], v3, s[8:11], s17 offen offset:2560 sc1
    ds_read_b128 v[24:27], v2 offset:20480
    s_waitcnt lgkmcnt(6)
    v_mfma_f32_32x32x16_bf16 v[40:55], v[32:35], a[112:115], v[40:55]
    v_cvt_pk_bf16_f32 v116, v96, v97
    v_mfma_f32_32x32x16_bf16 v[56:71], v[32:35], a[116:119], v[56:71]
    v_cvt_pk_bf16_f32 v117, v98, v99
    ds_read_b128 v[28:31], v2 offset:21504
    s_waitcnt lgkmcnt(6)
    v_mfma_f32_32x32x16_bf16 v[40:55], v[36:39], a[120:123], v[40:55]
    v_cvt_pk_bf16_f32 v118, v100, v101
    v_mfma_f32_32x32x16_bf16 v[56:71], v[36:39], a[124:127], v[56:71]
    v_cvt_pk_bf16_f32 v119, v102, v103
    ds_read_b128 v[32:35], v2 offset:22528
    s_waitcnt lgkmcnt(6)
    v_mfma_f32_32x32x16_bf16 v[40:55], v[8:11], a[128:131], v[40:55]
    s_nop 1
    v_mfma_f32_32x32x16_bf16 v[56:71], v[8:11], a[132:135], v[56:71]
    v_permlane32_swap_b32 v116, v118
    ds_read_b128 v[36:39], v2 offset:23552
    s_waitcnt lgkmcnt(6)
    v_mfma_f32_32x32x16_bf16 v[40:55], v[12:15], a[136:139], v[40:55]
    v_permlane32_swap_b32 v117, v119
    v_mfma_f32_32x32x16_bf16 v[56:71], v[12:15], a[140:143], v[56:71]
    buffer_store_dwordx4 v[116:119], v3, s[8:11], s17 offen offset:2816 sc1
    ds_read_b128 v[8:11], v2 offset:24576
    s_waitcnt lgkmcnt(6)
    v_mfma_f32_32x32x16_bf16 v[40:55], v[16:19], a[144:147], v[40:55]
    s_add_u32 s17, s17, s20
    v_mfma_f32_32x32x16_bf16 v[56:71], v[16:19], a[148:151], v[56:71]
    s_add_u32 s18, s18, s20
    ds_read_b128 v[12:15], v2 offset:25600
    s_waitcnt lgkmcnt(6)
    v_mfma_f32_32x32x16_bf16 v[40:55], v[20:23], a[152:155], v[40:55]
    v_mfma_f32_32x32x16_bf16 v[56:71], v[20:23], a[156:159], v[56:71]
    ds_read_b128 v[16:19], v2 offset:26624
    s_waitcnt lgkmcnt(6)
    v_mfma_f32_32x32x16_bf16 v[40:55], v[24:27], a[160:163], v[40:55]
    v_mfma_f32_32x32x16_bf16 v[56:71], v[24:27], a[164:167], v[56:71]
    ds_read_b128 v[20:23], v2 offset:27648
    s_waitcnt lgkmcnt(6)
    v_mfma_f32_32x32x16_bf16 v[40:55], v[28:31], a[168:171], v[40:55]
    v_mfma_f32_32x32x16_bf16 v[56:71], v[28:31], a[172:175], v[56:71]
    ds_read_b128 v[24:27], v2 offset:28672
    s_waitcnt lgkmcnt(6)
    v_mfma_f32_32x32x16_bf16 v[40:55], v[32:35], a[176:179], v[40:55]
    v_mfma_f32_32x32x16_bf16 v[56:71], v[32:35], a[180:183], v[56:71]
    ds_read_b128 v[28:31], v2 offset:29696
    s_waitcnt lgkmcnt(6)
    v_mfma_f32_32x32x16_bf16 v[40:55], v[36:39], a[184:187], v[40:55]
    v_mfma_f32_32x32x16_bf16 v[56:71], v[36:39], a[188:191], v[56:71]
    ds_read_b128 v[32:35], v2 offset:30720
    s_waitcnt lgkmcnt(6)
    v_mfma_f32_32x32x16_bf16 v[40:55], v[8:11], a[192:195], v[40:55]
    v_mfma_f32_32x32x16_bf16 v[56:71], v[8:11], a[196:199], v[56:71]
    ds_read_b128 v[36:39], v2 offset:31744
    s_waitcnt lgkmcnt(6)
    v_mfma_f32_32x32x16_bf16 v[40:55], v[12:15], a[200:203], v[40:55]
    v_mfma_f32_32x32x16_bf16 v[56:71], v[12:15], a[204:207], v[56:71]
    ds_read_b128 v[8:11], v2 offset:32768
    s_waitcnt lgkmcnt(6)
    v_mfma_f32_32x32x16_bf16 v[40:55], v[16:19], a[208:211], v[40:55]
    v_mfma_f32_32x32x16_bf16 v[56:71], v[16:19], a[212:215], v[56:71]
    ds_read_b128 v[12:15], v2 offset:33792
    s_waitcnt lgkmcnt(6)
    v_mfma_f32_32x32x16_bf16 v[40:55], v[20:23], a[216:219], v[40:55]
    v_mfma_f32_32x32x16_bf16 v[56:71], v[20:23], a[220:223], v[56:71]
    ds_read_b128 v[16:19], v2 offset:34816
    s_waitcnt lgkmcnt(6)
    v_mfma_f32_32x32x16_bf16 v[40:55], v[24:27], a[224:227], v[40:55]
    v_mfma_f32_32x32x16_bf16 v[56:71], v[24:27], a[228:231], v[56:71]
    s_add_u32 s23, s14, 2
    s_cmp_lg_u32 s13, 0
    s_cbranch_scc1 layerb1_kernel_gu_lw5
    s_min_u32 s28, s23, 63
    s_cmp_gt_u32 s56, s28
    s_cbranch_scc1 layerb1_kernel_gu_lw5
layerb1_kernel_gu_lp5:
    buffer_load_dwordx4 v[124:127], v1, s[8:11], s57 offen sc1
    s_waitcnt vmcnt(0)
    v_min_u32 v124, v124, v125
    v_min_u32 v126, v126, v127
    v_min_u32 v124, v124, v126
    v_cmp_eq_u32 vcc, 0, v124
    s_nop 1
    s_ff1_i32_b64 s56, vcc
    s_min_u32 s56, s56, 64
    s_sub_u32 s58, s58, 1
    s_cbranch_scc1 layerb1_kernel_bail
    s_cmp_gt_u32 s56, s28
    s_cbranch_scc0 layerb1_kernel_gu_lp5
layerb1_kernel_gu_lw5:
    s_cmp_gt_u32 s14, 5
    s_cbranch_scc1 layerb1_kernel_gu_dr6
    s_waitcnt vmcnt(0)
    s_mov_b32 s27, s14
    s_branch layerb1_kernel_gu_dq6
layerb1_kernel_gu_dr6:
    s_waitcnt vmcnt(4)
    s_sub_u32 s27, s14, 1
layerb1_kernel_gu_dq6:
    s_barrier
    s_cmp_lg_u32 s13, 0
    s_cbranch_scc1 layerb1_kernel_gu_fl7
    s_mov_b64 exec, 1
    s_lshl_b32 s26, s12, 7
    v_mov_b32 v7, s26
    v_mov_b32 v120, s27
    buffer_store_dword v120, v7, s[8:11], s48 offen sc1
    s_mov_b64 exec, -1
layerb1_kernel_gu_fl7:
    s_add_u32 s21, s16, 40960
    s_cmp_eq_u32 s21, 122880
    s_cselect_b32 s21, 0, s21
    s_add_u32 s23, s14, 2
    s_min_u32 s24, s23, 63
    s_mul_i32 s24, s24, 40960
    s_add_u32 s24, s24, s19
    s_mul_i32 s25, s13, 10240
    s_add_u32 s25, s25, s22
    s_add_u32 s22, s22, 40960
    s_cmp_eq_u32 s22, 122880
    s_cselect_b32 s22, 0, s22
    ds_read_b128 v[20:23], v2 offset:35840
    s_waitcnt lgkmcnt(6)
    v_mfma_f32_32x32x16_bf16 v[40:55], v[28:31], a[232:235], v[40:55]
    s_mov_b32 m0, s25
    s_nop 0
    buffer_load_dwordx4 v1, s[8:11], s24 offen offset:0 sc1 lds
    v_mfma_f32_32x32x16_bf16 v[56:71], v[28:31], a[236:239], v[56:71]
    ds_read_b128 v[24:27], v2 offset:36864
    s_waitcnt lgkmcnt(6)
    v_mfma_f32_32x32x16_bf16 v[40:55], v[32:35], a[240:243], v[40:55]
    buffer_load_dwordx4 v1, s[8:11], s24 offen offset:1024 sc1 lds
    v_mfma_f32_32x32x16_bf16 v[56:71], v[32:35], a[244:247], v[56:71]
    ds_read_b128 v[28:31], v2 offset:37888
    s_waitcnt lgkmcnt(6)
    v_mfma_f32_32x32x16_bf16 v[40:55], v[36:39], a[248:251], v[40:55]
    buffer_load_dwordx4 v1, s[8:11], s24 offen offset:2048 sc1 lds
    v_mfma_f32_32x32x16_bf16 v[56:71], v[36:39], a[252:255], v[56:71]
    ds_read_b128 v[32:35], v2 offset:38912
    s_waitcnt lgkmcnt(6)
    v_mfma_f32_32x32x16_bf16 v[40:55], v[8:11], v[192:195], v[40:55]
    buffer_load_dwordx4 v1, s[8:11], s24 offen offset:3072 sc1 lds
    v_mfma_f32_32x32x16_bf16 v[56:71], v[8:11], v[196:199], v[56:71]
    ds_read_b128 v[36:39], v2 offset:39936
    s_waitcnt lgkmcnt(6)
    v_mfma_f32_32x32x16_bf16 v[40:55], v[12:15], v[200:203], v[40:55]
    s_add_u32 s24, s24, 4096
    s_add_u32 s25, s25, 4096
    s_mov_b32 m0, s25
    s_nop 0
    buffer_load_dwordx4 v1, s[8:11], s24 offen offset:0 sc1 lds
    v_mfma_f32_32x32x16_bf16 v[56:71], v[12:15], v[204:207], v[56:71]
    v_add_u32 v6, s21, v1
    ds_read_b128 v[8:11], v6 offset:0
    s_waitcnt lgkmcnt(6)
    v_mfma_f32_32x32x16_bf16 v[40:55], v[16:19], v[208:211], v[40:55]
    buffer_load_dwordx4 v1, s[8:11], s24 offen offset:1024 sc1 lds
    v_mfma_f32_32x32x16_bf16 v[56:71], v[16:19], v[212:215], v[56:71]
    ds_read_b128 v[12:15], v6 offset:1024
    s_waitcnt lgkmcnt(6)
    v_mfma_f32_32x32x16_bf16 v[40:55], v[20:23], v[216:219], v[40:55]
    buffer_load_dwordx4 v1, s[8:11], s24 offen offset:2048 sc1 lds
    v_mfma_f32_32x32x16_bf16 v[56:71], v[20:23], v[220:223], v[56:71]
    ds_read_b128 v[16:19], v6 offset:2048
    s_waitcnt lgkmcnt(6)
    v_mfma_f32_32x32x16_bf16 v[40:55], v[24:27], v[224:227], v[40:55]
    buffer_load_dwordx4 v1, s[8:11], s24 offen offset:3072 sc1 lds
    v_mfma_f32_32x32x16_bf16 v[56:71], v[24:27], v[228:231], v[56:71]
    ds_read_b128 v[20:23], v6 offset:3072
    s_waitcnt lgkmcnt(6)
    v_mfma_f32_32x32x16_bf16 v[40:55], v[28:31], v[232:235], v[40:55]
    s_add_u32 s24, s24, 4096
    s_add_u32 s25, s25, 4096
    s_mov_b32 m0, s25
    s_nop 0
    buffer_load_dwordx4 v1, s[8:11], s24 offen offset:0 sc1 lds
    v_mfma_f32_32x32x16_bf16 v[56:71], v[28:31], v[236:239], v[56:71]
    ds_read_b128 v[24:27], v6 offset:4096
    s_waitcnt lgkmcnt(6)
    v_mfma_f32_32x32x16_bf16 v[40:55], v[32:35], v[240:243], v[40:55]
    buffer_load_dwordx4 v1, s[8:11], s24 offen offset:1024 sc1 lds
    v_mfma_f32_32x32x16_bf16 v[56:71], v[32:35], v[244:247], v[56:71]
    ds_read_b128 v[28:31], v6 offset:5120
    s_waitcnt lgkmcnt(6)
    v_mfma_f32_32x32x16_bf16 v[40:55], v[36:39], v[248:251], v[40:55]
    v_mfma_f32_32x32x16_bf16 v[56:71], v[36:39], v[252:255], v[56:71]
    v_mov_b32 v2, v6
    s_mov_b32 s16, s21
    s_add_u32 s14, s14, 1
    s_cmp_ge_u32 s14, s15
    s_cbranch_scc1 layerb1_kernel_gu_fin0
    ds_read_b128 v[32:35], v2 offset:6144
    s_waitcnt lgkmcnt(6)
    v_mfma_f32_32x32x16_bf16 v[72:87], v[8:11], a[0:3], 0
    v_mfma_f32_32x32x16_bf16 v[88:103], v[8:11], a[4:7], 0
    ds_read_b128 v[36:39], v2 offset:7168
    s_waitcnt lgkmcnt(6)
    v_mfma_f32_32x32x16_bf16 v[72:87], v[12:15], a[8:11], v[72:87]
    v_mfma_f32_32x32x16_bf16 v[88:103], v[12:15], a[12:15], v[88:103]
    ds_read_b128 v[8:11], v2 offset:8192
    s_waitcnt lgkmcnt(6)
    v_mfma_f32_32x32x16_bf16 v[72:87], v[16:19], a[16:19], v[72:87]
    v_cvt_pk_bf16_f32 v104, v40, v41
    v_mfma_f32_32x32x16_bf16 v[88:103], v[16:19], a[20:23], v[88:103]
    v_cvt_pk_bf16_f32 v105, v42, v43
    ds_read_b128 v[12:15], v2 offset:9216
    s_waitcnt lgkmcnt(6)
    v_mfma_f32_32x32x16_bf16 v[72:87], v[20:23], a[24:27], v[72:87]
    v_cvt_pk_bf16_f32 v106, v44, v45
    v_mfma_f32_32x32x16_bf16 v[88:103], v[20:23], a[28:31], v[88:103]
    v_cvt_pk_bf16_f32 v107, v46, v47
    ds_read_b128 v[16:19], v2 offset:10240
    s_waitcnt lgkmcnt(6)
    v_mfma_f32_32x32x16_bf16 v[72:87], v[24:27], a[32:35], v[72:87]
    s_nop 1
    v_mfma_f32_32x32x16_bf16 v[88:103], v[24:27], a[36:39], v[88:103]
    v_permlane32_swap_b32 v104, v106
    ds_read_b128 v[20:23], v2 offset:11264
    s_waitcnt lgkmcnt(6)
    v_mfma_f32_32x32x16_bf16 v[72:87], v[28:31], a[40:43], v[72:87]
    v_permlane32_swap_b32 v105, v107
    v_mfma_f32_32x32x16_bf16 v[88:103], v[28:31], a[44:47], v[88:103]
    buffer_store_dwordx4 v[104:107], v3, s[8:11], s17 offen offset:0 sc1
    ds_read_b128 v[24:27], v2 offset:12288
    s_waitcnt lgkmcnt(6)
    v_mfma_f32_32x32x16_bf16 v[72:87], v[32:35], a[48:51], v[72:87]
    v_cvt_pk_bf16_f32 v108, v48, v49
    v_mfma_f32_32x32x16_bf16 v[88:103], v[32:35], a[52:55], v[88:103]
    v_cvt_pk_bf16_f32 v109, v50, v51
    ds_read_b128 v[28:31], v2 offset:13312
    s_waitcnt lgkmcnt(6)
    v_mfma_f32_32x32x16_bf16 v[72:87], v[36:39], a[56:59], v[72:87]
    v_cvt_pk_bf16_f32 v110, v52, v53
    v_mfma_f32_32x32x16_bf16 v[88:103], v[36:39], a[60:63], v[88:103]
    v_cvt_pk_bf16_f32 v111, v54, v55
    ds_read_b128 v[32:35], v2 offset:14336
    s_waitcnt lgkmcnt(6)
    v_mfma_f32_32x32x16_bf16 v[72:87], v[8:11], a[64:67], v[72:87]
    s_nop 1
    v_mfma_f32_32x32x16_bf16 v[88:103], v[8:11], a[68:71], v[88:103]
    v_permlane32_swap_b32 v108, v110
    ds_read_b128 v[36:39], v2 offset:15360
    s_waitcnt lgkmcnt(6)
    v_mfma_f32_32x32x16_bf16 v[72:87], v[12:15], a[72:75], v[72:87]
    v_permlane32_swap_b32 v109, v111
    v_mfma_f32_32x32x16_bf16 v[88:103], v[12:15], a[76:79], v[88:103]
    buffer_store_dwordx4 v[108:111], v3, s[8:11], s17 offen offset:256 sc1
    ds_read_b128 v[8:11], v2 offset:16384
    s_waitcnt lgkmcnt(6)
    v_mfma_f32_32x32x16_bf16 v[72:87], v[16:19], a[80:83], v[72:87]
    v_cvt_pk_bf16_f32 v112, v56, v57
    v_mfma_f32_32x32x16_bf16 v[88:103], v[16:19], a[84:87], v[88:103]
    v_cvt_pk_bf16_f32 v113, v58, v59
    ds_read_b128 v[12:15], v2 offset:17408
    s_waitcnt lgkmcnt(6)
    v_mfma_f32_32x32x16_bf16 v[72:87], v[20:23], a[88:91], v[72:87]
    v_cvt_pk_bf16_f32 v114, v60, v61
    v_mfma_f32_32x32x16_bf16 v[88:103], v[20:23], a[92:95], v[88:103]
    v_cvt_pk_bf16_f32 v115, v62, v63
    ds_read_b128 v[16:19], v2 offset:18432
    s_waitcnt lgkmcnt(6)
    v_mfma_f32_32x32x16_bf16 v[72:87], v[24:27], a[96:99], v[72:87]
    s_nop 1
    v_mfma_f32_32x32x16_bf16 v[88:103], v[24:27], a[100:103], v[88:103]
    v_permlane32_swap_b32 v112, v114
    ds_read_b128 v[20:23], v2 offset:19456
    s_waitcnt lgkmcnt(6)
    v_mfma_f32_32x32x16_bf16 v[72:87], v[28:31], a[104:107], v[72:87]
    v_permlane32_swap_b32 v113, v115
    v_mfma_f32_32x32x16_bf16 v[88:103], v[28:31], a[108:111], v[88:103]
    buffer_store_dwordx4 v[112:115], v3, s[8:11], s17 offen offset:2560 sc1
    ds_read_b128 v[24:27], v2 offset:20480
    s_waitcnt lgkmcnt(6)
    v_mfma_f32_32x32x16_bf16 v[72:87], v[32:35], a[112:115], v[72:87]
    v_cvt_pk_bf16_f32 v116, v64, v65
    v_mfma_f32_32x32x16_bf16 v[88:103], v[32:35], a[116:119], v[88:103]
    v_cvt_pk_bf16_f32 v117, v66, v67
    ds_read_b128 v[28:31], v2 offset:21504
    s_waitcnt lgkmcnt(6)
    v_mfma_f32_32x32x16_bf16 v[72:87], v[36:39], a[120:123], v[72:87]
    v_cvt_pk_bf16_f32 v118, v68, v69
    v_mfma_f32_32x32x16_bf16 v[88:103], v[36:39], a[124:127], v[88:103]
    v_cvt_pk_bf16_f32 v119, v70, v71
    ds_read_b128 v[32:35], v2 offset:22528
    s_waitcnt lgkmcnt(6)
    v_mfma_f32_32x32x16_bf16 v[72:87], v[8:11], a[128:131], v[72:87]
    s_nop 1
    v_mfma_f32_32x32x16_bf16 v[88:103], v[8:11], a[132:135], v[88:103]
    v_permlane32_swap_b32 v116, v118
    ds_read_b128 v[36:39], v2 offset:23552
    s_waitcnt lgkmcnt(6)
    v_mfma_f32_32x32x16_bf16 v[72:87], v[12:15], a[136:139], v[72:87]
    v_permlane32_swap_b32 v117, v119
    v_mfma_f32_32x32x16_bf16 v[88:103], v[12:15], a[140:143], v[88:103]
    buffer_store_dwordx4 v[116:119], v3, s[8:11], s17 offen offset:2816 sc1
    ds_read_b128 v[8:11], v2 offset:24576
    s_waitcnt lgkmcnt(6)
    v_mfma_f32_32x32x16_bf16 v[72:87], v[16:19], a[144:147], v[72:87]
    s_add_u32 s17, s17, s20
    v_mfma_f32_32x32x16_bf16 v[88:103], v[16:19], a[148:151], v[88:103]
    s_add_u32 s18, s18, s20
    ds_read_b128 v[12:15], v2 offset:25600
    s_waitcnt lgkmcnt(6)
    v_mfma_f32_32x32x16_bf16 v[72:87], v[20:23], a[152:155], v[72:87]
    v_mfma_f32_32x32x16_bf16 v[88:103], v[20:23], a[156:159], v[88:103]
    ds_read_b128 v[16:19], v2 offset:26624
    s_waitcnt lgkmcnt(6)
    v_mfma_f32_32x32x16_bf16 v[72:87], v[24:27], a[160:163], v[72:87]
    v_mfma_f32_32x32x16_bf16 v[88:103], v[24:27], a[164:167], v[88:103]
    ds_read_b128 v[20:23], v2 offset:27648
    s_waitcnt lgkmcnt(6)
    v_mfma_f32_32x32x16_bf16 v[72:87], v[28:31], a[168:171], v[72:87]
    v_mfma_f32_32x32x16_bf16 v[88:103], v[28:31], a[172:175], v[88:103]
    ds_read_b128 v[24:27], v2 offset:28672
    s_waitcnt lgkmcnt(6)
    v_mfma_f32_32x32x16_bf16 v[72:87], v[32:35], a[176:179], v[72:87]
    v_mfma_f32_32x32x16_bf16 v[88:103], v[32:35], a[180:183], v[88:103]
    ds_read_b128 v[28:31], v2 offset:29696
    s_waitcnt lgkmcnt(6)
    v_mfma_f32_32x32x16_bf16 v[72:87], v[36:39], a[184:187], v[72:87]
    v_mfma_f32_32x32x16_bf16 v[88:103], v[36:39], a[188:191], v[88:103]
    ds_read_b128 v[32:35], v2 offset:30720
    s_waitcnt lgkmcnt(6)
    v_mfma_f32_32x32x16_bf16 v[72:87], v[8:11], a[192:195], v[72:87]
    v_mfma_f32_32x32x16_bf16 v[88:103], v[8:11], a[196:199], v[88:103]
    ds_read_b128 v[36:39], v2 offset:31744
    s_waitcnt lgkmcnt(6)
    v_mfma_f32_32x32x16_bf16 v[72:87], v[12:15], a[200:203], v[72:87]
    v_mfma_f32_32x32x16_bf16 v[88:103], v[12:15], a[204:207], v[88:103]
    ds_read_b128 v[8:11], v2 offset:32768
    s_waitcnt lgkmcnt(6)
    v_mfma_f32_32x32x16_bf16 v[72:87], v[16:19], a[208:211], v[72:87]
    v_mfma_f32_32x32x16_bf16 v[88:103], v[16:19], a[212:215], v[88:103]
    ds_read_b128 v[12:15], v2 offset:33792
    s_waitcnt lgkmcnt(6)
    v_mfma_f32_32x32x16_bf16 v[72:87], v[20:23], a[216:219], v[72:87]
    v_mfma_f32_32x32x16_bf16 v[88:103], v[20:23], a[220:223], v[88:103]
    ds_read_b128 v[16:19], v2 offset:34816
    s_waitcnt lgkmcnt(6)
    v_mfma_f32_32x32x16_bf16 v[72:87], v[24:27], a[224:227], v[72:87]
    v_mfma_f32_32x32x16_bf16 v[88:103], v[24:27], a[228:231], v[88:103]
    s_add_u32 s23, s14, 2
    s_cmp_lg_u32 s13, 0
    s_cbranch_scc1 layerb1_kernel_gu_lw8
    s_min_u32 s28, s23, 63
    s_cmp_gt_u32 s56, s28
    s_cbranch_scc1 layerb1_kernel_gu_lw8
layerb1_kernel_gu_lp8:
    buffer_load_dwordx4 v[124:127], v1, s[8:11], s57 offen sc1
    s_waitcnt vmcnt(0)
    v_min_u32 v124, v124, v125
    v_min_u32 v126, v126, v127
    v_min_u32 v124, v124, v126
    v_cmp_eq_u32 vcc, 0, v124
    s_nop 1
    s_ff1_i32_b64 s56, vcc
    s_min_u32 s56, s56, 64
    s_sub_u32 s58, s58, 1
    s_cbranch_scc1 layerb1_kernel_bail
    s_cmp_gt_u32 s56, s28
    s_cbranch_scc0 layerb1_kernel_gu_lp8
layerb1_kernel_gu_lw8:
    s_cmp_gt_u32 s14, 5
    s_cbranch_scc1 layerb1_kernel_gu_dr9
    s_waitcnt vmcnt(0)
    s_mov_b32 s27, s14
    s_branch layerb1_kernel_gu_dq9
layerb1_kernel_gu_dr9:
    s_waitcnt vmcnt(4)
    s_sub_u32 s27, s14, 1
layerb1_kernel_gu_dq9:
    s_barrier
    s_cmp_lg_u32 s13, 0
    s_cbranch_scc1 layerb1_kernel_gu_fl10
    s_mov_b64 exec, 1
    s_lshl_b32 s26, s12, 7
    v_mov_b32 v7, s26
    v_mov_b32 v120, s27
    buffer_store_dword v120, v7, s[8:11], s48 offen sc1
    s_mov_b64 exec, -1
layerb1_kernel_gu_fl10:
    s_add_u32 s21, s16, 40960
    s_cmp_eq_u32 s21, 122880
    s_cselect_b32 s21, 0, s21
    s_add_u32 s23, s14, 2
    s_min_u32 s24, s23, 63
    s_mul_i32 s24, s24, 40960
    s_add_u32 s24, s24, s19
    s_mul_i32 s25, s13, 10240
    s_add_u32 s25, s25, s22
    s_add_u32 s22, s22, 40960
    s_cmp_eq_u32 s22, 122880
    s_cselect_b32 s22, 0, s22
    ds_read_b128 v[20:23], v2 offset:35840
    s_waitcnt lgkmcnt(6)
    v_mfma_f32_32x32x16_bf16 v[72:87], v[28:31], a[232:235], v[72:87]
    s_mov_b32 m0, s25
    s_nop 0
    buffer_load_dwordx4 v1, s[8:11], s24 offen offset:0 sc1 lds
    v_mfma_f32_32x32x16_bf16 v[88:103], v[28:31], a[236:239], v[88:103]
    ds_read_b128 v[24:27], v2 offset:36864
    s_waitcnt lgkmcnt(6)
    v_mfma_f32_32x32x16_bf16 v[72:87], v[32:35], a[240:243], v[72:87]
    buffer_load_dwordx4 v1, s[8:11], s24 offen offset:1024 sc1 lds
    v_mfma_f32_32x32x16_bf16 v[88:103], v[32:35], a[244:247], v[88:103]
    ds_read_b128 v[28:31], v2 offset:37888
    s_waitcnt lgkmcnt(6)
    v_mfma_f32_32x32x16_bf16 v[72:87], v[36:39], a[248:251], v[72:87]
    buffer_load_dwordx4 v1, s[8:11], s24 offen offset:2048 sc1 lds
    v_mfma_f32_32x32x16_bf16 v[88:103], v[36:39], a[252:255], v[88:103]
    ds_read_b128 v[32:35], v2 offset:38912
    s_waitcnt lgkmcnt(6)
    v_mfma_f32_32x32x16_bf16 v[72:87], v[8:11], v[192:195], v[72:87]
    buffer_load_dwordx4 v1, s[8:11], s24 offen offset:3072 sc1 lds
    v_mfma_f32_32x32x16_bf16 v[88:103], v[8:11], v[196:199], v[88:103]
    ds_read_b128 v[36:39], v2 offset:39936
    s_waitcnt lgkmcnt(6)
    v_mfma_f32_32x32x16_bf16 v[72:87], v[12:15], v[200:203], v[72:87]
    s_add_u32 s24, s24, 4096
    s_add_u32 s25, s25, 4096
    s_mov_b32 m0, s25
    s_nop 0
    buffer_load_dwordx4 v1, s[8:11], s24 offen offset:0 sc1 lds
    v_mfma_f32_32x32x16_bf16 v[88:103], v[12:15], v[204:207], v[88:103]
    v_add_u32 v6, s21, v1
    ds_read_b128 v[8:11], v6 offset:0
    s_waitcnt lgkmcnt(6)
    v_mfma_f32_32x32x16_bf16 v[72:87], v[16:19], v[208:211], v[72:87]
    buffer_load_dwordx4 v1, s[8:11], s24 offen offset:1024 sc1 lds
    v_mfma_f32_32x32x16_bf16 v[88:103], v[16:19], v[212:215], v[88:103]
    ds_read_b128 v[12:15], v6 offset:1024
    s_waitcnt lgkmcnt(6)
    v_mfma_f32_32x32x16_bf16 v[72:87], v[20:23], v[216:219], v[72:87]
    buffer_load_dwordx4 v1, s[8:11], s24 offen offset:2048 sc1 lds
    v_mfma_f32_32x32x16_bf16 v[88:103], v[20:23], v[220:223], v[88:103]
    ds_read_b128 v[16:19], v6 offset:2048
    s_waitcnt lgkmcnt(6)
    v_mfma_f32_32x32x16_bf16 v[72:87], v[24:27], v[224:227], v[72:87]
    buffer_load_dwordx4 v1, s[8:11], s24 offen offset:3072 sc1 lds
    v_mfma_f32_32x32x16_bf16 v[88:103], v[24:27], v[228:231], v[88:103]
    ds_read_b128 v[20:23], v6 offset:3072
    s_waitcnt lgkmcnt(6)
    v_mfma_f32_32x32x16_bf16 v[72:87], v[28:31], v[232:235], v[72:87]
    s_add_u32 s24, s24, 4096
    s_add_u32 s25, s25, 4096
    s_mov_b32 m0, s25
    s_nop 0
    buffer_load_dwordx4 v1, s[8:11], s24 offen offset:0 sc1 lds
    v_mfma_f32_32x32x16_bf16 v[88:103], v[28:31], v[236:239], v[88:103]
    ds_read_b128 v[24:27], v6 offset:4096
    s_waitcnt lgkmcnt(6)
    v_mfma_f32_32x32x16_bf16 v[72:87], v[32:35], v[240:243], v[72:87]
    buffer_load_dwordx4 v1, s[8:11], s24 offen offset:1024 sc1 lds
    v_mfma_f32_32x32x16_bf16 v[88:103], v[32:35], v[244:247], v[88:103]
    ds_read_b128 v[28:31], v6 offset:5120
    s_waitcnt lgkmcnt(6)
    v_mfma_f32_32x32x16_bf16 v[72:87], v[36:39], v[248:251], v[72:87]
    v_mfma_f32_32x32x16_bf16 v[88:103], v[36:39], v[252:255], v[88:103]
    v_mov_b32 v2, v6
    s_mov_b32 s16, s21
    s_add_u32 s14, s14, 1
    s_cmp_lt_u32 s14, s15
    s_cbranch_scc1 layerb1_kernel_gu_loop
    s_branch layerb1_kernel_gu_fin1
layerb1_kernel_gu_fin0:
    s_nop 7
    s_nop 7
    v_cvt_pk_bf16_f32 v104, v40, v41
    v_cvt_pk_bf16_f32 v105, v42, v43
    v_cvt_pk_bf16_f32 v106, v44, v45
    v_cvt_pk_bf16_f32 v107, v46, v47
    s_nop 1
    v_permlane32_swap_b32 v104, v106
    v_permlane32_swap_b32 v105, v107
    buffer_store_dwordx4 v[104:107], v3, s[8:11], s17 offen offset:0 sc1
    v_cvt_pk_bf16_f32 v108, v48, v49
    v_cvt_pk_bf16_f32 v109, v50, v51
    v_cvt_pk_bf16_f32 v110, v52, v53
    v_cvt_pk_bf16_f32 v111, v54, v55
    s_nop 1
    v_permlane32_swap_b32 v108, v110
    v_permlane32_swap_b32 v109, v111
    buffer_store_dwordx4 v[108:111], v3, s[8:11], s17 offen offset:256 sc1
    v_cvt_pk_bf16_f32 v112, v56, v57
    v_cvt_pk_bf16_f32 v113, v58, v59
    v_cvt_pk_bf16_f32 v114, v60, v61
    v_cvt_pk_bf16_f32 v115, v62, v63
    s_nop 1
    v_permlane32_swap_b32 v112, v114
    v_permlane32_swap_b32 v113, v115
    buffer_store_dwordx4 v[112:115], v3, s[8:11], s17 offen offset:2560 sc1
    v_cvt_pk_bf16_f32 v116, v64, v65
    v_cvt_pk_bf16_f32 v117, v66, v67
    v_cvt_pk_bf16_f32 v118, v68, v69
    v_cvt_pk_bf16_f32 v119, v70, v71
    s_nop 1
    v_permlane32_swap_b32 v116, v118
    v_permlane32_swap_b32 v117, v119
    buffer_store_dwordx4 v[116:119], v3, s[8:11], s17 offen offset:2816 sc1
    s_add_u32 s17, s17, s20
    s_add_u32 s18, s18, s20
    s_branch layerb1_kernel_gu_done
layerb1_kernel_gu_fin1:
    s_nop 7
    s_nop 7
    v_cvt_pk_bf16_f32 v104, v72, v73
    v_cvt_pk_bf16_f32 v105, v74, v75
    v_cvt_pk_bf16_f32 v106, v76, v77
    v_cvt_pk_bf16_f32 v107, v78, v79
    s_nop 1
    v_permlane32_swap_b32 v104, v106
    v_permlane32_swap_b32 v105, v107
    buffer_store_dwordx4 v[104:107], v3, s[8:11], s17 offen offset:0 sc1
    v_cvt_pk_bf16_f32 v108, v80, v81
    v_cvt_pk_bf16_f32 v109, v82, v83
    v_cvt_pk_bf16_f32 v110, v84, v85
    v_cvt_pk_bf16_f32 v111, v86, v87
    s_nop 1
    v_permlane32_swap_b32 v108, v110
    v_permlane32_swap_b32 v109, v111
    buffer_store_dwordx4 v[108:111], v3, s[8:11], s17 offen offset:256 sc1
    v_cvt_pk_bf16_f32 v112, v88, v89
    v_cvt_pk_bf16_f32 v113, v90, v91
    v_cvt_pk_bf16_f32 v114, v92, v93
    v_cvt_pk_bf16_f32 v115, v94, v95
    s_nop 1
    v_permlane32_swap_b32 v112, v114
    v_permlane32_swap_b32 v113, v115
    buffer_store_dwordx4 v[112:115], v3, s[8:11], s17 offen offset:2560 sc1
    v_cvt_pk_bf16_f32 v116, v96, v97
    v_cvt_pk_bf16_f32 v117, v98, v99
    v_cvt_pk_bf16_f32 v118, v100, v101
    v_cvt_pk_bf16_f32 v119, v102, v103
    s_nop 1
    v_permlane32_swap_b32 v116, v118
    v_permlane32_swap_b32 v117, v119
    buffer_store_dwordx4 v[116:119], v3, s[8:11], s17 offen offset:2816 sc1
    s_add_u32 s17, s17, s20
    s_add_u32 s18, s18, s20
layerb1_kernel_gu_done:
    s_waitcnt vmcnt(0) lgkmcnt(0)
    s_barrier
    s_cmp_lg_u32 s13, 0
    s_cbranch_scc1 layerb1_kernel_gu_fl11
    s_mov_b64 exec, 1
    s_lshl_b32 s26, s12, 7
    v_mov_b32 v7, s26
    v_mov_b32 v120, s14
    buffer_store_dword v120, v7, s[8:11], s48 offen sc1
    s_mov_b64 exec, -1
layerb1_kernel_gu_fl11:
    s_branch layerb1_kernel_g_done
layerb1_kernel_g_qk:
    s_sub_u32 s26, s12, 80
    s_cmp_ge_u32 s26, 24
    s_cselect_b32 s27, 1, 0
    s_cselect_b32 s28, 24, 0
    s_sub_u32 s26, s26, s28
    s_lshl_b32 s26, s26, 3
    s_lshl_b32 s28, s13, 1
    s_add_u32 s26, s26, s28
    s_add_u32 s28, s26, 0
    s_mul_i32 s29, s28, 171
    s_lshr_b32 s29, s29, 10
    s_mul_i32 s30, s29, 6
    s_sub_u32 s30, s28, s30
    s_mul_i32 s31, s29, 12288
    s_lshl_b32 s32, s30, 11
    s_add_u32 s31, s31, s32
    s_mul_i32 s32, s14, 393216
    s_add_u32 s31, s31, s32
    s_mul_i32 s32, s27, 25165824
    s_add_u32 s31, s31, s32
    s_add_u32 s17, s31, 53477376
    s_lshl_b32 s30, s30, 5
    v_add_u32 v10, s30, v8
    v_and_b32 v11, 0xc1, v10
    v_and_b32 v12, 8, v10
    v_lshl_or_b32 v11, v12, 2, v11
    v_and_b32 v12, 32, v10
    v_lshrrev_b32 v12, 1, v12
    v_or_b32 v11, v11, v12
    v_and_b32 v12, 2, v10
    v_lshl_or_b32 v11, v12, 2, v11
    v_and_b32 v12, 16, v10
    v_lshrrev_b32 v12, 2, v12
    v_or_b32 v11, v11, v12
    v_and_b32 v12, 4, v10
    v_lshrrev_b32 v12, 1, v12
    v_or_b32 v11, v11, v12
    s_cmp_eq_u32 s27, 1
    s_cselect_b64 vcc, -1, 0
    s_nop 1
    v_cndmask_b32 v10, v10, v11, vcc
    v_lshrrev_b32 v12, 4, v10
    v_and_b32 v13, 3, v12
    v_mul_u32_u24 v13, 6, v13
    v_lshrrev_b32 v12, 2, v12
    v_add_u32 v12, v12, v13
    v_mul_u32_u24 v12, 20480, v12
    v_and_b32 v13, 15, v10
    v_lshl_add_u32 v11, v13, 4, v12
    v_lshl_add_u32 v4, v9, 8, v11
    s_xor_b32 s30, s27, 1
    s_mul_i32 s30, s30, 61440
    s_mul_i32 s31, s29, 491520
    s_add_u32 s30, s30, s31
    s_add_u32 s34, s30, 11534336
    s_add_u32 s28, s26, 1
    s_mul_i32 s29, s28, 171
    s_lshr_b32 s29, s29, 10
    s_mul_i32 s30, s29, 6
    s_sub_u32 s30, s28, s30
    s_mul_i32 s31, s29, 12288
    s_lshl_b32 s32, s30, 11
    s_add_u32 s31, s31, s32
    s_mul_i32 s32, s14, 393216
    s_add_u32 s31, s31, s32
    s_mul_i32 s32, s27, 25165824
    s_add_u32 s31, s31, s32
    s_add_u32 s18, s31, 53477376
    s_lshl_b32 s30, s30, 5
    v_add_u32 v10, s30, v8
    v_and_b32 v11, 0xc1, v10
    v_and_b32 v12, 8, v10
    v_lshl_or_b32 v11, v12, 2, v11
    v_and_b32 v12, 32, v10
    v_lshrrev_b32 v12, 1, v12
    v_or_b32 v11, v11, v12
    v_and_b32 v12, 2, v10
    v_lshl_or_b32 v11, v12, 2, v11
    v_and_b32 v12, 16, v10
    v_lshrrev_b32 v12, 2, v12
    v_or_b32 v11, v11, v12
    v_and_b32 v12, 4, v10
    v_lshrrev_b32 v12, 1, v12
    v_or_b32 v11, v11, v12
    s_cmp_eq_u32 s27, 1
    s_cselect_b64 vcc, -1, 0
    s_nop 1
    v_cndmask_b32 v10, v10, v11, vcc
    v_lshrrev_b32 v12, 4, v10
    v_and_b32 v13, 3, v12
    v_mul_u32_u24 v13, 6, v13
    v_lshrrev_b32 v12, 2, v12
    v_add_u32 v12, v12, v13
    v_mul_u32_u24 v12, 20480, v12
    v_and_b32 v13, 15, v10
    v_lshl_add_u32 v11, v13, 4, v12
    v_lshl_add_u32 v5, v9, 8, v11
    s_xor_b32 s30, s27, 1
    s_mul_i32 s30, s30, 61440
    s_mul_i32 s31, s29, 491520
    s_add_u32 s30, s30, s31
    s_add_u32 s35, s30, 11534336
    s_add_u32 s34, s34, 4096
    s_add_u32 s35, s35, 4096
    s_add_u32 s34, s34, 4096
    s_add_u32 s35, s35, 4096
    s_add_u32 s34, s34, 4096
    s_add_u32 s35, s35, 4096
    s_add_u32 s34, s34, 4096
    s_add_u32 s35, s35, 4096
    buffer_load_dwordx4 v[192:195], v4, s[8:11], s34 offen offset:0
    buffer_load_dwordx4 v[196:199], v5, s[8:11], s35 offen offset:0
    buffer_load_dwordx4 v[200:203], v4, s[8:11], s34 offen offset:512
    buffer_load_dwordx4 v[204:207], v5, s[8:11], s35 offen offset:512
    buffer_load_dwordx4 v[208:211], v4, s[8:11], s34 offen offset:1024
    buffer_load_dwordx4 v[212:215], v5, s[8:11], s35 offen offset:1024
    buffer_load_dwordx4 v[216:219], v4, s[8:11], s34 offen offset:1536
    buffer_load_dwordx4 v[220:223], v5, s[8:11], s35 offen offset:1536
    buffer_load_dwordx4 v[224:227], v4, s[8:11], s34 offen offset:2048
    buffer_load_dwordx4 v[228:231], v5, s[8:11], s35 offen offset:2048
    buffer_load_dwordx4 v[232:235], v4, s[8:11], s34 offen offset:2560
    buffer_load_dwordx4 v[236:239], v5, s[8:11], s35 offen offset:2560
    buffer_load_dwordx4 v[240:243], v4, s[8:11], s34 offen offset:3072
    buffer_load_dwordx4 v[244:247], v5, s[8:11], s35 offen offset:3072
    buffer_load_dwordx4 v[248:251], v4, s[8:11], s34 offen offset:3584
    buffer_load_dwordx4 v[252:255], v5, s[8:11], s35 offen offset:3584
    v_mov_b32 v3, v1
    s_mov_b32 s20, 393216
    s_mul_i32 s19, s13, 10240
    s_add_u32 s19, s19, 220200960
    s_mov_b32 s22, 0
    s_mov_b32 s56, 0
    s_mov_b32 s58, 400000
    s_add_u32 s57, s48, 45056
    s_cmp_lg_u32 s13, 0
    s_cbranch_scc1 layerb1_kernel_gk_lw1
    s_min_u32 s28, s14, 63
    s_cmp_gt_u32 s56, s28
    s_cbranch_scc1 layerb1_kernel_gk_lw1
layerb1_kernel_gk_lp1:
    buffer_load_dwordx4 v[124:127], v1, s[8:11], s57 offen sc1
    s_waitcnt vmcnt(0)
    v_min_u32 v124, v124, v125
    v_min_u32 v126, v126, v127
    v_min_u32 v124, v124, v126
    v_cmp_eq_u32 vcc, 0, v124
    s_nop 1
    s_ff1_i32_b64 s56, vcc
    s_min_u32 s56, s56, 64
    s_sub_u32 s58, s58, 1
    s_cbranch_scc1 layerb1_kernel_bail
    s_cmp_gt_u32 s56, s28
    s_cbranch_scc0 layerb1_kernel_gk_lp1
layerb1_kernel_gk_lw1:
    s_barrier
    s_min_u32 s24, s14, 63
    s_mul_i32 s24, s24, 40960
    s_add_u32 s24, s24, s19
    s_mul_i32 s25, s13, 10240
    s_add_u32 s25, s25, s22
    s_mov_b32 m0, s25
    s_nop 0
    buffer_load_dwordx4 v1, s[8:11], s24 offen offset:0 sc1 lds
    buffer_load_dwordx4 v1, s[8:11], s24 offen offset:1024 sc1 lds
    buffer_load_dwordx4 v1, s[8:11], s24 offen offset:2048 sc1 lds
    buffer_load_dwordx4 v1, s[8:11], s24 offen offset:3072 sc1 lds
    s_add_u32 s24, s24, 4096
    s_add_u32 s25, s25, 4096
    s_mov_b32 m0, s25
    s_nop 0
    buffer_load_dwordx4 v1, s[8:11], s24 offen offset:0 sc1 lds
    buffer_load_dwordx4 v1, s[8:11], s24 offen offset:1024 sc1 lds
    buffer_load_dwordx4 v1, s[8:11], s24 offen offset:2048 sc1 lds
    buffer_load_dwordx4 v1, s[8:11], s24 offen offset:3072 sc1 lds
    s_add_u32 s24, s24, 4096
    s_add_u32 s25, s25, 4096
    s_mov_b32 m0, s25
    s_nop 0
    buffer_load_dwordx4 v1, s[8:11], s24 offen offset:0 sc1 lds
    buffer_load_dwordx4 v1, s[8:11], s24 offen offset:1024 sc1 lds
    s_mov_b32 s22, 40960
    s_mov_b32 s16, 0
    s_waitcnt vmcnt(0)
    s_barrier
    v_mov_b32 v2, v1
    ds_read_b128 v[8:11], v2 offset:0
    ds_read_b128 v[12:15], v2 offset:1024
    ds_read_b128 v[16:19], v2 offset:2048
    ds_read_b128 v[20:23], v2 offset:3072
    ds_read_b128 v[24:27], v2 offset:4096
    ds_read_b128 v[28:31], v2 offset:5120
layerb1_kernel_gk_solo:
    ds_read_b128 v[32:35], v2 offset:6144
    s_waitcnt lgkmcnt(6)
    v_mfma_f32_32x32x16_bf16 v[40:55], a[0:3], v[8:11], 0
    v_mfma_f32_32x32x16_bf16 v[56:71], a[4:7], v[8:11], 0
    ds_read_b128 v[36:39], v2 offset:7168
    s_waitcnt lgkmcnt(6)
    v_mfma_f32_32x32x16_bf16 v[40:55], a[8:11], v[12:15], v[40:55]
    v_mfma_f32_32x32x16_bf16 v[56:71], a[12:15], v[12:15], v[56:71]
    ds_read_b128 v[8:11], v2 offset:8192
    s_waitcnt lgkmcnt(6)
    v_mfma_f32_32x32x16_bf16 v[40:55], a[16:19], v[16:19], v[40:55]
    v_mfma_f32_32x32x16_bf16 v[56:71], a[20:23], v[16:19], v[56:71]
    ds_read_b128 v[12:15], v2 offset:9216
    s_waitcnt lgkmcnt(6)
    v_mfma_f32_32x32x16_bf16 v[40:55], a[24:27], v[20:23], v[40:55]
    v_mfma_f32_32x32x16_bf16 v[56:71], a[28:31], v[20:23], v[56:71]
    ds_read_b128 v[16:19], v2 offset:10240
    s_waitcnt lgkmcnt(6)
    v_mfma_f32_32x32x16_bf16 v[40:55], a[32:35], v[24:27], v[40:55]
    v_mfma_f32_32x32x16_bf16 v[56:71], a[36:39], v[24:27], v[56:71]
    ds_read_b128 v[20:23], v2 offset:11264
    s_waitcnt lgkmcnt(6)
    v_mfma_f32_32x32x16_bf16 v[40:55], a[40:43], v[28:31], v[40:55]
    v_mfma_f32_32x32x16_bf16 v[56:71], a[44:47], v[28:31], v[56:71]
    ds_read_b128 v[24:27], v2 offset:12288
    s_waitcnt lgkmcnt(6)
    v_mfma_f32_32x32x16_bf16 v[40:55], a[48:51], v[32:35], v[40:55]
    v_mfma_f32_32x32x16_bf16 v[56:71], a[52:55], v[32:35], v[56:71]
    ds_read_b128 v[28:31], v2 offset:13312
    s_waitcnt lgkmcnt(6)
    v_mfma_f32_32x32x16_bf16 v[40:55], a[56:59], v[36:39], v[40:55]
    v_mfma_f32_32x32x16_bf16 v[56:71], a[60:63], v[36:39], v[56:71]
    ds_read_b128 v[32:35], v2 offset:14336
    s_waitcnt lgkmcnt(6)
    v_mfma_f32_32x32x16_bf16 v[40:55], a[64:67], v[8:11], v[40:55]
    v_mfma_f32_32x32x16_bf16 v[56:71], a[68:71], v[8:11], v[56:71]
    ds_read_b128 v[36:39], v2 offset:15360
    s_waitcnt lgkmcnt(6)
    v_mfma_f32_32x32x16_bf16 v[40:55], a[72:75], v[12:15], v[40:55]
    v_mfma_f32_32x32x16_bf16 v[56:71], a[76:79], v[12:15], v[56:71]
    ds_read_b128 v[8:11], v2 offset:16384
    s_waitcnt lgkmcnt(6)
    v_mfma_f32_32x32x16_bf16 v[40:55], a[80:83], v[16:19], v[40:55]
    v_mfma_f32_32x32x16_bf16 v[56:71], a[84:87], v[16:19], v[56:71]
    ds_read_b128 v[12:15], v2 offset:17408
    s_waitcnt lgkmcnt(6)
    v_mfma_f32_32x32x16_bf16 v[40:55], a[88:91], v[20:23], v[40:55]
    v_mfma_f32_32x32x16_bf16 v[56:71], a[92:95], v[20:23], v[56:71]
    ds_read_b128 v[16:19], v2 offset:18432
    s_waitcnt lgkmcnt(6)
    v_mfma_f32_32x32x16_bf16 v[40:55], a[96:99], v[24:27], v[40:55]
    v_mfma_f32_32x32x16_bf16 v[56:71], a[100:103], v[24:27], v[56:71]
    ds_read_b128 v[20:23], v2 offset:19456
    s_waitcnt lgkmcnt(6)
    v_mfma_f32_32x32x16_bf16 v[40:55], a[104:107], v[28:31], v[40:55]
    v_mfma_f32_32x32x16_bf16 v[56:71], a[108:111], v[28:31], v[56:71]
    ds_read_b128 v[24:27], v2 offset:20480
    s_waitcnt lgkmcnt(6)
    v_mfma_f32_32x32x16_bf16 v[40:55], a[112:115], v[32:35], v[40:55]
    v_mfma_f32_32x32x16_bf16 v[56:71], a[116:119], v[32:35], v[56:71]
    ds_read_b128 v[28:31], v2 offset:21504
    s_waitcnt lgkmcnt(6)
    v_mfma_f32_32x32x16_bf16 v[40:55], a[120:123], v[36:39], v[40:55]
    v_mfma_f32_32x32x16_bf16 v[56:71], a[124:127], v[36:39], v[56:71]
    ds_read_b128 v[32:35], v2 offset:22528
    s_waitcnt lgkmcnt(6)
    v_mfma_f32_32x32x16_bf16 v[40:55], a[128:131], v[8:11], v[40:55]
    v_mfma_f32_32x32x16_bf16 v[56:71], a[132:135], v[8:11], v[56:71]
    ds_read_b128 v[36:39], v2 offset:23552
    s_waitcnt lgkmcnt(6)
    v_mfma_f32_32x32x16_bf16 v[40:55], a[136:139], v[12:15], v[40:55]
    v_mfma_f32_32x32x16_bf16 v[56:71], a[140:143], v[12:15], v[56:71]
    ds_read_b128 v[8:11], v2 offset:24576
    s_waitcnt lgkmcnt(6)
    v_mfma_f32_32x32x16_bf16 v[40:55], a[144:147], v[16:19], v[40:55]
    v_mfma_f32_32x32x16_bf16 v[56:71], a[148:151], v[16:19], v[56:71]
    ds_read_b128 v[12:15], v2 offset:25600
    s_waitcnt lgkmcnt(6)
    v_mfma_f32_32x32x16_bf16 v[40:55], a[152:155], v[20:23], v[40:55]
    v_mfma_f32_32x32x16_bf16 v[56:71], a[156:159], v[20:23], v[56:71]
    ds_read_b128 v[16:19], v2 offset:26624
    s_waitcnt lgkmcnt(6)
    v_mfma_f32_32x32x16_bf16 v[40:55], a[160:163], v[24:27], v[40:55]
    v_mfma_f32_32x32x16_bf16 v[56:71], a[164:167], v[24:27], v[56:71]
    ds_read_b128 v[20:23], v2 offset:27648
    s_waitcnt lgkmcnt(6)
    v_mfma_f32_32x32x16_bf16 v[40:55], a[168:171], v[28:31], v[40:55]
    v_mfma_f32_32x32x16_bf16 v[56:71], a[172:175], v[28:31], v[56:71]
    ds_read_b128 v[24:27], v2 offset:28672
    s_waitcnt lgkmcnt(6)
    v_mfma_f32_32x32x16_bf16 v[40:55], a[176:179], v[32:35], v[40:55]
    v_mfma_f32_32x32x16_bf16 v[56:71], a[180:183], v[32:35], v[56:71]
    ds_read_b128 v[28:31], v2 offset:29696
    s_waitcnt lgkmcnt(6)
    v_mfma_f32_32x32x16_bf16 v[40:55], a[184:187], v[36:39], v[40:55]
    v_mfma_f32_32x32x16_bf16 v[56:71], a[188:191], v[36:39], v[56:71]
    ds_read_b128 v[32:35], v2 offset:30720
    s_waitcnt lgkmcnt(6)
    v_mfma_f32_32x32x16_bf16 v[40:55], a[192:195], v[8:11], v[40:55]
    v_mfma_f32_32x32x16_bf16 v[56:71], a[196:199], v[8:11], v[56:71]
    ds_read_b128 v[36:39], v2 offset:31744
    s_waitcnt lgkmcnt(6)
    v_mfma_f32_32x32x16_bf16 v[40:55], a[200:203], v[12:15], v[40:55]
    v_mfma_f32_32x32x16_bf16 v[56:71], a[204:207], v[12:15], v[56:71]
    ds_read_b128 v[8:11], v2 offset:32768
    s_waitcnt lgkmcnt(6)
    v_mfma_f32_32x32x16_bf16 v[40:55], a[208:211], v[16:19], v[40:55]
    v_mfma_f32_32x32x16_bf16 v[56:71], a[212:215], v[16:19], v[56:71]
    ds_read_b128 v[12:15], v2 offset:33792
    s_waitcnt lgkmcnt(6)
    v_mfma_f32_32x32x16_bf16 v[40:55], a[216:219], v[20:23], v[40:55]
    v_mfma_f32_32x32x16_bf16 v[56:71], a[220:223], v[20:23], v[56:71]
    ds_read_b128 v[16:19], v2 offset:34816
    s_waitcnt lgkmcnt(6)
    v_mfma_f32_32x32x16_bf16 v[40:55], a[224:227], v[24:27], v[40:55]
    v_mfma_f32_32x32x16_bf16 v[56:71], a[228:231], v[24:27], v[56:71]
    ds_read_b128 v[20:23], v2 offset:35840
    s_waitcnt lgkmcnt(6)
    v_mfma_f32_32x32x16_bf16 v[40:55], a[232:235], v[28:31], v[40:55]
    v_mfma_f32_32x32x16_bf16 v[56:71], a[236:239], v[28:31], v[56:71]
    ds_read_b128 v[24:27], v2 offset:36864
    s_waitcnt lgkmcnt(6)
    buffer_load_dwordx4 v[124:127], v1, s[8:11], s57 offen sc1
    v_mfma_f32_32x32x16_bf16 v[40:55], a[240:243], v[32:35], v[40:55]
    v_mfma_f32_32x32x16_bf16 v[56:71], a[244:247], v[32:35], v[56:71]
    ds_read_b128 v[28:31], v2 offset:37888
    s_waitcnt lgkmcnt(6)
    v_mfma_f32_32x32x16_bf16 v[40:55], a[248:251], v[36:39], v[40:55]
    v_mfma_f32_32x32x16_bf16 v[56:71], a[252:255], v[36:39], v[56:71]
    ds_read_b128 v[32:35], v2 offset:38912
    s_waitcnt lgkmcnt(6)
    v_mfma_f32_32x32x16_bf16 v[40:55], v[192:195], v[8:11], v[40:55]
    v_mfma_f32_32x32x16_bf16 v[56:71], v[196:199], v[8:11], v[56:71]
    ds_read_b128 v[36:39], v2 offset:39936
    s_waitcnt lgkmcnt(6)
    v_mfma_f32_32x32x16_bf16 v[40:55], v[200:203], v[12:15], v[40:55]
    v_mfma_f32_32x32x16_bf16 v[56:71], v[204:207], v[12:15], v[56:71]
    s_waitcnt lgkmcnt(5)
    v_mfma_f32_32x32x16_bf16 v[40:55], v[208:211], v[16:19], v[40:55]
    v_mfma_f32_32x32x16_bf16 v[56:71], v[212:215], v[16:19], v[56:71]
    s_waitcnt lgkmcnt(4)
    v_mfma_f32_32x32x16_bf16 v[40:55], v[216:219], v[20:23], v[40:55]
    v_mfma_f32_32x32x16_bf16 v[56:71], v[220:223], v[20:23], v[56:71]
    s_waitcnt lgkmcnt(3)
    v_mfma_f32_32x32x16_bf16 v[40:55], v[224:227], v[24:27], v[40:55]
    v_mfma_f32_32x32x16_bf16 v[56:71], v[228:231], v[24:27], v[56:71]
    s_waitcnt lgkmcnt(2)
    v_mfma_f32_32x32x16_bf16 v[40:55], v[232:235], v[28:31], v[40:55]
    v_mfma_f32_32x32x16_bf16 v[56:71], v[236:239], v[28:31], v[56:71]
    s_waitcnt lgkmcnt(1)
    v_mfma_f32_32x32x16_bf16 v[40:55], v[240:243], v[32:35], v[40:55]
    v_mfma_f32_32x32x16_bf16 v[56:71], v[244:247], v[32:35], v[56:71]
    s_waitcnt lgkmcnt(0)
    v_mfma_f32_32x32x16_bf16 v[40:55], v[248:251], v[36:39], v[40:55]
    v_mfma_f32_32x32x16_bf16 v[56:71], v[252:255], v[36:39], v[56:71]
    s_add_u32 s14, s14, 1
    s_nop 7
    s_nop 7
    v_cvt_pk_bf16_f32 v104, v40, v41
    v_cvt_pk_bf16_f32 v105, v42, v43
    v_cvt_pk_bf16_f32 v106, v44, v45
    v_cvt_pk_bf16_f32 v107, v46, v47
    s_nop 1
    v_permlane32_swap_b32 v104, v106
    v_permlane32_swap_b32 v105, v107
    buffer_store_dwordx4 v[104:107], v3, s[8:11], s17 offen offset:0 sc1
    v_cvt_pk_bf16_f32 v108, v48, v49
    v_cvt_pk_bf16_f32 v109, v50, v51
    v_cvt_pk_bf16_f32 v110, v52, v53
    v_cvt_pk_bf16_f32 v111, v54, v55
    s_nop 1
    v_permlane32_swap_b32 v108, v110
    v_permlane32_swap_b32 v109, v111
    buffer_store_dwordx4 v[108:111], v3, s[8:11], s17 offen offset:1024 sc1
    v_cvt_pk_bf16_f32 v112, v56, v57
    v_cvt_pk_bf16_f32 v113, v58, v59
    v_cvt_pk_bf16_f32 v114, v60, v61
    v_cvt_pk_bf16_f32 v115, v62, v63
    s_nop 1
    v_permlane32_swap_b32 v112, v114
    v_permlane32_swap_b32 v113, v115
    buffer_store_dwordx4 v[112:115], v3, s[8:11], s18 offen offset:0 sc1
    v_cvt_pk_bf16_f32 v116, v64, v65
    v_cvt_pk_bf16_f32 v117, v66, v67
    v_cvt_pk_bf16_f32 v118, v68, v69
    v_cvt_pk_bf16_f32 v119, v70, v71
    s_nop 1
    v_permlane32_swap_b32 v116, v118
    v_permlane32_swap_b32 v117, v119
    buffer_store_dwordx4 v[116:119], v3, s[8:11], s18 offen offset:1024 sc1
    s_add_u32 s17, s17, s20
    s_add_u32 s18, s18, s20
    s_waitcnt vmcnt(0)
    s_barrier
    s_cmp_lg_u32 s13, 0
    s_cbranch_scc1 layerb1_kernel_gk_fl2
    s_mov_b64 exec, 1
    s_lshl_b32 s26, s12, 7
    v_mov_b32 v7, s26
    v_mov_b32 v120, s14
    buffer_store_dword v120, v7, s[8:11], s48 offen sc1
    s_mov_b64 exec, -1
layerb1_kernel_gk_fl2:
layerb1_kernel_gk_spoll:
    v_min_u32 v124, v124, v125
    v_min_u32 v126, v126, v127
    v_min_u32 v124, v124, v126
    v_cmp_eq_u32 vcc, 0, v124
    s_nop 1
    s_ff1_i32_b64 s56, vcc
    s_min_u32 s56, s56, 64
    s_cmp_gt_u32 s56, s14
    s_cbranch_scc1 layerb1_kernel_gk_sok
    s_sub_u32 s58, s58, 1
    s_cbranch_scc1 layerb1_kernel_bail
    buffer_load_dwordx4 v[124:127], v1, s[8:11], s57 offen sc1
    s_waitcnt vmcnt(0)
    s_branch layerb1_kernel_gk_spoll
layerb1_kernel_gk_sok:
    s_min_u32 s24, s14, 63
    s_mul_i32 s24, s24, 40960
    s_add_u32 s24, s24, s19
    s_mul_i32 s25, s13, 10240
    s_add_u32 s25, s25, s22
    s_mov_b32 m0, s25
    s_nop 0
    buffer_load_dwordx4 v1, s[8:11], s24 offen offset:0 sc1 lds
    buffer_load_dwordx4 v1, s[8:11], s24 offen offset:1024 sc1 lds
    buffer_load_dwordx4 v1, s[8:11], s24 offen offset:2048 sc1 lds
    buffer_load_dwordx4 v1, s[8:11], s24 offen offset:3072 sc1 lds
    s_add_u32 s24, s24, 4096
    s_add_u32 s25, s25, 4096
    s_mov_b32 m0, s25
    s_nop 0
    buffer_load_dwordx4 v1, s[8:11], s24 offen offset:0 sc1 lds
    buffer_load_dwordx4 v1, s[8:11], s24 offen offset:1024 sc1 lds
    buffer_load_dwordx4 v1, s[8:11], s24 offen offset:2048 sc1 lds
    buffer_load_dwordx4 v1, s[8:11], s24 offen offset:3072 sc1 lds
    s_add_u32 s24, s24, 4096
    s_add_u32 s25, s25, 4096
    s_mov_b32 m0, s25
    s_nop 0
    buffer_load_dwordx4 v1, s[8:11], s24 offen offset:0 sc1 lds
    buffer_load_dwordx4 v1, s[8:11], s24 offen offset:1024 sc1 lds
    s_mov_b32 s16, s22
    s_add_u32 s22, s22, 40960
    s_cmp_eq_u32 s22, 122880
    s_cselect_b32 s22, 0, s22
    v_add_u32 v2, s16, v1
    s_waitcnt vmcnt(0)
    s_barrier
    ds_read_b128 v[8:11], v2 offset:0
    ds_read_b128 v[12:15], v2 offset:1024
    ds_read_b128 v[16:19], v2 offset:2048
    ds_read_b128 v[20:23], v2 offset:3072
    ds_read_b128 v[24:27], v2 offset:4096
    ds_read_b128 v[28:31], v2 offset:5120
    s_cmp_lt_u32 s14, 3
    s_cbranch_scc1 layerb1_kernel_gk_solo
    ds_read_b128 v[32:35], v2 offset:6144
    s_waitcnt lgkmcnt(6)
    v_mfma_f32_32x32x16_bf16 v[72:87], a[0:3], v[8:11], 0
    v_mfma_f32_32x32x16_bf16 v[88:103], a[4:7], v[8:11], 0
    ds_read_b128 v[36:39], v2 offset:7168
    s_waitcnt lgkmcnt(6)
    v_mfma_f32_32x32x16_bf16 v[72:87], a[8:11], v[12:15], v[72:87]
    v_mfma_f32_32x32x16_bf16 v[88:103], a[12:15], v[12:15], v[88:103]
    ds_read_b128 v[8:11], v2 offset:8192
    s_waitcnt lgkmcnt(6)
    v_mfma_f32_32x32x16_bf16 v[72:87], a[16:19], v[16:19], v[72:87]
    v_mfma_f32_32x32x16_bf16 v[88:103], a[20:23], v[16:19], v[88:103]
    s_add_u32 s23, s14, 1
    s_cmp_lg_u32 s13, 0
    s_cbranch_scc1 layerb1_kernel_gk_lw3
    s_min_u32 s28, s23, 63
    s_cmp_gt_u32 s56, s28
    s_cbranch_scc1 layerb1_kernel_gk_lw3
layerb1_kernel_gk_lp3:
    buffer_load_dwordx4 v[124:127], v1, s[8:11], s57 offen sc1
    s_waitcnt vmcnt(0)
    v_min_u32 v124, v124, v125
    v_min_u32 v126, v126, v127
    v_min_u32 v124, v124, v126
    v_cmp_eq_u32 vcc, 0, v124
    s_nop 1
    s_ff1_i32_b64 s56, vcc
    s_min_u32 s56, s56, 64
    s_sub_u32 s58, s58, 1
    s_cbranch_scc1 layerb1_kernel_bail
    s_cmp_gt_u32 s56, s28
    s_cbranch_scc0 layerb1_kernel_gk_lp3
layerb1_kernel_gk_lw3:
    s_barrier
    s_min_u32 s24, s23, 63
    s_mul_i32 s24, s24, 40960
    s_add_u32 s24, s24, s19
    s_mul_i32 s25, s13, 10240
    s_add_u32 s25, s25, s22
    s_add_u32 s22, s22, 40960
    s_cmp_eq_u32 s22, 122880
    s_cselect_b32 s22, 0, s22
    ds_read_b128 v[12:15], v2 offset:9216
    s_waitcnt lgkmcnt(6)
    v_mfma_f32_32x32x16_bf16 v[72:87], a[24:27], v[20:23], v[72:87]
    s_mov_b32 m0, s25
    s_nop 0
    buffer_load_dwordx4 v1, s[8:11], s24 offen offset:0 sc1 lds
    v_mfma_f32_32x32x16_bf16 v[88:103], a[28:31], v[20:23], v[88:103]
    ds_read_b128 v[16:19], v2 offset:10240
    s_waitcnt lgkmcnt(6)
    v_mfma_f32_32x32x16_bf16 v[72:87], a[32:35], v[24:27], v[72:87]
    buffer_load_dwordx4 v1, s[8:11], s24 offen offset:1024 sc1 lds
    v_mfma_f32_32x32x16_bf16 v[88:103], a[36:39], v[24:27], v[88:103]
    ds_read_b128 v[20:23], v2 offset:11264
    s_waitcnt lgkmcnt(6)
    v_mfma_f32_32x32x16_bf16 v[72:87], a[40:43], v[28:31], v[72:87]
    buffer_load_dwordx4 v1, s[8:11], s24 offen offset:2048 sc1 lds
    v_mfma_f32_32x32x16_bf16 v[88:103], a[44:47], v[28:31], v[88:103]
    ds_read_b128 v[24:27], v2 offset:12288
    s_waitcnt lgkmcnt(6)
    v_mfma_f32_32x32x16_bf16 v[72:87], a[48:51], v[32:35], v[72:87]
    buffer_load_dwordx4 v1, s[8:11], s24 offen offset:3072 sc1 lds
    v_mfma_f32_32x32x16_bf16 v[88:103], a[52:55], v[32:35], v[88:103]
    ds_read_b128 v[28:31], v2 offset:13312
    s_waitcnt lgkmcnt(6)
    v_mfma_f32_32x32x16_bf16 v[72:87], a[56:59], v[36:39], v[72:87]
    s_add_u32 s24, s24, 4096
    s_add_u32 s25, s25, 4096
    s_mov_b32 m0, s25
    s_nop 0
    buffer_load_dwordx4 v1, s[8:11], s24 offen offset:0 sc1 lds
    v_mfma_f32_32x32x16_bf16 v[88:103], a[60:63], v[36:39], v[88:103]
    ds_read_b128 v[32:35], v2 offset:14336
    s_waitcnt lgkmcnt(6)
    v_mfma_f32_32x32x16_bf16 v[72:87], a[64:67], v[8:11], v[72:87]
    buffer_load_dwordx4 v1, s[8:11], s24 offen offset:1024 sc1 lds
    v_mfma_f32_32x32x16_bf16 v[88:103], a[68:71], v[8:11], v[88:103]
    ds_read_b128 v[36:39], v2 offset:15360
    s_waitcnt lgkmcnt(6)
    v_mfma_f32_32x32x16_bf16 v[72:87], a[72:75], v[12:15], v[72:87]
    buffer_load_dwordx4 v1, s[8:11], s24 offen offset:2048 sc1 lds
    v_mfma_f32_32x32x16_bf16 v[88:103], a[76:79], v[12:15], v[88:103]
    ds_read_b128 v[8:11], v2 offset:16384
    s_waitcnt lgkmcnt(6)
    v_mfma_f32_32x32x16_bf16 v[72:87], a[80:83], v[16:19], v[72:87]
    buffer_load_dwordx4 v1, s[8:11], s24 offen offset:3072 sc1 lds
    v_mfma_f32_32x32x16_bf16 v[88:103], a[84:87], v[16:19], v[88:103]
    ds_read_b128 v[12:15], v2 offset:17408
    s_waitcnt lgkmcnt(6)
    v_mfma_f32_32x32x16_bf16 v[72:87], a[88:91], v[20:23], v[72:87]
    s_add_u32 s24, s24, 4096
    s_add_u32 s25, s25, 4096
    s_mov_b32 m0, s25
    s_nop 0
    buffer_load_dwordx4 v1, s[8:11], s24 offen offset:0 sc1 lds
    v_mfma_f32_32x32x16_bf16 v[88:103], a[92:95], v[20:23], v[88:103]
    ds_read_b128 v[16:19], v2 offset:18432
    s_waitcnt lgkmcnt(6)
    v_mfma_f32_32x32x16_bf16 v[72:87], a[96:99], v[24:27], v[72:87]
    buffer_load_dwordx4 v1, s[8:11], s24 offen offset:1024 sc1 lds
    v_mfma_f32_32x32x16_bf16 v[88:103], a[100:103], v[24:27], v[88:103]
    ds_read_b128 v[20:23], v2 offset:19456
    s_waitcnt lgkmcnt(6)
    v_mfma_f32_32x32x16_bf16 v[72:87], a[104:107], v[28:31], v[72:87]
    v_mfma_f32_32x32x16_bf16 v[88:103], a[108:111], v[28:31], v[88:103]
    ds_read_b128 v[24:27], v2 offset:20480
    s_waitcnt lgkmcnt(6)
    v_mfma_f32_32x32x16_bf16 v[72:87], a[112:115], v[32:35], v[72:87]
    v_mfma_f32_32x32x16_bf16 v[88:103], a[116:119], v[32:35], v[88:103]
    ds_read_b128 v[28:31], v2 offset:21504
    s_waitcnt lgkmcnt(6)
    v_mfma_f32_32x32x16_bf16 v[72:87], a[120:123], v[36:39], v[72:87]
    v_mfma_f32_32x32x16_bf16 v[88:103], a[124:127], v[36:39], v[88:103]
    ds_read_b128 v[32:35], v2 offset:22528
    s_waitcnt lgkmcnt(6)
    v_mfma_f32_32x32x16_bf16 v[72:87], a[128:131], v[8:11], v[72:87]
    v_mfma_f32_32x32x16_bf16 v[88:103], a[132:135], v[8:11], v[88:103]
    ds_read_b128 v[36:39], v2 offset:23552
    s_waitcnt lgkmcnt(6)
    v_mfma_f32_32x32x16_bf16 v[72:87], a[136:139], v[12:15], v[72:87]
    v_mfma_f32_32x32x16_bf16 v[88:103], a[140:143], v[12:15], v[88:103]
    ds_read_b128 v[8:11], v2 offset:24576
    s_waitcnt lgkmcnt(6)
    v_mfma_f32_32x32x16_bf16 v[72:87], a[144:147], v[16:19], v[72:87]
    v_mfma_f32_32x32x16_bf16 v[88:103], a[148:151], v[16:19], v[88:103]
    ds_read_b128 v[12:15], v2 offset:25600
    s_waitcnt lgkmcnt(6)
    v_mfma_f32_32x32x16_bf16 v[72:87], a[152:155], v[20:23], v[72:87]
    v_mfma_f32_32x32x16_bf16 v[88:103], a[156:159], v[20:23], v[88:103]
    ds_read_b128 v[16:19], v2 offset:26624
    s_waitcnt lgkmcnt(6)
    v_mfma_f32_32x32x16_bf16 v[72:87], a[160:163], v[24:27], v[72:87]
    v_mfma_f32_32x32x16_bf16 v[88:103], a[164:167], v[24:27], v[88:103]
    ds_read_b128 v[20:23], v2 offset:27648
    s_waitcnt lgkmcnt(6)
    v_mfma_f32_32x32x16_bf16 v[72:87], a[168:171], v[28:31], v[72:87]
    v_mfma_f32_32x32x16_bf16 v[88:103], a[172:175], v[28:31], v[88:103]
    ds_read_b128 v[24:27], v2 offset:28672
    s_waitcnt lgkmcnt(6)
    v_mfma_f32_32x32x16_bf16 v[72:87], a[176:179], v[32:35], v[72:87]
    v_mfma_f32_32x32x16_bf16 v[88:103], a[180:183], v[32:35], v[88:103]
    ds_read_b128 v[28:31], v2 offset:29696
    s_waitcnt lgkmcnt(6)
    v_mfma_f32_32x32x16_bf16 v[72:87], a[184:187], v[36:39], v[72:87]
    v_mfma_f32_32x32x16_bf16 v[88:103], a[188:191], v[36:39], v[88:103]
    ds_read_b128 v[32:35], v2 offset:30720
    s_waitcnt lgkmcnt(6)
    v_mfma_f32_32x32x16_bf16 v[72:87], a[192:195], v[8:11], v[72:87]
    v_mfma_f32_32x32x16_bf16 v[88:103], a[196:199], v[8:11], v[88:103]
    ds_read_b128 v[36:39], v2 offset:31744
    s_waitcnt lgkmcnt(6)
    v_mfma_f32_32x32x16_bf16 v[72:87], a[200:203], v[12:15], v[72:87]
    v_mfma_f32_32x32x16_bf16 v[88:103], a[204:207], v[12:15], v[88:103]
    ds_read_b128 v[8:11], v2 offset:32768
    s_waitcnt lgkmcnt(6)
    v_mfma_f32_32x32x16_bf16 v[72:87], a[208:211], v[16:19], v[72:87]
    v_mfma_f32_32x32x16_bf16 v[88:103], a[212:215], v[16:19], v[88:103]
    ds_read_b128 v[12:15], v2 offset:33792
    s_waitcnt lgkmcnt(6)
    v_mfma_f32_32x32x16_bf16 v[72:87], a[216:219], v[20:23], v[72:87]
    v_mfma_f32_32x32x16_bf16 v[88:103], a[220:223], v[20:23], v[88:103]
    ds_read_b128 v[16:19], v2 offset:34816
    s_waitcnt lgkmcnt(6)
    v_mfma_f32_32x32x16_bf16 v[72:87], a[224:227], v[24:27], v[72:87]
    v_mfma_f32_32x32x16_bf16 v[88:103], a[228:231], v[24:27], v[88:103]
    s_add_u32 s23, s14, 2
    s_cmp_lg_u32 s13, 0
    s_cbranch_scc1 layerb1_kernel_gk_lw4
    s_min_u32 s28, s23, 63
    s_cmp_gt_u32 s56, s28
    s_cbranch_scc1 layerb1_kernel_gk_lw4
layerb1_kernel_gk_lp4:
    buffer_load_dwordx4 v[124:127], v1, s[8:11], s57 offen sc1
    s_waitcnt vmcnt(0)
    v_min_u32 v124, v124, v125
    v_min_u32 v126, v126, v127
    v_min_u32 v124, v124, v126
    v_cmp_eq_u32 vcc, 0, v124
    s_nop 1
    s_ff1_i32_b64 s56, vcc
    s_min_u32 s56, s56, 64
    s_sub_u32 s58, s58, 1
    s_cbranch_scc1 layerb1_kernel_bail
    s_cmp_gt_u32 s56, s28
    s_cbranch_scc0 layerb1_kernel_gk_lp4
layerb1_kernel_gk_lw4:
    s_waitcnt vmcnt(0)
    s_barrier
    s_add_u32 s21, s16, 40960
    s_cmp_eq_u32 s21, 122880
    s_cselect_b32 s21, 0, s21
    s_add_u32 s23, s14, 2
    s_min_u32 s24, s23, 63
    s_mul_i32 s24, s24, 40960
    s_add_u32 s24, s24, s19
    s_mul_i32 s25, s13, 10240
    s_add_u32 s25, s25, s22
    s_add_u32 s22, s22, 40960
    s_cmp_eq_u32 s22, 122880
    s_cselect_b32 s22, 0, s22
    ds_read_b128 v[20:23], v2 offset:35840
    s_waitcnt lgkmcnt(6)
    v_mfma_f32_32x32x16_bf16 v[72:87], a[232:235], v[28:31], v[72:87]
    s_mov_b32 m0, s25
    s_nop 0
    buffer_load_dwordx4 v1, s[8:11], s24 offen offset:0 sc1 lds
    v_mfma_f32_32x32x16_bf16 v[88:103], a[236:239], v[28:31], v[88:103]
    ds_read_b128 v[24:27], v2 offset:36864
    s_waitcnt lgkmcnt(6)
    v_mfma_f32_32x32x16_bf16 v[72:87], a[240:243], v[32:35], v[72:87]
    buffer_load_dwordx4 v1, s[8:11], s24 offen offset:1024 sc1 lds
    v_mfma_f32_32x32x16_bf16 v[88:103], a[244:247], v[32:35], v[88:103]
    ds_read_b128 v[28:31], v2 offset:37888
    s_waitcnt lgkmcnt(6)
    v_mfma_f32_32x32x16_bf16 v[72:87], a[248:251], v[36:39], v[72:87]
    buffer_load_dwordx4 v1, s[8:11], s24 offen offset:2048 sc1 lds
    v_mfma_f32_32x32x16_bf16 v[88:103], a[252:255], v[36:39], v[88:103]
    ds_read_b128 v[32:35], v2 offset:38912
    s_waitcnt lgkmcnt(6)
    v_mfma_f32_32x32x16_bf16 v[72:87], v[192:195], v[8:11], v[72:87]
    buffer_load_dwordx4 v1, s[8:11], s24 offen offset:3072 sc1 lds
    v_mfma_f32_32x32x16_bf16 v[88:103], v[196:199], v[8:11], v[88:103]
    ds_read_b128 v[36:39], v2 offset:39936
    s_waitcnt lgkmcnt(6)
    v_mfma_f32_32x32x16_bf16 v[72:87], v[200:203], v[12:15], v[72:87]
    s_add_u32 s24, s24, 4096
    s_add_u32 s25, s25, 4096
    s_mov_b32 m0, s25
    s_nop 0
    buffer_load_dwordx4 v1, s[8:11], s24 offen offset:0 sc1 lds
    v_mfma_f32_32x32x16_bf16 v[88:103], v[204:207], v[12:15], v[88:103]
    v_add_u32 v6, s21, v1
    ds_read_b128 v[8:11], v6 offset:0
    s_waitcnt lgkmcnt(6)
    v_mfma_f32_32x32x16_bf16 v[72:87], v[208:211], v[16:19], v[72:87]
    buffer_load_dwordx4 v1, s[8:11], s24 offen offset:1024 sc1 lds
    v_mfma_f32_32x32x16_bf16 v[88:103], v[212:215], v[16:19], v[88:103]
    ds_read_b128 v[12:15], v6 offset:1024
    s_waitcnt lgkmcnt(6)
    v_mfma_f32_32x32x16_bf16 v[72:87], v[216:219], v[20:23], v[72:87]
    buffer_load_dwordx4 v1, s[8:11], s24 offen offset:2048 sc1 lds
    v_mfma_f32_32x32x16_bf16 v[88:103], v[220:223], v[20:23], v[88:103]
    ds_read_b128 v[16:19], v6 offset:2048
    s_waitcnt lgkmcnt(6)
    v_mfma_f32_32x32x16_bf16 v[72:87], v[224:227], v[24:27], v[72:87]
    buffer_load_dwordx4 v1, s[8:11], s24 offen offset:3072 sc1 lds
    v_mfma_f32_32x32x16_bf16 v[88:103], v[228:231], v[24:27], v[88:103]
    ds_read_b128 v[20:23], v6 offset:3072
    s_waitcnt lgkmcnt(6)
    v_mfma_f32_32x32x16_bf16 v[72:87], v[232:235], v[28:31], v[72:87]
    s_add_u32 s24, s24, 4096
    s_add_u32 s25, s25, 4096
    s_mov_b32 m0, s25
    s_nop 0
    buffer_load_dwordx4 v1, s[8:11], s24 offen offset:0 sc1 lds
    v_mfma_f32_32x32x16_bf16 v[88:103], v[236:239], v[28:31], v[88:103]
    ds_read_b128 v[24:27], v6 offset:4096
    s_waitcnt lgkmcnt(6)
    v_mfma_f32_32x32x16_bf16 v[72:87], v[240:243], v[32:35], v[72:87]
    buffer_load_dwordx4 v1, s[8:11], s24 offen offset:1024 sc1 lds
    v_mfma_f32_32x32x16_bf16 v[88:103], v[244:247], v[32:35], v[88:103]
    ds_read_b128 v[28:31], v6 offset:5120
    s_waitcnt lgkmcnt(6)
    v_mfma_f32_32x32x16_bf16 v[72:87], v[248:251], v[36:39], v[72:87]
    v_mfma_f32_32x32x16_bf16 v[88:103], v[252:255], v[36:39], v[88:103]
    v_mov_b32 v2, v6
    s_mov_b32 s16, s21
    s_add_u32 s14, s14, 1
layerb1_kernel_gk_loop:
    ds_read_b128 v[32:35], v2 offset:6144
    s_waitcnt lgkmcnt(6)
    v_mfma_f32_32x32x16_bf16 v[40:55], a[0:3], v[8:11], 0
    v_mfma_f32_32x32x16_bf16 v[56:71], a[4:7], v[8:11], 0
    ds_read_b128 v[36:39], v2 offset:7168
    s_waitcnt lgkmcnt(6)
    v_mfma_f32_32x32x16_bf16 v[40:55], a[8:11], v[12:15], v[40:55]
    v_mfma_f32_32x32x16_bf16 v[56:71], a[12:15], v[12:15], v[56:71]
    ds_read_b128 v[8:11], v2 offset:8192
    s_waitcnt lgkmcnt(6)
    v_mfma_f32_32x32x16_bf16 v[40:55], a[16:19], v[16:19], v[40:55]
    v_cvt_pk_bf16_f32 v104, v72, v73
    v_mfma_f32_32x32x16_bf16 v[56:71], a[20:23], v[16:19], v[56:71]
    v_cvt_pk_bf16_f32 v105, v74, v75
    ds_read_b128 v[12:15], v2 offset:9216
    s_waitcnt lgkmcnt(6)
    v_mfma_f32_32x32x16_bf16 v[40:55], a[24:27], v[20:23], v[40:55]
    v_cvt_pk_bf16_f32 v106, v76, v77
    v_mfma_f32_32x32x16_bf16 v[56:71], a[28:31], v[20:23], v[56:71]
    v_cvt_pk_bf16_f32 v107, v78, v79
    ds_read_b128 v[16:19], v2 offset:10240
    s_waitcnt lgkmcnt(6)
    v_mfma_f32_32x32x16_bf16 v[40:55], a[32:35], v[24:27], v[40:55]
    s_nop 1
    v_mfma_f32_32x32x16_bf16 v[56:71], a[36:39], v[24:27], v[56:71]
    v_permlane32_swap_b32 v104, v106
    ds_read_b128 v[20:23], v2 offset:11264
    s_waitcnt lgkmcnt(6)
    v_mfma_f32_32x32x16_bf16 v[40:55], a[40:43], v[28:31], v[40:55]
    v_permlane32_swap_b32 v105, v107
    v_mfma_f32_32x32x16_bf16 v[56:71], a[44:47], v[28:31], v[56:71]
    buffer_store_dwordx4 v[104:107], v3, s[8:11], s17 offen offset:0 sc1
    ds_read_b128 v[24:27], v2 offset:12288
    s_waitcnt lgkmcnt(6)
    v_mfma_f32_32x32x16_bf16 v[40:55], a[48:51], v[32:35], v[40:55]
    v_cvt_pk_bf16_f32 v108, v80, v81
    v_mfma_f32_32x32x16_bf16 v[56:71], a[52:55], v[32:35], v[56:71]
    v_cvt_pk_bf16_f32 v109, v82, v83
    ds_read_b128 v[28:31], v2 offset:13312
    s_waitcnt lgkmcnt(6)
    v_mfma_f32_32x32x16_bf16 v[40:55], a[56:59], v[36:39], v[40:55]
    v_cvt_pk_bf16_f32 v110, v84, v85
    v_mfma_f32_32x32x16_bf16 v[56:71], a[60:63], v[36:39], v[56:71]
    v_cvt_pk_bf16_f32 v111, v86, v87
    ds_read_b128 v[32:35], v2 offset:14336
    s_waitcnt lgkmcnt(6)
    v_mfma_f32_32x32x16_bf16 v[40:55], a[64:67], v[8:11], v[40:55]
    s_nop 1
    v_mfma_f32_32x32x16_bf16 v[56:71], a[68:71], v[8:11], v[56:71]
    v_permlane32_swap_b32 v108, v110
    ds_read_b128 v[36:39], v2 offset:15360
    s_waitcnt lgkmcnt(6)
    v_mfma_f32_32x32x16_bf16 v[40:55], a[72:75], v[12:15], v[40:55]
    v_permlane32_swap_b32 v109, v111
    v_mfma_f32_32x32x16_bf16 v[56:71], a[76:79], v[12:15], v[56:71]
    buffer_store_dwordx4 v[108:111], v3, s[8:11], s17 offen offset:1024 sc1
    ds_read_b128 v[8:11], v2 offset:16384
    s_waitcnt lgkmcnt(6)
    v_mfma_f32_32x32x16_bf16 v[40:55], a[80:83], v[16:19], v[40:55]
    v_cvt_pk_bf16_f32 v112, v88, v89
    v_mfma_f32_32x32x16_bf16 v[56:71], a[84:87], v[16:19], v[56:71]
    v_cvt_pk_bf16_f32 v113, v90, v91
    ds_read_b128 v[12:15], v2 offset:17408
    s_waitcnt lgkmcnt(6)
    v_mfma_f32_32x32x16_bf16 v[40:55], a[88:91], v[20:23], v[40:55]
    v_cvt_pk_bf16_f32 v114, v92, v93
    v_mfma_f32_32x32x16_bf16 v[56:71], a[92:95], v[20:23], v[56:71]
    v_cvt_pk_bf16_f32 v115, v94, v95
    ds_read_b128 v[16:19], v2 offset:18432
    s_waitcnt lgkmcnt(6)
    v_mfma_f32_32x32x16_bf16 v[40:55], a[96:99], v[24:27], v[40:55]
    s_nop 1
    v_mfma_f32_32x32x16_bf16 v[56:71], a[100:103], v[24:27], v[56:71]
    v_permlane32_swap_b32 v112, v114
    ds_read_b128 v[20:23], v2 offset:19456
    s_waitcnt lgkmcnt(6)
    v_mfma_f32_32x32x16_bf16 v[40:55], a[104:107], v[28:31], v[40:55]
    v_permlane32_swap_b32 v113, v115
    v_mfma_f32_32x32x16_bf16 v[56:71], a[108:111], v[28:31], v[56:71]
    buffer_store_dwordx4 v[112:115], v3, s[8:11], s18 offen offset:0 sc1
    ds_read_b128 v[24:27], v2 offset:20480
    s_waitcnt lgkmcnt(6)
    v_mfma_f32_32x32x16_bf16 v[40:55], a[112:115], v[32:35], v[40:55]
    v_cvt_pk_bf16_f32 v116, v96, v97
    v_mfma_f32_32x32x16_bf16 v[56:71], a[116:119], v[32:35], v[56:71]
    v_cvt_pk_bf16_f32 v117, v98, v99
    ds_read_b128 v[28:31], v2 offset:21504
    s_waitcnt lgkmcnt(6)
    v_mfma_f32_32x32x16_bf16 v[40:55], a[120:123], v[36:39], v[40:55]
    v_cvt_pk_bf16_f32 v118, v100, v101
    v_mfma_f32_32x32x16_bf16 v[56:71], a[124:127], v[36:39], v[56:71]
    v_cvt_pk_bf16_f32 v119, v102, v103
    ds_read_b128 v[32:35], v2 offset:22528
    s_waitcnt lgkmcnt(6)
    v_mfma_f32_32x32x16_bf16 v[40:55], a[128:131], v[8:11], v[40:55]
    s_nop 1
    v_mfma_f32_32x32x16_bf16 v[56:71], a[132:135], v[8:11], v[56:71]
    v_permlane32_swap_b32 v116, v118
    ds_read_b128 v[36:39], v2 offset:23552
    s_waitcnt lgkmcnt(6)
    v_mfma_f32_32x32x16_bf16 v[40:55], a[136:139], v[12:15], v[40:55]
    v_permlane32_swap_b32 v117, v119
    v_mfma_f32_32x32x16_bf16 v[56:71], a[140:143], v[12:15], v[56:71]
    buffer_store_dwordx4 v[116:119], v3, s[8:11], s18 offen offset:1024 sc1
    ds_read_b128 v[8:11], v2 offset:24576
    s_waitcnt lgkmcnt(6)
    v_mfma_f32_32x32x16_bf16 v[40:55], a[144:147], v[16:19], v[40:55]
    s_add_u32 s17, s17, s20
    v_mfma_f32_32x32x16_bf16 v[56:71], a[148:151], v[16:19], v[56:71]
    s_add_u32 s18, s18, s20
    ds_read_b128 v[12:15], v2 offset:25600
    s_waitcnt lgkmcnt(6)
    v_mfma_f32_32x32x16_bf16 v[40:55], a[152:155], v[20:23], v[40:55]
    v_mfma_f32_32x32x16_bf16 v[56:71], a[156:159], v[20:23], v[56:71]
    ds_read_b128 v[16:19], v2 offset:26624
    s_waitcnt lgkmcnt(6)
    v_mfma_f32_32x32x16_bf16 v[40:55], a[160:163], v[24:27], v[40:55]
    v_mfma_f32_32x32x16_bf16 v[56:71], a[164:167], v[24:27], v[56:71]
    ds_read_b128 v[20:23], v2 offset:27648
    s_waitcnt lgkmcnt(6)
    v_mfma_f32_32x32x16_bf16 v[40:55], a[168:171], v[28:31], v[40:55]
    v_mfma_f32_32x32x16_bf16 v[56:71], a[172:175], v[28:31], v[56:71]
    ds_read_b128 v[24:27], v2 offset:28672
    s_waitcnt lgkmcnt(6)
    v_mfma_f32_32x32x16_bf16 v[40:55], a[176:179], v[32:35], v[40:55]
    v_mfma_f32_32x32x16_bf16 v[56:71], a[180:183], v[32:35], v[56:71]
    ds_read_b128 v[28:31], v2 offset:29696
    s_waitcnt lgkmcnt(6)
    v_mfma_f32_32x32x16_bf16 v[40:55], a[184:187], v[36:39], v[40:55]
    v_mfma_f32_32x32x16_bf16 v[56:71], a[188:191], v[36:39], v[56:71]
    ds_read_b128 v[32:35], v2 offset:30720
    s_waitcnt lgkmcnt(6)
    v_mfma_f32_32x32x16_bf16 v[40:55], a[192:195], v[8:11], v[40:55]
    v_mfma_f32_32x32x16_bf16 v[56:71], a[196:199], v[8:11], v[56:71]
    ds_read_b128 v[36:39], v2 offset:31744
    s_waitcnt lgkmcnt(6)
    v_mfma_f32_32x32x16_bf16 v[40:55], a[200:203], v[12:15], v[40:55]
    v_mfma_f32_32x32x16_bf16 v[56:71], a[204:207], v[12:15], v[56:71]
    ds_read_b128 v[8:11], v2 offset:32768
    s_waitcnt lgkmcnt(6)
    v_mfma_f32_32x32x16_bf16 v[40:55], a[208:211], v[16:19], v[40:55]
    v_mfma_f32_32x32x16_bf16 v[56:71], a[212:215], v[16:19], v[56:71]
    ds_read_b128 v[12:15], v2 offset:33792
    s_waitcnt lgkmcnt(6)
    v_mfma_f32_32x32x16_bf16 v[40:55], a[216:219], v[20:23], v[40:55]
    v_mfma_f32_32x32x16_bf16 v[56:71], a[220:223], v[20:23], v[56:71]
    ds_read_b128 v[16:19], v2 offset:34816
    s_waitcnt lgkmcnt(6)
    v_mfma_f32_32x32x16_bf16 v[40:55], a[224:227], v[24:27], v[40:55]
    v_mfma_f32_32x32x16_bf16 v[56:71], a[228:231], v[24:27], v[56:71]
    s_add_u32 s23, s14, 2
    s_cmp_lg_u32 s13, 0
    s_cbranch_scc1 layerb1_kernel_gk_lw5
    s_min_u32 s28, s23, 63
    s_cmp_gt_u32 s56, s28
    s_cbranch_scc1 layerb1_kernel_gk_lw5
layerb1_kernel_gk_lp5:
    buffer_load_dwordx4 v[124:127], v1, s[8:11], s57 offen sc1
    s_waitcnt vmcnt(0)
    v_min_u32 v124, v124, v125
    v_min_u32 v126, v126, v127
    v_min_u32 v124, v124, v126
    v_cmp_eq_u32 vcc, 0, v124
    s_nop 1
    s_ff1_i32_b64 s56, vcc
    s_min_u32 s56, s56, 64
    s_sub_u32 s58, s58, 1
    s_cbranch_scc1 layerb1_kernel_bail
    s_cmp_gt_u32 s56, s28
    s_cbranch_scc0 layerb1_kernel_gk_lp5
layerb1_kernel_gk_lw5:
    s_cmp_gt_u32 s14, 5
    s_cbranch_scc1 layerb1_kernel_gk_dr6
    s_waitcnt vmcnt(0)
    s_mov_b32 s27, s14
    s_branch layerb1_kernel_gk_dq6
layerb1_kernel_gk_dr6:
    s_waitcnt vmcnt(4)
    s_sub_u32 s27, s14, 1
layerb1_kernel_gk_dq6:
    s_barrier
    s_cmp_lg_u32 s13, 0
    s_cbranch_scc1 layerb1_kernel_gk_fl7
    s_mov_b64 exec, 1
    s_lshl_b32 s26, s12, 7
    v_mov_b32 v7, s26
    v_mov_b32 v120, s27
    buffer_store_dword v120, v7, s[8:11], s48 offen sc1
    s_mov_b64 exec, -1
layerb1_kernel_gk_fl7:
    s_add_u32 s21, s16, 40960
    s_cmp_eq_u32 s21, 122880
    s_cselect_b32 s21, 0, s21
    s_add_u32 s23, s14, 2
    s_min_u32 s24, s23, 63
    s_mul_i32 s24, s24, 40960
    s_add_u32 s24, s24, s19
    s_mul_i32 s25, s13, 10240
    s_add_u32 s25, s25, s22
    s_add_u32 s22, s22, 40960
    s_cmp_eq_u32 s22, 122880
    s_cselect_b32 s22, 0, s22
    ds_read_b128 v[20:23], v2 offset:35840
    s_waitcnt lgkmcnt(6)
    v_mfma_f32_32x32x16_bf16 v[40:55], a[232:235], v[28:31], v[40:55]
    s_mov_b32 m0, s25
    s_nop 0
    buffer_load_dwordx4 v1, s[8:11], s24 offen offset:0 sc1 lds
    v_mfma_f32_32x32x16_bf16 v[56:71], a[236:239], v[28:31], v[56:71]
    ds_read_b128 v[24:27], v2 offset:36864
    s_waitcnt lgkmcnt(6)
    v_mfma_f32_32x32x16_bf16 v[40:55], a[240:243], v[32:35], v[40:55]
    buffer_load_dwordx4 v1, s[8:11], s24 offen offset:1024 sc1 lds
    v_mfma_f32_32x32x16_bf16 v[56:71], a[244:247], v[32:35], v[56:71]
    ds_read_b128 v[28:31], v2 offset:37888
    s_waitcnt lgkmcnt(6)
    v_mfma_f32_32x32x16_bf16 v[40:55], a[248:251], v[36:39], v[40:55]
    buffer_load_dwordx4 v1, s[8:11], s24 offen offset:2048 sc1 lds
    v_mfma_f32_32x32x16_bf16 v[56:71], a[252:255], v[36:39], v[56:71]
    ds_read_b128 v[32:35], v2 offset:38912
    s_waitcnt lgkmcnt(6)
    v_mfma_f32_32x32x16_bf16 v[40:55], v[192:195], v[8:11], v[40:55]
    buffer_load_dwordx4 v1, s[8:11], s24 offen offset:3072 sc1 lds
    v_mfma_f32_32x32x16_bf16 v[56:71], v[196:199], v[8:11], v[56:71]
    ds_read_b128 v[36:39], v2 offset:39936
    s_waitcnt lgkmcnt(6)
    v_mfma_f32_32x32x16_bf16 v[40:55], v[200:203], v[12:15], v[40:55]
    s_add_u32 s24, s24, 4096
    s_add_u32 s25, s25, 4096
    s_mov_b32 m0, s25
    s_nop 0
    buffer_load_dwordx4 v1, s[8:11], s24 offen offset:0 sc1 lds
    v_mfma_f32_32x32x16_bf16 v[56:71], v[204:207], v[12:15], v[56:71]
    v_add_u32 v6, s21, v1
    ds_read_b128 v[8:11], v6 offset:0
    s_waitcnt lgkmcnt(6)
    v_mfma_f32_32x32x16_bf16 v[40:55], v[208:211], v[16:19], v[40:55]
    buffer_load_dwordx4 v1, s[8:11], s24 offen offset:1024 sc1 lds
    v_mfma_f32_32x32x16_bf16 v[56:71], v[212:215], v[16:19], v[56:71]
    ds_read_b128 v[12:15], v6 offset:1024
    s_waitcnt lgkmcnt(6)
    v_mfma_f32_32x32x16_bf16 v[40:55], v[216:219], v[20:23], v[40:55]
    buffer_load_dwordx4 v1, s[8:11], s24 offen offset:2048 sc1 lds
    v_mfma_f32_32x32x16_bf16 v[56:71], v[220:223], v[20:23], v[56:71]
    ds_read_b128 v[16:19], v6 offset:2048
    s_waitcnt lgkmcnt(6)
    v_mfma_f32_32x32x16_bf16 v[40:55], v[224:227], v[24:27], v[40:55]
    buffer_load_dwordx4 v1, s[8:11], s24 offen offset:3072 sc1 lds
    v_mfma_f32_32x32x16_bf16 v[56:71], v[228:231], v[24:27], v[56:71]
    ds_read_b128 v[20:23], v6 offset:3072
    s_waitcnt lgkmcnt(6)
    v_mfma_f32_32x32x16_bf16 v[40:55], v[232:235], v[28:31], v[40:55]
    s_add_u32 s24, s24, 4096
    s_add_u32 s25, s25, 4096
    s_mov_b32 m0, s25
    s_nop 0
    buffer_load_dwordx4 v1, s[8:11], s24 offen offset:0 sc1 lds
    v_mfma_f32_32x32x16_bf16 v[56:71], v[236:239], v[28:31], v[56:71]
    ds_read_b128 v[24:27], v6 offset:4096
    s_waitcnt lgkmcnt(6)
    v_mfma_f32_32x32x16_bf16 v[40:55], v[240:243], v[32:35], v[40:55]
    buffer_load_dwordx4 v1, s[8:11], s24 offen offset:1024 sc1 lds
    v_mfma_f32_32x32x16_bf16 v[56:71], v[244:247], v[32:35], v[56:71]
    ds_read_b128 v[28:31], v6 offset:5120
    s_waitcnt lgkmcnt(6)
    v_mfma_f32_32x32x16_bf16 v[40:55], v[248:251], v[36:39], v[40:55]
    v_mfma_f32_32x32x16_bf16 v[56:71], v[252:255], v[36:39], v[56:71]
    v_mov_b32 v2, v6
    s_mov_b32 s16, s21
    s_add_u32 s14, s14, 1
    s_cmp_ge_u32 s14, s15
    s_cbranch_scc1 layerb1_kernel_gk_fin0
    ds_read_b128 v[32:35], v2 offset:6144
    s_waitcnt lgkmcnt(6)
    v_mfma_f32_32x32x16_bf16 v[72:87], a[0:3], v[8:11], 0
    v_mfma_f32_32x32x16_bf16 v[88:103], a[4:7], v[8:11], 0
    ds_read_b128 v[36:39], v2 offset:7168
    s_waitcnt lgkmcnt(6)
    v_mfma_f32_32x32x16_bf16 v[72:87], a[8:11], v[12:15], v[72:87]
    v_mfma_f32_32x32x16_bf16 v[88:103], a[12:15], v[12:15], v[88:103]
    ds_read_b128 v[8:11], v2 offset:8192
    s_waitcnt lgkmcnt(6)
    v_mfma_f32_32x32x16_bf16 v[72:87], a[16:19], v[16:19], v[72:87]
    v_cvt_pk_bf16_f32 v104, v40, v41
    v_mfma_f32_32x32x16_bf16 v[88:103], a[20:23], v[16:19], v[88:103]
    v_cvt_pk_bf16_f32 v105, v42, v43
    ds_read_b128 v[12:15], v2 offset:9216
    s_waitcnt lgkmcnt(6)
    v_mfma_f32_32x32x16_bf16 v[72:87], a[24:27], v[20:23], v[72:87]
    v_cvt_pk_bf16_f32 v106, v44, v45
    v_mfma_f32_32x32x16_bf16 v[88:103], a[28:31], v[20:23], v[88:103]
    v_cvt_pk_bf16_f32 v107, v46, v47
    ds_read_b128 v[16:19], v2 offset:10240
    s_waitcnt lgkmcnt(6)
    v_mfma_f32_32x32x16_bf16 v[72:87], a[32:35], v[24:27], v[72:87]
    s_nop 1
    v_mfma_f32_32x32x16_bf16 v[88:103], a[36:39], v[24:27], v[88:103]
    v_permlane32_swap_b32 v104, v106
    ds_read_b128 v[20:23], v2 offset:11264
    s_waitcnt lgkmcnt(6)
    v_mfma_f32_32x32x16_bf16 v[72:87], a[40:43], v[28:31], v[72:87]
    v_permlane32_swap_b32 v105, v107
    v_mfma_f32_32x32x16_bf16 v[88:103], a[44:47], v[28:31], v[88:103]
    buffer_store_dwordx4 v[104:107], v3, s[8:11], s17 offen offset:0 sc1
    ds_read_b128 v[24:27], v2 offset:12288
    s_waitcnt lgkmcnt(6)
    v_mfma_f32_32x32x16_bf16 v[72:87], a[48:51], v[32:35], v[72:87]
    v_cvt_pk_bf16_f32 v108, v48, v49
    v_mfma_f32_32x32x16_bf16 v[88:103], a[52:55], v[32:35], v[88:103]
    v_cvt_pk_bf16_f32 v109, v50, v51
    ds_read_b128 v[28:31], v2 offset:13312
    s_waitcnt lgkmcnt(6)
    v_mfma_f32_32x32x16_bf16 v[72:87], a[56:59], v[36:39], v[72:87]
    v_cvt_pk_bf16_f32 v110, v52, v53
    v_mfma_f32_32x32x16_bf16 v[88:103], a[60:63], v[36:39], v[88:103]
    v_cvt_pk_bf16_f32 v111, v54, v55
    ds_read_b128 v[32:35], v2 offset:14336
    s_waitcnt lgkmcnt(6)
    v_mfma_f32_32x32x16_bf16 v[72:87], a[64:67], v[8:11], v[72:87]
    s_nop 1
    v_mfma_f32_32x32x16_bf16 v[88:103], a[68:71], v[8:11], v[88:103]
    v_permlane32_swap_b32 v108, v110
    ds_read_b128 v[36:39], v2 offset:15360
    s_waitcnt lgkmcnt(6)
    v_mfma_f32_32x32x16_bf16 v[72:87], a[72:75], v[12:15], v[72:87]
    v_permlane32_swap_b32 v109, v111
    v_mfma_f32_32x32x16_bf16 v[88:103], a[76:79], v[12:15], v[88:103]
    buffer_store_dwordx4 v[108:111], v3, s[8:11], s17 offen offset:1024 sc1
    ds_read_b128 v[8:11], v2 offset:16384
    s_waitcnt lgkmcnt(6)
    v_mfma_f32_32x32x16_bf16 v[72:87], a[80:83], v[16:19], v[72:87]
    v_cvt_pk_bf16_f32 v112, v56, v57
    v_mfma_f32_32x32x16_bf16 v[88:103], a[84:87], v[16:19], v[88:103]
    v_cvt_pk_bf16_f32 v113, v58, v59
    ds_read_b128 v[12:15], v2 offset:17408
    s_waitcnt lgkmcnt(6)
    v_mfma_f32_32x32x16_bf16 v[72:87], a[88:91], v[20:23], v[72:87]
    v_cvt_pk_bf16_f32 v114, v60, v61
    v_mfma_f32_32x32x16_bf16 v[88:103], a[92:95], v[20:23], v[88:103]
    v_cvt_pk_bf16_f32 v115, v62, v63
    ds_read_b128 v[16:19], v2 offset:18432
    s_waitcnt lgkmcnt(6)
    v_mfma_f32_32x32x16_bf16 v[72:87], a[96:99], v[24:27], v[72:87]
    s_nop 1
    v_mfma_f32_32x32x16_bf16 v[88:103], a[100:103], v[24:27], v[88:103]
    v_permlane32_swap_b32 v112, v114
    ds_read_b128 v[20:23], v2 offset:19456
    s_waitcnt lgkmcnt(6)
    v_mfma_f32_32x32x16_bf16 v[72:87], a[104:107], v[28:31], v[72:87]
    v_permlane32_swap_b32 v113, v115
    v_mfma_f32_32x32x16_bf16 v[88:103], a[108:111], v[28:31], v[88:103]
    buffer_store_dwordx4 v[112:115], v3, s[8:11], s18 offen offset:0 sc1
    ds_read_b128 v[24:27], v2 offset:20480
    s_waitcnt lgkmcnt(6)
    v_mfma_f32_32x32x16_bf16 v[72:87], a[112:115], v[32:35], v[72:87]
    v_cvt_pk_bf16_f32 v116, v64, v65
    v_mfma_f32_32x32x16_bf16 v[88:103], a[116:119], v[32:35], v[88:103]
    v_cvt_pk_bf16_f32 v117, v66, v67
    ds_read_b128 v[28:31], v2 offset:21504
    s_waitcnt lgkmcnt(6)
    v_mfma_f32_32x32x16_bf16 v[72:87], a[120:123], v[36:39], v[72:87]
    v_cvt_pk_bf16_f32 v118, v68, v69
    v_mfma_f32_32x32x16_bf16 v[88:103], a[124:127], v[36:39], v[88:103]
    v_cvt_pk_bf16_f32 v119, v70, v71
    ds_read_b128 v[32:35], v2 offset:22528
    s_waitcnt lgkmcnt(6)
    v_mfma_f32_32x32x16_bf16 v[72:87], a[128:131], v[8:11], v[72:87]
    s_nop 1
    v_mfma_f32_32x32x16_bf16 v[88:103], a[132:135], v[8:11], v[88:103]
    v_permlane32_swap_b32 v116, v118
    ds_read_b128 v[36:39], v2 offset:23552
    s_waitcnt lgkmcnt(6)
    v_mfma_f32_32x32x16_bf16 v[72:87], a[136:139], v[12:15], v[72:87]
    v_permlane32_swap_b32 v117, v119
    v_mfma_f32_32x32x16_bf16 v[88:103], a[140:143], v[12:15], v[88:103]
    buffer_store_dwordx4 v[116:119], v3, s[8:11], s18 offen offset:1024 sc1
    ds_read_b128 v[8:11], v2 offset:24576
    s_waitcnt lgkmcnt(6)
    v_mfma_f32_32x32x16_bf16 v[72:87], a[144:147], v[16:19], v[72:87]
    s_add_u32 s17, s17, s20
    v_mfma_f32_32x32x16_bf16 v[88:103], a[148:151], v[16:19], v[88:103]
    s_add_u32 s18, s18, s20
    ds_read_b128 v[12:15], v2 offset:25600
    s_waitcnt lgkmcnt(6)
    v_mfma_f32_32x32x16_bf16 v[72:87], a[152:155], v[20:23], v[72:87]
    v_mfma_f32_32x32x16_bf16 v[88:103], a[156:159], v[20:23], v[88:103]
    ds_read_b128 v[16:19], v2 offset:26624
    s_waitcnt lgkmcnt(6)
    v_mfma_f32_32x32x16_bf16 v[72:87], a[160:163], v[24:27], v[72:87]
    v_mfma_f32_32x32x16_bf16 v[88:103], a[164:167], v[24:27], v[88:103]
    ds_read_b128 v[20:23], v2 offset:27648
    s_waitcnt lgkmcnt(6)
    v_mfma_f32_32x32x16_bf16 v[72:87], a[168:171], v[28:31], v[72:87]
    v_mfma_f32_32x32x16_bf16 v[88:103], a[172:175], v[28:31], v[88:103]
    ds_read_b128 v[24:27], v2 offset:28672
    s_waitcnt lgkmcnt(6)
    v_mfma_f32_32x32x16_bf16 v[72:87], a[176:179], v[32:35], v[72:87]
    v_mfma_f32_32x32x16_bf16 v[88:103], a[180:183], v[32:35], v[88:103]
    ds_read_b128 v[28:31], v2 offset:29696
    s_waitcnt lgkmcnt(6)
    v_mfma_f32_32x32x16_bf16 v[72:87], a[184:187], v[36:39], v[72:87]
    v_mfma_f32_32x32x16_bf16 v[88:103], a[188:191], v[36:39], v[88:103]
    ds_read_b128 v[32:35], v2 offset:30720
    s_waitcnt lgkmcnt(6)
    v_mfma_f32_32x32x16_bf16 v[72:87], a[192:195], v[8:11], v[72:87]
    v_mfma_f32_32x32x16_bf16 v[88:103], a[196:199], v[8:11], v[88:103]
    ds_read_b128 v[36:39], v2 offset:31744
    s_waitcnt lgkmcnt(6)
    v_mfma_f32_32x32x16_bf16 v[72:87], a[200:203], v[12:15], v[72:87]
    v_mfma_f32_32x32x16_bf16 v[88:103], a[204:207], v[12:15], v[88:103]
    ds_read_b128 v[8:11], v2 offset:32768
    s_waitcnt lgkmcnt(6)
    v_mfma_f32_32x32x16_bf16 v[72:87], a[208:211], v[16:19], v[72:87]
    v_mfma_f32_32x32x16_bf16 v[88:103], a[212:215], v[16:19], v[88:103]
    ds_read_b128 v[12:15], v2 offset:33792
    s_waitcnt lgkmcnt(6)
    v_mfma_f32_32x32x16_bf16 v[72:87], a[216:219], v[20:23], v[72:87]
    v_mfma_f32_32x32x16_bf16 v[88:103], a[220:223], v[20:23], v[88:103]
    ds_read_b128 v[16:19], v2 offset:34816
    s_waitcnt lgkmcnt(6)
    v_mfma_f32_32x32x16_bf16 v[72:87], a[224:227], v[24:27], v[72:87]
    v_mfma_f32_32x32x16_bf16 v[88:103], a[228:231], v[24:27], v[88:103]
    s_add_u32 s23, s14, 2
    s_cmp_lg_u32 s13, 0
    s_cbranch_scc1 layerb1_kernel_gk_lw8
    s_min_u32 s28, s23, 63
    s_cmp_gt_u32 s56, s28
    s_cbranch_scc1 layerb1_kernel_gk_lw8
layerb1_kernel_gk_lp8:
    buffer_load_dwordx4 v[124:127], v1, s[8:11], s57 offen sc1
    s_waitcnt vmcnt(0)
    v_min_u32 v124, v124, v125
    v_min_u32 v126, v126, v127
    v_min_u32 v124, v124, v126
    v_cmp_eq_u32 vcc, 0, v124
    s_nop 1
    s_ff1_i32_b64 s56, vcc
    s_min_u32 s56, s56, 64
    s_sub_u32 s58, s58, 1
    s_cbranch_scc1 layerb1_kernel_bail
    s_cmp_gt_u32 s56, s28
    s_cbranch_scc0 layerb1_kernel_gk_lp8
layerb1_kernel_gk_lw8:
    s_cmp_gt_u32 s14, 5
    s_cbranch_scc1 layerb1_kernel_gk_dr9
    s_waitcnt vmcnt(0)
    s_mov_b32 s27, s14
    s_branch layerb1_kernel_gk_dq9
layerb1_kernel_gk_dr9:
    s_waitcnt vmcnt(4)
    s_sub_u32 s27, s14, 1
layerb1_kernel_gk_dq9:
    s_barrier
    s_cmp_lg_u32 s13, 0
    s_cbranch_scc1 layerb1_kernel_gk_fl10
    s_mov_b64 exec, 1
    s_lshl_b32 s26, s12, 7
    v_mov_b32 v7, s26
    v_mov_b32 v120, s27
    buffer_store_dword v120, v7, s[8:11], s48 offen sc1
    s_mov_b64 exec, -1
layerb1_kernel_gk_fl10:
    s_add_u32 s21, s16, 40960
    s_cmp_eq_u32 s21, 122880
    s_cselect_b32 s21, 0, s21
    s_add_u32 s23, s14, 2
    s_min_u32 s24, s23, 63
    s_mul_i32 s24, s24, 40960
    s_add_u32 s24, s24, s19
    s_mul_i32 s25, s13, 10240
    s_add_u32 s25, s25, s22
    s_add_u32 s22, s22, 40960
    s_cmp_eq_u32 s22, 122880
    s_cselect_b32 s22, 0, s22
    ds_read_b128 v[20:23], v2 offset:35840
    s_waitcnt lgkmcnt(6)
    v_mfma_f32_32x32x16_bf16 v[72:87], a[232:235], v[28:31], v[72:87]
    s_mov_b32 m0, s25
    s_nop 0
    buffer_load_dwordx4 v1, s[8:11], s24 offen offset:0 sc1 lds
    v_mfma_f32_32x32x16_bf16 v[88:103], a[236:239], v[28:31], v[88:103]
    ds_read_b128 v[24:27], v2 offset:36864
    s_waitcnt lgkmcnt(6)
    v_mfma_f32_32x32x16_bf16 v[72:87], a[240:243], v[32:35], v[72:87]
    buffer_load_dwordx4 v1, s[8:11], s24 offen offset:1024 sc1 lds
    v_mfma_f32_32x32x16_bf16 v[88:103], a[244:247], v[32:35], v[88:103]
    ds_read_b128 v[28:31], v2 offset:37888
    s_waitcnt lgkmcnt(6)
    v_mfma_f32_32x32x16_bf16 v[72:87], a[248:251], v[36:39], v[72:87]
    buffer_load_dwordx4 v1, s[8:11], s24 offen offset:2048 sc1 lds
    v_mfma_f32_32x32x16_bf16 v[88:103], a[252:255], v[36:39], v[88:103]
    ds_read_b128 v[32:35], v2 offset:38912
    s_waitcnt lgkmcnt(6)
    v_mfma_f32_32x32x16_bf16 v[72:87], v[192:195], v[8:11], v[72:87]
    buffer_load_dwordx4 v1, s[8:11], s24 offen offset:3072 sc1 lds
    v_mfma_f32_32x32x16_bf16 v[88:103], v[196:199], v[8:11], v[88:103]
    ds_read_b128 v[36:39], v2 offset:39936
    s_waitcnt lgkmcnt(6)
    v_mfma_f32_32x32x16_bf16 v[72:87], v[200:203], v[12:15], v[72:87]
    s_add_u32 s24, s24, 4096
    s_add_u32 s25, s25, 4096
    s_mov_b32 m0, s25
    s_nop 0
    buffer_load_dwordx4 v1, s[8:11], s24 offen offset:0 sc1 lds
    v_mfma_f32_32x32x16_bf16 v[88:103], v[204:207], v[12:15], v[88:103]
    v_add_u32 v6, s21, v1
    ds_read_b128 v[8:11], v6 offset:0
    s_waitcnt lgkmcnt(6)
    v_mfma_f32_32x32x16_bf16 v[72:87], v[208:211], v[16:19], v[72:87]
    buffer_load_dwordx4 v1, s[8:11], s24 offen offset:1024 sc1 lds
    v_mfma_f32_32x32x16_bf16 v[88:103], v[212:215], v[16:19], v[88:103]
    ds_read_b128 v[12:15], v6 offset:1024
    s_waitcnt lgkmcnt(6)
    v_mfma_f32_32x32x16_bf16 v[72:87], v[216:219], v[20:23], v[72:87]
    buffer_load_dwordx4 v1, s[8:11], s24 offen offset:2048 sc1 lds
    v_mfma_f32_32x32x16_bf16 v[88:103], v[220:223], v[20:23], v[88:103]
    ds_read_b128 v[16:19], v6 offset:2048
    s_waitcnt lgkmcnt(6)
    v_mfma_f32_32x32x16_bf16 v[72:87], v[224:227], v[24:27], v[72:87]
    buffer_load_dwordx4 v1, s[8:11], s24 offen offset:3072 sc1 lds
    v_mfma_f32_32x32x16_bf16 v[88:103], v[228:231], v[24:27], v[88:103]
    ds_read_b128 v[20:23], v6 offset:3072
    s_waitcnt lgkmcnt(6)
    v_mfma_f32_32x32x16_bf16 v[72:87], v[232:235], v[28:31], v[72:87]
    s_add_u32 s24, s24, 4096
    s_add_u32 s25, s25, 4096
    s_mov_b32 m0, s25
    s_nop 0
    buffer_load_dwordx4 v1, s[8:11], s24 offen offset:0 sc1 lds
    v_mfma_f32_32x32x16_bf16 v[88:103], v[236:239], v[28:31], v[88:103]
    ds_read_b128 v[24:27], v6 offset:4096
    s_waitcnt lgkmcnt(6)
    v_mfma_f32_32x32x16_bf16 v[72:87], v[240:243], v[32:35], v[72:87]
    buffer_load_dwordx4 v1, s[8:11], s24 offen offset:1024 sc1 lds
    v_mfma_f32_32x32x16_bf16 v[88:103], v[244:247], v[32:35], v[88:103]
    ds_read_b128 v[28:31], v6 offset:5120
    s_waitcnt lgkmcnt(6)
    v_mfma_f32_32x32x16_bf16 v[72:87], v[248:251], v[36:39], v[72:87]
    v_mfma_f32_32x32x16_bf16 v[88:103], v[252:255], v[36:39], v[88:103]
    v_mov_b32 v2, v6
    s_mov_b32 s16, s21
    s_add_u32 s14, s14, 1
    s_cmp_lt_u32 s14, s15
    s_cbranch_scc1 layerb1_kernel_gk_loop
    s_branch layerb1_kernel_gk_fin1
layerb1_kernel_gk_fin0:
    s_nop 7
    s_nop 7
    v_cvt_pk_bf16_f32 v104, v40, v41
    v_cvt_pk_bf16_f32 v105, v42, v43
    v_cvt_pk_bf16_f32 v106, v44, v45
    v_cvt_pk_bf16_f32 v107, v46, v47
    s_nop 1
    v_permlane32_swap_b32 v104, v106
    v_permlane32_swap_b32 v105, v107
    buffer_store_dwordx4 v[104:107], v3, s[8:11], s17 offen offset:0 sc1
    v_cvt_pk_bf16_f32 v108, v48, v49
    v_cvt_pk_bf16_f32 v109, v50, v51
    v_cvt_pk_bf16_f32 v110, v52, v53
    v_cvt_pk_bf16_f32 v111, v54, v55
    s_nop 1
    v_permlane32_swap_b32 v108, v110
    v_permlane32_swap_b32 v109, v111
    buffer_store_dwordx4 v[108:111], v3, s[8:11], s17 offen offset:1024 sc1
    v_cvt_pk_bf16_f32 v112, v56, v57
    v_cvt_pk_bf16_f32 v113, v58, v59
    v_cvt_pk_bf16_f32 v114, v60, v61
    v_cvt_pk_bf16_f32 v115, v62, v63
    s_nop 1
    v_permlane32_swap_b32 v112, v114
    v_permlane32_swap_b32 v113, v115
    buffer_store_dwordx4 v[112:115], v3, s[8:11], s18 offen offset:0 sc1
    v_cvt_pk_bf16_f32 v116, v64, v65
    v_cvt_pk_bf16_f32 v117, v66, v67
    v_cvt_pk_bf16_f32 v118, v68, v69
    v_cvt_pk_bf16_f32 v119, v70, v71
    s_nop 1
    v_permlane32_swap_b32 v116, v118
    v_permlane32_swap_b32 v117, v119
    buffer_store_dwordx4 v[116:119], v3, s[8:11], s18 offen offset:1024 sc1
    s_add_u32 s17, s17, s20
    s_add_u32 s18, s18, s20
    s_branch layerb1_kernel_gk_done
layerb1_kernel_gk_fin1:
    s_nop 7
    s_nop 7
    v_cvt_pk_bf16_f32 v104, v72, v73
    v_cvt_pk_bf16_f32 v105, v74, v75
    v_cvt_pk_bf16_f32 v106, v76, v77
    v_cvt_pk_bf16_f32 v107, v78, v79
    s_nop 1
    v_permlane32_swap_b32 v104, v106
    v_permlane32_swap_b32 v105, v107
    buffer_store_dwordx4 v[104:107], v3, s[8:11], s17 offen offset:0 sc1
    v_cvt_pk_bf16_f32 v108, v80, v81
    v_cvt_pk_bf16_f32 v109, v82, v83
    v_cvt_pk_bf16_f32 v110, v84, v85
    v_cvt_pk_bf16_f32 v111, v86, v87
    s_nop 1
    v_permlane32_swap_b32 v108, v110
    v_permlane32_swap_b32 v109, v111
    buffer_store_dwordx4 v[108:111], v3, s[8:11], s17 offen offset:1024 sc1
    v_cvt_pk_bf16_f32 v112, v88, v89
    v_cvt_pk_bf16_f32 v113, v90, v91
    v_cvt_pk_bf16_f32 v114, v92, v93
    v_cvt_pk_bf16_f32 v115, v94, v95
    s_nop 1
    v_permlane32_swap_b32 v112, v114
    v_permlane32_swap_b32 v113, v115
    buffer_store_dwordx4 v[112:115], v3, s[8:11], s18 offen offset:0 sc1
    v_cvt_pk_bf16_f32 v116, v96, v97
    v_cvt_pk_bf16_f32 v117, v98, v99
    v_cvt_pk_bf16_f32 v118, v100, v101
    v_cvt_pk_bf16_f32 v119, v102, v103
    s_nop 1
    v_permlane32_swap_b32 v116, v118
    v_permlane32_swap_b32 v117, v119
    buffer_store_dwordx4 v[116:119], v3, s[8:11], s18 offen offset:1024 sc1
    s_add_u32 s17, s17, s20
    s_add_u32 s18, s18, s20
layerb1_kernel_gk_done:
    s_waitcnt vmcnt(0) lgkmcnt(0)
    s_barrier
    s_cmp_lg_u32 s13, 0
    s_cbranch_scc1 layerb1_kernel_gk_fl11
    s_mov_b64 exec, 1
    s_lshl_b32 s26, s12, 7
    v_mov_b32 v7, s26
    v_mov_b32 v120, s14
    buffer_store_dword v120, v7, s[8:11], s48 offen sc1
    s_mov_b64 exec, -1
layerb1_kernel_gk_fl11:
layerb1_kernel_g_done:
    s_branch layerb1_kernel_w3
layerb1_kernel_spare:
    s_sub_u32 s22, s20, 1
    s_mul_i32 s22, s22, 5
    s_add_u32 s22, s22, s21
    s_sub_u32 s22, s22, 27
    s_cmp_ge_u32 s21, 27
    s_cselect_b32 s22, s22, 15
    s_cmp_lt_u32 s22, 5
    s_cbranch_scc1 layerb1_kernel_sp_ab
    s_cmp_lt_u32 s22, 9
    s_cbranch_scc1 layerb1_kernel_sp_ln
    s_cmp_eq_u32 s22, 9
    s_cbranch_scc0 layerb1_kernel_w3
    s_load_dwordx2 s[24:25], s[0:1], 32
    s_lshl_b32 s26, s13, 6
    v_add_u32 v1, s26, v0
    s_waitcnt lgkmcnt(0)
    s_mov_b32 s28, s24
    s_mov_b32 s29, s25
    s_mov_b32 s30, 10240
    s_mov_b32 s31, 0x00020000
    v_add_u32 v2, 0, v1
    v_and_b32 v3, 7, v2
    v_mul_u32_u24 v3, 1280, v3
    v_lshrrev_b32 v4, 3, v2
    v_lshl_add_u32 v3, v4, 4, v3
    v_lshlrev_b32 v5, 4, v2
    v_add_u32 v5, 20480, v5
    v_lshrrev_b32 v6, 13, v5
    v_lshlrev_b32 v6, 14, v6
    v_and_b32 v5, 8191, v5
    v_add_u32 v5, v5, v6
    v_cmp_gt_u32 vcc, 640, v2
    s_and_saveexec_b64 s[32:33], vcc
    s_cbranch_execz layerb1_kernel_m0s0
    buffer_load_dwordx4 v[8:11], v3, s[28:31], 0 offen
    s_waitcnt vmcnt(0)
    buffer_store_dwordx4 v[8:11], v5, s[8:11], s16 offen sc1
layerb1_kernel_m0s0:
    s_mov_b64 exec, s[32:33]
    v_add_u32 v2, 256, v1
    v_and_b32 v3, 7, v2
    v_mul_u32_u24 v3, 1280, v3
    v_lshrrev_b32 v4, 3, v2
    v_lshl_add_u32 v3, v4, 4, v3
    v_lshlrev_b32 v5, 4, v2
    v_add_u32 v5, 20480, v5
    v_lshrrev_b32 v6, 13, v5
    v_lshlrev_b32 v6, 14, v6
    v_and_b32 v5, 8191, v5
    v_add_u32 v5, v5, v6
    v_cmp_gt_u32 vcc, 640, v2
    s_and_saveexec_b64 s[32:33], vcc
    s_cbranch_execz layerb1_kernel_m0s1
    buffer_load_dwordx4 v[8:11], v3, s[28:31], 0 offen
    s_waitcnt vmcnt(0)
    buffer_store_dwordx4 v[8:11], v5, s[8:11], s16 offen sc1
layerb1_kernel_m0s1:
    s_mov_b64 exec, s[32:33]
    v_add_u32 v2, 512, v1
    v_and_b32 v3, 7, v2
    v_mul_u32_u24 v3, 1280, v3
    v_lshrrev_b32 v4, 3, v2
    v_lshl_add_u32 v3, v4, 4, v3
    v_lshlrev_b32 v5, 4, v2
    v_add_u32 v5, 20480, v5
    v_lshrrev_b32 v6, 13, v5
    v_lshlrev_b32 v6, 14, v6
    v_and_b32 v5, 8191, v5
    v_add_u32 v5, v5, v6
    v_cmp_gt_u32 vcc, 640, v2
    s_and_saveexec_b64 s[32:33], vcc
    s_cbranch_execz layerb1_kernel_m0s2
    buffer_load_dwordx4 v[8:11], v3, s[28:31], 0 offen
    s_waitcnt vmcnt(0)
    buffer_store_dwordx4 v[8:11], v5, s[8:11], s16 offen sc1
layerb1_kernel_m0s2:
    s_mov_b64 exec, s[32:33]
    s_waitcnt vmcnt(0)
    s_branch layerb1_kernel_w3
layerb1_kernel_sp_ab:
    s_mov_b32 s12, s22
    s_mov_b32 s14, 0
    s_mov_b32 s15, 64
    s_load_dwordx2 s[52:53], s[0:1], 0
    v_lshlrev_b32 v1, 4, v0
    s_lshl_b32 s21, s12, 2
    s_add_u32 s21, s21, s13
    s_add_u32 s24, s4, 247463936
    s_addc_u32 s25, s5, 0
    s_waitcnt lgkmcnt(0)
    s_cmp_eq_u32 s49, 0
    s_cselect_b32 s52, s52, s24
    s_cselect_b32 s53, s53, s25
    s_mov_b32 s54, 2621440
    s_mov_b32 s55, 0x00020000
    v_and_b32 v6, 31, v0
    v_lshrrev_b32 v7, 5, v0
    v_mul_u32_u24 v6, 1280, v6
    v_lshl_add_u32 v3, v7, 4, v6
    s_mul_i32 s19, s14, 40960
    s_lshl_b32 s24, s21, 6
    s_add_u32 s19, s19, s24
    s_lshl_b32 s20, s14, 7
    s_lshl_b32 s24, s21, 2
    s_add_u32 s20, s20, s24
    s_add_u32 s20, s20, 36864
    v_mov_b32 v5, 1
    v_mov_b32 v4, 0
    s_mul_i32 s18, s13, 10240
    s_add_u32 s18, s18, 229638144
    s_mov_b32 s17, 0
    buffer_load_dwordx4 v[96:99], v3, s[52:55], s19 offen offset:0
    buffer_load_dwordx4 v[100:103], v3, s[52:55], s19 offen offset:32
    s_mul_i32 s24, s21, 40960
    s_add_u32 s24, s24, 246415360
    s_add_u32 s24, s24, 4096
    s_add_u32 s24, s24, 4096
    s_add_u32 s24, s24, 4096
    s_add_u32 s24, s24, 4096
    s_add_u32 s24, s24, 4096
    s_add_u32 s24, s24, 4096
    s_add_u32 s24, s24, 4096
    s_add_u32 s24, s24, 4096
    s_add_u32 s24, s24, 4096
    s_mov_b32 s22, 0
    s_mov_b32 s30, 400000
    s_add_u32 s29, s48, 49152
    v_lshlrev_b32 v112, 3, v0
    s_cmp_lg_u32 s13, 0
    s_cbranch_scc1 layerb1_kernel_ab_ow1
    s_min_u32 s28, s14, 63
    s_cmp_gt_u32 s22, s28
    s_cbranch_scc1 layerb1_kernel_ab_ow1
layerb1_kernel_ab_op1:
    buffer_load_dwordx4 v[116:119], v1, s[8:11], s29 offen sc1
    s_waitcnt vmcnt(0)
    v_min_u32 v116, v116, v117
    v_min_u32 v118, v118, v119
    v_min_u32 v114, v116, v118
    v_cmp_eq_u32 vcc, 0, v114
    s_nop 1
    s_ff1_i32_b64 s22, vcc
    s_min_u32 s22, s22, 64
    s_and_b32 s22, s22, 0x7c
    s_sub_u32 s30, s30, 1
    s_cbranch_scc1 layerb1_kernel_bail
    s_cmp_gt_u32 s22, s28
    s_cbranch_scc0 layerb1_kernel_ab_op1
layerb1_kernel_ab_ow1:
    s_barrier
    s_min_u32 s24, s14, 63
    s_mul_i32 s24, s24, 40960
    s_add_u32 s24, s24, s18
    s_mul_i32 s25, s13, 10240
    s_add_u32 s25, s25, s17
    s_mov_b32 m0, s25
    s_nop 0
    buffer_load_dwordx4 v1, s[8:11], s24 offen offset:0 sc1 lds
    buffer_load_dwordx4 v1, s[8:11], s24 offen offset:1024 sc1 lds
    buffer_load_dwordx4 v1, s[8:11], s24 offen offset:2048 sc1 lds
    buffer_load_dwordx4 v1, s[8:11], s24 offen offset:3072 sc1 lds
    s_add_u32 s24, s24, 4096
    s_add_u32 s25, s25, 4096
    s_mov_b32 m0, s25
    s_nop 0
    buffer_load_dwordx4 v1, s[8:11], s24 offen offset:0 sc1 lds
    buffer_load_dwordx4 v1, s[8:11], s24 offen offset:1024 sc1 lds
    buffer_load_dwordx4 v1, s[8:11], s24 offen offset:2048 sc1 lds
    buffer_load_dwordx4 v1, s[8:11], s24 offen offset:3072 sc1 lds
    s_add_u32 s24, s24, 4096
    s_add_u32 s25, s25, 4096
    s_mov_b32 m0, s25
    s_nop 0
    buffer_load_dwordx4 v1, s[8:11], s24 offen offset:0 sc1 lds
    buffer_load_dwordx4 v1, s[8:11], s24 offen offset:1024 sc1 lds
    s_mov_b32 s17, 40960
    s_add_u32 s23, s14, 1
    s_cmp_lg_u32 s13, 0
    s_cbranch_scc1 layerb1_kernel_ab_ow2
    s_min_u32 s28, s23, 63
    s_cmp_gt_u32 s22, s28
    s_cbranch_scc1 layerb1_kernel_ab_ow2
layerb1_kernel_ab_op2:
    buffer_load_dwordx4 v[116:119], v1, s[8:11], s29 offen sc1
    s_waitcnt vmcnt(0)
    v_min_u32 v116, v116, v117
    v_min_u32 v118, v118, v119
    v_min_u32 v114, v116, v118
    v_cmp_eq_u32 vcc, 0, v114
    s_nop 1
    s_ff1_i32_b64 s22, vcc
    s_min_u32 s22, s22, 64
    s_and_b32 s22, s22, 0x7c
    s_sub_u32 s30, s30, 1
    s_cbranch_scc1 layerb1_kernel_bail
    s_cmp_gt_u32 s22, s28
    s_cbranch_scc0 layerb1_kernel_ab_op2
layerb1_kernel_ab_ow2:
    s_barrier
    s_min_u32 s24, s23, 63
    s_mul_i32 s24, s24, 40960
    s_add_u32 s24, s24, s18
    s_mul_i32 s25, s13, 10240
    s_add_u32 s25, s25, s17
    s_mov_b32 m0, s25
    s_nop 0
    buffer_load_dwordx4 v1, s[8:11], s24 offen offset:0 sc1 lds
    buffer_load_dwordx4 v1, s[8:11], s24 offen offset:1024 sc1 lds
    buffer_load_dwordx4 v1, s[8:11], s24 offen offset:2048 sc1 lds
    buffer_load_dwordx4 v1, s[8:11], s24 offen offset:3072 sc1 lds
    s_add_u32 s24, s24, 4096
    s_add_u32 s25, s25, 4096
    s_mov_b32 m0, s25
    s_nop 0
    buffer_load_dwordx4 v1, s[8:11], s24 offen offset:0 sc1 lds
    buffer_load_dwordx4 v1, s[8:11], s24 offen offset:1024 sc1 lds
    buffer_load_dwordx4 v1, s[8:11], s24 offen offset:2048 sc1 lds
    buffer_load_dwordx4 v1, s[8:11], s24 offen offset:3072 sc1 lds
    s_add_u32 s24, s24, 4096
    s_add_u32 s25, s25, 4096
    s_mov_b32 m0, s25
    s_nop 0
    buffer_load_dwordx4 v1, s[8:11], s24 offen offset:0 sc1 lds
    buffer_load_dwordx4 v1, s[8:11], s24 offen offset:1024 sc1 lds
    s_mov_b32 s17, 81920
    s_mov_b32 s16, 0
    s_waitcnt vmcnt(10)
    s_add_u32 s23, s14, 2
    s_cmp_lg_u32 s13, 0
    s_cbranch_scc1 layerb1_kernel_ab_ow3
    s_min_u32 s28, s23, 63
    s_cmp_gt_u32 s22, s28
    s_cbranch_scc1 layerb1_kernel_ab_ow3
layerb1_kernel_ab_op3:
    buffer_load_dwordx4 v[116:119], v1, s[8:11], s29 offen sc1
    s_waitcnt vmcnt(0)
    v_min_u32 v116, v116, v117
    v_min_u32 v118, v118, v119
    v_min_u32 v114, v116, v118
    v_cmp_eq_u32 vcc, 0, v114
    s_nop 1
    s_ff1_i32_b64 s22, vcc
    s_min_u32 s22, s22, 64
    s_and_b32 s22, s22, 0x7c
    s_sub_u32 s30, s30, 1
    s_cbranch_scc1 layerb1_kernel_bail
    s_cmp_gt_u32 s22, s28
    s_cbranch_scc0 layerb1_kernel_ab_op3
layerb1_kernel_ab_ow3:
    s_barrier
    v_add_u32 v2, s16, v1
    ds_read_b128 v[16:19], v2 offset:0
    ds_read_b128 v[20:23], v2 offset:1024
    ds_read_b128 v[24:27], v2 offset:2048
    ds_read_b128 v[28:31], v2 offset:3072
    ds_read_b128 v[32:35], v2 offset:4096
    ds_read_b128 v[36:39], v2 offset:5120
    s_add_u32 s27, s19, 40960
    s_cmp_ge_u32 s14, 63
    s_cselect_b32 s27, s19, s27
    buffer_load_dwordx4 v[104:107], v3, s[52:55], s27 offen offset:0
    buffer_load_dwordx4 v[108:111], v3, s[52:55], s27 offen offset:32
    s_add_u32 s23, s14, 2
    s_min_u32 s24, s23, 63
    s_mul_i32 s24, s24, 40960
    s_add_u32 s24, s24, s18
    s_mul_i32 s25, s13, 10240
    s_add_u32 s25, s25, s17
    s_add_u32 s17, s17, 40960
    s_cmp_eq_u32 s17, 122880
    s_cselect_b32 s17, 0, s17
    ds_read_b128 v[40:43], v2 offset:6144
    s_waitcnt lgkmcnt(6)
    v_mfma_f32_32x32x16_bf16 v[48:63], a[0:3], v[16:19], 0
    ds_read_b128 v[44:47], v2 offset:7168
    s_waitcnt lgkmcnt(6)
    v_mfma_f32_32x32x16_bf16 v[64:79], a[4:7], v[20:23], 0
    s_mov_b32 m0, s25
    s_nop 0
    buffer_load_dwordx4 v1, s[8:11], s24 offen offset:0 sc1 lds
    ds_read_b128 v[16:19], v2 offset:8192
    s_waitcnt lgkmcnt(6)
    v_mfma_f32_32x32x16_bf16 v[48:63], a[8:11], v[24:27], v[48:63]
    ds_read_b128 v[20:23], v2 offset:9216
    s_waitcnt lgkmcnt(6)
    v_mfma_f32_32x32x16_bf16 v[64:79], a[12:15], v[28:31], v[64:79]
    ds_read_b128 v[24:27], v2 offset:10240
    s_waitcnt lgkmcnt(6)
    v_mfma_f32_32x32x16_bf16 v[48:63], a[16:19], v[32:35], v[48:63]
    buffer_load_dwordx4 v1, s[8:11], s24 offen offset:1024 sc1 lds
    ds_read_b128 v[28:31], v2 offset:11264
    s_waitcnt lgkmcnt(6)
    v_mfma_f32_32x32x16_bf16 v[64:79], a[20:23], v[36:39], v[64:79]
    ds_read_b128 v[32:35], v2 offset:12288
    s_waitcnt lgkmcnt(6)
    v_mfma_f32_32x32x16_bf16 v[48:63], a[24:27], v[40:43], v[48:63]
    ds_read_b128 v[36:39], v2 offset:13312
    s_waitcnt lgkmcnt(6)
    v_mfma_f32_32x32x16_bf16 v[64:79], a[28:31], v[44:47], v[64:79]
    buffer_load_dwordx4 v1, s[8:11], s24 offen offset:2048 sc1 lds
    ds_read_b128 v[40:43], v2 offset:14336
    s_waitcnt lgkmcnt(6)
    v_mfma_f32_32x32x16_bf16 v[48:63], a[32:35], v[16:19], v[48:63]
    ds_read_b128 v[44:47], v2 offset:15360
    s_waitcnt lgkmcnt(6)
    v_mfma_f32_32x32x16_bf16 v[64:79], a[36:39], v[20:23], v[64:79]
    ds_read_b128 v[16:19], v2 offset:16384
    s_waitcnt lgkmcnt(6)
    v_mfma_f32_32x32x16_bf16 v[48:63], a[40:43], v[24:27], v[48:63]
    buffer_load_dwordx4 v1, s[8:11], s24 offen offset:3072 sc1 lds
    ds_read_b128 v[20:23], v2 offset:17408
    s_waitcnt lgkmcnt(6)
    v_mfma_f32_32x32x16_bf16 v[64:79], a[44:47], v[28:31], v[64:79]
    ds_read_b128 v[24:27], v2 offset:18432
    s_waitcnt lgkmcnt(6)
    v_mfma_f32_32x32x16_bf16 v[48:63], a[48:51], v[32:35], v[48:63]
    ds_read_b128 v[28:31], v2 offset:19456
    s_waitcnt lgkmcnt(6)
    v_mfma_f32_32x32x16_bf16 v[64:79], a[52:55], v[36:39], v[64:79]
    s_add_u32 s24, s24, 4096
    s_add_u32 s25, s25, 4096
    s_mov_b32 m0, s25
    s_nop 0
    buffer_load_dwordx4 v1, s[8:11], s24 offen offset:0 sc1 lds
    ds_read_b128 v[32:35], v2 offset:20480
    s_waitcnt lgkmcnt(6)
    v_mfma_f32_32x32x16_bf16 v[48:63], a[56:59], v[40:43], v[48:63]
    ds_read_b128 v[36:39], v2 offset:21504
    s_waitcnt lgkmcnt(6)
    v_mfma_f32_32x32x16_bf16 v[64:79], a[60:63], v[44:47], v[64:79]
    ds_read_b128 v[40:43], v2 offset:22528
    s_waitcnt lgkmcnt(6)
    v_mfma_f32_32x32x16_bf16 v[48:63], a[64:67], v[16:19], v[48:63]
    buffer_load_dwordx4 v1, s[8:11], s24 offen offset:1024 sc1 lds
    ds_read_b128 v[44:47], v2 offset:23552
    s_waitcnt lgkmcnt(6)
    v_mfma_f32_32x32x16_bf16 v[64:79], a[68:71], v[20:23], v[64:79]
    ds_read_b128 v[16:19], v2 offset:24576
    s_waitcnt lgkmcnt(6)
    v_mfma_f32_32x32x16_bf16 v[48:63], a[72:75], v[24:27], v[48:63]
    ds_read_b128 v[20:23], v2 offset:25600
    s_waitcnt lgkmcnt(6)
    v_mfma_f32_32x32x16_bf16 v[64:79], a[76:79], v[28:31], v[64:79]
    buffer_load_dwordx4 v1, s[8:11], s24 offen offset:2048 sc1 lds
    ds_read_b128 v[24:27], v2 offset:26624
    s_waitcnt lgkmcnt(6)
    v_mfma_f32_32x32x16_bf16 v[48:63], a[80:83], v[32:35], v[48:63]
    ds_read_b128 v[28:31], v2 offset:27648
    s_waitcnt lgkmcnt(6)
    v_mfma_f32_32x32x16_bf16 v[64:79], a[84:87], v[36:39], v[64:79]
    ds_read_b128 v[32:35], v2 offset:28672
    s_waitcnt lgkmcnt(6)
    v_mfma_f32_32x32x16_bf16 v[48:63], a[88:91], v[40:43], v[48:63]
    buffer_load_dwordx4 v1, s[8:11], s24 offen offset:3072 sc1 lds
    ds_read_b128 v[36:39], v2 offset:29696
    s_waitcnt lgkmcnt(6)
    v_mfma_f32_32x32x16_bf16 v[64:79], a[92:95], v[44:47], v[64:79]
    ds_read_b128 v[40:43], v2 offset:30720
    s_waitcnt lgkmcnt(6)
    v_mfma_f32_32x32x16_bf16 v[48:63], a[96:99], v[16:19], v[48:63]
    ds_read_b128 v[44:47], v2 offset:31744
    s_waitcnt lgkmcnt(6)
    v_mfma_f32_32x32x16_bf16 v[64:79], a[100:103], v[20:23], v[64:79]
    s_add_u32 s24, s24, 4096
    s_add_u32 s25, s25, 4096
    s_mov_b32 m0, s25
    s_nop 0
    buffer_load_dwordx4 v1, s[8:11], s24 offen offset:0 sc1 lds
    ds_read_b128 v[16:19], v2 offset:32768
    s_waitcnt lgkmcnt(6)
    v_mfma_f32_32x32x16_bf16 v[48:63], a[104:107], v[24:27], v[48:63]
    ds_read_b128 v[20:23], v2 offset:33792
    s_waitcnt lgkmcnt(6)
    v_mfma_f32_32x32x16_bf16 v[64:79], a[108:111], v[28:31], v[64:79]
    ds_read_b128 v[24:27], v2 offset:34816
    s_waitcnt lgkmcnt(6)
    v_mfma_f32_32x32x16_bf16 v[48:63], a[112:115], v[32:35], v[48:63]
    buffer_load_dwordx4 v1, s[8:11], s24 offen offset:1024 sc1 lds
    ds_read_b128 v[28:31], v2 offset:35840
    s_waitcnt lgkmcnt(6)
    v_mfma_f32_32x32x16_bf16 v[64:79], a[116:119], v[36:39], v[64:79]
    ds_read_b128 v[32:35], v2 offset:36864
    s_waitcnt lgkmcnt(6)
    v_mfma_f32_32x32x16_bf16 v[48:63], a[120:123], v[40:43], v[48:63]
    ds_read_b128 v[36:39], v2 offset:37888
    s_waitcnt lgkmcnt(6)
    v_mfma_f32_32x32x16_bf16 v[64:79], a[124:127], v[44:47], v[64:79]
    ds_read_b128 v[40:43], v2 offset:38912
    s_waitcnt lgkmcnt(6)
    v_mfma_f32_32x32x16_bf16 v[48:63], a[128:131], v[16:19], v[48:63]
    ds_read_b128 v[44:47], v2 offset:39936
    s_waitcnt lgkmcnt(6)
    v_mfma_f32_32x32x16_bf16 v[64:79], a[132:135], v[20:23], v[64:79]
    s_waitcnt lgkmcnt(5)
    v_mfma_f32_32x32x16_bf16 v[48:63], a[136:139], v[24:27], v[48:63]
    s_waitcnt lgkmcnt(4)
    v_mfma_f32_32x32x16_bf16 v[64:79], a[140:143], v[28:31], v[64:79]
    s_waitcnt lgkmcnt(3)
    v_mfma_f32_32x32x16_bf16 v[48:63], a[144:147], v[32:35], v[48:63]
    s_waitcnt lgkmcnt(2)
    v_mfma_f32_32x32x16_bf16 v[64:79], a[148:151], v[36:39], v[64:79]
    s_waitcnt lgkmcnt(1)
    v_mfma_f32_32x32x16_bf16 v[48:63], a[152:155], v[40:43], v[48:63]
    s_waitcnt lgkmcnt(0)
    v_mfma_f32_32x32x16_bf16 v[64:79], a[156:159], v[44:47], v[64:79]
    s_waitcnt vmcnt(12)
    s_nop 7
    s_nop 3
    v_add_f32 v48, v48, v64
    v_add_f32 v49, v49, v65
    v_add_f32 v50, v50, v66
    v_add_f32 v51, v51, v67
    v_add_f32 v52, v52, v68
    v_add_f32 v53, v53, v69
    v_add_f32 v54, v54, v70
    v_add_f32 v55, v55, v71
    v_add_f32 v56, v56, v72
    v_add_f32 v57, v57, v73
    v_add_f32 v58, v58, v74
    v_add_f32 v59, v59, v75
    v_add_f32 v60, v60, v76
    v_add_f32 v61, v61, v77
    v_add_f32 v62, v62, v78
    v_add_f32 v63, v63, v79
    s_add_u32 s26, s19, 226492416
    v_cvt_pk_bf16_f32 v80, v48, v49
    v_cvt_pk_bf16_f32 v81, v50, v51
    v_cvt_pk_bf16_f32 v82, v52, v53
    v_cvt_pk_bf16_f32 v83, v54, v55
    s_nop 1
    v_permlane32_swap_b32 v80, v82
    v_permlane32_swap_b32 v81, v83
    s_nop 1
    v_lshlrev_b32 v88, 16, v80
    v_and_b32 v89, 0xffff0000, v80
    v_lshlrev_b32 v90, 16, v96
    v_and_b32 v91, 0xffff0000, v96
    v_add_f32 v88, v88, v90
    v_add_f32 v89, v89, v91
    v_cvt_pk_bf16_f32 v80, v88, v89
    v_lshlrev_b32 v92, 16, v81
    v_and_b32 v93, 0xffff0000, v81
    v_lshlrev_b32 v94, 16, v97
    v_and_b32 v95, 0xffff0000, v97
    v_add_f32 v92, v92, v94
    v_add_f32 v93, v93, v95
    v_cvt_pk_bf16_f32 v81, v92, v93
    v_lshlrev_b32 v88, 16, v82
    v_and_b32 v89, 0xffff0000, v82
    v_lshlrev_b32 v90, 16, v98
    v_and_b32 v91, 0xffff0000, v98
    v_add_f32 v88, v88, v90
    v_add_f32 v89, v89, v91
    v_cvt_pk_bf16_f32 v82, v88, v89
    v_lshlrev_b32 v92, 16, v83
    v_and_b32 v93, 0xffff0000, v83
    v_lshlrev_b32 v94, 16, v99
    v_and_b32 v95, 0xffff0000, v99
    v_add_f32 v92, v92, v94
    v_add_f32 v93, v93, v95
    v_cvt_pk_bf16_f32 v83, v92, v93
    buffer_store_dwordx4 v[80:83], v3, s[8:11], s26 offen offset:0 sc1
    v_cvt_pk_bf16_f32 v84, v56, v57
    v_cvt_pk_bf16_f32 v85, v58, v59
    v_cvt_pk_bf16_f32 v86, v60, v61
    v_cvt_pk_bf16_f32 v87, v62, v63
    s_nop 1
    v_permlane32_swap_b32 v84, v86
    v_permlane32_swap_b32 v85, v87
    s_nop 1
    v_lshlrev_b32 v88, 16, v84
    v_and_b32 v89, 0xffff0000, v84
    v_lshlrev_b32 v90, 16, v100
    v_and_b32 v91, 0xffff0000, v100
    v_add_f32 v88, v88, v90
    v_add_f32 v89, v89, v91
    v_cvt_pk_bf16_f32 v84, v88, v89
    v_lshlrev_b32 v92, 16, v85
    v_and_b32 v93, 0xffff0000, v85
    v_lshlrev_b32 v94, 16, v101
    v_and_b32 v95, 0xffff0000, v101
    v_add_f32 v92, v92, v94
    v_add_f32 v93, v93, v95
    v_cvt_pk_bf16_f32 v85, v92, v93
    v_lshlrev_b32 v88, 16, v86
    v_and_b32 v89, 0xffff0000, v86
    v_lshlrev_b32 v90, 16, v102
    v_and_b32 v91, 0xffff0000, v102
    v_add_f32 v88, v88, v90
    v_add_f32 v89, v89, v91
    v_cvt_pk_bf16_f32 v86, v88, v89
    v_lshlrev_b32 v92, 16, v87
    v_and_b32 v93, 0xffff0000, v87
    v_lshlrev_b32 v94, 16, v103
    v_and_b32 v95, 0xffff0000, v103
    v_add_f32 v92, v92, v94
    v_add_f32 v93, v93, v95
    v_cvt_pk_bf16_f32 v87, v92, v93
    buffer_store_dwordx4 v[84:87], v3, s[8:11], s26 offen offset:32 sc1
    s_waitcnt vmcnt(0)
    s_mov_b64 exec, 1
    s_add_u32 s26, s48, s20
    buffer_store_dword v5, v4, s[8:11], s26 offen sc1
    s_mov_b64 exec, -1
    s_add_u32 s20, s20, 128
    s_add_u32 s19, s19, 40960
    s_add_u32 s16, s16, 40960
    s_cmp_eq_u32 s16, 122880
    s_cselect_b32 s16, 0, s16
    s_add_u32 s14, s14, 1
    s_cmp_ge_u32 s14, s15
    s_cbranch_scc1 layerb1_kernel_ab_fin
    s_add_u32 s23, s14, 2
    s_cmp_lg_u32 s13, 0
    s_cbranch_scc1 layerb1_kernel_ab_ow4
    s_min_u32 s28, s23, 63
    s_cmp_gt_u32 s22, s28
    s_cbranch_scc1 layerb1_kernel_ab_ow4
layerb1_kernel_ab_op4:
    buffer_load_dwordx4 v[116:119], v1, s[8:11], s29 offen sc1
    s_waitcnt vmcnt(0)
    v_min_u32 v116, v116, v117
    v_min_u32 v118, v118, v119
    v_min_u32 v114, v116, v118
    v_cmp_eq_u32 vcc, 0, v114
    s_nop 1
    s_ff1_i32_b64 s22, vcc
    s_min_u32 s22, s22, 64
    s_and_b32 s22, s22, 0x7c
    s_sub_u32 s30, s30, 1
    s_cbranch_scc1 layerb1_kernel_bail
    s_cmp_gt_u32 s22, s28
    s_cbranch_scc0 layerb1_kernel_ab_op4
layerb1_kernel_ab_ow4:
    s_barrier
    v_add_u32 v2, s16, v1
    ds_read_b128 v[16:19], v2 offset:0
    ds_read_b128 v[20:23], v2 offset:1024
    ds_read_b128 v[24:27], v2 offset:2048
    ds_read_b128 v[28:31], v2 offset:3072
    ds_read_b128 v[32:35], v2 offset:4096
    ds_read_b128 v[36:39], v2 offset:5120
    s_add_u32 s27, s19, 40960
    s_cmp_ge_u32 s14, 63
    s_cselect_b32 s27, s19, s27
    buffer_load_dwordx4 v[96:99], v3, s[52:55], s27 offen offset:0
    buffer_load_dwordx4 v[100:103], v3, s[52:55], s27 offen offset:32
    s_add_u32 s23, s14, 2
    s_min_u32 s24, s23, 63
    s_mul_i32 s24, s24, 40960
    s_add_u32 s24, s24, s18
    s_mul_i32 s25, s13, 10240
    s_add_u32 s25, s25, s17
    s_add_u32 s17, s17, 40960
    s_cmp_eq_u32 s17, 122880
    s_cselect_b32 s17, 0, s17
    ds_read_b128 v[40:43], v2 offset:6144
    s_waitcnt lgkmcnt(6)
    v_mfma_f32_32x32x16_bf16 v[48:63], a[0:3], v[16:19], 0
    ds_read_b128 v[44:47], v2 offset:7168
    s_waitcnt lgkmcnt(6)
    v_mfma_f32_32x32x16_bf16 v[64:79], a[4:7], v[20:23], 0
    s_mov_b32 m0, s25
    s_nop 0
    buffer_load_dwordx4 v1, s[8:11], s24 offen offset:0 sc1 lds
    ds_read_b128 v[16:19], v2 offset:8192
    s_waitcnt lgkmcnt(6)
    v_mfma_f32_32x32x16_bf16 v[48:63], a[8:11], v[24:27], v[48:63]
    ds_read_b128 v[20:23], v2 offset:9216
    s_waitcnt lgkmcnt(6)
    v_mfma_f32_32x32x16_bf16 v[64:79], a[12:15], v[28:31], v[64:79]
    ds_read_b128 v[24:27], v2 offset:10240
    s_waitcnt lgkmcnt(6)
    v_mfma_f32_32x32x16_bf16 v[48:63], a[16:19], v[32:35], v[48:63]
    buffer_load_dwordx4 v1, s[8:11], s24 offen offset:1024 sc1 lds
    ds_read_b128 v[28:31], v2 offset:11264
    s_waitcnt lgkmcnt(6)
    v_mfma_f32_32x32x16_bf16 v[64:79], a[20:23], v[36:39], v[64:79]
    ds_read_b128 v[32:35], v2 offset:12288
    s_waitcnt lgkmcnt(6)
    v_mfma_f32_32x32x16_bf16 v[48:63], a[24:27], v[40:43], v[48:63]
    ds_read_b128 v[36:39], v2 offset:13312
    s_waitcnt lgkmcnt(6)
    v_mfma_f32_32x32x16_bf16 v[64:79], a[28:31], v[44:47], v[64:79]
    buffer_load_dwordx4 v1, s[8:11], s24 offen offset:2048 sc1 lds
    ds_read_b128 v[40:43], v2 offset:14336
    s_waitcnt lgkmcnt(6)
    v_mfma_f32_32x32x16_bf16 v[48:63], a[32:35], v[16:19], v[48:63]
    ds_read_b128 v[44:47], v2 offset:15360
    s_waitcnt lgkmcnt(6)
    v_mfma_f32_32x32x16_bf16 v[64:79], a[36:39], v[20:23], v[64:79]
    ds_read_b128 v[16:19], v2 offset:16384
    s_waitcnt lgkmcnt(6)
    v_mfma_f32_32x32x16_bf16 v[48:63], a[40:43], v[24:27], v[48:63]
    buffer_load_dwordx4 v1, s[8:11], s24 offen offset:3072 sc1 lds
    ds_read_b128 v[20:23], v2 offset:17408
    s_waitcnt lgkmcnt(6)
    v_mfma_f32_32x32x16_bf16 v[64:79], a[44:47], v[28:31], v[64:79]
    ds_read_b128 v[24:27], v2 offset:18432
    s_waitcnt lgkmcnt(6)
    v_mfma_f32_32x32x16_bf16 v[48:63], a[48:51], v[32:35], v[48:63]
    ds_read_b128 v[28:31], v2 offset:19456
    s_waitcnt lgkmcnt(6)
    v_mfma_f32_32x32x16_bf16 v[64:79], a[52:55], v[36:39], v[64:79]
    s_add_u32 s24, s24, 4096
    s_add_u32 s25, s25, 4096
    s_mov_b32 m0, s25
    s_nop 0
    buffer_load_dwordx4 v1, s[8:11], s24 offen offset:0 sc1 lds
    ds_read_b128 v[32:35], v2 offset:20480
    s_waitcnt lgkmcnt(6)
    v_mfma_f32_32x32x16_bf16 v[48:63], a[56:59], v[40:43], v[48:63]
    ds_read_b128 v[36:39], v2 offset:21504
    s_waitcnt lgkmcnt(6)
    v_mfma_f32_32x32x16_bf16 v[64:79], a[60:63], v[44:47], v[64:79]
    ds_read_b128 v[40:43], v2 offset:22528
    s_waitcnt lgkmcnt(6)
    v_mfma_f32_32x32x16_bf16 v[48:63], a[64:67], v[16:19], v[48:63]
    buffer_load_dwordx4 v1, s[8:11], s24 offen offset:1024 sc1 lds
    ds_read_b128 v[44:47], v2 offset:23552
    s_waitcnt lgkmcnt(6)
    v_mfma_f32_32x32x16_bf16 v[64:79], a[68:71], v[20:23], v[64:79]
    ds_read_b128 v[16:19], v2 offset:24576
    s_waitcnt lgkmcnt(6)
    v_mfma_f32_32x32x16_bf16 v[48:63], a[72:75], v[24:27], v[48:63]
    ds_read_b128 v[20:23], v2 offset:25600
    s_waitcnt lgkmcnt(6)
    v_mfma_f32_32x32x16_bf16 v[64:79], a[76:79], v[28:31], v[64:79]
    buffer_load_dwordx4 v1, s[8:11], s24 offen offset:2048 sc1 lds
    ds_read_b128 v[24:27], v2 offset:26624
    s_waitcnt lgkmcnt(6)
    v_mfma_f32_32x32x16_bf16 v[48:63], a[80:83], v[32:35], v[48:63]
    ds_read_b128 v[28:31], v2 offset:27648
    s_waitcnt lgkmcnt(6)
    v_mfma_f32_32x32x16_bf16 v[64:79], a[84:87], v[36:39], v[64:79]
    ds_read_b128 v[32:35], v2 offset:28672
    s_waitcnt lgkmcnt(6)
    v_mfma_f32_32x32x16_bf16 v[48:63], a[88:91], v[40:43], v[48:63]
    buffer_load_dwordx4 v1, s[8:11], s24 offen offset:3072 sc1 lds
    ds_read_b128 v[36:39], v2 offset:29696
    s_waitcnt lgkmcnt(6)
    v_mfma_f32_32x32x16_bf16 v[64:79], a[92:95], v[44:47], v[64:79]
    ds_read_b128 v[40:43], v2 offset:30720
    s_waitcnt lgkmcnt(6)
    v_mfma_f32_32x32x16_bf16 v[48:63], a[96:99], v[16:19], v[48:63]
    ds_read_b128 v[44:47], v2 offset:31744
    s_waitcnt lgkmcnt(6)
    v_mfma_f32_32x32x16_bf16 v[64:79], a[100:103], v[20:23], v[64:79]
    s_add_u32 s24, s24, 4096
    s_add_u32 s25, s25, 4096
    s_mov_b32 m0, s25
    s_nop 0
    buffer_load_dwordx4 v1, s[8:11], s24 offen offset:0 sc1 lds
    ds_read_b128 v[16:19], v2 offset:32768
    s_waitcnt lgkmcnt(6)
    v_mfma_f32_32x32x16_bf16 v[48:63], a[104:107], v[24:27], v[48:63]
    ds_read_b128 v[20:23], v2 offset:33792
    s_waitcnt lgkmcnt(6)
    v_mfma_f32_32x32x16_bf16 v[64:79], a[108:111], v[28:31], v[64:79]
    ds_read_b128 v[24:27], v2 offset:34816
    s_waitcnt lgkmcnt(6)
    v_mfma_f32_32x32x16_bf16 v[48:63], a[112:115], v[32:35], v[48:63]
    buffer_load_dwordx4 v1, s[8:11], s24 offen offset:1024 sc1 lds
    ds_read_b128 v[28:31], v2 offset:35840
    s_waitcnt lgkmcnt(6)
    v_mfma_f32_32x32x16_bf16 v[64:79], a[116:119], v[36:39], v[64:79]
    ds_read_b128 v[32:35], v2 offset:36864
    s_waitcnt lgkmcnt(6)
    v_mfma_f32_32x32x16_bf16 v[48:63], a[120:123], v[40:43], v[48:63]
    ds_read_b128 v[36:39], v2 offset:37888
    s_waitcnt lgkmcnt(6)
    v_mfma_f32_32x32x16_bf16 v[64:79], a[124:127], v[44:47], v[64:79]
    ds_read_b128 v[40:43], v2 offset:38912
    s_waitcnt lgkmcnt(6)
    v_mfma_f32_32x32x16_bf16 v[48:63], a[128:131], v[16:19], v[48:63]
    ds_read_b128 v[44:47], v2 offset:39936
    s_waitcnt lgkmcnt(6)
    v_mfma_f32_32x32x16_bf16 v[64:79], a[132:135], v[20:23], v[64:79]
    s_waitcnt lgkmcnt(5)
    v_mfma_f32_32x32x16_bf16 v[48:63], a[136:139], v[24:27], v[48:63]
    s_waitcnt lgkmcnt(4)
    v_mfma_f32_32x32x16_bf16 v[64:79], a[140:143], v[28:31], v[64:79]
    s_waitcnt lgkmcnt(3)
    v_mfma_f32_32x32x16_bf16 v[48:63], a[144:147], v[32:35], v[48:63]
    s_waitcnt lgkmcnt(2)
    v_mfma_f32_32x32x16_bf16 v[64:79], a[148:151], v[36:39], v[64:79]
    s_waitcnt lgkmcnt(1)
    v_mfma_f32_32x32x16_bf16 v[48:63], a[152:155], v[40:43], v[48:63]
    s_waitcnt lgkmcnt(0)
    v_mfma_f32_32x32x16_bf16 v[64:79], a[156:159], v[44:47], v[64:79]
    s_waitcnt vmcnt(12)
    s_nop 7
    s_nop 3
    v_add_f32 v48, v48, v64
    v_add_f32 v49, v49, v65
    v_add_f32 v50, v50, v66
    v_add_f32 v51, v51, v67
    v_add_f32 v52, v52, v68
    v_add_f32 v53, v53, v69
    v_add_f32 v54, v54, v70
    v_add_f32 v55, v55, v71
    v_add_f32 v56, v56, v72
    v_add_f32 v57, v57, v73
    v_add_f32 v58, v58, v74
    v_add_f32 v59, v59, v75
    v_add_f32 v60, v60, v76
    v_add_f32 v61, v61, v77
    v_add_f32 v62, v62, v78
    v_add_f32 v63, v63, v79
    s_add_u32 s26, s19, 226492416
    v_cvt_pk_bf16_f32 v80, v48, v49
    v_cvt_pk_bf16_f32 v81, v50, v51
    v_cvt_pk_bf16_f32 v82, v52, v53
    v_cvt_pk_bf16_f32 v83, v54, v55
    s_nop 1
    v_permlane32_swap_b32 v80, v82
    v_permlane32_swap_b32 v81, v83
    s_nop 1
    v_lshlrev_b32 v88, 16, v80
    v_and_b32 v89, 0xffff0000, v80
    v_lshlrev_b32 v90, 16, v104
    v_and_b32 v91, 0xffff0000, v104
    v_add_f32 v88, v88, v90
    v_add_f32 v89, v89, v91
    v_cvt_pk_bf16_f32 v80, v88, v89
    v_lshlrev_b32 v92, 16, v81
    v_and_b32 v93, 0xffff0000, v81
    v_lshlrev_b32 v94, 16, v105
    v_and_b32 v95, 0xffff0000, v105
    v_add_f32 v92, v92, v94
    v_add_f32 v93, v93, v95
    v_cvt_pk_bf16_f32 v81, v92, v93
    v_lshlrev_b32 v88, 16, v82
    v_and_b32 v89, 0xffff0000, v82
    v_lshlrev_b32 v90, 16, v106
    v_and_b32 v91, 0xffff0000, v106
    v_add_f32 v88, v88, v90
    v_add_f32 v89, v89, v91
    v_cvt_pk_bf16_f32 v82, v88, v89
    v_lshlrev_b32 v92, 16, v83
    v_and_b32 v93, 0xffff0000, v83
    v_lshlrev_b32 v94, 16, v107
    v_and_b32 v95, 0xffff0000, v107
    v_add_f32 v92, v92, v94
    v_add_f32 v93, v93, v95
    v_cvt_pk_bf16_f32 v83, v92, v93
    buffer_store_dwordx4 v[80:83], v3, s[8:11], s26 offen offset:0 sc1
    v_cvt_pk_bf16_f32 v84, v56, v57
    v_cvt_pk_bf16_f32 v85, v58, v59
    v_cvt_pk_bf16_f32 v86, v60, v61
    v_cvt_pk_bf16_f32 v87, v62, v63
    s_nop 1
    v_permlane32_swap_b32 v84, v86
    v_permlane32_swap_b32 v85, v87
    s_nop 1
    v_lshlrev_b32 v88, 16, v84
    v_and_b32 v89, 0xffff0000, v84
    v_lshlrev_b32 v90, 16, v108
    v_and_b32 v91, 0xffff0000, v108
    v_add_f32 v88, v88, v90
    v_add_f32 v89, v89, v91
    v_cvt_pk_bf16_f32 v84, v88, v89
    v_lshlrev_b32 v92, 16, v85
    v_and_b32 v93, 0xffff0000, v85
    v_lshlrev_b32 v94, 16, v109
    v_and_b32 v95, 0xffff0000, v109
    v_add_f32 v92, v92, v94
    v_add_f32 v93, v93, v95
    v_cvt_pk_bf16_f32 v85, v92, v93
    v_lshlrev_b32 v88, 16, v86
    v_and_b32 v89, 0xffff0000, v86
    v_lshlrev_b32 v90, 16, v110
    v_and_b32 v91, 0xffff0000, v110
    v_add_f32 v88, v88, v90
    v_add_f32 v89, v89, v91
    v_cvt_pk_bf16_f32 v86, v88, v89
    v_lshlrev_b32 v92, 16, v87
    v_and_b32 v93, 0xffff0000, v87
    v_lshlrev_b32 v94, 16, v111
    v_and_b32 v95, 0xffff0000, v111
    v_add_f32 v92, v92, v94
    v_add_f32 v93, v93, v95
    v_cvt_pk_bf16_f32 v87, v92, v93
    buffer_store_dwordx4 v[84:87], v3, s[8:11], s26 offen offset:32 sc1
    s_waitcnt vmcnt(0)
    s_mov_b64 exec, 1
    s_add_u32 s26, s48, s20
    buffer_store_dword v5, v4, s[8:11], s26 offen sc1
    s_mov_b64 exec, -1
    s_add_u32 s20, s20, 128
    s_add_u32 s19, s19, 40960
    s_add_u32 s16, s16, 40960
    s_cmp_eq_u32 s16, 122880
    s_cselect_b32 s16, 0, s16
    s_add_u32 s14, s14, 1
    s_cmp_ge_u32 s14, s15
    s_cbranch_scc1 layerb1_kernel_ab_fin
    s_add_u32 s23, s14, 2
    s_cmp_lg_u32 s13, 0
    s_cbranch_scc1 layerb1_kernel_ab_ow5
    s_min_u32 s28, s23, 63
    s_cmp_gt_u32 s22, s28
    s_cbranch_scc1 layerb1_kernel_ab_ow5
layerb1_kernel_ab_op5:
    buffer_load_dwordx4 v[116:119], v1, s[8:11], s29 offen sc1
    s_waitcnt vmcnt(0)
    v_min_u32 v116, v116, v117
    v_min_u32 v118, v118, v119
    v_min_u32 v114, v116, v118
    v_cmp_eq_u32 vcc, 0, v114
    s_nop 1
    s_ff1_i32_b64 s22, vcc
    s_min_u32 s22, s22, 64
    s_and_b32 s22, s22, 0x7c
    s_sub_u32 s30, s30, 1
    s_cbranch_scc1 layerb1_kernel_bail
    s_cmp_gt_u32 s22, s28
    s_cbranch_scc0 layerb1_kernel_ab_op5
layerb1_kernel_ab_ow5:
    s_barrier
    v_add_u32 v2, s16, v1
    ds_read_b128 v[16:19], v2 offset:0
    ds_read_b128 v[20:23], v2 offset:1024
    ds_read_b128 v[24:27], v2 offset:2048
    ds_read_b128 v[28:31], v2 offset:3072
    ds_read_b128 v[32:35], v2 offset:4096
    ds_read_b128 v[36:39], v2 offset:5120
    s_add_u32 s27, s19, 40960
    s_cmp_ge_u32 s14, 63
    s_cselect_b32 s27, s19, s27
    buffer_load_dwordx4 v[104:107], v3, s[52:55], s27 offen offset:0
    buffer_load_dwordx4 v[108:111], v3, s[52:55], s27 offen offset:32
    s_add_u32 s23, s14, 2
    s_min_u32 s24, s23, 63
    s_mul_i32 s24, s24, 40960
    s_add_u32 s24, s24, s18
    s_mul_i32 s25, s13, 10240
    s_add_u32 s25, s25, s17
    s_add_u32 s17, s17, 40960
    s_cmp_eq_u32 s17, 122880
    s_cselect_b32 s17, 0, s17
    ds_read_b128 v[40:43], v2 offset:6144
    s_waitcnt lgkmcnt(6)
    v_mfma_f32_32x32x16_bf16 v[48:63], a[0:3], v[16:19], 0
    ds_read_b128 v[44:47], v2 offset:7168
    s_waitcnt lgkmcnt(6)
    v_mfma_f32_32x32x16_bf16 v[64:79], a[4:7], v[20:23], 0
    s_mov_b32 m0, s25
    s_nop 0
    buffer_load_dwordx4 v1, s[8:11], s24 offen offset:0 sc1 lds
    ds_read_b128 v[16:19], v2 offset:8192
    s_waitcnt lgkmcnt(6)
    v_mfma_f32_32x32x16_bf16 v[48:63], a[8:11], v[24:27], v[48:63]
    ds_read_b128 v[20:23], v2 offset:9216
    s_waitcnt lgkmcnt(6)
    v_mfma_f32_32x32x16_bf16 v[64:79], a[12:15], v[28:31], v[64:79]
    ds_read_b128 v[24:27], v2 offset:10240
    s_waitcnt lgkmcnt(6)
    v_mfma_f32_32x32x16_bf16 v[48:63], a[16:19], v[32:35], v[48:63]
    buffer_load_dwordx4 v1, s[8:11], s24 offen offset:1024 sc1 lds
    ds_read_b128 v[28:31], v2 offset:11264
    s_waitcnt lgkmcnt(6)
    v_mfma_f32_32x32x16_bf16 v[64:79], a[20:23], v[36:39], v[64:79]
    ds_read_b128 v[32:35], v2 offset:12288
    s_waitcnt lgkmcnt(6)
    v_mfma_f32_32x32x16_bf16 v[48:63], a[24:27], v[40:43], v[48:63]
    ds_read_b128 v[36:39], v2 offset:13312
    s_waitcnt lgkmcnt(6)
    v_mfma_f32_32x32x16_bf16 v[64:79], a[28:31], v[44:47], v[64:79]
    buffer_load_dwordx4 v1, s[8:11], s24 offen offset:2048 sc1 lds
    ds_read_b128 v[40:43], v2 offset:14336
    s_waitcnt lgkmcnt(6)
    v_mfma_f32_32x32x16_bf16 v[48:63], a[32:35], v[16:19], v[48:63]
    ds_read_b128 v[44:47], v2 offset:15360
    s_waitcnt lgkmcnt(6)
    v_mfma_f32_32x32x16_bf16 v[64:79], a[36:39], v[20:23], v[64:79]
    ds_read_b128 v[16:19], v2 offset:16384
    s_waitcnt lgkmcnt(6)
    v_mfma_f32_32x32x16_bf16 v[48:63], a[40:43], v[24:27], v[48:63]
    buffer_load_dwordx4 v1, s[8:11], s24 offen offset:3072 sc1 lds
    ds_read_b128 v[20:23], v2 offset:17408
    s_waitcnt lgkmcnt(6)
    v_mfma_f32_32x32x16_bf16 v[64:79], a[44:47], v[28:31], v[64:79]
    ds_read_b128 v[24:27], v2 offset:18432
    s_waitcnt lgkmcnt(6)
    v_mfma_f32_32x32x16_bf16 v[48:63], a[48:51], v[32:35], v[48:63]
    ds_read_b128 v[28:31], v2 offset:19456
    s_waitcnt lgkmcnt(6)
    v_mfma_f32_32x32x16_bf16 v[64:79], a[52:55], v[36:39], v[64:79]
    s_add_u32 s24, s24, 4096
    s_add_u32 s25, s25, 4096
    s_mov_b32 m0, s25
    s_nop 0
    buffer_load_dwordx4 v1, s[8:11], s24 offen offset:0 sc1 lds
    ds_read_b128 v[32:35], v2 offset:20480
    s_waitcnt lgkmcnt(6)
    v_mfma_f32_32x32x16_bf16 v[48:63], a[56:59], v[40:43], v[48:63]
    ds_read_b128 v[36:39], v2 offset:21504
    s_waitcnt lgkmcnt(6)
    v_mfma_f32_32x32x16_bf16 v[64:79], a[60:63], v[44:47], v[64:79]
    ds_read_b128 v[40:43], v2 offset:22528
    s_waitcnt lgkmcnt(6)
    v_mfma_f32_32x32x16_bf16 v[48:63], a[64:67], v[16:19], v[48:63]
    buffer_load_dwordx4 v1, s[8:11], s24 offen offset:1024 sc1 lds
    ds_read_b128 v[44:47], v2 offset:23552
    s_waitcnt lgkmcnt(6)
    v_mfma_f32_32x32x16_bf16 v[64:79], a[68:71], v[20:23], v[64:79]
    ds_read_b128 v[16:19], v2 offset:24576
    s_waitcnt lgkmcnt(6)
    v_mfma_f32_32x32x16_bf16 v[48:63], a[72:75], v[24:27], v[48:63]
    ds_read_b128 v[20:23], v2 offset:25600
    s_waitcnt lgkmcnt(6)
    v_mfma_f32_32x32x16_bf16 v[64:79], a[76:79], v[28:31], v[64:79]
    buffer_load_dwordx4 v1, s[8:11], s24 offen offset:2048 sc1 lds
    ds_read_b128 v[24:27], v2 offset:26624
    s_waitcnt lgkmcnt(6)
    v_mfma_f32_32x32x16_bf16 v[48:63], a[80:83], v[32:35], v[48:63]
    ds_read_b128 v[28:31], v2 offset:27648
    s_waitcnt lgkmcnt(6)
    v_mfma_f32_32x32x16_bf16 v[64:79], a[84:87], v[36:39], v[64:79]
    ds_read_b128 v[32:35], v2 offset:28672
    s_waitcnt lgkmcnt(6)
    v_mfma_f32_32x32x16_bf16 v[48:63], a[88:91], v[40:43], v[48:63]
    buffer_load_dwordx4 v1, s[8:11], s24 offen offset:3072 sc1 lds
    ds_read_b128 v[36:39], v2 offset:29696
    s_waitcnt lgkmcnt(6)
    v_mfma_f32_32x32x16_bf16 v[64:79], a[92:95], v[44:47], v[64:79]
    ds_read_b128 v[40:43], v2 offset:30720
    s_waitcnt lgkmcnt(6)
    v_mfma_f32_32x32x16_bf16 v[48:63], a[96:99], v[16:19], v[48:63]
    ds_read_b128 v[44:47], v2 offset:31744
    s_waitcnt lgkmcnt(6)
    v_mfma_f32_32x32x16_bf16 v[64:79], a[100:103], v[20:23], v[64:79]
    s_add_u32 s24, s24, 4096
    s_add_u32 s25, s25, 4096
    s_mov_b32 m0, s25
    s_nop 0
    buffer_load_dwordx4 v1, s[8:11], s24 offen offset:0 sc1 lds
    ds_read_b128 v[16:19], v2 offset:32768
    s_waitcnt lgkmcnt(6)
    v_mfma_f32_32x32x16_bf16 v[48:63], a[104:107], v[24:27], v[48:63]
    ds_read_b128 v[20:23], v2 offset:33792
    s_waitcnt lgkmcnt(6)
    v_mfma_f32_32x32x16_bf16 v[64:79], a[108:111], v[28:31], v[64:79]
    ds_read_b128 v[24:27], v2 offset:34816
    s_waitcnt lgkmcnt(6)
    v_mfma_f32_32x32x16_bf16 v[48:63], a[112:115], v[32:35], v[48:63]
    buffer_load_dwordx4 v1, s[8:11], s24 offen offset:1024 sc1 lds
    ds_read_b128 v[28:31], v2 offset:35840
    s_waitcnt lgkmcnt(6)
    v_mfma_f32_32x32x16_bf16 v[64:79], a[116:119], v[36:39], v[64:79]
    ds_read_b128 v[32:35], v2 offset:36864
    s_waitcnt lgkmcnt(6)
    v_mfma_f32_32x32x16_bf16 v[48:63], a[120:123], v[40:43], v[48:63]
    ds_read_b128 v[36:39], v2 offset:37888
    s_waitcnt lgkmcnt(6)
    v_mfma_f32_32x32x16_bf16 v[64:79], a[124:127], v[44:47], v[64:79]
    ds_read_b128 v[40:43], v2 offset:38912
    s_waitcnt lgkmcnt(6)
    v_mfma_f32_32x32x16_bf16 v[48:63], a[128:131], v[16:19], v[48:63]
    ds_read_b128 v[44:47], v2 offset:39936
    s_waitcnt lgkmcnt(6)
    v_mfma_f32_32x32x16_bf16 v[64:79], a[132:135], v[20:23], v[64:79]
    s_waitcnt lgkmcnt(5)
    v_mfma_f32_32x32x16_bf16 v[48:63], a[136:139], v[24:27], v[48:63]
    s_waitcnt lgkmcnt(4)
    v_mfma_f32_32x32x16_bf16 v[64:79], a[140:143], v[28:31], v[64:79]
    s_waitcnt lgkmcnt(3)
    v_mfma_f32_32x32x16_bf16 v[48:63], a[144:147], v[32:35], v[48:63]
    s_waitcnt lgkmcnt(2)
    v_mfma_f32_32x32x16_bf16 v[64:79], a[148:151], v[36:39], v[64:79]
    s_waitcnt lgkmcnt(1)
    v_mfma_f32_32x32x16_bf16 v[48:63], a[152:155], v[40:43], v[48:63]
    s_waitcnt lgkmcnt(0)
    v_mfma_f32_32x32x16_bf16 v[64:79], a[156:159], v[44:47], v[64:79]
    s_waitcnt vmcnt(12)
    s_nop 7
    s_nop 3
    v_add_f32 v48, v48, v64
    v_add_f32 v49, v49, v65
    v_add_f32 v50, v50, v66
    v_add_f32 v51, v51, v67
    v_add_f32 v52, v52, v68
    v_add_f32 v53, v53, v69
    v_add_f32 v54, v54, v70
    v_add_f32 v55, v55, v71
    v_add_f32 v56, v56, v72
    v_add_f32 v57, v57, v73
    v_add_f32 v58, v58, v74
    v_add_f32 v59, v59, v75
    v_add_f32 v60, v60, v76
    v_add_f32 v61, v61, v77
    v_add_f32 v62, v62, v78
    v_add_f32 v63, v63, v79
    s_add_u32 s26, s19, 226492416
    v_cvt_pk_bf16_f32 v80, v48, v49
    v_cvt_pk_bf16_f32 v81, v50, v51
    v_cvt_pk_bf16_f32 v82, v52, v53
    v_cvt_pk_bf16_f32 v83, v54, v55
    s_nop 1
    v_permlane32_swap_b32 v80, v82
    v_permlane32_swap_b32 v81, v83
    s_nop 1
    v_lshlrev_b32 v88, 16, v80
    v_and_b32 v89, 0xffff0000, v80
    v_lshlrev_b32 v90, 16, v96
    v_and_b32 v91, 0xffff0000, v96
    v_add_f32 v88, v88, v90
    v_add_f32 v89, v89, v91
    v_cvt_pk_bf16_f32 v80, v88, v89
    v_lshlrev_b32 v92, 16, v81
    v_and_b32 v93, 0xffff0000, v81
    v_lshlrev_b32 v94, 16, v97
    v_and_b32 v95, 0xffff0000, v97
    v_add_f32 v92, v92, v94
    v_add_f32 v93, v93, v95
    v_cvt_pk_bf16_f32 v81, v92, v93
    v_lshlrev_b32 v88, 16, v82
    v_and_b32 v89, 0xffff0000, v82
    v_lshlrev_b32 v90, 16, v98
    v_and_b32 v91, 0xffff0000, v98
    v_add_f32 v88, v88, v90
    v_add_f32 v89, v89, v91
    v_cvt_pk_bf16_f32 v82, v88, v89
    v_lshlrev_b32 v92, 16, v83
    v_and_b32 v93, 0xffff0000, v83
    v_lshlrev_b32 v94, 16, v99
    v_and_b32 v95, 0xffff0000, v99
    v_add_f32 v92, v92, v94
    v_add_f32 v93, v93, v95
    v_cvt_pk_bf16_f32 v83, v92, v93
    buffer_store_dwordx4 v[80:83], v3, s[8:11], s26 offen offset:0 sc1
    v_cvt_pk_bf16_f32 v84, v56, v57
    v_cvt_pk_bf16_f32 v85, v58, v59
    v_cvt_pk_bf16_f32 v86, v60, v61
    v_cvt_pk_bf16_f32 v87, v62, v63
    s_nop 1
    v_permlane32_swap_b32 v84, v86
    v_permlane32_swap_b32 v85, v87
    s_nop 1
    v_lshlrev_b32 v88, 16, v84
    v_and_b32 v89, 0xffff0000, v84
    v_lshlrev_b32 v90, 16, v100
    v_and_b32 v91, 0xffff0000, v100
    v_add_f32 v88, v88, v90
    v_add_f32 v89, v89, v91
    v_cvt_pk_bf16_f32 v84, v88, v89
    v_lshlrev_b32 v92, 16, v85
    v_and_b32 v93, 0xffff0000, v85
    v_lshlrev_b32 v94, 16, v101
    v_and_b32 v95, 0xffff0000, v101
    v_add_f32 v92, v92, v94
    v_add_f32 v93, v93, v95
    v_cvt_pk_bf16_f32 v85, v92, v93
    v_lshlrev_b32 v88, 16, v86
    v_and_b32 v89, 0xffff0000, v86
    v_lshlrev_b32 v90, 16, v102
    v_and_b32 v91, 0xffff0000, v102
    v_add_f32 v88, v88, v90
    v_add_f32 v89, v89, v91
    v_cvt_pk_bf16_f32 v86, v88, v89
    v_lshlrev_b32 v92, 16, v87
    v_and_b32 v93, 0xffff0000, v87
    v_lshlrev_b32 v94, 16, v103
    v_and_b32 v95, 0xffff0000, v103
    v_add_f32 v92, v92, v94
    v_add_f32 v93, v93, v95
    v_cvt_pk_bf16_f32 v87, v92, v93
    buffer_store_dwordx4 v[84:87], v3, s[8:11], s26 offen offset:32 sc1
    s_waitcnt vmcnt(0)
    s_mov_b64 exec, 1
    s_add_u32 s26, s48, s20
    buffer_store_dword v5, v4, s[8:11], s26 offen sc1
    s_mov_b64 exec, -1
    s_add_u32 s20, s20, 128
    s_add_u32 s19, s19, 40960
    s_add_u32 s16, s16, 40960
    s_cmp_eq_u32 s16, 122880
    s_cselect_b32 s16, 0, s16
    s_add_u32 s14, s14, 1
    s_cmp_ge_u32 s14, s15
    s_cbranch_scc1 layerb1_kernel_ab_fin
    s_add_u32 s23, s14, 2
    s_cmp_lg_u32 s13, 0
    s_cbranch_scc1 layerb1_kernel_ab_ow6
    s_min_u32 s28, s23, 63
    s_cmp_gt_u32 s22, s28
    s_cbranch_scc1 layerb1_kernel_ab_ow6
layerb1_kernel_ab_op6:
    buffer_load_dwordx4 v[116:119], v1, s[8:11], s29 offen sc1
    s_waitcnt vmcnt(0)
    v_min_u32 v116, v116, v117
    v_min_u32 v118, v118, v119
    v_min_u32 v114, v116, v118
    v_cmp_eq_u32 vcc, 0, v114
    s_nop 1
    s_ff1_i32_b64 s22, vcc
    s_min_u32 s22, s22, 64
    s_and_b32 s22, s22, 0x7c
    s_sub_u32 s30, s30, 1
    s_cbranch_scc1 layerb1_kernel_bail
    s_cmp_gt_u32 s22, s28
    s_cbranch_scc0 layerb1_kernel_ab_op6
layerb1_kernel_ab_ow6:
    s_barrier
    v_add_u32 v2, s16, v1
    ds_read_b128 v[16:19], v2 offset:0
    ds_read_b128 v[20:23], v2 offset:1024
    ds_read_b128 v[24:27], v2 offset:2048
    ds_read_b128 v[28:31], v2 offset:3072
    ds_read_b128 v[32:35], v2 offset:4096
    ds_read_b128 v[36:39], v2 offset:5120
    s_add_u32 s27, s19, 40960
    s_cmp_ge_u32 s14, 63
    s_cselect_b32 s27, s19, s27
    buffer_load_dwordx4 v[96:99], v3, s[52:55], s27 offen offset:0
    buffer_load_dwordx4 v[100:103], v3, s[52:55], s27 offen offset:32
    s_add_u32 s23, s14, 2
    s_min_u32 s24, s23, 63
    s_mul_i32 s24, s24, 40960
    s_add_u32 s24, s24, s18
    s_mul_i32 s25, s13, 10240
    s_add_u32 s25, s25, s17
    s_add_u32 s17, s17, 40960
    s_cmp_eq_u32 s17, 122880
    s_cselect_b32 s17, 0, s17
    ds_read_b128 v[40:43], v2 offset:6144
    s_waitcnt lgkmcnt(6)
    v_mfma_f32_32x32x16_bf16 v[48:63], a[0:3], v[16:19], 0
    ds_read_b128 v[44:47], v2 offset:7168
    s_waitcnt lgkmcnt(6)
    v_mfma_f32_32x32x16_bf16 v[64:79], a[4:7], v[20:23], 0
    s_mov_b32 m0, s25
    s_nop 0
    buffer_load_dwordx4 v1, s[8:11], s24 offen offset:0 sc1 lds
    ds_read_b128 v[16:19], v2 offset:8192
    s_waitcnt lgkmcnt(6)
    v_mfma_f32_32x32x16_bf16 v[48:63], a[8:11], v[24:27], v[48:63]
    ds_read_b128 v[20:23], v2 offset:9216
    s_waitcnt lgkmcnt(6)
    v_mfma_f32_32x32x16_bf16 v[64:79], a[12:15], v[28:31], v[64:79]
    ds_read_b128 v[24:27], v2 offset:10240
    s_waitcnt lgkmcnt(6)
    v_mfma_f32_32x32x16_bf16 v[48:63], a[16:19], v[32:35], v[48:63]
    buffer_load_dwordx4 v1, s[8:11], s24 offen offset:1024 sc1 lds
    ds_read_b128 v[28:31], v2 offset:11264
    s_waitcnt lgkmcnt(6)
    v_mfma_f32_32x32x16_bf16 v[64:79], a[20:23], v[36:39], v[64:79]
    ds_read_b128 v[32:35], v2 offset:12288
    s_waitcnt lgkmcnt(6)
    v_mfma_f32_32x32x16_bf16 v[48:63], a[24:27], v[40:43], v[48:63]
    ds_read_b128 v[36:39], v2 offset:13312
    s_waitcnt lgkmcnt(6)
    v_mfma_f32_32x32x16_bf16 v[64:79], a[28:31], v[44:47], v[64:79]
    buffer_load_dwordx4 v1, s[8:11], s24 offen offset:2048 sc1 lds
    ds_read_b128 v[40:43], v2 offset:14336
    s_waitcnt lgkmcnt(6)
    v_mfma_f32_32x32x16_bf16 v[48:63], a[32:35], v[16:19], v[48:63]
    ds_read_b128 v[44:47], v2 offset:15360
    s_waitcnt lgkmcnt(6)
    v_mfma_f32_32x32x16_bf16 v[64:79], a[36:39], v[20:23], v[64:79]
    ds_read_b128 v[16:19], v2 offset:16384
    s_waitcnt lgkmcnt(6)
    v_mfma_f32_32x32x16_bf16 v[48:63], a[40:43], v[24:27], v[48:63]
    buffer_load_dwordx4 v1, s[8:11], s24 offen offset:3072 sc1 lds
    ds_read_b128 v[20:23], v2 offset:17408
    s_waitcnt lgkmcnt(6)
    v_mfma_f32_32x32x16_bf16 v[64:79], a[44:47], v[28:31], v[64:79]
    ds_read_b128 v[24:27], v2 offset:18432
    s_waitcnt lgkmcnt(6)
    v_mfma_f32_32x32x16_bf16 v[48:63], a[48:51], v[32:35], v[48:63]
    ds_read_b128 v[28:31], v2 offset:19456
    s_waitcnt lgkmcnt(6)
    v_mfma_f32_32x32x16_bf16 v[64:79], a[52:55], v[36:39], v[64:79]
    s_add_u32 s24, s24, 4096
    s_add_u32 s25, s25, 4096
    s_mov_b32 m0, s25
    s_nop 0
    buffer_load_dwordx4 v1, s[8:11], s24 offen offset:0 sc1 lds
    ds_read_b128 v[32:35], v2 offset:20480
    s_waitcnt lgkmcnt(6)
    v_mfma_f32_32x32x16_bf16 v[48:63], a[56:59], v[40:43], v[48:63]
    ds_read_b128 v[36:39], v2 offset:21504
    s_waitcnt lgkmcnt(6)
    v_mfma_f32_32x32x16_bf16 v[64:79], a[60:63], v[44:47], v[64:79]
    ds_read_b128 v[40:43], v2 offset:22528
    s_waitcnt lgkmcnt(6)
    v_mfma_f32_32x32x16_bf16 v[48:63], a[64:67], v[16:19], v[48:63]
    buffer_load_dwordx4 v1, s[8:11], s24 offen offset:1024 sc1 lds
    ds_read_b128 v[44:47], v2 offset:23552
    s_waitcnt lgkmcnt(6)
    v_mfma_f32_32x32x16_bf16 v[64:79], a[68:71], v[20:23], v[64:79]
    ds_read_b128 v[16:19], v2 offset:24576
    s_waitcnt lgkmcnt(6)
    v_mfma_f32_32x32x16_bf16 v[48:63], a[72:75], v[24:27], v[48:63]
    ds_read_b128 v[20:23], v2 offset:25600
    s_waitcnt lgkmcnt(6)
    v_mfma_f32_32x32x16_bf16 v[64:79], a[76:79], v[28:31], v[64:79]
    buffer_load_dwordx4 v1, s[8:11], s24 offen offset:2048 sc1 lds
    ds_read_b128 v[24:27], v2 offset:26624
    s_waitcnt lgkmcnt(6)
    v_mfma_f32_32x32x16_bf16 v[48:63], a[80:83], v[32:35], v[48:63]
    ds_read_b128 v[28:31], v2 offset:27648
    s_waitcnt lgkmcnt(6)
    v_mfma_f32_32x32x16_bf16 v[64:79], a[84:87], v[36:39], v[64:79]
    ds_read_b128 v[32:35], v2 offset:28672
    s_waitcnt lgkmcnt(6)
    v_mfma_f32_32x32x16_bf16 v[48:63], a[88:91], v[40:43], v[48:63]
    buffer_load_dwordx4 v1, s[8:11], s24 offen offset:3072 sc1 lds
    ds_read_b128 v[36:39], v2 offset:29696
    s_waitcnt lgkmcnt(6)
    v_mfma_f32_32x32x16_bf16 v[64:79], a[92:95], v[44:47], v[64:79]
    ds_read_b128 v[40:43], v2 offset:30720
    s_waitcnt lgkmcnt(6)
    v_mfma_f32_32x32x16_bf16 v[48:63], a[96:99], v[16:19], v[48:63]
    ds_read_b128 v[44:47], v2 offset:31744
    s_waitcnt lgkmcnt(6)
    v_mfma_f32_32x32x16_bf16 v[64:79], a[100:103], v[20:23], v[64:79]
    s_add_u32 s24, s24, 4096
    s_add_u32 s25, s25, 4096
    s_mov_b32 m0, s25
    s_nop 0
    buffer_load_dwordx4 v1, s[8:11], s24 offen offset:0 sc1 lds
    ds_read_b128 v[16:19], v2 offset:32768
    s_waitcnt lgkmcnt(6)
    v_mfma_f32_32x32x16_bf16 v[48:63], a[104:107], v[24:27], v[48:63]
    ds_read_b128 v[20:23], v2 offset:33792
    s_waitcnt lgkmcnt(6)
    v_mfma_f32_32x32x16_bf16 v[64:79], a[108:111], v[28:31], v[64:79]
    ds_read_b128 v[24:27], v2 offset:34816
    s_waitcnt lgkmcnt(6)
    v_mfma_f32_32x32x16_bf16 v[48:63], a[112:115], v[32:35], v[48:63]
    buffer_load_dwordx4 v1, s[8:11], s24 offen offset:1024 sc1 lds
    ds_read_b128 v[28:31], v2 offset:35840
    s_waitcnt lgkmcnt(6)
    v_mfma_f32_32x32x16_bf16 v[64:79], a[116:119], v[36:39], v[64:79]
    ds_read_b128 v[32:35], v2 offset:36864
    s_waitcnt lgkmcnt(6)
    v_mfma_f32_32x32x16_bf16 v[48:63], a[120:123], v[40:43], v[48:63]
    ds_read_b128 v[36:39], v2 offset:37888
    s_waitcnt lgkmcnt(6)
    v_mfma_f32_32x32x16_bf16 v[64:79], a[124:127], v[44:47], v[64:79]
    ds_read_b128 v[40:43], v2 offset:38912
    s_waitcnt lgkmcnt(6)
    v_mfma_f32_32x32x16_bf16 v[48:63], a[128:131], v[16:19], v[48:63]
    ds_read_b128 v[44:47], v2 offset:39936
    s_waitcnt lgkmcnt(6)
    v_mfma_f32_32x32x16_bf16 v[64:79], a[132:135], v[20:23], v[64:79]
    s_waitcnt lgkmcnt(5)
    v_mfma_f32_32x32x16_bf16 v[48:63], a[136:139], v[24:27], v[48:63]
    s_waitcnt lgkmcnt(4)
    v_mfma_f32_32x32x16_bf16 v[64:79], a[140:143], v[28:31], v[64:79]
    s_waitcnt lgkmcnt(3)
    v_mfma_f32_32x32x16_bf16 v[48:63], a[144:147], v[32:35], v[48:63]
    s_waitcnt lgkmcnt(2)
    v_mfma_f32_32x32x16_bf16 v[64:79], a[148:151], v[36:39], v[64:79]
    s_waitcnt lgkmcnt(1)
    v_mfma_f32_32x32x16_bf16 v[48:63], a[152:155], v[40:43], v[48:63]
    s_waitcnt lgkmcnt(0)
    v_mfma_f32_32x32x16_bf16 v[64:79], a[156:159], v[44:47], v[64:79]
    s_waitcnt vmcnt(12)
    s_nop 7
    s_nop 3
    v_add_f32 v48, v48, v64
    v_add_f32 v49, v49, v65
    v_add_f32 v50, v50, v66
    v_add_f32 v51, v51, v67
    v_add_f32 v52, v52, v68
    v_add_f32 v53, v53, v69
    v_add_f32 v54, v54, v70
    v_add_f32 v55, v55, v71
    v_add_f32 v56, v56, v72
    v_add_f32 v57, v57, v73
    v_add_f32 v58, v58, v74
    v_add_f32 v59, v59, v75
    v_add_f32 v60, v60, v76
    v_add_f32 v61, v61, v77
    v_add_f32 v62, v62, v78
    v_add_f32 v63, v63, v79
    s_add_u32 s26, s19, 226492416
    v_cvt_pk_bf16_f32 v80, v48, v49
    v_cvt_pk_bf16_f32 v81, v50, v51
    v_cvt_pk_bf16_f32 v82, v52, v53
    v_cvt_pk_bf16_f32 v83, v54, v55
    s_nop 1
    v_permlane32_swap_b32 v80, v82
    v_permlane32_swap_b32 v81, v83
    s_nop 1
    v_lshlrev_b32 v88, 16, v80
    v_and_b32 v89, 0xffff0000, v80
    v_lshlrev_b32 v90, 16, v104
    v_and_b32 v91, 0xffff0000, v104
    v_add_f32 v88, v88, v90
    v_add_f32 v89, v89, v91
    v_cvt_pk_bf16_f32 v80, v88, v89
    v_lshlrev_b32 v92, 16, v81
    v_and_b32 v93, 0xffff0000, v81
    v_lshlrev_b32 v94, 16, v105
    v_and_b32 v95, 0xffff0000, v105
    v_add_f32 v92, v92, v94
    v_add_f32 v93, v93, v95
    v_cvt_pk_bf16_f32 v81, v92, v93
    v_lshlrev_b32 v88, 16, v82
    v_and_b32 v89, 0xffff0000, v82
    v_lshlrev_b32 v90, 16, v106
    v_and_b32 v91, 0xffff0000, v106
    v_add_f32 v88, v88, v90
    v_add_f32 v89, v89, v91
    v_cvt_pk_bf16_f32 v82, v88, v89
    v_lshlrev_b32 v92, 16, v83
    v_and_b32 v93, 0xffff0000, v83
    v_lshlrev_b32 v94, 16, v107
    v_and_b32 v95, 0xffff0000, v107
    v_add_f32 v92, v92, v94
    v_add_f32 v93, v93, v95
    v_cvt_pk_bf16_f32 v83, v92, v93
    buffer_store_dwordx4 v[80:83], v3, s[8:11], s26 offen offset:0 sc1
    v_cvt_pk_bf16_f32 v84, v56, v57
    v_cvt_pk_bf16_f32 v85, v58, v59
    v_cvt_pk_bf16_f32 v86, v60, v61
    v_cvt_pk_bf16_f32 v87, v62, v63
    s_nop 1
    v_permlane32_swap_b32 v84, v86
    v_permlane32_swap_b32 v85, v87
    s_nop 1
    v_lshlrev_b32 v88, 16, v84
    v_and_b32 v89, 0xffff0000, v84
    v_lshlrev_b32 v90, 16, v108
    v_and_b32 v91, 0xffff0000, v108
    v_add_f32 v88, v88, v90
    v_add_f32 v89, v89, v91
    v_cvt_pk_bf16_f32 v84, v88, v89
    v_lshlrev_b32 v92, 16, v85
    v_and_b32 v93, 0xffff0000, v85
    v_lshlrev_b32 v94, 16, v109
    v_and_b32 v95, 0xffff0000, v109
    v_add_f32 v92, v92, v94
    v_add_f32 v93, v93, v95
    v_cvt_pk_bf16_f32 v85, v92, v93
    v_lshlrev_b32 v88, 16, v86
    v_and_b32 v89, 0xffff0000, v86
    v_lshlrev_b32 v90, 16, v110
    v_and_b32 v91, 0xffff0000, v110
    v_add_f32 v88, v88, v90
    v_add_f32 v89, v89, v91
    v_cvt_pk_bf16_f32 v86, v88, v89
    v_lshlrev_b32 v92, 16, v87
    v_and_b32 v93, 0xffff0000, v87
    v_lshlrev_b32 v94, 16, v111
    v_and_b32 v95, 0xffff0000, v111
    v_add_f32 v92, v92, v94
    v_add_f32 v93, v93, v95
    v_cvt_pk_bf16_f32 v87, v92, v93
    buffer_store_dwordx4 v[84:87], v3, s[8:11], s26 offen offset:32 sc1
    s_waitcnt vmcnt(0)
    s_mov_b64 exec, 1
    s_add_u32 s26, s48, s20
    buffer_store_dword v5, v4, s[8:11], s26 offen sc1
    s_mov_b64 exec, -1
    s_add_u32 s20, s20, 128
    s_add_u32 s19, s19, 40960
    s_add_u32 s16, s16, 40960
    s_cmp_eq_u32 s16, 122880
    s_cselect_b32 s16, 0, s16
    s_add_u32 s14, s14, 1
    s_cmp_ge_u32 s14, s15
    s_cbranch_scc1 layerb1_kernel_ab_fin
    s_add_u32 s23, s14, 2
    s_cmp_lg_u32 s13, 0
    s_cbranch_scc1 layerb1_kernel_ab_ow7
    s_min_u32 s28, s23, 63
    s_cmp_gt_u32 s22, s28
    s_cbranch_scc1 layerb1_kernel_ab_ow7
layerb1_kernel_ab_op7:
    buffer_load_dwordx4 v[116:119], v1, s[8:11], s29 offen sc1
    s_waitcnt vmcnt(0)
    v_min_u32 v116, v116, v117
    v_min_u32 v118, v118, v119
    v_min_u32 v114, v116, v118
    v_cmp_eq_u32 vcc, 0, v114
    s_nop 1
    s_ff1_i32_b64 s22, vcc
    s_min_u32 s22, s22, 64
    s_and_b32 s22, s22, 0x7c
    s_sub_u32 s30, s30, 1
    s_cbranch_scc1 layerb1_kernel_bail
    s_cmp_gt_u32 s22, s28
    s_cbranch_scc0 layerb1_kernel_ab_op7
layerb1_kernel_ab_ow7:
    s_barrier
    v_add_u32 v2, s16, v1
    ds_read_b128 v[16:19], v2 offset:0
    ds_read_b128 v[20:23], v2 offset:1024
    ds_read_b128 v[24:27], v2 offset:2048
    ds_read_b128 v[28:31], v2 offset:3072
    ds_read_b128 v[32:35], v2 offset:4096
    ds_read_b128 v[36:39], v2 offset:5120
    s_add_u32 s27, s19, 40960
    s_cmp_ge_u32 s14, 63
    s_cselect_b32 s27, s19, s27
    buffer_load_dwordx4 v[104:107], v3, s[52:55], s27 offen offset:0
    buffer_load_dwordx4 v[108:111], v3, s[52:55], s27 offen offset:32
    s_add_u32 s23, s14, 2
    s_min_u32 s24, s23, 63
    s_mul_i32 s24, s24, 40960
    s_add_u32 s24, s24, s18
    s_mul_i32 s25, s13, 10240
    s_add_u32 s25, s25, s17
    s_add_u32 s17, s17, 40960
    s_cmp_eq_u32 s17, 122880
    s_cselect_b32 s17, 0, s17
    ds_read_b128 v[40:43], v2 offset:6144
    s_waitcnt lgkmcnt(6)
    v_mfma_f32_32x32x16_bf16 v[48:63], a[0:3], v[16:19], 0
    ds_read_b128 v[44:47], v2 offset:7168
    s_waitcnt lgkmcnt(6)
    v_mfma_f32_32x32x16_bf16 v[64:79], a[4:7], v[20:23], 0
    s_mov_b32 m0, s25
    s_nop 0
    buffer_load_dwordx4 v1, s[8:11], s24 offen offset:0 sc1 lds
    ds_read_b128 v[16:19], v2 offset:8192
    s_waitcnt lgkmcnt(6)
    v_mfma_f32_32x32x16_bf16 v[48:63], a[8:11], v[24:27], v[48:63]
    ds_read_b128 v[20:23], v2 offset:9216
    s_waitcnt lgkmcnt(6)
    v_mfma_f32_32x32x16_bf16 v[64:79], a[12:15], v[28:31], v[64:79]
    ds_read_b128 v[24:27], v2 offset:10240
    s_waitcnt lgkmcnt(6)
    v_mfma_f32_32x32x16_bf16 v[48:63], a[16:19], v[32:35], v[48:63]
    buffer_load_dwordx4 v1, s[8:11], s24 offen offset:1024 sc1 lds
    ds_read_b128 v[28:31], v2 offset:11264
    s_waitcnt lgkmcnt(6)
    v_mfma_f32_32x32x16_bf16 v[64:79], a[20:23], v[36:39], v[64:79]
    ds_read_b128 v[32:35], v2 offset:12288
    s_waitcnt lgkmcnt(6)
    v_mfma_f32_32x32x16_bf16 v[48:63], a[24:27], v[40:43], v[48:63]
    ds_read_b128 v[36:39], v2 offset:13312
    s_waitcnt lgkmcnt(6)
    v_mfma_f32_32x32x16_bf16 v[64:79], a[28:31], v[44:47], v[64:79]
    buffer_load_dwordx4 v1, s[8:11], s24 offen offset:2048 sc1 lds
    ds_read_b128 v[40:43], v2 offset:14336
    s_waitcnt lgkmcnt(6)
    v_mfma_f32_32x32x16_bf16 v[48:63], a[32:35], v[16:19], v[48:63]
    ds_read_b128 v[44:47], v2 offset:15360
    s_waitcnt lgkmcnt(6)
    v_mfma_f32_32x32x16_bf16 v[64:79], a[36:39], v[20:23], v[64:79]
    ds_read_b128 v[16:19], v2 offset:16384
    s_waitcnt lgkmcnt(6)
    v_mfma_f32_32x32x16_bf16 v[48:63], a[40:43], v[24:27], v[48:63]
    buffer_load_dwordx4 v1, s[8:11], s24 offen offset:3072 sc1 lds
    ds_read_b128 v[20:23], v2 offset:17408
    s_waitcnt lgkmcnt(6)
    v_mfma_f32_32x32x16_bf16 v[64:79], a[44:47], v[28:31], v[64:79]
    ds_read_b128 v[24:27], v2 offset:18432
    s_waitcnt lgkmcnt(6)
    v_mfma_f32_32x32x16_bf16 v[48:63], a[48:51], v[32:35], v[48:63]
    ds_read_b128 v[28:31], v2 offset:19456
    s_waitcnt lgkmcnt(6)
    v_mfma_f32_32x32x16_bf16 v[64:79], a[52:55], v[36:39], v[64:79]
    s_add_u32 s24, s24, 4096
    s_add_u32 s25, s25, 4096
    s_mov_b32 m0, s25
    s_nop 0
    buffer_load_dwordx4 v1, s[8:11], s24 offen offset:0 sc1 lds
    ds_read_b128 v[32:35], v2 offset:20480
    s_waitcnt lgkmcnt(6)
    v_mfma_f32_32x32x16_bf16 v[48:63], a[56:59], v[40:43], v[48:63]
    ds_read_b128 v[36:39], v2 offset:21504
    s_waitcnt lgkmcnt(6)
    v_mfma_f32_32x32x16_bf16 v[64:79], a[60:63], v[44:47], v[64:79]
    ds_read_b128 v[40:43], v2 offset:22528
    s_waitcnt lgkmcnt(6)
    v_mfma_f32_32x32x16_bf16 v[48:63], a[64:67], v[16:19], v[48:63]
    buffer_load_dwordx4 v1, s[8:11], s24 offen offset:1024 sc1 lds
    ds_read_b128 v[44:47], v2 offset:23552
    s_waitcnt lgkmcnt(6)
    v_mfma_f32_32x32x16_bf16 v[64:79], a[68:71], v[20:23], v[64:79]
    ds_read_b128 v[16:19], v2 offset:24576
    s_waitcnt lgkmcnt(6)
    v_mfma_f32_32x32x16_bf16 v[48:63], a[72:75], v[24:27], v[48:63]
    ds_read_b128 v[20:23], v2 offset:25600
    s_waitcnt lgkmcnt(6)
    v_mfma_f32_32x32x16_bf16 v[64:79], a[76:79], v[28:31], v[64:79]
    buffer_load_dwordx4 v1, s[8:11], s24 offen offset:2048 sc1 lds
    ds_read_b128 v[24:27], v2 offset:26624
    s_waitcnt lgkmcnt(6)
    v_mfma_f32_32x32x16_bf16 v[48:63], a[80:83], v[32:35], v[48:63]
    ds_read_b128 v[28:31], v2 offset:27648
    s_waitcnt lgkmcnt(6)
    v_mfma_f32_32x32x16_bf16 v[64:79], a[84:87], v[36:39], v[64:79]
    ds_read_b128 v[32:35], v2 offset:28672
    s_waitcnt lgkmcnt(6)
    v_mfma_f32_32x32x16_bf16 v[48:63], a[88:91], v[40:43], v[48:63]
    buffer_load_dwordx4 v1, s[8:11], s24 offen offset:3072 sc1 lds
    ds_read_b128 v[36:39], v2 offset:29696
    s_waitcnt lgkmcnt(6)
    v_mfma_f32_32x32x16_bf16 v[64:79], a[92:95], v[44:47], v[64:79]
    ds_read_b128 v[40:43], v2 offset:30720
    s_waitcnt lgkmcnt(6)
    v_mfma_f32_32x32x16_bf16 v[48:63], a[96:99], v[16:19], v[48:63]
    ds_read_b128 v[44:47], v2 offset:31744
    s_waitcnt lgkmcnt(6)
    v_mfma_f32_32x32x16_bf16 v[64:79], a[100:103], v[20:23], v[64:79]
    s_add_u32 s24, s24, 4096
    s_add_u32 s25, s25, 4096
    s_mov_b32 m0, s25
    s_nop 0
    buffer_load_dwordx4 v1, s[8:11], s24 offen offset:0 sc1 lds
    ds_read_b128 v[16:19], v2 offset:32768
    s_waitcnt lgkmcnt(6)
    v_mfma_f32_32x32x16_bf16 v[48:63], a[104:107], v[24:27], v[48:63]
    ds_read_b128 v[20:23], v2 offset:33792
    s_waitcnt lgkmcnt(6)
    v_mfma_f32_32x32x16_bf16 v[64:79], a[108:111], v[28:31], v[64:79]
    ds_read_b128 v[24:27], v2 offset:34816
    s_waitcnt lgkmcnt(6)
    v_mfma_f32_32x32x16_bf16 v[48:63], a[112:115], v[32:35], v[48:63]
    buffer_load_dwordx4 v1, s[8:11], s24 offen offset:1024 sc1 lds
    ds_read_b128 v[28:31], v2 offset:35840
    s_waitcnt lgkmcnt(6)
    v_mfma_f32_32x32x16_bf16 v[64:79], a[116:119], v[36:39], v[64:79]
    ds_read_b128 v[32:35], v2 offset:36864
    s_waitcnt lgkmcnt(6)
    v_mfma_f32_32x32x16_bf16 v[48:63], a[120:123], v[40:43], v[48:63]
    ds_read_b128 v[36:39], v2 offset:37888
    s_waitcnt lgkmcnt(6)
    v_mfma_f32_32x32x16_bf16 v[64:79], a[124:127], v[44:47], v[64:79]
    ds_read_b128 v[40:43], v2 offset:38912
    s_waitcnt lgkmcnt(6)
    v_mfma_f32_32x32x16_bf16 v[48:63], a[128:131], v[16:19], v[48:63]
    ds_read_b128 v[44:47], v2 offset:39936
    s_waitcnt lgkmcnt(6)
    v_mfma_f32_32x32x16_bf16 v[64:79], a[132:135], v[20:23], v[64:79]
    s_waitcnt lgkmcnt(5)
    v_mfma_f32_32x32x16_bf16 v[48:63], a[136:139], v[24:27], v[48:63]
    s_waitcnt lgkmcnt(4)
    v_mfma_f32_32x32x16_bf16 v[64:79], a[140:143], v[28:31], v[64:79]
    s_waitcnt lgkmcnt(3)
    v_mfma_f32_32x32x16_bf16 v[48:63], a[144:147], v[32:35], v[48:63]
    s_waitcnt lgkmcnt(2)
    v_mfma_f32_32x32x16_bf16 v[64:79], a[148:151], v[36:39], v[64:79]
    s_waitcnt lgkmcnt(1)
    v_mfma_f32_32x32x16_bf16 v[48:63], a[152:155], v[40:43], v[48:63]
    s_waitcnt lgkmcnt(0)
    v_mfma_f32_32x32x16_bf16 v[64:79], a[156:159], v[44:47], v[64:79]
    s_waitcnt vmcnt(12)
    s_nop 7
    s_nop 3
    v_add_f32 v48, v48, v64
    v_add_f32 v49, v49, v65
    v_add_f32 v50, v50, v66
    v_add_f32 v51, v51, v67
    v_add_f32 v52, v52, v68
    v_add_f32 v53, v53, v69
    v_add_f32 v54, v54, v70
    v_add_f32 v55, v55, v71
    v_add_f32 v56, v56, v72
    v_add_f32 v57, v57, v73
    v_add_f32 v58, v58, v74
    v_add_f32 v59, v59, v75
    v_add_f32 v60, v60, v76
    v_add_f32 v61, v61, v77
    v_add_f32 v62, v62, v78
    v_add_f32 v63, v63, v79
    s_add_u32 s26, s19, 226492416
    v_cvt_pk_bf16_f32 v80, v48, v49
    v_cvt_pk_bf16_f32 v81, v50, v51
    v_cvt_pk_bf16_f32 v82, v52, v53
    v_cvt_pk_bf16_f32 v83, v54, v55
    s_nop 1
    v_permlane32_swap_b32 v80, v82
    v_permlane32_swap_b32 v81, v83
    s_nop 1
    v_lshlrev_b32 v88, 16, v80
    v_and_b32 v89, 0xffff0000, v80
    v_lshlrev_b32 v90, 16, v96
    v_and_b32 v91, 0xffff0000, v96
    v_add_f32 v88, v88, v90
    v_add_f32 v89, v89, v91
    v_cvt_pk_bf16_f32 v80, v88, v89
    v_lshlrev_b32 v92, 16, v81
    v_and_b32 v93, 0xffff0000, v81
    v_lshlrev_b32 v94, 16, v97
    v_and_b32 v95, 0xffff0000, v97
    v_add_f32 v92, v92, v94
    v_add_f32 v93, v93, v95
    v_cvt_pk_bf16_f32 v81, v92, v93
    v_lshlrev_b32 v88, 16, v82
    v_and_b32 v89, 0xffff0000, v82
    v_lshlrev_b32 v90, 16, v98
    v_and_b32 v91, 0xffff0000, v98
    v_add_f32 v88, v88, v90
    v_add_f32 v89, v89, v91
    v_cvt_pk_bf16_f32 v82, v88, v89
    v_lshlrev_b32 v92, 16, v83
    v_and_b32 v93, 0xffff0000, v83
    v_lshlrev_b32 v94, 16, v99
    v_and_b32 v95, 0xffff0000, v99
    v_add_f32 v92, v92, v94
    v_add_f32 v93, v93, v95
    v_cvt_pk_bf16_f32 v83, v92, v93
    buffer_store_dwordx4 v[80:83], v3, s[8:11], s26 offen offset:0 sc1
    v_cvt_pk_bf16_f32 v84, v56, v57
    v_cvt_pk_bf16_f32 v85, v58, v59
    v_cvt_pk_bf16_f32 v86, v60, v61
    v_cvt_pk_bf16_f32 v87, v62, v63
    s_nop 1
    v_permlane32_swap_b32 v84, v86
    v_permlane32_swap_b32 v85, v87
    s_nop 1
    v_lshlrev_b32 v88, 16, v84
    v_and_b32 v89, 0xffff0000, v84
    v_lshlrev_b32 v90, 16, v100
    v_and_b32 v91, 0xffff0000, v100
    v_add_f32 v88, v88, v90
    v_add_f32 v89, v89, v91
    v_cvt_pk_bf16_f32 v84, v88, v89
    v_lshlrev_b32 v92, 16, v85
    v_and_b32 v93, 0xffff0000, v85
    v_lshlrev_b32 v94, 16, v101
    v_and_b32 v95, 0xffff0000, v101
    v_add_f32 v92, v92, v94
    v_add_f32 v93, v93, v95
    v_cvt_pk_bf16_f32 v85, v92, v93
    v_lshlrev_b32 v88, 16, v86
    v_and_b32 v89, 0xffff0000, v86
    v_lshlrev_b32 v90, 16, v102
    v_and_b32 v91, 0xffff0000, v102
    v_add_f32 v88, v88, v90
    v_add_f32 v89, v89, v91
    v_cvt_pk_bf16_f32 v86, v88, v89
    v_lshlrev_b32 v92, 16, v87
    v_and_b32 v93, 0xffff0000, v87
    v_lshlrev_b32 v94, 16, v103
    v_and_b32 v95, 0xffff0000, v103
    v_add_f32 v92, v92, v94
    v_add_f32 v93, v93, v95
    v_cvt_pk_bf16_f32 v87, v92, v93
    buffer_store_dwordx4 v[84:87], v3, s[8:11], s26 offen offset:32 sc1
    s_waitcnt vmcnt(0)
    s_mov_b64 exec, 1
    s_add_u32 s26, s48, s20
    buffer_store_dword v5, v4, s[8:11], s26 offen sc1
    s_mov_b64 exec, -1
    s_add_u32 s20, s20, 128
    s_add_u32 s19, s19, 40960
    s_add_u32 s16, s16, 40960
    s_cmp_eq_u32 s16, 122880
    s_cselect_b32 s16, 0, s16
    s_add_u32 s14, s14, 1
    s_cmp_ge_u32 s14, s15
    s_cbranch_scc1 layerb1_kernel_ab_fin
    s_add_u32 s23, s14, 2
    s_cmp_lg_u32 s13, 0
    s_cbranch_scc1 layerb1_kernel_ab_ow8
    s_min_u32 s28, s23, 63
    s_cmp_gt_u32 s22, s28
    s_cbranch_scc1 layerb1_kernel_ab_ow8
layerb1_kernel_ab_op8:
    buffer_load_dwordx4 v[116:119], v1, s[8:11], s29 offen sc1
    s_waitcnt vmcnt(0)
    v_min_u32 v116, v116, v117
    v_min_u32 v118, v118, v119
    v_min_u32 v114, v116, v118
    v_cmp_eq_u32 vcc, 0, v114
    s_nop 1
    s_ff1_i32_b64 s22, vcc
    s_min_u32 s22, s22, 64
    s_and_b32 s22, s22, 0x7c
    s_sub_u32 s30, s30, 1
    s_cbranch_scc1 layerb1_kernel_bail
    s_cmp_gt_u32 s22, s28
    s_cbranch_scc0 layerb1_kernel_ab_op8
layerb1_kernel_ab_ow8:
    s_barrier
    v_add_u32 v2, s16, v1
    ds_read_b128 v[16:19], v2 offset:0
    ds_read_b128 v[20:23], v2 offset:1024
    ds_read_b128 v[24:27], v2 offset:2048
    ds_read_b128 v[28:31], v2 offset:3072
    ds_read_b128 v[32:35], v2 offset:4096
    ds_read_b128 v[36:39], v2 offset:5120
    s_add_u32 s27, s19, 40960
    s_cmp_ge_u32 s14, 63
    s_cselect_b32 s27, s19, s27
    buffer_load_dwordx4 v[96:99], v3, s[52:55], s27 offen offset:0
    buffer_load_dwordx4 v[100:103], v3, s[52:55], s27 offen offset:32
    s_add_u32 s23, s14, 2
    s_min_u32 s24, s23, 63
    s_mul_i32 s24, s24, 40960
    s_add_u32 s24, s24, s18
    s_mul_i32 s25, s13, 10240
    s_add_u32 s25, s25, s17
    s_add_u32 s17, s17, 40960
    s_cmp_eq_u32 s17, 122880
    s_cselect_b32 s17, 0, s17
    ds_read_b128 v[40:43], v2 offset:6144
    s_waitcnt lgkmcnt(6)
    v_mfma_f32_32x32x16_bf16 v[48:63], a[0:3], v[16:19], 0
    ds_read_b128 v[44:47], v2 offset:7168
    s_waitcnt lgkmcnt(6)
    v_mfma_f32_32x32x16_bf16 v[64:79], a[4:7], v[20:23], 0
    s_mov_b32 m0, s25
    s_nop 0
    buffer_load_dwordx4 v1, s[8:11], s24 offen offset:0 sc1 lds
    ds_read_b128 v[16:19], v2 offset:8192
    s_waitcnt lgkmcnt(6)
    v_mfma_f32_32x32x16_bf16 v[48:63], a[8:11], v[24:27], v[48:63]
    ds_read_b128 v[20:23], v2 offset:9216
    s_waitcnt lgkmcnt(6)
    v_mfma_f32_32x32x16_bf16 v[64:79], a[12:15], v[28:31], v[64:79]
    ds_read_b128 v[24:27], v2 offset:10240
    s_waitcnt lgkmcnt(6)
    v_mfma_f32_32x32x16_bf16 v[48:63], a[16:19], v[32:35], v[48:63]
    buffer_load_dwordx4 v1, s[8:11], s24 offen offset:1024 sc1 lds
    ds_read_b128 v[28:31], v2 offset:11264
    s_waitcnt lgkmcnt(6)
    v_mfma_f32_32x32x16_bf16 v[64:79], a[20:23], v[36:39], v[64:79]
    ds_read_b128 v[32:35], v2 offset:12288
    s_waitcnt lgkmcnt(6)
    v_mfma_f32_32x32x16_bf16 v[48:63], a[24:27], v[40:43], v[48:63]
    ds_read_b128 v[36:39], v2 offset:13312
    s_waitcnt lgkmcnt(6)
    v_mfma_f32_32x32x16_bf16 v[64:79], a[28:31], v[44:47], v[64:79]
    buffer_load_dwordx4 v1, s[8:11], s24 offen offset:2048 sc1 lds
    ds_read_b128 v[40:43], v2 offset:14336
    s_waitcnt lgkmcnt(6)
    v_mfma_f32_32x32x16_bf16 v[48:63], a[32:35], v[16:19], v[48:63]
    ds_read_b128 v[44:47], v2 offset:15360
    s_waitcnt lgkmcnt(6)
    v_mfma_f32_32x32x16_bf16 v[64:79], a[36:39], v[20:23], v[64:79]
    ds_read_b128 v[16:19], v2 offset:16384
    s_waitcnt lgkmcnt(6)
    v_mfma_f32_32x32x16_bf16 v[48:63], a[40:43], v[24:27], v[48:63]
    buffer_load_dwordx4 v1, s[8:11], s24 offen offset:3072 sc1 lds
    ds_read_b128 v[20:23], v2 offset:17408
    s_waitcnt lgkmcnt(6)
    v_mfma_f32_32x32x16_bf16 v[64:79], a[44:47], v[28:31], v[64:79]
    ds_read_b128 v[24:27], v2 offset:18432
    s_waitcnt lgkmcnt(6)
    v_mfma_f32_32x32x16_bf16 v[48:63], a[48:51], v[32:35], v[48:63]
    ds_read_b128 v[28:31], v2 offset:19456
    s_waitcnt lgkmcnt(6)
    v_mfma_f32_32x32x16_bf16 v[64:79], a[52:55], v[36:39], v[64:79]
    s_add_u32 s24, s24, 4096
    s_add_u32 s25, s25, 4096
    s_mov_b32 m0, s25
    s_nop 0
    buffer_load_dwordx4 v1, s[8:11], s24 offen offset:0 sc1 lds
    ds_read_b128 v[32:35], v2 offset:20480
    s_waitcnt lgkmcnt(6)
    v_mfma_f32_32x32x16_bf16 v[48:63], a[56:59], v[40:43], v[48:63]
    ds_read_b128 v[36:39], v2 offset:21504
    s_waitcnt lgkmcnt(6)
    v_mfma_f32_32x32x16_bf16 v[64:79], a[60:63], v[44:47], v[64:79]
    ds_read_b128 v[40:43], v2 offset:22528
    s_waitcnt lgkmcnt(6)
    v_mfma_f32_32x32x16_bf16 v[48:63], a[64:67], v[16:19], v[48:63]
    buffer_load_dwordx4 v1, s[8:11], s24 offen offset:1024 sc1 lds
    ds_read_b128 v[44:47], v2 offset:23552
    s_waitcnt lgkmcnt(6)
    v_mfma_f32_32x32x16_bf16 v[64:79], a[68:71], v[20:23], v[64:79]
    ds_read_b128 v[16:19], v2 offset:24576
    s_waitcnt lgkmcnt(6)
    v_mfma_f32_32x32x16_bf16 v[48:63], a[72:75], v[24:27], v[48:63]
    ds_read_b128 v[20:23], v2 offset:25600
    s_waitcnt lgkmcnt(6)
    v_mfma_f32_32x32x16_bf16 v[64:79], a[76:79], v[28:31], v[64:79]
    buffer_load_dwordx4 v1, s[8:11], s24 offen offset:2048 sc1 lds
    ds_read_b128 v[24:27], v2 offset:26624
    s_waitcnt lgkmcnt(6)
    v_mfma_f32_32x32x16_bf16 v[48:63], a[80:83], v[32:35], v[48:63]
    ds_read_b128 v[28:31], v2 offset:27648
    s_waitcnt lgkmcnt(6)
    v_mfma_f32_32x32x16_bf16 v[64:79], a[84:87], v[36:39], v[64:79]
    ds_read_b128 v[32:35], v2 offset:28672
    s_waitcnt lgkmcnt(6)
    v_mfma_f32_32x32x16_bf16 v[48:63], a[88:91], v[40:43], v[48:63]
    buffer_load_dwordx4 v1, s[8:11], s24 offen offset:3072 sc1 lds
    ds_read_b128 v[36:39], v2 offset:29696
    s_waitcnt lgkmcnt(6)
    v_mfma_f32_32x32x16_bf16 v[64:79], a[92:95], v[44:47], v[64:79]
    ds_read_b128 v[40:43], v2 offset:30720
    s_waitcnt lgkmcnt(6)
    v_mfma_f32_32x32x16_bf16 v[48:63], a[96:99], v[16:19], v[48:63]
    ds_read_b128 v[44:47], v2 offset:31744
    s_waitcnt lgkmcnt(6)
    v_mfma_f32_32x32x16_bf16 v[64:79], a[100:103], v[20:23], v[64:79]
    s_add_u32 s24, s24, 4096
    s_add_u32 s25, s25, 4096
    s_mov_b32 m0, s25
    s_nop 0
    buffer_load_dwordx4 v1, s[8:11], s24 offen offset:0 sc1 lds
    ds_read_b128 v[16:19], v2 offset:32768
    s_waitcnt lgkmcnt(6)
    v_mfma_f32_32x32x16_bf16 v[48:63], a[104:107], v[24:27], v[48:63]
    ds_read_b128 v[20:23], v2 offset:33792
    s_waitcnt lgkmcnt(6)
    v_mfma_f32_32x32x16_bf16 v[64:79], a[108:111], v[28:31], v[64:79]
    ds_read_b128 v[24:27], v2 offset:34816
    s_waitcnt lgkmcnt(6)
    v_mfma_f32_32x32x16_bf16 v[48:63], a[112:115], v[32:35], v[48:63]
    buffer_load_dwordx4 v1, s[8:11], s24 offen offset:1024 sc1 lds
    ds_read_b128 v[28:31], v2 offset:35840
    s_waitcnt lgkmcnt(6)
    v_mfma_f32_32x32x16_bf16 v[64:79], a[116:119], v[36:39], v[64:79]
    ds_read_b128 v[32:35], v2 offset:36864
    s_waitcnt lgkmcnt(6)
    v_mfma_f32_32x32x16_bf16 v[48:63], a[120:123], v[40:43], v[48:63]
    ds_read_b128 v[36:39], v2 offset:37888
    s_waitcnt lgkmcnt(6)
    v_mfma_f32_32x32x16_bf16 v[64:79], a[124:127], v[44:47], v[64:79]
    ds_read_b128 v[40:43], v2 offset:38912
    s_waitcnt lgkmcnt(6)
    v_mfma_f32_32x32x16_bf16 v[48:63], a[128:131], v[16:19], v[48:63]
    ds_read_b128 v[44:47], v2 offset:39936
    s_waitcnt lgkmcnt(6)
    v_mfma_f32_32x32x16_bf16 v[64:79], a[132:135], v[20:23], v[64:79]
    s_waitcnt lgkmcnt(5)
    v_mfma_f32_32x32x16_bf16 v[48:63], a[136:139], v[24:27], v[48:63]
    s_waitcnt lgkmcnt(4)
    v_mfma_f32_32x32x16_bf16 v[64:79], a[140:143], v[28:31], v[64:79]
    s_waitcnt lgkmcnt(3)
    v_mfma_f32_32x32x16_bf16 v[48:63], a[144:147], v[32:35], v[48:63]
    s_waitcnt lgkmcnt(2)
    v_mfma_f32_32x32x16_bf16 v[64:79], a[148:151], v[36:39], v[64:79]
    s_waitcnt lgkmcnt(1)
    v_mfma_f32_32x32x16_bf16 v[48:63], a[152:155], v[40:43], v[48:63]
    s_waitcnt lgkmcnt(0)
    v_mfma_f32_32x32x16_bf16 v[64:79], a[156:159], v[44:47], v[64:79]
    s_waitcnt vmcnt(12)
    s_nop 7
    s_nop 3
    v_add_f32 v48, v48, v64
    v_add_f32 v49, v49, v65
    v_add_f32 v50, v50, v66
    v_add_f32 v51, v51, v67
    v_add_f32 v52, v52, v68
    v_add_f32 v53, v53, v69
    v_add_f32 v54, v54, v70
    v_add_f32 v55, v55, v71
    v_add_f32 v56, v56, v72
    v_add_f32 v57, v57, v73
    v_add_f32 v58, v58, v74
    v_add_f32 v59, v59, v75
    v_add_f32 v60, v60, v76
    v_add_f32 v61, v61, v77
    v_add_f32 v62, v62, v78
    v_add_f32 v63, v63, v79
    s_add_u32 s26, s19, 226492416
    v_cvt_pk_bf16_f32 v80, v48, v49
    v_cvt_pk_bf16_f32 v81, v50, v51
    v_cvt_pk_bf16_f32 v82, v52, v53
    v_cvt_pk_bf16_f32 v83, v54, v55
    s_nop 1
    v_permlane32_swap_b32 v80, v82
    v_permlane32_swap_b32 v81, v83
    s_nop 1
    v_lshlrev_b32 v88, 16, v80
    v_and_b32 v89, 0xffff0000, v80
    v_lshlrev_b32 v90, 16, v104
    v_and_b32 v91, 0xffff0000, v104
    v_add_f32 v88, v88, v90
    v_add_f32 v89, v89, v91
    v_cvt_pk_bf16_f32 v80, v88, v89
    v_lshlrev_b32 v92, 16, v81
    v_and_b32 v93, 0xffff0000, v81
    v_lshlrev_b32 v94, 16, v105
    v_and_b32 v95, 0xffff0000, v105
    v_add_f32 v92, v92, v94
    v_add_f32 v93, v93, v95
    v_cvt_pk_bf16_f32 v81, v92, v93
    v_lshlrev_b32 v88, 16, v82
    v_and_b32 v89, 0xffff0000, v82
    v_lshlrev_b32 v90, 16, v106
    v_and_b32 v91, 0xffff0000, v106
    v_add_f32 v88, v88, v90
    v_add_f32 v89, v89, v91
    v_cvt_pk_bf16_f32 v82, v88, v89
    v_lshlrev_b32 v92, 16, v83
    v_and_b32 v93, 0xffff0000, v83
    v_lshlrev_b32 v94, 16, v107
    v_and_b32 v95, 0xffff0000, v107
    v_add_f32 v92, v92, v94
    v_add_f32 v93, v93, v95
    v_cvt_pk_bf16_f32 v83, v92, v93
    buffer_store_dwordx4 v[80:83], v3, s[8:11], s26 offen offset:0 sc1
    v_cvt_pk_bf16_f32 v84, v56, v57
    v_cvt_pk_bf16_f32 v85, v58, v59
    v_cvt_pk_bf16_f32 v86, v60, v61
    v_cvt_pk_bf16_f32 v87, v62, v63
    s_nop 1
    v_permlane32_swap_b32 v84, v86
    v_permlane32_swap_b32 v85, v87
    s_nop 1
    v_lshlrev_b32 v88, 16, v84
    v_and_b32 v89, 0xffff0000, v84
    v_lshlrev_b32 v90, 16, v108
    v_and_b32 v91, 0xffff0000, v108
    v_add_f32 v88, v88, v90
    v_add_f32 v89, v89, v91
    v_cvt_pk_bf16_f32 v84, v88, v89
    v_lshlrev_b32 v92, 16, v85
    v_and_b32 v93, 0xffff0000, v85
    v_lshlrev_b32 v94, 16, v109
    v_and_b32 v95, 0xffff0000, v109
    v_add_f32 v92, v92, v94
    v_add_f32 v93, v93, v95
    v_cvt_pk_bf16_f32 v85, v92, v93
    v_lshlrev_b32 v88, 16, v86
    v_and_b32 v89, 0xffff0000, v86
    v_lshlrev_b32 v90, 16, v110
    v_and_b32 v91, 0xffff0000, v110
    v_add_f32 v88, v88, v90
    v_add_f32 v89, v89, v91
    v_cvt_pk_bf16_f32 v86, v88, v89
    v_lshlrev_b32 v92, 16, v87
    v_and_b32 v93, 0xffff0000, v87
    v_lshlrev_b32 v94, 16, v111
    v_and_b32 v95, 0xffff0000, v111
    v_add_f32 v92, v92, v94
    v_add_f32 v93, v93, v95
    v_cvt_pk_bf16_f32 v87, v92, v93
    buffer_store_dwordx4 v[84:87], v3, s[8:11], s26 offen offset:32 sc1
    s_waitcnt vmcnt(0)
    s_mov_b64 exec, 1
    s_add_u32 s26, s48, s20
    buffer_store_dword v5, v4, s[8:11], s26 offen sc1
    s_mov_b64 exec, -1
    s_add_u32 s20, s20, 128
    s_add_u32 s19, s19, 40960
    s_add_u32 s16, s16, 40960
    s_cmp_eq_u32 s16, 122880
    s_cselect_b32 s16, 0, s16
    s_add_u32 s14, s14, 1
    s_cmp_ge_u32 s14, s15
    s_cbranch_scc1 layerb1_kernel_ab_fin
    s_sub_u32 s20, s20, 128
layerb1_kernel_ab_loop:
    s_add_u32 s23, s14, 2
    s_cmp_lg_u32 s13, 0
    s_cbranch_scc1 layerb1_kernel_ab_ow9
    s_min_u32 s28, s23, 63
    s_cmp_gt_u32 s22, s28
    s_cbranch_scc1 layerb1_kernel_ab_ow9
layerb1_kernel_ab_op9:
    buffer_load_dwordx4 v[116:119], v1, s[8:11], s29 offen sc1
    s_waitcnt vmcnt(0)
    v_min_u32 v116, v116, v117
    v_min_u32 v118, v118, v119
    v_min_u32 v114, v116, v118
    v_cmp_eq_u32 vcc, 0, v114
    s_nop 1
    s_ff1_i32_b64 s22, vcc
    s_min_u32 s22, s22, 64
    s_and_b32 s22, s22, 0x7c
    s_sub_u32 s30, s30, 1
    s_cbranch_scc1 layerb1_kernel_bail
    s_cmp_gt_u32 s22, s28
    s_cbranch_scc0 layerb1_kernel_ab_op9
layerb1_kernel_ab_ow9:
    s_barrier
    v_add_u32 v2, s16, v1
    ds_read_b128 v[16:19], v2 offset:0
    ds_read_b128 v[20:23], v2 offset:1024
    ds_read_b128 v[24:27], v2 offset:2048
    ds_read_b128 v[28:31], v2 offset:3072
    ds_read_b128 v[32:35], v2 offset:4096
    ds_read_b128 v[36:39], v2 offset:5120
    s_add_u32 s27, s19, 40960
    s_cmp_ge_u32 s14, 63
    s_cselect_b32 s27, s19, s27
    buffer_load_dwordx4 v[104:107], v3, s[52:55], s27 offen offset:0
    buffer_load_dwordx4 v[108:111], v3, s[52:55], s27 offen offset:32
    s_add_u32 s23, s14, 2
    s_min_u32 s24, s23, 63
    s_mul_i32 s24, s24, 40960
    s_add_u32 s24, s24, s18
    s_mul_i32 s25, s13, 10240
    s_add_u32 s25, s25, s17
    s_add_u32 s17, s17, 40960
    s_cmp_eq_u32 s17, 122880
    s_cselect_b32 s17, 0, s17
    ds_read_b128 v[40:43], v2 offset:6144
    s_waitcnt lgkmcnt(6)
    v_mfma_f32_32x32x16_bf16 v[48:63], a[0:3], v[16:19], 0
    ds_read_b128 v[44:47], v2 offset:7168
    s_waitcnt lgkmcnt(6)
    v_mfma_f32_32x32x16_bf16 v[64:79], a[4:7], v[20:23], 0
    s_mov_b32 m0, s25
    s_nop 0
    buffer_load_dwordx4 v1, s[8:11], s24 offen offset:0 sc1 lds
    ds_read_b128 v[16:19], v2 offset:8192
    s_waitcnt lgkmcnt(6)
    v_mfma_f32_32x32x16_bf16 v[48:63], a[8:11], v[24:27], v[48:63]
    ds_read_b128 v[20:23], v2 offset:9216
    s_waitcnt lgkmcnt(6)
    v_mfma_f32_32x32x16_bf16 v[64:79], a[12:15], v[28:31], v[64:79]
    ds_read_b128 v[24:27], v2 offset:10240
    s_waitcnt lgkmcnt(6)
    v_mfma_f32_32x32x16_bf16 v[48:63], a[16:19], v[32:35], v[48:63]
    buffer_load_dwordx4 v1, s[8:11], s24 offen offset:1024 sc1 lds
    ds_read_b128 v[28:31], v2 offset:11264
    s_waitcnt lgkmcnt(6)
    v_mfma_f32_32x32x16_bf16 v[64:79], a[20:23], v[36:39], v[64:79]
    ds_read_b128 v[32:35], v2 offset:12288
    s_waitcnt lgkmcnt(6)
    v_mfma_f32_32x32x16_bf16 v[48:63], a[24:27], v[40:43], v[48:63]
    ds_read_b128 v[36:39], v2 offset:13312
    s_waitcnt lgkmcnt(6)
    v_mfma_f32_32x32x16_bf16 v[64:79], a[28:31], v[44:47], v[64:79]
    buffer_load_dwordx4 v1, s[8:11], s24 offen offset:2048 sc1 lds
    ds_read_b128 v[40:43], v2 offset:14336
    s_waitcnt lgkmcnt(6)
    v_mfma_f32_32x32x16_bf16 v[48:63], a[32:35], v[16:19], v[48:63]
    ds_read_b128 v[44:47], v2 offset:15360
    s_waitcnt lgkmcnt(6)
    v_mfma_f32_32x32x16_bf16 v[64:79], a[36:39], v[20:23], v[64:79]
    ds_read_b128 v[16:19], v2 offset:16384
    s_waitcnt lgkmcnt(6)
    v_mfma_f32_32x32x16_bf16 v[48:63], a[40:43], v[24:27], v[48:63]
    buffer_load_dwordx4 v1, s[8:11], s24 offen offset:3072 sc1 lds
    ds_read_b128 v[20:23], v2 offset:17408
    s_waitcnt lgkmcnt(6)
    v_mfma_f32_32x32x16_bf16 v[64:79], a[44:47], v[28:31], v[64:79]
    ds_read_b128 v[24:27], v2 offset:18432
    s_waitcnt lgkmcnt(6)
    v_mfma_f32_32x32x16_bf16 v[48:63], a[48:51], v[32:35], v[48:63]
    ds_read_b128 v[28:31], v2 offset:19456
    s_waitcnt lgkmcnt(6)
    v_mfma_f32_32x32x16_bf16 v[64:79], a[52:55], v[36:39], v[64:79]
    s_add_u32 s24, s24, 4096
    s_add_u32 s25, s25, 4096
    s_mov_b32 m0, s25
    s_nop 0
    buffer_load_dwordx4 v1, s[8:11], s24 offen offset:0 sc1 lds
    ds_read_b128 v[32:35], v2 offset:20480
    s_waitcnt lgkmcnt(6)
    v_mfma_f32_32x32x16_bf16 v[48:63], a[56:59], v[40:43], v[48:63]
    ds_read_b128 v[36:39], v2 offset:21504
    s_waitcnt lgkmcnt(6)
    v_mfma_f32_32x32x16_bf16 v[64:79], a[60:63], v[44:47], v[64:79]
    ds_read_b128 v[40:43], v2 offset:22528
    s_waitcnt lgkmcnt(6)
    v_mfma_f32_32x32x16_bf16 v[48:63], a[64:67], v[16:19], v[48:63]
    buffer_load_dwordx4 v1, s[8:11], s24 offen offset:1024 sc1 lds
    ds_read_b128 v[44:47], v2 offset:23552
    s_waitcnt lgkmcnt(6)
    v_mfma_f32_32x32x16_bf16 v[64:79], a[68:71], v[20:23], v[64:79]
    ds_read_b128 v[16:19], v2 offset:24576
    s_waitcnt lgkmcnt(6)
    v_mfma_f32_32x32x16_bf16 v[48:63], a[72:75], v[24:27], v[48:63]
    ds_read_b128 v[20:23], v2 offset:25600
    s_waitcnt lgkmcnt(6)
    v_mfma_f32_32x32x16_bf16 v[64:79], a[76:79], v[28:31], v[64:79]
    buffer_load_dwordx4 v1, s[8:11], s24 offen offset:2048 sc1 lds
    ds_read_b128 v[24:27], v2 offset:26624
    s_waitcnt lgkmcnt(6)
    v_mfma_f32_32x32x16_bf16 v[48:63], a[80:83], v[32:35], v[48:63]
    ds_read_b128 v[28:31], v2 offset:27648
    s_waitcnt lgkmcnt(6)
    v_mfma_f32_32x32x16_bf16 v[64:79], a[84:87], v[36:39], v[64:79]
    ds_read_b128 v[32:35], v2 offset:28672
    s_waitcnt lgkmcnt(6)
    v_mfma_f32_32x32x16_bf16 v[48:63], a[88:91], v[40:43], v[48:63]
    buffer_load_dwordx4 v1, s[8:11], s24 offen offset:3072 sc1 lds
    ds_read_b128 v[36:39], v2 offset:29696
    s_waitcnt lgkmcnt(6)
    v_mfma_f32_32x32x16_bf16 v[64:79], a[92:95], v[44:47], v[64:79]
    ds_read_b128 v[40:43], v2 offset:30720
    s_waitcnt lgkmcnt(6)
    v_mfma_f32_32x32x16_bf16 v[48:63], a[96:99], v[16:19], v[48:63]
    ds_read_b128 v[44:47], v2 offset:31744
    s_waitcnt lgkmcnt(6)
    v_mfma_f32_32x32x16_bf16 v[64:79], a[100:103], v[20:23], v[64:79]
    s_add_u32 s24, s24, 4096
    s_add_u32 s25, s25, 4096
    s_mov_b32 m0, s25
    s_nop 0
    buffer_load_dwordx4 v1, s[8:11], s24 offen offset:0 sc1 lds
    ds_read_b128 v[16:19], v2 offset:32768
    s_waitcnt lgkmcnt(6)
    v_mfma_f32_32x32x16_bf16 v[48:63], a[104:107], v[24:27], v[48:63]
    ds_read_b128 v[20:23], v2 offset:33792
    s_waitcnt lgkmcnt(6)
    v_mfma_f32_32x32x16_bf16 v[64:79], a[108:111], v[28:31], v[64:79]
    ds_read_b128 v[24:27], v2 offset:34816
    s_waitcnt lgkmcnt(6)
    v_mfma_f32_32x32x16_bf16 v[48:63], a[112:115], v[32:35], v[48:63]
    buffer_load_dwordx4 v1, s[8:11], s24 offen offset:1024 sc1 lds
    ds_read_b128 v[28:31], v2 offset:35840
    s_waitcnt lgkmcnt(6)
    v_mfma_f32_32x32x16_bf16 v[64:79], a[116:119], v[36:39], v[64:79]
    ds_read_b128 v[32:35], v2 offset:36864
    s_waitcnt lgkmcnt(6)
    v_mfma_f32_32x32x16_bf16 v[48:63], a[120:123], v[40:43], v[48:63]
    ds_read_b128 v[36:39], v2 offset:37888
    s_waitcnt lgkmcnt(6)
    v_mfma_f32_32x32x16_bf16 v[64:79], a[124:127], v[44:47], v[64:79]
    ds_read_b128 v[40:43], v2 offset:38912
    s_waitcnt lgkmcnt(6)
    v_mfma_f32_32x32x16_bf16 v[48:63], a[128:131], v[16:19], v[48:63]
    ds_read_b128 v[44:47], v2 offset:39936
    s_waitcnt lgkmcnt(6)
    v_mfma_f32_32x32x16_bf16 v[64:79], a[132:135], v[20:23], v[64:79]
    s_waitcnt lgkmcnt(5)
    v_mfma_f32_32x32x16_bf16 v[48:63], a[136:139], v[24:27], v[48:63]
    s_waitcnt lgkmcnt(4)
    v_mfma_f32_32x32x16_bf16 v[64:79], a[140:143], v[28:31], v[64:79]
    s_waitcnt lgkmcnt(3)
    v_mfma_f32_32x32x16_bf16 v[48:63], a[144:147], v[32:35], v[48:63]
    s_waitcnt lgkmcnt(2)
    v_mfma_f32_32x32x16_bf16 v[64:79], a[148:151], v[36:39], v[64:79]
    s_waitcnt lgkmcnt(1)
    v_mfma_f32_32x32x16_bf16 v[48:63], a[152:155], v[40:43], v[48:63]
    s_waitcnt lgkmcnt(0)
    v_mfma_f32_32x32x16_bf16 v[64:79], a[156:159], v[44:47], v[64:79]
    s_waitcnt vmcnt(15)
    s_nop 7
    s_nop 3
    v_add_f32 v48, v48, v64
    v_add_f32 v49, v49, v65
    v_add_f32 v50, v50, v66
    v_add_f32 v51, v51, v67
    v_add_f32 v52, v52, v68
    v_add_f32 v53, v53, v69
    v_add_f32 v54, v54, v70
    v_add_f32 v55, v55, v71
    v_add_f32 v56, v56, v72
    v_add_f32 v57, v57, v73
    v_add_f32 v58, v58, v74
    v_add_f32 v59, v59, v75
    v_add_f32 v60, v60, v76
    v_add_f32 v61, v61, v77
    v_add_f32 v62, v62, v78
    v_add_f32 v63, v63, v79
    s_add_u32 s26, s19, 226492416
    v_cvt_pk_bf16_f32 v80, v48, v49
    v_cvt_pk_bf16_f32 v81, v50, v51
    v_cvt_pk_bf16_f32 v82, v52, v53
    v_cvt_pk_bf16_f32 v83, v54, v55
    s_nop 1
    v_permlane32_swap_b32 v80, v82
    v_permlane32_swap_b32 v81, v83
    s_nop 1
    v_lshlrev_b32 v88, 16, v80
    v_and_b32 v89, 0xffff0000, v80
    v_lshlrev_b32 v90, 16, v96
    v_and_b32 v91, 0xffff0000, v96
    v_add_f32 v88, v88, v90
    v_add_f32 v89, v89, v91
    v_cvt_pk_bf16_f32 v80, v88, v89
    v_lshlrev_b32 v92, 16, v81
    v_and_b32 v93, 0xffff0000, v81
    v_lshlrev_b32 v94, 16, v97
    v_and_b32 v95, 0xffff0000, v97
    v_add_f32 v92, v92, v94
    v_add_f32 v93, v93, v95
    v_cvt_pk_bf16_f32 v81, v92, v93
    v_lshlrev_b32 v88, 16, v82
    v_and_b32 v89, 0xffff0000, v82
    v_lshlrev_b32 v90, 16, v98
    v_and_b32 v91, 0xffff0000, v98
    v_add_f32 v88, v88, v90
    v_add_f32 v89, v89, v91
    v_cvt_pk_bf16_f32 v82, v88, v89
    v_lshlrev_b32 v92, 16, v83
    v_and_b32 v93, 0xffff0000, v83
    v_lshlrev_b32 v94, 16, v99
    v_and_b32 v95, 0xffff0000, v99
    v_add_f32 v92, v92, v94
    v_add_f32 v93, v93, v95
    v_cvt_pk_bf16_f32 v83, v92, v93
    buffer_store_dwordx4 v[80:83], v3, s[8:11], s26 offen offset:0 sc1
    v_cvt_pk_bf16_f32 v84, v56, v57
    v_cvt_pk_bf16_f32 v85, v58, v59
    v_cvt_pk_bf16_f32 v86, v60, v61
    v_cvt_pk_bf16_f32 v87, v62, v63
    s_nop 1
    v_permlane32_swap_b32 v84, v86
    v_permlane32_swap_b32 v85, v87
    s_nop 1
    v_lshlrev_b32 v88, 16, v84
    v_and_b32 v89, 0xffff0000, v84
    v_lshlrev_b32 v90, 16, v100
    v_and_b32 v91, 0xffff0000, v100
    v_add_f32 v88, v88, v90
    v_add_f32 v89, v89, v91
    v_cvt_pk_bf16_f32 v84, v88, v89
    v_lshlrev_b32 v92, 16, v85
    v_and_b32 v93, 0xffff0000, v85
    v_lshlrev_b32 v94, 16, v101
    v_and_b32 v95, 0xffff0000, v101
    v_add_f32 v92, v92, v94
    v_add_f32 v93, v93, v95
    v_cvt_pk_bf16_f32 v85, v92, v93
    v_lshlrev_b32 v88, 16, v86
    v_and_b32 v89, 0xffff0000, v86
    v_lshlrev_b32 v90, 16, v102
    v_and_b32 v91, 0xffff0000, v102
    v_add_f32 v88, v88, v90
    v_add_f32 v89, v89, v91
    v_cvt_pk_bf16_f32 v86, v88, v89
    v_lshlrev_b32 v92, 16, v87
    v_and_b32 v93, 0xffff0000, v87
    v_lshlrev_b32 v94, 16, v103
    v_and_b32 v95, 0xffff0000, v103
    v_add_f32 v92, v92, v94
    v_add_f32 v93, v93, v95
    v_cvt_pk_bf16_f32 v87, v92, v93
    buffer_store_dwordx4 v[84:87], v3, s[8:11], s26 offen offset:32 sc1
    s_waitcnt vmcnt(15)
    s_mov_b64 exec, 1
    s_add_u32 s26, s48, s20
    buffer_store_dword v5, v4, s[8:11], s26 offen sc1
    s_mov_b64 exec, -1
    s_add_u32 s20, s20, 128
    s_add_u32 s19, s19, 40960
    s_add_u32 s16, s16, 40960
    s_cmp_eq_u32 s16, 122880
    s_cselect_b32 s16, 0, s16
    s_add_u32 s14, s14, 1
    s_cmp_ge_u32 s14, s15
    s_cbranch_scc1 layerb1_kernel_ab_fin
    s_add_u32 s23, s14, 2
    s_cmp_lg_u32 s13, 0
    s_cbranch_scc1 layerb1_kernel_ab_ow10
    s_min_u32 s28, s23, 63
    s_cmp_gt_u32 s22, s28
    s_cbranch_scc1 layerb1_kernel_ab_ow10
layerb1_kernel_ab_op10:
    buffer_load_dwordx4 v[116:119], v1, s[8:11], s29 offen sc1
    s_waitcnt vmcnt(0)
    v_min_u32 v116, v116, v117
    v_min_u32 v118, v118, v119
    v_min_u32 v114, v116, v118
    v_cmp_eq_u32 vcc, 0, v114
    s_nop 1
    s_ff1_i32_b64 s22, vcc
    s_min_u32 s22, s22, 64
    s_and_b32 s22, s22, 0x7c
    s_sub_u32 s30, s30, 1
    s_cbranch_scc1 layerb1_kernel_bail
    s_cmp_gt_u32 s22, s28
    s_cbranch_scc0 layerb1_kernel_ab_op10
layerb1_kernel_ab_ow10:
    s_barrier
    v_add_u32 v2, s16, v1
    ds_read_b128 v[16:19], v2 offset:0
    ds_read_b128 v[20:23], v2 offset:1024
    ds_read_b128 v[24:27], v2 offset:2048
    ds_read_b128 v[28:31], v2 offset:3072
    ds_read_b128 v[32:35], v2 offset:4096
    ds_read_b128 v[36:39], v2 offset:5120
    s_add_u32 s27, s19, 40960
    s_cmp_ge_u32 s14, 63
    s_cselect_b32 s27, s19, s27
    buffer_load_dwordx4 v[96:99], v3, s[52:55], s27 offen offset:0
    buffer_load_dwordx4 v[100:103], v3, s[52:55], s27 offen offset:32
    s_add_u32 s23, s14, 2
    s_min_u32 s24, s23, 63
    s_mul_i32 s24, s24, 40960
    s_add_u32 s24, s24, s18
    s_mul_i32 s25, s13, 10240
    s_add_u32 s25, s25, s17
    s_add_u32 s17, s17, 40960
    s_cmp_eq_u32 s17, 122880
    s_cselect_b32 s17, 0, s17
    ds_read_b128 v[40:43], v2 offset:6144
    s_waitcnt lgkmcnt(6)
    v_mfma_f32_32x32x16_bf16 v[48:63], a[0:3], v[16:19], 0
    ds_read_b128 v[44:47], v2 offset:7168
    s_waitcnt lgkmcnt(6)
    v_mfma_f32_32x32x16_bf16 v[64:79], a[4:7], v[20:23], 0
    s_mov_b32 m0, s25
    s_nop 0
    buffer_load_dwordx4 v1, s[8:11], s24 offen offset:0 sc1 lds
    ds_read_b128 v[16:19], v2 offset:8192
    s_waitcnt lgkmcnt(6)
    v_mfma_f32_32x32x16_bf16 v[48:63], a[8:11], v[24:27], v[48:63]
    ds_read_b128 v[20:23], v2 offset:9216
    s_waitcnt lgkmcnt(6)
    v_mfma_f32_32x32x16_bf16 v[64:79], a[12:15], v[28:31], v[64:79]
    ds_read_b128 v[24:27], v2 offset:10240
    s_waitcnt lgkmcnt(6)
    v_mfma_f32_32x32x16_bf16 v[48:63], a[16:19], v[32:35], v[48:63]
    buffer_load_dwordx4 v1, s[8:11], s24 offen offset:1024 sc1 lds
    ds_read_b128 v[28:31], v2 offset:11264
    s_waitcnt lgkmcnt(6)
    v_mfma_f32_32x32x16_bf16 v[64:79], a[20:23], v[36:39], v[64:79]
    ds_read_b128 v[32:35], v2 offset:12288
    s_waitcnt lgkmcnt(6)
    v_mfma_f32_32x32x16_bf16 v[48:63], a[24:27], v[40:43], v[48:63]
    ds_read_b128 v[36:39], v2 offset:13312
    s_waitcnt lgkmcnt(6)
    v_mfma_f32_32x32x16_bf16 v[64:79], a[28:31], v[44:47], v[64:79]
    buffer_load_dwordx4 v1, s[8:11], s24 offen offset:2048 sc1 lds
    ds_read_b128 v[40:43], v2 offset:14336
    s_waitcnt lgkmcnt(6)
    v_mfma_f32_32x32x16_bf16 v[48:63], a[32:35], v[16:19], v[48:63]
    ds_read_b128 v[44:47], v2 offset:15360
    s_waitcnt lgkmcnt(6)
    v_mfma_f32_32x32x16_bf16 v[64:79], a[36:39], v[20:23], v[64:79]
    ds_read_b128 v[16:19], v2 offset:16384
    s_waitcnt lgkmcnt(6)
    v_mfma_f32_32x32x16_bf16 v[48:63], a[40:43], v[24:27], v[48:63]
    buffer_load_dwordx4 v1, s[8:11], s24 offen offset:3072 sc1 lds
    ds_read_b128 v[20:23], v2 offset:17408
    s_waitcnt lgkmcnt(6)
    v_mfma_f32_32x32x16_bf16 v[64:79], a[44:47], v[28:31], v[64:79]
    ds_read_b128 v[24:27], v2 offset:18432
    s_waitcnt lgkmcnt(6)
    v_mfma_f32_32x32x16_bf16 v[48:63], a[48:51], v[32:35], v[48:63]
    ds_read_b128 v[28:31], v2 offset:19456
    s_waitcnt lgkmcnt(6)
    v_mfma_f32_32x32x16_bf16 v[64:79], a[52:55], v[36:39], v[64:79]
    s_add_u32 s24, s24, 4096
    s_add_u32 s25, s25, 4096
    s_mov_b32 m0, s25
    s_nop 0
    buffer_load_dwordx4 v1, s[8:11], s24 offen offset:0 sc1 lds
    ds_read_b128 v[32:35], v2 offset:20480
    s_waitcnt lgkmcnt(6)
    v_mfma_f32_32x32x16_bf16 v[48:63], a[56:59], v[40:43], v[48:63]
    ds_read_b128 v[36:39], v2 offset:21504
    s_waitcnt lgkmcnt(6)
    v_mfma_f32_32x32x16_bf16 v[64:79], a[60:63], v[44:47], v[64:79]
    ds_read_b128 v[40:43], v2 offset:22528
    s_waitcnt lgkmcnt(6)
    v_mfma_f32_32x32x16_bf16 v[48:63], a[64:67], v[16:19], v[48:63]
    buffer_load_dwordx4 v1, s[8:11], s24 offen offset:1024 sc1 lds
    ds_read_b128 v[44:47], v2 offset:23552
    s_waitcnt lgkmcnt(6)
    v_mfma_f32_32x32x16_bf16 v[64:79], a[68:71], v[20:23], v[64:79]
    ds_read_b128 v[16:19], v2 offset:24576
    s_waitcnt lgkmcnt(6)
    v_mfma_f32_32x32x16_bf16 v[48:63], a[72:75], v[24:27], v[48:63]
    ds_read_b128 v[20:23], v2 offset:25600
    s_waitcnt lgkmcnt(6)
    v_mfma_f32_32x32x16_bf16 v[64:79], a[76:79], v[28:31], v[64:79]
    buffer_load_dwordx4 v1, s[8:11], s24 offen offset:2048 sc1 lds
    ds_read_b128 v[24:27], v2 offset:26624
    s_waitcnt lgkmcnt(6)
    v_mfma_f32_32x32x16_bf16 v[48:63], a[80:83], v[32:35], v[48:63]
    ds_read_b128 v[28:31], v2 offset:27648
    s_waitcnt lgkmcnt(6)
    v_mfma_f32_32x32x16_bf16 v[64:79], a[84:87], v[36:39], v[64:79]
    ds_read_b128 v[32:35], v2 offset:28672
    s_waitcnt lgkmcnt(6)
    v_mfma_f32_32x32x16_bf16 v[48:63], a[88:91], v[40:43], v[48:63]
    buffer_load_dwordx4 v1, s[8:11], s24 offen offset:3072 sc1 lds
    ds_read_b128 v[36:39], v2 offset:29696
    s_waitcnt lgkmcnt(6)
    v_mfma_f32_32x32x16_bf16 v[64:79], a[92:95], v[44:47], v[64:79]
    ds_read_b128 v[40:43], v2 offset:30720
    s_waitcnt lgkmcnt(6)
    v_mfma_f32_32x32x16_bf16 v[48:63], a[96:99], v[16:19], v[48:63]
    ds_read_b128 v[44:47], v2 offset:31744
    s_waitcnt lgkmcnt(6)
    v_mfma_f32_32x32x16_bf16 v[64:79], a[100:103], v[20:23], v[64:79]
    s_add_u32 s24, s24, 4096
    s_add_u32 s25, s25, 4096
    s_mov_b32 m0, s25
    s_nop 0
    buffer_load_dwordx4 v1, s[8:11], s24 offen offset:0 sc1 lds
    ds_read_b128 v[16:19], v2 offset:32768
    s_waitcnt lgkmcnt(6)
    v_mfma_f32_32x32x16_bf16 v[48:63], a[104:107], v[24:27], v[48:63]
    ds_read_b128 v[20:23], v2 offset:33792
    s_waitcnt lgkmcnt(6)
    v_mfma_f32_32x32x16_bf16 v[64:79], a[108:111], v[28:31], v[64:79]
    ds_read_b128 v[24:27], v2 offset:34816
    s_waitcnt lgkmcnt(6)
    v_mfma_f32_32x32x16_bf16 v[48:63], a[112:115], v[32:35], v[48:63]
    buffer_load_dwordx4 v1, s[8:11], s24 offen offset:1024 sc1 lds
    ds_read_b128 v[28:31], v2 offset:35840
    s_waitcnt lgkmcnt(6)
    v_mfma_f32_32x32x16_bf16 v[64:79], a[116:119], v[36:39], v[64:79]
    ds_read_b128 v[32:35], v2 offset:36864
    s_waitcnt lgkmcnt(6)
    v_mfma_f32_32x32x16_bf16 v[48:63], a[120:123], v[40:43], v[48:63]
    ds_read_b128 v[36:39], v2 offset:37888
    s_waitcnt lgkmcnt(6)
    v_mfma_f32_32x32x16_bf16 v[64:79], a[124:127], v[44:47], v[64:79]
    ds_read_b128 v[40:43], v2 offset:38912
    s_waitcnt lgkmcnt(6)
    v_mfma_f32_32x32x16_bf16 v[48:63], a[128:131], v[16:19], v[48:63]
    ds_read_b128 v[44:47], v2 offset:39936
    s_waitcnt lgkmcnt(6)
    v_mfma_f32_32x32x16_bf16 v[64:79], a[132:135], v[20:23], v[64:79]
    s_waitcnt lgkmcnt(5)
    v_mfma_f32_32x32x16_bf16 v[48:63], a[136:139], v[24:27], v[48:63]
    s_waitcnt lgkmcnt(4)
    v_mfma_f32_32x32x16_bf16 v[64:79], a[140:143], v[28:31], v[64:79]
    s_waitcnt lgkmcnt(3)
    v_mfma_f32_32x32x16_bf16 v[48:63], a[144:147], v[32:35], v[48:63]
    s_waitcnt lgkmcnt(2)
    v_mfma_f32_32x32x16_bf16 v[64:79], a[148:151], v[36:39], v[64:79]
    s_waitcnt lgkmcnt(1)
    v_mfma_f32_32x32x16_bf16 v[48:63], a[152:155], v[40:43], v[48:63]
    s_waitcnt lgkmcnt(0)
    v_mfma_f32_32x32x16_bf16 v[64:79], a[156:159], v[44:47], v[64:79]
    s_waitcnt vmcnt(15)
    s_nop 7
    s_nop 3
    v_add_f32 v48, v48, v64
    v_add_f32 v49, v49, v65
    v_add_f32 v50, v50, v66
    v_add_f32 v51, v51, v67
    v_add_f32 v52, v52, v68
    v_add_f32 v53, v53, v69
    v_add_f32 v54, v54, v70
    v_add_f32 v55, v55, v71
    v_add_f32 v56, v56, v72
    v_add_f32 v57, v57, v73
    v_add_f32 v58, v58, v74
    v_add_f32 v59, v59, v75
    v_add_f32 v60, v60, v76
    v_add_f32 v61, v61, v77
    v_add_f32 v62, v62, v78
    v_add_f32 v63, v63, v79
    s_add_u32 s26, s19, 226492416
    v_cvt_pk_bf16_f32 v80, v48, v49
    v_cvt_pk_bf16_f32 v81, v50, v51
    v_cvt_pk_bf16_f32 v82, v52, v53
    v_cvt_pk_bf16_f32 v83, v54, v55
    s_nop 1
    v_permlane32_swap_b32 v80, v82
    v_permlane32_swap_b32 v81, v83
    s_nop 1
    v_lshlrev_b32 v88, 16, v80
    v_and_b32 v89, 0xffff0000, v80
    v_lshlrev_b32 v90, 16, v104
    v_and_b32 v91, 0xffff0000, v104
    v_add_f32 v88, v88, v90
    v_add_f32 v89, v89, v91
    v_cvt_pk_bf16_f32 v80, v88, v89
    v_lshlrev_b32 v92, 16, v81
    v_and_b32 v93, 0xffff0000, v81
    v_lshlrev_b32 v94, 16, v105
    v_and_b32 v95, 0xffff0000, v105
    v_add_f32 v92, v92, v94
    v_add_f32 v93, v93, v95
    v_cvt_pk_bf16_f32 v81, v92, v93
    v_lshlrev_b32 v88, 16, v82
    v_and_b32 v89, 0xffff0000, v82
    v_lshlrev_b32 v90, 16, v106
    v_and_b32 v91, 0xffff0000, v106
    v_add_f32 v88, v88, v90
    v_add_f32 v89, v89, v91
    v_cvt_pk_bf16_f32 v82, v88, v89
    v_lshlrev_b32 v92, 16, v83
    v_and_b32 v93, 0xffff0000, v83
    v_lshlrev_b32 v94, 16, v107
    v_and_b32 v95, 0xffff0000, v107
    v_add_f32 v92, v92, v94
    v_add_f32 v93, v93, v95
    v_cvt_pk_bf16_f32 v83, v92, v93
    buffer_store_dwordx4 v[80:83], v3, s[8:11], s26 offen offset:0 sc1
    v_cvt_pk_bf16_f32 v84, v56, v57
    v_cvt_pk_bf16_f32 v85, v58, v59
    v_cvt_pk_bf16_f32 v86, v60, v61
    v_cvt_pk_bf16_f32 v87, v62, v63
    s_nop 1
    v_permlane32_swap_b32 v84, v86
    v_permlane32_swap_b32 v85, v87
    s_nop 1
    v_lshlrev_b32 v88, 16, v84
    v_and_b32 v89, 0xffff0000, v84
    v_lshlrev_b32 v90, 16, v108
    v_and_b32 v91, 0xffff0000, v108
    v_add_f32 v88, v88, v90
    v_add_f32 v89, v89, v91
    v_cvt_pk_bf16_f32 v84, v88, v89
    v_lshlrev_b32 v92, 16, v85
    v_and_b32 v93, 0xffff0000, v85
    v_lshlrev_b32 v94, 16, v109
    v_and_b32 v95, 0xffff0000, v109
    v_add_f32 v92, v92, v94
    v_add_f32 v93, v93, v95
    v_cvt_pk_bf16_f32 v85, v92, v93
    v_lshlrev_b32 v88, 16, v86
    v_and_b32 v89, 0xffff0000, v86
    v_lshlrev_b32 v90, 16, v110
    v_and_b32 v91, 0xffff0000, v110
    v_add_f32 v88, v88, v90
    v_add_f32 v89, v89, v91
    v_cvt_pk_bf16_f32 v86, v88, v89
    v_lshlrev_b32 v92, 16, v87
    v_and_b32 v93, 0xffff0000, v87
    v_lshlrev_b32 v94, 16, v111
    v_and_b32 v95, 0xffff0000, v111
    v_add_f32 v92, v92, v94
    v_add_f32 v93, v93, v95
    v_cvt_pk_bf16_f32 v87, v92, v93
    buffer_store_dwordx4 v[84:87], v3, s[8:11], s26 offen offset:32 sc1
    s_waitcnt vmcnt(15)
    s_mov_b64 exec, 1
    s_add_u32 s26, s48, s20
    buffer_store_dword v5, v4, s[8:11], s26 offen sc1
    s_mov_b64 exec, -1
    s_add_u32 s20, s20, 128
    s_add_u32 s19, s19, 40960
    s_add_u32 s16, s16, 40960
    s_cmp_eq_u32 s16, 122880
    s_cselect_b32 s16, 0, s16
    s_add_u32 s14, s14, 1
    s_cmp_lt_u32 s14, s15
    s_cbranch_scc1 layerb1_kernel_ab_loop
layerb1_kernel_ab_fin:
    s_waitcnt vmcnt(0) lgkmcnt(0)
    s_mov_b64 exec, 1
    s_add_u32 s26, s48, s20
    buffer_store_dword v5, v4, s[8:11], s26 offen sc1
    s_mov_b64 exec, -1
    s_add_u32 s20, s20, 128
    s_barrier
    s_branch layerb1_kernel_w3
layerb1_kernel_sp_ln:
    s_sub_u32 s12, s22, 5
    s_mov_b32 s14, s12
    s_mov_b32 s16, 0x3f803f80
    v_lshrrev_b32 v6, 3, v0
    v_and_b32 v7, 7, v0
    v_mul_u32_u24 v1, 1280, v6
    v_lshl_add_u32 v1, v7, 5, v1
    v_lshlrev_b32 v2, 10, v7
    v_lshl_add_u32 v2, v6, 4, v2
    v_lshlrev_b32 v3, 2, v0
    v_mov_b32 v4, 1
layerb1_kernel_ln_seg:
    s_lshl_b32 s17, s14, 7
    s_add_u32 s17, s17, s48
    s_add_u32 s17, s17, 36864
    s_mov_b64 exec, 0xfffff
layerb1_kernel_ln_poll:
    buffer_load_dword v5, v3, s[8:11], s17 offen sc1
    s_waitcnt vmcnt(0)
    v_cmp_eq_u32 vcc, 0, v5
    s_sub_u32 s15, s15, 1
    s_cbranch_scc1 layerb1_kernel_bail
    s_cbranch_vccnz layerb1_kernel_ln_poll
    s_mov_b64 exec, -1
    s_lshl_b32 s18, s14, 5
    s_lshl_b32 s19, s13, 3
    s_add_u32 s18, s18, s19
    s_mul_i32 s18, s18, 1280
    s_add_u32 s18, s18, 226492416
    buffer_load_dwordx4 v[16:19], v1, s[8:11], s18 offen offset:0 sc1
    buffer_load_dwordx4 v[20:23], v1, s[8:11], s18 offen offset:16 sc1
    buffer_load_dwordx4 v[24:27], v1, s[8:11], s18 offen offset:256 sc1
    buffer_load_dwordx4 v[28:31], v1, s[8:11], s18 offen offset:272 sc1
    buffer_load_dwordx4 v[32:35], v1, s[8:11], s18 offen offset:512 sc1
    buffer_load_dwordx4 v[36:39], v1, s[8:11], s18 offen offset:528 sc1
    buffer_load_dwordx4 v[40:43], v1, s[8:11], s18 offen offset:768 sc1
    buffer_load_dwordx4 v[44:47], v1, s[8:11], s18 offen offset:784 sc1
    buffer_load_dwordx4 v[48:51], v1, s[8:11], s18 offen offset:1024 sc1
    buffer_load_dwordx4 v[52:55], v1, s[8:11], s18 offen offset:1040 sc1
    v_mov_b32 v8, 0
    v_mov_b32 v9, 0
    v_mov_b32 v10, 0
    v_mov_b32 v11, 0
    s_waitcnt vmcnt(9)
    v_dot2c_f32_bf16 v8, s16, v16
    v_dot2c_f32_bf16 v10, v16, v16
    v_dot2c_f32_bf16 v9, s16, v17
    v_dot2c_f32_bf16 v11, v17, v17
    v_dot2c_f32_bf16 v8, s16, v18
    v_dot2c_f32_bf16 v10, v18, v18
    v_dot2c_f32_bf16 v9, s16, v19
    v_dot2c_f32_bf16 v11, v19, v19
    s_waitcnt vmcnt(8)
    v_dot2c_f32_bf16 v8, s16, v20
    v_dot2c_f32_bf16 v10, v20, v20
    v_dot2c_f32_bf16 v9, s16, v21
    v_dot2c_f32_bf16 v11, v21, v21
    v_dot2c_f32_bf16 v8, s16, v22
    v_dot2c_f32_bf16 v10, v22, v22
    v_dot2c_f32_bf16 v9, s16, v23
    v_dot2c_f32_bf16 v11, v23, v23
    s_waitcnt vmcnt(7)
    v_dot2c_f32_bf16 v8, s16, v24
    v_dot2c_f32_bf16 v10, v24, v24
    v_dot2c_f32_bf16 v9, s16, v25
    v_dot2c_f32_bf16 v11, v25, v25
    v_dot2c_f32_bf16 v8, s16, v26
    v_dot2c_f32_bf16 v10, v26, v26
    v_dot2c_f32_bf16 v9, s16, v27
    v_dot2c_f32_bf16 v11, v27, v27
    s_waitcnt vmcnt(6)
    v_dot2c_f32_bf16 v8, s16, v28
    v_dot2c_f32_bf16 v10, v28, v28
    v_dot2c_f32_bf16 v9, s16, v29
    v_dot2c_f32_bf16 v11, v29, v29
    v_dot2c_f32_bf16 v8, s16, v30
    v_dot2c_f32_bf16 v10, v30, v30
    v_dot2c_f32_bf16 v9, s16, v31
    v_dot2c_f32_bf16 v11, v31, v31
    s_waitcnt vmcnt(5)
    v_dot2c_f32_bf16 v8, s16, v32
    v_dot2c_f32_bf16 v10, v32, v32
    v_dot2c_f32_bf16 v9, s16, v33
    v_dot2c_f32_bf16 v11, v33, v33
    v_dot2c_f32_bf16 v8, s16, v34
    v_dot2c_f32_bf16 v10, v34, v34
    v_dot2c_f32_bf16 v9, s16, v35
    v_dot2c_f32_bf16 v11, v35, v35
    s_waitcnt vmcnt(4)
    v_dot2c_f32_bf16 v8, s16, v36
    v_dot2c_f32_bf16 v10, v36, v36
    v_dot2c_f32_bf16 v9, s16, v37
    v_dot2c_f32_bf16 v11, v37, v37
    v_dot2c_f32_bf16 v8, s16, v38
    v_dot2c_f32_bf16 v10, v38, v38
    v_dot2c_f32_bf16 v9, s16, v39
    v_dot2c_f32_bf16 v11, v39, v39
    s_waitcnt vmcnt(3)
    v_dot2c_f32_bf16 v8, s16, v40
    v_dot2c_f32_bf16 v10, v40, v40
    v_dot2c_f32_bf16 v9, s16, v41
    v_dot2c_f32_bf16 v11, v41, v41
    v_dot2c_f32_bf16 v8, s16, v42
    v_dot2c_f32_bf16 v10, v42, v42
    v_dot2c_f32_bf16 v9, s16, v43
    v_dot2c_f32_bf16 v11, v43, v43
    s_waitcnt vmcnt(2)
    v_dot2c_f32_bf16 v8, s16, v44
    v_dot2c_f32_bf16 v10, v44, v44
    v_dot2c_f32_bf16 v9, s16, v45
    v_dot2c_f32_bf16 v11, v45, v45
    v_dot2c_f32_bf16 v8, s16, v46
    v_dot2c_f32_bf16 v10, v46, v46
    v_dot2c_f32_bf16 v9, s16, v47
    v_dot2c_f32_bf16 v11, v47, v47
    s_waitcnt vmcnt(1)
    v_dot2c_f32_bf16 v8, s16, v48
    v_dot2c_f32_bf16 v10, v48, v48
    v_dot2c_f32_bf16 v9, s16, v49
    v_dot2c_f32_bf16 v11, v49, v49
    v_dot2c_f32_bf16 v8, s16, v50
    v_dot2c_f32_bf16 v10, v50, v50
    v_dot2c_f32_bf16 v9, s16, v51
    v_dot2c_f32_bf16 v11, v51, v51
    s_waitcnt vmcnt(0)
    v_dot2c_f32_bf16 v8, s16, v52
    v_dot2c_f32_bf16 v10, v52, v52
    v_dot2c_f32_bf16 v9, s16, v53
    v_dot2c_f32_bf16 v11, v53, v53
    v_dot2c_f32_bf16 v8, s16, v54
    v_dot2c_f32_bf16 v10, v54, v54
    v_dot2c_f32_bf16 v9, s16, v55
    v_dot2c_f32_bf16 v11, v55, v55
    s_nop 3
    v_add_f32 v8, v8, v9
    v_add_f32 v10, v10, v11
    s_nop 1
    v_add_f32_dpp v8, v8, v8 quad_perm:[1,0,3,2] row_mask:0xf bank_mask:0xf
    v_add_f32_dpp v10, v10, v10 quad_perm:[1,0,3,2] row_mask:0xf bank_mask:0xf
    s_nop 1
    v_add_f32_dpp v8, v8, v8 quad_perm:[2,3,0,1] row_mask:0xf bank_mask:0xf
    v_add_f32_dpp v10, v10, v10 quad_perm:[2,3,0,1] row_mask:0xf bank_mask:0xf
    s_nop 1
    v_add_f32_dpp v8, v8, v8 row_half_mirror row_mask:0xf bank_mask:0xf
    v_add_f32_dpp v10, v10, v10 row_half_mirror row_mask:0xf bank_mask:0xf
    v_mul_f32 v8, 0x3acccccd, v8
    v_mul_f32 v9, v8, v8
    v_mul_f32 v10, 0x3acccccd, v10
    v_sub_f32 v10, v10, v9
    v_max_f32 v10, 0, v10
    v_add_f32 v10, 0x3727c5ac, v10
    v_rsq_f32 v10, v10
    s_nop 0
    v_mul_f32 v8, v8, v10
    v_sub_f32 v8, 0, v8
    s_mul_i32 s18, s14, 40960
    s_lshl_b32 s19, s13, 7
    s_add_u32 s18, s18, s19
    s_add_u32 s18, s18, 220200960
    v_lshlrev_b32 v64, 16, v16
    v_and_b32 v65, 0xffff0000, v16
    v_fma_f32 v64, v64, v10, v8
    v_fma_f32 v65, v65, v10, v8
    v_cvt_pk_bf16_f32 v72, v64, v65
    v_lshlrev_b32 v66, 16, v17
    v_and_b32 v67, 0xffff0000, v17
    v_fma_f32 v66, v66, v10, v8
    v_fma_f32 v67, v67, v10, v8
    v_cvt_pk_bf16_f32 v74, v66, v67
    v_lshlrev_b32 v68, 16, v18
    v_and_b32 v69, 0xffff0000, v18
    v_fma_f32 v68, v68, v10, v8
    v_fma_f32 v69, v69, v10, v8
    v_cvt_pk_bf16_f32 v76, v68, v69
    v_lshlrev_b32 v70, 16, v19
    v_and_b32 v71, 0xffff0000, v19
    v_fma_f32 v70, v70, v10, v8
    v_fma_f32 v71, v71, v10, v8
    v_cvt_pk_bf16_f32 v78, v70, v71
    v_lshlrev_b32 v64, 16, v20
    v_and_b32 v65, 0xffff0000, v20
    v_fma_f32 v64, v64, v10, v8
    v_fma_f32 v65, v65, v10, v8
    v_cvt_pk_bf16_f32 v73, v64, v65
    v_lshlrev_b32 v66, 16, v21
    v_and_b32 v67, 0xffff0000, v21
    v_fma_f32 v66, v66, v10, v8
    v_fma_f32 v67, v67, v10, v8
    v_cvt_pk_bf16_f32 v75, v66, v67
    v_lshlrev_b32 v68, 16, v22
    v_and_b32 v69, 0xffff0000, v22
    v_fma_f32 v68, v68, v10, v8
    v_fma_f32 v69, v69, v10, v8
    v_cvt_pk_bf16_f32 v77, v68, v69
    v_lshlrev_b32 v70, 16, v23
    v_and_b32 v71, 0xffff0000, v23
    v_fma_f32 v70, v70, v10, v8
    v_fma_f32 v71, v71, v10, v8
    v_cvt_pk_bf16_f32 v79, v70, v71
    buffer_store_dwordx4 v[72:75], v2, s[8:11], s18 offen offset:0 sc1
    buffer_store_dwordx4 v[76:79], v2, s[8:11], s18 offen offset:512 sc1
    s_add_u32 s18, s18, 8192
    v_lshlrev_b32 v64, 16, v24
    v_and_b32 v65, 0xffff0000, v24
    v_fma_f32 v64, v64, v10, v8
    v_fma_f32 v65, v65, v10, v8
    v_cvt_pk_bf16_f32 v80, v64, v65
    v_lshlrev_b32 v66, 16, v25
    v_and_b32 v67, 0xffff0000, v25
    v_fma_f32 v66, v66, v10, v8
    v_fma_f32 v67, v67, v10, v8
    v_cvt_pk_bf16_f32 v82, v66, v67
    v_lshlrev_b32 v68, 16, v26
    v_and_b32 v69, 0xffff0000, v26
    v_fma_f32 v68, v68, v10, v8
    v_fma_f32 v69, v69, v10, v8
    v_cvt_pk_bf16_f32 v84, v68, v69
    v_lshlrev_b32 v70, 16, v27
    v_and_b32 v71, 0xffff0000, v27
    v_fma_f32 v70, v70, v10, v8
    v_fma_f32 v71, v71, v10, v8
    v_cvt_pk_bf16_f32 v86, v70, v71
    v_lshlrev_b32 v64, 16, v28
    v_and_b32 v65, 0xffff0000, v28
    v_fma_f32 v64, v64, v10, v8
    v_fma_f32 v65, v65, v10, v8
    v_cvt_pk_bf16_f32 v81, v64, v65
    v_lshlrev_b32 v66, 16, v29
    v_and_b32 v67, 0xffff0000, v29
    v_fma_f32 v66, v66, v10, v8
    v_fma_f32 v67, v67, v10, v8
    v_cvt_pk_bf16_f32 v83, v66, v67
    v_lshlrev_b32 v68, 16, v30
    v_and_b32 v69, 0xffff0000, v30
    v_fma_f32 v68, v68, v10, v8
    v_fma_f32 v69, v69, v10, v8
    v_cvt_pk_bf16_f32 v85, v68, v69
    v_lshlrev_b32 v70, 16, v31
    v_and_b32 v71, 0xffff0000, v31
    v_fma_f32 v70, v70, v10, v8
    v_fma_f32 v71, v71, v10, v8
    v_cvt_pk_bf16_f32 v87, v70, v71
    buffer_store_dwordx4 v[80:83], v2, s[8:11], s18 offen offset:0 sc1
    buffer_store_dwordx4 v[84:87], v2, s[8:11], s18 offen offset:512 sc1
    s_add_u32 s18, s18, 8192
    v_lshlrev_b32 v64, 16, v32
    v_and_b32 v65, 0xffff0000, v32
    v_fma_f32 v64, v64, v10, v8
    v_fma_f32 v65, v65, v10, v8
    v_cvt_pk_bf16_f32 v72, v64, v65
    v_lshlrev_b32 v66, 16, v33
    v_and_b32 v67, 0xffff0000, v33
    v_fma_f32 v66, v66, v10, v8
    v_fma_f32 v67, v67, v10, v8
    v_cvt_pk_bf16_f32 v74, v66, v67
    v_lshlrev_b32 v68, 16, v34
    v_and_b32 v69, 0xffff0000, v34
    v_fma_f32 v68, v68, v10, v8
    v_fma_f32 v69, v69, v10, v8
    v_cvt_pk_bf16_f32 v76, v68, v69
    v_lshlrev_b32 v70, 16, v35
    v_and_b32 v71, 0xffff0000, v35
    v_fma_f32 v70, v70, v10, v8
    v_fma_f32 v71, v71, v10, v8
    v_cvt_pk_bf16_f32 v78, v70, v71
    v_lshlrev_b32 v64, 16, v36
    v_and_b32 v65, 0xffff0000, v36
    v_fma_f32 v64, v64, v10, v8
    v_fma_f32 v65, v65, v10, v8
    v_cvt_pk_bf16_f32 v73, v64, v65
    v_lshlrev_b32 v66, 16, v37
    v_and_b32 v67, 0xffff0000, v37
    v_fma_f32 v66, v66, v10, v8
    v_fma_f32 v67, v67, v10, v8
    v_cvt_pk_bf16_f32 v75, v66, v67
    v_lshlrev_b32 v68, 16, v38
    v_and_b32 v69, 0xffff0000, v38
    v_fma_f32 v68, v68, v10, v8
    v_fma_f32 v69, v69, v10, v8
    v_cvt_pk_bf16_f32 v77, v68, v69
    v_lshlrev_b32 v70, 16, v39
    v_and_b32 v71, 0xffff0000, v39
    v_fma_f32 v70, v70, v10, v8
    v_fma_f32 v71, v71, v10, v8
    v_cvt_pk_bf16_f32 v79, v70, v71
    buffer_store_dwordx4 v[72:75], v2, s[8:11], s18 offen offset:0 sc1
    buffer_store_dwordx4 v[76:79], v2, s[8:11], s18 offen offset:512 sc1
    s_add_u32 s18, s18, 8192
    v_lshlrev_b32 v64, 16, v40
    v_and_b32 v65, 0xffff0000, v40
    v_fma_f32 v64, v64, v10, v8
    v_fma_f32 v65, v65, v10, v8
    v_cvt_pk_bf16_f32 v80, v64, v65
    v_lshlrev_b32 v66, 16, v41
    v_and_b32 v67, 0xffff0000, v41
    v_fma_f32 v66, v66, v10, v8
    v_fma_f32 v67, v67, v10, v8
    v_cvt_pk_bf16_f32 v82, v66, v67
    v_lshlrev_b32 v68, 16, v42
    v_and_b32 v69, 0xffff0000, v42
    v_fma_f32 v68, v68, v10, v8
    v_fma_f32 v69, v69, v10, v8
    v_cvt_pk_bf16_f32 v84, v68, v69
    v_lshlrev_b32 v70, 16, v43
    v_and_b32 v71, 0xffff0000, v43
    v_fma_f32 v70, v70, v10, v8
    v_fma_f32 v71, v71, v10, v8
    v_cvt_pk_bf16_f32 v86, v70, v71
    v_lshlrev_b32 v64, 16, v44
    v_and_b32 v65, 0xffff0000, v44
    v_fma_f32 v64, v64, v10, v8
    v_fma_f32 v65, v65, v10, v8
    v_cvt_pk_bf16_f32 v81, v64, v65
    v_lshlrev_b32 v66, 16, v45
    v_and_b32 v67, 0xffff0000, v45
    v_fma_f32 v66, v66, v10, v8
    v_fma_f32 v67, v67, v10, v8
    v_cvt_pk_bf16_f32 v83, v66, v67
    v_lshlrev_b32 v68, 16, v46
    v_and_b32 v69, 0xffff0000, v46
    v_fma_f32 v68, v68, v10, v8
    v_fma_f32 v69, v69, v10, v8
    v_cvt_pk_bf16_f32 v85, v68, v69
    v_lshlrev_b32 v70, 16, v47
    v_and_b32 v71, 0xffff0000, v47
    v_fma_f32 v70, v70, v10, v8
    v_fma_f32 v71, v71, v10, v8
    v_cvt_pk_bf16_f32 v87, v70, v71
    buffer_store_dwordx4 v[80:83], v2, s[8:11], s18 offen offset:0 sc1
    buffer_store_dwordx4 v[84:87], v2, s[8:11], s18 offen offset:512 sc1
    s_add_u32 s18, s18, 8192
    v_lshlrev_b32 v64, 16, v48
    v_and_b32 v65, 0xffff0000, v48
    v_fma_f32 v64, v64, v10, v8
    v_fma_f32 v65, v65, v10, v8
    v_cvt_pk_bf16_f32 v72, v64, v65
    v_lshlrev_b32 v66, 16, v49
    v_and_b32 v67, 0xffff0000, v49
    v_fma_f32 v66, v66, v10, v8
    v_fma_f32 v67, v67, v10, v8
    v_cvt_pk_bf16_f32 v74, v66, v67
    v_lshlrev_b32 v68, 16, v50
    v_and_b32 v69, 0xffff0000, v50
    v_fma_f32 v68, v68, v10, v8
    v_fma_f32 v69, v69, v10, v8
    v_cvt_pk_bf16_f32 v76, v68, v69
    v_lshlrev_b32 v70, 16, v51
    v_and_b32 v71, 0xffff0000, v51
    v_fma_f32 v70, v70, v10, v8
    v_fma_f32 v71, v71, v10, v8
    v_cvt_pk_bf16_f32 v78, v70, v71
    v_lshlrev_b32 v64, 16, v52
    v_and_b32 v65, 0xffff0000, v52
    v_fma_f32 v64, v64, v10, v8
    v_fma_f32 v65, v65, v10, v8
    v_cvt_pk_bf16_f32 v73, v64, v65
    v_lshlrev_b32 v66, 16, v53
    v_and_b32 v67, 0xffff0000, v53
    v_fma_f32 v66, v66, v10, v8
    v_fma_f32 v67, v67, v10, v8
    v_cvt_pk_bf16_f32 v75, v66, v67
    v_lshlrev_b32 v68, 16, v54
    v_and_b32 v69, 0xffff0000, v54
    v_fma_f32 v68, v68, v10, v8
    v_fma_f32 v69, v69, v10, v8
    v_cvt_pk_bf16_f32 v77, v68, v69
    v_lshlrev_b32 v70, 16, v55
    v_and_b32 v71, 0xffff0000, v55
    v_fma_f32 v70, v70, v10, v8
    v_fma_f32 v71, v71, v10, v8
    v_cvt_pk_bf16_f32 v79, v70, v71
    buffer_store_dwordx4 v[72:75], v2, s[8:11], s18 offen offset:0 sc1
    buffer_store_dwordx4 v[76:79], v2, s[8:11], s18 offen offset:512 sc1
    s_waitcnt vmcnt(0)
    s_lshl_b32 s17, s14, 4
    s_lshl_b32 s19, s13, 2
    s_add_u32 s17, s17, s19
    s_add_u32 s17, s17, s48
    s_add_u32 s17, s17, 45056
    v_mov_b32 v5, 0
    s_mov_b64 exec, 1
    buffer_store_dword v4, v5, s[8:11], s17 offen sc1
    s_mov_b64 exec, -1
    s_add_u32 s14, s14, 4
    s_cmp_lt_u32 s14, 64
    s_cbranch_scc1 layerb1_kernel_ln_seg
    s_waitcnt vmcnt(0)
    s_barrier
layerb1_kernel_w3:
    s_mov_b32 s15, 400000
layerb1_kernel_j_next:
    s_cmp_lg_u32 s13, 0
    s_cbranch_scc1 layerb1_kernel_j_rel
    s_mov_b64 exec, 1
    v_mov_b32 v2, 31744
    v_mov_b32 v3, 1
    buffer_atomic_add v3, v2, s[8:11], s48 offen sc0 sc1
    s_waitcnt vmcnt(0)
    s_mov_b64 exec, -1
    s_nop 0
    v_readfirstlane_b32 s38, v3
    s_cmp_ge_u32 s38, 1152
    s_cbranch_scc1 layerb1_kernel_j_pub
    s_mul_i32 s39, s38, 58255
    s_lshr_b32 s40, s39, 20
    s_mul_i32 s39, s40, 18
    s_sub_u32 s41, s38, s39
    s_add_u32 s42, s40, 1
    v_mov_b32 v4, s42
    s_cmp_ge_u32 s41, 8
    s_cbranch_scc1 layerb1_kernel_j_dep_b
    s_lshl_b32 s24, s41, 9
    s_add_u32 s24, s24, 16384
    v_lshlrev_b32 v2, 7, v0
    v_add_u32 v2, s24, v2
    s_mul_i32 s25, s41, 3
    s_add_u32 s25, s25, 104
    s_lshl_b32 s25, s25, 7
    v_writelane_b32 v2, s25, 4
    s_add_u32 s25, s25, 128
    v_writelane_b32 v2, s25, 5
    s_add_u32 s25, s25, 128
    v_writelane_b32 v2, s25, 6
    s_mov_b64 exec, 0x7f
    s_branch layerb1_kernel_j_poll
layerb1_kernel_j_dep_b:
    s_sub_u32 s24, s41, 8
    s_lshl_b32 s24, s24, 10
    s_add_u32 s24, s24, 20480
    v_lshlrev_b32 v2, 7, v0
    v_add_u32 v2, s24, v2
    s_lshl_b32 s25, s40, 4
    s_add_u32 s25, s25, 30720
    v_writelane_b32 v2, s25, 8
    s_mov_b32 s26, 8
    v_writelane_b32 v4, s26, 8
    s_mov_b64 exec, 0x1ff
layerb1_kernel_j_poll:
    buffer_load_dword v3, v2, s[8:11], s48 offen sc1
    s_waitcnt vmcnt(0)
    v_cmp_gt_u32 vcc, v4, v3
    s_sub_u32 s15, s15, 1
    s_cbranch_scc1 layerb1_kernel_j_giveup
    s_cbranch_vccnz layerb1_kernel_j_poll
    s_mov_b64 exec, -1
layerb1_kernel_j_pub:
    v_mov_b32 v2, 0
    v_mov_b32 v3, s38
    ds_write_b32 v2, v3 offset:32768
    s_waitcnt lgkmcnt(0)
layerb1_kernel_j_rel:
    s_barrier
    v_mov_b32 v2, 0
    ds_read_b32 v3, v2 offset:32768
    s_waitcnt lgkmcnt(0)
    v_readfirstlane_b32 s38, v3
    s_cmp_ge_u32 s38, 1152
    s_cbranch_scc1 layerb1_kernel_j_done
    s_mul_i32 s39, s38, 58255
    s_lshr_b32 s40, s39, 20
    s_mul_i32 s39, s40, 18
    s_sub_u32 s41, s38, s39
    s_cmp_ge_u32 s41, 8
    s_cbranch_scc1 layerb1_kernel_j_b
    s_lshl_b32 s41, s41, 2
    s_add_u32 s41, s41, s13
    v_lshlrev_b32 v1, 4, v0
    v_and_b32 v2, 31, v0
    v_lshrrev_b32 v3, 5, v0
    s_lshl_b32 s24, s40, 5
    s_add_u32 s24, s24, s41
    s_mul_i32 s25, s24, 12288
    s_add_u32 s26, s25, 78643200
    s_add_u32 s27, s25, 53477376
    s_mul_i32 s28, s24, 3072
    s_add_u32 s28, s28, 208666624
    v_and_b32 v4, 7, v0
    v_lshlrev_b32 v4, 4, v4
    v_lshl_add_u32 v4, v3, 7, v4
    buffer_load_dwordx4 v[16:19], v1, s[8:11], s26 offen offset:0 sc1
    buffer_load_dwordx4 v[64:67], v1, s[8:11], s27 offen offset:0 sc1
    buffer_load_dwordx4 v[112:115], v4, s[8:11], s28 offen offset:0 sc1
    buffer_load_dwordx4 v[20:23], v1, s[8:11], s26 offen offset:1024 sc1
    buffer_load_dwordx4 v[68:71], v1, s[8:11], s27 offen offset:1024 sc1
    buffer_load_dwordx4 v[116:119], v4, s[8:11], s28 offen offset:256 sc1
    buffer_load_dwordx4 v[24:27], v1, s[8:11], s26 offen offset:2048 sc1
    buffer_load_dwordx4 v[72:75], v1, s[8:11], s27 offen offset:2048 sc1
    buffer_load_dwordx4 v[120:123], v4, s[8:11], s28 offen offset:512 sc1
    buffer_load_dwordx4 v[28:31], v1, s[8:11], s26 offen offset:3072 sc1
    buffer_load_dwordx4 v[76:79], v1, s[8:11], s27 offen offset:3072 sc1
    buffer_load_dwordx4 v[124:127], v4, s[8:11], s28 offen offset:768 sc1
    s_add_u32 s26, s26, 4096
    s_add_u32 s27, s27, 4096
    buffer_load_dwordx4 v[32:35], v1, s[8:11], s26 offen offset:0 sc1
    buffer_load_dwordx4 v[80:83], v1, s[8:11], s27 offen offset:0 sc1
    buffer_load_dwordx4 v[128:131], v4, s[8:11], s28 offen offset:1024 sc1
    buffer_load_dwordx4 v[36:39], v1, s[8:11], s26 offen offset:1024 sc1
    buffer_load_dwordx4 v[84:87], v1, s[8:11], s27 offen offset:1024 sc1
    buffer_load_dwordx4 v[132:135], v4, s[8:11], s28 offen offset:1280 sc1
    buffer_load_dwordx4 v[40:43], v1, s[8:11], s26 offen offset:2048 sc1
    buffer_load_dwordx4 v[88:91], v1, s[8:11], s27 offen offset:2048 sc1
    buffer_load_dwordx4 v[136:139], v4, s[8:11], s28 offen offset:1536 sc1
    buffer_load_dwordx4 v[44:47], v1, s[8:11], s26 offen offset:3072 sc1
    buffer_load_dwordx4 v[92:95], v1, s[8:11], s27 offen offset:3072 sc1
    buffer_load_dwordx4 v[140:143], v4, s[8:11], s28 offen offset:1792 sc1
    s_add_u32 s26, s26, 4096
    s_add_u32 s27, s27, 4096
    buffer_load_dwordx4 v[48:51], v1, s[8:11], s26 offen offset:0 sc1
    buffer_load_dwordx4 v[96:99], v1, s[8:11], s27 offen offset:0 sc1
    buffer_load_dwordx4 v[144:147], v4, s[8:11], s28 offen offset:2048 sc1
    buffer_load_dwordx4 v[52:55], v1, s[8:11], s26 offen offset:1024 sc1
    buffer_load_dwordx4 v[100:103], v1, s[8:11], s27 offen offset:1024 sc1
    buffer_load_dwordx4 v[148:151], v4, s[8:11], s28 offen offset:2304 sc1
    buffer_load_dwordx4 v[56:59], v1, s[8:11], s26 offen offset:2048 sc1
    buffer_load_dwordx4 v[104:107], v1, s[8:11], s27 offen offset:2048 sc1
    buffer_load_dwordx4 v[152:155], v4, s[8:11], s28 offen offset:2560 sc1
    buffer_load_dwordx4 v[60:63], v1, s[8:11], s26 offen offset:3072 sc1
    buffer_load_dwordx4 v[108:111], v1, s[8:11], s27 offen offset:3072 sc1
    buffer_load_dwordx4 v[156:159], v4, s[8:11], s28 offen offset:2816 sc1
    v_lshlrev_b32 v5, 2, v3
    v_sub_u32 v5, v2, v5
    v_mov_b32 v6, 0xf149f2ca
    v_cmp_gt_i32 vcc, 0, v5
    s_nop 1
    v_cndmask_b32 v192, 0, v6, vcc
    v_cmp_gt_i32 vcc, 1, v5
    s_nop 1
    v_cndmask_b32 v193, 0, v6, vcc
    v_cmp_gt_i32 vcc, 2, v5
    s_nop 1
    v_cndmask_b32 v194, 0, v6, vcc
    v_cmp_gt_i32 vcc, 3, v5
    s_nop 1
    v_cndmask_b32 v195, 0, v6, vcc
    v_cmp_gt_i32 vcc, 8, v5
    s_nop 1
    v_cndmask_b32 v196, 0, v6, vcc
    v_cmp_gt_i32 vcc, 9, v5
    s_nop 1
    v_cndmask_b32 v197, 0, v6, vcc
    v_cmp_gt_i32 vcc, 10, v5
    s_nop 1
    v_cndmask_b32 v198, 0, v6, vcc
    v_cmp_gt_i32 vcc, 11, v5
    s_nop 1
    v_cndmask_b32 v199, 0, v6, vcc
    v_cmp_gt_i32 vcc, 16, v5
    s_nop 1
    v_cndmask_b32 v200, 0, v6, vcc
    v_cmp_gt_i32 vcc, 17, v5
    s_nop 1
    v_cndmask_b32 v201, 0, v6, vcc
    v_cmp_gt_i32 vcc, 18, v5
    s_nop 1
    v_cndmask_b32 v202, 0, v6, vcc
    v_cmp_gt_i32 vcc, 19, v5
    s_nop 1
    v_cndmask_b32 v203, 0, v6, vcc
    v_cmp_gt_i32 vcc, 24, v5
    s_nop 1
    v_cndmask_b32 v204, 0, v6, vcc
    v_cmp_gt_i32 vcc, 25, v5
    s_nop 1
    v_cndmask_b32 v205, 0, v6, vcc
    v_cmp_gt_i32 vcc, 26, v5
    s_nop 1
    v_cndmask_b32 v206, 0, v6, vcc
    v_cmp_gt_i32 vcc, 27, v5
    s_nop 1
    v_cndmask_b32 v207, 0, v6, vcc
    s_waitcnt vmcnt(33)
    v_mfma_f32_32x32x16_bf16 v[160:175], v[64:67], v[16:19], 0
    v_mfma_f32_32x32x16_bf16 v[176:191], v[112:115], v[16:19], 0
    s_waitcnt vmcnt(30)
    v_mfma_f32_32x32x16_bf16 v[160:175], v[68:71], v[20:23], v[160:175]
    v_mfma_f32_32x32x16_bf16 v[176:191], v[116:119], v[20:23], v[176:191]
    s_waitcnt vmcnt(27)
    v_mfma_f32_32x32x16_bf16 v[160:175], v[72:75], v[24:27], v[160:175]
    v_mfma_f32_32x32x16_bf16 v[176:191], v[120:123], v[24:27], v[176:191]
    s_waitcnt vmcnt(24)
    v_mfma_f32_32x32x16_bf16 v[160:175], v[76:79], v[28:31], v[160:175]
    v_mfma_f32_32x32x16_bf16 v[176:191], v[124:127], v[28:31], v[176:191]
    s_waitcnt vmcnt(21)
    v_mfma_f32_32x32x16_bf16 v[160:175], v[80:83], v[32:35], v[160:175]
    v_mfma_f32_32x32x16_bf16 v[176:191], v[128:131], v[32:35], v[176:191]
    s_waitcnt vmcnt(18)
    v_mfma_f32_32x32x16_bf16 v[160:175], v[84:87], v[36:39], v[160:175]
    v_mfma_f32_32x32x16_bf16 v[176:191], v[132:135], v[36:39], v[176:191]
    s_waitcnt vmcnt(15)
    v_mfma_f32_32x32x16_bf16 v[160:175], v[88:91], v[40:43], v[160:175]
    v_mfma_f32_32x32x16_bf16 v[176:191], v[136:139], v[40:43], v[176:191]
    s_waitcnt vmcnt(12)
    v_mfma_f32_32x32x16_bf16 v[160:175], v[92:95], v[44:47], v[160:175]
    v_mfma_f32_32x32x16_bf16 v[176:191], v[140:143], v[44:47], v[176:191]
    s_waitcnt vmcnt(9)
    v_mfma_f32_32x32x16_bf16 v[160:175], v[96:99], v[48:51], v[160:175]
    v_mfma_f32_32x32x16_bf16 v[176:191], v[144:147], v[48:51], v[176:191]
    s_waitcnt vmcnt(6)
    v_mfma_f32_32x32x16_bf16 v[160:175], v[100:103], v[52:55], v[160:175]
    v_mfma_f32_32x32x16_bf16 v[176:191], v[148:151], v[52:55], v[176:191]
    s_waitcnt vmcnt(3)
    v_mfma_f32_32x32x16_bf16 v[160:175], v[104:107], v[56:59], v[160:175]
    v_mfma_f32_32x32x16_bf16 v[176:191], v[152:155], v[56:59], v[176:191]
    s_waitcnt vmcnt(0)
    v_mfma_f32_32x32x16_bf16 v[160:175], v[108:111], v[60:63], v[160:175]
    v_mfma_f32_32x32x16_bf16 v[176:191], v[156:159], v[60:63], v[176:191]
    s_nop 7
    s_nop 7
    v_mov_b32 v7, 0x3dd53b95
    v_fma_f32 v160, v160, v7, v192
    v_fma_f32 v161, v161, v7, v193
    v_fma_f32 v162, v162, v7, v194
    v_fma_f32 v163, v163, v7, v195
    v_fma_f32 v164, v164, v7, v196
    v_fma_f32 v165, v165, v7, v197
    v_fma_f32 v166, v166, v7, v198
    v_fma_f32 v167, v167, v7, v199
    v_fma_f32 v168, v168, v7, v200
    v_fma_f32 v169, v169, v7, v201
    v_fma_f32 v170, v170, v7, v202
    v_fma_f32 v171, v171, v7, v203
    v_fma_f32 v172, v172, v7, v204
    v_fma_f32 v173, v173, v7, v205
    v_fma_f32 v174, v174, v7, v206
    v_fma_f32 v175, v175, v7, v207
    v_mul_f32 v176, v176, v7
    v_mul_f32 v177, v177, v7
    v_mul_f32 v178, v178, v7
    v_mul_f32 v179, v179, v7
    v_max3_f32 v208, v160, v161, v162
    v_max3_f32 v208, v208, v163, v164
    v_max3_f32 v208, v208, v165, v166
    v_max3_f32 v208, v208, v167, v168
    v_max3_f32 v208, v208, v169, v170
    v_max3_f32 v208, v208, v171, v172
    v_max3_f32 v208, v208, v173, v174
    v_max3_f32 v208, v208, v175, v176
    v_max3_f32 v208, v208, v177, v178
    v_max_f32 v208, v208, v179
    v_mov_b32 v209, v208
    s_nop 1
    v_permlane32_swap_b32 v208, v209
    v_max_f32 v208, v208, v209
    v_sub_f32 v160, v160, v208
    v_sub_f32 v161, v161, v208
    v_sub_f32 v162, v162, v208
    v_sub_f32 v163, v163, v208
    v_sub_f32 v164, v164, v208
    v_sub_f32 v165, v165, v208
    v_sub_f32 v166, v166, v208
    v_sub_f32 v167, v167, v208
    v_sub_f32 v168, v168, v208
    v_sub_f32 v169, v169, v208
    v_sub_f32 v170, v170, v208
    v_sub_f32 v171, v171, v208
    v_sub_f32 v172, v172, v208
    v_sub_f32 v173, v173, v208
    v_sub_f32 v174, v174, v208
    v_sub_f32 v175, v175, v208
    v_sub_f32 v176, v176, v208
    v_sub_f32 v177, v177, v208
    v_sub_f32 v178, v178, v208
    v_sub_f32 v179, v179, v208
    v_exp_f32 v160, v160
    v_exp_f32 v161, v161
    v_exp_f32 v162, v162
    v_exp_f32 v163, v163
    v_exp_f32 v164, v164
    v_exp_f32 v165, v165
    v_exp_f32 v166, v166
    v_exp_f32 v167, v167
    v_exp_f32 v168, v168
    v_exp_f32 v169, v169
    v_exp_f32 v170, v170
    v_exp_f32 v171, v171
    v_exp_f32 v172, v172
    v_exp_f32 v173, v173
    v_exp_f32 v174, v174
    v_exp_f32 v175, v175
    v_exp_f32 v176, v176
    v_exp_f32 v177, v177
    v_exp_f32 v178, v178
    v_exp_f32 v179, v179
    s_nop 0
    v_add_f32 v210, v160, v161
    v_add_f32 v210, v210, v162
    v_add_f32 v210, v210, v163
    v_add_f32 v210, v210, v164
    v_add_f32 v210, v210, v165
    v_add_f32 v210, v210, v166
    v_add_f32 v210, v210, v167
    v_add_f32 v210, v210, v168
    v_add_f32 v210, v210, v169
    v_add_f32 v210, v210, v170
    v_add_f32 v210, v210, v171
    v_add_f32 v210, v210, v172
    v_add_f32 v210, v210, v173
    v_add_f32 v210, v210, v174
    v_add_f32 v210, v210, v175
    v_add_f32 v210, v210, v176
    v_add_f32 v210, v210, v177
    v_add_f32 v210, v210, v178
    v_add_f32 v210, v210, v179
    v_mov_b32 v209, v210
    s_nop 1
    v_permlane32_swap_b32 v210, v209
    v_add_f32 v210, v210, v209
    v_rcp_f32 v210, v210
    s_nop 0
    v_mul_f32 v160, v160, v210
    v_mul_f32 v161, v161, v210
    v_mul_f32 v162, v162, v210
    v_mul_f32 v163, v163, v210
    v_mul_f32 v164, v164, v210
    v_mul_f32 v165, v165, v210
    v_mul_f32 v166, v166, v210
    v_mul_f32 v167, v167, v210
    v_mul_f32 v168, v168, v210
    v_mul_f32 v169, v169, v210
    v_mul_f32 v170, v170, v210
    v_mul_f32 v171, v171, v210
    v_mul_f32 v172, v172, v210
    v_mul_f32 v173, v173, v210
    v_mul_f32 v174, v174, v210
    v_mul_f32 v175, v175, v210
    v_mul_f32 v176, v176, v210
    v_mul_f32 v177, v177, v210
    v_mul_f32 v178, v178, v210
    v_mul_f32 v179, v179, v210
    s_mul_i32 s25, s40, 81920
    s_mul_i32 s26, s41, 2560
    s_add_u32 s25, s25, s26
    s_add_u32 s25, s25, 214958080
    v_cvt_pk_bf16_f32 v16, v160, v161
    v_cvt_pk_bf16_f32 v17, v162, v163
    v_cvt_pk_bf16_f32 v18, v164, v165
    v_cvt_pk_bf16_f32 v19, v166, v167
    s_nop 1
    v_permlane32_swap_b32 v16, v18
    v_permlane32_swap_b32 v17, v19
    buffer_store_dwordx4 v[16:19], v1, s[8:11], s25 offen offset:512 sc1
    v_cvt_pk_bf16_f32 v20, v168, v169
    v_cvt_pk_bf16_f32 v21, v170, v171
    v_cvt_pk_bf16_f32 v22, v172, v173
    v_cvt_pk_bf16_f32 v23, v174, v175
    s_nop 1
    v_permlane32_swap_b32 v20, v22
    v_permlane32_swap_b32 v21, v23
    buffer_store_dwordx4 v[20:23], v1, s[8:11], s25 offen offset:1536 sc1
    v_cvt_pk_bf16_f32 v24, v176, v177
    v_cvt_pk_bf16_f32 v25, v178, v179
    v_lshlrev_b32 v4, 4, v2
    v_lshl_add_u32 v4, v3, 3, v4
    buffer_store_dwordx2 v[24:25], v4, s[8:11], s25 offen sc1
    s_waitcnt vmcnt(0)
    s_barrier
    s_cmp_lg_u32 s13, 0
    s_cbranch_scc1 layerb1_kernel_j_next
    s_mov_b64 exec, 1
    s_lshl_b32 s24, s40, 4
    s_add_u32 s24, s24, 30720
    v_mov_b32 v2, s24
    v_mov_b32 v3, 1
    buffer_atomic_add v3, v2, s[8:11], s48 offen sc1
    s_mov_b64 exec, -1
    s_branch layerb1_kernel_j_next
layerb1_kernel_j_b:
    s_sub_u32 s41, s41, 8
    v_lshlrev_b32 v1, 4, v0
    v_and_b32 v2, 31, v0
    v_lshrrev_b32 v3, 5, v0
    v_lshrrev_b32 v4, 3, v2
    v_mul_u32_u24 v4, 20480, v4
    v_and_b32 v5, 7, v2
    v_lshl_add_u32 v4, v5, 4, v4
    v_lshl_add_u32 v4, v3, 7, v4
    s_mul_i32 s24, s40, 1638400
    s_mul_i32 s25, s41, 163840
    s_add_u32 s24, s24, s25
    s_mul_i32 s25, s13, 5120
    s_add_u32 s24, s24, s25
    s_add_u32 s24, s24, 103809024
    s_add_u32 s28, s24, 81920
    s_mul_i32 s25, s40, 81920
    s_mul_i32 s26, s13, 20480
    s_add_u32 s25, s25, s26
    s_add_u32 s25, s25, 214958080
    v_mul_u32_u24 v6, 1280, v2
    v_lshl_add_u32 v6, v3, 4, v6
    s_mul_i32 s26, s40, 40960
    s_lshl_b32 s27, s41, 7
    s_add_u32 s26, s26, s27
    s_lshl_b32 s27, s13, 5
    s_add_u32 s26, s26, s27
    s_add_u32 s27, s26, 226492416
    buffer_load_dwordx4 v[8:11], v6, s[8:11], s27 offen sc1
    buffer_load_dwordx4 a[160:163], v1, s[8:11], s25 offen offset:0 sc1
    buffer_load_dwordx4 a[0:3], v4, s[8:11], s24 offen offset:0 sc1
    buffer_load_dwordx4 a[80:83], v4, s[8:11], s28 offen offset:0 sc1
    buffer_load_dwordx4 a[164:167], v1, s[8:11], s25 offen offset:1024 sc1
    buffer_load_dwordx4 a[4:7], v4, s[8:11], s24 offen offset:256 sc1
    buffer_load_dwordx4 a[84:87], v4, s[8:11], s28 offen offset:256 sc1
    buffer_load_dwordx4 a[168:171], v1, s[8:11], s25 offen offset:2048 sc1
    buffer_load_dwordx4 a[8:11], v4, s[8:11], s24 offen offset:512 sc1
    buffer_load_dwordx4 a[88:91], v4, s[8:11], s28 offen offset:512 sc1
    buffer_load_dwordx4 a[172:175], v1, s[8:11], s25 offen offset:3072 sc1
    buffer_load_dwordx4 a[12:15], v4, s[8:11], s24 offen offset:768 sc1
    buffer_load_dwordx4 a[92:95], v4, s[8:11], s28 offen offset:768 sc1
    s_add_u32 s25, s25, 4096
    buffer_load_dwordx4 a[176:179], v1, s[8:11], s25 offen offset:0 sc1
    buffer_load_dwordx4 a[16:19], v4, s[8:11], s24 offen offset:1024 sc1
    buffer_load_dwordx4 a[96:99], v4, s[8:11], s28 offen offset:1024 sc1
    buffer_load_dwordx4 a[180:183], v1, s[8:11], s25 offen offset:1024 sc1
    buffer_load_dwordx4 a[20:23], v4, s[8:11], s24 offen offset:1280 sc1
    buffer_load_dwordx4 a[100:103], v4, s[8:11], s28 offen offset:1280 sc1
    buffer_load_dwordx4 a[184:187], v1, s[8:11], s25 offen offset:2048 sc1
    buffer_load_dwordx4 a[24:27], v4, s[8:11], s24 offen offset:1536 sc1
    buffer_load_dwordx4 a[104:107], v4, s[8:11], s28 offen offset:1536 sc1
    buffer_load_dwordx4 a[188:191], v1, s[8:11], s25 offen offset:3072 sc1
    buffer_load_dwordx4 a[28:31], v4, s[8:11], s24 offen offset:1792 sc1
    buffer_load_dwordx4 a[108:111], v4, s[8:11], s28 offen offset:1792 sc1
    s_add_u32 s25, s25, 4096
    buffer_load_dwordx4 a[192:195], v1, s[8:11], s25 offen offset:0 sc1
    buffer_load_dwordx4 a[32:35], v4, s[8:11], s24 offen offset:2048 sc1
    buffer_load_dwordx4 a[112:115], v4, s[8:11], s28 offen offset:2048 sc1
    buffer_load_dwordx4 a[196:199], v1, s[8:11], s25 offen offset:1024 sc1
    buffer_load_dwordx4 a[36:39], v4, s[8:11], s24 offen offset:2304 sc1
    buffer_load_dwordx4 a[116:119], v4, s[8:11], s28 offen offset:2304 sc1
    buffer_load_dwordx4 a[200:203], v1, s[8:11], s25 offen offset:2048 sc1
    buffer_load_dwordx4 a[40:43], v4, s[8:11], s24 offen offset:2560 sc1
    buffer_load_dwordx4 a[120:123], v4, s[8:11], s28 offen offset:2560 sc1
    buffer_load_dwordx4 a[204:207], v1, s[8:11], s25 offen offset:3072 sc1
    buffer_load_dwordx4 a[44:47], v4, s[8:11], s24 offen offset:2816 sc1
    buffer_load_dwordx4 a[124:127], v4, s[8:11], s28 offen offset:2816 sc1
    s_add_u32 s25, s25, 4096
    buffer_load_dwordx4 a[208:211], v1, s[8:11], s25 offen offset:0 sc1
    buffer_load_dwordx4 a[48:51], v4, s[8:11], s24 offen offset:3072 sc1
    buffer_load_dwordx4 a[128:131], v4, s[8:11], s28 offen offset:3072 sc1
    buffer_load_dwordx4 a[212:215], v1, s[8:11], s25 offen offset:1024 sc1
    buffer_load_dwordx4 a[52:55], v4, s[8:11], s24 offen offset:3328 sc1
    buffer_load_dwordx4 a[132:135], v4, s[8:11], s28 offen offset:3328 sc1
    buffer_load_dwordx4 a[216:219], v1, s[8:11], s25 offen offset:2048 sc1
    buffer_load_dwordx4 a[56:59], v4, s[8:11], s24 offen offset:3584 sc1
    buffer_load_dwordx4 a[136:139], v4, s[8:11], s28 offen offset:3584 sc1
    buffer_load_dwordx4 a[220:223], v1, s[8:11], s25 offen offset:3072 sc1
    buffer_load_dwordx4 a[60:63], v4, s[8:11], s24 offen offset:3840 sc1
    buffer_load_dwordx4 a[140:143], v4, s[8:11], s28 offen offset:3840 sc1
    s_add_u32 s25, s25, 4096
    s_add_u32 s24, s24, 4096
    s_add_u32 s28, s28, 4096
    buffer_load_dwordx4 a[224:227], v1, s[8:11], s25 offen offset:0 sc1
    buffer_load_dwordx4 a[64:67], v4, s[8:11], s24 offen offset:0 sc1
    buffer_load_dwordx4 a[144:147], v4, s[8:11], s28 offen offset:0 sc1
    buffer_load_dwordx4 a[228:231], v1, s[8:11], s25 offen offset:1024 sc1
    buffer_load_dwordx4 a[68:71], v4, s[8:11], s24 offen offset:256 sc1
    buffer_load_dwordx4 a[148:151], v4, s[8:11], s28 offen offset:256 sc1
    buffer_load_dwordx4 a[232:235], v1, s[8:11], s25 offen offset:2048 sc1
    buffer_load_dwordx4 a[72:75], v4, s[8:11], s24 offen offset:512 sc1
    buffer_load_dwordx4 a[152:155], v4, s[8:11], s28 offen offset:512 sc1
    buffer_load_dwordx4 a[236:239], v1, s[8:11], s25 offen offset:3072 sc1
    buffer_load_dwordx4 a[76:79], v4, s[8:11], s24 offen offset:768 sc1
    buffer_load_dwordx4 a[156:159], v4, s[8:11], s28 offen offset:768 sc1
    s_waitcnt vmcnt(57)
    v_mfma_f32_32x32x16_bf16 v[16:31], a[0:3], a[160:163], 0
    v_mfma_f32_32x32x16_bf16 v[32:47], a[80:83], a[160:163], 0
    s_waitcnt vmcnt(54)
    v_mfma_f32_32x32x16_bf16 v[16:31], a[4:7], a[164:167], v[16:31]
    v_mfma_f32_32x32x16_bf16 v[32:47], a[84:87], a[164:167], v[32:47]
    s_waitcnt vmcnt(51)
    v_mfma_f32_32x32x16_bf16 v[16:31], a[8:11], a[168:171], v[16:31]
    v_mfma_f32_32x32x16_bf16 v[32:47], a[88:91], a[168:171], v[32:47]
    s_waitcnt vmcnt(48)
    v_mfma_f32_32x32x16_bf16 v[16:31], a[12:15], a[172:175], v[16:31]
    v_mfma_f32_32x32x16_bf16 v[32:47], a[92:95], a[172:175], v[32:47]
    s_waitcnt vmcnt(45)
    v_mfma_f32_32x32x16_bf16 v[16:31], a[16:19], a[176:179], v[16:31]
    v_mfma_f32_32x32x16_bf16 v[32:47], a[96:99], a[176:179], v[32:47]
    s_waitcnt vmcnt(42)
    v_mfma_f32_32x32x16_bf16 v[16:31], a[20:23], a[180:183], v[16:31]
    v_mfma_f32_32x32x16_bf16 v[32:47], a[100:103], a[180:183], v[32:47]
    s_waitcnt vmcnt(39)
    v_mfma_f32_32x32x16_bf16 v[16:31], a[24:27], a[184:187], v[16:31]
    v_mfma_f32_32x32x16_bf16 v[32:47], a[104:107], a[184:187], v[32:47]
    s_waitcnt vmcnt(36)
    v_mfma_f32_32x32x16_bf16 v[16:31], a[28:31], a[188:191], v[16:31]
    v_mfma_f32_32x32x16_bf16 v[32:47], a[108:111], a[188:191], v[32:47]
    s_waitcnt vmcnt(33)
    v_mfma_f32_32x32x16_bf16 v[16:31], a[32:35], a[192:195], v[16:31]
    v_mfma_f32_32x32x16_bf16 v[32:47], a[112:115], a[192:195], v[32:47]
    s_waitcnt vmcnt(30)
    v_mfma_f32_32x32x16_bf16 v[16:31], a[36:39], a[196:199], v[16:31]
    v_mfma_f32_32x32x16_bf16 v[32:47], a[116:119], a[196:199], v[32:47]
    s_waitcnt vmcnt(27)
    v_mfma_f32_32x32x16_bf16 v[16:31], a[40:43], a[200:203], v[16:31]
    v_mfma_f32_32x32x16_bf16 v[32:47], a[120:123], a[200:203], v[32:47]
    s_waitcnt vmcnt(24)
    v_mfma_f32_32x32x16_bf16 v[16:31], a[44:47], a[204:207], v[16:31]
    v_mfma_f32_32x32x16_bf16 v[32:47], a[124:127], a[204:207], v[32:47]
    s_waitcnt vmcnt(21)
    v_mfma_f32_32x32x16_bf16 v[16:31], a[48:51], a[208:211], v[16:31]
    v_mfma_f32_32x32x16_bf16 v[32:47], a[128:131], a[208:211], v[32:47]
    s_waitcnt vmcnt(18)
    v_mfma_f32_32x32x16_bf16 v[16:31], a[52:55], a[212:215], v[16:31]
    v_mfma_f32_32x32x16_bf16 v[32:47], a[132:135], a[212:215], v[32:47]
    s_waitcnt vmcnt(15)
    v_mfma_f32_32x32x16_bf16 v[16:31], a[56:59], a[216:219], v[16:31]
    v_mfma_f32_32x32x16_bf16 v[32:47], a[136:139], a[216:219], v[32:47]
    s_waitcnt vmcnt(12)
    v_mfma_f32_32x32x16_bf16 v[16:31], a[60:63], a[220:223], v[16:31]
    v_mfma_f32_32x32x16_bf16 v[32:47], a[140:143], a[220:223], v[32:47]
    s_waitcnt vmcnt(9)
    v_mfma_f32_32x32x16_bf16 v[16:31], a[64:67], a[224:227], v[16:31]
    v_mfma_f32_32x32x16_bf16 v[32:47], a[144:147], a[224:227], v[32:47]
    s_waitcnt vmcnt(6)
    v_mfma_f32_32x32x16_bf16 v[16:31], a[68:71], a[228:231], v[16:31]
    v_mfma_f32_32x32x16_bf16 v[32:47], a[148:151], a[228:231], v[32:47]
    s_waitcnt vmcnt(3)
    v_mfma_f32_32x32x16_bf16 v[16:31], a[72:75], a[232:235], v[16:31]
    v_mfma_f32_32x32x16_bf16 v[32:47], a[152:155], a[232:235], v[32:47]
    s_waitcnt vmcnt(0)
    v_mfma_f32_32x32x16_bf16 v[16:31], a[76:79], a[236:239], v[16:31]
    v_mfma_f32_32x32x16_bf16 v[32:47], a[156:159], a[236:239], v[32:47]
    s_lshl_b32 s27, s13, 11
    v_add_u32 v7, s27, v1
    s_nop 7
    s_nop 7
    ds_write_b128 v7, v[16:19] offset:0
    ds_write_b128 v7, v[20:23] offset:1024
    ds_write_b128 v7, v[24:27] offset:8192
    ds_write_b128 v7, v[28:31] offset:9216
    ds_write_b128 v7, v[32:35] offset:16384
    ds_write_b128 v7, v[36:39] offset:17408
    ds_write_b128 v7, v[40:43] offset:24576
    ds_write_b128 v7, v[44:47] offset:25600
    s_waitcnt lgkmcnt(0)
    s_barrier
    s_lshl_b32 s27, s13, 13
    v_add_u32 v7, s27, v1
    ds_read_b128 v[48:51], v7 offset:0
    ds_read_b128 v[52:55], v7 offset:1024
    ds_read_b128 v[56:59], v7 offset:2048
    ds_read_b128 v[60:63], v7 offset:3072
    ds_read_b128 v[64:67], v7 offset:4096
    ds_read_b128 v[68:71], v7 offset:5120
    ds_read_b128 v[72:75], v7 offset:6144
    ds_read_b128 v[76:79], v7 offset:7168
    s_waitcnt lgkmcnt(4)
    v_add_f32 v48, v48, v56
    v_add_f32 v49, v49, v57
    v_add_f32 v50, v50, v58
    v_add_f32 v51, v51, v59
    v_add_f32 v52, v52, v60
    v_add_f32 v53, v53, v61
    v_add_f32 v54, v54, v62
    v_add_f32 v55, v55, v63
    s_waitcnt lgkmcnt(0)
    v_add_f32 v64, v64, v72
    v_add_f32 v65, v65, v73
    v_add_f32 v66, v66, v74
    v_add_f32 v67, v67, v75
    v_add_f32 v68, v68, v76
    v_add_f32 v69, v69, v77
    v_add_f32 v70, v70, v78
    v_add_f32 v71, v71, v79
    v_add_f32 v48, v48, v64
    v_add_f32 v49, v49, v65
    v_add_f32 v50, v50, v66
    v_add_f32 v51, v51, v67
    v_add_f32 v52, v52, v68
    v_add_f32 v53, v53, v69
    v_add_f32 v54, v54, v70
    v_add_f32 v55, v55, v71
    v_cvt_pk_bf16_f32 v16, v48, v49
    v_cvt_pk_bf16_f32 v17, v50, v51
    v_cvt_pk_bf16_f32 v18, v52, v53
    v_cvt_pk_bf16_f32 v19, v54, v55
    s_nop 1
    v_permlane32_swap_b32 v16, v18
    v_permlane32_swap_b32 v17, v19
    s_nop 1
    v_lshlrev_b32 v48, 16, v16
    v_and_b32 v49, 0xffff0000, v16
    v_lshlrev_b32 v50, 16, v8
    v_and_b32 v51, 0xffff0000, v8
    v_add_f32 v48, v48, v50
    v_add_f32 v49, v49, v51
    v_cvt_pk_bf16_f32 v16, v48, v49
    v_lshlrev_b32 v48, 16, v17
    v_and_b32 v49, 0xffff0000, v17
    v_lshlrev_b32 v50, 16, v9
    v_and_b32 v51, 0xffff0000, v9
    v_add_f32 v48, v48, v50
    v_add_f32 v49, v49, v51
    v_cvt_pk_bf16_f32 v17, v48, v49
    v_lshlrev_b32 v48, 16, v18
    v_and_b32 v49, 0xffff0000, v18
    v_lshlrev_b32 v50, 16, v10
    v_and_b32 v51, 0xffff0000, v10
    v_add_f32 v48, v48, v50
    v_add_f32 v49, v49, v51
    v_cvt_pk_bf16_f32 v18, v48, v49
    v_lshlrev_b32 v48, 16, v19
    v_and_b32 v49, 0xffff0000, v19
    v_lshlrev_b32 v50, 16, v11
    v_and_b32 v51, 0xffff0000, v11
    v_add_f32 v48, v48, v50
    v_add_f32 v49, v49, v51
    v_cvt_pk_bf16_f32 v19, v48, v49
    buffer_store_dwordx4 v[16:19], v6, s[84:87], s26 offen
    s_branch layerb1_kernel_j_next
layerb1_kernel_j_giveup:
    s_mov_b64 exec, -1
    v_mov_b32 v2, 0
    v_mov_b32 v3, -1
    ds_write_b32 v2, v3 offset:32768
    s_waitcnt lgkmcnt(0)
    s_barrier
    s_branch layerb1_kernel_bail
layerb1_kernel_j_done:
    s_branch layerb1_kernel_end
layerb1_kernel_bail:
    s_mov_b64 exec, 1
    s_load_dwordx2 s[6:7], s[0:1], 88
    s_waitcnt lgkmcnt(0)
    s_mov_b32 s24, s6
    s_mov_b32 s25, s7
    s_mov_b32 s26, 256
    s_mov_b32 s27, 0x00020000
    v_mov_b32 v1, 0xdead
    v_mov_b32 v2, s14
    v_mov_b32 v3, 0
    buffer_store_dword v1, v3, s[24:27], 0 offen
    buffer_store_dword v2, v3, s[24:27], 0 offen offset:4
layerb1_kernel_end:
layerb1_kernel_end0:
    s_endpgm
.section .rodata,"a"
.p2align 6
.amdhsa_kernel layerb1_kernel
  .amdhsa_next_free_vgpr 512
  .amdhsa_next_free_sgpr 100
  .amdhsa_accum_offset 256
  .amdhsa_group_segment_fixed_size 0
  .amdhsa_kernarg_size 104
  .amdhsa_user_sgpr_count 2
  .amdhsa_user_sgpr_kernarg_segment_ptr 1
  .amdhsa_system_sgpr_workgroup_id_x 1
.end_amdhsa_kernel
```

```asm
; @launch kernel=prep_kernel grid=(733,1,1) block=(256,1,1) lds=73728
; @launch kernel=layerb1_kernel grid=(256,1,1) block=(256,1,1) lds=149760
; @launch kernel=layerb2_kernel grid=(256,1,1) block=(256,1,1) lds=149760
.amdgcn_target "amdgcn-amd-amdhsa--gfx950"
.text
.globl prep_kernel
.p2align 8
.type prep_kernel,@function
prep_kernel:
    s_cmp_ge_u32 s2, 733
    s_cbranch_scc1 prep_kernel_end
    s_load_dwordx2 s[4:5], s[0:1], 96
    v_lshrrev_b32 v1, 6, v0
    v_and_b32 v0, 63, v0
    s_nop 0
    v_readfirstlane_b32 s13, v1
    s_waitcnt lgkmcnt(0)
    s_mov_b32 s8, s4
    s_mov_b32 s9, s5
    s_mov_b32 s10, 268435456
    s_mov_b32 s11, 0x00020000
    s_mov_b32 s20, s2
    s_cmp_lt_u32 s2, 4
    s_cbranch_scc1 prep_kernel_r_cal
    s_cmp_eq_u32 s2, 4
    s_cbranch_scc1 prep_kernel_r_zero
    s_sub_u32 s20, s2, 5
    s_cmp_lt_u32 s20, 64
    s_cbranch_scc1 prep_kernel_r_pwa
    s_sub_u32 s20, s20, 64
    s_cmp_lt_u32 s20, 40
    s_cbranch_scc1 prep_kernel_r_pwo
    s_sub_u32 s20, s20, 40
    s_cmp_lt_u32 s20, 320
    s_cbranch_scc1 prep_kernel_r_wvo
    s_sub_u32 s20, s20, 320
    s_cmp_lt_u32 s20, 240
    s_cbranch_scc1 prep_kernel_r_pwp
    s_sub_u32 s20, s20, 240
    s_sub_u32 s21, 0, s4
    s_and_b32 s21, s21, 0x1fffff
    s_mul_i32 s22, s20, 131072
    s_add_u32 s21, s21, s22
    s_lshl_b32 s22, s13, 10
    s_add_u32 s21, s21, s22
    v_lshlrev_b32 v1, 4, v0
    v_mov_b32 v4, -1
    v_mov_b32 v5, -1
    v_mov_b32 v6, -1
    v_mov_b32 v7, -1
    s_mov_b32 s22, 32
prep_kernel_clr_loop:
    buffer_store_dwordx4 v[4:7], v1, s[8:11], s21 offen
    s_add_u32 s21, s21, 4096
    s_sub_u32 s22, s22, 1
    s_cmp_lg_u32 s22, 0
    s_cbranch_scc1 prep_kernel_clr_loop
    s_branch prep_kernel_end
prep_kernel_r_cal:
    s_branch prep_kernel_end
    s_cmp_lg_u32 s13, 0
    s_cbranch_scc1 prep_kernel_end
    s_sub_u32 s22, 0, s4
    s_and_b32 s22, s22, 0x1fffff
    s_getreg_b32 s23, hwreg(HW_REG_XCC_ID)
    s_bfe_u32 s23, s23, 0x10002
    s_mov_b64 exec, 1
    v_mov_b32 v1, 0
    s_mul_i32 s24, s20, 2097152
    s_add_u32 s22, s22, s24
    s_add_u32 s22, s22, 2086912
    s_mov_b32 s30, -1
    s_mov_b32 s31, -1
    s_mov_b32 s25, 8
    v_mov_b32 v2, 0
prep_kernel_cal:
    s_and_b32 s24, s25, 15
    s_lshl_b32 s24, s24, 7
    s_add_u32 s24, s24, s22
    s_memtime s[26:27]
    s_waitcnt lgkmcnt(0)
    buffer_atomic_add v2, v1, s[8:11], s24 offen sc0 sc1
    s_waitcnt vmcnt(0)
    s_memtime s[28:29]
    v_mov_b32 v2, 0
    s_waitcnt lgkmcnt(0)
    s_sub_u32 s26, s28, s26
    s_min_u32 s30, s30, s26
    s_and_b32 s24, s25, 15
    s_lshl_b32 s24, s24, 7
    s_add_u32 s24, s24, s22
    s_add_u32 s24, s24, 8192
    s_memtime s[26:27]
    s_waitcnt lgkmcnt(0)
    buffer_atomic_add v2, v1, s[8:11], s24 offen sc0 sc1
    s_waitcnt vmcnt(0)
    s_memtime s[28:29]
    v_mov_b32 v2, 0
    s_waitcnt lgkmcnt(0)
    s_sub_u32 s26, s28, s26
    s_min_u32 s31, s31, s26
    s_sub_u32 s25, s25, 1
    s_cmp_lg_u32 s25, 0
    s_cbranch_scc1 prep_kernel_cal
    s_cmp_lt_u32 s31, s30
    s_cselect_b32 s24, 1, 0
    s_xor_b32 s24, s24, s23
    s_lshl_b32 s24, s24, 13
    v_mov_b32 v3, s24
    s_lshl_b32 s25, s20, 2
    s_add_u32 s25, s25, 10551296
    buffer_store_dword v3, v1, s[8:11], s25 offen
    s_lshl_b32 s26, s30, 16
    s_or_b32 s26, s26, s31
    v_mov_b32 v3, s26
    buffer_store_dword v3, v1, s[8:11], s25 offen offset:64
    s_branch prep_kernel_end
prep_kernel_r_zero:
    v_lshlrev_b32 v1, 4, v0
    v_mov_b32 v4, 0
    v_mov_b32 v5, 0
    v_mov_b32 v6, 0
    v_mov_b32 v7, 0
    s_lshl_b32 s21, s13, 10
    s_add_u32 s21, s21, 10485760
    buffer_store_dwordx4 v[4:7], v1, s[8:11], s21 offen
    s_lshl_b32 s21, s13, 15
    s_add_u32 s21, s21, 10616832
    buffer_store_dwordx4 v[4:7], v1, s[8:11], s21 offen offset:0
    buffer_store_dwordx4 v[4:7], v1, s[8:11], s21 offen offset:1024
    buffer_store_dwordx4 v[4:7], v1, s[8:11], s21 offen offset:2048
    buffer_store_dwordx4 v[4:7], v1, s[8:11], s21 offen offset:3072
    s_add_u32 s21, s21, 4096
    buffer_store_dwordx4 v[4:7], v1, s[8:11], s21 offen offset:0
    buffer_store_dwordx4 v[4:7], v1, s[8:11], s21 offen offset:1024
    buffer_store_dwordx4 v[4:7], v1, s[8:11], s21 offen offset:2048
    buffer_store_dwordx4 v[4:7], v1, s[8:11], s21 offen offset:3072
    s_add_u32 s21, s21, 4096
    buffer_store_dwordx4 v[4:7], v1, s[8:11], s21 offen offset:0
    buffer_store_dwordx4 v[4:7], v1, s[8:11], s21 offen offset:1024
    buffer_store_dwordx4 v[4:7], v1, s[8:11], s21 offen offset:2048
    buffer_store_dwordx4 v[4:7], v1, s[8:11], s21 offen offset:3072
    s_add_u32 s21, s21, 4096
    buffer_store_dwordx4 v[4:7], v1, s[8:11], s21 offen offset:0
    buffer_store_dwordx4 v[4:7], v1, s[8:11], s21 offen offset:1024
    buffer_store_dwordx4 v[4:7], v1, s[8:11], s21 offen offset:2048
    buffer_store_dwordx4 v[4:7], v1, s[8:11], s21 offen offset:3072
    s_add_u32 s21, s21, 4096
    buffer_store_dwordx4 v[4:7], v1, s[8:11], s21 offen offset:0
    buffer_store_dwordx4 v[4:7], v1, s[8:11], s21 offen offset:1024
    buffer_store_dwordx4 v[4:7], v1, s[8:11], s21 offen offset:2048
    buffer_store_dwordx4 v[4:7], v1, s[8:11], s21 offen offset:3072
    s_add_u32 s21, s21, 4096
    buffer_store_dwordx4 v[4:7], v1, s[8:11], s21 offen offset:0
    buffer_store_dwordx4 v[4:7], v1, s[8:11], s21 offen offset:1024
    buffer_store_dwordx4 v[4:7], v1, s[8:11], s21 offen offset:2048
    buffer_store_dwordx4 v[4:7], v1, s[8:11], s21 offen offset:3072
    s_add_u32 s21, s21, 4096
    buffer_store_dwordx4 v[4:7], v1, s[8:11], s21 offen offset:0
    buffer_store_dwordx4 v[4:7], v1, s[8:11], s21 offen offset:1024
    buffer_store_dwordx4 v[4:7], v1, s[8:11], s21 offen offset:2048
    buffer_store_dwordx4 v[4:7], v1, s[8:11], s21 offen offset:3072
    s_add_u32 s21, s21, 4096
    buffer_store_dwordx4 v[4:7], v1, s[8:11], s21 offen offset:0
    buffer_store_dwordx4 v[4:7], v1, s[8:11], s21 offen offset:1024
    buffer_store_dwordx4 v[4:7], v1, s[8:11], s21 offen offset:2048
    buffer_store_dwordx4 v[4:7], v1, s[8:11], s21 offen offset:3072
    s_add_u32 s21, s21, 4096
    s_lshl_b32 s21, s13, 15
    s_add_u32 s21, s21, 10747904
    buffer_store_dwordx4 v[4:7], v1, s[8:11], s21 offen offset:0
    buffer_store_dwordx4 v[4:7], v1, s[8:11], s21 offen offset:1024
    buffer_store_dwordx4 v[4:7], v1, s[8:11], s21 offen offset:2048
    buffer_store_dwordx4 v[4:7], v1, s[8:11], s21 offen offset:3072
    s_add_u32 s21, s21, 4096
    buffer_store_dwordx4 v[4:7], v1, s[8:11], s21 offen offset:0
    buffer_store_dwordx4 v[4:7], v1, s[8:11], s21 offen offset:1024
    buffer_store_dwordx4 v[4:7], v1, s[8:11], s21 offen offset:2048
    buffer_store_dwordx4 v[4:7], v1, s[8:11], s21 offen offset:3072
    s_add_u32 s21, s21, 4096
    buffer_store_dwordx4 v[4:7], v1, s[8:11], s21 offen offset:0
    buffer_store_dwordx4 v[4:7], v1, s[8:11], s21 offen offset:1024
    buffer_store_dwordx4 v[4:7], v1, s[8:11], s21 offen offset:2048
    buffer_store_dwordx4 v[4:7], v1, s[8:11], s21 offen offset:3072
    s_add_u32 s21, s21, 4096
    buffer_store_dwordx4 v[4:7], v1, s[8:11], s21 offen offset:0
    buffer_store_dwordx4 v[4:7], v1, s[8:11], s21 offen offset:1024
    buffer_store_dwordx4 v[4:7], v1, s[8:11], s21 offen offset:2048
    buffer_store_dwordx4 v[4:7], v1, s[8:11], s21 offen offset:3072
    s_add_u32 s21, s21, 4096
    buffer_store_dwordx4 v[4:7], v1, s[8:11], s21 offen offset:0
    buffer_store_dwordx4 v[4:7], v1, s[8:11], s21 offen offset:1024
    buffer_store_dwordx4 v[4:7], v1, s[8:11], s21 offen offset:2048
    buffer_store_dwordx4 v[4:7], v1, s[8:11], s21 offen offset:3072
    s_add_u32 s21, s21, 4096
    buffer_store_dwordx4 v[4:7], v1, s[8:11], s21 offen offset:0
    buffer_store_dwordx4 v[4:7], v1, s[8:11], s21 offen offset:1024
    buffer_store_dwordx4 v[4:7], v1, s[8:11], s21 offen offset:2048
    buffer_store_dwordx4 v[4:7], v1, s[8:11], s21 offen offset:3072
    s_add_u32 s21, s21, 4096
    buffer_store_dwordx4 v[4:7], v1, s[8:11], s21 offen offset:0
    buffer_store_dwordx4 v[4:7], v1, s[8:11], s21 offen offset:1024
    buffer_store_dwordx4 v[4:7], v1, s[8:11], s21 offen offset:2048
    buffer_store_dwordx4 v[4:7], v1, s[8:11], s21 offen offset:3072
    s_add_u32 s21, s21, 4096
    buffer_store_dwordx4 v[4:7], v1, s[8:11], s21 offen offset:0
    buffer_store_dwordx4 v[4:7], v1, s[8:11], s21 offen offset:1024
    buffer_store_dwordx4 v[4:7], v1, s[8:11], s21 offen offset:2048
    buffer_store_dwordx4 v[4:7], v1, s[8:11], s21 offen offset:3072
    s_add_u32 s21, s21, 4096
    s_branch prep_kernel_end
prep_kernel_r_wvo:
    s_load_dwordx2 s[24:25], s[0:1], 56
    s_load_dwordx2 s[26:27], s[0:1], 64
    s_mul_i32 s23, s20, 6554
    s_lshr_b32 s23, s23, 16
    s_mul_i32 s28, s23, 10
    s_sub_u32 s22, s20, s28
    s_and_b32 s21, s22, 1
    s_lshr_b32 s22, s22, 1
    s_waitcnt lgkmcnt(0)
    s_mov_b32 s32, s24
    s_mov_b32 s33, s25
    s_mov_b32 s34, 7864320
    s_mov_b32 s35, 0x00020000
    s_mov_b32 s36, s26
    s_mov_b32 s37, s27
    s_mov_b32 s38, 7864320
    s_mov_b32 s39, 0x00020000
    v_and_b32 v1, 31, v0
    v_lshrrev_b32 v2, 5, v0
    v_lshrrev_b32 v11, 3, v0
    v_mul_u32_u24 v3, 1280, v11
    v_bfe_u32 v12, v0, 4, 1
    v_lshlrev_b32 v12, 2, v12
    v_and_b32 v13, 7, v0
    v_xor_b32 v13, v13, v12
    v_lshl_add_u32 v3, v13, 4, v3
    s_mul_i32 s28, s23, 192
    s_mul_i32 s29, s13, 48
    s_add_u32 s28, s28, s29
    s_mul_i32 s28, s28, 1280
    s_mul_i32 s29, s21, 640
    s_add_u32 s28, s28, s29
    s_mul_i32 s29, s13, 6144
    v_bfe_u32 v11, v0, 2, 2
    v_lshl_add_u32 v12, v2, 3, v11
    v_lshlrev_b32 v12, 7, v12
    v_bfe_u32 v13, v0, 4, 1
    v_lshlrev_b32 v13, 1, v13
    v_bfe_u32 v14, v0, 1, 1
    v_add_u32 v13, v13, v14
    v_lshl_add_u32 v12, v13, 4, v12
    v_and_b32 v13, 1, v0
    v_lshl_add_u32 v12, v13, 3, v12
    v_bfe_u32 v13, v0, 3, 1
    v_lshl_add_u32 v4, v13, 6, v12
    v_xor_b32 v13, 1, v13
    v_lshl_add_u32 v5, v13, 6, v12
    v_lshrrev_b32 v6, 3, v1
    v_lshrrev_b32 v7, 2, v6
    v_lshlrev_b32 v7, 5, v7
    v_and_b32 v8, 2, v6
    v_lshl_add_u32 v7, v8, 3, v7
    v_and_b32 v8, 1, v6
    v_lshl_add_u32 v7, v8, 2, v7
    v_and_b32 v8, 7, v1
    v_and_b32 v9, 1, v8
    v_add_u32 v7, v7, v9
    v_and_b32 v9, 2, v8
    v_lshl_add_u32 v7, v9, 2, v7
    v_lshrrev_b32 v9, 2, v8
    v_lshl_add_u32 v7, v9, 1, v7
    v_mul_u32_u24 v7, 12288, v7
    v_lshl_add_u32 v7, v2, 4, v7
    s_lshl_b32 s30, s22, 2
    s_add_u32 s30, s30, s13
    s_mul_i32 s31, s30, 393216
    s_mul_i32 s40, s23, 384
    s_add_u32 s31, s31, s40
    v_lshrrev_b32 v10, 3, v1
    v_mul_u32_u24 v10, 20480, v10
    v_lshlrev_b32 v10, 4, v10
    v_and_b32 v11, 7, v1
    v_lshl_add_u32 v10, v11, 4, v10
    v_lshl_add_u32 v10, v2, 8, v10
    s_mul_i32 s41, s21, 13107200
    s_lshr_b32 s40, s23, 3
    s_mul_i32 s40, s40, 81920
    s_add_u32 s41, s41, s40
    s_and_b32 s40, s23, 3
    s_mul_i32 s40, s40, 20480
    s_add_u32 s41, s41, s40
    s_bfe_u32 s40, s23, 0x10002
    s_lshl_b32 s40, s40, 7
    s_add_u32 s41, s41, s40
    s_lshl_b32 s40, s30, 10
    s_add_u32 s41, s41, s40
    s_add_u32 s41, s41, 27262976
    buffer_load_dwordx4 v[16:19], v7, s[32:35], s31 offen offset:0
    buffer_load_dwordx4 v[20:23], v7, s[32:35], s31 offen offset:32
    buffer_load_dwordx4 v[24:27], v7, s[32:35], s31 offen offset:64
    buffer_load_dwordx4 v[28:31], v7, s[32:35], s31 offen offset:96
    buffer_load_dwordx4 v[32:35], v7, s[32:35], s31 offen offset:128
    buffer_load_dwordx4 v[36:39], v7, s[32:35], s31 offen offset:160
    buffer_load_dwordx4 v[40:43], v7, s[32:35], s31 offen offset:192
    buffer_load_dwordx4 v[44:47], v7, s[32:35], s31 offen offset:224
    buffer_load_dwordx4 v[48:51], v7, s[32:35], s31 offen offset:256
    buffer_load_dwordx4 v[52:55], v7, s[32:35], s31 offen offset:288
    buffer_load_dwordx4 v[56:59], v7, s[32:35], s31 offen offset:320
    buffer_load_dwordx4 v[60:63], v7, s[32:35], s31 offen offset:352
    s_add_u32 s42, s29, 0
    s_mov_b32 m0, s42
    s_add_u32 s43, s28, 0
    buffer_load_dwordx4 v3, s[36:39], s43 offen lds
    s_add_u32 s42, s29, 1024
    s_mov_b32 m0, s42
    s_add_u32 s43, s28, 10240
    buffer_load_dwordx4 v3, s[36:39], s43 offen lds
    s_add_u32 s42, s29, 2048
    s_mov_b32 m0, s42
    s_add_u32 s43, s28, 20480
    buffer_load_dwordx4 v3, s[36:39], s43 offen lds
    s_add_u32 s42, s29, 3072
    s_mov_b32 m0, s42
    s_add_u32 s43, s28, 30720
    buffer_load_dwordx4 v3, s[36:39], s43 offen lds
    s_add_u32 s42, s29, 4096
    s_mov_b32 m0, s42
    s_add_u32 s43, s28, 40960
    buffer_load_dwordx4 v3, s[36:39], s43 offen lds
    s_add_u32 s42, s29, 5120
    s_mov_b32 m0, s42
    s_add_u32 s43, s28, 51200
    buffer_load_dwordx4 v3, s[36:39], s43 offen lds
    s_add_u32 s42, s29, 24576
    s_mov_b32 m0, s42
    s_add_u32 s43, s28, 128
    buffer_load_dwordx4 v3, s[36:39], s43 offen lds
    s_add_u32 s42, s29, 25600
    s_mov_b32 m0, s42
    s_add_u32 s43, s28, 10368
    buffer_load_dwordx4 v3, s[36:39], s43 offen lds
    s_add_u32 s42, s29, 26624
    s_mov_b32 m0, s42
    s_add_u32 s43, s28, 20608
    buffer_load_dwordx4 v3, s[36:39], s43 offen lds
    s_add_u32 s42, s29, 27648
    s_mov_b32 m0, s42
    s_add_u32 s43, s28, 30848
    buffer_load_dwordx4 v3, s[36:39], s43 offen lds
    s_add_u32 s42, s29, 28672
    s_mov_b32 m0, s42
    s_add_u32 s43, s28, 41088
    buffer_load_dwordx4 v3, s[36:39], s43 offen lds
    s_add_u32 s42, s29, 29696
    s_mov_b32 m0, s42
    s_add_u32 s43, s28, 51328
    buffer_load_dwordx4 v3, s[36:39], s43 offen lds
    s_add_u32 s42, s29, 49152
    s_mov_b32 m0, s42
    s_add_u32 s43, s28, 256
    buffer_load_dwordx4 v3, s[36:39], s43 offen lds
    s_add_u32 s42, s29, 50176
    s_mov_b32 m0, s42
    s_add_u32 s43, s28, 10496
    buffer_load_dwordx4 v3, s[36:39], s43 offen lds
    s_add_u32 s42, s29, 51200
    s_mov_b32 m0, s42
    s_add_u32 s43, s28, 20736
    buffer_load_dwordx4 v3, s[36:39], s43 offen lds
    s_add_u32 s42, s29, 52224
    s_mov_b32 m0, s42
    s_add_u32 s43, s28, 30976
    buffer_load_dwordx4 v3, s[36:39], s43 offen lds
    s_add_u32 s42, s29, 53248
    s_mov_b32 m0, s42
    s_add_u32 s43, s28, 41216
    buffer_load_dwordx4 v3, s[36:39], s43 offen lds
    s_add_u32 s42, s29, 54272
    s_mov_b32 m0, s42
    s_add_u32 s43, s28, 51456
    buffer_load_dwordx4 v3, s[36:39], s43 offen lds
    v_add_u32 v200, 0, v4
    v_add_u32 v201, 0, v5
    v_add_u32 v202, 24576, v4
    v_add_u32 v203, 24576, v5
    v_add_u32 v204, 49152, v4
    v_add_u32 v205, 49152, v5
    s_waitcnt vmcnt(12)
    s_barrier
    ds_read_b64_tr_b16 v[64:65], v200 offset:0
    ds_read_b64_tr_b16 v[66:67], v200 offset:512
    ds_read_b64_tr_b16 v[68:69], v200 offset:2048
    ds_read_b64_tr_b16 v[70:71], v200 offset:2560
    ds_read_b64_tr_b16 v[72:73], v200 offset:4096
    ds_read_b64_tr_b16 v[74:75], v200 offset:4608
    ds_read_b64_tr_b16 v[76:77], v200 offset:6144
    ds_read_b64_tr_b16 v[78:79], v200 offset:6656
    ds_read_b64_tr_b16 v[80:81], v200 offset:8192
    ds_read_b64_tr_b16 v[82:83], v200 offset:8704
    ds_read_b64_tr_b16 v[84:85], v200 offset:10240
    ds_read_b64_tr_b16 v[86:87], v200 offset:10752
    s_waitcnt lgkmcnt(0)
    ds_read_b64_tr_b16 v[88:89], v200 offset:12288
    ds_read_b64_tr_b16 v[90:91], v200 offset:12800
    ds_read_b64_tr_b16 v[92:93], v200 offset:14336
    ds_read_b64_tr_b16 v[94:95], v200 offset:14848
    ds_read_b64_tr_b16 v[96:97], v200 offset:16384
    ds_read_b64_tr_b16 v[98:99], v200 offset:16896
    ds_read_b64_tr_b16 v[100:101], v200 offset:18432
    ds_read_b64_tr_b16 v[102:103], v200 offset:18944
    ds_read_b64_tr_b16 v[104:105], v200 offset:20480
    ds_read_b64_tr_b16 v[106:107], v200 offset:20992
    ds_read_b64_tr_b16 v[108:109], v200 offset:22528
    ds_read_b64_tr_b16 v[110:111], v200 offset:23040
    s_waitcnt lgkmcnt(0)
    v_mfma_f32_32x32x16_bf16 v[160:175], v[16:19], v[64:67], 0
    ds_read_b64_tr_b16 v[112:113], v201 offset:0
    ds_read_b64_tr_b16 v[114:115], v201 offset:512
    v_mfma_f32_32x32x16_bf16 v[160:175], v[20:23], v[68:71], v[160:175]
    ds_read_b64_tr_b16 v[116:117], v201 offset:2048
    ds_read_b64_tr_b16 v[118:119], v201 offset:2560
    v_mfma_f32_32x32x16_bf16 v[160:175], v[24:27], v[72:75], v[160:175]
    ds_read_b64_tr_b16 v[120:121], v201 offset:4096
    ds_read_b64_tr_b16 v[122:123], v201 offset:4608
    v_mfma_f32_32x32x16_bf16 v[160:175], v[28:31], v[76:79], v[160:175]
    ds_read_b64_tr_b16 v[124:125], v201 offset:6144
    ds_read_b64_tr_b16 v[126:127], v201 offset:6656
    v_mfma_f32_32x32x16_bf16 v[160:175], v[32:35], v[80:83], v[160:175]
    ds_read_b64_tr_b16 v[128:129], v201 offset:8192
    ds_read_b64_tr_b16 v[130:131], v201 offset:8704
    v_mfma_f32_32x32x16_bf16 v[160:175], v[36:39], v[84:87], v[160:175]
    ds_read_b64_tr_b16 v[132:133], v201 offset:10240
    ds_read_b64_tr_b16 v[134:135], v201 offset:10752
    v_mfma_f32_32x32x16_bf16 v[160:175], v[40:43], v[88:91], v[160:175]
    ds_read_b64_tr_b16 v[136:137], v201 offset:12288
    ds_read_b64_tr_b16 v[138:139], v201 offset:12800
    v_mfma_f32_32x32x16_bf16 v[160:175], v[44:47], v[92:95], v[160:175]
    ds_read_b64_tr_b16 v[140:141], v201 offset:14336
    ds_read_b64_tr_b16 v[142:143], v201 offset:14848
    v_mfma_f32_32x32x16_bf16 v[160:175], v[48:51], v[96:99], v[160:175]
    ds_read_b64_tr_b16 v[144:145], v201 offset:16384
    ds_read_b64_tr_b16 v[146:147], v201 offset:16896
    v_mfma_f32_32x32x16_bf16 v[160:175], v[52:55], v[100:103], v[160:175]
    ds_read_b64_tr_b16 v[148:149], v201 offset:18432
    ds_read_b64_tr_b16 v[150:151], v201 offset:18944
    v_mfma_f32_32x32x16_bf16 v[160:175], v[56:59], v[104:107], v[160:175]
    ds_read_b64_tr_b16 v[152:153], v201 offset:20480
    ds_read_b64_tr_b16 v[154:155], v201 offset:20992
    v_mfma_f32_32x32x16_bf16 v[160:175], v[60:63], v[108:111], v[160:175]
    ds_read_b64_tr_b16 v[156:157], v201 offset:22528
    ds_read_b64_tr_b16 v[158:159], v201 offset:23040
    s_waitcnt lgkmcnt(0)
    s_waitcnt vmcnt(6)
    s_barrier
    s_add_u32 s42, s29, 0
    s_mov_b32 m0, s42
    s_add_u32 s43, s28, 384
    buffer_load_dwordx4 v3, s[36:39], s43 offen lds
    s_add_u32 s42, s29, 1024
    s_mov_b32 m0, s42
    s_add_u32 s43, s28, 10624
    buffer_load_dwordx4 v3, s[36:39], s43 offen lds
    s_add_u32 s42, s29, 2048
    s_mov_b32 m0, s42
    s_add_u32 s43, s28, 20864
    buffer_load_dwordx4 v3, s[36:39], s43 offen lds
    s_add_u32 s42, s29, 3072
    s_mov_b32 m0, s42
    s_add_u32 s43, s28, 31104
    buffer_load_dwordx4 v3, s[36:39], s43 offen lds
    s_add_u32 s42, s29, 4096
    s_mov_b32 m0, s42
    s_add_u32 s43, s28, 41344
    buffer_load_dwordx4 v3, s[36:39], s43 offen lds
    s_add_u32 s42, s29, 5120
    s_mov_b32 m0, s42
    s_add_u32 s43, s28, 51584
    buffer_load_dwordx4 v3, s[36:39], s43 offen lds
    v_mfma_f32_32x32x16_bf16 v[176:191], v[16:19], v[112:115], 0
    ds_read_b64_tr_b16 v[64:65], v202 offset:0
    ds_read_b64_tr_b16 v[66:67], v202 offset:512
    v_mfma_f32_32x32x16_bf16 v[176:191], v[20:23], v[116:119], v[176:191]
    ds_read_b64_tr_b16 v[68:69], v202 offset:2048
    ds_read_b64_tr_b16 v[70:71], v202 offset:2560
    v_mfma_f32_32x32x16_bf16 v[176:191], v[24:27], v[120:123], v[176:191]
    ds_read_b64_tr_b16 v[72:73], v202 offset:4096
    ds_read_b64_tr_b16 v[74:75], v202 offset:4608
    s_add_u32 s42, s41, 0
    v_cvt_pk_bf16_f32 v192, v160, v161
    v_cvt_pk_bf16_f32 v193, v162, v163
    v_mfma_f32_32x32x16_bf16 v[176:191], v[28:31], v[124:127], v[176:191]
    ds_read_b64_tr_b16 v[76:77], v202 offset:6144
    ds_read_b64_tr_b16 v[78:79], v202 offset:6656
    v_cvt_pk_bf16_f32 v194, v164, v165
    v_cvt_pk_bf16_f32 v195, v166, v167
    s_nop 1
    v_mfma_f32_32x32x16_bf16 v[176:191], v[32:35], v[128:131], v[176:191]
    ds_read_b64_tr_b16 v[80:81], v202 offset:8192
    ds_read_b64_tr_b16 v[82:83], v202 offset:8704
    v_permlane32_swap_b32 v192, v194
    v_permlane32_swap_b32 v193, v195
    buffer_store_dwordx4 v[192:195], v10, s[8:11], s42 offen offset:0
    v_mfma_f32_32x32x16_bf16 v[176:191], v[36:39], v[132:135], v[176:191]
    ds_read_b64_tr_b16 v[84:85], v202 offset:10240
    ds_read_b64_tr_b16 v[86:87], v202 offset:10752
    v_cvt_pk_bf16_f32 v196, v168, v169
    v_cvt_pk_bf16_f32 v197, v170, v171
    v_cvt_pk_bf16_f32 v198, v172, v173
    v_mfma_f32_32x32x16_bf16 v[176:191], v[40:43], v[136:139], v[176:191]
    ds_read_b64_tr_b16 v[88:89], v202 offset:12288
    ds_read_b64_tr_b16 v[90:91], v202 offset:12800
    v_cvt_pk_bf16_f32 v199, v174, v175
    s_nop 1
    v_permlane32_swap_b32 v196, v198
    v_mfma_f32_32x32x16_bf16 v[176:191], v[44:47], v[140:143], v[176:191]
    ds_read_b64_tr_b16 v[92:93], v202 offset:14336
    ds_read_b64_tr_b16 v[94:95], v202 offset:14848
    v_permlane32_swap_b32 v197, v199
    buffer_store_dwordx4 v[196:199], v10, s[8:11], s42 offen offset:512
    v_mfma_f32_32x32x16_bf16 v[176:191], v[48:51], v[144:147], v[176:191]
    ds_read_b64_tr_b16 v[96:97], v202 offset:16384
    ds_read_b64_tr_b16 v[98:99], v202 offset:16896
    v_mfma_f32_32x32x16_bf16 v[176:191], v[52:55], v[148:151], v[176:191]
    ds_read_b64_tr_b16 v[100:101], v202 offset:18432
    ds_read_b64_tr_b16 v[102:103], v202 offset:18944
    v_mfma_f32_32x32x16_bf16 v[176:191], v[56:59], v[152:155], v[176:191]
    ds_read_b64_tr_b16 v[104:105], v202 offset:20480
    ds_read_b64_tr_b16 v[106:107], v202 offset:20992
    v_mfma_f32_32x32x16_bf16 v[176:191], v[60:63], v[156:159], v[176:191]
    ds_read_b64_tr_b16 v[108:109], v202 offset:22528
    ds_read_b64_tr_b16 v[110:111], v202 offset:23040
    s_waitcnt lgkmcnt(0)
    v_mfma_f32_32x32x16_bf16 v[160:175], v[16:19], v[64:67], 0
    ds_read_b64_tr_b16 v[112:113], v203 offset:0
    ds_read_b64_tr_b16 v[114:115], v203 offset:512
    v_mfma_f32_32x32x16_bf16 v[160:175], v[20:23], v[68:71], v[160:175]
    ds_read_b64_tr_b16 v[116:117], v203 offset:2048
    ds_read_b64_tr_b16 v[118:119], v203 offset:2560
    v_mfma_f32_32x32x16_bf16 v[160:175], v[24:27], v[72:75], v[160:175]
    ds_read_b64_tr_b16 v[120:121], v203 offset:4096
    ds_read_b64_tr_b16 v[122:123], v203 offset:4608
    s_add_u32 s42, s41, 1310720
    v_cvt_pk_bf16_f32 v192, v176, v177
    v_cvt_pk_bf16_f32 v193, v178, v179
    v_mfma_f32_32x32x16_bf16 v[160:175], v[28:31], v[76:79], v[160:175]
    ds_read_b64_tr_b16 v[124:125], v203 offset:6144
    ds_read_b64_tr_b16 v[126:127], v203 offset:6656
    v_cvt_pk_bf16_f32 v194, v180, v181
    v_cvt_pk_bf16_f32 v195, v182, v183
    s_nop 1
    v_mfma_f32_32x32x16_bf16 v[160:175], v[32:35], v[80:83], v[160:175]
    ds_read_b64_tr_b16 v[128:129], v203 offset:8192
    ds_read_b64_tr_b16 v[130:131], v203 offset:8704
    v_permlane32_swap_b32 v192, v194
    v_permlane32_swap_b32 v193, v195
    buffer_store_dwordx4 v[192:195], v10, s[8:11], s42 offen offset:0
    v_mfma_f32_32x32x16_bf16 v[160:175], v[36:39], v[84:87], v[160:175]
    ds_read_b64_tr_b16 v[132:133], v203 offset:10240
    ds_read_b64_tr_b16 v[134:135], v203 offset:10752
    v_cvt_pk_bf16_f32 v196, v184, v185
    v_cvt_pk_bf16_f32 v197, v186, v187
    v_cvt_pk_bf16_f32 v198, v188, v189
    v_mfma_f32_32x32x16_bf16 v[160:175], v[40:43], v[88:91], v[160:175]
    ds_read_b64_tr_b16 v[136:137], v203 offset:12288
    ds_read_b64_tr_b16 v[138:139], v203 offset:12800
    v_cvt_pk_bf16_f32 v199, v190, v191
    s_nop 1
    v_permlane32_swap_b32 v196, v198
    v_mfma_f32_32x32x16_bf16 v[160:175], v[44:47], v[92:95], v[160:175]
    ds_read_b64_tr_b16 v[140:141], v203 offset:14336
    ds_read_b64_tr_b16 v[142:143], v203 offset:14848
    v_permlane32_swap_b32 v197, v199
    buffer_store_dwordx4 v[196:199], v10, s[8:11], s42 offen offset:512
    v_mfma_f32_32x32x16_bf16 v[160:175], v[48:51], v[96:99], v[160:175]
    ds_read_b64_tr_b16 v[144:145], v203 offset:16384
    ds_read_b64_tr_b16 v[146:147], v203 offset:16896
    v_mfma_f32_32x32x16_bf16 v[160:175], v[52:55], v[100:103], v[160:175]
    ds_read_b64_tr_b16 v[148:149], v203 offset:18432
    ds_read_b64_tr_b16 v[150:151], v203 offset:18944
    v_mfma_f32_32x32x16_bf16 v[160:175], v[56:59], v[104:107], v[160:175]
    ds_read_b64_tr_b16 v[152:153], v203 offset:20480
    ds_read_b64_tr_b16 v[154:155], v203 offset:20992
    v_mfma_f32_32x32x16_bf16 v[160:175], v[60:63], v[108:111], v[160:175]
    ds_read_b64_tr_b16 v[156:157], v203 offset:22528
    ds_read_b64_tr_b16 v[158:159], v203 offset:23040
    s_waitcnt lgkmcnt(0)
    s_waitcnt vmcnt(10)
    s_barrier
    s_add_u32 s42, s29, 24576
    s_mov_b32 m0, s42
    s_add_u32 s43, s28, 512
    buffer_load_dwordx4 v3, s[36:39], s43 offen lds
    s_add_u32 s42, s29, 25600
    s_mov_b32 m0, s42
    s_add_u32 s43, s28, 10752
    buffer_load_dwordx4 v3, s[36:39], s43 offen lds
    s_add_u32 s42, s29, 26624
    s_mov_b32 m0, s42
    s_add_u32 s43, s28, 20992
    buffer_load_dwordx4 v3, s[36:39], s43 offen lds
    s_add_u32 s42, s29, 27648
    s_mov_b32 m0, s42
    s_add_u32 s43, s28, 31232
    buffer_load_dwordx4 v3, s[36:39], s43 offen lds
    s_add_u32 s42, s29, 28672
    s_mov_b32 m0, s42
    s_add_u32 s43, s28, 41472
    buffer_load_dwordx4 v3, s[36:39], s43 offen lds
    s_add_u32 s42, s29, 29696
    s_mov_b32 m0, s42
    s_add_u32 s43, s28, 51712
    buffer_load_dwordx4 v3, s[36:39], s43 offen lds
    v_mfma_f32_32x32x16_bf16 v[176:191], v[16:19], v[112:115], 0
    ds_read_b64_tr_b16 v[64:65], v204 offset:0
    ds_read_b64_tr_b16 v[66:67], v204 offset:512
    v_mfma_f32_32x32x16_bf16 v[176:191], v[20:23], v[116:119], v[176:191]
    ds_read_b64_tr_b16 v[68:69], v204 offset:2048
    ds_read_b64_tr_b16 v[70:71], v204 offset:2560
    v_mfma_f32_32x32x16_bf16 v[176:191], v[24:27], v[120:123], v[176:191]
    ds_read_b64_tr_b16 v[72:73], v204 offset:4096
    ds_read_b64_tr_b16 v[74:75], v204 offset:4608
    s_add_u32 s42, s41, 2621440
    v_cvt_pk_bf16_f32 v192, v160, v161
    v_cvt_pk_bf16_f32 v193, v162, v163
    v_mfma_f32_32x32x16_bf16 v[176:191], v[28:31], v[124:127], v[176:191]
    ds_read_b64_tr_b16 v[76:77], v204 offset:6144
    ds_read_b64_tr_b16 v[78:79], v204 offset:6656
    v_cvt_pk_bf16_f32 v194, v164, v165
    v_cvt_pk_bf16_f32 v195, v166, v167
    s_nop 1
    v_mfma_f32_32x32x16_bf16 v[176:191], v[32:35], v[128:131], v[176:191]
    ds_read_b64_tr_b16 v[80:81], v204 offset:8192
    ds_read_b64_tr_b16 v[82:83], v204 offset:8704
    v_permlane32_swap_b32 v192, v194
    v_permlane32_swap_b32 v193, v195
    buffer_store_dwordx4 v[192:195], v10, s[8:11], s42 offen offset:0
    v_mfma_f32_32x32x16_bf16 v[176:191], v[36:39], v[132:135], v[176:191]
    ds_read_b64_tr_b16 v[84:85], v204 offset:10240
    ds_read_b64_tr_b16 v[86:87], v204 offset:10752
    v_cvt_pk_bf16_f32 v196, v168, v169
    v_cvt_pk_bf16_f32 v197, v170, v171
    v_cvt_pk_bf16_f32 v198, v172, v173
    v_mfma_f32_32x32x16_bf16 v[176:191], v[40:43], v[136:139], v[176:191]
    ds_read_b64_tr_b16 v[88:89], v204 offset:12288
    ds_read_b64_tr_b16 v[90:91], v204 offset:12800
    v_cvt_pk_bf16_f32 v199, v174, v175
    s_nop 1
    v_permlane32_swap_b32 v196, v198
    v_mfma_f32_32x32x16_bf16 v[176:191], v[44:47], v[140:143], v[176:191]
    ds_read_b64_tr_b16 v[92:93], v204 offset:14336
    ds_read_b64_tr_b16 v[94:95], v204 offset:14848
    v_permlane32_swap_b32 v197, v199
    buffer_store_dwordx4 v[196:199], v10, s[8:11], s42 offen offset:512
    v_mfma_f32_32x32x16_bf16 v[176:191], v[48:51], v[144:147], v[176:191]
    ds_read_b64_tr_b16 v[96:97], v204 offset:16384
    ds_read_b64_tr_b16 v[98:99], v204 offset:16896
    v_mfma_f32_32x32x16_bf16 v[176:191], v[52:55], v[148:151], v[176:191]
    ds_read_b64_tr_b16 v[100:101], v204 offset:18432
    ds_read_b64_tr_b16 v[102:103], v204 offset:18944
    v_mfma_f32_32x32x16_bf16 v[176:191], v[56:59], v[152:155], v[176:191]
    ds_read_b64_tr_b16 v[104:105], v204 offset:20480
    ds_read_b64_tr_b16 v[106:107], v204 offset:20992
    v_mfma_f32_32x32x16_bf16 v[176:191], v[60:63], v[156:159], v[176:191]
    ds_read_b64_tr_b16 v[108:109], v204 offset:22528
    ds_read_b64_tr_b16 v[110:111], v204 offset:23040
    s_waitcnt lgkmcnt(0)
    v_mfma_f32_32x32x16_bf16 v[160:175], v[16:19], v[64:67], 0
    ds_read_b64_tr_b16 v[112:113], v205 offset:0
    ds_read_b64_tr_b16 v[114:115], v205 offset:512
    v_mfma_f32_32x32x16_bf16 v[160:175], v[20:23], v[68:71], v[160:175]
    ds_read_b64_tr_b16 v[116:117], v205 offset:2048
    ds_read_b64_tr_b16 v[118:119], v205 offset:2560
    v_mfma_f32_32x32x16_bf16 v[160:175], v[24:27], v[72:75], v[160:175]
    ds_read_b64_tr_b16 v[120:121], v205 offset:4096
    ds_read_b64_tr_b16 v[122:123], v205 offset:4608
    s_add_u32 s42, s41, 3932160
    v_cvt_pk_bf16_f32 v192, v176, v177
    v_cvt_pk_bf16_f32 v193, v178, v179
    v_mfma_f32_32x32x16_bf16 v[160:175], v[28:31], v[76:79], v[160:175]
    ds_read_b64_tr_b16 v[124:125], v205 offset:6144
    ds_read_b64_tr_b16 v[126:127], v205 offset:6656
    v_cvt_pk_bf16_f32 v194, v180, v181
    v_cvt_pk_bf16_f32 v195, v182, v183
    s_nop 1
    v_mfma_f32_32x32x16_bf16 v[160:175], v[32:35], v[80:83], v[160:175]
    ds_read_b64_tr_b16 v[128:129], v205 offset:8192
    ds_read_b64_tr_b16 v[130:131], v205 offset:8704
    v_permlane32_swap_b32 v192, v194
    v_permlane32_swap_b32 v193, v195
    buffer_store_dwordx4 v[192:195], v10, s[8:11], s42 offen offset:0
    v_mfma_f32_32x32x16_bf16 v[160:175], v[36:39], v[84:87], v[160:175]
    ds_read_b64_tr_b16 v[132:133], v205 offset:10240
    ds_read_b64_tr_b16 v[134:135], v205 offset:10752
    v_cvt_pk_bf16_f32 v196, v184, v185
    v_cvt_pk_bf16_f32 v197, v186, v187
    v_cvt_pk_bf16_f32 v198, v188, v189
    v_mfma_f32_32x32x16_bf16 v[160:175], v[40:43], v[88:91], v[160:175]
    ds_read_b64_tr_b16 v[136:137], v205 offset:12288
    ds_read_b64_tr_b16 v[138:139], v205 offset:12800
    v_cvt_pk_bf16_f32 v199, v190, v191
    s_nop 1
    v_permlane32_swap_b32 v196, v198
    v_mfma_f32_32x32x16_bf16 v[160:175], v[44:47], v[92:95], v[160:175]
    ds_read_b64_tr_b16 v[140:141], v205 offset:14336
    ds_read_b64_tr_b16 v[142:143], v205 offset:14848
    v_permlane32_swap_b32 v197, v199
    buffer_store_dwordx4 v[196:199], v10, s[8:11], s42 offen offset:512
    v_mfma_f32_32x32x16_bf16 v[160:175], v[48:51], v[96:99], v[160:175]
    ds_read_b64_tr_b16 v[144:145], v205 offset:16384
    ds_read_b64_tr_b16 v[146:147], v205 offset:16896
    v_mfma_f32_32x32x16_bf16 v[160:175], v[52:55], v[100:103], v[160:175]
    ds_read_b64_tr_b16 v[148:149], v205 offset:18432
    ds_read_b64_tr_b16 v[150:151], v205 offset:18944
    v_mfma_f32_32x32x16_bf16 v[160:175], v[56:59], v[104:107], v[160:175]
    ds_read_b64_tr_b16 v[152:153], v205 offset:20480
    ds_read_b64_tr_b16 v[154:155], v205 offset:20992
    v_mfma_f32_32x32x16_bf16 v[160:175], v[60:63], v[108:111], v[160:175]
    ds_read_b64_tr_b16 v[156:157], v205 offset:22528
    ds_read_b64_tr_b16 v[158:159], v205 offset:23040
    s_waitcnt lgkmcnt(0)
    s_waitcnt vmcnt(14)
    s_barrier
    v_mfma_f32_32x32x16_bf16 v[176:191], v[16:19], v[112:115], 0
    ds_read_b64_tr_b16 v[64:65], v200 offset:0
    ds_read_b64_tr_b16 v[66:67], v200 offset:512
    v_mfma_f32_32x32x16_bf16 v[176:191], v[20:23], v[116:119], v[176:191]
    ds_read_b64_tr_b16 v[68:69], v200 offset:2048
    ds_read_b64_tr_b16 v[70:71], v200 offset:2560
    v_mfma_f32_32x32x16_bf16 v[176:191], v[24:27], v[120:123], v[176:191]
    ds_read_b64_tr_b16 v[72:73], v200 offset:4096
    ds_read_b64_tr_b16 v[74:75], v200 offset:4608
    s_add_u32 s42, s41, 5242880
    v_cvt_pk_bf16_f32 v192, v160, v161
    v_cvt_pk_bf16_f32 v193, v162, v163
    v_mfma_f32_32x32x16_bf16 v[176:191], v[28:31], v[124:127], v[176:191]
    ds_read_b64_tr_b16 v[76:77], v200 offset:6144
    ds_read_b64_tr_b16 v[78:79], v200 offset:6656
    v_cvt_pk_bf16_f32 v194, v164, v165
    v_cvt_pk_bf16_f32 v195, v166, v167
    s_nop 1
    v_mfma_f32_32x32x16_bf16 v[176:191], v[32:35], v[128:131], v[176:191]
    ds_read_b64_tr_b16 v[80:81], v200 offset:8192
    ds_read_b64_tr_b16 v[82:83], v200 offset:8704
    v_permlane32_swap_b32 v192, v194
    v_permlane32_swap_b32 v193, v195
    buffer_store_dwordx4 v[192:195], v10, s[8:11], s42 offen offset:0
    v_mfma_f32_32x32x16_bf16 v[176:191], v[36:39], v[132:135], v[176:191]
    ds_read_b64_tr_b16 v[84:85], v200 offset:10240
    ds_read_b64_tr_b16 v[86:87], v200 offset:10752
    v_cvt_pk_bf16_f32 v196, v168, v169
    v_cvt_pk_bf16_f32 v197, v170, v171
    v_cvt_pk_bf16_f32 v198, v172, v173
    v_mfma_f32_32x32x16_bf16 v[176:191], v[40:43], v[136:139], v[176:191]
    ds_read_b64_tr_b16 v[88:89], v200 offset:12288
    ds_read_b64_tr_b16 v[90:91], v200 offset:12800
    v_cvt_pk_bf16_f32 v199, v174, v175
    s_nop 1
    v_permlane32_swap_b32 v196, v198
    v_mfma_f32_32x32x16_bf16 v[176:191], v[44:47], v[140:143], v[176:191]
    ds_read_b64_tr_b16 v[92:93], v200 offset:14336
    ds_read_b64_tr_b16 v[94:95], v200 offset:14848
    v_permlane32_swap_b32 v197, v199
    buffer_store_dwordx4 v[196:199], v10, s[8:11], s42 offen offset:512
    v_mfma_f32_32x32x16_bf16 v[176:191], v[48:51], v[144:147], v[176:191]
    ds_read_b64_tr_b16 v[96:97], v200 offset:16384
    ds_read_b64_tr_b16 v[98:99], v200 offset:16896
    v_mfma_f32_32x32x16_bf16 v[176:191], v[52:55], v[148:151], v[176:191]
    ds_read_b64_tr_b16 v[100:101], v200 offset:18432
    ds_read_b64_tr_b16 v[102:103], v200 offset:18944
    v_mfma_f32_32x32x16_bf16 v[176:191], v[56:59], v[152:155], v[176:191]
    ds_read_b64_tr_b16 v[104:105], v200 offset:20480
    ds_read_b64_tr_b16 v[106:107], v200 offset:20992
    v_mfma_f32_32x32x16_bf16 v[176:191], v[60:63], v[156:159], v[176:191]
    ds_read_b64_tr_b16 v[108:109], v200 offset:22528
    ds_read_b64_tr_b16 v[110:111], v200 offset:23040
    s_waitcnt lgkmcnt(0)
    v_mfma_f32_32x32x16_bf16 v[160:175], v[16:19], v[64:67], 0
    ds_read_b64_tr_b16 v[112:113], v201 offset:0
    ds_read_b64_tr_b16 v[114:115], v201 offset:512
    v_mfma_f32_32x32x16_bf16 v[160:175], v[20:23], v[68:71], v[160:175]
    ds_read_b64_tr_b16 v[116:117], v201 offset:2048
    ds_read_b64_tr_b16 v[118:119], v201 offset:2560
    v_mfma_f32_32x32x16_bf16 v[160:175], v[24:27], v[72:75], v[160:175]
    ds_read_b64_tr_b16 v[120:121], v201 offset:4096
    ds_read_b64_tr_b16 v[122:123], v201 offset:4608
    s_add_u32 s42, s41, 6553600
    v_cvt_pk_bf16_f32 v192, v176, v177
    v_cvt_pk_bf16_f32 v193, v178, v179
    v_mfma_f32_32x32x16_bf16 v[160:175], v[28:31], v[76:79], v[160:175]
    ds_read_b64_tr_b16 v[124:125], v201 offset:6144
    ds_read_b64_tr_b16 v[126:127], v201 offset:6656
    v_cvt_pk_bf16_f32 v194, v180, v181
    v_cvt_pk_bf16_f32 v195, v182, v183
    s_nop 1
    v_mfma_f32_32x32x16_bf16 v[160:175], v[32:35], v[80:83], v[160:175]
    ds_read_b64_tr_b16 v[128:129], v201 offset:8192
    ds_read_b64_tr_b16 v[130:131], v201 offset:8704
    v_permlane32_swap_b32 v192, v194
    v_permlane32_swap_b32 v193, v195
    buffer_store_dwordx4 v[192:195], v10, s[8:11], s42 offen offset:0
    v_mfma_f32_32x32x16_bf16 v[160:175], v[36:39], v[84:87], v[160:175]
    ds_read_b64_tr_b16 v[132:133], v201 offset:10240
    ds_read_b64_tr_b16 v[134:135], v201 offset:10752
    v_cvt_pk_bf16_f32 v196, v184, v185
    v_cvt_pk_bf16_f32 v197, v186, v187
    v_cvt_pk_bf16_f32 v198, v188, v189
    v_mfma_f32_32x32x16_bf16 v[160:175], v[40:43], v[88:91], v[160:175]
    ds_read_b64_tr_b16 v[136:137], v201 offset:12288
    ds_read_b64_tr_b16 v[138:139], v201 offset:12800
    v_cvt_pk_bf16_f32 v199, v190, v191
    s_nop 1
    v_permlane32_swap_b32 v196, v198
    v_mfma_f32_32x32x16_bf16 v[160:175], v[44:47], v[92:95], v[160:175]
    ds_read_b64_tr_b16 v[140:141], v201 offset:14336
    ds_read_b64_tr_b16 v[142:143], v201 offset:14848
    v_permlane32_swap_b32 v197, v199
    buffer_store_dwordx4 v[196:199], v10, s[8:11], s42 offen offset:512
    v_mfma_f32_32x32x16_bf16 v[160:175], v[48:51], v[96:99], v[160:175]
    ds_read_b64_tr_b16 v[144:145], v201 offset:16384
    ds_read_b64_tr_b16 v[146:147], v201 offset:16896
    v_mfma_f32_32x32x16_bf16 v[160:175], v[52:55], v[100:103], v[160:175]
    ds_read_b64_tr_b16 v[148:149], v201 offset:18432
    ds_read_b64_tr_b16 v[150:151], v201 offset:18944
    v_mfma_f32_32x32x16_bf16 v[160:175], v[56:59], v[104:107], v[160:175]
    ds_read_b64_tr_b16 v[152:153], v201 offset:20480
    ds_read_b64_tr_b16 v[154:155], v201 offset:20992
    v_mfma_f32_32x32x16_bf16 v[160:175], v[60:63], v[108:111], v[160:175]
    ds_read_b64_tr_b16 v[156:157], v201 offset:22528
    ds_read_b64_tr_b16 v[158:159], v201 offset:23040
    s_waitcnt lgkmcnt(0)
    s_waitcnt vmcnt(8)
    s_barrier
    v_mfma_f32_32x32x16_bf16 v[176:191], v[16:19], v[112:115], 0
    ds_read_b64_tr_b16 v[64:65], v202 offset:0
    ds_read_b64_tr_b16 v[66:67], v202 offset:512
    v_mfma_f32_32x32x16_bf16 v[176:191], v[20:23], v[116:119], v[176:191]
    ds_read_b64_tr_b16 v[68:69], v202 offset:2048
    ds_read_b64_tr_b16 v[70:71], v202 offset:2560
    v_mfma_f32_32x32x16_bf16 v[176:191], v[24:27], v[120:123], v[176:191]
    ds_read_b64_tr_b16 v[72:73], v202 offset:4096
    ds_read_b64_tr_b16 v[74:75], v202 offset:4608
    s_add_u32 s42, s41, 7864320
    v_cvt_pk_bf16_f32 v192, v160, v161
    v_cvt_pk_bf16_f32 v193, v162, v163
    v_mfma_f32_32x32x16_bf16 v[176:191], v[28:31], v[124:127], v[176:191]
    ds_read_b64_tr_b16 v[76:77], v202 offset:6144
    ds_read_b64_tr_b16 v[78:79], v202 offset:6656
    v_cvt_pk_bf16_f32 v194, v164, v165
    v_cvt_pk_bf16_f32 v195, v166, v167
    s_nop 1
    v_mfma_f32_32x32x16_bf16 v[176:191], v[32:35], v[128:131], v[176:191]
    ds_read_b64_tr_b16 v[80:81], v202 offset:8192
    ds_read_b64_tr_b16 v[82:83], v202 offset:8704
    v_permlane32_swap_b32 v192, v194
    v_permlane32_swap_b32 v193, v195
    buffer_store_dwordx4 v[192:195], v10, s[8:11], s42 offen offset:0
    v_mfma_f32_32x32x16_bf16 v[176:191], v[36:39], v[132:135], v[176:191]
    ds_read_b64_tr_b16 v[84:85], v202 offset:10240
    ds_read_b64_tr_b16 v[86:87], v202 offset:10752
    v_cvt_pk_bf16_f32 v196, v168, v169
    v_cvt_pk_bf16_f32 v197, v170, v171
    v_cvt_pk_bf16_f32 v198, v172, v173
    v_mfma_f32_32x32x16_bf16 v[176:191], v[40:43], v[136:139], v[176:191]
    ds_read_b64_tr_b16 v[88:89], v202 offset:12288
    ds_read_b64_tr_b16 v[90:91], v202 offset:12800
    v_cvt_pk_bf16_f32 v199, v174, v175
    s_nop 1
    v_permlane32_swap_b32 v196, v198
    v_mfma_f32_32x32x16_bf16 v[176:191], v[44:47], v[140:143], v[176:191]
    ds_read_b64_tr_b16 v[92:93], v202 offset:14336
    ds_read_b64_tr_b16 v[94:95], v202 offset:14848
    v_permlane32_swap_b32 v197, v199
    buffer_store_dwordx4 v[196:199], v10, s[8:11], s42 offen offset:512
    v_mfma_f32_32x32x16_bf16 v[176:191], v[48:51], v[144:147], v[176:191]
    ds_read_b64_tr_b16 v[96:97], v202 offset:16384
    ds_read_b64_tr_b16 v[98:99], v202 offset:16896
    v_mfma_f32_32x32x16_bf16 v[176:191], v[52:55], v[148:151], v[176:191]
    ds_read_b64_tr_b16 v[100:101], v202 offset:18432
    ds_read_b64_tr_b16 v[102:103], v202 offset:18944
    v_mfma_f32_32x32x16_bf16 v[176:191], v[56:59], v[152:155], v[176:191]
    ds_read_b64_tr_b16 v[104:105], v202 offset:20480
    ds_read_b64_tr_b16 v[106:107], v202 offset:20992
    v_mfma_f32_32x32x16_bf16 v[176:191], v[60:63], v[156:159], v[176:191]
    ds_read_b64_tr_b16 v[108:109], v202 offset:22528
    ds_read_b64_tr_b16 v[110:111], v202 offset:23040
    s_waitcnt lgkmcnt(0)
    v_mfma_f32_32x32x16_bf16 v[160:175], v[16:19], v[64:67], 0
    ds_read_b64_tr_b16 v[112:113], v203 offset:0
    ds_read_b64_tr_b16 v[114:115], v203 offset:512
    v_mfma_f32_32x32x16_bf16 v[160:175], v[20:23], v[68:71], v[160:175]
    ds_read_b64_tr_b16 v[116:117], v203 offset:2048
    ds_read_b64_tr_b16 v[118:119], v203 offset:2560
    v_mfma_f32_32x32x16_bf16 v[160:175], v[24:27], v[72:75], v[160:175]
    ds_read_b64_tr_b16 v[120:121], v203 offset:4096
    ds_read_b64_tr_b16 v[122:123], v203 offset:4608
    s_add_u32 s42, s41, 9175040
    v_cvt_pk_bf16_f32 v192, v176, v177
    v_cvt_pk_bf16_f32 v193, v178, v179
    v_mfma_f32_32x32x16_bf16 v[160:175], v[28:31], v[76:79], v[160:175]
    ds_read_b64_tr_b16 v[124:125], v203 offset:6144
    ds_read_b64_tr_b16 v[126:127], v203 offset:6656
    v_cvt_pk_bf16_f32 v194, v180, v181
    v_cvt_pk_bf16_f32 v195, v182, v183
    s_nop 1
    v_mfma_f32_32x32x16_bf16 v[160:175], v[32:35], v[80:83], v[160:175]
    ds_read_b64_tr_b16 v[128:129], v203 offset:8192
    ds_read_b64_tr_b16 v[130:131], v203 offset:8704
    v_permlane32_swap_b32 v192, v194
    v_permlane32_swap_b32 v193, v195
    buffer_store_dwordx4 v[192:195], v10, s[8:11], s42 offen offset:0
    v_mfma_f32_32x32x16_bf16 v[160:175], v[36:39], v[84:87], v[160:175]
    ds_read_b64_tr_b16 v[132:133], v203 offset:10240
    ds_read_b64_tr_b16 v[134:135], v203 offset:10752
    v_cvt_pk_bf16_f32 v196, v184, v185
    v_cvt_pk_bf16_f32 v197, v186, v187
    v_cvt_pk_bf16_f32 v198, v188, v189
    v_mfma_f32_32x32x16_bf16 v[160:175], v[40:43], v[88:91], v[160:175]
    ds_read_b64_tr_b16 v[136:137], v203 offset:12288
    ds_read_b64_tr_b16 v[138:139], v203 offset:12800
    v_cvt_pk_bf16_f32 v199, v190, v191
    s_nop 1
    v_permlane32_swap_b32 v196, v198
    v_mfma_f32_32x32x16_bf16 v[160:175], v[44:47], v[92:95], v[160:175]
    ds_read_b64_tr_b16 v[140:141], v203 offset:14336
    ds_read_b64_tr_b16 v[142:143], v203 offset:14848
    v_permlane32_swap_b32 v197, v199
    buffer_store_dwordx4 v[196:199], v10, s[8:11], s42 offen offset:512
    v_mfma_f32_32x32x16_bf16 v[160:175], v[48:51], v[96:99], v[160:175]
    ds_read_b64_tr_b16 v[144:145], v203 offset:16384
    ds_read_b64_tr_b16 v[146:147], v203 offset:16896
    v_mfma_f32_32x32x16_bf16 v[160:175], v[52:55], v[100:103], v[160:175]
    ds_read_b64_tr_b16 v[148:149], v203 offset:18432
    ds_read_b64_tr_b16 v[150:151], v203 offset:18944
    v_mfma_f32_32x32x16_bf16 v[160:175], v[56:59], v[104:107], v[160:175]
    ds_read_b64_tr_b16 v[152:153], v203 offset:20480
    ds_read_b64_tr_b16 v[154:155], v203 offset:20992
    v_mfma_f32_32x32x16_bf16 v[160:175], v[60:63], v[108:111], v[160:175]
    ds_read_b64_tr_b16 v[156:157], v203 offset:22528
    ds_read_b64_tr_b16 v[158:159], v203 offset:23040
    s_waitcnt lgkmcnt(0)
    s_barrier
    v_mfma_f32_32x32x16_bf16 v[176:191], v[16:19], v[112:115], 0
    v_mfma_f32_32x32x16_bf16 v[176:191], v[20:23], v[116:119], v[176:191]
    v_mfma_f32_32x32x16_bf16 v[176:191], v[24:27], v[120:123], v[176:191]
    s_add_u32 s42, s41, 10485760
    v_cvt_pk_bf16_f32 v192, v160, v161
    v_cvt_pk_bf16_f32 v193, v162, v163
    v_mfma_f32_32x32x16_bf16 v[176:191], v[28:31], v[124:127], v[176:191]
    v_cvt_pk_bf16_f32 v194, v164, v165
    v_cvt_pk_bf16_f32 v195, v166, v167
    s_nop 1
    v_mfma_f32_32x32x16_bf16 v[176:191], v[32:35], v[128:131], v[176:191]
    v_permlane32_swap_b32 v192, v194
    v_permlane32_swap_b32 v193, v195
    buffer_store_dwordx4 v[192:195], v10, s[8:11], s42 offen offset:0
    v_mfma_f32_32x32x16_bf16 v[176:191], v[36:39], v[132:135], v[176:191]
    v_cvt_pk_bf16_f32 v196, v168, v169
    v_cvt_pk_bf16_f32 v197, v170, v171
    v_cvt_pk_bf16_f32 v198, v172, v173
    v_mfma_f32_32x32x16_bf16 v[176:191], v[40:43], v[136:139], v[176:191]
    v_cvt_pk_bf16_f32 v199, v174, v175
    s_nop 1
    v_permlane32_swap_b32 v196, v198
    v_mfma_f32_32x32x16_bf16 v[176:191], v[44:47], v[140:143], v[176:191]
    v_permlane32_swap_b32 v197, v199
    buffer_store_dwordx4 v[196:199], v10, s[8:11], s42 offen offset:512
    v_mfma_f32_32x32x16_bf16 v[176:191], v[48:51], v[144:147], v[176:191]
    v_mfma_f32_32x32x16_bf16 v[176:191], v[52:55], v[148:151], v[176:191]
    v_mfma_f32_32x32x16_bf16 v[176:191], v[56:59], v[152:155], v[176:191]
    v_mfma_f32_32x32x16_bf16 v[176:191], v[60:63], v[156:159], v[176:191]
    s_nop 7
    s_nop 7
    s_nop 7
    s_add_u32 s42, s41, 11796480
    v_cvt_pk_bf16_f32 v192, v176, v177
    v_cvt_pk_bf16_f32 v193, v178, v179
    v_cvt_pk_bf16_f32 v194, v180, v181
    v_cvt_pk_bf16_f32 v195, v182, v183
    s_nop 1
    v_permlane32_swap_b32 v192, v194
    v_permlane32_swap_b32 v193, v195
    buffer_store_dwordx4 v[192:195], v10, s[8:11], s42 offen offset:0
    v_cvt_pk_bf16_f32 v196, v184, v185
    v_cvt_pk_bf16_f32 v197, v186, v187
    v_cvt_pk_bf16_f32 v198, v188, v189
    v_cvt_pk_bf16_f32 v199, v190, v191
    s_nop 1
    v_permlane32_swap_b32 v196, v198
    v_permlane32_swap_b32 v197, v199
    buffer_store_dwordx4 v[196:199], v10, s[8:11], s42 offen offset:512
    s_branch prep_kernel_end
prep_kernel_r_pwp:
    s_lshl_b32 s20, s20, 2
    s_add_u32 s20, s20, s13
    s_mul_i32 s21, s20, 13108
    s_lshr_b32 s21, s21, 16
    s_mul_i32 s22, s21, 5
    s_sub_u32 s22, s20, s22
    s_mul_i32 s23, s21, 21846
    s_lshr_b32 s23, s23, 16
    s_mul_i32 s28, s23, 3
    s_sub_u32 s21, s21, s28
    s_lshr_b32 s29, s23, 5
    s_and_b32 s23, s23, 31
    s_cmp_eq_u32 s29, 0
    s_cbranch_scc0 prep_kernel_pwp_k
    s_load_dwordx2 s[24:25], s[0:1], 40
    s_branch prep_kernel_pwp_go
prep_kernel_pwp_k:
    s_load_dwordx2 s[24:25], s[0:1], 48
prep_kernel_pwp_go:
    v_and_b32 v1, 31, v0
    v_lshrrev_b32 v2, 5, v0
    s_lshl_b32 s28, s21, 6
    v_lshlrev_b32 v3, 1, v1
    v_add_u32 v3, s28, v3
    v_and_b32 v4, 0xc1, v3
    v_and_b32 v5, 8, v3
    v_lshl_or_b32 v4, v5, 2, v4
    v_and_b32 v5, 32, v3
    v_lshrrev_b32 v5, 1, v5
    v_or_b32 v4, v4, v5
    v_and_b32 v5, 2, v3
    v_lshl_or_b32 v4, v5, 2, v4
    v_and_b32 v5, 16, v3
    v_lshrrev_b32 v5, 2, v5
    v_or_b32 v4, v4, v5
    v_and_b32 v5, 4, v3
    v_lshrrev_b32 v5, 1, v5
    v_or_b32 v4, v4, v5
    s_cmp_eq_u32 s29, 0
    s_cselect_b64 vcc, -1, 0
    s_nop 1
    v_cndmask_b32 v4, v4, v3, vcc
    v_lshrrev_b32 v5, 4, v3
    v_and_b32 v6, 3, v5
    v_mul_u32_u24 v6, 6, v6
    v_lshrrev_b32 v5, 2, v5
    v_add_u32 v5, v5, v6
    v_mul_u32_u24 v5, 20480, v5
    v_and_b32 v6, 15, v3
    v_lshl_add_u32 v7, v6, 4, v5
    s_mul_i32 s30, s29, 61440
    s_mul_i32 s31, s23, 491520
    s_add_u32 s30, s30, s31
    s_add_u32 s30, s30, 11534336
    s_lshl_b32 s31, s22, 4
    v_add_u32 v8, s31, v2
    s_waitcnt lgkmcnt(0)
    s_mov_b32 s32, s24
    s_mov_b32 s33, s25
    s_mov_b32 s34, 7864320
    s_mov_b32 s35, 0x00020000
    s_mul_i32 s28, s23, 384
    v_add_u32 v9, 0, v8
    v_lshrrev_b32 v10, 2, v9
    v_lshlrev_b32 v10, 5, v10
    v_and_b32 v11, 2, v9
    v_lshl_add_u32 v10, v11, 3, v10
    v_and_b32 v11, 1, v9
    v_lshl_add_u32 v10, v11, 2, v10
    v_mul_u32_u24 v10, 12288, v10
    v_lshl_add_u32 v10, v4, 1, v10
    s_add_u32 s31, s28, 0
    buffer_load_dword v16, v10, s[32:35], s31 offen
    s_add_u32 s31, s28, 12288
    buffer_load_dword v17, v10, s[32:35], s31 offen
    s_add_u32 s31, s28, 98304
    buffer_load_dword v18, v10, s[32:35], s31 offen
    s_add_u32 s31, s28, 110592
    buffer_load_dword v19, v10, s[32:35], s31 offen
    s_add_u32 s31, s28, 24576
    buffer_load_dword v20, v10, s[32:35], s31 offen
    s_add_u32 s31, s28, 36864
    buffer_load_dword v21, v10, s[32:35], s31 offen
    s_add_u32 s31, s28, 122880
    buffer_load_dword v22, v10, s[32:35], s31 offen
    s_add_u32 s31, s28, 135168
    buffer_load_dword v23, v10, s[32:35], s31 offen
    v_add_u32 v9, 2, v8
    v_lshrrev_b32 v10, 2, v9
    v_lshlrev_b32 v10, 5, v10
    v_and_b32 v11, 2, v9
    v_lshl_add_u32 v10, v11, 3, v10
    v_and_b32 v11, 1, v9
    v_lshl_add_u32 v10, v11, 2, v10
    v_mul_u32_u24 v10, 12288, v10
    v_lshl_add_u32 v10, v4, 1, v10
    s_add_u32 s31, s28, 0
    buffer_load_dword v24, v10, s[32:35], s31 offen
    s_add_u32 s31, s28, 12288
    buffer_load_dword v25, v10, s[32:35], s31 offen
    s_add_u32 s31, s28, 98304
    buffer_load_dword v26, v10, s[32:35], s31 offen
    s_add_u32 s31, s28, 110592
    buffer_load_dword v27, v10, s[32:35], s31 offen
    s_add_u32 s31, s28, 24576
    buffer_load_dword v28, v10, s[32:35], s31 offen
    s_add_u32 s31, s28, 36864
    buffer_load_dword v29, v10, s[32:35], s31 offen
    s_add_u32 s31, s28, 122880
    buffer_load_dword v30, v10, s[32:35], s31 offen
    s_add_u32 s31, s28, 135168
    buffer_load_dword v31, v10, s[32:35], s31 offen
    v_add_u32 v9, 4, v8
    v_lshrrev_b32 v10, 2, v9
    v_lshlrev_b32 v10, 5, v10
    v_and_b32 v11, 2, v9
    v_lshl_add_u32 v10, v11, 3, v10
    v_and_b32 v11, 1, v9
    v_lshl_add_u32 v10, v11, 2, v10
    v_mul_u32_u24 v10, 12288, v10
    v_lshl_add_u32 v10, v4, 1, v10
    s_add_u32 s31, s28, 0
    buffer_load_dword v32, v10, s[32:35], s31 offen
    s_add_u32 s31, s28, 12288
    buffer_load_dword v33, v10, s[32:35], s31 offen
    s_add_u32 s31, s28, 98304
    buffer_load_dword v34, v10, s[32:35], s31 offen
    s_add_u32 s31, s28, 110592
    buffer_load_dword v35, v10, s[32:35], s31 offen
    s_add_u32 s31, s28, 24576
    buffer_load_dword v36, v10, s[32:35], s31 offen
    s_add_u32 s31, s28, 36864
    buffer_load_dword v37, v10, s[32:35], s31 offen
    s_add_u32 s31, s28, 122880
    buffer_load_dword v38, v10, s[32:35], s31 offen
    s_add_u32 s31, s28, 135168
    buffer_load_dword v39, v10, s[32:35], s31 offen
    v_add_u32 v9, 6, v8
    v_lshrrev_b32 v10, 2, v9
    v_lshlrev_b32 v10, 5, v10
    v_and_b32 v11, 2, v9
    v_lshl_add_u32 v10, v11, 3, v10
    v_and_b32 v11, 1, v9
    v_lshl_add_u32 v10, v11, 2, v10
    v_mul_u32_u24 v10, 12288, v10
    v_lshl_add_u32 v10, v4, 1, v10
    s_add_u32 s31, s28, 0
    buffer_load_dword v40, v10, s[32:35], s31 offen
    s_add_u32 s31, s28, 12288
    buffer_load_dword v41, v10, s[32:35], s31 offen
    s_add_u32 s31, s28, 98304
    buffer_load_dword v42, v10, s[32:35], s31 offen
    s_add_u32 s31, s28, 110592
    buffer_load_dword v43, v10, s[32:35], s31 offen
    s_add_u32 s31, s28, 24576
    buffer_load_dword v44, v10, s[32:35], s31 offen
    s_add_u32 s31, s28, 36864
    buffer_load_dword v45, v10, s[32:35], s31 offen
    s_add_u32 s31, s28, 122880
    buffer_load_dword v46, v10, s[32:35], s31 offen
    s_add_u32 s31, s28, 135168
    buffer_load_dword v47, v10, s[32:35], s31 offen
    v_add_u32 v9, 8, v8
    v_lshrrev_b32 v10, 2, v9
    v_lshlrev_b32 v10, 5, v10
    v_and_b32 v11, 2, v9
    v_lshl_add_u32 v10, v11, 3, v10
    v_and_b32 v11, 1, v9
    v_lshl_add_u32 v10, v11, 2, v10
    v_mul_u32_u24 v10, 12288, v10
    v_lshl_add_u32 v10, v4, 1, v10
    s_add_u32 s31, s28, 0
    buffer_load_dword v48, v10, s[32:35], s31 offen
    s_add_u32 s31, s28, 12288
    buffer_load_dword v49, v10, s[32:35], s31 offen
    s_add_u32 s31, s28, 98304
    buffer_load_dword v50, v10, s[32:35], s31 offen
    s_add_u32 s31, s28, 110592
    buffer_load_dword v51, v10, s[32:35], s31 offen
    s_add_u32 s31, s28, 24576
    buffer_load_dword v52, v10, s[32:35], s31 offen
    s_add_u32 s31, s28, 36864
    buffer_load_dword v53, v10, s[32:35], s31 offen
    s_add_u32 s31, s28, 122880
    buffer_load_dword v54, v10, s[32:35], s31 offen
    s_add_u32 s31, s28, 135168
    buffer_load_dword v55, v10, s[32:35], s31 offen
    v_add_u32 v9, 10, v8
    v_lshrrev_b32 v10, 2, v9
    v_lshlrev_b32 v10, 5, v10
    v_and_b32 v11, 2, v9
    v_lshl_add_u32 v10, v11, 3, v10
    v_and_b32 v11, 1, v9
    v_lshl_add_u32 v10, v11, 2, v10
    v_mul_u32_u24 v10, 12288, v10
    v_lshl_add_u32 v10, v4, 1, v10
    s_add_u32 s31, s28, 0
    buffer_load_dword v56, v10, s[32:35], s31 offen
    s_add_u32 s31, s28, 12288
    buffer_load_dword v57, v10, s[32:35], s31 offen
    s_add_u32 s31, s28, 98304
    buffer_load_dword v58, v10, s[32:35], s31 offen
    s_add_u32 s31, s28, 110592
    buffer_load_dword v59, v10, s[32:35], s31 offen
    s_add_u32 s31, s28, 24576
    buffer_load_dword v60, v10, s[32:35], s31 offen
    s_add_u32 s31, s28, 36864
    buffer_load_dword v61, v10, s[32:35], s31 offen
    s_add_u32 s31, s28, 122880
    buffer_load_dword v62, v10, s[32:35], s31 offen
    s_add_u32 s31, s28, 135168
    buffer_load_dword v63, v10, s[32:35], s31 offen
    v_add_u32 v9, 12, v8
    v_lshrrev_b32 v10, 2, v9
    v_lshlrev_b32 v10, 5, v10
    v_and_b32 v11, 2, v9
    v_lshl_add_u32 v10, v11, 3, v10
    v_and_b32 v11, 1, v9
    v_lshl_add_u32 v10, v11, 2, v10
    v_mul_u32_u24 v10, 12288, v10
    v_lshl_add_u32 v10, v4, 1, v10
    s_add_u32 s31, s28, 0
    buffer_load_dword v64, v10, s[32:35], s31 offen
    s_add_u32 s31, s28, 12288
    buffer_load_dword v65, v10, s[32:35], s31 offen
    s_add_u32 s31, s28, 98304
    buffer_load_dword v66, v10, s[32:35], s31 offen
    s_add_u32 s31, s28, 110592
    buffer_load_dword v67, v10, s[32:35], s31 offen
    s_add_u32 s31, s28, 24576
    buffer_load_dword v68, v10, s[32:35], s31 offen
    s_add_u32 s31, s28, 36864
    buffer_load_dword v69, v10, s[32:35], s31 offen
    s_add_u32 s31, s28, 122880
    buffer_load_dword v70, v10, s[32:35], s31 offen
    s_add_u32 s31, s28, 135168
    buffer_load_dword v71, v10, s[32:35], s31 offen
    v_add_u32 v9, 14, v8
    v_lshrrev_b32 v10, 2, v9
    v_lshlrev_b32 v10, 5, v10
    v_and_b32 v11, 2, v9
    v_lshl_add_u32 v10, v11, 3, v10
    v_and_b32 v11, 1, v9
    v_lshl_add_u32 v10, v11, 2, v10
    v_mul_u32_u24 v10, 12288, v10
    v_lshl_add_u32 v10, v4, 1, v10
    s_add_u32 s31, s28, 0
    buffer_load_dword v72, v10, s[32:35], s31 offen
    s_add_u32 s31, s28, 12288
    buffer_load_dword v73, v10, s[32:35], s31 offen
    s_add_u32 s31, s28, 98304
    buffer_load_dword v74, v10, s[32:35], s31 offen
    s_add_u32 s31, s28, 110592
    buffer_load_dword v75, v10, s[32:35], s31 offen
    s_add_u32 s31, s28, 24576
    buffer_load_dword v76, v10, s[32:35], s31 offen
    s_add_u32 s31, s28, 36864
    buffer_load_dword v77, v10, s[32:35], s31 offen
    s_add_u32 s31, s28, 122880
    buffer_load_dword v78, v10, s[32:35], s31 offen
    s_add_u32 s31, s28, 135168
    buffer_load_dword v79, v10, s[32:35], s31 offen
    v_lshl_add_u32 v7, v8, 8, v7
    v_mov_b32 v4, 0x05040100
    v_mov_b32 v5, 0x07060302
    s_waitcnt vmcnt(56)
    v_perm_b32 v80, v17, v16, v4
    v_perm_b32 v84, v17, v16, v5
    v_perm_b32 v81, v19, v18, v4
    v_perm_b32 v85, v19, v18, v5
    v_perm_b32 v82, v21, v20, v4
    v_perm_b32 v86, v21, v20, v5
    v_perm_b32 v83, v23, v22, v4
    v_perm_b32 v87, v23, v22, v5
    buffer_store_dwordx4 v[80:83], v7, s[8:11], s30 offen offset:0
    buffer_store_dwordx4 v[84:87], v7, s[8:11], s30 offen offset:16
    s_waitcnt vmcnt(48)
    v_perm_b32 v88, v25, v24, v4
    v_perm_b32 v92, v25, v24, v5
    v_perm_b32 v89, v27, v26, v4
    v_perm_b32 v93, v27, v26, v5
    v_perm_b32 v90, v29, v28, v4
    v_perm_b32 v94, v29, v28, v5
    v_perm_b32 v91, v31, v30, v4
    v_perm_b32 v95, v31, v30, v5
    buffer_store_dwordx4 v[88:91], v7, s[8:11], s30 offen offset:512
    buffer_store_dwordx4 v[92:95], v7, s[8:11], s30 offen offset:528
    s_nop 0
    s_waitcnt vmcnt(40)
    v_perm_b32 v80, v33, v32, v4
    v_perm_b32 v84, v33, v32, v5
    v_perm_b32 v81, v35, v34, v4
    v_perm_b32 v85, v35, v34, v5
    v_perm_b32 v82, v37, v36, v4
    v_perm_b32 v86, v37, v36, v5
    v_perm_b32 v83, v39, v38, v4
    v_perm_b32 v87, v39, v38, v5
    buffer_store_dwordx4 v[80:83], v7, s[8:11], s30 offen offset:1024
    buffer_store_dwordx4 v[84:87], v7, s[8:11], s30 offen offset:1040
    s_nop 0
    s_waitcnt vmcnt(32)
    v_perm_b32 v88, v41, v40, v4
    v_perm_b32 v92, v41, v40, v5
    v_perm_b32 v89, v43, v42, v4
    v_perm_b32 v93, v43, v42, v5
    v_perm_b32 v90, v45, v44, v4
    v_perm_b32 v94, v45, v44, v5
    v_perm_b32 v91, v47, v46, v4
    v_perm_b32 v95, v47, v46, v5
    buffer_store_dwordx4 v[88:91], v7, s[8:11], s30 offen offset:1536
    buffer_store_dwordx4 v[92:95], v7, s[8:11], s30 offen offset:1552
    s_nop 0
    s_waitcnt vmcnt(24)
    v_perm_b32 v80, v49, v48, v4
    v_perm_b32 v84, v49, v48, v5
    v_perm_b32 v81, v51, v50, v4
    v_perm_b32 v85, v51, v50, v5
    v_perm_b32 v82, v53, v52, v4
    v_perm_b32 v86, v53, v52, v5
    v_perm_b32 v83, v55, v54, v4
    v_perm_b32 v87, v55, v54, v5
    buffer_store_dwordx4 v[80:83], v7, s[8:11], s30 offen offset:2048
    buffer_store_dwordx4 v[84:87], v7, s[8:11], s30 offen offset:2064
    s_nop 0
    s_waitcnt vmcnt(16)
    v_perm_b32 v88, v57, v56, v4
    v_perm_b32 v92, v57, v56, v5
    v_perm_b32 v89, v59, v58, v4
    v_perm_b32 v93, v59, v58, v5
    v_perm_b32 v90, v61, v60, v4
    v_perm_b32 v94, v61, v60, v5
    v_perm_b32 v91, v63, v62, v4
    v_perm_b32 v95, v63, v62, v5
    buffer_store_dwordx4 v[88:91], v7, s[8:11], s30 offen offset:2560
    buffer_store_dwordx4 v[92:95], v7, s[8:11], s30 offen offset:2576
    s_nop 0
    s_waitcnt vmcnt(8)
    v_perm_b32 v80, v65, v64, v4
    v_perm_b32 v84, v65, v64, v5
    v_perm_b32 v81, v67, v66, v4
    v_perm_b32 v85, v67, v66, v5
    v_perm_b32 v82, v69, v68, v4
    v_perm_b32 v86, v69, v68, v5
    v_perm_b32 v83, v71, v70, v4
    v_perm_b32 v87, v71, v70, v5
    buffer_store_dwordx4 v[80:83], v7, s[8:11], s30 offen offset:3072
    buffer_store_dwordx4 v[84:87], v7, s[8:11], s30 offen offset:3088
    s_nop 0
    s_waitcnt vmcnt(0)
    v_perm_b32 v88, v73, v72, v4
    v_perm_b32 v92, v73, v72, v5
    v_perm_b32 v89, v75, v74, v4
    v_perm_b32 v93, v75, v74, v5
    v_perm_b32 v90, v77, v76, v4
    v_perm_b32 v94, v77, v76, v5
    v_perm_b32 v91, v79, v78, v4
    v_perm_b32 v95, v79, v78, v5
    buffer_store_dwordx4 v[88:91], v7, s[8:11], s30 offen offset:3584
    buffer_store_dwordx4 v[92:95], v7, s[8:11], s30 offen offset:3600
    s_nop 0
    s_branch prep_kernel_end
prep_kernel_r_pwa:
    s_load_dwordx2 s[24:25], s[0:1], 8
    s_lshr_b32 s21, s20, 1
    s_and_b32 s22, s20, 1
    v_and_b32 v1, 31, v0
    v_lshrrev_b32 v2, 5, v0
    s_mul_i32 s23, s21, 20
    v_add_u32 v3, 640, v1
    v_add_u32 v4, 1260, v1
    v_cmp_gt_u32 vcc, 20, v1
    s_nop 1
    v_cndmask_b32 v3, v4, v3, vcc
    v_add_u32 v4, 1292, v1
    v_subrev_u32 v5, 12, v1
    v_cmp_gt_u32 vcc, 8, v1
    s_nop 1
    v_cndmask_b32 v4, v5, v4, vcc
    s_cmp_eq_u32 s22, 0
    s_cselect_b64 vcc, -1, 0
    s_nop 1
    v_cndmask_b32 v3, v4, v3, vcc
    v_add_u32 v3, s23, v3
    v_lshlrev_b32 v3, 1, v3
    v_mul_u32_u24 v4, 30720, v2
    v_add_u32 v3, v3, v4
    s_mov_b32 s26, 0xfffff0ff
    s_cmp_eq_u32 s22, 0
    s_cselect_b32 s26, -1, s26
    s_mov_b32 s27, s26
    v_mov_b32 v16, 0
    v_mov_b32 v17, 0
    v_mov_b32 v18, 0
    v_mov_b32 v19, 0
    v_mov_b32 v20, 0
    v_mov_b32 v21, 0
    v_mov_b32 v22, 0
    v_mov_b32 v23, 0
    v_mov_b32 v24, 0
    v_mov_b32 v25, 0
    v_mov_b32 v26, 0
    v_mov_b32 v27, 0
    v_mov_b32 v28, 0
    v_mov_b32 v29, 0
    v_mov_b32 v30, 0
    v_mov_b32 v31, 0
    v_mov_b32 v32, 0
    v_mov_b32 v33, 0
    v_mov_b32 v34, 0
    v_mov_b32 v35, 0
    v_mov_b32 v36, 0
    v_mov_b32 v37, 0
    v_mov_b32 v38, 0
    v_mov_b32 v39, 0
    v_mov_b32 v40, 0
    v_mov_b32 v41, 0
    v_mov_b32 v42, 0
    v_mov_b32 v43, 0
    v_mov_b32 v44, 0
    v_mov_b32 v45, 0
    v_mov_b32 v46, 0
    v_mov_b32 v47, 0
    v_mov_b32 v48, 0
    v_mov_b32 v49, 0
    v_mov_b32 v50, 0
    v_mov_b32 v51, 0
    v_mov_b32 v52, 0
    v_mov_b32 v53, 0
    v_mov_b32 v54, 0
    v_mov_b32 v55, 0
    v_mov_b32 v56, 0
    v_mov_b32 v57, 0
    v_mov_b32 v58, 0
    v_mov_b32 v59, 0
    v_mov_b32 v60, 0
    v_mov_b32 v61, 0
    v_mov_b32 v62, 0
    v_mov_b32 v63, 0
    v_mov_b32 v64, 0
    v_mov_b32 v65, 0
    v_mov_b32 v66, 0
    v_mov_b32 v67, 0
    v_mov_b32 v68, 0
    v_mov_b32 v69, 0
    v_mov_b32 v70, 0
    v_mov_b32 v71, 0
    v_mov_b32 v72, 0
    v_mov_b32 v73, 0
    v_mov_b32 v74, 0
    v_mov_b32 v75, 0
    v_mov_b32 v76, 0
    v_mov_b32 v77, 0
    v_mov_b32 v78, 0
    v_mov_b32 v79, 0
    v_mov_b32 v80, 0
    v_mov_b32 v81, 0
    v_mov_b32 v82, 0
    v_mov_b32 v83, 0
    v_mov_b32 v84, 0
    v_mov_b32 v85, 0
    v_mov_b32 v86, 0
    v_mov_b32 v87, 0
    v_mov_b32 v88, 0
    v_mov_b32 v89, 0
    v_mov_b32 v90, 0
    v_mov_b32 v91, 0
    v_mov_b32 v92, 0
    v_mov_b32 v93, 0
    v_mov_b32 v94, 0
    v_mov_b32 v95, 0
    s_waitcnt lgkmcnt(0)
    s_mov_b32 s32, s24
    s_mov_b32 s33, s25
    s_mov_b32 s34, 2457600
    s_mov_b32 s35, 0x00020000
    s_mul_i32 s28, s13, 614400
    s_mov_b64 exec, s[26:27]
    s_add_u32 s29, s28, 0
    buffer_load_short_d16_hi v16, v3, s[32:35], s29 offen
    s_add_u32 s29, s28, 3840
    buffer_load_short_d16_hi v17, v3, s[32:35], s29 offen
    s_add_u32 s29, s28, 7680
    buffer_load_short_d16_hi v18, v3, s[32:35], s29 offen
    s_add_u32 s29, s28, 11520
    buffer_load_short_d16_hi v19, v3, s[32:35], s29 offen
    s_add_u32 s29, s28, 15360
    buffer_load_short_d16_hi v20, v3, s[32:35], s29 offen
    s_add_u32 s29, s28, 19200
    buffer_load_short_d16_hi v21, v3, s[32:35], s29 offen
    s_add_u32 s29, s28, 23040
    buffer_load_short_d16_hi v22, v3, s[32:35], s29 offen
    s_add_u32 s29, s28, 26880
    buffer_load_short_d16_hi v23, v3, s[32:35], s29 offen
    s_add_u32 s29, s28, 61440
    buffer_load_short_d16_hi v24, v3, s[32:35], s29 offen
    s_add_u32 s29, s28, 65280
    buffer_load_short_d16_hi v25, v3, s[32:35], s29 offen
    s_add_u32 s29, s28, 69120
    buffer_load_short_d16_hi v26, v3, s[32:35], s29 offen
    s_add_u32 s29, s28, 72960
    buffer_load_short_d16_hi v27, v3, s[32:35], s29 offen
    s_add_u32 s29, s28, 76800
    buffer_load_short_d16_hi v28, v3, s[32:35], s29 offen
    s_add_u32 s29, s28, 80640
    buffer_load_short_d16_hi v29, v3, s[32:35], s29 offen
    s_add_u32 s29, s28, 84480
    buffer_load_short_d16_hi v30, v3, s[32:35], s29 offen
    s_add_u32 s29, s28, 88320
    buffer_load_short_d16_hi v31, v3, s[32:35], s29 offen
    s_add_u32 s29, s28, 122880
    buffer_load_short_d16_hi v32, v3, s[32:35], s29 offen
    s_add_u32 s29, s28, 126720
    buffer_load_short_d16_hi v33, v3, s[32:35], s29 offen
    s_add_u32 s29, s28, 130560
    buffer_load_short_d16_hi v34, v3, s[32:35], s29 offen
    s_add_u32 s29, s28, 134400
    buffer_load_short_d16_hi v35, v3, s[32:35], s29 offen
    s_add_u32 s29, s28, 138240
    buffer_load_short_d16_hi v36, v3, s[32:35], s29 offen
    s_add_u32 s29, s28, 142080
    buffer_load_short_d16_hi v37, v3, s[32:35], s29 offen
    s_add_u32 s29, s28, 145920
    buffer_load_short_d16_hi v38, v3, s[32:35], s29 offen
    s_add_u32 s29, s28, 149760
    buffer_load_short_d16_hi v39, v3, s[32:35], s29 offen
    s_add_u32 s29, s28, 184320
    buffer_load_short_d16_hi v40, v3, s[32:35], s29 offen
    s_add_u32 s29, s28, 188160
    buffer_load_short_d16_hi v41, v3, s[32:35], s29 offen
    s_add_u32 s29, s28, 192000
    buffer_load_short_d16_hi v42, v3, s[32:35], s29 offen
    s_add_u32 s29, s28, 195840
    buffer_load_short_d16_hi v43, v3, s[32:35], s29 offen
    s_add_u32 s29, s28, 199680
    buffer_load_short_d16_hi v44, v3, s[32:35], s29 offen
    s_add_u32 s29, s28, 203520
    buffer_load_short_d16_hi v45, v3, s[32:35], s29 offen
    s_add_u32 s29, s28, 207360
    buffer_load_short_d16_hi v46, v3, s[32:35], s29 offen
    s_add_u32 s29, s28, 211200
    buffer_load_short_d16_hi v47, v3, s[32:35], s29 offen
    s_add_u32 s29, s28, 245760
    buffer_load_short_d16_hi v48, v3, s[32:35], s29 offen
    s_add_u32 s29, s28, 249600
    buffer_load_short_d16_hi v49, v3, s[32:35], s29 offen
    s_add_u32 s29, s28, 253440
    buffer_load_short_d16_hi v50, v3, s[32:35], s29 offen
    s_add_u32 s29, s28, 257280
    buffer_load_short_d16_hi v51, v3, s[32:35], s29 offen
    s_add_u32 s29, s28, 261120
    buffer_load_short_d16_hi v52, v3, s[32:35], s29 offen
    s_add_u32 s29, s28, 264960
    buffer_load_short_d16_hi v53, v3, s[32:35], s29 offen
    s_add_u32 s29, s28, 268800
    buffer_load_short_d16_hi v54, v3, s[32:35], s29 offen
    s_add_u32 s29, s28, 272640
    buffer_load_short_d16_hi v55, v3, s[32:35], s29 offen
    s_add_u32 s29, s28, 307200
    buffer_load_short_d16_hi v56, v3, s[32:35], s29 offen
    s_add_u32 s29, s28, 311040
    buffer_load_short_d16_hi v57, v3, s[32:35], s29 offen
    s_add_u32 s29, s28, 314880
    buffer_load_short_d16_hi v58, v3, s[32:35], s29 offen
    s_add_u32 s29, s28, 318720
    buffer_load_short_d16_hi v59, v3, s[32:35], s29 offen
    s_add_u32 s29, s28, 322560
    buffer_load_short_d16_hi v60, v3, s[32:35], s29 offen
    s_add_u32 s29, s28, 326400
    buffer_load_short_d16_hi v61, v3, s[32:35], s29 offen
    s_add_u32 s29, s28, 330240
    buffer_load_short_d16_hi v62, v3, s[32:35], s29 offen
    s_add_u32 s29, s28, 334080
    buffer_load_short_d16_hi v63, v3, s[32:35], s29 offen
    s_add_u32 s29, s28, 368640
    buffer_load_short_d16_hi v64, v3, s[32:35], s29 offen
    s_add_u32 s29, s28, 372480
    buffer_load_short_d16_hi v65, v3, s[32:35], s29 offen
    s_add_u32 s29, s28, 376320
    buffer_load_short_d16_hi v66, v3, s[32:35], s29 offen
    s_add_u32 s29, s28, 380160
    buffer_load_short_d16_hi v67, v3, s[32:35], s29 offen
    s_add_u32 s29, s28, 384000
    buffer_load_short_d16_hi v68, v3, s[32:35], s29 offen
    s_add_u32 s29, s28, 387840
    buffer_load_short_d16_hi v69, v3, s[32:35], s29 offen
    s_add_u32 s29, s28, 391680
    buffer_load_short_d16_hi v70, v3, s[32:35], s29 offen
    s_add_u32 s29, s28, 395520
    buffer_load_short_d16_hi v71, v3, s[32:35], s29 offen
    s_add_u32 s29, s28, 430080
    buffer_load_short_d16_hi v72, v3, s[32:35], s29 offen
    s_add_u32 s29, s28, 433920
    buffer_load_short_d16_hi v73, v3, s[32:35], s29 offen
    s_add_u32 s29, s28, 437760
    buffer_load_short_d16_hi v74, v3, s[32:35], s29 offen
    s_add_u32 s29, s28, 441600
    buffer_load_short_d16_hi v75, v3, s[32:35], s29 offen
    s_add_u32 s29, s28, 445440
    buffer_load_short_d16_hi v76, v3, s[32:35], s29 offen
    s_add_u32 s29, s28, 449280
    buffer_load_short_d16_hi v77, v3, s[32:35], s29 offen
    s_add_u32 s29, s28, 453120
    buffer_load_short_d16_hi v78, v3, s[32:35], s29 offen
    s_add_u32 s29, s28, 456960
    buffer_load_short_d16_hi v79, v3, s[32:35], s29 offen
    s_add_u32 s29, s28, 491520
    buffer_load_short_d16_hi v80, v3, s[32:35], s29 offen
    s_add_u32 s29, s28, 495360
    buffer_load_short_d16_hi v81, v3, s[32:35], s29 offen
    s_add_u32 s29, s28, 499200
    buffer_load_short_d16_hi v82, v3, s[32:35], s29 offen
    s_add_u32 s29, s28, 503040
    buffer_load_short_d16_hi v83, v3, s[32:35], s29 offen
    s_add_u32 s29, s28, 506880
    buffer_load_short_d16_hi v84, v3, s[32:35], s29 offen
    s_add_u32 s29, s28, 510720
    buffer_load_short_d16_hi v85, v3, s[32:35], s29 offen
    s_add_u32 s29, s28, 514560
    buffer_load_short_d16_hi v86, v3, s[32:35], s29 offen
    s_add_u32 s29, s28, 518400
    buffer_load_short_d16_hi v87, v3, s[32:35], s29 offen
    s_add_u32 s29, s28, 552960
    buffer_load_short_d16_hi v88, v3, s[32:35], s29 offen
    s_add_u32 s29, s28, 556800
    buffer_load_short_d16_hi v89, v3, s[32:35], s29 offen
    s_add_u32 s29, s28, 560640
    buffer_load_short_d16_hi v90, v3, s[32:35], s29 offen
    s_add_u32 s29, s28, 564480
    buffer_load_short_d16_hi v91, v3, s[32:35], s29 offen
    s_add_u32 s29, s28, 568320
    buffer_load_short_d16_hi v92, v3, s[32:35], s29 offen
    s_add_u32 s29, s28, 572160
    buffer_load_short_d16_hi v93, v3, s[32:35], s29 offen
    s_add_u32 s29, s28, 576000
    buffer_load_short_d16_hi v94, v3, s[32:35], s29 offen
    s_add_u32 s29, s28, 579840
    buffer_load_short_d16_hi v95, v3, s[32:35], s29 offen
    s_mov_b64 exec, -1
    s_waitcnt vmcnt(0)
    v_add_f32 v5, v16, v17
    v_add_f32 v5, v5, v18
    v_add_f32 v5, v5, v19
    v_add_f32 v5, v5, v20
    v_add_f32 v5, v5, v21
    v_add_f32 v5, v5, v22
    v_add_f32 v5, v5, v23
    v_add_f32 v5, v5, v24
    v_add_f32 v5, v5, v25
    v_add_f32 v5, v5, v26
    v_add_f32 v5, v5, v27
    v_add_f32 v5, v5, v28
    v_add_f32 v5, v5, v29
    v_add_f32 v5, v5, v30
    v_add_f32 v5, v5, v31
    v_add_f32 v5, v5, v32
    v_add_f32 v5, v5, v33
    v_add_f32 v5, v5, v34
    v_add_f32 v5, v5, v35
    v_add_f32 v5, v5, v36
    v_add_f32 v5, v5, v37
    v_add_f32 v5, v5, v38
    v_add_f32 v5, v5, v39
    v_add_f32 v5, v5, v40
    v_add_f32 v5, v5, v41
    v_add_f32 v5, v5, v42
    v_add_f32 v5, v5, v43
    v_add_f32 v5, v5, v44
    v_add_f32 v5, v5, v45
    v_add_f32 v5, v5, v46
    v_add_f32 v5, v5, v47
    v_add_f32 v5, v5, v48
    v_add_f32 v5, v5, v49
    v_add_f32 v5, v5, v50
    v_add_f32 v5, v5, v51
    v_add_f32 v5, v5, v52
    v_add_f32 v5, v5, v53
    v_add_f32 v5, v5, v54
    v_add_f32 v5, v5, v55
    v_add_f32 v5, v5, v56
    v_add_f32 v5, v5, v57
    v_add_f32 v5, v5, v58
    v_add_f32 v5, v5, v59
    v_add_f32 v5, v5, v60
    v_add_f32 v5, v5, v61
    v_add_f32 v5, v5, v62
    v_add_f32 v5, v5, v63
    v_add_f32 v5, v5, v64
    v_add_f32 v5, v5, v65
    v_add_f32 v5, v5, v66
    v_add_f32 v5, v5, v67
    v_add_f32 v5, v5, v68
    v_add_f32 v5, v5, v69
    v_add_f32 v5, v5, v70
    v_add_f32 v5, v5, v71
    v_add_f32 v5, v5, v72
    v_add_f32 v5, v5, v73
    v_add_f32 v5, v5, v74
    v_add_f32 v5, v5, v75
    v_add_f32 v5, v5, v76
    v_add_f32 v5, v5, v77
    v_add_f32 v5, v5, v78
    v_add_f32 v5, v5, v79
    v_add_f32 v5, v5, v80
    v_add_f32 v5, v5, v81
    v_add_f32 v5, v5, v82
    v_add_f32 v5, v5, v83
    v_add_f32 v5, v5, v84
    v_add_f32 v5, v5, v85
    v_add_f32 v5, v5, v86
    v_add_f32 v5, v5, v87
    v_add_f32 v5, v5, v88
    v_add_f32 v5, v5, v89
    v_add_f32 v5, v5, v90
    v_add_f32 v5, v5, v91
    v_add_f32 v5, v5, v92
    v_add_f32 v5, v5, v93
    v_add_f32 v5, v5, v94
    v_add_f32 v5, v5, v95
    v_mov_b32 v6, v5
    s_nop 1
    v_permlane32_swap_b32 v5, v6
    v_add_f32 v5, v5, v6
    s_lshl_b32 s29, s13, 8
    v_lshlrev_b32 v7, 2, v0
    v_add_u32 v8, s29, v7
    ds_write_b32 v8, v5
    s_waitcnt lgkmcnt(0)
    s_barrier
    ds_read_b32 v8, v7 offset:0
    ds_read_b32 v9, v7 offset:256
    ds_read_b32 v10, v7 offset:512
    ds_read_b32 v11, v7 offset:768
    s_waitcnt lgkmcnt(0)
    v_add_f32 v8, v8, v9
    v_add_f32 v10, v10, v11
    v_add_f32 v8, v8, v10
    v_mul_f32 v8, 0x3acccccd, v8
    v_sub_f32 v16, v16, v8
    v_sub_f32 v17, v17, v8
    v_sub_f32 v18, v18, v8
    v_sub_f32 v19, v19, v8
    v_sub_f32 v20, v20, v8
    v_sub_f32 v21, v21, v8
    v_sub_f32 v22, v22, v8
    v_sub_f32 v23, v23, v8
    v_sub_f32 v24, v24, v8
    v_sub_f32 v25, v25, v8
    v_sub_f32 v26, v26, v8
    v_sub_f32 v27, v27, v8
    v_sub_f32 v28, v28, v8
    v_sub_f32 v29, v29, v8
    v_sub_f32 v30, v30, v8
    v_sub_f32 v31, v31, v8
    v_sub_f32 v32, v32, v8
    v_sub_f32 v33, v33, v8
    v_sub_f32 v34, v34, v8
    v_sub_f32 v35, v35, v8
    v_sub_f32 v36, v36, v8
    v_sub_f32 v37, v37, v8
    v_sub_f32 v38, v38, v8
    v_sub_f32 v39, v39, v8
    v_sub_f32 v40, v40, v8
    v_sub_f32 v41, v41, v8
    v_sub_f32 v42, v42, v8
    v_sub_f32 v43, v43, v8
    v_sub_f32 v44, v44, v8
    v_sub_f32 v45, v45, v8
    v_sub_f32 v46, v46, v8
    v_sub_f32 v47, v47, v8
    v_sub_f32 v48, v48, v8
    v_sub_f32 v49, v49, v8
    v_sub_f32 v50, v50, v8
    v_sub_f32 v51, v51, v8
    v_sub_f32 v52, v52, v8
    v_sub_f32 v53, v53, v8
    v_sub_f32 v54, v54, v8
    v_sub_f32 v55, v55, v8
    v_sub_f32 v56, v56, v8
    v_sub_f32 v57, v57, v8
    v_sub_f32 v58, v58, v8
    v_sub_f32 v59, v59, v8
    v_sub_f32 v60, v60, v8
    v_sub_f32 v61, v61, v8
    v_sub_f32 v62, v62, v8
    v_sub_f32 v63, v63, v8
    v_sub_f32 v64, v64, v8
    v_sub_f32 v65, v65, v8
    v_sub_f32 v66, v66, v8
    v_sub_f32 v67, v67, v8
    v_sub_f32 v68, v68, v8
    v_sub_f32 v69, v69, v8
    v_sub_f32 v70, v70, v8
    v_sub_f32 v71, v71, v8
    v_sub_f32 v72, v72, v8
    v_sub_f32 v73, v73, v8
    v_sub_f32 v74, v74, v8
    v_sub_f32 v75, v75, v8
    v_sub_f32 v76, v76, v8
    v_sub_f32 v77, v77, v8
    v_sub_f32 v78, v78, v8
    v_sub_f32 v79, v79, v8
    v_sub_f32 v80, v80, v8
    v_sub_f32 v81, v81, v8
    v_sub_f32 v82, v82, v8
    v_sub_f32 v83, v83, v8
    v_sub_f32 v84, v84, v8
    v_sub_f32 v85, v85, v8
    v_sub_f32 v86, v86, v8
    v_sub_f32 v87, v87, v8
    v_sub_f32 v88, v88, v8
    v_sub_f32 v89, v89, v8
    v_sub_f32 v90, v90, v8
    v_sub_f32 v91, v91, v8
    v_sub_f32 v92, v92, v8
    v_sub_f32 v93, v93, v8
    v_sub_f32 v94, v94, v8
    v_sub_f32 v95, v95, v8
    s_lshl_b32 s26, s22, 9
    s_mov_b32 s27, s26
    v_cndmask_b32 v16, v16, 1.0, s[26:27]
    v_cndmask_b32 v17, v17, 1.0, s[26:27]
    v_cndmask_b32 v18, v18, 1.0, s[26:27]
    v_cndmask_b32 v19, v19, 1.0, s[26:27]
    v_cndmask_b32 v20, v20, 1.0, s[26:27]
    v_cndmask_b32 v21, v21, 1.0, s[26:27]
    v_cndmask_b32 v22, v22, 1.0, s[26:27]
    v_cndmask_b32 v23, v23, 1.0, s[26:27]
    v_cndmask_b32 v24, v24, 1.0, s[26:27]
    v_cndmask_b32 v25, v25, 1.0, s[26:27]
    v_cndmask_b32 v26, v26, 1.0, s[26:27]
    v_cndmask_b32 v27, v27, 1.0, s[26:27]
    v_cndmask_b32 v28, v28, 1.0, s[26:27]
    v_cndmask_b32 v29, v29, 1.0, s[26:27]
    v_cndmask_b32 v30, v30, 1.0, s[26:27]
    v_cndmask_b32 v31, v31, 1.0, s[26:27]
    v_cndmask_b32 v32, v32, 1.0, s[26:27]
    v_cndmask_b32 v33, v33, 1.0, s[26:27]
    v_cndmask_b32 v34, v34, 1.0, s[26:27]
    v_cndmask_b32 v35, v35, 1.0, s[26:27]
    v_cndmask_b32 v36, v36, 1.0, s[26:27]
    v_cndmask_b32 v37, v37, 1.0, s[26:27]
    v_cndmask_b32 v38, v38, 1.0, s[26:27]
    v_cndmask_b32 v39, v39, 1.0, s[26:27]
    v_cndmask_b32 v40, v40, 1.0, s[26:27]
    v_cndmask_b32 v41, v41, 1.0, s[26:27]
    v_cndmask_b32 v42, v42, 1.0, s[26:27]
    v_cndmask_b32 v43, v43, 1.0, s[26:27]
    v_cndmask_b32 v44, v44, 1.0, s[26:27]
    v_cndmask_b32 v45, v45, 1.0, s[26:27]
    v_cndmask_b32 v46, v46, 1.0, s[26:27]
    v_cndmask_b32 v47, v47, 1.0, s[26:27]
    v_cndmask_b32 v48, v48, 1.0, s[26:27]
    v_cndmask_b32 v49, v49, 1.0, s[26:27]
    v_cndmask_b32 v50, v50, 1.0, s[26:27]
    v_cndmask_b32 v51, v51, 1.0, s[26:27]
    v_cndmask_b32 v52, v52, 1.0, s[26:27]
    v_cndmask_b32 v53, v53, 1.0, s[26:27]
    v_cndmask_b32 v54, v54, 1.0, s[26:27]
    v_cndmask_b32 v55, v55, 1.0, s[26:27]
    v_cndmask_b32 v56, v56, 1.0, s[26:27]
    v_cndmask_b32 v57, v57, 1.0, s[26:27]
    v_cndmask_b32 v58, v58, 1.0, s[26:27]
    v_cndmask_b32 v59, v59, 1.0, s[26:27]
    v_cndmask_b32 v60, v60, 1.0, s[26:27]
    v_cndmask_b32 v61, v61, 1.0, s[26:27]
    v_cndmask_b32 v62, v62, 1.0, s[26:27]
    v_cndmask_b32 v63, v63, 1.0, s[26:27]
    v_cndmask_b32 v64, v64, 1.0, s[26:27]
    v_cndmask_b32 v65, v65, 1.0, s[26:27]
    v_cndmask_b32 v66, v66, 1.0, s[26:27]
    v_cndmask_b32 v67, v67, 1.0, s[26:27]
    v_cndmask_b32 v68, v68, 1.0, s[26:27]
    v_cndmask_b32 v69, v69, 1.0, s[26:27]
    v_cndmask_b32 v70, v70, 1.0, s[26:27]
    v_cndmask_b32 v71, v71, 1.0, s[26:27]
    v_cndmask_b32 v72, v72, 1.0, s[26:27]
    v_cndmask_b32 v73, v73, 1.0, s[26:27]
    v_cndmask_b32 v74, v74, 1.0, s[26:27]
    v_cndmask_b32 v75, v75, 1.0, s[26:27]
    v_cndmask_b32 v76, v76, 1.0, s[26:27]
    v_cndmask_b32 v77, v77, 1.0, s[26:27]
    v_cndmask_b32 v78, v78, 1.0, s[26:27]
    v_cndmask_b32 v79, v79, 1.0, s[26:27]
    v_cndmask_b32 v80, v80, 1.0, s[26:27]
    v_cndmask_b32 v81, v81, 1.0, s[26:27]
    v_cndmask_b32 v82, v82, 1.0, s[26:27]
    v_cndmask_b32 v83, v83, 1.0, s[26:27]
    v_cndmask_b32 v84, v84, 1.0, s[26:27]
    v_cndmask_b32 v85, v85, 1.0, s[26:27]
    v_cndmask_b32 v86, v86, 1.0, s[26:27]
    v_cndmask_b32 v87, v87, 1.0, s[26:27]
    v_cndmask_b32 v88, v88, 1.0, s[26:27]
    v_cndmask_b32 v89, v89, 1.0, s[26:27]
    v_cndmask_b32 v90, v90, 1.0, s[26:27]
    v_cndmask_b32 v91, v91, 1.0, s[26:27]
    v_cndmask_b32 v92, v92, 1.0, s[26:27]
    v_cndmask_b32 v93, v93, 1.0, s[26:27]
    v_cndmask_b32 v94, v94, 1.0, s[26:27]
    v_cndmask_b32 v95, v95, 1.0, s[26:27]
    s_mul_i32 s29, s21, 81920
    s_lshl_b32 s30, s22, 10
    s_add_u32 s29, s29, s30
    s_mul_i32 s30, s13, 20480
    s_add_u32 s29, s29, s30
    s_add_u32 s29, s29, 243269632
    v_lshlrev_b32 v7, 4, v0
    v_cvt_pk_bf16_f32 v100, v16, v17
    v_cvt_pk_bf16_f32 v101, v18, v19
    v_cvt_pk_bf16_f32 v102, v20, v21
    v_cvt_pk_bf16_f32 v103, v22, v23
    buffer_store_dwordx4 v[100:103], v7, s[8:11], s29 offen
    s_add_u32 s29, s29, 2048
    v_cvt_pk_bf16_f32 v104, v24, v25
    v_cvt_pk_bf16_f32 v105, v26, v27
    v_cvt_pk_bf16_f32 v106, v28, v29
    v_cvt_pk_bf16_f32 v107, v30, v31
    buffer_store_dwordx4 v[104:107], v7, s[8:11], s29 offen
    s_add_u32 s29, s29, 2048
    v_cvt_pk_bf16_f32 v100, v32, v33
    v_cvt_pk_bf16_f32 v101, v34, v35
    v_cvt_pk_bf16_f32 v102, v36, v37
    v_cvt_pk_bf16_f32 v103, v38, v39
    buffer_store_dwordx4 v[100:103], v7, s[8:11], s29 offen
    s_add_u32 s29, s29, 2048
    v_cvt_pk_bf16_f32 v104, v40, v41
    v_cvt_pk_bf16_f32 v105, v42, v43
    v_cvt_pk_bf16_f32 v106, v44, v45
    v_cvt_pk_bf16_f32 v107, v46, v47
    buffer_store_dwordx4 v[104:107], v7, s[8:11], s29 offen
    s_add_u32 s29, s29, 2048
    v_cvt_pk_bf16_f32 v100, v48, v49
    v_cvt_pk_bf16_f32 v101, v50, v51
    v_cvt_pk_bf16_f32 v102, v52, v53
    v_cvt_pk_bf16_f32 v103, v54, v55
    buffer_store_dwordx4 v[100:103], v7, s[8:11], s29 offen
    s_add_u32 s29, s29, 2048
    v_cvt_pk_bf16_f32 v104, v56, v57
    v_cvt_pk_bf16_f32 v105, v58, v59
    v_cvt_pk_bf16_f32 v106, v60, v61
    v_cvt_pk_bf16_f32 v107, v62, v63
    buffer_store_dwordx4 v[104:107], v7, s[8:11], s29 offen
    s_add_u32 s29, s29, 2048
    v_cvt_pk_bf16_f32 v100, v64, v65
    v_cvt_pk_bf16_f32 v101, v66, v67
    v_cvt_pk_bf16_f32 v102, v68, v69
    v_cvt_pk_bf16_f32 v103, v70, v71
    buffer_store_dwordx4 v[100:103], v7, s[8:11], s29 offen
    s_add_u32 s29, s29, 2048
    v_cvt_pk_bf16_f32 v104, v72, v73
    v_cvt_pk_bf16_f32 v105, v74, v75
    v_cvt_pk_bf16_f32 v106, v76, v77
    v_cvt_pk_bf16_f32 v107, v78, v79
    buffer_store_dwordx4 v[104:107], v7, s[8:11], s29 offen
    s_add_u32 s29, s29, 2048
    v_cvt_pk_bf16_f32 v100, v80, v81
    v_cvt_pk_bf16_f32 v101, v82, v83
    v_cvt_pk_bf16_f32 v102, v84, v85
    v_cvt_pk_bf16_f32 v103, v86, v87
    buffer_store_dwordx4 v[100:103], v7, s[8:11], s29 offen
    s_add_u32 s29, s29, 2048
    v_cvt_pk_bf16_f32 v104, v88, v89
    v_cvt_pk_bf16_f32 v105, v90, v91
    v_cvt_pk_bf16_f32 v106, v92, v93
    v_cvt_pk_bf16_f32 v107, v94, v95
    buffer_store_dwordx4 v[104:107], v7, s[8:11], s29 offen
    s_add_u32 s29, s29, 2048
    s_branch prep_kernel_end
prep_kernel_r_pwo:
    s_lshl_b32 s20, s20, 2
    s_add_u32 s20, s20, s13
    s_load_dwordx2 s[24:25], s[0:1], 16
    s_lshr_b32 s21, s20, 3
    s_and_b32 s22, s20, 7
    v_and_b32 v1, 31, v0
    v_lshrrev_b32 v2, 5, v0
    v_lshlrev_b32 v3, 1, v1
    v_mul_u32_u24 v4, 10240, v2
    v_add_u32 v3, v3, v4
    s_lshl_b32 s29, s21, 6
    s_mul_i32 s30, s22, 102400
    s_add_u32 s29, s29, s30
    s_waitcnt lgkmcnt(0)
    s_mov_b32 s32, s24
    s_mov_b32 s33, s25
    s_mov_b32 s34, 819200
    s_mov_b32 s35, 0x00020000
    s_add_u32 s30, s29, 0
    buffer_load_ushort v16, v3, s[32:35], s30 offen
    s_add_u32 s30, s29, 1280
    buffer_load_ushort v17, v3, s[32:35], s30 offen
    s_add_u32 s30, s29, 2560
    buffer_load_ushort v18, v3, s[32:35], s30 offen
    s_add_u32 s30, s29, 3840
    buffer_load_ushort v19, v3, s[32:35], s30 offen
    s_add_u32 s30, s29, 5120
    buffer_load_ushort v20, v3, s[32:35], s30 offen
    s_add_u32 s30, s29, 6400
    buffer_load_ushort v21, v3, s[32:35], s30 offen
    s_add_u32 s30, s29, 7680
    buffer_load_ushort v22, v3, s[32:35], s30 offen
    s_add_u32 s30, s29, 8960
    buffer_load_ushort v23, v3, s[32:35], s30 offen
    s_add_u32 s30, s29, 20480
    buffer_load_ushort v24, v3, s[32:35], s30 offen
    s_add_u32 s30, s29, 21760
    buffer_load_ushort v25, v3, s[32:35], s30 offen
    s_add_u32 s30, s29, 23040
    buffer_load_ushort v26, v3, s[32:35], s30 offen
    s_add_u32 s30, s29, 24320
    buffer_load_ushort v27, v3, s[32:35], s30 offen
    s_add_u32 s30, s29, 25600
    buffer_load_ushort v28, v3, s[32:35], s30 offen
    s_add_u32 s30, s29, 26880
    buffer_load_ushort v29, v3, s[32:35], s30 offen
    s_add_u32 s30, s29, 28160
    buffer_load_ushort v30, v3, s[32:35], s30 offen
    s_add_u32 s30, s29, 29440
    buffer_load_ushort v31, v3, s[32:35], s30 offen
    s_add_u32 s30, s29, 40960
    buffer_load_ushort v32, v3, s[32:35], s30 offen
    s_add_u32 s30, s29, 42240
    buffer_load_ushort v33, v3, s[32:35], s30 offen
    s_add_u32 s30, s29, 43520
    buffer_load_ushort v34, v3, s[32:35], s30 offen
    s_add_u32 s30, s29, 44800
    buffer_load_ushort v35, v3, s[32:35], s30 offen
    s_add_u32 s30, s29, 46080
    buffer_load_ushort v36, v3, s[32:35], s30 offen
    s_add_u32 s30, s29, 47360
    buffer_load_ushort v37, v3, s[32:35], s30 offen
    s_add_u32 s30, s29, 48640
    buffer_load_ushort v38, v3, s[32:35], s30 offen
    s_add_u32 s30, s29, 49920
    buffer_load_ushort v39, v3, s[32:35], s30 offen
    s_add_u32 s30, s29, 61440
    buffer_load_ushort v40, v3, s[32:35], s30 offen
    s_add_u32 s30, s29, 62720
    buffer_load_ushort v41, v3, s[32:35], s30 offen
    s_add_u32 s30, s29, 64000
    buffer_load_ushort v42, v3, s[32:35], s30 offen
    s_add_u32 s30, s29, 65280
    buffer_load_ushort v43, v3, s[32:35], s30 offen
    s_add_u32 s30, s29, 66560
    buffer_load_ushort v44, v3, s[32:35], s30 offen
    s_add_u32 s30, s29, 67840
    buffer_load_ushort v45, v3, s[32:35], s30 offen
    s_add_u32 s30, s29, 69120
    buffer_load_ushort v46, v3, s[32:35], s30 offen
    s_add_u32 s30, s29, 70400
    buffer_load_ushort v47, v3, s[32:35], s30 offen
    s_add_u32 s30, s29, 81920
    buffer_load_ushort v48, v3, s[32:35], s30 offen
    s_add_u32 s30, s29, 83200
    buffer_load_ushort v49, v3, s[32:35], s30 offen
    s_add_u32 s30, s29, 84480
    buffer_load_ushort v50, v3, s[32:35], s30 offen
    s_add_u32 s30, s29, 85760
    buffer_load_ushort v51, v3, s[32:35], s30 offen
    s_add_u32 s30, s29, 87040
    buffer_load_ushort v52, v3, s[32:35], s30 offen
    s_add_u32 s30, s29, 88320
    buffer_load_ushort v53, v3, s[32:35], s30 offen
    s_add_u32 s30, s29, 89600
    buffer_load_ushort v54, v3, s[32:35], s30 offen
    s_add_u32 s30, s29, 90880
    buffer_load_ushort v55, v3, s[32:35], s30 offen
    s_mul_i32 s29, s20, 5120
    s_add_u32 s29, s29, 246415360
    v_lshlrev_b32 v7, 4, v0
    s_waitcnt vmcnt(32)
    v_lshl_or_b32 v64, v17, 16, v16
    v_lshl_or_b32 v65, v19, 16, v18
    v_lshl_or_b32 v66, v21, 16, v20
    v_lshl_or_b32 v67, v23, 16, v22
    buffer_store_dwordx4 v[64:67], v7, s[8:11], s29 offen offset:0
    s_waitcnt vmcnt(25)
    v_lshl_or_b32 v68, v25, 16, v24
    v_lshl_or_b32 v69, v27, 16, v26
    v_lshl_or_b32 v70, v29, 16, v28
    v_lshl_or_b32 v71, v31, 16, v30
    buffer_store_dwordx4 v[68:71], v7, s[8:11], s29 offen offset:1024
    s_waitcnt vmcnt(18)
    v_lshl_or_b32 v72, v33, 16, v32
    v_lshl_or_b32 v73, v35, 16, v34
    v_lshl_or_b32 v74, v37, 16, v36
    v_lshl_or_b32 v75, v39, 16, v38
    buffer_store_dwordx4 v[72:75], v7, s[8:11], s29 offen offset:2048
    s_waitcnt vmcnt(11)
    v_lshl_or_b32 v76, v41, 16, v40
    v_lshl_or_b32 v77, v43, 16, v42
    v_lshl_or_b32 v78, v45, 16, v44
    v_lshl_or_b32 v79, v47, 16, v46
    buffer_store_dwordx4 v[76:79], v7, s[8:11], s29 offen offset:3072
    s_add_u32 s29, s29, 4096
    s_waitcnt vmcnt(4)
    v_lshl_or_b32 v80, v49, 16, v48
    v_lshl_or_b32 v81, v51, 16, v50
    v_lshl_or_b32 v82, v53, 16, v52
    v_lshl_or_b32 v83, v55, 16, v54
    buffer_store_dwordx4 v[80:83], v7, s[8:11], s29 offen offset:0
    s_branch prep_kernel_end
prep_kernel_end:
    s_endpgm
.section .rodata,"a"
.p2align 6
.amdhsa_kernel prep_kernel
  .amdhsa_next_free_vgpr 248
  .amdhsa_next_free_sgpr 64
  .amdhsa_accum_offset 248
  .amdhsa_group_segment_fixed_size 0
  .amdhsa_kernarg_size 104
  .amdhsa_user_sgpr_count 2
  .amdhsa_user_sgpr_kernarg_segment_ptr 1
  .amdhsa_system_sgpr_workgroup_id_x 1
.end_amdhsa_kernel
.text
.globl layerb2_kernel
.p2align 8
.type layerb2_kernel,@function
layerb2_kernel:
    s_mov_b32 s49, 1
    s_branch layerb1_kernel_body
    s_endpgm
.section .rodata,"a"
.p2align 6
.amdhsa_kernel layerb2_kernel
  .amdhsa_next_free_vgpr 512
  .amdhsa_next_free_sgpr 100
  .amdhsa_accum_offset 256
  .amdhsa_group_segment_fixed_size 0
  .amdhsa_kernarg_size 104
  .amdhsa_user_sgpr_count 2
  .amdhsa_user_sgpr_kernarg_segment_ptr 1
  .amdhsa_system_sgpr_workgroup_id_x 1
.end_amdhsa_kernel
.text
.globl layerb1_kernel
.p2align 8
.type layerb1_kernel,@function
layerb1_kernel:
    s_mov_b32 s49, 0
layerb1_kernel_body:
    s_cmp_ge_u32 s2, 256
    s_cbranch_scc1 layerb1_kernel_end0
    s_load_dwordx2 s[4:5], s[0:1], 96
    s_load_dwordx2 s[6:7], s[0:1], 80
    v_lshrrev_b32 v1, 6, v0
    v_and_b32 v0, 63, v0
    s_nop 0
    v_readfirstlane_b32 s13, v1
    s_mov_b32 s15, 400000
    s_waitcnt lgkmcnt(0)
    s_mov_b32 s8, s4
    s_mov_b32 s9, s5
    s_mov_b32 s10, 268435456
    s_mov_b32 s11, 0x00020000
    s_mul_i32 s48, s49, 65536
    s_add_u32 s48, s48, 10616832
    s_lshl_b32 s60, s49, 11
    s_add_u32 s60, s60, 10485760
    s_getreg_b32 s61, hwreg(HW_REG_XCC_ID)
    s_and_b32 s61, s61, 7
    s_cmp_lg_u32 s13, 0
    s_cbranch_scc1 layerb1_kernel_tk_p1
    s_lshl_b32 s63, s61, 8
    s_add_u32 s63, s63, s60
    s_mov_b64 exec, 1
    v_mov_b32 v230, 0
    v_mov_b32 v231, 1
    buffer_atomic_add v231, v230, s[8:11], s63 offen sc0 sc1
    s_mov_b64 exec, -1
layerb1_kernel_tk_p1:
    s_load_dwordx2 s[16:17], s[0:1], 0
    s_add_u32 s28, s4, 247463936
    s_addc_u32 s29, s5, 0
    s_waitcnt lgkmcnt(0)
    s_cmp_eq_u32 s49, 0
    s_cselect_b32 s16, s16, s28
    s_cselect_b32 s17, s17, s29
    s_mov_b32 s18, 2621440
    s_mov_b32 s19, 0x00020000
    s_and_b32 s28, s2, 7
    s_lshr_b32 s29, s2, 3
    s_and_b32 s30, s28, 3
    s_lshl_b32 s30, s30, 2
    s_and_b32 s31, s29, 3
    s_add_u32 s20, s30, s31
    s_lshr_b32 s30, s28, 2
    s_lshl_b32 s30, s30, 3
    s_lshr_b32 s31, s29, 2
    s_add_u32 s21, s30, s31
    s_lshr_b32 s22, s13, 1
    s_and_b32 s23, s13, 1
    s_lshl_b32 s26, s20, 1
    s_add_u32 s26, s26, s23
    s_mov_b32 s27, 0x3f803f80
    s_lshl_b32 s28, s21, 7
    s_lshl_b32 s29, s13, 5
    s_add_u32 s28, s28, s29
    s_mul_i32 s24, s28, 1280
    s_lshl_b32 s28, s20, 1
    s_add_u32 s28, s28, s22
    s_mul_i32 s25, s28, 81920
    s_lshl_b32 s29, s23, 12
    s_add_u32 s25, s25, s29
    s_add_u32 s25, s25, 243269632
    v_lshlrev_b32 v1, 4, v0
    v_lshrrev_b32 v16, 3, v0
    v_mul_u32_u24 v16, 1280, v16
    v_and_b32 v17, 7, v0
    v_lshrrev_b32 v18, 4, v0
    v_xor_b32 v19, v17, v18
    v_lshl_add_u32 v2, v19, 4, v16
    v_xor_b32 v19, 4, v19
    v_lshl_add_u32 v3, v19, 4, v16
    s_lshl_b32 s28, s13, 12
    s_mov_b32 m0, s28
    s_add_u32 s29, s24, 0
    buffer_load_dwordx4 v2, s[16:19], s29 offen offset:0 lds
    s_add_u32 s29, s29, 9216
    buffer_load_dwordx4 v3, s[16:19], s29 offen offset:1024 lds
    s_add_u32 s29, s29, 9216
    buffer_load_dwordx4 v2, s[16:19], s29 offen offset:2048 lds
    s_add_u32 s29, s29, 9216
    buffer_load_dwordx4 v3, s[16:19], s29 offen offset:3072 lds
    s_add_u32 s28, s28, 16384
    s_mov_b32 m0, s28
    s_add_u32 s29, s25, 0
    buffer_load_dwordx4 v1, s[8:11], s29 offen offset:0 lds
    buffer_load_dwordx4 v1, s[8:11], s29 offen offset:1024 lds
    buffer_load_dwordx4 v1, s[8:11], s29 offen offset:2048 lds
    buffer_load_dwordx4 v1, s[8:11], s29 offen offset:3072 lds
    s_lshl_b32 s28, s13, 12
    s_add_u32 s28, s28, 32768
    s_mov_b32 m0, s28
    s_add_u32 s29, s24, 128
    buffer_load_dwordx4 v2, s[16:19], s29 offen offset:0 lds
    s_add_u32 s29, s29, 9216
    buffer_load_dwordx4 v3, s[16:19], s29 offen offset:1024 lds
    s_add_u32 s29, s29, 9216
    buffer_load_dwordx4 v2, s[16:19], s29 offen offset:2048 lds
    s_add_u32 s29, s29, 9216
    buffer_load_dwordx4 v3, s[16:19], s29 offen offset:3072 lds
    s_add_u32 s28, s28, 16384
    s_mov_b32 m0, s28
    s_add_u32 s29, s25, 8192
    buffer_load_dwordx4 v1, s[8:11], s29 offen offset:0 lds
    buffer_load_dwordx4 v1, s[8:11], s29 offen offset:1024 lds
    buffer_load_dwordx4 v1, s[8:11], s29 offen offset:2048 lds
    buffer_load_dwordx4 v1, s[8:11], s29 offen offset:3072 lds
    s_lshl_b32 s28, s13, 12
    s_add_u32 s28, s28, 65536
    s_mov_b32 m0, s28
    s_add_u32 s29, s24, 256
    buffer_load_dwordx4 v2, s[16:19], s29 offen offset:0 lds
    s_add_u32 s29, s29, 9216
    buffer_load_dwordx4 v3, s[16:19], s29 offen offset:1024 lds
    s_add_u32 s29, s29, 9216
    buffer_load_dwordx4 v2, s[16:19], s29 offen offset:2048 lds
    s_add_u32 s29, s29, 9216
    buffer_load_dwordx4 v3, s[16:19], s29 offen offset:3072 lds
    s_add_u32 s28, s28, 16384
    s_mov_b32 m0, s28
    s_add_u32 s29, s25, 16384
    buffer_load_dwordx4 v1, s[8:11], s29 offen offset:0 lds
    buffer_load_dwordx4 v1, s[8:11], s29 offen offset:1024 lds
    buffer_load_dwordx4 v1, s[8:11], s29 offen offset:2048 lds
    buffer_load_dwordx4 v1, s[8:11], s29 offen offset:3072 lds
    s_cmp_lg_u32 s13, 0
    s_cbranch_scc1 layerb1_kernel_tk_wait
    s_waitcnt vmcnt(24)
    s_nop 0
    v_readfirstlane_b32 s62, v231
    s_cmp_lt_u32 s62, 32
    s_cbranch_scc1 layerb1_kernel_tk_pub
    v_lshlrev_b32 v230, 8, v0
    v_and_b32 v230, 0x7ff, v230
    s_mov_b32 s63, s60
layerb1_kernel_tk_poll:
    buffer_load_dword v231, v230, s[8:11], s63 offen sc1
    s_waitcnt vmcnt(0)
    s_mov_b32 s64, 0
    v_readlane_b32 s65, v231, 0
    s_nop 0
    s_add_u32 s64, s64, s65
    v_readlane_b32 s66, v231, 1
    s_nop 0
    s_add_u32 s64, s64, s66
    v_readlane_b32 s67, v231, 2
    s_nop 0
    s_add_u32 s64, s64, s67
    v_readlane_b32 s68, v231, 3
    s_nop 0
    s_add_u32 s64, s64, s68
    v_readlane_b32 s69, v231, 4
    s_nop 0
    s_add_u32 s64, s64, s69
    v_readlane_b32 s70, v231, 5
    s_nop 0
    s_add_u32 s64, s64, s70
    v_readlane_b32 s71, v231, 6
    s_nop 0
    s_add_u32 s64, s64, s71
    v_readlane_b32 s72, v231, 7
    s_nop 0
    s_add_u32 s64, s64, s72
    s_sub_u32 s15, s15, 1
    s_cbranch_scc1 layerb1_kernel_bail
    s_cmp_lt_u32 s64, 256
    s_cbranch_scc1 layerb1_kernel_tk_poll
    s_sub_u32 s62, s62, 32
    s_max_u32 s64, s65, 32
    s_sub_u32 s64, s64, 32
    s_cmp_gt_u32 s61, 0
    s_cselect_b32 s64, s64, 0
    s_add_u32 s62, s62, s64
    s_max_u32 s64, s66, 32
    s_sub_u32 s64, s64, 32
    s_cmp_gt_u32 s61, 1
    s_cselect_b32 s64, s64, 0
    s_add_u32 s62, s62, s64
    s_max_u32 s64, s67, 32
    s_sub_u32 s64, s64, 32
    s_cmp_gt_u32 s61, 2
    s_cselect_b32 s64, s64, 0
    s_add_u32 s62, s62, s64
    s_max_u32 s64, s68, 32
    s_sub_u32 s64, s64, 32
    s_cmp_gt_u32 s61, 3
    s_cselect_b32 s64, s64, 0
    s_add_u32 s62, s62, s64
    s_max_u32 s64, s69, 32
    s_sub_u32 s64, s64, 32
    s_cmp_gt_u32 s61, 4
    s_cselect_b32 s64, s64, 0
    s_add_u32 s62, s62, s64
    s_max_u32 s64, s70, 32
    s_sub_u32 s64, s64, 32
    s_cmp_gt_u32 s61, 5
    s_cselect_b32 s64, s64, 0
    s_add_u32 s62, s62, s64
    s_max_u32 s64, s71, 32
    s_sub_u32 s64, s64, 32
    s_cmp_gt_u32 s61, 6
    s_cselect_b32 s64, s64, 0
    s_add_u32 s62, s62, s64
    s_min_u32 s64, s65, 32
    s_sub_u32 s63, 32, s64
    s_cmp_lt_u32 s62, s63
    s_cbranch_scc0 layerb1_kernel_tk_n0
    s_mov_b32 s61, 0
    s_add_u32 s62, s62, s64
    s_branch layerb1_kernel_tk_pub
layerb1_kernel_tk_n0:
    s_sub_u32 s62, s62, s63
    s_min_u32 s64, s66, 32
    s_sub_u32 s63, 32, s64
    s_cmp_lt_u32 s62, s63
    s_cbranch_scc0 layerb1_kernel_tk_n1
    s_mov_b32 s61, 1
    s_add_u32 s62, s62, s64
    s_branch layerb1_kernel_tk_pub
layerb1_kernel_tk_n1:
    s_sub_u32 s62, s62, s63
    s_min_u32 s64, s67, 32
    s_sub_u32 s63, 32, s64
    s_cmp_lt_u32 s62, s63
    s_cbranch_scc0 layerb1_kernel_tk_n2
    s_mov_b32 s61, 2
    s_add_u32 s62, s62, s64
    s_branch layerb1_kernel_tk_pub
layerb1_kernel_tk_n2:
    s_sub_u32 s62, s62, s63
    s_min_u32 s64, s68, 32
    s_sub_u32 s63, 32, s64
    s_cmp_lt_u32 s62, s63
    s_cbranch_scc0 layerb1_kernel_tk_n3
    s_mov_b32 s61, 3
    s_add_u32 s62, s62, s64
    s_branch layerb1_kernel_tk_pub
layerb1_kernel_tk_n3:
    s_sub_u32 s62, s62, s63
    s_min_u32 s64, s69, 32
    s_sub_u32 s63, 32, s64
    s_cmp_lt_u32 s62, s63
    s_cbranch_scc0 layerb1_kernel_tk_n4
    s_mov_b32 s61, 4
    s_add_u32 s62, s62, s64
    s_branch layerb1_kernel_tk_pub
layerb1_kernel_tk_n4:
    s_sub_u32 s62, s62, s63
    s_min_u32 s64, s70, 32
    s_sub_u32 s63, 32, s64
    s_cmp_lt_u32 s62, s63
    s_cbranch_scc0 layerb1_kernel_tk_n5
    s_mov_b32 s61, 5
    s_add_u32 s62, s62, s64
    s_branch layerb1_kernel_tk_pub
layerb1_kernel_tk_n5:
    s_sub_u32 s62, s62, s63
    s_min_u32 s64, s71, 32
    s_sub_u32 s63, 32, s64
    s_cmp_lt_u32 s62, s63
    s_cbranch_scc0 layerb1_kernel_tk_n6
    s_mov_b32 s61, 6
    s_add_u32 s62, s62, s64
    s_branch layerb1_kernel_tk_pub
layerb1_kernel_tk_n6:
    s_sub_u32 s62, s62, s63
    s_min_u32 s64, s72, 32
    s_sub_u32 s63, 32, s64
    s_cmp_lt_u32 s62, s63
    s_cbranch_scc0 layerb1_kernel_tk_n7
    s_mov_b32 s61, 7
    s_add_u32 s62, s62, s64
    s_branch layerb1_kernel_tk_pub
layerb1_kernel_tk_n7:
    s_sub_u32 s62, s62, s63
    s_branch layerb1_kernel_bail
layerb1_kernel_tk_pub:
    s_lshl_b32 s63, s61, 8
    s_or_b32 s63, s63, s62
    v_mov_b32 v230, 131136
    v_mov_b32 v231, s63
    ds_write_b32 v230, v231
    s_waitcnt lgkmcnt(0)
layerb1_kernel_tk_wait:
    s_barrier
    v_mov_b32 v230, 131136
    ds_read_b32 v231, v230
    s_waitcnt lgkmcnt(0)
    v_readfirstlane_b32 s63, v231
    s_lshr_b32 s61, s63, 8
    s_and_b32 s62, s63, 255
    s_mov_b32 s98, s61
    s_mov_b32 s99, s62
    v_lshlrev_b32 v240, 4, v0
    v_mov_b32 v241, v240
    s_mov_b32 s50, 0x3020100
    s_mov_b32 s51, 0x7060504
    s_mov_b32 s52, 0xb0a0908
    s_mov_b32 s53, 0xf0e0d0c
    s_mov_b32 s54, 0x13121110
    s_mov_b32 s55, 0x17161514
    s_mov_b32 s56, 0x1b1a1918
    s_mov_b32 s57, 0x1f1e1d1c
    s_mov_b32 s40, 2048
    s_mov_b32 s44, 0
    s_cmp_eq_u32 s98, 0
    s_cbranch_scc1 layerb1_kernel_pf_p
    s_cmp_ge_u32 s98, 4
    s_cbranch_scc1 layerb1_kernel_pf_g
    s_sub_u32 s60, s98, 1
    s_cmp_ge_u32 s99, 27
    s_cbranch_scc1 layerb1_kernel_pf_sp
    s_mul_i32 s61, s60, 27
    s_add_u32 s61, s61, s99
    s_cmp_ge_u32 s61, 80
    s_cbranch_scc1 layerb1_kernel_pf_no
    s_mul_i32 s61, s61, 327680
    s_mul_i32 s62, s13, 81920
    s_add_u32 s61, s61, s62
    s_add_u32 s58, s61, 27262976
    s_add_u32 s59, s58, 1024
    s_branch layerb1_kernel_pf_done
layerb1_kernel_pf_sp:
    s_mul_i32 s61, s60, 5
    s_add_u32 s61, s61, s99
    s_sub_u32 s61, s61, 27
    s_cmp_lt_u32 s61, 5
    s_cbranch_scc0 layerb1_kernel_pf_no
    s_mov_b32 s44, 1
    s_lshl_b32 s61, s61, 2
    s_add_u32 s61, s61, s13
    s_mul_i32 s61, s61, 40960
    s_add_u32 s58, s61, 246415360
    s_add_u32 s59, s58, 1024
    s_branch layerb1_kernel_pf_done
layerb1_kernel_pf_no:
    s_mov_b32 s44, 2
    s_mov_b32 s58, 27262976
    s_mov_b32 s59, 27262976
    s_mov_b32 s40, 0
    s_branch layerb1_kernel_pf_done
layerb1_kernel_pf_p:
    s_mul_i32 s61, s99, 491520
    s_mul_i32 s62, s13, 122880
    s_add_u32 s61, s61, s62
    s_add_u32 s58, s61, 11534336
    s_add_u32 s59, s58, 1024
    s_cmp_lg_u32 s13, 0
    s_cbranch_scc1 layerb1_kernel_pf_pw0
    s_mov_b32 s50, 0xb140a00
    s_mov_b32 s51, 0x1e160215
    s_mov_b32 s52, 0x605041f
    s_mov_b32 s53, 0xf0d0908
    s_mov_b32 s54, 0x17131110
    s_mov_b32 s55, 0x1c1b1a18
    s_mov_b32 s56, 0x25232221
    s_mov_b32 s57, 0x2c2b2726
    s_branch layerb1_kernel_pf_done
layerb1_kernel_pf_pw0:
    s_cmp_lg_u32 s13, 1
    s_cbranch_scc1 layerb1_kernel_pf_pw1
    s_mov_b32 s50, 0xe170d03
    s_mov_b32 s51, 0x21190518
    s_mov_b32 s52, 0x6020122
    s_mov_b32 s53, 0xc0a0908
    s_mov_b32 s54, 0x14131110
    s_mov_b32 s55, 0x1c1b1a15
    s_mov_b32 s56, 0x25201f1e
    s_mov_b32 s57, 0x29282726
    s_branch layerb1_kernel_pf_done
layerb1_kernel_pf_pw1:
    s_cmp_lg_u32 s13, 2
    s_cbranch_scc1 layerb1_kernel_pf_pw2
    s_mov_b32 s50, 0x111a1006
    s_mov_b32 s51, 0x2f2e241b
    s_mov_b32 s52, 0x3020138
    s_mov_b32 s53, 0xb090805
    s_mov_b32 s54, 0x120f0d0c
    s_mov_b32 s55, 0x17161513
    s_mov_b32 s56, 0x1f1d1c19
    s_mov_b32 s57, 0x26232120
    s_branch layerb1_kernel_pf_done
layerb1_kernel_pf_pw2:
    s_mov_b32 s50, 0x131c1208
    s_mov_b32 s51, 0x3130261d
    s_mov_b32 s52, 0x302013a
    s_mov_b32 s53, 0xb070605
    s_mov_b32 s54, 0x100f0d0c
    s_mov_b32 s55, 0x17161511
    s_mov_b32 s56, 0x1f1b1a19
    s_mov_b32 s57, 0x24232120
    s_branch layerb1_kernel_pf_done
layerb1_kernel_pf_g:
    s_sub_u32 s60, s98, 4
    s_lshl_b32 s60, s60, 5
    s_add_u32 s60, s60, s99
    s_mov_b32 s40, 512
    v_and_b32 v230, 31, v0
    v_lshrrev_b32 v231, 5, v0
    s_cmp_ge_u32 s60, 80
    s_cbranch_scc1 layerb1_kernel_pf_qk
    v_lshrrev_b32 v232, 3, v230
    v_and_b32 v233, 7, v230
    v_mul_u32_u24 v234, 20480, v232
    v_lshl_add_u32 v234, v233, 4, v234
    v_lshl_add_u32 v240, v231, 8, v234
    s_mul_i32 s61, s60, 327680
    s_mul_i32 s62, s13, 81920
    s_add_u32 s61, s61, s62
    s_add_u32 s58, s61, 27262976
    v_mov_b32 v241, v240
    s_add_u32 s59, s58, 128
    s_branch layerb1_kernel_pf_done
layerb1_kernel_pf_qk:
    s_sub_u32 s61, s60, 80
    s_cmp_ge_u32 s61, 24
    s_cselect_b32 s62, 1, 0
    s_cselect_b32 s63, 24, 0
    s_sub_u32 s61, s61, s63
    s_lshl_b32 s61, s61, 3
    s_lshl_b32 s63, s13, 1
    s_add_u32 s61, s61, s63
    s_add_u32 s63, s61, 0
    s_mul_i32 s64, s63, 171
    s_lshr_b32 s64, s64, 10
    s_mul_i32 s65, s64, 6
    s_sub_u32 s65, s63, s65
    s_lshl_b32 s65, s65, 5
    v_add_u32 v232, s65, v230
    v_and_b32 v233, 0xc1, v232
    v_and_b32 v234, 8, v232
    v_lshl_or_b32 v233, v234, 2, v233
    v_and_b32 v234, 32, v232
    v_lshrrev_b32 v234, 1, v234
    v_or_b32 v233, v233, v234
    v_and_b32 v234, 2, v232
    v_lshl_or_b32 v233, v234, 2, v233
    v_and_b32 v234, 16, v232
    v_lshrrev_b32 v234, 2, v234
    v_or_b32 v233, v233, v234
    v_and_b32 v234, 4, v232
    v_lshrrev_b32 v234, 1, v234
    v_or_b32 v233, v233, v234
    s_cmp_eq_u32 s62, 1
    s_cselect_b64 vcc, -1, 0
    s_nop 1
    v_cndmask_b32 v232, v232, v233, vcc
    v_lshrrev_b32 v234, 4, v232
    v_and_b32 v235, 3, v234
    v_mul_u32_u24 v235, 6, v235
    v_lshrrev_b32 v234, 2, v234
    v_add_u32 v234, v234, v235
    v_mul_u32_u24 v234, 20480, v234
    v_and_b32 v235, 15, v232
    v_lshl_add_u32 v233, v235, 4, v234
    v_lshl_add_u32 v240, v231, 8, v233
    s_xor_b32 s65, s62, 1
    s_mul_i32 s65, s65, 61440
    s_mul_i32 s66, s64, 491520
    s_add_u32 s65, s65, s66
    s_add_u32 s58, s65, 11534336
    s_add_u32 s63, s61, 1
    s_mul_i32 s64, s63, 171
    s_lshr_b32 s64, s64, 10
    s_mul_i32 s65, s64, 6
    s_sub_u32 s65, s63, s65
    s_lshl_b32 s65, s65, 5
    v_add_u32 v232, s65, v230
    v_and_b32 v233, 0xc1, v232
    v_and_b32 v234, 8, v232
    v_lshl_or_b32 v233, v234, 2, v233
    v_and_b32 v234, 32, v232
    v_lshrrev_b32 v234, 1, v234
    v_or_b32 v233, v233, v234
    v_and_b32 v234, 2, v232
    v_lshl_or_b32 v233, v234, 2, v233
    v_and_b32 v234, 16, v232
    v_lshrrev_b32 v234, 2, v234
    v_or_b32 v233, v233, v234
    v_and_b32 v234, 4, v232
    v_lshrrev_b32 v234, 1, v234
    v_or_b32 v233, v233, v234
    s_cmp_eq_u32 s62, 1
    s_cselect_b64 vcc, -1, 0
    s_nop 1
    v_cndmask_b32 v232, v232, v233, vcc
    v_lshrrev_b32 v234, 4, v232
    v_and_b32 v235, 3, v234
    v_mul_u32_u24 v235, 6, v235
    v_lshrrev_b32 v234, 2, v234
    v_add_u32 v234, v234, v235
    v_mul_u32_u24 v234, 20480, v234
    v_and_b32 v235, 15, v232
    v_lshl_add_u32 v233, v235, 4, v234
    v_lshl_add_u32 v241, v231, 8, v233
    s_xor_b32 s65, s62, 1
    s_mul_i32 s65, s65, 61440
    s_mul_i32 s66, s64, 491520
    s_add_u32 s65, s65, s66
    s_add_u32 s59, s65, 11534336
layerb1_kernel_pf_done:
    v_and_b32 v16, 31, v0
    v_lshrrev_b32 v17, 5, v0
    v_lshrrev_b32 v18, 1, v16
    v_and_b32 v18, 7, v18
    v_xor_b32 v18, v18, v17
    v_lshlrev_b32 v18, 4, v18
    v_lshl_add_u32 v18, v16, 7, v18
    s_lshl_b32 s28, s22, 13
    v_add_u32 v18, s28, v18
    v_xor_b32 v6, 0, v18
    v_add_u32 v10, 65536, v6
    v_xor_b32 v7, 32, v18
    v_add_u32 v11, 65536, v7
    v_xor_b32 v8, 64, v18
    v_add_u32 v12, 65536, v8
    v_xor_b32 v9, 96, v18
    v_add_u32 v13, 65536, v9
    s_lshl_b32 s28, s23, 13
    s_add_u32 s28, s28, 16384
    v_add_u32 v4, s28, v1
    v_add_u32 v5, 65536, v4
    v_mov_b32 v20, 0
    v_mov_b32 v21, 0
    v_mov_b32 v22, 0
    v_mov_b32 v23, 0
    s_waitcnt vmcnt(16)
    s_barrier
    ds_read_b128 v[32:35], v6 offset:0
    ds_read_b128 v[36:39], v6 offset:4096
    ds_read_b128 v[40:43], v4 offset:0
    ds_read_b128 v[44:47], v4 offset:1024
    s_cmp_eq_u32 s23, 1
    s_cbranch_scc1 layerb1_kernel_af_h1
    s_waitcnt lgkmcnt(0)
    v_mfma_f32_32x32x16_bf16 v[64:79], v[32:35], v[40:43], 0
    v_mfma_f32_4x4x4_16b_bf16 v[20:23], v[32:33], v[32:33], v[20:23]
    v_mfma_f32_32x32x16_bf16 v[96:111], v[32:35], v[44:47], 0
    ds_read_b128 v[48:51], v7 offset:0
    v_mfma_f32_32x32x16_bf16 v[128:143], v[44:47], v[32:35], 0
    ds_read_b128 v[52:55], v7 offset:4096
    v_mfma_f32_32x32x16_bf16 v[80:95], v[36:39], v[40:43], 0
    ds_read_b128 v[56:59], v4 offset:2048
    v_mfma_f32_32x32x16_bf16 v[112:127], v[36:39], v[44:47], 0
    v_mfma_f32_4x4x4_16b_bf16 v[20:23], v[34:35], v[34:35], v[20:23]
    ds_read_b128 v[60:63], v4 offset:3072
    v_mfma_f32_32x32x16_bf16 v[144:159], v[44:47], v[36:39], 0
    s_waitcnt lgkmcnt(0)
    v_mfma_f32_32x32x16_bf16 v[64:79], v[48:51], v[56:59], v[64:79]
    v_mfma_f32_4x4x4_16b_bf16 v[20:23], v[48:49], v[48:49], v[20:23]
    v_mfma_f32_32x32x16_bf16 v[96:111], v[48:51], v[60:63], v[96:111]
    ds_read_b128 v[32:35], v8 offset:0
    v_mfma_f32_32x32x16_bf16 v[128:143], v[60:63], v[48:51], v[128:143]
    ds_read_b128 v[36:39], v8 offset:4096
    v_mfma_f32_32x32x16_bf16 v[80:95], v[52:55], v[56:59], v[80:95]
    ds_read_b128 v[40:43], v4 offset:4096
    v_mfma_f32_32x32x16_bf16 v[112:127], v[52:55], v[60:63], v[112:127]
    v_mfma_f32_4x4x4_16b_bf16 v[20:23], v[50:51], v[50:51], v[20:23]
    ds_read_b128 v[44:47], v4 offset:5120
    v_mfma_f32_32x32x16_bf16 v[144:159], v[60:63], v[52:55], v[144:159]
    s_waitcnt lgkmcnt(0)
    v_mfma_f32_32x32x16_bf16 v[64:79], v[32:35], v[40:43], v[64:79]
    v_mfma_f32_4x4x4_16b_bf16 v[20:23], v[32:33], v[32:33], v[20:23]
    v_mfma_f32_32x32x16_bf16 v[96:111], v[32:35], v[44:47], v[96:111]
    ds_read_b128 v[48:51], v9 offset:0
    v_mfma_f32_32x32x16_bf16 v[128:143], v[44:47], v[32:35], v[128:143]
    ds_read_b128 v[52:55], v9 offset:4096
    v_mfma_f32_32x32x16_bf16 v[80:95], v[36:39], v[40:43], v[80:95]
    ds_read_b128 v[56:59], v4 offset:6144
    v_mfma_f32_32x32x16_bf16 v[112:127], v[36:39], v[44:47], v[112:127]
    v_mfma_f32_4x4x4_16b_bf16 v[20:23], v[34:35], v[34:35], v[20:23]
    ds_read_b128 v[60:63], v4 offset:7168
    v_mfma_f32_32x32x16_bf16 v[144:159], v[44:47], v[36:39], v[144:159]
    s_waitcnt vmcnt(8)
    s_barrier
    s_waitcnt lgkmcnt(0)
    v_mfma_f32_32x32x16_bf16 v[64:79], v[48:51], v[56:59], v[64:79]
    v_mfma_f32_4x4x4_16b_bf16 v[20:23], v[48:49], v[48:49], v[20:23]
    s_lshl_b32 s28, s13, 12
    s_add_u32 s28, s28, 98304
    s_mov_b32 m0, s28
    s_add_u32 s29, s24, 384
    buffer_load_dwordx4 v2, s[16:19], s29 offen offset:0 lds
    v_mfma_f32_32x32x16_bf16 v[96:111], v[48:51], v[60:63], v[96:111]
    ds_read_b128 v[32:35], v6 offset:32768
    s_add_u32 s29, s29, 9216
    buffer_load_dwordx4 v3, s[16:19], s29 offen offset:1024 lds
    v_mfma_f32_32x32x16_bf16 v[128:143], v[60:63], v[48:51], v[128:143]
    ds_read_b128 v[36:39], v6 offset:36864
    s_add_u32 s29, s29, 9216
    buffer_load_dwordx4 v2, s[16:19], s29 offen offset:2048 lds
    v_mfma_f32_32x32x16_bf16 v[80:95], v[52:55], v[56:59], v[80:95]
    ds_read_b128 v[40:43], v4 offset:32768
    s_add_u32 s29, s29, 9216
    buffer_load_dwordx4 v3, s[16:19], s29 offen offset:3072 lds
    v_mfma_f32_32x32x16_bf16 v[112:127], v[52:55], v[60:63], v[112:127]
    v_mfma_f32_4x4x4_16b_bf16 v[20:23], v[50:51], v[50:51], v[20:23]
    ds_read_b128 v[44:47], v4 offset:33792
    s_add_u32 s28, s28, 16384
    s_mov_b32 m0, s28
    s_add_u32 s29, s25, 24576
    buffer_load_dwordx4 v1, s[8:11], s29 offen offset:0 lds
    v_mfma_f32_32x32x16_bf16 v[144:159], v[60:63], v[52:55], v[144:159]
    buffer_load_dwordx4 v1, s[8:11], s29 offen offset:1024 lds
    s_waitcnt lgkmcnt(0)
    v_mfma_f32_32x32x16_bf16 v[64:79], v[32:35], v[40:43], v[64:79]
    v_mfma_f32_4x4x4_16b_bf16 v[20:23], v[32:33], v[32:33], v[20:23]
    buffer_load_dwordx4 v1, s[8:11], s29 offen offset:2048 lds
    v_mfma_f32_32x32x16_bf16 v[96:111], v[32:35], v[44:47], v[96:111]
    ds_read_b128 v[48:51], v7 offset:32768
    buffer_load_dwordx4 v1, s[8:11], s29 offen offset:3072 lds
    v_mfma_f32_32x32x16_bf16 v[128:143], v[44:47], v[32:35], v[128:143]
    ds_read_b128 v[52:55], v7 offset:36864
    s_bfe_u32 s41, s50, 524288
    s_mul_i32 s41, s41, s40
    s_add_u32 s42, s58, s41
    s_add_u32 s43, s59, s41
    buffer_load_dwordx4 a[0:3], v240, s[8:11], s42 offen
    v_mfma_f32_32x32x16_bf16 v[80:95], v[36:39], v[40:43], v[80:95]
    ds_read_b128 v[56:59], v4 offset:34816
    buffer_load_dwordx4 a[4:7], v241, s[8:11], s43 offen
    v_mfma_f32_32x32x16_bf16 v[112:127], v[36:39], v[44:47], v[112:127]
    v_mfma_f32_4x4x4_16b_bf16 v[20:23], v[34:35], v[34:35], v[20:23]
    ds_read_b128 v[60:63], v4 offset:35840
    s_bfe_u32 s41, s50, 524296
    s_mul_i32 s41, s41, s40
    s_add_u32 s42, s58, s41
    s_add_u32 s43, s59, s41
    buffer_load_dwordx4 a[8:11], v240, s[8:11], s42 offen
    v_mfma_f32_32x32x16_bf16 v[144:159], v[44:47], v[36:39], v[144:159]
    buffer_load_dwordx4 a[12:15], v241, s[8:11], s43 offen
    s_waitcnt lgkmcnt(0)
    v_mfma_f32_32x32x16_bf16 v[64:79], v[48:51], v[56:59], v[64:79]
    v_mfma_f32_4x4x4_16b_bf16 v[20:23], v[48:49], v[48:49], v[20:23]
    v_mfma_f32_32x32x16_bf16 v[96:111], v[48:51], v[60:63], v[96:111]
    ds_read_b128 v[32:35], v8 offset:32768
    v_mfma_f32_32x32x16_bf16 v[128:143], v[60:63], v[48:51], v[128:143]
    ds_read_b128 v[36:39], v8 offset:36864
    v_mfma_f32_32x32x16_bf16 v[80:95], v[52:55], v[56:59], v[80:95]
    ds_read_b128 v[40:43], v4 offset:36864
    v_mfma_f32_32x32x16_bf16 v[112:127], v[52:55], v[60:63], v[112:127]
    v_mfma_f32_4x4x4_16b_bf16 v[20:23], v[50:51], v[50:51], v[20:23]
    ds_read_b128 v[44:47], v4 offset:37888
    v_mfma_f32_32x32x16_bf16 v[144:159], v[60:63], v[52:55], v[144:159]
    s_waitcnt lgkmcnt(0)
    v_mfma_f32_32x32x16_bf16 v[64:79], v[32:35], v[40:43], v[64:79]
    v_mfma_f32_4x4x4_16b_bf16 v[20:23], v[32:33], v[32:33], v[20:23]
    v_mfma_f32_32x32x16_bf16 v[96:111], v[32:35], v[44:47], v[96:111]
    ds_read_b128 v[48:51], v9 offset:32768
    v_mfma_f32_32x32x16_bf16 v[128:143], v[44:47], v[32:35], v[128:143]
    ds_read_b128 v[52:55], v9 offset:36864
    v_mfma_f32_32x32x16_bf16 v[80:95], v[36:39], v[40:43], v[80:95]
    ds_read_b128 v[56:59], v4 offset:38912
    v_mfma_f32_32x32x16_bf16 v[112:127], v[36:39], v[44:47], v[112:127]
    v_mfma_f32_4x4x4_16b_bf16 v[20:23], v[34:35], v[34:35], v[20:23]
    ds_read_b128 v[60:63], v4 offset:39936
    v_mfma_f32_32x32x16_bf16 v[144:159], v[44:47], v[36:39], v[144:159]
    s_waitcnt vmcnt(12)
    s_barrier
    s_waitcnt lgkmcnt(0)
    v_mfma_f32_32x32x16_bf16 v[64:79], v[48:51], v[56:59], v[64:79]
    v_mfma_f32_4x4x4_16b_bf16 v[20:23], v[48:49], v[48:49], v[20:23]
    s_lshl_b32 s28, s13, 12
    s_mov_b32 m0, s28
    s_add_u32 s29, s24, 512
    buffer_load_dwordx4 v2, s[16:19], s29 offen offset:0 lds
    v_mfma_f32_32x32x16_bf16 v[96:111], v[48:51], v[60:63], v[96:111]
    ds_read_b128 v[32:35], v10 offset:0
    s_add_u32 s29, s29, 9216
    buffer_load_dwordx4 v3, s[16:19], s29 offen offset:1024 lds
    v_mfma_f32_32x32x16_bf16 v[128:143], v[60:63], v[48:51], v[128:143]
    ds_read_b128 v[36:39], v10 offset:4096
    s_add_u32 s29, s29, 9216
    buffer_load_dwordx4 v2, s[16:19], s29 offen offset:2048 lds
    v_mfma_f32_32x32x16_bf16 v[80:95], v[52:55], v[56:59], v[80:95]
    ds_read_b128 v[40:43], v5 offset:0
    s_add_u32 s29, s29, 9216
    buffer_load_dwordx4 v3, s[16:19], s29 offen offset:3072 lds
    v_mfma_f32_32x32x16_bf16 v[112:127], v[52:55], v[60:63], v[112:127]
    v_mfma_f32_4x4x4_16b_bf16 v[20:23], v[50:51], v[50:51], v[20:23]
    ds_read_b128 v[44:47], v5 offset:1024
    s_add_u32 s28, s28, 16384
    s_mov_b32 m0, s28
    s_add_u32 s29, s25, 32768
    buffer_load_dwordx4 v1, s[8:11], s29 offen offset:0 lds
    v_mfma_f32_32x32x16_bf16 v[144:159], v[60:63], v[52:55], v[144:159]
    buffer_load_dwordx4 v1, s[8:11], s29 offen offset:1024 lds
    s_waitcnt lgkmcnt(0)
    v_mfma_f32_32x32x16_bf16 v[64:79], v[32:35], v[40:43], v[64:79]
    v_mfma_f32_4x4x4_16b_bf16 v[20:23], v[32:33], v[32:33], v[20:23]
    buffer_load_dwordx4 v1, s[8:11], s29 offen offset:2048 lds
    v_mfma_f32_32x32x16_bf16 v[96:111], v[32:35], v[44:47], v[96:111]
    ds_read_b128 v[48:51], v11 offset:0
    buffer_load_dwordx4 v1, s[8:11], s29 offen offset:3072 lds
    v_mfma_f32_32x32x16_bf16 v[128:143], v[44:47], v[32:35], v[128:143]
    ds_read_b128 v[52:55], v11 offset:4096
    s_bfe_u32 s41, s50, 524304
    s_mul_i32 s41, s41, s40
    s_add_u32 s42, s58, s41
    s_add_u32 s43, s59, s41
    buffer_load_dwordx4 a[16:19], v240, s[8:11], s42 offen
    v_mfma_f32_32x32x16_bf16 v[80:95], v[36:39], v[40:43], v[80:95]
    ds_read_b128 v[56:59], v5 offset:2048
    buffer_load_dwordx4 a[20:23], v241, s[8:11], s43 offen
    v_mfma_f32_32x32x16_bf16 v[112:127], v[36:39], v[44:47], v[112:127]
    v_mfma_f32_4x4x4_16b_bf16 v[20:23], v[34:35], v[34:35], v[20:23]
    ds_read_b128 v[60:63], v5 offset:3072
    s_bfe_u32 s41, s50, 524312
    s_mul_i32 s41, s41, s40
    s_add_u32 s42, s58, s41
    s_add_u32 s43, s59, s41
    buffer_load_dwordx4 a[24:27], v240, s[8:11], s42 offen
    v_mfma_f32_32x32x16_bf16 v[144:159], v[44:47], v[36:39], v[144:159]
    buffer_load_dwordx4 a[28:31], v241, s[8:11], s43 offen
    s_waitcnt lgkmcnt(0)
    v_mfma_f32_32x32x16_bf16 v[64:79], v[48:51], v[56:59], v[64:79]
    v_mfma_f32_4x4x4_16b_bf16 v[20:23], v[48:49], v[48:49], v[20:23]
    v_mfma_f32_32x32x16_bf16 v[96:111], v[48:51], v[60:63], v[96:111]
    ds_read_b128 v[32:35], v12 offset:0
    v_mfma_f32_32x32x16_bf16 v[128:143], v[60:63], v[48:51], v[128:143]
    ds_read_b128 v[36:39], v12 offset:4096
    v_mfma_f32_32x32x16_bf16 v[80:95], v[52:55], v[56:59], v[80:95]
    ds_read_b128 v[40:43], v5 offset:4096
    v_mfma_f32_32x32x16_bf16 v[112:127], v[52:55], v[60:63], v[112:127]
    v_mfma_f32_4x4x4_16b_bf16 v[20:23], v[50:51], v[50:51], v[20:23]
    ds_read_b128 v[44:47], v5 offset:5120
    v_mfma_f32_32x32x16_bf16 v[144:159], v[60:63], v[52:55], v[144:159]
    s_waitcnt lgkmcnt(0)
    v_mfma_f32_32x32x16_bf16 v[64:79], v[32:35], v[40:43], v[64:79]
    v_mfma_f32_4x4x4_16b_bf16 v[20:23], v[32:33], v[32:33], v[20:23]
    v_mfma_f32_32x32x16_bf16 v[96:111], v[32:35], v[44:47], v[96:111]
    ds_read_b128 v[48:51], v13 offset:0
    v_mfma_f32_32x32x16_bf16 v[128:143], v[44:47], v[32:35], v[128:143]
    ds_read_b128 v[52:55], v13 offset:4096
    v_mfma_f32_32x32x16_bf16 v[80:95], v[36:39], v[40:43], v[80:95]
    ds_read_b128 v[56:59], v5 offset:6144
    v_mfma_f32_32x32x16_bf16 v[112:127], v[36:39], v[44:47], v[112:127]
    v_mfma_f32_4x4x4_16b_bf16 v[20:23], v[34:35], v[34:35], v[20:23]
    ds_read_b128 v[60:63], v5 offset:7168
    v_mfma_f32_32x32x16_bf16 v[144:159], v[44:47], v[36:39], v[144:159]
    s_waitcnt vmcnt(16)
    s_barrier
    s_waitcnt lgkmcnt(0)
    v_mfma_f32_32x32x16_bf16 v[64:79], v[48:51], v[56:59], v[64:79]
    v_mfma_f32_4x4x4_16b_bf16 v[20:23], v[48:49], v[48:49], v[20:23]
    s_lshl_b32 s28, s13, 12
    s_add_u32 s28, s28, 32768
    s_mov_b32 m0, s28
    s_add_u32 s29, s24, 640
    buffer_load_dwordx4 v2, s[16:19], s29 offen offset:0 lds
    v_mfma_f32_32x32x16_bf16 v[96:111], v[48:51], v[60:63], v[96:111]
    ds_read_b128 v[32:35], v10 offset:32768
    s_add_u32 s29, s29, 9216
    buffer_load_dwordx4 v3, s[16:19], s29 offen offset:1024 lds
    v_mfma_f32_32x32x16_bf16 v[128:143], v[60:63], v[48:51], v[128:143]
    ds_read_b128 v[36:39], v10 offset:36864
    s_add_u32 s29, s29, 9216
    buffer_load_dwordx4 v2, s[16:19], s29 offen offset:2048 lds
    v_mfma_f32_32x32x16_bf16 v[80:95], v[52:55], v[56:59], v[80:95]
    ds_read_b128 v[40:43], v5 offset:32768
    s_add_u32 s29, s29, 9216
    buffer_load_dwordx4 v3, s[16:19], s29 offen offset:3072 lds
    v_mfma_f32_32x32x16_bf16 v[112:127], v[52:55], v[60:63], v[112:127]
    v_mfma_f32_4x4x4_16b_bf16 v[20:23], v[50:51], v[50:51], v[20:23]
    ds_read_b128 v[44:47], v5 offset:33792
    s_add_u32 s28, s28, 16384
    s_mov_b32 m0, s28
    s_add_u32 s29, s25, 40960
    buffer_load_dwordx4 v1, s[8:11], s29 offen offset:0 lds
    v_mfma_f32_32x32x16_bf16 v[144:159], v[60:63], v[52:55], v[144:159]
    buffer_load_dwordx4 v1, s[8:11], s29 offen offset:1024 lds
    s_waitcnt lgkmcnt(0)
    v_mfma_f32_32x32x16_bf16 v[64:79], v[32:35], v[40:43], v[64:79]
    v_mfma_f32_4x4x4_16b_bf16 v[20:23], v[32:33], v[32:33], v[20:23]
    buffer_load_dwordx4 v1, s[8:11], s29 offen offset:2048 lds
    v_mfma_f32_32x32x16_bf16 v[96:111], v[32:35], v[44:47], v[96:111]
    ds_read_b128 v[48:51], v11 offset:32768
    buffer_load_dwordx4 v1, s[8:11], s29 offen offset:3072 lds
    v_mfma_f32_32x32x16_bf16 v[128:143], v[44:47], v[32:35], v[128:143]
    ds_read_b128 v[52:55], v11 offset:36864
    s_bfe_u32 s41, s51, 524288
    s_mul_i32 s41, s41, s40
    s_add_u32 s42, s58, s41
    s_add_u32 s43, s59, s41
    buffer_load_dwordx4 a[32:35], v240, s[8:11], s42 offen
    v_mfma_f32_32x32x16_bf16 v[80:95], v[36:39], v[40:43], v[80:95]
    ds_read_b128 v[56:59], v5 offset:34816
    buffer_load_dwordx4 a[36:39], v241, s[8:11], s43 offen
    v_mfma_f32_32x32x16_bf16 v[112:127], v[36:39], v[44:47], v[112:127]
    v_mfma_f32_4x4x4_16b_bf16 v[20:23], v[34:35], v[34:35], v[20:23]
    ds_read_b128 v[60:63], v5 offset:35840
    s_bfe_u32 s41, s51, 524296
    s_mul_i32 s41, s41, s40
    s_add_u32 s42, s58, s41
    s_add_u32 s43, s59, s41
    buffer_load_dwordx4 a[40:43], v240, s[8:11], s42 offen
    v_mfma_f32_32x32x16_bf16 v[144:159], v[44:47], v[36:39], v[144:159]
    buffer_load_dwordx4 a[44:47], v241, s[8:11], s43 offen
    s_waitcnt lgkmcnt(0)
    v_mfma_f32_32x32x16_bf16 v[64:79], v[48:51], v[56:59], v[64:79]
    v_mfma_f32_4x4x4_16b_bf16 v[20:23], v[48:49], v[48:49], v[20:23]
    v_mfma_f32_32x32x16_bf16 v[96:111], v[48:51], v[60:63], v[96:111]
    ds_read_b128 v[32:35], v12 offset:32768
    v_mfma_f32_32x32x16_bf16 v[128:143], v[60:63], v[48:51], v[128:143]
    ds_read_b128 v[36:39], v12 offset:36864
    v_mfma_f32_32x32x16_bf16 v[80:95], v[52:55], v[56:59], v[80:95]
    ds_read_b128 v[40:43], v5 offset:36864
    v_mfma_f32_32x32x16_bf16 v[112:127], v[52:55], v[60:63], v[112:127]
    v_mfma_f32_4x4x4_16b_bf16 v[20:23], v[50:51], v[50:51], v[20:23]
    ds_read_b128 v[44:47], v5 offset:37888
    v_mfma_f32_32x32x16_bf16 v[144:159], v[60:63], v[52:55], v[144:159]
    s_waitcnt lgkmcnt(0)
    v_mfma_f32_32x32x16_bf16 v[64:79], v[32:35], v[40:43], v[64:79]
    v_mfma_f32_4x4x4_16b_bf16 v[20:23], v[32:33], v[32:33], v[20:23]
    v_mfma_f32_32x32x16_bf16 v[96:111], v[32:35], v[44:47], v[96:111]
    ds_read_b128 v[48:51], v13 offset:32768
    v_mfma_f32_32x32x16_bf16 v[128:143], v[44:47], v[32:35], v[128:143]
    ds_read_b128 v[52:55], v13 offset:36864
    v_mfma_f32_32x32x16_bf16 v[80:95], v[36:39], v[40:43], v[80:95]
    ds_read_b128 v[56:59], v5 offset:38912
    v_mfma_f32_32x32x16_bf16 v[112:127], v[36:39], v[44:47], v[112:127]
    v_mfma_f32_4x4x4_16b_bf16 v[20:23], v[34:35], v[34:35], v[20:23]
    ds_read_b128 v[60:63], v5 offset:39936
    v_mfma_f32_32x32x16_bf16 v[144:159], v[44:47], v[36:39], v[144:159]
    s_waitcnt vmcnt(16)
    s_barrier
    s_waitcnt lgkmcnt(0)
    v_mfma_f32_32x32x16_bf16 v[64:79], v[48:51], v[56:59], v[64:79]
    v_mfma_f32_4x4x4_16b_bf16 v[20:23], v[48:49], v[48:49], v[20:23]
    s_lshl_b32 s28, s13, 12
    s_add_u32 s28, s28, 65536
    s_mov_b32 m0, s28
    s_add_u32 s29, s24, 768
    buffer_load_dwordx4 v2, s[16:19], s29 offen offset:0 lds
    v_mfma_f32_32x32x16_bf16 v[96:111], v[48:51], v[60:63], v[96:111]
    ds_read_b128 v[32:35], v6 offset:0
    s_add_u32 s29, s29, 9216
    buffer_load_dwordx4 v3, s[16:19], s29 offen offset:1024 lds
    v_mfma_f32_32x32x16_bf16 v[128:143], v[60:63], v[48:51], v[128:143]
    ds_read_b128 v[36:39], v6 offset:4096
    s_add_u32 s29, s29, 9216
    buffer_load_dwordx4 v2, s[16:19], s29 offen offset:2048 lds
    v_mfma_f32_32x32x16_bf16 v[80:95], v[52:55], v[56:59], v[80:95]
    ds_read_b128 v[40:43], v4 offset:0
    s_add_u32 s29, s29, 9216
    buffer_load_dwordx4 v3, s[16:19], s29 offen offset:3072 lds
    v_mfma_f32_32x32x16_bf16 v[112:127], v[52:55], v[60:63], v[112:127]
    v_mfma_f32_4x4x4_16b_bf16 v[20:23], v[50:51], v[50:51], v[20:23]
    ds_read_b128 v[44:47], v4 offset:1024
    s_add_u32 s28, s28, 16384
    s_mov_b32 m0, s28
    s_add_u32 s29, s25, 49152
    buffer_load_dwordx4 v1, s[8:11], s29 offen offset:0 lds
    v_mfma_f32_32x32x16_bf16 v[144:159], v[60:63], v[52:55], v[144:159]
    buffer_load_dwordx4 v1, s[8:11], s29 offen offset:1024 lds
    s_waitcnt lgkmcnt(0)
    v_mfma_f32_32x32x16_bf16 v[64:79], v[32:35], v[40:43], v[64:79]
    v_mfma_f32_4x4x4_16b_bf16 v[20:23], v[32:33], v[32:33], v[20:23]
    buffer_load_dwordx4 v1, s[8:11], s29 offen offset:2048 lds
    v_mfma_f32_32x32x16_bf16 v[96:111], v[32:35], v[44:47], v[96:111]
    ds_read_b128 v[48:51], v7 offset:0
    buffer_load_dwordx4 v1, s[8:11], s29 offen offset:3072 lds
    v_mfma_f32_32x32x16_bf16 v[128:143], v[44:47], v[32:35], v[128:143]
    ds_read_b128 v[52:55], v7 offset:4096
    s_bfe_u32 s41, s51, 524304
    s_mul_i32 s41, s41, s40
    s_add_u32 s42, s58, s41
    s_add_u32 s43, s59, s41
    buffer_load_dwordx4 a[48:51], v240, s[8:11], s42 offen
    v_mfma_f32_32x32x16_bf16 v[80:95], v[36:39], v[40:43], v[80:95]
    ds_read_b128 v[56:59], v4 offset:2048
    buffer_load_dwordx4 a[52:55], v241, s[8:11], s43 offen
    v_mfma_f32_32x32x16_bf16 v[112:127], v[36:39], v[44:47], v[112:127]
    v_mfma_f32_4x4x4_16b_bf16 v[20:23], v[34:35], v[34:35], v[20:23]
    ds_read_b128 v[60:63], v4 offset:3072
    s_bfe_u32 s41, s51, 524312
    s_mul_i32 s41, s41, s40
    s_add_u32 s42, s58, s41
    s_add_u32 s43, s59, s41
    buffer_load_dwordx4 a[56:59], v240, s[8:11], s42 offen
    v_mfma_f32_32x32x16_bf16 v[144:159], v[44:47], v[36:39], v[144:159]
    buffer_load_dwordx4 a[60:63], v241, s[8:11], s43 offen
    s_waitcnt lgkmcnt(0)
    v_mfma_f32_32x32x16_bf16 v[64:79], v[48:51], v[56:59], v[64:79]
    v_mfma_f32_4x4x4_16b_bf16 v[20:23], v[48:49], v[48:49], v[20:23]
    v_mfma_f32_32x32x16_bf16 v[96:111], v[48:51], v[60:63], v[96:111]
    ds_read_b128 v[32:35], v8 offset:0
    v_mfma_f32_32x32x16_bf16 v[128:143], v[60:63], v[48:51], v[128:143]
    ds_read_b128 v[36:39], v8 offset:4096
    v_mfma_f32_32x32x16_bf16 v[80:95], v[52:55], v[56:59], v[80:95]
    ds_read_b128 v[40:43], v4 offset:4096
    v_mfma_f32_32x32x16_bf16 v[112:127], v[52:55], v[60:63], v[112:127]
    v_mfma_f32_4x4x4_16b_bf16 v[20:23], v[50:51], v[50:51], v[20:23]
    ds_read_b128 v[44:47], v4 offset:5120
    v_mfma_f32_32x32x16_bf16 v[144:159], v[60:63], v[52:55], v[144:159]
    s_waitcnt lgkmcnt(0)
    v_mfma_f32_32x32x16_bf16 v[64:79], v[32:35], v[40:43], v[64:79]
    v_mfma_f32_4x4x4_16b_bf16 v[20:23], v[32:33], v[32:33], v[20:23]
    v_mfma_f32_32x32x16_bf16 v[96:111], v[32:35], v[44:47], v[96:111]
    ds_read_b128 v[48:51], v9 offset:0
    v_mfma_f32_32x32x16_bf16 v[128:143], v[44:47], v[32:35], v[128:143]
    ds_read_b128 v[52:55], v9 offset:4096
    v_mfma_f32_32x32x16_bf16 v[80:95], v[36:39], v[40:43], v[80:95]
    ds_read_b128 v[56:59], v4 offset:6144
    v_mfma_f32_32x32x16_bf16 v[112:127], v[36:39], v[44:47], v[112:127]
    v_mfma_f32_4x4x4_16b_bf16 v[20:23], v[34:35], v[34:35], v[20:23]
    ds_read_b128 v[60:63], v4 offset:7168
    v_mfma_f32_32x32x16_bf16 v[144:159], v[44:47], v[36:39], v[144:159]
    s_waitcnt vmcnt(16)
    s_barrier
    s_waitcnt lgkmcnt(0)
    v_mfma_f32_32x32x16_bf16 v[64:79], v[48:51], v[56:59], v[64:79]
    v_mfma_f32_4x4x4_16b_bf16 v[20:23], v[48:49], v[48:49], v[20:23]
    s_lshl_b32 s28, s13, 12
    s_add_u32 s28, s28, 98304
    s_mov_b32 m0, s28
    s_add_u32 s29, s24, 896
    buffer_load_dwordx4 v2, s[16:19], s29 offen offset:0 lds
    v_mfma_f32_32x32x16_bf16 v[96:111], v[48:51], v[60:63], v[96:111]
    ds_read_b128 v[32:35], v6 offset:32768
    s_add_u32 s29, s29, 9216
    buffer_load_dwordx4 v3, s[16:19], s29 offen offset:1024 lds
    v_mfma_f32_32x32x16_bf16 v[128:143], v[60:63], v[48:51], v[128:143]
    ds_read_b128 v[36:39], v6 offset:36864
    s_add_u32 s29, s29, 9216
    buffer_load_dwordx4 v2, s[16:19], s29 offen offset:2048 lds
    v_mfma_f32_32x32x16_bf16 v[80:95], v[52:55], v[56:59], v[80:95]
    ds_read_b128 v[40:43], v4 offset:32768
    s_add_u32 s29, s29, 9216
    buffer_load_dwordx4 v3, s[16:19], s29 offen offset:3072 lds
    v_mfma_f32_32x32x16_bf16 v[112:127], v[52:55], v[60:63], v[112:127]
    v_mfma_f32_4x4x4_16b_bf16 v[20:23], v[50:51], v[50:51], v[20:23]
    ds_read_b128 v[44:47], v4 offset:33792
    s_add_u32 s28, s28, 16384
    s_mov_b32 m0, s28
    s_add_u32 s29, s25, 57344
    buffer_load_dwordx4 v1, s[8:11], s29 offen offset:0 lds
    v_mfma_f32_32x32x16_bf16 v[144:159], v[60:63], v[52:55], v[144:159]
    buffer_load_dwordx4 v1, s[8:11], s29 offen offset:1024 lds
    s_waitcnt lgkmcnt(0)
    v_mfma_f32_32x32x16_bf16 v[64:79], v[32:35], v[40:43], v[64:79]
    v_mfma_f32_4x4x4_16b_bf16 v[20:23], v[32:33], v[32:33], v[20:23]
    buffer_load_dwordx4 v1, s[8:11], s29 offen offset:2048 lds
    v_mfma_f32_32x32x16_bf16 v[96:111], v[32:35], v[44:47], v[96:111]
    ds_read_b128 v[48:51], v7 offset:32768
    buffer_load_dwordx4 v1, s[8:11], s29 offen offset:3072 lds
    v_mfma_f32_32x32x16_bf16 v[128:143], v[44:47], v[32:35], v[128:143]
    ds_read_b128 v[52:55], v7 offset:36864
    s_bfe_u32 s41, s52, 524288
    s_mul_i32 s41, s41, s40
    s_add_u32 s42, s58, s41
    s_add_u32 s43, s59, s41
    buffer_load_dwordx4 a[64:67], v240, s[8:11], s42 offen
    v_mfma_f32_32x32x16_bf16 v[80:95], v[36:39], v[40:43], v[80:95]
    ds_read_b128 v[56:59], v4 offset:34816
    buffer_load_dwordx4 a[68:71], v241, s[8:11], s43 offen
    v_mfma_f32_32x32x16_bf16 v[112:127], v[36:39], v[44:47], v[112:127]
    v_mfma_f32_4x4x4_16b_bf16 v[20:23], v[34:35], v[34:35], v[20:23]
    ds_read_b128 v[60:63], v4 offset:35840
    s_bfe_u32 s41, s52, 524296
    s_mul_i32 s41, s41, s40
    s_add_u32 s42, s58, s41
    s_add_u32 s43, s59, s41
    buffer_load_dwordx4 a[72:75], v240, s[8:11], s42 offen
    v_mfma_f32_32x32x16_bf16 v[144:159], v[44:47], v[36:39], v[144:159]
    buffer_load_dwordx4 a[76:79], v241, s[8:11], s43 offen
    s_waitcnt lgkmcnt(0)
    v_mfma_f32_32x32x16_bf16 v[64:79], v[48:51], v[56:59], v[64:79]
    v_mfma_f32_4x4x4_16b_bf16 v[20:23], v[48:49], v[48:49], v[20:23]
    v_mfma_f32_32x32x16_bf16 v[96:111], v[48:51], v[60:63], v[96:111]
    ds_read_b128 v[32:35], v8 offset:32768
    v_mfma_f32_32x32x16_bf16 v[128:143], v[60:63], v[48:51], v[128:143]
    ds_read_b128 v[36:39], v8 offset:36864
    v_mfma_f32_32x32x16_bf16 v[80:95], v[52:55], v[56:59], v[80:95]
    ds_read_b128 v[40:43], v4 offset:36864
    v_mfma_f32_32x32x16_bf16 v[112:127], v[52:55], v[60:63], v[112:127]
    v_mfma_f32_4x4x4_16b_bf16 v[20:23], v[50:51], v[50:51], v[20:23]
    ds_read_b128 v[44:47], v4 offset:37888
    v_mfma_f32_32x32x16_bf16 v[144:159], v[60:63], v[52:55], v[144:159]
    s_waitcnt lgkmcnt(0)
    v_mfma_f32_32x32x16_bf16 v[64:79], v[32:35], v[40:43], v[64:79]
    v_mfma_f32_4x4x4_16b_bf16 v[20:23], v[32:33], v[32:33], v[20:23]
    v_mfma_f32_32x32x16_bf16 v[96:111], v[32:35], v[44:47], v[96:111]
    ds_read_b128 v[48:51], v9 offset:32768
    v_mfma_f32_32x32x16_bf16 v[128:143], v[44:47], v[32:35], v[128:143]
    ds_read_b128 v[52:55], v9 offset:36864
    v_mfma_f32_32x32x16_bf16 v[80:95], v[36:39], v[40:43], v[80:95]
    ds_read_b128 v[56:59], v4 offset:38912
    v_mfma_f32_32x32x16_bf16 v[112:127], v[36:39], v[44:47], v[112:127]
    v_mfma_f32_4x4x4_16b_bf16 v[20:23], v[34:35], v[34:35], v[20:23]
    ds_read_b128 v[60:63], v4 offset:39936
    v_mfma_f32_32x32x16_bf16 v[144:159], v[44:47], v[36:39], v[144:159]
    s_waitcnt vmcnt(16)
    s_barrier
    s_waitcnt lgkmcnt(0)
    v_mfma_f32_32x32x16_bf16 v[64:79], v[48:51], v[56:59], v[64:79]
    v_mfma_f32_4x4x4_16b_bf16 v[20:23], v[48:49], v[48:49], v[20:23]
    s_lshl_b32 s28, s13, 12
    s_mov_b32 m0, s28
    s_add_u32 s29, s24, 1024
    buffer_load_dwordx4 v2, s[16:19], s29 offen offset:0 lds
    v_mfma_f32_32x32x16_bf16 v[96:111], v[48:51], v[60:63], v[96:111]
    ds_read_b128 v[32:35], v10 offset:0
    s_add_u32 s29, s29, 9216
    buffer_load_dwordx4 v3, s[16:19], s29 offen offset:1024 lds
    v_mfma_f32_32x32x16_bf16 v[128:143], v[60:63], v[48:51], v[128:143]
    ds_read_b128 v[36:39], v10 offset:4096
    s_add_u32 s29, s29, 9216
    buffer_load_dwordx4 v2, s[16:19], s29 offen offset:2048 lds
    v_mfma_f32_32x32x16_bf16 v[80:95], v[52:55], v[56:59], v[80:95]
    ds_read_b128 v[40:43], v5 offset:0
    s_add_u32 s29, s29, 9216
    buffer_load_dwordx4 v3, s[16:19], s29 offen offset:3072 lds
    v_mfma_f32_32x32x16_bf16 v[112:127], v[52:55], v[60:63], v[112:127]
    v_mfma_f32_4x4x4_16b_bf16 v[20:23], v[50:51], v[50:51], v[20:23]
    ds_read_b128 v[44:47], v5 offset:1024
    s_add_u32 s28, s28, 16384
    s_mov_b32 m0, s28
    s_add_u32 s29, s25, 65536
    buffer_load_dwordx4 v1, s[8:11], s29 offen offset:0 lds
    v_mfma_f32_32x32x16_bf16 v[144:159], v[60:63], v[52:55], v[144:159]
    buffer_load_dwordx4 v1, s[8:11], s29 offen offset:1024 lds
    s_waitcnt lgkmcnt(0)
    v_mfma_f32_32x32x16_bf16 v[64:79], v[32:35], v[40:43], v[64:79]
    v_mfma_f32_4x4x4_16b_bf16 v[20:23], v[32:33], v[32:33], v[20:23]
    buffer_load_dwordx4 v1, s[8:11], s29 offen offset:2048 lds
    v_mfma_f32_32x32x16_bf16 v[96:111], v[32:35], v[44:47], v[96:111]
    ds_read_b128 v[48:51], v11 offset:0
    buffer_load_dwordx4 v1, s[8:11], s29 offen offset:3072 lds
    v_mfma_f32_32x32x16_bf16 v[128:143], v[44:47], v[32:35], v[128:143]
    ds_read_b128 v[52:55], v11 offset:4096
    s_bfe_u32 s41, s52, 524304
    s_mul_i32 s41, s41, s40
    s_add_u32 s42, s58, s41
    s_add_u32 s43, s59, s41
    buffer_load_dwordx4 a[80:83], v240, s[8:11], s42 offen
    v_mfma_f32_32x32x16_bf16 v[80:95], v[36:39], v[40:43], v[80:95]
    ds_read_b128 v[56:59], v5 offset:2048
    buffer_load_dwordx4 a[84:87], v241, s[8:11], s43 offen
    v_mfma_f32_32x32x16_bf16 v[112:127], v[36:39], v[44:47], v[112:127]
    v_mfma_f32_4x4x4_16b_bf16 v[20:23], v[34:35], v[34:35], v[20:23]
    ds_read_b128 v[60:63], v5 offset:3072
    s_bfe_u32 s41, s52, 524312
    s_mul_i32 s41, s41, s40
    s_add_u32 s42, s58, s41
    s_add_u32 s43, s59, s41
    buffer_load_dwordx4 a[88:91], v240, s[8:11], s42 offen
    v_mfma_f32_32x32x16_bf16 v[144:159], v[44:47], v[36:39], v[144:159]
    buffer_load_dwordx4 a[92:95], v241, s[8:11], s43 offen
    s_waitcnt lgkmcnt(0)
    v_mfma_f32_32x32x16_bf16 v[64:79], v[48:51], v[56:59], v[64:79]
    v_mfma_f32_4x4x4_16b_bf16 v[20:23], v[48:49], v[48:49], v[20:23]
    v_mfma_f32_32x32x16_bf16 v[96:111], v[48:51], v[60:63], v[96:111]
    ds_read_b128 v[32:35], v12 offset:0
    v_mfma_f32_32x32x16_bf16 v[128:143], v[60:63], v[48:51], v[128:143]
    ds_read_b128 v[36:39], v12 offset:4096
    v_mfma_f32_32x32x16_bf16 v[80:95], v[52:55], v[56:59], v[80:95]
    ds_read_b128 v[40:43], v5 offset:4096
    v_mfma_f32_32x32x16_bf16 v[112:127], v[52:55], v[60:63], v[112:127]
    v_mfma_f32_4x4x4_16b_bf16 v[20:23], v[50:51], v[50:51], v[20:23]
    ds_read_b128 v[44:47], v5 offset:5120
    v_mfma_f32_32x32x16_bf16 v[144:159], v[60:63], v[52:55], v[144:159]
    s_waitcnt lgkmcnt(0)
    v_mfma_f32_32x32x16_bf16 v[64:79], v[32:35], v[40:43], v[64:79]
    v_mfma_f32_4x4x4_16b_bf16 v[20:23], v[32:33], v[32:33], v[20:23]
    v_mfma_f32_32x32x16_bf16 v[96:111], v[32:35], v[44:47], v[96:111]
    ds_read_b128 v[48:51], v13 offset:0
    v_mfma_f32_32x32x16_bf16 v[128:143], v[44:47], v[32:35], v[128:143]
    ds_read_b128 v[52:55], v13 offset:4096
    v_mfma_f32_32x32x16_bf16 v[80:95], v[36:39], v[40:43], v[80:95]
    ds_read_b128 v[56:59], v5 offset:6144
    v_mfma_f32_32x32x16_bf16 v[112:127], v[36:39], v[44:47], v[112:127]
    v_mfma_f32_4x4x4_16b_bf16 v[20:23], v[34:35], v[34:35], v[20:23]
    ds_read_b128 v[60:63], v5 offset:7168
    v_mfma_f32_32x32x16_bf16 v[144:159], v[44:47], v[36:39], v[144:159]
    s_waitcnt vmcnt(16)
    s_barrier
    s_waitcnt lgkmcnt(0)
    v_mfma_f32_32x32x16_bf16 v[64:79], v[48:51], v[56:59], v[64:79]
    v_mfma_f32_4x4x4_16b_bf16 v[20:23], v[48:49], v[48:49], v[20:23]
    s_lshl_b32 s28, s13, 12
    s_add_u32 s28, s28, 32768
    s_mov_b32 m0, s28
    s_add_u32 s29, s24, 1152
    buffer_load_dwordx4 v2, s[16:19], s29 offen offset:0 lds
    v_mfma_f32_32x32x16_bf16 v[96:111], v[48:51], v[60:63], v[96:111]
    ds_read_b128 v[32:35], v10 offset:32768
    s_add_u32 s29, s29, 9216
    buffer_load_dwordx4 v3, s[16:19], s29 offen offset:1024 lds
    v_mfma_f32_32x32x16_bf16 v[128:143], v[60:63], v[48:51], v[128:143]
    ds_read_b128 v[36:39], v10 offset:36864
    s_add_u32 s29, s29, 9216
    buffer_load_dwordx4 v2, s[16:19], s29 offen offset:2048 lds
    v_mfma_f32_32x32x16_bf16 v[80:95], v[52:55], v[56:59], v[80:95]
    ds_read_b128 v[40:43], v5 offset:32768
    s_add_u32 s29, s29, 9216
    buffer_load_dwordx4 v3, s[16:19], s29 offen offset:3072 lds
    v_mfma_f32_32x32x16_bf16 v[112:127], v[52:55], v[60:63], v[112:127]
    v_mfma_f32_4x4x4_16b_bf16 v[20:23], v[50:51], v[50:51], v[20:23]
    ds_read_b128 v[44:47], v5 offset:33792
    s_add_u32 s28, s28, 16384
    s_mov_b32 m0, s28
    s_add_u32 s29, s25, 73728
    buffer_load_dwordx4 v1, s[8:11], s29 offen offset:0 lds
    v_mfma_f32_32x32x16_bf16 v[144:159], v[60:63], v[52:55], v[144:159]
    buffer_load_dwordx4 v1, s[8:11], s29 offen offset:1024 lds
    s_waitcnt lgkmcnt(0)
    v_mfma_f32_32x32x16_bf16 v[64:79], v[32:35], v[40:43], v[64:79]
    v_mfma_f32_4x4x4_16b_bf16 v[20:23], v[32:33], v[32:33], v[20:23]
    buffer_load_dwordx4 v1, s[8:11], s29 offen offset:2048 lds
    v_mfma_f32_32x32x16_bf16 v[96:111], v[32:35], v[44:47], v[96:111]
    ds_read_b128 v[48:51], v11 offset:32768
    buffer_load_dwordx4 v1, s[8:11], s29 offen offset:3072 lds
    v_mfma_f32_32x32x16_bf16 v[128:143], v[44:47], v[32:35], v[128:143]
    ds_read_b128 v[52:55], v11 offset:36864
    s_bfe_u32 s41, s53, 524288
    s_mul_i32 s41, s41, s40
    s_add_u32 s42, s58, s41
    s_add_u32 s43, s59, s41
    buffer_load_dwordx4 a[96:99], v240, s[8:11], s42 offen
    v_mfma_f32_32x32x16_bf16 v[80:95], v[36:39], v[40:43], v[80:95]
    ds_read_b128 v[56:59], v5 offset:34816
    buffer_load_dwordx4 a[100:103], v241, s[8:11], s43 offen
    v_mfma_f32_32x32x16_bf16 v[112:127], v[36:39], v[44:47], v[112:127]
    v_mfma_f32_4x4x4_16b_bf16 v[20:23], v[34:35], v[34:35], v[20:23]
    ds_read_b128 v[60:63], v5 offset:35840
    s_bfe_u32 s41, s53, 524296
    s_mul_i32 s41, s41, s40
    s_add_u32 s42, s58, s41
    s_add_u32 s43, s59, s41
    buffer_load_dwordx4 a[104:107], v240, s[8:11], s42 offen
    v_mfma_f32_32x32x16_bf16 v[144:159], v[44:47], v[36:39], v[144:159]
    buffer_load_dwordx4 a[108:111], v241, s[8:11], s43 offen
    s_waitcnt lgkmcnt(0)
    v_mfma_f32_32x32x16_bf16 v[64:79], v[48:51], v[56:59], v[64:79]
    v_mfma_f32_4x4x4_16b_bf16 v[20:23], v[48:49], v[48:49], v[20:23]
    v_mfma_f32_32x32x16_bf16 v[96:111], v[48:51], v[60:63], v[96:111]
    ds_read_b128 v[32:35], v12 offset:32768
    v_mfma_f32_32x32x16_bf16 v[128:143], v[60:63], v[48:51], v[128:143]
    ds_read_b128 v[36:39], v12 offset:36864
    v_mfma_f32_32x32x16_bf16 v[80:95], v[52:55], v[56:59], v[80:95]
    ds_read_b128 v[40:43], v5 offset:36864
    v_mfma_f32_32x32x16_bf16 v[112:127], v[52:55], v[60:63], v[112:127]
    v_mfma_f32_4x4x4_16b_bf16 v[20:23], v[50:51], v[50:51], v[20:23]
    ds_read_b128 v[44:47], v5 offset:37888
    v_mfma_f32_32x32x16_bf16 v[144:159], v[60:63], v[52:55], v[144:159]
    s_waitcnt lgkmcnt(0)
    v_mfma_f32_32x32x16_bf16 v[64:79], v[32:35], v[40:43], v[64:79]
    v_mfma_f32_4x4x4_16b_bf16 v[20:23], v[32:33], v[32:33], v[20:23]
    v_mfma_f32_32x32x16_bf16 v[96:111], v[32:35], v[44:47], v[96:111]
    ds_read_b128 v[48:51], v13 offset:32768
    v_mfma_f32_32x32x16_bf16 v[128:143], v[44:47], v[32:35], v[128:143]
    ds_read_b128 v[52:55], v13 offset:36864
    v_mfma_f32_32x32x16_bf16 v[80:95], v[36:39], v[40:43], v[80:95]
    ds_read_b128 v[56:59], v5 offset:38912
    v_mfma_f32_32x32x16_bf16 v[112:127], v[36:39], v[44:47], v[112:127]
    v_mfma_f32_4x4x4_16b_bf16 v[20:23], v[34:35], v[34:35], v[20:23]
    ds_read_b128 v[60:63], v5 offset:39936
    v_mfma_f32_32x32x16_bf16 v[144:159], v[44:47], v[36:39], v[144:159]
    s_waitcnt vmcnt(16)
    s_barrier
    s_waitcnt lgkmcnt(0)
    v_mfma_f32_32x32x16_bf16 v[64:79], v[48:51], v[56:59], v[64:79]
    v_mfma_f32_4x4x4_16b_bf16 v[20:23], v[48:49], v[48:49], v[20:23]
    s_bfe_u32 s41, s53, 524304
    s_mul_i32 s41, s41, s40
    s_add_u32 s42, s58, s41
    s_add_u32 s43, s59, s41
    buffer_load_dwordx4 a[112:115], v240, s[8:11], s42 offen
    v_mfma_f32_32x32x16_bf16 v[96:111], v[48:51], v[60:63], v[96:111]
    ds_read_b128 v[32:35], v6 offset:0
    buffer_load_dwordx4 a[116:119], v241, s[8:11], s43 offen
    v_mfma_f32_32x32x16_bf16 v[128:143], v[60:63], v[48:51], v[128:143]
    ds_read_b128 v[36:39], v6 offset:4096
    s_bfe_u32 s41, s53, 524312
    s_mul_i32 s41, s41, s40
    s_add_u32 s42, s58, s41
    s_add_u32 s43, s59, s41
    buffer_load_dwordx4 a[120:123], v240, s[8:11], s42 offen
    v_mfma_f32_32x32x16_bf16 v[80:95], v[52:55], v[56:59], v[80:95]
    ds_read_b128 v[40:43], v4 offset:0
    buffer_load_dwordx4 a[124:127], v241, s[8:11], s43 offen
    v_mfma_f32_32x32x16_bf16 v[112:127], v[52:55], v[60:63], v[112:127]
    v_mfma_f32_4x4x4_16b_bf16 v[20:23], v[50:51], v[50:51], v[20:23]
    ds_read_b128 v[44:47], v4 offset:1024
    v_mfma_f32_32x32x16_bf16 v[144:159], v[60:63], v[52:55], v[144:159]
    s_waitcnt lgkmcnt(0)
    v_mfma_f32_32x32x16_bf16 v[64:79], v[32:35], v[40:43], v[64:79]
    v_mfma_f32_4x4x4_16b_bf16 v[20:23], v[32:33], v[32:33], v[20:23]
    v_mfma_f32_32x32x16_bf16 v[96:111], v[32:35], v[44:47], v[96:111]
    ds_read_b128 v[48:51], v7 offset:0
    v_mfma_f32_32x32x16_bf16 v[128:143], v[44:47], v[32:35], v[128:143]
    ds_read_b128 v[52:55], v7 offset:4096
    v_mfma_f32_32x32x16_bf16 v[80:95], v[36:39], v[40:43], v[80:95]
    ds_read_b128 v[56:59], v4 offset:2048
    v_mfma_f32_32x32x16_bf16 v[112:127], v[36:39], v[44:47], v[112:127]
    v_mfma_f32_4x4x4_16b_bf16 v[20:23], v[34:35], v[34:35], v[20:23]
    ds_read_b128 v[60:63], v4 offset:3072
    v_mfma_f32_32x32x16_bf16 v[144:159], v[44:47], v[36:39], v[144:159]
    s_waitcnt lgkmcnt(0)
    v_mfma_f32_32x32x16_bf16 v[64:79], v[48:51], v[56:59], v[64:79]
    v_mfma_f32_4x4x4_16b_bf16 v[20:23], v[48:49], v[48:49], v[20:23]
    v_mfma_f32_32x32x16_bf16 v[96:111], v[48:51], v[60:63], v[96:111]
    ds_read_b128 v[32:35], v8 offset:0
    v_mfma_f32_32x32x16_bf16 v[128:143], v[60:63], v[48:51], v[128:143]
    ds_read_b128 v[36:39], v8 offset:4096
    v_mfma_f32_32x32x16_bf16 v[80:95], v[52:55], v[56:59], v[80:95]
    ds_read_b128 v[40:43], v4 offset:4096
    v_mfma_f32_32x32x16_bf16 v[112:127], v[52:55], v[60:63], v[112:127]
    v_mfma_f32_4x4x4_16b_bf16 v[20:23], v[50:51], v[50:51], v[20:23]
    ds_read_b128 v[44:47], v4 offset:5120
    v_mfma_f32_32x32x16_bf16 v[144:159], v[60:63], v[52:55], v[144:159]
    s_waitcnt lgkmcnt(0)
    v_mfma_f32_32x32x16_bf16 v[64:79], v[32:35], v[40:43], v[64:79]
    v_mfma_f32_4x4x4_16b_bf16 v[20:23], v[32:33], v[32:33], v[20:23]
    v_mfma_f32_32x32x16_bf16 v[96:111], v[32:35], v[44:47], v[96:111]
    ds_read_b128 v[48:51], v9 offset:0
    v_mfma_f32_32x32x16_bf16 v[128:143], v[44:47], v[32:35], v[128:143]
    ds_read_b128 v[52:55], v9 offset:4096
    v_mfma_f32_32x32x16_bf16 v[80:95], v[36:39], v[40:43], v[80:95]
    ds_read_b128 v[56:59], v4 offset:6144
    v_mfma_f32_32x32x16_bf16 v[112:127], v[36:39], v[44:47], v[112:127]
    v_mfma_f32_4x4x4_16b_bf16 v[20:23], v[34:35], v[34:35], v[20:23]
    ds_read_b128 v[60:63], v4 offset:7168
    v_mfma_f32_32x32x16_bf16 v[144:159], v[44:47], v[36:39], v[144:159]
    s_waitcnt vmcnt(8)
    s_barrier
    s_waitcnt lgkmcnt(0)
    v_mfma_f32_32x32x16_bf16 v[64:79], v[48:51], v[56:59], v[64:79]
    v_mfma_f32_4x4x4_16b_bf16 v[20:23], v[48:49], v[48:49], v[20:23]
    s_bfe_u32 s41, s54, 524288
    s_mul_i32 s41, s41, s40
    s_add_u32 s42, s58, s41
    s_add_u32 s43, s59, s41
    buffer_load_dwordx4 a[128:131], v240, s[8:11], s42 offen
    v_mfma_f32_32x32x16_bf16 v[96:111], v[48:51], v[60:63], v[96:111]
    ds_read_b128 v[32:35], v6 offset:32768
    buffer_load_dwordx4 a[132:135], v241, s[8:11], s43 offen
    v_mfma_f32_32x32x16_bf16 v[128:143], v[60:63], v[48:51], v[128:143]
    ds_read_b128 v[36:39], v6 offset:36864
    v_mfma_f32_32x32x16_bf16 v[80:95], v[52:55], v[56:59], v[80:95]
    ds_read_b128 v[40:43], v4 offset:32768
    v_mfma_f32_32x32x16_bf16 v[112:127], v[52:55], v[60:63], v[112:127]
    v_mfma_f32_4x4x4_16b_bf16 v[20:23], v[50:51], v[50:51], v[20:23]
    ds_read_b128 v[44:47], v4 offset:33792
    v_mfma_f32_32x32x16_bf16 v[144:159], v[60:63], v[52:55], v[144:159]
    s_waitcnt lgkmcnt(0)
    v_mfma_f32_32x32x16_bf16 v[64:79], v[32:35], v[40:43], v[64:79]
    v_mfma_f32_4x4x4_16b_bf16 v[20:23], v[32:33], v[32:33], v[20:23]
    v_mfma_f32_32x32x16_bf16 v[96:111], v[32:35], v[44:47], v[96:111]
    ds_read_b128 v[48:51], v7 offset:32768
    v_mfma_f32_32x32x16_bf16 v[128:143], v[44:47], v[32:35], v[128:143]
    ds_read_b128 v[52:55], v7 offset:36864
    v_mfma_f32_32x32x16_bf16 v[80:95], v[36:39], v[40:43], v[80:95]
    ds_read_b128 v[56:59], v4 offset:34816
    v_mfma_f32_32x32x16_bf16 v[112:127], v[36:39], v[44:47], v[112:127]
    v_mfma_f32_4x4x4_16b_bf16 v[20:23], v[34:35], v[34:35], v[20:23]
    ds_read_b128 v[60:63], v4 offset:35840
    v_mfma_f32_32x32x16_bf16 v[144:159], v[44:47], v[36:39], v[144:159]
    s_waitcnt lgkmcnt(0)
    v_mfma_f32_32x32x16_bf16 v[64:79], v[48:51], v[56:59], v[64:79]
    v_mfma_f32_4x4x4_16b_bf16 v[20:23], v[48:49], v[48:49], v[20:23]
    v_mfma_f32_32x32x16_bf16 v[96:111], v[48:51], v[60:63], v[96:111]
    ds_read_b128 v[32:35], v8 offset:32768
    v_mfma_f32_32x32x16_bf16 v[128:143], v[60:63], v[48:51], v[128:143]
    ds_read_b128 v[36:39], v8 offset:36864
    v_mfma_f32_32x32x16_bf16 v[80:95], v[52:55], v[56:59], v[80:95]
    ds_read_b128 v[40:43], v4 offset:36864
    v_mfma_f32_32x32x16_bf16 v[112:127], v[52:55], v[60:63], v[112:127]
    v_mfma_f32_4x4x4_16b_bf16 v[20:23], v[50:51], v[50:51], v[20:23]
    ds_read_b128 v[44:47], v4 offset:37888
    v_mfma_f32_32x32x16_bf16 v[144:159], v[60:63], v[52:55], v[144:159]
    s_waitcnt lgkmcnt(0)
    v_mfma_f32_32x32x16_bf16 v[64:79], v[32:35], v[40:43], v[64:79]
    v_mfma_f32_4x4x4_16b_bf16 v[20:23], v[32:33], v[32:33], v[20:23]
    v_mfma_f32_32x32x16_bf16 v[96:111], v[32:35], v[44:47], v[96:111]
    ds_read_b128 v[48:51], v9 offset:32768
    v_mfma_f32_32x32x16_bf16 v[128:143], v[44:47], v[32:35], v[128:143]
    ds_read_b128 v[52:55], v9 offset:36864
    v_mfma_f32_32x32x16_bf16 v[80:95], v[36:39], v[40:43], v[80:95]
    ds_read_b128 v[56:59], v4 offset:38912
    v_mfma_f32_32x32x16_bf16 v[112:127], v[36:39], v[44:47], v[112:127]
    v_mfma_f32_4x4x4_16b_bf16 v[20:23], v[34:35], v[34:35], v[20:23]
    ds_read_b128 v[60:63], v4 offset:39936
    v_mfma_f32_32x32x16_bf16 v[144:159], v[44:47], v[36:39], v[144:159]
    s_waitcnt lgkmcnt(0)
    v_mfma_f32_32x32x16_bf16 v[64:79], v[48:51], v[56:59], v[64:79]
    v_mfma_f32_4x4x4_16b_bf16 v[20:23], v[48:49], v[48:49], v[20:23]
    s_bfe_u32 s41, s54, 524296
    s_mul_i32 s41, s41, s40
    s_add_u32 s42, s58, s41
    s_add_u32 s43, s59, s41
    buffer_load_dwordx4 a[136:139], v240, s[8:11], s42 offen
    v_mfma_f32_32x32x16_bf16 v[96:111], v[48:51], v[60:63], v[96:111]
    buffer_load_dwordx4 a[140:143], v241, s[8:11], s43 offen
    v_mfma_f32_32x32x16_bf16 v[128:143], v[60:63], v[48:51], v[128:143]
    v_mfma_f32_32x32x16_bf16 v[80:95], v[52:55], v[56:59], v[80:95]
    v_mfma_f32_32x32x16_bf16 v[112:127], v[52:55], v[60:63], v[112:127]
    v_mfma_f32_4x4x4_16b_bf16 v[20:23], v[50:51], v[50:51], v[20:23]
    v_mfma_f32_32x32x16_bf16 v[144:159], v[60:63], v[52:55], v[144:159]
    s_branch layerb1_kernel_af_epi
layerb1_kernel_af_h1:
    s_waitcnt lgkmcnt(0)
    v_mfma_f32_32x32x16_bf16 v[64:79], v[32:35], v[40:43], 0
    v_mfma_f32_4x4x4_16b_bf16 v[20:23], v[36:37], v[36:37], v[20:23]
    v_mfma_f32_32x32x16_bf16 v[96:111], v[32:35], v[44:47], 0
    ds_read_b128 v[48:51], v7 offset:0
    v_mfma_f32_32x32x16_bf16 v[128:143], v[44:47], v[32:35], 0
    ds_read_b128 v[52:55], v7 offset:4096
    v_mfma_f32_32x32x16_bf16 v[80:95], v[36:39], v[40:43], 0
    ds_read_b128 v[56:59], v4 offset:2048
    v_mfma_f32_32x32x16_bf16 v[112:127], v[36:39], v[44:47], 0
    v_mfma_f32_4x4x4_16b_bf16 v[20:23], v[38:39], v[38:39], v[20:23]
    ds_read_b128 v[60:63], v4 offset:3072
    v_mfma_f32_32x32x16_bf16 v[144:159], v[44:47], v[36:39], 0
    s_waitcnt lgkmcnt(0)
    v_mfma_f32_32x32x16_bf16 v[64:79], v[48:51], v[56:59], v[64:79]
    v_mfma_f32_4x4x4_16b_bf16 v[20:23], v[52:53], v[52:53], v[20:23]
    v_mfma_f32_32x32x16_bf16 v[96:111], v[48:51], v[60:63], v[96:111]
    ds_read_b128 v[32:35], v8 offset:0
    v_mfma_f32_32x32x16_bf16 v[128:143], v[60:63], v[48:51], v[128:143]
    ds_read_b128 v[36:39], v8 offset:4096
    v_mfma_f32_32x32x16_bf16 v[80:95], v[52:55], v[56:59], v[80:95]
    ds_read_b128 v[40:43], v4 offset:4096
    v_mfma_f32_32x32x16_bf16 v[112:127], v[52:55], v[60:63], v[112:127]
    v_mfma_f32_4x4x4_16b_bf16 v[20:23], v[54:55], v[54:55], v[20:23]
    ds_read_b128 v[44:47], v4 offset:5120
    v_mfma_f32_32x32x16_bf16 v[144:159], v[60:63], v[52:55], v[144:159]
    s_waitcnt lgkmcnt(0)
    v_mfma_f32_32x32x16_bf16 v[64:79], v[32:35], v[40:43], v[64:79]
    v_mfma_f32_4x4x4_16b_bf16 v[20:23], v[36:37], v[36:37], v[20:23]
    v_mfma_f32_32x32x16_bf16 v[96:111], v[32:35], v[44:47], v[96:111]
    ds_read_b128 v[48:51], v9 offset:0
    v_mfma_f32_32x32x16_bf16 v[128:143], v[44:47], v[32:35], v[128:143]
    ds_read_b128 v[52:55], v9 offset:4096
    v_mfma_f32_32x32x16_bf16 v[80:95], v[36:39], v[40:43], v[80:95]
    ds_read_b128 v[56:59], v4 offset:6144
    v_mfma_f32_32x32x16_bf16 v[112:127], v[36:39], v[44:47], v[112:127]
    v_mfma_f32_4x4x4_16b_bf16 v[20:23], v[38:39], v[38:39], v[20:23]
    ds_read_b128 v[60:63], v4 offset:7168
    v_mfma_f32_32x32x16_bf16 v[144:159], v[44:47], v[36:39], v[144:159]
    s_waitcnt vmcnt(8)
    s_barrier
    s_waitcnt lgkmcnt(0)
    v_mfma_f32_32x32x16_bf16 v[64:79], v[48:51], v[56:59], v[64:79]
    v_mfma_f32_4x4x4_16b_bf16 v[20:23], v[52:53], v[52:53], v[20:23]
    s_lshl_b32 s28, s13, 12
    s_add_u32 s28, s28, 98304
    s_mov_b32 m0, s28
    s_add_u32 s29, s24, 384
    buffer_load_dwordx4 v2, s[16:19], s29 offen offset:0 lds
    v_mfma_f32_32x32x16_bf16 v[96:111], v[48:51], v[60:63], v[96:111]
    ds_read_b128 v[32:35], v6 offset:32768
    s_add_u32 s29, s29, 9216
    buffer_load_dwordx4 v3, s[16:19], s29 offen offset:1024 lds
    v_mfma_f32_32x32x16_bf16 v[128:143], v[60:63], v[48:51], v[128:143]
    ds_read_b128 v[36:39], v6 offset:36864
    s_add_u32 s29, s29, 9216
    buffer_load_dwordx4 v2, s[16:19], s29 offen offset:2048 lds
    v_mfma_f32_32x32x16_bf16 v[80:95], v[52:55], v[56:59], v[80:95]
    ds_read_b128 v[40:43], v4 offset:32768
    s_add_u32 s29, s29, 9216
    buffer_load_dwordx4 v3, s[16:19], s29 offen offset:3072 lds
    v_mfma_f32_32x32x16_bf16 v[112:127], v[52:55], v[60:63], v[112:127]
    v_mfma_f32_4x4x4_16b_bf16 v[20:23], v[54:55], v[54:55], v[20:23]
    ds_read_b128 v[44:47], v4 offset:33792
    s_add_u32 s28, s28, 16384
    s_mov_b32 m0, s28
    s_add_u32 s29, s25, 24576
    buffer_load_dwordx4 v1, s[8:11], s29 offen offset:0 lds
    v_mfma_f32_32x32x16_bf16 v[144:159], v[60:63], v[52:55], v[144:159]
    buffer_load_dwordx4 v1, s[8:11], s29 offen offset:1024 lds
    s_waitcnt lgkmcnt(0)
    v_mfma_f32_32x32x16_bf16 v[64:79], v[32:35], v[40:43], v[64:79]
    v_mfma_f32_4x4x4_16b_bf16 v[20:23], v[36:37], v[36:37], v[20:23]
    buffer_load_dwordx4 v1, s[8:11], s29 offen offset:2048 lds
    v_mfma_f32_32x32x16_bf16 v[96:111], v[32:35], v[44:47], v[96:111]
    ds_read_b128 v[48:51], v7 offset:32768
    buffer_load_dwordx4 v1, s[8:11], s29 offen offset:3072 lds
    v_mfma_f32_32x32x16_bf16 v[128:143], v[44:47], v[32:35], v[128:143]
    ds_read_b128 v[52:55], v7 offset:36864
    s_bfe_u32 s41, s50, 524288
    s_mul_i32 s41, s41, s40
    s_add_u32 s42, s58, s41
    s_add_u32 s43, s59, s41
    buffer_load_dwordx4 a[0:3], v240, s[8:11], s42 offen
    v_mfma_f32_32x32x16_bf16 v[80:95], v[36:39], v[40:43], v[80:95]
    ds_read_b128 v[56:59], v4 offset:34816
    buffer_load_dwordx4 a[4:7], v241, s[8:11], s43 offen
    v_mfma_f32_32x32x16_bf16 v[112:127], v[36:39], v[44:47], v[112:127]
    v_mfma_f32_4x4x4_16b_bf16 v[20:23], v[38:39], v[38:39], v[20:23]
    ds_read_b128 v[60:63], v4 offset:35840
    s_bfe_u32 s41, s50, 524296
    s_mul_i32 s41, s41, s40
    s_add_u32 s42, s58, s41
    s_add_u32 s43, s59, s41
    buffer_load_dwordx4 a[8:11], v240, s[8:11], s42 offen
    v_mfma_f32_32x32x16_bf16 v[144:159], v[44:47], v[36:39], v[144:159]
    buffer_load_dwordx4 a[12:15], v241, s[8:11], s43 offen
    s_waitcnt lgkmcnt(0)
    v_mfma_f32_32x32x16_bf16 v[64:79], v[48:51], v[56:59], v[64:79]
    v_mfma_f32_4x4x4_16b_bf16 v[20:23], v[52:53], v[52:53], v[20:23]
    v_mfma_f32_32x32x16_bf16 v[96:111], v[48:51], v[60:63], v[96:111]
    ds_read_b128 v[32:35], v8 offset:32768
    v_mfma_f32_32x32x16_bf16 v[128:143], v[60:63], v[48:51], v[128:143]
    ds_read_b128 v[36:39], v8 offset:36864
    v_mfma_f32_32x32x16_bf16 v[80:95], v[52:55], v[56:59], v[80:95]
    ds_read_b128 v[40:43], v4 offset:36864
    v_mfma_f32_32x32x16_bf16 v[112:127], v[52:55], v[60:63], v[112:127]
    v_mfma_f32_4x4x4_16b_bf16 v[20:23], v[54:55], v[54:55], v[20:23]
    ds_read_b128 v[44:47], v4 offset:37888
    v_mfma_f32_32x32x16_bf16 v[144:159], v[60:63], v[52:55], v[144:159]
    s_waitcnt lgkmcnt(0)
    v_mfma_f32_32x32x16_bf16 v[64:79], v[32:35], v[40:43], v[64:79]
    v_mfma_f32_4x4x4_16b_bf16 v[20:23], v[36:37], v[36:37], v[20:23]
    v_mfma_f32_32x32x16_bf16 v[96:111], v[32:35], v[44:47], v[96:111]
    ds_read_b128 v[48:51], v9 offset:32768
    v_mfma_f32_32x32x16_bf16 v[128:143], v[44:47], v[32:35], v[128:143]
    ds_read_b128 v[52:55], v9 offset:36864
    v_mfma_f32_32x32x16_bf16 v[80:95], v[36:39], v[40:43], v[80:95]
    ds_read_b128 v[56:59], v4 offset:38912
    v_mfma_f32_32x32x16_bf16 v[112:127], v[36:39], v[44:47], v[112:127]
    v_mfma_f32_4x4x4_16b_bf16 v[20:23], v[38:39], v[38:39], v[20:23]
    ds_read_b128 v[60:63], v4 offset:39936
    v_mfma_f32_32x32x16_bf16 v[144:159], v[44:47], v[36:39], v[144:159]
    s_waitcnt vmcnt(12)
    s_barrier
    s_waitcnt lgkmcnt(0)
    v_mfma_f32_32x32x16_bf16 v[64:79], v[48:51], v[56:59], v[64:79]
    v_mfma_f32_4x4x4_16b_bf16 v[20:23], v[52:53], v[52:53], v[20:23]
    s_lshl_b32 s28, s13, 12
    s_mov_b32 m0, s28
    s_add_u32 s29, s24, 512
    buffer_load_dwordx4 v2, s[16:19], s29 offen offset:0 lds
    v_mfma_f32_32x32x16_bf16 v[96:111], v[48:51], v[60:63], v[96:111]
    ds_read_b128 v[32:35], v10 offset:0
    s_add_u32 s29, s29, 9216
    buffer_load_dwordx4 v3, s[16:19], s29 offen offset:1024 lds
    v_mfma_f32_32x32x16_bf16 v[128:143], v[60:63], v[48:51], v[128:143]
    ds_read_b128 v[36:39], v10 offset:4096
    s_add_u32 s29, s29, 9216
    buffer_load_dwordx4 v2, s[16:19], s29 offen offset:2048 lds
    v_mfma_f32_32x32x16_bf16 v[80:95], v[52:55], v[56:59], v[80:95]
    ds_read_b128 v[40:43], v5 offset:0
    s_add_u32 s29, s29, 9216
    buffer_load_dwordx4 v3, s[16:19], s29 offen offset:3072 lds
    v_mfma_f32_32x32x16_bf16 v[112:127], v[52:55], v[60:63], v[112:127]
    v_mfma_f32_4x4x4_16b_bf16 v[20:23], v[54:55], v[54:55], v[20:23]
    ds_read_b128 v[44:47], v5 offset:1024
    s_add_u32 s28, s28, 16384
    s_mov_b32 m0, s28
    s_add_u32 s29, s25, 32768
    buffer_load_dwordx4 v1, s[8:11], s29 offen offset:0 lds
    v_mfma_f32_32x32x16_bf16 v[144:159], v[60:63], v[52:55], v[144:159]
    buffer_load_dwordx4 v1, s[8:11], s29 offen offset:1024 lds
    s_waitcnt lgkmcnt(0)
    v_mfma_f32_32x32x16_bf16 v[64:79], v[32:35], v[40:43], v[64:79]
    v_mfma_f32_4x4x4_16b_bf16 v[20:23], v[36:37], v[36:37], v[20:23]
    buffer_load_dwordx4 v1, s[8:11], s29 offen offset:2048 lds
    v_mfma_f32_32x32x16_bf16 v[96:111], v[32:35], v[44:47], v[96:111]
    ds_read_b128 v[48:51], v11 offset:0
    buffer_load_dwordx4 v1, s[8:11], s29 offen offset:3072 lds
    v_mfma_f32_32x32x16_bf16 v[128:143], v[44:47], v[32:35], v[128:143]
    ds_read_b128 v[52:55], v11 offset:4096
    s_bfe_u32 s41, s50, 524304
    s_mul_i32 s41, s41, s40
    s_add_u32 s42, s58, s41
    s_add_u32 s43, s59, s41
    buffer_load_dwordx4 a[16:19], v240, s[8:11], s42 offen
    v_mfma_f32_32x32x16_bf16 v[80:95], v[36:39], v[40:43], v[80:95]
    ds_read_b128 v[56:59], v5 offset:2048
    buffer_load_dwordx4 a[20:23], v241, s[8:11], s43 offen
    v_mfma_f32_32x32x16_bf16 v[112:127], v[36:39], v[44:47], v[112:127]
    v_mfma_f32_4x4x4_16b_bf16 v[20:23], v[38:39], v[38:39], v[20:23]
    ds_read_b128 v[60:63], v5 offset:3072
    s_bfe_u32 s41, s50, 524312
    s_mul_i32 s41, s41, s40
    s_add_u32 s42, s58, s41
    s_add_u32 s43, s59, s41
    buffer_load_dwordx4 a[24:27], v240, s[8:11], s42 offen
    v_mfma_f32_32x32x16_bf16 v[144:159], v[44:47], v[36:39], v[144:159]
    buffer_load_dwordx4 a[28:31], v241, s[8:11], s43 offen
    s_waitcnt lgkmcnt(0)
    v_mfma_f32_32x32x16_bf16 v[64:79], v[48:51], v[56:59], v[64:79]
    v_mfma_f32_4x4x4_16b_bf16 v[20:23], v[52:53], v[52:53], v[20:23]
    v_mfma_f32_32x32x16_bf16 v[96:111], v[48:51], v[60:63], v[96:111]
    ds_read_b128 v[32:35], v12 offset:0
    v_mfma_f32_32x32x16_bf16 v[128:143], v[60:63], v[48:51], v[128:143]
    ds_read_b128 v[36:39], v12 offset:4096
    v_mfma_f32_32x32x16_bf16 v[80:95], v[52:55], v[56:59], v[80:95]
    ds_read_b128 v[40:43], v5 offset:4096
    v_mfma_f32_32x32x16_bf16 v[112:127], v[52:55], v[60:63], v[112:127]
    v_mfma_f32_4x4x4_16b_bf16 v[20:23], v[54:55], v[54:55], v[20:23]
    ds_read_b128 v[44:47], v5 offset:5120
    v_mfma_f32_32x32x16_bf16 v[144:159], v[60:63], v[52:55], v[144:159]
    s_waitcnt lgkmcnt(0)
    v_mfma_f32_32x32x16_bf16 v[64:79], v[32:35], v[40:43], v[64:79]
    v_mfma_f32_4x4x4_16b_bf16 v[20:23], v[36:37], v[36:37], v[20:23]
    v_mfma_f32_32x32x16_bf16 v[96:111], v[32:35], v[44:47], v[96:111]
    ds_read_b128 v[48:51], v13 offset:0
    v_mfma_f32_32x32x16_bf16 v[128:143], v[44:47], v[32:35], v[128:143]
    ds_read_b128 v[52:55], v13 offset:4096
    v_mfma_f32_32x32x16_bf16 v[80:95], v[36:39], v[40:43], v[80:95]
    ds_read_b128 v[56:59], v5 offset:6144
    v_mfma_f32_32x32x16_bf16 v[112:127], v[36:39], v[44:47], v[112:127]
    v_mfma_f32_4x4x4_16b_bf16 v[20:23], v[38:39], v[38:39], v[20:23]
    ds_read_b128 v[60:63], v5 offset:7168
    v_mfma_f32_32x32x16_bf16 v[144:159], v[44:47], v[36:39], v[144:159]
    s_waitcnt vmcnt(16)
    s_barrier
    s_waitcnt lgkmcnt(0)
    v_mfma_f32_32x32x16_bf16 v[64:79], v[48:51], v[56:59], v[64:79]
    v_mfma_f32_4x4x4_16b_bf16 v[20:23], v[52:53], v[52:53], v[20:23]
    s_lshl_b32 s28, s13, 12
    s_add_u32 s28, s28, 32768
    s_mov_b32 m0, s28
    s_add_u32 s29, s24, 640
    buffer_load_dwordx4 v2, s[16:19], s29 offen offset:0 lds
    v_mfma_f32_32x32x16_bf16 v[96:111], v[48:51], v[60:63], v[96:111]
    ds_read_b128 v[32:35], v10 offset:32768
    s_add_u32 s29, s29, 9216
    buffer_load_dwordx4 v3, s[16:19], s29 offen offset:1024 lds
    v_mfma_f32_32x32x16_bf16 v[128:143], v[60:63], v[48:51], v[128:143]
    ds_read_b128 v[36:39], v10 offset:36864
    s_add_u32 s29, s29, 9216
    buffer_load_dwordx4 v2, s[16:19], s29 offen offset:2048 lds
    v_mfma_f32_32x32x16_bf16 v[80:95], v[52:55], v[56:59], v[80:95]
    ds_read_b128 v[40:43], v5 offset:32768
    s_add_u32 s29, s29, 9216
    buffer_load_dwordx4 v3, s[16:19], s29 offen offset:3072 lds
    v_mfma_f32_32x32x16_bf16 v[112:127], v[52:55], v[60:63], v[112:127]
    v_mfma_f32_4x4x4_16b_bf16 v[20:23], v[54:55], v[54:55], v[20:23]
    ds_read_b128 v[44:47], v5 offset:33792
    s_add_u32 s28, s28, 16384
    s_mov_b32 m0, s28
    s_add_u32 s29, s25, 40960
    buffer_load_dwordx4 v1, s[8:11], s29 offen offset:0 lds
    v_mfma_f32_32x32x16_bf16 v[144:159], v[60:63], v[52:55], v[144:159]
    buffer_load_dwordx4 v1, s[8:11], s29 offen offset:1024 lds
    s_waitcnt lgkmcnt(0)
    v_mfma_f32_32x32x16_bf16 v[64:79], v[32:35], v[40:43], v[64:79]
    v_mfma_f32_4x4x4_16b_bf16 v[20:23], v[36:37], v[36:37], v[20:23]
    buffer_load_dwordx4 v1, s[8:11], s29 offen offset:2048 lds
    v_mfma_f32_32x32x16_bf16 v[96:111], v[32:35], v[44:47], v[96:111]
    ds_read_b128 v[48:51], v11 offset:32768
    buffer_load_dwordx4 v1, s[8:11], s29 offen offset:3072 lds
    v_mfma_f32_32x32x16_bf16 v[128:143], v[44:47], v[32:35], v[128:143]
    ds_read_b128 v[52:55], v11 offset:36864
    s_bfe_u32 s41, s51, 524288
    s_mul_i32 s41, s41, s40
    s_add_u32 s42, s58, s41
    s_add_u32 s43, s59, s41
    buffer_load_dwordx4 a[32:35], v240, s[8:11], s42 offen
    v_mfma_f32_32x32x16_bf16 v[80:95], v[36:39], v[40:43], v[80:95]
    ds_read_b128 v[56:59], v5 offset:34816
    buffer_load_dwordx4 a[36:39], v241, s[8:11], s43 offen
    v_mfma_f32_32x32x16_bf16 v[112:127], v[36:39], v[44:47], v[112:127]
    v_mfma_f32_4x4x4_16b_bf16 v[20:23], v[38:39], v[38:39], v[20:23]
    ds_read_b128 v[60:63], v5 offset:35840
    s_bfe_u32 s41, s51, 524296
    s_mul_i32 s41, s41, s40
    s_add_u32 s42, s58, s41
    s_add_u32 s43, s59, s41
    buffer_load_dwordx4 a[40:43], v240, s[8:11], s42 offen
    v_mfma_f32_32x32x16_bf16 v[144:159], v[44:47], v[36:39], v[144:159]
    buffer_load_dwordx4 a[44:47], v241, s[8:11], s43 offen
    s_waitcnt lgkmcnt(0)
    v_mfma_f32_32x32x16_bf16 v[64:79], v[48:51], v[56:59], v[64:79]
    v_mfma_f32_4x4x4_16b_bf16 v[20:23], v[52:53], v[52:53], v[20:23]
    v_mfma_f32_32x32x16_bf16 v[96:111], v[48:51], v[60:63], v[96:111]
    ds_read_b128 v[32:35], v12 offset:32768
    v_mfma_f32_32x32x16_bf16 v[128:143], v[60:63], v[48:51], v[128:143]
    ds_read_b128 v[36:39], v12 offset:36864
    v_mfma_f32_32x32x16_bf16 v[80:95], v[52:55], v[56:59], v[80:95]
    ds_read_b128 v[40:43], v5 offset:36864
    v_mfma_f32_32x32x16_bf16 v[112:127], v[52:55], v[60:63], v[112:127]
    v_mfma_f32_4x4x4_16b_bf16 v[20:23], v[54:55], v[54:55], v[20:23]
    ds_read_b128 v[44:47], v5 offset:37888
    v_mfma_f32_32x32x16_bf16 v[144:159], v[60:63], v[52:55], v[144:159]
    s_waitcnt lgkmcnt(0)
    v_mfma_f32_32x32x16_bf16 v[64:79], v[32:35], v[40:43], v[64:79]
    v_mfma_f32_4x4x4_16b_bf16 v[20:23], v[36:37], v[36:37], v[20:23]
    v_mfma_f32_32x32x16_bf16 v[96:111], v[32:35], v[44:47], v[96:111]
    ds_read_b128 v[48:51], v13 offset:32768
    v_mfma_f32_32x32x16_bf16 v[128:143], v[44:47], v[32:35], v[128:143]
    ds_read_b128 v[52:55], v13 offset:36864
    v_mfma_f32_32x32x16_bf16 v[80:95], v[36:39], v[40:43], v[80:95]
    ds_read_b128 v[56:59], v5 offset:38912
    v_mfma_f32_32x32x16_bf16 v[112:127], v[36:39], v[44:47], v[112:127]
    v_mfma_f32_4x4x4_16b_bf16 v[20:23], v[38:39], v[38:39], v[20:23]
    ds_read_b128 v[60:63], v5 offset:39936
    v_mfma_f32_32x32x16_bf16 v[144:159], v[44:47], v[36:39], v[144:159]
    s_waitcnt vmcnt(16)
    s_barrier
    s_waitcnt lgkmcnt(0)
    v_mfma_f32_32x32x16_bf16 v[64:79], v[48:51], v[56:59], v[64:79]
    v_mfma_f32_4x4x4_16b_bf16 v[20:23], v[52:53], v[52:53], v[20:23]
    s_lshl_b32 s28, s13, 12
    s_add_u32 s28, s28, 65536
    s_mov_b32 m0, s28
    s_add_u32 s29, s24, 768
    buffer_load_dwordx4 v2, s[16:19], s29 offen offset:0 lds
    v_mfma_f32_32x32x16_bf16 v[96:111], v[48:51], v[60:63], v[96:111]
    ds_read_b128 v[32:35], v6 offset:0
    s_add_u32 s29, s29, 9216
    buffer_load_dwordx4 v3, s[16:19], s29 offen offset:1024 lds
    v_mfma_f32_32x32x16_bf16 v[128:143], v[60:63], v[48:51], v[128:143]
    ds_read_b128 v[36:39], v6 offset:4096
    s_add_u32 s29, s29, 9216
    buffer_load_dwordx4 v2, s[16:19], s29 offen offset:2048 lds
    v_mfma_f32_32x32x16_bf16 v[80:95], v[52:55], v[56:59], v[80:95]
    ds_read_b128 v[40:43], v4 offset:0
    s_add_u32 s29, s29, 9216
    buffer_load_dwordx4 v3, s[16:19], s29 offen offset:3072 lds
    v_mfma_f32_32x32x16_bf16 v[112:127], v[52:55], v[60:63], v[112:127]
    v_mfma_f32_4x4x4_16b_bf16 v[20:23], v[54:55], v[54:55], v[20:23]
    ds_read_b128 v[44:47], v4 offset:1024
    s_add_u32 s28, s28, 16384
    s_mov_b32 m0, s28
    s_add_u32 s29, s25, 49152
    buffer_load_dwordx4 v1, s[8:11], s29 offen offset:0 lds
    v_mfma_f32_32x32x16_bf16 v[144:159], v[60:63], v[52:55], v[144:159]
    buffer_load_dwordx4 v1, s[8:11], s29 offen offset:1024 lds
    s_waitcnt lgkmcnt(0)
    v_mfma_f32_32x32x16_bf16 v[64:79], v[32:35], v[40:43], v[64:79]
    v_mfma_f32_4x4x4_16b_bf16 v[20:23], v[36:37], v[36:37], v[20:23]
    buffer_load_dwordx4 v1, s[8:11], s29 offen offset:2048 lds
    v_mfma_f32_32x32x16_bf16 v[96:111], v[32:35], v[44:47], v[96:111]
    ds_read_b128 v[48:51], v7 offset:0
    buffer_load_dwordx4 v1, s[8:11], s29 offen offset:3072 lds
    v_mfma_f32_32x32x16_bf16 v[128:143], v[44:47], v[32:35], v[128:143]
    ds_read_b128 v[52:55], v7 offset:4096
    s_bfe_u32 s41, s51, 524304
    s_mul_i32 s41, s41, s40
    s_add_u32 s42, s58, s41
    s_add_u32 s43, s59, s41
    buffer_load_dwordx4 a[48:51], v240, s[8:11], s42 offen
    v_mfma_f32_32x32x16_bf16 v[80:95], v[36:39], v[40:43], v[80:95]
    ds_read_b128 v[56:59], v4 offset:2048
    buffer_load_dwordx4 a[52:55], v241, s[8:11], s43 offen
    v_mfma_f32_32x32x16_bf16 v[112:127], v[36:39], v[44:47], v[112:127]
    v_mfma_f32_4x4x4_16b_bf16 v[20:23], v[38:39], v[38:39], v[20:23]
    ds_read_b128 v[60:63], v4 offset:3072
    s_bfe_u32 s41, s51, 524312
    s_mul_i32 s41, s41, s40
    s_add_u32 s42, s58, s41
    s_add_u32 s43, s59, s41
    buffer_load_dwordx4 a[56:59], v240, s[8:11], s42 offen
    v_mfma_f32_32x32x16_bf16 v[144:159], v[44:47], v[36:39], v[144:159]
    buffer_load_dwordx4 a[60:63], v241, s[8:11], s43 offen
    s_waitcnt lgkmcnt(0)
    v_mfma_f32_32x32x16_bf16 v[64:79], v[48:51], v[56:59], v[64:79]
    v_mfma_f32_4x4x4_16b_bf16 v[20:23], v[52:53], v[52:53], v[20:23]
    v_mfma_f32_32x32x16_bf16 v[96:111], v[48:51], v[60:63], v[96:111]
    ds_read_b128 v[32:35], v8 offset:0
    v_mfma_f32_32x32x16_bf16 v[128:143], v[60:63], v[48:51], v[128:143]
    ds_read_b128 v[36:39], v8 offset:4096
    v_mfma_f32_32x32x16_bf16 v[80:95], v[52:55], v[56:59], v[80:95]
    ds_read_b128 v[40:43], v4 offset:4096
    v_mfma_f32_32x32x16_bf16 v[112:127], v[52:55], v[60:63], v[112:127]
    v_mfma_f32_4x4x4_16b_bf16 v[20:23], v[54:55], v[54:55], v[20:23]
    ds_read_b128 v[44:47], v4 offset:5120
    v_mfma_f32_32x32x16_bf16 v[144:159], v[60:63], v[52:55], v[144:159]
    s_waitcnt lgkmcnt(0)
    v_mfma_f32_32x32x16_bf16 v[64:79], v[32:35], v[40:43], v[64:79]
    v_mfma_f32_4x4x4_16b_bf16 v[20:23], v[36:37], v[36:37], v[20:23]
    v_mfma_f32_32x32x16_bf16 v[96:111], v[32:35], v[44:47], v[96:111]
    ds_read_b128 v[48:51], v9 offset:0
    v_mfma_f32_32x32x16_bf16 v[128:143], v[44:47], v[32:35], v[128:143]
    ds_read_b128 v[52:55], v9 offset:4096
    v_mfma_f32_32x32x16_bf16 v[80:95], v[36:39], v[40:43], v[80:95]
    ds_read_b128 v[56:59], v4 offset:6144
    v_mfma_f32_32x32x16_bf16 v[112:127], v[36:39], v[44:47], v[112:127]
    v_mfma_f32_4x4x4_16b_bf16 v[20:23], v[38:39], v[38:39], v[20:23]
    ds_read_b128 v[60:63], v4 offset:7168
    v_mfma_f32_32x32x16_bf16 v[144:159], v[44:47], v[36:39], v[144:159]
    s_waitcnt vmcnt(16)
    s_barrier
    s_waitcnt lgkmcnt(0)
    v_mfma_f32_32x32x16_bf16 v[64:79], v[48:51], v[56:59], v[64:79]
    v_mfma_f32_4x4x4_16b_bf16 v[20:23], v[52:53], v[52:53], v[20:23]
    s_lshl_b32 s28, s13, 12
    s_add_u32 s28, s28, 98304
    s_mov_b32 m0, s28
    s_add_u32 s29, s24, 896
    buffer_load_dwordx4 v2, s[16:19], s29 offen offset:0 lds
    v_mfma_f32_32x32x16_bf16 v[96:111], v[48:51], v[60:63], v[96:111]
    ds_read_b128 v[32:35], v6 offset:32768
    s_add_u32 s29, s29, 9216
    buffer_load_dwordx4 v3, s[16:19], s29 offen offset:1024 lds
    v_mfma_f32_32x32x16_bf16 v[128:143], v[60:63], v[48:51], v[128:143]
    ds_read_b128 v[36:39], v6 offset:36864
    s_add_u32 s29, s29, 9216
    buffer_load_dwordx4 v2, s[16:19], s29 offen offset:2048 lds
    v_mfma_f32_32x32x16_bf16 v[80:95], v[52:55], v[56:59], v[80:95]
    ds_read_b128 v[40:43], v4 offset:32768
    s_add_u32 s29, s29, 9216
    buffer_load_dwordx4 v3, s[16:19], s29 offen offset:3072 lds
    v_mfma_f32_32x32x16_bf16 v[112:127], v[52:55], v[60:63], v[112:127]
    v_mfma_f32_4x4x4_16b_bf16 v[20:23], v[54:55], v[54:55], v[20:23]
    ds_read_b128 v[44:47], v4 offset:33792
    s_add_u32 s28, s28, 16384
    s_mov_b32 m0, s28
    s_add_u32 s29, s25, 57344
    buffer_load_dwordx4 v1, s[8:11], s29 offen offset:0 lds
    v_mfma_f32_32x32x16_bf16 v[144:159], v[60:63], v[52:55], v[144:159]
    buffer_load_dwordx4 v1, s[8:11], s29 offen offset:1024 lds
    s_waitcnt lgkmcnt(0)
    v_mfma_f32_32x32x16_bf16 v[64:79], v[32:35], v[40:43], v[64:79]
    v_mfma_f32_4x4x4_16b_bf16 v[20:23], v[36:37], v[36:37], v[20:23]
    buffer_load_dwordx4 v1, s[8:11], s29 offen offset:2048 lds
    v_mfma_f32_32x32x16_bf16 v[96:111], v[32:35], v[44:47], v[96:111]
    ds_read_b128 v[48:51], v7 offset:32768
    buffer_load_dwordx4 v1, s[8:11], s29 offen offset:3072 lds
    v_mfma_f32_32x32x16_bf16 v[128:143], v[44:47], v[32:35], v[128:143]
    ds_read_b128 v[52:55], v7 offset:36864
    s_bfe_u32 s41, s52, 524288
    s_mul_i32 s41, s41, s40
    s_add_u32 s42, s58, s41
    s_add_u32 s43, s59, s41
    buffer_load_dwordx4 a[64:67], v240, s[8:11], s42 offen
    v_mfma_f32_32x32x16_bf16 v[80:95], v[36:39], v[40:43], v[80:95]
    ds_read_b128 v[56:59], v4 offset:34816
    buffer_load_dwordx4 a[68:71], v241, s[8:11], s43 offen
    v_mfma_f32_32x32x16_bf16 v[112:127], v[36:39], v[44:47], v[112:127]
    v_mfma_f32_4x4x4_16b_bf16 v[20:23], v[38:39], v[38:39], v[20:23]
    ds_read_b128 v[60:63], v4 offset:35840
    s_bfe_u32 s41, s52, 524296
    s_mul_i32 s41, s41, s40
    s_add_u32 s42, s58, s41
    s_add_u32 s43, s59, s41
    buffer_load_dwordx4 a[72:75], v240, s[8:11], s42 offen
    v_mfma_f32_32x32x16_bf16 v[144:159], v[44:47], v[36:39], v[144:159]
    buffer_load_dwordx4 a[76:79], v241, s[8:11], s43 offen
    s_waitcnt lgkmcnt(0)
    v_mfma_f32_32x32x16_bf16 v[64:79], v[48:51], v[56:59], v[64:79]
    v_mfma_f32_4x4x4_16b_bf16 v[20:23], v[52:53], v[52:53], v[20:23]
    v_mfma_f32_32x32x16_bf16 v[96:111], v[48:51], v[60:63], v[96:111]
    ds_read_b128 v[32:35], v8 offset:32768
    v_mfma_f32_32x32x16_bf16 v[128:143], v[60:63], v[48:51], v[128:143]
    ds_read_b128 v[36:39], v8 offset:36864
    v_mfma_f32_32x32x16_bf16 v[80:95], v[52:55], v[56:59], v[80:95]
    ds_read_b128 v[40:43], v4 offset:36864
    v_mfma_f32_32x32x16_bf16 v[112:127], v[52:55], v[60:63], v[112:127]
    v_mfma_f32_4x4x4_16b_bf16 v[20:23], v[54:55], v[54:55], v[20:23]
    ds_read_b128 v[44:47], v4 offset:37888
    v_mfma_f32_32x32x16_bf16 v[144:159], v[60:63], v[52:55], v[144:159]
    s_waitcnt lgkmcnt(0)
    v_mfma_f32_32x32x16_bf16 v[64:79], v[32:35], v[40:43], v[64:79]
    v_mfma_f32_4x4x4_16b_bf16 v[20:23], v[36:37], v[36:37], v[20:23]
    v_mfma_f32_32x32x16_bf16 v[96:111], v[32:35], v[44:47], v[96:111]
    ds_read_b128 v[48:51], v9 offset:32768
    v_mfma_f32_32x32x16_bf16 v[128:143], v[44:47], v[32:35], v[128:143]
    ds_read_b128 v[52:55], v9 offset:36864
    v_mfma_f32_32x32x16_bf16 v[80:95], v[36:39], v[40:43], v[80:95]
    ds_read_b128 v[56:59], v4 offset:38912
    v_mfma_f32_32x32x16_bf16 v[112:127], v[36:39], v[44:47], v[112:127]
    v_mfma_f32_4x4x4_16b_bf16 v[20:23], v[38:39], v[38:39], v[20:23]
    ds_read_b128 v[60:63], v4 offset:39936
    v_mfma_f32_32x32x16_bf16 v[144:159], v[44:47], v[36:39], v[144:159]
    s_waitcnt vmcnt(16)
    s_barrier
    s_waitcnt lgkmcnt(0)
    v_mfma_f32_32x32x16_bf16 v[64:79], v[48:51], v[56:59], v[64:79]
    v_mfma_f32_4x4x4_16b_bf16 v[20:23], v[52:53], v[52:53], v[20:23]
    s_lshl_b32 s28, s13, 12
    s_mov_b32 m0, s28
    s_add_u32 s29, s24, 1024
    buffer_load_dwordx4 v2, s[16:19], s29 offen offset:0 lds
    v_mfma_f32_32x32x16_bf16 v[96:111], v[48:51], v[60:63], v[96:111]
    ds_read_b128 v[32:35], v10 offset:0
    s_add_u32 s29, s29, 9216
    buffer_load_dwordx4 v3, s[16:19], s29 offen offset:1024 lds
    v_mfma_f32_32x32x16_bf16 v[128:143], v[60:63], v[48:51], v[128:143]
    ds_read_b128 v[36:39], v10 offset:4096
    s_add_u32 s29, s29, 9216
    buffer_load_dwordx4 v2, s[16:19], s29 offen offset:2048 lds
    v_mfma_f32_32x32x16_bf16 v[80:95], v[52:55], v[56:59], v[80:95]
    ds_read_b128 v[40:43], v5 offset:0
    s_add_u32 s29, s29, 9216
    buffer_load_dwordx4 v3, s[16:19], s29 offen offset:3072 lds
    v_mfma_f32_32x32x16_bf16 v[112:127], v[52:55], v[60:63], v[112:127]
    v_mfma_f32_4x4x4_16b_bf16 v[20:23], v[54:55], v[54:55], v[20:23]
    ds_read_b128 v[44:47], v5 offset:1024
    s_add_u32 s28, s28, 16384
    s_mov_b32 m0, s28
    s_add_u32 s29, s25, 65536
    buffer_load_dwordx4 v1, s[8:11], s29 offen offset:0 lds
    v_mfma_f32_32x32x16_bf16 v[144:159], v[60:63], v[52:55], v[144:159]
    buffer_load_dwordx4 v1, s[8:11], s29 offen offset:1024 lds
    s_waitcnt lgkmcnt(0)
    v_mfma_f32_32x32x16_bf16 v[64:79], v[32:35], v[40:43], v[64:79]
    v_mfma_f32_4x4x4_16b_bf16 v[20:23], v[36:37], v[36:37], v[20:23]
    buffer_load_dwordx4 v1, s[8:11], s29 offen offset:2048 lds
    v_mfma_f32_32x32x16_bf16 v[96:111], v[32:35], v[44:47], v[96:111]
    ds_read_b128 v[48:51], v11 offset:0
    buffer_load_dwordx4 v1, s[8:11], s29 offen offset:3072 lds
    v_mfma_f32_32x32x16_bf16 v[128:143], v[44:47], v[32:35], v[128:143]
    ds_read_b128 v[52:55], v11 offset:4096
    s_bfe_u32 s41, s52, 524304
    s_mul_i32 s41, s41, s40
    s_add_u32 s42, s58, s41
    s_add_u32 s43, s59, s41
    buffer_load_dwordx4 a[80:83], v240, s[8:11], s42 offen
    v_mfma_f32_32x32x16_bf16 v[80:95], v[36:39], v[40:43], v[80:95]
    ds_read_b128 v[56:59], v5 offset:2048
    buffer_load_dwordx4 a[84:87], v241, s[8:11], s43 offen
    v_mfma_f32_32x32x16_bf16 v[112:127], v[36:39], v[44:47], v[112:127]
    v_mfma_f32_4x4x4_16b_bf16 v[20:23], v[38:39], v[38:39], v[20:23]
    ds_read_b128 v[60:63], v5 offset:3072
    s_bfe_u32 s41, s52, 524312
    s_mul_i32 s41, s41, s40
    s_add_u32 s42, s58, s41
    s_add_u32 s43, s59, s41
    buffer_load_dwordx4 a[88:91], v240, s[8:11], s42 offen
    v_mfma_f32_32x32x16_bf16 v[144:159], v[44:47], v[36:39], v[144:159]
    buffer_load_dwordx4 a[92:95], v241, s[8:11], s43 offen
    s_waitcnt lgkmcnt(0)
    v_mfma_f32_32x32x16_bf16 v[64:79], v[48:51], v[56:59], v[64:79]
    v_mfma_f32_4x4x4_16b_bf16 v[20:23], v[52:53], v[52:53], v[20:23]
    v_mfma_f32_32x32x16_bf16 v[96:111], v[48:51], v[60:63], v[96:111]
    ds_read_b128 v[32:35], v12 offset:0
    v_mfma_f32_32x32x16_bf16 v[128:143], v[60:63], v[48:51], v[128:143]
    ds_read_b128 v[36:39], v12 offset:4096
    v_mfma_f32_32x32x16_bf16 v[80:95], v[52:55], v[56:59], v[80:95]
    ds_read_b128 v[40:43], v5 offset:4096
    v_mfma_f32_32x32x16_bf16 v[112:127], v[52:55], v[60:63], v[112:127]
    v_mfma_f32_4x4x4_16b_bf16 v[20:23], v[54:55], v[54:55], v[20:23]
    ds_read_b128 v[44:47], v5 offset:5120
    v_mfma_f32_32x32x16_bf16 v[144:159], v[60:63], v[52:55], v[144:159]
    s_waitcnt lgkmcnt(0)
    v_mfma_f32_32x32x16_bf16 v[64:79], v[32:35], v[40:43], v[64:79]
    v_mfma_f32_4x4x4_16b_bf16 v[20:23], v[36:37], v[36:37], v[20:23]
    v_mfma_f32_32x32x16_bf16 v[96:111], v[32:35], v[44:47], v[96:111]
    ds_read_b128 v[48:51], v13 offset:0
    v_mfma_f32_32x32x16_bf16 v[128:143], v[44:47], v[32:35], v[128:143]
    ds_read_b128 v[52:55], v13 offset:4096
    v_mfma_f32_32x32x16_bf16 v[80:95], v[36:39], v[40:43], v[80:95]
    ds_read_b128 v[56:59], v5 offset:6144
    v_mfma_f32_32x32x16_bf16 v[112:127], v[36:39], v[44:47], v[112:127]
    v_mfma_f32_4x4x4_16b_bf16 v[20:23], v[38:39], v[38:39], v[20:23]
    ds_read_b128 v[60:63], v5 offset:7168
    v_mfma_f32_32x32x16_bf16 v[144:159], v[44:47], v[36:39], v[144:159]
    s_waitcnt vmcnt(16)
    s_barrier
    s_waitcnt lgkmcnt(0)
    v_mfma_f32_32x32x16_bf16 v[64:79], v[48:51], v[56:59], v[64:79]
    v_mfma_f32_4x4x4_16b_bf16 v[20:23], v[52:53], v[52:53], v[20:23]
    s_lshl_b32 s28, s13, 12
    s_add_u32 s28, s28, 32768
    s_mov_b32 m0, s28
    s_add_u32 s29, s24, 1152
    buffer_load_dwordx4 v2, s[16:19], s29 offen offset:0 lds
    v_mfma_f32_32x32x16_bf16 v[96:111], v[48:51], v[60:63], v[96:111]
    ds_read_b128 v[32:35], v10 offset:32768
    s_add_u32 s29, s29, 9216
    buffer_load_dwordx4 v3, s[16:19], s29 offen offset:1024 lds
    v_mfma_f32_32x32x16_bf16 v[128:143], v[60:63], v[48:51], v[128:143]
    ds_read_b128 v[36:39], v10 offset:36864
    s_add_u32 s29, s29, 9216
    buffer_load_dwordx4 v2, s[16:19], s29 offen offset:2048 lds
    v_mfma_f32_32x32x16_bf16 v[80:95], v[52:55], v[56:59], v[80:95]
    ds_read_b128 v[40:43], v5 offset:32768
    s_add_u32 s29, s29, 9216
    buffer_load_dwordx4 v3, s[16:19], s29 offen offset:3072 lds
    v_mfma_f32_32x32x16_bf16 v[112:127], v[52:55], v[60:63], v[112:127]
    v_mfma_f32_4x4x4_16b_bf16 v[20:23], v[54:55], v[54:55], v[20:23]
    ds_read_b128 v[44:47], v5 offset:33792
    s_add_u32 s28, s28, 16384
    s_mov_b32 m0, s28
    s_add_u32 s29, s25, 73728
    buffer_load_dwordx4 v1, s[8:11], s29 offen offset:0 lds
    v_mfma_f32_32x32x16_bf16 v[144:159], v[60:63], v[52:55], v[144:159]
    buffer_load_dwordx4 v1, s[8:11], s29 offen offset:1024 lds
    s_waitcnt lgkmcnt(0)
    v_mfma_f32_32x32x16_bf16 v[64:79], v[32:35], v[40:43], v[64:79]
    v_mfma_f32_4x4x4_16b_bf16 v[20:23], v[36:37], v[36:37], v[20:23]
    buffer_load_dwordx4 v1, s[8:11], s29 offen offset:2048 lds
    v_mfma_f32_32x32x16_bf16 v[96:111], v[32:35], v[44:47], v[96:111]
    ds_read_b128 v[48:51], v11 offset:32768
    buffer_load_dwordx4 v1, s[8:11], s29 offen offset:3072 lds
    v_mfma_f32_32x32x16_bf16 v[128:143], v[44:47], v[32:35], v[128:143]
    ds_read_b128 v[52:55], v11 offset:36864
    s_bfe_u32 s41, s53, 524288
    s_mul_i32 s41, s41, s40
    s_add_u32 s42, s58, s41
    s_add_u32 s43, s59, s41
    buffer_load_dwordx4 a[96:99], v240, s[8:11], s42 offen
    v_mfma_f32_32x32x16_bf16 v[80:95], v[36:39], v[40:43], v[80:95]
    ds_read_b128 v[56:59], v5 offset:34816
    buffer_load_dwordx4 a[100:103], v241, s[8:11], s43 offen
    v_mfma_f32_32x32x16_bf16 v[112:127], v[36:39], v[44:47], v[112:127]
    v_mfma_f32_4x4x4_16b_bf16 v[20:23], v[38:39], v[38:39], v[20:23]
    ds_read_b128 v[60:63], v5 offset:35840
    s_bfe_u32 s41, s53, 524296
    s_mul_i32 s41, s41, s40
    s_add_u32 s42, s58, s41
    s_add_u32 s43, s59, s41
    buffer_load_dwordx4 a[104:107], v240, s[8:11], s42 offen
    v_mfma_f32_32x32x16_bf16 v[144:159], v[44:47], v[36:39], v[144:159]
    buffer_load_dwordx4 a[108:111], v241, s[8:11], s43 offen
    s_waitcnt lgkmcnt(0)
    v_mfma_f32_32x32x16_bf16 v[64:79], v[48:51], v[56:59], v[64:79]
    v_mfma_f32_4x4x4_16b_bf16 v[20:23], v[52:53], v[52:53], v[20:23]
    v_mfma_f32_32x32x16_bf16 v[96:111], v[48:51], v[60:63], v[96:111]
    ds_read_b128 v[32:35], v12 offset:32768
    v_mfma_f32_32x32x16_bf16 v[128:143], v[60:63], v[48:51], v[128:143]
    ds_read_b128 v[36:39], v12 offset:36864
    v_mfma_f32_32x32x16_bf16 v[80:95], v[52:55], v[56:59], v[80:95]
    ds_read_b128 v[40:43], v5 offset:36864
    v_mfma_f32_32x32x16_bf16 v[112:127], v[52:55], v[60:63], v[112:127]
    v_mfma_f32_4x4x4_16b_bf16 v[20:23], v[54:55], v[54:55], v[20:23]
    ds_read_b128 v[44:47], v5 offset:37888
    v_mfma_f32_32x32x16_bf16 v[144:159], v[60:63], v[52:55], v[144:159]
    s_waitcnt lgkmcnt(0)
    v_mfma_f32_32x32x16_bf16 v[64:79], v[32:35], v[40:43], v[64:79]
    v_mfma_f32_4x4x4_16b_bf16 v[20:23], v[36:37], v[36:37], v[20:23]
    v_mfma_f32_32x32x16_bf16 v[96:111], v[32:35], v[44:47], v[96:111]
    ds_read_b128 v[48:51], v13 offset:32768
    v_mfma_f32_32x32x16_bf16 v[128:143], v[44:47], v[32:35], v[128:143]
    ds_read_b128 v[52:55], v13 offset:36864
    v_mfma_f32_32x32x16_bf16 v[80:95], v[36:39], v[40:43], v[80:95]
    ds_read_b128 v[56:59], v5 offset:38912
    v_mfma_f32_32x32x16_bf16 v[112:127], v[36:39], v[44:47], v[112:127]
    v_mfma_f32_4x4x4_16b_bf16 v[20:23], v[38:39], v[38:39], v[20:23]
    ds_read_b128 v[60:63], v5 offset:39936
    v_mfma_f32_32x32x16_bf16 v[144:159], v[44:47], v[36:39], v[144:159]
    s_waitcnt vmcnt(16)
    s_barrier
    s_waitcnt lgkmcnt(0)
    v_mfma_f32_32x32x16_bf16 v[64:79], v[48:51], v[56:59], v[64:79]
    v_mfma_f32_4x4x4_16b_bf16 v[20:23], v[52:53], v[52:53], v[20:23]
    s_bfe_u32 s41, s53, 524304
    s_mul_i32 s41, s41, s40
    s_add_u32 s42, s58, s41
    s_add_u32 s43, s59, s41
    buffer_load_dwordx4 a[112:115], v240, s[8:11], s42 offen
    v_mfma_f32_32x32x16_bf16 v[96:111], v[48:51], v[60:63], v[96:111]
    ds_read_b128 v[32:35], v6 offset:0
    buffer_load_dwordx4 a[116:119], v241, s[8:11], s43 offen
    v_mfma_f32_32x32x16_bf16 v[128:143], v[60:63], v[48:51], v[128:143]
    ds_read_b128 v[36:39], v6 offset:4096
    s_bfe_u32 s41, s53, 524312
    s_mul_i32 s41, s41, s40
    s_add_u32 s42, s58, s41
    s_add_u32 s43, s59, s41
    buffer_load_dwordx4 a[120:123], v240, s[8:11], s42 offen
    v_mfma_f32_32x32x16_bf16 v[80:95], v[52:55], v[56:59], v[80:95]
    ds_read_b128 v[40:43], v4 offset:0
    buffer_load_dwordx4 a[124:127], v241, s[8:11], s43 offen
    v_mfma_f32_32x32x16_bf16 v[112:127], v[52:55], v[60:63], v[112:127]
    v_mfma_f32_4x4x4_16b_bf16 v[20:23], v[54:55], v[54:55], v[20:23]
    ds_read_b128 v[44:47], v4 offset:1024
    v_mfma_f32_32x32x16_bf16 v[144:159], v[60:63], v[52:55], v[144:159]
    s_waitcnt lgkmcnt(0)
    v_mfma_f32_32x32x16_bf16 v[64:79], v[32:35], v[40:43], v[64:79]
    v_mfma_f32_4x4x4_16b_bf16 v[20:23], v[36:37], v[36:37], v[20:23]
    v_mfma_f32_32x32x16_bf16 v[96:111], v[32:35], v[44:47], v[96:111]
    ds_read_b128 v[48:51], v7 offset:0
    v_mfma_f32_32x32x16_bf16 v[128:143], v[44:47], v[32:35], v[128:143]
    ds_read_b128 v[52:55], v7 offset:4096
    v_mfma_f32_32x32x16_bf16 v[80:95], v[36:39], v[40:43], v[80:95]
    ds_read_b128 v[56:59], v4 offset:2048
    v_mfma_f32_32x32x16_bf16 v[112:127], v[36:39], v[44:47], v[112:127]
    v_mfma_f32_4x4x4_16b_bf16 v[20:23], v[38:39], v[38:39], v[20:23]
    ds_read_b128 v[60:63], v4 offset:3072
    v_mfma_f32_32x32x16_bf16 v[144:159], v[44:47], v[36:39], v[144:159]
    s_waitcnt lgkmcnt(0)
    v_mfma_f32_32x32x16_bf16 v[64:79], v[48:51], v[56:59], v[64:79]
    v_mfma_f32_4x4x4_16b_bf16 v[20:23], v[52:53], v[52:53], v[20:23]
    v_mfma_f32_32x32x16_bf16 v[96:111], v[48:51], v[60:63], v[96:111]
    ds_read_b128 v[32:35], v8 offset:0
    v_mfma_f32_32x32x16_bf16 v[128:143], v[60:63], v[48:51], v[128:143]
    ds_read_b128 v[36:39], v8 offset:4096
    v_mfma_f32_32x32x16_bf16 v[80:95], v[52:55], v[56:59], v[80:95]
    ds_read_b128 v[40:43], v4 offset:4096
    v_mfma_f32_32x32x16_bf16 v[112:127], v[52:55], v[60:63], v[112:127]
    v_mfma_f32_4x4x4_16b_bf16 v[20:23], v[54:55], v[54:55], v[20:23]
    ds_read_b128 v[44:47], v4 offset:5120
    v_mfma_f32_32x32x16_bf16 v[144:159], v[60:63], v[52:55], v[144:159]
    s_waitcnt lgkmcnt(0)
    v_mfma_f32_32x32x16_bf16 v[64:79], v[32:35], v[40:43], v[64:79]
    v_mfma_f32_4x4x4_16b_bf16 v[20:23], v[36:37], v[36:37], v[20:23]
    v_mfma_f32_32x32x16_bf16 v[96:111], v[32:35], v[44:47], v[96:111]
    ds_read_b128 v[48:51], v9 offset:0
    v_mfma_f32_32x32x16_bf16 v[128:143], v[44:47], v[32:35], v[128:143]
    ds_read_b128 v[52:55], v9 offset:4096
    v_mfma_f32_32x32x16_bf16 v[80:95], v[36:39], v[40:43], v[80:95]
    ds_read_b128 v[56:59], v4 offset:6144
    v_mfma_f32_32x32x16_bf16 v[112:127], v[36:39], v[44:47], v[112:127]
    v_mfma_f32_4x4x4_16b_bf16 v[20:23], v[38:39], v[38:39], v[20:23]
    ds_read_b128 v[60:63], v4 offset:7168
    v_mfma_f32_32x32x16_bf16 v[144:159], v[44:47], v[36:39], v[144:159]
    s_waitcnt vmcnt(8)
    s_barrier
    s_waitcnt lgkmcnt(0)
    v_mfma_f32_32x32x16_bf16 v[64:79], v[48:51], v[56:59], v[64:79]
    v_mfma_f32_4x4x4_16b_bf16 v[20:23], v[52:53], v[52:53], v[20:23]
    s_bfe_u32 s41, s54, 524288
    s_mul_i32 s41, s41, s40
    s_add_u32 s42, s58, s41
    s_add_u32 s43, s59, s41
    buffer_load_dwordx4 a[128:131], v240, s[8:11], s42 offen
    v_mfma_f32_32x32x16_bf16 v[96:111], v[48:51], v[60:63], v[96:111]
    ds_read_b128 v[32:35], v6 offset:32768
    buffer_load_dwordx4 a[132:135], v241, s[8:11], s43 offen
    v_mfma_f32_32x32x16_bf16 v[128:143], v[60:63], v[48:51], v[128:143]
    ds_read_b128 v[36:39], v6 offset:36864
    v_mfma_f32_32x32x16_bf16 v[80:95], v[52:55], v[56:59], v[80:95]
    ds_read_b128 v[40:43], v4 offset:32768
    v_mfma_f32_32x32x16_bf16 v[112:127], v[52:55], v[60:63], v[112:127]
    v_mfma_f32_4x4x4_16b_bf16 v[20:23], v[54:55], v[54:55], v[20:23]
    ds_read_b128 v[44:47], v4 offset:33792
    v_mfma_f32_32x32x16_bf16 v[144:159], v[60:63], v[52:55], v[144:159]
    s_waitcnt lgkmcnt(0)
    v_mfma_f32_32x32x16_bf16 v[64:79], v[32:35], v[40:43], v[64:79]
    v_mfma_f32_4x4x4_16b_bf16 v[20:23], v[36:37], v[36:37], v[20:23]
    v_mfma_f32_32x32x16_bf16 v[96:111], v[32:35], v[44:47], v[96:111]
    ds_read_b128 v[48:51], v7 offset:32768
    v_mfma_f32_32x32x16_bf16 v[128:143], v[44:47], v[32:35], v[128:143]
    ds_read_b128 v[52:55], v7 offset:36864
    v_mfma_f32_32x32x16_bf16 v[80:95], v[36:39], v[40:43], v[80:95]
    ds_read_b128 v[56:59], v4 offset:34816
    v_mfma_f32_32x32x16_bf16 v[112:127], v[36:39], v[44:47], v[112:127]
    v_mfma_f32_4x4x4_16b_bf16 v[20:23], v[38:39], v[38:39], v[20:23]
    ds_read_b128 v[60:63], v4 offset:35840
    v_mfma_f32_32x32x16_bf16 v[144:159], v[44:47], v[36:39], v[144:159]
    s_waitcnt lgkmcnt(0)
    v_mfma_f32_32x32x16_bf16 v[64:79], v[48:51], v[56:59], v[64:79]
    v_mfma_f32_4x4x4_16b_bf16 v[20:23], v[52:53], v[52:53], v[20:23]
    v_mfma_f32_32x32x16_bf16 v[96:111], v[48:51], v[60:63], v[96:111]
    ds_read_b128 v[32:35], v8 offset:32768
    v_mfma_f32_32x32x16_bf16 v[128:143], v[60:63], v[48:51], v[128:143]
    ds_read_b128 v[36:39], v8 offset:36864
    v_mfma_f32_32x32x16_bf16 v[80:95], v[52:55], v[56:59], v[80:95]
    ds_read_b128 v[40:43], v4 offset:36864
    v_mfma_f32_32x32x16_bf16 v[112:127], v[52:55], v[60:63], v[112:127]
    v_mfma_f32_4x4x4_16b_bf16 v[20:23], v[54:55], v[54:55], v[20:23]
    ds_read_b128 v[44:47], v4 offset:37888
    v_mfma_f32_32x32x16_bf16 v[144:159], v[60:63], v[52:55], v[144:159]
    s_waitcnt lgkmcnt(0)
    v_mfma_f32_32x32x16_bf16 v[64:79], v[32:35], v[40:43], v[64:79]
    v_mfma_f32_4x4x4_16b_bf16 v[20:23], v[36:37], v[36:37], v[20:23]
    v_mfma_f32_32x32x16_bf16 v[96:111], v[32:35], v[44:47], v[96:111]
    ds_read_b128 v[48:51], v9 offset:32768
    v_mfma_f32_32x32x16_bf16 v[128:143], v[44:47], v[32:35], v[128:143]
    ds_read_b128 v[52:55], v9 offset:36864
    v_mfma_f32_32x32x16_bf16 v[80:95], v[36:39], v[40:43], v[80:95]
    ds_read_b128 v[56:59], v4 offset:38912
    v_mfma_f32_32x32x16_bf16 v[112:127], v[36:39], v[44:47], v[112:127]
    v_mfma_f32_4x4x4_16b_bf16 v[20:23], v[38:39], v[38:39], v[20:23]
    ds_read_b128 v[60:63], v4 offset:39936
    v_mfma_f32_32x32x16_bf16 v[144:159], v[44:47], v[36:39], v[144:159]
    s_waitcnt lgkmcnt(0)
    v_mfma_f32_32x32x16_bf16 v[64:79], v[48:51], v[56:59], v[64:79]
    v_mfma_f32_4x4x4_16b_bf16 v[20:23], v[52:53], v[52:53], v[20:23]
    s_bfe_u32 s41, s54, 524296
    s_mul_i32 s41, s41, s40
    s_add_u32 s42, s58, s41
    s_add_u32 s43, s59, s41
    buffer_load_dwordx4 a[136:139], v240, s[8:11], s42 offen
    v_mfma_f32_32x32x16_bf16 v[96:111], v[48:51], v[60:63], v[96:111]
    buffer_load_dwordx4 a[140:143], v241, s[8:11], s43 offen
    v_mfma_f32_32x32x16_bf16 v[128:143], v[60:63], v[48:51], v[128:143]
    v_mfma_f32_32x32x16_bf16 v[80:95], v[52:55], v[56:59], v[80:95]
    v_mfma_f32_32x32x16_bf16 v[112:127], v[52:55], v[60:63], v[112:127]
    v_mfma_f32_4x4x4_16b_bf16 v[20:23], v[54:55], v[54:55], v[20:23]
    v_mfma_f32_32x32x16_bf16 v[144:159], v[60:63], v[52:55], v[144:159]
layerb1_kernel_af_epi:
    s_cmp_eq_u32 s44, 2
    s_cbranch_scc1 layerb1_kernel_pf_post
    s_bfe_u32 s41, s54, 524304
    s_mul_i32 s41, s41, s40
    s_add_u32 s42, s58, s41
    s_add_u32 s43, s59, s41
    buffer_load_dwordx4 a[144:147], v240, s[8:11], s42 offen
    buffer_load_dwordx4 a[148:151], v241, s[8:11], s43 offen
    s_bfe_u32 s41, s54, 524312
    s_mul_i32 s41, s41, s40
    s_add_u32 s42, s58, s41
    s_add_u32 s43, s59, s41
    buffer_load_dwordx4 a[152:155], v240, s[8:11], s42 offen
    buffer_load_dwordx4 a[156:159], v241, s[8:11], s43 offen
    s_bfe_u32 s41, s55, 524288
    s_mul_i32 s41, s41, s40
    s_add_u32 s42, s58, s41
    s_add_u32 s43, s59, s41
    buffer_load_dwordx4 a[160:163], v240, s[8:11], s42 offen
    buffer_load_dwordx4 a[164:167], v241, s[8:11], s43 offen
    s_bfe_u32 s41, s55, 524296
    s_mul_i32 s41, s41, s40
    s_add_u32 s42, s58, s41
    s_add_u32 s43, s59, s41
    buffer_load_dwordx4 a[168:171], v240, s[8:11], s42 offen
    buffer_load_dwordx4 a[172:175], v241, s[8:11], s43 offen
    s_bfe_u32 s41, s55, 524304
    s_mul_i32 s41, s41, s40
    s_add_u32 s42, s58, s41
    s_add_u32 s43, s59, s41
    buffer_load_dwordx4 a[176:179], v240, s[8:11], s42 offen
    buffer_load_dwordx4 a[180:183], v241, s[8:11], s43 offen
    s_bfe_u32 s41, s55, 524312
    s_mul_i32 s41, s41, s40
    s_add_u32 s42, s58, s41
    s_add_u32 s43, s59, s41
    buffer_load_dwordx4 a[184:187], v240, s[8:11], s42 offen
    buffer_load_dwordx4 a[188:191], v241, s[8:11], s43 offen
layerb1_kernel_pf_post:
    s_mov_b32 s32, 0x22222222
    s_mov_b32 s33, 0x22222222
    s_mov_b32 s34, 0x44444444
    s_mov_b32 s35, 0x44444444
    s_mov_b32 s36, 0x88888888
    s_mov_b32 s37, 0x88888888
    s_cmp_eq_u32 s23, 1
    s_cselect_b64 vcc, -1, 0
    v_cndmask_b32 v20, v20, v21, s[32:33]
    v_cndmask_b32 v20, v20, v22, s[34:35]
    v_cndmask_b32 v20, v20, v23, s[36:37]
    v_mov_b32 v22, v20
    s_nop 1
    v_permlane32_swap_b32 v20, v22
    v_add_f32 v22, v20, v22
    v_cndmask_b32 v20, v133, v149, vcc
    v_mul_f32 v20, 0x3acccccd, v20
    v_mul_f32 v21, v20, v20
    v_mul_f32 v22, 0x3acccccd, v22
    v_sub_f32 v22, v22, v21
    v_max_f32 v22, 0, v22
    v_add_f32 v22, 0x3727c5ac, v22
    v_rsq_f32 v22, v22
    v_and_b32 v16, 31, v0
    s_lshl_b32 s28, s13, 7
    s_add_u32 s28, s28, 65536
    v_lshl_add_u32 v17, v16, 2, s28
    s_mov_b32 exec_hi, 0
    ds_write_b32 v17, v22
    s_mov_b32 exec_hi, -1
    s_waitcnt lgkmcnt(0)
    s_barrier
    s_lshl_b32 s28, s22, 8
    s_add_u32 s28, s28, 65536
    v_lshl_add_u32 v17, v16, 2, s28
    v_lshrrev_b32 v18, 5, v0
    v_lshlrev_b32 v18, 4, v18
    v_add_u32 v18, s28, v18
    ds_read_b32 v224, v17 offset:0
    ds_read_b128 v[192:195], v18 offset:0
    ds_read_b128 v[196:199], v18 offset:32
    ds_read_b128 v[200:203], v18 offset:64
    ds_read_b128 v[204:207], v18 offset:96
    ds_read_b32 v225, v17 offset:128
    ds_read_b128 v[208:211], v18 offset:128
    ds_read_b128 v[212:215], v18 offset:160
    ds_read_b128 v[216:219], v18 offset:192
    ds_read_b128 v[220:223], v18 offset:224
    v_and_b32 v16, 31, v0
    v_mov_b32 v228, 0x358637bd
    v_cmp_gt_u32 vcc, 20, v16
    s_mov_b64 s[30:31], vcc
    s_nop 0
    v_cndmask_b32 v226, 0, v228, vcc
    v_cmp_eq_u32 vcc, 8, v16
    s_nop 1
    v_cndmask_b32 v227, 0, 1.0, vcc
    s_waitcnt lgkmcnt(0)
    v_fma_f32 v64, v64, v192, v226
    v_mul_f32 v48, 0x3fb8aa3b, v64
    v_exp_f32 v48, v48 clamp
    v_max_f32 v49, v64, v228
    v_fma_f32 v96, v96, v192, v227
    v_add_f32 v48, v48, v49
    v_cndmask_b32 v64, v64, v48, s[30:31]
    v_fma_f32 v65, v65, v193, v226
    v_mul_f32 v50, 0x3fb8aa3b, v65
    v_exp_f32 v50, v50 clamp
    v_max_f32 v51, v65, v228
    v_fma_f32 v97, v97, v193, v227
    v_add_f32 v50, v50, v51
    v_cndmask_b32 v65, v65, v50, s[30:31]
    v_fma_f32 v66, v66, v194, v226
    v_mul_f32 v52, 0x3fb8aa3b, v66
    v_exp_f32 v52, v52 clamp
    v_max_f32 v53, v66, v228
    v_fma_f32 v98, v98, v194, v227
    v_add_f32 v52, v52, v53
    v_cndmask_b32 v66, v66, v52, s[30:31]
    v_fma_f32 v67, v67, v195, v226
    v_mul_f32 v54, 0x3fb8aa3b, v67
    v_exp_f32 v54, v54 clamp
    v_max_f32 v55, v67, v228
    v_fma_f32 v99, v99, v195, v227
    v_add_f32 v54, v54, v55
    v_cndmask_b32 v67, v67, v54, s[30:31]
    v_fma_f32 v68, v68, v196, v226
    v_mul_f32 v48, 0x3fb8aa3b, v68
    v_exp_f32 v48, v48 clamp
    v_max_f32 v49, v68, v228
    v_fma_f32 v100, v100, v196, v227
    v_add_f32 v48, v48, v49
    v_cndmask_b32 v68, v68, v48, s[30:31]
    v_fma_f32 v69, v69, v197, v226
    v_mul_f32 v50, 0x3fb8aa3b, v69
    v_exp_f32 v50, v50 clamp
    v_max_f32 v51, v69, v228
    v_fma_f32 v101, v101, v197, v227
    v_add_f32 v50, v50, v51
    v_cndmask_b32 v69, v69, v50, s[30:31]
    v_fma_f32 v70, v70, v198, v226
    v_mul_f32 v52, 0x3fb8aa3b, v70
    v_exp_f32 v52, v52 clamp
    v_max_f32 v53, v70, v228
    v_fma_f32 v102, v102, v198, v227
    v_add_f32 v52, v52, v53
    v_cndmask_b32 v70, v70, v52, s[30:31]
    v_fma_f32 v71, v71, v199, v226
    v_mul_f32 v54, 0x3fb8aa3b, v71
    v_exp_f32 v54, v54 clamp
    v_max_f32 v55, v71, v228
    v_fma_f32 v103, v103, v199, v227
    v_add_f32 v54, v54, v55
    v_cndmask_b32 v71, v71, v54, s[30:31]
    v_fma_f32 v72, v72, v200, v226
    v_mul_f32 v48, 0x3fb8aa3b, v72
    v_exp_f32 v48, v48 clamp
    v_max_f32 v49, v72, v228
    v_fma_f32 v104, v104, v200, v227
    v_add_f32 v48, v48, v49
    v_cndmask_b32 v72, v72, v48, s[30:31]
    v_fma_f32 v73, v73, v201, v226
    v_mul_f32 v50, 0x3fb8aa3b, v73
    v_exp_f32 v50, v50 clamp
    v_max_f32 v51, v73, v228
    v_fma_f32 v105, v105, v201, v227
    v_add_f32 v50, v50, v51
    v_cndmask_b32 v73, v73, v50, s[30:31]
    v_fma_f32 v74, v74, v202, v226
    v_mul_f32 v52, 0x3fb8aa3b, v74
    v_exp_f32 v52, v52 clamp
    v_max_f32 v53, v74, v228
    v_fma_f32 v106, v106, v202, v227
    v_add_f32 v52, v52, v53
    v_cndmask_b32 v74, v74, v52, s[30:31]
    v_fma_f32 v75, v75, v203, v226
    v_mul_f32 v54, 0x3fb8aa3b, v75
    v_exp_f32 v54, v54 clamp
    v_max_f32 v55, v75, v228
    v_fma_f32 v107, v107, v203, v227
    v_add_f32 v54, v54, v55
    v_cndmask_b32 v75, v75, v54, s[30:31]
    v_fma_f32 v76, v76, v204, v226
    v_mul_f32 v48, 0x3fb8aa3b, v76
    v_exp_f32 v48, v48 clamp
    v_max_f32 v49, v76, v228
    v_fma_f32 v108, v108, v204, v227
    v_add_f32 v48, v48, v49
    v_cndmask_b32 v76, v76, v48, s[30:31]
    v_fma_f32 v77, v77, v205, v226
    v_mul_f32 v50, 0x3fb8aa3b, v77
    v_exp_f32 v50, v50 clamp
    v_max_f32 v51, v77, v228
    v_fma_f32 v109, v109, v205, v227
    v_add_f32 v50, v50, v51
    v_cndmask_b32 v77, v77, v50, s[30:31]
    v_fma_f32 v78, v78, v206, v226
    v_mul_f32 v52, 0x3fb8aa3b, v78
    v_exp_f32 v52, v52 clamp
    v_max_f32 v53, v78, v228
    v_fma_f32 v110, v110, v206, v227
    v_add_f32 v52, v52, v53
    v_cndmask_b32 v78, v78, v52, s[30:31]
    v_fma_f32 v79, v79, v207, v226
    v_mul_f32 v54, 0x3fb8aa3b, v79
    v_exp_f32 v54, v54 clamp
    v_max_f32 v55, v79, v228
    v_fma_f32 v111, v111, v207, v227
    v_add_f32 v54, v54, v55
    v_cndmask_b32 v79, v79, v54, s[30:31]
    v_cvt_pk_bf16_f32 v32, v64, v65
    v_cvt_pk_bf16_f32 v40, v96, v97
    v_cvt_pk_bf16_f32 v33, v66, v67
    v_cvt_pk_bf16_f32 v41, v98, v99
    v_cvt_pk_bf16_f32 v34, v68, v69
    v_cvt_pk_bf16_f32 v42, v100, v101
    v_cvt_pk_bf16_f32 v35, v70, v71
    v_cvt_pk_bf16_f32 v43, v102, v103
    v_cvt_pk_bf16_f32 v36, v72, v73
    v_cvt_pk_bf16_f32 v44, v104, v105
    v_cvt_pk_bf16_f32 v37, v74, v75
    v_cvt_pk_bf16_f32 v45, v106, v107
    v_cvt_pk_bf16_f32 v38, v76, v77
    v_cvt_pk_bf16_f32 v46, v108, v109
    v_cvt_pk_bf16_f32 v39, v78, v79
    v_cvt_pk_bf16_f32 v47, v110, v111
    s_nop 1
    v_mfma_f32_32x32x16_bf16 v[160:175], v[32:35], v[32:35], 0
    v_mfma_f32_32x32x16_bf16 v[176:191], v[40:43], v[32:35], 0
    v_mfma_f32_32x32x16_bf16 v[160:175], v[36:39], v[36:39], v[160:175]
    v_mfma_f32_32x32x16_bf16 v[176:191], v[44:47], v[36:39], v[176:191]
    v_fma_f32 v80, v80, v208, v226
    v_mul_f32 v48, 0x3fb8aa3b, v80
    v_exp_f32 v48, v48 clamp
    v_max_f32 v49, v80, v228
    v_fma_f32 v112, v112, v208, v227
    v_add_f32 v48, v48, v49
    v_cndmask_b32 v80, v80, v48, s[30:31]
    v_fma_f32 v81, v81, v209, v226
    v_mul_f32 v50, 0x3fb8aa3b, v81
    v_exp_f32 v50, v50 clamp
    v_max_f32 v51, v81, v228
    v_fma_f32 v113, v113, v209, v227
    v_add_f32 v50, v50, v51
    v_cndmask_b32 v81, v81, v50, s[30:31]
    v_fma_f32 v82, v82, v210, v226
    v_mul_f32 v52, 0x3fb8aa3b, v82
    v_exp_f32 v52, v52 clamp
    v_max_f32 v53, v82, v228
    v_fma_f32 v114, v114, v210, v227
    v_add_f32 v52, v52, v53
    v_cndmask_b32 v82, v82, v52, s[30:31]
    v_fma_f32 v83, v83, v211, v226
    v_mul_f32 v54, 0x3fb8aa3b, v83
    v_exp_f32 v54, v54 clamp
    v_max_f32 v55, v83, v228
    v_fma_f32 v115, v115, v211, v227
    v_add_f32 v54, v54, v55
    v_cndmask_b32 v83, v83, v54, s[30:31]
    v_fma_f32 v84, v84, v212, v226
    v_mul_f32 v48, 0x3fb8aa3b, v84
    v_exp_f32 v48, v48 clamp
    v_max_f32 v49, v84, v228
    v_fma_f32 v116, v116, v212, v227
    v_add_f32 v48, v48, v49
    v_cndmask_b32 v84, v84, v48, s[30:31]
    v_fma_f32 v85, v85, v213, v226
    v_mul_f32 v50, 0x3fb8aa3b, v85
    v_exp_f32 v50, v50 clamp
    v_max_f32 v51, v85, v228
    v_fma_f32 v117, v117, v213, v227
    v_add_f32 v50, v50, v51
    v_cndmask_b32 v85, v85, v50, s[30:31]
    v_fma_f32 v86, v86, v214, v226
    v_mul_f32 v52, 0x3fb8aa3b, v86
    v_exp_f32 v52, v52 clamp
    v_max_f32 v53, v86, v228
    v_fma_f32 v118, v118, v214, v227
    v_add_f32 v52, v52, v53
    v_cndmask_b32 v86, v86, v52, s[30:31]
    v_fma_f32 v87, v87, v215, v226
    v_mul_f32 v54, 0x3fb8aa3b, v87
    v_exp_f32 v54, v54 clamp
    v_max_f32 v55, v87, v228
    v_fma_f32 v119, v119, v215, v227
    v_add_f32 v54, v54, v55
    v_cndmask_b32 v87, v87, v54, s[30:31]
    v_fma_f32 v88, v88, v216, v226
    v_mul_f32 v48, 0x3fb8aa3b, v88
    v_exp_f32 v48, v48 clamp
    v_max_f32 v49, v88, v228
    v_fma_f32 v120, v120, v216, v227
    v_add_f32 v48, v48, v49
    v_cndmask_b32 v88, v88, v48, s[30:31]
    v_fma_f32 v89, v89, v217, v226
    v_mul_f32 v50, 0x3fb8aa3b, v89
    v_exp_f32 v50, v50 clamp
    v_max_f32 v51, v89, v228
    v_fma_f32 v121, v121, v217, v227
    v_add_f32 v50, v50, v51
    v_cndmask_b32 v89, v89, v50, s[30:31]
    v_fma_f32 v90, v90, v218, v226
    v_mul_f32 v52, 0x3fb8aa3b, v90
    v_exp_f32 v52, v52 clamp
    v_max_f32 v53, v90, v228
    v_fma_f32 v122, v122, v218, v227
    v_add_f32 v52, v52, v53
    v_cndmask_b32 v90, v90, v52, s[30:31]
    v_fma_f32 v91, v91, v219, v226
    v_mul_f32 v54, 0x3fb8aa3b, v91
    v_exp_f32 v54, v54 clamp
    v_max_f32 v55, v91, v228
    v_fma_f32 v123, v123, v219, v227
    v_add_f32 v54, v54, v55
    v_cndmask_b32 v91, v91, v54, s[30:31]
    v_fma_f32 v92, v92, v220, v226
    v_mul_f32 v48, 0x3fb8aa3b, v92
    v_exp_f32 v48, v48 clamp
    v_max_f32 v49, v92, v228
    v_fma_f32 v124, v124, v220, v227
    v_add_f32 v48, v48, v49
    v_cndmask_b32 v92, v92, v48, s[30:31]
    v_fma_f32 v93, v93, v221, v226
    v_mul_f32 v50, 0x3fb8aa3b, v93
    v_exp_f32 v50, v50 clamp
    v_max_f32 v51, v93, v228
    v_fma_f32 v125, v125, v221, v227
    v_add_f32 v50, v50, v51
    v_cndmask_b32 v93, v93, v50, s[30:31]
    v_fma_f32 v94, v94, v222, v226
    v_mul_f32 v52, 0x3fb8aa3b, v94
    v_exp_f32 v52, v52 clamp
    v_max_f32 v53, v94, v228
    v_fma_f32 v126, v126, v222, v227
    v_add_f32 v52, v52, v53
    v_cndmask_b32 v94, v94, v52, s[30:31]
    v_fma_f32 v95, v95, v223, v226
    v_mul_f32 v54, 0x3fb8aa3b, v95
    v_exp_f32 v54, v54 clamp
    v_max_f32 v55, v95, v228
    v_fma_f32 v127, v127, v223, v227
    v_add_f32 v54, v54, v55
    v_cndmask_b32 v95, v95, v54, s[30:31]
    v_cvt_pk_bf16_f32 v32, v80, v81
    v_cvt_pk_bf16_f32 v40, v112, v113
    v_cvt_pk_bf16_f32 v33, v82, v83
    v_cvt_pk_bf16_f32 v41, v114, v115
    v_cvt_pk_bf16_f32 v34, v84, v85
    v_cvt_pk_bf16_f32 v42, v116, v117
    v_cvt_pk_bf16_f32 v35, v86, v87
    v_cvt_pk_bf16_f32 v43, v118, v119
    v_cvt_pk_bf16_f32 v36, v88, v89
    v_cvt_pk_bf16_f32 v44, v120, v121
    v_cvt_pk_bf16_f32 v37, v90, v91
    v_cvt_pk_bf16_f32 v45, v122, v123
    v_cvt_pk_bf16_f32 v38, v92, v93
    v_cvt_pk_bf16_f32 v46, v124, v125
    v_cvt_pk_bf16_f32 v39, v94, v95
    v_cvt_pk_bf16_f32 v47, v126, v127
    s_nop 1
    v_mfma_f32_32x32x16_bf16 v[160:175], v[32:35], v[32:35], v[160:175]
    v_mfma_f32_32x32x16_bf16 v[176:191], v[40:43], v[32:35], v[176:191]
    v_mfma_f32_32x32x16_bf16 v[160:175], v[36:39], v[36:39], v[160:175]
    v_mfma_f32_32x32x16_bf16 v[176:191], v[44:47], v[36:39], v[176:191]
    v_fma_f32 v132, v132, v224, v228
    v_mul_f32 v48, 0x3fb8aa3b, v132
    v_exp_f32 v48, v48 clamp
    v_max_f32 v49, v132, v228
    v_add_f32 v132, v48, v49
    v_fma_f32 v133, v133, v224, v228
    v_mul_f32 v50, 0x3fb8aa3b, v133
    v_exp_f32 v50, v50 clamp
    v_max_f32 v51, v133, v228
    v_add_f32 v133, v50, v51
    v_fma_f32 v134, v134, v224, v228
    v_mul_f32 v52, 0x3fb8aa3b, v134
    v_exp_f32 v52, v52 clamp
    v_max_f32 v53, v134, v228
    v_add_f32 v134, v52, v53
    v_fma_f32 v135, v135, v224, v228
    v_mul_f32 v54, 0x3fb8aa3b, v135
    v_exp_f32 v54, v54 clamp
    v_max_f32 v55, v135, v228
    v_add_f32 v135, v54, v55
    v_fma_f32 v136, v136, v224, v228
    v_mul_f32 v48, 0x3fb8aa3b, v136
    v_exp_f32 v48, v48 clamp
    v_max_f32 v49, v136, v228
    v_add_f32 v136, v48, v49
    v_fma_f32 v137, v137, v224, v228
    v_mul_f32 v50, 0x3fb8aa3b, v137
    v_exp_f32 v50, v50 clamp
    v_max_f32 v51, v137, v228
    v_add_f32 v137, v50, v51
    v_fma_f32 v138, v138, v224, v228
    v_mul_f32 v52, 0x3fb8aa3b, v138
    v_exp_f32 v52, v52 clamp
    v_max_f32 v53, v138, v228
    v_add_f32 v138, v52, v53
    v_fma_f32 v139, v139, v224, v228
    v_mul_f32 v54, 0x3fb8aa3b, v139
    v_exp_f32 v54, v54 clamp
    v_max_f32 v55, v139, v228
    v_add_f32 v139, v54, v55
    v_fma_f32 v140, v140, v224, v228
    v_mul_f32 v48, 0x3fb8aa3b, v140
    v_exp_f32 v48, v48 clamp
    v_max_f32 v49, v140, v228
    v_add_f32 v140, v48, v49
    v_fma_f32 v141, v141, v224, v228
    v_mul_f32 v50, 0x3fb8aa3b, v141
    v_exp_f32 v50, v50 clamp
    v_max_f32 v51, v141, v228
    v_add_f32 v141, v50, v51
    v_fma_f32 v142, v142, v224, v228
    v_mul_f32 v52, 0x3fb8aa3b, v142
    v_exp_f32 v52, v52 clamp
    v_max_f32 v53, v142, v228
    v_add_f32 v142, v52, v53
    v_fma_f32 v143, v143, v224, v228
    v_mul_f32 v54, 0x3fb8aa3b, v143
    v_exp_f32 v54, v54 clamp
    v_max_f32 v55, v143, v228
    v_add_f32 v143, v54, v55
    v_cvt_pk_bf16_f32 v130, v132, v133
    v_cvt_pk_bf16_f32 v131, v134, v135
    v_cvt_pk_bf16_f32 v132, v136, v137
    v_cvt_pk_bf16_f32 v133, v138, v139
    v_cvt_pk_bf16_f32 v134, v140, v141
    v_cvt_pk_bf16_f32 v135, v142, v143
    v_mov_b32 v128, 0
    v_mov_b32 v129, 0
    s_lshl_b32 s28, s13, 13
    s_add_u32 s28, s28, 66560
    v_add_u32 v17, s28, v1
    ds_write_b128 v17, v[160:163] offset:0
    ds_write_b128 v17, v[164:167] offset:1024
    ds_write_b128 v17, v[168:171] offset:2048
    ds_write_b128 v17, v[172:175] offset:3072
    ds_write_b128 v17, v[176:179] offset:4096
    ds_write_b128 v17, v[180:183] offset:5120
    ds_write_b128 v17, v[184:187] offset:6144
    ds_write_b128 v17, v[188:191] offset:7168
    s_lshl_b32 s28, s13, 6
    v_add_u32 v32, s28, v0
    v_cmp_le_u32 vcc, 105, v32
    s_nop 1
    v_cndmask_b32 v33, 0, 1, vcc
    v_mul_u32_u24 v34, 105, v33
    v_sub_u32 v34, v32, v34
    v_mul_u32_u24 v35, 13108, v34
    v_lshrrev_b32 v35, 16, v35
    v_mul_u32_u24 v36, 5, v35
    v_sub_u32 v36, v34, v36
    v_add_u32 v37, 20, v35
    v_subrev_u32 v38, 12, v35
    v_cmp_gt_u32 vcc, 12, v35
    s_nop 1
    v_cndmask_b32 v37, v38, v37, vcc
    v_cndmask_b32 v38, 1, 0, vcc
    v_lshlrev_b32 v38, 12, v38
    v_lshl_add_u32 v38, v33, 13, v38
    v_lshrrev_b32 v39, 3, v37
    v_lshl_add_u32 v38, v39, 10, v38
    v_bfe_u32 v39, v37, 2, 1
    v_lshlrev_b32 v39, 5, v39
    v_lshl_add_u32 v39, v36, 2, v39
    v_lshl_add_u32 v38, v39, 4, v38
    v_and_b32 v39, 3, v37
    v_lshl_add_u32 v38, v39, 2, v38
    v_min_u32 v38, 16320, v38
    v_add_u32 v38, 66560, v38
    s_waitcnt lgkmcnt(0)
    s_barrier
    ds_read_b32 v40, v38 offset:0
    ds_read_b32 v41, v38 offset:16
    ds_read_b32 v42, v38 offset:32
    ds_read_b32 v43, v38 offset:48
    ds_read_b32 v44, v38 offset:16384
    ds_read_b32 v45, v38 offset:16400
    ds_read_b32 v46, v38 offset:16416
    ds_read_b32 v47, v38 offset:16432
    s_lshl_b32 s28, s20, 4
    s_add_u32 s28, s28, s21
    s_lshl_b32 s28, s28, 12
    s_mul_i32 s39, s49, 1048576
    s_add_u32 s39, s39, 232783872
    s_add_u32 s28, s28, s39
    v_lshlrev_b32 v39, 4, v32
    v_cmp_gt_u32 vcc, 210, v32
    s_mov_b64 s[32:33], vcc
    s_waitcnt lgkmcnt(0)
    v_add_f32 v40, v40, v44
    v_add_f32 v41, v41, v45
    v_add_f32 v42, v42, v46
    v_add_f32 v43, v43, v47
    s_mov_b64 exec, s[32:33]
    buffer_store_dwordx4 v[40:43], v39, s[8:11], s28 offen sc1
    s_mov_b64 exec, -1
    v_fma_f32 v148, v148, v225, v228
    v_mul_f32 v48, 0x3fb8aa3b, v148
    v_exp_f32 v48, v48 clamp
    v_max_f32 v49, v148, v228
    v_add_f32 v148, v48, v49
    v_fma_f32 v149, v149, v225, v228
    v_mul_f32 v50, 0x3fb8aa3b, v149
    v_exp_f32 v50, v50 clamp
    v_max_f32 v51, v149, v228
    v_add_f32 v149, v50, v51
    v_fma_f32 v150, v150, v225, v228
    v_mul_f32 v52, 0x3fb8aa3b, v150
    v_exp_f32 v52, v52 clamp
    v_max_f32 v53, v150, v228
    v_add_f32 v150, v52, v53
    v_fma_f32 v151, v151, v225, v228
    v_mul_f32 v54, 0x3fb8aa3b, v151
    v_exp_f32 v54, v54 clamp
    v_max_f32 v55, v151, v228
    v_add_f32 v151, v54, v55
    v_fma_f32 v152, v152, v225, v228
    v_mul_f32 v48, 0x3fb8aa3b, v152
    v_exp_f32 v48, v48 clamp
    v_max_f32 v49, v152, v228
    v_add_f32 v152, v48, v49
    v_fma_f32 v153, v153, v225, v228
    v_mul_f32 v50, 0x3fb8aa3b, v153
    v_exp_f32 v50, v50 clamp
    v_max_f32 v51, v153, v228
    v_add_f32 v153, v50, v51
    v_fma_f32 v154, v154, v225, v228
    v_mul_f32 v52, 0x3fb8aa3b, v154
    v_exp_f32 v52, v52 clamp
    v_max_f32 v53, v154, v228
    v_add_f32 v154, v52, v53
    v_fma_f32 v155, v155, v225, v228
    v_mul_f32 v54, 0x3fb8aa3b, v155
    v_exp_f32 v54, v54 clamp
    v_max_f32 v55, v155, v228
    v_add_f32 v155, v54, v55
    v_fma_f32 v156, v156, v225, v228
    v_mul_f32 v48, 0x3fb8aa3b, v156
    v_exp_f32 v48, v48 clamp
    v_max_f32 v49, v156, v228
    v_add_f32 v156, v48, v49
    v_fma_f32 v157, v157, v225, v228
    v_mul_f32 v50, 0x3fb8aa3b, v157
    v_exp_f32 v50, v50 clamp
    v_max_f32 v51, v157, v228
    v_add_f32 v157, v50, v51
    v_fma_f32 v158, v158, v225, v228
    v_mul_f32 v52, 0x3fb8aa3b, v158
    v_exp_f32 v52, v52 clamp
    v_max_f32 v53, v158, v228
    v_add_f32 v158, v52, v53
    v_fma_f32 v159, v159, v225, v228
    v_mul_f32 v54, 0x3fb8aa3b, v159
    v_exp_f32 v54, v54 clamp
    v_max_f32 v55, v159, v228
    v_add_f32 v159, v54, v55
    v_cvt_pk_bf16_f32 v146, v148, v149
    v_cvt_pk_bf16_f32 v147, v150, v151
    v_cvt_pk_bf16_f32 v148, v152, v153
    v_cvt_pk_bf16_f32 v149, v154, v155
    v_cvt_pk_bf16_f32 v150, v156, v157
    v_cvt_pk_bf16_f32 v151, v158, v159
    v_mov_b32 v144, 0
    v_mov_b32 v145, 0
    s_mul_i32 s29, s26, 5
    v_lshrrev_b32 v17, 5, v0
    v_add_u32 v17, s29, v17
    v_lshrrev_b32 v18, 1, v17
    v_lshlrev_b32 v18, 9, v18
    v_and_b32 v17, 1, v17
    v_lshl_add_u32 v18, v17, 3, v18
    v_and_b32 v16, 31, v0
    v_lshl_add_u32 v14, v16, 4, v18
    v_mul_u32_u24 v15, 80, v16
    v_lshrrev_b32 v17, 5, v0
    v_lshl_add_u32 v15, v17, 4, v15
    s_mul_i32 s29, s23, 1680
    s_add_u32 s29, s29, 48
    v_add_u32 v15, s29, v15
    v_mov_b32 v48, 0
    v_mov_b32 v49, 0
    v_mov_b32 v50, 0
    v_mov_b32 v51, 0
    v_mov_b32 v52, 0
    v_mov_b32 v53, 0
    v_mov_b32 v54, 0
    v_mov_b32 v55, 0
    v_mov_b32 v56, 0
    v_mov_b32 v57, 0
    v_mov_b32 v58, 0
    v_mov_b32 v59, 0
    s_waitcnt vmcnt(0)
    s_barrier
    s_cmp_lg_u32 s13, 0
    s_cbranch_scc0 layerb1_kernel_af_w0
    s_cmp_eq_u32 s44, 2
    s_cbranch_scc1 layerb1_kernel_pf_wait
    s_bfe_u32 s41, s56, 524288
    s_mul_i32 s41, s41, s40
    s_add_u32 s42, s58, s41
    s_add_u32 s43, s59, s41
    buffer_load_dwordx4 a[192:195], v240, s[8:11], s42 offen
    buffer_load_dwordx4 a[196:199], v241, s[8:11], s43 offen
    s_bfe_u32 s41, s56, 524296
    s_mul_i32 s41, s41, s40
    s_add_u32 s42, s58, s41
    s_add_u32 s43, s59, s41
    buffer_load_dwordx4 a[200:203], v240, s[8:11], s42 offen
    buffer_load_dwordx4 a[204:207], v241, s[8:11], s43 offen
    s_bfe_u32 s41, s56, 524304
    s_mul_i32 s41, s41, s40
    s_add_u32 s42, s58, s41
    s_add_u32 s43, s59, s41
    buffer_load_dwordx4 a[208:211], v240, s[8:11], s42 offen
    buffer_load_dwordx4 a[212:215], v241, s[8:11], s43 offen
    s_bfe_u32 s41, s56, 524312
    s_mul_i32 s41, s41, s40
    s_add_u32 s42, s58, s41
    s_add_u32 s43, s59, s41
    buffer_load_dwordx4 a[216:219], v240, s[8:11], s42 offen
    buffer_load_dwordx4 a[220:223], v241, s[8:11], s43 offen
    s_bfe_u32 s41, s57, 524288
    s_mul_i32 s41, s41, s40
    s_add_u32 s42, s58, s41
    s_add_u32 s43, s59, s41
    buffer_load_dwordx4 a[224:227], v240, s[8:11], s42 offen
    buffer_load_dwordx4 a[228:231], v241, s[8:11], s43 offen
    s_bfe_u32 s41, s57, 524296
    s_mul_i32 s41, s41, s40
    s_add_u32 s42, s58, s41
    s_add_u32 s43, s59, s41
    buffer_load_dwordx4 a[232:235], v240, s[8:11], s42 offen
    buffer_load_dwordx4 a[236:239], v241, s[8:11], s43 offen
    s_bfe_u32 s41, s57, 524304
    s_mul_i32 s41, s41, s40
    s_add_u32 s42, s58, s41
    s_add_u32 s43, s59, s41
    buffer_load_dwordx4 a[240:243], v240, s[8:11], s42 offen
    buffer_load_dwordx4 a[244:247], v241, s[8:11], s43 offen
layerb1_kernel_pf_wait:
    s_branch layerb1_kernel_af_go
layerb1_kernel_af_w0:
    s_lshl_b32 s29, s20, 7
    s_add_u32 s29, s29, s48
    s_add_u32 s29, s29, 32768
    s_lshl_b32 s30, s21, 2
    v_mov_b32 v16, s30
    v_mov_b32 v17, 1
    s_mov_b64 exec, 1
    buffer_store_dword v17, v16, s[8:11], s29 offen sc1
    s_mov_b64 exec, 0xffff
    v_lshlrev_b32 v16, 2, v0
    s_mov_b32 s31, 400000
layerb1_kernel_af_poll:
    buffer_load_dword v17, v16, s[8:11], s29 offen sc1
    s_waitcnt vmcnt(0)
    v_cmp_eq_u32 vcc, 0, v17
    s_sub_u32 s31, s31, 1
    s_cbranch_scc1 layerb1_kernel_af_fail
    s_cbranch_vccnz layerb1_kernel_af_poll
    s_branch layerb1_kernel_af_ok
layerb1_kernel_af_fail:
    s_load_dwordx2 s[34:35], s[0:1], 88
    s_waitcnt lgkmcnt(0)
    s_mov_b32 s36, s34
    s_mov_b32 s37, s35
    s_mov_b32 s38, 256
    s_mov_b32 s39, 0x00020000
    s_mov_b64 exec, 1
    v_mov_b32 v16, 0
    v_mov_b32 v17, 0xdead
    buffer_store_dword v17, v16, s[36:39], 0 offen
layerb1_kernel_af_ok:
    s_mov_b64 exec, -1
layerb1_kernel_af_go:
    s_barrier
    s_lshl_b32 s28, s20, 16
    s_add_u32 s28, s28, s39
    s_mov_b64 exec, s[32:33]
    buffer_load_dwordx4 v[160:163], v39, s[8:11], s28 offen sc1
    s_add_u32 s28, s28, 4096
    buffer_load_dwordx4 v[164:167], v39, s[8:11], s28 offen sc1
    s_add_u32 s28, s28, 4096
    buffer_load_dwordx4 v[168:171], v39, s[8:11], s28 offen sc1
    s_add_u32 s28, s28, 4096
    buffer_load_dwordx4 v[172:175], v39, s[8:11], s28 offen sc1
    s_add_u32 s28, s28, 4096
    buffer_load_dwordx4 v[176:179], v39, s[8:11], s28 offen sc1
    s_add_u32 s28, s28, 4096
    buffer_load_dwordx4 v[180:183], v39, s[8:11], s28 offen sc1
    s_add_u32 s28, s28, 4096
    buffer_load_dwordx4 v[184:187], v39, s[8:11], s28 offen sc1
    s_add_u32 s28, s28, 4096
    buffer_load_dwordx4 v[188:191], v39, s[8:11], s28 offen sc1
    s_add_u32 s28, s28, 4096
    buffer_load_dwordx4 v[192:195], v39, s[8:11], s28 offen sc1
    s_add_u32 s28, s28, 4096
    buffer_load_dwordx4 v[196:199], v39, s[8:11], s28 offen sc1
    s_add_u32 s28, s28, 4096
    buffer_load_dwordx4 v[200:203], v39, s[8:11], s28 offen sc1
    s_add_u32 s28, s28, 4096
    buffer_load_dwordx4 v[204:207], v39, s[8:11], s28 offen sc1
    s_add_u32 s28, s28, 4096
    buffer_load_dwordx4 v[208:211], v39, s[8:11], s28 offen sc1
    s_add_u32 s28, s28, 4096
    buffer_load_dwordx4 v[212:215], v39, s[8:11], s28 offen sc1
    s_add_u32 s28, s28, 4096
    buffer_load_dwordx4 v[216:219], v39, s[8:11], s28 offen sc1
    s_add_u32 s28, s28, 4096
    buffer_load_dwordx4 v[220:223], v39, s[8:11], s28 offen sc1
    s_mov_b64 exec, -1
    s_waitcnt vmcnt(14)
    v_add_f32 v160, v160, v164
    v_add_f32 v161, v161, v165
    v_add_f32 v162, v162, v166
    v_add_f32 v163, v163, v167
    s_waitcnt vmcnt(12)
    v_add_f32 v168, v168, v172
    v_add_f32 v169, v169, v173
    v_add_f32 v170, v170, v174
    v_add_f32 v171, v171, v175
    s_waitcnt vmcnt(10)
    v_add_f32 v176, v176, v180
    v_add_f32 v177, v177, v181
    v_add_f32 v178, v178, v182
    v_add_f32 v179, v179, v183
    s_waitcnt vmcnt(8)
    v_add_f32 v184, v184, v188
    v_add_f32 v185, v185, v189
    v_add_f32 v186, v186, v190
    v_add_f32 v187, v187, v191
    s_waitcnt vmcnt(6)
    v_add_f32 v192, v192, v196
    v_add_f32 v193, v193, v197
    v_add_f32 v194, v194, v198
    v_add_f32 v195, v195, v199
    s_waitcnt vmcnt(4)
    v_add_f32 v200, v200, v204
    v_add_f32 v201, v201, v205
    v_add_f32 v202, v202, v206
    v_add_f32 v203, v203, v207
    s_waitcnt vmcnt(2)
    v_add_f32 v208, v208, v212
    v_add_f32 v209, v209, v213
    v_add_f32 v210, v210, v214
    v_add_f32 v211, v211, v215
    s_waitcnt vmcnt(0)
    v_add_f32 v216, v216, v220
    v_add_f32 v217, v217, v221
    v_add_f32 v218, v218, v222
    v_add_f32 v219, v219, v223
    v_add_f32 v160, v160, v168
    v_add_f32 v161, v161, v169
    v_add_f32 v162, v162, v170
    v_add_f32 v163, v163, v171
    v_add_f32 v176, v176, v184
    v_add_f32 v177, v177, v185
    v_add_f32 v178, v178, v186
    v_add_f32 v179, v179, v187
    v_add_f32 v192, v192, v200
    v_add_f32 v193, v193, v201
    v_add_f32 v194, v194, v202
    v_add_f32 v195, v195, v203
    v_add_f32 v208, v208, v216
    v_add_f32 v209, v209, v217
    v_add_f32 v210, v210, v218
    v_add_f32 v211, v211, v219
    v_add_f32 v160, v160, v176
    v_add_f32 v161, v161, v177
    v_add_f32 v162, v162, v178
    v_add_f32 v163, v163, v179
    v_add_f32 v192, v192, v208
    v_add_f32 v193, v193, v209
    v_add_f32 v194, v194, v210
    v_add_f32 v195, v195, v211
    v_add_f32 v160, v160, v192
    v_add_f32 v161, v161, v193
    v_add_f32 v162, v162, v194
    v_add_f32 v163, v163, v195
    v_add_u32 v39, 64, v39
    s_mov_b64 exec, s[32:33]
    ds_write_b128 v39, v[160:163]
    s_mov_b64 exec, -1
    s_waitcnt lgkmcnt(0)
    s_barrier
    s_mov_b32 exec_lo, 0x1fffff
    s_mov_b32 exec_hi, 0x1fffff
    ds_read_b128 v[52:55], v15 offset:32
    ds_read_b128 v[56:59], v15 offset:64
    s_mov_b32 exec_lo, 0
    ds_read_b128 v[48:51], v15
    s_mov_b64 exec, -1
    v_mov_b32 v32, 0
    v_mov_b32 v33, 0
    s_waitcnt lgkmcnt(0)
    v_cvt_pk_bf16_f32 v34, v48, v49
    v_cvt_pk_bf16_f32 v35, v50, v51
    v_cvt_pk_bf16_f32 v36, v52, v53
    v_cvt_pk_bf16_f32 v37, v54, v55
    v_cvt_pk_bf16_f32 v38, v56, v57
    v_cvt_pk_bf16_f32 v39, v58, v59
    s_nop 1
    v_mfma_f32_32x32x16_bf16 v[64:79], v[32:35], v[128:131], 0
    v_mfma_f32_32x32x16_bf16 v[64:79], v[36:39], v[132:135], v[64:79]
    v_mfma_f32_32x32x16_bf16 v[80:95], v[32:35], v[144:147], 0
    v_mfma_f32_32x32x16_bf16 v[80:95], v[36:39], v[148:151], v[80:95]
    s_lshl_b32 s28, s21, 2
    s_lshl_b32 s29, s22, 1
    s_add_u32 s28, s28, s29
    s_mul_i32 s28, s28, 40960
    s_add_u32 s28, s28, 229638144
    s_nop 7
    s_nop 3
    v_add_f32 v40, 0x358637bd, v72
    v_mov_b32 v41, v40
    s_nop 1
    v_permlane32_swap_b32 v40, v41
    v_rcp_f32 v41, v41
    s_nop 0
    v_mul_f32 v64, v64, v41
    v_mul_f32 v65, v65, v41
    v_mul_f32 v66, v66, v41
    v_mul_f32 v67, v67, v41
    v_mul_f32 v68, v68, v41
    v_mul_f32 v69, v69, v41
    v_mul_f32 v70, v70, v41
    v_mul_f32 v71, v71, v41
    v_mul_f32 v72, v72, v41
    v_mul_f32 v73, v73, v41
    v_mul_f32 v74, v74, v41
    v_mul_f32 v75, v75, v41
    v_cvt_pk_bf16_f32 v42, v64, v65
    v_cvt_pk_bf16_f32 v43, v66, v67
    v_cvt_pk_bf16_f32 v44, v68, v69
    v_cvt_pk_bf16_f32 v45, v70, v71
    v_cvt_pk_bf16_f32 v46, v72, v73
    v_cvt_pk_bf16_f32 v47, v74, v75
    buffer_store_dwordx2 v[42:43], v14, s[8:11], s28 offen offset:0 sc1
    buffer_store_dwordx2 v[44:45], v14, s[8:11], s28 offen offset:512 sc1
    s_mov_b32 exec_hi, 0
    buffer_store_dwordx2 v[46:47], v14, s[8:11], s28 offen offset:1024 sc1
    s_mov_b32 exec_hi, -1
    s_add_u32 s28, s28, 40960
    s_nop 7
    v_add_f32 v40, 0x358637bd, v88
    v_mov_b32 v41, v40
    s_nop 1
    v_permlane32_swap_b32 v40, v41
    v_rcp_f32 v41, v41
    s_nop 0
    v_mul_f32 v80, v80, v41
    v_mul_f32 v81, v81, v41
    v_mul_f32 v82, v82, v41
    v_mul_f32 v83, v83, v41
    v_mul_f32 v84, v84, v41
    v_mul_f32 v85, v85, v41
    v_mul_f32 v86, v86, v41
    v_mul_f32 v87, v87, v41
    v_mul_f32 v88, v88, v41
    v_mul_f32 v89, v89, v41
    v_mul_f32 v90, v90, v41
    v_mul_f32 v91, v91, v41
    v_cvt_pk_bf16_f32 v48, v80, v81
    v_cvt_pk_bf16_f32 v49, v82, v83
    v_cvt_pk_bf16_f32 v50, v84, v85
    v_cvt_pk_bf16_f32 v51, v86, v87
    v_cvt_pk_bf16_f32 v52, v88, v89
    v_cvt_pk_bf16_f32 v53, v90, v91
    buffer_store_dwordx2 v[48:49], v14, s[8:11], s28 offen offset:0 sc1
    buffer_store_dwordx2 v[50:51], v14, s[8:11], s28 offen offset:512 sc1
    s_mov_b32 exec_hi, 0
    buffer_store_dwordx2 v[52:53], v14, s[8:11], s28 offen offset:1024 sc1
    s_mov_b32 exec_hi, -1
    s_waitcnt vmcnt(0)
    s_barrier
    s_cmp_lg_u32 s13, 0
    s_cbranch_scc1 layerb1_kernel_af_pub
    s_lshl_b32 s28, s21, 4
    s_add_u32 s28, s28, s20
    s_lshl_b32 s28, s28, 2
    s_add_u32 s28, s28, s48
    s_add_u32 s28, s28, 49152
    v_mov_b32 v16, 0
    v_mov_b32 v17, 1
    s_mov_b64 exec, 1
    buffer_store_dword v17, v16, s[8:11], s28 offen sc1
    s_mov_b64 exec, -1
layerb1_kernel_af_pub:
    s_cmp_lg_u32 s44, 0
    s_cbranch_scc1 layerb1_kernel_pf_late
    s_cmp_lg_u32 s13, 0
    s_cbranch_scc1 layerb1_kernel_pf_late1
    s_bfe_u32 s41, s56, 524288
    s_mul_i32 s41, s41, s40
    s_add_u32 s42, s58, s41
    s_add_u32 s43, s59, s41
    buffer_load_dwordx4 a[192:195], v240, s[8:11], s42 offen
    buffer_load_dwordx4 a[196:199], v241, s[8:11], s43 offen
    s_bfe_u32 s41, s56, 524296
    s_mul_i32 s41, s41, s40
    s_add_u32 s42, s58, s41
    s_add_u32 s43, s59, s41
    buffer_load_dwordx4 a[200:203], v240, s[8:11], s42 offen
    buffer_load_dwordx4 a[204:207], v241, s[8:11], s43 offen
    s_bfe_u32 s41, s56, 524304
    s_mul_i32 s41, s41, s40
    s_add_u32 s42, s58, s41
    s_add_u32 s43, s59, s41
    buffer_load_dwordx4 a[208:211], v240, s[8:11], s42 offen
    buffer_load_dwordx4 a[212:215], v241, s[8:11], s43 offen
    s_bfe_u32 s41, s56, 524312
    s_mul_i32 s41, s41, s40
    s_add_u32 s42, s58, s41
    s_add_u32 s43, s59, s41
    buffer_load_dwordx4 a[216:219], v240, s[8:11], s42 offen
    buffer_load_dwordx4 a[220:223], v241, s[8:11], s43 offen
    s_bfe_u32 s41, s57, 524288
    s_mul_i32 s41, s41, s40
    s_add_u32 s42, s58, s41
    s_add_u32 s43, s59, s41
    buffer_load_dwordx4 a[224:227], v240, s[8:11], s42 offen
    buffer_load_dwordx4 a[228:231], v241, s[8:11], s43 offen
    s_bfe_u32 s41, s57, 524296
    s_mul_i32 s41, s41, s40
    s_add_u32 s42, s58, s41
    s_add_u32 s43, s59, s41
    buffer_load_dwordx4 a[232:235], v240, s[8:11], s42 offen
    buffer_load_dwordx4 a[236:239], v241, s[8:11], s43 offen
    s_bfe_u32 s41, s57, 524304
    s_mul_i32 s41, s41, s40
    s_add_u32 s42, s58, s41
    s_add_u32 s43, s59, s41
    buffer_load_dwordx4 a[240:243], v240, s[8:11], s42 offen
    buffer_load_dwordx4 a[244:247], v241, s[8:11], s43 offen
layerb1_kernel_pf_late1:
    s_bfe_u32 s41, s57, 524312
    s_mul_i32 s41, s41, s40
    s_add_u32 s42, s58, s41
    s_add_u32 s43, s59, s41
    buffer_load_dwordx4 a[248:251], v240, s[8:11], s42 offen
    buffer_load_dwordx4 a[252:255], v241, s[8:11], s43 offen
layerb1_kernel_pf_late:
    s_add_u32 s22, s4, 247463936
    s_addc_u32 s23, s5, 0
    s_cmp_eq_u32 s49, 0
    s_cselect_b32 s84, s22, s6
    s_cselect_b32 s85, s23, s7
    s_mov_b32 s86, 2621440
    s_mov_b32 s87, 0x00020000
    s_mov_b32 s20, s98
    s_mov_b32 s21, s99
    s_sub_u32 s22, 0, s4
    s_and_b32 s22, s22, 0x1fffff
    s_mov_b32 s24, 0
    s_mov_b32 s25, 0
    s_lshl_b32 s82, s24, 1
    s_sub_u32 s82, 8192, s82
    s_lshl_b32 s83, s25, 1
    s_sub_u32 s83, 8192, s83
    s_mul_i32 s23, s49, 4194304
    s_add_u32 s22, s22, s23
    s_add_u32 s16, s22, s24
    s_add_u32 s17, s22, s25
    s_add_u32 s17, s17, 2097152
    s_mov_b32 s40, 0x01010101
    s_mov_b32 s41, 0x01010101
    s_mov_b32 s42, 0x00010001
    s_mov_b32 s43, 0
    v_lshlrev_b32 v1, 4, v0
    v_and_b32 v16, 8, v0
    v_cmp_eq_u32 vcc, 0, v16
    v_mov_b32 v17, 0xeeeeeeee
    v_mov_b32 v18, 0x44444444
    v_cndmask_b32 v2, v17, v18, vcc
    s_cmp_eq_u32 s20, 0
    s_cbranch_scc0 layerb1_kernel_notp
    s_mov_b32 s12, s21
    s_cmp_eq_u32 s13, 0
    s_cbranch_scc1 layerb1_kernel_p0_start
    s_cmp_eq_u32 s13, 1
    s_cbranch_scc1 layerb1_kernel_p1_start
    s_cmp_eq_u32 s13, 2
    s_cbranch_scc1 layerb1_kernel_p2_start
    s_cmp_eq_u32 s13, 3
    s_cbranch_scc1 layerb1_kernel_p3_start
layerb1_kernel_notp:
    s_cmp_ge_u32 s20, 4
    s_cbranch_scc1 layerb1_kernel_proj
    s_cmp_ge_u32 s21, 27
    s_cbranch_scc1 layerb1_kernel_spare
    s_sub_u32 s22, s20, 1
    s_mul_i32 s22, s22, 27
    s_add_u32 s12, s22, s21
    s_cmp_ge_u32 s12, 80
    s_cbranch_scc1 layerb1_kernel_spare
    s_cmp_eq_u32 s13, 0
    s_cbranch_scc1 layerb1_kernel_y0_start
    s_cmp_eq_u32 s13, 1
    s_cbranch_scc1 layerb1_kernel_y1_start
    s_cmp_eq_u32 s13, 2
    s_cbranch_scc1 layerb1_kernel_y2_start
    s_cmp_eq_u32 s13, 3
    s_cbranch_scc1 layerb1_kernel_y3_start
    s_branch layerb1_kernel_end
layerb1_kernel_p0_start:
    v_lshrrev_b32 v16, 4, v0
    v_and_b32 v17, 15, v0
    v_and_b32 v18, 2, v0
    v_cmp_eq_u32 vcc, 0, v18
    v_mov_b32 v18, 0xeeeeeeee
    v_mov_b32 v19, 0x44444444
    v_cndmask_b32 v2, v18, v19, vcc
    v_lshrrev_b32 v20, 2, v17
    v_lshlrev_b32 v20, 1, v20
    v_and_b32 v21, 1, v17
    v_add_u32 v20, v20, v21
    v_bfe_u32 v21, v17, 1, 1
    v_lshl_add_u32 v18, v16, 1, v21
    v_lshlrev_b32 v18, 7, v18
    v_lshl_add_u32 v12, v20, 4, v18
    v_mul_u32_u24 v18, 400, v20
    v_lshl_add_u32 v18, v16, 5, v18
    v_lshl_add_u32 v18, v21, 4, v18
    v_add_u32 v4, 141312, v18
    v_mul_u32_u24 v18, 800, v16
    v_lshl_add_u32 v18, v17, 1, v18
    v_add_u32 v3, 141312, v18
    v_and_b32 v18, 7, v0
    v_mul_u32_u24 v18, 400, v18
    v_lshl_add_u32 v18, v16, 5, v18
    v_add_u32 v5, 144512, v18
    v_lshlrev_b32 v18, 3, v0
    v_add_u32 v6, 147712, v18
    v_lshlrev_b32 v18, 4, v16
    v_bfe_u32 v19, v17, 1, 2
    v_lshl_add_u32 v18, v19, 2, v18
    s_lshl_b32 s20, s12, 7
    s_add_u32 s20, s20, 0
    v_add_u32 v18, s20, v18
    v_lshrrev_b32 v19, 3, v17
    v_add_u32 v19, 1, v19
    v_lshrrev_b32 v20, 1, v19
    v_lshlrev_b32 v20, 14, v20
    v_and_b32 v19, 1, v19
    v_lshl_add_u32 v19, v19, 12, v20
    v_add_u32 v19, v19, v18
    v_mov_b32 v20, 0x7ffffff0
    v_and_b32 v21, 7, v0
    v_cmp_eq_u32 vcc, 4, v21
    v_subrev_u32 v21, 8, v18
    s_nop 0
    v_cndmask_b32 v7, v19, v21, vcc
    v_and_b32 v21, 0x29, v0
    v_cmp_eq_u32 vcc, 0, v21
    s_nop 1
    v_cndmask_b32 v8, v20, v18, vcc
    v_lshlrev_b32 v18, 4, v17
    v_lshl_add_u32 v18, v16, 10, v18
    v_add_u32 v9, 0, v18
    v_add_u32 v18, 0, v0
    v_mul_u32_u24 v19, 2731, v18
    v_lshrrev_b32 v19, 16, v19
    v_mul_u32_u24 v20, 24, v19
    v_sub_u32 v20, v18, v20
    v_mul_u32_u24 v21, 400, v19
    v_lshl_add_u32 v21, v20, 4, v21
    v_add_u32 v10, 144512, v21
    v_lshlrev_b32 v21, 4, v19
    v_lshl_add_u32 v11, v20, 7, v21
    v_add_u32 v13, 0, v1
    v_add_u32 v14, 131072, v1
    s_mul_i32 s44, s12, 12288
    s_add_u32 s44, s44, 53477376
    s_mul_i32 s45, s12, 3072
    s_add_u32 s45, s45, 208666624
    s_mul_i32 s20, s12, 6
    s_add_u32 s21, s20, 5
    s_lshr_b32 s20, s20, 3
    s_lshr_b32 s21, s21, 3
    s_add_u32 s20, s20, 80
    s_add_u32 s21, s21, 80
    s_lshl_b32 s20, s20, 7
    s_lshl_b32 s21, s21, 7
    v_mov_b32 v255, s21
    v_mov_b32 v253, s20
    v_cmp_eq_u32 vcc, 0, v0
    s_nop 1
    v_cndmask_b32 v255, v255, v253, vcc
    s_mov_b32 s47, 0
    s_mul_i32 s20, s12, 491520
    s_add_u32 s20, s20, 11534336
    s_add_u32 s21, s20, 2048
    buffer_load_dwordx4 v[16:19], v1, s[8:11], s21 offen offset:0
    buffer_load_dwordx4 v[20:23], v1, s[8:11], s21 offen offset:1024
    s_add_u32 s21, s20, 24576
    buffer_load_dwordx4 v[24:27], v1, s[8:11], s21 offen offset:0
    buffer_load_dwordx4 v[28:31], v1, s[8:11], s21 offen offset:1024
    s_add_u32 s21, s20, 6144
    buffer_load_dwordx4 v[32:35], v1, s[8:11], s21 offen offset:0
    buffer_load_dwordx4 v[36:39], v1, s[8:11], s21 offen offset:1024
    s_add_u32 s21, s20, 14336
    buffer_load_dwordx4 v[40:43], v1, s[8:11], s21 offen offset:0
    buffer_load_dwordx4 v[44:47], v1, s[8:11], s21 offen offset:1024
    s_add_u32 s21, s20, 28672
    buffer_load_dwordx4 v[48:51], v1, s[8:11], s21 offen offset:0
    buffer_load_dwordx4 v[52:55], v1, s[8:11], s21 offen offset:1024
    s_add_u32 s21, s20, 36864
    buffer_load_dwordx4 v[56:59], v1, s[8:11], s21 offen offset:0
    buffer_load_dwordx4 v[60:63], v1, s[8:11], s21 offen offset:1024
    s_add_u32 s21, s20, 51200
    buffer_load_dwordx4 v[64:67], v1, s[8:11], s21 offen offset:0
    buffer_load_dwordx4 v[68:71], v1, s[8:11], s21 offen offset:1024
    s_add_u32 s21, s20, 59392
    buffer_load_dwordx4 v[72:75], v1, s[8:11], s21 offen offset:0
    buffer_load_dwordx4 v[76:79], v1, s[8:11], s21 offen offset:1024
    s_add_u32 s21, s20, 73728
    buffer_load_dwordx4 v[80:83], v1, s[8:11], s21 offen offset:0
    buffer_load_dwordx4 v[84:87], v1, s[8:11], s21 offen offset:1024
    s_add_u32 s21, s20, 65536
    buffer_load_dwordx4 v[88:91], v1, s[8:11], s21 offen offset:0
    buffer_load_dwordx4 v[92:95], v1, s[8:11], s21 offen offset:1024
    s_add_u32 s21, s20, 94208
    buffer_load_dwordx4 v[96:99], v1, s[8:11], s21 offen offset:0
    buffer_load_dwordx4 v[100:103], v1, s[8:11], s21 offen offset:1024
    s_add_u32 s21, s20, 81920
    buffer_load_dwordx4 v[104:107], v1, s[8:11], s21 offen offset:0
    buffer_load_dwordx4 v[108:111], v1, s[8:11], s21 offen offset:1024
    s_add_u32 s21, s20, 108544
    buffer_load_dwordx4 v[112:115], v1, s[8:11], s21 offen offset:0
    buffer_load_dwordx4 v[116:119], v1, s[8:11], s21 offen offset:1024
    s_add_u32 s21, s20, 114688
    buffer_load_dwordx4 v[120:123], v1, s[8:11], s21 offen offset:0
    buffer_load_dwordx4 v[124:127], v1, s[8:11], s21 offen offset:1024
    s_add_u32 s21, s20, 120832
    buffer_load_dwordx4 v[128:131], v1, s[8:11], s21 offen offset:0
    buffer_load_dwordx4 v[132:135], v1, s[8:11], s21 offen offset:1024
    s_add_u32 s21, s20, 104448
    buffer_load_dwordx4 v[136:139], v1, s[8:11], s21 offen offset:0
    buffer_load_dwordx4 v[140:143], v1, s[8:11], s21 offen offset:1024
    s_add_u32 s21, s20, 92160
    buffer_load_dwordx4 v[156:159], v1, s[8:11], s21 offen offset:0
    buffer_load_dwordx4 v[160:163], v1, s[8:11], s21 offen offset:1024
    s_add_u32 s21, s20, 96256
    buffer_load_dwordx4 v[164:167], v1, s[8:11], s21 offen offset:0
    buffer_load_dwordx4 v[168:171], v1, s[8:11], s21 offen offset:1024
    s_add_u32 s21, s20, 98304
    buffer_load_dwordx4 v[172:175], v1, s[8:11], s21 offen offset:0
    buffer_load_dwordx4 v[176:179], v1, s[8:11], s21 offen offset:1024
    s_add_u32 s21, s20, 100352
    buffer_load_dwordx4 v[180:183], v1, s[8:11], s21 offen offset:0
    buffer_load_dwordx4 v[184:187], v1, s[8:11], s21 offen offset:1024
    s_add_u32 s21, s20, 83968
    buffer_load_dwordx4 v[188:191], v1, s[8:11], s21 offen offset:0
    buffer_load_dwordx4 v[192:195], v1, s[8:11], s21 offen offset:1024
    s_add_u32 s21, s20, 86016
    buffer_load_dwordx4 v[196:199], v1, s[8:11], s21 offen offset:0
    buffer_load_dwordx4 v[200:203], v1, s[8:11], s21 offen offset:1024
    s_add_u32 s21, s20, 110592
    buffer_load_dwordx4 v[204:207], v1, s[8:11], s21 offen offset:0
    buffer_load_dwordx4 v[208:211], v1, s[8:11], s21 offen offset:1024
    s_add_u32 s21, s20, 112640
    buffer_load_dwordx4 v[212:215], v1, s[8:11], s21 offen offset:0
    buffer_load_dwordx4 v[216:219], v1, s[8:11], s21 offen offset:1024
    s_add_u32 s21, s20, 116736
    buffer_load_dwordx4 v[220:223], v1, s[8:11], s21 offen offset:0
    buffer_load_dwordx4 v[224:227], v1, s[8:11], s21 offen offset:1024
    s_add_u32 s21, s20, 118784
    buffer_load_dwordx4 v[228:231], v1, s[8:11], s21 offen offset:0
    buffer_load_dwordx4 v[232:235], v1, s[8:11], s21 offen offset:1024
    s_add_u32 s21, s20, 102400
    buffer_load_dwordx4 v[236:239], v1, s[8:11], s21 offen offset:0
    buffer_load_dwordx4 v[240:243], v1, s[8:11], s21 offen offset:1024
    s_add_u32 s21, s20, 106496
    buffer_load_dwordx4 v[244:247], v1, s[8:11], s21 offen offset:0
    buffer_load_dwordx4 v[248:251], v1, s[8:11], s21 offen offset:1024
    s_waitcnt vmcnt(24)
    ds_write_b128 v13, v[16:19] offset:0
    ds_write_b128 v13, v[20:23] offset:1024
    ds_write_b128 v13, v[24:27] offset:2048
    ds_write_b128 v13, v[28:31] offset:3072
    ds_write_b128 v13, v[32:35] offset:4096
    ds_write_b128 v13, v[36:39] offset:5120
    ds_write_b128 v13, v[40:43] offset:6144
    ds_write_b128 v13, v[44:47] offset:7168
    ds_write_b128 v13, v[48:51] offset:8192
    ds_write_b128 v13, v[52:55] offset:9216
    ds_write_b128 v13, v[56:59] offset:10240
    ds_write_b128 v13, v[60:63] offset:11264
    ds_write_b128 v13, v[64:67] offset:12288
    ds_write_b128 v13, v[68:71] offset:13312
    ds_write_b128 v13, v[72:75] offset:14336
    ds_write_b128 v13, v[76:79] offset:15360
    ds_write_b128 v13, v[80:83] offset:16384
    ds_write_b128 v13, v[84:87] offset:17408
    ds_write_b128 v13, v[88:91] offset:18432
    ds_write_b128 v13, v[92:95] offset:19456
    ds_write_b128 v13, v[96:99] offset:20480
    ds_write_b128 v13, v[100:103] offset:21504
    ds_write_b128 v13, v[104:107] offset:22528
    ds_write_b128 v13, v[108:111] offset:23552
    ds_write_b128 v13, v[112:115] offset:24576
    ds_write_b128 v13, v[116:119] offset:25600
    ds_write_b128 v13, v[120:123] offset:26624
    ds_write_b128 v13, v[124:127] offset:27648
    ds_write_b128 v13, v[128:131] offset:28672
    ds_write_b128 v13, v[132:135] offset:29696
    ds_write_b128 v13, v[136:139] offset:30720
    ds_write_b128 v13, v[140:143] offset:31744
    s_waitcnt lgkmcnt(0)
    s_add_u32 s20, s48, 51200
    s_mov_b64 exec, 3
    v_lshlrev_b32 v16, 2, v0
layerb1_kernel_p0_par:
    buffer_load_dword v17, v16, s[8:11], s20 offen sc1
    s_waitcnt vmcnt(0)
    v_cmp_eq_u32 vcc, 0, v17
    s_sub_u32 s15, s15, 1
    s_cbranch_scc1 layerb1_kernel_bail
    s_cbranch_vccnz layerb1_kernel_p0_par
    s_mov_b64 exec, -1
    v_readlane_b32 s20, v17, 0
    v_readlane_b32 s21, v17, 1
    s_nop 0
    s_and_b32 s20, s20, 8192
    s_and_b32 s21, s21, 8192
    s_add_u32 s16, s16, s20
    s_add_u32 s17, s17, s21
    s_mov_b32 s14, 0
    s_cmp_gt_u32 s47, s14
    s_cbranch_scc1 layerb1_kernel_p0_gw1_ok
layerb1_kernel_p0_gw1_lp:
    buffer_load_dword v253, v255, s[8:11], s48 offen sc1
    s_waitcnt vmcnt(0)
    v_readlane_b32 s47, v253, 0
    v_readlane_b32 s29, v253, 1
    s_nop 0
    s_min_u32 s47, s47, s29
    s_sub_u32 s15, s15, 1
    s_cbranch_scc1 layerb1_kernel_bail
    s_cmp_gt_u32 s47, s14
    s_cbranch_scc0 layerb1_kernel_p0_gw1_lp
layerb1_kernel_p0_gw1_ok:
    s_mul_i32 s20, s14, 393216
    s_add_u32 s20, s20, s44
    s_add_u32 s21, s20, 0
    buffer_load_dwordx4 v[100:103], v9, s[8:11], s21 offen offset:0 sc1
    buffer_load_dwordx4 v[104:107], v9, s[8:11], s21 offen offset:512 sc1
    s_add_u32 s21, s20, 4096
    buffer_load_dwordx4 v[108:111], v9, s[8:11], s21 offen offset:0 sc1
    buffer_load_dwordx4 v[112:115], v9, s[8:11], s21 offen offset:512 sc1
    s_add_u32 s21, s20, 8192
    buffer_load_dwordx4 v[116:119], v9, s[8:11], s21 offen offset:0 sc1
    buffer_load_dwordx4 v[120:123], v9, s[8:11], s21 offen offset:512 sc1
    v_mov_b32 v56, 0
    v_mov_b32 v57, 0
    v_mov_b32 v58, 0
    v_mov_b32 v59, 0
    v_mov_b32 v60, 0
    v_mov_b32 v61, 0
    v_mov_b32 v62, 0
    v_mov_b32 v63, 0
    v_mov_b32 v64, 0
    v_mov_b32 v65, 0
    v_mov_b32 v66, 0
    v_mov_b32 v67, 0
    v_mov_b32 v68, 0
    v_mov_b32 v69, 0
    v_mov_b32 v70, 0
    v_mov_b32 v71, 0
    v_mov_b32 v72, 0
    v_mov_b32 v73, 0
    v_mov_b32 v74, 0
    v_mov_b32 v75, 0
    v_mov_b32 v76, 0
    v_mov_b32 v77, 0
    v_mov_b32 v78, 0
    v_mov_b32 v79, 0
    v_mov_b32 v80, 0
    v_mov_b32 v81, 0
    v_mov_b32 v82, 0
    v_mov_b32 v83, 0
    v_mov_b32 v84, 0
    v_mov_b32 v85, 0
    v_mov_b32 v86, 0
    v_mov_b32 v87, 0
    ds_read_b128 v[124:127], v13 offset:0
    ds_read_b128 v[128:131], v13 offset:1024
    ds_read_b128 v[132:135], v13 offset:2048
    ds_read_b128 v[136:139], v13 offset:3072
    ds_read_b128 v[140:143], v13 offset:4096
    ds_read_b128 v[144:147], v13 offset:5120
    ds_read_b128 v[148:151], v13 offset:6144
    ds_read_b128 v[152:155], v13 offset:7168
    s_waitcnt lgkmcnt(0)
layerb1_kernel_p0_step:
    s_cmp_lt_u32 s14, 32
    s_cselect_b32 s18, s16, s17
    s_and_b32 s20, s14, 31
    s_lshl_b32 s20, s20, 16
    s_add_u32 s18, s18, s20
    s_add_u32 s22, s18, 36864
    s_add_u32 s23, s18, 37888
    s_add_u32 s24, s18, 38912
layerb1_kernel_p0_poll:
    buffer_load_dwordx4 v[16:19], v12, s[8:11], s22 offen sc1
    buffer_load_dwordx4 v[20:23], v12, s[8:11], s23 offen sc1
    buffer_load_dwordx4 v[24:27], v12, s[8:11], s24 offen sc1
    s_waitcnt vmcnt(0)
    ds_write_b128 v14, v[16:19] offset:0
    ds_write_b128 v14, v[20:23] offset:1024
    ds_write_b128 v14, v[24:27] offset:2048
    v_max3_u32 v88, v16, v17, v18
    v_max3_u32 v88, v88, v19, v20
    v_max3_u32 v88, v88, v21, v22
    v_max3_u32 v88, v88, v23, v24
    v_max3_u32 v88, v88, v25, v26
    v_max_u32 v88, v88, v27
    v_cmp_eq_u32 vcc, -1, v88
    s_sub_u32 s15, s15, 1
    s_cbranch_scc1 layerb1_kernel_bail
    s_cbranch_vccnz layerb1_kernel_p0_poll
    v_smfmac_f32_16x16x64_bf16 v[56:59], v[16:19], a[0:7], v2
    v_smfmac_f32_16x16x64_bf16 v[60:63], v[16:19], a[8:15], v2
    v_smfmac_f32_16x16x64_bf16 v[64:67], v[16:19], a[16:23], v2
    v_smfmac_f32_16x16x64_bf16 v[56:59], v[20:23], v[124:131], v2
    ds_read_b128 v[124:127], v13 offset:8192
    v_smfmac_f32_16x16x64_bf16 v[60:63], v[20:23], a[24:31], v2
    s_waitcnt lgkmcnt(1)
    s_barrier
    v_smfmac_f32_16x16x64_bf16 v[64:67], v[20:23], a[32:39], v2
    ds_read_b128 v[28:31], v14 offset:3072
    v_smfmac_f32_16x16x64_bf16 v[56:59], v[24:27], a[40:47], v2
    ds_read_b128 v[32:35], v14 offset:4096
    v_smfmac_f32_16x16x64_bf16 v[60:63], v[24:27], v[132:139], v2
    ds_read_b128 v[36:39], v14 offset:5120
    v_smfmac_f32_16x16x64_bf16 v[64:67], v[24:27], a[48:55], v2
    ds_read_b128 v[40:43], v14 offset:6144
    v_smfmac_f32_16x16x64_bf16 v[68:71], v[16:19], a[56:63], v2
    ds_read_b128 v[44:47], v14 offset:7168
    v_smfmac_f32_16x16x64_bf16 v[68:71], v[20:23], a[64:71], v2
    s_waitcnt lgkmcnt(4)
    ds_read_b128 v[48:51], v14 offset:8192
    v_smfmac_f32_16x16x64_bf16 v[56:59], v[28:31], v[140:147], v2
    s_waitcnt lgkmcnt(4)
    ds_read_b128 v[52:55], v14 offset:9216
    v_smfmac_f32_16x16x64_bf16 v[56:59], v[32:35], a[72:79], v2
    s_waitcnt lgkmcnt(4)
    ds_read_b128 v[128:131], v13 offset:9216
    v_smfmac_f32_16x16x64_bf16 v[56:59], v[36:39], a[80:87], v2
    s_waitcnt lgkmcnt(4)
    ds_read_b128 v[132:135], v13 offset:10240
    v_smfmac_f32_16x16x64_bf16 v[56:59], v[40:43], a[88:95], v2
    s_waitcnt lgkmcnt(4)
    ds_read_b128 v[136:139], v13 offset:11264
    v_smfmac_f32_16x16x64_bf16 v[56:59], v[44:47], v[148:155], v2
    s_waitcnt lgkmcnt(4)
    ds_read_b128 v[140:143], v13 offset:12288
    v_smfmac_f32_16x16x64_bf16 v[56:59], v[48:51], a[96:103], v2
    s_waitcnt lgkmcnt(4)
    ds_read_b128 v[144:147], v13 offset:13312
    v_smfmac_f32_16x16x64_bf16 v[56:59], v[52:55], a[104:111], v2
    ds_read_b128 v[148:151], v13 offset:14336
    v_smfmac_f32_16x16x64_bf16 v[60:63], v[28:31], a[112:119], v2
    s_waitcnt lgkmcnt(5)
    ds_read_b128 v[152:155], v13 offset:15360
    v_smfmac_f32_16x16x64_bf16 v[60:63], v[32:35], v[124:131], v2
    ds_read_b128 v[124:127], v13 offset:16384
    v_add_f32 v56, v56, v58
    v_smfmac_f32_16x16x64_bf16 v[60:63], v[36:39], a[120:127], v2
    ds_read_b128 v[128:131], v13 offset:17408
    v_add_f32 v57, v57, v59
    v_smfmac_f32_16x16x64_bf16 v[60:63], v[40:43], a[128:135], v2
    v_cvt_pk_bf16_f32 v56, v56, v57
    v_smfmac_f32_16x16x64_bf16 v[60:63], v[44:47], a[136:143], v2
    s_waitcnt lgkmcnt(6)
    ds_write_b16 v3, v56 offset:0
    v_smfmac_f32_16x16x64_bf16 v[60:63], v[48:51], v[132:139], v2
    ds_write_b16_d16_hi v3, v56 offset:400
    v_smfmac_f32_16x16x64_bf16 v[60:63], v[52:55], a[144:151], v2
    ds_read_b128 v[132:135], v13 offset:18432
    v_smfmac_f32_16x16x64_bf16 v[64:67], v[28:31], a[152:159], v2
    ds_read_b128 v[136:139], v13 offset:19456
    v_smfmac_f32_16x16x64_bf16 v[64:67], v[32:35], a[160:167], v2
    s_waitcnt lgkmcnt(8)
    v_add_f32 v60, v60, v62
    v_smfmac_f32_16x16x64_bf16 v[64:67], v[36:39], v[140:147], v2
    ds_read_b128 v[140:143], v13 offset:20480
    v_add_f32 v61, v61, v63
    v_smfmac_f32_16x16x64_bf16 v[64:67], v[40:43], a[168:175], v2
    ds_read_b128 v[144:147], v13 offset:21504
    v_cvt_pk_bf16_f32 v60, v60, v61
    v_smfmac_f32_16x16x64_bf16 v[64:67], v[44:47], a[176:183], v2
    ds_write_b16 v3, v60 offset:128
    v_smfmac_f32_16x16x64_bf16 v[64:67], v[48:51], a[184:191], v2
    s_waitcnt lgkmcnt(9)
    ds_write_b16_d16_hi v3, v60 offset:528
    v_smfmac_f32_16x16x64_bf16 v[64:67], v[52:55], v[148:155], v2
    ds_read_b128 v[148:151], v13 offset:22528
    v_smfmac_f32_16x16x64_bf16 v[68:71], v[28:31], a[192:199], v2
    ds_read_b128 v[152:155], v13 offset:23552
    v_smfmac_f32_16x16x64_bf16 v[68:71], v[32:35], a[200:207], v2
    v_add_f32 v64, v64, v66
    v_smfmac_f32_16x16x64_bf16 v[68:71], v[36:39], a[208:215], v2
    s_waitcnt lgkmcnt(10)
    v_add_f32 v65, v65, v67
    v_smfmac_f32_16x16x64_bf16 v[68:71], v[40:43], v[124:131], v2
    ds_read_b128 v[124:127], v13 offset:24576
    v_cvt_pk_bf16_f32 v64, v64, v65
    v_smfmac_f32_16x16x64_bf16 v[68:71], v[44:47], a[216:223], v2
    ds_write_b16 v3, v64 offset:256
    v_smfmac_f32_16x16x64_bf16 v[68:71], v[48:51], a[224:231], v2
    ds_write_b16_d16_hi v3, v64 offset:656
    v_smfmac_f32_16x16x64_bf16 v[68:71], v[52:55], a[232:239], v2
    s_waitcnt lgkmcnt(9)
    ds_read_b128 v[128:131], v13 offset:25600
    v_smfmac_f32_16x16x64_bf16 v[68:71], v[24:27], v[132:139], v2
    ds_read_b128 v[132:135], v13 offset:26624
    v_smfmac_f32_16x16x64_bf16 v[72:75], v[28:31], a[240:247], v2
    ds_read_b128 v[136:139], v13 offset:27648
    v_smfmac_f32_16x16x64_bf16 v[72:75], v[32:35], a[248:255], v2
    v_add_f32 v68, v68, v70
    v_smfmac_f32_16x16x64_bf16 v[72:75], v[36:39], v[156:163], v2
    s_waitcnt lgkmcnt(10)
    v_add_f32 v69, v69, v71
    v_smfmac_f32_16x16x64_bf16 v[72:75], v[40:43], v[140:147], v2
    ds_read_b128 v[140:143], v13 offset:28672
    v_cvt_pk_bf16_f32 v68, v68, v69
    v_smfmac_f32_16x16x64_bf16 v[72:75], v[44:47], v[164:171], v2
    s_waitcnt lgkmcnt(4)
    s_barrier
    v_smfmac_f32_16x16x64_bf16 v[72:75], v[48:51], v[172:179], v2
    ds_read_b128 v[88:91], v4 offset:0
    v_smfmac_f32_16x16x64_bf16 v[72:75], v[52:55], v[180:187], v2
    ds_read_b128 v[92:95], v4 offset:128
    v_smfmac_f32_16x16x64_bf16 v[72:75], v[16:19], v[148:155], v2
    ds_read_b128 v[96:99], v4 offset:256
    v_smfmac_f32_16x16x64_bf16 v[72:75], v[20:23], v[188:195], v2
    ds_write_b16 v3, v68 offset:3200
    v_smfmac_f32_16x16x64_bf16 v[72:75], v[24:27], v[196:203], v2
    s_waitcnt lgkmcnt(7)
    ds_write_b16_d16_hi v3, v68 offset:3600
    v_smfmac_f32_16x16x64_bf16 v[76:79], v[28:31], v[124:131], v2
    s_waitcnt lgkmcnt(4)
    ds_read_b128 v[144:147], v13 offset:29696
    v_smfmac_f32_16x16x64_bf16 v[80:83], v[88:91], v[100:107], v2
    s_waitcnt lgkmcnt(4)
    ds_read_b128 v[148:151], v13 offset:30720
    v_add_f32 v72, v72, v74
    v_smfmac_f32_16x16x64_bf16 v[80:83], v[92:95], v[108:115], v2
    s_waitcnt lgkmcnt(4)
    ds_read_b128 v[152:155], v13 offset:31744
    v_add_f32 v73, v73, v75
    v_smfmac_f32_16x16x64_bf16 v[80:83], v[96:99], v[116:123], v2
    v_cvt_pk_bf16_f32 v72, v72, v73
    v_smfmac_f32_16x16x64_bf16 v[76:79], v[32:35], v[204:211], v2
    ds_write_b16 v3, v72 offset:3328
    v_smfmac_f32_16x16x64_bf16 v[76:79], v[36:39], v[212:219], v2
    ds_write_b16_d16_hi v3, v72 offset:3728
    v_smfmac_f32_16x16x64_bf16 v[76:79], v[40:43], v[132:139], v2
    v_add_f32 v56, v80, v82
    v_smfmac_f32_16x16x64_bf16 v[76:79], v[44:47], v[220:227], v2
    v_mul_f32 v56, 0x3dd53b95, v56
    v_smfmac_f32_16x16x64_bf16 v[76:79], v[48:51], v[228:235], v2
    s_waitcnt lgkmcnt(4)
    v_max_f32_dpp v58, v56, v56 row_ror:8 row_mask:0xf bank_mask:0xf
    v_smfmac_f32_16x16x64_bf16 v[76:79], v[52:55], v[140:147], v2
    s_waitcnt lgkmcnt(0)
    s_barrier
    v_max_f32_dpp v58, v58, v58 row_ror:4 row_mask:0xf bank_mask:0xf
    v_smfmac_f32_16x16x64_bf16 v[76:79], v[16:19], v[236:243], v2
    ds_read_b128 v[100:103], v5 offset:0
    v_max_f32_dpp v58, v58, v58 row_ror:2 row_mask:0xf bank_mask:0xf
    v_smfmac_f32_16x16x64_bf16 v[76:79], v[20:23], v[148:155], v2
    ds_read_b128 v[104:107], v5 offset:16
    v_max_f32_dpp v58, v58, v58 row_ror:1 row_mask:0xf bank_mask:0xf
    v_smfmac_f32_16x16x64_bf16 v[76:79], v[24:27], v[244:251], v2
    ds_read_b128 v[108:111], v5 offset:128
    v_sub_f32 v60, v56, v58
    ds_read_b128 v[112:115], v5 offset:144
    v_exp_f32 v60, v60
    s_nop 1
    v_add_f32_dpp v59, v60, v60 row_ror:8 row_mask:0xf bank_mask:0xf
    s_nop 1
    v_add_f32_dpp v59, v59, v59 row_ror:4 row_mask:0xf bank_mask:0xf
    s_nop 1
    v_add_f32_dpp v59, v59, v59 row_ror:2 row_mask:0xf bank_mask:0xf
    s_nop 1
    v_add_f32_dpp v59, v59, v59 row_ror:1 row_mask:0xf bank_mask:0xf
    v_add_f32 v76, v76, v78
    v_add_f32 v77, v77, v79
    v_cvt_pk_bf16_f32 v76, v76, v77
    ds_write_b16 v3, v76 offset:3456
    ds_write_b16_d16_hi v3, v76 offset:3856
    ds_write_b64 v6, v[58:59] offset:0
    s_waitcnt lgkmcnt(5)
    v_smfmac_f32_16x16x64_bf16 v[84:87], v[88:91], v[100:107], v2
    s_waitcnt lgkmcnt(3)
    v_smfmac_f32_16x16x64_bf16 v[84:87], v[92:95], v[108:115], v2
    s_waitcnt lgkmcnt(0)
    s_barrier
    ds_read_b128 v[116:119], v5 offset:256
    ds_read_b128 v[120:123], v5 offset:272
    ds_read_b64 v[16:17], v6 offset:512
    s_waitcnt lgkmcnt(1)
    v_smfmac_f32_16x16x64_bf16 v[84:87], v[96:99], v[116:123], v2
    s_waitcnt lgkmcnt(0)
    v_max_f32 v18, v58, v16
    v_sub_f32 v19, v58, v18
    v_sub_f32 v20, v16, v18
    v_exp_f32 v19, v19
    v_exp_f32 v20, v20
    s_nop 0
    v_mul_f32 v21, v59, v19
    v_mul_f32 v60, v60, v19
    v_fmac_f32 v21, v17, v20
    v_add_f32 v22, v84, v86
    v_mul_f32 v22, 0x3dd53b95, v22
    v_max_f32 v23, v22, v18
    s_nop 0
    v_max_f32_dpp v24, v22, v23 row_ror:4 row_mask:0xf bank_mask:0xf
    s_nop 1
    v_max_f32_dpp v24, v24, v24 row_ror:2 row_mask:0xf bank_mask:0xf
    s_nop 1
    v_max_f32_dpp v24, v24, v24 row_ror:1 row_mask:0xf bank_mask:0xf
    v_sub_f32 v25, v22, v24
    v_sub_f32 v26, v18, v24
    v_exp_f32 v25, v25
    v_exp_f32 v26, v26
    s_nop 0
    v_add_f32_dpp v23, v25, v25 row_ror:4 row_mask:0xf bank_mask:0xf
    v_mul_f32 v60, v60, v26
    s_nop 0
    v_add_f32_dpp v23, v23, v23 row_ror:2 row_mask:0xf bank_mask:0xf
    s_nop 1
    v_add_f32_dpp v23, v23, v23 row_ror:1 row_mask:0xf bank_mask:0xf
    v_fmac_f32 v23, v26, v21
    v_rcp_f32 v27, v23
    s_nop 0
    v_mul_f32 v60, v60, v27
    v_mul_f32 v25, v25, v27
    s_nop 0
    v_mov_b32_dpp v19, v60 quad_perm:[1,0,3,2] row_mask:0xf bank_mask:0xf
    v_mov_b32_dpp v20, v25 quad_perm:[1,0,3,2] row_mask:0xf bank_mask:0xf
    v_cvt_pk_bf16_f32 v28, v60, v19
    v_cvt_pk_bf16_f32 v25, v25, v20
    s_nop 0
    v_mov_b32_dpp v29, v28 row_shl:2 row_mask:0xf bank_mask:0xf
    v_mov_b32_dpp v30, v28 row_shl:4 row_mask:0xf bank_mask:0xf
    v_mov_b32_dpp v31, v28 row_shl:6 row_mask:0xf bank_mask:0xf
    v_mov_b32_dpp v28, v25 row_shr:4 row_mask:0xf bank_mask:0x2
    v_mov_b32_dpp v29, v25 row_shr:2 row_mask:0xf bank_mask:0x2
    v_mov_b32_dpp v30, v25 quad_perm:[0,1,2,3] row_mask:0xf bank_mask:0x2
    v_mov_b32_dpp v31, v25 row_shl:2 row_mask:0xf bank_mask:0x2
    s_mov_b32 exec_lo, 0x1110111
    s_mov_b32 exec_hi, 0x1010101
    buffer_store_dwordx4 v[28:31], v7, s[8:11], s18 offen sc1
    s_mov_b64 exec, -1
    ds_read_b128 v[40:43], v10
    s_add_u32 s28, s14, 1
    s_min_u32 s28, s28, 63
    s_cmp_gt_u32 s47, s28
    s_cbranch_scc1 layerb1_kernel_p0_gw2_ok
layerb1_kernel_p0_gw2_lp:
    buffer_load_dword v253, v255, s[8:11], s48 offen sc1
    s_waitcnt vmcnt(0)
    v_readlane_b32 s47, v253, 0
    v_readlane_b32 s29, v253, 1
    s_nop 0
    s_min_u32 s47, s47, s29
    s_sub_u32 s15, s15, 1
    s_cbranch_scc1 layerb1_kernel_bail
    s_cmp_gt_u32 s47, s28
    s_cbranch_scc0 layerb1_kernel_p0_gw2_lp
layerb1_kernel_p0_gw2_ok:
    s_mul_i32 s20, s28, 393216
    s_add_u32 s20, s20, s44
    s_add_u32 s21, s20, 0
    buffer_load_dwordx4 v[100:103], v9, s[8:11], s21 offen offset:0 sc1
    buffer_load_dwordx4 v[104:107], v9, s[8:11], s21 offen offset:512 sc1
    s_add_u32 s21, s20, 4096
    buffer_load_dwordx4 v[108:111], v9, s[8:11], s21 offen offset:0 sc1
    buffer_load_dwordx4 v[112:115], v9, s[8:11], s21 offen offset:512 sc1
    s_add_u32 s21, s20, 8192
    buffer_load_dwordx4 v[116:119], v9, s[8:11], s21 offen offset:0 sc1
    buffer_load_dwordx4 v[120:123], v9, s[8:11], s21 offen offset:512 sc1
    v_mov_b32 v56, 0
    v_mov_b32 v57, 0
    v_mov_b32 v58, 0
    v_mov_b32 v59, 0
    v_mov_b32 v60, 0
    v_mov_b32 v61, 0
    v_mov_b32 v62, 0
    v_mov_b32 v63, 0
    v_mov_b32 v64, 0
    v_mov_b32 v65, 0
    v_mov_b32 v66, 0
    v_mov_b32 v67, 0
    v_mov_b32 v68, 0
    v_mov_b32 v69, 0
    v_mov_b32 v70, 0
    v_mov_b32 v71, 0
    v_mov_b32 v72, 0
    v_mov_b32 v73, 0
    v_mov_b32 v74, 0
    v_mov_b32 v75, 0
    v_mov_b32 v76, 0
    v_mov_b32 v77, 0
    v_mov_b32 v78, 0
    v_mov_b32 v79, 0
    v_mov_b32 v80, 0
    v_mov_b32 v81, 0
    v_mov_b32 v82, 0
    v_mov_b32 v83, 0
    v_mov_b32 v84, 0
    v_mov_b32 v85, 0
    v_mov_b32 v86, 0
    v_mov_b32 v87, 0
    s_waitcnt lgkmcnt(0)
    s_mul_i32 s20, s14, 98304
    s_add_u32 s20, s20, s45
    buffer_store_dwordx4 v[40:43], v11, s[8:11], s20 offen sc1
    ds_read_b128 v[124:127], v13 offset:0
    ds_read_b128 v[128:131], v13 offset:1024
    ds_read_b128 v[132:135], v13 offset:2048
    ds_read_b128 v[136:139], v13 offset:3072
    ds_read_b128 v[140:143], v13 offset:4096
    ds_read_b128 v[144:147], v13 offset:5120
    ds_read_b128 v[148:151], v13 offset:6144
    ds_read_b128 v[152:155], v13 offset:7168
    s_waitcnt lgkmcnt(0)
    s_add_u32 s14, s14, 1
    s_cmp_lt_u32 s14, 64
    s_cbranch_scc1 layerb1_kernel_p0_step
    s_waitcnt vmcnt(0)
    s_barrier
    s_branch layerb1_kernel_end
layerb1_kernel_p1_start:
    v_lshrrev_b32 v16, 4, v0
    v_and_b32 v17, 15, v0
    v_and_b32 v18, 2, v0
    v_cmp_eq_u32 vcc, 0, v18
    v_mov_b32 v18, 0xeeeeeeee
    v_mov_b32 v19, 0x44444444
    v_cndmask_b32 v2, v18, v19, vcc
    v_lshrrev_b32 v20, 2, v17
    v_lshlrev_b32 v20, 1, v20
    v_and_b32 v21, 1, v17
    v_add_u32 v20, v20, v21
    v_bfe_u32 v21, v17, 1, 1
    v_lshl_add_u32 v18, v16, 1, v21
    v_lshlrev_b32 v18, 7, v18
    v_lshl_add_u32 v12, v20, 4, v18
    v_mul_u32_u24 v18, 400, v20
    v_lshl_add_u32 v18, v16, 5, v18
    v_lshl_add_u32 v18, v21, 4, v18
    v_add_u32 v4, 141312, v18
    v_mul_u32_u24 v18, 800, v16
    v_lshl_add_u32 v18, v17, 1, v18
    v_add_u32 v3, 141344, v18
    v_and_b32 v18, 7, v0
    v_mul_u32_u24 v18, 400, v18
    v_lshl_add_u32 v18, v16, 5, v18
    v_add_u32 v5, 144512, v18
    v_lshlrev_b32 v18, 3, v0
    v_add_u32 v6, 147712, v18
    v_lshlrev_b32 v18, 4, v16
    v_bfe_u32 v19, v17, 1, 2
    v_lshl_add_u32 v18, v19, 2, v18
    s_lshl_b32 s20, s12, 7
    s_add_u32 s20, s20, 0
    v_add_u32 v18, s20, v18
    v_lshrrev_b32 v19, 3, v17
    v_add_u32 v19, 3, v19
    v_lshrrev_b32 v20, 1, v19
    v_lshlrev_b32 v20, 14, v20
    v_and_b32 v19, 1, v19
    v_lshl_add_u32 v19, v19, 12, v20
    v_add_u32 v19, v19, v18
    v_mov_b32 v20, 0x7ffffff0
    v_and_b32 v21, 7, v0
    v_cmp_eq_u32 vcc, 4, v21
    v_subrev_u32 v21, 8, v18
    s_nop 0
    v_cndmask_b32 v7, v19, v21, vcc
    v_and_b32 v21, 0x29, v0
    v_cmp_eq_u32 vcc, 32, v21
    s_nop 1
    v_cndmask_b32 v8, v20, v18, vcc
    v_lshlrev_b32 v18, 4, v17
    v_lshl_add_u32 v18, v16, 10, v18
    v_add_u32 v9, 256, v18
    v_add_u32 v18, 64, v0
    v_mul_u32_u24 v19, 2731, v18
    v_lshrrev_b32 v19, 16, v19
    v_mul_u32_u24 v20, 24, v19
    v_sub_u32 v20, v18, v20
    v_mul_u32_u24 v21, 400, v19
    v_lshl_add_u32 v21, v20, 4, v21
    v_add_u32 v10, 144512, v21
    v_lshlrev_b32 v21, 4, v19
    v_lshl_add_u32 v11, v20, 7, v21
    v_add_u32 v13, 32768, v1
    v_add_u32 v14, 131072, v1
    s_mul_i32 s44, s12, 12288
    s_add_u32 s44, s44, 53477376
    s_mul_i32 s45, s12, 3072
    s_add_u32 s45, s45, 208666624
    s_mul_i32 s20, s12, 6
    s_add_u32 s21, s20, 5
    s_lshr_b32 s20, s20, 3
    s_lshr_b32 s21, s21, 3
    s_add_u32 s20, s20, 80
    s_add_u32 s21, s21, 80
    s_lshl_b32 s20, s20, 7
    s_lshl_b32 s21, s21, 7
    v_mov_b32 v255, s21
    v_mov_b32 v253, s20
    v_cmp_eq_u32 vcc, 0, v0
    s_nop 1
    v_cndmask_b32 v255, v255, v253, vcc
    s_mov_b32 s47, 0
    s_mul_i32 s20, s12, 491520
    s_add_u32 s20, s20, 11657216
    s_add_u32 s21, s20, 8192
    buffer_load_dwordx4 v[16:19], v1, s[8:11], s21 offen offset:0
    buffer_load_dwordx4 v[20:23], v1, s[8:11], s21 offen offset:1024
    s_add_u32 s21, s20, 30720
    buffer_load_dwordx4 v[24:27], v1, s[8:11], s21 offen offset:0
    buffer_load_dwordx4 v[28:31], v1, s[8:11], s21 offen offset:1024
    s_add_u32 s21, s20, 0
    buffer_load_dwordx4 v[32:35], v1, s[8:11], s21 offen offset:0
    buffer_load_dwordx4 v[36:39], v1, s[8:11], s21 offen offset:1024
    s_add_u32 s21, s20, 14336
    buffer_load_dwordx4 v[40:43], v1, s[8:11], s21 offen offset:0
    buffer_load_dwordx4 v[44:47], v1, s[8:11], s21 offen offset:1024
    s_add_u32 s21, s20, 22528
    buffer_load_dwordx4 v[48:51], v1, s[8:11], s21 offen offset:0
    buffer_load_dwordx4 v[52:55], v1, s[8:11], s21 offen offset:1024
    s_add_u32 s21, s20, 36864
    buffer_load_dwordx4 v[56:59], v1, s[8:11], s21 offen offset:0
    buffer_load_dwordx4 v[60:63], v1, s[8:11], s21 offen offset:1024
    s_add_u32 s21, s20, 45056
    buffer_load_dwordx4 v[64:67], v1, s[8:11], s21 offen offset:0
    buffer_load_dwordx4 v[68:71], v1, s[8:11], s21 offen offset:1024
    s_add_u32 s21, s20, 59392
    buffer_load_dwordx4 v[72:75], v1, s[8:11], s21 offen offset:0
    buffer_load_dwordx4 v[76:79], v1, s[8:11], s21 offen offset:1024
    s_add_u32 s21, s20, 73728
    buffer_load_dwordx4 v[80:83], v1, s[8:11], s21 offen offset:0
    buffer_load_dwordx4 v[84:87], v1, s[8:11], s21 offen offset:1024
    s_add_u32 s21, s20, 71680
    buffer_load_dwordx4 v[88:91], v1, s[8:11], s21 offen offset:0
    buffer_load_dwordx4 v[92:95], v1, s[8:11], s21 offen offset:1024
    s_add_u32 s21, s20, 94208
    buffer_load_dwordx4 v[96:99], v1, s[8:11], s21 offen offset:0
    buffer_load_dwordx4 v[100:103], v1, s[8:11], s21 offen offset:1024
    s_add_u32 s21, s20, 88064
    buffer_load_dwordx4 v[104:107], v1, s[8:11], s21 offen offset:0
    buffer_load_dwordx4 v[108:111], v1, s[8:11], s21 offen offset:1024
    s_add_u32 s21, s20, 102400
    buffer_load_dwordx4 v[112:115], v1, s[8:11], s21 offen offset:0
    buffer_load_dwordx4 v[116:119], v1, s[8:11], s21 offen offset:1024
    s_add_u32 s21, s20, 114688
    buffer_load_dwordx4 v[120:123], v1, s[8:11], s21 offen offset:0
    buffer_load_dwordx4 v[124:127], v1, s[8:11], s21 offen offset:1024
    s_add_u32 s21, s20, 120832
    buffer_load_dwordx4 v[128:131], v1, s[8:11], s21 offen offset:0
    buffer_load_dwordx4 v[132:135], v1, s[8:11], s21 offen offset:1024
    s_add_u32 s21, s20, 110592
    buffer_load_dwordx4 v[136:139], v1, s[8:11], s21 offen offset:0
    buffer_load_dwordx4 v[140:143], v1, s[8:11], s21 offen offset:1024
    s_add_u32 s21, s20, 86016
    buffer_load_dwordx4 v[156:159], v1, s[8:11], s21 offen offset:0
    buffer_load_dwordx4 v[160:163], v1, s[8:11], s21 offen offset:1024
    s_add_u32 s21, s20, 96256
    buffer_load_dwordx4 v[164:167], v1, s[8:11], s21 offen offset:0
    buffer_load_dwordx4 v[168:171], v1, s[8:11], s21 offen offset:1024
    s_add_u32 s21, s20, 98304
    buffer_load_dwordx4 v[172:175], v1, s[8:11], s21 offen offset:0
    buffer_load_dwordx4 v[176:179], v1, s[8:11], s21 offen offset:1024
    s_add_u32 s21, s20, 100352
    buffer_load_dwordx4 v[180:183], v1, s[8:11], s21 offen offset:0
    buffer_load_dwordx4 v[184:187], v1, s[8:11], s21 offen offset:1024
    s_add_u32 s21, s20, 90112
    buffer_load_dwordx4 v[188:191], v1, s[8:11], s21 offen offset:0
    buffer_load_dwordx4 v[192:195], v1, s[8:11], s21 offen offset:1024
    s_add_u32 s21, s20, 92160
    buffer_load_dwordx4 v[196:199], v1, s[8:11], s21 offen offset:0
    buffer_load_dwordx4 v[200:203], v1, s[8:11], s21 offen offset:1024
    s_add_u32 s21, s20, 104448
    buffer_load_dwordx4 v[204:207], v1, s[8:11], s21 offen offset:0
    buffer_load_dwordx4 v[208:211], v1, s[8:11], s21 offen offset:1024
    s_add_u32 s21, s20, 106496
    buffer_load_dwordx4 v[212:215], v1, s[8:11], s21 offen offset:0
    buffer_load_dwordx4 v[216:219], v1, s[8:11], s21 offen offset:1024
    s_add_u32 s21, s20, 116736
    buffer_load_dwordx4 v[220:223], v1, s[8:11], s21 offen offset:0
    buffer_load_dwordx4 v[224:227], v1, s[8:11], s21 offen offset:1024
    s_add_u32 s21, s20, 118784
    buffer_load_dwordx4 v[228:231], v1, s[8:11], s21 offen offset:0
    buffer_load_dwordx4 v[232:235], v1, s[8:11], s21 offen offset:1024
    s_add_u32 s21, s20, 108544
    buffer_load_dwordx4 v[236:239], v1, s[8:11], s21 offen offset:0
    buffer_load_dwordx4 v[240:243], v1, s[8:11], s21 offen offset:1024
    s_add_u32 s21, s20, 112640
    buffer_load_dwordx4 v[244:247], v1, s[8:11], s21 offen offset:0
    buffer_load_dwordx4 v[248:251], v1, s[8:11], s21 offen offset:1024
    s_waitcnt vmcnt(24)
    ds_write_b128 v13, v[16:19] offset:0
    ds_write_b128 v13, v[20:23] offset:1024
    ds_write_b128 v13, v[24:27] offset:2048
    ds_write_b128 v13, v[28:31] offset:3072
    ds_write_b128 v13, v[32:35] offset:4096
    ds_write_b128 v13, v[36:39] offset:5120
    ds_write_b128 v13, v[40:43] offset:6144
    ds_write_b128 v13, v[44:47] offset:7168
    ds_write_b128 v13, v[48:51] offset:8192
    ds_write_b128 v13, v[52:55] offset:9216
    ds_write_b128 v13, v[56:59] offset:10240
    ds_write_b128 v13, v[60:63] offset:11264
    ds_write_b128 v13, v[64:67] offset:12288
    ds_write_b128 v13, v[68:71] offset:13312
    ds_write_b128 v13, v[72:75] offset:14336
    ds_write_b128 v13, v[76:79] offset:15360
    ds_write_b128 v13, v[80:83] offset:16384
    ds_write_b128 v13, v[84:87] offset:17408
    ds_write_b128 v13, v[88:91] offset:18432
    ds_write_b128 v13, v[92:95] offset:19456
    ds_write_b128 v13, v[96:99] offset:20480
    ds_write_b128 v13, v[100:103] offset:21504
    ds_write_b128 v13, v[104:107] offset:22528
    ds_write_b128 v13, v[108:111] offset:23552
    ds_write_b128 v13, v[112:115] offset:24576
    ds_write_b128 v13, v[116:119] offset:25600
    ds_write_b128 v13, v[120:123] offset:26624
    ds_write_b128 v13, v[124:127] offset:27648
    ds_write_b128 v13, v[128:131] offset:28672
    ds_write_b128 v13, v[132:135] offset:29696
    ds_write_b128 v13, v[136:139] offset:30720
    ds_write_b128 v13, v[140:143] offset:31744
    s_waitcnt lgkmcnt(0)
    s_add_u32 s20, s48, 51200
    s_mov_b64 exec, 3
    v_lshlrev_b32 v16, 2, v0
layerb1_kernel_p1_par:
    buffer_load_dword v17, v16, s[8:11], s20 offen sc1
    s_waitcnt vmcnt(0)
    v_cmp_eq_u32 vcc, 0, v17
    s_sub_u32 s15, s15, 1
    s_cbranch_scc1 layerb1_kernel_bail
    s_cbranch_vccnz layerb1_kernel_p1_par
    s_mov_b64 exec, -1
    v_readlane_b32 s20, v17, 0
    v_readlane_b32 s21, v17, 1
    s_nop 0
    s_and_b32 s20, s20, 8192
    s_and_b32 s21, s21, 8192
    s_add_u32 s16, s16, s20
    s_add_u32 s17, s17, s21
    s_mov_b32 s14, 0
    s_cmp_gt_u32 s47, s14
    s_cbranch_scc1 layerb1_kernel_p1_gw1_ok
layerb1_kernel_p1_gw1_lp:
    buffer_load_dword v253, v255, s[8:11], s48 offen sc1
    s_waitcnt vmcnt(0)
    v_readlane_b32 s47, v253, 0
    v_readlane_b32 s29, v253, 1
    s_nop 0
    s_min_u32 s47, s47, s29
    s_sub_u32 s15, s15, 1
    s_cbranch_scc1 layerb1_kernel_bail
    s_cmp_gt_u32 s47, s14
    s_cbranch_scc0 layerb1_kernel_p1_gw1_lp
layerb1_kernel_p1_gw1_ok:
    s_mul_i32 s20, s14, 393216
    s_add_u32 s20, s20, s44
    s_add_u32 s21, s20, 0
    buffer_load_dwordx4 v[100:103], v9, s[8:11], s21 offen offset:0 sc1
    buffer_load_dwordx4 v[104:107], v9, s[8:11], s21 offen offset:512 sc1
    s_add_u32 s21, s20, 4096
    buffer_load_dwordx4 v[108:111], v9, s[8:11], s21 offen offset:0 sc1
    buffer_load_dwordx4 v[112:115], v9, s[8:11], s21 offen offset:512 sc1
    s_add_u32 s21, s20, 8192
    buffer_load_dwordx4 v[116:119], v9, s[8:11], s21 offen offset:0 sc1
    buffer_load_dwordx4 v[120:123], v9, s[8:11], s21 offen offset:512 sc1
    v_mov_b32 v56, 0
    v_mov_b32 v57, 0
    v_mov_b32 v58, 0
    v_mov_b32 v59, 0
    v_mov_b32 v60, 0
    v_mov_b32 v61, 0
    v_mov_b32 v62, 0
    v_mov_b32 v63, 0
    v_mov_b32 v64, 0
    v_mov_b32 v65, 0
    v_mov_b32 v66, 0
    v_mov_b32 v67, 0
    v_mov_b32 v68, 0
    v_mov_b32 v69, 0
    v_mov_b32 v70, 0
    v_mov_b32 v71, 0
    v_mov_b32 v72, 0
    v_mov_b32 v73, 0
    v_mov_b32 v74, 0
    v_mov_b32 v75, 0
    v_mov_b32 v76, 0
    v_mov_b32 v77, 0
    v_mov_b32 v78, 0
    v_mov_b32 v79, 0
    v_mov_b32 v80, 0
    v_mov_b32 v81, 0
    v_mov_b32 v82, 0
    v_mov_b32 v83, 0
    v_mov_b32 v84, 0
    v_mov_b32 v85, 0
    v_mov_b32 v86, 0
    v_mov_b32 v87, 0
    ds_read_b128 v[124:127], v13 offset:0
    ds_read_b128 v[128:131], v13 offset:1024
    ds_read_b128 v[132:135], v13 offset:2048
    ds_read_b128 v[136:139], v13 offset:3072
    ds_read_b128 v[140:143], v13 offset:4096
    ds_read_b128 v[144:147], v13 offset:5120
    ds_read_b128 v[148:151], v13 offset:6144
    ds_read_b128 v[152:155], v13 offset:7168
    s_waitcnt lgkmcnt(0)
layerb1_kernel_p1_step:
    s_cmp_lt_u32 s14, 32
    s_cselect_b32 s18, s16, s17
    s_and_b32 s20, s14, 31
    s_lshl_b32 s20, s20, 16
    s_add_u32 s18, s18, s20
    s_add_u32 s22, s18, 39936
    s_add_u32 s23, s18, 49152
    s_add_u32 s24, s18, 50176
layerb1_kernel_p1_poll:
    buffer_load_dwordx4 v[28:31], v12, s[8:11], s22 offen sc1
    buffer_load_dwordx4 v[32:35], v12, s[8:11], s23 offen sc1
    buffer_load_dwordx4 v[36:39], v12, s[8:11], s24 offen sc1
    s_waitcnt vmcnt(0)
    ds_write_b128 v14, v[28:31] offset:3072
    ds_write_b128 v14, v[32:35] offset:4096
    ds_write_b128 v14, v[36:39] offset:5120
    v_max3_u32 v88, v28, v29, v30
    v_max3_u32 v88, v88, v31, v32
    v_max3_u32 v88, v88, v33, v34
    v_max3_u32 v88, v88, v35, v36
    v_max3_u32 v88, v88, v37, v38
    v_max_u32 v88, v88, v39
    v_cmp_eq_u32 vcc, -1, v88
    s_sub_u32 s15, s15, 1
    s_cbranch_scc1 layerb1_kernel_bail
    s_cbranch_vccnz layerb1_kernel_p1_poll
    v_smfmac_f32_16x16x64_bf16 v[56:59], v[28:31], a[0:7], v2
    v_smfmac_f32_16x16x64_bf16 v[60:63], v[28:31], a[8:15], v2
    v_smfmac_f32_16x16x64_bf16 v[64:67], v[28:31], a[16:23], v2
    v_smfmac_f32_16x16x64_bf16 v[56:59], v[32:35], v[124:131], v2
    ds_read_b128 v[124:127], v13 offset:8192
    v_smfmac_f32_16x16x64_bf16 v[60:63], v[32:35], a[24:31], v2
    s_waitcnt lgkmcnt(1)
    s_barrier
    v_smfmac_f32_16x16x64_bf16 v[64:67], v[32:35], a[32:39], v2
    ds_read_b128 v[16:19], v14 offset:0
    v_smfmac_f32_16x16x64_bf16 v[56:59], v[36:39], a[40:47], v2
    ds_read_b128 v[20:23], v14 offset:1024
    v_smfmac_f32_16x16x64_bf16 v[60:63], v[36:39], v[132:139], v2
    ds_read_b128 v[24:27], v14 offset:2048
    v_smfmac_f32_16x16x64_bf16 v[64:67], v[36:39], a[48:55], v2
    ds_read_b128 v[40:43], v14 offset:6144
    v_smfmac_f32_16x16x64_bf16 v[68:71], v[28:31], a[56:63], v2
    ds_read_b128 v[44:47], v14 offset:7168
    v_smfmac_f32_16x16x64_bf16 v[68:71], v[32:35], a[64:71], v2
    s_waitcnt lgkmcnt(4)
    ds_read_b128 v[48:51], v14 offset:8192
    v_smfmac_f32_16x16x64_bf16 v[56:59], v[16:19], v[140:147], v2
    s_waitcnt lgkmcnt(4)
    ds_read_b128 v[52:55], v14 offset:9216
    v_smfmac_f32_16x16x64_bf16 v[56:59], v[20:23], a[72:79], v2
    s_waitcnt lgkmcnt(4)
    ds_read_b128 v[128:131], v13 offset:9216
    v_smfmac_f32_16x16x64_bf16 v[56:59], v[24:27], a[80:87], v2
    s_waitcnt lgkmcnt(4)
    ds_read_b128 v[132:135], v13 offset:10240
    v_smfmac_f32_16x16x64_bf16 v[56:59], v[40:43], a[88:95], v2
    s_waitcnt lgkmcnt(4)
    ds_read_b128 v[136:139], v13 offset:11264
    v_smfmac_f32_16x16x64_bf16 v[56:59], v[44:47], v[148:155], v2
    s_waitcnt lgkmcnt(4)
    ds_read_b128 v[140:143], v13 offset:12288
    v_smfmac_f32_16x16x64_bf16 v[56:59], v[48:51], a[96:103], v2
    s_waitcnt lgkmcnt(4)
    ds_read_b128 v[144:147], v13 offset:13312
    v_smfmac_f32_16x16x64_bf16 v[56:59], v[52:55], a[104:111], v2
    ds_read_b128 v[148:151], v13 offset:14336
    v_smfmac_f32_16x16x64_bf16 v[60:63], v[16:19], a[112:119], v2
    s_waitcnt lgkmcnt(5)
    ds_read_b128 v[152:155], v13 offset:15360
    v_smfmac_f32_16x16x64_bf16 v[60:63], v[20:23], v[124:131], v2
    ds_read_b128 v[124:127], v13 offset:16384
    v_add_f32 v56, v56, v58
    v_smfmac_f32_16x16x64_bf16 v[60:63], v[24:27], a[120:127], v2
    ds_read_b128 v[128:131], v13 offset:17408
    v_add_f32 v57, v57, v59
    v_smfmac_f32_16x16x64_bf16 v[60:63], v[40:43], a[128:135], v2
    v_cvt_pk_bf16_f32 v56, v56, v57
    v_smfmac_f32_16x16x64_bf16 v[60:63], v[44:47], a[136:143], v2
    s_waitcnt lgkmcnt(6)
    ds_write_b16 v3, v56 offset:0
    v_smfmac_f32_16x16x64_bf16 v[60:63], v[48:51], v[132:139], v2
    ds_write_b16_d16_hi v3, v56 offset:400
    v_smfmac_f32_16x16x64_bf16 v[60:63], v[52:55], a[144:151], v2
    ds_read_b128 v[132:135], v13 offset:18432
    v_smfmac_f32_16x16x64_bf16 v[64:67], v[16:19], a[152:159], v2
    ds_read_b128 v[136:139], v13 offset:19456
    v_smfmac_f32_16x16x64_bf16 v[64:67], v[20:23], a[160:167], v2
    s_waitcnt lgkmcnt(8)
    v_add_f32 v60, v60, v62
    v_smfmac_f32_16x16x64_bf16 v[64:67], v[24:27], v[140:147], v2
    ds_read_b128 v[140:143], v13 offset:20480
    v_add_f32 v61, v61, v63
    v_smfmac_f32_16x16x64_bf16 v[64:67], v[40:43], a[168:175], v2
    ds_read_b128 v[144:147], v13 offset:21504
    v_cvt_pk_bf16_f32 v60, v60, v61
    v_smfmac_f32_16x16x64_bf16 v[64:67], v[44:47], a[176:183], v2
    ds_write_b16 v3, v60 offset:128
    v_smfmac_f32_16x16x64_bf16 v[64:67], v[48:51], a[184:191], v2
    s_waitcnt lgkmcnt(9)
    ds_write_b16_d16_hi v3, v60 offset:528
    v_smfmac_f32_16x16x64_bf16 v[64:67], v[52:55], v[148:155], v2
    ds_read_b128 v[148:151], v13 offset:22528
    v_smfmac_f32_16x16x64_bf16 v[68:71], v[16:19], a[192:199], v2
    ds_read_b128 v[152:155], v13 offset:23552
    v_smfmac_f32_16x16x64_bf16 v[68:71], v[20:23], a[200:207], v2
    v_add_f32 v64, v64, v66
    v_smfmac_f32_16x16x64_bf16 v[68:71], v[24:27], a[208:215], v2
    s_waitcnt lgkmcnt(10)
    v_add_f32 v65, v65, v67
    v_smfmac_f32_16x16x64_bf16 v[68:71], v[40:43], v[124:131], v2
    ds_read_b128 v[124:127], v13 offset:24576
    v_cvt_pk_bf16_f32 v64, v64, v65
    v_smfmac_f32_16x16x64_bf16 v[68:71], v[44:47], a[216:223], v2
    ds_write_b16 v3, v64 offset:256
    v_smfmac_f32_16x16x64_bf16 v[68:71], v[48:51], a[224:231], v2
    ds_write_b16_d16_hi v3, v64 offset:656
    v_smfmac_f32_16x16x64_bf16 v[68:71], v[52:55], a[232:239], v2
    s_waitcnt lgkmcnt(9)
    ds_read_b128 v[128:131], v13 offset:25600
    v_smfmac_f32_16x16x64_bf16 v[68:71], v[36:39], v[132:139], v2
    ds_read_b128 v[132:135], v13 offset:26624
    v_smfmac_f32_16x16x64_bf16 v[72:75], v[16:19], a[240:247], v2
    ds_read_b128 v[136:139], v13 offset:27648
    v_smfmac_f32_16x16x64_bf16 v[72:75], v[20:23], a[248:255], v2
    v_add_f32 v68, v68, v70
    v_smfmac_f32_16x16x64_bf16 v[72:75], v[24:27], v[156:163], v2
    s_waitcnt lgkmcnt(10)
    v_add_f32 v69, v69, v71
    v_smfmac_f32_16x16x64_bf16 v[72:75], v[40:43], v[140:147], v2
    ds_read_b128 v[140:143], v13 offset:28672
    v_cvt_pk_bf16_f32 v68, v68, v69
    v_smfmac_f32_16x16x64_bf16 v[72:75], v[44:47], v[164:171], v2
    s_waitcnt lgkmcnt(4)
    s_barrier
    v_smfmac_f32_16x16x64_bf16 v[72:75], v[48:51], v[172:179], v2
    ds_read_b128 v[88:91], v4 offset:0
    v_smfmac_f32_16x16x64_bf16 v[72:75], v[52:55], v[180:187], v2
    ds_read_b128 v[92:95], v4 offset:128
    v_smfmac_f32_16x16x64_bf16 v[72:75], v[28:31], v[148:155], v2
    ds_read_b128 v[96:99], v4 offset:256
    v_smfmac_f32_16x16x64_bf16 v[72:75], v[32:35], v[188:195], v2
    ds_write_b16 v3, v68 offset:3200
    v_smfmac_f32_16x16x64_bf16 v[72:75], v[36:39], v[196:203], v2
    s_waitcnt lgkmcnt(7)
    ds_write_b16_d16_hi v3, v68 offset:3600
    v_smfmac_f32_16x16x64_bf16 v[76:79], v[16:19], v[124:131], v2
    s_waitcnt lgkmcnt(4)
    ds_read_b128 v[144:147], v13 offset:29696
    v_smfmac_f32_16x16x64_bf16 v[80:83], v[88:91], v[100:107], v2
    s_waitcnt lgkmcnt(4)
    ds_read_b128 v[148:151], v13 offset:30720
    v_add_f32 v72, v72, v74
    v_smfmac_f32_16x16x64_bf16 v[80:83], v[92:95], v[108:115], v2
    s_waitcnt lgkmcnt(4)
    ds_read_b128 v[152:155], v13 offset:31744
    v_add_f32 v73, v73, v75
    v_smfmac_f32_16x16x64_bf16 v[80:83], v[96:99], v[116:123], v2
    v_cvt_pk_bf16_f32 v72, v72, v73
    v_smfmac_f32_16x16x64_bf16 v[76:79], v[20:23], v[204:211], v2
    ds_write_b16 v3, v72 offset:3328
    v_smfmac_f32_16x16x64_bf16 v[76:79], v[24:27], v[212:219], v2
    ds_write_b16_d16_hi v3, v72 offset:3728
    v_smfmac_f32_16x16x64_bf16 v[76:79], v[40:43], v[132:139], v2
    v_add_f32 v56, v80, v82
    v_smfmac_f32_16x16x64_bf16 v[76:79], v[44:47], v[220:227], v2
    v_mul_f32 v56, 0x3dd53b95, v56
    v_smfmac_f32_16x16x64_bf16 v[76:79], v[48:51], v[228:235], v2
    s_waitcnt lgkmcnt(4)
    v_max_f32_dpp v58, v56, v56 row_ror:8 row_mask:0xf bank_mask:0xf
    v_smfmac_f32_16x16x64_bf16 v[76:79], v[52:55], v[140:147], v2
    s_waitcnt lgkmcnt(0)
    s_barrier
    v_max_f32_dpp v58, v58, v58 row_ror:4 row_mask:0xf bank_mask:0xf
    v_smfmac_f32_16x16x64_bf16 v[76:79], v[28:31], v[236:243], v2
    ds_read_b128 v[100:103], v5 offset:0
    v_max_f32_dpp v58, v58, v58 row_ror:2 row_mask:0xf bank_mask:0xf
    v_smfmac_f32_16x16x64_bf16 v[76:79], v[32:35], v[148:155], v2
    ds_read_b128 v[104:107], v5 offset:16
    v_max_f32_dpp v58, v58, v58 row_ror:1 row_mask:0xf bank_mask:0xf
    v_smfmac_f32_16x16x64_bf16 v[76:79], v[36:39], v[244:251], v2
    ds_read_b128 v[108:111], v5 offset:128
    v_sub_f32 v60, v56, v58
    ds_read_b128 v[112:115], v5 offset:144
    v_exp_f32 v60, v60
    s_nop 1
    v_add_f32_dpp v59, v60, v60 row_ror:8 row_mask:0xf bank_mask:0xf
    s_nop 1
    v_add_f32_dpp v59, v59, v59 row_ror:4 row_mask:0xf bank_mask:0xf
    s_nop 1
    v_add_f32_dpp v59, v59, v59 row_ror:2 row_mask:0xf bank_mask:0xf
    s_nop 1
    v_add_f32_dpp v59, v59, v59 row_ror:1 row_mask:0xf bank_mask:0xf
    v_add_f32 v76, v76, v78
    v_add_f32 v77, v77, v79
    v_cvt_pk_bf16_f32 v76, v76, v77
    ds_write_b16 v3, v76 offset:3456
    ds_write_b16_d16_hi v3, v76 offset:3856
    ds_write_b64 v6, v[58:59] offset:512
    s_waitcnt lgkmcnt(5)
    v_smfmac_f32_16x16x64_bf16 v[84:87], v[88:91], v[100:107], v2
    s_waitcnt lgkmcnt(3)
    v_smfmac_f32_16x16x64_bf16 v[84:87], v[92:95], v[108:115], v2
    s_waitcnt lgkmcnt(0)
    s_barrier
    ds_read_b128 v[116:119], v5 offset:256
    ds_read_b128 v[120:123], v5 offset:272
    ds_read_b64 v[16:17], v6 offset:0
    s_waitcnt lgkmcnt(1)
    v_smfmac_f32_16x16x64_bf16 v[84:87], v[96:99], v[116:123], v2
    s_waitcnt lgkmcnt(0)
    v_max_f32 v18, v58, v16
    v_sub_f32 v19, v58, v18
    v_sub_f32 v20, v16, v18
    v_exp_f32 v19, v19
    v_exp_f32 v20, v20
    s_nop 0
    v_mul_f32 v21, v59, v19
    v_mul_f32 v60, v60, v19
    v_fmac_f32 v21, v17, v20
    v_add_f32 v22, v84, v86
    v_mul_f32 v22, 0x3dd53b95, v22
    v_max_f32 v23, v22, v18
    s_nop 0
    v_max_f32_dpp v24, v22, v23 row_ror:4 row_mask:0xf bank_mask:0xf
    s_nop 1
    v_max_f32_dpp v24, v24, v24 row_ror:2 row_mask:0xf bank_mask:0xf
    s_nop 1
    v_max_f32_dpp v24, v24, v24 row_ror:1 row_mask:0xf bank_mask:0xf
    v_sub_f32 v25, v22, v24
    v_sub_f32 v26, v18, v24
    v_exp_f32 v25, v25
    v_exp_f32 v26, v26
    s_nop 0
    v_add_f32_dpp v23, v25, v25 row_ror:4 row_mask:0xf bank_mask:0xf
    v_mul_f32 v60, v60, v26
    s_nop 0
    v_add_f32_dpp v23, v23, v23 row_ror:2 row_mask:0xf bank_mask:0xf
    s_nop 1
    v_add_f32_dpp v23, v23, v23 row_ror:1 row_mask:0xf bank_mask:0xf
    v_fmac_f32 v23, v26, v21
    v_rcp_f32 v27, v23
    s_nop 0
    v_mul_f32 v60, v60, v27
    v_mul_f32 v25, v25, v27
    s_nop 0
    v_mov_b32_dpp v19, v60 quad_perm:[1,0,3,2] row_mask:0xf bank_mask:0xf
    v_mov_b32_dpp v20, v25 quad_perm:[1,0,3,2] row_mask:0xf bank_mask:0xf
    v_cvt_pk_bf16_f32 v28, v60, v19
    v_cvt_pk_bf16_f32 v25, v25, v20
    s_nop 0
    v_mov_b32_dpp v29, v28 row_shl:2 row_mask:0xf bank_mask:0xf
    v_mov_b32_dpp v30, v28 row_shl:4 row_mask:0xf bank_mask:0xf
    v_mov_b32_dpp v31, v28 row_shl:6 row_mask:0xf bank_mask:0xf
    v_mov_b32_dpp v28, v25 row_shr:4 row_mask:0xf bank_mask:0x2
    v_mov_b32_dpp v29, v25 row_shr:2 row_mask:0xf bank_mask:0x2
    v_mov_b32_dpp v30, v25 quad_perm:[0,1,2,3] row_mask:0xf bank_mask:0x2
    v_mov_b32_dpp v31, v25 row_shl:2 row_mask:0xf bank_mask:0x2
    s_mov_b32 exec_lo, 0x1010101
    s_mov_b32 exec_hi, 0x1110111
    buffer_store_dwordx4 v[28:31], v7, s[8:11], s18 offen sc1
    s_mov_b64 exec, -1
    ds_read_b128 v[40:43], v10
    s_add_u32 s28, s14, 1
    s_min_u32 s28, s28, 63
    s_cmp_gt_u32 s47, s28
    s_cbranch_scc1 layerb1_kernel_p1_gw2_ok
layerb1_kernel_p1_gw2_lp:
    buffer_load_dword v253, v255, s[8:11], s48 offen sc1
    s_waitcnt vmcnt(0)
    v_readlane_b32 s47, v253, 0
    v_readlane_b32 s29, v253, 1
    s_nop 0
    s_min_u32 s47, s47, s29
    s_sub_u32 s15, s15, 1
    s_cbranch_scc1 layerb1_kernel_bail
    s_cmp_gt_u32 s47, s28
    s_cbranch_scc0 layerb1_kernel_p1_gw2_lp
layerb1_kernel_p1_gw2_ok:
    s_mul_i32 s20, s28, 393216
    s_add_u32 s20, s20, s44
    s_add_u32 s21, s20, 0
    buffer_load_dwordx4 v[100:103], v9, s[8:11], s21 offen offset:0 sc1
    buffer_load_dwordx4 v[104:107], v9, s[8:11], s21 offen offset:512 sc1
    s_add_u32 s21, s20, 4096
    buffer_load_dwordx4 v[108:111], v9, s[8:11], s21 offen offset:0 sc1
    buffer_load_dwordx4 v[112:115], v9, s[8:11], s21 offen offset:512 sc1
    s_add_u32 s21, s20, 8192
    buffer_load_dwordx4 v[116:119], v9, s[8:11], s21 offen offset:0 sc1
    buffer_load_dwordx4 v[120:123], v9, s[8:11], s21 offen offset:512 sc1
    v_mov_b32 v56, 0
    v_mov_b32 v57, 0
    v_mov_b32 v58, 0
    v_mov_b32 v59, 0
    v_mov_b32 v60, 0
    v_mov_b32 v61, 0
    v_mov_b32 v62, 0
    v_mov_b32 v63, 0
    v_mov_b32 v64, 0
    v_mov_b32 v65, 0
    v_mov_b32 v66, 0
    v_mov_b32 v67, 0
    v_mov_b32 v68, 0
    v_mov_b32 v69, 0
    v_mov_b32 v70, 0
    v_mov_b32 v71, 0
    v_mov_b32 v72, 0
    v_mov_b32 v73, 0
    v_mov_b32 v74, 0
    v_mov_b32 v75, 0
    v_mov_b32 v76, 0
    v_mov_b32 v77, 0
    v_mov_b32 v78, 0
    v_mov_b32 v79, 0
    v_mov_b32 v80, 0
    v_mov_b32 v81, 0
    v_mov_b32 v82, 0
    v_mov_b32 v83, 0
    v_mov_b32 v84, 0
    v_mov_b32 v85, 0
    v_mov_b32 v86, 0
    v_mov_b32 v87, 0
    s_waitcnt lgkmcnt(0)
    s_mul_i32 s20, s14, 98304
    s_add_u32 s20, s20, s45
    buffer_store_dwordx4 v[40:43], v11, s[8:11], s20 offen sc1
    ds_read_b128 v[124:127], v13 offset:0
    ds_read_b128 v[128:131], v13 offset:1024
    ds_read_b128 v[132:135], v13 offset:2048
    ds_read_b128 v[136:139], v13 offset:3072
    ds_read_b128 v[140:143], v13 offset:4096
    ds_read_b128 v[144:147], v13 offset:5120
    ds_read_b128 v[148:151], v13 offset:6144
    ds_read_b128 v[152:155], v13 offset:7168
    s_waitcnt lgkmcnt(0)
    s_add_u32 s14, s14, 1
    s_cmp_lt_u32 s14, 64
    s_cbranch_scc1 layerb1_kernel_p1_step
    s_waitcnt vmcnt(0)
    s_barrier
    s_branch layerb1_kernel_end
layerb1_kernel_p2_start:
    v_lshrrev_b32 v16, 4, v0
    v_and_b32 v17, 15, v0
    v_and_b32 v18, 2, v0
    v_cmp_eq_u32 vcc, 0, v18
    v_mov_b32 v18, 0xeeeeeeee
    v_mov_b32 v19, 0x44444444
    v_cndmask_b32 v2, v18, v19, vcc
    v_lshrrev_b32 v20, 2, v17
    v_lshlrev_b32 v20, 1, v20
    v_and_b32 v21, 1, v17
    v_add_u32 v20, v20, v21
    v_bfe_u32 v21, v17, 1, 1
    v_lshl_add_u32 v18, v16, 1, v21
    v_lshlrev_b32 v18, 7, v18
    v_lshl_add_u32 v12, v20, 4, v18
    v_mul_u32_u24 v18, 400, v20
    v_lshl_add_u32 v18, v16, 5, v18
    v_lshl_add_u32 v18, v21, 4, v18
    v_add_u32 v4, 141312, v18
    v_mul_u32_u24 v18, 800, v16
    v_lshl_add_u32 v18, v17, 1, v18
    v_add_u32 v3, 141376, v18
    v_and_b32 v18, 7, v0
    v_mul_u32_u24 v18, 400, v18
    v_lshl_add_u32 v18, v16, 5, v18
    v_add_u32 v5, 144512, v18
    v_lshlrev_b32 v18, 3, v0
    v_add_u32 v6, 147712, v18
    v_lshlrev_b32 v18, 4, v16
    v_bfe_u32 v19, v17, 1, 2
    v_lshl_add_u32 v18, v19, 2, v18
    s_lshl_b32 s20, s12, 7
    s_add_u32 s20, s20, 64
    v_add_u32 v18, s20, v18
    v_lshrrev_b32 v19, 3, v17
    v_add_u32 v19, 1, v19
    v_lshrrev_b32 v20, 1, v19
    v_lshlrev_b32 v20, 14, v20
    v_and_b32 v19, 1, v19
    v_lshl_add_u32 v19, v19, 12, v20
    v_add_u32 v19, v19, v18
    v_mov_b32 v20, 0x7ffffff0
    v_and_b32 v21, 7, v0
    v_cmp_eq_u32 vcc, 4, v21
    v_subrev_u32 v21, 8, v18
    s_nop 0
    v_cndmask_b32 v7, v19, v21, vcc
    v_and_b32 v21, 0x29, v0
    v_cmp_eq_u32 vcc, 0, v21
    s_nop 1
    v_cndmask_b32 v8, v20, v18, vcc
    v_lshlrev_b32 v18, 4, v17
    v_lshl_add_u32 v18, v16, 10, v18
    v_add_u32 v9, 0, v18
    v_add_u32 v18, 128, v0
    v_mul_u32_u24 v19, 2731, v18
    v_lshrrev_b32 v19, 16, v19
    v_mul_u32_u24 v20, 24, v19
    v_sub_u32 v20, v18, v20
    v_mul_u32_u24 v21, 400, v19
    v_lshl_add_u32 v21, v20, 4, v21
    v_add_u32 v10, 144512, v21
    v_lshlrev_b32 v21, 4, v19
    v_lshl_add_u32 v11, v20, 7, v21
    v_add_u32 v13, 65536, v1
    v_add_u32 v14, 131072, v1
    s_mul_i32 s44, s12, 12288
    s_add_u32 s44, s44, 53477376
    s_mul_i32 s45, s12, 3072
    s_add_u32 s45, s45, 208666624
    s_mul_i32 s20, s12, 6
    s_add_u32 s21, s20, 5
    s_lshr_b32 s20, s20, 3
    s_lshr_b32 s21, s21, 3
    s_add_u32 s20, s20, 80
    s_add_u32 s21, s21, 80
    s_lshl_b32 s20, s20, 7
    s_lshl_b32 s21, s21, 7
    v_mov_b32 v255, s21
    v_mov_b32 v253, s20
    v_cmp_eq_u32 vcc, 0, v0
    s_nop 1
    v_cndmask_b32 v255, v255, v253, vcc
    s_mov_b32 s47, 0
    s_mul_i32 s20, s12, 491520
    s_add_u32 s20, s20, 11780096
    s_add_u32 s21, s20, 14336
    buffer_load_dwordx4 v[16:19], v1, s[8:11], s21 offen offset:0
    buffer_load_dwordx4 v[20:23], v1, s[8:11], s21 offen offset:1024
    s_add_u32 s21, s20, 75776
    buffer_load_dwordx4 v[24:27], v1, s[8:11], s21 offen offset:0
    buffer_load_dwordx4 v[28:31], v1, s[8:11], s21 offen offset:1024
    s_add_u32 s21, s20, 0
    buffer_load_dwordx4 v[32:35], v1, s[8:11], s21 offen offset:0
    buffer_load_dwordx4 v[36:39], v1, s[8:11], s21 offen offset:1024
    s_add_u32 s21, s20, 8192
    buffer_load_dwordx4 v[40:43], v1, s[8:11], s21 offen offset:0
    buffer_load_dwordx4 v[44:47], v1, s[8:11], s21 offen offset:1024
    s_add_u32 s21, s20, 20480
    buffer_load_dwordx4 v[48:51], v1, s[8:11], s21 offen offset:0
    buffer_load_dwordx4 v[52:55], v1, s[8:11], s21 offen offset:1024
    s_add_u32 s21, s20, 28672
    buffer_load_dwordx4 v[56:59], v1, s[8:11], s21 offen offset:0
    buffer_load_dwordx4 v[60:63], v1, s[8:11], s21 offen offset:1024
    s_add_u32 s21, s20, 40960
    buffer_load_dwordx4 v[64:67], v1, s[8:11], s21 offen offset:0
    buffer_load_dwordx4 v[68:71], v1, s[8:11], s21 offen offset:1024
    s_add_u32 s21, s20, 49152
    buffer_load_dwordx4 v[72:75], v1, s[8:11], s21 offen offset:0
    buffer_load_dwordx4 v[76:79], v1, s[8:11], s21 offen offset:1024
    s_add_u32 s21, s20, 61440
    buffer_load_dwordx4 v[80:83], v1, s[8:11], s21 offen offset:0
    buffer_load_dwordx4 v[84:87], v1, s[8:11], s21 offen offset:1024
    s_add_u32 s21, s20, 69632
    buffer_load_dwordx4 v[88:91], v1, s[8:11], s21 offen offset:0
    buffer_load_dwordx4 v[92:95], v1, s[8:11], s21 offen offset:1024
    s_add_u32 s21, s20, 81920
    buffer_load_dwordx4 v[96:99], v1, s[8:11], s21 offen offset:0
    buffer_load_dwordx4 v[100:103], v1, s[8:11], s21 offen offset:1024
    s_add_u32 s21, s20, 90112
    buffer_load_dwordx4 v[104:107], v1, s[8:11], s21 offen offset:0
    buffer_load_dwordx4 v[108:111], v1, s[8:11], s21 offen offset:1024
    s_add_u32 s21, s20, 100352
    buffer_load_dwordx4 v[112:115], v1, s[8:11], s21 offen offset:0
    buffer_load_dwordx4 v[116:119], v1, s[8:11], s21 offen offset:1024
    s_add_u32 s21, s20, 106496
    buffer_load_dwordx4 v[120:123], v1, s[8:11], s21 offen offset:0
    buffer_load_dwordx4 v[124:127], v1, s[8:11], s21 offen offset:1024
    s_add_u32 s21, s20, 112640
    buffer_load_dwordx4 v[128:131], v1, s[8:11], s21 offen offset:0
    buffer_load_dwordx4 v[132:135], v1, s[8:11], s21 offen offset:1024
    s_add_u32 s21, s20, 120832
    buffer_load_dwordx4 v[136:139], v1, s[8:11], s21 offen offset:0
    buffer_load_dwordx4 v[140:143], v1, s[8:11], s21 offen offset:1024
    s_add_u32 s21, s20, 79872
    buffer_load_dwordx4 v[156:159], v1, s[8:11], s21 offen offset:0
    buffer_load_dwordx4 v[160:163], v1, s[8:11], s21 offen offset:1024
    s_add_u32 s21, s20, 83968
    buffer_load_dwordx4 v[164:167], v1, s[8:11], s21 offen offset:0
    buffer_load_dwordx4 v[168:171], v1, s[8:11], s21 offen offset:1024
    s_add_u32 s21, s20, 86016
    buffer_load_dwordx4 v[172:175], v1, s[8:11], s21 offen offset:0
    buffer_load_dwordx4 v[176:179], v1, s[8:11], s21 offen offset:1024
    s_add_u32 s21, s20, 88064
    buffer_load_dwordx4 v[180:183], v1, s[8:11], s21 offen offset:0
    buffer_load_dwordx4 v[184:187], v1, s[8:11], s21 offen offset:1024
    s_add_u32 s21, s20, 92160
    buffer_load_dwordx4 v[188:191], v1, s[8:11], s21 offen offset:0
    buffer_load_dwordx4 v[192:195], v1, s[8:11], s21 offen offset:1024
    s_add_u32 s21, s20, 98304
    buffer_load_dwordx4 v[196:199], v1, s[8:11], s21 offen offset:0
    buffer_load_dwordx4 v[200:203], v1, s[8:11], s21 offen offset:1024
    s_add_u32 s21, s20, 102400
    buffer_load_dwordx4 v[204:207], v1, s[8:11], s21 offen offset:0
    buffer_load_dwordx4 v[208:211], v1, s[8:11], s21 offen offset:1024
    s_add_u32 s21, s20, 104448
    buffer_load_dwordx4 v[212:215], v1, s[8:11], s21 offen offset:0
    buffer_load_dwordx4 v[216:219], v1, s[8:11], s21 offen offset:1024
    s_add_u32 s21, s20, 108544
    buffer_load_dwordx4 v[220:223], v1, s[8:11], s21 offen offset:0
    buffer_load_dwordx4 v[224:227], v1, s[8:11], s21 offen offset:1024
    s_add_u32 s21, s20, 110592
    buffer_load_dwordx4 v[228:231], v1, s[8:11], s21 offen offset:0
    buffer_load_dwordx4 v[232:235], v1, s[8:11], s21 offen offset:1024
    s_add_u32 s21, s20, 118784
    buffer_load_dwordx4 v[236:239], v1, s[8:11], s21 offen offset:0
    buffer_load_dwordx4 v[240:243], v1, s[8:11], s21 offen offset:1024
    s_add_u32 s21, s20, 116736
    buffer_load_dwordx4 v[244:247], v1, s[8:11], s21 offen offset:0
    buffer_load_dwordx4 v[248:251], v1, s[8:11], s21 offen offset:1024
    s_waitcnt vmcnt(24)
    ds_write_b128 v13, v[16:19] offset:0
    ds_write_b128 v13, v[20:23] offset:1024
    ds_write_b128 v13, v[24:27] offset:2048
    ds_write_b128 v13, v[28:31] offset:3072
    ds_write_b128 v13, v[32:35] offset:4096
    ds_write_b128 v13, v[36:39] offset:5120
    ds_write_b128 v13, v[40:43] offset:6144
    ds_write_b128 v13, v[44:47] offset:7168
    ds_write_b128 v13, v[48:51] offset:8192
    ds_write_b128 v13, v[52:55] offset:9216
    ds_write_b128 v13, v[56:59] offset:10240
    ds_write_b128 v13, v[60:63] offset:11264
    ds_write_b128 v13, v[64:67] offset:12288
    ds_write_b128 v13, v[68:71] offset:13312
    ds_write_b128 v13, v[72:75] offset:14336
    ds_write_b128 v13, v[76:79] offset:15360
    ds_write_b128 v13, v[80:83] offset:16384
    ds_write_b128 v13, v[84:87] offset:17408
    ds_write_b128 v13, v[88:91] offset:18432
    ds_write_b128 v13, v[92:95] offset:19456
    ds_write_b128 v13, v[96:99] offset:20480
    ds_write_b128 v13, v[100:103] offset:21504
    ds_write_b128 v13, v[104:107] offset:22528
    ds_write_b128 v13, v[108:111] offset:23552
    ds_write_b128 v13, v[112:115] offset:24576
    ds_write_b128 v13, v[116:119] offset:25600
    ds_write_b128 v13, v[120:123] offset:26624
    ds_write_b128 v13, v[124:127] offset:27648
    ds_write_b128 v13, v[128:131] offset:28672
    ds_write_b128 v13, v[132:135] offset:29696
    ds_write_b128 v13, v[136:139] offset:30720
    ds_write_b128 v13, v[140:143] offset:31744
    s_waitcnt lgkmcnt(0)
    s_add_u32 s20, s48, 51200
    s_mov_b64 exec, 3
    v_lshlrev_b32 v16, 2, v0
layerb1_kernel_p2_par:
    buffer_load_dword v17, v16, s[8:11], s20 offen sc1
    s_waitcnt vmcnt(0)
    v_cmp_eq_u32 vcc, 0, v17
    s_sub_u32 s15, s15, 1
    s_cbranch_scc1 layerb1_kernel_bail
    s_cbranch_vccnz layerb1_kernel_p2_par
    s_mov_b64 exec, -1
    v_readlane_b32 s20, v17, 0
    v_readlane_b32 s21, v17, 1
    s_nop 0
    s_and_b32 s20, s20, 8192
    s_and_b32 s21, s21, 8192
    s_add_u32 s16, s16, s20
    s_add_u32 s17, s17, s21
    s_mov_b32 s14, 0
    s_cmp_gt_u32 s47, s14
    s_cbranch_scc1 layerb1_kernel_p2_gw1_ok
layerb1_kernel_p2_gw1_lp:
    buffer_load_dword v253, v255, s[8:11], s48 offen sc1
    s_waitcnt vmcnt(0)
    v_readlane_b32 s47, v253, 0
    v_readlane_b32 s29, v253, 1
    s_nop 0
    s_min_u32 s47, s47, s29
    s_sub_u32 s15, s15, 1
    s_cbranch_scc1 layerb1_kernel_bail
    s_cmp_gt_u32 s47, s14
    s_cbranch_scc0 layerb1_kernel_p2_gw1_lp
layerb1_kernel_p2_gw1_ok:
    s_mul_i32 s20, s14, 393216
    s_add_u32 s20, s20, s44
    s_add_u32 s21, s20, 0
    buffer_load_dwordx4 v[100:103], v9, s[8:11], s21 offen offset:0 sc1
    buffer_load_dwordx4 v[104:107], v9, s[8:11], s21 offen offset:512 sc1
    s_add_u32 s21, s20, 4096
    buffer_load_dwordx4 v[108:111], v9, s[8:11], s21 offen offset:0 sc1
    buffer_load_dwordx4 v[112:115], v9, s[8:11], s21 offen offset:512 sc1
    s_add_u32 s21, s20, 8192
    buffer_load_dwordx4 v[116:119], v9, s[8:11], s21 offen offset:0 sc1
    buffer_load_dwordx4 v[120:123], v9, s[8:11], s21 offen offset:512 sc1
    v_mov_b32 v56, 0
    v_mov_b32 v57, 0
    v_mov_b32 v58, 0
    v_mov_b32 v59, 0
    v_mov_b32 v60, 0
    v_mov_b32 v61, 0
    v_mov_b32 v62, 0
    v_mov_b32 v63, 0
    v_mov_b32 v64, 0
    v_mov_b32 v65, 0
    v_mov_b32 v66, 0
    v_mov_b32 v67, 0
    v_mov_b32 v68, 0
    v_mov_b32 v69, 0
    v_mov_b32 v70, 0
    v_mov_b32 v71, 0
    v_mov_b32 v72, 0
    v_mov_b32 v73, 0
    v_mov_b32 v74, 0
    v_mov_b32 v75, 0
    v_mov_b32 v76, 0
    v_mov_b32 v77, 0
    v_mov_b32 v78, 0
    v_mov_b32 v79, 0
    v_mov_b32 v80, 0
    v_mov_b32 v81, 0
    v_mov_b32 v82, 0
    v_mov_b32 v83, 0
    v_mov_b32 v84, 0
    v_mov_b32 v85, 0
    v_mov_b32 v86, 0
    v_mov_b32 v87, 0
    ds_read_b128 v[124:127], v13 offset:0
    ds_read_b128 v[128:131], v13 offset:1024
    ds_read_b128 v[132:135], v13 offset:2048
    ds_read_b128 v[136:139], v13 offset:3072
    ds_read_b128 v[140:143], v13 offset:4096
    ds_read_b128 v[144:147], v13 offset:5120
    ds_read_b128 v[148:151], v13 offset:6144
    ds_read_b128 v[152:155], v13 offset:7168
    s_waitcnt lgkmcnt(0)
layerb1_kernel_p2_step:
    s_cmp_lt_u32 s14, 32
    s_cselect_b32 s18, s16, s17
    s_and_b32 s20, s14, 31
    s_lshl_b32 s20, s20, 16
    s_add_u32 s18, s18, s20
    s_add_u32 s22, s18, 51200
    s_add_u32 s23, s18, 52224
layerb1_kernel_p2_poll:
    buffer_load_dwordx4 v[40:43], v12, s[8:11], s22 offen sc1
    buffer_load_dwordx4 v[44:47], v12, s[8:11], s23 offen sc1
    s_waitcnt vmcnt(0)
    ds_write_b128 v14, v[40:43] offset:6144
    ds_write_b128 v14, v[44:47] offset:7168
    v_max3_u32 v88, v40, v41, v42
    v_max3_u32 v88, v88, v43, v44
    v_max3_u32 v88, v88, v45, v46
    v_max_u32 v88, v88, v47
    v_cmp_eq_u32 vcc, -1, v88
    s_sub_u32 s15, s15, 1
    s_cbranch_scc1 layerb1_kernel_bail
    s_cbranch_vccnz layerb1_kernel_p2_poll
    v_smfmac_f32_16x16x64_bf16 v[56:59], v[40:43], a[0:7], v2
    v_smfmac_f32_16x16x64_bf16 v[60:63], v[40:43], a[8:15], v2
    v_smfmac_f32_16x16x64_bf16 v[64:67], v[40:43], a[16:23], v2
    v_smfmac_f32_16x16x64_bf16 v[56:59], v[44:47], v[124:131], v2
    ds_read_b128 v[124:127], v13 offset:8192
    v_smfmac_f32_16x16x64_bf16 v[60:63], v[44:47], a[24:31], v2
    s_waitcnt lgkmcnt(1)
    s_barrier
    v_smfmac_f32_16x16x64_bf16 v[64:67], v[44:47], a[32:39], v2
    ds_read_b128 v[16:19], v14 offset:0
    v_smfmac_f32_16x16x64_bf16 v[68:71], v[40:43], a[40:47], v2
    ds_read_b128 v[20:23], v14 offset:1024
    v_smfmac_f32_16x16x64_bf16 v[68:71], v[44:47], v[132:139], v2
    ds_read_b128 v[24:27], v14 offset:2048
    v_smfmac_f32_16x16x64_bf16 v[72:75], v[40:43], a[48:55], v2
    ds_read_b128 v[28:31], v14 offset:3072
    v_smfmac_f32_16x16x64_bf16 v[72:75], v[44:47], a[56:63], v2
    ds_read_b128 v[32:35], v14 offset:4096
    v_smfmac_f32_16x16x64_bf16 v[76:79], v[40:43], a[64:71], v2
    s_waitcnt lgkmcnt(4)
    ds_read_b128 v[36:39], v14 offset:5120
    v_smfmac_f32_16x16x64_bf16 v[56:59], v[16:19], v[140:147], v2
    s_waitcnt lgkmcnt(4)
    ds_read_b128 v[48:51], v14 offset:8192
    v_smfmac_f32_16x16x64_bf16 v[56:59], v[20:23], a[72:79], v2
    s_waitcnt lgkmcnt(4)
    ds_read_b128 v[52:55], v14 offset:9216
    v_smfmac_f32_16x16x64_bf16 v[56:59], v[24:27], a[80:87], v2
    s_waitcnt lgkmcnt(4)
    ds_read_b128 v[128:131], v13 offset:9216
    v_smfmac_f32_16x16x64_bf16 v[56:59], v[28:31], a[88:95], v2
    s_waitcnt lgkmcnt(4)
    ds_read_b128 v[132:135], v13 offset:10240
    v_smfmac_f32_16x16x64_bf16 v[56:59], v[32:35], v[148:155], v2
    s_waitcnt lgkmcnt(4)
    ds_read_b128 v[136:139], v13 offset:11264
    v_smfmac_f32_16x16x64_bf16 v[56:59], v[36:39], a[96:103], v2
    s_waitcnt lgkmcnt(4)
    ds_read_b128 v[140:143], v13 offset:12288
    v_smfmac_f32_16x16x64_bf16 v[56:59], v[48:51], a[104:111], v2
    s_waitcnt lgkmcnt(4)
    ds_read_b128 v[144:147], v13 offset:13312
    v_smfmac_f32_16x16x64_bf16 v[56:59], v[52:55], a[112:119], v2
    s_waitcnt lgkmcnt(4)
    ds_read_b128 v[148:151], v13 offset:14336
    v_smfmac_f32_16x16x64_bf16 v[60:63], v[16:19], v[124:131], v2
    ds_read_b128 v[152:155], v13 offset:15360
    v_smfmac_f32_16x16x64_bf16 v[60:63], v[20:23], a[120:127], v2
    ds_read_b128 v[124:127], v13 offset:16384
    v_add_f32 v56, v56, v58
    v_smfmac_f32_16x16x64_bf16 v[60:63], v[24:27], a[128:135], v2
    ds_read_b128 v[128:131], v13 offset:17408
    v_add_f32 v57, v57, v59
    v_smfmac_f32_16x16x64_bf16 v[60:63], v[28:31], a[136:143], v2
    s_waitcnt lgkmcnt(6)
    v_cvt_pk_bf16_f32 v56, v56, v57
    v_smfmac_f32_16x16x64_bf16 v[60:63], v[32:35], v[132:139], v2
    ds_write_b16 v3, v56 offset:0
    v_smfmac_f32_16x16x64_bf16 v[60:63], v[36:39], a[144:151], v2
    ds_write_b16_d16_hi v3, v56 offset:400
    v_smfmac_f32_16x16x64_bf16 v[60:63], v[48:51], a[152:159], v2
    ds_read_b128 v[132:135], v13 offset:18432
    v_smfmac_f32_16x16x64_bf16 v[60:63], v[52:55], a[160:167], v2
    s_waitcnt lgkmcnt(7)
    ds_read_b128 v[136:139], v13 offset:19456
    v_smfmac_f32_16x16x64_bf16 v[64:67], v[16:19], v[140:147], v2
    ds_read_b128 v[140:143], v13 offset:20480
    v_smfmac_f32_16x16x64_bf16 v[64:67], v[20:23], a[168:175], v2
    ds_read_b128 v[144:147], v13 offset:21504
    v_add_f32 v60, v60, v62
    v_smfmac_f32_16x16x64_bf16 v[64:67], v[24:27], a[176:183], v2
    v_add_f32 v61, v61, v63
    v_smfmac_f32_16x16x64_bf16 v[64:67], v[28:31], a[184:191], v2
    s_waitcnt lgkmcnt(8)
    v_cvt_pk_bf16_f32 v60, v60, v61
    v_smfmac_f32_16x16x64_bf16 v[64:67], v[32:35], v[148:155], v2
    ds_write_b16 v3, v60 offset:128
    v_smfmac_f32_16x16x64_bf16 v[64:67], v[36:39], a[192:199], v2
    ds_write_b16_d16_hi v3, v60 offset:528
    v_smfmac_f32_16x16x64_bf16 v[64:67], v[48:51], a[200:207], v2
    ds_read_b128 v[148:151], v13 offset:22528
    v_smfmac_f32_16x16x64_bf16 v[64:67], v[52:55], a[208:215], v2
    s_waitcnt lgkmcnt(9)
    ds_read_b128 v[152:155], v13 offset:23552
    v_smfmac_f32_16x16x64_bf16 v[68:71], v[16:19], v[124:131], v2
    ds_read_b128 v[124:127], v13 offset:24576
    v_smfmac_f32_16x16x64_bf16 v[68:71], v[20:23], a[216:223], v2
    ds_read_b128 v[128:131], v13 offset:25600
    v_add_f32 v64, v64, v66
    v_smfmac_f32_16x16x64_bf16 v[68:71], v[24:27], a[224:231], v2
    v_add_f32 v65, v65, v67
    v_smfmac_f32_16x16x64_bf16 v[68:71], v[28:31], a[232:239], v2
    s_waitcnt lgkmcnt(8)
    v_cvt_pk_bf16_f32 v64, v64, v65
    v_smfmac_f32_16x16x64_bf16 v[68:71], v[32:35], v[132:139], v2
    ds_write_b16 v3, v64 offset:256
    v_smfmac_f32_16x16x64_bf16 v[68:71], v[36:39], a[240:247], v2
    ds_write_b16_d16_hi v3, v64 offset:656
    v_smfmac_f32_16x16x64_bf16 v[68:71], v[48:51], a[248:255], v2
    ds_read_b128 v[132:135], v13 offset:26624
    v_smfmac_f32_16x16x64_bf16 v[68:71], v[52:55], v[156:163], v2
    s_waitcnt lgkmcnt(9)
    ds_read_b128 v[136:139], v13 offset:27648
    v_smfmac_f32_16x16x64_bf16 v[72:75], v[16:19], v[140:147], v2
    ds_read_b128 v[140:143], v13 offset:28672
    v_smfmac_f32_16x16x64_bf16 v[72:75], v[20:23], v[164:171], v2
    s_waitcnt lgkmcnt(3)
    s_barrier
    v_add_f32 v68, v68, v70
    v_smfmac_f32_16x16x64_bf16 v[72:75], v[24:27], v[172:179], v2
    ds_read_b128 v[88:91], v4 offset:0
    v_add_f32 v69, v69, v71
    v_smfmac_f32_16x16x64_bf16 v[72:75], v[28:31], v[180:187], v2
    ds_read_b128 v[92:95], v4 offset:128
    v_cvt_pk_bf16_f32 v68, v68, v69
    v_smfmac_f32_16x16x64_bf16 v[72:75], v[32:35], v[148:155], v2
    ds_read_b128 v[96:99], v4 offset:256
    v_smfmac_f32_16x16x64_bf16 v[72:75], v[36:39], v[188:195], v2
    ds_write_b16 v3, v68 offset:3200
    v_smfmac_f32_16x16x64_bf16 v[72:75], v[48:51], v[196:203], v2
    ds_write_b16_d16_hi v3, v68 offset:3600
    v_smfmac_f32_16x16x64_bf16 v[72:75], v[52:55], v[124:131], v2
    s_waitcnt lgkmcnt(4)
    ds_read_b128 v[144:147], v13 offset:29696
    v_smfmac_f32_16x16x64_bf16 v[80:83], v[88:91], v[100:107], v2
    s_waitcnt lgkmcnt(4)
    ds_read_b128 v[148:151], v13 offset:30720
    v_smfmac_f32_16x16x64_bf16 v[80:83], v[92:95], v[108:115], v2
    s_waitcnt lgkmcnt(4)
    ds_read_b128 v[152:155], v13 offset:31744
    v_add_f32 v72, v72, v74
    v_smfmac_f32_16x16x64_bf16 v[80:83], v[96:99], v[116:123], v2
    v_add_f32 v73, v73, v75
    v_smfmac_f32_16x16x64_bf16 v[76:79], v[16:19], v[204:211], v2
    v_cvt_pk_bf16_f32 v72, v72, v73
    v_smfmac_f32_16x16x64_bf16 v[76:79], v[20:23], v[212:219], v2
    ds_write_b16 v3, v72 offset:3328
    v_smfmac_f32_16x16x64_bf16 v[76:79], v[24:27], v[132:139], v2
    ds_write_b16_d16_hi v3, v72 offset:3728
    v_smfmac_f32_16x16x64_bf16 v[76:79], v[28:31], v[220:227], v2
    v_add_f32 v56, v81, v83
    v_smfmac_f32_16x16x64_bf16 v[76:79], v[32:35], v[228:235], v2
    s_waitcnt lgkmcnt(4)
    v_mul_f32 v56, 0x3dd53b95, v56
    v_smfmac_f32_16x16x64_bf16 v[76:79], v[36:39], v[140:147], v2
    s_waitcnt lgkmcnt(0)
    s_barrier
    v_max_f32_dpp v58, v56, v56 row_ror:8 row_mask:0xf bank_mask:0xf
    v_smfmac_f32_16x16x64_bf16 v[76:79], v[48:51], v[236:243], v2
    ds_read_b128 v[100:103], v5 offset:0
    v_max_f32_dpp v58, v58, v58 row_ror:4 row_mask:0xf bank_mask:0xf
    v_smfmac_f32_16x16x64_bf16 v[76:79], v[52:55], v[148:155], v2
    ds_read_b128 v[104:107], v5 offset:16
    v_max_f32_dpp v58, v58, v58 row_ror:2 row_mask:0xf bank_mask:0xf
    v_smfmac_f32_16x16x64_bf16 v[76:79], v[44:47], v[244:251], v2
    ds_read_b128 v[108:111], v5 offset:128
    v_max_f32_dpp v58, v58, v58 row_ror:1 row_mask:0xf bank_mask:0xf
    ds_read_b128 v[112:115], v5 offset:144
    v_sub_f32 v60, v56, v58
    s_nop 1
    v_exp_f32 v60, v60
    s_nop 1
    v_add_f32_dpp v59, v60, v60 row_ror:8 row_mask:0xf bank_mask:0xf
    s_nop 1
    v_add_f32_dpp v59, v59, v59 row_ror:4 row_mask:0xf bank_mask:0xf
    s_nop 1
    v_add_f32_dpp v59, v59, v59 row_ror:2 row_mask:0xf bank_mask:0xf
    s_nop 1
    v_add_f32_dpp v59, v59, v59 row_ror:1 row_mask:0xf bank_mask:0xf
    v_add_f32 v76, v76, v78
    v_add_f32 v77, v77, v79
    v_cvt_pk_bf16_f32 v76, v76, v77
    ds_write_b16 v3, v76 offset:3456
    ds_write_b16_d16_hi v3, v76 offset:3856
    ds_write_b64 v6, v[58:59] offset:1024
    s_waitcnt lgkmcnt(5)
    v_smfmac_f32_16x16x64_bf16 v[84:87], v[88:91], v[100:107], v2
    s_waitcnt lgkmcnt(3)
    v_smfmac_f32_16x16x64_bf16 v[84:87], v[92:95], v[108:115], v2
    s_waitcnt lgkmcnt(0)
    s_barrier
    ds_read_b128 v[116:119], v5 offset:256
    ds_read_b128 v[120:123], v5 offset:272
    ds_read_b64 v[16:17], v6 offset:1536
    s_waitcnt lgkmcnt(1)
    v_smfmac_f32_16x16x64_bf16 v[84:87], v[96:99], v[116:123], v2
    s_waitcnt lgkmcnt(0)
    v_max_f32 v18, v58, v16
    v_sub_f32 v19, v58, v18
    v_sub_f32 v20, v16, v18
    v_exp_f32 v19, v19
    v_exp_f32 v20, v20
    s_nop 0
    v_mul_f32 v21, v59, v19
    v_mul_f32 v60, v60, v19
    v_fmac_f32 v21, v17, v20
    v_add_f32 v22, v85, v87
    v_mul_f32 v22, 0x3dd53b95, v22
    v_max_f32 v23, v22, v18
    s_nop 0
    v_max_f32_dpp v24, v22, v23 row_ror:4 row_mask:0xf bank_mask:0xf
    s_nop 1
    v_max_f32_dpp v24, v24, v24 row_ror:2 row_mask:0xf bank_mask:0xf
    s_nop 1
    v_max_f32_dpp v24, v24, v24 row_ror:1 row_mask:0xf bank_mask:0xf
    v_sub_f32 v25, v22, v24
    v_sub_f32 v26, v18, v24
    v_exp_f32 v25, v25
    v_exp_f32 v26, v26
    s_nop 0
    v_add_f32_dpp v23, v25, v25 row_ror:4 row_mask:0xf bank_mask:0xf
    v_mul_f32 v60, v60, v26
    s_nop 0
    v_add_f32_dpp v23, v23, v23 row_ror:2 row_mask:0xf bank_mask:0xf
    s_nop 1
    v_add_f32_dpp v23, v23, v23 row_ror:1 row_mask:0xf bank_mask:0xf
    v_fmac_f32 v23, v26, v21
    v_rcp_f32 v27, v23
    s_nop 0
    v_mul_f32 v60, v60, v27
    v_mul_f32 v25, v25, v27
    s_nop 0
    v_mov_b32_dpp v19, v60 quad_perm:[1,0,3,2] row_mask:0xf bank_mask:0xf
    v_mov_b32_dpp v20, v25 quad_perm:[1,0,3,2] row_mask:0xf bank_mask:0xf
    v_cvt_pk_bf16_f32 v28, v60, v19
    v_cvt_pk_bf16_f32 v25, v25, v20
    s_nop 0
    v_mov_b32_dpp v29, v28 row_shl:2 row_mask:0xf bank_mask:0xf
    v_mov_b32_dpp v30, v28 row_shl:4 row_mask:0xf bank_mask:0xf
    v_mov_b32_dpp v31, v28 row_shl:6 row_mask:0xf bank_mask:0xf
    v_mov_b32_dpp v28, v25 row_shr:4 row_mask:0xf bank_mask:0x2
    v_mov_b32_dpp v29, v25 row_shr:2 row_mask:0xf bank_mask:0x2
    v_mov_b32_dpp v30, v25 quad_perm:[0,1,2,3] row_mask:0xf bank_mask:0x2
    v_mov_b32_dpp v31, v25 row_shl:2 row_mask:0xf bank_mask:0x2
    s_mov_b32 exec_lo, 0x1110111
    s_mov_b32 exec_hi, 0x1010101
    buffer_store_dwordx4 v[28:31], v7, s[8:11], s18 offen sc1
    s_mov_b64 exec, -1
    ds_read_b128 v[40:43], v10
    s_add_u32 s28, s14, 1
    s_min_u32 s28, s28, 63
    s_cmp_gt_u32 s47, s28
    s_cbranch_scc1 layerb1_kernel_p2_gw2_ok
layerb1_kernel_p2_gw2_lp:
    buffer_load_dword v253, v255, s[8:11], s48 offen sc1
    s_waitcnt vmcnt(0)
    v_readlane_b32 s47, v253, 0
    v_readlane_b32 s29, v253, 1
    s_nop 0
    s_min_u32 s47, s47, s29
    s_sub_u32 s15, s15, 1
    s_cbranch_scc1 layerb1_kernel_bail
    s_cmp_gt_u32 s47, s28
    s_cbranch_scc0 layerb1_kernel_p2_gw2_lp
layerb1_kernel_p2_gw2_ok:
    s_mul_i32 s20, s28, 393216
    s_add_u32 s20, s20, s44
    s_add_u32 s21, s20, 0
    buffer_load_dwordx4 v[100:103], v9, s[8:11], s21 offen offset:0 sc1
    buffer_load_dwordx4 v[104:107], v9, s[8:11], s21 offen offset:512 sc1
    s_add_u32 s21, s20, 4096
    buffer_load_dwordx4 v[108:111], v9, s[8:11], s21 offen offset:0 sc1
    buffer_load_dwordx4 v[112:115], v9, s[8:11], s21 offen offset:512 sc1
    s_add_u32 s21, s20, 8192
    buffer_load_dwordx4 v[116:119], v9, s[8:11], s21 offen offset:0 sc1
    buffer_load_dwordx4 v[120:123], v9, s[8:11], s21 offen offset:512 sc1
    v_mov_b32 v56, 0
    v_mov_b32 v57, 0
    v_mov_b32 v58, 0
    v_mov_b32 v59, 0
    v_mov_b32 v60, 0
    v_mov_b32 v61, 0
    v_mov_b32 v62, 0
    v_mov_b32 v63, 0
    v_mov_b32 v64, 0
    v_mov_b32 v65, 0
    v_mov_b32 v66, 0
    v_mov_b32 v67, 0
    v_mov_b32 v68, 0
    v_mov_b32 v69, 0
    v_mov_b32 v70, 0
    v_mov_b32 v71, 0
    v_mov_b32 v72, 0
    v_mov_b32 v73, 0
    v_mov_b32 v74, 0
    v_mov_b32 v75, 0
    v_mov_b32 v76, 0
    v_mov_b32 v77, 0
    v_mov_b32 v78, 0
    v_mov_b32 v79, 0
    v_mov_b32 v80, 0
    v_mov_b32 v81, 0
    v_mov_b32 v82, 0
    v_mov_b32 v83, 0
    v_mov_b32 v84, 0
    v_mov_b32 v85, 0
    v_mov_b32 v86, 0
    v_mov_b32 v87, 0
    s_waitcnt lgkmcnt(0)
    s_mul_i32 s20, s14, 98304
    s_add_u32 s20, s20, s45
    buffer_store_dwordx4 v[40:43], v11, s[8:11], s20 offen sc1
    ds_read_b128 v[124:127], v13 offset:0
    ds_read_b128 v[128:131], v13 offset:1024
    ds_read_b128 v[132:135], v13 offset:2048
    ds_read_b128 v[136:139], v13 offset:3072
    ds_read_b128 v[140:143], v13 offset:4096
    ds_read_b128 v[144:147], v13 offset:5120
    ds_read_b128 v[148:151], v13 offset:6144
    ds_read_b128 v[152:155], v13 offset:7168
    s_waitcnt lgkmcnt(0)
    s_add_u32 s14, s14, 1
    s_cmp_lt_u32 s14, 64
    s_cbranch_scc1 layerb1_kernel_p2_step
    s_waitcnt vmcnt(0)
    s_barrier
    s_branch layerb1_kernel_end
layerb1_kernel_p3_start:
    v_lshrrev_b32 v16, 4, v0
    v_and_b32 v17, 15, v0
    v_and_b32 v18, 2, v0
    v_cmp_eq_u32 vcc, 0, v18
    v_mov_b32 v18, 0xeeeeeeee
    v_mov_b32 v19, 0x44444444
    v_cndmask_b32 v2, v18, v19, vcc
    v_lshrrev_b32 v20, 2, v17
    v_lshlrev_b32 v20, 1, v20
    v_and_b32 v21, 1, v17
    v_add_u32 v20, v20, v21
    v_bfe_u32 v21, v17, 1, 1
    v_lshl_add_u32 v18, v16, 1, v21
    v_lshlrev_b32 v18, 7, v18
    v_lshl_add_u32 v12, v20, 4, v18
    v_mul_u32_u24 v18, 400, v20
    v_lshl_add_u32 v18, v16, 5, v18
    v_lshl_add_u32 v18, v21, 4, v18
    v_add_u32 v4, 141312, v18
    v_mul_u32_u24 v18, 800, v16
    v_lshl_add_u32 v18, v17, 1, v18
    v_add_u32 v3, 141408, v18
    v_and_b32 v18, 7, v0
    v_mul_u32_u24 v18, 400, v18
    v_lshl_add_u32 v18, v16, 5, v18
    v_add_u32 v5, 144512, v18
    v_lshlrev_b32 v18, 3, v0
    v_add_u32 v6, 147712, v18
    v_lshlrev_b32 v18, 4, v16
    v_bfe_u32 v19, v17, 1, 2
    v_lshl_add_u32 v18, v19, 2, v18
    s_lshl_b32 s20, s12, 7
    s_add_u32 s20, s20, 64
    v_add_u32 v18, s20, v18
    v_lshrrev_b32 v19, 3, v17
    v_add_u32 v19, 3, v19
    v_lshrrev_b32 v20, 1, v19
    v_lshlrev_b32 v20, 14, v20
    v_and_b32 v19, 1, v19
    v_lshl_add_u32 v19, v19, 12, v20
    v_add_u32 v19, v19, v18
    v_mov_b32 v20, 0x7ffffff0
    v_and_b32 v21, 7, v0
    v_cmp_eq_u32 vcc, 4, v21
    v_subrev_u32 v21, 8, v18
    s_nop 0
    v_cndmask_b32 v7, v19, v21, vcc
    v_and_b32 v21, 0x29, v0
    v_cmp_eq_u32 vcc, 32, v21
    s_nop 1
    v_cndmask_b32 v8, v20, v18, vcc
    v_lshlrev_b32 v18, 4, v17
    v_lshl_add_u32 v18, v16, 10, v18
    v_add_u32 v9, 256, v18
    v_add_u32 v18, 192, v0
    v_mul_u32_u24 v19, 2731, v18
    v_lshrrev_b32 v19, 16, v19
    v_mul_u32_u24 v20, 24, v19
    v_sub_u32 v20, v18, v20
    v_mul_u32_u24 v21, 400, v19
    v_lshl_add_u32 v21, v20, 4, v21
    v_add_u32 v10, 144512, v21
    v_lshlrev_b32 v21, 4, v19
    v_lshl_add_u32 v11, v20, 7, v21
    v_add_u32 v13, 98304, v1
    v_add_u32 v14, 131072, v1
    s_mul_i32 s44, s12, 12288
    s_add_u32 s44, s44, 53477376
    s_mul_i32 s45, s12, 3072
    s_add_u32 s45, s45, 208666624
    s_mul_i32 s20, s12, 6
    s_add_u32 s21, s20, 5
    s_lshr_b32 s20, s20, 3
    s_lshr_b32 s21, s21, 3
    s_add_u32 s20, s20, 80
    s_add_u32 s21, s21, 80
    s_lshl_b32 s20, s20, 7
    s_lshl_b32 s21, s21, 7
    v_mov_b32 v255, s21
    v_mov_b32 v253, s20
    v_cmp_eq_u32 vcc, 0, v0
    s_nop 1
    v_cndmask_b32 v255, v255, v253, vcc
    s_mov_b32 s47, 0
    s_mul_i32 s20, s12, 491520
    s_add_u32 s20, s20, 11902976
    s_add_u32 s21, s20, 18432
    buffer_load_dwordx4 v[16:19], v1, s[8:11], s21 offen offset:0
    buffer_load_dwordx4 v[20:23], v1, s[8:11], s21 offen offset:1024
    s_add_u32 s21, s20, 79872
    buffer_load_dwordx4 v[24:27], v1, s[8:11], s21 offen offset:0
    buffer_load_dwordx4 v[28:31], v1, s[8:11], s21 offen offset:1024
    s_add_u32 s21, s20, 0
    buffer_load_dwordx4 v[32:35], v1, s[8:11], s21 offen offset:0
    buffer_load_dwordx4 v[36:39], v1, s[8:11], s21 offen offset:1024
    s_add_u32 s21, s20, 8192
    buffer_load_dwordx4 v[40:43], v1, s[8:11], s21 offen offset:0
    buffer_load_dwordx4 v[44:47], v1, s[8:11], s21 offen offset:1024
    s_add_u32 s21, s20, 20480
    buffer_load_dwordx4 v[48:51], v1, s[8:11], s21 offen offset:0
    buffer_load_dwordx4 v[52:55], v1, s[8:11], s21 offen offset:1024
    s_add_u32 s21, s20, 28672
    buffer_load_dwordx4 v[56:59], v1, s[8:11], s21 offen offset:0
    buffer_load_dwordx4 v[60:63], v1, s[8:11], s21 offen offset:1024
    s_add_u32 s21, s20, 40960
    buffer_load_dwordx4 v[64:67], v1, s[8:11], s21 offen offset:0
    buffer_load_dwordx4 v[68:71], v1, s[8:11], s21 offen offset:1024
    s_add_u32 s21, s20, 49152
    buffer_load_dwordx4 v[72:75], v1, s[8:11], s21 offen offset:0
    buffer_load_dwordx4 v[76:79], v1, s[8:11], s21 offen offset:1024
    s_add_u32 s21, s20, 61440
    buffer_load_dwordx4 v[80:83], v1, s[8:11], s21 offen offset:0
    buffer_load_dwordx4 v[84:87], v1, s[8:11], s21 offen offset:1024
    s_add_u32 s21, s20, 69632
    buffer_load_dwordx4 v[88:91], v1, s[8:11], s21 offen offset:0
    buffer_load_dwordx4 v[92:95], v1, s[8:11], s21 offen offset:1024
    s_add_u32 s21, s20, 81920
    buffer_load_dwordx4 v[96:99], v1, s[8:11], s21 offen offset:0
    buffer_load_dwordx4 v[100:103], v1, s[8:11], s21 offen offset:1024
    s_add_u32 s21, s20, 90112
    buffer_load_dwordx4 v[104:107], v1, s[8:11], s21 offen offset:0
    buffer_load_dwordx4 v[108:111], v1, s[8:11], s21 offen offset:1024
    s_add_u32 s21, s20, 96256
    buffer_load_dwordx4 v[112:115], v1, s[8:11], s21 offen offset:0
    buffer_load_dwordx4 v[116:119], v1, s[8:11], s21 offen offset:1024
    s_add_u32 s21, s20, 106496
    buffer_load_dwordx4 v[120:123], v1, s[8:11], s21 offen offset:0
    buffer_load_dwordx4 v[124:127], v1, s[8:11], s21 offen offset:1024
    s_add_u32 s21, s20, 112640
    buffer_load_dwordx4 v[128:131], v1, s[8:11], s21 offen offset:0
    buffer_load_dwordx4 v[132:135], v1, s[8:11], s21 offen offset:1024
    s_add_u32 s21, s20, 116736
    buffer_load_dwordx4 v[136:139], v1, s[8:11], s21 offen offset:0
    buffer_load_dwordx4 v[140:143], v1, s[8:11], s21 offen offset:1024
    s_add_u32 s21, s20, 75776
    buffer_load_dwordx4 v[156:159], v1, s[8:11], s21 offen offset:0
    buffer_load_dwordx4 v[160:163], v1, s[8:11], s21 offen offset:1024
    s_add_u32 s21, s20, 83968
    buffer_load_dwordx4 v[164:167], v1, s[8:11], s21 offen offset:0
    buffer_load_dwordx4 v[168:171], v1, s[8:11], s21 offen offset:1024
    s_add_u32 s21, s20, 86016
    buffer_load_dwordx4 v[172:175], v1, s[8:11], s21 offen offset:0
    buffer_load_dwordx4 v[176:179], v1, s[8:11], s21 offen offset:1024
    s_add_u32 s21, s20, 88064
    buffer_load_dwordx4 v[180:183], v1, s[8:11], s21 offen offset:0
    buffer_load_dwordx4 v[184:187], v1, s[8:11], s21 offen offset:1024
    s_add_u32 s21, s20, 92160
    buffer_load_dwordx4 v[188:191], v1, s[8:11], s21 offen offset:0
    buffer_load_dwordx4 v[192:195], v1, s[8:11], s21 offen offset:1024
    s_add_u32 s21, s20, 94208
    buffer_load_dwordx4 v[196:199], v1, s[8:11], s21 offen offset:0
    buffer_load_dwordx4 v[200:203], v1, s[8:11], s21 offen offset:1024
    s_add_u32 s21, s20, 102400
    buffer_load_dwordx4 v[204:207], v1, s[8:11], s21 offen offset:0
    buffer_load_dwordx4 v[208:211], v1, s[8:11], s21 offen offset:1024
    s_add_u32 s21, s20, 104448
    buffer_load_dwordx4 v[212:215], v1, s[8:11], s21 offen offset:0
    buffer_load_dwordx4 v[216:219], v1, s[8:11], s21 offen offset:1024
    s_add_u32 s21, s20, 108544
    buffer_load_dwordx4 v[220:223], v1, s[8:11], s21 offen offset:0
    buffer_load_dwordx4 v[224:227], v1, s[8:11], s21 offen offset:1024
    s_add_u32 s21, s20, 110592
    buffer_load_dwordx4 v[228:231], v1, s[8:11], s21 offen offset:0
    buffer_load_dwordx4 v[232:235], v1, s[8:11], s21 offen offset:1024
    s_add_u32 s21, s20, 114688
    buffer_load_dwordx4 v[236:239], v1, s[8:11], s21 offen offset:0
    buffer_load_dwordx4 v[240:243], v1, s[8:11], s21 offen offset:1024
    s_add_u32 s21, s20, 120832
    buffer_load_dwordx4 v[244:247], v1, s[8:11], s21 offen offset:0
    buffer_load_dwordx4 v[248:251], v1, s[8:11], s21 offen offset:1024
    s_waitcnt vmcnt(24)
    ds_write_b128 v13, v[16:19] offset:0
    ds_write_b128 v13, v[20:23] offset:1024
    ds_write_b128 v13, v[24:27] offset:2048
    ds_write_b128 v13, v[28:31] offset:3072
    ds_write_b128 v13, v[32:35] offset:4096
    ds_write_b128 v13, v[36:39] offset:5120
    ds_write_b128 v13, v[40:43] offset:6144
    ds_write_b128 v13, v[44:47] offset:7168
    ds_write_b128 v13, v[48:51] offset:8192
    ds_write_b128 v13, v[52:55] offset:9216
    ds_write_b128 v13, v[56:59] offset:10240
    ds_write_b128 v13, v[60:63] offset:11264
    ds_write_b128 v13, v[64:67] offset:12288
    ds_write_b128 v13, v[68:71] offset:13312
    ds_write_b128 v13, v[72:75] offset:14336
    ds_write_b128 v13, v[76:79] offset:15360
    ds_write_b128 v13, v[80:83] offset:16384
    ds_write_b128 v13, v[84:87] offset:17408
    ds_write_b128 v13, v[88:91] offset:18432
    ds_write_b128 v13, v[92:95] offset:19456
    ds_write_b128 v13, v[96:99] offset:20480
    ds_write_b128 v13, v[100:103] offset:21504
    ds_write_b128 v13, v[104:107] offset:22528
    ds_write_b128 v13, v[108:111] offset:23552
    ds_write_b128 v13, v[112:115] offset:24576
    ds_write_b128 v13, v[116:119] offset:25600
    ds_write_b128 v13, v[120:123] offset:26624
    ds_write_b128 v13, v[124:127] offset:27648
    ds_write_b128 v13, v[128:131] offset:28672
    ds_write_b128 v13, v[132:135] offset:29696
    ds_write_b128 v13, v[136:139] offset:30720
    ds_write_b128 v13, v[140:143] offset:31744
    s_waitcnt lgkmcnt(0)
    s_add_u32 s20, s48, 51200
    s_mov_b64 exec, 3
    v_lshlrev_b32 v16, 2, v0
layerb1_kernel_p3_par:
    buffer_load_dword v17, v16, s[8:11], s20 offen sc1
    s_waitcnt vmcnt(0)
    v_cmp_eq_u32 vcc, 0, v17
    s_sub_u32 s15, s15, 1
    s_cbranch_scc1 layerb1_kernel_bail
    s_cbranch_vccnz layerb1_kernel_p3_par
    s_mov_b64 exec, -1
    v_readlane_b32 s20, v17, 0
    v_readlane_b32 s21, v17, 1
    s_nop 0
    s_and_b32 s20, s20, 8192
    s_and_b32 s21, s21, 8192
    s_add_u32 s16, s16, s20
    s_add_u32 s17, s17, s21
    s_mov_b32 s14, 0
    s_cmp_gt_u32 s47, s14
    s_cbranch_scc1 layerb1_kernel_p3_gw1_ok
layerb1_kernel_p3_gw1_lp:
    buffer_load_dword v253, v255, s[8:11], s48 offen sc1
    s_waitcnt vmcnt(0)
    v_readlane_b32 s47, v253, 0
    v_readlane_b32 s29, v253, 1
    s_nop 0
    s_min_u32 s47, s47, s29
    s_sub_u32 s15, s15, 1
    s_cbranch_scc1 layerb1_kernel_bail
    s_cmp_gt_u32 s47, s14
    s_cbranch_scc0 layerb1_kernel_p3_gw1_lp
layerb1_kernel_p3_gw1_ok:
    s_mul_i32 s20, s14, 393216
    s_add_u32 s20, s20, s44
    s_add_u32 s21, s20, 0
    buffer_load_dwordx4 v[100:103], v9, s[8:11], s21 offen offset:0 sc1
    buffer_load_dwordx4 v[104:107], v9, s[8:11], s21 offen offset:512 sc1
    s_add_u32 s21, s20, 4096
    buffer_load_dwordx4 v[108:111], v9, s[8:11], s21 offen offset:0 sc1
    buffer_load_dwordx4 v[112:115], v9, s[8:11], s21 offen offset:512 sc1
    s_add_u32 s21, s20, 8192
    buffer_load_dwordx4 v[116:119], v9, s[8:11], s21 offen offset:0 sc1
    buffer_load_dwordx4 v[120:123], v9, s[8:11], s21 offen offset:512 sc1
    v_mov_b32 v56, 0
    v_mov_b32 v57, 0
    v_mov_b32 v58, 0
    v_mov_b32 v59, 0
    v_mov_b32 v60, 0
    v_mov_b32 v61, 0
    v_mov_b32 v62, 0
    v_mov_b32 v63, 0
    v_mov_b32 v64, 0
    v_mov_b32 v65, 0
    v_mov_b32 v66, 0
    v_mov_b32 v67, 0
    v_mov_b32 v68, 0
    v_mov_b32 v69, 0
    v_mov_b32 v70, 0
    v_mov_b32 v71, 0
    v_mov_b32 v72, 0
    v_mov_b32 v73, 0
    v_mov_b32 v74, 0
    v_mov_b32 v75, 0
    v_mov_b32 v76, 0
    v_mov_b32 v77, 0
    v_mov_b32 v78, 0
    v_mov_b32 v79, 0
    v_mov_b32 v80, 0
    v_mov_b32 v81, 0
    v_mov_b32 v82, 0
    v_mov_b32 v83, 0
    v_mov_b32 v84, 0
    v_mov_b32 v85, 0
    v_mov_b32 v86, 0
    v_mov_b32 v87, 0
    ds_read_b128 v[124:127], v13 offset:0
    ds_read_b128 v[128:131], v13 offset:1024
    ds_read_b128 v[132:135], v13 offset:2048
    ds_read_b128 v[136:139], v13 offset:3072
    ds_read_b128 v[140:143], v13 offset:4096
    ds_read_b128 v[144:147], v13 offset:5120
    ds_read_b128 v[148:151], v13 offset:6144
    ds_read_b128 v[152:155], v13 offset:7168
    s_waitcnt lgkmcnt(0)
layerb1_kernel_p3_step:
    s_cmp_lt_u32 s14, 32
    s_cselect_b32 s18, s16, s17
    s_and_b32 s20, s14, 31
    s_lshl_b32 s20, s20, 16
    s_add_u32 s18, s18, s20
    s_add_u32 s22, s18, 53248
    s_add_u32 s23, s18, 54272
layerb1_kernel_p3_poll:
    buffer_load_dwordx4 v[48:51], v12, s[8:11], s22 offen sc1
    buffer_load_dwordx4 v[52:55], v12, s[8:11], s23 offen sc1
    s_waitcnt vmcnt(0)
    ds_write_b128 v14, v[48:51] offset:8192
    ds_write_b128 v14, v[52:55] offset:9216
    v_max3_u32 v88, v48, v49, v50
    v_max3_u32 v88, v88, v51, v52
    v_max3_u32 v88, v88, v53, v54
    v_max_u32 v88, v88, v55
    v_cmp_eq_u32 vcc, -1, v88
    s_sub_u32 s15, s15, 1
    s_cbranch_scc1 layerb1_kernel_bail
    s_cbranch_vccnz layerb1_kernel_p3_poll
    v_smfmac_f32_16x16x64_bf16 v[56:59], v[48:51], a[0:7], v2
    v_smfmac_f32_16x16x64_bf16 v[60:63], v[48:51], a[8:15], v2
    v_smfmac_f32_16x16x64_bf16 v[64:67], v[48:51], a[16:23], v2
    v_smfmac_f32_16x16x64_bf16 v[56:59], v[52:55], v[124:131], v2
    ds_read_b128 v[124:127], v13 offset:8192
    v_smfmac_f32_16x16x64_bf16 v[60:63], v[52:55], a[24:31], v2
    s_waitcnt lgkmcnt(1)
    s_barrier
    v_smfmac_f32_16x16x64_bf16 v[64:67], v[52:55], a[32:39], v2
    ds_read_b128 v[16:19], v14 offset:0
    v_smfmac_f32_16x16x64_bf16 v[68:71], v[48:51], a[40:47], v2
    ds_read_b128 v[20:23], v14 offset:1024
    v_smfmac_f32_16x16x64_bf16 v[68:71], v[52:55], v[132:139], v2
    ds_read_b128 v[24:27], v14 offset:2048
    v_smfmac_f32_16x16x64_bf16 v[72:75], v[48:51], a[48:55], v2
    ds_read_b128 v[28:31], v14 offset:3072
    v_smfmac_f32_16x16x64_bf16 v[72:75], v[52:55], a[56:63], v2
    ds_read_b128 v[32:35], v14 offset:4096
    v_smfmac_f32_16x16x64_bf16 v[76:79], v[48:51], a[64:71], v2
    s_waitcnt lgkmcnt(4)
    ds_read_b128 v[36:39], v14 offset:5120
    v_smfmac_f32_16x16x64_bf16 v[56:59], v[16:19], v[140:147], v2
    s_waitcnt lgkmcnt(4)
    ds_read_b128 v[40:43], v14 offset:6144
    v_smfmac_f32_16x16x64_bf16 v[56:59], v[20:23], a[72:79], v2
    s_waitcnt lgkmcnt(4)
    ds_read_b128 v[44:47], v14 offset:7168
    v_smfmac_f32_16x16x64_bf16 v[56:59], v[24:27], a[80:87], v2
    s_waitcnt lgkmcnt(4)
    ds_read_b128 v[128:131], v13 offset:9216
    v_smfmac_f32_16x16x64_bf16 v[56:59], v[28:31], a[88:95], v2
    s_waitcnt lgkmcnt(4)
    ds_read_b128 v[132:135], v13 offset:10240
    v_smfmac_f32_16x16x64_bf16 v[56:59], v[32:35], v[148:155], v2
    s_waitcnt lgkmcnt(4)
    ds_read_b128 v[136:139], v13 offset:11264
    v_smfmac_f32_16x16x64_bf16 v[56:59], v[36:39], a[96:103], v2
    s_waitcnt lgkmcnt(4)
    ds_read_b128 v[140:143], v13 offset:12288
    v_smfmac_f32_16x16x64_bf16 v[56:59], v[40:43], a[104:111], v2
    s_waitcnt lgkmcnt(4)
    ds_read_b128 v[144:147], v13 offset:13312
    v_smfmac_f32_16x16x64_bf16 v[56:59], v[44:47], a[112:119], v2
    s_waitcnt lgkmcnt(4)
    ds_read_b128 v[148:151], v13 offset:14336
    v_smfmac_f32_16x16x64_bf16 v[60:63], v[16:19], v[124:131], v2
    ds_read_b128 v[152:155], v13 offset:15360
    v_smfmac_f32_16x16x64_bf16 v[60:63], v[20:23], a[120:127], v2
    ds_read_b128 v[124:127], v13 offset:16384
    v_add_f32 v56, v56, v58
    v_smfmac_f32_16x16x64_bf16 v[60:63], v[24:27], a[128:135], v2
    ds_read_b128 v[128:131], v13 offset:17408
    v_add_f32 v57, v57, v59
    v_smfmac_f32_16x16x64_bf16 v[60:63], v[28:31], a[136:143], v2
    s_waitcnt lgkmcnt(6)
    v_cvt_pk_bf16_f32 v56, v56, v57
    v_smfmac_f32_16x16x64_bf16 v[60:63], v[32:35], v[132:139], v2
    ds_write_b16 v3, v56 offset:0
    v_smfmac_f32_16x16x64_bf16 v[60:63], v[36:39], a[144:151], v2
    ds_write_b16_d16_hi v3, v56 offset:400
    v_smfmac_f32_16x16x64_bf16 v[60:63], v[40:43], a[152:159], v2
    ds_read_b128 v[132:135], v13 offset:18432
    v_smfmac_f32_16x16x64_bf16 v[60:63], v[44:47], a[160:167], v2
    s_waitcnt lgkmcnt(7)
    ds_read_b128 v[136:139], v13 offset:19456
    v_smfmac_f32_16x16x64_bf16 v[64:67], v[16:19], v[140:147], v2
    ds_read_b128 v[140:143], v13 offset:20480
    v_smfmac_f32_16x16x64_bf16 v[64:67], v[20:23], a[168:175], v2
    ds_read_b128 v[144:147], v13 offset:21504
    v_add_f32 v60, v60, v62
    v_smfmac_f32_16x16x64_bf16 v[64:67], v[24:27], a[176:183], v2
    v_add_f32 v61, v61, v63
    v_smfmac_f32_16x16x64_bf16 v[64:67], v[28:31], a[184:191], v2
    s_waitcnt lgkmcnt(8)
    v_cvt_pk_bf16_f32 v60, v60, v61
    v_smfmac_f32_16x16x64_bf16 v[64:67], v[32:35], v[148:155], v2
    ds_write_b16 v3, v60 offset:128
    v_smfmac_f32_16x16x64_bf16 v[64:67], v[36:39], a[192:199], v2
    ds_write_b16_d16_hi v3, v60 offset:528
    v_smfmac_f32_16x16x64_bf16 v[64:67], v[40:43], a[200:207], v2
    ds_read_b128 v[148:151], v13 offset:22528
    v_smfmac_f32_16x16x64_bf16 v[64:67], v[44:47], a[208:215], v2
    s_waitcnt lgkmcnt(9)
    ds_read_b128 v[152:155], v13 offset:23552
    v_smfmac_f32_16x16x64_bf16 v[68:71], v[16:19], v[124:131], v2
    ds_read_b128 v[124:127], v13 offset:24576
    v_smfmac_f32_16x16x64_bf16 v[68:71], v[20:23], a[216:223], v2
    ds_read_b128 v[128:131], v13 offset:25600
    v_add_f32 v64, v64, v66
    v_smfmac_f32_16x16x64_bf16 v[68:71], v[24:27], a[224:231], v2
    v_add_f32 v65, v65, v67
    v_smfmac_f32_16x16x64_bf16 v[68:71], v[28:31], a[232:239], v2
    s_waitcnt lgkmcnt(8)
    v_cvt_pk_bf16_f32 v64, v64, v65
    v_smfmac_f32_16x16x64_bf16 v[68:71], v[32:35], v[132:139], v2
    ds_write_b16 v3, v64 offset:256
    v_smfmac_f32_16x16x64_bf16 v[68:71], v[36:39], a[240:247], v2
    ds_write_b16_d16_hi v3, v64 offset:656
    v_smfmac_f32_16x16x64_bf16 v[68:71], v[40:43], a[248:255], v2
    ds_read_b128 v[132:135], v13 offset:26624
    v_smfmac_f32_16x16x64_bf16 v[68:71], v[44:47], v[156:163], v2
    s_waitcnt lgkmcnt(9)
    ds_read_b128 v[136:139], v13 offset:27648
    v_smfmac_f32_16x16x64_bf16 v[72:75], v[16:19], v[140:147], v2
    ds_read_b128 v[140:143], v13 offset:28672
    v_smfmac_f32_16x16x64_bf16 v[72:75], v[20:23], v[164:171], v2
    s_waitcnt lgkmcnt(3)
    s_barrier
    v_add_f32 v68, v68, v70
    v_smfmac_f32_16x16x64_bf16 v[72:75], v[24:27], v[172:179], v2
    ds_read_b128 v[88:91], v4 offset:0
    v_add_f32 v69, v69, v71
    v_smfmac_f32_16x16x64_bf16 v[72:75], v[28:31], v[180:187], v2
    ds_read_b128 v[92:95], v4 offset:128
    v_cvt_pk_bf16_f32 v68, v68, v69
    v_smfmac_f32_16x16x64_bf16 v[72:75], v[32:35], v[148:155], v2
    ds_read_b128 v[96:99], v4 offset:256
    v_smfmac_f32_16x16x64_bf16 v[72:75], v[36:39], v[188:195], v2
    ds_write_b16 v3, v68 offset:3200
    v_smfmac_f32_16x16x64_bf16 v[72:75], v[40:43], v[196:203], v2
    ds_write_b16_d16_hi v3, v68 offset:3600
    v_smfmac_f32_16x16x64_bf16 v[72:75], v[44:47], v[124:131], v2
    s_waitcnt lgkmcnt(4)
    ds_read_b128 v[144:147], v13 offset:29696
    v_smfmac_f32_16x16x64_bf16 v[80:83], v[88:91], v[100:107], v2
    s_waitcnt lgkmcnt(4)
    ds_read_b128 v[148:151], v13 offset:30720
    v_smfmac_f32_16x16x64_bf16 v[80:83], v[92:95], v[108:115], v2
    s_waitcnt lgkmcnt(4)
    ds_read_b128 v[152:155], v13 offset:31744
    v_add_f32 v72, v72, v74
    v_smfmac_f32_16x16x64_bf16 v[80:83], v[96:99], v[116:123], v2
    v_add_f32 v73, v73, v75
    v_smfmac_f32_16x16x64_bf16 v[76:79], v[16:19], v[204:211], v2
    v_cvt_pk_bf16_f32 v72, v72, v73
    v_smfmac_f32_16x16x64_bf16 v[76:79], v[20:23], v[212:219], v2
    ds_write_b16 v3, v72 offset:3328
    v_smfmac_f32_16x16x64_bf16 v[76:79], v[24:27], v[132:139], v2
    ds_write_b16_d16_hi v3, v72 offset:3728
    v_smfmac_f32_16x16x64_bf16 v[76:79], v[28:31], v[220:227], v2
    v_add_f32 v56, v81, v83
    v_smfmac_f32_16x16x64_bf16 v[76:79], v[32:35], v[228:235], v2
    s_waitcnt lgkmcnt(4)
    v_mul_f32 v56, 0x3dd53b95, v56
    v_smfmac_f32_16x16x64_bf16 v[76:79], v[36:39], v[140:147], v2
    s_waitcnt lgkmcnt(0)
    s_barrier
    v_max_f32_dpp v58, v56, v56 row_ror:8 row_mask:0xf bank_mask:0xf
    v_smfmac_f32_16x16x64_bf16 v[76:79], v[40:43], v[236:243], v2
    ds_read_b128 v[100:103], v5 offset:0
    v_max_f32_dpp v58, v58, v58 row_ror:4 row_mask:0xf bank_mask:0xf
    v_smfmac_f32_16x16x64_bf16 v[76:79], v[44:47], v[148:155], v2
    ds_read_b128 v[104:107], v5 offset:16
    v_max_f32_dpp v58, v58, v58 row_ror:2 row_mask:0xf bank_mask:0xf
    v_smfmac_f32_16x16x64_bf16 v[76:79], v[52:55], v[244:251], v2
    ds_read_b128 v[108:111], v5 offset:128
    v_max_f32_dpp v58, v58, v58 row_ror:1 row_mask:0xf bank_mask:0xf
    ds_read_b128 v[112:115], v5 offset:144
    v_sub_f32 v60, v56, v58
    s_nop 1
    v_exp_f32 v60, v60
    s_nop 1
    v_add_f32_dpp v59, v60, v60 row_ror:8 row_mask:0xf bank_mask:0xf
    s_nop 1
    v_add_f32_dpp v59, v59, v59 row_ror:4 row_mask:0xf bank_mask:0xf
    s_nop 1
    v_add_f32_dpp v59, v59, v59 row_ror:2 row_mask:0xf bank_mask:0xf
    s_nop 1
    v_add_f32_dpp v59, v59, v59 row_ror:1 row_mask:0xf bank_mask:0xf
    v_add_f32 v76, v76, v78
    v_add_f32 v77, v77, v79
    v_cvt_pk_bf16_f32 v76, v76, v77
    ds_write_b16 v3, v76 offset:3456
    ds_write_b16_d16_hi v3, v76 offset:3856
    ds_write_b64 v6, v[58:59] offset:1536
    s_waitcnt lgkmcnt(5)
    v_smfmac_f32_16x16x64_bf16 v[84:87], v[88:91], v[100:107], v2
    s_waitcnt lgkmcnt(3)
    v_smfmac_f32_16x16x64_bf16 v[84:87], v[92:95], v[108:115], v2
    s_waitcnt lgkmcnt(0)
    s_barrier
    ds_read_b128 v[116:119], v5 offset:256
    ds_read_b128 v[120:123], v5 offset:272
    ds_read_b64 v[16:17], v6 offset:1024
    s_waitcnt lgkmcnt(1)
    v_smfmac_f32_16x16x64_bf16 v[84:87], v[96:99], v[116:123], v2
    s_waitcnt lgkmcnt(0)
    v_max_f32 v18, v58, v16
    v_sub_f32 v19, v58, v18
    v_sub_f32 v20, v16, v18
    v_exp_f32 v19, v19
    v_exp_f32 v20, v20
    s_nop 0
    v_mul_f32 v21, v59, v19
    v_mul_f32 v60, v60, v19
    v_fmac_f32 v21, v17, v20
    v_add_f32 v22, v85, v87
    v_mul_f32 v22, 0x3dd53b95, v22
    v_max_f32 v23, v22, v18
    s_nop 0
    v_max_f32_dpp v24, v22, v23 row_ror:4 row_mask:0xf bank_mask:0xf
    s_nop 1
    v_max_f32_dpp v24, v24, v24 row_ror:2 row_mask:0xf bank_mask:0xf
    s_nop 1
    v_max_f32_dpp v24, v24, v24 row_ror:1 row_mask:0xf bank_mask:0xf
    v_sub_f32 v25, v22, v24
    v_sub_f32 v26, v18, v24
    v_exp_f32 v25, v25
    v_exp_f32 v26, v26
    s_nop 0
    v_add_f32_dpp v23, v25, v25 row_ror:4 row_mask:0xf bank_mask:0xf
    v_mul_f32 v60, v60, v26
    s_nop 0
    v_add_f32_dpp v23, v23, v23 row_ror:2 row_mask:0xf bank_mask:0xf
    s_nop 1
    v_add_f32_dpp v23, v23, v23 row_ror:1 row_mask:0xf bank_mask:0xf
    v_fmac_f32 v23, v26, v21
    v_rcp_f32 v27, v23
    s_nop 0
    v_mul_f32 v60, v60, v27
    v_mul_f32 v25, v25, v27
    s_nop 0
    v_mov_b32_dpp v19, v60 quad_perm:[1,0,3,2] row_mask:0xf bank_mask:0xf
    v_mov_b32_dpp v20, v25 quad_perm:[1,0,3,2] row_mask:0xf bank_mask:0xf
    v_cvt_pk_bf16_f32 v28, v60, v19
    v_cvt_pk_bf16_f32 v25, v25, v20
    s_nop 0
    v_mov_b32_dpp v29, v28 row_shl:2 row_mask:0xf bank_mask:0xf
    v_mov_b32_dpp v30, v28 row_shl:4 row_mask:0xf bank_mask:0xf
    v_mov_b32_dpp v31, v28 row_shl:6 row_mask:0xf bank_mask:0xf
    v_mov_b32_dpp v28, v25 row_shr:4 row_mask:0xf bank_mask:0x2
    v_mov_b32_dpp v29, v25 row_shr:2 row_mask:0xf bank_mask:0x2
    v_mov_b32_dpp v30, v25 quad_perm:[0,1,2,3] row_mask:0xf bank_mask:0x2
    v_mov_b32_dpp v31, v25 row_shl:2 row_mask:0xf bank_mask:0x2
    s_mov_b32 exec_lo, 0x1010101
    s_mov_b32 exec_hi, 0x1110111
    buffer_store_dwordx4 v[28:31], v7, s[8:11], s18 offen sc1
    s_mov_b64 exec, -1
    s_add_u32 s28, s14, 1
    s_min_u32 s28, s28, 63
    s_cmp_gt_u32 s47, s28
    s_cbranch_scc1 layerb1_kernel_p3_gw2_ok
layerb1_kernel_p3_gw2_lp:
    buffer_load_dword v253, v255, s[8:11], s48 offen sc1
    s_waitcnt vmcnt(0)
    v_readlane_b32 s47, v253, 0
    v_readlane_b32 s29, v253, 1
    s_nop 0
    s_min_u32 s47, s47, s29
    s_sub_u32 s15, s15, 1
    s_cbranch_scc1 layerb1_kernel_bail
    s_cmp_gt_u32 s47, s28
    s_cbranch_scc0 layerb1_kernel_p3_gw2_lp
layerb1_kernel_p3_gw2_ok:
    s_mul_i32 s20, s28, 393216
    s_add_u32 s20, s20, s44
    s_add_u32 s21, s20, 0
    buffer_load_dwordx4 v[100:103], v9, s[8:11], s21 offen offset:0 sc1
    buffer_load_dwordx4 v[104:107], v9, s[8:11], s21 offen offset:512 sc1
    s_add_u32 s21, s20, 4096
    buffer_load_dwordx4 v[108:111], v9, s[8:11], s21 offen offset:0 sc1
    buffer_load_dwordx4 v[112:115], v9, s[8:11], s21 offen offset:512 sc1
    s_add_u32 s21, s20, 8192
    buffer_load_dwordx4 v[116:119], v9, s[8:11], s21 offen offset:0 sc1
    buffer_load_dwordx4 v[120:123], v9, s[8:11], s21 offen offset:512 sc1
    v_mov_b32 v56, 0
    v_mov_b32 v57, 0
    v_mov_b32 v58, 0
    v_mov_b32 v59, 0
    v_mov_b32 v60, 0
    v_mov_b32 v61, 0
    v_mov_b32 v62, 0
    v_mov_b32 v63, 0
    v_mov_b32 v64, 0
    v_mov_b32 v65, 0
    v_mov_b32 v66, 0
    v_mov_b32 v67, 0
    v_mov_b32 v68, 0
    v_mov_b32 v69, 0
    v_mov_b32 v70, 0
    v_mov_b32 v71, 0
    v_mov_b32 v72, 0
    v_mov_b32 v73, 0
    v_mov_b32 v74, 0
    v_mov_b32 v75, 0
    v_mov_b32 v76, 0
    v_mov_b32 v77, 0
    v_mov_b32 v78, 0
    v_mov_b32 v79, 0
    v_mov_b32 v80, 0
    v_mov_b32 v81, 0
    v_mov_b32 v82, 0
    v_mov_b32 v83, 0
    v_mov_b32 v84, 0
    v_mov_b32 v85, 0
    v_mov_b32 v86, 0
    v_mov_b32 v87, 0
    s_lshl_b32 s20, s12, 7
    s_add_u32 s20, s20, 16384
    s_mov_b64 exec, 1
    v_mov_b32 v253, s20
    v_mov_b32 v254, s14
    buffer_store_dword v254, v253, s[8:11], s48 offen sc1
    s_mov_b64 exec, -1
    ds_read_b128 v[124:127], v13 offset:0
    ds_read_b128 v[128:131], v13 offset:1024
    ds_read_b128 v[132:135], v13 offset:2048
    ds_read_b128 v[136:139], v13 offset:3072
    ds_read_b128 v[140:143], v13 offset:4096
    ds_read_b128 v[144:147], v13 offset:5120
    ds_read_b128 v[148:151], v13 offset:6144
    ds_read_b128 v[152:155], v13 offset:7168
    s_waitcnt lgkmcnt(0)
    s_add_u32 s14, s14, 1
    s_cmp_lt_u32 s14, 64
    s_cbranch_scc1 layerb1_kernel_p3_step
    s_waitcnt vmcnt(0)
    s_barrier
    s_lshl_b32 s20, s12, 7
    s_add_u32 s20, s20, 16384
    s_mov_b64 exec, 1
    v_mov_b32 v253, s20
    v_mov_b32 v254, s14
    buffer_store_dword v254, v253, s[8:11], s48 offen sc1
    s_mov_b64 exec, -1
    s_branch layerb1_kernel_end
layerb1_kernel_y0_start:
    v_lshrrev_b32 v16, 4, v0
    v_and_b32 v17, 7, v0
    v_lshrrev_b32 v18, 3, v0
    v_and_b32 v18, 1, v18
    v_lshl_add_u32 v19, v18, 2, v16
    v_add_u32 v19, 0, v19
    v_mul_u32_u24 v20, 640, v19
    v_lshl_add_u32 v4, v17, 4, v20
    v_and_b32 v20, 1, v17
    v_lshlrev_b32 v20, 2, v20
    v_lshrrev_b32 v21, 1, v17
    v_add_u32 v20, v20, v21
    v_lshlrev_b32 v20, 4, v20
    v_lshl_add_u32 v5, v19, 7, v20
    v_add_u32 v3, 0, v1
    v_lshrrev_b32 v20, 1, v17
    v_lshlrev_b32 v20, 7, v20
    v_and_b32 v21, 1, v17
    v_lshl_add_u32 v20, v21, 2, v20
    v_add_u32 v10, 0, v20
    v_lshlrev_b32 v20, 8, v18
    v_lshl_add_u32 v20, v17, 5, v20
    v_and_b32 v21, 1, v16
    v_lshl_add_u32 v20, v21, 4, v20
    v_add_u32 v20, 10240, v20
    v_add_u32 v21, 12288, v1
    v_lshrrev_b32 v22, 1, v16
    v_cmp_eq_u32 vcc, v22, v18
    s_nop 1
    v_cndmask_b32 v6, v21, v20, vcc
    v_lshrrev_b32 v20, 3, v0
    v_lshlrev_b32 v20, 2, v20
    v_lshl_add_u32 v20, v17, 5, v20
    v_add_u32 v7, 10240, v20
    s_lshl_b32 s20, s12, 7
    s_add_u32 s20, s20, 20480
    s_lshr_b32 s21, s20, 13
    s_lshl_b32 s21, s21, 14
    s_and_b32 s20, s20, 8191
    s_add_u32 s20, s20, s21
    v_lshrrev_b32 v20, 3, v0
    v_lshlrev_b32 v20, 4, v20
    v_add_u32 v8, s20, v20
    s_mul_i32 s46, s12, 20480
    s_add_u32 s46, s46, 103809024
    s_mul_i32 s20, s12, 327680
    s_add_u32 s20, s20, 27262976
    s_add_u32 s21, s20, 65536
    buffer_load_dwordx4 v[176:179], v1, s[8:11], s21 offen offset:0
    buffer_load_dwordx4 v[180:183], v1, s[8:11], s21 offen offset:1024
    s_add_u32 s21, s20, 67584
    buffer_load_dwordx4 v[184:187], v1, s[8:11], s21 offen offset:0
    buffer_load_dwordx4 v[188:191], v1, s[8:11], s21 offen offset:1024
    s_add_u32 s21, s20, 69632
    buffer_load_dwordx4 v[192:195], v1, s[8:11], s21 offen offset:0
    buffer_load_dwordx4 v[196:199], v1, s[8:11], s21 offen offset:1024
    s_add_u32 s21, s20, 71680
    buffer_load_dwordx4 v[200:203], v1, s[8:11], s21 offen offset:0
    buffer_load_dwordx4 v[204:207], v1, s[8:11], s21 offen offset:1024
    s_add_u32 s21, s20, 73728
    buffer_load_dwordx4 v[208:211], v1, s[8:11], s21 offen offset:0
    buffer_load_dwordx4 v[212:215], v1, s[8:11], s21 offen offset:1024
    s_add_u32 s21, s20, 75776
    buffer_load_dwordx4 v[216:219], v1, s[8:11], s21 offen offset:0
    buffer_load_dwordx4 v[220:223], v1, s[8:11], s21 offen offset:1024
    s_add_u32 s21, s20, 77824
    buffer_load_dwordx4 v[224:227], v1, s[8:11], s21 offen offset:0
    buffer_load_dwordx4 v[228:231], v1, s[8:11], s21 offen offset:1024
    s_add_u32 s21, s20, 79872
    buffer_load_dwordx4 v[232:235], v1, s[8:11], s21 offen offset:0
    buffer_load_dwordx4 v[236:239], v1, s[8:11], s21 offen offset:1024
    s_add_u32 s20, s48, 51200
    s_mov_b64 exec, 3
    v_lshlrev_b32 v16, 2, v0
layerb1_kernel_y0_par:
    buffer_load_dword v17, v16, s[8:11], s20 offen sc1
    s_waitcnt vmcnt(0)
    v_cmp_eq_u32 vcc, 0, v17
    s_sub_u32 s15, s15, 1
    s_cbranch_scc1 layerb1_kernel_bail
    s_cbranch_vccnz layerb1_kernel_y0_par
    s_mov_b64 exec, -1
    v_readlane_b32 s20, v17, 0
    v_readlane_b32 s21, v17, 1
    s_nop 0
    s_and_b32 s20, s20, 8192
    s_and_b32 s21, s21, 8192
    s_add_u32 s16, s16, s20
    s_add_u32 s17, s17, s21
    s_mov_b32 s14, 0
    s_lshl_b32 s20, s12, 7
    v_mov_b32 v9, s20
    s_mov_b32 s47, 0
layerb1_kernel_y0_step:
    s_cmp_lt_u32 s14, 32
    s_cselect_b32 s18, s16, s17
    s_and_b32 s20, s14, 31
    s_lshl_b32 s20, s20, 16
    s_add_u32 s18, s18, s20
    s_mul_i32 s28, s14, 1638400
    s_add_u32 s28, s28, s46
    v_mov_b32 v56, 0
    v_mov_b32 v57, 0
    v_mov_b32 v58, 0
    v_mov_b32 v59, 0
    v_mov_b32 v60, 0
    v_mov_b32 v61, 0
    v_mov_b32 v62, 0
    v_mov_b32 v63, 0
    v_mov_b32 v64, 0
    v_mov_b32 v65, 0
    v_mov_b32 v66, 0
    v_mov_b32 v67, 0
    v_mov_b32 v68, 0
    v_mov_b32 v69, 0
    v_mov_b32 v70, 0
    v_mov_b32 v71, 0
    s_add_u32 s22, s18, 36864
    s_add_u32 s23, s18, 37888
    s_add_u32 s24, s18, 38912
layerb1_kernel_y0_poll:
    buffer_load_dwordx4 v[16:19], v1, s[8:11], s22 offen sc1
    buffer_load_dwordx4 v[20:23], v1, s[8:11], s23 offen sc1
    buffer_load_dwordx4 v[24:27], v1, s[8:11], s24 offen sc1
    s_waitcnt vmcnt(0)
    ds_write_b128 v3, v[16:19] offset:0
    ds_write_b128 v3, v[20:23] offset:1024
    ds_write_b128 v3, v[24:27] offset:2048
    v_max3_u32 v116, v16, v17, v18
    v_max3_u32 v116, v116, v19, v20
    v_max3_u32 v116, v116, v21, v22
    v_max3_u32 v116, v116, v23, v24
    v_max3_u32 v116, v116, v25, v26
    v_max_u32 v116, v116, v27
    v_cmp_eq_u32 vcc, -1, v116
    s_sub_u32 s15, s15, 1
    s_cbranch_scc1 layerb1_kernel_bail
    s_cbranch_vccnz layerb1_kernel_y0_poll
    s_waitcnt lgkmcnt(0)
    s_barrier
    ds_read_b128 v[28:31], v3 offset:3072
    ds_read_b128 v[32:35], v3 offset:4096
    ds_read_b128 v[36:39], v3 offset:5120
    ds_read_b128 v[40:43], v3 offset:6144
    ds_read_b128 v[44:47], v3 offset:7168
    ds_read_b128 v[48:51], v3 offset:8192
    ds_read_b128 v[52:55], v3 offset:9216
    s_cmp_gt_u32 s47, s14
    s_cbranch_scc1 layerb1_kernel_y0_gw_ok
layerb1_kernel_y0_gw_lp:
    buffer_load_dword v116, v9, s[8:11], s48 offen sc1
    s_waitcnt vmcnt(0)
    v_readlane_b32 s47, v116, 0
    s_nop 0
    s_sub_u32 s15, s15, 1
    s_cbranch_scc1 layerb1_kernel_bail
    s_cmp_gt_u32 s47, s14
    s_cbranch_scc0 layerb1_kernel_y0_gw_lp
layerb1_kernel_y0_gw_ok:
    buffer_load_dwordx4 v[76:79], v4, s[8:11], s28 offen offset:128 sc1
    buffer_load_dwordx4 v[80:83], v4, s[8:11], s28 offen offset:256 sc1
    buffer_load_dwordx4 v[84:87], v4, s[8:11], s28 offen offset:384 sc1
    buffer_load_dwordx4 v[88:91], v4, s[8:11], s28 offen offset:512 sc1
    v_smfmac_f32_16x16x64_bf16 v[56:59], v[16:19], a[0:7], v2
    v_smfmac_f32_16x16x64_bf16 v[60:63], v[16:19], a[80:87], v2
    v_smfmac_f32_16x16x64_bf16 v[64:67], v[16:19], a[160:167], v2
    v_smfmac_f32_16x16x64_bf16 v[68:71], v[16:19], a[240:247], v2
    v_smfmac_f32_16x16x64_bf16 v[56:59], v[20:23], a[8:15], v2
    v_smfmac_f32_16x16x64_bf16 v[60:63], v[20:23], a[88:95], v2
    v_smfmac_f32_16x16x64_bf16 v[64:67], v[20:23], a[168:175], v2
    v_smfmac_f32_16x16x64_bf16 v[68:71], v[20:23], a[248:255], v2
    v_smfmac_f32_16x16x64_bf16 v[56:59], v[24:27], a[16:23], v2
    v_smfmac_f32_16x16x64_bf16 v[60:63], v[24:27], a[96:103], v2
    v_smfmac_f32_16x16x64_bf16 v[64:67], v[24:27], a[176:183], v2
    v_smfmac_f32_16x16x64_bf16 v[68:71], v[24:27], v[176:183], v2
    s_waitcnt lgkmcnt(6)
    v_smfmac_f32_16x16x64_bf16 v[56:59], v[28:31], a[24:31], v2
    v_smfmac_f32_16x16x64_bf16 v[60:63], v[28:31], a[104:111], v2
    v_smfmac_f32_16x16x64_bf16 v[64:67], v[28:31], a[184:191], v2
    v_smfmac_f32_16x16x64_bf16 v[68:71], v[28:31], v[184:191], v2
    s_waitcnt lgkmcnt(5)
    v_smfmac_f32_16x16x64_bf16 v[56:59], v[32:35], a[32:39], v2
    v_smfmac_f32_16x16x64_bf16 v[60:63], v[32:35], a[112:119], v2
    v_smfmac_f32_16x16x64_bf16 v[64:67], v[32:35], a[192:199], v2
    v_smfmac_f32_16x16x64_bf16 v[68:71], v[32:35], v[192:199], v2
    s_waitcnt lgkmcnt(4)
    v_smfmac_f32_16x16x64_bf16 v[56:59], v[36:39], a[40:47], v2
    v_smfmac_f32_16x16x64_bf16 v[60:63], v[36:39], a[120:127], v2
    v_smfmac_f32_16x16x64_bf16 v[64:67], v[36:39], a[200:207], v2
    v_smfmac_f32_16x16x64_bf16 v[68:71], v[36:39], v[200:207], v2
    s_waitcnt lgkmcnt(3)
    v_smfmac_f32_16x16x64_bf16 v[56:59], v[40:43], a[48:55], v2
    v_smfmac_f32_16x16x64_bf16 v[60:63], v[40:43], a[128:135], v2
    v_smfmac_f32_16x16x64_bf16 v[64:67], v[40:43], a[208:215], v2
    v_smfmac_f32_16x16x64_bf16 v[68:71], v[40:43], v[208:215], v2
    s_waitcnt lgkmcnt(2)
    v_smfmac_f32_16x16x64_bf16 v[56:59], v[44:47], a[56:63], v2
    v_smfmac_f32_16x16x64_bf16 v[60:63], v[44:47], a[136:143], v2
    v_smfmac_f32_16x16x64_bf16 v[64:67], v[44:47], a[216:223], v2
    v_smfmac_f32_16x16x64_bf16 v[68:71], v[44:47], v[216:223], v2
    s_waitcnt lgkmcnt(1)
    v_smfmac_f32_16x16x64_bf16 v[56:59], v[48:51], a[64:71], v2
    v_smfmac_f32_16x16x64_bf16 v[60:63], v[48:51], a[144:151], v2
    v_smfmac_f32_16x16x64_bf16 v[64:67], v[48:51], a[224:231], v2
    v_smfmac_f32_16x16x64_bf16 v[68:71], v[48:51], v[224:231], v2
    s_waitcnt lgkmcnt(0)
    v_smfmac_f32_16x16x64_bf16 v[56:59], v[52:55], a[72:79], v2
    v_smfmac_f32_16x16x64_bf16 v[60:63], v[52:55], a[152:159], v2
    v_smfmac_f32_16x16x64_bf16 v[64:67], v[52:55], a[232:239], v2
    v_smfmac_f32_16x16x64_bf16 v[68:71], v[52:55], v[232:239], v2
    s_nop 7
    v_permlane32_swap_b32 v56, v64
    v_permlane32_swap_b32 v60, v68
    v_permlane32_swap_b32 v57, v65
    v_permlane32_swap_b32 v61, v69
    v_permlane32_swap_b32 v58, v66
    v_permlane32_swap_b32 v62, v70
    v_permlane32_swap_b32 v59, v67
    v_permlane32_swap_b32 v63, v71
    v_add_f32 v56, v56, v64
    v_add_f32 v60, v60, v68
    v_add_f32 v57, v57, v65
    v_add_f32 v61, v61, v69
    v_add_f32 v58, v58, v66
    v_add_f32 v62, v62, v70
    v_add_f32 v59, v59, v67
    v_add_f32 v63, v63, v71
    s_nop 1
    v_permlane16_swap_b32 v56, v60
    v_permlane16_swap_b32 v57, v61
    v_permlane16_swap_b32 v58, v62
    v_permlane16_swap_b32 v59, v63
    s_nop 1
    v_cvt_pk_bf16_f32 v72, v56, v57
    v_cvt_pk_bf16_f32 v73, v58, v59
    v_cvt_pk_bf16_f32 v74, v60, v61
    v_cvt_pk_bf16_f32 v75, v62, v63
    buffer_store_dwordx4 v[72:75], v4, s[8:11], s28 offen sc1
    s_cmp_eq_u32 s14, 63
    s_cbranch_scc1 layerb1_kernel_y0_last
    s_add_u32 s30, s18, 0
    s_add_u32 s31, s18, 4096
    s_add_u32 s32, s18, 16384
    s_add_u32 s33, s18, 20480
    s_add_u32 s34, s18, 32768
    s_add_u32 s29, s14, 1
    s_cmp_lt_u32 s29, 32
    s_cselect_b32 s19, s16, s17
    s_and_b32 s20, s29, 31
    s_lshl_b32 s20, s20, 16
    s_add_u32 s19, s19, s20
layerb1_kernel_y0_ppoll:
    buffer_load_dwordx4 v[92:95], v5, s[8:11], s30 offen sc1
    buffer_load_dwordx4 v[96:99], v5, s[8:11], s31 offen sc1
    buffer_load_dwordx4 v[100:103], v5, s[8:11], s32 offen sc1
    buffer_load_dwordx4 v[104:107], v5, s[8:11], s33 offen sc1
    buffer_load_dwordx4 v[108:111], v5, s[8:11], s34 offen sc1
    s_waitcnt vmcnt(0)
    v_mfma_f32_16x16x32_bf16 v[112:115], v[92:95], v[72:75], 0
    v_mfma_f32_16x16x32_bf16 v[112:115], v[96:99], v[76:79], v[112:115]
    v_mfma_f32_16x16x32_bf16 v[112:115], v[100:103], v[80:83], v[112:115]
    v_mfma_f32_16x16x32_bf16 v[112:115], v[104:107], v[84:87], v[112:115]
    v_mfma_f32_16x16x32_bf16 v[112:115], v[108:111], v[88:91], v[112:115]
    v_max3_u32 v116, v92, v93, v94
    v_max3_u32 v116, v116, v95, v96
    v_max3_u32 v116, v116, v97, v98
    v_max3_u32 v116, v116, v99, v100
    v_max3_u32 v116, v116, v101, v102
    v_max3_u32 v116, v116, v103, v104
    v_max3_u32 v116, v116, v105, v106
    v_max3_u32 v116, v116, v107, v108
    v_max3_u32 v116, v116, v109, v110
    v_max_u32 v116, v116, v111
    v_cmp_eq_u32 vcc, -1, v116
    s_sub_u32 s15, s15, 1
    s_cbranch_scc1 layerb1_kernel_bail
    s_cbranch_vccnz layerb1_kernel_y0_ppoll
    ds_write_b128 v6, v[112:115]
    s_waitcnt lgkmcnt(0)
    s_barrier
    ds_read2st64_b32 v[116:117], v7 offset0:0 offset1:1
    ds_read2st64_b32 v[118:119], v7 offset0:2 offset1:3
    ds_read2st64_b32 v[120:121], v7 offset0:4 offset1:5
    ds_read2st64_b32 v[122:123], v7 offset0:6 offset1:7
    s_waitcnt lgkmcnt(2)
    v_add_f32 v116, v116, v117
    v_add_f32 v118, v118, v119
    s_waitcnt lgkmcnt(0)
    v_add_f32 v120, v120, v121
    v_add_f32 v122, v122, v123
    v_add_f32 v116, v116, v118
    v_add_f32 v120, v120, v122
    v_add_f32 v116, v116, v120
    s_nop 1
    v_mov_b32_dpp v117, v116 quad_perm:[1,0,3,2] row_mask:0xf bank_mask:0xf
    v_cvt_pk_bf16_f32 v124, v116, v117
    s_nop 1
    v_mov_b32_dpp v125, v124 row_shl:2 row_mask:0xf bank_mask:0xf
    v_mov_b32_dpp v126, v124 row_shl:4 row_mask:0xf bank_mask:0xf
    v_mov_b32_dpp v127, v124 row_shl:6 row_mask:0xf bank_mask:0xf
    s_mov_b64 exec, s[40:41]
    buffer_store_dwordx4 v[124:127], v8, s[8:11], s19 offen sc1
    s_mov_b64 exec, -1
    s_lshl_b32 s20, s12, 7
    s_add_u32 s20, s20, 20480
    s_mov_b64 exec, 1
    v_mov_b32 v116, s20
    v_mov_b32 v117, s29
    buffer_store_dword v117, v116, s[8:11], s48 offen sc1
    s_mov_b64 exec, -1
    s_waitcnt vmcnt(0)
    s_barrier
    s_add_u32 s14, s14, 1
    s_branch layerb1_kernel_y0_step
layerb1_kernel_y0_last:
    s_waitcnt vmcnt(0)
    s_barrier
    s_lshl_b32 s20, s12, 7
    s_add_u32 s20, s20, 20480
    s_mov_b32 s29, 64
    s_mov_b64 exec, 1
    v_mov_b32 v116, s20
    v_mov_b32 v117, s29
    buffer_store_dword v117, v116, s[8:11], s48 offen sc1
    s_mov_b64 exec, -1
    s_branch layerb1_kernel_end
layerb1_kernel_y1_start:
    v_lshrrev_b32 v16, 4, v0
    v_and_b32 v17, 7, v0
    v_lshrrev_b32 v18, 3, v0
    v_and_b32 v18, 1, v18
    v_lshl_add_u32 v19, v18, 2, v16
    v_add_u32 v19, 8, v19
    v_mul_u32_u24 v20, 640, v19
    v_lshl_add_u32 v4, v17, 4, v20
    v_and_b32 v20, 1, v17
    v_lshlrev_b32 v20, 2, v20
    v_lshrrev_b32 v21, 1, v17
    v_add_u32 v20, v20, v21
    v_lshlrev_b32 v20, 4, v20
    v_lshl_add_u32 v5, v19, 7, v20
    v_add_u32 v3, 0, v1
    v_lshrrev_b32 v20, 1, v17
    v_lshlrev_b32 v20, 7, v20
    v_and_b32 v21, 1, v17
    v_lshl_add_u32 v20, v21, 2, v20
    v_add_u32 v10, 512, v20
    v_lshlrev_b32 v20, 8, v18
    v_lshl_add_u32 v20, v17, 5, v20
    v_and_b32 v21, 1, v16
    v_lshl_add_u32 v20, v21, 4, v20
    v_add_u32 v20, 10752, v20
    v_add_u32 v21, 12288, v1
    v_lshrrev_b32 v22, 1, v16
    v_cmp_eq_u32 vcc, v22, v18
    s_nop 1
    v_cndmask_b32 v6, v21, v20, vcc
    v_lshrrev_b32 v20, 3, v0
    v_lshlrev_b32 v20, 2, v20
    v_lshl_add_u32 v20, v17, 5, v20
    v_add_u32 v7, 10240, v20
    s_lshl_b32 s20, s12, 7
    s_add_u32 s20, s20, 20480
    s_lshr_b32 s21, s20, 13
    s_lshl_b32 s21, s21, 14
    s_and_b32 s20, s20, 8191
    s_add_u32 s20, s20, s21
    v_lshrrev_b32 v20, 3, v0
    v_lshlrev_b32 v20, 4, v20
    v_add_u32 v8, s20, v20
    s_mul_i32 s46, s12, 20480
    s_add_u32 s46, s46, 103809024
    s_mul_i32 s20, s12, 327680
    s_add_u32 s20, s20, 27344896
    s_add_u32 s21, s20, 65536
    buffer_load_dwordx4 v[176:179], v1, s[8:11], s21 offen offset:0
    buffer_load_dwordx4 v[180:183], v1, s[8:11], s21 offen offset:1024
    s_add_u32 s21, s20, 67584
    buffer_load_dwordx4 v[184:187], v1, s[8:11], s21 offen offset:0
    buffer_load_dwordx4 v[188:191], v1, s[8:11], s21 offen offset:1024
    s_add_u32 s21, s20, 69632
    buffer_load_dwordx4 v[192:195], v1, s[8:11], s21 offen offset:0
    buffer_load_dwordx4 v[196:199], v1, s[8:11], s21 offen offset:1024
    s_add_u32 s21, s20, 71680
    buffer_load_dwordx4 v[200:203], v1, s[8:11], s21 offen offset:0
    buffer_load_dwordx4 v[204:207], v1, s[8:11], s21 offen offset:1024
    s_add_u32 s21, s20, 73728
    buffer_load_dwordx4 v[208:211], v1, s[8:11], s21 offen offset:0
    buffer_load_dwordx4 v[212:215], v1, s[8:11], s21 offen offset:1024
    s_add_u32 s21, s20, 75776
    buffer_load_dwordx4 v[216:219], v1, s[8:11], s21 offen offset:0
    buffer_load_dwordx4 v[220:223], v1, s[8:11], s21 offen offset:1024
    s_add_u32 s21, s20, 77824
    buffer_load_dwordx4 v[224:227], v1, s[8:11], s21 offen offset:0
    buffer_load_dwordx4 v[228:231], v1, s[8:11], s21 offen offset:1024
    s_add_u32 s21, s20, 79872
    buffer_load_dwordx4 v[232:235], v1, s[8:11], s21 offen offset:0
    buffer_load_dwordx4 v[236:239], v1, s[8:11], s21 offen offset:1024
    s_add_u32 s20, s48, 51200
    s_mov_b64 exec, 3
    v_lshlrev_b32 v16, 2, v0
layerb1_kernel_y1_par:
    buffer_load_dword v17, v16, s[8:11], s20 offen sc1
    s_waitcnt vmcnt(0)
    v_cmp_eq_u32 vcc, 0, v17
    s_sub_u32 s15, s15, 1
    s_cbranch_scc1 layerb1_kernel_bail
    s_cbranch_vccnz layerb1_kernel_y1_par
    s_mov_b64 exec, -1
    v_readlane_b32 s20, v17, 0
    v_readlane_b32 s21, v17, 1
    s_nop 0
    s_and_b32 s20, s20, 8192
    s_and_b32 s21, s21, 8192
    s_add_u32 s16, s16, s20
    s_add_u32 s17, s17, s21
    s_mov_b32 s14, 0
    s_lshl_b32 s20, s12, 7
    v_mov_b32 v9, s20
    s_mov_b32 s47, 0
layerb1_kernel_y1_step:
    s_cmp_lt_u32 s14, 32
    s_cselect_b32 s18, s16, s17
    s_and_b32 s20, s14, 31
    s_lshl_b32 s20, s20, 16
    s_add_u32 s18, s18, s20
    s_mul_i32 s28, s14, 1638400
    s_add_u32 s28, s28, s46
    v_mov_b32 v56, 0
    v_mov_b32 v57, 0
    v_mov_b32 v58, 0
    v_mov_b32 v59, 0
    v_mov_b32 v60, 0
    v_mov_b32 v61, 0
    v_mov_b32 v62, 0
    v_mov_b32 v63, 0
    v_mov_b32 v64, 0
    v_mov_b32 v65, 0
    v_mov_b32 v66, 0
    v_mov_b32 v67, 0
    v_mov_b32 v68, 0
    v_mov_b32 v69, 0
    v_mov_b32 v70, 0
    v_mov_b32 v71, 0
    s_add_u32 s22, s18, 39936
    s_add_u32 s23, s18, 49152
    s_add_u32 s24, s18, 50176
layerb1_kernel_y1_poll:
    buffer_load_dwordx4 v[28:31], v1, s[8:11], s22 offen sc1
    buffer_load_dwordx4 v[32:35], v1, s[8:11], s23 offen sc1
    buffer_load_dwordx4 v[36:39], v1, s[8:11], s24 offen sc1
    s_waitcnt vmcnt(0)
    ds_write_b128 v3, v[28:31] offset:3072
    ds_write_b128 v3, v[32:35] offset:4096
    ds_write_b128 v3, v[36:39] offset:5120
    v_max3_u32 v116, v28, v29, v30
    v_max3_u32 v116, v116, v31, v32
    v_max3_u32 v116, v116, v33, v34
    v_max3_u32 v116, v116, v35, v36
    v_max3_u32 v116, v116, v37, v38
    v_max_u32 v116, v116, v39
    v_cmp_eq_u32 vcc, -1, v116
    s_sub_u32 s15, s15, 1
    s_cbranch_scc1 layerb1_kernel_bail
    s_cbranch_vccnz layerb1_kernel_y1_poll
    s_waitcnt lgkmcnt(0)
    s_barrier
    ds_read_b128 v[16:19], v3 offset:0
    ds_read_b128 v[20:23], v3 offset:1024
    ds_read_b128 v[24:27], v3 offset:2048
    ds_read_b128 v[40:43], v3 offset:6144
    ds_read_b128 v[44:47], v3 offset:7168
    ds_read_b128 v[48:51], v3 offset:8192
    ds_read_b128 v[52:55], v3 offset:9216
    s_cmp_gt_u32 s47, s14
    s_cbranch_scc1 layerb1_kernel_y1_gw_ok
layerb1_kernel_y1_gw_lp:
    buffer_load_dword v116, v9, s[8:11], s48 offen sc1
    s_waitcnt vmcnt(0)
    v_readlane_b32 s47, v116, 0
    s_nop 0
    s_sub_u32 s15, s15, 1
    s_cbranch_scc1 layerb1_kernel_bail
    s_cmp_gt_u32 s47, s14
    s_cbranch_scc0 layerb1_kernel_y1_gw_lp
layerb1_kernel_y1_gw_ok:
    buffer_load_dwordx4 v[76:79], v4, s[8:11], s28 offen offset:128 sc1
    buffer_load_dwordx4 v[80:83], v4, s[8:11], s28 offen offset:256 sc1
    buffer_load_dwordx4 v[84:87], v4, s[8:11], s28 offen offset:384 sc1
    buffer_load_dwordx4 v[88:91], v4, s[8:11], s28 offen offset:512 sc1
    v_smfmac_f32_16x16x64_bf16 v[56:59], v[28:31], a[24:31], v2
    v_smfmac_f32_16x16x64_bf16 v[60:63], v[28:31], a[104:111], v2
    v_smfmac_f32_16x16x64_bf16 v[64:67], v[28:31], a[184:191], v2
    v_smfmac_f32_16x16x64_bf16 v[68:71], v[28:31], v[184:191], v2
    v_smfmac_f32_16x16x64_bf16 v[56:59], v[32:35], a[32:39], v2
    v_smfmac_f32_16x16x64_bf16 v[60:63], v[32:35], a[112:119], v2
    v_smfmac_f32_16x16x64_bf16 v[64:67], v[32:35], a[192:199], v2
    v_smfmac_f32_16x16x64_bf16 v[68:71], v[32:35], v[192:199], v2
    v_smfmac_f32_16x16x64_bf16 v[56:59], v[36:39], a[40:47], v2
    v_smfmac_f32_16x16x64_bf16 v[60:63], v[36:39], a[120:127], v2
    v_smfmac_f32_16x16x64_bf16 v[64:67], v[36:39], a[200:207], v2
    v_smfmac_f32_16x16x64_bf16 v[68:71], v[36:39], v[200:207], v2
    s_waitcnt lgkmcnt(6)
    v_smfmac_f32_16x16x64_bf16 v[56:59], v[16:19], a[0:7], v2
    v_smfmac_f32_16x16x64_bf16 v[60:63], v[16:19], a[80:87], v2
    v_smfmac_f32_16x16x64_bf16 v[64:67], v[16:19], a[160:167], v2
    v_smfmac_f32_16x16x64_bf16 v[68:71], v[16:19], a[240:247], v2
    s_waitcnt lgkmcnt(5)
    v_smfmac_f32_16x16x64_bf16 v[56:59], v[20:23], a[8:15], v2
    v_smfmac_f32_16x16x64_bf16 v[60:63], v[20:23], a[88:95], v2
    v_smfmac_f32_16x16x64_bf16 v[64:67], v[20:23], a[168:175], v2
    v_smfmac_f32_16x16x64_bf16 v[68:71], v[20:23], a[248:255], v2
    s_waitcnt lgkmcnt(4)
    v_smfmac_f32_16x16x64_bf16 v[56:59], v[24:27], a[16:23], v2
    v_smfmac_f32_16x16x64_bf16 v[60:63], v[24:27], a[96:103], v2
    v_smfmac_f32_16x16x64_bf16 v[64:67], v[24:27], a[176:183], v2
    v_smfmac_f32_16x16x64_bf16 v[68:71], v[24:27], v[176:183], v2
    s_waitcnt lgkmcnt(3)
    v_smfmac_f32_16x16x64_bf16 v[56:59], v[40:43], a[48:55], v2
    v_smfmac_f32_16x16x64_bf16 v[60:63], v[40:43], a[128:135], v2
    v_smfmac_f32_16x16x64_bf16 v[64:67], v[40:43], a[208:215], v2
    v_smfmac_f32_16x16x64_bf16 v[68:71], v[40:43], v[208:215], v2
    s_waitcnt lgkmcnt(2)
    v_smfmac_f32_16x16x64_bf16 v[56:59], v[44:47], a[56:63], v2
    v_smfmac_f32_16x16x64_bf16 v[60:63], v[44:47], a[136:143], v2
    v_smfmac_f32_16x16x64_bf16 v[64:67], v[44:47], a[216:223], v2
    v_smfmac_f32_16x16x64_bf16 v[68:71], v[44:47], v[216:223], v2
    s_waitcnt lgkmcnt(1)
    v_smfmac_f32_16x16x64_bf16 v[56:59], v[48:51], a[64:71], v2
    v_smfmac_f32_16x16x64_bf16 v[60:63], v[48:51], a[144:151], v2
    v_smfmac_f32_16x16x64_bf16 v[64:67], v[48:51], a[224:231], v2
    v_smfmac_f32_16x16x64_bf16 v[68:71], v[48:51], v[224:231], v2
    s_waitcnt lgkmcnt(0)
    v_smfmac_f32_16x16x64_bf16 v[56:59], v[52:55], a[72:79], v2
    v_smfmac_f32_16x16x64_bf16 v[60:63], v[52:55], a[152:159], v2
    v_smfmac_f32_16x16x64_bf16 v[64:67], v[52:55], a[232:239], v2
    v_smfmac_f32_16x16x64_bf16 v[68:71], v[52:55], v[232:239], v2
    s_nop 7
    v_permlane32_swap_b32 v56, v64
    v_permlane32_swap_b32 v60, v68
    v_permlane32_swap_b32 v57, v65
    v_permlane32_swap_b32 v61, v69
    v_permlane32_swap_b32 v58, v66
    v_permlane32_swap_b32 v62, v70
    v_permlane32_swap_b32 v59, v67
    v_permlane32_swap_b32 v63, v71
    v_add_f32 v56, v56, v64
    v_add_f32 v60, v60, v68
    v_add_f32 v57, v57, v65
    v_add_f32 v61, v61, v69
    v_add_f32 v58, v58, v66
    v_add_f32 v62, v62, v70
    v_add_f32 v59, v59, v67
    v_add_f32 v63, v63, v71
    s_nop 1
    v_permlane16_swap_b32 v56, v60
    v_permlane16_swap_b32 v57, v61
    v_permlane16_swap_b32 v58, v62
    v_permlane16_swap_b32 v59, v63
    s_nop 1
    v_cvt_pk_bf16_f32 v72, v56, v57
    v_cvt_pk_bf16_f32 v73, v58, v59
    v_cvt_pk_bf16_f32 v74, v60, v61
    v_cvt_pk_bf16_f32 v75, v62, v63
    buffer_store_dwordx4 v[72:75], v4, s[8:11], s28 offen sc1
    s_cmp_eq_u32 s14, 63
    s_cbranch_scc1 layerb1_kernel_y1_last
    s_add_u32 s30, s18, 0
    s_add_u32 s31, s18, 4096
    s_add_u32 s32, s18, 16384
    s_add_u32 s33, s18, 20480
    s_add_u32 s34, s18, 32768
    s_add_u32 s29, s14, 1
    s_cmp_lt_u32 s29, 32
    s_cselect_b32 s19, s16, s17
    s_and_b32 s20, s29, 31
    s_lshl_b32 s20, s20, 16
    s_add_u32 s19, s19, s20
layerb1_kernel_y1_ppoll:
    buffer_load_dwordx4 v[92:95], v5, s[8:11], s30 offen sc1
    buffer_load_dwordx4 v[96:99], v5, s[8:11], s31 offen sc1
    buffer_load_dwordx4 v[100:103], v5, s[8:11], s32 offen sc1
    buffer_load_dwordx4 v[104:107], v5, s[8:11], s33 offen sc1
    buffer_load_dwordx4 v[108:111], v5, s[8:11], s34 offen sc1
    s_waitcnt vmcnt(0)
    v_mfma_f32_16x16x32_bf16 v[112:115], v[92:95], v[72:75], 0
    v_mfma_f32_16x16x32_bf16 v[112:115], v[96:99], v[76:79], v[112:115]
    v_mfma_f32_16x16x32_bf16 v[112:115], v[100:103], v[80:83], v[112:115]
    v_mfma_f32_16x16x32_bf16 v[112:115], v[104:107], v[84:87], v[112:115]
    v_mfma_f32_16x16x32_bf16 v[112:115], v[108:111], v[88:91], v[112:115]
    v_max3_u32 v116, v92, v93, v94
    v_max3_u32 v116, v116, v95, v96
    v_max3_u32 v116, v116, v97, v98
    v_max3_u32 v116, v116, v99, v100
    v_max3_u32 v116, v116, v101, v102
    v_max3_u32 v116, v116, v103, v104
    v_max3_u32 v116, v116, v105, v106
    v_max3_u32 v116, v116, v107, v108
    v_max3_u32 v116, v116, v109, v110
    v_max_u32 v116, v116, v111
    v_cmp_eq_u32 vcc, -1, v116
    s_sub_u32 s15, s15, 1
    s_cbranch_scc1 layerb1_kernel_bail
    s_cbranch_vccnz layerb1_kernel_y1_ppoll
    ds_write_b128 v6, v[112:115]
    s_waitcnt lgkmcnt(0)
    s_barrier
    s_barrier
    s_add_u32 s14, s14, 1
    s_branch layerb1_kernel_y1_step
layerb1_kernel_y1_last:
    s_waitcnt vmcnt(0)
    s_barrier
    s_branch layerb1_kernel_end
layerb1_kernel_y2_start:
    v_lshrrev_b32 v16, 4, v0
    v_and_b32 v17, 7, v0
    v_lshrrev_b32 v18, 3, v0
    v_and_b32 v18, 1, v18
    v_lshl_add_u32 v19, v18, 2, v16
    v_add_u32 v19, 16, v19
    v_mul_u32_u24 v20, 640, v19
    v_lshl_add_u32 v4, v17, 4, v20
    v_and_b32 v20, 1, v17
    v_lshlrev_b32 v20, 2, v20
    v_lshrrev_b32 v21, 1, v17
    v_add_u32 v20, v20, v21
    v_lshlrev_b32 v20, 4, v20
    v_lshl_add_u32 v5, v19, 7, v20
    v_add_u32 v3, 0, v1
    v_lshrrev_b32 v20, 1, v17
    v_lshlrev_b32 v20, 7, v20
    v_and_b32 v21, 1, v17
    v_lshl_add_u32 v20, v21, 2, v20
    v_add_u32 v10, 1024, v20
    v_lshlrev_b32 v20, 8, v18
    v_lshl_add_u32 v20, v17, 5, v20
    v_and_b32 v21, 1, v16
    v_lshl_add_u32 v20, v21, 4, v20
    v_add_u32 v20, 11264, v20
    v_add_u32 v21, 12288, v1
    v_lshrrev_b32 v22, 1, v16
    v_cmp_eq_u32 vcc, v22, v18
    s_nop 1
    v_cndmask_b32 v6, v21, v20, vcc
    v_lshrrev_b32 v20, 3, v0
    v_lshlrev_b32 v20, 2, v20
    v_lshl_add_u32 v20, v17, 5, v20
    v_add_u32 v7, 10240, v20
    s_lshl_b32 s20, s12, 7
    s_add_u32 s20, s20, 20480
    s_lshr_b32 s21, s20, 13
    s_lshl_b32 s21, s21, 14
    s_and_b32 s20, s20, 8191
    s_add_u32 s20, s20, s21
    v_lshrrev_b32 v20, 3, v0
    v_lshlrev_b32 v20, 4, v20
    v_add_u32 v8, s20, v20
    s_mul_i32 s46, s12, 20480
    s_add_u32 s46, s46, 103809024
    s_mul_i32 s20, s12, 327680
    s_add_u32 s20, s20, 27426816
    s_add_u32 s21, s20, 65536
    buffer_load_dwordx4 v[176:179], v1, s[8:11], s21 offen offset:0
    buffer_load_dwordx4 v[180:183], v1, s[8:11], s21 offen offset:1024
    s_add_u32 s21, s20, 67584
    buffer_load_dwordx4 v[184:187], v1, s[8:11], s21 offen offset:0
    buffer_load_dwordx4 v[188:191], v1, s[8:11], s21 offen offset:1024
    s_add_u32 s21, s20, 69632
    buffer_load_dwordx4 v[192:195], v1, s[8:11], s21 offen offset:0
    buffer_load_dwordx4 v[196:199], v1, s[8:11], s21 offen offset:1024
    s_add_u32 s21, s20, 71680
    buffer_load_dwordx4 v[200:203], v1, s[8:11], s21 offen offset:0
    buffer_load_dwordx4 v[204:207], v1, s[8:11], s21 offen offset:1024
    s_add_u32 s21, s20, 73728
    buffer_load_dwordx4 v[208:211], v1, s[8:11], s21 offen offset:0
    buffer_load_dwordx4 v[212:215], v1, s[8:11], s21 offen offset:1024
    s_add_u32 s21, s20, 75776
    buffer_load_dwordx4 v[216:219], v1, s[8:11], s21 offen offset:0
    buffer_load_dwordx4 v[220:223], v1, s[8:11], s21 offen offset:1024
    s_add_u32 s21, s20, 77824
    buffer_load_dwordx4 v[224:227], v1, s[8:11], s21 offen offset:0
    buffer_load_dwordx4 v[228:231], v1, s[8:11], s21 offen offset:1024
    s_add_u32 s21, s20, 79872
    buffer_load_dwordx4 v[232:235], v1, s[8:11], s21 offen offset:0
    buffer_load_dwordx4 v[236:239], v1, s[8:11], s21 offen offset:1024
    s_add_u32 s20, s48, 51200
    s_mov_b64 exec, 3
    v_lshlrev_b32 v16, 2, v0
layerb1_kernel_y2_par:
    buffer_load_dword v17, v16, s[8:11], s20 offen sc1
    s_waitcnt vmcnt(0)
    v_cmp_eq_u32 vcc, 0, v17
    s_sub_u32 s15, s15, 1
    s_cbranch_scc1 layerb1_kernel_bail
    s_cbranch_vccnz layerb1_kernel_y2_par
    s_mov_b64 exec, -1
    v_readlane_b32 s20, v17, 0
    v_readlane_b32 s21, v17, 1
    s_nop 0
    s_and_b32 s20, s20, 8192
    s_and_b32 s21, s21, 8192
    s_add_u32 s16, s16, s20
    s_add_u32 s17, s17, s21
    s_mov_b32 s14, 0
    s_lshl_b32 s20, s12, 7
    v_mov_b32 v9, s20
    s_mov_b32 s47, 0
layerb1_kernel_y2_step:
    s_cmp_lt_u32 s14, 32
    s_cselect_b32 s18, s16, s17
    s_and_b32 s20, s14, 31
    s_lshl_b32 s20, s20, 16
    s_add_u32 s18, s18, s20
    s_mul_i32 s28, s14, 1638400
    s_add_u32 s28, s28, s46
    v_mov_b32 v56, 0
    v_mov_b32 v57, 0
    v_mov_b32 v58, 0
    v_mov_b32 v59, 0
    v_mov_b32 v60, 0
    v_mov_b32 v61, 0
    v_mov_b32 v62, 0
    v_mov_b32 v63, 0
    v_mov_b32 v64, 0
    v_mov_b32 v65, 0
    v_mov_b32 v66, 0
    v_mov_b32 v67, 0
    v_mov_b32 v68, 0
    v_mov_b32 v69, 0
    v_mov_b32 v70, 0
    v_mov_b32 v71, 0
    s_add_u32 s22, s18, 51200
    s_add_u32 s23, s18, 52224
layerb1_kernel_y2_poll:
    buffer_load_dwordx4 v[40:43], v1, s[8:11], s22 offen sc1
    buffer_load_dwordx4 v[44:47], v1, s[8:11], s23 offen sc1
    s_waitcnt vmcnt(0)
    ds_write_b128 v3, v[40:43] offset:6144
    ds_write_b128 v3, v[44:47] offset:7168
    v_max3_u32 v116, v40, v41, v42
    v_max3_u32 v116, v116, v43, v44
    v_max3_u32 v116, v116, v45, v46
    v_max_u32 v116, v116, v47
    v_cmp_eq_u32 vcc, -1, v116
    s_sub_u32 s15, s15, 1
    s_cbranch_scc1 layerb1_kernel_bail
    s_cbranch_vccnz layerb1_kernel_y2_poll
    s_waitcnt lgkmcnt(0)
    s_barrier
    ds_read_b128 v[16:19], v3 offset:0
    ds_read_b128 v[20:23], v3 offset:1024
    ds_read_b128 v[24:27], v3 offset:2048
    ds_read_b128 v[28:31], v3 offset:3072
    ds_read_b128 v[32:35], v3 offset:4096
    ds_read_b128 v[36:39], v3 offset:5120
    ds_read_b128 v[48:51], v3 offset:8192
    ds_read_b128 v[52:55], v3 offset:9216
    s_cmp_gt_u32 s47, s14
    s_cbranch_scc1 layerb1_kernel_y2_gw_ok
layerb1_kernel_y2_gw_lp:
    buffer_load_dword v116, v9, s[8:11], s48 offen sc1
    s_waitcnt vmcnt(0)
    v_readlane_b32 s47, v116, 0
    s_nop 0
    s_sub_u32 s15, s15, 1
    s_cbranch_scc1 layerb1_kernel_bail
    s_cmp_gt_u32 s47, s14
    s_cbranch_scc0 layerb1_kernel_y2_gw_lp
layerb1_kernel_y2_gw_ok:
    buffer_load_dwordx4 v[76:79], v4, s[8:11], s28 offen offset:128 sc1
    buffer_load_dwordx4 v[80:83], v4, s[8:11], s28 offen offset:256 sc1
    buffer_load_dwordx4 v[84:87], v4, s[8:11], s28 offen offset:384 sc1
    buffer_load_dwordx4 v[88:91], v4, s[8:11], s28 offen offset:512 sc1
    v_smfmac_f32_16x16x64_bf16 v[56:59], v[40:43], a[48:55], v2
    v_smfmac_f32_16x16x64_bf16 v[60:63], v[40:43], a[128:135], v2
    v_smfmac_f32_16x16x64_bf16 v[64:67], v[40:43], a[208:215], v2
    v_smfmac_f32_16x16x64_bf16 v[68:71], v[40:43], v[208:215], v2
    v_smfmac_f32_16x16x64_bf16 v[56:59], v[44:47], a[56:63], v2
    v_smfmac_f32_16x16x64_bf16 v[60:63], v[44:47], a[136:143], v2
    v_smfmac_f32_16x16x64_bf16 v[64:67], v[44:47], a[216:223], v2
    v_smfmac_f32_16x16x64_bf16 v[68:71], v[44:47], v[216:223], v2
    s_waitcnt lgkmcnt(7)
    v_smfmac_f32_16x16x64_bf16 v[56:59], v[16:19], a[0:7], v2
    v_smfmac_f32_16x16x64_bf16 v[60:63], v[16:19], a[80:87], v2
    v_smfmac_f32_16x16x64_bf16 v[64:67], v[16:19], a[160:167], v2
    v_smfmac_f32_16x16x64_bf16 v[68:71], v[16:19], a[240:247], v2
    s_waitcnt lgkmcnt(6)
    v_smfmac_f32_16x16x64_bf16 v[56:59], v[20:23], a[8:15], v2
    v_smfmac_f32_16x16x64_bf16 v[60:63], v[20:23], a[88:95], v2
    v_smfmac_f32_16x16x64_bf16 v[64:67], v[20:23], a[168:175], v2
    v_smfmac_f32_16x16x64_bf16 v[68:71], v[20:23], a[248:255], v2
    s_waitcnt lgkmcnt(5)
    v_smfmac_f32_16x16x64_bf16 v[56:59], v[24:27], a[16:23], v2
    v_smfmac_f32_16x16x64_bf16 v[60:63], v[24:27], a[96:103], v2
    v_smfmac_f32_16x16x64_bf16 v[64:67], v[24:27], a[176:183], v2
    v_smfmac_f32_16x16x64_bf16 v[68:71], v[24:27], v[176:183], v2
    s_waitcnt lgkmcnt(4)
    v_smfmac_f32_16x16x64_bf16 v[56:59], v[28:31], a[24:31], v2
    v_smfmac_f32_16x16x64_bf16 v[60:63], v[28:31], a[104:111], v2
    v_smfmac_f32_16x16x64_bf16 v[64:67], v[28:31], a[184:191], v2
    v_smfmac_f32_16x16x64_bf16 v[68:71], v[28:31], v[184:191], v2
    s_waitcnt lgkmcnt(3)
    v_smfmac_f32_16x16x64_bf16 v[56:59], v[32:35], a[32:39], v2
    v_smfmac_f32_16x16x64_bf16 v[60:63], v[32:35], a[112:119], v2
    v_smfmac_f32_16x16x64_bf16 v[64:67], v[32:35], a[192:199], v2
    v_smfmac_f32_16x16x64_bf16 v[68:71], v[32:35], v[192:199], v2
    s_waitcnt lgkmcnt(2)
    v_smfmac_f32_16x16x64_bf16 v[56:59], v[36:39], a[40:47], v2
    v_smfmac_f32_16x16x64_bf16 v[60:63], v[36:39], a[120:127], v2
    v_smfmac_f32_16x16x64_bf16 v[64:67], v[36:39], a[200:207], v2
    v_smfmac_f32_16x16x64_bf16 v[68:71], v[36:39], v[200:207], v2
    s_waitcnt lgkmcnt(1)
    v_smfmac_f32_16x16x64_bf16 v[56:59], v[48:51], a[64:71], v2
    v_smfmac_f32_16x16x64_bf16 v[60:63], v[48:51], a[144:151], v2
    v_smfmac_f32_16x16x64_bf16 v[64:67], v[48:51], a[224:231], v2
    v_smfmac_f32_16x16x64_bf16 v[68:71], v[48:51], v[224:231], v2
    s_waitcnt lgkmcnt(0)
    v_smfmac_f32_16x16x64_bf16 v[56:59], v[52:55], a[72:79], v2
    v_smfmac_f32_16x16x64_bf16 v[60:63], v[52:55], a[152:159], v2
    v_smfmac_f32_16x16x64_bf16 v[64:67], v[52:55], a[232:239], v2
    v_smfmac_f32_16x16x64_bf16 v[68:71], v[52:55], v[232:239], v2
    s_nop 7
    v_permlane32_swap_b32 v56, v64
    v_permlane32_swap_b32 v60, v68
    v_permlane32_swap_b32 v57, v65
    v_permlane32_swap_b32 v61, v69
    v_permlane32_swap_b32 v58, v66
    v_permlane32_swap_b32 v62, v70
    v_permlane32_swap_b32 v59, v67
    v_permlane32_swap_b32 v63, v71
    v_add_f32 v56, v56, v64
    v_add_f32 v60, v60, v68
    v_add_f32 v57, v57, v65
    v_add_f32 v61, v61, v69
    v_add_f32 v58, v58, v66
    v_add_f32 v62, v62, v70
    v_add_f32 v59, v59, v67
    v_add_f32 v63, v63, v71
    s_nop 1
    v_permlane16_swap_b32 v56, v60
    v_permlane16_swap_b32 v57, v61
    v_permlane16_swap_b32 v58, v62
    v_permlane16_swap_b32 v59, v63
    s_nop 1
    v_cvt_pk_bf16_f32 v72, v56, v57
    v_cvt_pk_bf16_f32 v73, v58, v59
    v_cvt_pk_bf16_f32 v74, v60, v61
    v_cvt_pk_bf16_f32 v75, v62, v63
    buffer_store_dwordx4 v[72:75], v4, s[8:11], s28 offen sc1
    s_cmp_eq_u32 s14, 63
    s_cbranch_scc1 layerb1_kernel_y2_last
    s_add_u32 s30, s18, 0
    s_add_u32 s31, s18, 4096
    s_add_u32 s32, s18, 16384
    s_add_u32 s33, s18, 20480
    s_add_u32 s34, s18, 32768
    s_add_u32 s29, s14, 1
    s_cmp_lt_u32 s29, 32
    s_cselect_b32 s19, s16, s17
    s_and_b32 s20, s29, 31
    s_lshl_b32 s20, s20, 16
    s_add_u32 s19, s19, s20
layerb1_kernel_y2_ppoll:
    buffer_load_dwordx4 v[92:95], v5, s[8:11], s30 offen sc1
    buffer_load_dwordx4 v[96:99], v5, s[8:11], s31 offen sc1
    buffer_load_dwordx4 v[100:103], v5, s[8:11], s32 offen sc1
    buffer_load_dwordx4 v[104:107], v5, s[8:11], s33 offen sc1
    buffer_load_dwordx4 v[108:111], v5, s[8:11], s34 offen sc1
    s_waitcnt vmcnt(0)
    v_mfma_f32_16x16x32_bf16 v[112:115], v[92:95], v[72:75], 0
    v_mfma_f32_16x16x32_bf16 v[112:115], v[96:99], v[76:79], v[112:115]
    v_mfma_f32_16x16x32_bf16 v[112:115], v[100:103], v[80:83], v[112:115]
    v_mfma_f32_16x16x32_bf16 v[112:115], v[104:107], v[84:87], v[112:115]
    v_mfma_f32_16x16x32_bf16 v[112:115], v[108:111], v[88:91], v[112:115]
    v_max3_u32 v116, v92, v93, v94
    v_max3_u32 v116, v116, v95, v96
    v_max3_u32 v116, v116, v97, v98
    v_max3_u32 v116, v116, v99, v100
    v_max3_u32 v116, v116, v101, v102
    v_max3_u32 v116, v116, v103, v104
    v_max3_u32 v116, v116, v105, v106
    v_max3_u32 v116, v116, v107, v108
    v_max3_u32 v116, v116, v109, v110
    v_max_u32 v116, v116, v111
    v_cmp_eq_u32 vcc, -1, v116
    s_sub_u32 s15, s15, 1
    s_cbranch_scc1 layerb1_kernel_bail
    s_cbranch_vccnz layerb1_kernel_y2_ppoll
    ds_write_b128 v6, v[112:115]
    s_waitcnt lgkmcnt(0)
    s_barrier
    s_barrier
    s_add_u32 s14, s14, 1
    s_branch layerb1_kernel_y2_step
layerb1_kernel_y2_last:
    s_waitcnt vmcnt(0)
    s_barrier
    s_branch layerb1_kernel_end
layerb1_kernel_y3_start:
    v_lshrrev_b32 v16, 4, v0
    v_and_b32 v17, 7, v0
    v_lshrrev_b32 v18, 3, v0
    v_and_b32 v18, 1, v18
    v_lshl_add_u32 v19, v18, 2, v16
    v_add_u32 v19, 24, v19
    v_mul_u32_u24 v20, 640, v19
    v_lshl_add_u32 v4, v17, 4, v20
    v_and_b32 v20, 1, v17
    v_lshlrev_b32 v20, 2, v20
    v_lshrrev_b32 v21, 1, v17
    v_add_u32 v20, v20, v21
    v_lshlrev_b32 v20, 4, v20
    v_lshl_add_u32 v5, v19, 7, v20
    v_add_u32 v3, 0, v1
    v_lshrrev_b32 v20, 1, v17
    v_lshlrev_b32 v20, 7, v20
    v_and_b32 v21, 1, v17
    v_lshl_add_u32 v20, v21, 2, v20
    v_add_u32 v10, 1536, v20
    v_lshlrev_b32 v20, 8, v18
    v_lshl_add_u32 v20, v17, 5, v20
    v_and_b32 v21, 1, v16
    v_lshl_add_u32 v20, v21, 4, v20
    v_add_u32 v20, 11776, v20
    v_add_u32 v21, 12288, v1
    v_lshrrev_b32 v22, 1, v16
    v_cmp_eq_u32 vcc, v22, v18
    s_nop 1
    v_cndmask_b32 v6, v21, v20, vcc
    v_lshrrev_b32 v20, 3, v0
    v_lshlrev_b32 v20, 2, v20
    v_lshl_add_u32 v20, v17, 5, v20
    v_add_u32 v7, 10240, v20
    s_lshl_b32 s20, s12, 7
    s_add_u32 s20, s20, 20480
    s_lshr_b32 s21, s20, 13
    s_lshl_b32 s21, s21, 14
    s_and_b32 s20, s20, 8191
    s_add_u32 s20, s20, s21
    v_lshrrev_b32 v20, 3, v0
    v_lshlrev_b32 v20, 4, v20
    v_add_u32 v8, s20, v20
    s_mul_i32 s46, s12, 20480
    s_add_u32 s46, s46, 103809024
    s_mul_i32 s20, s12, 327680
    s_add_u32 s20, s20, 27508736
    s_add_u32 s21, s20, 65536
    buffer_load_dwordx4 v[176:179], v1, s[8:11], s21 offen offset:0
    buffer_load_dwordx4 v[180:183], v1, s[8:11], s21 offen offset:1024
    s_add_u32 s21, s20, 67584
    buffer_load_dwordx4 v[184:187], v1, s[8:11], s21 offen offset:0
    buffer_load_dwordx4 v[188:191], v1, s[8:11], s21 offen offset:1024
    s_add_u32 s21, s20, 69632
    buffer_load_dwordx4 v[192:195], v1, s[8:11], s21 offen offset:0
    buffer_load_dwordx4 v[196:199], v1, s[8:11], s21 offen offset:1024
    s_add_u32 s21, s20, 71680
    buffer_load_dwordx4 v[200:203], v1, s[8:11], s21 offen offset:0
    buffer_load_dwordx4 v[204:207], v1, s[8:11], s21 offen offset:1024
    s_add_u32 s21, s20, 73728
    buffer_load_dwordx4 v[208:211], v1, s[8:11], s21 offen offset:0
    buffer_load_dwordx4 v[212:215], v1, s[8:11], s21 offen offset:1024
    s_add_u32 s21, s20, 75776
    buffer_load_dwordx4 v[216:219], v1, s[8:11], s21 offen offset:0
    buffer_load_dwordx4 v[220:223], v1, s[8:11], s21 offen offset:1024
    s_add_u32 s21, s20, 77824
    buffer_load_dwordx4 v[224:227], v1, s[8:11], s21 offen offset:0
    buffer_load_dwordx4 v[228:231], v1, s[8:11], s21 offen offset:1024
    s_add_u32 s21, s20, 79872
    buffer_load_dwordx4 v[232:235], v1, s[8:11], s21 offen offset:0
    buffer_load_dwordx4 v[236:239], v1, s[8:11], s21 offen offset:1024
    s_add_u32 s20, s48, 51200
    s_mov_b64 exec, 3
    v_lshlrev_b32 v16, 2, v0
layerb1_kernel_y3_par:
    buffer_load_dword v17, v16, s[8:11], s20 offen sc1
    s_waitcnt vmcnt(0)
    v_cmp_eq_u32 vcc, 0, v17
    s_sub_u32 s15, s15, 1
    s_cbranch_scc1 layerb1_kernel_bail
    s_cbranch_vccnz layerb1_kernel_y3_par
    s_mov_b64 exec, -1
    v_readlane_b32 s20, v17, 0
    v_readlane_b32 s21, v17, 1
    s_nop 0
    s_and_b32 s20, s20, 8192
    s_and_b32 s21, s21, 8192
    s_add_u32 s16, s16, s20
    s_add_u32 s17, s17, s21
    s_mov_b32 s14, 0
    s_lshl_b32 s20, s12, 7
    v_mov_b32 v9, s20
    s_mov_b32 s47, 0
layerb1_kernel_y3_step:
    s_cmp_lt_u32 s14, 32
    s_cselect_b32 s18, s16, s17
    s_and_b32 s20, s14, 31
    s_lshl_b32 s20, s20, 16
    s_add_u32 s18, s18, s20
    s_mul_i32 s28, s14, 1638400
    s_add_u32 s28, s28, s46
    v_mov_b32 v56, 0
    v_mov_b32 v57, 0
    v_mov_b32 v58, 0
    v_mov_b32 v59, 0
    v_mov_b32 v60, 0
    v_mov_b32 v61, 0
    v_mov_b32 v62, 0
    v_mov_b32 v63, 0
    v_mov_b32 v64, 0
    v_mov_b32 v65, 0
    v_mov_b32 v66, 0
    v_mov_b32 v67, 0
    v_mov_b32 v68, 0
    v_mov_b32 v69, 0
    v_mov_b32 v70, 0
    v_mov_b32 v71, 0
    s_add_u32 s22, s18, 53248
    s_add_u32 s23, s18, 54272
layerb1_kernel_y3_poll:
    buffer_load_dwordx4 v[48:51], v1, s[8:11], s22 offen sc1
    buffer_load_dwordx4 v[52:55], v1, s[8:11], s23 offen sc1
    s_waitcnt vmcnt(0)
    ds_write_b128 v3, v[48:51] offset:8192
    ds_write_b128 v3, v[52:55] offset:9216
    v_max3_u32 v116, v48, v49, v50
    v_max3_u32 v116, v116, v51, v52
    v_max3_u32 v116, v116, v53, v54
    v_max_u32 v116, v116, v55
    v_cmp_eq_u32 vcc, -1, v116
    s_sub_u32 s15, s15, 1
    s_cbranch_scc1 layerb1_kernel_bail
    s_cbranch_vccnz layerb1_kernel_y3_poll
    s_waitcnt lgkmcnt(0)
    s_barrier
    ds_read_b128 v[16:19], v3 offset:0
    ds_read_b128 v[20:23], v3 offset:1024
    ds_read_b128 v[24:27], v3 offset:2048
    ds_read_b128 v[28:31], v3 offset:3072
    ds_read_b128 v[32:35], v3 offset:4096
    ds_read_b128 v[36:39], v3 offset:5120
    ds_read_b128 v[40:43], v3 offset:6144
    ds_read_b128 v[44:47], v3 offset:7168
    s_cmp_gt_u32 s47, s14
    s_cbranch_scc1 layerb1_kernel_y3_gw_ok
layerb1_kernel_y3_gw_lp:
    buffer_load_dword v116, v9, s[8:11], s48 offen sc1
    s_waitcnt vmcnt(0)
    v_readlane_b32 s47, v116, 0
    s_nop 0
    s_sub_u32 s15, s15, 1
    s_cbranch_scc1 layerb1_kernel_bail
    s_cmp_gt_u32 s47, s14
    s_cbranch_scc0 layerb1_kernel_y3_gw_lp
layerb1_kernel_y3_gw_ok:
    buffer_load_dwordx4 v[76:79], v4, s[8:11], s28 offen offset:128 sc1
    buffer_load_dwordx4 v[80:83], v4, s[8:11], s28 offen offset:256 sc1
    buffer_load_dwordx4 v[84:87], v4, s[8:11], s28 offen offset:384 sc1
    buffer_load_dwordx4 v[88:91], v4, s[8:11], s28 offen offset:512 sc1
    v_smfmac_f32_16x16x64_bf16 v[56:59], v[48:51], a[64:71], v2
    v_smfmac_f32_16x16x64_bf16 v[60:63], v[48:51], a[144:151], v2
    v_smfmac_f32_16x16x64_bf16 v[64:67], v[48:51], a[224:231], v2
    v_smfmac_f32_16x16x64_bf16 v[68:71], v[48:51], v[224:231], v2
    v_smfmac_f32_16x16x64_bf16 v[56:59], v[52:55], a[72:79], v2
    v_smfmac_f32_16x16x64_bf16 v[60:63], v[52:55], a[152:159], v2
    v_smfmac_f32_16x16x64_bf16 v[64:67], v[52:55], a[232:239], v2
    v_smfmac_f32_16x16x64_bf16 v[68:71], v[52:55], v[232:239], v2
    s_waitcnt lgkmcnt(7)
    v_smfmac_f32_16x16x64_bf16 v[56:59], v[16:19], a[0:7], v2
    v_smfmac_f32_16x16x64_bf16 v[60:63], v[16:19], a[80:87], v2
    v_smfmac_f32_16x16x64_bf16 v[64:67], v[16:19], a[160:167], v2
    v_smfmac_f32_16x16x64_bf16 v[68:71], v[16:19], a[240:247], v2
    s_waitcnt lgkmcnt(6)
    v_smfmac_f32_16x16x64_bf16 v[56:59], v[20:23], a[8:15], v2
    v_smfmac_f32_16x16x64_bf16 v[60:63], v[20:23], a[88:95], v2
    v_smfmac_f32_16x16x64_bf16 v[64:67], v[20:23], a[168:175], v2
    v_smfmac_f32_16x16x64_bf16 v[68:71], v[20:23], a[248:255], v2
    s_waitcnt lgkmcnt(5)
    v_smfmac_f32_16x16x64_bf16 v[56:59], v[24:27], a[16:23], v2
    v_smfmac_f32_16x16x64_bf16 v[60:63], v[24:27], a[96:103], v2
    v_smfmac_f32_16x16x64_bf16 v[64:67], v[24:27], a[176:183], v2
    v_smfmac_f32_16x16x64_bf16 v[68:71], v[24:27], v[176:183], v2
    s_waitcnt lgkmcnt(4)
    v_smfmac_f32_16x16x64_bf16 v[56:59], v[28:31], a[24:31], v2
    v_smfmac_f32_16x16x64_bf16 v[60:63], v[28:31], a[104:111], v2
    v_smfmac_f32_16x16x64_bf16 v[64:67], v[28:31], a[184:191], v2
    v_smfmac_f32_16x16x64_bf16 v[68:71], v[28:31], v[184:191], v2
    s_waitcnt lgkmcnt(3)
    v_smfmac_f32_16x16x64_bf16 v[56:59], v[32:35], a[32:39], v2
    v_smfmac_f32_16x16x64_bf16 v[60:63], v[32:35], a[112:119], v2
    v_smfmac_f32_16x16x64_bf16 v[64:67], v[32:35], a[192:199], v2
    v_smfmac_f32_16x16x64_bf16 v[68:71], v[32:35], v[192:199], v2
    s_waitcnt lgkmcnt(2)
    v_smfmac_f32_16x16x64_bf16 v[56:59], v[36:39], a[40:47], v2
    v_smfmac_f32_16x16x64_bf16 v[60:63], v[36:39], a[120:127], v2
    v_smfmac_f32_16x16x64_bf16 v[64:67], v[36:39], a[200:207], v2
    v_smfmac_f32_16x16x64_bf16 v[68:71], v[36:39], v[200:207], v2
    s_waitcnt lgkmcnt(1)
    v_smfmac_f32_16x16x64_bf16 v[56:59], v[40:43], a[48:55], v2
    v_smfmac_f32_16x16x64_bf16 v[60:63], v[40:43], a[128:135], v2
    v_smfmac_f32_16x16x64_bf16 v[64:67], v[40:43], a[208:215], v2
    v_smfmac_f32_16x16x64_bf16 v[68:71], v[40:43], v[208:215], v2
    s_waitcnt lgkmcnt(0)
    v_smfmac_f32_16x16x64_bf16 v[56:59], v[44:47], a[56:63], v2
    v_smfmac_f32_16x16x64_bf16 v[60:63], v[44:47], a[136:143], v2
    v_smfmac_f32_16x16x64_bf16 v[64:67], v[44:47], a[216:223], v2
    v_smfmac_f32_16x16x64_bf16 v[68:71], v[44:47], v[216:223], v2
    s_nop 7
    v_permlane32_swap_b32 v56, v64
    v_permlane32_swap_b32 v60, v68
    v_permlane32_swap_b32 v57, v65
    v_permlane32_swap_b32 v61, v69
    v_permlane32_swap_b32 v58, v66
    v_permlane32_swap_b32 v62, v70
    v_permlane32_swap_b32 v59, v67
    v_permlane32_swap_b32 v63, v71
    v_add_f32 v56, v56, v64
    v_add_f32 v60, v60, v68
    v_add_f32 v57, v57, v65
    v_add_f32 v61, v61, v69
    v_add_f32 v58, v58, v66
    v_add_f32 v62, v62, v70
    v_add_f32 v59, v59, v67
    v_add_f32 v63, v63, v71
    s_nop 1
    v_permlane16_swap_b32 v56, v60
    v_permlane16_swap_b32 v57, v61
    v_permlane16_swap_b32 v58, v62
    v_permlane16_swap_b32 v59, v63
    s_nop 1
    v_cvt_pk_bf16_f32 v72, v56, v57
    v_cvt_pk_bf16_f32 v73, v58, v59
    v_cvt_pk_bf16_f32 v74, v60, v61
    v_cvt_pk_bf16_f32 v75, v62, v63
    buffer_store_dwordx4 v[72:75], v4, s[8:11], s28 offen sc1
    s_cmp_eq_u32 s14, 63
    s_cbranch_scc1 layerb1_kernel_y3_last
    s_add_u32 s30, s18, 0
    s_add_u32 s31, s18, 4096
    s_add_u32 s32, s18, 16384
    s_add_u32 s33, s18, 20480
    s_add_u32 s34, s18, 32768
    s_add_u32 s29, s14, 1
    s_cmp_lt_u32 s29, 32
    s_cselect_b32 s19, s16, s17
    s_and_b32 s20, s29, 31
    s_lshl_b32 s20, s20, 16
    s_add_u32 s19, s19, s20
layerb1_kernel_y3_ppoll:
    buffer_load_dwordx4 v[92:95], v5, s[8:11], s30 offen sc1
    buffer_load_dwordx4 v[96:99], v5, s[8:11], s31 offen sc1
    buffer_load_dwordx4 v[100:103], v5, s[8:11], s32 offen sc1
    buffer_load_dwordx4 v[104:107], v5, s[8:11], s33 offen sc1
    buffer_load_dwordx4 v[108:111], v5, s[8:11], s34 offen sc1
    s_waitcnt vmcnt(0)
    v_mfma_f32_16x16x32_bf16 v[112:115], v[92:95], v[72:75], 0
    v_mfma_f32_16x16x32_bf16 v[112:115], v[96:99], v[76:79], v[112:115]
    v_mfma_f32_16x16x32_bf16 v[112:115], v[100:103], v[80:83], v[112:115]
    v_mfma_f32_16x16x32_bf16 v[112:115], v[104:107], v[84:87], v[112:115]
    v_mfma_f32_16x16x32_bf16 v[112:115], v[108:111], v[88:91], v[112:115]
    v_max3_u32 v116, v92, v93, v94
    v_max3_u32 v116, v116, v95, v96
    v_max3_u32 v116, v116, v97, v98
    v_max3_u32 v116, v116, v99, v100
    v_max3_u32 v116, v116, v101, v102
    v_max3_u32 v116, v116, v103, v104
    v_max3_u32 v116, v116, v105, v106
    v_max3_u32 v116, v116, v107, v108
    v_max3_u32 v116, v116, v109, v110
    v_max_u32 v116, v116, v111
    v_cmp_eq_u32 vcc, -1, v116
    s_sub_u32 s15, s15, 1
    s_cbranch_scc1 layerb1_kernel_bail
    s_cbranch_vccnz layerb1_kernel_y3_ppoll
    ds_write_b128 v6, v[112:115]
    s_waitcnt lgkmcnt(0)
    s_barrier
    s_barrier
    s_add_u32 s14, s14, 1
    s_branch layerb1_kernel_y3_step
layerb1_kernel_y3_last:
    s_waitcnt vmcnt(0)
    s_barrier
    s_branch layerb1_kernel_end
layerb1_kernel_proj:
    s_sub_u32 s22, s20, 4
    s_lshl_b32 s22, s22, 5
    s_add_u32 s12, s22, s21
    s_mov_b32 s14, 0
    s_mov_b32 s15, 64
    v_lshlrev_b32 v1, 4, v0
    v_and_b32 v8, 31, v0
    v_lshrrev_b32 v9, 5, v0
    s_cmp_ge_u32 s12, 80
    s_cbranch_scc1 layerb1_kernel_g_qk
    v_lshrrev_b32 v10, 3, v8
    v_and_b32 v11, 7, v8
    v_mul_u32_u24 v12, 20480, v10
    v_lshl_add_u32 v12, v11, 4, v12
    v_lshl_add_u32 v4, v9, 8, v12
    s_mul_i32 s24, s12, 327680
    s_mul_i32 s25, s13, 81920
    s_add_u32 s24, s24, s25
    s_add_u32 s24, s24, 27262976
    s_add_u32 s24, s24, 3584
    s_add_u32 s24, s24, 3584
    s_add_u32 s24, s24, 3584
    s_add_u32 s24, s24, 3584
    buffer_load_dwordx4 v[192:195], v4, s[8:11], s24 offen offset:2048
    buffer_load_dwordx4 v[196:199], v4, s[8:11], s24 offen offset:2176
    buffer_load_dwordx4 v[200:203], v4, s[8:11], s24 offen offset:2560
    buffer_load_dwordx4 v[204:207], v4, s[8:11], s24 offen offset:2688
    buffer_load_dwordx4 v[208:211], v4, s[8:11], s24 offen offset:3072
    buffer_load_dwordx4 v[212:215], v4, s[8:11], s24 offen offset:3200
    s_add_u32 s24, s24, 3584
    buffer_load_dwordx4 v[216:219], v4, s[8:11], s24 offen offset:0
    buffer_load_dwordx4 v[220:223], v4, s[8:11], s24 offen offset:128
    buffer_load_dwordx4 v[224:227], v4, s[8:11], s24 offen offset:512
    buffer_load_dwordx4 v[228:231], v4, s[8:11], s24 offen offset:640
    buffer_load_dwordx4 v[232:235], v4, s[8:11], s24 offen offset:1024
    buffer_load_dwordx4 v[236:239], v4, s[8:11], s24 offen offset:1152
    buffer_load_dwordx4 v[240:243], v4, s[8:11], s24 offen offset:1536
    buffer_load_dwordx4 v[244:247], v4, s[8:11], s24 offen offset:1664
    buffer_load_dwordx4 v[248:251], v4, s[8:11], s24 offen offset:2048
    buffer_load_dwordx4 v[252:255], v4, s[8:11], s24 offen offset:2176
    s_lshl_b32 s25, s13, 3
    v_add_u32 v10, s25, v10
    v_mul_u32_u24 v10, 640, v10
    v_lshl_add_u32 v10, v9, 7, v10
    v_lshl_add_u32 v10, v11, 4, v10
    v_add_u32 v3, 128, v10
    s_mul_i32 s17, s12, 20480
    s_mul_i32 s25, s14, 1638400
    s_add_u32 s17, s17, s25
    s_add_u32 s17, s17, 103809024
    s_mov_b32 s20, 1638400
    s_mul_i32 s19, s13, 10240
    s_add_u32 s19, s19, 220200960
    s_mov_b32 s22, 0
    s_mov_b32 s56, 0
    s_mov_b32 s58, 400000
    s_add_u32 s57, s48, 45056
    s_cmp_lg_u32 s13, 0
    s_cbranch_scc1 layerb1_kernel_gu_lw1
    s_min_u32 s28, s14, 63
    s_cmp_gt_u32 s56, s28
    s_cbranch_scc1 layerb1_kernel_gu_lw1
layerb1_kernel_gu_lp1:
    buffer_load_dwordx4 v[124:127], v1, s[8:11], s57 offen sc1
    s_waitcnt vmcnt(0)
    v_min_u32 v124, v124, v125
    v_min_u32 v126, v126, v127
    v_min_u32 v124, v124, v126
    v_cmp_eq_u32 vcc, 0, v124
    s_nop 1
    s_ff1_i32_b64 s56, vcc
    s_min_u32 s56, s56, 64
    s_sub_u32 s58, s58, 1
    s_cbranch_scc1 layerb1_kernel_bail
    s_cmp_gt_u32 s56, s28
    s_cbranch_scc0 layerb1_kernel_gu_lp1
layerb1_kernel_gu_lw1:
    s_barrier
    s_min_u32 s24, s14, 63
    s_mul_i32 s24, s24, 40960
    s_add_u32 s24, s24, s19
    s_mul_i32 s25, s13, 10240
    s_add_u32 s25, s25, s22
    s_mov_b32 m0, s25
    s_nop 0
    buffer_load_dwordx4 v1, s[8:11], s24 offen offset:0 sc1 lds
    buffer_load_dwordx4 v1, s[8:11], s24 offen offset:1024 sc1 lds
    buffer_load_dwordx4 v1, s[8:11], s24 offen offset:2048 sc1 lds
    buffer_load_dwordx4 v1, s[8:11], s24 offen offset:3072 sc1 lds
    s_add_u32 s24, s24, 4096
    s_add_u32 s25, s25, 4096
    s_mov_b32 m0, s25
    s_nop 0
    buffer_load_dwordx4 v1, s[8:11], s24 offen offset:0 sc1 lds
    buffer_load_dwordx4 v1, s[8:11], s24 offen offset:1024 sc1 lds
    buffer_load_dwordx4 v1, s[8:11], s24 offen offset:2048 sc1 lds
    buffer_load_dwordx4 v1, s[8:11], s24 offen offset:3072 sc1 lds
    s_add_u32 s24, s24, 4096
    s_add_u32 s25, s25, 4096
    s_mov_b32 m0, s25
    s_nop 0
    buffer_load_dwordx4 v1, s[8:11], s24 offen offset:0 sc1 lds
    buffer_load_dwordx4 v1, s[8:11], s24 offen offset:1024 sc1 lds
    s_mov_b32 s22, 40960
    s_mov_b32 s16, 0
    s_waitcnt vmcnt(0)
    s_barrier
    v_mov_b32 v2, v1
    ds_read_b128 v[8:11], v2 offset:0
    ds_read_b128 v[12:15], v2 offset:1024
    ds_read_b128 v[16:19], v2 offset:2048
    ds_read_b128 v[20:23], v2 offset:3072
    ds_read_b128 v[24:27], v2 offset:4096
    ds_read_b128 v[28:31], v2 offset:5120
layerb1_kernel_gu_solo:
    ds_read_b128 v[32:35], v2 offset:6144
    s_waitcnt lgkmcnt(6)
    v_mfma_f32_32x32x16_bf16 v[40:55], v[8:11], a[0:3], 0
    v_mfma_f32_32x32x16_bf16 v[56:71], v[8:11], a[4:7], 0
    ds_read_b128 v[36:39], v2 offset:7168
    s_waitcnt lgkmcnt(6)
    v_mfma_f32_32x32x16_bf16 v[40:55], v[12:15], a[8:11], v[40:55]
    v_mfma_f32_32x32x16_bf16 v[56:71], v[12:15], a[12:15], v[56:71]
    ds_read_b128 v[8:11], v2 offset:8192
    s_waitcnt lgkmcnt(6)
    v_mfma_f32_32x32x16_bf16 v[40:55], v[16:19], a[16:19], v[40:55]
    v_mfma_f32_32x32x16_bf16 v[56:71], v[16:19], a[20:23], v[56:71]
    ds_read_b128 v[12:15], v2 offset:9216
    s_waitcnt lgkmcnt(6)
    v_mfma_f32_32x32x16_bf16 v[40:55], v[20:23], a[24:27], v[40:55]
    v_mfma_f32_32x32x16_bf16 v[56:71], v[20:23], a[28:31], v[56:71]
    ds_read_b128 v[16:19], v2 offset:10240
    s_waitcnt lgkmcnt(6)
    v_mfma_f32_32x32x16_bf16 v[40:55], v[24:27], a[32:35], v[40:55]
    v_mfma_f32_32x32x16_bf16 v[56:71], v[24:27], a[36:39], v[56:71]
    ds_read_b128 v[20:23], v2 offset:11264
    s_waitcnt lgkmcnt(6)
    v_mfma_f32_32x32x16_bf16 v[40:55], v[28:31], a[40:43], v[40:55]
    v_mfma_f32_32x32x16_bf16 v[56:71], v[28:31], a[44:47], v[56:71]
    ds_read_b128 v[24:27], v2 offset:12288
    s_waitcnt lgkmcnt(6)
    v_mfma_f32_32x32x16_bf16 v[40:55], v[32:35], a[48:51], v[40:55]
    v_mfma_f32_32x32x16_bf16 v[56:71], v[32:35], a[52:55], v[56:71]
    ds_read_b128 v[28:31], v2 offset:13312
    s_waitcnt lgkmcnt(6)
    v_mfma_f32_32x32x16_bf16 v[40:55], v[36:39], a[56:59], v[40:55]
    v_mfma_f32_32x32x16_bf16 v[56:71], v[36:39], a[60:63], v[56:71]
    ds_read_b128 v[32:35], v2 offset:14336
    s_waitcnt lgkmcnt(6)
    v_mfma_f32_32x32x16_bf16 v[40:55], v[8:11], a[64:67], v[40:55]
    v_mfma_f32_32x32x16_bf16 v[56:71], v[8:11], a[68:71], v[56:71]
    ds_read_b128 v[36:39], v2 offset:15360
    s_waitcnt lgkmcnt(6)
    v_mfma_f32_32x32x16_bf16 v[40:55], v[12:15], a[72:75], v[40:55]
    v_mfma_f32_32x32x16_bf16 v[56:71], v[12:15], a[76:79], v[56:71]
    ds_read_b128 v[8:11], v2 offset:16384
    s_waitcnt lgkmcnt(6)
    v_mfma_f32_32x32x16_bf16 v[40:55], v[16:19], a[80:83], v[40:55]
    v_mfma_f32_32x32x16_bf16 v[56:71], v[16:19], a[84:87], v[56:71]
    ds_read_b128 v[12:15], v2 offset:17408
    s_waitcnt lgkmcnt(6)
    v_mfma_f32_32x32x16_bf16 v[40:55], v[20:23], a[88:91], v[40:55]
    v_mfma_f32_32x32x16_bf16 v[56:71], v[20:23], a[92:95], v[56:71]
    ds_read_b128 v[16:19], v2 offset:18432
    s_waitcnt lgkmcnt(6)
    v_mfma_f32_32x32x16_bf16 v[40:55], v[24:27], a[96:99], v[40:55]
    v_mfma_f32_32x32x16_bf16 v[56:71], v[24:27], a[100:103], v[56:71]
    ds_read_b128 v[20:23], v2 offset:19456
    s_waitcnt lgkmcnt(6)
    v_mfma_f32_32x32x16_bf16 v[40:55], v[28:31], a[104:107], v[40:55]
    v_mfma_f32_32x32x16_bf16 v[56:71], v[28:31], a[108:111], v[56:71]
    ds_read_b128 v[24:27], v2 offset:20480
    s_waitcnt lgkmcnt(6)
    v_mfma_f32_32x32x16_bf16 v[40:55], v[32:35], a[112:115], v[40:55]
    v_mfma_f32_32x32x16_bf16 v[56:71], v[32:35], a[116:119], v[56:71]
    ds_read_b128 v[28:31], v2 offset:21504
    s_waitcnt lgkmcnt(6)
    v_mfma_f32_32x32x16_bf16 v[40:55], v[36:39], a[120:123], v[40:55]
    v_mfma_f32_32x32x16_bf16 v[56:71], v[36:39], a[124:127], v[56:71]
    ds_read_b128 v[32:35], v2 offset:22528
    s_waitcnt lgkmcnt(6)
    v_mfma_f32_32x32x16_bf16 v[40:55], v[8:11], a[128:131], v[40:55]
    v_mfma_f32_32x32x16_bf16 v[56:71], v[8:11], a[132:135], v[56:71]
    ds_read_b128 v[36:39], v2 offset:23552
    s_waitcnt lgkmcnt(6)
    v_mfma_f32_32x32x16_bf16 v[40:55], v[12:15], a[136:139], v[40:55]
    v_mfma_f32_32x32x16_bf16 v[56:71], v[12:15], a[140:143], v[56:71]
    ds_read_b128 v[8:11], v2 offset:24576
    s_waitcnt lgkmcnt(6)
    v_mfma_f32_32x32x16_bf16 v[40:55], v[16:19], a[144:147], v[40:55]
    v_mfma_f32_32x32x16_bf16 v[56:71], v[16:19], a[148:151], v[56:71]
    ds_read_b128 v[12:15], v2 offset:25600
    s_waitcnt lgkmcnt(6)
    v_mfma_f32_32x32x16_bf16 v[40:55], v[20:23], a[152:155], v[40:55]
    v_mfma_f32_32x32x16_bf16 v[56:71], v[20:23], a[156:159], v[56:71]
    ds_read_b128 v[16:19], v2 offset:26624
    s_waitcnt lgkmcnt(6)
    v_mfma_f32_32x32x16_bf16 v[40:55], v[24:27], a[160:163], v[40:55]
    v_mfma_f32_32x32x16_bf16 v[56:71], v[24:27], a[164:167], v[56:71]
    ds_read_b128 v[20:23], v2 offset:27648
    s_waitcnt lgkmcnt(6)
    v_mfma_f32_32x32x16_bf16 v[40:55], v[28:31], a[168:171], v[40:55]
    v_mfma_f32_32x32x16_bf16 v[56:71], v[28:31], a[172:175], v[56:71]
    ds_read_b128 v[24:27], v2 offset:28672
    s_waitcnt lgkmcnt(6)
    v_mfma_f32_32x32x16_bf16 v[40:55], v[32:35], a[176:179], v[40:55]
    v_mfma_f32_32x32x16_bf16 v[56:71], v[32:35], a[180:183], v[56:71]
    ds_read_b128 v[28:31], v2 offset:29696
    s_waitcnt lgkmcnt(6)
    v_mfma_f32_32x32x16_bf16 v[40:55], v[36:39], a[184:187], v[40:55]
    v_mfma_f32_32x32x16_bf16 v[56:71], v[36:39], a[188:191], v[56:71]
    ds_read_b128 v[32:35], v2 offset:30720
    s_waitcnt lgkmcnt(6)
    v_mfma_f32_32x32x16_bf16 v[40:55], v[8:11], a[192:195], v[40:55]
    v_mfma_f32_32x32x16_bf16 v[56:71], v[8:11], a[196:199], v[56:71]
    ds_read_b128 v[36:39], v2 offset:31744
    s_waitcnt lgkmcnt(6)
    v_mfma_f32_32x32x16_bf16 v[40:55], v[12:15], a[200:203], v[40:55]
    v_mfma_f32_32x32x16_bf16 v[56:71], v[12:15], a[204:207], v[56:71]
    ds_read_b128 v[8:11], v2 offset:32768
    s_waitcnt lgkmcnt(6)
    v_mfma_f32_32x32x16_bf16 v[40:55], v[16:19], a[208:211], v[40:55]
    v_mfma_f32_32x32x16_bf16 v[56:71], v[16:19], a[212:215], v[56:71]
    ds_read_b128 v[12:15], v2 offset:33792
    s_waitcnt lgkmcnt(6)
    v_mfma_f32_32x32x16_bf16 v[40:55], v[20:23], a[216:219], v[40:55]
    v_mfma_f32_32x32x16_bf16 v[56:71], v[20:23], a[220:223], v[56:71]
    ds_read_b128 v[16:19], v2 offset:34816
    s_waitcnt lgkmcnt(6)
    v_mfma_f32_32x32x16_bf16 v[40:55], v[24:27], a[224:227], v[40:55]
    v_mfma_f32_32x32x16_bf16 v[56:71], v[24:27], a[228:231], v[56:71]
    ds_read_b128 v[20:23], v2 offset:35840
    s_waitcnt lgkmcnt(6)
    v_mfma_f32_32x32x16_bf16 v[40:55], v[28:31], a[232:235], v[40:55]
    v_mfma_f32_32x32x16_bf16 v[56:71], v[28:31], a[236:239], v[56:71]
    ds_read_b128 v[24:27], v2 offset:36864
    s_waitcnt lgkmcnt(6)
    buffer_load_dwordx4 v[124:127], v1, s[8:11], s57 offen sc1
    v_mfma_f32_32x32x16_bf16 v[40:55], v[32:35], a[240:243], v[40:55]
    v_mfma_f32_32x32x16_bf16 v[56:71], v[32:35], a[244:247], v[56:71]
    ds_read_b128 v[28:31], v2 offset:37888
    s_waitcnt lgkmcnt(6)
    v_mfma_f32_32x32x16_bf16 v[40:55], v[36:39], a[248:251], v[40:55]
    v_mfma_f32_32x32x16_bf16 v[56:71], v[36:39], a[252:255], v[56:71]
    ds_read_b128 v[32:35], v2 offset:38912
    s_waitcnt lgkmcnt(6)
    v_mfma_f32_32x32x16_bf16 v[40:55], v[8:11], v[192:195], v[40:55]
    v_mfma_f32_32x32x16_bf16 v[56:71], v[8:11], v[196:199], v[56:71]
    ds_read_b128 v[36:39], v2 offset:39936
    s_waitcnt lgkmcnt(6)
    v_mfma_f32_32x32x16_bf16 v[40:55], v[12:15], v[200:203], v[40:55]
    v_mfma_f32_32x32x16_bf16 v[56:71], v[12:15], v[204:207], v[56:71]
    s_waitcnt lgkmcnt(5)
    v_mfma_f32_32x32x16_bf16 v[40:55], v[16:19], v[208:211], v[40:55]
    v_mfma_f32_32x32x16_bf16 v[56:71], v[16:19], v[212:215], v[56:71]
    s_waitcnt lgkmcnt(4)
    v_mfma_f32_32x32x16_bf16 v[40:55], v[20:23], v[216:219], v[40:55]
    v_mfma_f32_32x32x16_bf16 v[56:71], v[20:23], v[220:223], v[56:71]
    s_waitcnt lgkmcnt(3)
    v_mfma_f32_32x32x16_bf16 v[40:55], v[24:27], v[224:227], v[40:55]
    v_mfma_f32_32x32x16_bf16 v[56:71], v[24:27], v[228:231], v[56:71]
    s_waitcnt lgkmcnt(2)
    v_mfma_f32_32x32x16_bf16 v[40:55], v[28:31], v[232:235], v[40:55]
    v_mfma_f32_32x32x16_bf16 v[56:71], v[28:31], v[236:239], v[56:71]
    s_waitcnt lgkmcnt(1)
    v_mfma_f32_32x32x16_bf16 v[40:55], v[32:35], v[240:243], v[40:55]
    v_mfma_f32_32x32x16_bf16 v[56:71], v[32:35], v[244:247], v[56:71]
    s_waitcnt lgkmcnt(0)
    v_mfma_f32_32x32x16_bf16 v[40:55], v[36:39], v[248:251], v[40:55]
    v_mfma_f32_32x32x16_bf16 v[56:71], v[36:39], v[252:255], v[56:71]
    s_add_u32 s14, s14, 1
    s_nop 7
    s_nop 7
    v_cvt_pk_bf16_f32 v104, v40, v41
    v_cvt_pk_bf16_f32 v105, v42, v43
    v_cvt_pk_bf16_f32 v106, v44, v45
    v_cvt_pk_bf16_f32 v107, v46, v47
    s_nop 1
    v_permlane32_swap_b32 v104, v106
    v_permlane32_swap_b32 v105, v107
    buffer_store_dwordx4 v[104:107], v3, s[8:11], s17 offen offset:0 sc1
    v_cvt_pk_bf16_f32 v108, v48, v49
    v_cvt_pk_bf16_f32 v109, v50, v51
    v_cvt_pk_bf16_f32 v110, v52, v53
    v_cvt_pk_bf16_f32 v111, v54, v55
    s_nop 1
    v_permlane32_swap_b32 v108, v110
    v_permlane32_swap_b32 v109, v111
    buffer_store_dwordx4 v[108:111], v3, s[8:11], s17 offen offset:256 sc1
    v_cvt_pk_bf16_f32 v112, v56, v57
    v_cvt_pk_bf16_f32 v113, v58, v59
    v_cvt_pk_bf16_f32 v114, v60, v61
    v_cvt_pk_bf16_f32 v115, v62, v63
    s_nop 1
    v_permlane32_swap_b32 v112, v114
    v_permlane32_swap_b32 v113, v115
    buffer_store_dwordx4 v[112:115], v3, s[8:11], s17 offen offset:2560 sc1
    v_cvt_pk_bf16_f32 v116, v64, v65
    v_cvt_pk_bf16_f32 v117, v66, v67
    v_cvt_pk_bf16_f32 v118, v68, v69
    v_cvt_pk_bf16_f32 v119, v70, v71
    s_nop 1
    v_permlane32_swap_b32 v116, v118
    v_permlane32_swap_b32 v117, v119
    buffer_store_dwordx4 v[116:119], v3, s[8:11], s17 offen offset:2816 sc1
    s_add_u32 s17, s17, s20
    s_add_u32 s18, s18, s20
    s_waitcnt vmcnt(0)
    s_barrier
    s_cmp_lg_u32 s13, 0
    s_cbranch_scc1 layerb1_kernel_gu_fl2
    s_mov_b64 exec, 1
    s_lshl_b32 s26, s12, 7
    v_mov_b32 v7, s26
    v_mov_b32 v120, s14
    buffer_store_dword v120, v7, s[8:11], s48 offen sc1
    s_mov_b64 exec, -1
layerb1_kernel_gu_fl2:
layerb1_kernel_gu_spoll:
    v_min_u32 v124, v124, v125
    v_min_u32 v126, v126, v127
    v_min_u32 v124, v124, v126
    v_cmp_eq_u32 vcc, 0, v124
    s_nop 1
    s_ff1_i32_b64 s56, vcc
    s_min_u32 s56, s56, 64
    s_cmp_gt_u32 s56, s14
    s_cbranch_scc1 layerb1_kernel_gu_sok
    s_sub_u32 s58, s58, 1
    s_cbranch_scc1 layerb1_kernel_bail
    buffer_load_dwordx4 v[124:127], v1, s[8:11], s57 offen sc1
    s_waitcnt vmcnt(0)
    s_branch layerb1_kernel_gu_spoll
layerb1_kernel_gu_sok:
    s_min_u32 s24, s14, 63
    s_mul_i32 s24, s24, 40960
    s_add_u32 s24, s24, s19
    s_mul_i32 s25, s13, 10240
    s_add_u32 s25, s25, s22
    s_mov_b32 m0, s25
    s_nop 0
    buffer_load_dwordx4 v1, s[8:11], s24 offen offset:0 sc1 lds
    buffer_load_dwordx4 v1, s[8:11], s24 offen offset:1024 sc1 lds
    buffer_load_dwordx4 v1, s[8:11], s24 offen offset:2048 sc1 lds
    buffer_load_dwordx4 v1, s[8:11], s24 offen offset:3072 sc1 lds
    s_add_u32 s24, s24, 4096
    s_add_u32 s25, s25, 4096
    s_mov_b32 m0, s25
    s_nop 0
    buffer_load_dwordx4 v1, s[8:11], s24 offen offset:0 sc1 lds
    buffer_load_dwordx4 v1, s[8:11], s24 offen offset:1024 sc1 lds
    buffer_load_dwordx4 v1, s[8:11], s24 offen offset:2048 sc1 lds
    buffer_load_dwordx4 v1, s[8:11], s24 offen offset:3072 sc1 lds
    s_add_u32 s24, s24, 4096
    s_add_u32 s25, s25, 4096
    s_mov_b32 m0, s25
    s_nop 0
    buffer_load_dwordx4 v1, s[8:11], s24 offen offset:0 sc1 lds
    buffer_load_dwordx4 v1, s[8:11], s24 offen offset:1024 sc1 lds
    s_mov_b32 s16, s22
    s_add_u32 s22, s22, 40960
    s_cmp_eq_u32 s22, 122880
    s_cselect_b32 s22, 0, s22
    v_add_u32 v2, s16, v1
    s_waitcnt vmcnt(0)
    s_barrier
    ds_read_b128 v[8:11], v2 offset:0
    ds_read_b128 v[12:15], v2 offset:1024
    ds_read_b128 v[16:19], v2 offset:2048
    ds_read_b128 v[20:23], v2 offset:3072
    ds_read_b128 v[24:27], v2 offset:4096
    ds_read_b128 v[28:31], v2 offset:5120
    s_cmp_lt_u32 s14, 3
    s_cbranch_scc1 layerb1_kernel_gu_solo
    ds_read_b128 v[32:35], v2 offset:6144
    s_waitcnt lgkmcnt(6)
    v_mfma_f32_32x32x16_bf16 v[72:87], v[8:11], a[0:3], 0
    v_mfma_f32_32x32x16_bf16 v[88:103], v[8:11], a[4:7], 0
    ds_read_b128 v[36:39], v2 offset:7168
    s_waitcnt lgkmcnt(6)
    v_mfma_f32_32x32x16_bf16 v[72:87], v[12:15], a[8:11], v[72:87]
    v_mfma_f32_32x32x16_bf16 v[88:103], v[12:15], a[12:15], v[88:103]
    ds_read_b128 v[8:11], v2 offset:8192
    s_waitcnt lgkmcnt(6)
    v_mfma_f32_32x32x16_bf16 v[72:87], v[16:19], a[16:19], v[72:87]
    v_mfma_f32_32x32x16_bf16 v[88:103], v[16:19], a[20:23], v[88:103]
    s_add_u32 s23, s14, 1
    s_cmp_lg_u32 s13, 0
    s_cbranch_scc1 layerb1_kernel_gu_lw3
    s_min_u32 s28, s23, 63
    s_cmp_gt_u32 s56, s28
    s_cbranch_scc1 layerb1_kernel_gu_lw3
layerb1_kernel_gu_lp3:
    buffer_load_dwordx4 v[124:127], v1, s[8:11], s57 offen sc1
    s_waitcnt vmcnt(0)
    v_min_u32 v124, v124, v125
    v_min_u32 v126, v126, v127
    v_min_u32 v124, v124, v126
    v_cmp_eq_u32 vcc, 0, v124
    s_nop 1
    s_ff1_i32_b64 s56, vcc
    s_min_u32 s56, s56, 64
    s_sub_u32 s58, s58, 1
    s_cbranch_scc1 layerb1_kernel_bail
    s_cmp_gt_u32 s56, s28
    s_cbranch_scc0 layerb1_kernel_gu_lp3
layerb1_kernel_gu_lw3:
    s_barrier
    s_min_u32 s24, s23, 63
    s_mul_i32 s24, s24, 40960
    s_add_u32 s24, s24, s19
    s_mul_i32 s25, s13, 10240
    s_add_u32 s25, s25, s22
    s_add_u32 s22, s22, 40960
    s_cmp_eq_u32 s22, 122880
    s_cselect_b32 s22, 0, s22
    ds_read_b128 v[12:15], v2 offset:9216
    s_waitcnt lgkmcnt(6)
    v_mfma_f32_32x32x16_bf16 v[72:87], v[20:23], a[24:27], v[72:87]
    s_mov_b32 m0, s25
    s_nop 0
    buffer_load_dwordx4 v1, s[8:11], s24 offen offset:0 sc1 lds
    v_mfma_f32_32x32x16_bf16 v[88:103], v[20:23], a[28:31], v[88:103]
    ds_read_b128 v[16:19], v2 offset:10240
    s_waitcnt lgkmcnt(6)
    v_mfma_f32_32x32x16_bf16 v[72:87], v[24:27], a[32:35], v[72:87]
    buffer_load_dwordx4 v1, s[8:11], s24 offen offset:1024 sc1 lds
    v_mfma_f32_32x32x16_bf16 v[88:103], v[24:27], a[36:39], v[88:103]
    ds_read_b128 v[20:23], v2 offset:11264
    s_waitcnt lgkmcnt(6)
    v_mfma_f32_32x32x16_bf16 v[72:87], v[28:31], a[40:43], v[72:87]
    buffer_load_dwordx4 v1, s[8:11], s24 offen offset:2048 sc1 lds
    v_mfma_f32_32x32x16_bf16 v[88:103], v[28:31], a[44:47], v[88:103]
    ds_read_b128 v[24:27], v2 offset:12288
    s_waitcnt lgkmcnt(6)
    v_mfma_f32_32x32x16_bf16 v[72:87], v[32:35], a[48:51], v[72:87]
    buffer_load_dwordx4 v1, s[8:11], s24 offen offset:3072 sc1 lds
    v_mfma_f32_32x32x16_bf16 v[88:103], v[32:35], a[52:55], v[88:103]
    ds_read_b128 v[28:31], v2 offset:13312
    s_waitcnt lgkmcnt(6)
    v_mfma_f32_32x32x16_bf16 v[72:87], v[36:39], a[56:59], v[72:87]
    s_add_u32 s24, s24, 4096
    s_add_u32 s25, s25, 4096
    s_mov_b32 m0, s25
    s_nop 0
    buffer_load_dwordx4 v1, s[8:11], s24 offen offset:0 sc1 lds
    v_mfma_f32_32x32x16_bf16 v[88:103], v[36:39], a[60:63], v[88:103]
    ds_read_b128 v[32:35], v2 offset:14336
    s_waitcnt lgkmcnt(6)
    v_mfma_f32_32x32x16_bf16 v[72:87], v[8:11], a[64:67], v[72:87]
    buffer_load_dwordx4 v1, s[8:11], s24 offen offset:1024 sc1 lds
    v_mfma_f32_32x32x16_bf16 v[88:103], v[8:11], a[68:71], v[88:103]
    ds_read_b128 v[36:39], v2 offset:15360
    s_waitcnt lgkmcnt(6)
    v_mfma_f32_32x32x16_bf16 v[72:87], v[12:15], a[72:75], v[72:87]
    buffer_load_dwordx4 v1, s[8:11], s24 offen offset:2048 sc1 lds
    v_mfma_f32_32x32x16_bf16 v[88:103], v[12:15], a[76:79], v[88:103]
    ds_read_b128 v[8:11], v2 offset:16384
    s_waitcnt lgkmcnt(6)
    v_mfma_f32_32x32x16_bf16 v[72:87], v[16:19], a[80:83], v[72:87]
    buffer_load_dwordx4 v1, s[8:11], s24 offen offset:3072 sc1 lds
    v_mfma_f32_32x32x16_bf16 v[88:103], v[16:19], a[84:87], v[88:103]
    ds_read_b128 v[12:15], v2 offset:17408
    s_waitcnt lgkmcnt(6)
    v_mfma_f32_32x32x16_bf16 v[72:87], v[20:23], a[88:91], v[72:87]
    s_add_u32 s24, s24, 4096
    s_add_u32 s25, s25, 4096
    s_mov_b32 m0, s25
    s_nop 0
    buffer_load_dwordx4 v1, s[8:11], s24 offen offset:0 sc1 lds
    v_mfma_f32_32x32x16_bf16 v[88:103], v[20:23], a[92:95], v[88:103]
    ds_read_b128 v[16:19], v2 offset:18432
    s_waitcnt lgkmcnt(6)
    v_mfma_f32_32x32x16_bf16 v[72:87], v[24:27], a[96:99], v[72:87]
    buffer_load_dwordx4 v1, s[8:11], s24 offen offset:1024 sc1 lds
    v_mfma_f32_32x32x16_bf16 v[88:103], v[24:27], a[100:103], v[88:103]
    ds_read_b128 v[20:23], v2 offset:19456
    s_waitcnt lgkmcnt(6)
    v_mfma_f32_32x32x16_bf16 v[72:87], v[28:31], a[104:107], v[72:87]
    v_mfma_f32_32x32x16_bf16 v[88:103], v[28:31], a[108:111], v[88:103]
    ds_read_b128 v[24:27], v2 offset:20480
    s_waitcnt lgkmcnt(6)
    v_mfma_f32_32x32x16_bf16 v[72:87], v[32:35], a[112:115], v[72:87]
    v_mfma_f32_32x32x16_bf16 v[88:103], v[32:35], a[116:119], v[88:103]
    ds_read_b128 v[28:31], v2 offset:21504
    s_waitcnt lgkmcnt(6)
    v_mfma_f32_32x32x16_bf16 v[72:87], v[36:39], a[120:123], v[72:87]
    v_mfma_f32_32x32x16_bf16 v[88:103], v[36:39], a[124:127], v[88:103]
    ds_read_b128 v[32:35], v2 offset:22528
    s_waitcnt lgkmcnt(6)
    v_mfma_f32_32x32x16_bf16 v[72:87], v[8:11], a[128:131], v[72:87]
    v_mfma_f32_32x32x16_bf16 v[88:103], v[8:11], a[132:135], v[88:103]
    ds_read_b128 v[36:39], v2 offset:23552
    s_waitcnt lgkmcnt(6)
    v_mfma_f32_32x32x16_bf16 v[72:87], v[12:15], a[136:139], v[72:87]
    v_mfma_f32_32x32x16_bf16 v[88:103], v[12:15], a[140:143], v[88:103]
    ds_read_b128 v[8:11], v2 offset:24576
    s_waitcnt lgkmcnt(6)
    v_mfma_f32_32x32x16_bf16 v[72:87], v[16:19], a[144:147], v[72:87]
    v_mfma_f32_32x32x16_bf16 v[88:103], v[16:19], a[148:151], v[88:103]
    ds_read_b128 v[12:15], v2 offset:25600
    s_waitcnt lgkmcnt(6)
    v_mfma_f32_32x32x16_bf16 v[72:87], v[20:23], a[152:155], v[72:87]
    v_mfma_f32_32x32x16_bf16 v[88:103], v[20:23], a[156:159], v[88:103]
    ds_read_b128 v[16:19], v2 offset:26624
    s_waitcnt lgkmcnt(6)
    v_mfma_f32_32x32x16_bf16 v[72:87], v[24:27], a[160:163], v[72:87]
    v_mfma_f32_32x32x16_bf16 v[88:103], v[24:27], a[164:167], v[88:103]
    ds_read_b128 v[20:23], v2 offset:27648
    s_waitcnt lgkmcnt(6)
    v_mfma_f32_32x32x16_bf16 v[72:87], v[28:31], a[168:171], v[72:87]
    v_mfma_f32_32x32x16_bf16 v[88:103], v[28:31], a[172:175], v[88:103]
    ds_read_b128 v[24:27], v2 offset:28672
    s_waitcnt lgkmcnt(6)
    v_mfma_f32_32x32x16_bf16 v[72:87], v[32:35], a[176:179], v[72:87]
    v_mfma_f32_32x32x16_bf16 v[88:103], v[32:35], a[180:183], v[88:103]
    ds_read_b128 v[28:31], v2 offset:29696
    s_waitcnt lgkmcnt(6)
    v_mfma_f32_32x32x16_bf16 v[72:87], v[36:39], a[184:187], v[72:87]
    v_mfma_f32_32x32x16_bf16 v[88:103], v[36:39], a[188:191], v[88:103]
    ds_read_b128 v[32:35], v2 offset:30720
    s_waitcnt lgkmcnt(6)
    v_mfma_f32_32x32x16_bf16 v[72:87], v[8:11], a[192:195], v[72:87]
    v_mfma_f32_32x32x16_bf16 v[88:103], v[8:11], a[196:199], v[88:103]
    ds_read_b128 v[36:39], v2 offset:31744
    s_waitcnt lgkmcnt(6)
    v_mfma_f32_32x32x16_bf16 v[72:87], v[12:15], a[200:203], v[72:87]
    v_mfma_f32_32x32x16_bf16 v[88:103], v[12:15], a[204:207], v[88:103]
    ds_read_b128 v[8:11], v2 offset:32768
    s_waitcnt lgkmcnt(6)
    v_mfma_f32_32x32x16_bf16 v[72:87], v[16:19], a[208:211], v[72:87]
    v_mfma_f32_32x32x16_bf16 v[88:103], v[16:19], a[212:215], v[88:103]
    ds_read_b128 v[12:15], v2 offset:33792
    s_waitcnt lgkmcnt(6)
    v_mfma_f32_32x32x16_bf16 v[72:87], v[20:23], a[216:219], v[72:87]
    v_mfma_f32_32x32x16_bf16 v[88:103], v[20:23], a[220:223], v[88:103]
    ds_read_b128 v[16:19], v2 offset:34816
    s_waitcnt lgkmcnt(6)
    v_mfma_f32_32x32x16_bf16 v[72:87], v[24:27], a[224:227], v[72:87]
    v_mfma_f32_32x32x16_bf16 v[88:103], v[24:27], a[228:231], v[88:103]
    s_add_u32 s23, s14, 2
    s_cmp_lg_u32 s13, 0
    s_cbranch_scc1 layerb1_kernel_gu_lw4
    s_min_u32 s28, s23, 63
    s_cmp_gt_u32 s56, s28
    s_cbranch_scc1 layerb1_kernel_gu_lw4
layerb1_kernel_gu_lp4:
    buffer_load_dwordx4 v[124:127], v1, s[8:11], s57 offen sc1
    s_waitcnt vmcnt(0)
    v_min_u32 v124, v124, v125
    v_min_u32 v126, v126, v127
    v_min_u32 v124, v124, v126
    v_cmp_eq_u32 vcc, 0, v124
    s_nop 1
    s_ff1_i32_b64 s56, vcc
    s_min_u32 s56, s56, 64
    s_sub_u32 s58, s58, 1
    s_cbranch_scc1 layerb1_kernel_bail
    s_cmp_gt_u32 s56, s28
    s_cbranch_scc0 layerb1_kernel_gu_lp4
layerb1_kernel_gu_lw4:
    s_waitcnt vmcnt(0)
    s_barrier
    s_add_u32 s21, s16, 40960
    s_cmp_eq_u32 s21, 122880
    s_cselect_b32 s21, 0, s21
    s_add_u32 s23, s14, 2
    s_min_u32 s24, s23, 63
    s_mul_i32 s24, s24, 40960
    s_add_u32 s24, s24, s19
    s_mul_i32 s25, s13, 10240
    s_add_u32 s25, s25, s22
    s_add_u32 s22, s22, 40960
    s_cmp_eq_u32 s22, 122880
    s_cselect_b32 s22, 0, s22
    ds_read_b128 v[20:23], v2 offset:35840
    s_waitcnt lgkmcnt(6)
    v_mfma_f32_32x32x16_bf16 v[72:87], v[28:31], a[232:235], v[72:87]
    s_mov_b32 m0, s25
    s_nop 0
    buffer_load_dwordx4 v1, s[8:11], s24 offen offset:0 sc1 lds
    v_mfma_f32_32x32x16_bf16 v[88:103], v[28:31], a[236:239], v[88:103]
    ds_read_b128 v[24:27], v2 offset:36864
    s_waitcnt lgkmcnt(6)
    v_mfma_f32_32x32x16_bf16 v[72:87], v[32:35], a[240:243], v[72:87]
    buffer_load_dwordx4 v1, s[8:11], s24 offen offset:1024 sc1 lds
    v_mfma_f32_32x32x16_bf16 v[88:103], v[32:35], a[244:247], v[88:103]
    ds_read_b128 v[28:31], v2 offset:37888
    s_waitcnt lgkmcnt(6)
    v_mfma_f32_32x32x16_bf16 v[72:87], v[36:39], a[248:251], v[72:87]
    buffer_load_dwordx4 v1, s[8:11], s24 offen offset:2048 sc1 lds
    v_mfma_f32_32x32x16_bf16 v[88:103], v[36:39], a[252:255], v[88:103]
    ds_read_b128 v[32:35], v2 offset:38912
    s_waitcnt lgkmcnt(6)
    v_mfma_f32_32x32x16_bf16 v[72:87], v[8:11], v[192:195], v[72:87]
    buffer_load_dwordx4 v1, s[8:11], s24 offen offset:3072 sc1 lds
    v_mfma_f32_32x32x16_bf16 v[88:103], v[8:11], v[196:199], v[88:103]
    ds_read_b128 v[36:39], v2 offset:39936
    s_waitcnt lgkmcnt(6)
    v_mfma_f32_32x32x16_bf16 v[72:87], v[12:15], v[200:203], v[72:87]
    s_add_u32 s24, s24, 4096
    s_add_u32 s25, s25, 4096
    s_mov_b32 m0, s25
    s_nop 0
    buffer_load_dwordx4 v1, s[8:11], s24 offen offset:0 sc1 lds
    v_mfma_f32_32x32x16_bf16 v[88:103], v[12:15], v[204:207], v[88:103]
    v_add_u32 v6, s21, v1
    ds_read_b128 v[8:11], v6 offset:0
    s_waitcnt lgkmcnt(6)
    v_mfma_f32_32x32x16_bf16 v[72:87], v[16:19], v[208:211], v[72:87]
    buffer_load_dwordx4 v1, s[8:11], s24 offen offset:1024 sc1 lds
    v_mfma_f32_32x32x16_bf16 v[88:103], v[16:19], v[212:215], v[88:103]
    ds_read_b128 v[12:15], v6 offset:1024
    s_waitcnt lgkmcnt(6)
    v_mfma_f32_32x32x16_bf16 v[72:87], v[20:23], v[216:219], v[72:87]
    buffer_load_dwordx4 v1, s[8:11], s24 offen offset:2048 sc1 lds
    v_mfma_f32_32x32x16_bf16 v[88:103], v[20:23], v[220:223], v[88:103]
    ds_read_b128 v[16:19], v6 offset:2048
    s_waitcnt lgkmcnt(6)
    v_mfma_f32_32x32x16_bf16 v[72:87], v[24:27], v[224:227], v[72:87]
    buffer_load_dwordx4 v1, s[8:11], s24 offen offset:3072 sc1 lds
    v_mfma_f32_32x32x16_bf16 v[88:103], v[24:27], v[228:231], v[88:103]
    ds_read_b128 v[20:23], v6 offset:3072
    s_waitcnt lgkmcnt(6)
    v_mfma_f32_32x32x16_bf16 v[72:87], v[28:31], v[232:235], v[72:87]
    s_add_u32 s24, s24, 4096
    s_add_u32 s25, s25, 4096
    s_mov_b32 m0, s25
    s_nop 0
    buffer_load_dwordx4 v1, s[8:11], s24 offen offset:0 sc1 lds
    v_mfma_f32_32x32x16_bf16 v[88:103], v[28:31], v[236:239], v[88:103]
    ds_read_b128 v[24:27], v6 offset:4096
    s_waitcnt lgkmcnt(6)
    v_mfma_f32_32x32x16_bf16 v[72:87], v[32:35], v[240:243], v[72:87]
    buffer_load_dwordx4 v1, s[8:11], s24 offen offset:1024 sc1 lds
    v_mfma_f32_32x32x16_bf16 v[88:103], v[32:35], v[244:247], v[88:103]
    ds_read_b128 v[28:31], v6 offset:5120
    s_waitcnt lgkmcnt(6)
    v_mfma_f32_32x32x16_bf16 v[72:87], v[36:39], v[248:251], v[72:87]
    v_mfma_f32_32x32x16_bf16 v[88:103], v[36:39], v[252:255], v[88:103]
    v_mov_b32 v2, v6
    s_mov_b32 s16, s21
    s_add_u32 s14, s14, 1
layerb1_kernel_gu_loop:
    ds_read_b128 v[32:35], v2 offset:6144
    s_waitcnt lgkmcnt(6)
    v_mfma_f32_32x32x16_bf16 v[40:55], v[8:11], a[0:3], 0
    v_mfma_f32_32x32x16_bf16 v[56:71], v[8:11], a[4:7], 0
    ds_read_b128 v[36:39], v2 offset:7168
    s_waitcnt lgkmcnt(6)
    v_mfma_f32_32x32x16_bf16 v[40:55], v[12:15], a[8:11], v[40:55]
    v_mfma_f32_32x32x16_bf16 v[56:71], v[12:15], a[12:15], v[56:71]
    ds_read_b128 v[8:11], v2 offset:8192
    s_waitcnt lgkmcnt(6)
    v_mfma_f32_32x32x16_bf16 v[40:55], v[16:19], a[16:19], v[40:55]
    v_cvt_pk_bf16_f32 v104, v72, v73
    v_mfma_f32_32x32x16_bf16 v[56:71], v[16:19], a[20:23], v[56:71]
    v_cvt_pk_bf16_f32 v105, v74, v75
    ds_read_b128 v[12:15], v2 offset:9216
    s_waitcnt lgkmcnt(6)
    v_mfma_f32_32x32x16_bf16 v[40:55], v[20:23], a[24:27], v[40:55]
    v_cvt_pk_bf16_f32 v106, v76, v77
    v_mfma_f32_32x32x16_bf16 v[56:71], v[20:23], a[28:31], v[56:71]
    v_cvt_pk_bf16_f32 v107, v78, v79
    ds_read_b128 v[16:19], v2 offset:10240
    s_waitcnt lgkmcnt(6)
    v_mfma_f32_32x32x16_bf16 v[40:55], v[24:27], a[32:35], v[40:55]
    s_nop 1
    v_mfma_f32_32x32x16_bf16 v[56:71], v[24:27], a[36:39], v[56:71]
    v_permlane32_swap_b32 v104, v106
    ds_read_b128 v[20:23], v2 offset:11264
    s_waitcnt lgkmcnt(6)
    v_mfma_f32_32x32x16_bf16 v[40:55], v[28:31], a[40:43], v[40:55]
    v_permlane32_swap_b32 v105, v107
    v_mfma_f32_32x32x16_bf16 v[56:71], v[28:31], a[44:47], v[56:71]
    buffer_store_dwordx4 v[104:107], v3, s[8:11], s17 offen offset:0 sc1
    ds_read_b128 v[24:27], v2 offset:12288
    s_waitcnt lgkmcnt(6)
    v_mfma_f32_32x32x16_bf16 v[40:55], v[32:35], a[48:51], v[40:55]
    v_cvt_pk_bf16_f32 v108, v80, v81
    v_mfma_f32_32x32x16_bf16 v[56:71], v[32:35], a[52:55], v[56:71]
    v_cvt_pk_bf16_f32 v109, v82, v83
    ds_read_b128 v[28:31], v2 offset:13312
    s_waitcnt lgkmcnt(6)
    v_mfma_f32_32x32x16_bf16 v[40:55], v[36:39], a[56:59], v[40:55]
    v_cvt_pk_bf16_f32 v110, v84, v85
    v_mfma_f32_32x32x16_bf16 v[56:71], v[36:39], a[60:63], v[56:71]
    v_cvt_pk_bf16_f32 v111, v86, v87
    ds_read_b128 v[32:35], v2 offset:14336
    s_waitcnt lgkmcnt(6)
    v_mfma_f32_32x32x16_bf16 v[40:55], v[8:11], a[64:67], v[40:55]
    s_nop 1
    v_mfma_f32_32x32x16_bf16 v[56:71], v[8:11], a[68:71], v[56:71]
    v_permlane32_swap_b32 v108, v110
    ds_read_b128 v[36:39], v2 offset:15360
    s_waitcnt lgkmcnt(6)
    v_mfma_f32_32x32x16_bf16 v[40:55], v[12:15], a[72:75], v[40:55]
    v_permlane32_swap_b32 v109, v111
    v_mfma_f32_32x32x16_bf16 v[56:71], v[12:15], a[76:79], v[56:71]
    buffer_store_dwordx4 v[108:111], v3, s[8:11], s17 offen offset:256 sc1
    ds_read_b128 v[8:11], v2 offset:16384
    s_waitcnt lgkmcnt(6)
    v_mfma_f32_32x32x16_bf16 v[40:55], v[16:19], a[80:83], v[40:55]
    v_cvt_pk_bf16_f32 v112, v88, v89
    v_mfma_f32_32x32x16_bf16 v[56:71], v[16:19], a[84:87], v[56:71]
    v_cvt_pk_bf16_f32 v113, v90, v91
    ds_read_b128 v[12:15], v2 offset:17408
    s_waitcnt lgkmcnt(6)
    v_mfma_f32_32x32x16_bf16 v[40:55], v[20:23], a[88:91], v[40:55]
    v_cvt_pk_bf16_f32 v114, v92, v93
    v_mfma_f32_32x32x16_bf16 v[56:71], v[20:23], a[92:95], v[56:71]
    v_cvt_pk_bf16_f32 v115, v94, v95
    ds_read_b128 v[16:19], v2 offset:18432
    s_waitcnt lgkmcnt(6)
    v_mfma_f32_32x32x16_bf16 v[40:55], v[24:27], a[96:99], v[40:55]
    s_nop 1
    v_mfma_f32_32x32x16_bf16 v[56:71], v[24:27], a[100:103], v[56:71]
    v_permlane32_swap_b32 v112, v114
    ds_read_b128 v[20:23], v2 offset:19456
    s_waitcnt lgkmcnt(6)
    v_mfma_f32_32x32x16_bf16 v[40:55], v[28:31], a[104:107], v[40:55]
    v_permlane32_swap_b32 v113, v115
    v_mfma_f32_32x32x16_bf16 v[56:71], v[28:31], a[108:111], v[56:71]
    buffer_store_dwordx4 v[112:115], v3, s[8:11], s17 offen offset:2560 sc1
    ds_read_b128 v[24:27], v2 offset:20480
    s_waitcnt lgkmcnt(6)
    v_mfma_f32_32x32x16_bf16 v[40:55], v[32:35], a[112:115], v[40:55]
    v_cvt_pk_bf16_f32 v116, v96, v97
    v_mfma_f32_32x32x16_bf16 v[56:71], v[32:35], a[116:119], v[56:71]
    v_cvt_pk_bf16_f32 v117, v98, v99
    ds_read_b128 v[28:31], v2 offset:21504
    s_waitcnt lgkmcnt(6)
    v_mfma_f32_32x32x16_bf16 v[40:55], v[36:39], a[120:123], v[40:55]
    v_cvt_pk_bf16_f32 v118, v100, v101
    v_mfma_f32_32x32x16_bf16 v[56:71], v[36:39], a[124:127], v[56:71]
    v_cvt_pk_bf16_f32 v119, v102, v103
    ds_read_b128 v[32:35], v2 offset:22528
    s_waitcnt lgkmcnt(6)
    v_mfma_f32_32x32x16_bf16 v[40:55], v[8:11], a[128:131], v[40:55]
    s_nop 1
    v_mfma_f32_32x32x16_bf16 v[56:71], v[8:11], a[132:135], v[56:71]
    v_permlane32_swap_b32 v116, v118
    ds_read_b128 v[36:39], v2 offset:23552
    s_waitcnt lgkmcnt(6)
    v_mfma_f32_32x32x16_bf16 v[40:55], v[12:15], a[136:139], v[40:55]
    v_permlane32_swap_b32 v117, v119
    v_mfma_f32_32x32x16_bf16 v[56:71], v[12:15], a[140:143], v[56:71]
    buffer_store_dwordx4 v[116:119], v3, s[8:11], s17 offen offset:2816 sc1
    ds_read_b128 v[8:11], v2 offset:24576
    s_waitcnt lgkmcnt(6)
    v_mfma_f32_32x32x16_bf16 v[40:55], v[16:19], a[144:147], v[40:55]
    s_add_u32 s17, s17, s20
    v_mfma_f32_32x32x16_bf16 v[56:71], v[16:19], a[148:151], v[56:71]
    s_add_u32 s18, s18, s20
    ds_read_b128 v[12:15], v2 offset:25600
    s_waitcnt lgkmcnt(6)
    v_mfma_f32_32x32x16_bf16 v[40:55], v[20:23], a[152:155], v[40:55]
    v_mfma_f32_32x32x16_bf16 v[56:71], v[20:23], a[156:159], v[56:71]
    ds_read_b128 v[16:19], v2 offset:26624
    s_waitcnt lgkmcnt(6)
    v_mfma_f32_32x32x16_bf16 v[40:55], v[24:27], a[160:163], v[40:55]
    v_mfma_f32_32x32x16_bf16 v[56:71], v[24:27], a[164:167], v[56:71]
    ds_read_b128 v[20:23], v2 offset:27648
    s_waitcnt lgkmcnt(6)
    v_mfma_f32_32x32x16_bf16 v[40:55], v[28:31], a[168:171], v[40:55]
    v_mfma_f32_32x32x16_bf16 v[56:71], v[28:31], a[172:175], v[56:71]
    ds_read_b128 v[24:27], v2 offset:28672
    s_waitcnt lgkmcnt(6)
    v_mfma_f32_32x32x16_bf16 v[40:55], v[32:35], a[176:179], v[40:55]
    v_mfma_f32_32x32x16_bf16 v[56:71], v[32:35], a[180:183], v[56:71]
    ds_read_b128 v[28:31], v2 offset:29696
    s_waitcnt lgkmcnt(6)
    v_mfma_f32_32x32x16_bf16 v[40:55], v[36:39], a[184:187], v[40:55]
    v_mfma_f32_32x32x16_bf16 v[56:71], v[36:39], a[188:191], v[56:71]
    ds_read_b128 v[32:35], v2 offset:30720
    s_waitcnt lgkmcnt(6)
    v_mfma_f32_32x32x16_bf16 v[40:55], v[8:11], a[192:195], v[40:55]
    v_mfma_f32_32x32x16_bf16 v[56:71], v[8:11], a[196:199], v[56:71]
    ds_read_b128 v[36:39], v2 offset:31744
    s_waitcnt lgkmcnt(6)
    v_mfma_f32_32x32x16_bf16 v[40:55], v[12:15], a[200:203], v[40:55]
    v_mfma_f32_32x32x16_bf16 v[56:71], v[12:15], a[204:207], v[56:71]
    ds_read_b128 v[8:11], v2 offset:32768
    s_waitcnt lgkmcnt(6)
    v_mfma_f32_32x32x16_bf16 v[40:55], v[16:19], a[208:211], v[40:55]
    v_mfma_f32_32x32x16_bf16 v[56:71], v[16:19], a[212:215], v[56:71]
    ds_read_b128 v[12:15], v2 offset:33792
    s_waitcnt lgkmcnt(6)
    v_mfma_f32_32x32x16_bf16 v[40:55], v[20:23], a[216:219], v[40:55]
    v_mfma_f32_32x32x16_bf16 v[56:71], v[20:23], a[220:223], v[56:71]
    ds_read_b128 v[16:19], v2 offset:34816
    s_waitcnt lgkmcnt(6)
    v_mfma_f32_32x32x16_bf16 v[40:55], v[24:27], a[224:227], v[40:55]
    v_mfma_f32_32x32x16_bf16 v[56:71], v[24:27], a[228:231], v[56:71]
    s_add_u32 s23, s14, 2
    s_cmp_lg_u32 s13, 0
    s_cbranch_scc1 layerb1_kernel_gu_lw5
    s_min_u32 s28, s23, 63
    s_cmp_gt_u32 s56, s28
    s_cbranch_scc1 layerb1_kernel_gu_lw5
layerb1_kernel_gu_lp5:
    buffer_load_dwordx4 v[124:127], v1, s[8:11], s57 offen sc1
    s_waitcnt vmcnt(0)
    v_min_u32 v124, v124, v125
    v_min_u32 v126, v126, v127
    v_min_u32 v124, v124, v126
    v_cmp_eq_u32 vcc, 0, v124
    s_nop 1
    s_ff1_i32_b64 s56, vcc
    s_min_u32 s56, s56, 64
    s_sub_u32 s58, s58, 1
    s_cbranch_scc1 layerb1_kernel_bail
    s_cmp_gt_u32 s56, s28
    s_cbranch_scc0 layerb1_kernel_gu_lp5
layerb1_kernel_gu_lw5:
    s_cmp_gt_u32 s14, 5
    s_cbranch_scc1 layerb1_kernel_gu_dr6
    s_waitcnt vmcnt(0)
    s_mov_b32 s27, s14
    s_branch layerb1_kernel_gu_dq6
layerb1_kernel_gu_dr6:
    s_waitcnt vmcnt(4)
    s_sub_u32 s27, s14, 1
layerb1_kernel_gu_dq6:
    s_barrier
    s_cmp_lg_u32 s13, 0
    s_cbranch_scc1 layerb1_kernel_gu_fl7
    s_mov_b64 exec, 1
    s_lshl_b32 s26, s12, 7
    v_mov_b32 v7, s26
    v_mov_b32 v120, s27
    buffer_store_dword v120, v7, s[8:11], s48 offen sc1
    s_mov_b64 exec, -1
layerb1_kernel_gu_fl7:
    s_add_u32 s21, s16, 40960
    s_cmp_eq_u32 s21, 122880
    s_cselect_b32 s21, 0, s21
    s_add_u32 s23, s14, 2
    s_min_u32 s24, s23, 63
    s_mul_i32 s24, s24, 40960
    s_add_u32 s24, s24, s19
    s_mul_i32 s25, s13, 10240
    s_add_u32 s25, s25, s22
    s_add_u32 s22, s22, 40960
    s_cmp_eq_u32 s22, 122880
    s_cselect_b32 s22, 0, s22
    ds_read_b128 v[20:23], v2 offset:35840
    s_waitcnt lgkmcnt(6)
    v_mfma_f32_32x32x16_bf16 v[40:55], v[28:31], a[232:235], v[40:55]
    s_mov_b32 m0, s25
    s_nop 0
    buffer_load_dwordx4 v1, s[8:11], s24 offen offset:0 sc1 lds
    v_mfma_f32_32x32x16_bf16 v[56:71], v[28:31], a[236:239], v[56:71]
    ds_read_b128 v[24:27], v2 offset:36864
    s_waitcnt lgkmcnt(6)
    v_mfma_f32_32x32x16_bf16 v[40:55], v[32:35], a[240:243], v[40:55]
    buffer_load_dwordx4 v1, s[8:11], s24 offen offset:1024 sc1 lds
    v_mfma_f32_32x32x16_bf16 v[56:71], v[32:35], a[244:247], v[56:71]
    ds_read_b128 v[28:31], v2 offset:37888
    s_waitcnt lgkmcnt(6)
    v_mfma_f32_32x32x16_bf16 v[40:55], v[36:39], a[248:251], v[40:55]
    buffer_load_dwordx4 v1, s[8:11], s24 offen offset:2048 sc1 lds
    v_mfma_f32_32x32x16_bf16 v[56:71], v[36:39], a[252:255], v[56:71]
    ds_read_b128 v[32:35], v2 offset:38912
    s_waitcnt lgkmcnt(6)
    v_mfma_f32_32x32x16_bf16 v[40:55], v[8:11], v[192:195], v[40:55]
    buffer_load_dwordx4 v1, s[8:11], s24 offen offset:3072 sc1 lds
    v_mfma_f32_32x32x16_bf16 v[56:71], v[8:11], v[196:199], v[56:71]
    ds_read_b128 v[36:39], v2 offset:39936
    s_waitcnt lgkmcnt(6)
    v_mfma_f32_32x32x16_bf16 v[40:55], v[12:15], v[200:203], v[40:55]
    s_add_u32 s24, s24, 4096
    s_add_u32 s25, s25, 4096
    s_mov_b32 m0, s25
    s_nop 0
    buffer_load_dwordx4 v1, s[8:11], s24 offen offset:0 sc1 lds
    v_mfma_f32_32x32x16_bf16 v[56:71], v[12:15], v[204:207], v[56:71]
    v_add_u32 v6, s21, v1
    ds_read_b128 v[8:11], v6 offset:0
    s_waitcnt lgkmcnt(6)
    v_mfma_f32_32x32x16_bf16 v[40:55], v[16:19], v[208:211], v[40:55]
    buffer_load_dwordx4 v1, s[8:11], s24 offen offset:1024 sc1 lds
    v_mfma_f32_32x32x16_bf16 v[56:71], v[16:19], v[212:215], v[56:71]
    ds_read_b128 v[12:15], v6 offset:1024
    s_waitcnt lgkmcnt(6)
    v_mfma_f32_32x32x16_bf16 v[40:55], v[20:23], v[216:219], v[40:55]
    buffer_load_dwordx4 v1, s[8:11], s24 offen offset:2048 sc1 lds
    v_mfma_f32_32x32x16_bf16 v[56:71], v[20:23], v[220:223], v[56:71]
    ds_read_b128 v[16:19], v6 offset:2048
    s_waitcnt lgkmcnt(6)
    v_mfma_f32_32x32x16_bf16 v[40:55], v[24:27], v[224:227], v[40:55]
    buffer_load_dwordx4 v1, s[8:11], s24 offen offset:3072 sc1 lds
    v_mfma_f32_32x32x16_bf16 v[56:71], v[24:27], v[228:231], v[56:71]
    ds_read_b128 v[20:23], v6 offset:3072
    s_waitcnt lgkmcnt(6)
    v_mfma_f32_32x32x16_bf16 v[40:55], v[28:31], v[232:235], v[40:55]
    s_add_u32 s24, s24, 4096
    s_add_u32 s25, s25, 4096
    s_mov_b32 m0, s25
    s_nop 0
    buffer_load_dwordx4 v1, s[8:11], s24 offen offset:0 sc1 lds
    v_mfma_f32_32x32x16_bf16 v[56:71], v[28:31], v[236:239], v[56:71]
    ds_read_b128 v[24:27], v6 offset:4096
    s_waitcnt lgkmcnt(6)
    v_mfma_f32_32x32x16_bf16 v[40:55], v[32:35], v[240:243], v[40:55]
    buffer_load_dwordx4 v1, s[8:11], s24 offen offset:1024 sc1 lds
    v_mfma_f32_32x32x16_bf16 v[56:71], v[32:35], v[244:247], v[56:71]
    ds_read_b128 v[28:31], v6 offset:5120
    s_waitcnt lgkmcnt(6)
    v_mfma_f32_32x32x16_bf16 v[40:55], v[36:39], v[248:251], v[40:55]
    v_mfma_f32_32x32x16_bf16 v[56:71], v[36:39], v[252:255], v[56:71]
    v_mov_b32 v2, v6
    s_mov_b32 s16, s21
    s_add_u32 s14, s14, 1
    s_cmp_ge_u32 s14, s15
    s_cbranch_scc1 layerb1_kernel_gu_fin0
    ds_read_b128 v[32:35], v2 offset:6144
    s_waitcnt lgkmcnt(6)
    v_mfma_f32_32x32x16_bf16 v[72:87], v[8:11], a[0:3], 0
    v_mfma_f32_32x32x16_bf16 v[88:103], v[8:11], a[4:7], 0
    ds_read_b128 v[36:39], v2 offset:7168
    s_waitcnt lgkmcnt(6)
    v_mfma_f32_32x32x16_bf16 v[72:87], v[12:15], a[8:11], v[72:87]
    v_mfma_f32_32x32x16_bf16 v[88:103], v[12:15], a[12:15], v[88:103]
    ds_read_b128 v[8:11], v2 offset:8192
    s_waitcnt lgkmcnt(6)
    v_mfma_f32_32x32x16_bf16 v[72:87], v[16:19], a[16:19], v[72:87]
    v_cvt_pk_bf16_f32 v104, v40, v41
    v_mfma_f32_32x32x16_bf16 v[88:103], v[16:19], a[20:23], v[88:103]
    v_cvt_pk_bf16_f32 v105, v42, v43
    ds_read_b128 v[12:15], v2 offset:9216
    s_waitcnt lgkmcnt(6)
    v_mfma_f32_32x32x16_bf16 v[72:87], v[20:23], a[24:27], v[72:87]
    v_cvt_pk_bf16_f32 v106, v44, v45
    v_mfma_f32_32x32x16_bf16 v[88:103], v[20:23], a[28:31], v[88:103]
    v_cvt_pk_bf16_f32 v107, v46, v47
    ds_read_b128 v[16:19], v2 offset:10240
    s_waitcnt lgkmcnt(6)
    v_mfma_f32_32x32x16_bf16 v[72:87], v[24:27], a[32:35], v[72:87]
    s_nop 1
    v_mfma_f32_32x32x16_bf16 v[88:103], v[24:27], a[36:39], v[88:103]
    v_permlane32_swap_b32 v104, v106
    ds_read_b128 v[20:23], v2 offset:11264
    s_waitcnt lgkmcnt(6)
    v_mfma_f32_32x32x16_bf16 v[72:87], v[28:31], a[40:43], v[72:87]
    v_permlane32_swap_b32 v105, v107
    v_mfma_f32_32x32x16_bf16 v[88:103], v[28:31], a[44:47], v[88:103]
    buffer_store_dwordx4 v[104:107], v3, s[8:11], s17 offen offset:0 sc1
    ds_read_b128 v[24:27], v2 offset:12288
    s_waitcnt lgkmcnt(6)
    v_mfma_f32_32x32x16_bf16 v[72:87], v[32:35], a[48:51], v[72:87]
    v_cvt_pk_bf16_f32 v108, v48, v49
    v_mfma_f32_32x32x16_bf16 v[88:103], v[32:35], a[52:55], v[88:103]
    v_cvt_pk_bf16_f32 v109, v50, v51
    ds_read_b128 v[28:31], v2 offset:13312
    s_waitcnt lgkmcnt(6)
    v_mfma_f32_32x32x16_bf16 v[72:87], v[36:39], a[56:59], v[72:87]
    v_cvt_pk_bf16_f32 v110, v52, v53
    v_mfma_f32_32x32x16_bf16 v[88:103], v[36:39], a[60:63], v[88:103]
    v_cvt_pk_bf16_f32 v111, v54, v55
    ds_read_b128 v[32:35], v2 offset:14336
    s_waitcnt lgkmcnt(6)
    v_mfma_f32_32x32x16_bf16 v[72:87], v[8:11], a[64:67], v[72:87]
    s_nop 1
    v_mfma_f32_32x32x16_bf16 v[88:103], v[8:11], a[68:71], v[88:103]
    v_permlane32_swap_b32 v108, v110
    ds_read_b128 v[36:39], v2 offset:15360
    s_waitcnt lgkmcnt(6)
    v_mfma_f32_32x32x16_bf16 v[72:87], v[12:15], a[72:75], v[72:87]
    v_permlane32_swap_b32 v109, v111
    v_mfma_f32_32x32x16_bf16 v[88:103], v[12:15], a[76:79], v[88:103]
    buffer_store_dwordx4 v[108:111], v3, s[8:11], s17 offen offset:256 sc1
    ds_read_b128 v[8:11], v2 offset:16384
    s_waitcnt lgkmcnt(6)
    v_mfma_f32_32x32x16_bf16 v[72:87], v[16:19], a[80:83], v[72:87]
    v_cvt_pk_bf16_f32 v112, v56, v57
    v_mfma_f32_32x32x16_bf16 v[88:103], v[16:19], a[84:87], v[88:103]
    v_cvt_pk_bf16_f32 v113, v58, v59
    ds_read_b128 v[12:15], v2 offset:17408
    s_waitcnt lgkmcnt(6)
    v_mfma_f32_32x32x16_bf16 v[72:87], v[20:23], a[88:91], v[72:87]
    v_cvt_pk_bf16_f32 v114, v60, v61
    v_mfma_f32_32x32x16_bf16 v[88:103], v[20:23], a[92:95], v[88:103]
    v_cvt_pk_bf16_f32 v115, v62, v63
    ds_read_b128 v[16:19], v2 offset:18432
    s_waitcnt lgkmcnt(6)
    v_mfma_f32_32x32x16_bf16 v[72:87], v[24:27], a[96:99], v[72:87]
    s_nop 1
    v_mfma_f32_32x32x16_bf16 v[88:103], v[24:27], a[100:103], v[88:103]
    v_permlane32_swap_b32 v112, v114
    ds_read_b128 v[20:23], v2 offset:19456
    s_waitcnt lgkmcnt(6)
    v_mfma_f32_32x32x16_bf16 v[72:87], v[28:31], a[104:107], v[72:87]
    v_permlane32_swap_b32 v113, v115
    v_mfma_f32_32x32x16_bf16 v[88:103], v[28:31], a[108:111], v[88:103]
    buffer_store_dwordx4 v[112:115], v3, s[8:11], s17 offen offset:2560 sc1
    ds_read_b128 v[24:27], v2 offset:20480
    s_waitcnt lgkmcnt(6)
    v_mfma_f32_32x32x16_bf16 v[72:87], v[32:35], a[112:115], v[72:87]
    v_cvt_pk_bf16_f32 v116, v64, v65
    v_mfma_f32_32x32x16_bf16 v[88:103], v[32:35], a[116:119], v[88:103]
    v_cvt_pk_bf16_f32 v117, v66, v67
    ds_read_b128 v[28:31], v2 offset:21504
    s_waitcnt lgkmcnt(6)
    v_mfma_f32_32x32x16_bf16 v[72:87], v[36:39], a[120:123], v[72:87]
    v_cvt_pk_bf16_f32 v118, v68, v69
    v_mfma_f32_32x32x16_bf16 v[88:103], v[36:39], a[124:127], v[88:103]
    v_cvt_pk_bf16_f32 v119, v70, v71
    ds_read_b128 v[32:35], v2 offset:22528
    s_waitcnt lgkmcnt(6)
    v_mfma_f32_32x32x16_bf16 v[72:87], v[8:11], a[128:131], v[72:87]
    s_nop 1
    v_mfma_f32_32x32x16_bf16 v[88:103], v[8:11], a[132:135], v[88:103]
    v_permlane32_swap_b32 v116, v118
    ds_read_b128 v[36:39], v2 offset:23552
    s_waitcnt lgkmcnt(6)
    v_mfma_f32_32x32x16_bf16 v[72:87], v[12:15], a[136:139], v[72:87]
    v_permlane32_swap_b32 v117, v119
    v_mfma_f32_32x32x16_bf16 v[88:103], v[12:15], a[140:143], v[88:103]
    buffer_store_dwordx4 v[116:119], v3, s[8:11], s17 offen offset:2816 sc1
    ds_read_b128 v[8:11], v2 offset:24576
    s_waitcnt lgkmcnt(6)
    v_mfma_f32_32x32x16_bf16 v[72:87], v[16:19], a[144:147], v[72:87]
    s_add_u32 s17, s17, s20
    v_mfma_f32_32x32x16_bf16 v[88:103], v[16:19], a[148:151], v[88:103]
    s_add_u32 s18, s18, s20
    ds_read_b128 v[12:15], v2 offset:25600
    s_waitcnt lgkmcnt(6)
    v_mfma_f32_32x32x16_bf16 v[72:87], v[20:23], a[152:155], v[72:87]
    v_mfma_f32_32x32x16_bf16 v[88:103], v[20:23], a[156:159], v[88:103]
    ds_read_b128 v[16:19], v2 offset:26624
    s_waitcnt lgkmcnt(6)
    v_mfma_f32_32x32x16_bf16 v[72:87], v[24:27], a[160:163], v[72:87]
    v_mfma_f32_32x32x16_bf16 v[88:103], v[24:27], a[164:167], v[88:103]
    ds_read_b128 v[20:23], v2 offset:27648
    s_waitcnt lgkmcnt(6)
    v_mfma_f32_32x32x16_bf16 v[72:87], v[28:31], a[168:171], v[72:87]
    v_mfma_f32_32x32x16_bf16 v[88:103], v[28:31], a[172:175], v[88:103]
    ds_read_b128 v[24:27], v2 offset:28672
    s_waitcnt lgkmcnt(6)
    v_mfma_f32_32x32x16_bf16 v[72:87], v[32:35], a[176:179], v[72:87]
    v_mfma_f32_32x32x16_bf16 v[88:103], v[32:35], a[180:183], v[88:103]
    ds_read_b128 v[28:31], v2 offset:29696
    s_waitcnt lgkmcnt(6)
    v_mfma_f32_32x32x16_bf16 v[72:87], v[36:39], a[184:187], v[72:87]
    v_mfma_f32_32x32x16_bf16 v[88:103], v[36:39], a[188:191], v[88:103]
    ds_read_b128 v[32:35], v2 offset:30720
    s_waitcnt lgkmcnt(6)
    v_mfma_f32_32x32x16_bf16 v[72:87], v[8:11], a[192:195], v[72:87]
    v_mfma_f32_32x32x16_bf16 v[88:103], v[8:11], a[196:199], v[88:103]
    ds_read_b128 v[36:39], v2 offset:31744
    s_waitcnt lgkmcnt(6)
    v_mfma_f32_32x32x16_bf16 v[72:87], v[12:15], a[200:203], v[72:87]
    v_mfma_f32_32x32x16_bf16 v[88:103], v[12:15], a[204:207], v[88:103]
    ds_read_b128 v[8:11], v2 offset:32768
    s_waitcnt lgkmcnt(6)
    v_mfma_f32_32x32x16_bf16 v[72:87], v[16:19], a[208:211], v[72:87]
    v_mfma_f32_32x32x16_bf16 v[88:103], v[16:19], a[212:215], v[88:103]
    ds_read_b128 v[12:15], v2 offset:33792
    s_waitcnt lgkmcnt(6)
    v_mfma_f32_32x32x16_bf16 v[72:87], v[20:23], a[216:219], v[72:87]
    v_mfma_f32_32x32x16_bf16 v[88:103], v[20:23], a[220:223], v[88:103]
    ds_read_b128 v[16:19], v2 offset:34816
    s_waitcnt lgkmcnt(6)
    v_mfma_f32_32x32x16_bf16 v[72:87], v[24:27], a[224:227], v[72:87]
    v_mfma_f32_32x32x16_bf16 v[88:103], v[24:27], a[228:231], v[88:103]
    s_add_u32 s23, s14, 2
    s_cmp_lg_u32 s13, 0
    s_cbranch_scc1 layerb1_kernel_gu_lw8
    s_min_u32 s28, s23, 63
    s_cmp_gt_u32 s56, s28
    s_cbranch_scc1 layerb1_kernel_gu_lw8
layerb1_kernel_gu_lp8:
    buffer_load_dwordx4 v[124:127], v1, s[8:11], s57 offen sc1
    s_waitcnt vmcnt(0)
    v_min_u32 v124, v124, v125
    v_min_u32 v126, v126, v127
    v_min_u32 v124, v124, v126
    v_cmp_eq_u32 vcc, 0, v124
    s_nop 1
    s_ff1_i32_b64 s56, vcc
    s_min_u32 s56, s56, 64
    s_sub_u32 s58, s58, 1
    s_cbranch_scc1 layerb1_kernel_bail
    s_cmp_gt_u32 s56, s28
    s_cbranch_scc0 layerb1_kernel_gu_lp8
layerb1_kernel_gu_lw8:
    s_cmp_gt_u32 s14, 5
    s_cbranch_scc1 layerb1_kernel_gu_dr9
    s_waitcnt vmcnt(0)
    s_mov_b32 s27, s14
    s_branch layerb1_kernel_gu_dq9
layerb1_kernel_gu_dr9:
    s_waitcnt vmcnt(4)
    s_sub_u32 s27, s14, 1
layerb1_kernel_gu_dq9:
    s_barrier
    s_cmp_lg_u32 s13, 0
    s_cbranch_scc1 layerb1_kernel_gu_fl10
    s_mov_b64 exec, 1
    s_lshl_b32 s26, s12, 7
    v_mov_b32 v7, s26
    v_mov_b32 v120, s27
    buffer_store_dword v120, v7, s[8:11], s48 offen sc1
    s_mov_b64 exec, -1
layerb1_kernel_gu_fl10:
    s_add_u32 s21, s16, 40960
    s_cmp_eq_u32 s21, 122880
    s_cselect_b32 s21, 0, s21
    s_add_u32 s23, s14, 2
    s_min_u32 s24, s23, 63
    s_mul_i32 s24, s24, 40960
    s_add_u32 s24, s24, s19
    s_mul_i32 s25, s13, 10240
    s_add_u32 s25, s25, s22
    s_add_u32 s22, s22, 40960
    s_cmp_eq_u32 s22, 122880
    s_cselect_b32 s22, 0, s22
    ds_read_b128 v[20:23], v2 offset:35840
    s_waitcnt lgkmcnt(6)
    v_mfma_f32_32x32x16_bf16 v[72:87], v[28:31], a[232:235], v[72:87]
    s_mov_b32 m0, s25
    s_nop 0
    buffer_load_dwordx4 v1, s[8:11], s24 offen offset:0 sc1 lds
    v_mfma_f32_32x32x16_bf16 v[88:103], v[28:31], a[236:239], v[88:103]
    ds_read_b128 v[24:27], v2 offset:36864
    s_waitcnt lgkmcnt(6)
    v_mfma_f32_32x32x16_bf16 v[72:87], v[32:35], a[240:243], v[72:87]
    buffer_load_dwordx4 v1, s[8:11], s24 offen offset:1024 sc1 lds
    v_mfma_f32_32x32x16_bf16 v[88:103], v[32:35], a[244:247], v[88:103]
    ds_read_b128 v[28:31], v2 offset:37888
    s_waitcnt lgkmcnt(6)
    v_mfma_f32_32x32x16_bf16 v[72:87], v[36:39], a[248:251], v[72:87]
    buffer_load_dwordx4 v1, s[8:11], s24 offen offset:2048 sc1 lds
    v_mfma_f32_32x32x16_bf16 v[88:103], v[36:39], a[252:255], v[88:103]
    ds_read_b128 v[32:35], v2 offset:38912
    s_waitcnt lgkmcnt(6)
    v_mfma_f32_32x32x16_bf16 v[72:87], v[8:11], v[192:195], v[72:87]
    buffer_load_dwordx4 v1, s[8:11], s24 offen offset:3072 sc1 lds
    v_mfma_f32_32x32x16_bf16 v[88:103], v[8:11], v[196:199], v[88:103]
    ds_read_b128 v[36:39], v2 offset:39936
    s_waitcnt lgkmcnt(6)
    v_mfma_f32_32x32x16_bf16 v[72:87], v[12:15], v[200:203], v[72:87]
    s_add_u32 s24, s24, 4096
    s_add_u32 s25, s25, 4096
    s_mov_b32 m0, s25
    s_nop 0
    buffer_load_dwordx4 v1, s[8:11], s24 offen offset:0 sc1 lds
    v_mfma_f32_32x32x16_bf16 v[88:103], v[12:15], v[204:207], v[88:103]
    v_add_u32 v6, s21, v1
    ds_read_b128 v[8:11], v6 offset:0
    s_waitcnt lgkmcnt(6)
    v_mfma_f32_32x32x16_bf16 v[72:87], v[16:19], v[208:211], v[72:87]
    buffer_load_dwordx4 v1, s[8:11], s24 offen offset:1024 sc1 lds
    v_mfma_f32_32x32x16_bf16 v[88:103], v[16:19], v[212:215], v[88:103]
    ds_read_b128 v[12:15], v6 offset:1024
    s_waitcnt lgkmcnt(6)
    v_mfma_f32_32x32x16_bf16 v[72:87], v[20:23], v[216:219], v[72:87]
    buffer_load_dwordx4 v1, s[8:11], s24 offen offset:2048 sc1 lds
    v_mfma_f32_32x32x16_bf16 v[88:103], v[20:23], v[220:223], v[88:103]
    ds_read_b128 v[16:19], v6 offset:2048
    s_waitcnt lgkmcnt(6)
    v_mfma_f32_32x32x16_bf16 v[72:87], v[24:27], v[224:227], v[72:87]
    buffer_load_dwordx4 v1, s[8:11], s24 offen offset:3072 sc1 lds
    v_mfma_f32_32x32x16_bf16 v[88:103], v[24:27], v[228:231], v[88:103]
    ds_read_b128 v[20:23], v6 offset:3072
    s_waitcnt lgkmcnt(6)
    v_mfma_f32_32x32x16_bf16 v[72:87], v[28:31], v[232:235], v[72:87]
    s_add_u32 s24, s24, 4096
    s_add_u32 s25, s25, 4096
    s_mov_b32 m0, s25
    s_nop 0
    buffer_load_dwordx4 v1, s[8:11], s24 offen offset:0 sc1 lds
    v_mfma_f32_32x32x16_bf16 v[88:103], v[28:31], v[236:239], v[88:103]
    ds_read_b128 v[24:27], v6 offset:4096
    s_waitcnt lgkmcnt(6)
    v_mfma_f32_32x32x16_bf16 v[72:87], v[32:35], v[240:243], v[72:87]
    buffer_load_dwordx4 v1, s[8:11], s24 offen offset:1024 sc1 lds
    v_mfma_f32_32x32x16_bf16 v[88:103], v[32:35], v[244:247], v[88:103]
    ds_read_b128 v[28:31], v6 offset:5120
    s_waitcnt lgkmcnt(6)
    v_mfma_f32_32x32x16_bf16 v[72:87], v[36:39], v[248:251], v[72:87]
    v_mfma_f32_32x32x16_bf16 v[88:103], v[36:39], v[252:255], v[88:103]
    v_mov_b32 v2, v6
    s_mov_b32 s16, s21
    s_add_u32 s14, s14, 1
    s_cmp_lt_u32 s14, s15
    s_cbranch_scc1 layerb1_kernel_gu_loop
    s_branch layerb1_kernel_gu_fin1
layerb1_kernel_gu_fin0:
    s_nop 7
    s_nop 7
    v_cvt_pk_bf16_f32 v104, v40, v41
    v_cvt_pk_bf16_f32 v105, v42, v43
    v_cvt_pk_bf16_f32 v106, v44, v45
    v_cvt_pk_bf16_f32 v107, v46, v47
    s_nop 1
    v_permlane32_swap_b32 v104, v106
    v_permlane32_swap_b32 v105, v107
    buffer_store_dwordx4 v[104:107], v3, s[8:11], s17 offen offset:0 sc1
    v_cvt_pk_bf16_f32 v108, v48, v49
    v_cvt_pk_bf16_f32 v109, v50, v51
    v_cvt_pk_bf16_f32 v110, v52, v53
    v_cvt_pk_bf16_f32 v111, v54, v55
    s_nop 1
    v_permlane32_swap_b32 v108, v110
    v_permlane32_swap_b32 v109, v111
    buffer_store_dwordx4 v[108:111], v3, s[8:11], s17 offen offset:256 sc1
    v_cvt_pk_bf16_f32 v112, v56, v57
    v_cvt_pk_bf16_f32 v113, v58, v59
    v_cvt_pk_bf16_f32 v114, v60, v61
    v_cvt_pk_bf16_f32 v115, v62, v63
    s_nop 1
    v_permlane32_swap_b32 v112, v114
    v_permlane32_swap_b32 v113, v115
    buffer_store_dwordx4 v[112:115], v3, s[8:11], s17 offen offset:2560 sc1
    v_cvt_pk_bf16_f32 v116, v64, v65
    v_cvt_pk_bf16_f32 v117, v66, v67
    v_cvt_pk_bf16_f32 v118, v68, v69
    v_cvt_pk_bf16_f32 v119, v70, v71
    s_nop 1
    v_permlane32_swap_b32 v116, v118
    v_permlane32_swap_b32 v117, v119
    buffer_store_dwordx4 v[116:119], v3, s[8:11], s17 offen offset:2816 sc1
    s_add_u32 s17, s17, s20
    s_add_u32 s18, s18, s20
    s_branch layerb1_kernel_gu_done
layerb1_kernel_gu_fin1:
    s_nop 7
    s_nop 7
    v_cvt_pk_bf16_f32 v104, v72, v73
    v_cvt_pk_bf16_f32 v105, v74, v75
    v_cvt_pk_bf16_f32 v106, v76, v77
    v_cvt_pk_bf16_f32 v107, v78, v79
    s_nop 1
    v_permlane32_swap_b32 v104, v106
    v_permlane32_swap_b32 v105, v107
    buffer_store_dwordx4 v[104:107], v3, s[8:11], s17 offen offset:0 sc1
    v_cvt_pk_bf16_f32 v108, v80, v81
    v_cvt_pk_bf16_f32 v109, v82, v83
    v_cvt_pk_bf16_f32 v110, v84, v85
    v_cvt_pk_bf16_f32 v111, v86, v87
    s_nop 1
    v_permlane32_swap_b32 v108, v110
    v_permlane32_swap_b32 v109, v111
    buffer_store_dwordx4 v[108:111], v3, s[8:11], s17 offen offset:256 sc1
    v_cvt_pk_bf16_f32 v112, v88, v89
    v_cvt_pk_bf16_f32 v113, v90, v91
    v_cvt_pk_bf16_f32 v114, v92, v93
    v_cvt_pk_bf16_f32 v115, v94, v95
    s_nop 1
    v_permlane32_swap_b32 v112, v114
    v_permlane32_swap_b32 v113, v115
    buffer_store_dwordx4 v[112:115], v3, s[8:11], s17 offen offset:2560 sc1
    v_cvt_pk_bf16_f32 v116, v96, v97
    v_cvt_pk_bf16_f32 v117, v98, v99
    v_cvt_pk_bf16_f32 v118, v100, v101
    v_cvt_pk_bf16_f32 v119, v102, v103
    s_nop 1
    v_permlane32_swap_b32 v116, v118
    v_permlane32_swap_b32 v117, v119
    buffer_store_dwordx4 v[116:119], v3, s[8:11], s17 offen offset:2816 sc1
    s_add_u32 s17, s17, s20
    s_add_u32 s18, s18, s20
layerb1_kernel_gu_done:
    s_waitcnt vmcnt(0) lgkmcnt(0)
    s_barrier
    s_cmp_lg_u32 s13, 0
    s_cbranch_scc1 layerb1_kernel_gu_fl11
    s_mov_b64 exec, 1
    s_lshl_b32 s26, s12, 7
    v_mov_b32 v7, s26
    v_mov_b32 v120, s14
    buffer_store_dword v120, v7, s[8:11], s48 offen sc1
    s_mov_b64 exec, -1
layerb1_kernel_gu_fl11:
    s_branch layerb1_kernel_g_done
layerb1_kernel_g_qk:
    s_sub_u32 s26, s12, 80
    s_cmp_ge_u32 s26, 24
    s_cselect_b32 s27, 1, 0
    s_cselect_b32 s28, 24, 0
    s_sub_u32 s26, s26, s28
    s_lshl_b32 s26, s26, 3
    s_lshl_b32 s28, s13, 1
    s_add_u32 s26, s26, s28
    s_add_u32 s28, s26, 0
    s_mul_i32 s29, s28, 171
    s_lshr_b32 s29, s29, 10
    s_mul_i32 s30, s29, 6
    s_sub_u32 s30, s28, s30
    s_mul_i32 s31, s29, 12288
    s_lshl_b32 s32, s30, 11
    s_add_u32 s31, s31, s32
    s_mul_i32 s32, s14, 393216
    s_add_u32 s31, s31, s32
    s_mul_i32 s32, s27, 25165824
    s_add_u32 s31, s31, s32
    s_add_u32 s17, s31, 53477376
    s_lshl_b32 s30, s30, 5
    v_add_u32 v10, s30, v8
    v_and_b32 v11, 0xc1, v10
    v_and_b32 v12, 8, v10
    v_lshl_or_b32 v11, v12, 2, v11
    v_and_b32 v12, 32, v10
    v_lshrrev_b32 v12, 1, v12
    v_or_b32 v11, v11, v12
    v_and_b32 v12, 2, v10
    v_lshl_or_b32 v11, v12, 2, v11
    v_and_b32 v12, 16, v10
    v_lshrrev_b32 v12, 2, v12
    v_or_b32 v11, v11, v12
    v_and_b32 v12, 4, v10
    v_lshrrev_b32 v12, 1, v12
    v_or_b32 v11, v11, v12
    s_cmp_eq_u32 s27, 1
    s_cselect_b64 vcc, -1, 0
    s_nop 1
    v_cndmask_b32 v10, v10, v11, vcc
    v_lshrrev_b32 v12, 4, v10
    v_and_b32 v13, 3, v12
    v_mul_u32_u24 v13, 6, v13
    v_lshrrev_b32 v12, 2, v12
    v_add_u32 v12, v12, v13
    v_mul_u32_u24 v12, 20480, v12
    v_and_b32 v13, 15, v10
    v_lshl_add_u32 v11, v13, 4, v12
    v_lshl_add_u32 v4, v9, 8, v11
    s_xor_b32 s30, s27, 1
    s_mul_i32 s30, s30, 61440
    s_mul_i32 s31, s29, 491520
    s_add_u32 s30, s30, s31
    s_add_u32 s34, s30, 11534336
    s_add_u32 s28, s26, 1
    s_mul_i32 s29, s28, 171
    s_lshr_b32 s29, s29, 10
    s_mul_i32 s30, s29, 6
    s_sub_u32 s30, s28, s30
    s_mul_i32 s31, s29, 12288
    s_lshl_b32 s32, s30, 11
    s_add_u32 s31, s31, s32
    s_mul_i32 s32, s14, 393216
    s_add_u32 s31, s31, s32
    s_mul_i32 s32, s27, 25165824
    s_add_u32 s31, s31, s32
    s_add_u32 s18, s31, 53477376
    s_lshl_b32 s30, s30, 5
    v_add_u32 v10, s30, v8
    v_and_b32 v11, 0xc1, v10
    v_and_b32 v12, 8, v10
    v_lshl_or_b32 v11, v12, 2, v11
    v_and_b32 v12, 32, v10
    v_lshrrev_b32 v12, 1, v12
    v_or_b32 v11, v11, v12
    v_and_b32 v12, 2, v10
    v_lshl_or_b32 v11, v12, 2, v11
    v_and_b32 v12, 16, v10
    v_lshrrev_b32 v12, 2, v12
    v_or_b32 v11, v11, v12
    v_and_b32 v12, 4, v10
    v_lshrrev_b32 v12, 1, v12
    v_or_b32 v11, v11, v12
    s_cmp_eq_u32 s27, 1
    s_cselect_b64 vcc, -1, 0
    s_nop 1
    v_cndmask_b32 v10, v10, v11, vcc
    v_lshrrev_b32 v12, 4, v10
    v_and_b32 v13, 3, v12
    v_mul_u32_u24 v13, 6, v13
    v_lshrrev_b32 v12, 2, v12
    v_add_u32 v12, v12, v13
    v_mul_u32_u24 v12, 20480, v12
    v_and_b32 v13, 15, v10
    v_lshl_add_u32 v11, v13, 4, v12
    v_lshl_add_u32 v5, v9, 8, v11
    s_xor_b32 s30, s27, 1
    s_mul_i32 s30, s30, 61440
    s_mul_i32 s31, s29, 491520
    s_add_u32 s30, s30, s31
    s_add_u32 s35, s30, 11534336
    s_add_u32 s34, s34, 4096
    s_add_u32 s35, s35, 4096
    s_add_u32 s34, s34, 4096
    s_add_u32 s35, s35, 4096
    s_add_u32 s34, s34, 4096
    s_add_u32 s35, s35, 4096
    s_add_u32 s34, s34, 4096
    s_add_u32 s35, s35, 4096
    buffer_load_dwordx4 v[192:195], v4, s[8:11], s34 offen offset:0
    buffer_load_dwordx4 v[196:199], v5, s[8:11], s35 offen offset:0
    buffer_load_dwordx4 v[200:203], v4, s[8:11], s34 offen offset:512
    buffer_load_dwordx4 v[204:207], v5, s[8:11], s35 offen offset:512
    buffer_load_dwordx4 v[208:211], v4, s[8:11], s34 offen offset:1024
    buffer_load_dwordx4 v[212:215], v5, s[8:11], s35 offen offset:1024
    buffer_load_dwordx4 v[216:219], v4, s[8:11], s34 offen offset:1536
    buffer_load_dwordx4 v[220:223], v5, s[8:11], s35 offen offset:1536
    buffer_load_dwordx4 v[224:227], v4, s[8:11], s34 offen offset:2048
    buffer_load_dwordx4 v[228:231], v5, s[8:11], s35 offen offset:2048
    buffer_load_dwordx4 v[232:235], v4, s[8:11], s34 offen offset:2560
    buffer_load_dwordx4 v[236:239], v5, s[8:11], s35 offen offset:2560
    buffer_load_dwordx4 v[240:243], v4, s[8:11], s34 offen offset:3072
    buffer_load_dwordx4 v[244:247], v5, s[8:11], s35 offen offset:3072
    buffer_load_dwordx4 v[248:251], v4, s[8:11], s34 offen offset:3584
    buffer_load_dwordx4 v[252:255], v5, s[8:11], s35 offen offset:3584
    v_mov_b32 v3, v1
    s_mov_b32 s20, 393216
    s_mul_i32 s19, s13, 10240
    s_add_u32 s19, s19, 220200960
    s_mov_b32 s22, 0
    s_mov_b32 s56, 0
    s_mov_b32 s58, 400000
    s_add_u32 s57, s48, 45056
    s_cmp_lg_u32 s13, 0
    s_cbranch_scc1 layerb1_kernel_gk_lw1
    s_min_u32 s28, s14, 63
    s_cmp_gt_u32 s56, s28
    s_cbranch_scc1 layerb1_kernel_gk_lw1
layerb1_kernel_gk_lp1:
    buffer_load_dwordx4 v[124:127], v1, s[8:11], s57 offen sc1
    s_waitcnt vmcnt(0)
    v_min_u32 v124, v124, v125
    v_min_u32 v126, v126, v127
    v_min_u32 v124, v124, v126
    v_cmp_eq_u32 vcc, 0, v124
    s_nop 1
    s_ff1_i32_b64 s56, vcc
    s_min_u32 s56, s56, 64
    s_sub_u32 s58, s58, 1
    s_cbranch_scc1 layerb1_kernel_bail
    s_cmp_gt_u32 s56, s28
    s_cbranch_scc0 layerb1_kernel_gk_lp1
layerb1_kernel_gk_lw1:
    s_barrier
    s_min_u32 s24, s14, 63
    s_mul_i32 s24, s24, 40960
    s_add_u32 s24, s24, s19
    s_mul_i32 s25, s13, 10240
    s_add_u32 s25, s25, s22
    s_mov_b32 m0, s25
    s_nop 0
    buffer_load_dwordx4 v1, s[8:11], s24 offen offset:0 sc1 lds
    buffer_load_dwordx4 v1, s[8:11], s24 offen offset:1024 sc1 lds
    buffer_load_dwordx4 v1, s[8:11], s24 offen offset:2048 sc1 lds
    buffer_load_dwordx4 v1, s[8:11], s24 offen offset:3072 sc1 lds
    s_add_u32 s24, s24, 4096
    s_add_u32 s25, s25, 4096
    s_mov_b32 m0, s25
    s_nop 0
    buffer_load_dwordx4 v1, s[8:11], s24 offen offset:0 sc1 lds
    buffer_load_dwordx4 v1, s[8:11], s24 offen offset:1024 sc1 lds
    buffer_load_dwordx4 v1, s[8:11], s24 offen offset:2048 sc1 lds
    buffer_load_dwordx4 v1, s[8:11], s24 offen offset:3072 sc1 lds
    s_add_u32 s24, s24, 4096
    s_add_u32 s25, s25, 4096
    s_mov_b32 m0, s25
    s_nop 0
    buffer_load_dwordx4 v1, s[8:11], s24 offen offset:0 sc1 lds
    buffer_load_dwordx4 v1, s[8:11], s24 offen offset:1024 sc1 lds
    s_mov_b32 s22, 40960
    s_mov_b32 s16, 0
    s_waitcnt vmcnt(0)
    s_barrier
    v_mov_b32 v2, v1
    ds_read_b128 v[8:11], v2 offset:0
    ds_read_b128 v[12:15], v2 offset:1024
    ds_read_b128 v[16:19], v2 offset:2048
    ds_read_b128 v[20:23], v2 offset:3072
    ds_read_b128 v[24:27], v2 offset:4096
    ds_read_b128 v[28:31], v2 offset:5120
layerb1_kernel_gk_solo:
    ds_read_b128 v[32:35], v2 offset:6144
    s_waitcnt lgkmcnt(6)
    v_mfma_f32_32x32x16_bf16 v[40:55], a[0:3], v[8:11], 0
    v_mfma_f32_32x32x16_bf16 v[56:71], a[4:7], v[8:11], 0
    ds_read_b128 v[36:39], v2 offset:7168
    s_waitcnt lgkmcnt(6)
    v_mfma_f32_32x32x16_bf16 v[40:55], a[8:11], v[12:15], v[40:55]
    v_mfma_f32_32x32x16_bf16 v[56:71], a[12:15], v[12:15], v[56:71]
    ds_read_b128 v[8:11], v2 offset:8192
    s_waitcnt lgkmcnt(6)
    v_mfma_f32_32x32x16_bf16 v[40:55], a[16:19], v[16:19], v[40:55]
    v_mfma_f32_32x32x16_bf16 v[56:71], a[20:23], v[16:19], v[56:71]
    ds_read_b128 v[12:15], v2 offset:9216
    s_waitcnt lgkmcnt(6)
    v_mfma_f32_32x32x16_bf16 v[40:55], a[24:27], v[20:23], v[40:55]
    v_mfma_f32_32x32x16_bf16 v[56:71], a[28:31], v[20:23], v[56:71]
    ds_read_b128 v[16:19], v2 offset:10240
    s_waitcnt lgkmcnt(6)
    v_mfma_f32_32x32x16_bf16 v[40:55], a[32:35], v[24:27], v[40:55]
    v_mfma_f32_32x32x16_bf16 v[56:71], a[36:39], v[24:27], v[56:71]
    ds_read_b128 v[20:23], v2 offset:11264
    s_waitcnt lgkmcnt(6)
    v_mfma_f32_32x32x16_bf16 v[40:55], a[40:43], v[28:31], v[40:55]
    v_mfma_f32_32x32x16_bf16 v[56:71], a[44:47], v[28:31], v[56:71]
    ds_read_b128 v[24:27], v2 offset:12288
    s_waitcnt lgkmcnt(6)
    v_mfma_f32_32x32x16_bf16 v[40:55], a[48:51], v[32:35], v[40:55]
    v_mfma_f32_32x32x16_bf16 v[56:71], a[52:55], v[32:35], v[56:71]
    ds_read_b128 v[28:31], v2 offset:13312
    s_waitcnt lgkmcnt(6)
    v_mfma_f32_32x32x16_bf16 v[40:55], a[56:59], v[36:39], v[40:55]
    v_mfma_f32_32x32x16_bf16 v[56:71], a[60:63], v[36:39], v[56:71]
    ds_read_b128 v[32:35], v2 offset:14336
    s_waitcnt lgkmcnt(6)
    v_mfma_f32_32x32x16_bf16 v[40:55], a[64:67], v[8:11], v[40:55]
    v_mfma_f32_32x32x16_bf16 v[56:71], a[68:71], v[8:11], v[56:71]
    ds_read_b128 v[36:39], v2 offset:15360
    s_waitcnt lgkmcnt(6)
    v_mfma_f32_32x32x16_bf16 v[40:55], a[72:75], v[12:15], v[40:55]
    v_mfma_f32_32x32x16_bf16 v[56:71], a[76:79], v[12:15], v[56:71]
    ds_read_b128 v[8:11], v2 offset:16384
    s_waitcnt lgkmcnt(6)
    v_mfma_f32_32x32x16_bf16 v[40:55], a[80:83], v[16:19], v[40:55]
    v_mfma_f32_32x32x16_bf16 v[56:71], a[84:87], v[16:19], v[56:71]
    ds_read_b128 v[12:15], v2 offset:17408
    s_waitcnt lgkmcnt(6)
    v_mfma_f32_32x32x16_bf16 v[40:55], a[88:91], v[20:23], v[40:55]
    v_mfma_f32_32x32x16_bf16 v[56:71], a[92:95], v[20:23], v[56:71]
    ds_read_b128 v[16:19], v2 offset:18432
    s_waitcnt lgkmcnt(6)
    v_mfma_f32_32x32x16_bf16 v[40:55], a[96:99], v[24:27], v[40:55]
    v_mfma_f32_32x32x16_bf16 v[56:71], a[100:103], v[24:27], v[56:71]
    ds_read_b128 v[20:23], v2 offset:19456
    s_waitcnt lgkmcnt(6)
    v_mfma_f32_32x32x16_bf16 v[40:55], a[104:107], v[28:31], v[40:55]
    v_mfma_f32_32x32x16_bf16 v[56:71], a[108:111], v[28:31], v[56:71]
    ds_read_b128 v[24:27], v2 offset:20480
    s_waitcnt lgkmcnt(6)
    v_mfma_f32_32x32x16_bf16 v[40:55], a[112:115], v[32:35], v[40:55]
    v_mfma_f32_32x32x16_bf16 v[56:71], a[116:119], v[32:35], v[56:71]
    ds_read_b128 v[28:31], v2 offset:21504
    s_waitcnt lgkmcnt(6)
    v_mfma_f32_32x32x16_bf16 v[40:55], a[120:123], v[36:39], v[40:55]
    v_mfma_f32_32x32x16_bf16 v[56:71], a[124:127], v[36:39], v[56:71]
    ds_read_b128 v[32:35], v2 offset:22528
    s_waitcnt lgkmcnt(6)
    v_mfma_f32_32x32x16_bf16 v[40:55], a[128:131], v[8:11], v[40:55]
    v_mfma_f32_32x32x16_bf16 v[56:71], a[132:135], v[8:11], v[56:71]
    ds_read_b128 v[36:39], v2 offset:23552
    s_waitcnt lgkmcnt(6)
    v_mfma_f32_32x32x16_bf16 v[40:55], a[136:139], v[12:15], v[40:55]
    v_mfma_f32_32x32x16_bf16 v[56:71], a[140:143], v[12:15], v[56:71]
    ds_read_b128 v[8:11], v2 offset:24576
    s_waitcnt lgkmcnt(6)
    v_mfma_f32_32x32x16_bf16 v[40:55], a[144:147], v[16:19], v[40:55]
    v_mfma_f32_32x32x16_bf16 v[56:71], a[148:151], v[16:19], v[56:71]
    ds_read_b128 v[12:15], v2 offset:25600
    s_waitcnt lgkmcnt(6)
    v_mfma_f32_32x32x16_bf16 v[40:55], a[152:155], v[20:23], v[40:55]
    v_mfma_f32_32x32x16_bf16 v[56:71], a[156:159], v[20:23], v[56:71]
    ds_read_b128 v[16:19], v2 offset:26624
    s_waitcnt lgkmcnt(6)
    v_mfma_f32_32x32x16_bf16 v[40:55], a[160:163], v[24:27], v[40:55]
    v_mfma_f32_32x32x16_bf16 v[56:71], a[164:167], v[24:27], v[56:71]
    ds_read_b128 v[20:23], v2 offset:27648
    s_waitcnt lgkmcnt(6)
    v_mfma_f32_32x32x16_bf16 v[40:55], a[168:171], v[28:31], v[40:55]
    v_mfma_f32_32x32x16_bf16 v[56:71], a[172:175], v[28:31], v[56:71]
    ds_read_b128 v[24:27], v2 offset:28672
    s_waitcnt lgkmcnt(6)
    v_mfma_f32_32x32x16_bf16 v[40:55], a[176:179], v[32:35], v[40:55]
    v_mfma_f32_32x32x16_bf16 v[56:71], a[180:183], v[32:35], v[56:71]
    ds_read_b128 v[28:31], v2 offset:29696
    s_waitcnt lgkmcnt(6)
    v_mfma_f32_32x32x16_bf16 v[40:55], a[184:187], v[36:39], v[40:55]
    v_mfma_f32_32x32x16_bf16 v[56:71], a[188:191], v[36:39], v[56:71]
    ds_read_b128 v[32:35], v2 offset:30720
    s_waitcnt lgkmcnt(6)
    v_mfma_f32_32x32x16_bf16 v[40:55], a[192:195], v[8:11], v[40:55]
    v_mfma_f32_32x32x16_bf16 v[56:71], a[196:199], v[8:11], v[56:71]
    ds_read_b128 v[36:39], v2 offset:31744
    s_waitcnt lgkmcnt(6)
    v_mfma_f32_32x32x16_bf16 v[40:55], a[200:203], v[12:15], v[40:55]
    v_mfma_f32_32x32x16_bf16 v[56:71], a[204:207], v[12:15], v[56:71]
    ds_read_b128 v[8:11], v2 offset:32768
    s_waitcnt lgkmcnt(6)
    v_mfma_f32_32x32x16_bf16 v[40:55], a[208:211], v[16:19], v[40:55]
    v_mfma_f32_32x32x16_bf16 v[56:71], a[212:215], v[16:19], v[56:71]
    ds_read_b128 v[12:15], v2 offset:33792
    s_waitcnt lgkmcnt(6)
    v_mfma_f32_32x32x16_bf16 v[40:55], a[216:219], v[20:23], v[40:55]
    v_mfma_f32_32x32x16_bf16 v[56:71], a[220:223], v[20:23], v[56:71]
    ds_read_b128 v[16:19], v2 offset:34816
    s_waitcnt lgkmcnt(6)
    v_mfma_f32_32x32x16_bf16 v[40:55], a[224:227], v[24:27], v[40:55]
    v_mfma_f32_32x32x16_bf16 v[56:71], a[228:231], v[24:27], v[56:71]
    ds_read_b128 v[20:23], v2 offset:35840
    s_waitcnt lgkmcnt(6)
    v_mfma_f32_32x32x16_bf16 v[40:55], a[232:235], v[28:31], v[40:55]
    v_mfma_f32_32x32x16_bf16 v[56:71], a[236:239], v[28:31], v[56:71]
    ds_read_b128 v[24:27], v2 offset:36864
    s_waitcnt lgkmcnt(6)
    buffer_load_dwordx4 v[124:127], v1, s[8:11], s57 offen sc1
    v_mfma_f32_32x32x16_bf16 v[40:55], a[240:243], v[32:35], v[40:55]
    v_mfma_f32_32x32x16_bf16 v[56:71], a[244:247], v[32:35], v[56:71]
    ds_read_b128 v[28:31], v2 offset:37888
    s_waitcnt lgkmcnt(6)
    v_mfma_f32_32x32x16_bf16 v[40:55], a[248:251], v[36:39], v[40:55]
    v_mfma_f32_32x32x16_bf16 v[56:71], a[252:255], v[36:39], v[56:71]
    ds_read_b128 v[32:35], v2 offset:38912
    s_waitcnt lgkmcnt(6)
    v_mfma_f32_32x32x16_bf16 v[40:55], v[192:195], v[8:11], v[40:55]
    v_mfma_f32_32x32x16_bf16 v[56:71], v[196:199], v[8:11], v[56:71]
    ds_read_b128 v[36:39], v2 offset:39936
    s_waitcnt lgkmcnt(6)
    v_mfma_f32_32x32x16_bf16 v[40:55], v[200:203], v[12:15], v[40:55]
    v_mfma_f32_32x32x16_bf16 v[56:71], v[204:207], v[12:15], v[56:71]
    s_waitcnt lgkmcnt(5)
    v_mfma_f32_32x32x16_bf16 v[40:55], v[208:211], v[16:19], v[40:55]
    v_mfma_f32_32x32x16_bf16 v[56:71], v[212:215], v[16:19], v[56:71]
    s_waitcnt lgkmcnt(4)
    v_mfma_f32_32x32x16_bf16 v[40:55], v[216:219], v[20:23], v[40:55]
    v_mfma_f32_32x32x16_bf16 v[56:71], v[220:223], v[20:23], v[56:71]
    s_waitcnt lgkmcnt(3)
    v_mfma_f32_32x32x16_bf16 v[40:55], v[224:227], v[24:27], v[40:55]
    v_mfma_f32_32x32x16_bf16 v[56:71], v[228:231], v[24:27], v[56:71]
    s_waitcnt lgkmcnt(2)
    v_mfma_f32_32x32x16_bf16 v[40:55], v[232:235], v[28:31], v[40:55]
    v_mfma_f32_32x32x16_bf16 v[56:71], v[236:239], v[28:31], v[56:71]
    s_waitcnt lgkmcnt(1)
    v_mfma_f32_32x32x16_bf16 v[40:55], v[240:243], v[32:35], v[40:55]
    v_mfma_f32_32x32x16_bf16 v[56:71], v[244:247], v[32:35], v[56:71]
    s_waitcnt lgkmcnt(0)
    v_mfma_f32_32x32x16_bf16 v[40:55], v[248:251], v[36:39], v[40:55]
    v_mfma_f32_32x32x16_bf16 v[56:71], v[252:255], v[36:39], v[56:71]
    s_add_u32 s14, s14, 1
    s_nop 7
    s_nop 7
    v_cvt_pk_bf16_f32 v104, v40, v41
    v_cvt_pk_bf16_f32 v105, v42, v43
    v_cvt_pk_bf16_f32 v106, v44, v45
    v_cvt_pk_bf16_f32 v107, v46, v47
    s_nop 1
    v_permlane32_swap_b32 v104, v106
    v_permlane32_swap_b32 v105, v107
    buffer_store_dwordx4 v[104:107], v3, s[8:11], s17 offen offset:0 sc1
    v_cvt_pk_bf16_f32 v108, v48, v49
    v_cvt_pk_bf16_f32 v109, v50, v51
    v_cvt_pk_bf16_f32 v110, v52, v53
    v_cvt_pk_bf16_f32 v111, v54, v55
    s_nop 1
    v_permlane32_swap_b32 v108, v110
    v_permlane32_swap_b32 v109, v111
    buffer_store_dwordx4 v[108:111], v3, s[8:11], s17 offen offset:1024 sc1
    v_cvt_pk_bf16_f32 v112, v56, v57
    v_cvt_pk_bf16_f32 v113, v58, v59
    v_cvt_pk_bf16_f32 v114, v60, v61
    v_cvt_pk_bf16_f32 v115, v62, v63
    s_nop 1
    v_permlane32_swap_b32 v112, v114
    v_permlane32_swap_b32 v113, v115
    buffer_store_dwordx4 v[112:115], v3, s[8:11], s18 offen offset:0 sc1
    v_cvt_pk_bf16_f32 v116, v64, v65
    v_cvt_pk_bf16_f32 v117, v66, v67
    v_cvt_pk_bf16_f32 v118, v68, v69
    v_cvt_pk_bf16_f32 v119, v70, v71
    s_nop 1
    v_permlane32_swap_b32 v116, v118
    v_permlane32_swap_b32 v117, v119
    buffer_store_dwordx4 v[116:119], v3, s[8:11], s18 offen offset:1024 sc1
    s_add_u32 s17, s17, s20
    s_add_u32 s18, s18, s20
    s_waitcnt vmcnt(0)
    s_barrier
    s_cmp_lg_u32 s13, 0
    s_cbranch_scc1 layerb1_kernel_gk_fl2
    s_mov_b64 exec, 1
    s_lshl_b32 s26, s12, 7
    v_mov_b32 v7, s26
    v_mov_b32 v120, s14
    buffer_store_dword v120, v7, s[8:11], s48 offen sc1
    s_mov_b64 exec, -1
layerb1_kernel_gk_fl2:
layerb1_kernel_gk_spoll:
    v_min_u32 v124, v124, v125
    v_min_u32 v126, v126, v127
    v_min_u32 v124, v124, v126
    v_cmp_eq_u32 vcc, 0, v124
    s_nop 1
    s_ff1_i32_b64 s56, vcc
    s_min_u32 s56, s56, 64
    s_cmp_gt_u32 s56, s14
    s_cbranch_scc1 layerb1_kernel_gk_sok
    s_sub_u32 s58, s58, 1
    s_cbranch_scc1 layerb1_kernel_bail
    buffer_load_dwordx4 v[124:127], v1, s[8:11], s57 offen sc1
    s_waitcnt vmcnt(0)
    s_branch layerb1_kernel_gk_spoll
layerb1_kernel_gk_sok:
    s_min_u32 s24, s14, 63
    s_mul_i32 s24, s24, 40960
    s_add_u32 s24, s24, s19
    s_mul_i32 s25, s13, 10240
    s_add_u32 s25, s25, s22
    s_mov_b32 m0, s25
    s_nop 0
    buffer_load_dwordx4 v1, s[8:11], s24 offen offset:0 sc1 lds
    buffer_load_dwordx4 v1, s[8:11], s24 offen offset:1024 sc1 lds
    buffer_load_dwordx4 v1, s[8:11], s24 offen offset:2048 sc1 lds
    buffer_load_dwordx4 v1, s[8:11], s24 offen offset:3072 sc1 lds
    s_add_u32 s24, s24, 4096
    s_add_u32 s25, s25, 4096
    s_mov_b32 m0, s25
    s_nop 0
    buffer_load_dwordx4 v1, s[8:11], s24 offen offset:0 sc1 lds
    buffer_load_dwordx4 v1, s[8:11], s24 offen offset:1024 sc1 lds
    buffer_load_dwordx4 v1, s[8:11], s24 offen offset:2048 sc1 lds
    buffer_load_dwordx4 v1, s[8:11], s24 offen offset:3072 sc1 lds
    s_add_u32 s24, s24, 4096
    s_add_u32 s25, s25, 4096
    s_mov_b32 m0, s25
    s_nop 0
    buffer_load_dwordx4 v1, s[8:11], s24 offen offset:0 sc1 lds
    buffer_load_dwordx4 v1, s[8:11], s24 offen offset:1024 sc1 lds
    s_mov_b32 s16, s22
    s_add_u32 s22, s22, 40960
    s_cmp_eq_u32 s22, 122880
    s_cselect_b32 s22, 0, s22
    v_add_u32 v2, s16, v1
    s_waitcnt vmcnt(0)
    s_barrier
    ds_read_b128 v[8:11], v2 offset:0
    ds_read_b128 v[12:15], v2 offset:1024
    ds_read_b128 v[16:19], v2 offset:2048
    ds_read_b128 v[20:23], v2 offset:3072
    ds_read_b128 v[24:27], v2 offset:4096
    ds_read_b128 v[28:31], v2 offset:5120
    s_cmp_lt_u32 s14, 3
    s_cbranch_scc1 layerb1_kernel_gk_solo
    ds_read_b128 v[32:35], v2 offset:6144
    s_waitcnt lgkmcnt(6)
    v_mfma_f32_32x32x16_bf16 v[72:87], a[0:3], v[8:11], 0
    v_mfma_f32_32x32x16_bf16 v[88:103], a[4:7], v[8:11], 0
    ds_read_b128 v[36:39], v2 offset:7168
    s_waitcnt lgkmcnt(6)
    v_mfma_f32_32x32x16_bf16 v[72:87], a[8:11], v[12:15], v[72:87]
    v_mfma_f32_32x32x16_bf16 v[88:103], a[12:15], v[12:15], v[88:103]
    ds_read_b128 v[8:11], v2 offset:8192
    s_waitcnt lgkmcnt(6)
    v_mfma_f32_32x32x16_bf16 v[72:87], a[16:19], v[16:19], v[72:87]
    v_mfma_f32_32x32x16_bf16 v[88:103], a[20:23], v[16:19], v[88:103]
    s_add_u32 s23, s14, 1
    s_cmp_lg_u32 s13, 0
    s_cbranch_scc1 layerb1_kernel_gk_lw3
    s_min_u32 s28, s23, 63
    s_cmp_gt_u32 s56, s28
    s_cbranch_scc1 layerb1_kernel_gk_lw3
layerb1_kernel_gk_lp3:
    buffer_load_dwordx4 v[124:127], v1, s[8:11], s57 offen sc1
    s_waitcnt vmcnt(0)
    v_min_u32 v124, v124, v125
    v_min_u32 v126, v126, v127
    v_min_u32 v124, v124, v126
    v_cmp_eq_u32 vcc, 0, v124
    s_nop 1
    s_ff1_i32_b64 s56, vcc
    s_min_u32 s56, s56, 64
    s_sub_u32 s58, s58, 1
    s_cbranch_scc1 layerb1_kernel_bail
    s_cmp_gt_u32 s56, s28
    s_cbranch_scc0 layerb1_kernel_gk_lp3
layerb1_kernel_gk_lw3:
    s_barrier
    s_min_u32 s24, s23, 63
    s_mul_i32 s24, s24, 40960
    s_add_u32 s24, s24, s19
    s_mul_i32 s25, s13, 10240
    s_add_u32 s25, s25, s22
    s_add_u32 s22, s22, 40960
    s_cmp_eq_u32 s22, 122880
    s_cselect_b32 s22, 0, s22
    ds_read_b128 v[12:15], v2 offset:9216
    s_waitcnt lgkmcnt(6)
    v_mfma_f32_32x32x16_bf16 v[72:87], a[24:27], v[20:23], v[72:87]
    s_mov_b32 m0, s25
    s_nop 0
    buffer_load_dwordx4 v1, s[8:11], s24 offen offset:0 sc1 lds
    v_mfma_f32_32x32x16_bf16 v[88:103], a[28:31], v[20:23], v[88:103]
    ds_read_b128 v[16:19], v2 offset:10240
    s_waitcnt lgkmcnt(6)
    v_mfma_f32_32x32x16_bf16 v[72:87], a[32:35], v[24:27], v[72:87]
    buffer_load_dwordx4 v1, s[8:11], s24 offen offset:1024 sc1 lds
    v_mfma_f32_32x32x16_bf16 v[88:103], a[36:39], v[24:27], v[88:103]
    ds_read_b128 v[20:23], v2 offset:11264
    s_waitcnt lgkmcnt(6)
    v_mfma_f32_32x32x16_bf16 v[72:87], a[40:43], v[28:31], v[72:87]
    buffer_load_dwordx4 v1, s[8:11], s24 offen offset:2048 sc1 lds
    v_mfma_f32_32x32x16_bf16 v[88:103], a[44:47], v[28:31], v[88:103]
    ds_read_b128 v[24:27], v2 offset:12288
    s_waitcnt lgkmcnt(6)
    v_mfma_f32_32x32x16_bf16 v[72:87], a[48:51], v[32:35], v[72:87]
    buffer_load_dwordx4 v1, s[8:11], s24 offen offset:3072 sc1 lds
    v_mfma_f32_32x32x16_bf16 v[88:103], a[52:55], v[32:35], v[88:103]
    ds_read_b128 v[28:31], v2 offset:13312
    s_waitcnt lgkmcnt(6)
    v_mfma_f32_32x32x16_bf16 v[72:87], a[56:59], v[36:39], v[72:87]
    s_add_u32 s24, s24, 4096
    s_add_u32 s25, s25, 4096
    s_mov_b32 m0, s25
    s_nop 0
    buffer_load_dwordx4 v1, s[8:11], s24 offen offset:0 sc1 lds
    v_mfma_f32_32x32x16_bf16 v[88:103], a[60:63], v[36:39], v[88:103]
    ds_read_b128 v[32:35], v2 offset:14336
    s_waitcnt lgkmcnt(6)
    v_mfma_f32_32x32x16_bf16 v[72:87], a[64:67], v[8:11], v[72:87]
    buffer_load_dwordx4 v1, s[8:11], s24 offen offset:1024 sc1 lds
    v_mfma_f32_32x32x16_bf16 v[88:103], a[68:71], v[8:11], v[88:103]
    ds_read_b128 v[36:39], v2 offset:15360
    s_waitcnt lgkmcnt(6)
    v_mfma_f32_32x32x16_bf16 v[72:87], a[72:75], v[12:15], v[72:87]
    buffer_load_dwordx4 v1, s[8:11], s24 offen offset:2048 sc1 lds
    v_mfma_f32_32x32x16_bf16 v[88:103], a[76:79], v[12:15], v[88:103]
    ds_read_b128 v[8:11], v2 offset:16384
    s_waitcnt lgkmcnt(6)
    v_mfma_f32_32x32x16_bf16 v[72:87], a[80:83], v[16:19], v[72:87]
    buffer_load_dwordx4 v1, s[8:11], s24 offen offset:3072 sc1 lds
    v_mfma_f32_32x32x16_bf16 v[88:103], a[84:87], v[16:19], v[88:103]
    ds_read_b128 v[12:15], v2 offset:17408
    s_waitcnt lgkmcnt(6)
    v_mfma_f32_32x32x16_bf16 v[72:87], a[88:91], v[20:23], v[72:87]
    s_add_u32 s24, s24, 4096
    s_add_u32 s25, s25, 4096
    s_mov_b32 m0, s25
    s_nop 0
    buffer_load_dwordx4 v1, s[8:11], s24 offen offset:0 sc1 lds
    v_mfma_f32_32x32x16_bf16 v[88:103], a[92:95], v[20:23], v[88:103]
    ds_read_b128 v[16:19], v2 offset:18432
    s_waitcnt lgkmcnt(6)
    v_mfma_f32_32x32x16_bf16 v[72:87], a[96:99], v[24:27], v[72:87]
    buffer_load_dwordx4 v1, s[8:11], s24 offen offset:1024 sc1 lds
    v_mfma_f32_32x32x16_bf16 v[88:103], a[100:103], v[24:27], v[88:103]
    ds_read_b128 v[20:23], v2 offset:19456
    s_waitcnt lgkmcnt(6)
    v_mfma_f32_32x32x16_bf16 v[72:87], a[104:107], v[28:31], v[72:87]
    v_mfma_f32_32x32x16_bf16 v[88:103], a[108:111], v[28:31], v[88:103]
    ds_read_b128 v[24:27], v2 offset:20480
    s_waitcnt lgkmcnt(6)
    v_mfma_f32_32x32x16_bf16 v[72:87], a[112:115], v[32:35], v[72:87]
    v_mfma_f32_32x32x16_bf16 v[88:103], a[116:119], v[32:35], v[88:103]
    ds_read_b128 v[28:31], v2 offset:21504
    s_waitcnt lgkmcnt(6)
    v_mfma_f32_32x32x16_bf16 v[72:87], a[120:123], v[36:39], v[72:87]
    v_mfma_f32_32x32x16_bf16 v[88:103], a[124:127], v[36:39], v[88:103]
    ds_read_b128 v[32:35], v2 offset:22528
    s_waitcnt lgkmcnt(6)
    v_mfma_f32_32x32x16_bf16 v[72:87], a[128:131], v[8:11], v[72:87]
    v_mfma_f32_32x32x16_bf16 v[88:103], a[132:135], v[8:11], v[88:103]
    ds_read_b128 v[36:39], v2 offset:23552
    s_waitcnt lgkmcnt(6)
    v_mfma_f32_32x32x16_bf16 v[72:87], a[136:139], v[12:15], v[72:87]
    v_mfma_f32_32x32x16_bf16 v[88:103], a[140:143], v[12:15], v[88:103]
    ds_read_b128 v[8:11], v2 offset:24576
    s_waitcnt lgkmcnt(6)
    v_mfma_f32_32x32x16_bf16 v[72:87], a[144:147], v[16:19], v[72:87]
    v_mfma_f32_32x32x16_bf16 v[88:103], a[148:151], v[16:19], v[88:103]
    ds_read_b128 v[12:15], v2 offset:25600
    s_waitcnt lgkmcnt(6)
    v_mfma_f32_32x32x16_bf16 v[72:87], a[152:155], v[20:23], v[72:87]
    v_mfma_f32_32x32x16_bf16 v[88:103], a[156:159], v[20:23], v[88:103]
    ds_read_b128 v[16:19], v2 offset:26624
    s_waitcnt lgkmcnt(6)
    v_mfma_f32_32x32x16_bf16 v[72:87], a[160:163], v[24:27], v[72:87]
    v_mfma_f32_32x32x16_bf16 v[88:103], a[164:167], v[24:27], v[88:103]
    ds_read_b128 v[20:23], v2 offset:27648
    s_waitcnt lgkmcnt(6)
    v_mfma_f32_32x32x16_bf16 v[72:87], a[168:171], v[28:31], v[72:87]
    v_mfma_f32_32x32x16_bf16 v[88:103], a[172:175], v[28:31], v[88:103]
    ds_read_b128 v[24:27], v2 offset:28672
    s_waitcnt lgkmcnt(6)
    v_mfma_f32_32x32x16_bf16 v[72:87], a[176:179], v[32:35], v[72:87]
    v_mfma_f32_32x32x16_bf16 v[88:103], a[180:183], v[32:35], v[88:103]
    ds_read_b128 v[28:31], v2 offset:29696
    s_waitcnt lgkmcnt(6)
    v_mfma_f32_32x32x16_bf16 v[72:87], a[184:187], v[36:39], v[72:87]
    v_mfma_f32_32x32x16_bf16 v[88:103], a[188:191], v[36:39], v[88:103]
    ds_read_b128 v[32:35], v2 offset:30720
    s_waitcnt lgkmcnt(6)
    v_mfma_f32_32x32x16_bf16 v[72:87], a[192:195], v[8:11], v[72:87]
    v_mfma_f32_32x32x16_bf16 v[88:103], a[196:199], v[8:11], v[88:103]
    ds_read_b128 v[36:39], v2 offset:31744
    s_waitcnt lgkmcnt(6)
    v_mfma_f32_32x32x16_bf16 v[72:87], a[200:203], v[12:15], v[72:87]
    v_mfma_f32_32x32x16_bf16 v[88:103], a[204:207], v[12:15], v[88:103]
    ds_read_b128 v[8:11], v2 offset:32768
    s_waitcnt lgkmcnt(6)
    v_mfma_f32_32x32x16_bf16 v[72:87], a[208:211], v[16:19], v[72:87]
    v_mfma_f32_32x32x16_bf16 v[88:103], a[212:215], v[16:19], v[88:103]
    ds_read_b128 v[12:15], v2 offset:33792
    s_waitcnt lgkmcnt(6)
    v_mfma_f32_32x32x16_bf16 v[72:87], a[216:219], v[20:23], v[72:87]
    v_mfma_f32_32x32x16_bf16 v[88:103], a[220:223], v[20:23], v[88:103]
    ds_read_b128 v[16:19], v2 offset:34816
    s_waitcnt lgkmcnt(6)
    v_mfma_f32_32x32x16_bf16 v[72:87], a[224:227], v[24:27], v[72:87]
    v_mfma_f32_32x32x16_bf16 v[88:103], a[228:231], v[24:27], v[88:103]
    s_add_u32 s23, s14, 2
    s_cmp_lg_u32 s13, 0
    s_cbranch_scc1 layerb1_kernel_gk_lw4
    s_min_u32 s28, s23, 63
    s_cmp_gt_u32 s56, s28
    s_cbranch_scc1 layerb1_kernel_gk_lw4
layerb1_kernel_gk_lp4:
    buffer_load_dwordx4 v[124:127], v1, s[8:11], s57 offen sc1
    s_waitcnt vmcnt(0)
    v_min_u32 v124, v124, v125
    v_min_u32 v126, v126, v127
    v_min_u32 v124, v124, v126
    v_cmp_eq_u32 vcc, 0, v124
    s_nop 1
    s_ff1_i32_b64 s56, vcc
    s_min_u32 s56, s56, 64
    s_sub_u32 s58, s58, 1
    s_cbranch_scc1 layerb1_kernel_bail
    s_cmp_gt_u32 s56, s28
    s_cbranch_scc0 layerb1_kernel_gk_lp4
layerb1_kernel_gk_lw4:
    s_waitcnt vmcnt(0)
    s_barrier
    s_add_u32 s21, s16, 40960
    s_cmp_eq_u32 s21, 122880
    s_cselect_b32 s21, 0, s21
    s_add_u32 s23, s14, 2
    s_min_u32 s24, s23, 63
    s_mul_i32 s24, s24, 40960
    s_add_u32 s24, s24, s19
    s_mul_i32 s25, s13, 10240
    s_add_u32 s25, s25, s22
    s_add_u32 s22, s22, 40960
    s_cmp_eq_u32 s22, 122880
    s_cselect_b32 s22, 0, s22
    ds_read_b128 v[20:23], v2 offset:35840
    s_waitcnt lgkmcnt(6)
    v_mfma_f32_32x32x16_bf16 v[72:87], a[232:235], v[28:31], v[72:87]
    s_mov_b32 m0, s25
    s_nop 0
    buffer_load_dwordx4 v1, s[8:11], s24 offen offset:0 sc1 lds
    v_mfma_f32_32x32x16_bf16 v[88:103], a[236:239], v[28:31], v[88:103]
    ds_read_b128 v[24:27], v2 offset:36864
    s_waitcnt lgkmcnt(6)
    v_mfma_f32_32x32x16_bf16 v[72:87], a[240:243], v[32:35], v[72:87]
    buffer_load_dwordx4 v1, s[8:11], s24 offen offset:1024 sc1 lds
    v_mfma_f32_32x32x16_bf16 v[88:103], a[244:247], v[32:35], v[88:103]
    ds_read_b128 v[28:31], v2 offset:37888
    s_waitcnt lgkmcnt(6)
    v_mfma_f32_32x32x16_bf16 v[72:87], a[248:251], v[36:39], v[72:87]
    buffer_load_dwordx4 v1, s[8:11], s24 offen offset:2048 sc1 lds
    v_mfma_f32_32x32x16_bf16 v[88:103], a[252:255], v[36:39], v[88:103]
    ds_read_b128 v[32:35], v2 offset:38912
    s_waitcnt lgkmcnt(6)
    v_mfma_f32_32x32x16_bf16 v[72:87], v[192:195], v[8:11], v[72:87]
    buffer_load_dwordx4 v1, s[8:11], s24 offen offset:3072 sc1 lds
    v_mfma_f32_32x32x16_bf16 v[88:103], v[196:199], v[8:11], v[88:103]
    ds_read_b128 v[36:39], v2 offset:39936
    s_waitcnt lgkmcnt(6)
    v_mfma_f32_32x32x16_bf16 v[72:87], v[200:203], v[12:15], v[72:87]
    s_add_u32 s24, s24, 4096
    s_add_u32 s25, s25, 4096
    s_mov_b32 m0, s25
    s_nop 0
    buffer_load_dwordx4 v1, s[8:11], s24 offen offset:0 sc1 lds
    v_mfma_f32_32x32x16_bf16 v[88:103], v[204:207], v[12:15], v[88:103]
    v_add_u32 v6, s21, v1
    ds_read_b128 v[8:11], v6 offset:0
    s_waitcnt lgkmcnt(6)
    v_mfma_f32_32x32x16_bf16 v[72:87], v[208:211], v[16:19], v[72:87]
    buffer_load_dwordx4 v1, s[8:11], s24 offen offset:1024 sc1 lds
    v_mfma_f32_32x32x16_bf16 v[88:103], v[212:215], v[16:19], v[88:103]
    ds_read_b128 v[12:15], v6 offset:1024
    s_waitcnt lgkmcnt(6)
    v_mfma_f32_32x32x16_bf16 v[72:87], v[216:219], v[20:23], v[72:87]
    buffer_load_dwordx4 v1, s[8:11], s24 offen offset:2048 sc1 lds
    v_mfma_f32_32x32x16_bf16 v[88:103], v[220:223], v[20:23], v[88:103]
    ds_read_b128 v[16:19], v6 offset:2048
    s_waitcnt lgkmcnt(6)
    v_mfma_f32_32x32x16_bf16 v[72:87], v[224:227], v[24:27], v[72:87]
    buffer_load_dwordx4 v1, s[8:11], s24 offen offset:3072 sc1 lds
    v_mfma_f32_32x32x16_bf16 v[88:103], v[228:231], v[24:27], v[88:103]
    ds_read_b128 v[20:23], v6 offset:3072
    s_waitcnt lgkmcnt(6)
    v_mfma_f32_32x32x16_bf16 v[72:87], v[232:235], v[28:31], v[72:87]
    s_add_u32 s24, s24, 4096
    s_add_u32 s25, s25, 4096
    s_mov_b32 m0, s25
    s_nop 0
    buffer_load_dwordx4 v1, s[8:11], s24 offen offset:0 sc1 lds
    v_mfma_f32_32x32x16_bf16 v[88:103], v[236:239], v[28:31], v[88:103]
    ds_read_b128 v[24:27], v6 offset:4096
    s_waitcnt lgkmcnt(6)
    v_mfma_f32_32x32x16_bf16 v[72:87], v[240:243], v[32:35], v[72:87]
    buffer_load_dwordx4 v1, s[8:11], s24 offen offset:1024 sc1 lds
    v_mfma_f32_32x32x16_bf16 v[88:103], v[244:247], v[32:35], v[88:103]
    ds_read_b128 v[28:31], v6 offset:5120
    s_waitcnt lgkmcnt(6)
    v_mfma_f32_32x32x16_bf16 v[72:87], v[248:251], v[36:39], v[72:87]
    v_mfma_f32_32x32x16_bf16 v[88:103], v[252:255], v[36:39], v[88:103]
    v_mov_b32 v2, v6
    s_mov_b32 s16, s21
    s_add_u32 s14, s14, 1
layerb1_kernel_gk_loop:
    ds_read_b128 v[32:35], v2 offset:6144
    s_waitcnt lgkmcnt(6)
    v_mfma_f32_32x32x16_bf16 v[40:55], a[0:3], v[8:11], 0
    v_mfma_f32_32x32x16_bf16 v[56:71], a[4:7], v[8:11], 0
    ds_read_b128 v[36:39], v2 offset:7168
    s_waitcnt lgkmcnt(6)
    v_mfma_f32_32x32x16_bf16 v[40:55], a[8:11], v[12:15], v[40:55]
    v_mfma_f32_32x32x16_bf16 v[56:71], a[12:15], v[12:15], v[56:71]
    ds_read_b128 v[8:11], v2 offset:8192
    s_waitcnt lgkmcnt(6)
    v_mfma_f32_32x32x16_bf16 v[40:55], a[16:19], v[16:19], v[40:55]
    v_cvt_pk_bf16_f32 v104, v72, v73
    v_mfma_f32_32x32x16_bf16 v[56:71], a[20:23], v[16:19], v[56:71]
    v_cvt_pk_bf16_f32 v105, v74, v75
    ds_read_b128 v[12:15], v2 offset:9216
    s_waitcnt lgkmcnt(6)
    v_mfma_f32_32x32x16_bf16 v[40:55], a[24:27], v[20:23], v[40:55]
    v_cvt_pk_bf16_f32 v106, v76, v77
    v_mfma_f32_32x32x16_bf16 v[56:71], a[28:31], v[20:23], v[56:71]
    v_cvt_pk_bf16_f32 v107, v78, v79
    ds_read_b128 v[16:19], v2 offset:10240
    s_waitcnt lgkmcnt(6)
    v_mfma_f32_32x32x16_bf16 v[40:55], a[32:35], v[24:27], v[40:55]
    s_nop 1
    v_mfma_f32_32x32x16_bf16 v[56:71], a[36:39], v[24:27], v[56:71]
    v_permlane32_swap_b32 v104, v106
    ds_read_b128 v[20:23], v2 offset:11264
    s_waitcnt lgkmcnt(6)
    v_mfma_f32_32x32x16_bf16 v[40:55], a[40:43], v[28:31], v[40:55]
    v_permlane32_swap_b32 v105, v107
    v_mfma_f32_32x32x16_bf16 v[56:71], a[44:47], v[28:31], v[56:71]
    buffer_store_dwordx4 v[104:107], v3, s[8:11], s17 offen offset:0 sc1
    ds_read_b128 v[24:27], v2 offset:12288
    s_waitcnt lgkmcnt(6)
    v_mfma_f32_32x32x16_bf16 v[40:55], a[48:51], v[32:35], v[40:55]
    v_cvt_pk_bf16_f32 v108, v80, v81
    v_mfma_f32_32x32x16_bf16 v[56:71], a[52:55], v[32:35], v[56:71]
    v_cvt_pk_bf16_f32 v109, v82, v83
    ds_read_b128 v[28:31], v2 offset:13312
    s_waitcnt lgkmcnt(6)
    v_mfma_f32_32x32x16_bf16 v[40:55], a[56:59], v[36:39], v[40:55]
    v_cvt_pk_bf16_f32 v110, v84, v85
    v_mfma_f32_32x32x16_bf16 v[56:71], a[60:63], v[36:39], v[56:71]
    v_cvt_pk_bf16_f32 v111, v86, v87
    ds_read_b128 v[32:35], v2 offset:14336
    s_waitcnt lgkmcnt(6)
    v_mfma_f32_32x32x16_bf16 v[40:55], a[64:67], v[8:11], v[40:55]
    s_nop 1
    v_mfma_f32_32x32x16_bf16 v[56:71], a[68:71], v[8:11], v[56:71]
    v_permlane32_swap_b32 v108, v110
    ds_read_b128 v[36:39], v2 offset:15360
    s_waitcnt lgkmcnt(6)
    v_mfma_f32_32x32x16_bf16 v[40:55], a[72:75], v[12:15], v[40:55]
    v_permlane32_swap_b32 v109, v111
    v_mfma_f32_32x32x16_bf16 v[56:71], a[76:79], v[12:15], v[56:71]
    buffer_store_dwordx4 v[108:111], v3, s[8:11], s17 offen offset:1024 sc1
    ds_read_b128 v[8:11], v2 offset:16384
    s_waitcnt lgkmcnt(6)
    v_mfma_f32_32x32x16_bf16 v[40:55], a[80:83], v[16:19], v[40:55]
    v_cvt_pk_bf16_f32 v112, v88, v89
    v_mfma_f32_32x32x16_bf16 v[56:71], a[84:87], v[16:19], v[56:71]
    v_cvt_pk_bf16_f32 v113, v90, v91
    ds_read_b128 v[12:15], v2 offset:17408
    s_waitcnt lgkmcnt(6)
    v_mfma_f32_32x32x16_bf16 v[40:55], a[88:91], v[20:23], v[40:55]
    v_cvt_pk_bf16_f32 v114, v92, v93
    v_mfma_f32_32x32x16_bf16 v[56:71], a[92:95], v[20:23], v[56:71]
    v_cvt_pk_bf16_f32 v115, v94, v95
    ds_read_b128 v[16:19], v2 offset:18432
    s_waitcnt lgkmcnt(6)
    v_mfma_f32_32x32x16_bf16 v[40:55], a[96:99], v[24:27], v[40:55]
    s_nop 1
    v_mfma_f32_32x32x16_bf16 v[56:71], a[100:103], v[24:27], v[56:71]
    v_permlane32_swap_b32 v112, v114
    ds_read_b128 v[20:23], v2 offset:19456
    s_waitcnt lgkmcnt(6)
    v_mfma_f32_32x32x16_bf16 v[40:55], a[104:107], v[28:31], v[40:55]
    v_permlane32_swap_b32 v113, v115
    v_mfma_f32_32x32x16_bf16 v[56:71], a[108:111], v[28:31], v[56:71]
    buffer_store_dwordx4 v[112:115], v3, s[8:11], s18 offen offset:0 sc1
    ds_read_b128 v[24:27], v2 offset:20480
    s_waitcnt lgkmcnt(6)
    v_mfma_f32_32x32x16_bf16 v[40:55], a[112:115], v[32:35], v[40:55]
    v_cvt_pk_bf16_f32 v116, v96, v97
    v_mfma_f32_32x32x16_bf16 v[56:71], a[116:119], v[32:35], v[56:71]
    v_cvt_pk_bf16_f32 v117, v98, v99
    ds_read_b128 v[28:31], v2 offset:21504
    s_waitcnt lgkmcnt(6)
    v_mfma_f32_32x32x16_bf16 v[40:55], a[120:123], v[36:39], v[40:55]
    v_cvt_pk_bf16_f32 v118, v100, v101
    v_mfma_f32_32x32x16_bf16 v[56:71], a[124:127], v[36:39], v[56:71]
    v_cvt_pk_bf16_f32 v119, v102, v103
    ds_read_b128 v[32:35], v2 offset:22528
    s_waitcnt lgkmcnt(6)
    v_mfma_f32_32x32x16_bf16 v[40:55], a[128:131], v[8:11], v[40:55]
    s_nop 1
    v_mfma_f32_32x32x16_bf16 v[56:71], a[132:135], v[8:11], v[56:71]
    v_permlane32_swap_b32 v116, v118
    ds_read_b128 v[36:39], v2 offset:23552
    s_waitcnt lgkmcnt(6)
    v_mfma_f32_32x32x16_bf16 v[40:55], a[136:139], v[12:15], v[40:55]
    v_permlane32_swap_b32 v117, v119
    v_mfma_f32_32x32x16_bf16 v[56:71], a[140:143], v[12:15], v[56:71]
    buffer_store_dwordx4 v[116:119], v3, s[8:11], s18 offen offset:1024 sc1
    ds_read_b128 v[8:11], v2 offset:24576
    s_waitcnt lgkmcnt(6)
    v_mfma_f32_32x32x16_bf16 v[40:55], a[144:147], v[16:19], v[40:55]
    s_add_u32 s17, s17, s20
    v_mfma_f32_32x32x16_bf16 v[56:71], a[148:151], v[16:19], v[56:71]
    s_add_u32 s18, s18, s20
    ds_read_b128 v[12:15], v2 offset:25600
    s_waitcnt lgkmcnt(6)
    v_mfma_f32_32x32x16_bf16 v[40:55], a[152:155], v[20:23], v[40:55]
    v_mfma_f32_32x32x16_bf16 v[56:71], a[156:159], v[20:23], v[56:71]
    ds_read_b128 v[16:19], v2 offset:26624
    s_waitcnt lgkmcnt(6)
    v_mfma_f32_32x32x16_bf16 v[40:55], a[160:163], v[24:27], v[40:55]
    v_mfma_f32_32x32x16_bf16 v[56:71], a[164:167], v[24:27], v[56:71]
    ds_read_b128 v[20:23], v2 offset:27648
    s_waitcnt lgkmcnt(6)
    v_mfma_f32_32x32x16_bf16 v[40:55], a[168:171], v[28:31], v[40:55]
    v_mfma_f32_32x32x16_bf16 v[56:71], a[172:175], v[28:31], v[56:71]
    ds_read_b128 v[24:27], v2 offset:28672
    s_waitcnt lgkmcnt(6)
    v_mfma_f32_32x32x16_bf16 v[40:55], a[176:179], v[32:35], v[40:55]
    v_mfma_f32_32x32x16_bf16 v[56:71], a[180:183], v[32:35], v[56:71]
    ds_read_b128 v[28:31], v2 offset:29696
    s_waitcnt lgkmcnt(6)
    v_mfma_f32_32x32x16_bf16 v[40:55], a[184:187], v[36:39], v[40:55]
    v_mfma_f32_32x32x16_bf16 v[56:71], a[188:191], v[36:39], v[56:71]
    ds_read_b128 v[32:35], v2 offset:30720
    s_waitcnt lgkmcnt(6)
    v_mfma_f32_32x32x16_bf16 v[40:55], a[192:195], v[8:11], v[40:55]
    v_mfma_f32_32x32x16_bf16 v[56:71], a[196:199], v[8:11], v[56:71]
    ds_read_b128 v[36:39], v2 offset:31744
    s_waitcnt lgkmcnt(6)
    v_mfma_f32_32x32x16_bf16 v[40:55], a[200:203], v[12:15], v[40:55]
    v_mfma_f32_32x32x16_bf16 v[56:71], a[204:207], v[12:15], v[56:71]
    ds_read_b128 v[8:11], v2 offset:32768
    s_waitcnt lgkmcnt(6)
    v_mfma_f32_32x32x16_bf16 v[40:55], a[208:211], v[16:19], v[40:55]
    v_mfma_f32_32x32x16_bf16 v[56:71], a[212:215], v[16:19], v[56:71]
    ds_read_b128 v[12:15], v2 offset:33792
    s_waitcnt lgkmcnt(6)
    v_mfma_f32_32x32x16_bf16 v[40:55], a[216:219], v[20:23], v[40:55]
    v_mfma_f32_32x32x16_bf16 v[56:71], a[220:223], v[20:23], v[56:71]
    ds_read_b128 v[16:19], v2 offset:34816
    s_waitcnt lgkmcnt(6)
    v_mfma_f32_32x32x16_bf16 v[40:55], a[224:227], v[24:27], v[40:55]
    v_mfma_f32_32x32x16_bf16 v[56:71], a[228:231], v[24:27], v[56:71]
    s_add_u32 s23, s14, 2
    s_cmp_lg_u32 s13, 0
    s_cbranch_scc1 layerb1_kernel_gk_lw5
    s_min_u32 s28, s23, 63
    s_cmp_gt_u32 s56, s28
    s_cbranch_scc1 layerb1_kernel_gk_lw5
layerb1_kernel_gk_lp5:
    buffer_load_dwordx4 v[124:127], v1, s[8:11], s57 offen sc1
    s_waitcnt vmcnt(0)
    v_min_u32 v124, v124, v125
    v_min_u32 v126, v126, v127
    v_min_u32 v124, v124, v126
    v_cmp_eq_u32 vcc, 0, v124
    s_nop 1
    s_ff1_i32_b64 s56, vcc
    s_min_u32 s56, s56, 64
    s_sub_u32 s58, s58, 1
    s_cbranch_scc1 layerb1_kernel_bail
    s_cmp_gt_u32 s56, s28
    s_cbranch_scc0 layerb1_kernel_gk_lp5
layerb1_kernel_gk_lw5:
    s_cmp_gt_u32 s14, 5
    s_cbranch_scc1 layerb1_kernel_gk_dr6
    s_waitcnt vmcnt(0)
    s_mov_b32 s27, s14
    s_branch layerb1_kernel_gk_dq6
layerb1_kernel_gk_dr6:
    s_waitcnt vmcnt(4)
    s_sub_u32 s27, s14, 1
layerb1_kernel_gk_dq6:
    s_barrier
    s_cmp_lg_u32 s13, 0
    s_cbranch_scc1 layerb1_kernel_gk_fl7
    s_mov_b64 exec, 1
    s_lshl_b32 s26, s12, 7
    v_mov_b32 v7, s26
    v_mov_b32 v120, s27
    buffer_store_dword v120, v7, s[8:11], s48 offen sc1
    s_mov_b64 exec, -1
layerb1_kernel_gk_fl7:
    s_add_u32 s21, s16, 40960
    s_cmp_eq_u32 s21, 122880
    s_cselect_b32 s21, 0, s21
    s_add_u32 s23, s14, 2
    s_min_u32 s24, s23, 63
    s_mul_i32 s24, s24, 40960
    s_add_u32 s24, s24, s19
    s_mul_i32 s25, s13, 10240
    s_add_u32 s25, s25, s22
    s_add_u32 s22, s22, 40960
    s_cmp_eq_u32 s22, 122880
    s_cselect_b32 s22, 0, s22
    ds_read_b128 v[20:23], v2 offset:35840
    s_waitcnt lgkmcnt(6)
    v_mfma_f32_32x32x16_bf16 v[40:55], a[232:235], v[28:31], v[40:55]
    s_mov_b32 m0, s25
    s_nop 0
    buffer_load_dwordx4 v1, s[8:11], s24 offen offset:0 sc1 lds
    v_mfma_f32_32x32x16_bf16 v[56:71], a[236:239], v[28:31], v[56:71]
    ds_read_b128 v[24:27], v2 offset:36864
    s_waitcnt lgkmcnt(6)
    v_mfma_f32_32x32x16_bf16 v[40:55], a[240:243], v[32:35], v[40:55]
    buffer_load_dwordx4 v1, s[8:11], s24 offen offset:1024 sc1 lds
    v_mfma_f32_32x32x16_bf16 v[56:71], a[244:247], v[32:35], v[56:71]
    ds_read_b128 v[28:31], v2 offset:37888
    s_waitcnt lgkmcnt(6)
    v_mfma_f32_32x32x16_bf16 v[40:55], a[248:251], v[36:39], v[40:55]
    buffer_load_dwordx4 v1, s[8:11], s24 offen offset:2048 sc1 lds
    v_mfma_f32_32x32x16_bf16 v[56:71], a[252:255], v[36:39], v[56:71]
    ds_read_b128 v[32:35], v2 offset:38912
    s_waitcnt lgkmcnt(6)
    v_mfma_f32_32x32x16_bf16 v[40:55], v[192:195], v[8:11], v[40:55]
    buffer_load_dwordx4 v1, s[8:11], s24 offen offset:3072 sc1 lds
    v_mfma_f32_32x32x16_bf16 v[56:71], v[196:199], v[8:11], v[56:71]
    ds_read_b128 v[36:39], v2 offset:39936
    s_waitcnt lgkmcnt(6)
    v_mfma_f32_32x32x16_bf16 v[40:55], v[200:203], v[12:15], v[40:55]
    s_add_u32 s24, s24, 4096
    s_add_u32 s25, s25, 4096
    s_mov_b32 m0, s25
    s_nop 0
    buffer_load_dwordx4 v1, s[8:11], s24 offen offset:0 sc1 lds
    v_mfma_f32_32x32x16_bf16 v[56:71], v[204:207], v[12:15], v[56:71]
    v_add_u32 v6, s21, v1
    ds_read_b128 v[8:11], v6 offset:0
    s_waitcnt lgkmcnt(6)
    v_mfma_f32_32x32x16_bf16 v[40:55], v[208:211], v[16:19], v[40:55]
    buffer_load_dwordx4 v1, s[8:11], s24 offen offset:1024 sc1 lds
    v_mfma_f32_32x32x16_bf16 v[56:71], v[212:215], v[16:19], v[56:71]
    ds_read_b128 v[12:15], v6 offset:1024
    s_waitcnt lgkmcnt(6)
    v_mfma_f32_32x32x16_bf16 v[40:55], v[216:219], v[20:23], v[40:55]
    buffer_load_dwordx4 v1, s[8:11], s24 offen offset:2048 sc1 lds
    v_mfma_f32_32x32x16_bf16 v[56:71], v[220:223], v[20:23], v[56:71]
    ds_read_b128 v[16:19], v6 offset:2048
    s_waitcnt lgkmcnt(6)
    v_mfma_f32_32x32x16_bf16 v[40:55], v[224:227], v[24:27], v[40:55]
    buffer_load_dwordx4 v1, s[8:11], s24 offen offset:3072 sc1 lds
    v_mfma_f32_32x32x16_bf16 v[56:71], v[228:231], v[24:27], v[56:71]
    ds_read_b128 v[20:23], v6 offset:3072
    s_waitcnt lgkmcnt(6)
    v_mfma_f32_32x32x16_bf16 v[40:55], v[232:235], v[28:31], v[40:55]
    s_add_u32 s24, s24, 4096
    s_add_u32 s25, s25, 4096
    s_mov_b32 m0, s25
    s_nop 0
    buffer_load_dwordx4 v1, s[8:11], s24 offen offset:0 sc1 lds
    v_mfma_f32_32x32x16_bf16 v[56:71], v[236:239], v[28:31], v[56:71]
    ds_read_b128 v[24:27], v6 offset:4096
    s_waitcnt lgkmcnt(6)
    v_mfma_f32_32x32x16_bf16 v[40:55], v[240:243], v[32:35], v[40:55]
    buffer_load_dwordx4 v1, s[8:11], s24 offen offset:1024 sc1 lds
    v_mfma_f32_32x32x16_bf16 v[56:71], v[244:247], v[32:35], v[56:71]
    ds_read_b128 v[28:31], v6 offset:5120
    s_waitcnt lgkmcnt(6)
    v_mfma_f32_32x32x16_bf16 v[40:55], v[248:251], v[36:39], v[40:55]
    v_mfma_f32_32x32x16_bf16 v[56:71], v[252:255], v[36:39], v[56:71]
    v_mov_b32 v2, v6
    s_mov_b32 s16, s21
    s_add_u32 s14, s14, 1
    s_cmp_ge_u32 s14, s15
    s_cbranch_scc1 layerb1_kernel_gk_fin0
    ds_read_b128 v[32:35], v2 offset:6144
    s_waitcnt lgkmcnt(6)
    v_mfma_f32_32x32x16_bf16 v[72:87], a[0:3], v[8:11], 0
    v_mfma_f32_32x32x16_bf16 v[88:103], a[4:7], v[8:11], 0
    ds_read_b128 v[36:39], v2 offset:7168
    s_waitcnt lgkmcnt(6)
    v_mfma_f32_32x32x16_bf16 v[72:87], a[8:11], v[12:15], v[72:87]
    v_mfma_f32_32x32x16_bf16 v[88:103], a[12:15], v[12:15], v[88:103]
    ds_read_b128 v[8:11], v2 offset:8192
    s_waitcnt lgkmcnt(6)
    v_mfma_f32_32x32x16_bf16 v[72:87], a[16:19], v[16:19], v[72:87]
    v_cvt_pk_bf16_f32 v104, v40, v41
    v_mfma_f32_32x32x16_bf16 v[88:103], a[20:23], v[16:19], v[88:103]
    v_cvt_pk_bf16_f32 v105, v42, v43
    ds_read_b128 v[12:15], v2 offset:9216
    s_waitcnt lgkmcnt(6)
    v_mfma_f32_32x32x16_bf16 v[72:87], a[24:27], v[20:23], v[72:87]
    v_cvt_pk_bf16_f32 v106, v44, v45
    v_mfma_f32_32x32x16_bf16 v[88:103], a[28:31], v[20:23], v[88:103]
    v_cvt_pk_bf16_f32 v107, v46, v47
    ds_read_b128 v[16:19], v2 offset:10240
    s_waitcnt lgkmcnt(6)
    v_mfma_f32_32x32x16_bf16 v[72:87], a[32:35], v[24:27], v[72:87]
    s_nop 1
    v_mfma_f32_32x32x16_bf16 v[88:103], a[36:39], v[24:27], v[88:103]
    v_permlane32_swap_b32 v104, v106
    ds_read_b128 v[20:23], v2 offset:11264
    s_waitcnt lgkmcnt(6)
    v_mfma_f32_32x32x16_bf16 v[72:87], a[40:43], v[28:31], v[72:87]
    v_permlane32_swap_b32 v105, v107
    v_mfma_f32_32x32x16_bf16 v[88:103], a[44:47], v[28:31], v[88:103]
    buffer_store_dwordx4 v[104:107], v3, s[8:11], s17 offen offset:0 sc1
    ds_read_b128 v[24:27], v2 offset:12288
    s_waitcnt lgkmcnt(6)
    v_mfma_f32_32x32x16_bf16 v[72:87], a[48:51], v[32:35], v[72:87]
    v_cvt_pk_bf16_f32 v108, v48, v49
    v_mfma_f32_32x32x16_bf16 v[88:103], a[52:55], v[32:35], v[88:103]
    v_cvt_pk_bf16_f32 v109, v50, v51
    ds_read_b128 v[28:31], v2 offset:13312
    s_waitcnt lgkmcnt(6)
    v_mfma_f32_32x32x16_bf16 v[72:87], a[56:59], v[36:39], v[72:87]
    v_cvt_pk_bf16_f32 v110, v52, v53
    v_mfma_f32_32x32x16_bf16 v[88:103], a[60:63], v[36:39], v[88:103]
    v_cvt_pk_bf16_f32 v111, v54, v55
    ds_read_b128 v[32:35], v2 offset:14336
    s_waitcnt lgkmcnt(6)
    v_mfma_f32_32x32x16_bf16 v[72:87], a[64:67], v[8:11], v[72:87]
    s_nop 1
    v_mfma_f32_32x32x16_bf16 v[88:103], a[68:71], v[8:11], v[88:103]
    v_permlane32_swap_b32 v108, v110
    ds_read_b128 v[36:39], v2 offset:15360
    s_waitcnt lgkmcnt(6)
    v_mfma_f32_32x32x16_bf16 v[72:87], a[72:75], v[12:15], v[72:87]
    v_permlane32_swap_b32 v109, v111
    v_mfma_f32_32x32x16_bf16 v[88:103], a[76:79], v[12:15], v[88:103]
    buffer_store_dwordx4 v[108:111], v3, s[8:11], s17 offen offset:1024 sc1
    ds_read_b128 v[8:11], v2 offset:16384
    s_waitcnt lgkmcnt(6)
    v_mfma_f32_32x32x16_bf16 v[72:87], a[80:83], v[16:19], v[72:87]
    v_cvt_pk_bf16_f32 v112, v56, v57
    v_mfma_f32_32x32x16_bf16 v[88:103], a[84:87], v[16:19], v[88:103]
    v_cvt_pk_bf16_f32 v113, v58, v59
    ds_read_b128 v[12:15], v2 offset:17408
    s_waitcnt lgkmcnt(6)
    v_mfma_f32_32x32x16_bf16 v[72:87], a[88:91], v[20:23], v[72:87]
    v_cvt_pk_bf16_f32 v114, v60, v61
    v_mfma_f32_32x32x16_bf16 v[88:103], a[92:95], v[20:23], v[88:103]
    v_cvt_pk_bf16_f32 v115, v62, v63
    ds_read_b128 v[16:19], v2 offset:18432
    s_waitcnt lgkmcnt(6)
    v_mfma_f32_32x32x16_bf16 v[72:87], a[96:99], v[24:27], v[72:87]
    s_nop 1
    v_mfma_f32_32x32x16_bf16 v[88:103], a[100:103], v[24:27], v[88:103]
    v_permlane32_swap_b32 v112, v114
    ds_read_b128 v[20:23], v2 offset:19456
    s_waitcnt lgkmcnt(6)
    v_mfma_f32_32x32x16_bf16 v[72:87], a[104:107], v[28:31], v[72:87]
    v_permlane32_swap_b32 v113, v115
    v_mfma_f32_32x32x16_bf16 v[88:103], a[108:111], v[28:31], v[88:103]
    buffer_store_dwordx4 v[112:115], v3, s[8:11], s18 offen offset:0 sc1
    ds_read_b128 v[24:27], v2 offset:20480
    s_waitcnt lgkmcnt(6)
    v_mfma_f32_32x32x16_bf16 v[72:87], a[112:115], v[32:35], v[72:87]
    v_cvt_pk_bf16_f32 v116, v64, v65
    v_mfma_f32_32x32x16_bf16 v[88:103], a[116:119], v[32:35], v[88:103]
    v_cvt_pk_bf16_f32 v117, v66, v67
    ds_read_b128 v[28:31], v2 offset:21504
    s_waitcnt lgkmcnt(6)
    v_mfma_f32_32x32x16_bf16 v[72:87], a[120:123], v[36:39], v[72:87]
    v_cvt_pk_bf16_f32 v118, v68, v69
    v_mfma_f32_32x32x16_bf16 v[88:103], a[124:127], v[36:39], v[88:103]
    v_cvt_pk_bf16_f32 v119, v70, v71
    ds_read_b128 v[32:35], v2 offset:22528
    s_waitcnt lgkmcnt(6)
    v_mfma_f32_32x32x16_bf16 v[72:87], a[128:131], v[8:11], v[72:87]
    s_nop 1
    v_mfma_f32_32x32x16_bf16 v[88:103], a[132:135], v[8:11], v[88:103]
    v_permlane32_swap_b32 v116, v118
    ds_read_b128 v[36:39], v2 offset:23552
    s_waitcnt lgkmcnt(6)
    v_mfma_f32_32x32x16_bf16 v[72:87], a[136:139], v[12:15], v[72:87]
    v_permlane32_swap_b32 v117, v119
    v_mfma_f32_32x32x16_bf16 v[88:103], a[140:143], v[12:15], v[88:103]
    buffer_store_dwordx4 v[116:119], v3, s[8:11], s18 offen offset:1024 sc1
    ds_read_b128 v[8:11], v2 offset:24576
    s_waitcnt lgkmcnt(6)
    v_mfma_f32_32x32x16_bf16 v[72:87], a[144:147], v[16:19], v[72:87]
    s_add_u32 s17, s17, s20
    v_mfma_f32_32x32x16_bf16 v[88:103], a[148:151], v[16:19], v[88:103]
    s_add_u32 s18, s18, s20
    ds_read_b128 v[12:15], v2 offset:25600
    s_waitcnt lgkmcnt(6)
    v_mfma_f32_32x32x16_bf16 v[72:87], a[152:155], v[20:23], v[72:87]
    v_mfma_f32_32x32x16_bf16 v[88:103], a[156:159], v[20:23], v[88:103]
    ds_read_b128 v[16:19], v2 offset:26624
    s_waitcnt lgkmcnt(6)
    v_mfma_f32_32x32x16_bf16 v[72:87], a[160:163], v[24:27], v[72:87]
    v_mfma_f32_32x32x16_bf16 v[88:103], a[164:167], v[24:27], v[88:103]
    ds_read_b128 v[20:23], v2 offset:27648
    s_waitcnt lgkmcnt(6)
    v_mfma_f32_32x32x16_bf16 v[72:87], a[168:171], v[28:31], v[72:87]
    v_mfma_f32_32x32x16_bf16 v[88:103], a[172:175], v[28:31], v[88:103]
    ds_read_b128 v[24:27], v2 offset:28672
    s_waitcnt lgkmcnt(6)
    v_mfma_f32_32x32x16_bf16 v[72:87], a[176:179], v[32:35], v[72:87]
    v_mfma_f32_32x32x16_bf16 v[88:103], a[180:183], v[32:35], v[88:103]
    ds_read_b128 v[28:31], v2 offset:29696
    s_waitcnt lgkmcnt(6)
    v_mfma_f32_32x32x16_bf16 v[72:87], a[184:187], v[36:39], v[72:87]
    v_mfma_f32_32x32x16_bf16 v[88:103], a[188:191], v[36:39], v[88:103]
    ds_read_b128 v[32:35], v2 offset:30720
    s_waitcnt lgkmcnt(6)
    v_mfma_f32_32x32x16_bf16 v[72:87], a[192:195], v[8:11], v[72:87]
    v_mfma_f32_32x32x16_bf16 v[88:103], a[196:199], v[8:11], v[88:103]
    ds_read_b128 v[36:39], v2 offset:31744
    s_waitcnt lgkmcnt(6)
    v_mfma_f32_32x32x16_bf16 v[72:87], a[200:203], v[12:15], v[72:87]
    v_mfma_f32_32x32x16_bf16 v[88:103], a[204:207], v[12:15], v[88:103]
    ds_read_b128 v[8:11], v2 offset:32768
    s_waitcnt lgkmcnt(6)
    v_mfma_f32_32x32x16_bf16 v[72:87], a[208:211], v[16:19], v[72:87]
    v_mfma_f32_32x32x16_bf16 v[88:103], a[212:215], v[16:19], v[88:103]
    ds_read_b128 v[12:15], v2 offset:33792
    s_waitcnt lgkmcnt(6)
    v_mfma_f32_32x32x16_bf16 v[72:87], a[216:219], v[20:23], v[72:87]
    v_mfma_f32_32x32x16_bf16 v[88:103], a[220:223], v[20:23], v[88:103]
    ds_read_b128 v[16:19], v2 offset:34816
    s_waitcnt lgkmcnt(6)
    v_mfma_f32_32x32x16_bf16 v[72:87], a[224:227], v[24:27], v[72:87]
    v_mfma_f32_32x32x16_bf16 v[88:103], a[228:231], v[24:27], v[88:103]
    s_add_u32 s23, s14, 2
    s_cmp_lg_u32 s13, 0
    s_cbranch_scc1 layerb1_kernel_gk_lw8
    s_min_u32 s28, s23, 63
    s_cmp_gt_u32 s56, s28
    s_cbranch_scc1 layerb1_kernel_gk_lw8
layerb1_kernel_gk_lp8:
    buffer_load_dwordx4 v[124:127], v1, s[8:11], s57 offen sc1
    s_waitcnt vmcnt(0)
    v_min_u32 v124, v124, v125
    v_min_u32 v126, v126, v127
    v_min_u32 v124, v124, v126
    v_cmp_eq_u32 vcc, 0, v124
    s_nop 1
    s_ff1_i32_b64 s56, vcc
    s_min_u32 s56, s56, 64
    s_sub_u32 s58, s58, 1
    s_cbranch_scc1 layerb1_kernel_bail
    s_cmp_gt_u32 s56, s28
    s_cbranch_scc0 layerb1_kernel_gk_lp8
layerb1_kernel_gk_lw8:
    s_cmp_gt_u32 s14, 5
    s_cbranch_scc1 layerb1_kernel_gk_dr9
    s_waitcnt vmcnt(0)
    s_mov_b32 s27, s14
    s_branch layerb1_kernel_gk_dq9
layerb1_kernel_gk_dr9:
    s_waitcnt vmcnt(4)
    s_sub_u32 s27, s14, 1
layerb1_kernel_gk_dq9:
    s_barrier
    s_cmp_lg_u32 s13, 0
    s_cbranch_scc1 layerb1_kernel_gk_fl10
    s_mov_b64 exec, 1
    s_lshl_b32 s26, s12, 7
    v_mov_b32 v7, s26
    v_mov_b32 v120, s27
    buffer_store_dword v120, v7, s[8:11], s48 offen sc1
    s_mov_b64 exec, -1
layerb1_kernel_gk_fl10:
    s_add_u32 s21, s16, 40960
    s_cmp_eq_u32 s21, 122880
    s_cselect_b32 s21, 0, s21
    s_add_u32 s23, s14, 2
    s_min_u32 s24, s23, 63
    s_mul_i32 s24, s24, 40960
    s_add_u32 s24, s24, s19
    s_mul_i32 s25, s13, 10240
    s_add_u32 s25, s25, s22
    s_add_u32 s22, s22, 40960
    s_cmp_eq_u32 s22, 122880
    s_cselect_b32 s22, 0, s22
    ds_read_b128 v[20:23], v2 offset:35840
    s_waitcnt lgkmcnt(6)
    v_mfma_f32_32x32x16_bf16 v[72:87], a[232:235], v[28:31], v[72:87]
    s_mov_b32 m0, s25
    s_nop 0
    buffer_load_dwordx4 v1, s[8:11], s24 offen offset:0 sc1 lds
    v_mfma_f32_32x32x16_bf16 v[88:103], a[236:239], v[28:31], v[88:103]
    ds_read_b128 v[24:27], v2 offset:36864
    s_waitcnt lgkmcnt(6)
    v_mfma_f32_32x32x16_bf16 v[72:87], a[240:243], v[32:35], v[72:87]
    buffer_load_dwordx4 v1, s[8:11], s24 offen offset:1024 sc1 lds
    v_mfma_f32_32x32x16_bf16 v[88:103], a[244:247], v[32:35], v[88:103]
    ds_read_b128 v[28:31], v2 offset:37888
    s_waitcnt lgkmcnt(6)
    v_mfma_f32_32x32x16_bf16 v[72:87], a[248:251], v[36:39], v[72:87]
    buffer_load_dwordx4 v1, s[8:11], s24 offen offset:2048 sc1 lds
    v_mfma_f32_32x32x16_bf16 v[88:103], a[252:255], v[36:39], v[88:103]
    ds_read_b128 v[32:35], v2 offset:38912
    s_waitcnt lgkmcnt(6)
    v_mfma_f32_32x32x16_bf16 v[72:87], v[192:195], v[8:11], v[72:87]
    buffer_load_dwordx4 v1, s[8:11], s24 offen offset:3072 sc1 lds
    v_mfma_f32_32x32x16_bf16 v[88:103], v[196:199], v[8:11], v[88:103]
    ds_read_b128 v[36:39], v2 offset:39936
    s_waitcnt lgkmcnt(6)
    v_mfma_f32_32x32x16_bf16 v[72:87], v[200:203], v[12:15], v[72:87]
    s_add_u32 s24, s24, 4096
    s_add_u32 s25, s25, 4096
    s_mov_b32 m0, s25
    s_nop 0
    buffer_load_dwordx4 v1, s[8:11], s24 offen offset:0 sc1 lds
    v_mfma_f32_32x32x16_bf16 v[88:103], v[204:207], v[12:15], v[88:103]
    v_add_u32 v6, s21, v1
    ds_read_b128 v[8:11], v6 offset:0
    s_waitcnt lgkmcnt(6)
    v_mfma_f32_32x32x16_bf16 v[72:87], v[208:211], v[16:19], v[72:87]
    buffer_load_dwordx4 v1, s[8:11], s24 offen offset:1024 sc1 lds
    v_mfma_f32_32x32x16_bf16 v[88:103], v[212:215], v[16:19], v[88:103]
    ds_read_b128 v[12:15], v6 offset:1024
    s_waitcnt lgkmcnt(6)
    v_mfma_f32_32x32x16_bf16 v[72:87], v[216:219], v[20:23], v[72:87]
    buffer_load_dwordx4 v1, s[8:11], s24 offen offset:2048 sc1 lds
    v_mfma_f32_32x32x16_bf16 v[88:103], v[220:223], v[20:23], v[88:103]
    ds_read_b128 v[16:19], v6 offset:2048
    s_waitcnt lgkmcnt(6)
    v_mfma_f32_32x32x16_bf16 v[72:87], v[224:227], v[24:27], v[72:87]
    buffer_load_dwordx4 v1, s[8:11], s24 offen offset:3072 sc1 lds
    v_mfma_f32_32x32x16_bf16 v[88:103], v[228:231], v[24:27], v[88:103]
    ds_read_b128 v[20:23], v6 offset:3072
    s_waitcnt lgkmcnt(6)
    v_mfma_f32_32x32x16_bf16 v[72:87], v[232:235], v[28:31], v[72:87]
    s_add_u32 s24, s24, 4096
    s_add_u32 s25, s25, 4096
    s_mov_b32 m0, s25
    s_nop 0
    buffer_load_dwordx4 v1, s[8:11], s24 offen offset:0 sc1 lds
    v_mfma_f32_32x32x16_bf16 v[88:103], v[236:239], v[28:31], v[88:103]
    ds_read_b128 v[24:27], v6 offset:4096
    s_waitcnt lgkmcnt(6)
    v_mfma_f32_32x32x16_bf16 v[72:87], v[240:243], v[32:35], v[72:87]
    buffer_load_dwordx4 v1, s[8:11], s24 offen offset:1024 sc1 lds
    v_mfma_f32_32x32x16_bf16 v[88:103], v[244:247], v[32:35], v[88:103]
    ds_read_b128 v[28:31], v6 offset:5120
    s_waitcnt lgkmcnt(6)
    v_mfma_f32_32x32x16_bf16 v[72:87], v[248:251], v[36:39], v[72:87]
    v_mfma_f32_32x32x16_bf16 v[88:103], v[252:255], v[36:39], v[88:103]
    v_mov_b32 v2, v6
    s_mov_b32 s16, s21
    s_add_u32 s14, s14, 1
    s_cmp_lt_u32 s14, s15
    s_cbranch_scc1 layerb1_kernel_gk_loop
    s_branch layerb1_kernel_gk_fin1
layerb1_kernel_gk_fin0:
    s_nop 7
    s_nop 7
    v_cvt_pk_bf16_f32 v104, v40, v41
    v_cvt_pk_bf16_f32 v105, v42, v43
    v_cvt_pk_bf16_f32 v106, v44, v45
    v_cvt_pk_bf16_f32 v107, v46, v47
    s_nop 1
    v_permlane32_swap_b32 v104, v106
    v_permlane32_swap_b32 v105, v107
    buffer_store_dwordx4 v[104:107], v3, s[8:11], s17 offen offset:0 sc1
    v_cvt_pk_bf16_f32 v108, v48, v49
    v_cvt_pk_bf16_f32 v109, v50, v51
    v_cvt_pk_bf16_f32 v110, v52, v53
    v_cvt_pk_bf16_f32 v111, v54, v55
    s_nop 1
    v_permlane32_swap_b32 v108, v110
    v_permlane32_swap_b32 v109, v111
    buffer_store_dwordx4 v[108:111], v3, s[8:11], s17 offen offset:1024 sc1
    v_cvt_pk_bf16_f32 v112, v56, v57
    v_cvt_pk_bf16_f32 v113, v58, v59
    v_cvt_pk_bf16_f32 v114, v60, v61
    v_cvt_pk_bf16_f32 v115, v62, v63
    s_nop 1
    v_permlane32_swap_b32 v112, v114
    v_permlane32_swap_b32 v113, v115
    buffer_store_dwordx4 v[112:115], v3, s[8:11], s18 offen offset:0 sc1
    v_cvt_pk_bf16_f32 v116, v64, v65
    v_cvt_pk_bf16_f32 v117, v66, v67
    v_cvt_pk_bf16_f32 v118, v68, v69
    v_cvt_pk_bf16_f32 v119, v70, v71
    s_nop 1
    v_permlane32_swap_b32 v116, v118
    v_permlane32_swap_b32 v117, v119
    buffer_store_dwordx4 v[116:119], v3, s[8:11], s18 offen offset:1024 sc1
    s_add_u32 s17, s17, s20
    s_add_u32 s18, s18, s20
    s_branch layerb1_kernel_gk_done
layerb1_kernel_gk_fin1:
    s_nop 7
    s_nop 7
    v_cvt_pk_bf16_f32 v104, v72, v73
    v_cvt_pk_bf16_f32 v105, v74, v75
    v_cvt_pk_bf16_f32 v106, v76, v77
    v_cvt_pk_bf16_f32 v107, v78, v79
    s_nop 1
    v_permlane32_swap_b32 v104, v106
    v_permlane32_swap_b32 v105, v107
    buffer_store_dwordx4 v[104:107], v3, s[8:11], s17 offen offset:0 sc1
    v_cvt_pk_bf16_f32 v108, v80, v81
    v_cvt_pk_bf16_f32 v109, v82, v83
    v_cvt_pk_bf16_f32 v110, v84, v85
    v_cvt_pk_bf16_f32 v111, v86, v87
    s_nop 1
    v_permlane32_swap_b32 v108, v110
    v_permlane32_swap_b32 v109, v111
    buffer_store_dwordx4 v[108:111], v3, s[8:11], s17 offen offset:1024 sc1
    v_cvt_pk_bf16_f32 v112, v88, v89
    v_cvt_pk_bf16_f32 v113, v90, v91
    v_cvt_pk_bf16_f32 v114, v92, v93
    v_cvt_pk_bf16_f32 v115, v94, v95
    s_nop 1
    v_permlane32_swap_b32 v112, v114
    v_permlane32_swap_b32 v113, v115
    buffer_store_dwordx4 v[112:115], v3, s[8:11], s18 offen offset:0 sc1
    v_cvt_pk_bf16_f32 v116, v96, v97
    v_cvt_pk_bf16_f32 v117, v98, v99
    v_cvt_pk_bf16_f32 v118, v100, v101
    v_cvt_pk_bf16_f32 v119, v102, v103
    s_nop 1
    v_permlane32_swap_b32 v116, v118
    v_permlane32_swap_b32 v117, v119
    buffer_store_dwordx4 v[116:119], v3, s[8:11], s18 offen offset:1024 sc1
    s_add_u32 s17, s17, s20
    s_add_u32 s18, s18, s20
layerb1_kernel_gk_done:
    s_waitcnt vmcnt(0) lgkmcnt(0)
    s_barrier
    s_cmp_lg_u32 s13, 0
    s_cbranch_scc1 layerb1_kernel_gk_fl11
    s_mov_b64 exec, 1
    s_lshl_b32 s26, s12, 7
    v_mov_b32 v7, s26
    v_mov_b32 v120, s14
    buffer_store_dword v120, v7, s[8:11], s48 offen sc1
    s_mov_b64 exec, -1
layerb1_kernel_gk_fl11:
layerb1_kernel_g_done:
    s_branch layerb1_kernel_w3
layerb1_kernel_spare:
    s_sub_u32 s22, s20, 1
    s_mul_i32 s22, s22, 5
    s_add_u32 s22, s22, s21
    s_sub_u32 s22, s22, 27
    s_cmp_ge_u32 s21, 27
    s_cselect_b32 s22, s22, 15
    s_cmp_lt_u32 s22, 5
    s_cbranch_scc1 layerb1_kernel_sp_ab
    s_cmp_lt_u32 s22, 9
    s_cbranch_scc1 layerb1_kernel_sp_ln
    s_cmp_eq_u32 s22, 10
    s_cbranch_scc0 layerb1_kernel_sp_n10
    s_cmp_lg_u32 s13, 0
    s_cbranch_scc1 layerb1_kernel_cal1x
    s_add_u32 s24, s17, 2086912
    s_getreg_b32 s25, hwreg(HW_REG_XCC_ID)
    s_bfe_u32 s25, s25, 0x10002
    s_mov_b64 exec, 1
    v_mov_b32 v1, 0
    v_mov_b32 v2, 0
    s_mov_b32 s30, -1
    s_mov_b32 s31, -1
    s_mov_b32 s26, 8
    s_waitcnt vmcnt(0)
layerb1_kernel_cal1:
    s_and_b32 s27, s26, 15
    s_lshl_b32 s27, s27, 7
    s_add_u32 s27, s27, s24
    s_memtime s[28:29]
    s_waitcnt lgkmcnt(0)
    buffer_atomic_add v2, v1, s[8:11], s27 offen sc0 sc1
    s_waitcnt vmcnt(0)
    s_memtime s[32:33]
    v_mov_b32 v2, 0
    s_waitcnt lgkmcnt(0)
    s_sub_u32 s28, s32, s28
    s_min_u32 s30, s30, s28
    s_and_b32 s27, s26, 15
    s_lshl_b32 s27, s27, 7
    s_add_u32 s27, s27, s24
    s_add_u32 s27, s27, 8192
    s_memtime s[28:29]
    s_waitcnt lgkmcnt(0)
    buffer_atomic_add v2, v1, s[8:11], s27 offen sc0 sc1
    s_waitcnt vmcnt(0)
    s_memtime s[32:33]
    v_mov_b32 v2, 0
    s_waitcnt lgkmcnt(0)
    s_sub_u32 s28, s32, s28
    s_min_u32 s31, s31, s28
    s_sub_u32 s26, s26, 1
    s_cmp_lg_u32 s26, 0
    s_cbranch_scc1 layerb1_kernel_cal1
    s_cmp_lt_u32 s31, s30
    s_cselect_b32 s27, 1, 0
    s_xor_b32 s27, s27, s25
    s_lshl_b32 s27, s27, 13
    s_or_b32 s27, s27, 1
    v_mov_b32 v3, s27
    s_add_u32 s27, s48, 51204
    buffer_store_dword v3, v1, s[8:11], s27 offen sc1
    s_lshl_b32 s28, s30, 16
    s_or_b32 s28, s28, s31
    v_mov_b32 v3, s28
    buffer_store_dword v3, v1, s[8:11], s27 offen offset:8 sc1
    s_mov_b64 exec, -1
    s_waitcnt vmcnt(0)
layerb1_kernel_cal1x:
    s_barrier
    s_branch layerb1_kernel_w3
layerb1_kernel_sp_n10:
    s_cmp_eq_u32 s22, 9
    s_cbranch_scc0 layerb1_kernel_w3
    s_cmp_lg_u32 s13, 0
    s_cbranch_scc1 layerb1_kernel_cal0x
    s_add_u32 s24, s16, 2086912
    s_getreg_b32 s25, hwreg(HW_REG_XCC_ID)
    s_bfe_u32 s25, s25, 0x10002
    s_mov_b64 exec, 1
    v_mov_b32 v1, 0
    v_mov_b32 v2, 0
    s_mov_b32 s30, -1
    s_mov_b32 s31, -1
    s_mov_b32 s26, 8
    s_waitcnt vmcnt(0)
layerb1_kernel_cal0:
    s_and_b32 s27, s26, 15
    s_lshl_b32 s27, s27, 7
    s_add_u32 s27, s27, s24
    s_memtime s[28:29]
    s_waitcnt lgkmcnt(0)
    buffer_atomic_add v2, v1, s[8:11], s27 offen sc0 sc1
    s_waitcnt vmcnt(0)
    s_memtime s[32:33]
    v_mov_b32 v2, 0
    s_waitcnt lgkmcnt(0)
    s_sub_u32 s28, s32, s28
    s_min_u32 s30, s30, s28
    s_and_b32 s27, s26, 15
    s_lshl_b32 s27, s27, 7
    s_add_u32 s27, s27, s24
    s_add_u32 s27, s27, 8192
    s_memtime s[28:29]
    s_waitcnt lgkmcnt(0)
    buffer_atomic_add v2, v1, s[8:11], s27 offen sc0 sc1
    s_waitcnt vmcnt(0)
    s_memtime s[32:33]
    v_mov_b32 v2, 0
    s_waitcnt lgkmcnt(0)
    s_sub_u32 s28, s32, s28
    s_min_u32 s31, s31, s28
    s_sub_u32 s26, s26, 1
    s_cmp_lg_u32 s26, 0
    s_cbranch_scc1 layerb1_kernel_cal0
    s_cmp_lt_u32 s31, s30
    s_cselect_b32 s27, 1, 0
    s_xor_b32 s27, s27, s25
    s_lshl_b32 s27, s27, 13
    s_or_b32 s27, s27, 1
    v_mov_b32 v3, s27
    s_add_u32 s27, s48, 51200
    buffer_store_dword v3, v1, s[8:11], s27 offen sc1
    s_lshl_b32 s28, s30, 16
    s_or_b32 s28, s28, s31
    v_mov_b32 v3, s28
    buffer_store_dword v3, v1, s[8:11], s27 offen offset:8 sc1
    s_mov_b64 exec, -1
    s_waitcnt vmcnt(0)
layerb1_kernel_cal0x:
    s_barrier
    s_add_u32 s20, s48, 51200
    s_mov_b64 exec, 3
    v_lshlrev_b32 v16, 2, v0
layerb1_kernel_m0_par:
    buffer_load_dword v17, v16, s[8:11], s20 offen sc1
    s_waitcnt vmcnt(0)
    v_cmp_eq_u32 vcc, 0, v17
    s_sub_u32 s15, s15, 1
    s_cbranch_scc1 layerb1_kernel_bail
    s_cbranch_vccnz layerb1_kernel_m0_par
    s_mov_b64 exec, -1
    v_readlane_b32 s20, v17, 0
    v_readlane_b32 s21, v17, 1
    s_nop 0
    s_and_b32 s20, s20, 8192
    s_and_b32 s21, s21, 8192
    s_add_u32 s16, s16, s20
    s_add_u32 s17, s17, s21
    s_load_dwordx2 s[24:25], s[0:1], 32
    s_lshl_b32 s26, s13, 6
    v_add_u32 v1, s26, v0
    s_waitcnt lgkmcnt(0)
    s_mov_b32 s28, s24
    s_mov_b32 s29, s25
    s_mov_b32 s30, 10240
    s_mov_b32 s31, 0x00020000
    v_add_u32 v2, 0, v1
    v_and_b32 v3, 7, v2
    v_mul_u32_u24 v3, 1280, v3
    v_lshrrev_b32 v4, 3, v2
    v_lshl_add_u32 v3, v4, 4, v3
    v_lshlrev_b32 v5, 4, v2
    v_add_u32 v5, 20480, v5
    v_lshrrev_b32 v6, 13, v5
    v_lshlrev_b32 v6, 14, v6
    v_and_b32 v5, 8191, v5
    v_add_u32 v5, v5, v6
    v_cmp_gt_u32 vcc, 640, v2
    s_and_saveexec_b64 s[32:33], vcc
    s_cbranch_execz layerb1_kernel_m0s0
    buffer_load_dwordx4 v[8:11], v3, s[28:31], 0 offen
    s_waitcnt vmcnt(0)
    buffer_store_dwordx4 v[8:11], v5, s[8:11], s16 offen sc1
layerb1_kernel_m0s0:
    s_mov_b64 exec, s[32:33]
    v_add_u32 v2, 256, v1
    v_and_b32 v3, 7, v2
    v_mul_u32_u24 v3, 1280, v3
    v_lshrrev_b32 v4, 3, v2
    v_lshl_add_u32 v3, v4, 4, v3
    v_lshlrev_b32 v5, 4, v2
    v_add_u32 v5, 20480, v5
    v_lshrrev_b32 v6, 13, v5
    v_lshlrev_b32 v6, 14, v6
    v_and_b32 v5, 8191, v5
    v_add_u32 v5, v5, v6
    v_cmp_gt_u32 vcc, 640, v2
    s_and_saveexec_b64 s[32:33], vcc
    s_cbranch_execz layerb1_kernel_m0s1
    buffer_load_dwordx4 v[8:11], v3, s[28:31], 0 offen
    s_waitcnt vmcnt(0)
    buffer_store_dwordx4 v[8:11], v5, s[8:11], s16 offen sc1
layerb1_kernel_m0s1:
    s_mov_b64 exec, s[32:33]
    v_add_u32 v2, 512, v1
    v_and_b32 v3, 7, v2
    v_mul_u32_u24 v3, 1280, v3
    v_lshrrev_b32 v4, 3, v2
    v_lshl_add_u32 v3, v4, 4, v3
    v_lshlrev_b32 v5, 4, v2
    v_add_u32 v5, 20480, v5
    v_lshrrev_b32 v6, 13, v5
    v_lshlrev_b32 v6, 14, v6
    v_and_b32 v5, 8191, v5
    v_add_u32 v5, v5, v6
    v_cmp_gt_u32 vcc, 640, v2
    s_and_saveexec_b64 s[32:33], vcc
    s_cbranch_execz layerb1_kernel_m0s2
    buffer_load_dwordx4 v[8:11], v3, s[28:31], 0 offen
    s_waitcnt vmcnt(0)
    buffer_store_dwordx4 v[8:11], v5, s[8:11], s16 offen sc1
layerb1_kernel_m0s2:
    s_mov_b64 exec, s[32:33]
    s_waitcnt vmcnt(0)
    s_branch layerb1_kernel_w3
layerb1_kernel_sp_ab:
    s_mov_b32 s12, s22
    s_mov_b32 s14, 0
    s_mov_b32 s15, 64
    s_load_dwordx2 s[52:53], s[0:1], 0
    v_lshlrev_b32 v1, 4, v0
    s_lshl_b32 s21, s12, 2
    s_add_u32 s21, s21, s13
    s_add_u32 s24, s4, 247463936
    s_addc_u32 s25, s5, 0
    s_waitcnt lgkmcnt(0)
    s_cmp_eq_u32 s49, 0
    s_cselect_b32 s52, s52, s24
    s_cselect_b32 s53, s53, s25
    s_mov_b32 s54, 2621440
    s_mov_b32 s55, 0x00020000
    v_and_b32 v6, 31, v0
    v_lshrrev_b32 v7, 5, v0
    v_mul_u32_u24 v6, 1280, v6
    v_lshl_add_u32 v3, v7, 4, v6
    s_mul_i32 s19, s14, 40960
    s_lshl_b32 s24, s21, 6
    s_add_u32 s19, s19, s24
    s_lshl_b32 s20, s14, 7
    s_lshl_b32 s24, s21, 2
    s_add_u32 s20, s20, s24
    s_add_u32 s20, s20, 36864
    v_mov_b32 v5, 1
    v_mov_b32 v4, 0
    s_mul_i32 s18, s13, 10240
    s_add_u32 s18, s18, 229638144
    s_mov_b32 s17, 0
    buffer_load_dwordx4 v[96:99], v3, s[52:55], s19 offen offset:0
    buffer_load_dwordx4 v[100:103], v3, s[52:55], s19 offen offset:32
    s_mul_i32 s24, s21, 40960
    s_add_u32 s24, s24, 246415360
    s_add_u32 s24, s24, 4096
    s_add_u32 s24, s24, 4096
    s_add_u32 s24, s24, 4096
    s_add_u32 s24, s24, 4096
    s_add_u32 s24, s24, 4096
    s_add_u32 s24, s24, 4096
    s_add_u32 s24, s24, 4096
    s_add_u32 s24, s24, 4096
    s_add_u32 s24, s24, 4096
    s_mov_b32 s22, 0
    s_mov_b32 s30, 400000
    s_add_u32 s29, s48, 49152
    v_lshlrev_b32 v112, 3, v0
    s_cmp_lg_u32 s13, 0
    s_cbranch_scc1 layerb1_kernel_ab_ow1
    s_min_u32 s28, s14, 63
    s_cmp_gt_u32 s22, s28
    s_cbranch_scc1 layerb1_kernel_ab_ow1
layerb1_kernel_ab_op1:
    buffer_load_dwordx4 v[116:119], v1, s[8:11], s29 offen sc1
    s_waitcnt vmcnt(0)
    v_min_u32 v116, v116, v117
    v_min_u32 v118, v118, v119
    v_min_u32 v114, v116, v118
    v_cmp_eq_u32 vcc, 0, v114
    s_nop 1
    s_ff1_i32_b64 s22, vcc
    s_min_u32 s22, s22, 64
    s_and_b32 s22, s22, 0x7c
    s_sub_u32 s30, s30, 1
    s_cbranch_scc1 layerb1_kernel_bail
    s_cmp_gt_u32 s22, s28
    s_cbranch_scc0 layerb1_kernel_ab_op1
layerb1_kernel_ab_ow1:
    s_barrier
    s_min_u32 s24, s14, 63
    s_mul_i32 s24, s24, 40960
    s_add_u32 s24, s24, s18
    s_mul_i32 s25, s13, 10240
    s_add_u32 s25, s25, s17
    s_mov_b32 m0, s25
    s_nop 0
    buffer_load_dwordx4 v1, s[8:11], s24 offen offset:0 sc1 lds
    buffer_load_dwordx4 v1, s[8:11], s24 offen offset:1024 sc1 lds
    buffer_load_dwordx4 v1, s[8:11], s24 offen offset:2048 sc1 lds
    buffer_load_dwordx4 v1, s[8:11], s24 offen offset:3072 sc1 lds
    s_add_u32 s24, s24, 4096
    s_add_u32 s25, s25, 4096
    s_mov_b32 m0, s25
    s_nop 0
    buffer_load_dwordx4 v1, s[8:11], s24 offen offset:0 sc1 lds
    buffer_load_dwordx4 v1, s[8:11], s24 offen offset:1024 sc1 lds
    buffer_load_dwordx4 v1, s[8:11], s24 offen offset:2048 sc1 lds
    buffer_load_dwordx4 v1, s[8:11], s24 offen offset:3072 sc1 lds
    s_add_u32 s24, s24, 4096
    s_add_u32 s25, s25, 4096
    s_mov_b32 m0, s25
    s_nop 0
    buffer_load_dwordx4 v1, s[8:11], s24 offen offset:0 sc1 lds
    buffer_load_dwordx4 v1, s[8:11], s24 offen offset:1024 sc1 lds
    s_mov_b32 s17, 40960
    s_add_u32 s23, s14, 1
    s_cmp_lg_u32 s13, 0
    s_cbranch_scc1 layerb1_kernel_ab_ow2
    s_min_u32 s28, s23, 63
    s_cmp_gt_u32 s22, s28
    s_cbranch_scc1 layerb1_kernel_ab_ow2
layerb1_kernel_ab_op2:
    buffer_load_dwordx4 v[116:119], v1, s[8:11], s29 offen sc1
    s_waitcnt vmcnt(0)
    v_min_u32 v116, v116, v117
    v_min_u32 v118, v118, v119
    v_min_u32 v114, v116, v118
    v_cmp_eq_u32 vcc, 0, v114
    s_nop 1
    s_ff1_i32_b64 s22, vcc
    s_min_u32 s22, s22, 64
    s_and_b32 s22, s22, 0x7c
    s_sub_u32 s30, s30, 1
    s_cbranch_scc1 layerb1_kernel_bail
    s_cmp_gt_u32 s22, s28
    s_cbranch_scc0 layerb1_kernel_ab_op2
layerb1_kernel_ab_ow2:
    s_barrier
    s_min_u32 s24, s23, 63
    s_mul_i32 s24, s24, 40960
    s_add_u32 s24, s24, s18
    s_mul_i32 s25, s13, 10240
    s_add_u32 s25, s25, s17
    s_mov_b32 m0, s25
    s_nop 0
    buffer_load_dwordx4 v1, s[8:11], s24 offen offset:0 sc1 lds
    buffer_load_dwordx4 v1, s[8:11], s24 offen offset:1024 sc1 lds
    buffer_load_dwordx4 v1, s[8:11], s24 offen offset:2048 sc1 lds
    buffer_load_dwordx4 v1, s[8:11], s24 offen offset:3072 sc1 lds
    s_add_u32 s24, s24, 4096
    s_add_u32 s25, s25, 4096
    s_mov_b32 m0, s25
    s_nop 0
    buffer_load_dwordx4 v1, s[8:11], s24 offen offset:0 sc1 lds
    buffer_load_dwordx4 v1, s[8:11], s24 offen offset:1024 sc1 lds
    buffer_load_dwordx4 v1, s[8:11], s24 offen offset:2048 sc1 lds
    buffer_load_dwordx4 v1, s[8:11], s24 offen offset:3072 sc1 lds
    s_add_u32 s24, s24, 4096
    s_add_u32 s25, s25, 4096
    s_mov_b32 m0, s25
    s_nop 0
    buffer_load_dwordx4 v1, s[8:11], s24 offen offset:0 sc1 lds
    buffer_load_dwordx4 v1, s[8:11], s24 offen offset:1024 sc1 lds
    s_mov_b32 s17, 81920
    s_mov_b32 s16, 0
    s_waitcnt vmcnt(10)
    s_add_u32 s23, s14, 2
    s_cmp_lg_u32 s13, 0
    s_cbranch_scc1 layerb1_kernel_ab_ow3
    s_min_u32 s28, s23, 63
    s_cmp_gt_u32 s22, s28
    s_cbranch_scc1 layerb1_kernel_ab_ow3
layerb1_kernel_ab_op3:
    buffer_load_dwordx4 v[116:119], v1, s[8:11], s29 offen sc1
    s_waitcnt vmcnt(0)
    v_min_u32 v116, v116, v117
    v_min_u32 v118, v118, v119
    v_min_u32 v114, v116, v118
    v_cmp_eq_u32 vcc, 0, v114
    s_nop 1
    s_ff1_i32_b64 s22, vcc
    s_min_u32 s22, s22, 64
    s_and_b32 s22, s22, 0x7c
    s_sub_u32 s30, s30, 1
    s_cbranch_scc1 layerb1_kernel_bail
    s_cmp_gt_u32 s22, s28
    s_cbranch_scc0 layerb1_kernel_ab_op3
layerb1_kernel_ab_ow3:
    s_barrier
    v_add_u32 v2, s16, v1
    ds_read_b128 v[16:19], v2 offset:0
    ds_read_b128 v[20:23], v2 offset:1024
    ds_read_b128 v[24:27], v2 offset:2048
    ds_read_b128 v[28:31], v2 offset:3072
    ds_read_b128 v[32:35], v2 offset:4096
    ds_read_b128 v[36:39], v2 offset:5120
    s_add_u32 s27, s19, 40960
    s_cmp_ge_u32 s14, 63
    s_cselect_b32 s27, s19, s27
    buffer_load_dwordx4 v[104:107], v3, s[52:55], s27 offen offset:0
    buffer_load_dwordx4 v[108:111], v3, s[52:55], s27 offen offset:32
    s_add_u32 s23, s14, 2
    s_min_u32 s24, s23, 63
    s_mul_i32 s24, s24, 40960
    s_add_u32 s24, s24, s18
    s_mul_i32 s25, s13, 10240
    s_add_u32 s25, s25, s17
    s_add_u32 s17, s17, 40960
    s_cmp_eq_u32 s17, 122880
    s_cselect_b32 s17, 0, s17
    ds_read_b128 v[40:43], v2 offset:6144
    s_waitcnt lgkmcnt(6)
    v_mfma_f32_32x32x16_bf16 v[48:63], a[0:3], v[16:19], 0
    ds_read_b128 v[44:47], v2 offset:7168
    s_waitcnt lgkmcnt(6)
    v_mfma_f32_32x32x16_bf16 v[64:79], a[4:7], v[20:23], 0
    s_mov_b32 m0, s25
    s_nop 0
    buffer_load_dwordx4 v1, s[8:11], s24 offen offset:0 sc1 lds
    ds_read_b128 v[16:19], v2 offset:8192
    s_waitcnt lgkmcnt(6)
    v_mfma_f32_32x32x16_bf16 v[48:63], a[8:11], v[24:27], v[48:63]
    ds_read_b128 v[20:23], v2 offset:9216
    s_waitcnt lgkmcnt(6)
    v_mfma_f32_32x32x16_bf16 v[64:79], a[12:15], v[28:31], v[64:79]
    ds_read_b128 v[24:27], v2 offset:10240
    s_waitcnt lgkmcnt(6)
    v_mfma_f32_32x32x16_bf16 v[48:63], a[16:19], v[32:35], v[48:63]
    buffer_load_dwordx4 v1, s[8:11], s24 offen offset:1024 sc1 lds
    ds_read_b128 v[28:31], v2 offset:11264
    s_waitcnt lgkmcnt(6)
    v_mfma_f32_32x32x16_bf16 v[64:79], a[20:23], v[36:39], v[64:79]
    ds_read_b128 v[32:35], v2 offset:12288
    s_waitcnt lgkmcnt(6)
    v_mfma_f32_32x32x16_bf16 v[48:63], a[24:27], v[40:43], v[48:63]
    ds_read_b128 v[36:39], v2 offset:13312
    s_waitcnt lgkmcnt(6)
    v_mfma_f32_32x32x16_bf16 v[64:79], a[28:31], v[44:47], v[64:79]
    buffer_load_dwordx4 v1, s[8:11], s24 offen offset:2048 sc1 lds
    ds_read_b128 v[40:43], v2 offset:14336
    s_waitcnt lgkmcnt(6)
    v_mfma_f32_32x32x16_bf16 v[48:63], a[32:35], v[16:19], v[48:63]
    ds_read_b128 v[44:47], v2 offset:15360
    s_waitcnt lgkmcnt(6)
    v_mfma_f32_32x32x16_bf16 v[64:79], a[36:39], v[20:23], v[64:79]
    ds_read_b128 v[16:19], v2 offset:16384
    s_waitcnt lgkmcnt(6)
    v_mfma_f32_32x32x16_bf16 v[48:63], a[40:43], v[24:27], v[48:63]
    buffer_load_dwordx4 v1, s[8:11], s24 offen offset:3072 sc1 lds
    ds_read_b128 v[20:23], v2 offset:17408
    s_waitcnt lgkmcnt(6)
    v_mfma_f32_32x32x16_bf16 v[64:79], a[44:47], v[28:31], v[64:79]
    ds_read_b128 v[24:27], v2 offset:18432
    s_waitcnt lgkmcnt(6)
    v_mfma_f32_32x32x16_bf16 v[48:63], a[48:51], v[32:35], v[48:63]
    ds_read_b128 v[28:31], v2 offset:19456
    s_waitcnt lgkmcnt(6)
    v_mfma_f32_32x32x16_bf16 v[64:79], a[52:55], v[36:39], v[64:79]
    s_add_u32 s24, s24, 4096
    s_add_u32 s25, s25, 4096
    s_mov_b32 m0, s25
    s_nop 0
    buffer_load_dwordx4 v1, s[8:11], s24 offen offset:0 sc1 lds
    ds_read_b128 v[32:35], v2 offset:20480
    s_waitcnt lgkmcnt(6)
    v_mfma_f32_32x32x16_bf16 v[48:63], a[56:59], v[40:43], v[48:63]
    ds_read_b128 v[36:39], v2 offset:21504
    s_waitcnt lgkmcnt(6)
    v_mfma_f32_32x32x16_bf16 v[64:79], a[60:63], v[44:47], v[64:79]
    ds_read_b128 v[40:43], v2 offset:22528
    s_waitcnt lgkmcnt(6)
    v_mfma_f32_32x32x16_bf16 v[48:63], a[64:67], v[16:19], v[48:63]
    buffer_load_dwordx4 v1, s[8:11], s24 offen offset:1024 sc1 lds
    ds_read_b128 v[44:47], v2 offset:23552
    s_waitcnt lgkmcnt(6)
    v_mfma_f32_32x32x16_bf16 v[64:79], a[68:71], v[20:23], v[64:79]
    ds_read_b128 v[16:19], v2 offset:24576
    s_waitcnt lgkmcnt(6)
    v_mfma_f32_32x32x16_bf16 v[48:63], a[72:75], v[24:27], v[48:63]
    ds_read_b128 v[20:23], v2 offset:25600
    s_waitcnt lgkmcnt(6)
    v_mfma_f32_32x32x16_bf16 v[64:79], a[76:79], v[28:31], v[64:79]
    buffer_load_dwordx4 v1, s[8:11], s24 offen offset:2048 sc1 lds
    ds_read_b128 v[24:27], v2 offset:26624
    s_waitcnt lgkmcnt(6)
    v_mfma_f32_32x32x16_bf16 v[48:63], a[80:83], v[32:35], v[48:63]
    ds_read_b128 v[28:31], v2 offset:27648
    s_waitcnt lgkmcnt(6)
    v_mfma_f32_32x32x16_bf16 v[64:79], a[84:87], v[36:39], v[64:79]
    ds_read_b128 v[32:35], v2 offset:28672
    s_waitcnt lgkmcnt(6)
    v_mfma_f32_32x32x16_bf16 v[48:63], a[88:91], v[40:43], v[48:63]
    buffer_load_dwordx4 v1, s[8:11], s24 offen offset:3072 sc1 lds
    ds_read_b128 v[36:39], v2 offset:29696
    s_waitcnt lgkmcnt(6)
    v_mfma_f32_32x32x16_bf16 v[64:79], a[92:95], v[44:47], v[64:79]
    ds_read_b128 v[40:43], v2 offset:30720
    s_waitcnt lgkmcnt(6)
    v_mfma_f32_32x32x16_bf16 v[48:63], a[96:99], v[16:19], v[48:63]
    ds_read_b128 v[44:47], v2 offset:31744
    s_waitcnt lgkmcnt(6)
    v_mfma_f32_32x32x16_bf16 v[64:79], a[100:103], v[20:23], v[64:79]
    s_add_u32 s24, s24, 4096
    s_add_u32 s25, s25, 4096
    s_mov_b32 m0, s25
    s_nop 0
    buffer_load_dwordx4 v1, s[8:11], s24 offen offset:0 sc1 lds
    ds_read_b128 v[16:19], v2 offset:32768
    s_waitcnt lgkmcnt(6)
    v_mfma_f32_32x32x16_bf16 v[48:63], a[104:107], v[24:27], v[48:63]
    ds_read_b128 v[20:23], v2 offset:33792
    s_waitcnt lgkmcnt(6)
    v_mfma_f32_32x32x16_bf16 v[64:79], a[108:111], v[28:31], v[64:79]
    ds_read_b128 v[24:27], v2 offset:34816
    s_waitcnt lgkmcnt(6)
    v_mfma_f32_32x32x16_bf16 v[48:63], a[112:115], v[32:35], v[48:63]
    buffer_load_dwordx4 v1, s[8:11], s24 offen offset:1024 sc1 lds
    ds_read_b128 v[28:31], v2 offset:35840
    s_waitcnt lgkmcnt(6)
    v_mfma_f32_32x32x16_bf16 v[64:79], a[116:119], v[36:39], v[64:79]
    ds_read_b128 v[32:35], v2 offset:36864
    s_waitcnt lgkmcnt(6)
    v_mfma_f32_32x32x16_bf16 v[48:63], a[120:123], v[40:43], v[48:63]
    ds_read_b128 v[36:39], v2 offset:37888
    s_waitcnt lgkmcnt(6)
    v_mfma_f32_32x32x16_bf16 v[64:79], a[124:127], v[44:47], v[64:79]
    ds_read_b128 v[40:43], v2 offset:38912
    s_waitcnt lgkmcnt(6)
    v_mfma_f32_32x32x16_bf16 v[48:63], a[128:131], v[16:19], v[48:63]
    ds_read_b128 v[44:47], v2 offset:39936
    s_waitcnt lgkmcnt(6)
    v_mfma_f32_32x32x16_bf16 v[64:79], a[132:135], v[20:23], v[64:79]
    s_waitcnt lgkmcnt(5)
    v_mfma_f32_32x32x16_bf16 v[48:63], a[136:139], v[24:27], v[48:63]
    s_waitcnt lgkmcnt(4)
    v_mfma_f32_32x32x16_bf16 v[64:79], a[140:143], v[28:31], v[64:79]
    s_waitcnt lgkmcnt(3)
    v_mfma_f32_32x32x16_bf16 v[48:63], a[144:147], v[32:35], v[48:63]
    s_waitcnt lgkmcnt(2)
    v_mfma_f32_32x32x16_bf16 v[64:79], a[148:151], v[36:39], v[64:79]
    s_waitcnt lgkmcnt(1)
    v_mfma_f32_32x32x16_bf16 v[48:63], a[152:155], v[40:43], v[48:63]
    s_waitcnt lgkmcnt(0)
    v_mfma_f32_32x32x16_bf16 v[64:79], a[156:159], v[44:47], v[64:79]
    s_waitcnt vmcnt(12)
    s_nop 7
    s_nop 3
    v_add_f32 v48, v48, v64
    v_add_f32 v49, v49, v65
    v_add_f32 v50, v50, v66
    v_add_f32 v51, v51, v67
    v_add_f32 v52, v52, v68
    v_add_f32 v53, v53, v69
    v_add_f32 v54, v54, v70
    v_add_f32 v55, v55, v71
    v_add_f32 v56, v56, v72
    v_add_f32 v57, v57, v73
    v_add_f32 v58, v58, v74
    v_add_f32 v59, v59, v75
    v_add_f32 v60, v60, v76
    v_add_f32 v61, v61, v77
    v_add_f32 v62, v62, v78
    v_add_f32 v63, v63, v79
    s_add_u32 s26, s19, 226492416
    v_cvt_pk_bf16_f32 v80, v48, v49
    v_cvt_pk_bf16_f32 v81, v50, v51
    v_cvt_pk_bf16_f32 v82, v52, v53
    v_cvt_pk_bf16_f32 v83, v54, v55
    s_nop 1
    v_permlane32_swap_b32 v80, v82
    v_permlane32_swap_b32 v81, v83
    s_nop 1
    v_lshlrev_b32 v88, 16, v80
    v_and_b32 v89, 0xffff0000, v80
    v_lshlrev_b32 v90, 16, v96
    v_and_b32 v91, 0xffff0000, v96
    v_add_f32 v88, v88, v90
    v_add_f32 v89, v89, v91
    v_cvt_pk_bf16_f32 v80, v88, v89
    v_lshlrev_b32 v92, 16, v81
    v_and_b32 v93, 0xffff0000, v81
    v_lshlrev_b32 v94, 16, v97
    v_and_b32 v95, 0xffff0000, v97
    v_add_f32 v92, v92, v94
    v_add_f32 v93, v93, v95
    v_cvt_pk_bf16_f32 v81, v92, v93
    v_lshlrev_b32 v88, 16, v82
    v_and_b32 v89, 0xffff0000, v82
    v_lshlrev_b32 v90, 16, v98
    v_and_b32 v91, 0xffff0000, v98
    v_add_f32 v88, v88, v90
    v_add_f32 v89, v89, v91
    v_cvt_pk_bf16_f32 v82, v88, v89
    v_lshlrev_b32 v92, 16, v83
    v_and_b32 v93, 0xffff0000, v83
    v_lshlrev_b32 v94, 16, v99
    v_and_b32 v95, 0xffff0000, v99
    v_add_f32 v92, v92, v94
    v_add_f32 v93, v93, v95
    v_cvt_pk_bf16_f32 v83, v92, v93
    buffer_store_dwordx4 v[80:83], v3, s[8:11], s26 offen offset:0 sc1
    v_cvt_pk_bf16_f32 v84, v56, v57
    v_cvt_pk_bf16_f32 v85, v58, v59
    v_cvt_pk_bf16_f32 v86, v60, v61
    v_cvt_pk_bf16_f32 v87, v62, v63
    s_nop 1
    v_permlane32_swap_b32 v84, v86
    v_permlane32_swap_b32 v85, v87
    s_nop 1
    v_lshlrev_b32 v88, 16, v84
    v_and_b32 v89, 0xffff0000, v84
    v_lshlrev_b32 v90, 16, v100
    v_and_b32 v91, 0xffff0000, v100
    v_add_f32 v88, v88, v90
    v_add_f32 v89, v89, v91
    v_cvt_pk_bf16_f32 v84, v88, v89
    v_lshlrev_b32 v92, 16, v85
    v_and_b32 v93, 0xffff0000, v85
    v_lshlrev_b32 v94, 16, v101
    v_and_b32 v95, 0xffff0000, v101
    v_add_f32 v92, v92, v94
    v_add_f32 v93, v93, v95
    v_cvt_pk_bf16_f32 v85, v92, v93
    v_lshlrev_b32 v88, 16, v86
    v_and_b32 v89, 0xffff0000, v86
    v_lshlrev_b32 v90, 16, v102
    v_and_b32 v91, 0xffff0000, v102
    v_add_f32 v88, v88, v90
    v_add_f32 v89, v89, v91
    v_cvt_pk_bf16_f32 v86, v88, v89
    v_lshlrev_b32 v92, 16, v87
    v_and_b32 v93, 0xffff0000, v87
    v_lshlrev_b32 v94, 16, v103
    v_and_b32 v95, 0xffff0000, v103
    v_add_f32 v92, v92, v94
    v_add_f32 v93, v93, v95
    v_cvt_pk_bf16_f32 v87, v92, v93
    buffer_store_dwordx4 v[84:87], v3, s[8:11], s26 offen offset:32 sc1
    s_waitcnt vmcnt(0)
    s_mov_b64 exec, 1
    s_add_u32 s26, s48, s20
    buffer_store_dword v5, v4, s[8:11], s26 offen sc1
    s_mov_b64 exec, -1
    s_add_u32 s20, s20, 128
    s_add_u32 s19, s19, 40960
    s_add_u32 s16, s16, 40960
    s_cmp_eq_u32 s16, 122880
    s_cselect_b32 s16, 0, s16
    s_add_u32 s14, s14, 1
    s_cmp_ge_u32 s14, s15
    s_cbranch_scc1 layerb1_kernel_ab_fin
    s_add_u32 s23, s14, 2
    s_cmp_lg_u32 s13, 0
    s_cbranch_scc1 layerb1_kernel_ab_ow4
    s_min_u32 s28, s23, 63
    s_cmp_gt_u32 s22, s28
    s_cbranch_scc1 layerb1_kernel_ab_ow4
layerb1_kernel_ab_op4:
    buffer_load_dwordx4 v[116:119], v1, s[8:11], s29 offen sc1
    s_waitcnt vmcnt(0)
    v_min_u32 v116, v116, v117
    v_min_u32 v118, v118, v119
    v_min_u32 v114, v116, v118
    v_cmp_eq_u32 vcc, 0, v114
    s_nop 1
    s_ff1_i32_b64 s22, vcc
    s_min_u32 s22, s22, 64
    s_and_b32 s22, s22, 0x7c
    s_sub_u32 s30, s30, 1
    s_cbranch_scc1 layerb1_kernel_bail
    s_cmp_gt_u32 s22, s28
    s_cbranch_scc0 layerb1_kernel_ab_op4
layerb1_kernel_ab_ow4:
    s_barrier
    v_add_u32 v2, s16, v1
    ds_read_b128 v[16:19], v2 offset:0
    ds_read_b128 v[20:23], v2 offset:1024
    ds_read_b128 v[24:27], v2 offset:2048
    ds_read_b128 v[28:31], v2 offset:3072
    ds_read_b128 v[32:35], v2 offset:4096
    ds_read_b128 v[36:39], v2 offset:5120
    s_add_u32 s27, s19, 40960
    s_cmp_ge_u32 s14, 63
    s_cselect_b32 s27, s19, s27
    buffer_load_dwordx4 v[96:99], v3, s[52:55], s27 offen offset:0
    buffer_load_dwordx4 v[100:103], v3, s[52:55], s27 offen offset:32
    s_add_u32 s23, s14, 2
    s_min_u32 s24, s23, 63
    s_mul_i32 s24, s24, 40960
    s_add_u32 s24, s24, s18
    s_mul_i32 s25, s13, 10240
    s_add_u32 s25, s25, s17
    s_add_u32 s17, s17, 40960
    s_cmp_eq_u32 s17, 122880
    s_cselect_b32 s17, 0, s17
    ds_read_b128 v[40:43], v2 offset:6144
    s_waitcnt lgkmcnt(6)
    v_mfma_f32_32x32x16_bf16 v[48:63], a[0:3], v[16:19], 0
    ds_read_b128 v[44:47], v2 offset:7168
    s_waitcnt lgkmcnt(6)
    v_mfma_f32_32x32x16_bf16 v[64:79], a[4:7], v[20:23], 0
    s_mov_b32 m0, s25
    s_nop 0
    buffer_load_dwordx4 v1, s[8:11], s24 offen offset:0 sc1 lds
    ds_read_b128 v[16:19], v2 offset:8192
    s_waitcnt lgkmcnt(6)
    v_mfma_f32_32x32x16_bf16 v[48:63], a[8:11], v[24:27], v[48:63]
    ds_read_b128 v[20:23], v2 offset:9216
    s_waitcnt lgkmcnt(6)
    v_mfma_f32_32x32x16_bf16 v[64:79], a[12:15], v[28:31], v[64:79]
    ds_read_b128 v[24:27], v2 offset:10240
    s_waitcnt lgkmcnt(6)
    v_mfma_f32_32x32x16_bf16 v[48:63], a[16:19], v[32:35], v[48:63]
    buffer_load_dwordx4 v1, s[8:11], s24 offen offset:1024 sc1 lds
    ds_read_b128 v[28:31], v2 offset:11264
    s_waitcnt lgkmcnt(6)
    v_mfma_f32_32x32x16_bf16 v[64:79], a[20:23], v[36:39], v[64:79]
    ds_read_b128 v[32:35], v2 offset:12288
    s_waitcnt lgkmcnt(6)
    v_mfma_f32_32x32x16_bf16 v[48:63], a[24:27], v[40:43], v[48:63]
    ds_read_b128 v[36:39], v2 offset:13312
    s_waitcnt lgkmcnt(6)
    v_mfma_f32_32x32x16_bf16 v[64:79], a[28:31], v[44:47], v[64:79]
    buffer_load_dwordx4 v1, s[8:11], s24 offen offset:2048 sc1 lds
    ds_read_b128 v[40:43], v2 offset:14336
    s_waitcnt lgkmcnt(6)
    v_mfma_f32_32x32x16_bf16 v[48:63], a[32:35], v[16:19], v[48:63]
    ds_read_b128 v[44:47], v2 offset:15360
    s_waitcnt lgkmcnt(6)
    v_mfma_f32_32x32x16_bf16 v[64:79], a[36:39], v[20:23], v[64:79]
    ds_read_b128 v[16:19], v2 offset:16384
    s_waitcnt lgkmcnt(6)
    v_mfma_f32_32x32x16_bf16 v[48:63], a[40:43], v[24:27], v[48:63]
    buffer_load_dwordx4 v1, s[8:11], s24 offen offset:3072 sc1 lds
    ds_read_b128 v[20:23], v2 offset:17408
    s_waitcnt lgkmcnt(6)
    v_mfma_f32_32x32x16_bf16 v[64:79], a[44:47], v[28:31], v[64:79]
    ds_read_b128 v[24:27], v2 offset:18432
    s_waitcnt lgkmcnt(6)
    v_mfma_f32_32x32x16_bf16 v[48:63], a[48:51], v[32:35], v[48:63]
    ds_read_b128 v[28:31], v2 offset:19456
    s_waitcnt lgkmcnt(6)
    v_mfma_f32_32x32x16_bf16 v[64:79], a[52:55], v[36:39], v[64:79]
    s_add_u32 s24, s24, 4096
    s_add_u32 s25, s25, 4096
    s_mov_b32 m0, s25
    s_nop 0
    buffer_load_dwordx4 v1, s[8:11], s24 offen offset:0 sc1 lds
    ds_read_b128 v[32:35], v2 offset:20480
    s_waitcnt lgkmcnt(6)
    v_mfma_f32_32x32x16_bf16 v[48:63], a[56:59], v[40:43], v[48:63]
    ds_read_b128 v[36:39], v2 offset:21504
    s_waitcnt lgkmcnt(6)
    v_mfma_f32_32x32x16_bf16 v[64:79], a[60:63], v[44:47], v[64:79]
    ds_read_b128 v[40:43], v2 offset:22528
    s_waitcnt lgkmcnt(6)
    v_mfma_f32_32x32x16_bf16 v[48:63], a[64:67], v[16:19], v[48:63]
    buffer_load_dwordx4 v1, s[8:11], s24 offen offset:1024 sc1 lds
    ds_read_b128 v[44:47], v2 offset:23552
    s_waitcnt lgkmcnt(6)
    v_mfma_f32_32x32x16_bf16 v[64:79], a[68:71], v[20:23], v[64:79]
    ds_read_b128 v[16:19], v2 offset:24576
    s_waitcnt lgkmcnt(6)
    v_mfma_f32_32x32x16_bf16 v[48:63], a[72:75], v[24:27], v[48:63]
    ds_read_b128 v[20:23], v2 offset:25600
    s_waitcnt lgkmcnt(6)
    v_mfma_f32_32x32x16_bf16 v[64:79], a[76:79], v[28:31], v[64:79]
    buffer_load_dwordx4 v1, s[8:11], s24 offen offset:2048 sc1 lds
    ds_read_b128 v[24:27], v2 offset:26624
    s_waitcnt lgkmcnt(6)
    v_mfma_f32_32x32x16_bf16 v[48:63], a[80:83], v[32:35], v[48:63]
    ds_read_b128 v[28:31], v2 offset:27648
    s_waitcnt lgkmcnt(6)
    v_mfma_f32_32x32x16_bf16 v[64:79], a[84:87], v[36:39], v[64:79]
    ds_read_b128 v[32:35], v2 offset:28672
    s_waitcnt lgkmcnt(6)
    v_mfma_f32_32x32x16_bf16 v[48:63], a[88:91], v[40:43], v[48:63]
    buffer_load_dwordx4 v1, s[8:11], s24 offen offset:3072 sc1 lds
    ds_read_b128 v[36:39], v2 offset:29696
    s_waitcnt lgkmcnt(6)
    v_mfma_f32_32x32x16_bf16 v[64:79], a[92:95], v[44:47], v[64:79]
    ds_read_b128 v[40:43], v2 offset:30720
    s_waitcnt lgkmcnt(6)
    v_mfma_f32_32x32x16_bf16 v[48:63], a[96:99], v[16:19], v[48:63]
    ds_read_b128 v[44:47], v2 offset:31744
    s_waitcnt lgkmcnt(6)
    v_mfma_f32_32x32x16_bf16 v[64:79], a[100:103], v[20:23], v[64:79]
    s_add_u32 s24, s24, 4096
    s_add_u32 s25, s25, 4096
    s_mov_b32 m0, s25
    s_nop 0
    buffer_load_dwordx4 v1, s[8:11], s24 offen offset:0 sc1 lds
    ds_read_b128 v[16:19], v2 offset:32768
    s_waitcnt lgkmcnt(6)
    v_mfma_f32_32x32x16_bf16 v[48:63], a[104:107], v[24:27], v[48:63]
    ds_read_b128 v[20:23], v2 offset:33792
    s_waitcnt lgkmcnt(6)
    v_mfma_f32_32x32x16_bf16 v[64:79], a[108:111], v[28:31], v[64:79]
    ds_read_b128 v[24:27], v2 offset:34816
    s_waitcnt lgkmcnt(6)
    v_mfma_f32_32x32x16_bf16 v[48:63], a[112:115], v[32:35], v[48:63]
    buffer_load_dwordx4 v1, s[8:11], s24 offen offset:1024 sc1 lds
    ds_read_b128 v[28:31], v2 offset:35840
    s_waitcnt lgkmcnt(6)
    v_mfma_f32_32x32x16_bf16 v[64:79], a[116:119], v[36:39], v[64:79]
    ds_read_b128 v[32:35], v2 offset:36864
    s_waitcnt lgkmcnt(6)
    v_mfma_f32_32x32x16_bf16 v[48:63], a[120:123], v[40:43], v[48:63]
    ds_read_b128 v[36:39], v2 offset:37888
    s_waitcnt lgkmcnt(6)
    v_mfma_f32_32x32x16_bf16 v[64:79], a[124:127], v[44:47], v[64:79]
    ds_read_b128 v[40:43], v2 offset:38912
    s_waitcnt lgkmcnt(6)
    v_mfma_f32_32x32x16_bf16 v[48:63], a[128:131], v[16:19], v[48:63]
    ds_read_b128 v[44:47], v2 offset:39936
    s_waitcnt lgkmcnt(6)
    v_mfma_f32_32x32x16_bf16 v[64:79], a[132:135], v[20:23], v[64:79]
    s_waitcnt lgkmcnt(5)
    v_mfma_f32_32x32x16_bf16 v[48:63], a[136:139], v[24:27], v[48:63]
    s_waitcnt lgkmcnt(4)
    v_mfma_f32_32x32x16_bf16 v[64:79], a[140:143], v[28:31], v[64:79]
    s_waitcnt lgkmcnt(3)
    v_mfma_f32_32x32x16_bf16 v[48:63], a[144:147], v[32:35], v[48:63]
    s_waitcnt lgkmcnt(2)
    v_mfma_f32_32x32x16_bf16 v[64:79], a[148:151], v[36:39], v[64:79]
    s_waitcnt lgkmcnt(1)
    v_mfma_f32_32x32x16_bf16 v[48:63], a[152:155], v[40:43], v[48:63]
    s_waitcnt lgkmcnt(0)
    v_mfma_f32_32x32x16_bf16 v[64:79], a[156:159], v[44:47], v[64:79]
    s_waitcnt vmcnt(12)
    s_nop 7
    s_nop 3
    v_add_f32 v48, v48, v64
    v_add_f32 v49, v49, v65
    v_add_f32 v50, v50, v66
    v_add_f32 v51, v51, v67
    v_add_f32 v52, v52, v68
    v_add_f32 v53, v53, v69
    v_add_f32 v54, v54, v70
    v_add_f32 v55, v55, v71
    v_add_f32 v56, v56, v72
    v_add_f32 v57, v57, v73
    v_add_f32 v58, v58, v74
    v_add_f32 v59, v59, v75
    v_add_f32 v60, v60, v76
    v_add_f32 v61, v61, v77
    v_add_f32 v62, v62, v78
    v_add_f32 v63, v63, v79
    s_add_u32 s26, s19, 226492416
    v_cvt_pk_bf16_f32 v80, v48, v49
    v_cvt_pk_bf16_f32 v81, v50, v51
    v_cvt_pk_bf16_f32 v82, v52, v53
    v_cvt_pk_bf16_f32 v83, v54, v55
    s_nop 1
    v_permlane32_swap_b32 v80, v82
    v_permlane32_swap_b32 v81, v83
    s_nop 1
    v_lshlrev_b32 v88, 16, v80
    v_and_b32 v89, 0xffff0000, v80
    v_lshlrev_b32 v90, 16, v104
    v_and_b32 v91, 0xffff0000, v104
    v_add_f32 v88, v88, v90
    v_add_f32 v89, v89, v91
    v_cvt_pk_bf16_f32 v80, v88, v89
    v_lshlrev_b32 v92, 16, v81
    v_and_b32 v93, 0xffff0000, v81
    v_lshlrev_b32 v94, 16, v105
    v_and_b32 v95, 0xffff0000, v105
    v_add_f32 v92, v92, v94
    v_add_f32 v93, v93, v95
    v_cvt_pk_bf16_f32 v81, v92, v93
    v_lshlrev_b32 v88, 16, v82
    v_and_b32 v89, 0xffff0000, v82
    v_lshlrev_b32 v90, 16, v106
    v_and_b32 v91, 0xffff0000, v106
    v_add_f32 v88, v88, v90
    v_add_f32 v89, v89, v91
    v_cvt_pk_bf16_f32 v82, v88, v89
    v_lshlrev_b32 v92, 16, v83
    v_and_b32 v93, 0xffff0000, v83
    v_lshlrev_b32 v94, 16, v107
    v_and_b32 v95, 0xffff0000, v107
    v_add_f32 v92, v92, v94
    v_add_f32 v93, v93, v95
    v_cvt_pk_bf16_f32 v83, v92, v93
    buffer_store_dwordx4 v[80:83], v3, s[8:11], s26 offen offset:0 sc1
    v_cvt_pk_bf16_f32 v84, v56, v57
    v_cvt_pk_bf16_f32 v85, v58, v59
    v_cvt_pk_bf16_f32 v86, v60, v61
    v_cvt_pk_bf16_f32 v87, v62, v63
    s_nop 1
    v_permlane32_swap_b32 v84, v86
    v_permlane32_swap_b32 v85, v87
    s_nop 1
    v_lshlrev_b32 v88, 16, v84
    v_and_b32 v89, 0xffff0000, v84
    v_lshlrev_b32 v90, 16, v108
    v_and_b32 v91, 0xffff0000, v108
    v_add_f32 v88, v88, v90
    v_add_f32 v89, v89, v91
    v_cvt_pk_bf16_f32 v84, v88, v89
    v_lshlrev_b32 v92, 16, v85
    v_and_b32 v93, 0xffff0000, v85
    v_lshlrev_b32 v94, 16, v109
    v_and_b32 v95, 0xffff0000, v109
    v_add_f32 v92, v92, v94
    v_add_f32 v93, v93, v95
    v_cvt_pk_bf16_f32 v85, v92, v93
    v_lshlrev_b32 v88, 16, v86
    v_and_b32 v89, 0xffff0000, v86
    v_lshlrev_b32 v90, 16, v110
    v_and_b32 v91, 0xffff0000, v110
    v_add_f32 v88, v88, v90
    v_add_f32 v89, v89, v91
    v_cvt_pk_bf16_f32 v86, v88, v89
    v_lshlrev_b32 v92, 16, v87
    v_and_b32 v93, 0xffff0000, v87
    v_lshlrev_b32 v94, 16, v111
    v_and_b32 v95, 0xffff0000, v111
    v_add_f32 v92, v92, v94
    v_add_f32 v93, v93, v95
    v_cvt_pk_bf16_f32 v87, v92, v93
    buffer_store_dwordx4 v[84:87], v3, s[8:11], s26 offen offset:32 sc1
    s_waitcnt vmcnt(0)
    s_mov_b64 exec, 1
    s_add_u32 s26, s48, s20
    buffer_store_dword v5, v4, s[8:11], s26 offen sc1
    s_mov_b64 exec, -1
    s_add_u32 s20, s20, 128
    s_add_u32 s19, s19, 40960
    s_add_u32 s16, s16, 40960
    s_cmp_eq_u32 s16, 122880
    s_cselect_b32 s16, 0, s16
    s_add_u32 s14, s14, 1
    s_cmp_ge_u32 s14, s15
    s_cbranch_scc1 layerb1_kernel_ab_fin
    s_add_u32 s23, s14, 2
    s_cmp_lg_u32 s13, 0
    s_cbranch_scc1 layerb1_kernel_ab_ow5
    s_min_u32 s28, s23, 63
    s_cmp_gt_u32 s22, s28
    s_cbranch_scc1 layerb1_kernel_ab_ow5
layerb1_kernel_ab_op5:
    buffer_load_dwordx4 v[116:119], v1, s[8:11], s29 offen sc1
    s_waitcnt vmcnt(0)
    v_min_u32 v116, v116, v117
    v_min_u32 v118, v118, v119
    v_min_u32 v114, v116, v118
    v_cmp_eq_u32 vcc, 0, v114
    s_nop 1
    s_ff1_i32_b64 s22, vcc
    s_min_u32 s22, s22, 64
    s_and_b32 s22, s22, 0x7c
    s_sub_u32 s30, s30, 1
    s_cbranch_scc1 layerb1_kernel_bail
    s_cmp_gt_u32 s22, s28
    s_cbranch_scc0 layerb1_kernel_ab_op5
layerb1_kernel_ab_ow5:
    s_barrier
    v_add_u32 v2, s16, v1
    ds_read_b128 v[16:19], v2 offset:0
    ds_read_b128 v[20:23], v2 offset:1024
    ds_read_b128 v[24:27], v2 offset:2048
    ds_read_b128 v[28:31], v2 offset:3072
    ds_read_b128 v[32:35], v2 offset:4096
    ds_read_b128 v[36:39], v2 offset:5120
    s_add_u32 s27, s19, 40960
    s_cmp_ge_u32 s14, 63
    s_cselect_b32 s27, s19, s27
    buffer_load_dwordx4 v[104:107], v3, s[52:55], s27 offen offset:0
    buffer_load_dwordx4 v[108:111], v3, s[52:55], s27 offen offset:32
    s_add_u32 s23, s14, 2
    s_min_u32 s24, s23, 63
    s_mul_i32 s24, s24, 40960
    s_add_u32 s24, s24, s18
    s_mul_i32 s25, s13, 10240
    s_add_u32 s25, s25, s17
    s_add_u32 s17, s17, 40960
    s_cmp_eq_u32 s17, 122880
    s_cselect_b32 s17, 0, s17
    ds_read_b128 v[40:43], v2 offset:6144
    s_waitcnt lgkmcnt(6)
    v_mfma_f32_32x32x16_bf16 v[48:63], a[0:3], v[16:19], 0
    ds_read_b128 v[44:47], v2 offset:7168
    s_waitcnt lgkmcnt(6)
    v_mfma_f32_32x32x16_bf16 v[64:79], a[4:7], v[20:23], 0
    s_mov_b32 m0, s25
    s_nop 0
    buffer_load_dwordx4 v1, s[8:11], s24 offen offset:0 sc1 lds
    ds_read_b128 v[16:19], v2 offset:8192
    s_waitcnt lgkmcnt(6)
    v_mfma_f32_32x32x16_bf16 v[48:63], a[8:11], v[24:27], v[48:63]
    ds_read_b128 v[20:23], v2 offset:9216
    s_waitcnt lgkmcnt(6)
    v_mfma_f32_32x32x16_bf16 v[64:79], a[12:15], v[28:31], v[64:79]
    ds_read_b128 v[24:27], v2 offset:10240
    s_waitcnt lgkmcnt(6)
    v_mfma_f32_32x32x16_bf16 v[48:63], a[16:19], v[32:35], v[48:63]
    buffer_load_dwordx4 v1, s[8:11], s24 offen offset:1024 sc1 lds
    ds_read_b128 v[28:31], v2 offset:11264
    s_waitcnt lgkmcnt(6)
    v_mfma_f32_32x32x16_bf16 v[64:79], a[20:23], v[36:39], v[64:79]
    ds_read_b128 v[32:35], v2 offset:12288
    s_waitcnt lgkmcnt(6)
    v_mfma_f32_32x32x16_bf16 v[48:63], a[24:27], v[40:43], v[48:63]
    ds_read_b128 v[36:39], v2 offset:13312
    s_waitcnt lgkmcnt(6)
    v_mfma_f32_32x32x16_bf16 v[64:79], a[28:31], v[44:47], v[64:79]
    buffer_load_dwordx4 v1, s[8:11], s24 offen offset:2048 sc1 lds
    ds_read_b128 v[40:43], v2 offset:14336
    s_waitcnt lgkmcnt(6)
    v_mfma_f32_32x32x16_bf16 v[48:63], a[32:35], v[16:19], v[48:63]
    ds_read_b128 v[44:47], v2 offset:15360
    s_waitcnt lgkmcnt(6)
    v_mfma_f32_32x32x16_bf16 v[64:79], a[36:39], v[20:23], v[64:79]
    ds_read_b128 v[16:19], v2 offset:16384
    s_waitcnt lgkmcnt(6)
    v_mfma_f32_32x32x16_bf16 v[48:63], a[40:43], v[24:27], v[48:63]
    buffer_load_dwordx4 v1, s[8:11], s24 offen offset:3072 sc1 lds
    ds_read_b128 v[20:23], v2 offset:17408
    s_waitcnt lgkmcnt(6)
    v_mfma_f32_32x32x16_bf16 v[64:79], a[44:47], v[28:31], v[64:79]
    ds_read_b128 v[24:27], v2 offset:18432
    s_waitcnt lgkmcnt(6)
    v_mfma_f32_32x32x16_bf16 v[48:63], a[48:51], v[32:35], v[48:63]
    ds_read_b128 v[28:31], v2 offset:19456
    s_waitcnt lgkmcnt(6)
    v_mfma_f32_32x32x16_bf16 v[64:79], a[52:55], v[36:39], v[64:79]
    s_add_u32 s24, s24, 4096
    s_add_u32 s25, s25, 4096
    s_mov_b32 m0, s25
    s_nop 0
    buffer_load_dwordx4 v1, s[8:11], s24 offen offset:0 sc1 lds
    ds_read_b128 v[32:35], v2 offset:20480
    s_waitcnt lgkmcnt(6)
    v_mfma_f32_32x32x16_bf16 v[48:63], a[56:59], v[40:43], v[48:63]
    ds_read_b128 v[36:39], v2 offset:21504
    s_waitcnt lgkmcnt(6)
    v_mfma_f32_32x32x16_bf16 v[64:79], a[60:63], v[44:47], v[64:79]
    ds_read_b128 v[40:43], v2 offset:22528
    s_waitcnt lgkmcnt(6)
    v_mfma_f32_32x32x16_bf16 v[48:63], a[64:67], v[16:19], v[48:63]
    buffer_load_dwordx4 v1, s[8:11], s24 offen offset:1024 sc1 lds
    ds_read_b128 v[44:47], v2 offset:23552
    s_waitcnt lgkmcnt(6)
    v_mfma_f32_32x32x16_bf16 v[64:79], a[68:71], v[20:23], v[64:79]
    ds_read_b128 v[16:19], v2 offset:24576
    s_waitcnt lgkmcnt(6)
    v_mfma_f32_32x32x16_bf16 v[48:63], a[72:75], v[24:27], v[48:63]
    ds_read_b128 v[20:23], v2 offset:25600
    s_waitcnt lgkmcnt(6)
    v_mfma_f32_32x32x16_bf16 v[64:79], a[76:79], v[28:31], v[64:79]
    buffer_load_dwordx4 v1, s[8:11], s24 offen offset:2048 sc1 lds
    ds_read_b128 v[24:27], v2 offset:26624
    s_waitcnt lgkmcnt(6)
    v_mfma_f32_32x32x16_bf16 v[48:63], a[80:83], v[32:35], v[48:63]
    ds_read_b128 v[28:31], v2 offset:27648
    s_waitcnt lgkmcnt(6)
    v_mfma_f32_32x32x16_bf16 v[64:79], a[84:87], v[36:39], v[64:79]
    ds_read_b128 v[32:35], v2 offset:28672
    s_waitcnt lgkmcnt(6)
    v_mfma_f32_32x32x16_bf16 v[48:63], a[88:91], v[40:43], v[48:63]
    buffer_load_dwordx4 v1, s[8:11], s24 offen offset:3072 sc1 lds
    ds_read_b128 v[36:39], v2 offset:29696
    s_waitcnt lgkmcnt(6)
    v_mfma_f32_32x32x16_bf16 v[64:79], a[92:95], v[44:47], v[64:79]
    ds_read_b128 v[40:43], v2 offset:30720
    s_waitcnt lgkmcnt(6)
    v_mfma_f32_32x32x16_bf16 v[48:63], a[96:99], v[16:19], v[48:63]
    ds_read_b128 v[44:47], v2 offset:31744
    s_waitcnt lgkmcnt(6)
    v_mfma_f32_32x32x16_bf16 v[64:79], a[100:103], v[20:23], v[64:79]
    s_add_u32 s24, s24, 4096
    s_add_u32 s25, s25, 4096
    s_mov_b32 m0, s25
    s_nop 0
    buffer_load_dwordx4 v1, s[8:11], s24 offen offset:0 sc1 lds
    ds_read_b128 v[16:19], v2 offset:32768
    s_waitcnt lgkmcnt(6)
    v_mfma_f32_32x32x16_bf16 v[48:63], a[104:107], v[24:27], v[48:63]
    ds_read_b128 v[20:23], v2 offset:33792
    s_waitcnt lgkmcnt(6)
    v_mfma_f32_32x32x16_bf16 v[64:79], a[108:111], v[28:31], v[64:79]
    ds_read_b128 v[24:27], v2 offset:34816
    s_waitcnt lgkmcnt(6)
    v_mfma_f32_32x32x16_bf16 v[48:63], a[112:115], v[32:35], v[48:63]
    buffer_load_dwordx4 v1, s[8:11], s24 offen offset:1024 sc1 lds
    ds_read_b128 v[28:31], v2 offset:35840
    s_waitcnt lgkmcnt(6)
    v_mfma_f32_32x32x16_bf16 v[64:79], a[116:119], v[36:39], v[64:79]
    ds_read_b128 v[32:35], v2 offset:36864
    s_waitcnt lgkmcnt(6)
    v_mfma_f32_32x32x16_bf16 v[48:63], a[120:123], v[40:43], v[48:63]
    ds_read_b128 v[36:39], v2 offset:37888
    s_waitcnt lgkmcnt(6)
    v_mfma_f32_32x32x16_bf16 v[64:79], a[124:127], v[44:47], v[64:79]
    ds_read_b128 v[40:43], v2 offset:38912
    s_waitcnt lgkmcnt(6)
    v_mfma_f32_32x32x16_bf16 v[48:63], a[128:131], v[16:19], v[48:63]
    ds_read_b128 v[44:47], v2 offset:39936
    s_waitcnt lgkmcnt(6)
    v_mfma_f32_32x32x16_bf16 v[64:79], a[132:135], v[20:23], v[64:79]
    s_waitcnt lgkmcnt(5)
    v_mfma_f32_32x32x16_bf16 v[48:63], a[136:139], v[24:27], v[48:63]
    s_waitcnt lgkmcnt(4)
    v_mfma_f32_32x32x16_bf16 v[64:79], a[140:143], v[28:31], v[64:79]
    s_waitcnt lgkmcnt(3)
    v_mfma_f32_32x32x16_bf16 v[48:63], a[144:147], v[32:35], v[48:63]
    s_waitcnt lgkmcnt(2)
    v_mfma_f32_32x32x16_bf16 v[64:79], a[148:151], v[36:39], v[64:79]
    s_waitcnt lgkmcnt(1)
    v_mfma_f32_32x32x16_bf16 v[48:63], a[152:155], v[40:43], v[48:63]
    s_waitcnt lgkmcnt(0)
    v_mfma_f32_32x32x16_bf16 v[64:79], a[156:159], v[44:47], v[64:79]
    s_waitcnt vmcnt(12)
    s_nop 7
    s_nop 3
    v_add_f32 v48, v48, v64
    v_add_f32 v49, v49, v65
    v_add_f32 v50, v50, v66
    v_add_f32 v51, v51, v67
    v_add_f32 v52, v52, v68
    v_add_f32 v53, v53, v69
    v_add_f32 v54, v54, v70
    v_add_f32 v55, v55, v71
    v_add_f32 v56, v56, v72
    v_add_f32 v57, v57, v73
    v_add_f32 v58, v58, v74
    v_add_f32 v59, v59, v75
    v_add_f32 v60, v60, v76
    v_add_f32 v61, v61, v77
    v_add_f32 v62, v62, v78
    v_add_f32 v63, v63, v79
    s_add_u32 s26, s19, 226492416
    v_cvt_pk_bf16_f32 v80, v48, v49
    v_cvt_pk_bf16_f32 v81, v50, v51
    v_cvt_pk_bf16_f32 v82, v52, v53
    v_cvt_pk_bf16_f32 v83, v54, v55
    s_nop 1
    v_permlane32_swap_b32 v80, v82
    v_permlane32_swap_b32 v81, v83
    s_nop 1
    v_lshlrev_b32 v88, 16, v80
    v_and_b32 v89, 0xffff0000, v80
    v_lshlrev_b32 v90, 16, v96
    v_and_b32 v91, 0xffff0000, v96
    v_add_f32 v88, v88, v90
    v_add_f32 v89, v89, v91
    v_cvt_pk_bf16_f32 v80, v88, v89
    v_lshlrev_b32 v92, 16, v81
    v_and_b32 v93, 0xffff0000, v81
    v_lshlrev_b32 v94, 16, v97
    v_and_b32 v95, 0xffff0000, v97
    v_add_f32 v92, v92, v94
    v_add_f32 v93, v93, v95
    v_cvt_pk_bf16_f32 v81, v92, v93
    v_lshlrev_b32 v88, 16, v82
    v_and_b32 v89, 0xffff0000, v82
    v_lshlrev_b32 v90, 16, v98
    v_and_b32 v91, 0xffff0000, v98
    v_add_f32 v88, v88, v90
    v_add_f32 v89, v89, v91
    v_cvt_pk_bf16_f32 v82, v88, v89
    v_lshlrev_b32 v92, 16, v83
    v_and_b32 v93, 0xffff0000, v83
    v_lshlrev_b32 v94, 16, v99
    v_and_b32 v95, 0xffff0000, v99
    v_add_f32 v92, v92, v94
    v_add_f32 v93, v93, v95
    v_cvt_pk_bf16_f32 v83, v92, v93
    buffer_store_dwordx4 v[80:83], v3, s[8:11], s26 offen offset:0 sc1
    v_cvt_pk_bf16_f32 v84, v56, v57
    v_cvt_pk_bf16_f32 v85, v58, v59
    v_cvt_pk_bf16_f32 v86, v60, v61
    v_cvt_pk_bf16_f32 v87, v62, v63
    s_nop 1
    v_permlane32_swap_b32 v84, v86
    v_permlane32_swap_b32 v85, v87
    s_nop 1
    v_lshlrev_b32 v88, 16, v84
    v_and_b32 v89, 0xffff0000, v84
    v_lshlrev_b32 v90, 16, v100
    v_and_b32 v91, 0xffff0000, v100
    v_add_f32 v88, v88, v90
    v_add_f32 v89, v89, v91
    v_cvt_pk_bf16_f32 v84, v88, v89
    v_lshlrev_b32 v92, 16, v85
    v_and_b32 v93, 0xffff0000, v85
    v_lshlrev_b32 v94, 16, v101
    v_and_b32 v95, 0xffff0000, v101
    v_add_f32 v92, v92, v94
    v_add_f32 v93, v93, v95
    v_cvt_pk_bf16_f32 v85, v92, v93
    v_lshlrev_b32 v88, 16, v86
    v_and_b32 v89, 0xffff0000, v86
    v_lshlrev_b32 v90, 16, v102
    v_and_b32 v91, 0xffff0000, v102
    v_add_f32 v88, v88, v90
    v_add_f32 v89, v89, v91
    v_cvt_pk_bf16_f32 v86, v88, v89
    v_lshlrev_b32 v92, 16, v87
    v_and_b32 v93, 0xffff0000, v87
    v_lshlrev_b32 v94, 16, v103
    v_and_b32 v95, 0xffff0000, v103
    v_add_f32 v92, v92, v94
    v_add_f32 v93, v93, v95
    v_cvt_pk_bf16_f32 v87, v92, v93
    buffer_store_dwordx4 v[84:87], v3, s[8:11], s26 offen offset:32 sc1
    s_waitcnt vmcnt(0)
    s_mov_b64 exec, 1
    s_add_u32 s26, s48, s20
    buffer_store_dword v5, v4, s[8:11], s26 offen sc1
    s_mov_b64 exec, -1
    s_add_u32 s20, s20, 128
    s_add_u32 s19, s19, 40960
    s_add_u32 s16, s16, 40960
    s_cmp_eq_u32 s16, 122880
    s_cselect_b32 s16, 0, s16
    s_add_u32 s14, s14, 1
    s_cmp_ge_u32 s14, s15
    s_cbranch_scc1 layerb1_kernel_ab_fin
    s_add_u32 s23, s14, 2
    s_cmp_lg_u32 s13, 0
    s_cbranch_scc1 layerb1_kernel_ab_ow6
    s_min_u32 s28, s23, 63
    s_cmp_gt_u32 s22, s28
    s_cbranch_scc1 layerb1_kernel_ab_ow6
layerb1_kernel_ab_op6:
    buffer_load_dwordx4 v[116:119], v1, s[8:11], s29 offen sc1
    s_waitcnt vmcnt(0)
    v_min_u32 v116, v116, v117
    v_min_u32 v118, v118, v119
    v_min_u32 v114, v116, v118
    v_cmp_eq_u32 vcc, 0, v114
    s_nop 1
    s_ff1_i32_b64 s22, vcc
    s_min_u32 s22, s22, 64
    s_and_b32 s22, s22, 0x7c
    s_sub_u32 s30, s30, 1
    s_cbranch_scc1 layerb1_kernel_bail
    s_cmp_gt_u32 s22, s28
    s_cbranch_scc0 layerb1_kernel_ab_op6
layerb1_kernel_ab_ow6:
    s_barrier
    v_add_u32 v2, s16, v1
    ds_read_b128 v[16:19], v2 offset:0
    ds_read_b128 v[20:23], v2 offset:1024
    ds_read_b128 v[24:27], v2 offset:2048
    ds_read_b128 v[28:31], v2 offset:3072
    ds_read_b128 v[32:35], v2 offset:4096
    ds_read_b128 v[36:39], v2 offset:5120
    s_add_u32 s27, s19, 40960
    s_cmp_ge_u32 s14, 63
    s_cselect_b32 s27, s19, s27
    buffer_load_dwordx4 v[96:99], v3, s[52:55], s27 offen offset:0
    buffer_load_dwordx4 v[100:103], v3, s[52:55], s27 offen offset:32
    s_add_u32 s23, s14, 2
    s_min_u32 s24, s23, 63
    s_mul_i32 s24, s24, 40960
    s_add_u32 s24, s24, s18
    s_mul_i32 s25, s13, 10240
    s_add_u32 s25, s25, s17
    s_add_u32 s17, s17, 40960
    s_cmp_eq_u32 s17, 122880
    s_cselect_b32 s17, 0, s17
    ds_read_b128 v[40:43], v2 offset:6144
    s_waitcnt lgkmcnt(6)
    v_mfma_f32_32x32x16_bf16 v[48:63], a[0:3], v[16:19], 0
    ds_read_b128 v[44:47], v2 offset:7168
    s_waitcnt lgkmcnt(6)
    v_mfma_f32_32x32x16_bf16 v[64:79], a[4:7], v[20:23], 0
    s_mov_b32 m0, s25
    s_nop 0
    buffer_load_dwordx4 v1, s[8:11], s24 offen offset:0 sc1 lds
    ds_read_b128 v[16:19], v2 offset:8192
    s_waitcnt lgkmcnt(6)
    v_mfma_f32_32x32x16_bf16 v[48:63], a[8:11], v[24:27], v[48:63]
    ds_read_b128 v[20:23], v2 offset:9216
    s_waitcnt lgkmcnt(6)
    v_mfma_f32_32x32x16_bf16 v[64:79], a[12:15], v[28:31], v[64:79]
    ds_read_b128 v[24:27], v2 offset:10240
    s_waitcnt lgkmcnt(6)
    v_mfma_f32_32x32x16_bf16 v[48:63], a[16:19], v[32:35], v[48:63]
    buffer_load_dwordx4 v1, s[8:11], s24 offen offset:1024 sc1 lds
    ds_read_b128 v[28:31], v2 offset:11264
    s_waitcnt lgkmcnt(6)
    v_mfma_f32_32x32x16_bf16 v[64:79], a[20:23], v[36:39], v[64:79]
    ds_read_b128 v[32:35], v2 offset:12288
    s_waitcnt lgkmcnt(6)
    v_mfma_f32_32x32x16_bf16 v[48:63], a[24:27], v[40:43], v[48:63]
    ds_read_b128 v[36:39], v2 offset:13312
    s_waitcnt lgkmcnt(6)
    v_mfma_f32_32x32x16_bf16 v[64:79], a[28:31], v[44:47], v[64:79]
    buffer_load_dwordx4 v1, s[8:11], s24 offen offset:2048 sc1 lds
    ds_read_b128 v[40:43], v2 offset:14336
    s_waitcnt lgkmcnt(6)
    v_mfma_f32_32x32x16_bf16 v[48:63], a[32:35], v[16:19], v[48:63]
    ds_read_b128 v[44:47], v2 offset:15360
    s_waitcnt lgkmcnt(6)
    v_mfma_f32_32x32x16_bf16 v[64:79], a[36:39], v[20:23], v[64:79]
    ds_read_b128 v[16:19], v2 offset:16384
    s_waitcnt lgkmcnt(6)
    v_mfma_f32_32x32x16_bf16 v[48:63], a[40:43], v[24:27], v[48:63]
    buffer_load_dwordx4 v1, s[8:11], s24 offen offset:3072 sc1 lds
    ds_read_b128 v[20:23], v2 offset:17408
    s_waitcnt lgkmcnt(6)
    v_mfma_f32_32x32x16_bf16 v[64:79], a[44:47], v[28:31], v[64:79]
    ds_read_b128 v[24:27], v2 offset:18432
    s_waitcnt lgkmcnt(6)
    v_mfma_f32_32x32x16_bf16 v[48:63], a[48:51], v[32:35], v[48:63]
    ds_read_b128 v[28:31], v2 offset:19456
    s_waitcnt lgkmcnt(6)
    v_mfma_f32_32x32x16_bf16 v[64:79], a[52:55], v[36:39], v[64:79]
    s_add_u32 s24, s24, 4096
    s_add_u32 s25, s25, 4096
    s_mov_b32 m0, s25
    s_nop 0
    buffer_load_dwordx4 v1, s[8:11], s24 offen offset:0 sc1 lds
    ds_read_b128 v[32:35], v2 offset:20480
    s_waitcnt lgkmcnt(6)
    v_mfma_f32_32x32x16_bf16 v[48:63], a[56:59], v[40:43], v[48:63]
    ds_read_b128 v[36:39], v2 offset:21504
    s_waitcnt lgkmcnt(6)
    v_mfma_f32_32x32x16_bf16 v[64:79], a[60:63], v[44:47], v[64:79]
    ds_read_b128 v[40:43], v2 offset:22528
    s_waitcnt lgkmcnt(6)
    v_mfma_f32_32x32x16_bf16 v[48:63], a[64:67], v[16:19], v[48:63]
    buffer_load_dwordx4 v1, s[8:11], s24 offen offset:1024 sc1 lds
    ds_read_b128 v[44:47], v2 offset:23552
    s_waitcnt lgkmcnt(6)
    v_mfma_f32_32x32x16_bf16 v[64:79], a[68:71], v[20:23], v[64:79]
    ds_read_b128 v[16:19], v2 offset:24576
    s_waitcnt lgkmcnt(6)
    v_mfma_f32_32x32x16_bf16 v[48:63], a[72:75], v[24:27], v[48:63]
    ds_read_b128 v[20:23], v2 offset:25600
    s_waitcnt lgkmcnt(6)
    v_mfma_f32_32x32x16_bf16 v[64:79], a[76:79], v[28:31], v[64:79]
    buffer_load_dwordx4 v1, s[8:11], s24 offen offset:2048 sc1 lds
    ds_read_b128 v[24:27], v2 offset:26624
    s_waitcnt lgkmcnt(6)
    v_mfma_f32_32x32x16_bf16 v[48:63], a[80:83], v[32:35], v[48:63]
    ds_read_b128 v[28:31], v2 offset:27648
    s_waitcnt lgkmcnt(6)
    v_mfma_f32_32x32x16_bf16 v[64:79], a[84:87], v[36:39], v[64:79]
    ds_read_b128 v[32:35], v2 offset:28672
    s_waitcnt lgkmcnt(6)
    v_mfma_f32_32x32x16_bf16 v[48:63], a[88:91], v[40:43], v[48:63]
    buffer_load_dwordx4 v1, s[8:11], s24 offen offset:3072 sc1 lds
    ds_read_b128 v[36:39], v2 offset:29696
    s_waitcnt lgkmcnt(6)
    v_mfma_f32_32x32x16_bf16 v[64:79], a[92:95], v[44:47], v[64:79]
    ds_read_b128 v[40:43], v2 offset:30720
    s_waitcnt lgkmcnt(6)
    v_mfma_f32_32x32x16_bf16 v[48:63], a[96:99], v[16:19], v[48:63]
    ds_read_b128 v[44:47], v2 offset:31744
    s_waitcnt lgkmcnt(6)
    v_mfma_f32_32x32x16_bf16 v[64:79], a[100:103], v[20:23], v[64:79]
    s_add_u32 s24, s24, 4096
    s_add_u32 s25, s25, 4096
    s_mov_b32 m0, s25
    s_nop 0
    buffer_load_dwordx4 v1, s[8:11], s24 offen offset:0 sc1 lds
    ds_read_b128 v[16:19], v2 offset:32768
    s_waitcnt lgkmcnt(6)
    v_mfma_f32_32x32x16_bf16 v[48:63], a[104:107], v[24:27], v[48:63]
    ds_read_b128 v[20:23], v2 offset:33792
    s_waitcnt lgkmcnt(6)
    v_mfma_f32_32x32x16_bf16 v[64:79], a[108:111], v[28:31], v[64:79]
    ds_read_b128 v[24:27], v2 offset:34816
    s_waitcnt lgkmcnt(6)
    v_mfma_f32_32x32x16_bf16 v[48:63], a[112:115], v[32:35], v[48:63]
    buffer_load_dwordx4 v1, s[8:11], s24 offen offset:1024 sc1 lds
    ds_read_b128 v[28:31], v2 offset:35840
    s_waitcnt lgkmcnt(6)
    v_mfma_f32_32x32x16_bf16 v[64:79], a[116:119], v[36:39], v[64:79]
    ds_read_b128 v[32:35], v2 offset:36864
    s_waitcnt lgkmcnt(6)
    v_mfma_f32_32x32x16_bf16 v[48:63], a[120:123], v[40:43], v[48:63]
    ds_read_b128 v[36:39], v2 offset:37888
    s_waitcnt lgkmcnt(6)
    v_mfma_f32_32x32x16_bf16 v[64:79], a[124:127], v[44:47], v[64:79]
    ds_read_b128 v[40:43], v2 offset:38912
    s_waitcnt lgkmcnt(6)
    v_mfma_f32_32x32x16_bf16 v[48:63], a[128:131], v[16:19], v[48:63]
    ds_read_b128 v[44:47], v2 offset:39936
    s_waitcnt lgkmcnt(6)
    v_mfma_f32_32x32x16_bf16 v[64:79], a[132:135], v[20:23], v[64:79]
    s_waitcnt lgkmcnt(5)
    v_mfma_f32_32x32x16_bf16 v[48:63], a[136:139], v[24:27], v[48:63]
    s_waitcnt lgkmcnt(4)
    v_mfma_f32_32x32x16_bf16 v[64:79], a[140:143], v[28:31], v[64:79]
    s_waitcnt lgkmcnt(3)
    v_mfma_f32_32x32x16_bf16 v[48:63], a[144:147], v[32:35], v[48:63]
    s_waitcnt lgkmcnt(2)
    v_mfma_f32_32x32x16_bf16 v[64:79], a[148:151], v[36:39], v[64:79]
    s_waitcnt lgkmcnt(1)
    v_mfma_f32_32x32x16_bf16 v[48:63], a[152:155], v[40:43], v[48:63]
    s_waitcnt lgkmcnt(0)
    v_mfma_f32_32x32x16_bf16 v[64:79], a[156:159], v[44:47], v[64:79]
    s_waitcnt vmcnt(12)
    s_nop 7
    s_nop 3
    v_add_f32 v48, v48, v64
    v_add_f32 v49, v49, v65
    v_add_f32 v50, v50, v66
    v_add_f32 v51, v51, v67
    v_add_f32 v52, v52, v68
    v_add_f32 v53, v53, v69
    v_add_f32 v54, v54, v70
    v_add_f32 v55, v55, v71
    v_add_f32 v56, v56, v72
    v_add_f32 v57, v57, v73
    v_add_f32 v58, v58, v74
    v_add_f32 v59, v59, v75
    v_add_f32 v60, v60, v76
    v_add_f32 v61, v61, v77
    v_add_f32 v62, v62, v78
    v_add_f32 v63, v63, v79
    s_add_u32 s26, s19, 226492416
    v_cvt_pk_bf16_f32 v80, v48, v49
    v_cvt_pk_bf16_f32 v81, v50, v51
    v_cvt_pk_bf16_f32 v82, v52, v53
    v_cvt_pk_bf16_f32 v83, v54, v55
    s_nop 1
    v_permlane32_swap_b32 v80, v82
    v_permlane32_swap_b32 v81, v83
    s_nop 1
    v_lshlrev_b32 v88, 16, v80
    v_and_b32 v89, 0xffff0000, v80
    v_lshlrev_b32 v90, 16, v104
    v_and_b32 v91, 0xffff0000, v104
    v_add_f32 v88, v88, v90
    v_add_f32 v89, v89, v91
    v_cvt_pk_bf16_f32 v80, v88, v89
    v_lshlrev_b32 v92, 16, v81
    v_and_b32 v93, 0xffff0000, v81
    v_lshlrev_b32 v94, 16, v105
    v_and_b32 v95, 0xffff0000, v105
    v_add_f32 v92, v92, v94
    v_add_f32 v93, v93, v95
    v_cvt_pk_bf16_f32 v81, v92, v93
    v_lshlrev_b32 v88, 16, v82
    v_and_b32 v89, 0xffff0000, v82
    v_lshlrev_b32 v90, 16, v106
    v_and_b32 v91, 0xffff0000, v106
    v_add_f32 v88, v88, v90
    v_add_f32 v89, v89, v91
    v_cvt_pk_bf16_f32 v82, v88, v89
    v_lshlrev_b32 v92, 16, v83
    v_and_b32 v93, 0xffff0000, v83
    v_lshlrev_b32 v94, 16, v107
    v_and_b32 v95, 0xffff0000, v107
    v_add_f32 v92, v92, v94
    v_add_f32 v93, v93, v95
    v_cvt_pk_bf16_f32 v83, v92, v93
    buffer_store_dwordx4 v[80:83], v3, s[8:11], s26 offen offset:0 sc1
    v_cvt_pk_bf16_f32 v84, v56, v57
    v_cvt_pk_bf16_f32 v85, v58, v59
    v_cvt_pk_bf16_f32 v86, v60, v61
    v_cvt_pk_bf16_f32 v87, v62, v63
    s_nop 1
    v_permlane32_swap_b32 v84, v86
    v_permlane32_swap_b32 v85, v87
    s_nop 1
    v_lshlrev_b32 v88, 16, v84
    v_and_b32 v89, 0xffff0000, v84
    v_lshlrev_b32 v90, 16, v108
    v_and_b32 v91, 0xffff0000, v108
    v_add_f32 v88, v88, v90
    v_add_f32 v89, v89, v91
    v_cvt_pk_bf16_f32 v84, v88, v89
    v_lshlrev_b32 v92, 16, v85
    v_and_b32 v93, 0xffff0000, v85
    v_lshlrev_b32 v94, 16, v109
    v_and_b32 v95, 0xffff0000, v109
    v_add_f32 v92, v92, v94
    v_add_f32 v93, v93, v95
    v_cvt_pk_bf16_f32 v85, v92, v93
    v_lshlrev_b32 v88, 16, v86
    v_and_b32 v89, 0xffff0000, v86
    v_lshlrev_b32 v90, 16, v110
    v_and_b32 v91, 0xffff0000, v110
    v_add_f32 v88, v88, v90
    v_add_f32 v89, v89, v91
    v_cvt_pk_bf16_f32 v86, v88, v89
    v_lshlrev_b32 v92, 16, v87
    v_and_b32 v93, 0xffff0000, v87
    v_lshlrev_b32 v94, 16, v111
    v_and_b32 v95, 0xffff0000, v111
    v_add_f32 v92, v92, v94
    v_add_f32 v93, v93, v95
    v_cvt_pk_bf16_f32 v87, v92, v93
    buffer_store_dwordx4 v[84:87], v3, s[8:11], s26 offen offset:32 sc1
    s_waitcnt vmcnt(0)
    s_mov_b64 exec, 1
    s_add_u32 s26, s48, s20
    buffer_store_dword v5, v4, s[8:11], s26 offen sc1
    s_mov_b64 exec, -1
    s_add_u32 s20, s20, 128
    s_add_u32 s19, s19, 40960
    s_add_u32 s16, s16, 40960
    s_cmp_eq_u32 s16, 122880
    s_cselect_b32 s16, 0, s16
    s_add_u32 s14, s14, 1
    s_cmp_ge_u32 s14, s15
    s_cbranch_scc1 layerb1_kernel_ab_fin
    s_add_u32 s23, s14, 2
    s_cmp_lg_u32 s13, 0
    s_cbranch_scc1 layerb1_kernel_ab_ow7
    s_min_u32 s28, s23, 63
    s_cmp_gt_u32 s22, s28
    s_cbranch_scc1 layerb1_kernel_ab_ow7
layerb1_kernel_ab_op7:
    buffer_load_dwordx4 v[116:119], v1, s[8:11], s29 offen sc1
    s_waitcnt vmcnt(0)
    v_min_u32 v116, v116, v117
    v_min_u32 v118, v118, v119
    v_min_u32 v114, v116, v118
    v_cmp_eq_u32 vcc, 0, v114
    s_nop 1
    s_ff1_i32_b64 s22, vcc
    s_min_u32 s22, s22, 64
    s_and_b32 s22, s22, 0x7c
    s_sub_u32 s30, s30, 1
    s_cbranch_scc1 layerb1_kernel_bail
    s_cmp_gt_u32 s22, s28
    s_cbranch_scc0 layerb1_kernel_ab_op7
layerb1_kernel_ab_ow7:
    s_barrier
    v_add_u32 v2, s16, v1
    ds_read_b128 v[16:19], v2 offset:0
    ds_read_b128 v[20:23], v2 offset:1024
    ds_read_b128 v[24:27], v2 offset:2048
    ds_read_b128 v[28:31], v2 offset:3072
    ds_read_b128 v[32:35], v2 offset:4096
    ds_read_b128 v[36:39], v2 offset:5120
    s_add_u32 s27, s19, 40960
    s_cmp_ge_u32 s14, 63
    s_cselect_b32 s27, s19, s27
    buffer_load_dwordx4 v[104:107], v3, s[52:55], s27 offen offset:0
    buffer_load_dwordx4 v[108:111], v3, s[52:55], s27 offen offset:32
    s_add_u32 s23, s14, 2
    s_min_u32 s24, s23, 63
    s_mul_i32 s24, s24, 40960
    s_add_u32 s24, s24, s18
    s_mul_i32 s25, s13, 10240
    s_add_u32 s25, s25, s17
    s_add_u32 s17, s17, 40960
    s_cmp_eq_u32 s17, 122880
    s_cselect_b32 s17, 0, s17
    ds_read_b128 v[40:43], v2 offset:6144
    s_waitcnt lgkmcnt(6)
    v_mfma_f32_32x32x16_bf16 v[48:63], a[0:3], v[16:19], 0
    ds_read_b128 v[44:47], v2 offset:7168
    s_waitcnt lgkmcnt(6)
    v_mfma_f32_32x32x16_bf16 v[64:79], a[4:7], v[20:23], 0
    s_mov_b32 m0, s25
    s_nop 0
    buffer_load_dwordx4 v1, s[8:11], s24 offen offset:0 sc1 lds
    ds_read_b128 v[16:19], v2 offset:8192
    s_waitcnt lgkmcnt(6)
    v_mfma_f32_32x32x16_bf16 v[48:63], a[8:11], v[24:27], v[48:63]
    ds_read_b128 v[20:23], v2 offset:9216
    s_waitcnt lgkmcnt(6)
    v_mfma_f32_32x32x16_bf16 v[64:79], a[12:15], v[28:31], v[64:79]
    ds_read_b128 v[24:27], v2 offset:10240
    s_waitcnt lgkmcnt(6)
    v_mfma_f32_32x32x16_bf16 v[48:63], a[16:19], v[32:35], v[48:63]
    buffer_load_dwordx4 v1, s[8:11], s24 offen offset:1024 sc1 lds
    ds_read_b128 v[28:31], v2 offset:11264
    s_waitcnt lgkmcnt(6)
    v_mfma_f32_32x32x16_bf16 v[64:79], a[20:23], v[36:39], v[64:79]
    ds_read_b128 v[32:35], v2 offset:12288
    s_waitcnt lgkmcnt(6)
    v_mfma_f32_32x32x16_bf16 v[48:63], a[24:27], v[40:43], v[48:63]
    ds_read_b128 v[36:39], v2 offset:13312
    s_waitcnt lgkmcnt(6)
    v_mfma_f32_32x32x16_bf16 v[64:79], a[28:31], v[44:47], v[64:79]
    buffer_load_dwordx4 v1, s[8:11], s24 offen offset:2048 sc1 lds
    ds_read_b128 v[40:43], v2 offset:14336
    s_waitcnt lgkmcnt(6)
    v_mfma_f32_32x32x16_bf16 v[48:63], a[32:35], v[16:19], v[48:63]
    ds_read_b128 v[44:47], v2 offset:15360
    s_waitcnt lgkmcnt(6)
    v_mfma_f32_32x32x16_bf16 v[64:79], a[36:39], v[20:23], v[64:79]
    ds_read_b128 v[16:19], v2 offset:16384
    s_waitcnt lgkmcnt(6)
    v_mfma_f32_32x32x16_bf16 v[48:63], a[40:43], v[24:27], v[48:63]
    buffer_load_dwordx4 v1, s[8:11], s24 offen offset:3072 sc1 lds
    ds_read_b128 v[20:23], v2 offset:17408
    s_waitcnt lgkmcnt(6)
    v_mfma_f32_32x32x16_bf16 v[64:79], a[44:47], v[28:31], v[64:79]
    ds_read_b128 v[24:27], v2 offset:18432
    s_waitcnt lgkmcnt(6)
    v_mfma_f32_32x32x16_bf16 v[48:63], a[48:51], v[32:35], v[48:63]
    ds_read_b128 v[28:31], v2 offset:19456
    s_waitcnt lgkmcnt(6)
    v_mfma_f32_32x32x16_bf16 v[64:79], a[52:55], v[36:39], v[64:79]
    s_add_u32 s24, s24, 4096
    s_add_u32 s25, s25, 4096
    s_mov_b32 m0, s25
    s_nop 0
    buffer_load_dwordx4 v1, s[8:11], s24 offen offset:0 sc1 lds
    ds_read_b128 v[32:35], v2 offset:20480
    s_waitcnt lgkmcnt(6)
    v_mfma_f32_32x32x16_bf16 v[48:63], a[56:59], v[40:43], v[48:63]
    ds_read_b128 v[36:39], v2 offset:21504
    s_waitcnt lgkmcnt(6)
    v_mfma_f32_32x32x16_bf16 v[64:79], a[60:63], v[44:47], v[64:79]
    ds_read_b128 v[40:43], v2 offset:22528
    s_waitcnt lgkmcnt(6)
    v_mfma_f32_32x32x16_bf16 v[48:63], a[64:67], v[16:19], v[48:63]
    buffer_load_dwordx4 v1, s[8:11], s24 offen offset:1024 sc1 lds
    ds_read_b128 v[44:47], v2 offset:23552
    s_waitcnt lgkmcnt(6)
    v_mfma_f32_32x32x16_bf16 v[64:79], a[68:71], v[20:23], v[64:79]
    ds_read_b128 v[16:19], v2 offset:24576
    s_waitcnt lgkmcnt(6)
    v_mfma_f32_32x32x16_bf16 v[48:63], a[72:75], v[24:27], v[48:63]
    ds_read_b128 v[20:23], v2 offset:25600
    s_waitcnt lgkmcnt(6)
    v_mfma_f32_32x32x16_bf16 v[64:79], a[76:79], v[28:31], v[64:79]
    buffer_load_dwordx4 v1, s[8:11], s24 offen offset:2048 sc1 lds
    ds_read_b128 v[24:27], v2 offset:26624
    s_waitcnt lgkmcnt(6)
    v_mfma_f32_32x32x16_bf16 v[48:63], a[80:83], v[32:35], v[48:63]
    ds_read_b128 v[28:31], v2 offset:27648
    s_waitcnt lgkmcnt(6)
    v_mfma_f32_32x32x16_bf16 v[64:79], a[84:87], v[36:39], v[64:79]
    ds_read_b128 v[32:35], v2 offset:28672
    s_waitcnt lgkmcnt(6)
    v_mfma_f32_32x32x16_bf16 v[48:63], a[88:91], v[40:43], v[48:63]
    buffer_load_dwordx4 v1, s[8:11], s24 offen offset:3072 sc1 lds
    ds_read_b128 v[36:39], v2 offset:29696
    s_waitcnt lgkmcnt(6)
    v_mfma_f32_32x32x16_bf16 v[64:79], a[92:95], v[44:47], v[64:79]
    ds_read_b128 v[40:43], v2 offset:30720
    s_waitcnt lgkmcnt(6)
    v_mfma_f32_32x32x16_bf16 v[48:63], a[96:99], v[16:19], v[48:63]
    ds_read_b128 v[44:47], v2 offset:31744
    s_waitcnt lgkmcnt(6)
    v_mfma_f32_32x32x16_bf16 v[64:79], a[100:103], v[20:23], v[64:79]
    s_add_u32 s24, s24, 4096
    s_add_u32 s25, s25, 4096
    s_mov_b32 m0, s25
    s_nop 0
    buffer_load_dwordx4 v1, s[8:11], s24 offen offset:0 sc1 lds
    ds_read_b128 v[16:19], v2 offset:32768
    s_waitcnt lgkmcnt(6)
    v_mfma_f32_32x32x16_bf16 v[48:63], a[104:107], v[24:27], v[48:63]
    ds_read_b128 v[20:23], v2 offset:33792
    s_waitcnt lgkmcnt(6)
    v_mfma_f32_32x32x16_bf16 v[64:79], a[108:111], v[28:31], v[64:79]
    ds_read_b128 v[24:27], v2 offset:34816
    s_waitcnt lgkmcnt(6)
    v_mfma_f32_32x32x16_bf16 v[48:63], a[112:115], v[32:35], v[48:63]
    buffer_load_dwordx4 v1, s[8:11], s24 offen offset:1024 sc1 lds
    ds_read_b128 v[28:31], v2 offset:35840
    s_waitcnt lgkmcnt(6)
    v_mfma_f32_32x32x16_bf16 v[64:79], a[116:119], v[36:39], v[64:79]
    ds_read_b128 v[32:35], v2 offset:36864
    s_waitcnt lgkmcnt(6)
    v_mfma_f32_32x32x16_bf16 v[48:63], a[120:123], v[40:43], v[48:63]
    ds_read_b128 v[36:39], v2 offset:37888
    s_waitcnt lgkmcnt(6)
    v_mfma_f32_32x32x16_bf16 v[64:79], a[124:127], v[44:47], v[64:79]
    ds_read_b128 v[40:43], v2 offset:38912
    s_waitcnt lgkmcnt(6)
    v_mfma_f32_32x32x16_bf16 v[48:63], a[128:131], v[16:19], v[48:63]
    ds_read_b128 v[44:47], v2 offset:39936
    s_waitcnt lgkmcnt(6)
    v_mfma_f32_32x32x16_bf16 v[64:79], a[132:135], v[20:23], v[64:79]
    s_waitcnt lgkmcnt(5)
    v_mfma_f32_32x32x16_bf16 v[48:63], a[136:139], v[24:27], v[48:63]
    s_waitcnt lgkmcnt(4)
    v_mfma_f32_32x32x16_bf16 v[64:79], a[140:143], v[28:31], v[64:79]
    s_waitcnt lgkmcnt(3)
    v_mfma_f32_32x32x16_bf16 v[48:63], a[144:147], v[32:35], v[48:63]
    s_waitcnt lgkmcnt(2)
    v_mfma_f32_32x32x16_bf16 v[64:79], a[148:151], v[36:39], v[64:79]
    s_waitcnt lgkmcnt(1)
    v_mfma_f32_32x32x16_bf16 v[48:63], a[152:155], v[40:43], v[48:63]
    s_waitcnt lgkmcnt(0)
    v_mfma_f32_32x32x16_bf16 v[64:79], a[156:159], v[44:47], v[64:79]
    s_waitcnt vmcnt(12)
    s_nop 7
    s_nop 3
    v_add_f32 v48, v48, v64
    v_add_f32 v49, v49, v65
    v_add_f32 v50, v50, v66
    v_add_f32 v51, v51, v67
    v_add_f32 v52, v52, v68
    v_add_f32 v53, v53, v69
    v_add_f32 v54, v54, v70
    v_add_f32 v55, v55, v71
    v_add_f32 v56, v56, v72
    v_add_f32 v57, v57, v73
    v_add_f32 v58, v58, v74
    v_add_f32 v59, v59, v75
    v_add_f32 v60, v60, v76
    v_add_f32 v61, v61, v77
    v_add_f32 v62, v62, v78
    v_add_f32 v63, v63, v79
    s_add_u32 s26, s19, 226492416
    v_cvt_pk_bf16_f32 v80, v48, v49
    v_cvt_pk_bf16_f32 v81, v50, v51
    v_cvt_pk_bf16_f32 v82, v52, v53
    v_cvt_pk_bf16_f32 v83, v54, v55
    s_nop 1
    v_permlane32_swap_b32 v80, v82
    v_permlane32_swap_b32 v81, v83
    s_nop 1
    v_lshlrev_b32 v88, 16, v80
    v_and_b32 v89, 0xffff0000, v80
    v_lshlrev_b32 v90, 16, v96
    v_and_b32 v91, 0xffff0000, v96
    v_add_f32 v88, v88, v90
    v_add_f32 v89, v89, v91
    v_cvt_pk_bf16_f32 v80, v88, v89
    v_lshlrev_b32 v92, 16, v81
    v_and_b32 v93, 0xffff0000, v81
    v_lshlrev_b32 v94, 16, v97
    v_and_b32 v95, 0xffff0000, v97
    v_add_f32 v92, v92, v94
    v_add_f32 v93, v93, v95
    v_cvt_pk_bf16_f32 v81, v92, v93
    v_lshlrev_b32 v88, 16, v82
    v_and_b32 v89, 0xffff0000, v82
    v_lshlrev_b32 v90, 16, v98
    v_and_b32 v91, 0xffff0000, v98
    v_add_f32 v88, v88, v90
    v_add_f32 v89, v89, v91
    v_cvt_pk_bf16_f32 v82, v88, v89
    v_lshlrev_b32 v92, 16, v83
    v_and_b32 v93, 0xffff0000, v83
    v_lshlrev_b32 v94, 16, v99
    v_and_b32 v95, 0xffff0000, v99
    v_add_f32 v92, v92, v94
    v_add_f32 v93, v93, v95
    v_cvt_pk_bf16_f32 v83, v92, v93
    buffer_store_dwordx4 v[80:83], v3, s[8:11], s26 offen offset:0 sc1
    v_cvt_pk_bf16_f32 v84, v56, v57
    v_cvt_pk_bf16_f32 v85, v58, v59
    v_cvt_pk_bf16_f32 v86, v60, v61
    v_cvt_pk_bf16_f32 v87, v62, v63
    s_nop 1
    v_permlane32_swap_b32 v84, v86
    v_permlane32_swap_b32 v85, v87
    s_nop 1
    v_lshlrev_b32 v88, 16, v84
    v_and_b32 v89, 0xffff0000, v84
    v_lshlrev_b32 v90, 16, v100
    v_and_b32 v91, 0xffff0000, v100
    v_add_f32 v88, v88, v90
    v_add_f32 v89, v89, v91
    v_cvt_pk_bf16_f32 v84, v88, v89
    v_lshlrev_b32 v92, 16, v85
    v_and_b32 v93, 0xffff0000, v85
    v_lshlrev_b32 v94, 16, v101
    v_and_b32 v95, 0xffff0000, v101
    v_add_f32 v92, v92, v94
    v_add_f32 v93, v93, v95
    v_cvt_pk_bf16_f32 v85, v92, v93
    v_lshlrev_b32 v88, 16, v86
    v_and_b32 v89, 0xffff0000, v86
    v_lshlrev_b32 v90, 16, v102
    v_and_b32 v91, 0xffff0000, v102
    v_add_f32 v88, v88, v90
    v_add_f32 v89, v89, v91
    v_cvt_pk_bf16_f32 v86, v88, v89
    v_lshlrev_b32 v92, 16, v87
    v_and_b32 v93, 0xffff0000, v87
    v_lshlrev_b32 v94, 16, v103
    v_and_b32 v95, 0xffff0000, v103
    v_add_f32 v92, v92, v94
    v_add_f32 v93, v93, v95
    v_cvt_pk_bf16_f32 v87, v92, v93
    buffer_store_dwordx4 v[84:87], v3, s[8:11], s26 offen offset:32 sc1
    s_waitcnt vmcnt(0)
    s_mov_b64 exec, 1
    s_add_u32 s26, s48, s20
    buffer_store_dword v5, v4, s[8:11], s26 offen sc1
    s_mov_b64 exec, -1
    s_add_u32 s20, s20, 128
    s_add_u32 s19, s19, 40960
    s_add_u32 s16, s16, 40960
    s_cmp_eq_u32 s16, 122880
    s_cselect_b32 s16, 0, s16
    s_add_u32 s14, s14, 1
    s_cmp_ge_u32 s14, s15
    s_cbranch_scc1 layerb1_kernel_ab_fin
    s_add_u32 s23, s14, 2
    s_cmp_lg_u32 s13, 0
    s_cbranch_scc1 layerb1_kernel_ab_ow8
    s_min_u32 s28, s23, 63
    s_cmp_gt_u32 s22, s28
    s_cbranch_scc1 layerb1_kernel_ab_ow8
layerb1_kernel_ab_op8:
    buffer_load_dwordx4 v[116:119], v1, s[8:11], s29 offen sc1
    s_waitcnt vmcnt(0)
    v_min_u32 v116, v116, v117
    v_min_u32 v118, v118, v119
    v_min_u32 v114, v116, v118
    v_cmp_eq_u32 vcc, 0, v114
    s_nop 1
    s_ff1_i32_b64 s22, vcc
    s_min_u32 s22, s22, 64
    s_and_b32 s22, s22, 0x7c
    s_sub_u32 s30, s30, 1
    s_cbranch_scc1 layerb1_kernel_bail
    s_cmp_gt_u32 s22, s28
    s_cbranch_scc0 layerb1_kernel_ab_op8
layerb1_kernel_ab_ow8:
    s_barrier
    v_add_u32 v2, s16, v1
    ds_read_b128 v[16:19], v2 offset:0
    ds_read_b128 v[20:23], v2 offset:1024
    ds_read_b128 v[24:27], v2 offset:2048
    ds_read_b128 v[28:31], v2 offset:3072
    ds_read_b128 v[32:35], v2 offset:4096
    ds_read_b128 v[36:39], v2 offset:5120
    s_add_u32 s27, s19, 40960
    s_cmp_ge_u32 s14, 63
    s_cselect_b32 s27, s19, s27
    buffer_load_dwordx4 v[96:99], v3, s[52:55], s27 offen offset:0
    buffer_load_dwordx4 v[100:103], v3, s[52:55], s27 offen offset:32
    s_add_u32 s23, s14, 2
    s_min_u32 s24, s23, 63
    s_mul_i32 s24, s24, 40960
    s_add_u32 s24, s24, s18
    s_mul_i32 s25, s13, 10240
    s_add_u32 s25, s25, s17
    s_add_u32 s17, s17, 40960
    s_cmp_eq_u32 s17, 122880
    s_cselect_b32 s17, 0, s17
    ds_read_b128 v[40:43], v2 offset:6144
    s_waitcnt lgkmcnt(6)
    v_mfma_f32_32x32x16_bf16 v[48:63], a[0:3], v[16:19], 0
    ds_read_b128 v[44:47], v2 offset:7168
    s_waitcnt lgkmcnt(6)
    v_mfma_f32_32x32x16_bf16 v[64:79], a[4:7], v[20:23], 0
    s_mov_b32 m0, s25
    s_nop 0
    buffer_load_dwordx4 v1, s[8:11], s24 offen offset:0 sc1 lds
    ds_read_b128 v[16:19], v2 offset:8192
    s_waitcnt lgkmcnt(6)
    v_mfma_f32_32x32x16_bf16 v[48:63], a[8:11], v[24:27], v[48:63]
    ds_read_b128 v[20:23], v2 offset:9216
    s_waitcnt lgkmcnt(6)
    v_mfma_f32_32x32x16_bf16 v[64:79], a[12:15], v[28:31], v[64:79]
    ds_read_b128 v[24:27], v2 offset:10240
    s_waitcnt lgkmcnt(6)
    v_mfma_f32_32x32x16_bf16 v[48:63], a[16:19], v[32:35], v[48:63]
    buffer_load_dwordx4 v1, s[8:11], s24 offen offset:1024 sc1 lds
    ds_read_b128 v[28:31], v2 offset:11264
    s_waitcnt lgkmcnt(6)
    v_mfma_f32_32x32x16_bf16 v[64:79], a[20:23], v[36:39], v[64:79]
    ds_read_b128 v[32:35], v2 offset:12288
    s_waitcnt lgkmcnt(6)
    v_mfma_f32_32x32x16_bf16 v[48:63], a[24:27], v[40:43], v[48:63]
    ds_read_b128 v[36:39], v2 offset:13312
    s_waitcnt lgkmcnt(6)
    v_mfma_f32_32x32x16_bf16 v[64:79], a[28:31], v[44:47], v[64:79]
    buffer_load_dwordx4 v1, s[8:11], s24 offen offset:2048 sc1 lds
    ds_read_b128 v[40:43], v2 offset:14336
    s_waitcnt lgkmcnt(6)
    v_mfma_f32_32x32x16_bf16 v[48:63], a[32:35], v[16:19], v[48:63]
    ds_read_b128 v[44:47], v2 offset:15360
    s_waitcnt lgkmcnt(6)
    v_mfma_f32_32x32x16_bf16 v[64:79], a[36:39], v[20:23], v[64:79]
    ds_read_b128 v[16:19], v2 offset:16384
    s_waitcnt lgkmcnt(6)
    v_mfma_f32_32x32x16_bf16 v[48:63], a[40:43], v[24:27], v[48:63]
    buffer_load_dwordx4 v1, s[8:11], s24 offen offset:3072 sc1 lds
    ds_read_b128 v[20:23], v2 offset:17408
    s_waitcnt lgkmcnt(6)
    v_mfma_f32_32x32x16_bf16 v[64:79], a[44:47], v[28:31], v[64:79]
    ds_read_b128 v[24:27], v2 offset:18432
    s_waitcnt lgkmcnt(6)
    v_mfma_f32_32x32x16_bf16 v[48:63], a[48:51], v[32:35], v[48:63]
    ds_read_b128 v[28:31], v2 offset:19456
    s_waitcnt lgkmcnt(6)
    v_mfma_f32_32x32x16_bf16 v[64:79], a[52:55], v[36:39], v[64:79]
    s_add_u32 s24, s24, 4096
    s_add_u32 s25, s25, 4096
    s_mov_b32 m0, s25
    s_nop 0
    buffer_load_dwordx4 v1, s[8:11], s24 offen offset:0 sc1 lds
    ds_read_b128 v[32:35], v2 offset:20480
    s_waitcnt lgkmcnt(6)
    v_mfma_f32_32x32x16_bf16 v[48:63], a[56:59], v[40:43], v[48:63]
    ds_read_b128 v[36:39], v2 offset:21504
    s_waitcnt lgkmcnt(6)
    v_mfma_f32_32x32x16_bf16 v[64:79], a[60:63], v[44:47], v[64:79]
    ds_read_b128 v[40:43], v2 offset:22528
    s_waitcnt lgkmcnt(6)
    v_mfma_f32_32x32x16_bf16 v[48:63], a[64:67], v[16:19], v[48:63]
    buffer_load_dwordx4 v1, s[8:11], s24 offen offset:1024 sc1 lds
    ds_read_b128 v[44:47], v2 offset:23552
    s_waitcnt lgkmcnt(6)
    v_mfma_f32_32x32x16_bf16 v[64:79], a[68:71], v[20:23], v[64:79]
    ds_read_b128 v[16:19], v2 offset:24576
    s_waitcnt lgkmcnt(6)
    v_mfma_f32_32x32x16_bf16 v[48:63], a[72:75], v[24:27], v[48:63]
    ds_read_b128 v[20:23], v2 offset:25600
    s_waitcnt lgkmcnt(6)
    v_mfma_f32_32x32x16_bf16 v[64:79], a[76:79], v[28:31], v[64:79]
    buffer_load_dwordx4 v1, s[8:11], s24 offen offset:2048 sc1 lds
    ds_read_b128 v[24:27], v2 offset:26624
    s_waitcnt lgkmcnt(6)
    v_mfma_f32_32x32x16_bf16 v[48:63], a[80:83], v[32:35], v[48:63]
    ds_read_b128 v[28:31], v2 offset:27648
    s_waitcnt lgkmcnt(6)
    v_mfma_f32_32x32x16_bf16 v[64:79], a[84:87], v[36:39], v[64:79]
    ds_read_b128 v[32:35], v2 offset:28672
    s_waitcnt lgkmcnt(6)
    v_mfma_f32_32x32x16_bf16 v[48:63], a[88:91], v[40:43], v[48:63]
    buffer_load_dwordx4 v1, s[8:11], s24 offen offset:3072 sc1 lds
    ds_read_b128 v[36:39], v2 offset:29696
    s_waitcnt lgkmcnt(6)
    v_mfma_f32_32x32x16_bf16 v[64:79], a[92:95], v[44:47], v[64:79]
    ds_read_b128 v[40:43], v2 offset:30720
    s_waitcnt lgkmcnt(6)
    v_mfma_f32_32x32x16_bf16 v[48:63], a[96:99], v[16:19], v[48:63]
    ds_read_b128 v[44:47], v2 offset:31744
    s_waitcnt lgkmcnt(6)
    v_mfma_f32_32x32x16_bf16 v[64:79], a[100:103], v[20:23], v[64:79]
    s_add_u32 s24, s24, 4096
    s_add_u32 s25, s25, 4096
    s_mov_b32 m0, s25
    s_nop 0
    buffer_load_dwordx4 v1, s[8:11], s24 offen offset:0 sc1 lds
    ds_read_b128 v[16:19], v2 offset:32768
    s_waitcnt lgkmcnt(6)
    v_mfma_f32_32x32x16_bf16 v[48:63], a[104:107], v[24:27], v[48:63]
    ds_read_b128 v[20:23], v2 offset:33792
    s_waitcnt lgkmcnt(6)
    v_mfma_f32_32x32x16_bf16 v[64:79], a[108:111], v[28:31], v[64:79]
    ds_read_b128 v[24:27], v2 offset:34816
    s_waitcnt lgkmcnt(6)
    v_mfma_f32_32x32x16_bf16 v[48:63], a[112:115], v[32:35], v[48:63]
    buffer_load_dwordx4 v1, s[8:11], s24 offen offset:1024 sc1 lds
    ds_read_b128 v[28:31], v2 offset:35840
    s_waitcnt lgkmcnt(6)
    v_mfma_f32_32x32x16_bf16 v[64:79], a[116:119], v[36:39], v[64:79]
    ds_read_b128 v[32:35], v2 offset:36864
    s_waitcnt lgkmcnt(6)
    v_mfma_f32_32x32x16_bf16 v[48:63], a[120:123], v[40:43], v[48:63]
    ds_read_b128 v[36:39], v2 offset:37888
    s_waitcnt lgkmcnt(6)
    v_mfma_f32_32x32x16_bf16 v[64:79], a[124:127], v[44:47], v[64:79]
    ds_read_b128 v[40:43], v2 offset:38912
    s_waitcnt lgkmcnt(6)
    v_mfma_f32_32x32x16_bf16 v[48:63], a[128:131], v[16:19], v[48:63]
    ds_read_b128 v[44:47], v2 offset:39936
    s_waitcnt lgkmcnt(6)
    v_mfma_f32_32x32x16_bf16 v[64:79], a[132:135], v[20:23], v[64:79]
    s_waitcnt lgkmcnt(5)
    v_mfma_f32_32x32x16_bf16 v[48:63], a[136:139], v[24:27], v[48:63]
    s_waitcnt lgkmcnt(4)
    v_mfma_f32_32x32x16_bf16 v[64:79], a[140:143], v[28:31], v[64:79]
    s_waitcnt lgkmcnt(3)
    v_mfma_f32_32x32x16_bf16 v[48:63], a[144:147], v[32:35], v[48:63]
    s_waitcnt lgkmcnt(2)
    v_mfma_f32_32x32x16_bf16 v[64:79], a[148:151], v[36:39], v[64:79]
    s_waitcnt lgkmcnt(1)
    v_mfma_f32_32x32x16_bf16 v[48:63], a[152:155], v[40:43], v[48:63]
    s_waitcnt lgkmcnt(0)
    v_mfma_f32_32x32x16_bf16 v[64:79], a[156:159], v[44:47], v[64:79]
    s_waitcnt vmcnt(12)
    s_nop 7
    s_nop 3
    v_add_f32 v48, v48, v64
    v_add_f32 v49, v49, v65
    v_add_f32 v50, v50, v66
    v_add_f32 v51, v51, v67
    v_add_f32 v52, v52, v68
    v_add_f32 v53, v53, v69
    v_add_f32 v54, v54, v70
    v_add_f32 v55, v55, v71
    v_add_f32 v56, v56, v72
    v_add_f32 v57, v57, v73
    v_add_f32 v58, v58, v74
    v_add_f32 v59, v59, v75
    v_add_f32 v60, v60, v76
    v_add_f32 v61, v61, v77
    v_add_f32 v62, v62, v78
    v_add_f32 v63, v63, v79
    s_add_u32 s26, s19, 226492416
    v_cvt_pk_bf16_f32 v80, v48, v49
    v_cvt_pk_bf16_f32 v81, v50, v51
    v_cvt_pk_bf16_f32 v82, v52, v53
    v_cvt_pk_bf16_f32 v83, v54, v55
    s_nop 1
    v_permlane32_swap_b32 v80, v82
    v_permlane32_swap_b32 v81, v83
    s_nop 1
    v_lshlrev_b32 v88, 16, v80
    v_and_b32 v89, 0xffff0000, v80
    v_lshlrev_b32 v90, 16, v104
    v_and_b32 v91, 0xffff0000, v104
    v_add_f32 v88, v88, v90
    v_add_f32 v89, v89, v91
    v_cvt_pk_bf16_f32 v80, v88, v89
    v_lshlrev_b32 v92, 16, v81
    v_and_b32 v93, 0xffff0000, v81
    v_lshlrev_b32 v94, 16, v105
    v_and_b32 v95, 0xffff0000, v105
    v_add_f32 v92, v92, v94
    v_add_f32 v93, v93, v95
    v_cvt_pk_bf16_f32 v81, v92, v93
    v_lshlrev_b32 v88, 16, v82
    v_and_b32 v89, 0xffff0000, v82
    v_lshlrev_b32 v90, 16, v106
    v_and_b32 v91, 0xffff0000, v106
    v_add_f32 v88, v88, v90
    v_add_f32 v89, v89, v91
    v_cvt_pk_bf16_f32 v82, v88, v89
    v_lshlrev_b32 v92, 16, v83
    v_and_b32 v93, 0xffff0000, v83
    v_lshlrev_b32 v94, 16, v107
    v_and_b32 v95, 0xffff0000, v107
    v_add_f32 v92, v92, v94
    v_add_f32 v93, v93, v95
    v_cvt_pk_bf16_f32 v83, v92, v93
    buffer_store_dwordx4 v[80:83], v3, s[8:11], s26 offen offset:0 sc1
    v_cvt_pk_bf16_f32 v84, v56, v57
    v_cvt_pk_bf16_f32 v85, v58, v59
    v_cvt_pk_bf16_f32 v86, v60, v61
    v_cvt_pk_bf16_f32 v87, v62, v63
    s_nop 1
    v_permlane32_swap_b32 v84, v86
    v_permlane32_swap_b32 v85, v87
    s_nop 1
    v_lshlrev_b32 v88, 16, v84
    v_and_b32 v89, 0xffff0000, v84
    v_lshlrev_b32 v90, 16, v108
    v_and_b32 v91, 0xffff0000, v108
    v_add_f32 v88, v88, v90
    v_add_f32 v89, v89, v91
    v_cvt_pk_bf16_f32 v84, v88, v89
    v_lshlrev_b32 v92, 16, v85
    v_and_b32 v93, 0xffff0000, v85
    v_lshlrev_b32 v94, 16, v109
    v_and_b32 v95, 0xffff0000, v109
    v_add_f32 v92, v92, v94
    v_add_f32 v93, v93, v95
    v_cvt_pk_bf16_f32 v85, v92, v93
    v_lshlrev_b32 v88, 16, v86
    v_and_b32 v89, 0xffff0000, v86
    v_lshlrev_b32 v90, 16, v110
    v_and_b32 v91, 0xffff0000, v110
    v_add_f32 v88, v88, v90
    v_add_f32 v89, v89, v91
    v_cvt_pk_bf16_f32 v86, v88, v89
    v_lshlrev_b32 v92, 16, v87
    v_and_b32 v93, 0xffff0000, v87
    v_lshlrev_b32 v94, 16, v111
    v_and_b32 v95, 0xffff0000, v111
    v_add_f32 v92, v92, v94
    v_add_f32 v93, v93, v95
    v_cvt_pk_bf16_f32 v87, v92, v93
    buffer_store_dwordx4 v[84:87], v3, s[8:11], s26 offen offset:32 sc1
    s_waitcnt vmcnt(0)
    s_mov_b64 exec, 1
    s_add_u32 s26, s48, s20
    buffer_store_dword v5, v4, s[8:11], s26 offen sc1
    s_mov_b64 exec, -1
    s_add_u32 s20, s20, 128
    s_add_u32 s19, s19, 40960
    s_add_u32 s16, s16, 40960
    s_cmp_eq_u32 s16, 122880
    s_cselect_b32 s16, 0, s16
    s_add_u32 s14, s14, 1
    s_cmp_ge_u32 s14, s15
    s_cbranch_scc1 layerb1_kernel_ab_fin
    s_sub_u32 s20, s20, 128
layerb1_kernel_ab_loop:
    s_add_u32 s23, s14, 2
    s_cmp_lg_u32 s13, 0
    s_cbranch_scc1 layerb1_kernel_ab_ow9
    s_min_u32 s28, s23, 63
    s_cmp_gt_u32 s22, s28
    s_cbranch_scc1 layerb1_kernel_ab_ow9
layerb1_kernel_ab_op9:
    buffer_load_dwordx4 v[116:119], v1, s[8:11], s29 offen sc1
    s_waitcnt vmcnt(0)
    v_min_u32 v116, v116, v117
    v_min_u32 v118, v118, v119
    v_min_u32 v114, v116, v118
    v_cmp_eq_u32 vcc, 0, v114
    s_nop 1
    s_ff1_i32_b64 s22, vcc
    s_min_u32 s22, s22, 64
    s_and_b32 s22, s22, 0x7c
    s_sub_u32 s30, s30, 1
    s_cbranch_scc1 layerb1_kernel_bail
    s_cmp_gt_u32 s22, s28
    s_cbranch_scc0 layerb1_kernel_ab_op9
layerb1_kernel_ab_ow9:
    s_barrier
    v_add_u32 v2, s16, v1
    ds_read_b128 v[16:19], v2 offset:0
    ds_read_b128 v[20:23], v2 offset:1024
    ds_read_b128 v[24:27], v2 offset:2048
    ds_read_b128 v[28:31], v2 offset:3072
    ds_read_b128 v[32:35], v2 offset:4096
    ds_read_b128 v[36:39], v2 offset:5120
    s_add_u32 s27, s19, 40960
    s_cmp_ge_u32 s14, 63
    s_cselect_b32 s27, s19, s27
    buffer_load_dwordx4 v[104:107], v3, s[52:55], s27 offen offset:0
    buffer_load_dwordx4 v[108:111], v3, s[52:55], s27 offen offset:32
    s_add_u32 s23, s14, 2
    s_min_u32 s24, s23, 63
    s_mul_i32 s24, s24, 40960
    s_add_u32 s24, s24, s18
    s_mul_i32 s25, s13, 10240
    s_add_u32 s25, s25, s17
    s_add_u32 s17, s17, 40960
    s_cmp_eq_u32 s17, 122880
    s_cselect_b32 s17, 0, s17
    ds_read_b128 v[40:43], v2 offset:6144
    s_waitcnt lgkmcnt(6)
    v_mfma_f32_32x32x16_bf16 v[48:63], a[0:3], v[16:19], 0
    ds_read_b128 v[44:47], v2 offset:7168
    s_waitcnt lgkmcnt(6)
    v_mfma_f32_32x32x16_bf16 v[64:79], a[4:7], v[20:23], 0
    s_mov_b32 m0, s25
    s_nop 0
    buffer_load_dwordx4 v1, s[8:11], s24 offen offset:0 sc1 lds
    ds_read_b128 v[16:19], v2 offset:8192
    s_waitcnt lgkmcnt(6)
    v_mfma_f32_32x32x16_bf16 v[48:63], a[8:11], v[24:27], v[48:63]
    ds_read_b128 v[20:23], v2 offset:9216
    s_waitcnt lgkmcnt(6)
    v_mfma_f32_32x32x16_bf16 v[64:79], a[12:15], v[28:31], v[64:79]
    ds_read_b128 v[24:27], v2 offset:10240
    s_waitcnt lgkmcnt(6)
    v_mfma_f32_32x32x16_bf16 v[48:63], a[16:19], v[32:35], v[48:63]
    buffer_load_dwordx4 v1, s[8:11], s24 offen offset:1024 sc1 lds
    ds_read_b128 v[28:31], v2 offset:11264
    s_waitcnt lgkmcnt(6)
    v_mfma_f32_32x32x16_bf16 v[64:79], a[20:23], v[36:39], v[64:79]
    ds_read_b128 v[32:35], v2 offset:12288
    s_waitcnt lgkmcnt(6)
    v_mfma_f32_32x32x16_bf16 v[48:63], a[24:27], v[40:43], v[48:63]
    ds_read_b128 v[36:39], v2 offset:13312
    s_waitcnt lgkmcnt(6)
    v_mfma_f32_32x32x16_bf16 v[64:79], a[28:31], v[44:47], v[64:79]
    buffer_load_dwordx4 v1, s[8:11], s24 offen offset:2048 sc1 lds
    ds_read_b128 v[40:43], v2 offset:14336
    s_waitcnt lgkmcnt(6)
    v_mfma_f32_32x32x16_bf16 v[48:63], a[32:35], v[16:19], v[48:63]
    ds_read_b128 v[44:47], v2 offset:15360
    s_waitcnt lgkmcnt(6)
    v_mfma_f32_32x32x16_bf16 v[64:79], a[36:39], v[20:23], v[64:79]
    ds_read_b128 v[16:19], v2 offset:16384
    s_waitcnt lgkmcnt(6)
    v_mfma_f32_32x32x16_bf16 v[48:63], a[40:43], v[24:27], v[48:63]
    buffer_load_dwordx4 v1, s[8:11], s24 offen offset:3072 sc1 lds
    ds_read_b128 v[20:23], v2 offset:17408
    s_waitcnt lgkmcnt(6)
    v_mfma_f32_32x32x16_bf16 v[64:79], a[44:47], v[28:31], v[64:79]
    ds_read_b128 v[24:27], v2 offset:18432
    s_waitcnt lgkmcnt(6)
    v_mfma_f32_32x32x16_bf16 v[48:63], a[48:51], v[32:35], v[48:63]
    ds_read_b128 v[28:31], v2 offset:19456
    s_waitcnt lgkmcnt(6)
    v_mfma_f32_32x32x16_bf16 v[64:79], a[52:55], v[36:39], v[64:79]
    s_add_u32 s24, s24, 4096
    s_add_u32 s25, s25, 4096
    s_mov_b32 m0, s25
    s_nop 0
    buffer_load_dwordx4 v1, s[8:11], s24 offen offset:0 sc1 lds
    ds_read_b128 v[32:35], v2 offset:20480
    s_waitcnt lgkmcnt(6)
    v_mfma_f32_32x32x16_bf16 v[48:63], a[56:59], v[40:43], v[48:63]
    ds_read_b128 v[36:39], v2 offset:21504
    s_waitcnt lgkmcnt(6)
    v_mfma_f32_32x32x16_bf16 v[64:79], a[60:63], v[44:47], v[64:79]
    ds_read_b128 v[40:43], v2 offset:22528
    s_waitcnt lgkmcnt(6)
    v_mfma_f32_32x32x16_bf16 v[48:63], a[64:67], v[16:19], v[48:63]
    buffer_load_dwordx4 v1, s[8:11], s24 offen offset:1024 sc1 lds
    ds_read_b128 v[44:47], v2 offset:23552
    s_waitcnt lgkmcnt(6)
    v_mfma_f32_32x32x16_bf16 v[64:79], a[68:71], v[20:23], v[64:79]
    ds_read_b128 v[16:19], v2 offset:24576
    s_waitcnt lgkmcnt(6)
    v_mfma_f32_32x32x16_bf16 v[48:63], a[72:75], v[24:27], v[48:63]
    ds_read_b128 v[20:23], v2 offset:25600
    s_waitcnt lgkmcnt(6)
    v_mfma_f32_32x32x16_bf16 v[64:79], a[76:79], v[28:31], v[64:79]
    buffer_load_dwordx4 v1, s[8:11], s24 offen offset:2048 sc1 lds
    ds_read_b128 v[24:27], v2 offset:26624
    s_waitcnt lgkmcnt(6)
    v_mfma_f32_32x32x16_bf16 v[48:63], a[80:83], v[32:35], v[48:63]
    ds_read_b128 v[28:31], v2 offset:27648
    s_waitcnt lgkmcnt(6)
    v_mfma_f32_32x32x16_bf16 v[64:79], a[84:87], v[36:39], v[64:79]
    ds_read_b128 v[32:35], v2 offset:28672
    s_waitcnt lgkmcnt(6)
    v_mfma_f32_32x32x16_bf16 v[48:63], a[88:91], v[40:43], v[48:63]
    buffer_load_dwordx4 v1, s[8:11], s24 offen offset:3072 sc1 lds
    ds_read_b128 v[36:39], v2 offset:29696
    s_waitcnt lgkmcnt(6)
    v_mfma_f32_32x32x16_bf16 v[64:79], a[92:95], v[44:47], v[64:79]
    ds_read_b128 v[40:43], v2 offset:30720
    s_waitcnt lgkmcnt(6)
    v_mfma_f32_32x32x16_bf16 v[48:63], a[96:99], v[16:19], v[48:63]
    ds_read_b128 v[44:47], v2 offset:31744
    s_waitcnt lgkmcnt(6)
    v_mfma_f32_32x32x16_bf16 v[64:79], a[100:103], v[20:23], v[64:79]
    s_add_u32 s24, s24, 4096
    s_add_u32 s25, s25, 4096
    s_mov_b32 m0, s25
    s_nop 0
    buffer_load_dwordx4 v1, s[8:11], s24 offen offset:0 sc1 lds
    ds_read_b128 v[16:19], v2 offset:32768
    s_waitcnt lgkmcnt(6)
    v_mfma_f32_32x32x16_bf16 v[48:63], a[104:107], v[24:27], v[48:63]
    ds_read_b128 v[20:23], v2 offset:33792
    s_waitcnt lgkmcnt(6)
    v_mfma_f32_32x32x16_bf16 v[64:79], a[108:111], v[28:31], v[64:79]
    ds_read_b128 v[24:27], v2 offset:34816
    s_waitcnt lgkmcnt(6)
    v_mfma_f32_32x32x16_bf16 v[48:63], a[112:115], v[32:35], v[48:63]
    buffer_load_dwordx4 v1, s[8:11], s24 offen offset:1024 sc1 lds
    ds_read_b128 v[28:31], v2 offset:35840
    s_waitcnt lgkmcnt(6)
    v_mfma_f32_32x32x16_bf16 v[64:79], a[116:119], v[36:39], v[64:79]
    ds_read_b128 v[32:35], v2 offset:36864
    s_waitcnt lgkmcnt(6)
    v_mfma_f32_32x32x16_bf16 v[48:63], a[120:123], v[40:43], v[48:63]
    ds_read_b128 v[36:39], v2 offset:37888
    s_waitcnt lgkmcnt(6)
    v_mfma_f32_32x32x16_bf16 v[64:79], a[124:127], v[44:47], v[64:79]
    ds_read_b128 v[40:43], v2 offset:38912
    s_waitcnt lgkmcnt(6)
    v_mfma_f32_32x32x16_bf16 v[48:63], a[128:131], v[16:19], v[48:63]
    ds_read_b128 v[44:47], v2 offset:39936
    s_waitcnt lgkmcnt(6)
    v_mfma_f32_32x32x16_bf16 v[64:79], a[132:135], v[20:23], v[64:79]
    s_waitcnt lgkmcnt(5)
    v_mfma_f32_32x32x16_bf16 v[48:63], a[136:139], v[24:27], v[48:63]
    s_waitcnt lgkmcnt(4)
    v_mfma_f32_32x32x16_bf16 v[64:79], a[140:143], v[28:31], v[64:79]
    s_waitcnt lgkmcnt(3)
    v_mfma_f32_32x32x16_bf16 v[48:63], a[144:147], v[32:35], v[48:63]
    s_waitcnt lgkmcnt(2)
    v_mfma_f32_32x32x16_bf16 v[64:79], a[148:151], v[36:39], v[64:79]
    s_waitcnt lgkmcnt(1)
    v_mfma_f32_32x32x16_bf16 v[48:63], a[152:155], v[40:43], v[48:63]
    s_waitcnt lgkmcnt(0)
    v_mfma_f32_32x32x16_bf16 v[64:79], a[156:159], v[44:47], v[64:79]
    s_waitcnt vmcnt(15)
    s_nop 7
    s_nop 3
    v_add_f32 v48, v48, v64
    v_add_f32 v49, v49, v65
    v_add_f32 v50, v50, v66
    v_add_f32 v51, v51, v67
    v_add_f32 v52, v52, v68
    v_add_f32 v53, v53, v69
    v_add_f32 v54, v54, v70
    v_add_f32 v55, v55, v71
    v_add_f32 v56, v56, v72
    v_add_f32 v57, v57, v73
    v_add_f32 v58, v58, v74
    v_add_f32 v59, v59, v75
    v_add_f32 v60, v60, v76
    v_add_f32 v61, v61, v77
    v_add_f32 v62, v62, v78
    v_add_f32 v63, v63, v79
    s_add_u32 s26, s19, 226492416
    v_cvt_pk_bf16_f32 v80, v48, v49
    v_cvt_pk_bf16_f32 v81, v50, v51
    v_cvt_pk_bf16_f32 v82, v52, v53
    v_cvt_pk_bf16_f32 v83, v54, v55
    s_nop 1
    v_permlane32_swap_b32 v80, v82
    v_permlane32_swap_b32 v81, v83
    s_nop 1
    v_lshlrev_b32 v88, 16, v80
    v_and_b32 v89, 0xffff0000, v80
    v_lshlrev_b32 v90, 16, v96
    v_and_b32 v91, 0xffff0000, v96
    v_add_f32 v88, v88, v90
    v_add_f32 v89, v89, v91
    v_cvt_pk_bf16_f32 v80, v88, v89
    v_lshlrev_b32 v92, 16, v81
    v_and_b32 v93, 0xffff0000, v81
    v_lshlrev_b32 v94, 16, v97
    v_and_b32 v95, 0xffff0000, v97
    v_add_f32 v92, v92, v94
    v_add_f32 v93, v93, v95
    v_cvt_pk_bf16_f32 v81, v92, v93
    v_lshlrev_b32 v88, 16, v82
    v_and_b32 v89, 0xffff0000, v82
    v_lshlrev_b32 v90, 16, v98
    v_and_b32 v91, 0xffff0000, v98
    v_add_f32 v88, v88, v90
    v_add_f32 v89, v89, v91
    v_cvt_pk_bf16_f32 v82, v88, v89
    v_lshlrev_b32 v92, 16, v83
    v_and_b32 v93, 0xffff0000, v83
    v_lshlrev_b32 v94, 16, v99
    v_and_b32 v95, 0xffff0000, v99
    v_add_f32 v92, v92, v94
    v_add_f32 v93, v93, v95
    v_cvt_pk_bf16_f32 v83, v92, v93
    buffer_store_dwordx4 v[80:83], v3, s[8:11], s26 offen offset:0 sc1
    v_cvt_pk_bf16_f32 v84, v56, v57
    v_cvt_pk_bf16_f32 v85, v58, v59
    v_cvt_pk_bf16_f32 v86, v60, v61
    v_cvt_pk_bf16_f32 v87, v62, v63
    s_nop 1
    v_permlane32_swap_b32 v84, v86
    v_permlane32_swap_b32 v85, v87
    s_nop 1
    v_lshlrev_b32 v88, 16, v84
    v_and_b32 v89, 0xffff0000, v84
    v_lshlrev_b32 v90, 16, v100
    v_and_b32 v91, 0xffff0000, v100
    v_add_f32 v88, v88, v90
    v_add_f32 v89, v89, v91
    v_cvt_pk_bf16_f32 v84, v88, v89
    v_lshlrev_b32 v92, 16, v85
    v_and_b32 v93, 0xffff0000, v85
    v_lshlrev_b32 v94, 16, v101
    v_and_b32 v95, 0xffff0000, v101
    v_add_f32 v92, v92, v94
    v_add_f32 v93, v93, v95
    v_cvt_pk_bf16_f32 v85, v92, v93
    v_lshlrev_b32 v88, 16, v86
    v_and_b32 v89, 0xffff0000, v86
    v_lshlrev_b32 v90, 16, v102
    v_and_b32 v91, 0xffff0000, v102
    v_add_f32 v88, v88, v90
    v_add_f32 v89, v89, v91
    v_cvt_pk_bf16_f32 v86, v88, v89
    v_lshlrev_b32 v92, 16, v87
    v_and_b32 v93, 0xffff0000, v87
    v_lshlrev_b32 v94, 16, v103
    v_and_b32 v95, 0xffff0000, v103
    v_add_f32 v92, v92, v94
    v_add_f32 v93, v93, v95
    v_cvt_pk_bf16_f32 v87, v92, v93
    buffer_store_dwordx4 v[84:87], v3, s[8:11], s26 offen offset:32 sc1
    s_waitcnt vmcnt(15)
    s_mov_b64 exec, 1
    s_add_u32 s26, s48, s20
    buffer_store_dword v5, v4, s[8:11], s26 offen sc1
    s_mov_b64 exec, -1
    s_add_u32 s20, s20, 128
    s_add_u32 s19, s19, 40960
    s_add_u32 s16, s16, 40960
    s_cmp_eq_u32 s16, 122880
    s_cselect_b32 s16, 0, s16
    s_add_u32 s14, s14, 1
    s_cmp_ge_u32 s14, s15
    s_cbranch_scc1 layerb1_kernel_ab_fin
    s_add_u32 s23, s14, 2
    s_cmp_lg_u32 s13, 0
    s_cbranch_scc1 layerb1_kernel_ab_ow10
    s_min_u32 s28, s23, 63
    s_cmp_gt_u32 s22, s28
    s_cbranch_scc1 layerb1_kernel_ab_ow10
layerb1_kernel_ab_op10:
    buffer_load_dwordx4 v[116:119], v1, s[8:11], s29 offen sc1
    s_waitcnt vmcnt(0)
    v_min_u32 v116, v116, v117
    v_min_u32 v118, v118, v119
    v_min_u32 v114, v116, v118
    v_cmp_eq_u32 vcc, 0, v114
    s_nop 1
    s_ff1_i32_b64 s22, vcc
    s_min_u32 s22, s22, 64
    s_and_b32 s22, s22, 0x7c
    s_sub_u32 s30, s30, 1
    s_cbranch_scc1 layerb1_kernel_bail
    s_cmp_gt_u32 s22, s28
    s_cbranch_scc0 layerb1_kernel_ab_op10
layerb1_kernel_ab_ow10:
    s_barrier
    v_add_u32 v2, s16, v1
    ds_read_b128 v[16:19], v2 offset:0
    ds_read_b128 v[20:23], v2 offset:1024
    ds_read_b128 v[24:27], v2 offset:2048
    ds_read_b128 v[28:31], v2 offset:3072
    ds_read_b128 v[32:35], v2 offset:4096
    ds_read_b128 v[36:39], v2 offset:5120
    s_add_u32 s27, s19, 40960
    s_cmp_ge_u32 s14, 63
    s_cselect_b32 s27, s19, s27
    buffer_load_dwordx4 v[96:99], v3, s[52:55], s27 offen offset:0
    buffer_load_dwordx4 v[100:103], v3, s[52:55], s27 offen offset:32
    s_add_u32 s23, s14, 2
    s_min_u32 s24, s23, 63
    s_mul_i32 s24, s24, 40960
    s_add_u32 s24, s24, s18
    s_mul_i32 s25, s13, 10240
    s_add_u32 s25, s25, s17
    s_add_u32 s17, s17, 40960
    s_cmp_eq_u32 s17, 122880
    s_cselect_b32 s17, 0, s17
    ds_read_b128 v[40:43], v2 offset:6144
    s_waitcnt lgkmcnt(6)
    v_mfma_f32_32x32x16_bf16 v[48:63], a[0:3], v[16:19], 0
    ds_read_b128 v[44:47], v2 offset:7168
    s_waitcnt lgkmcnt(6)
    v_mfma_f32_32x32x16_bf16 v[64:79], a[4:7], v[20:23], 0
    s_mov_b32 m0, s25
    s_nop 0
    buffer_load_dwordx4 v1, s[8:11], s24 offen offset:0 sc1 lds
    ds_read_b128 v[16:19], v2 offset:8192
    s_waitcnt lgkmcnt(6)
    v_mfma_f32_32x32x16_bf16 v[48:63], a[8:11], v[24:27], v[48:63]
    ds_read_b128 v[20:23], v2 offset:9216
    s_waitcnt lgkmcnt(6)
    v_mfma_f32_32x32x16_bf16 v[64:79], a[12:15], v[28:31], v[64:79]
    ds_read_b128 v[24:27], v2 offset:10240
    s_waitcnt lgkmcnt(6)
    v_mfma_f32_32x32x16_bf16 v[48:63], a[16:19], v[32:35], v[48:63]
    buffer_load_dwordx4 v1, s[8:11], s24 offen offset:1024 sc1 lds
    ds_read_b128 v[28:31], v2 offset:11264
    s_waitcnt lgkmcnt(6)
    v_mfma_f32_32x32x16_bf16 v[64:79], a[20:23], v[36:39], v[64:79]
    ds_read_b128 v[32:35], v2 offset:12288
    s_waitcnt lgkmcnt(6)
    v_mfma_f32_32x32x16_bf16 v[48:63], a[24:27], v[40:43], v[48:63]
    ds_read_b128 v[36:39], v2 offset:13312
    s_waitcnt lgkmcnt(6)
    v_mfma_f32_32x32x16_bf16 v[64:79], a[28:31], v[44:47], v[64:79]
    buffer_load_dwordx4 v1, s[8:11], s24 offen offset:2048 sc1 lds
    ds_read_b128 v[40:43], v2 offset:14336
    s_waitcnt lgkmcnt(6)
    v_mfma_f32_32x32x16_bf16 v[48:63], a[32:35], v[16:19], v[48:63]
    ds_read_b128 v[44:47], v2 offset:15360
    s_waitcnt lgkmcnt(6)
    v_mfma_f32_32x32x16_bf16 v[64:79], a[36:39], v[20:23], v[64:79]
    ds_read_b128 v[16:19], v2 offset:16384
    s_waitcnt lgkmcnt(6)
    v_mfma_f32_32x32x16_bf16 v[48:63], a[40:43], v[24:27], v[48:63]
    buffer_load_dwordx4 v1, s[8:11], s24 offen offset:3072 sc1 lds
    ds_read_b128 v[20:23], v2 offset:17408
    s_waitcnt lgkmcnt(6)
    v_mfma_f32_32x32x16_bf16 v[64:79], a[44:47], v[28:31], v[64:79]
    ds_read_b128 v[24:27], v2 offset:18432
    s_waitcnt lgkmcnt(6)
    v_mfma_f32_32x32x16_bf16 v[48:63], a[48:51], v[32:35], v[48:63]
    ds_read_b128 v[28:31], v2 offset:19456
    s_waitcnt lgkmcnt(6)
    v_mfma_f32_32x32x16_bf16 v[64:79], a[52:55], v[36:39], v[64:79]
    s_add_u32 s24, s24, 4096
    s_add_u32 s25, s25, 4096
    s_mov_b32 m0, s25
    s_nop 0
    buffer_load_dwordx4 v1, s[8:11], s24 offen offset:0 sc1 lds
    ds_read_b128 v[32:35], v2 offset:20480
    s_waitcnt lgkmcnt(6)
    v_mfma_f32_32x32x16_bf16 v[48:63], a[56:59], v[40:43], v[48:63]
    ds_read_b128 v[36:39], v2 offset:21504
    s_waitcnt lgkmcnt(6)
    v_mfma_f32_32x32x16_bf16 v[64:79], a[60:63], v[44:47], v[64:79]
    ds_read_b128 v[40:43], v2 offset:22528
    s_waitcnt lgkmcnt(6)
    v_mfma_f32_32x32x16_bf16 v[48:63], a[64:67], v[16:19], v[48:63]
    buffer_load_dwordx4 v1, s[8:11], s24 offen offset:1024 sc1 lds
    ds_read_b128 v[44:47], v2 offset:23552
    s_waitcnt lgkmcnt(6)
    v_mfma_f32_32x32x16_bf16 v[64:79], a[68:71], v[20:23], v[64:79]
    ds_read_b128 v[16:19], v2 offset:24576
    s_waitcnt lgkmcnt(6)
    v_mfma_f32_32x32x16_bf16 v[48:63], a[72:75], v[24:27], v[48:63]
    ds_read_b128 v[20:23], v2 offset:25600
    s_waitcnt lgkmcnt(6)
    v_mfma_f32_32x32x16_bf16 v[64:79], a[76:79], v[28:31], v[64:79]
    buffer_load_dwordx4 v1, s[8:11], s24 offen offset:2048 sc1 lds
    ds_read_b128 v[24:27], v2 offset:26624
    s_waitcnt lgkmcnt(6)
    v_mfma_f32_32x32x16_bf16 v[48:63], a[80:83], v[32:35], v[48:63]
    ds_read_b128 v[28:31], v2 offset:27648
    s_waitcnt lgkmcnt(6)
    v_mfma_f32_32x32x16_bf16 v[64:79], a[84:87], v[36:39], v[64:79]
    ds_read_b128 v[32:35], v2 offset:28672
    s_waitcnt lgkmcnt(6)
    v_mfma_f32_32x32x16_bf16 v[48:63], a[88:91], v[40:43], v[48:63]
    buffer_load_dwordx4 v1, s[8:11], s24 offen offset:3072 sc1 lds
    ds_read_b128 v[36:39], v2 offset:29696
    s_waitcnt lgkmcnt(6)
    v_mfma_f32_32x32x16_bf16 v[64:79], a[92:95], v[44:47], v[64:79]
    ds_read_b128 v[40:43], v2 offset:30720
    s_waitcnt lgkmcnt(6)
    v_mfma_f32_32x32x16_bf16 v[48:63], a[96:99], v[16:19], v[48:63]
    ds_read_b128 v[44:47], v2 offset:31744
    s_waitcnt lgkmcnt(6)
    v_mfma_f32_32x32x16_bf16 v[64:79], a[100:103], v[20:23], v[64:79]
    s_add_u32 s24, s24, 4096
    s_add_u32 s25, s25, 4096
    s_mov_b32 m0, s25
    s_nop 0
    buffer_load_dwordx4 v1, s[8:11], s24 offen offset:0 sc1 lds
    ds_read_b128 v[16:19], v2 offset:32768
    s_waitcnt lgkmcnt(6)
    v_mfma_f32_32x32x16_bf16 v[48:63], a[104:107], v[24:27], v[48:63]
    ds_read_b128 v[20:23], v2 offset:33792
    s_waitcnt lgkmcnt(6)
    v_mfma_f32_32x32x16_bf16 v[64:79], a[108:111], v[28:31], v[64:79]
    ds_read_b128 v[24:27], v2 offset:34816
    s_waitcnt lgkmcnt(6)
    v_mfma_f32_32x32x16_bf16 v[48:63], a[112:115], v[32:35], v[48:63]
    buffer_load_dwordx4 v1, s[8:11], s24 offen offset:1024 sc1 lds
    ds_read_b128 v[28:31], v2 offset:35840
    s_waitcnt lgkmcnt(6)
    v_mfma_f32_32x32x16_bf16 v[64:79], a[116:119], v[36:39], v[64:79]
    ds_read_b128 v[32:35], v2 offset:36864
    s_waitcnt lgkmcnt(6)
    v_mfma_f32_32x32x16_bf16 v[48:63], a[120:123], v[40:43], v[48:63]
    ds_read_b128 v[36:39], v2 offset:37888
    s_waitcnt lgkmcnt(6)
    v_mfma_f32_32x32x16_bf16 v[64:79], a[124:127], v[44:47], v[64:79]
    ds_read_b128 v[40:43], v2 offset:38912
    s_waitcnt lgkmcnt(6)
    v_mfma_f32_32x32x16_bf16 v[48:63], a[128:131], v[16:19], v[48:63]
    ds_read_b128 v[44:47], v2 offset:39936
    s_waitcnt lgkmcnt(6)
    v_mfma_f32_32x32x16_bf16 v[64:79], a[132:135], v[20:23], v[64:79]
    s_waitcnt lgkmcnt(5)
    v_mfma_f32_32x32x16_bf16 v[48:63], a[136:139], v[24:27], v[48:63]
    s_waitcnt lgkmcnt(4)
    v_mfma_f32_32x32x16_bf16 v[64:79], a[140:143], v[28:31], v[64:79]
    s_waitcnt lgkmcnt(3)
    v_mfma_f32_32x32x16_bf16 v[48:63], a[144:147], v[32:35], v[48:63]
    s_waitcnt lgkmcnt(2)
    v_mfma_f32_32x32x16_bf16 v[64:79], a[148:151], v[36:39], v[64:79]
    s_waitcnt lgkmcnt(1)
    v_mfma_f32_32x32x16_bf16 v[48:63], a[152:155], v[40:43], v[48:63]
    s_waitcnt lgkmcnt(0)
    v_mfma_f32_32x32x16_bf16 v[64:79], a[156:159], v[44:47], v[64:79]
    s_waitcnt vmcnt(15)
    s_nop 7
    s_nop 3
    v_add_f32 v48, v48, v64
    v_add_f32 v49, v49, v65
    v_add_f32 v50, v50, v66
    v_add_f32 v51, v51, v67
    v_add_f32 v52, v52, v68
    v_add_f32 v53, v53, v69
    v_add_f32 v54, v54, v70
    v_add_f32 v55, v55, v71
    v_add_f32 v56, v56, v72
    v_add_f32 v57, v57, v73
    v_add_f32 v58, v58, v74
    v_add_f32 v59, v59, v75
    v_add_f32 v60, v60, v76
    v_add_f32 v61, v61, v77
    v_add_f32 v62, v62, v78
    v_add_f32 v63, v63, v79
    s_add_u32 s26, s19, 226492416
    v_cvt_pk_bf16_f32 v80, v48, v49
    v_cvt_pk_bf16_f32 v81, v50, v51
    v_cvt_pk_bf16_f32 v82, v52, v53
    v_cvt_pk_bf16_f32 v83, v54, v55
    s_nop 1
    v_permlane32_swap_b32 v80, v82
    v_permlane32_swap_b32 v81, v83
    s_nop 1
    v_lshlrev_b32 v88, 16, v80
    v_and_b32 v89, 0xffff0000, v80
    v_lshlrev_b32 v90, 16, v104
    v_and_b32 v91, 0xffff0000, v104
    v_add_f32 v88, v88, v90
    v_add_f32 v89, v89, v91
    v_cvt_pk_bf16_f32 v80, v88, v89
    v_lshlrev_b32 v92, 16, v81
    v_and_b32 v93, 0xffff0000, v81
    v_lshlrev_b32 v94, 16, v105
    v_and_b32 v95, 0xffff0000, v105
    v_add_f32 v92, v92, v94
    v_add_f32 v93, v93, v95
    v_cvt_pk_bf16_f32 v81, v92, v93
    v_lshlrev_b32 v88, 16, v82
    v_and_b32 v89, 0xffff0000, v82
    v_lshlrev_b32 v90, 16, v106
    v_and_b32 v91, 0xffff0000, v106
    v_add_f32 v88, v88, v90
    v_add_f32 v89, v89, v91
    v_cvt_pk_bf16_f32 v82, v88, v89
    v_lshlrev_b32 v92, 16, v83
    v_and_b32 v93, 0xffff0000, v83
    v_lshlrev_b32 v94, 16, v107
    v_and_b32 v95, 0xffff0000, v107
    v_add_f32 v92, v92, v94
    v_add_f32 v93, v93, v95
    v_cvt_pk_bf16_f32 v83, v92, v93
    buffer_store_dwordx4 v[80:83], v3, s[8:11], s26 offen offset:0 sc1
    v_cvt_pk_bf16_f32 v84, v56, v57
    v_cvt_pk_bf16_f32 v85, v58, v59
    v_cvt_pk_bf16_f32 v86, v60, v61
    v_cvt_pk_bf16_f32 v87, v62, v63
    s_nop 1
    v_permlane32_swap_b32 v84, v86
    v_permlane32_swap_b32 v85, v87
    s_nop 1
    v_lshlrev_b32 v88, 16, v84
    v_and_b32 v89, 0xffff0000, v84
    v_lshlrev_b32 v90, 16, v108
    v_and_b32 v91, 0xffff0000, v108
    v_add_f32 v88, v88, v90
    v_add_f32 v89, v89, v91
    v_cvt_pk_bf16_f32 v84, v88, v89
    v_lshlrev_b32 v92, 16, v85
    v_and_b32 v93, 0xffff0000, v85
    v_lshlrev_b32 v94, 16, v109
    v_and_b32 v95, 0xffff0000, v109
    v_add_f32 v92, v92, v94
    v_add_f32 v93, v93, v95
    v_cvt_pk_bf16_f32 v85, v92, v93
    v_lshlrev_b32 v88, 16, v86
    v_and_b32 v89, 0xffff0000, v86
    v_lshlrev_b32 v90, 16, v110
    v_and_b32 v91, 0xffff0000, v110
    v_add_f32 v88, v88, v90
    v_add_f32 v89, v89, v91
    v_cvt_pk_bf16_f32 v86, v88, v89
    v_lshlrev_b32 v92, 16, v87
    v_and_b32 v93, 0xffff0000, v87
    v_lshlrev_b32 v94, 16, v111
    v_and_b32 v95, 0xffff0000, v111
    v_add_f32 v92, v92, v94
    v_add_f32 v93, v93, v95
    v_cvt_pk_bf16_f32 v87, v92, v93
    buffer_store_dwordx4 v[84:87], v3, s[8:11], s26 offen offset:32 sc1
    s_waitcnt vmcnt(15)
    s_mov_b64 exec, 1
    s_add_u32 s26, s48, s20
    buffer_store_dword v5, v4, s[8:11], s26 offen sc1
    s_mov_b64 exec, -1
    s_add_u32 s20, s20, 128
    s_add_u32 s19, s19, 40960
    s_add_u32 s16, s16, 40960
    s_cmp_eq_u32 s16, 122880
    s_cselect_b32 s16, 0, s16
    s_add_u32 s14, s14, 1
    s_cmp_lt_u32 s14, s15
    s_cbranch_scc1 layerb1_kernel_ab_loop
layerb1_kernel_ab_fin:
    s_waitcnt vmcnt(0) lgkmcnt(0)
    s_mov_b64 exec, 1
    s_add_u32 s26, s48, s20
    buffer_store_dword v5, v4, s[8:11], s26 offen sc1
    s_mov_b64 exec, -1
    s_add_u32 s20, s20, 128
    s_barrier
    s_branch layerb1_kernel_w3
layerb1_kernel_sp_ln:
    s_sub_u32 s12, s22, 5
    s_mov_b32 s14, s12
    s_mov_b32 s16, 0x3f803f80
    v_lshrrev_b32 v6, 3, v0
    v_and_b32 v7, 7, v0
    v_mul_u32_u24 v1, 1280, v6
    v_lshl_add_u32 v1, v7, 5, v1
    v_lshlrev_b32 v2, 10, v7
    v_lshl_add_u32 v2, v6, 4, v2
    v_lshlrev_b32 v3, 2, v0
    v_mov_b32 v4, 1
layerb1_kernel_ln_seg:
    s_lshl_b32 s17, s14, 7
    s_add_u32 s17, s17, s48
    s_add_u32 s17, s17, 36864
    s_mov_b64 exec, 0xfffff
layerb1_kernel_ln_poll:
    buffer_load_dword v5, v3, s[8:11], s17 offen sc1
    s_waitcnt vmcnt(0)
    v_cmp_eq_u32 vcc, 0, v5
    s_sub_u32 s15, s15, 1
    s_cbranch_scc1 layerb1_kernel_bail
    s_cbranch_vccnz layerb1_kernel_ln_poll
    s_mov_b64 exec, -1
    s_lshl_b32 s18, s14, 5
    s_lshl_b32 s19, s13, 3
    s_add_u32 s18, s18, s19
    s_mul_i32 s18, s18, 1280
    s_add_u32 s18, s18, 226492416
    buffer_load_dwordx4 v[16:19], v1, s[8:11], s18 offen offset:0 sc1
    buffer_load_dwordx4 v[20:23], v1, s[8:11], s18 offen offset:16 sc1
    buffer_load_dwordx4 v[24:27], v1, s[8:11], s18 offen offset:256 sc1
    buffer_load_dwordx4 v[28:31], v1, s[8:11], s18 offen offset:272 sc1
    buffer_load_dwordx4 v[32:35], v1, s[8:11], s18 offen offset:512 sc1
    buffer_load_dwordx4 v[36:39], v1, s[8:11], s18 offen offset:528 sc1
    buffer_load_dwordx4 v[40:43], v1, s[8:11], s18 offen offset:768 sc1
    buffer_load_dwordx4 v[44:47], v1, s[8:11], s18 offen offset:784 sc1
    buffer_load_dwordx4 v[48:51], v1, s[8:11], s18 offen offset:1024 sc1
    buffer_load_dwordx4 v[52:55], v1, s[8:11], s18 offen offset:1040 sc1
    v_mov_b32 v8, 0
    v_mov_b32 v9, 0
    v_mov_b32 v10, 0
    v_mov_b32 v11, 0
    s_waitcnt vmcnt(9)
    v_dot2c_f32_bf16 v8, s16, v16
    v_dot2c_f32_bf16 v10, v16, v16
    v_dot2c_f32_bf16 v9, s16, v17
    v_dot2c_f32_bf16 v11, v17, v17
    v_dot2c_f32_bf16 v8, s16, v18
    v_dot2c_f32_bf16 v10, v18, v18
    v_dot2c_f32_bf16 v9, s16, v19
    v_dot2c_f32_bf16 v11, v19, v19
    s_waitcnt vmcnt(8)
    v_dot2c_f32_bf16 v8, s16, v20
    v_dot2c_f32_bf16 v10, v20, v20
    v_dot2c_f32_bf16 v9, s16, v21
    v_dot2c_f32_bf16 v11, v21, v21
    v_dot2c_f32_bf16 v8, s16, v22
    v_dot2c_f32_bf16 v10, v22, v22
    v_dot2c_f32_bf16 v9, s16, v23
    v_dot2c_f32_bf16 v11, v23, v23
    s_waitcnt vmcnt(7)
    v_dot2c_f32_bf16 v8, s16, v24
    v_dot2c_f32_bf16 v10, v24, v24
    v_dot2c_f32_bf16 v9, s16, v25
    v_dot2c_f32_bf16 v11, v25, v25
    v_dot2c_f32_bf16 v8, s16, v26
    v_dot2c_f32_bf16 v10, v26, v26
    v_dot2c_f32_bf16 v9, s16, v27
    v_dot2c_f32_bf16 v11, v27, v27
    s_waitcnt vmcnt(6)
    v_dot2c_f32_bf16 v8, s16, v28
    v_dot2c_f32_bf16 v10, v28, v28
    v_dot2c_f32_bf16 v9, s16, v29
    v_dot2c_f32_bf16 v11, v29, v29
    v_dot2c_f32_bf16 v8, s16, v30
    v_dot2c_f32_bf16 v10, v30, v30
    v_dot2c_f32_bf16 v9, s16, v31
    v_dot2c_f32_bf16 v11, v31, v31
    s_waitcnt vmcnt(5)
    v_dot2c_f32_bf16 v8, s16, v32
    v_dot2c_f32_bf16 v10, v32, v32
    v_dot2c_f32_bf16 v9, s16, v33
    v_dot2c_f32_bf16 v11, v33, v33
    v_dot2c_f32_bf16 v8, s16, v34
    v_dot2c_f32_bf16 v10, v34, v34
    v_dot2c_f32_bf16 v9, s16, v35
    v_dot2c_f32_bf16 v11, v35, v35
    s_waitcnt vmcnt(4)
    v_dot2c_f32_bf16 v8, s16, v36
    v_dot2c_f32_bf16 v10, v36, v36
    v_dot2c_f32_bf16 v9, s16, v37
    v_dot2c_f32_bf16 v11, v37, v37
    v_dot2c_f32_bf16 v8, s16, v38
    v_dot2c_f32_bf16 v10, v38, v38
    v_dot2c_f32_bf16 v9, s16, v39
    v_dot2c_f32_bf16 v11, v39, v39
    s_waitcnt vmcnt(3)
    v_dot2c_f32_bf16 v8, s16, v40
    v_dot2c_f32_bf16 v10, v40, v40
    v_dot2c_f32_bf16 v9, s16, v41
    v_dot2c_f32_bf16 v11, v41, v41
    v_dot2c_f32_bf16 v8, s16, v42
    v_dot2c_f32_bf16 v10, v42, v42
    v_dot2c_f32_bf16 v9, s16, v43
    v_dot2c_f32_bf16 v11, v43, v43
    s_waitcnt vmcnt(2)
    v_dot2c_f32_bf16 v8, s16, v44
    v_dot2c_f32_bf16 v10, v44, v44
    v_dot2c_f32_bf16 v9, s16, v45
    v_dot2c_f32_bf16 v11, v45, v45
    v_dot2c_f32_bf16 v8, s16, v46
    v_dot2c_f32_bf16 v10, v46, v46
    v_dot2c_f32_bf16 v9, s16, v47
    v_dot2c_f32_bf16 v11, v47, v47
    s_waitcnt vmcnt(1)
    v_dot2c_f32_bf16 v8, s16, v48
    v_dot2c_f32_bf16 v10, v48, v48
    v_dot2c_f32_bf16 v9, s16, v49
    v_dot2c_f32_bf16 v11, v49, v49
    v_dot2c_f32_bf16 v8, s16, v50
    v_dot2c_f32_bf16 v10, v50, v50
    v_dot2c_f32_bf16 v9, s16, v51
    v_dot2c_f32_bf16 v11, v51, v51
    s_waitcnt vmcnt(0)
    v_dot2c_f32_bf16 v8, s16, v52
    v_dot2c_f32_bf16 v10, v52, v52
    v_dot2c_f32_bf16 v9, s16, v53
    v_dot2c_f32_bf16 v11, v53, v53
    v_dot2c_f32_bf16 v8, s16, v54
    v_dot2c_f32_bf16 v10, v54, v54
    v_dot2c_f32_bf16 v9, s16, v55
    v_dot2c_f32_bf16 v11, v55, v55
    s_nop 3
    v_add_f32 v8, v8, v9
    v_add_f32 v10, v10, v11
    s_nop 1
    v_add_f32_dpp v8, v8, v8 quad_perm:[1,0,3,2] row_mask:0xf bank_mask:0xf
    v_add_f32_dpp v10, v10, v10 quad_perm:[1,0,3,2] row_mask:0xf bank_mask:0xf
    s_nop 1
    v_add_f32_dpp v8, v8, v8 quad_perm:[2,3,0,1] row_mask:0xf bank_mask:0xf
    v_add_f32_dpp v10, v10, v10 quad_perm:[2,3,0,1] row_mask:0xf bank_mask:0xf
    s_nop 1
    v_add_f32_dpp v8, v8, v8 row_half_mirror row_mask:0xf bank_mask:0xf
    v_add_f32_dpp v10, v10, v10 row_half_mirror row_mask:0xf bank_mask:0xf
    v_mul_f32 v8, 0x3acccccd, v8
    v_mul_f32 v9, v8, v8
    v_mul_f32 v10, 0x3acccccd, v10
    v_sub_f32 v10, v10, v9
    v_max_f32 v10, 0, v10
    v_add_f32 v10, 0x3727c5ac, v10
    v_rsq_f32 v10, v10
    s_nop 0
    v_mul_f32 v8, v8, v10
    v_sub_f32 v8, 0, v8
    s_mul_i32 s18, s14, 40960
    s_lshl_b32 s19, s13, 7
    s_add_u32 s18, s18, s19
    s_add_u32 s18, s18, 220200960
    v_lshlrev_b32 v64, 16, v16
    v_and_b32 v65, 0xffff0000, v16
    v_fma_f32 v64, v64, v10, v8
    v_fma_f32 v65, v65, v10, v8
    v_cvt_pk_bf16_f32 v72, v64, v65
    v_lshlrev_b32 v66, 16, v17
    v_and_b32 v67, 0xffff0000, v17
    v_fma_f32 v66, v66, v10, v8
    v_fma_f32 v67, v67, v10, v8
    v_cvt_pk_bf16_f32 v74, v66, v67
    v_lshlrev_b32 v68, 16, v18
    v_and_b32 v69, 0xffff0000, v18
    v_fma_f32 v68, v68, v10, v8
    v_fma_f32 v69, v69, v10, v8
    v_cvt_pk_bf16_f32 v76, v68, v69
    v_lshlrev_b32 v70, 16, v19
    v_and_b32 v71, 0xffff0000, v19
    v_fma_f32 v70, v70, v10, v8
    v_fma_f32 v71, v71, v10, v8
    v_cvt_pk_bf16_f32 v78, v70, v71
    v_lshlrev_b32 v64, 16, v20
    v_and_b32 v65, 0xffff0000, v20
    v_fma_f32 v64, v64, v10, v8
    v_fma_f32 v65, v65, v10, v8
    v_cvt_pk_bf16_f32 v73, v64, v65
    v_lshlrev_b32 v66, 16, v21
    v_and_b32 v67, 0xffff0000, v21
    v_fma_f32 v66, v66, v10, v8
    v_fma_f32 v67, v67, v10, v8
    v_cvt_pk_bf16_f32 v75, v66, v67
    v_lshlrev_b32 v68, 16, v22
    v_and_b32 v69, 0xffff0000, v22
    v_fma_f32 v68, v68, v10, v8
    v_fma_f32 v69, v69, v10, v8
    v_cvt_pk_bf16_f32 v77, v68, v69
    v_lshlrev_b32 v70, 16, v23
    v_and_b32 v71, 0xffff0000, v23
    v_fma_f32 v70, v70, v10, v8
    v_fma_f32 v71, v71, v10, v8
    v_cvt_pk_bf16_f32 v79, v70, v71
    buffer_store_dwordx4 v[72:75], v2, s[8:11], s18 offen offset:0 sc1
    buffer_store_dwordx4 v[76:79], v2, s[8:11], s18 offen offset:512 sc1
    s_add_u32 s18, s18, 8192
    v_lshlrev_b32 v64, 16, v24
    v_and_b32 v65, 0xffff0000, v24
    v_fma_f32 v64, v64, v10, v8
    v_fma_f32 v65, v65, v10, v8
    v_cvt_pk_bf16_f32 v80, v64, v65
    v_lshlrev_b32 v66, 16, v25
    v_and_b32 v67, 0xffff0000, v25
    v_fma_f32 v66, v66, v10, v8
    v_fma_f32 v67, v67, v10, v8
    v_cvt_pk_bf16_f32 v82, v66, v67
    v_lshlrev_b32 v68, 16, v26
    v_and_b32 v69, 0xffff0000, v26
    v_fma_f32 v68, v68, v10, v8
    v_fma_f32 v69, v69, v10, v8
    v_cvt_pk_bf16_f32 v84, v68, v69
    v_lshlrev_b32 v70, 16, v27
    v_and_b32 v71, 0xffff0000, v27
    v_fma_f32 v70, v70, v10, v8
    v_fma_f32 v71, v71, v10, v8
    v_cvt_pk_bf16_f32 v86, v70, v71
    v_lshlrev_b32 v64, 16, v28
    v_and_b32 v65, 0xffff0000, v28
    v_fma_f32 v64, v64, v10, v8
    v_fma_f32 v65, v65, v10, v8
    v_cvt_pk_bf16_f32 v81, v64, v65
    v_lshlrev_b32 v66, 16, v29
    v_and_b32 v67, 0xffff0000, v29
    v_fma_f32 v66, v66, v10, v8
    v_fma_f32 v67, v67, v10, v8
    v_cvt_pk_bf16_f32 v83, v66, v67
    v_lshlrev_b32 v68, 16, v30
    v_and_b32 v69, 0xffff0000, v30
    v_fma_f32 v68, v68, v10, v8
    v_fma_f32 v69, v69, v10, v8
    v_cvt_pk_bf16_f32 v85, v68, v69
    v_lshlrev_b32 v70, 16, v31
    v_and_b32 v71, 0xffff0000, v31
    v_fma_f32 v70, v70, v10, v8
    v_fma_f32 v71, v71, v10, v8
    v_cvt_pk_bf16_f32 v87, v70, v71
    buffer_store_dwordx4 v[80:83], v2, s[8:11], s18 offen offset:0 sc1
    buffer_store_dwordx4 v[84:87], v2, s[8:11], s18 offen offset:512 sc1
    s_add_u32 s18, s18, 8192
    v_lshlrev_b32 v64, 16, v32
    v_and_b32 v65, 0xffff0000, v32
    v_fma_f32 v64, v64, v10, v8
    v_fma_f32 v65, v65, v10, v8
    v_cvt_pk_bf16_f32 v72, v64, v65
    v_lshlrev_b32 v66, 16, v33
    v_and_b32 v67, 0xffff0000, v33
    v_fma_f32 v66, v66, v10, v8
    v_fma_f32 v67, v67, v10, v8
    v_cvt_pk_bf16_f32 v74, v66, v67
    v_lshlrev_b32 v68, 16, v34
    v_and_b32 v69, 0xffff0000, v34
    v_fma_f32 v68, v68, v10, v8
    v_fma_f32 v69, v69, v10, v8
    v_cvt_pk_bf16_f32 v76, v68, v69
    v_lshlrev_b32 v70, 16, v35
    v_and_b32 v71, 0xffff0000, v35
    v_fma_f32 v70, v70, v10, v8
    v_fma_f32 v71, v71, v10, v8
    v_cvt_pk_bf16_f32 v78, v70, v71
    v_lshlrev_b32 v64, 16, v36
    v_and_b32 v65, 0xffff0000, v36
    v_fma_f32 v64, v64, v10, v8
    v_fma_f32 v65, v65, v10, v8
    v_cvt_pk_bf16_f32 v73, v64, v65
    v_lshlrev_b32 v66, 16, v37
    v_and_b32 v67, 0xffff0000, v37
    v_fma_f32 v66, v66, v10, v8
    v_fma_f32 v67, v67, v10, v8
    v_cvt_pk_bf16_f32 v75, v66, v67
    v_lshlrev_b32 v68, 16, v38
    v_and_b32 v69, 0xffff0000, v38
    v_fma_f32 v68, v68, v10, v8
    v_fma_f32 v69, v69, v10, v8
    v_cvt_pk_bf16_f32 v77, v68, v69
    v_lshlrev_b32 v70, 16, v39
    v_and_b32 v71, 0xffff0000, v39
    v_fma_f32 v70, v70, v10, v8
    v_fma_f32 v71, v71, v10, v8
    v_cvt_pk_bf16_f32 v79, v70, v71
    buffer_store_dwordx4 v[72:75], v2, s[8:11], s18 offen offset:0 sc1
    buffer_store_dwordx4 v[76:79], v2, s[8:11], s18 offen offset:512 sc1
    s_add_u32 s18, s18, 8192
    v_lshlrev_b32 v64, 16, v40
    v_and_b32 v65, 0xffff0000, v40
    v_fma_f32 v64, v64, v10, v8
    v_fma_f32 v65, v65, v10, v8
    v_cvt_pk_bf16_f32 v80, v64, v65
    v_lshlrev_b32 v66, 16, v41
    v_and_b32 v67, 0xffff0000, v41
    v_fma_f32 v66, v66, v10, v8
    v_fma_f32 v67, v67, v10, v8
    v_cvt_pk_bf16_f32 v82, v66, v67
    v_lshlrev_b32 v68, 16, v42
    v_and_b32 v69, 0xffff0000, v42
    v_fma_f32 v68, v68, v10, v8
    v_fma_f32 v69, v69, v10, v8
    v_cvt_pk_bf16_f32 v84, v68, v69
    v_lshlrev_b32 v70, 16, v43
    v_and_b32 v71, 0xffff0000, v43
    v_fma_f32 v70, v70, v10, v8
    v_fma_f32 v71, v71, v10, v8
    v_cvt_pk_bf16_f32 v86, v70, v71
    v_lshlrev_b32 v64, 16, v44
    v_and_b32 v65, 0xffff0000, v44
    v_fma_f32 v64, v64, v10, v8
    v_fma_f32 v65, v65, v10, v8
    v_cvt_pk_bf16_f32 v81, v64, v65
    v_lshlrev_b32 v66, 16, v45
    v_and_b32 v67, 0xffff0000, v45
    v_fma_f32 v66, v66, v10, v8
    v_fma_f32 v67, v67, v10, v8
    v_cvt_pk_bf16_f32 v83, v66, v67
    v_lshlrev_b32 v68, 16, v46
    v_and_b32 v69, 0xffff0000, v46
    v_fma_f32 v68, v68, v10, v8
    v_fma_f32 v69, v69, v10, v8
    v_cvt_pk_bf16_f32 v85, v68, v69
    v_lshlrev_b32 v70, 16, v47
    v_and_b32 v71, 0xffff0000, v47
    v_fma_f32 v70, v70, v10, v8
    v_fma_f32 v71, v71, v10, v8
    v_cvt_pk_bf16_f32 v87, v70, v71
    buffer_store_dwordx4 v[80:83], v2, s[8:11], s18 offen offset:0 sc1
    buffer_store_dwordx4 v[84:87], v2, s[8:11], s18 offen offset:512 sc1
    s_add_u32 s18, s18, 8192
    v_lshlrev_b32 v64, 16, v48
    v_and_b32 v65, 0xffff0000, v48
    v_fma_f32 v64, v64, v10, v8
    v_fma_f32 v65, v65, v10, v8
    v_cvt_pk_bf16_f32 v72, v64, v65
    v_lshlrev_b32 v66, 16, v49
    v_and_b32 v67, 0xffff0000, v49
    v_fma_f32 v66, v66, v10, v8
    v_fma_f32 v67, v67, v10, v8
    v_cvt_pk_bf16_f32 v74, v66, v67
    v_lshlrev_b32 v68, 16, v50
    v_and_b32 v69, 0xffff0000, v50
    v_fma_f32 v68, v68, v10, v8
    v_fma_f32 v69, v69, v10, v8
    v_cvt_pk_bf16_f32 v76, v68, v69
    v_lshlrev_b32 v70, 16, v51
    v_and_b32 v71, 0xffff0000, v51
    v_fma_f32 v70, v70, v10, v8
    v_fma_f32 v71, v71, v10, v8
    v_cvt_pk_bf16_f32 v78, v70, v71
    v_lshlrev_b32 v64, 16, v52
    v_and_b32 v65, 0xffff0000, v52
    v_fma_f32 v64, v64, v10, v8
    v_fma_f32 v65, v65, v10, v8
    v_cvt_pk_bf16_f32 v73, v64, v65
    v_lshlrev_b32 v66, 16, v53
    v_and_b32 v67, 0xffff0000, v53
    v_fma_f32 v66, v66, v10, v8
    v_fma_f32 v67, v67, v10, v8
    v_cvt_pk_bf16_f32 v75, v66, v67
    v_lshlrev_b32 v68, 16, v54
    v_and_b32 v69, 0xffff0000, v54
    v_fma_f32 v68, v68, v10, v8
    v_fma_f32 v69, v69, v10, v8
    v_cvt_pk_bf16_f32 v77, v68, v69
    v_lshlrev_b32 v70, 16, v55
    v_and_b32 v71, 0xffff0000, v55
    v_fma_f32 v70, v70, v10, v8
    v_fma_f32 v71, v71, v10, v8
    v_cvt_pk_bf16_f32 v79, v70, v71
    buffer_store_dwordx4 v[72:75], v2, s[8:11], s18 offen offset:0 sc1
    buffer_store_dwordx4 v[76:79], v2, s[8:11], s18 offen offset:512 sc1
    s_waitcnt vmcnt(0)
    s_lshl_b32 s17, s14, 4
    s_lshl_b32 s19, s13, 2
    s_add_u32 s17, s17, s19
    s_add_u32 s17, s17, s48
    s_add_u32 s17, s17, 45056
    v_mov_b32 v5, 0
    s_mov_b64 exec, 1
    buffer_store_dword v4, v5, s[8:11], s17 offen sc1
    s_mov_b64 exec, -1
    s_add_u32 s14, s14, 4
    s_cmp_lt_u32 s14, 64
    s_cbranch_scc1 layerb1_kernel_ln_seg
    s_waitcnt vmcnt(0)
    s_barrier
layerb1_kernel_w3:
    s_mov_b32 s15, 400000
    s_mov_b32 s43, 32768
layerb1_kernel_j_next:
    s_xor_b32 s43, s43, 4
    s_cmp_lg_u32 s13, 0
    s_cbranch_scc1 layerb1_kernel_j_rel
    s_mov_b64 exec, 1
    v_mov_b32 v2, 31744
    v_mov_b32 v3, 1
    buffer_atomic_add v3, v2, s[8:11], s48 offen sc0 sc1
    s_waitcnt vmcnt(0)
    s_mov_b64 exec, -1
    s_nop 0
    v_readfirstlane_b32 s38, v3
    s_cmp_ge_u32 s38, 1152
    s_cbranch_scc1 layerb1_kernel_j_pub
    s_mul_i32 s39, s38, 58255
    s_lshr_b32 s40, s39, 20
    s_mul_i32 s39, s40, 18
    s_sub_u32 s41, s38, s39
    s_add_u32 s42, s40, 1
    v_mov_b32 v4, s42
    v_lshlrev_b32 v2, 7, v0
    s_cmp_ge_u32 s41, 8
    s_cbranch_scc1 layerb1_kernel_j_dep_b
    s_lshl_b32 s24, s41, 9
    s_add_u32 s24, s24, 16384
    v_add_u32 v2, s24, v2
    s_mul_i32 s25, s41, 384
    s_add_u32 s26, s25, 10240
    v_writelane_b32 v2, s26, 4
    s_add_u32 s26, s25, 10368
    v_writelane_b32 v2, s26, 5
    s_add_u32 s26, s25, 10496
    v_writelane_b32 v2, s26, 6
    s_add_u32 s26, s25, 13312
    v_writelane_b32 v2, s26, 7
    s_add_u32 s26, s25, 13440
    v_writelane_b32 v2, s26, 8
    s_add_u32 s26, s25, 13568
    v_writelane_b32 v2, s26, 9
    s_mov_b64 exec, 0x3ff
    s_mov_b32 s44, 0xf
    s_branch layerb1_kernel_j_poll
layerb1_kernel_j_dep_b:
    s_sub_u32 s24, s41, 8
    s_lshl_b32 s24, s24, 10
    v_add_u32 v2, s24, v2
    v_cmp_gt_u32 vcc, 8, v0
    v_mov_b32 v5, 20480
    v_mov_b32 v6, -1024
    v_cndmask_b32 v5, v6, v5, vcc
    v_add_u32 v2, v5, v2
    s_lshl_b32 s25, s40, 7
    s_add_u32 s25, s25, 53184
    v_lshl_add_u32 v5, v0, 2, s25
    v_cmp_le_u32 vcc, 16, v0
    s_nop 1
    v_cndmask_b32 v2, v2, v5, vcc
    v_cndmask_b32 v4, v4, 1, vcc
    s_mov_b32 exec_lo, -1
    s_mov_b32 exec_hi, 0xffff
    s_mov_b32 s44, 0xffff00ff
layerb1_kernel_j_poll:
    buffer_load_dword v3, v2, s[8:11], s48 offen sc1
    s_waitcnt vmcnt(0)
    v_cmp_gt_u32 vcc, v4, v3
    s_sub_u32 s15, s15, 1
    s_cbranch_scc1 layerb1_kernel_j_giveup
    s_andn2_b32 s24, vcc_lo, s44
    s_cbranch_scc1 layerb1_kernel_j_poll
    s_mov_b64 exec, -1
    s_and_b32 s24, vcc_lo, s44
    s_or_b32 s25, s24, vcc_hi
    s_cselect_b32 s25, 0xf, 0
    s_cmp_ge_u32 s41, 8
    s_cselect_b32 s24, s25, s24
    s_lshl_b32 s24, s24, 11
    s_or_b32 s38, s38, s24
layerb1_kernel_j_pub:
    v_mov_b32 v2, s43
    v_mov_b32 v3, s38
    ds_write_b32 v2, v3
    s_waitcnt lgkmcnt(0)
layerb1_kernel_j_rel:
    s_barrier
    v_mov_b32 v2, s43
    ds_read_b32 v3, v2
    s_waitcnt lgkmcnt(0)
    v_readfirstlane_b32 s38, v3
    s_cmp_eq_u32 s38, -1
    s_cbranch_scc1 layerb1_kernel_j_done
    s_lshr_b32 s44, s38, 11
    s_and_b32 s38, s38, 0x7ff
    s_cmp_ge_u32 s38, 1152
    s_cbranch_scc1 layerb1_kernel_j_done
    s_lshr_b32 s44, s44, s13
    s_and_b32 s44, s44, 1
    s_mul_i32 s39, s38, 58255
    s_lshr_b32 s40, s39, 20
    s_mul_i32 s39, s40, 18
    s_sub_u32 s41, s38, s39
    s_add_u32 s42, s40, 1
    s_cmp_ge_u32 s41, 8
    s_cbranch_scc1 layerb1_kernel_j_b
    s_lshl_b32 s41, s41, 2
    s_add_u32 s41, s41, s13
    v_lshlrev_b32 v1, 4, v0
    v_and_b32 v2, 31, v0
    v_lshrrev_b32 v3, 5, v0
    s_lshl_b32 s24, s40, 5
    s_add_u32 s24, s24, s41
    s_mul_i32 s25, s24, 12288
    s_add_u32 s26, s25, 78643200
    s_add_u32 s27, s25, 53477376
    s_mul_i32 s28, s24, 3072
    s_add_u32 s28, s28, 208666624
    v_and_b32 v4, 7, v0
    v_lshlrev_b32 v4, 4, v4
    v_lshl_add_u32 v4, v3, 7, v4
    buffer_load_dwordx4 v[16:19], v1, s[8:11], s26 offen offset:0 sc1
    buffer_load_dwordx4 v[64:67], v1, s[8:11], s27 offen offset:0 sc1
    buffer_load_dwordx4 v[20:23], v1, s[8:11], s26 offen offset:1024 sc1
    buffer_load_dwordx4 v[68:71], v1, s[8:11], s27 offen offset:1024 sc1
    buffer_load_dwordx4 v[24:27], v1, s[8:11], s26 offen offset:2048 sc1
    buffer_load_dwordx4 v[72:75], v1, s[8:11], s27 offen offset:2048 sc1
    buffer_load_dwordx4 v[28:31], v1, s[8:11], s26 offen offset:3072 sc1
    buffer_load_dwordx4 v[76:79], v1, s[8:11], s27 offen offset:3072 sc1
    s_add_u32 s26, s26, 4096
    s_add_u32 s27, s27, 4096
    buffer_load_dwordx4 v[32:35], v1, s[8:11], s26 offen offset:0 sc1
    buffer_load_dwordx4 v[80:83], v1, s[8:11], s27 offen offset:0 sc1
    buffer_load_dwordx4 v[36:39], v1, s[8:11], s26 offen offset:1024 sc1
    buffer_load_dwordx4 v[84:87], v1, s[8:11], s27 offen offset:1024 sc1
    buffer_load_dwordx4 v[40:43], v1, s[8:11], s26 offen offset:2048 sc1
    buffer_load_dwordx4 v[88:91], v1, s[8:11], s27 offen offset:2048 sc1
    buffer_load_dwordx4 v[44:47], v1, s[8:11], s26 offen offset:3072 sc1
    buffer_load_dwordx4 v[92:95], v1, s[8:11], s27 offen offset:3072 sc1
    s_add_u32 s26, s26, 4096
    s_add_u32 s27, s27, 4096
    buffer_load_dwordx4 v[48:51], v1, s[8:11], s26 offen offset:0 sc1
    buffer_load_dwordx4 v[96:99], v1, s[8:11], s27 offen offset:0 sc1
    buffer_load_dwordx4 v[52:55], v1, s[8:11], s26 offen offset:1024 sc1
    buffer_load_dwordx4 v[100:103], v1, s[8:11], s27 offen offset:1024 sc1
    buffer_load_dwordx4 v[56:59], v1, s[8:11], s26 offen offset:2048 sc1
    buffer_load_dwordx4 v[104:107], v1, s[8:11], s27 offen offset:2048 sc1
    buffer_load_dwordx4 v[60:63], v1, s[8:11], s26 offen offset:3072 sc1
    buffer_load_dwordx4 v[108:111], v1, s[8:11], s27 offen offset:3072 sc1
    s_cmp_eq_u32 s44, 1
    s_cbranch_scc1 layerb1_kernel_w3a_nf
    buffer_load_dwordx4 v[112:115], v4, s[8:11], s28 offen offset:0 sc1
    buffer_load_dwordx4 v[116:119], v4, s[8:11], s28 offen offset:256 sc1
    buffer_load_dwordx4 v[120:123], v4, s[8:11], s28 offen offset:512 sc1
    buffer_load_dwordx4 v[124:127], v4, s[8:11], s28 offen offset:768 sc1
    buffer_load_dwordx4 v[128:131], v4, s[8:11], s28 offen offset:1024 sc1
    buffer_load_dwordx4 v[132:135], v4, s[8:11], s28 offen offset:1280 sc1
    buffer_load_dwordx4 v[136:139], v4, s[8:11], s28 offen offset:1536 sc1
    buffer_load_dwordx4 v[140:143], v4, s[8:11], s28 offen offset:1792 sc1
    buffer_load_dwordx4 v[144:147], v4, s[8:11], s28 offen offset:2048 sc1
    buffer_load_dwordx4 v[148:151], v4, s[8:11], s28 offen offset:2304 sc1
    buffer_load_dwordx4 v[152:155], v4, s[8:11], s28 offen offset:2560 sc1
    buffer_load_dwordx4 v[156:159], v4, s[8:11], s28 offen offset:2816 sc1
layerb1_kernel_w3a_nf:
    v_lshlrev_b32 v5, 2, v3
    v_sub_u32 v5, v2, v5
    v_mov_b32 v6, 0xf149f2ca
    v_cmp_gt_i32 vcc, 0, v5
    s_nop 1
    v_cndmask_b32 v192, 0, v6, vcc
    v_cmp_gt_i32 vcc, 1, v5
    s_nop 1
    v_cndmask_b32 v193, 0, v6, vcc
    v_cmp_gt_i32 vcc, 2, v5
    s_nop 1
    v_cndmask_b32 v194, 0, v6, vcc
    v_cmp_gt_i32 vcc, 3, v5
    s_nop 1
    v_cndmask_b32 v195, 0, v6, vcc
    v_cmp_gt_i32 vcc, 8, v5
    s_nop 1
    v_cndmask_b32 v196, 0, v6, vcc
    v_cmp_gt_i32 vcc, 9, v5
    s_nop 1
    v_cndmask_b32 v197, 0, v6, vcc
    v_cmp_gt_i32 vcc, 10, v5
    s_nop 1
    v_cndmask_b32 v198, 0, v6, vcc
    v_cmp_gt_i32 vcc, 11, v5
    s_nop 1
    v_cndmask_b32 v199, 0, v6, vcc
    v_cmp_gt_i32 vcc, 16, v5
    s_nop 1
    v_cndmask_b32 v200, 0, v6, vcc
    v_cmp_gt_i32 vcc, 17, v5
    s_nop 1
    v_cndmask_b32 v201, 0, v6, vcc
    v_cmp_gt_i32 vcc, 18, v5
    s_nop 1
    v_cndmask_b32 v202, 0, v6, vcc
    v_cmp_gt_i32 vcc, 19, v5
    s_nop 1
    v_cndmask_b32 v203, 0, v6, vcc
    v_cmp_gt_i32 vcc, 24, v5
    s_nop 1
    v_cndmask_b32 v204, 0, v6, vcc
    v_cmp_gt_i32 vcc, 25, v5
    s_nop 1
    v_cndmask_b32 v205, 0, v6, vcc
    v_cmp_gt_i32 vcc, 26, v5
    s_nop 1
    v_cndmask_b32 v206, 0, v6, vcc
    v_cmp_gt_i32 vcc, 27, v5
    s_nop 1
    v_cndmask_b32 v207, 0, v6, vcc
    s_waitcnt vmcnt(22)
    v_mfma_f32_32x32x16_bf16 v[160:175], v[64:67], v[16:19], 0
    s_waitcnt vmcnt(20)
    v_mfma_f32_32x32x16_bf16 v[160:175], v[68:71], v[20:23], v[160:175]
    s_waitcnt vmcnt(18)
    v_mfma_f32_32x32x16_bf16 v[160:175], v[72:75], v[24:27], v[160:175]
    s_waitcnt vmcnt(16)
    v_mfma_f32_32x32x16_bf16 v[160:175], v[76:79], v[28:31], v[160:175]
    s_waitcnt vmcnt(14)
    v_mfma_f32_32x32x16_bf16 v[160:175], v[80:83], v[32:35], v[160:175]
    s_waitcnt vmcnt(12)
    v_mfma_f32_32x32x16_bf16 v[160:175], v[84:87], v[36:39], v[160:175]
    s_waitcnt vmcnt(10)
    v_mfma_f32_32x32x16_bf16 v[160:175], v[88:91], v[40:43], v[160:175]
    s_waitcnt vmcnt(8)
    v_mfma_f32_32x32x16_bf16 v[160:175], v[92:95], v[44:47], v[160:175]
    s_waitcnt vmcnt(6)
    v_mfma_f32_32x32x16_bf16 v[160:175], v[96:99], v[48:51], v[160:175]
    s_waitcnt vmcnt(4)
    v_mfma_f32_32x32x16_bf16 v[160:175], v[100:103], v[52:55], v[160:175]
    s_waitcnt vmcnt(2)
    v_mfma_f32_32x32x16_bf16 v[160:175], v[104:107], v[56:59], v[160:175]
    s_waitcnt vmcnt(0)
    v_mfma_f32_32x32x16_bf16 v[160:175], v[108:111], v[60:63], v[160:175]
    s_cmp_eq_u32 s44, 0
    s_cbranch_scc1 layerb1_kernel_w3a_f
    s_lshl_b32 s31, s41, 7
    s_add_u32 s31, s31, 16384
    v_mov_b32 v212, s31
    v_mov_b32 v215, s42
    v_mov_b32 v214, -1
    s_mov_b32 exec_lo, 0x1
    s_mov_b32 exec_hi, 0x0
layerb1_kernel_j_la:
    buffer_load_dword v213, v212, s[8:11], s48 offen sc1
    s_waitcnt vmcnt(0)
    v_and_b32 v213, v213, v214
    v_cmp_gt_u32 vcc, v215, v213
    s_sub_u32 s15, s15, 1
    s_cbranch_scc1 layerb1_kernel_bail
    s_cbranch_vccnz layerb1_kernel_j_la
    s_mov_b64 exec, -1
    buffer_load_dwordx4 v[112:115], v4, s[8:11], s28 offen offset:0 sc1
    buffer_load_dwordx4 v[116:119], v4, s[8:11], s28 offen offset:256 sc1
    buffer_load_dwordx4 v[120:123], v4, s[8:11], s28 offen offset:512 sc1
    buffer_load_dwordx4 v[124:127], v4, s[8:11], s28 offen offset:768 sc1
    buffer_load_dwordx4 v[128:131], v4, s[8:11], s28 offen offset:1024 sc1
    buffer_load_dwordx4 v[132:135], v4, s[8:11], s28 offen offset:1280 sc1
    buffer_load_dwordx4 v[136:139], v4, s[8:11], s28 offen offset:1536 sc1
    buffer_load_dwordx4 v[140:143], v4, s[8:11], s28 offen offset:1792 sc1
    buffer_load_dwordx4 v[144:147], v4, s[8:11], s28 offen offset:2048 sc1
    buffer_load_dwordx4 v[148:151], v4, s[8:11], s28 offen offset:2304 sc1
    buffer_load_dwordx4 v[152:155], v4, s[8:11], s28 offen offset:2560 sc1
    buffer_load_dwordx4 v[156:159], v4, s[8:11], s28 offen offset:2816 sc1
layerb1_kernel_w3a_f:
    s_waitcnt vmcnt(11)
    v_mfma_f32_32x32x16_bf16 v[176:191], v[112:115], v[16:19], 0
    s_waitcnt vmcnt(10)
    v_mfma_f32_32x32x16_bf16 v[176:191], v[116:119], v[20:23], v[176:191]
    s_waitcnt vmcnt(9)
    v_mfma_f32_32x32x16_bf16 v[176:191], v[120:123], v[24:27], v[176:191]
    s_waitcnt vmcnt(8)
    v_mfma_f32_32x32x16_bf16 v[176:191], v[124:127], v[28:31], v[176:191]
    s_waitcnt vmcnt(7)
    v_mfma_f32_32x32x16_bf16 v[176:191], v[128:131], v[32:35], v[176:191]
    s_waitcnt vmcnt(6)
    v_mfma_f32_32x32x16_bf16 v[176:191], v[132:135], v[36:39], v[176:191]
    s_waitcnt vmcnt(5)
    v_mfma_f32_32x32x16_bf16 v[176:191], v[136:139], v[40:43], v[176:191]
    s_waitcnt vmcnt(4)
    v_mfma_f32_32x32x16_bf16 v[176:191], v[140:143], v[44:47], v[176:191]
    s_waitcnt vmcnt(3)
    v_mfma_f32_32x32x16_bf16 v[176:191], v[144:147], v[48:51], v[176:191]
    s_waitcnt vmcnt(2)
    v_mfma_f32_32x32x16_bf16 v[176:191], v[148:151], v[52:55], v[176:191]
    s_waitcnt vmcnt(1)
    v_mfma_f32_32x32x16_bf16 v[176:191], v[152:155], v[56:59], v[176:191]
    s_waitcnt vmcnt(0)
    v_mfma_f32_32x32x16_bf16 v[176:191], v[156:159], v[60:63], v[176:191]
    s_nop 7
    s_nop 7
    v_mov_b32 v7, 0x3dd53b95
    v_fma_f32 v160, v160, v7, v192
    v_fma_f32 v161, v161, v7, v193
    v_fma_f32 v162, v162, v7, v194
    v_fma_f32 v163, v163, v7, v195
    v_fma_f32 v164, v164, v7, v196
    v_fma_f32 v165, v165, v7, v197
    v_fma_f32 v166, v166, v7, v198
    v_fma_f32 v167, v167, v7, v199
    v_fma_f32 v168, v168, v7, v200
    v_fma_f32 v169, v169, v7, v201
    v_fma_f32 v170, v170, v7, v202
    v_fma_f32 v171, v171, v7, v203
    v_fma_f32 v172, v172, v7, v204
    v_fma_f32 v173, v173, v7, v205
    v_fma_f32 v174, v174, v7, v206
    v_fma_f32 v175, v175, v7, v207
    v_mul_f32 v176, v176, v7
    v_mul_f32 v177, v177, v7
    v_mul_f32 v178, v178, v7
    v_mul_f32 v179, v179, v7
    v_max3_f32 v208, v160, v161, v162
    v_max3_f32 v208, v208, v163, v164
    v_max3_f32 v208, v208, v165, v166
    v_max3_f32 v208, v208, v167, v168
    v_max3_f32 v208, v208, v169, v170
    v_max3_f32 v208, v208, v171, v172
    v_max3_f32 v208, v208, v173, v174
    v_max3_f32 v208, v208, v175, v176
    v_max3_f32 v208, v208, v177, v178
    v_max_f32 v208, v208, v179
    v_mov_b32 v209, v208
    s_nop 1
    v_permlane32_swap_b32 v208, v209
    v_max_f32 v208, v208, v209
    v_sub_f32 v160, v160, v208
    v_sub_f32 v161, v161, v208
    v_sub_f32 v162, v162, v208
    v_sub_f32 v163, v163, v208
    v_sub_f32 v164, v164, v208
    v_sub_f32 v165, v165, v208
    v_sub_f32 v166, v166, v208
    v_sub_f32 v167, v167, v208
    v_sub_f32 v168, v168, v208
    v_sub_f32 v169, v169, v208
    v_sub_f32 v170, v170, v208
    v_sub_f32 v171, v171, v208
    v_sub_f32 v172, v172, v208
    v_sub_f32 v173, v173, v208
    v_sub_f32 v174, v174, v208
    v_sub_f32 v175, v175, v208
    v_sub_f32 v176, v176, v208
    v_sub_f32 v177, v177, v208
    v_sub_f32 v178, v178, v208
    v_sub_f32 v179, v179, v208
    v_exp_f32 v160, v160
    v_exp_f32 v161, v161
    v_exp_f32 v162, v162
    v_exp_f32 v163, v163
    v_exp_f32 v164, v164
    v_exp_f32 v165, v165
    v_exp_f32 v166, v166
    v_exp_f32 v167, v167
    v_exp_f32 v168, v168
    v_exp_f32 v169, v169
    v_exp_f32 v170, v170
    v_exp_f32 v171, v171
    v_exp_f32 v172, v172
    v_exp_f32 v173, v173
    v_exp_f32 v174, v174
    v_exp_f32 v175, v175
    v_exp_f32 v176, v176
    v_exp_f32 v177, v177
    v_exp_f32 v178, v178
    v_exp_f32 v179, v179
    s_nop 0
    v_add_f32 v210, v160, v161
    v_add_f32 v210, v210, v162
    v_add_f32 v210, v210, v163
    v_add_f32 v210, v210, v164
    v_add_f32 v210, v210, v165
    v_add_f32 v210, v210, v166
    v_add_f32 v210, v210, v167
    v_add_f32 v210, v210, v168
    v_add_f32 v210, v210, v169
    v_add_f32 v210, v210, v170
    v_add_f32 v210, v210, v171
    v_add_f32 v210, v210, v172
    v_add_f32 v210, v210, v173
    v_add_f32 v210, v210, v174
    v_add_f32 v210, v210, v175
    v_add_f32 v210, v210, v176
    v_add_f32 v210, v210, v177
    v_add_f32 v210, v210, v178
    v_add_f32 v210, v210, v179
    v_mov_b32 v209, v210
    s_nop 1
    v_permlane32_swap_b32 v210, v209
    v_add_f32 v210, v210, v209
    v_rcp_f32 v210, v210
    s_nop 0
    v_mul_f32 v160, v160, v210
    v_mul_f32 v161, v161, v210
    v_mul_f32 v162, v162, v210
    v_mul_f32 v163, v163, v210
    v_mul_f32 v164, v164, v210
    v_mul_f32 v165, v165, v210
    v_mul_f32 v166, v166, v210
    v_mul_f32 v167, v167, v210
    v_mul_f32 v168, v168, v210
    v_mul_f32 v169, v169, v210
    v_mul_f32 v170, v170, v210
    v_mul_f32 v171, v171, v210
    v_mul_f32 v172, v172, v210
    v_mul_f32 v173, v173, v210
    v_mul_f32 v174, v174, v210
    v_mul_f32 v175, v175, v210
    v_mul_f32 v176, v176, v210
    v_mul_f32 v177, v177, v210
    v_mul_f32 v178, v178, v210
    v_mul_f32 v179, v179, v210
    s_mul_i32 s25, s40, 81920
    s_mul_i32 s26, s41, 2560
    s_add_u32 s25, s25, s26
    s_add_u32 s25, s25, 214958080
    v_cvt_pk_bf16_f32 v16, v160, v161
    v_cvt_pk_bf16_f32 v17, v162, v163
    v_cvt_pk_bf16_f32 v18, v164, v165
    v_cvt_pk_bf16_f32 v19, v166, v167
    s_nop 1
    v_permlane32_swap_b32 v16, v18
    v_permlane32_swap_b32 v17, v19
    buffer_store_dwordx4 v[16:19], v1, s[8:11], s25 offen offset:512 sc1
    v_cvt_pk_bf16_f32 v20, v168, v169
    v_cvt_pk_bf16_f32 v21, v170, v171
    v_cvt_pk_bf16_f32 v22, v172, v173
    v_cvt_pk_bf16_f32 v23, v174, v175
    s_nop 1
    v_permlane32_swap_b32 v20, v22
    v_permlane32_swap_b32 v21, v23
    buffer_store_dwordx4 v[20:23], v1, s[8:11], s25 offen offset:1536 sc1
    v_cvt_pk_bf16_f32 v24, v176, v177
    v_cvt_pk_bf16_f32 v25, v178, v179
    v_lshlrev_b32 v4, 4, v2
    v_lshl_add_u32 v4, v3, 3, v4
    buffer_store_dwordx2 v[24:25], v4, s[8:11], s25 offen sc1
    s_waitcnt vmcnt(0)
    s_mov_b64 exec, 1
    s_lshl_b32 s24, s40, 7
    s_lshl_b32 s25, s41, 2
    s_add_u32 s24, s24, s25
    s_add_u32 s24, s24, 53248
    v_mov_b32 v2, s24
    v_mov_b32 v3, 1
    buffer_store_dword v3, v2, s[8:11], s48 offen sc1
    s_mov_b64 exec, -1
    s_branch layerb1_kernel_j_next
layerb1_kernel_j_b:
    s_sub_u32 s41, s41, 8
    v_lshlrev_b32 v1, 4, v0
    v_and_b32 v2, 31, v0
    v_lshrrev_b32 v3, 5, v0
    v_lshrrev_b32 v4, 3, v2
    v_mul_u32_u24 v4, 20480, v4
    v_and_b32 v5, 7, v2
    v_lshl_add_u32 v4, v5, 4, v4
    v_lshl_add_u32 v4, v3, 7, v4
    s_mul_i32 s24, s40, 1638400
    s_mul_i32 s25, s41, 163840
    s_add_u32 s24, s24, s25
    s_mul_i32 s25, s13, 5120
    s_add_u32 s24, s24, s25
    s_add_u32 s24, s24, 103809024
    s_add_u32 s28, s24, 81920
    s_mul_i32 s25, s40, 81920
    s_mul_i32 s26, s13, 20480
    s_add_u32 s25, s25, s26
    s_add_u32 s25, s25, 214958080
    v_mul_u32_u24 v6, 1280, v2
    v_lshl_add_u32 v6, v3, 4, v6
    s_mul_i32 s26, s40, 40960
    s_lshl_b32 s27, s41, 7
    s_add_u32 s26, s26, s27
    s_lshl_b32 s27, s13, 5
    s_add_u32 s26, s26, s27
    s_add_u32 s27, s26, 226492416
    buffer_load_dwordx4 v[8:11], v6, s[8:11], s27 offen sc1
    s_add_u32 s29, s24, 4096
    s_add_u32 s30, s28, 4096
    s_mov_b32 exec_lo, 0
    s_mov_b32 exec_hi, -1
    buffer_load_dwordx4 a[0:3], v4, s[8:11], s24 offen offset:0 sc1
    buffer_load_dwordx4 a[80:83], v4, s[8:11], s28 offen offset:0 sc1
    s_mov_b64 exec, -1
    buffer_load_dwordx4 a[4:7], v4, s[8:11], s24 offen offset:256 sc1
    buffer_load_dwordx4 a[84:87], v4, s[8:11], s28 offen offset:256 sc1
    s_mov_b32 exec_lo, -1
    s_mov_b32 exec_hi, 0
    buffer_load_dwordx4 a[8:11], v4, s[8:11], s24 offen offset:512 sc1
    buffer_load_dwordx4 a[88:91], v4, s[8:11], s28 offen offset:512 sc1
    s_mov_b64 exec, -1
    buffer_load_dwordx4 a[12:15], v4, s[8:11], s24 offen offset:768 sc1
    buffer_load_dwordx4 a[92:95], v4, s[8:11], s28 offen offset:768 sc1
    buffer_load_dwordx4 a[16:19], v4, s[8:11], s24 offen offset:1024 sc1
    buffer_load_dwordx4 a[96:99], v4, s[8:11], s28 offen offset:1024 sc1
    s_mov_b32 exec_lo, 0
    s_mov_b32 exec_hi, -1
    buffer_load_dwordx4 a[20:23], v4, s[8:11], s24 offen offset:1280 sc1
    buffer_load_dwordx4 a[100:103], v4, s[8:11], s28 offen offset:1280 sc1
    s_mov_b64 exec, -1
    buffer_load_dwordx4 a[24:27], v4, s[8:11], s24 offen offset:1536 sc1
    buffer_load_dwordx4 a[104:107], v4, s[8:11], s28 offen offset:1536 sc1
    s_mov_b32 exec_lo, -1
    s_mov_b32 exec_hi, 0
    buffer_load_dwordx4 a[28:31], v4, s[8:11], s24 offen offset:1792 sc1
    buffer_load_dwordx4 a[108:111], v4, s[8:11], s28 offen offset:1792 sc1
    s_mov_b64 exec, -1
    buffer_load_dwordx4 a[32:35], v4, s[8:11], s24 offen offset:2048 sc1
    buffer_load_dwordx4 a[112:115], v4, s[8:11], s28 offen offset:2048 sc1
    buffer_load_dwordx4 a[36:39], v4, s[8:11], s24 offen offset:2304 sc1
    buffer_load_dwordx4 a[116:119], v4, s[8:11], s28 offen offset:2304 sc1
    s_mov_b32 exec_lo, 0
    s_mov_b32 exec_hi, -1
    buffer_load_dwordx4 a[40:43], v4, s[8:11], s24 offen offset:2560 sc1
    buffer_load_dwordx4 a[120:123], v4, s[8:11], s28 offen offset:2560 sc1
    s_mov_b64 exec, -1
    buffer_load_dwordx4 a[44:47], v4, s[8:11], s24 offen offset:2816 sc1
    buffer_load_dwordx4 a[124:127], v4, s[8:11], s28 offen offset:2816 sc1
    s_mov_b32 exec_lo, -1
    s_mov_b32 exec_hi, 0
    buffer_load_dwordx4 a[48:51], v4, s[8:11], s24 offen offset:3072 sc1
    buffer_load_dwordx4 a[128:131], v4, s[8:11], s28 offen offset:3072 sc1
    s_mov_b64 exec, -1
    buffer_load_dwordx4 a[52:55], v4, s[8:11], s24 offen offset:3328 sc1
    buffer_load_dwordx4 a[132:135], v4, s[8:11], s28 offen offset:3328 sc1
    buffer_load_dwordx4 a[56:59], v4, s[8:11], s24 offen offset:3584 sc1
    buffer_load_dwordx4 a[136:139], v4, s[8:11], s28 offen offset:3584 sc1
    s_mov_b32 exec_lo, 0
    s_mov_b32 exec_hi, -1
    buffer_load_dwordx4 a[60:63], v4, s[8:11], s24 offen offset:3840 sc1
    buffer_load_dwordx4 a[140:143], v4, s[8:11], s28 offen offset:3840 sc1
    s_mov_b64 exec, -1
    buffer_load_dwordx4 a[64:67], v4, s[8:11], s29 offen offset:0 sc1
    buffer_load_dwordx4 a[144:147], v4, s[8:11], s30 offen offset:0 sc1
    s_mov_b32 exec_lo, -1
    s_mov_b32 exec_hi, 0
    buffer_load_dwordx4 a[68:71], v4, s[8:11], s29 offen offset:256 sc1
    buffer_load_dwordx4 a[148:151], v4, s[8:11], s30 offen offset:256 sc1
    s_mov_b64 exec, -1
    buffer_load_dwordx4 a[72:75], v4, s[8:11], s29 offen offset:512 sc1
    buffer_load_dwordx4 a[152:155], v4, s[8:11], s30 offen offset:512 sc1
    buffer_load_dwordx4 a[76:79], v4, s[8:11], s29 offen offset:768 sc1
    buffer_load_dwordx4 a[156:159], v4, s[8:11], s30 offen offset:768 sc1
    s_cmp_eq_u32 s44, 0
    s_cbranch_scc1 layerb1_kernel_j_bf
    s_cmp_lg_u32 s13, 0
    s_cbranch_scc1 layerb1_kernel_j_bw
    s_lshl_b32 s31, s41, 10
    s_add_u32 s31, s31, 20480
    v_lshlrev_b32 v212, 7, v0
    v_add_u32 v212, s31, v212
    v_mov_b32 v215, s42
    v_mov_b32 v214, -1
    s_lshl_b32 s31, s40, 7
    s_add_u32 s31, s31, 53216
    v_lshl_add_u32 v213, v0, 2, s31
    v_cmp_le_u32 vcc, 8, v0
    s_nop 1
    v_cndmask_b32 v212, v212, v213, vcc
    v_cndmask_b32 v215, v215, 1, vcc
    s_mov_b32 exec_lo, 0xffffffff
    s_mov_b32 exec_hi, 0xff
layerb1_kernel_j_lb:
    buffer_load_dword v213, v212, s[8:11], s48 offen sc1
    s_waitcnt vmcnt(0)
    v_and_b32 v213, v213, v214
    v_cmp_gt_u32 vcc, v215, v213
    s_sub_u32 s15, s15, 1
    s_cbranch_scc1 layerb1_kernel_bail
    s_cbranch_vccnz layerb1_kernel_j_lb
    s_mov_b64 exec, -1
layerb1_kernel_j_bw:
    s_barrier
layerb1_kernel_j_bf:
    buffer_load_dwordx4 a[160:163], v1, s[8:11], s25 offen offset:0 sc1
    s_mov_b32 exec_lo, -1
    s_mov_b32 exec_hi, 0
    buffer_load_dwordx4 a[0:3], v4, s[8:11], s24 offen offset:0 sc1
    buffer_load_dwordx4 a[80:83], v4, s[8:11], s28 offen offset:0 sc1
    s_mov_b64 exec, -1
    buffer_load_dwordx4 a[164:167], v1, s[8:11], s25 offen offset:1024 sc1
    buffer_load_dwordx4 a[168:171], v1, s[8:11], s25 offen offset:2048 sc1
    s_mov_b32 exec_lo, 0
    s_mov_b32 exec_hi, -1
    buffer_load_dwordx4 a[8:11], v4, s[8:11], s24 offen offset:512 sc1
    buffer_load_dwordx4 a[88:91], v4, s[8:11], s28 offen offset:512 sc1
    s_mov_b64 exec, -1
    buffer_load_dwordx4 a[172:175], v1, s[8:11], s25 offen offset:3072 sc1
    s_add_u32 s25, s25, 4096
    buffer_load_dwordx4 a[176:179], v1, s[8:11], s25 offen offset:0 sc1
    buffer_load_dwordx4 a[180:183], v1, s[8:11], s25 offen offset:1024 sc1
    s_mov_b32 exec_lo, -1
    s_mov_b32 exec_hi, 0
    buffer_load_dwordx4 a[20:23], v4, s[8:11], s24 offen offset:1280 sc1
    buffer_load_dwordx4 a[100:103], v4, s[8:11], s28 offen offset:1280 sc1
    s_mov_b64 exec, -1
    buffer_load_dwordx4 a[184:187], v1, s[8:11], s25 offen offset:2048 sc1
    buffer_load_dwordx4 a[188:191], v1, s[8:11], s25 offen offset:3072 sc1
    s_mov_b32 exec_lo, 0
    s_mov_b32 exec_hi, -1
    buffer_load_dwordx4 a[28:31], v4, s[8:11], s24 offen offset:1792 sc1
    buffer_load_dwordx4 a[108:111], v4, s[8:11], s28 offen offset:1792 sc1
    s_mov_b64 exec, -1
    s_add_u32 s25, s25, 4096
    buffer_load_dwordx4 a[192:195], v1, s[8:11], s25 offen offset:0 sc1
    buffer_load_dwordx4 a[196:199], v1, s[8:11], s25 offen offset:1024 sc1
    buffer_load_dwordx4 a[200:203], v1, s[8:11], s25 offen offset:2048 sc1
    s_mov_b32 exec_lo, -1
    s_mov_b32 exec_hi, 0
    buffer_load_dwordx4 a[40:43], v4, s[8:11], s24 offen offset:2560 sc1
    buffer_load_dwordx4 a[120:123], v4, s[8:11], s28 offen offset:2560 sc1
    s_mov_b64 exec, -1
    buffer_load_dwordx4 a[204:207], v1, s[8:11], s25 offen offset:3072 sc1
    s_add_u32 s25, s25, 4096
    buffer_load_dwordx4 a[208:211], v1, s[8:11], s25 offen offset:0 sc1
    s_mov_b32 exec_lo, 0
    s_mov_b32 exec_hi, -1
    buffer_load_dwordx4 a[48:51], v4, s[8:11], s24 offen offset:3072 sc1
    buffer_load_dwordx4 a[128:131], v4, s[8:11], s28 offen offset:3072 sc1
    s_mov_b64 exec, -1
    buffer_load_dwordx4 a[212:215], v1, s[8:11], s25 offen offset:1024 sc1
    buffer_load_dwordx4 a[216:219], v1, s[8:11], s25 offen offset:2048 sc1
    buffer_load_dwordx4 a[220:223], v1, s[8:11], s25 offen offset:3072 sc1
    s_mov_b32 exec_lo, -1
    s_mov_b32 exec_hi, 0
    buffer_load_dwordx4 a[60:63], v4, s[8:11], s24 offen offset:3840 sc1
    buffer_load_dwordx4 a[140:143], v4, s[8:11], s28 offen offset:3840 sc1
    s_mov_b64 exec, -1
    s_add_u32 s25, s25, 4096
    buffer_load_dwordx4 a[224:227], v1, s[8:11], s25 offen offset:0 sc1
    buffer_load_dwordx4 a[228:231], v1, s[8:11], s25 offen offset:1024 sc1
    s_mov_b32 exec_lo, 0
    s_mov_b32 exec_hi, -1
    buffer_load_dwordx4 a[68:71], v4, s[8:11], s29 offen offset:256 sc1
    buffer_load_dwordx4 a[148:151], v4, s[8:11], s30 offen offset:256 sc1
    s_mov_b64 exec, -1
    buffer_load_dwordx4 a[232:235], v1, s[8:11], s25 offen offset:2048 sc1
    buffer_load_dwordx4 a[236:239], v1, s[8:11], s25 offen offset:3072 sc1
    s_nop 3
    s_waitcnt vmcnt(33)
    v_mfma_f32_32x32x16_bf16 v[16:31], a[0:3], a[160:163], 0
    v_mfma_f32_32x32x16_bf16 v[32:47], a[80:83], a[160:163], 0
    s_waitcnt vmcnt(32)
    v_mfma_f32_32x32x16_bf16 v[16:31], a[4:7], a[164:167], v[16:31]
    v_mfma_f32_32x32x16_bf16 v[32:47], a[84:87], a[164:167], v[32:47]
    s_waitcnt vmcnt(29)
    v_mfma_f32_32x32x16_bf16 v[16:31], a[8:11], a[168:171], v[16:31]
    v_mfma_f32_32x32x16_bf16 v[32:47], a[88:91], a[168:171], v[32:47]
    s_waitcnt vmcnt(28)
    v_mfma_f32_32x32x16_bf16 v[16:31], a[12:15], a[172:175], v[16:31]
    v_mfma_f32_32x32x16_bf16 v[32:47], a[92:95], a[172:175], v[32:47]
    s_waitcnt vmcnt(27)
    v_mfma_f32_32x32x16_bf16 v[16:31], a[16:19], a[176:179], v[16:31]
    v_mfma_f32_32x32x16_bf16 v[32:47], a[96:99], a[176:179], v[32:47]
    s_waitcnt vmcnt(24)
    v_mfma_f32_32x32x16_bf16 v[16:31], a[20:23], a[180:183], v[16:31]
    v_mfma_f32_32x32x16_bf16 v[32:47], a[100:103], a[180:183], v[32:47]
    s_waitcnt vmcnt(23)
    v_mfma_f32_32x32x16_bf16 v[16:31], a[24:27], a[184:187], v[16:31]
    v_mfma_f32_32x32x16_bf16 v[32:47], a[104:107], a[184:187], v[32:47]
    s_waitcnt vmcnt(20)
    v_mfma_f32_32x32x16_bf16 v[16:31], a[28:31], a[188:191], v[16:31]
    v_mfma_f32_32x32x16_bf16 v[32:47], a[108:111], a[188:191], v[32:47]
    s_waitcnt vmcnt(19)
    v_mfma_f32_32x32x16_bf16 v[16:31], a[32:35], a[192:195], v[16:31]
    v_mfma_f32_32x32x16_bf16 v[32:47], a[112:115], a[192:195], v[32:47]
    s_waitcnt vmcnt(18)
    v_mfma_f32_32x32x16_bf16 v[16:31], a[36:39], a[196:199], v[16:31]
    v_mfma_f32_32x32x16_bf16 v[32:47], a[116:119], a[196:199], v[32:47]
    s_waitcnt vmcnt(15)
    v_mfma_f32_32x32x16_bf16 v[16:31], a[40:43], a[200:203], v[16:31]
    v_mfma_f32_32x32x16_bf16 v[32:47], a[120:123], a[200:203], v[32:47]
    s_waitcnt vmcnt(14)
    v_mfma_f32_32x32x16_bf16 v[16:31], a[44:47], a[204:207], v[16:31]
    v_mfma_f32_32x32x16_bf16 v[32:47], a[124:127], a[204:207], v[32:47]
    s_waitcnt vmcnt(11)
    v_mfma_f32_32x32x16_bf16 v[16:31], a[48:51], a[208:211], v[16:31]
    v_mfma_f32_32x32x16_bf16 v[32:47], a[128:131], a[208:211], v[32:47]
    s_waitcnt vmcnt(10)
    v_mfma_f32_32x32x16_bf16 v[16:31], a[52:55], a[212:215], v[16:31]
    v_mfma_f32_32x32x16_bf16 v[32:47], a[132:135], a[212:215], v[32:47]
    s_waitcnt vmcnt(9)
    v_mfma_f32_32x32x16_bf16 v[16:31], a[56:59], a[216:219], v[16:31]
    v_mfma_f32_32x32x16_bf16 v[32:47], a[136:139], a[216:219], v[32:47]
    s_waitcnt vmcnt(6)
    v_mfma_f32_32x32x16_bf16 v[16:31], a[60:63], a[220:223], v[16:31]
    v_mfma_f32_32x32x16_bf16 v[32:47], a[140:143], a[220:223], v[32:47]
    s_waitcnt vmcnt(5)
    v_mfma_f32_32x32x16_bf16 v[16:31], a[64:67], a[224:227], v[16:31]
    v_mfma_f32_32x32x16_bf16 v[32:47], a[144:147], a[224:227], v[32:47]
    s_waitcnt vmcnt(2)
    v_mfma_f32_32x32x16_bf16 v[16:31], a[68:71], a[228:231], v[16:31]
    v_mfma_f32_32x32x16_bf16 v[32:47], a[148:151], a[228:231], v[32:47]
    s_waitcnt vmcnt(1)
    v_mfma_f32_32x32x16_bf16 v[16:31], a[72:75], a[232:235], v[16:31]
    v_mfma_f32_32x32x16_bf16 v[32:47], a[152:155], a[232:235], v[32:47]
    s_waitcnt vmcnt(0)
    v_mfma_f32_32x32x16_bf16 v[16:31], a[76:79], a[236:239], v[16:31]
    v_mfma_f32_32x32x16_bf16 v[32:47], a[156:159], a[236:239], v[32:47]
    s_lshl_b32 s27, s13, 11
    v_add_u32 v7, s27, v1
    s_nop 7
    s_nop 7
    ds_write_b128 v7, v[16:19] offset:0
    ds_write_b128 v7, v[20:23] offset:1024
    ds_write_b128 v7, v[24:27] offset:8192
    ds_write_b128 v7, v[28:31] offset:9216
    ds_write_b128 v7, v[32:35] offset:16384
    ds_write_b128 v7, v[36:39] offset:17408
    ds_write_b128 v7, v[40:43] offset:24576
    ds_write_b128 v7, v[44:47] offset:25600
    s_waitcnt lgkmcnt(0)
    s_barrier
    s_lshl_b32 s27, s13, 13
    v_add_u32 v7, s27, v1
    ds_read_b128 v[48:51], v7 offset:0
    ds_read_b128 v[52:55], v7 offset:1024
    ds_read_b128 v[56:59], v7 offset:2048
    ds_read_b128 v[60:63], v7 offset:3072
    ds_read_b128 v[64:67], v7 offset:4096
    ds_read_b128 v[68:71], v7 offset:5120
    ds_read_b128 v[72:75], v7 offset:6144
    ds_read_b128 v[76:79], v7 offset:7168
    s_waitcnt lgkmcnt(4)
    v_add_f32 v48, v48, v56
    v_add_f32 v49, v49, v57
    v_add_f32 v50, v50, v58
    v_add_f32 v51, v51, v59
    v_add_f32 v52, v52, v60
    v_add_f32 v53, v53, v61
    v_add_f32 v54, v54, v62
    v_add_f32 v55, v55, v63
    s_waitcnt lgkmcnt(0)
    v_add_f32 v64, v64, v72
    v_add_f32 v65, v65, v73
    v_add_f32 v66, v66, v74
    v_add_f32 v67, v67, v75
    v_add_f32 v68, v68, v76
    v_add_f32 v69, v69, v77
    v_add_f32 v70, v70, v78
    v_add_f32 v71, v71, v79
    v_add_f32 v48, v48, v64
    v_add_f32 v49, v49, v65
    v_add_f32 v50, v50, v66
    v_add_f32 v51, v51, v67
    v_add_f32 v52, v52, v68
    v_add_f32 v53, v53, v69
    v_add_f32 v54, v54, v70
    v_add_f32 v55, v55, v71
    v_cvt_pk_bf16_f32 v16, v48, v49
    v_cvt_pk_bf16_f32 v17, v50, v51
    v_cvt_pk_bf16_f32 v18, v52, v53
    v_cvt_pk_bf16_f32 v19, v54, v55
    s_nop 1
    v_permlane32_swap_b32 v16, v18
    v_permlane32_swap_b32 v17, v19
    s_nop 1
    v_lshlrev_b32 v48, 16, v16
    v_and_b32 v49, 0xffff0000, v16
    v_lshlrev_b32 v50, 16, v8
    v_and_b32 v51, 0xffff0000, v8
    v_add_f32 v48, v48, v50
    v_add_f32 v49, v49, v51
    v_cvt_pk_bf16_f32 v16, v48, v49
    v_lshlrev_b32 v48, 16, v17
    v_and_b32 v49, 0xffff0000, v17
    v_lshlrev_b32 v50, 16, v9
    v_and_b32 v51, 0xffff0000, v9
    v_add_f32 v48, v48, v50
    v_add_f32 v49, v49, v51
    v_cvt_pk_bf16_f32 v17, v48, v49
    v_lshlrev_b32 v48, 16, v18
    v_and_b32 v49, 0xffff0000, v18
    v_lshlrev_b32 v50, 16, v10
    v_and_b32 v51, 0xffff0000, v10
    v_add_f32 v48, v48, v50
    v_add_f32 v49, v49, v51
    v_cvt_pk_bf16_f32 v18, v48, v49
    v_lshlrev_b32 v48, 16, v19
    v_and_b32 v49, 0xffff0000, v19
    v_lshlrev_b32 v50, 16, v11
    v_and_b32 v51, 0xffff0000, v11
    v_add_f32 v48, v48, v50
    v_add_f32 v49, v49, v51
    v_cvt_pk_bf16_f32 v19, v48, v49
    buffer_store_dwordx4 v[16:19], v6, s[84:87], s26 offen
    s_branch layerb1_kernel_j_next
layerb1_kernel_j_giveup:
    s_mov_b64 exec, -1
    v_mov_b32 v2, s43
    v_mov_b32 v3, -1
    ds_write_b32 v2, v3
    s_waitcnt lgkmcnt(0)
    s_barrier
    s_branch layerb1_kernel_bail
layerb1_kernel_j_done:
    s_branch layerb1_kernel_end
layerb1_kernel_bail:
    s_mov_b64 exec, 1
    s_load_dwordx2 s[6:7], s[0:1], 88
    s_waitcnt lgkmcnt(0)
    s_mov_b32 s24, s6
    s_mov_b32 s25, s7
    s_mov_b32 s26, 256
    s_mov_b32 s27, 0x00020000
    v_mov_b32 v1, 0xdead
    v_mov_b32 v2, s14
    v_mov_b32 v3, 0
    buffer_store_dword v1, v3, s[24:27], 0 offen
    buffer_store_dword v2, v3, s[24:27], 0 offen offset:4
layerb1_kernel_end:
layerb1_kernel_end0:
    s_endpgm
.section .rodata,"a"
.p2align 6
.amdhsa_kernel layerb1_kernel
  .amdhsa_next_free_vgpr 512
  .amdhsa_next_free_sgpr 100
  .amdhsa_accum_offset 256
  .amdhsa_group_segment_fixed_size 0
  .amdhsa_kernarg_size 104
  .amdhsa_user_sgpr_count 2
  .amdhsa_user_sgpr_kernarg_segment_ptr 1
  .amdhsa_system_sgpr_workgroup_id_x 1
.end_amdhsa_kernel
```

```asm
; @launch kernel=prep_kernel grid=(736,1,1) block=(256,1,1) lds=49152
; @launch kernel=layerb1_kernel grid=(256,1,1) block=(256,1,1) lds=149760
; @launch kernel=layerb2_kernel grid=(256,1,1) block=(256,1,1) lds=149760
.amdgcn_target "amdgcn-amd-amdhsa--gfx950"
.text
.globl prep_kernel
.p2align 8
.type prep_kernel,@function
prep_kernel:
    s_cmp_ge_u32 s2, 736
    s_cbranch_scc1 prep_kernel_end
    s_load_dwordx2 s[4:5], s[0:1], 96
    v_lshrrev_b32 v1, 6, v0
    v_and_b32 v0, 63, v0
    s_nop 0
    v_readfirstlane_b32 s13, v1
    s_waitcnt lgkmcnt(0)
    s_mov_b32 s8, s4
    s_mov_b32 s9, s5
    s_mov_b32 s10, 268435456
    s_mov_b32 s11, 0x00020000
    s_cmp_ge_u32 s2, 64
    s_cbranch_scc1 prep_kernel_ord1
    s_sub_u32 s20, s2, 0
    s_branch prep_kernel_r_pwa
prep_kernel_ord1:
    s_cmp_ge_u32 s2, 65
    s_cbranch_scc1 prep_kernel_ord2
    s_sub_u32 s20, s2, 64
    s_branch prep_kernel_r_zero
prep_kernel_ord2:
    s_cmp_ge_u32 s2, 72
    s_cbranch_scc1 prep_kernel_ord3
    s_sub_u32 s20, s2, 65
    s_branch prep_kernel_r_pad
prep_kernel_ord3:
    s_cmp_ge_u32 s2, 112
    s_cbranch_scc1 prep_kernel_ord4
    s_sub_u32 s20, s2, 72
    s_branch prep_kernel_r_pwo
prep_kernel_ord4:
    s_cmp_ge_u32 s2, 432
    s_cbranch_scc1 prep_kernel_ord5
    s_sub_u32 s20, s2, 112
    s_branch prep_kernel_r_wvx
prep_kernel_ord5:
    s_cmp_ge_u32 s2, 672
    s_cbranch_scc1 prep_kernel_ord6
    s_sub_u32 s20, s2, 432
    s_branch prep_kernel_r_pwp
prep_kernel_ord6:
    s_cmp_ge_u32 s2, 736
    s_cbranch_scc1 prep_kernel_ord7
    s_sub_u32 s20, s2, 672
    s_branch prep_kernel_r_clr
prep_kernel_ord7:
prep_kernel_r_pad:
    s_branch prep_kernel_end
prep_kernel_r_wvx:
    s_lshr_b32 s21, s20, 3
    s_mul_i32 s22, s21, 6554
    s_lshr_b32 s22, s22, 16
    s_mul_i32 s23, s22, 10
    s_sub_u32 s21, s21, s23
    s_lshl_b32 s22, s22, 3
    s_and_b32 s20, s20, 7
    s_add_u32 s20, s20, s22
    s_mul_i32 s20, s20, 10
    s_add_u32 s20, s20, s21
    s_branch prep_kernel_r_wvo
    s_mov_b32 s20, s2
    s_cmp_lt_u32 s2, 4
    s_cbranch_scc1 prep_kernel_r_cal
    s_cmp_eq_u32 s2, 4
    s_cbranch_scc1 prep_kernel_r_zero
    s_sub_u32 s20, s2, 5
    s_cmp_lt_u32 s20, 64
    s_cbranch_scc1 prep_kernel_r_pwa
    s_sub_u32 s20, s20, 64
    s_cmp_lt_u32 s20, 40
    s_cbranch_scc1 prep_kernel_r_pwo
    s_sub_u32 s20, s20, 40
    s_cmp_lt_u32 s20, 320
    s_cbranch_scc1 prep_kernel_r_wvo
    s_sub_u32 s20, s20, 320
    s_cmp_lt_u32 s20, 240
    s_cbranch_scc1 prep_kernel_r_pwp
    s_sub_u32 s20, s20, 240
prep_kernel_r_clr:
    s_sub_u32 s21, 0, s4
    s_and_b32 s21, s21, 0x1fffff
    s_mul_i32 s22, s20, 131072
    s_add_u32 s21, s21, s22
    s_lshl_b32 s22, s13, 10
    s_add_u32 s21, s21, s22
    v_lshlrev_b32 v1, 4, v0
    v_mov_b32 v4, -1
    v_mov_b32 v5, -1
    v_mov_b32 v6, -1
    v_mov_b32 v7, -1
    s_mov_b32 s22, 32
prep_kernel_clr_loop:
    buffer_store_dwordx4 v[4:7], v1, s[8:11], s21 offen
    s_add_u32 s21, s21, 4096
    s_sub_u32 s22, s22, 1
    s_cmp_lg_u32 s22, 0
    s_cbranch_scc1 prep_kernel_clr_loop
    s_branch prep_kernel_end
prep_kernel_r_cal:
    s_branch prep_kernel_end
    s_cmp_lg_u32 s13, 0
    s_cbranch_scc1 prep_kernel_end
    s_sub_u32 s22, 0, s4
    s_and_b32 s22, s22, 0x1fffff
    s_getreg_b32 s23, hwreg(HW_REG_XCC_ID)
    s_bfe_u32 s23, s23, 0x10002
    s_mov_b64 exec, 1
    v_mov_b32 v1, 0
    s_mul_i32 s24, s20, 2097152
    s_add_u32 s22, s22, s24
    s_add_u32 s22, s22, 2086912
    s_mov_b32 s30, -1
    s_mov_b32 s31, -1
    s_mov_b32 s25, 8
    v_mov_b32 v2, 0
prep_kernel_cal:
    s_and_b32 s24, s25, 15
    s_lshl_b32 s24, s24, 7
    s_add_u32 s24, s24, s22
    s_memtime s[26:27]
    s_waitcnt lgkmcnt(0)
    buffer_atomic_add v2, v1, s[8:11], s24 offen sc0 sc1
    s_waitcnt vmcnt(0)
    s_memtime s[28:29]
    v_mov_b32 v2, 0
    s_waitcnt lgkmcnt(0)
    s_sub_u32 s26, s28, s26
    s_min_u32 s30, s30, s26
    s_and_b32 s24, s25, 15
    s_lshl_b32 s24, s24, 7
    s_add_u32 s24, s24, s22
    s_add_u32 s24, s24, 8192
    s_memtime s[26:27]
    s_waitcnt lgkmcnt(0)
    buffer_atomic_add v2, v1, s[8:11], s24 offen sc0 sc1
    s_waitcnt vmcnt(0)
    s_memtime s[28:29]
    v_mov_b32 v2, 0
    s_waitcnt lgkmcnt(0)
    s_sub_u32 s26, s28, s26
    s_min_u32 s31, s31, s26
    s_sub_u32 s25, s25, 1
    s_cmp_lg_u32 s25, 0
    s_cbranch_scc1 prep_kernel_cal
    s_cmp_lt_u32 s31, s30
    s_cselect_b32 s24, 1, 0
    s_xor_b32 s24, s24, s23
    s_lshl_b32 s24, s24, 13
    v_mov_b32 v3, s24
    s_lshl_b32 s25, s20, 2
    s_add_u32 s25, s25, 10551296
    buffer_store_dword v3, v1, s[8:11], s25 offen
    s_lshl_b32 s26, s30, 16
    s_or_b32 s26, s26, s31
    v_mov_b32 v3, s26
    buffer_store_dword v3, v1, s[8:11], s25 offen offset:64
    s_branch prep_kernel_end
prep_kernel_r_zero:
    v_lshlrev_b32 v1, 4, v0
    v_mov_b32 v4, 0
    v_mov_b32 v5, 0
    v_mov_b32 v6, 0
    v_mov_b32 v7, 0
    s_lshl_b32 s21, s13, 10
    s_add_u32 s21, s21, 10485760
    buffer_store_dwordx4 v[4:7], v1, s[8:11], s21 offen
    s_lshl_b32 s21, s13, 15
    s_add_u32 s21, s21, 10616832
    buffer_store_dwordx4 v[4:7], v1, s[8:11], s21 offen offset:0
    buffer_store_dwordx4 v[4:7], v1, s[8:11], s21 offen offset:1024
    buffer_store_dwordx4 v[4:7], v1, s[8:11], s21 offen offset:2048
    buffer_store_dwordx4 v[4:7], v1, s[8:11], s21 offen offset:3072
    s_add_u32 s21, s21, 4096
    buffer_store_dwordx4 v[4:7], v1, s[8:11], s21 offen offset:0
    buffer_store_dwordx4 v[4:7], v1, s[8:11], s21 offen offset:1024
    buffer_store_dwordx4 v[4:7], v1, s[8:11], s21 offen offset:2048
    buffer_store_dwordx4 v[4:7], v1, s[8:11], s21 offen offset:3072
    s_add_u32 s21, s21, 4096
    buffer_store_dwordx4 v[4:7], v1, s[8:11], s21 offen offset:0
    buffer_store_dwordx4 v[4:7], v1, s[8:11], s21 offen offset:1024
    buffer_store_dwordx4 v[4:7], v1, s[8:11], s21 offen offset:2048
    buffer_store_dwordx4 v[4:7], v1, s[8:11], s21 offen offset:3072
    s_add_u32 s21, s21, 4096
    buffer_store_dwordx4 v[4:7], v1, s[8:11], s21 offen offset:0
    buffer_store_dwordx4 v[4:7], v1, s[8:11], s21 offen offset:1024
    buffer_store_dwordx4 v[4:7], v1, s[8:11], s21 offen offset:2048
    buffer_store_dwordx4 v[4:7], v1, s[8:11], s21 offen offset:3072
    s_add_u32 s21, s21, 4096
    buffer_store_dwordx4 v[4:7], v1, s[8:11], s21 offen offset:0
    buffer_store_dwordx4 v[4:7], v1, s[8:11], s21 offen offset:1024
    buffer_store_dwordx4 v[4:7], v1, s[8:11], s21 offen offset:2048
    buffer_store_dwordx4 v[4:7], v1, s[8:11], s21 offen offset:3072
    s_add_u32 s21, s21, 4096
    buffer_store_dwordx4 v[4:7], v1, s[8:11], s21 offen offset:0
    buffer_store_dwordx4 v[4:7], v1, s[8:11], s21 offen offset:1024
    buffer_store_dwordx4 v[4:7], v1, s[8:11], s21 offen offset:2048
    buffer_store_dwordx4 v[4:7], v1, s[8:11], s21 offen offset:3072
    s_add_u32 s21, s21, 4096
    buffer_store_dwordx4 v[4:7], v1, s[8:11], s21 offen offset:0
    buffer_store_dwordx4 v[4:7], v1, s[8:11], s21 offen offset:1024
    buffer_store_dwordx4 v[4:7], v1, s[8:11], s21 offen offset:2048
    buffer_store_dwordx4 v[4:7], v1, s[8:11], s21 offen offset:3072
    s_add_u32 s21, s21, 4096
    buffer_store_dwordx4 v[4:7], v1, s[8:11], s21 offen offset:0
    buffer_store_dwordx4 v[4:7], v1, s[8:11], s21 offen offset:1024
    buffer_store_dwordx4 v[4:7], v1, s[8:11], s21 offen offset:2048
    buffer_store_dwordx4 v[4:7], v1, s[8:11], s21 offen offset:3072
    s_add_u32 s21, s21, 4096
    s_lshl_b32 s21, s13, 15
    s_add_u32 s21, s21, 10747904
    buffer_store_dwordx4 v[4:7], v1, s[8:11], s21 offen offset:0
    buffer_store_dwordx4 v[4:7], v1, s[8:11], s21 offen offset:1024
    buffer_store_dwordx4 v[4:7], v1, s[8:11], s21 offen offset:2048
    buffer_store_dwordx4 v[4:7], v1, s[8:11], s21 offen offset:3072
    s_add_u32 s21, s21, 4096
    buffer_store_dwordx4 v[4:7], v1, s[8:11], s21 offen offset:0
    buffer_store_dwordx4 v[4:7], v1, s[8:11], s21 offen offset:1024
    buffer_store_dwordx4 v[4:7], v1, s[8:11], s21 offen offset:2048
    buffer_store_dwordx4 v[4:7], v1, s[8:11], s21 offen offset:3072
    s_add_u32 s21, s21, 4096
    buffer_store_dwordx4 v[4:7], v1, s[8:11], s21 offen offset:0
    buffer_store_dwordx4 v[4:7], v1, s[8:11], s21 offen offset:1024
    buffer_store_dwordx4 v[4:7], v1, s[8:11], s21 offen offset:2048
    buffer_store_dwordx4 v[4:7], v1, s[8:11], s21 offen offset:3072
    s_add_u32 s21, s21, 4096
    buffer_store_dwordx4 v[4:7], v1, s[8:11], s21 offen offset:0
    buffer_store_dwordx4 v[4:7], v1, s[8:11], s21 offen offset:1024
    buffer_store_dwordx4 v[4:7], v1, s[8:11], s21 offen offset:2048
    buffer_store_dwordx4 v[4:7], v1, s[8:11], s21 offen offset:3072
    s_add_u32 s21, s21, 4096
    buffer_store_dwordx4 v[4:7], v1, s[8:11], s21 offen offset:0
    buffer_store_dwordx4 v[4:7], v1, s[8:11], s21 offen offset:1024
    buffer_store_dwordx4 v[4:7], v1, s[8:11], s21 offen offset:2048
    buffer_store_dwordx4 v[4:7], v1, s[8:11], s21 offen offset:3072
    s_add_u32 s21, s21, 4096
    buffer_store_dwordx4 v[4:7], v1, s[8:11], s21 offen offset:0
    buffer_store_dwordx4 v[4:7], v1, s[8:11], s21 offen offset:1024
    buffer_store_dwordx4 v[4:7], v1, s[8:11], s21 offen offset:2048
    buffer_store_dwordx4 v[4:7], v1, s[8:11], s21 offen offset:3072
    s_add_u32 s21, s21, 4096
    buffer_store_dwordx4 v[4:7], v1, s[8:11], s21 offen offset:0
    buffer_store_dwordx4 v[4:7], v1, s[8:11], s21 offen offset:1024
    buffer_store_dwordx4 v[4:7], v1, s[8:11], s21 offen offset:2048
    buffer_store_dwordx4 v[4:7], v1, s[8:11], s21 offen offset:3072
    s_add_u32 s21, s21, 4096
    buffer_store_dwordx4 v[4:7], v1, s[8:11], s21 offen offset:0
    buffer_store_dwordx4 v[4:7], v1, s[8:11], s21 offen offset:1024
    buffer_store_dwordx4 v[4:7], v1, s[8:11], s21 offen offset:2048
    buffer_store_dwordx4 v[4:7], v1, s[8:11], s21 offen offset:3072
    s_add_u32 s21, s21, 4096
    s_branch prep_kernel_end
prep_kernel_r_wvo:
    s_load_dwordx2 s[24:25], s[0:1], 56
    s_load_dwordx2 s[26:27], s[0:1], 64
    s_mul_i32 s23, s20, 6554
    s_lshr_b32 s23, s23, 16
    s_mul_i32 s28, s23, 10
    s_sub_u32 s22, s20, s28
    s_and_b32 s21, s22, 1
    s_lshr_b32 s22, s22, 1
    s_waitcnt lgkmcnt(0)
    s_mov_b32 s32, s24
    s_mov_b32 s33, s25
    s_mov_b32 s34, 7864320
    s_mov_b32 s35, 0x00020000
    s_mov_b32 s36, s26
    s_mov_b32 s37, s27
    s_mov_b32 s38, 7864320
    s_mov_b32 s39, 0x00020000
    v_and_b32 v1, 31, v0
    v_lshrrev_b32 v2, 5, v0
    v_lshrrev_b32 v11, 3, v0
    v_mul_u32_u24 v3, 1280, v11
    v_bfe_u32 v12, v0, 4, 1
    v_lshlrev_b32 v12, 2, v12
    v_and_b32 v13, 7, v0
    v_xor_b32 v13, v13, v12
    v_lshl_add_u32 v3, v13, 4, v3
    s_mul_i32 s28, s23, 192
    s_mul_i32 s29, s13, 48
    s_add_u32 s28, s28, s29
    s_mul_i32 s28, s28, 1280
    s_mul_i32 s29, s21, 640
    s_add_u32 s28, s28, s29
    s_mul_i32 s29, s13, 6144
    v_bfe_u32 v11, v0, 2, 2
    v_lshl_add_u32 v12, v2, 3, v11
    v_lshlrev_b32 v12, 7, v12
    v_bfe_u32 v13, v0, 4, 1
    v_lshlrev_b32 v13, 1, v13
    v_bfe_u32 v14, v0, 1, 1
    v_add_u32 v13, v13, v14
    v_lshl_add_u32 v12, v13, 4, v12
    v_and_b32 v13, 1, v0
    v_lshl_add_u32 v12, v13, 3, v12
    v_bfe_u32 v13, v0, 3, 1
    v_lshl_add_u32 v4, v13, 6, v12
    v_xor_b32 v13, 1, v13
    v_lshl_add_u32 v5, v13, 6, v12
    v_lshrrev_b32 v6, 3, v1
    v_lshrrev_b32 v7, 2, v6
    v_lshlrev_b32 v7, 5, v7
    v_and_b32 v8, 2, v6
    v_lshl_add_u32 v7, v8, 3, v7
    v_and_b32 v8, 1, v6
    v_lshl_add_u32 v7, v8, 2, v7
    v_and_b32 v8, 7, v1
    v_and_b32 v9, 1, v8
    v_add_u32 v7, v7, v9
    v_and_b32 v9, 2, v8
    v_lshl_add_u32 v7, v9, 2, v7
    v_lshrrev_b32 v9, 2, v8
    v_lshl_add_u32 v7, v9, 1, v7
    v_mul_u32_u24 v7, 12288, v7
    v_lshl_add_u32 v7, v2, 4, v7
    s_lshl_b32 s30, s22, 2
    s_add_u32 s30, s30, s13
    s_mul_i32 s31, s30, 393216
    s_mul_i32 s40, s23, 384
    s_add_u32 s31, s31, s40
    v_lshrrev_b32 v10, 3, v1
    v_mul_u32_u24 v10, 20480, v10
    v_lshlrev_b32 v10, 4, v10
    v_and_b32 v11, 7, v1
    v_lshl_add_u32 v10, v11, 4, v10
    v_lshl_add_u32 v10, v2, 8, v10
    s_mul_i32 s41, s21, 13107200
    s_lshr_b32 s40, s23, 3
    s_mul_i32 s40, s40, 81920
    s_add_u32 s41, s41, s40
    s_and_b32 s40, s23, 3
    s_mul_i32 s40, s40, 20480
    s_add_u32 s41, s41, s40
    s_bfe_u32 s40, s23, 0x10002
    s_lshl_b32 s40, s40, 7
    s_add_u32 s41, s41, s40
    s_lshl_b32 s40, s30, 10
    s_add_u32 s41, s41, s40
    s_add_u32 s41, s41, 27262976
    buffer_load_dwordx4 v[16:19], v7, s[32:35], s31 offen offset:0
    buffer_load_dwordx4 v[20:23], v7, s[32:35], s31 offen offset:32
    buffer_load_dwordx4 v[24:27], v7, s[32:35], s31 offen offset:64
    buffer_load_dwordx4 v[28:31], v7, s[32:35], s31 offen offset:96
    buffer_load_dwordx4 v[32:35], v7, s[32:35], s31 offen offset:128
    buffer_load_dwordx4 v[36:39], v7, s[32:35], s31 offen offset:160
    buffer_load_dwordx4 v[40:43], v7, s[32:35], s31 offen offset:192
    buffer_load_dwordx4 v[44:47], v7, s[32:35], s31 offen offset:224
    buffer_load_dwordx4 v[48:51], v7, s[32:35], s31 offen offset:256
    buffer_load_dwordx4 v[52:55], v7, s[32:35], s31 offen offset:288
    buffer_load_dwordx4 v[56:59], v7, s[32:35], s31 offen offset:320
    buffer_load_dwordx4 v[60:63], v7, s[32:35], s31 offen offset:352
    s_add_u32 s42, s29, 0
    s_mov_b32 m0, s42
    s_add_u32 s43, s28, 0
    buffer_load_dwordx4 v3, s[36:39], s43 offen lds
    s_add_u32 s42, s29, 1024
    s_mov_b32 m0, s42
    s_add_u32 s43, s28, 10240
    buffer_load_dwordx4 v3, s[36:39], s43 offen lds
    s_add_u32 s42, s29, 2048
    s_mov_b32 m0, s42
    s_add_u32 s43, s28, 20480
    buffer_load_dwordx4 v3, s[36:39], s43 offen lds
    s_add_u32 s42, s29, 3072
    s_mov_b32 m0, s42
    s_add_u32 s43, s28, 30720
    buffer_load_dwordx4 v3, s[36:39], s43 offen lds
    s_add_u32 s42, s29, 4096
    s_mov_b32 m0, s42
    s_add_u32 s43, s28, 40960
    buffer_load_dwordx4 v3, s[36:39], s43 offen lds
    s_add_u32 s42, s29, 5120
    s_mov_b32 m0, s42
    s_add_u32 s43, s28, 51200
    buffer_load_dwordx4 v3, s[36:39], s43 offen lds
    s_add_u32 s42, s29, 24576
    s_mov_b32 m0, s42
    s_add_u32 s43, s28, 128
    buffer_load_dwordx4 v3, s[36:39], s43 offen lds
    s_add_u32 s42, s29, 25600
    s_mov_b32 m0, s42
    s_add_u32 s43, s28, 10368
    buffer_load_dwordx4 v3, s[36:39], s43 offen lds
    s_add_u32 s42, s29, 26624
    s_mov_b32 m0, s42
    s_add_u32 s43, s28, 20608
    buffer_load_dwordx4 v3, s[36:39], s43 offen lds
    s_add_u32 s42, s29, 27648
    s_mov_b32 m0, s42
    s_add_u32 s43, s28, 30848
    buffer_load_dwordx4 v3, s[36:39], s43 offen lds
    s_add_u32 s42, s29, 28672
    s_mov_b32 m0, s42
    s_add_u32 s43, s28, 41088
    buffer_load_dwordx4 v3, s[36:39], s43 offen lds
    s_add_u32 s42, s29, 29696
    s_mov_b32 m0, s42
    s_add_u32 s43, s28, 51328
    buffer_load_dwordx4 v3, s[36:39], s43 offen lds
    v_add_u32 v152, 0, v4
    v_add_u32 v153, 0, v5
    v_add_u32 v154, 24576, v4
    v_add_u32 v155, 24576, v5
    s_waitcnt vmcnt(6)
    s_barrier
    ds_read_b64_tr_b16 v[64:65], v152 offset:0
    ds_read_b64_tr_b16 v[66:67], v152 offset:512
    ds_read_b64_tr_b16 v[68:69], v152 offset:2048
    ds_read_b64_tr_b16 v[70:71], v152 offset:2560
    ds_read_b64_tr_b16 v[72:73], v152 offset:4096
    ds_read_b64_tr_b16 v[74:75], v152 offset:4608
    ds_read_b64_tr_b16 v[76:77], v152 offset:6144
    ds_read_b64_tr_b16 v[78:79], v152 offset:6656
    ds_read_b64_tr_b16 v[80:81], v152 offset:8192
    ds_read_b64_tr_b16 v[82:83], v152 offset:8704
    ds_read_b64_tr_b16 v[84:85], v152 offset:10240
    ds_read_b64_tr_b16 v[86:87], v152 offset:10752
    s_waitcnt lgkmcnt(0)
    ds_read_b64_tr_b16 v[88:89], v152 offset:12288
    ds_read_b64_tr_b16 v[90:91], v152 offset:12800
    ds_read_b64_tr_b16 v[92:93], v152 offset:14336
    ds_read_b64_tr_b16 v[94:95], v152 offset:14848
    ds_read_b64_tr_b16 v[96:97], v152 offset:16384
    ds_read_b64_tr_b16 v[98:99], v152 offset:16896
    ds_read_b64_tr_b16 v[100:101], v152 offset:18432
    ds_read_b64_tr_b16 v[102:103], v152 offset:18944
    ds_read_b64_tr_b16 v[104:105], v152 offset:20480
    ds_read_b64_tr_b16 v[106:107], v152 offset:20992
    ds_read_b64_tr_b16 v[108:109], v152 offset:22528
    ds_read_b64_tr_b16 v[110:111], v152 offset:23040
    s_waitcnt lgkmcnt(0)
    v_mfma_f32_32x32x16_bf16 v[112:127], v[16:19], v[64:67], 0
    ds_read_b64_tr_b16 v[64:65], v153 offset:0
    ds_read_b64_tr_b16 v[66:67], v153 offset:512
    v_mfma_f32_32x32x16_bf16 v[112:127], v[20:23], v[68:71], v[112:127]
    ds_read_b64_tr_b16 v[68:69], v153 offset:2048
    ds_read_b64_tr_b16 v[70:71], v153 offset:2560
    v_mfma_f32_32x32x16_bf16 v[112:127], v[24:27], v[72:75], v[112:127]
    ds_read_b64_tr_b16 v[72:73], v153 offset:4096
    ds_read_b64_tr_b16 v[74:75], v153 offset:4608
    v_mfma_f32_32x32x16_bf16 v[112:127], v[28:31], v[76:79], v[112:127]
    ds_read_b64_tr_b16 v[76:77], v153 offset:6144
    ds_read_b64_tr_b16 v[78:79], v153 offset:6656
    v_mfma_f32_32x32x16_bf16 v[112:127], v[32:35], v[80:83], v[112:127]
    ds_read_b64_tr_b16 v[80:81], v153 offset:8192
    ds_read_b64_tr_b16 v[82:83], v153 offset:8704
    v_mfma_f32_32x32x16_bf16 v[112:127], v[36:39], v[84:87], v[112:127]
    ds_read_b64_tr_b16 v[84:85], v153 offset:10240
    ds_read_b64_tr_b16 v[86:87], v153 offset:10752
    v_mfma_f32_32x32x16_bf16 v[112:127], v[40:43], v[88:91], v[112:127]
    ds_read_b64_tr_b16 v[88:89], v153 offset:12288
    ds_read_b64_tr_b16 v[90:91], v153 offset:12800
    v_mfma_f32_32x32x16_bf16 v[112:127], v[44:47], v[92:95], v[112:127]
    ds_read_b64_tr_b16 v[92:93], v153 offset:14336
    ds_read_b64_tr_b16 v[94:95], v153 offset:14848
    v_mfma_f32_32x32x16_bf16 v[112:127], v[48:51], v[96:99], v[112:127]
    ds_read_b64_tr_b16 v[96:97], v153 offset:16384
    ds_read_b64_tr_b16 v[98:99], v153 offset:16896
    v_mfma_f32_32x32x16_bf16 v[112:127], v[52:55], v[100:103], v[112:127]
    ds_read_b64_tr_b16 v[100:101], v153 offset:18432
    ds_read_b64_tr_b16 v[102:103], v153 offset:18944
    v_mfma_f32_32x32x16_bf16 v[112:127], v[56:59], v[104:107], v[112:127]
    ds_read_b64_tr_b16 v[104:105], v153 offset:20480
    ds_read_b64_tr_b16 v[106:107], v153 offset:20992
    v_mfma_f32_32x32x16_bf16 v[112:127], v[60:63], v[108:111], v[112:127]
    ds_read_b64_tr_b16 v[108:109], v153 offset:22528
    ds_read_b64_tr_b16 v[110:111], v153 offset:23040
    s_waitcnt lgkmcnt(0)
    s_waitcnt vmcnt(0)
    s_barrier
    s_add_u32 s42, s29, 0
    s_mov_b32 m0, s42
    s_add_u32 s43, s28, 256
    buffer_load_dwordx4 v3, s[36:39], s43 offen lds
    s_add_u32 s42, s29, 1024
    s_mov_b32 m0, s42
    s_add_u32 s43, s28, 10496
    buffer_load_dwordx4 v3, s[36:39], s43 offen lds
    s_add_u32 s42, s29, 2048
    s_mov_b32 m0, s42
    s_add_u32 s43, s28, 20736
    buffer_load_dwordx4 v3, s[36:39], s43 offen lds
    s_add_u32 s42, s29, 3072
    s_mov_b32 m0, s42
    s_add_u32 s43, s28, 30976
    buffer_load_dwordx4 v3, s[36:39], s43 offen lds
    s_add_u32 s42, s29, 4096
    s_mov_b32 m0, s42
    s_add_u32 s43, s28, 41216
    buffer_load_dwordx4 v3, s[36:39], s43 offen lds
    s_add_u32 s42, s29, 5120
    s_mov_b32 m0, s42
    s_add_u32 s43, s28, 51456
    buffer_load_dwordx4 v3, s[36:39], s43 offen lds
    v_mfma_f32_32x32x16_bf16 v[128:143], v[16:19], v[64:67], 0
    ds_read_b64_tr_b16 v[64:65], v154 offset:0
    ds_read_b64_tr_b16 v[66:67], v154 offset:512
    v_mfma_f32_32x32x16_bf16 v[128:143], v[20:23], v[68:71], v[128:143]
    ds_read_b64_tr_b16 v[68:69], v154 offset:2048
    ds_read_b64_tr_b16 v[70:71], v154 offset:2560
    v_mfma_f32_32x32x16_bf16 v[128:143], v[24:27], v[72:75], v[128:143]
    ds_read_b64_tr_b16 v[72:73], v154 offset:4096
    ds_read_b64_tr_b16 v[74:75], v154 offset:4608
    s_add_u32 s42, s41, 0
    v_cvt_pk_bf16_f32 v144, v112, v113
    v_cvt_pk_bf16_f32 v145, v114, v115
    v_mfma_f32_32x32x16_bf16 v[128:143], v[28:31], v[76:79], v[128:143]
    ds_read_b64_tr_b16 v[76:77], v154 offset:6144
    ds_read_b64_tr_b16 v[78:79], v154 offset:6656
    v_cvt_pk_bf16_f32 v146, v116, v117
    v_cvt_pk_bf16_f32 v147, v118, v119
    s_nop 1
    v_mfma_f32_32x32x16_bf16 v[128:143], v[32:35], v[80:83], v[128:143]
    ds_read_b64_tr_b16 v[80:81], v154 offset:8192
    ds_read_b64_tr_b16 v[82:83], v154 offset:8704
    v_permlane32_swap_b32 v144, v146
    v_permlane32_swap_b32 v145, v147
    buffer_store_dwordx4 v[144:147], v10, s[8:11], s42 offen offset:0
    v_mfma_f32_32x32x16_bf16 v[128:143], v[36:39], v[84:87], v[128:143]
    ds_read_b64_tr_b16 v[84:85], v154 offset:10240
    ds_read_b64_tr_b16 v[86:87], v154 offset:10752
    v_cvt_pk_bf16_f32 v148, v120, v121
    v_cvt_pk_bf16_f32 v149, v122, v123
    v_cvt_pk_bf16_f32 v150, v124, v125
    v_mfma_f32_32x32x16_bf16 v[128:143], v[40:43], v[88:91], v[128:143]
    ds_read_b64_tr_b16 v[88:89], v154 offset:12288
    ds_read_b64_tr_b16 v[90:91], v154 offset:12800
    v_cvt_pk_bf16_f32 v151, v126, v127
    s_nop 1
    v_permlane32_swap_b32 v148, v150
    v_mfma_f32_32x32x16_bf16 v[128:143], v[44:47], v[92:95], v[128:143]
    ds_read_b64_tr_b16 v[92:93], v154 offset:14336
    ds_read_b64_tr_b16 v[94:95], v154 offset:14848
    v_permlane32_swap_b32 v149, v151
    buffer_store_dwordx4 v[148:151], v10, s[8:11], s42 offen offset:512
    v_mfma_f32_32x32x16_bf16 v[128:143], v[48:51], v[96:99], v[128:143]
    ds_read_b64_tr_b16 v[96:97], v154 offset:16384
    ds_read_b64_tr_b16 v[98:99], v154 offset:16896
    v_mfma_f32_32x32x16_bf16 v[128:143], v[52:55], v[100:103], v[128:143]
    ds_read_b64_tr_b16 v[100:101], v154 offset:18432
    ds_read_b64_tr_b16 v[102:103], v154 offset:18944
    v_mfma_f32_32x32x16_bf16 v[128:143], v[56:59], v[104:107], v[128:143]
    ds_read_b64_tr_b16 v[104:105], v154 offset:20480
    ds_read_b64_tr_b16 v[106:107], v154 offset:20992
    v_mfma_f32_32x32x16_bf16 v[128:143], v[60:63], v[108:111], v[128:143]
    ds_read_b64_tr_b16 v[108:109], v154 offset:22528
    ds_read_b64_tr_b16 v[110:111], v154 offset:23040
    s_waitcnt lgkmcnt(0)
    v_mfma_f32_32x32x16_bf16 v[112:127], v[16:19], v[64:67], 0
    ds_read_b64_tr_b16 v[64:65], v155 offset:0
    ds_read_b64_tr_b16 v[66:67], v155 offset:512
    v_mfma_f32_32x32x16_bf16 v[112:127], v[20:23], v[68:71], v[112:127]
    ds_read_b64_tr_b16 v[68:69], v155 offset:2048
    ds_read_b64_tr_b16 v[70:71], v155 offset:2560
    v_mfma_f32_32x32x16_bf16 v[112:127], v[24:27], v[72:75], v[112:127]
    ds_read_b64_tr_b16 v[72:73], v155 offset:4096
    ds_read_b64_tr_b16 v[74:75], v155 offset:4608
    s_add_u32 s42, s41, 1310720
    v_cvt_pk_bf16_f32 v144, v128, v129
    v_cvt_pk_bf16_f32 v145, v130, v131
    v_mfma_f32_32x32x16_bf16 v[112:127], v[28:31], v[76:79], v[112:127]
    ds_read_b64_tr_b16 v[76:77], v155 offset:6144
    ds_read_b64_tr_b16 v[78:79], v155 offset:6656
    v_cvt_pk_bf16_f32 v146, v132, v133
    v_cvt_pk_bf16_f32 v147, v134, v135
    s_nop 1
    v_mfma_f32_32x32x16_bf16 v[112:127], v[32:35], v[80:83], v[112:127]
    ds_read_b64_tr_b16 v[80:81], v155 offset:8192
    ds_read_b64_tr_b16 v[82:83], v155 offset:8704
    v_permlane32_swap_b32 v144, v146
    v_permlane32_swap_b32 v145, v147
    buffer_store_dwordx4 v[144:147], v10, s[8:11], s42 offen offset:0
    v_mfma_f32_32x32x16_bf16 v[112:127], v[36:39], v[84:87], v[112:127]
    ds_read_b64_tr_b16 v[84:85], v155 offset:10240
    ds_read_b64_tr_b16 v[86:87], v155 offset:10752
    v_cvt_pk_bf16_f32 v148, v136, v137
    v_cvt_pk_bf16_f32 v149, v138, v139
    v_cvt_pk_bf16_f32 v150, v140, v141
    v_mfma_f32_32x32x16_bf16 v[112:127], v[40:43], v[88:91], v[112:127]
    ds_read_b64_tr_b16 v[88:89], v155 offset:12288
    ds_read_b64_tr_b16 v[90:91], v155 offset:12800
    v_cvt_pk_bf16_f32 v151, v142, v143
    s_nop 1
    v_permlane32_swap_b32 v148, v150
    v_mfma_f32_32x32x16_bf16 v[112:127], v[44:47], v[92:95], v[112:127]
    ds_read_b64_tr_b16 v[92:93], v155 offset:14336
    ds_read_b64_tr_b16 v[94:95], v155 offset:14848
    v_permlane32_swap_b32 v149, v151
    buffer_store_dwordx4 v[148:151], v10, s[8:11], s42 offen offset:512
    v_mfma_f32_32x32x16_bf16 v[112:127], v[48:51], v[96:99], v[112:127]
    ds_read_b64_tr_b16 v[96:97], v155 offset:16384
    ds_read_b64_tr_b16 v[98:99], v155 offset:16896
    v_mfma_f32_32x32x16_bf16 v[112:127], v[52:55], v[100:103], v[112:127]
    ds_read_b64_tr_b16 v[100:101], v155 offset:18432
    ds_read_b64_tr_b16 v[102:103], v155 offset:18944
    v_mfma_f32_32x32x16_bf16 v[112:127], v[56:59], v[104:107], v[112:127]
    ds_read_b64_tr_b16 v[104:105], v155 offset:20480
    ds_read_b64_tr_b16 v[106:107], v155 offset:20992
    v_mfma_f32_32x32x16_bf16 v[112:127], v[60:63], v[108:111], v[112:127]
    ds_read_b64_tr_b16 v[108:109], v155 offset:22528
    ds_read_b64_tr_b16 v[110:111], v155 offset:23040
    s_waitcnt lgkmcnt(0)
    s_waitcnt vmcnt(4)
    s_barrier
    s_add_u32 s42, s29, 24576
    s_mov_b32 m0, s42
    s_add_u32 s43, s28, 384
    buffer_load_dwordx4 v3, s[36:39], s43 offen lds
    s_add_u32 s42, s29, 25600
    s_mov_b32 m0, s42
    s_add_u32 s43, s28, 10624
    buffer_load_dwordx4 v3, s[36:39], s43 offen lds
    s_add_u32 s42, s29, 26624
    s_mov_b32 m0, s42
    s_add_u32 s43, s28, 20864
    buffer_load_dwordx4 v3, s[36:39], s43 offen lds
    s_add_u32 s42, s29, 27648
    s_mov_b32 m0, s42
    s_add_u32 s43, s28, 31104
    buffer_load_dwordx4 v3, s[36:39], s43 offen lds
    s_add_u32 s42, s29, 28672
    s_mov_b32 m0, s42
    s_add_u32 s43, s28, 41344
    buffer_load_dwordx4 v3, s[36:39], s43 offen lds
    s_add_u32 s42, s29, 29696
    s_mov_b32 m0, s42
    s_add_u32 s43, s28, 51584
    buffer_load_dwordx4 v3, s[36:39], s43 offen lds
    v_mfma_f32_32x32x16_bf16 v[128:143], v[16:19], v[64:67], 0
    ds_read_b64_tr_b16 v[64:65], v152 offset:0
    ds_read_b64_tr_b16 v[66:67], v152 offset:512
    v_mfma_f32_32x32x16_bf16 v[128:143], v[20:23], v[68:71], v[128:143]
    ds_read_b64_tr_b16 v[68:69], v152 offset:2048
    ds_read_b64_tr_b16 v[70:71], v152 offset:2560
    v_mfma_f32_32x32x16_bf16 v[128:143], v[24:27], v[72:75], v[128:143]
    ds_read_b64_tr_b16 v[72:73], v152 offset:4096
    ds_read_b64_tr_b16 v[74:75], v152 offset:4608
    s_add_u32 s42, s41, 2621440
    v_cvt_pk_bf16_f32 v144, v112, v113
    v_cvt_pk_bf16_f32 v145, v114, v115
    v_mfma_f32_32x32x16_bf16 v[128:143], v[28:31], v[76:79], v[128:143]
    ds_read_b64_tr_b16 v[76:77], v152 offset:6144
    ds_read_b64_tr_b16 v[78:79], v152 offset:6656
    v_cvt_pk_bf16_f32 v146, v116, v117
    v_cvt_pk_bf16_f32 v147, v118, v119
    s_nop 1
    v_mfma_f32_32x32x16_bf16 v[128:143], v[32:35], v[80:83], v[128:143]
    ds_read_b64_tr_b16 v[80:81], v152 offset:8192
    ds_read_b64_tr_b16 v[82:83], v152 offset:8704
    v_permlane32_swap_b32 v144, v146
    v_permlane32_swap_b32 v145, v147
    buffer_store_dwordx4 v[144:147], v10, s[8:11], s42 offen offset:0
    v_mfma_f32_32x32x16_bf16 v[128:143], v[36:39], v[84:87], v[128:143]
    ds_read_b64_tr_b16 v[84:85], v152 offset:10240
    ds_read_b64_tr_b16 v[86:87], v152 offset:10752
    v_cvt_pk_bf16_f32 v148, v120, v121
    v_cvt_pk_bf16_f32 v149, v122, v123
    v_cvt_pk_bf16_f32 v150, v124, v125
    v_mfma_f32_32x32x16_bf16 v[128:143], v[40:43], v[88:91], v[128:143]
    ds_read_b64_tr_b16 v[88:89], v152 offset:12288
    ds_read_b64_tr_b16 v[90:91], v152 offset:12800
    v_cvt_pk_bf16_f32 v151, v126, v127
    s_nop 1
    v_permlane32_swap_b32 v148, v150
    v_mfma_f32_32x32x16_bf16 v[128:143], v[44:47], v[92:95], v[128:143]
    ds_read_b64_tr_b16 v[92:93], v152 offset:14336
    ds_read_b64_tr_b16 v[94:95], v152 offset:14848
    v_permlane32_swap_b32 v149, v151
    buffer_store_dwordx4 v[148:151], v10, s[8:11], s42 offen offset:512
    v_mfma_f32_32x32x16_bf16 v[128:143], v[48:51], v[96:99], v[128:143]
    ds_read_b64_tr_b16 v[96:97], v152 offset:16384
    ds_read_b64_tr_b16 v[98:99], v152 offset:16896
    v_mfma_f32_32x32x16_bf16 v[128:143], v[52:55], v[100:103], v[128:143]
    ds_read_b64_tr_b16 v[100:101], v152 offset:18432
    ds_read_b64_tr_b16 v[102:103], v152 offset:18944
    v_mfma_f32_32x32x16_bf16 v[128:143], v[56:59], v[104:107], v[128:143]
    ds_read_b64_tr_b16 v[104:105], v152 offset:20480
    ds_read_b64_tr_b16 v[106:107], v152 offset:20992
    v_mfma_f32_32x32x16_bf16 v[128:143], v[60:63], v[108:111], v[128:143]
    ds_read_b64_tr_b16 v[108:109], v152 offset:22528
    ds_read_b64_tr_b16 v[110:111], v152 offset:23040
    s_waitcnt lgkmcnt(0)
    v_mfma_f32_32x32x16_bf16 v[112:127], v[16:19], v[64:67], 0
    ds_read_b64_tr_b16 v[64:65], v153 offset:0
    ds_read_b64_tr_b16 v[66:67], v153 offset:512
    v_mfma_f32_32x32x16_bf16 v[112:127], v[20:23], v[68:71], v[112:127]
    ds_read_b64_tr_b16 v[68:69], v153 offset:2048
    ds_read_b64_tr_b16 v[70:71], v153 offset:2560
    v_mfma_f32_32x32x16_bf16 v[112:127], v[24:27], v[72:75], v[112:127]
    ds_read_b64_tr_b16 v[72:73], v153 offset:4096
    ds_read_b64_tr_b16 v[74:75], v153 offset:4608
    s_add_u32 s42, s41, 3932160
    v_cvt_pk_bf16_f32 v144, v128, v129
    v_cvt_pk_bf16_f32 v145, v130, v131
    v_mfma_f32_32x32x16_bf16 v[112:127], v[28:31], v[76:79], v[112:127]
    ds_read_b64_tr_b16 v[76:77], v153 offset:6144
    ds_read_b64_tr_b16 v[78:79], v153 offset:6656
    v_cvt_pk_bf16_f32 v146, v132, v133
    v_cvt_pk_bf16_f32 v147, v134, v135
    s_nop 1
    v_mfma_f32_32x32x16_bf16 v[112:127], v[32:35], v[80:83], v[112:127]
    ds_read_b64_tr_b16 v[80:81], v153 offset:8192
    ds_read_b64_tr_b16 v[82:83], v153 offset:8704
    v_permlane32_swap_b32 v144, v146
    v_permlane32_swap_b32 v145, v147
    buffer_store_dwordx4 v[144:147], v10, s[8:11], s42 offen offset:0
    v_mfma_f32_32x32x16_bf16 v[112:127], v[36:39], v[84:87], v[112:127]
    ds_read_b64_tr_b16 v[84:85], v153 offset:10240
    ds_read_b64_tr_b16 v[86:87], v153 offset:10752
    v_cvt_pk_bf16_f32 v148, v136, v137
    v_cvt_pk_bf16_f32 v149, v138, v139
    v_cvt_pk_bf16_f32 v150, v140, v141
    v_mfma_f32_32x32x16_bf16 v[112:127], v[40:43], v[88:91], v[112:127]
    ds_read_b64_tr_b16 v[88:89], v153 offset:12288
    ds_read_b64_tr_b16 v[90:91], v153 offset:12800
    v_cvt_pk_bf16_f32 v151, v142, v143
    s_nop 1
    v_permlane32_swap_b32 v148, v150
    v_mfma_f32_32x32x16_bf16 v[112:127], v[44:47], v[92:95], v[112:127]
    ds_read_b64_tr_b16 v[92:93], v153 offset:14336
    ds_read_b64_tr_b16 v[94:95], v153 offset:14848
    v_permlane32_swap_b32 v149, v151
    buffer_store_dwordx4 v[148:151], v10, s[8:11], s42 offen offset:512
    v_mfma_f32_32x32x16_bf16 v[112:127], v[48:51], v[96:99], v[112:127]
    ds_read_b64_tr_b16 v[96:97], v153 offset:16384
    ds_read_b64_tr_b16 v[98:99], v153 offset:16896
    v_mfma_f32_32x32x16_bf16 v[112:127], v[52:55], v[100:103], v[112:127]
    ds_read_b64_tr_b16 v[100:101], v153 offset:18432
    ds_read_b64_tr_b16 v[102:103], v153 offset:18944
    v_mfma_f32_32x32x16_bf16 v[112:127], v[56:59], v[104:107], v[112:127]
    ds_read_b64_tr_b16 v[104:105], v153 offset:20480
    ds_read_b64_tr_b16 v[106:107], v153 offset:20992
    v_mfma_f32_32x32x16_bf16 v[112:127], v[60:63], v[108:111], v[112:127]
    ds_read_b64_tr_b16 v[108:109], v153 offset:22528
    ds_read_b64_tr_b16 v[110:111], v153 offset:23040
    s_waitcnt lgkmcnt(0)
    s_waitcnt vmcnt(4)
    s_barrier
    s_add_u32 s42, s29, 0
    s_mov_b32 m0, s42
    s_add_u32 s43, s28, 512
    buffer_load_dwordx4 v3, s[36:39], s43 offen lds
    s_add_u32 s42, s29, 1024
    s_mov_b32 m0, s42
    s_add_u32 s43, s28, 10752
    buffer_load_dwordx4 v3, s[36:39], s43 offen lds
    s_add_u32 s42, s29, 2048
    s_mov_b32 m0, s42
    s_add_u32 s43, s28, 20992
    buffer_load_dwordx4 v3, s[36:39], s43 offen lds
    s_add_u32 s42, s29, 3072
    s_mov_b32 m0, s42
    s_add_u32 s43, s28, 31232
    buffer_load_dwordx4 v3, s[36:39], s43 offen lds
    s_add_u32 s42, s29, 4096
    s_mov_b32 m0, s42
    s_add_u32 s43, s28, 41472
    buffer_load_dwordx4 v3, s[36:39], s43 offen lds
    s_add_u32 s42, s29, 5120
    s_mov_b32 m0, s42
    s_add_u32 s43, s28, 51712
    buffer_load_dwordx4 v3, s[36:39], s43 offen lds
    v_mfma_f32_32x32x16_bf16 v[128:143], v[16:19], v[64:67], 0
    ds_read_b64_tr_b16 v[64:65], v154 offset:0
    ds_read_b64_tr_b16 v[66:67], v154 offset:512
    v_mfma_f32_32x32x16_bf16 v[128:143], v[20:23], v[68:71], v[128:143]
    ds_read_b64_tr_b16 v[68:69], v154 offset:2048
    ds_read_b64_tr_b16 v[70:71], v154 offset:2560
    v_mfma_f32_32x32x16_bf16 v[128:143], v[24:27], v[72:75], v[128:143]
    ds_read_b64_tr_b16 v[72:73], v154 offset:4096
    ds_read_b64_tr_b16 v[74:75], v154 offset:4608
    s_add_u32 s42, s41, 5242880
    v_cvt_pk_bf16_f32 v144, v112, v113
    v_cvt_pk_bf16_f32 v145, v114, v115
    v_mfma_f32_32x32x16_bf16 v[128:143], v[28:31], v[76:79], v[128:143]
    ds_read_b64_tr_b16 v[76:77], v154 offset:6144
    ds_read_b64_tr_b16 v[78:79], v154 offset:6656
    v_cvt_pk_bf16_f32 v146, v116, v117
    v_cvt_pk_bf16_f32 v147, v118, v119
    s_nop 1
    v_mfma_f32_32x32x16_bf16 v[128:143], v[32:35], v[80:83], v[128:143]
    ds_read_b64_tr_b16 v[80:81], v154 offset:8192
    ds_read_b64_tr_b16 v[82:83], v154 offset:8704
    v_permlane32_swap_b32 v144, v146
    v_permlane32_swap_b32 v145, v147
    buffer_store_dwordx4 v[144:147], v10, s[8:11], s42 offen offset:0
    v_mfma_f32_32x32x16_bf16 v[128:143], v[36:39], v[84:87], v[128:143]
    ds_read_b64_tr_b16 v[84:85], v154 offset:10240
    ds_read_b64_tr_b16 v[86:87], v154 offset:10752
    v_cvt_pk_bf16_f32 v148, v120, v121
    v_cvt_pk_bf16_f32 v149, v122, v123
    v_cvt_pk_bf16_f32 v150, v124, v125
    v_mfma_f32_32x32x16_bf16 v[128:143], v[40:43], v[88:91], v[128:143]
    ds_read_b64_tr_b16 v[88:89], v154 offset:12288
    ds_read_b64_tr_b16 v[90:91], v154 offset:12800
    v_cvt_pk_bf16_f32 v151, v126, v127
    s_nop 1
    v_permlane32_swap_b32 v148, v150
    v_mfma_f32_32x32x16_bf16 v[128:143], v[44:47], v[92:95], v[128:143]
    ds_read_b64_tr_b16 v[92:93], v154 offset:14336
    ds_read_b64_tr_b16 v[94:95], v154 offset:14848
    v_permlane32_swap_b32 v149, v151
    buffer_store_dwordx4 v[148:151], v10, s[8:11], s42 offen offset:512
    v_mfma_f32_32x32x16_bf16 v[128:143], v[48:51], v[96:99], v[128:143]
    ds_read_b64_tr_b16 v[96:97], v154 offset:16384
    ds_read_b64_tr_b16 v[98:99], v154 offset:16896
    v_mfma_f32_32x32x16_bf16 v[128:143], v[52:55], v[100:103], v[128:143]
    ds_read_b64_tr_b16 v[100:101], v154 offset:18432
    ds_read_b64_tr_b16 v[102:103], v154 offset:18944
    v_mfma_f32_32x32x16_bf16 v[128:143], v[56:59], v[104:107], v[128:143]
    ds_read_b64_tr_b16 v[104:105], v154 offset:20480
    ds_read_b64_tr_b16 v[106:107], v154 offset:20992
    v_mfma_f32_32x32x16_bf16 v[128:143], v[60:63], v[108:111], v[128:143]
    ds_read_b64_tr_b16 v[108:109], v154 offset:22528
    ds_read_b64_tr_b16 v[110:111], v154 offset:23040
    s_waitcnt lgkmcnt(0)
    v_mfma_f32_32x32x16_bf16 v[112:127], v[16:19], v[64:67], 0
    ds_read_b64_tr_b16 v[64:65], v155 offset:0
    ds_read_b64_tr_b16 v[66:67], v155 offset:512
    v_mfma_f32_32x32x16_bf16 v[112:127], v[20:23], v[68:71], v[112:127]
    ds_read_b64_tr_b16 v[68:69], v155 offset:2048
    ds_read_b64_tr_b16 v[70:71], v155 offset:2560
    v_mfma_f32_32x32x16_bf16 v[112:127], v[24:27], v[72:75], v[112:127]
    ds_read_b64_tr_b16 v[72:73], v155 offset:4096
    ds_read_b64_tr_b16 v[74:75], v155 offset:4608
    s_add_u32 s42, s41, 6553600
    v_cvt_pk_bf16_f32 v144, v128, v129
    v_cvt_pk_bf16_f32 v145, v130, v131
    v_mfma_f32_32x32x16_bf16 v[112:127], v[28:31], v[76:79], v[112:127]
    ds_read_b64_tr_b16 v[76:77], v155 offset:6144
    ds_read_b64_tr_b16 v[78:79], v155 offset:6656
    v_cvt_pk_bf16_f32 v146, v132, v133
    v_cvt_pk_bf16_f32 v147, v134, v135
    s_nop 1
    v_mfma_f32_32x32x16_bf16 v[112:127], v[32:35], v[80:83], v[112:127]
    ds_read_b64_tr_b16 v[80:81], v155 offset:8192
    ds_read_b64_tr_b16 v[82:83], v155 offset:8704
    v_permlane32_swap_b32 v144, v146
    v_permlane32_swap_b32 v145, v147
    buffer_store_dwordx4 v[144:147], v10, s[8:11], s42 offen offset:0
    v_mfma_f32_32x32x16_bf16 v[112:127], v[36:39], v[84:87], v[112:127]
    ds_read_b64_tr_b16 v[84:85], v155 offset:10240
    ds_read_b64_tr_b16 v[86:87], v155 offset:10752
    v_cvt_pk_bf16_f32 v148, v136, v137
    v_cvt_pk_bf16_f32 v149, v138, v139
    v_cvt_pk_bf16_f32 v150, v140, v141
    v_mfma_f32_32x32x16_bf16 v[112:127], v[40:43], v[88:91], v[112:127]
    ds_read_b64_tr_b16 v[88:89], v155 offset:12288
    ds_read_b64_tr_b16 v[90:91], v155 offset:12800
    v_cvt_pk_bf16_f32 v151, v142, v143
    s_nop 1
    v_permlane32_swap_b32 v148, v150
    v_mfma_f32_32x32x16_bf16 v[112:127], v[44:47], v[92:95], v[112:127]
    ds_read_b64_tr_b16 v[92:93], v155 offset:14336
    ds_read_b64_tr_b16 v[94:95], v155 offset:14848
    v_permlane32_swap_b32 v149, v151
    buffer_store_dwordx4 v[148:151], v10, s[8:11], s42 offen offset:512
    v_mfma_f32_32x32x16_bf16 v[112:127], v[48:51], v[96:99], v[112:127]
    ds_read_b64_tr_b16 v[96:97], v155 offset:16384
    ds_read_b64_tr_b16 v[98:99], v155 offset:16896
    v_mfma_f32_32x32x16_bf16 v[112:127], v[52:55], v[100:103], v[112:127]
    ds_read_b64_tr_b16 v[100:101], v155 offset:18432
    ds_read_b64_tr_b16 v[102:103], v155 offset:18944
    v_mfma_f32_32x32x16_bf16 v[112:127], v[56:59], v[104:107], v[112:127]
    ds_read_b64_tr_b16 v[104:105], v155 offset:20480
    ds_read_b64_tr_b16 v[106:107], v155 offset:20992
    v_mfma_f32_32x32x16_bf16 v[112:127], v[60:63], v[108:111], v[112:127]
    ds_read_b64_tr_b16 v[108:109], v155 offset:22528
    ds_read_b64_tr_b16 v[110:111], v155 offset:23040
    s_waitcnt lgkmcnt(0)
    s_waitcnt vmcnt(4)
    s_barrier
    v_mfma_f32_32x32x16_bf16 v[128:143], v[16:19], v[64:67], 0
    ds_read_b64_tr_b16 v[64:65], v152 offset:0
    ds_read_b64_tr_b16 v[66:67], v152 offset:512
    v_mfma_f32_32x32x16_bf16 v[128:143], v[20:23], v[68:71], v[128:143]
    ds_read_b64_tr_b16 v[68:69], v152 offset:2048
    ds_read_b64_tr_b16 v[70:71], v152 offset:2560
    v_mfma_f32_32x32x16_bf16 v[128:143], v[24:27], v[72:75], v[128:143]
    ds_read_b64_tr_b16 v[72:73], v152 offset:4096
    ds_read_b64_tr_b16 v[74:75], v152 offset:4608
    s_add_u32 s42, s41, 7864320
    v_cvt_pk_bf16_f32 v144, v112, v113
    v_cvt_pk_bf16_f32 v145, v114, v115
    v_mfma_f32_32x32x16_bf16 v[128:143], v[28:31], v[76:79], v[128:143]
    ds_read_b64_tr_b16 v[76:77], v152 offset:6144
    ds_read_b64_tr_b16 v[78:79], v152 offset:6656
    v_cvt_pk_bf16_f32 v146, v116, v117
    v_cvt_pk_bf16_f32 v147, v118, v119
    s_nop 1
    v_mfma_f32_32x32x16_bf16 v[128:143], v[32:35], v[80:83], v[128:143]
    ds_read_b64_tr_b16 v[80:81], v152 offset:8192
    ds_read_b64_tr_b16 v[82:83], v152 offset:8704
    v_permlane32_swap_b32 v144, v146
    v_permlane32_swap_b32 v145, v147
    buffer_store_dwordx4 v[144:147], v10, s[8:11], s42 offen offset:0
    v_mfma_f32_32x32x16_bf16 v[128:143], v[36:39], v[84:87], v[128:143]
    ds_read_b64_tr_b16 v[84:85], v152 offset:10240
    ds_read_b64_tr_b16 v[86:87], v152 offset:10752
    v_cvt_pk_bf16_f32 v148, v120, v121
    v_cvt_pk_bf16_f32 v149, v122, v123
    v_cvt_pk_bf16_f32 v150, v124, v125
    v_mfma_f32_32x32x16_bf16 v[128:143], v[40:43], v[88:91], v[128:143]
    ds_read_b64_tr_b16 v[88:89], v152 offset:12288
    ds_read_b64_tr_b16 v[90:91], v152 offset:12800
    v_cvt_pk_bf16_f32 v151, v126, v127
    s_nop 1
    v_permlane32_swap_b32 v148, v150
    v_mfma_f32_32x32x16_bf16 v[128:143], v[44:47], v[92:95], v[128:143]
    ds_read_b64_tr_b16 v[92:93], v152 offset:14336
    ds_read_b64_tr_b16 v[94:95], v152 offset:14848
    v_permlane32_swap_b32 v149, v151
    buffer_store_dwordx4 v[148:151], v10, s[8:11], s42 offen offset:512
    v_mfma_f32_32x32x16_bf16 v[128:143], v[48:51], v[96:99], v[128:143]
    ds_read_b64_tr_b16 v[96:97], v152 offset:16384
    ds_read_b64_tr_b16 v[98:99], v152 offset:16896
    v_mfma_f32_32x32x16_bf16 v[128:143], v[52:55], v[100:103], v[128:143]
    ds_read_b64_tr_b16 v[100:101], v152 offset:18432
    ds_read_b64_tr_b16 v[102:103], v152 offset:18944
    v_mfma_f32_32x32x16_bf16 v[128:143], v[56:59], v[104:107], v[128:143]
    ds_read_b64_tr_b16 v[104:105], v152 offset:20480
    ds_read_b64_tr_b16 v[106:107], v152 offset:20992
    v_mfma_f32_32x32x16_bf16 v[128:143], v[60:63], v[108:111], v[128:143]
    ds_read_b64_tr_b16 v[108:109], v152 offset:22528
    ds_read_b64_tr_b16 v[110:111], v152 offset:23040
    s_waitcnt lgkmcnt(0)
    v_mfma_f32_32x32x16_bf16 v[112:127], v[16:19], v[64:67], 0
    ds_read_b64_tr_b16 v[64:65], v153 offset:0
    ds_read_b64_tr_b16 v[66:67], v153 offset:512
    v_mfma_f32_32x32x16_bf16 v[112:127], v[20:23], v[68:71], v[112:127]
    ds_read_b64_tr_b16 v[68:69], v153 offset:2048
    ds_read_b64_tr_b16 v[70:71], v153 offset:2560
    v_mfma_f32_32x32x16_bf16 v[112:127], v[24:27], v[72:75], v[112:127]
    ds_read_b64_tr_b16 v[72:73], v153 offset:4096
    ds_read_b64_tr_b16 v[74:75], v153 offset:4608
    s_add_u32 s42, s41, 9175040
    v_cvt_pk_bf16_f32 v144, v128, v129
    v_cvt_pk_bf16_f32 v145, v130, v131
    v_mfma_f32_32x32x16_bf16 v[112:127], v[28:31], v[76:79], v[112:127]
    ds_read_b64_tr_b16 v[76:77], v153 offset:6144
    ds_read_b64_tr_b16 v[78:79], v153 offset:6656
    v_cvt_pk_bf16_f32 v146, v132, v133
    v_cvt_pk_bf16_f32 v147, v134, v135
    s_nop 1
    v_mfma_f32_32x32x16_bf16 v[112:127], v[32:35], v[80:83], v[112:127]
    ds_read_b64_tr_b16 v[80:81], v153 offset:8192
    ds_read_b64_tr_b16 v[82:83], v153 offset:8704
    v_permlane32_swap_b32 v144, v146
    v_permlane32_swap_b32 v145, v147
    buffer_store_dwordx4 v[144:147], v10, s[8:11], s42 offen offset:0
    v_mfma_f32_32x32x16_bf16 v[112:127], v[36:39], v[84:87], v[112:127]
    ds_read_b64_tr_b16 v[84:85], v153 offset:10240
    ds_read_b64_tr_b16 v[86:87], v153 offset:10752
    v_cvt_pk_bf16_f32 v148, v136, v137
    v_cvt_pk_bf16_f32 v149, v138, v139
    v_cvt_pk_bf16_f32 v150, v140, v141
    v_mfma_f32_32x32x16_bf16 v[112:127], v[40:43], v[88:91], v[112:127]
    ds_read_b64_tr_b16 v[88:89], v153 offset:12288
    ds_read_b64_tr_b16 v[90:91], v153 offset:12800
    v_cvt_pk_bf16_f32 v151, v142, v143
    s_nop 1
    v_permlane32_swap_b32 v148, v150
    v_mfma_f32_32x32x16_bf16 v[112:127], v[44:47], v[92:95], v[112:127]
    ds_read_b64_tr_b16 v[92:93], v153 offset:14336
    ds_read_b64_tr_b16 v[94:95], v153 offset:14848
    v_permlane32_swap_b32 v149, v151
    buffer_store_dwordx4 v[148:151], v10, s[8:11], s42 offen offset:512
    v_mfma_f32_32x32x16_bf16 v[112:127], v[48:51], v[96:99], v[112:127]
    ds_read_b64_tr_b16 v[96:97], v153 offset:16384
    ds_read_b64_tr_b16 v[98:99], v153 offset:16896
    v_mfma_f32_32x32x16_bf16 v[112:127], v[52:55], v[100:103], v[112:127]
    ds_read_b64_tr_b16 v[100:101], v153 offset:18432
    ds_read_b64_tr_b16 v[102:103], v153 offset:18944
    v_mfma_f32_32x32x16_bf16 v[112:127], v[56:59], v[104:107], v[112:127]
    ds_read_b64_tr_b16 v[104:105], v153 offset:20480
    ds_read_b64_tr_b16 v[106:107], v153 offset:20992
    v_mfma_f32_32x32x16_bf16 v[112:127], v[60:63], v[108:111], v[112:127]
    ds_read_b64_tr_b16 v[108:109], v153 offset:22528
    ds_read_b64_tr_b16 v[110:111], v153 offset:23040
    s_waitcnt lgkmcnt(0)
    s_barrier
    v_mfma_f32_32x32x16_bf16 v[128:143], v[16:19], v[64:67], 0
    v_mfma_f32_32x32x16_bf16 v[128:143], v[20:23], v[68:71], v[128:143]
    v_mfma_f32_32x32x16_bf16 v[128:143], v[24:27], v[72:75], v[128:143]
    s_add_u32 s42, s41, 10485760
    v_cvt_pk_bf16_f32 v144, v112, v113
    v_cvt_pk_bf16_f32 v145, v114, v115
    v_mfma_f32_32x32x16_bf16 v[128:143], v[28:31], v[76:79], v[128:143]
    v_cvt_pk_bf16_f32 v146, v116, v117
    v_cvt_pk_bf16_f32 v147, v118, v119
    s_nop 1
    v_mfma_f32_32x32x16_bf16 v[128:143], v[32:35], v[80:83], v[128:143]
    v_permlane32_swap_b32 v144, v146
    v_permlane32_swap_b32 v145, v147
    buffer_store_dwordx4 v[144:147], v10, s[8:11], s42 offen offset:0
    v_mfma_f32_32x32x16_bf16 v[128:143], v[36:39], v[84:87], v[128:143]
    v_cvt_pk_bf16_f32 v148, v120, v121
    v_cvt_pk_bf16_f32 v149, v122, v123
    v_cvt_pk_bf16_f32 v150, v124, v125
    v_mfma_f32_32x32x16_bf16 v[128:143], v[40:43], v[88:91], v[128:143]
    v_cvt_pk_bf16_f32 v151, v126, v127
    s_nop 1
    v_permlane32_swap_b32 v148, v150
    v_mfma_f32_32x32x16_bf16 v[128:143], v[44:47], v[92:95], v[128:143]
    v_permlane32_swap_b32 v149, v151
    buffer_store_dwordx4 v[148:151], v10, s[8:11], s42 offen offset:512
    v_mfma_f32_32x32x16_bf16 v[128:143], v[48:51], v[96:99], v[128:143]
    v_mfma_f32_32x32x16_bf16 v[128:143], v[52:55], v[100:103], v[128:143]
    v_mfma_f32_32x32x16_bf16 v[128:143], v[56:59], v[104:107], v[128:143]
    v_mfma_f32_32x32x16_bf16 v[128:143], v[60:63], v[108:111], v[128:143]
    s_nop 7
    s_nop 7
    s_nop 7
    s_add_u32 s42, s41, 11796480
    v_cvt_pk_bf16_f32 v144, v128, v129
    v_cvt_pk_bf16_f32 v145, v130, v131
    v_cvt_pk_bf16_f32 v146, v132, v133
    v_cvt_pk_bf16_f32 v147, v134, v135
    s_nop 1
    v_permlane32_swap_b32 v144, v146
    v_permlane32_swap_b32 v145, v147
    buffer_store_dwordx4 v[144:147], v10, s[8:11], s42 offen offset:0
    v_cvt_pk_bf16_f32 v148, v136, v137
    v_cvt_pk_bf16_f32 v149, v138, v139
    v_cvt_pk_bf16_f32 v150, v140, v141
    v_cvt_pk_bf16_f32 v151, v142, v143
    s_nop 1
    v_permlane32_swap_b32 v148, v150
    v_permlane32_swap_b32 v149, v151
    buffer_store_dwordx4 v[148:151], v10, s[8:11], s42 offen offset:512
    s_branch prep_kernel_end
prep_kernel_r_pwp:
    s_lshl_b32 s20, s20, 2
    s_add_u32 s20, s20, s13
    s_mul_i32 s21, s20, 13108
    s_lshr_b32 s21, s21, 16
    s_mul_i32 s22, s21, 5
    s_sub_u32 s22, s20, s22
    s_mul_i32 s23, s21, 21846
    s_lshr_b32 s23, s23, 16
    s_mul_i32 s28, s23, 3
    s_sub_u32 s21, s21, s28
    s_lshr_b32 s29, s23, 5
    s_and_b32 s23, s23, 31
    s_cmp_eq_u32 s29, 0
    s_cbranch_scc0 prep_kernel_pwp_k
    s_load_dwordx2 s[24:25], s[0:1], 40
    s_branch prep_kernel_pwp_go
prep_kernel_pwp_k:
    s_load_dwordx2 s[24:25], s[0:1], 48
prep_kernel_pwp_go:
    v_and_b32 v1, 31, v0
    v_lshrrev_b32 v2, 5, v0
    s_lshl_b32 s28, s21, 6
    v_lshlrev_b32 v3, 1, v1
    v_add_u32 v3, s28, v3
    v_and_b32 v4, 0xc1, v3
    v_and_b32 v5, 8, v3
    v_lshl_or_b32 v4, v5, 2, v4
    v_and_b32 v5, 32, v3
    v_lshrrev_b32 v5, 1, v5
    v_or_b32 v4, v4, v5
    v_and_b32 v5, 2, v3
    v_lshl_or_b32 v4, v5, 2, v4
    v_and_b32 v5, 16, v3
    v_lshrrev_b32 v5, 2, v5
    v_or_b32 v4, v4, v5
    v_and_b32 v5, 4, v3
    v_lshrrev_b32 v5, 1, v5
    v_or_b32 v4, v4, v5
    s_cmp_eq_u32 s29, 0
    s_cselect_b64 vcc, -1, 0
    s_nop 1
    v_cndmask_b32 v4, v4, v3, vcc
    v_lshrrev_b32 v5, 4, v3
    v_and_b32 v6, 3, v5
    v_mul_u32_u24 v6, 6, v6
    v_lshrrev_b32 v5, 2, v5
    v_add_u32 v5, v5, v6
    v_mul_u32_u24 v5, 20480, v5
    v_and_b32 v6, 15, v3
    v_lshl_add_u32 v7, v6, 4, v5
    s_mul_i32 s30, s29, 61440
    s_mul_i32 s31, s23, 491520
    s_add_u32 s30, s30, s31
    s_add_u32 s30, s30, 11534336
    s_lshl_b32 s31, s22, 4
    v_add_u32 v8, s31, v2
    s_waitcnt lgkmcnt(0)
    s_mov_b32 s32, s24
    s_mov_b32 s33, s25
    s_mov_b32 s34, 7864320
    s_mov_b32 s35, 0x00020000
    s_mul_i32 s28, s23, 384
    v_add_u32 v9, 0, v8
    v_lshrrev_b32 v10, 2, v9
    v_lshlrev_b32 v10, 5, v10
    v_and_b32 v11, 2, v9
    v_lshl_add_u32 v10, v11, 3, v10
    v_and_b32 v11, 1, v9
    v_lshl_add_u32 v10, v11, 2, v10
    v_mul_u32_u24 v10, 12288, v10
    v_lshl_add_u32 v10, v4, 1, v10
    s_add_u32 s31, s28, 0
    buffer_load_dword v16, v10, s[32:35], s31 offen
    s_add_u32 s31, s28, 12288
    buffer_load_dword v17, v10, s[32:35], s31 offen
    s_add_u32 s31, s28, 98304
    buffer_load_dword v18, v10, s[32:35], s31 offen
    s_add_u32 s31, s28, 110592
    buffer_load_dword v19, v10, s[32:35], s31 offen
    s_add_u32 s31, s28, 24576
    buffer_load_dword v20, v10, s[32:35], s31 offen
    s_add_u32 s31, s28, 36864
    buffer_load_dword v21, v10, s[32:35], s31 offen
    s_add_u32 s31, s28, 122880
    buffer_load_dword v22, v10, s[32:35], s31 offen
    s_add_u32 s31, s28, 135168
    buffer_load_dword v23, v10, s[32:35], s31 offen
    v_add_u32 v9, 2, v8
    v_lshrrev_b32 v10, 2, v9
    v_lshlrev_b32 v10, 5, v10
    v_and_b32 v11, 2, v9
    v_lshl_add_u32 v10, v11, 3, v10
    v_and_b32 v11, 1, v9
    v_lshl_add_u32 v10, v11, 2, v10
    v_mul_u32_u24 v10, 12288, v10
    v_lshl_add_u32 v10, v4, 1, v10
    s_add_u32 s31, s28, 0
    buffer_load_dword v24, v10, s[32:35], s31 offen
    s_add_u32 s31, s28, 12288
    buffer_load_dword v25, v10, s[32:35], s31 offen
    s_add_u32 s31, s28, 98304
    buffer_load_dword v26, v10, s[32:35], s31 offen
    s_add_u32 s31, s28, 110592
    buffer_load_dword v27, v10, s[32:35], s31 offen
    s_add_u32 s31, s28, 24576
    buffer_load_dword v28, v10, s[32:35], s31 offen
    s_add_u32 s31, s28, 36864
    buffer_load_dword v29, v10, s[32:35], s31 offen
    s_add_u32 s31, s28, 122880
    buffer_load_dword v30, v10, s[32:35], s31 offen
    s_add_u32 s31, s28, 135168
    buffer_load_dword v31, v10, s[32:35], s31 offen
    v_add_u32 v9, 4, v8
    v_lshrrev_b32 v10, 2, v9
    v_lshlrev_b32 v10, 5, v10
    v_and_b32 v11, 2, v9
    v_lshl_add_u32 v10, v11, 3, v10
    v_and_b32 v11, 1, v9
    v_lshl_add_u32 v10, v11, 2, v10
    v_mul_u32_u24 v10, 12288, v10
    v_lshl_add_u32 v10, v4, 1, v10
    s_add_u32 s31, s28, 0
    buffer_load_dword v32, v10, s[32:35], s31 offen
    s_add_u32 s31, s28, 12288
    buffer_load_dword v33, v10, s[32:35], s31 offen
    s_add_u32 s31, s28, 98304
    buffer_load_dword v34, v10, s[32:35], s31 offen
    s_add_u32 s31, s28, 110592
    buffer_load_dword v35, v10, s[32:35], s31 offen
    s_add_u32 s31, s28, 24576
    buffer_load_dword v36, v10, s[32:35], s31 offen
    s_add_u32 s31, s28, 36864
    buffer_load_dword v37, v10, s[32:35], s31 offen
    s_add_u32 s31, s28, 122880
    buffer_load_dword v38, v10, s[32:35], s31 offen
    s_add_u32 s31, s28, 135168
    buffer_load_dword v39, v10, s[32:35], s31 offen
    v_add_u32 v9, 6, v8
    v_lshrrev_b32 v10, 2, v9
    v_lshlrev_b32 v10, 5, v10
    v_and_b32 v11, 2, v9
    v_lshl_add_u32 v10, v11, 3, v10
    v_and_b32 v11, 1, v9
    v_lshl_add_u32 v10, v11, 2, v10
    v_mul_u32_u24 v10, 12288, v10
    v_lshl_add_u32 v10, v4, 1, v10
    s_add_u32 s31, s28, 0
    buffer_load_dword v40, v10, s[32:35], s31 offen
    s_add_u32 s31, s28, 12288
    buffer_load_dword v41, v10, s[32:35], s31 offen
    s_add_u32 s31, s28, 98304
    buffer_load_dword v42, v10, s[32:35], s31 offen
    s_add_u32 s31, s28, 110592
    buffer_load_dword v43, v10, s[32:35], s31 offen
    s_add_u32 s31, s28, 24576
    buffer_load_dword v44, v10, s[32:35], s31 offen
    s_add_u32 s31, s28, 36864
    buffer_load_dword v45, v10, s[32:35], s31 offen
    s_add_u32 s31, s28, 122880
    buffer_load_dword v46, v10, s[32:35], s31 offen
    s_add_u32 s31, s28, 135168
    buffer_load_dword v47, v10, s[32:35], s31 offen
    v_add_u32 v9, 8, v8
    v_lshrrev_b32 v10, 2, v9
    v_lshlrev_b32 v10, 5, v10
    v_and_b32 v11, 2, v9
    v_lshl_add_u32 v10, v11, 3, v10
    v_and_b32 v11, 1, v9
    v_lshl_add_u32 v10, v11, 2, v10
    v_mul_u32_u24 v10, 12288, v10
    v_lshl_add_u32 v10, v4, 1, v10
    s_add_u32 s31, s28, 0
    buffer_load_dword v48, v10, s[32:35], s31 offen
    s_add_u32 s31, s28, 12288
    buffer_load_dword v49, v10, s[32:35], s31 offen
    s_add_u32 s31, s28, 98304
    buffer_load_dword v50, v10, s[32:35], s31 offen
    s_add_u32 s31, s28, 110592
    buffer_load_dword v51, v10, s[32:35], s31 offen
    s_add_u32 s31, s28, 24576
    buffer_load_dword v52, v10, s[32:35], s31 offen
    s_add_u32 s31, s28, 36864
    buffer_load_dword v53, v10, s[32:35], s31 offen
    s_add_u32 s31, s28, 122880
    buffer_load_dword v54, v10, s[32:35], s31 offen
    s_add_u32 s31, s28, 135168
    buffer_load_dword v55, v10, s[32:35], s31 offen
    v_add_u32 v9, 10, v8
    v_lshrrev_b32 v10, 2, v9
    v_lshlrev_b32 v10, 5, v10
    v_and_b32 v11, 2, v9
    v_lshl_add_u32 v10, v11, 3, v10
    v_and_b32 v11, 1, v9
    v_lshl_add_u32 v10, v11, 2, v10
    v_mul_u32_u24 v10, 12288, v10
    v_lshl_add_u32 v10, v4, 1, v10
    s_add_u32 s31, s28, 0
    buffer_load_dword v56, v10, s[32:35], s31 offen
    s_add_u32 s31, s28, 12288
    buffer_load_dword v57, v10, s[32:35], s31 offen
    s_add_u32 s31, s28, 98304
    buffer_load_dword v58, v10, s[32:35], s31 offen
    s_add_u32 s31, s28, 110592
    buffer_load_dword v59, v10, s[32:35], s31 offen
    s_add_u32 s31, s28, 24576
    buffer_load_dword v60, v10, s[32:35], s31 offen
    s_add_u32 s31, s28, 36864
    buffer_load_dword v61, v10, s[32:35], s31 offen
    s_add_u32 s31, s28, 122880
    buffer_load_dword v62, v10, s[32:35], s31 offen
    s_add_u32 s31, s28, 135168
    buffer_load_dword v63, v10, s[32:35], s31 offen
    v_add_u32 v9, 12, v8
    v_lshrrev_b32 v10, 2, v9
    v_lshlrev_b32 v10, 5, v10
    v_and_b32 v11, 2, v9
    v_lshl_add_u32 v10, v11, 3, v10
    v_and_b32 v11, 1, v9
    v_lshl_add_u32 v10, v11, 2, v10
    v_mul_u32_u24 v10, 12288, v10
    v_lshl_add_u32 v10, v4, 1, v10
    s_add_u32 s31, s28, 0
    buffer_load_dword v64, v10, s[32:35], s31 offen
    s_add_u32 s31, s28, 12288
    buffer_load_dword v65, v10, s[32:35], s31 offen
    s_add_u32 s31, s28, 98304
    buffer_load_dword v66, v10, s[32:35], s31 offen
    s_add_u32 s31, s28, 110592
    buffer_load_dword v67, v10, s[32:35], s31 offen
    s_add_u32 s31, s28, 24576
    buffer_load_dword v68, v10, s[32:35], s31 offen
    s_add_u32 s31, s28, 36864
    buffer_load_dword v69, v10, s[32:35], s31 offen
    s_add_u32 s31, s28, 122880
    buffer_load_dword v70, v10, s[32:35], s31 offen
    s_add_u32 s31, s28, 135168
    buffer_load_dword v71, v10, s[32:35], s31 offen
    v_add_u32 v9, 14, v8
    v_lshrrev_b32 v10, 2, v9
    v_lshlrev_b32 v10, 5, v10
    v_and_b32 v11, 2, v9
    v_lshl_add_u32 v10, v11, 3, v10
    v_and_b32 v11, 1, v9
    v_lshl_add_u32 v10, v11, 2, v10
    v_mul_u32_u24 v10, 12288, v10
    v_lshl_add_u32 v10, v4, 1, v10
    s_add_u32 s31, s28, 0
    buffer_load_dword v72, v10, s[32:35], s31 offen
    s_add_u32 s31, s28, 12288
    buffer_load_dword v73, v10, s[32:35], s31 offen
    s_add_u32 s31, s28, 98304
    buffer_load_dword v74, v10, s[32:35], s31 offen
    s_add_u32 s31, s28, 110592
    buffer_load_dword v75, v10, s[32:35], s31 offen
    s_add_u32 s31, s28, 24576
    buffer_load_dword v76, v10, s[32:35], s31 offen
    s_add_u32 s31, s28, 36864
    buffer_load_dword v77, v10, s[32:35], s31 offen
    s_add_u32 s31, s28, 122880
    buffer_load_dword v78, v10, s[32:35], s31 offen
    s_add_u32 s31, s28, 135168
    buffer_load_dword v79, v10, s[32:35], s31 offen
    v_lshl_add_u32 v7, v8, 8, v7
    v_mov_b32 v4, 0x05040100
    v_mov_b32 v5, 0x07060302
    s_waitcnt vmcnt(56)
    v_perm_b32 v80, v17, v16, v4
    v_perm_b32 v84, v17, v16, v5
    v_perm_b32 v81, v19, v18, v4
    v_perm_b32 v85, v19, v18, v5
    v_perm_b32 v82, v21, v20, v4
    v_perm_b32 v86, v21, v20, v5
    v_perm_b32 v83, v23, v22, v4
    v_perm_b32 v87, v23, v22, v5
    buffer_store_dwordx4 v[80:83], v7, s[8:11], s30 offen offset:0
    buffer_store_dwordx4 v[84:87], v7, s[8:11], s30 offen offset:16
    s_waitcnt vmcnt(48)
    v_perm_b32 v88, v25, v24, v4
    v_perm_b32 v92, v25, v24, v5
    v_perm_b32 v89, v27, v26, v4
    v_perm_b32 v93, v27, v26, v5
    v_perm_b32 v90, v29, v28, v4
    v_perm_b32 v94, v29, v28, v5
    v_perm_b32 v91, v31, v30, v4
    v_perm_b32 v95, v31, v30, v5
    buffer_store_dwordx4 v[88:91], v7, s[8:11], s30 offen offset:512
    buffer_store_dwordx4 v[92:95], v7, s[8:11], s30 offen offset:528
    s_nop 0
    s_waitcnt vmcnt(40)
    v_perm_b32 v80, v33, v32, v4
    v_perm_b32 v84, v33, v32, v5
    v_perm_b32 v81, v35, v34, v4
    v_perm_b32 v85, v35, v34, v5
    v_perm_b32 v82, v37, v36, v4
    v_perm_b32 v86, v37, v36, v5
    v_perm_b32 v83, v39, v38, v4
    v_perm_b32 v87, v39, v38, v5
    buffer_store_dwordx4 v[80:83], v7, s[8:11], s30 offen offset:1024
    buffer_store_dwordx4 v[84:87], v7, s[8:11], s30 offen offset:1040
    s_nop 0
    s_waitcnt vmcnt(32)
    v_perm_b32 v88, v41, v40, v4
    v_perm_b32 v92, v41, v40, v5
    v_perm_b32 v89, v43, v42, v4
    v_perm_b32 v93, v43, v42, v5
    v_perm_b32 v90, v45, v44, v4
    v_perm_b32 v94, v45, v44, v5
    v_perm_b32 v91, v47, v46, v4
    v_perm_b32 v95, v47, v46, v5
    buffer_store_dwordx4 v[88:91], v7, s[8:11], s30 offen offset:1536
    buffer_store_dwordx4 v[92:95], v7, s[8:11], s30 offen offset:1552
    s_nop 0
    s_waitcnt vmcnt(24)
    v_perm_b32 v80, v49, v48, v4
    v_perm_b32 v84, v49, v48, v5
    v_perm_b32 v81, v51, v50, v4
    v_perm_b32 v85, v51, v50, v5
    v_perm_b32 v82, v53, v52, v4
    v_perm_b32 v86, v53, v52, v5
    v_perm_b32 v83, v55, v54, v4
    v_perm_b32 v87, v55, v54, v5
    buffer_store_dwordx4 v[80:83], v7, s[8:11], s30 offen offset:2048
    buffer_store_dwordx4 v[84:87], v7, s[8:11], s30 offen offset:2064
    s_nop 0
    s_waitcnt vmcnt(16)
    v_perm_b32 v88, v57, v56, v4
    v_perm_b32 v92, v57, v56, v5
    v_perm_b32 v89, v59, v58, v4
    v_perm_b32 v93, v59, v58, v5
    v_perm_b32 v90, v61, v60, v4
    v_perm_b32 v94, v61, v60, v5
    v_perm_b32 v91, v63, v62, v4
    v_perm_b32 v95, v63, v62, v5
    buffer_store_dwordx4 v[88:91], v7, s[8:11], s30 offen offset:2560
    buffer_store_dwordx4 v[92:95], v7, s[8:11], s30 offen offset:2576
    s_nop 0
    s_waitcnt vmcnt(8)
    v_perm_b32 v80, v65, v64, v4
    v_perm_b32 v84, v65, v64, v5
    v_perm_b32 v81, v67, v66, v4
    v_perm_b32 v85, v67, v66, v5
    v_perm_b32 v82, v69, v68, v4
    v_perm_b32 v86, v69, v68, v5
    v_perm_b32 v83, v71, v70, v4
    v_perm_b32 v87, v71, v70, v5
    buffer_store_dwordx4 v[80:83], v7, s[8:11], s30 offen offset:3072
    buffer_store_dwordx4 v[84:87], v7, s[8:11], s30 offen offset:3088
    s_nop 0
    s_waitcnt vmcnt(0)
    v_perm_b32 v88, v73, v72, v4
    v_perm_b32 v92, v73, v72, v5
    v_perm_b32 v89, v75, v74, v4
    v_perm_b32 v93, v75, v74, v5
    v_perm_b32 v90, v77, v76, v4
    v_perm_b32 v94, v77, v76, v5
    v_perm_b32 v91, v79, v78, v4
    v_perm_b32 v95, v79, v78, v5
    buffer_store_dwordx4 v[88:91], v7, s[8:11], s30 offen offset:3584
    buffer_store_dwordx4 v[92:95], v7, s[8:11], s30 offen offset:3600
    s_nop 0
    s_branch prep_kernel_end
prep_kernel_r_pwa:
    s_load_dwordx2 s[24:25], s[0:1], 8
    s_lshr_b32 s21, s20, 1
    s_and_b32 s22, s20, 1
    v_and_b32 v1, 31, v0
    v_lshrrev_b32 v2, 5, v0
    s_mul_i32 s23, s21, 20
    v_add_u32 v3, 640, v1
    v_add_u32 v4, 1260, v1
    v_cmp_gt_u32 vcc, 20, v1
    s_nop 1
    v_cndmask_b32 v3, v4, v3, vcc
    v_add_u32 v4, 1292, v1
    v_subrev_u32 v5, 12, v1
    v_cmp_gt_u32 vcc, 8, v1
    s_nop 1
    v_cndmask_b32 v4, v5, v4, vcc
    s_cmp_eq_u32 s22, 0
    s_cselect_b64 vcc, -1, 0
    s_nop 1
    v_cndmask_b32 v3, v4, v3, vcc
    v_add_u32 v3, s23, v3
    v_lshlrev_b32 v3, 1, v3
    v_mul_u32_u24 v4, 30720, v2
    v_add_u32 v3, v3, v4
    s_mov_b32 s26, 0xfffff0ff
    s_cmp_eq_u32 s22, 0
    s_cselect_b32 s26, -1, s26
    s_mov_b32 s27, s26
    v_mov_b32 v16, 0
    v_mov_b32 v17, 0
    v_mov_b32 v18, 0
    v_mov_b32 v19, 0
    v_mov_b32 v20, 0
    v_mov_b32 v21, 0
    v_mov_b32 v22, 0
    v_mov_b32 v23, 0
    v_mov_b32 v24, 0
    v_mov_b32 v25, 0
    v_mov_b32 v26, 0
    v_mov_b32 v27, 0
    v_mov_b32 v28, 0
    v_mov_b32 v29, 0
    v_mov_b32 v30, 0
    v_mov_b32 v31, 0
    v_mov_b32 v32, 0
    v_mov_b32 v33, 0
    v_mov_b32 v34, 0
    v_mov_b32 v35, 0
    v_mov_b32 v36, 0
    v_mov_b32 v37, 0
    v_mov_b32 v38, 0
    v_mov_b32 v39, 0
    v_mov_b32 v40, 0
    v_mov_b32 v41, 0
    v_mov_b32 v42, 0
    v_mov_b32 v43, 0
    v_mov_b32 v44, 0
    v_mov_b32 v45, 0
    v_mov_b32 v46, 0
    v_mov_b32 v47, 0
    v_mov_b32 v48, 0
    v_mov_b32 v49, 0
    v_mov_b32 v50, 0
    v_mov_b32 v51, 0
    v_mov_b32 v52, 0
    v_mov_b32 v53, 0
    v_mov_b32 v54, 0
    v_mov_b32 v55, 0
    v_mov_b32 v56, 0
    v_mov_b32 v57, 0
    v_mov_b32 v58, 0
    v_mov_b32 v59, 0
    v_mov_b32 v60, 0
    v_mov_b32 v61, 0
    v_mov_b32 v62, 0
    v_mov_b32 v63, 0
    v_mov_b32 v64, 0
    v_mov_b32 v65, 0
    v_mov_b32 v66, 0
    v_mov_b32 v67, 0
    v_mov_b32 v68, 0
    v_mov_b32 v69, 0
    v_mov_b32 v70, 0
    v_mov_b32 v71, 0
    v_mov_b32 v72, 0
    v_mov_b32 v73, 0
    v_mov_b32 v74, 0
    v_mov_b32 v75, 0
    v_mov_b32 v76, 0
    v_mov_b32 v77, 0
    v_mov_b32 v78, 0
    v_mov_b32 v79, 0
    v_mov_b32 v80, 0
    v_mov_b32 v81, 0
    v_mov_b32 v82, 0
    v_mov_b32 v83, 0
    v_mov_b32 v84, 0
    v_mov_b32 v85, 0
    v_mov_b32 v86, 0
    v_mov_b32 v87, 0
    v_mov_b32 v88, 0
    v_mov_b32 v89, 0
    v_mov_b32 v90, 0
    v_mov_b32 v91, 0
    v_mov_b32 v92, 0
    v_mov_b32 v93, 0
    v_mov_b32 v94, 0
    v_mov_b32 v95, 0
    s_waitcnt lgkmcnt(0)
    s_mov_b32 s32, s24
    s_mov_b32 s33, s25
    s_mov_b32 s34, 2457600
    s_mov_b32 s35, 0x00020000
    s_mul_i32 s28, s13, 614400
    s_mov_b64 exec, s[26:27]
    s_add_u32 s29, s28, 0
    buffer_load_short_d16_hi v16, v3, s[32:35], s29 offen
    s_add_u32 s29, s28, 3840
    buffer_load_short_d16_hi v17, v3, s[32:35], s29 offen
    s_add_u32 s29, s28, 7680
    buffer_load_short_d16_hi v18, v3, s[32:35], s29 offen
    s_add_u32 s29, s28, 11520
    buffer_load_short_d16_hi v19, v3, s[32:35], s29 offen
    s_add_u32 s29, s28, 15360
    buffer_load_short_d16_hi v20, v3, s[32:35], s29 offen
    s_add_u32 s29, s28, 19200
    buffer_load_short_d16_hi v21, v3, s[32:35], s29 offen
    s_add_u32 s29, s28, 23040
    buffer_load_short_d16_hi v22, v3, s[32:35], s29 offen
    s_add_u32 s29, s28, 26880
    buffer_load_short_d16_hi v23, v3, s[32:35], s29 offen
    s_add_u32 s29, s28, 61440
    buffer_load_short_d16_hi v24, v3, s[32:35], s29 offen
    s_add_u32 s29, s28, 65280
    buffer_load_short_d16_hi v25, v3, s[32:35], s29 offen
    s_add_u32 s29, s28, 69120
    buffer_load_short_d16_hi v26, v3, s[32:35], s29 offen
    s_add_u32 s29, s28, 72960
    buffer_load_short_d16_hi v27, v3, s[32:35], s29 offen
    s_add_u32 s29, s28, 76800
    buffer_load_short_d16_hi v28, v3, s[32:35], s29 offen
    s_add_u32 s29, s28, 80640
    buffer_load_short_d16_hi v29, v3, s[32:35], s29 offen
    s_add_u32 s29, s28, 84480
    buffer_load_short_d16_hi v30, v3, s[32:35], s29 offen
    s_add_u32 s29, s28, 88320
    buffer_load_short_d16_hi v31, v3, s[32:35], s29 offen
    s_add_u32 s29, s28, 122880
    buffer_load_short_d16_hi v32, v3, s[32:35], s29 offen
    s_add_u32 s29, s28, 126720
    buffer_load_short_d16_hi v33, v3, s[32:35], s29 offen
    s_add_u32 s29, s28, 130560
    buffer_load_short_d16_hi v34, v3, s[32:35], s29 offen
    s_add_u32 s29, s28, 134400
    buffer_load_short_d16_hi v35, v3, s[32:35], s29 offen
    s_add_u32 s29, s28, 138240
    buffer_load_short_d16_hi v36, v3, s[32:35], s29 offen
    s_add_u32 s29, s28, 142080
    buffer_load_short_d16_hi v37, v3, s[32:35], s29 offen
    s_add_u32 s29, s28, 145920
    buffer_load_short_d16_hi v38, v3, s[32:35], s29 offen
    s_add_u32 s29, s28, 149760
    buffer_load_short_d16_hi v39, v3, s[32:35], s29 offen
    s_add_u32 s29, s28, 184320
    buffer_load_short_d16_hi v40, v3, s[32:35], s29 offen
    s_add_u32 s29, s28, 188160
    buffer_load_short_d16_hi v41, v3, s[32:35], s29 offen
    s_add_u32 s29, s28, 192000
    buffer_load_short_d16_hi v42, v3, s[32:35], s29 offen
    s_add_u32 s29, s28, 195840
    buffer_load_short_d16_hi v43, v3, s[32:35], s29 offen
    s_add_u32 s29, s28, 199680
    buffer_load_short_d16_hi v44, v3, s[32:35], s29 offen
    s_add_u32 s29, s28, 203520
    buffer_load_short_d16_hi v45, v3, s[32:35], s29 offen
    s_add_u32 s29, s28, 207360
    buffer_load_short_d16_hi v46, v3, s[32:35], s29 offen
    s_add_u32 s29, s28, 211200
    buffer_load_short_d16_hi v47, v3, s[32:35], s29 offen
    s_add_u32 s29, s28, 245760
    buffer_load_short_d16_hi v48, v3, s[32:35], s29 offen
    s_add_u32 s29, s28, 249600
    buffer_load_short_d16_hi v49, v3, s[32:35], s29 offen
    s_add_u32 s29, s28, 253440
    buffer_load_short_d16_hi v50, v3, s[32:35], s29 offen
    s_add_u32 s29, s28, 257280
    buffer_load_short_d16_hi v51, v3, s[32:35], s29 offen
    s_add_u32 s29, s28, 261120
    buffer_load_short_d16_hi v52, v3, s[32:35], s29 offen
    s_add_u32 s29, s28, 264960
    buffer_load_short_d16_hi v53, v3, s[32:35], s29 offen
    s_add_u32 s29, s28, 268800
    buffer_load_short_d16_hi v54, v3, s[32:35], s29 offen
    s_add_u32 s29, s28, 272640
    buffer_load_short_d16_hi v55, v3, s[32:35], s29 offen
    s_add_u32 s29, s28, 307200
    buffer_load_short_d16_hi v56, v3, s[32:35], s29 offen
    s_add_u32 s29, s28, 311040
    buffer_load_short_d16_hi v57, v3, s[32:35], s29 offen
    s_add_u32 s29, s28, 314880
    buffer_load_short_d16_hi v58, v3, s[32:35], s29 offen
    s_add_u32 s29, s28, 318720
    buffer_load_short_d16_hi v59, v3, s[32:35], s29 offen
    s_add_u32 s29, s28, 322560
    buffer_load_short_d16_hi v60, v3, s[32:35], s29 offen
    s_add_u32 s29, s28, 326400
    buffer_load_short_d16_hi v61, v3, s[32:35], s29 offen
    s_add_u32 s29, s28, 330240
    buffer_load_short_d16_hi v62, v3, s[32:35], s29 offen
    s_add_u32 s29, s28, 334080
    buffer_load_short_d16_hi v63, v3, s[32:35], s29 offen
    s_add_u32 s29, s28, 368640
    buffer_load_short_d16_hi v64, v3, s[32:35], s29 offen
    s_add_u32 s29, s28, 372480
    buffer_load_short_d16_hi v65, v3, s[32:35], s29 offen
    s_add_u32 s29, s28, 376320
    buffer_load_short_d16_hi v66, v3, s[32:35], s29 offen
    s_add_u32 s29, s28, 380160
    buffer_load_short_d16_hi v67, v3, s[32:35], s29 offen
    s_add_u32 s29, s28, 384000
    buffer_load_short_d16_hi v68, v3, s[32:35], s29 offen
    s_add_u32 s29, s28, 387840
    buffer_load_short_d16_hi v69, v3, s[32:35], s29 offen
    s_add_u32 s29, s28, 391680
    buffer_load_short_d16_hi v70, v3, s[32:35], s29 offen
    s_add_u32 s29, s28, 395520
    buffer_load_short_d16_hi v71, v3, s[32:35], s29 offen
    s_add_u32 s29, s28, 430080
    buffer_load_short_d16_hi v72, v3, s[32:35], s29 offen
    s_add_u32 s29, s28, 433920
    buffer_load_short_d16_hi v73, v3, s[32:35], s29 offen
    s_add_u32 s29, s28, 437760
    buffer_load_short_d16_hi v74, v3, s[32:35], s29 offen
    s_add_u32 s29, s28, 441600
    buffer_load_short_d16_hi v75, v3, s[32:35], s29 offen
    s_add_u32 s29, s28, 445440
    buffer_load_short_d16_hi v76, v3, s[32:35], s29 offen
    s_add_u32 s29, s28, 449280
    buffer_load_short_d16_hi v77, v3, s[32:35], s29 offen
    s_add_u32 s29, s28, 453120
    buffer_load_short_d16_hi v78, v3, s[32:35], s29 offen
    s_add_u32 s29, s28, 456960
    buffer_load_short_d16_hi v79, v3, s[32:35], s29 offen
    s_add_u32 s29, s28, 491520
    buffer_load_short_d16_hi v80, v3, s[32:35], s29 offen
    s_add_u32 s29, s28, 495360
    buffer_load_short_d16_hi v81, v3, s[32:35], s29 offen
    s_add_u32 s29, s28, 499200
    buffer_load_short_d16_hi v82, v3, s[32:35], s29 offen
    s_add_u32 s29, s28, 503040
    buffer_load_short_d16_hi v83, v3, s[32:35], s29 offen
    s_add_u32 s29, s28, 506880
    buffer_load_short_d16_hi v84, v3, s[32:35], s29 offen
    s_add_u32 s29, s28, 510720
    buffer_load_short_d16_hi v85, v3, s[32:35], s29 offen
    s_add_u32 s29, s28, 514560
    buffer_load_short_d16_hi v86, v3, s[32:35], s29 offen
    s_add_u32 s29, s28, 518400
    buffer_load_short_d16_hi v87, v3, s[32:35], s29 offen
    s_add_u32 s29, s28, 552960
    buffer_load_short_d16_hi v88, v3, s[32:35], s29 offen
    s_add_u32 s29, s28, 556800
    buffer_load_short_d16_hi v89, v3, s[32:35], s29 offen
    s_add_u32 s29, s28, 560640
    buffer_load_short_d16_hi v90, v3, s[32:35], s29 offen
    s_add_u32 s29, s28, 564480
    buffer_load_short_d16_hi v91, v3, s[32:35], s29 offen
    s_add_u32 s29, s28, 568320
    buffer_load_short_d16_hi v92, v3, s[32:35], s29 offen
    s_add_u32 s29, s28, 572160
    buffer_load_short_d16_hi v93, v3, s[32:35], s29 offen
    s_add_u32 s29, s28, 576000
    buffer_load_short_d16_hi v94, v3, s[32:35], s29 offen
    s_add_u32 s29, s28, 579840
    buffer_load_short_d16_hi v95, v3, s[32:35], s29 offen
    s_mov_b64 exec, -1
    s_waitcnt vmcnt(0)
    v_add_f32 v5, v16, v17
    v_add_f32 v5, v5, v18
    v_add_f32 v5, v5, v19
    v_add_f32 v5, v5, v20
    v_add_f32 v5, v5, v21
    v_add_f32 v5, v5, v22
    v_add_f32 v5, v5, v23
    v_add_f32 v5, v5, v24
    v_add_f32 v5, v5, v25
    v_add_f32 v5, v5, v26
    v_add_f32 v5, v5, v27
    v_add_f32 v5, v5, v28
    v_add_f32 v5, v5, v29
    v_add_f32 v5, v5, v30
    v_add_f32 v5, v5, v31
    v_add_f32 v5, v5, v32
    v_add_f32 v5, v5, v33
    v_add_f32 v5, v5, v34
    v_add_f32 v5, v5, v35
    v_add_f32 v5, v5, v36
    v_add_f32 v5, v5, v37
    v_add_f32 v5, v5, v38
    v_add_f32 v5, v5, v39
    v_add_f32 v5, v5, v40
    v_add_f32 v5, v5, v41
    v_add_f32 v5, v5, v42
    v_add_f32 v5, v5, v43
    v_add_f32 v5, v5, v44
    v_add_f32 v5, v5, v45
    v_add_f32 v5, v5, v46
    v_add_f32 v5, v5, v47
    v_add_f32 v5, v5, v48
    v_add_f32 v5, v5, v49
    v_add_f32 v5, v5, v50
    v_add_f32 v5, v5, v51
    v_add_f32 v5, v5, v52
    v_add_f32 v5, v5, v53
    v_add_f32 v5, v5, v54
    v_add_f32 v5, v5, v55
    v_add_f32 v5, v5, v56
    v_add_f32 v5, v5, v57
    v_add_f32 v5, v5, v58
    v_add_f32 v5, v5, v59
    v_add_f32 v5, v5, v60
    v_add_f32 v5, v5, v61
    v_add_f32 v5, v5, v62
    v_add_f32 v5, v5, v63
    v_add_f32 v5, v5, v64
    v_add_f32 v5, v5, v65
    v_add_f32 v5, v5, v66
    v_add_f32 v5, v5, v67
    v_add_f32 v5, v5, v68
    v_add_f32 v5, v5, v69
    v_add_f32 v5, v5, v70
    v_add_f32 v5, v5, v71
    v_add_f32 v5, v5, v72
    v_add_f32 v5, v5, v73
    v_add_f32 v5, v5, v74
    v_add_f32 v5, v5, v75
    v_add_f32 v5, v5, v76
    v_add_f32 v5, v5, v77
    v_add_f32 v5, v5, v78
    v_add_f32 v5, v5, v79
    v_add_f32 v5, v5, v80
    v_add_f32 v5, v5, v81
    v_add_f32 v5, v5, v82
    v_add_f32 v5, v5, v83
    v_add_f32 v5, v5, v84
    v_add_f32 v5, v5, v85
    v_add_f32 v5, v5, v86
    v_add_f32 v5, v5, v87
    v_add_f32 v5, v5, v88
    v_add_f32 v5, v5, v89
    v_add_f32 v5, v5, v90
    v_add_f32 v5, v5, v91
    v_add_f32 v5, v5, v92
    v_add_f32 v5, v5, v93
    v_add_f32 v5, v5, v94
    v_add_f32 v5, v5, v95
    v_mov_b32 v6, v5
    s_nop 1
    v_permlane32_swap_b32 v5, v6
    v_add_f32 v5, v5, v6
    s_lshl_b32 s29, s13, 8
    v_lshlrev_b32 v7, 2, v0
    v_add_u32 v8, s29, v7
    ds_write_b32 v8, v5
    s_waitcnt lgkmcnt(0)
    s_barrier
    ds_read_b32 v8, v7 offset:0
    ds_read_b32 v9, v7 offset:256
    ds_read_b32 v10, v7 offset:512
    ds_read_b32 v11, v7 offset:768
    s_waitcnt lgkmcnt(0)
    v_add_f32 v8, v8, v9
    v_add_f32 v10, v10, v11
    v_add_f32 v8, v8, v10
    v_mul_f32 v8, 0x3acccccd, v8
    v_sub_f32 v16, v16, v8
    v_sub_f32 v17, v17, v8
    v_sub_f32 v18, v18, v8
    v_sub_f32 v19, v19, v8
    v_sub_f32 v20, v20, v8
    v_sub_f32 v21, v21, v8
    v_sub_f32 v22, v22, v8
    v_sub_f32 v23, v23, v8
    v_sub_f32 v24, v24, v8
    v_sub_f32 v25, v25, v8
    v_sub_f32 v26, v26, v8
    v_sub_f32 v27, v27, v8
    v_sub_f32 v28, v28, v8
    v_sub_f32 v29, v29, v8
    v_sub_f32 v30, v30, v8
    v_sub_f32 v31, v31, v8
    v_sub_f32 v32, v32, v8
    v_sub_f32 v33, v33, v8
    v_sub_f32 v34, v34, v8
    v_sub_f32 v35, v35, v8
    v_sub_f32 v36, v36, v8
    v_sub_f32 v37, v37, v8
    v_sub_f32 v38, v38, v8
    v_sub_f32 v39, v39, v8
    v_sub_f32 v40, v40, v8
    v_sub_f32 v41, v41, v8
    v_sub_f32 v42, v42, v8
    v_sub_f32 v43, v43, v8
    v_sub_f32 v44, v44, v8
    v_sub_f32 v45, v45, v8
    v_sub_f32 v46, v46, v8
    v_sub_f32 v47, v47, v8
    v_sub_f32 v48, v48, v8
    v_sub_f32 v49, v49, v8
    v_sub_f32 v50, v50, v8
    v_sub_f32 v51, v51, v8
    v_sub_f32 v52, v52, v8
    v_sub_f32 v53, v53, v8
    v_sub_f32 v54, v54, v8
    v_sub_f32 v55, v55, v8
    v_sub_f32 v56, v56, v8
    v_sub_f32 v57, v57, v8
    v_sub_f32 v58, v58, v8
    v_sub_f32 v59, v59, v8
    v_sub_f32 v60, v60, v8
    v_sub_f32 v61, v61, v8
    v_sub_f32 v62, v62, v8
    v_sub_f32 v63, v63, v8
    v_sub_f32 v64, v64, v8
    v_sub_f32 v65, v65, v8
    v_sub_f32 v66, v66, v8
    v_sub_f32 v67, v67, v8
    v_sub_f32 v68, v68, v8
    v_sub_f32 v69, v69, v8
    v_sub_f32 v70, v70, v8
    v_sub_f32 v71, v71, v8
    v_sub_f32 v72, v72, v8
    v_sub_f32 v73, v73, v8
    v_sub_f32 v74, v74, v8
    v_sub_f32 v75, v75, v8
    v_sub_f32 v76, v76, v8
    v_sub_f32 v77, v77, v8
    v_sub_f32 v78, v78, v8
    v_sub_f32 v79, v79, v8
    v_sub_f32 v80, v80, v8
    v_sub_f32 v81, v81, v8
    v_sub_f32 v82, v82, v8
    v_sub_f32 v83, v83, v8
    v_sub_f32 v84, v84, v8
    v_sub_f32 v85, v85, v8
    v_sub_f32 v86, v86, v8
    v_sub_f32 v87, v87, v8
    v_sub_f32 v88, v88, v8
    v_sub_f32 v89, v89, v8
    v_sub_f32 v90, v90, v8
    v_sub_f32 v91, v91, v8
    v_sub_f32 v92, v92, v8
    v_sub_f32 v93, v93, v8
    v_sub_f32 v94, v94, v8
    v_sub_f32 v95, v95, v8
    s_lshl_b32 s26, s22, 9
    s_mov_b32 s27, s26
    v_cndmask_b32 v16, v16, 1.0, s[26:27]
    v_cndmask_b32 v17, v17, 1.0, s[26:27]
    v_cndmask_b32 v18, v18, 1.0, s[26:27]
    v_cndmask_b32 v19, v19, 1.0, s[26:27]
    v_cndmask_b32 v20, v20, 1.0, s[26:27]
    v_cndmask_b32 v21, v21, 1.0, s[26:27]
    v_cndmask_b32 v22, v22, 1.0, s[26:27]
    v_cndmask_b32 v23, v23, 1.0, s[26:27]
    v_cndmask_b32 v24, v24, 1.0, s[26:27]
    v_cndmask_b32 v25, v25, 1.0, s[26:27]
    v_cndmask_b32 v26, v26, 1.0, s[26:27]
    v_cndmask_b32 v27, v27, 1.0, s[26:27]
    v_cndmask_b32 v28, v28, 1.0, s[26:27]
    v_cndmask_b32 v29, v29, 1.0, s[26:27]
    v_cndmask_b32 v30, v30, 1.0, s[26:27]
    v_cndmask_b32 v31, v31, 1.0, s[26:27]
    v_cndmask_b32 v32, v32, 1.0, s[26:27]
    v_cndmask_b32 v33, v33, 1.0, s[26:27]
    v_cndmask_b32 v34, v34, 1.0, s[26:27]
    v_cndmask_b32 v35, v35, 1.0, s[26:27]
    v_cndmask_b32 v36, v36, 1.0, s[26:27]
    v_cndmask_b32 v37, v37, 1.0, s[26:27]
    v_cndmask_b32 v38, v38, 1.0, s[26:27]
    v_cndmask_b32 v39, v39, 1.0, s[26:27]
    v_cndmask_b32 v40, v40, 1.0, s[26:27]
    v_cndmask_b32 v41, v41, 1.0, s[26:27]
    v_cndmask_b32 v42, v42, 1.0, s[26:27]
    v_cndmask_b32 v43, v43, 1.0, s[26:27]
    v_cndmask_b32 v44, v44, 1.0, s[26:27]
    v_cndmask_b32 v45, v45, 1.0, s[26:27]
    v_cndmask_b32 v46, v46, 1.0, s[26:27]
    v_cndmask_b32 v47, v47, 1.0, s[26:27]
    v_cndmask_b32 v48, v48, 1.0, s[26:27]
    v_cndmask_b32 v49, v49, 1.0, s[26:27]
    v_cndmask_b32 v50, v50, 1.0, s[26:27]
    v_cndmask_b32 v51, v51, 1.0, s[26:27]
    v_cndmask_b32 v52, v52, 1.0, s[26:27]
    v_cndmask_b32 v53, v53, 1.0, s[26:27]
    v_cndmask_b32 v54, v54, 1.0, s[26:27]
    v_cndmask_b32 v55, v55, 1.0, s[26:27]
    v_cndmask_b32 v56, v56, 1.0, s[26:27]
    v_cndmask_b32 v57, v57, 1.0, s[26:27]
    v_cndmask_b32 v58, v58, 1.0, s[26:27]
    v_cndmask_b32 v59, v59, 1.0, s[26:27]
    v_cndmask_b32 v60, v60, 1.0, s[26:27]
    v_cndmask_b32 v61, v61, 1.0, s[26:27]
    v_cndmask_b32 v62, v62, 1.0, s[26:27]
    v_cndmask_b32 v63, v63, 1.0, s[26:27]
    v_cndmask_b32 v64, v64, 1.0, s[26:27]
    v_cndmask_b32 v65, v65, 1.0, s[26:27]
    v_cndmask_b32 v66, v66, 1.0, s[26:27]
    v_cndmask_b32 v67, v67, 1.0, s[26:27]
    v_cndmask_b32 v68, v68, 1.0, s[26:27]
    v_cndmask_b32 v69, v69, 1.0, s[26:27]
    v_cndmask_b32 v70, v70, 1.0, s[26:27]
    v_cndmask_b32 v71, v71, 1.0, s[26:27]
    v_cndmask_b32 v72, v72, 1.0, s[26:27]
    v_cndmask_b32 v73, v73, 1.0, s[26:27]
    v_cndmask_b32 v74, v74, 1.0, s[26:27]
    v_cndmask_b32 v75, v75, 1.0, s[26:27]
    v_cndmask_b32 v76, v76, 1.0, s[26:27]
    v_cndmask_b32 v77, v77, 1.0, s[26:27]
    v_cndmask_b32 v78, v78, 1.0, s[26:27]
    v_cndmask_b32 v79, v79, 1.0, s[26:27]
    v_cndmask_b32 v80, v80, 1.0, s[26:27]
    v_cndmask_b32 v81, v81, 1.0, s[26:27]
    v_cndmask_b32 v82, v82, 1.0, s[26:27]
    v_cndmask_b32 v83, v83, 1.0, s[26:27]
    v_cndmask_b32 v84, v84, 1.0, s[26:27]
    v_cndmask_b32 v85, v85, 1.0, s[26:27]
    v_cndmask_b32 v86, v86, 1.0, s[26:27]
    v_cndmask_b32 v87, v87, 1.0, s[26:27]
    v_cndmask_b32 v88, v88, 1.0, s[26:27]
    v_cndmask_b32 v89, v89, 1.0, s[26:27]
    v_cndmask_b32 v90, v90, 1.0, s[26:27]
    v_cndmask_b32 v91, v91, 1.0, s[26:27]
    v_cndmask_b32 v92, v92, 1.0, s[26:27]
    v_cndmask_b32 v93, v93, 1.0, s[26:27]
    v_cndmask_b32 v94, v94, 1.0, s[26:27]
    v_cndmask_b32 v95, v95, 1.0, s[26:27]
    s_mul_i32 s29, s21, 81920
    s_lshl_b32 s30, s22, 10
    s_add_u32 s29, s29, s30
    s_mul_i32 s30, s13, 20480
    s_add_u32 s29, s29, s30
    s_add_u32 s29, s29, 243269632
    v_lshlrev_b32 v7, 4, v0
    v_cvt_pk_bf16_f32 v100, v16, v17
    v_cvt_pk_bf16_f32 v101, v18, v19
    v_cvt_pk_bf16_f32 v102, v20, v21
    v_cvt_pk_bf16_f32 v103, v22, v23
    buffer_store_dwordx4 v[100:103], v7, s[8:11], s29 offen
    s_add_u32 s29, s29, 2048
    v_cvt_pk_bf16_f32 v104, v24, v25
    v_cvt_pk_bf16_f32 v105, v26, v27
    v_cvt_pk_bf16_f32 v106, v28, v29
    v_cvt_pk_bf16_f32 v107, v30, v31
    buffer_store_dwordx4 v[104:107], v7, s[8:11], s29 offen
    s_add_u32 s29, s29, 2048
    v_cvt_pk_bf16_f32 v100, v32, v33
    v_cvt_pk_bf16_f32 v101, v34, v35
    v_cvt_pk_bf16_f32 v102, v36, v37
    v_cvt_pk_bf16_f32 v103, v38, v39
    buffer_store_dwordx4 v[100:103], v7, s[8:11], s29 offen
    s_add_u32 s29, s29, 2048
    v_cvt_pk_bf16_f32 v104, v40, v41
    v_cvt_pk_bf16_f32 v105, v42, v43
    v_cvt_pk_bf16_f32 v106, v44, v45
    v_cvt_pk_bf16_f32 v107, v46, v47
    buffer_store_dwordx4 v[104:107], v7, s[8:11], s29 offen
    s_add_u32 s29, s29, 2048
    v_cvt_pk_bf16_f32 v100, v48, v49
    v_cvt_pk_bf16_f32 v101, v50, v51
    v_cvt_pk_bf16_f32 v102, v52, v53
    v_cvt_pk_bf16_f32 v103, v54, v55
    buffer_store_dwordx4 v[100:103], v7, s[8:11], s29 offen
    s_add_u32 s29, s29, 2048
    v_cvt_pk_bf16_f32 v104, v56, v57
    v_cvt_pk_bf16_f32 v105, v58, v59
    v_cvt_pk_bf16_f32 v106, v60, v61
    v_cvt_pk_bf16_f32 v107, v62, v63
    buffer_store_dwordx4 v[104:107], v7, s[8:11], s29 offen
    s_add_u32 s29, s29, 2048
    v_cvt_pk_bf16_f32 v100, v64, v65
    v_cvt_pk_bf16_f32 v101, v66, v67
    v_cvt_pk_bf16_f32 v102, v68, v69
    v_cvt_pk_bf16_f32 v103, v70, v71
    buffer_store_dwordx4 v[100:103], v7, s[8:11], s29 offen
    s_add_u32 s29, s29, 2048
    v_cvt_pk_bf16_f32 v104, v72, v73
    v_cvt_pk_bf16_f32 v105, v74, v75
    v_cvt_pk_bf16_f32 v106, v76, v77
    v_cvt_pk_bf16_f32 v107, v78, v79
    buffer_store_dwordx4 v[104:107], v7, s[8:11], s29 offen
    s_add_u32 s29, s29, 2048
    v_cvt_pk_bf16_f32 v100, v80, v81
    v_cvt_pk_bf16_f32 v101, v82, v83
    v_cvt_pk_bf16_f32 v102, v84, v85
    v_cvt_pk_bf16_f32 v103, v86, v87
    buffer_store_dwordx4 v[100:103], v7, s[8:11], s29 offen
    s_add_u32 s29, s29, 2048
    v_cvt_pk_bf16_f32 v104, v88, v89
    v_cvt_pk_bf16_f32 v105, v90, v91
    v_cvt_pk_bf16_f32 v106, v92, v93
    v_cvt_pk_bf16_f32 v107, v94, v95
    buffer_store_dwordx4 v[104:107], v7, s[8:11], s29 offen
    s_add_u32 s29, s29, 2048
    s_branch prep_kernel_end
prep_kernel_r_pwo:
    s_lshl_b32 s20, s20, 2
    s_add_u32 s20, s20, s13
    s_load_dwordx2 s[24:25], s[0:1], 16
    s_lshr_b32 s21, s20, 3
    s_and_b32 s22, s20, 7
    v_and_b32 v1, 31, v0
    v_lshrrev_b32 v2, 5, v0
    v_lshlrev_b32 v3, 1, v1
    v_mul_u32_u24 v4, 10240, v2
    v_add_u32 v3, v3, v4
    s_lshl_b32 s29, s21, 6
    s_mul_i32 s30, s22, 102400
    s_add_u32 s29, s29, s30
    s_waitcnt lgkmcnt(0)
    s_mov_b32 s32, s24
    s_mov_b32 s33, s25
    s_mov_b32 s34, 819200
    s_mov_b32 s35, 0x00020000
    s_add_u32 s30, s29, 0
    buffer_load_ushort v16, v3, s[32:35], s30 offen
    s_add_u32 s30, s29, 1280
    buffer_load_ushort v17, v3, s[32:35], s30 offen
    s_add_u32 s30, s29, 2560
    buffer_load_ushort v18, v3, s[32:35], s30 offen
    s_add_u32 s30, s29, 3840
    buffer_load_ushort v19, v3, s[32:35], s30 offen
    s_add_u32 s30, s29, 5120
    buffer_load_ushort v20, v3, s[32:35], s30 offen
    s_add_u32 s30, s29, 6400
    buffer_load_ushort v21, v3, s[32:35], s30 offen
    s_add_u32 s30, s29, 7680
    buffer_load_ushort v22, v3, s[32:35], s30 offen
    s_add_u32 s30, s29, 8960
    buffer_load_ushort v23, v3, s[32:35], s30 offen
    s_add_u32 s30, s29, 20480
    buffer_load_ushort v24, v3, s[32:35], s30 offen
    s_add_u32 s30, s29, 21760
    buffer_load_ushort v25, v3, s[32:35], s30 offen
    s_add_u32 s30, s29, 23040
    buffer_load_ushort v26, v3, s[32:35], s30 offen
    s_add_u32 s30, s29, 24320
    buffer_load_ushort v27, v3, s[32:35], s30 offen
    s_add_u32 s30, s29, 25600
    buffer_load_ushort v28, v3, s[32:35], s30 offen
    s_add_u32 s30, s29, 26880
    buffer_load_ushort v29, v3, s[32:35], s30 offen
    s_add_u32 s30, s29, 28160
    buffer_load_ushort v30, v3, s[32:35], s30 offen
    s_add_u32 s30, s29, 29440
    buffer_load_ushort v31, v3, s[32:35], s30 offen
    s_add_u32 s30, s29, 40960
    buffer_load_ushort v32, v3, s[32:35], s30 offen
    s_add_u32 s30, s29, 42240
    buffer_load_ushort v33, v3, s[32:35], s30 offen
    s_add_u32 s30, s29, 43520
    buffer_load_ushort v34, v3, s[32:35], s30 offen
    s_add_u32 s30, s29, 44800
    buffer_load_ushort v35, v3, s[32:35], s30 offen
    s_add_u32 s30, s29, 46080
    buffer_load_ushort v36, v3, s[32:35], s30 offen
    s_add_u32 s30, s29, 47360
    buffer_load_ushort v37, v3, s[32:35], s30 offen
    s_add_u32 s30, s29, 48640
    buffer_load_ushort v38, v3, s[32:35], s30 offen
    s_add_u32 s30, s29, 49920
    buffer_load_ushort v39, v3, s[32:35], s30 offen
    s_add_u32 s30, s29, 61440
    buffer_load_ushort v40, v3, s[32:35], s30 offen
    s_add_u32 s30, s29, 62720
    buffer_load_ushort v41, v3, s[32:35], s30 offen
    s_add_u32 s30, s29, 64000
    buffer_load_ushort v42, v3, s[32:35], s30 offen
    s_add_u32 s30, s29, 65280
    buffer_load_ushort v43, v3, s[32:35], s30 offen
    s_add_u32 s30, s29, 66560
    buffer_load_ushort v44, v3, s[32:35], s30 offen
    s_add_u32 s30, s29, 67840
    buffer_load_ushort v45, v3, s[32:35], s30 offen
    s_add_u32 s30, s29, 69120
    buffer_load_ushort v46, v3, s[32:35], s30 offen
    s_add_u32 s30, s29, 70400
    buffer_load_ushort v47, v3, s[32:35], s30 offen
    s_add_u32 s30, s29, 81920
    buffer_load_ushort v48, v3, s[32:35], s30 offen
    s_add_u32 s30, s29, 83200
    buffer_load_ushort v49, v3, s[32:35], s30 offen
    s_add_u32 s30, s29, 84480
    buffer_load_ushort v50, v3, s[32:35], s30 offen
    s_add_u32 s30, s29, 85760
    buffer_load_ushort v51, v3, s[32:35], s30 offen
    s_add_u32 s30, s29, 87040
    buffer_load_ushort v52, v3, s[32:35], s30 offen
    s_add_u32 s30, s29, 88320
    buffer_load_ushort v53, v3, s[32:35], s30 offen
    s_add_u32 s30, s29, 89600
    buffer_load_ushort v54, v3, s[32:35], s30 offen
    s_add_u32 s30, s29, 90880
    buffer_load_ushort v55, v3, s[32:35], s30 offen
    s_mul_i32 s29, s20, 5120
    s_add_u32 s29, s29, 246415360
    v_lshlrev_b32 v7, 4, v0
    s_waitcnt vmcnt(32)
    v_lshl_or_b32 v64, v17, 16, v16
    v_lshl_or_b32 v65, v19, 16, v18
    v_lshl_or_b32 v66, v21, 16, v20
    v_lshl_or_b32 v67, v23, 16, v22
    buffer_store_dwordx4 v[64:67], v7, s[8:11], s29 offen offset:0
    s_waitcnt vmcnt(25)
    v_lshl_or_b32 v68, v25, 16, v24
    v_lshl_or_b32 v69, v27, 16, v26
    v_lshl_or_b32 v70, v29, 16, v28
    v_lshl_or_b32 v71, v31, 16, v30
    buffer_store_dwordx4 v[68:71], v7, s[8:11], s29 offen offset:1024
    s_waitcnt vmcnt(18)
    v_lshl_or_b32 v72, v33, 16, v32
    v_lshl_or_b32 v73, v35, 16, v34
    v_lshl_or_b32 v74, v37, 16, v36
    v_lshl_or_b32 v75, v39, 16, v38
    buffer_store_dwordx4 v[72:75], v7, s[8:11], s29 offen offset:2048
    s_waitcnt vmcnt(11)
    v_lshl_or_b32 v76, v41, 16, v40
    v_lshl_or_b32 v77, v43, 16, v42
    v_lshl_or_b32 v78, v45, 16, v44
    v_lshl_or_b32 v79, v47, 16, v46
    buffer_store_dwordx4 v[76:79], v7, s[8:11], s29 offen offset:3072
    s_add_u32 s29, s29, 4096
    s_waitcnt vmcnt(4)
    v_lshl_or_b32 v80, v49, 16, v48
    v_lshl_or_b32 v81, v51, 16, v50
    v_lshl_or_b32 v82, v53, 16, v52
    v_lshl_or_b32 v83, v55, 16, v54
    buffer_store_dwordx4 v[80:83], v7, s[8:11], s29 offen offset:0
    s_branch prep_kernel_end
prep_kernel_end:
    s_endpgm
.section .rodata,"a"
.p2align 6
.amdhsa_kernel prep_kernel
  .amdhsa_next_free_vgpr 160
  .amdhsa_next_free_sgpr 64
  .amdhsa_accum_offset 160
  .amdhsa_group_segment_fixed_size 0
  .amdhsa_kernarg_size 104
  .amdhsa_user_sgpr_count 2
  .amdhsa_user_sgpr_kernarg_segment_ptr 1
  .amdhsa_system_sgpr_workgroup_id_x 1
.end_amdhsa_kernel
.text
.globl layerb2_kernel
.p2align 8
.type layerb2_kernel,@function
layerb2_kernel:
    s_mov_b32 s49, 1
    s_branch layerb1_kernel_body
    s_endpgm
.section .rodata,"a"
.p2align 6
.amdhsa_kernel layerb2_kernel
  .amdhsa_next_free_vgpr 512
  .amdhsa_next_free_sgpr 100
  .amdhsa_accum_offset 256
  .amdhsa_group_segment_fixed_size 0
  .amdhsa_kernarg_size 104
  .amdhsa_user_sgpr_count 2
  .amdhsa_user_sgpr_kernarg_segment_ptr 1
  .amdhsa_system_sgpr_workgroup_id_x 1
.end_amdhsa_kernel
.text
.globl layerb1_kernel
.p2align 8
.type layerb1_kernel,@function
layerb1_kernel:
    s_mov_b32 s49, 0
layerb1_kernel_body:
    s_cmp_ge_u32 s2, 256
    s_cbranch_scc1 layerb1_kernel_end0
    s_load_dwordx2 s[4:5], s[0:1], 96
    s_load_dwordx2 s[6:7], s[0:1], 80
    v_lshrrev_b32 v1, 6, v0
    v_and_b32 v0, 63, v0
    s_nop 0
    v_readfirstlane_b32 s13, v1
    s_mov_b32 s15, 400000
    s_waitcnt lgkmcnt(0)
    s_mov_b32 s8, s4
    s_mov_b32 s9, s5
    s_mov_b32 s10, 268435456
    s_mov_b32 s11, 0x00020000
    s_mul_i32 s48, s49, 65536
    s_add_u32 s48, s48, 10616832
    s_lshl_b32 s60, s49, 11
    s_add_u32 s60, s60, 10485760
    s_getreg_b32 s61, hwreg(HW_REG_XCC_ID)
    s_and_b32 s61, s61, 7
    s_cmp_lg_u32 s13, 0
    s_cbranch_scc1 layerb1_kernel_tk_p1
    s_lshl_b32 s63, s61, 8
    s_add_u32 s63, s63, s60
    s_mov_b64 exec, 1
    v_mov_b32 v230, 0
    v_mov_b32 v231, 1
    buffer_atomic_add v231, v230, s[8:11], s63 offen sc0 sc1
    s_mov_b64 exec, -1
layerb1_kernel_tk_p1:
    s_load_dwordx2 s[16:17], s[0:1], 0
    s_add_u32 s28, s4, 247463936
    s_addc_u32 s29, s5, 0
    s_waitcnt lgkmcnt(0)
    s_cmp_eq_u32 s49, 0
    s_cselect_b32 s16, s16, s28
    s_cselect_b32 s17, s17, s29
    s_mov_b32 s18, 2621440
    s_mov_b32 s19, 0x00020000
    s_and_b32 s28, s2, 7
    s_lshr_b32 s29, s2, 3
    s_and_b32 s30, s28, 3
    s_lshl_b32 s30, s30, 2
    s_and_b32 s31, s29, 3
    s_add_u32 s20, s30, s31
    s_lshr_b32 s30, s28, 2
    s_lshl_b32 s30, s30, 3
    s_lshr_b32 s31, s29, 2
    s_add_u32 s21, s30, s31
    s_lshr_b32 s22, s13, 1
    s_and_b32 s23, s13, 1
    s_lshl_b32 s26, s20, 1
    s_add_u32 s26, s26, s23
    s_mov_b32 s27, 0x3f803f80
    s_lshl_b32 s28, s21, 7
    s_lshl_b32 s29, s13, 5
    s_add_u32 s28, s28, s29
    s_mul_i32 s24, s28, 1280
    s_lshl_b32 s28, s20, 1
    s_add_u32 s28, s28, s22
    s_mul_i32 s25, s28, 81920
    s_lshl_b32 s29, s23, 12
    s_add_u32 s25, s25, s29
    s_add_u32 s25, s25, 243269632
    v_lshlrev_b32 v1, 4, v0
    v_lshrrev_b32 v16, 3, v0
    v_mul_u32_u24 v16, 1280, v16
    v_and_b32 v17, 7, v0
    v_lshrrev_b32 v18, 4, v0
    v_xor_b32 v19, v17, v18
    v_lshl_add_u32 v2, v19, 4, v16
    v_xor_b32 v19, 4, v19
    v_lshl_add_u32 v3, v19, 4, v16
    s_lshl_b32 s28, s13, 12
    s_mov_b32 m0, s28
    s_add_u32 s29, s24, 0
    buffer_load_dwordx4 v2, s[16:19], s29 offen offset:0 lds
    s_add_u32 s29, s29, 9216
    buffer_load_dwordx4 v3, s[16:19], s29 offen offset:1024 lds
    s_add_u32 s29, s29, 9216
    buffer_load_dwordx4 v2, s[16:19], s29 offen offset:2048 lds
    s_add_u32 s29, s29, 9216
    buffer_load_dwordx4 v3, s[16:19], s29 offen offset:3072 lds
    s_add_u32 s28, s28, 16384
    s_mov_b32 m0, s28
    s_add_u32 s29, s25, 0
    buffer_load_dwordx4 v1, s[8:11], s29 offen offset:0 lds
    buffer_load_dwordx4 v1, s[8:11], s29 offen offset:1024 lds
    buffer_load_dwordx4 v1, s[8:11], s29 offen offset:2048 lds
    buffer_load_dwordx4 v1, s[8:11], s29 offen offset:3072 lds
    s_lshl_b32 s28, s13, 12
    s_add_u32 s28, s28, 32768
    s_mov_b32 m0, s28
    s_add_u32 s29, s24, 128
    buffer_load_dwordx4 v2, s[16:19], s29 offen offset:0 lds
    s_add_u32 s29, s29, 9216
    buffer_load_dwordx4 v3, s[16:19], s29 offen offset:1024 lds
    s_add_u32 s29, s29, 9216
    buffer_load_dwordx4 v2, s[16:19], s29 offen offset:2048 lds
    s_add_u32 s29, s29, 9216
    buffer_load_dwordx4 v3, s[16:19], s29 offen offset:3072 lds
    s_add_u32 s28, s28, 16384
    s_mov_b32 m0, s28
    s_add_u32 s29, s25, 8192
    buffer_load_dwordx4 v1, s[8:11], s29 offen offset:0 lds
    buffer_load_dwordx4 v1, s[8:11], s29 offen offset:1024 lds
    buffer_load_dwordx4 v1, s[8:11], s29 offen offset:2048 lds
    buffer_load_dwordx4 v1, s[8:11], s29 offen offset:3072 lds
    s_lshl_b32 s28, s13, 12
    s_add_u32 s28, s28, 65536
    s_mov_b32 m0, s28
    s_add_u32 s29, s24, 256
    buffer_load_dwordx4 v2, s[16:19], s29 offen offset:0 lds
    s_add_u32 s29, s29, 9216
    buffer_load_dwordx4 v3, s[16:19], s29 offen offset:1024 lds
    s_add_u32 s29, s29, 9216
    buffer_load_dwordx4 v2, s[16:19], s29 offen offset:2048 lds
    s_add_u32 s29, s29, 9216
    buffer_load_dwordx4 v3, s[16:19], s29 offen offset:3072 lds
    s_add_u32 s28, s28, 16384
    s_mov_b32 m0, s28
    s_add_u32 s29, s25, 16384
    buffer_load_dwordx4 v1, s[8:11], s29 offen offset:0 lds
    buffer_load_dwordx4 v1, s[8:11], s29 offen offset:1024 lds
    buffer_load_dwordx4 v1, s[8:11], s29 offen offset:2048 lds
    buffer_load_dwordx4 v1, s[8:11], s29 offen offset:3072 lds
    s_cmp_lg_u32 s13, 0
    s_cbranch_scc1 layerb1_kernel_tk_wait
    s_waitcnt vmcnt(24)
    s_nop 0
    v_readfirstlane_b32 s62, v231
    s_cmp_lt_u32 s62, 32
    s_cbranch_scc1 layerb1_kernel_tk_pub
    v_lshlrev_b32 v230, 8, v0
    v_and_b32 v230, 0x7ff, v230
    s_mov_b32 s63, s60
layerb1_kernel_tk_poll:
    buffer_load_dword v231, v230, s[8:11], s63 offen sc1
    s_waitcnt vmcnt(0)
    s_mov_b32 s64, 0
    v_readlane_b32 s65, v231, 0
    s_nop 0
    s_add_u32 s64, s64, s65
    v_readlane_b32 s66, v231, 1
    s_nop 0
    s_add_u32 s64, s64, s66
    v_readlane_b32 s67, v231, 2
    s_nop 0
    s_add_u32 s64, s64, s67
    v_readlane_b32 s68, v231, 3
    s_nop 0
    s_add_u32 s64, s64, s68
    v_readlane_b32 s69, v231, 4
    s_nop 0
    s_add_u32 s64, s64, s69
    v_readlane_b32 s70, v231, 5
    s_nop 0
    s_add_u32 s64, s64, s70
    v_readlane_b32 s71, v231, 6
    s_nop 0
    s_add_u32 s64, s64, s71
    v_readlane_b32 s72, v231, 7
    s_nop 0
    s_add_u32 s64, s64, s72
    s_sub_u32 s15, s15, 1
    s_cbranch_scc1 layerb1_kernel_bail
    s_cmp_lt_u32 s64, 256
    s_cbranch_scc1 layerb1_kernel_tk_poll
    s_sub_u32 s62, s62, 32
    s_max_u32 s64, s65, 32
    s_sub_u32 s64, s64, 32
    s_cmp_gt_u32 s61, 0
    s_cselect_b32 s64, s64, 0
    s_add_u32 s62, s62, s64
    s_max_u32 s64, s66, 32
    s_sub_u32 s64, s64, 32
    s_cmp_gt_u32 s61, 1
    s_cselect_b32 s64, s64, 0
    s_add_u32 s62, s62, s64
    s_max_u32 s64, s67, 32
    s_sub_u32 s64, s64, 32
    s_cmp_gt_u32 s61, 2
    s_cselect_b32 s64, s64, 0
    s_add_u32 s62, s62, s64
    s_max_u32 s64, s68, 32
    s_sub_u32 s64, s64, 32
    s_cmp_gt_u32 s61, 3
    s_cselect_b32 s64, s64, 0
    s_add_u32 s62, s62, s64
    s_max_u32 s64, s69, 32
    s_sub_u32 s64, s64, 32
    s_cmp_gt_u32 s61, 4
    s_cselect_b32 s64, s64, 0
    s_add_u32 s62, s62, s64
    s_max_u32 s64, s70, 32
    s_sub_u32 s64, s64, 32
    s_cmp_gt_u32 s61, 5
    s_cselect_b32 s64, s64, 0
    s_add_u32 s62, s62, s64
    s_max_u32 s64, s71, 32
    s_sub_u32 s64, s64, 32
    s_cmp_gt_u32 s61, 6
    s_cselect_b32 s64, s64, 0
    s_add_u32 s62, s62, s64
    s_min_u32 s64, s65, 32
    s_sub_u32 s63, 32, s64
    s_cmp_lt_u32 s62, s63
    s_cbranch_scc0 layerb1_kernel_tk_n0
    s_mov_b32 s61, 0
    s_add_u32 s62, s62, s64
    s_branch layerb1_kernel_tk_pub
layerb1_kernel_tk_n0:
    s_sub_u32 s62, s62, s63
    s_min_u32 s64, s66, 32
    s_sub_u32 s63, 32, s64
    s_cmp_lt_u32 s62, s63
    s_cbranch_scc0 layerb1_kernel_tk_n1
    s_mov_b32 s61, 1
    s_add_u32 s62, s62, s64
    s_branch layerb1_kernel_tk_pub
layerb1_kernel_tk_n1:
    s_sub_u32 s62, s62, s63
    s_min_u32 s64, s67, 32
    s_sub_u32 s63, 32, s64
    s_cmp_lt_u32 s62, s63
    s_cbranch_scc0 layerb1_kernel_tk_n2
    s_mov_b32 s61, 2
    s_add_u32 s62, s62, s64
    s_branch layerb1_kernel_tk_pub
layerb1_kernel_tk_n2:
    s_sub_u32 s62, s62, s63
    s_min_u32 s64, s68, 32
    s_sub_u32 s63, 32, s64
    s_cmp_lt_u32 s62, s63
    s_cbranch_scc0 layerb1_kernel_tk_n3
    s_mov_b32 s61, 3
    s_add_u32 s62, s62, s64
    s_branch layerb1_kernel_tk_pub
layerb1_kernel_tk_n3:
    s_sub_u32 s62, s62, s63
    s_min_u32 s64, s69, 32
    s_sub_u32 s63, 32, s64
    s_cmp_lt_u32 s62, s63
    s_cbranch_scc0 layerb1_kernel_tk_n4
    s_mov_b32 s61, 4
    s_add_u32 s62, s62, s64
    s_branch layerb1_kernel_tk_pub
layerb1_kernel_tk_n4:
    s_sub_u32 s62, s62, s63
    s_min_u32 s64, s70, 32
    s_sub_u32 s63, 32, s64
    s_cmp_lt_u32 s62, s63
    s_cbranch_scc0 layerb1_kernel_tk_n5
    s_mov_b32 s61, 5
    s_add_u32 s62, s62, s64
    s_branch layerb1_kernel_tk_pub
layerb1_kernel_tk_n5:
    s_sub_u32 s62, s62, s63
    s_min_u32 s64, s71, 32
    s_sub_u32 s63, 32, s64
    s_cmp_lt_u32 s62, s63
    s_cbranch_scc0 layerb1_kernel_tk_n6
    s_mov_b32 s61, 6
    s_add_u32 s62, s62, s64
    s_branch layerb1_kernel_tk_pub
layerb1_kernel_tk_n6:
    s_sub_u32 s62, s62, s63
    s_min_u32 s64, s72, 32
    s_sub_u32 s63, 32, s64
    s_cmp_lt_u32 s62, s63
    s_cbranch_scc0 layerb1_kernel_tk_n7
    s_mov_b32 s61, 7
    s_add_u32 s62, s62, s64
    s_branch layerb1_kernel_tk_pub
layerb1_kernel_tk_n7:
    s_sub_u32 s62, s62, s63
    s_branch layerb1_kernel_bail
layerb1_kernel_tk_pub:
    s_lshl_b32 s63, s61, 8
    s_or_b32 s63, s63, s62
    v_mov_b32 v230, 131136
    v_mov_b32 v231, s63
    ds_write_b32 v230, v231
    s_waitcnt lgkmcnt(0)
layerb1_kernel_tk_wait:
    s_barrier
    v_mov_b32 v230, 131136
    ds_read_b32 v231, v230
    s_waitcnt lgkmcnt(0)
    v_readfirstlane_b32 s63, v231
    s_lshr_b32 s61, s63, 8
    s_and_b32 s62, s63, 255
    s_mov_b32 s98, s61
    s_mov_b32 s99, s62
    v_lshlrev_b32 v240, 4, v0
    v_mov_b32 v241, v240
    s_mov_b32 s50, 0x3020100
    s_mov_b32 s51, 0x7060504
    s_mov_b32 s52, 0xb0a0908
    s_mov_b32 s53, 0xf0e0d0c
    s_mov_b32 s54, 0x13121110
    s_mov_b32 s55, 0x17161514
    s_mov_b32 s56, 0x1b1a1918
    s_mov_b32 s57, 0x1f1e1d1c
    s_mov_b32 s40, 2048
    s_mov_b32 s44, 0
    s_cmp_eq_u32 s98, 0
    s_cbranch_scc1 layerb1_kernel_pf_p
    s_cmp_ge_u32 s98, 4
    s_cbranch_scc1 layerb1_kernel_pf_g
    s_sub_u32 s60, s98, 1
    s_cmp_ge_u32 s99, 27
    s_cbranch_scc1 layerb1_kernel_pf_sp
    s_mul_i32 s61, s60, 27
    s_add_u32 s61, s61, s99
    s_cmp_ge_u32 s61, 80
    s_cbranch_scc1 layerb1_kernel_pf_no
    s_mul_i32 s61, s61, 327680
    s_mul_i32 s62, s13, 81920
    s_add_u32 s61, s61, s62
    s_add_u32 s58, s61, 27262976
    s_add_u32 s59, s58, 1024
    s_branch layerb1_kernel_pf_done
layerb1_kernel_pf_sp:
    s_mul_i32 s61, s60, 5
    s_add_u32 s61, s61, s99
    s_sub_u32 s61, s61, 27
    s_cmp_lt_u32 s61, 5
    s_cbranch_scc0 layerb1_kernel_pf_no
    s_mov_b32 s44, 1
    s_lshl_b32 s61, s61, 2
    s_add_u32 s61, s61, s13
    s_mul_i32 s61, s61, 40960
    s_add_u32 s58, s61, 246415360
    s_add_u32 s59, s58, 1024
    s_branch layerb1_kernel_pf_done
layerb1_kernel_pf_no:
    s_mov_b32 s44, 2
    s_mov_b32 s58, 27262976
    s_mov_b32 s59, 27262976
    s_mov_b32 s40, 0
    s_branch layerb1_kernel_pf_done
layerb1_kernel_pf_p:
    s_mul_i32 s61, s99, 491520
    s_mul_i32 s62, s13, 122880
    s_add_u32 s61, s61, s62
    s_add_u32 s58, s61, 11534336
    s_add_u32 s59, s58, 1024
    s_cmp_lg_u32 s13, 0
    s_cbranch_scc1 layerb1_kernel_pf_pw0
    s_mov_b32 s50, 0xb140a00
    s_mov_b32 s51, 0x1e160215
    s_mov_b32 s52, 0x605041f
    s_mov_b32 s53, 0xf0d0908
    s_mov_b32 s54, 0x17131110
    s_mov_b32 s55, 0x1c1b1a18
    s_mov_b32 s56, 0x25232221
    s_mov_b32 s57, 0x2c2b2726
    s_branch layerb1_kernel_pf_done
layerb1_kernel_pf_pw0:
    s_cmp_lg_u32 s13, 1
    s_cbranch_scc1 layerb1_kernel_pf_pw1
    s_mov_b32 s50, 0xe170d03
    s_mov_b32 s51, 0x21190518
    s_mov_b32 s52, 0x6020122
    s_mov_b32 s53, 0xc0a0908
    s_mov_b32 s54, 0x14131110
    s_mov_b32 s55, 0x1c1b1a15
    s_mov_b32 s56, 0x25201f1e
    s_mov_b32 s57, 0x29282726
    s_branch layerb1_kernel_pf_done
layerb1_kernel_pf_pw1:
    s_cmp_lg_u32 s13, 2
    s_cbranch_scc1 layerb1_kernel_pf_pw2
    s_mov_b32 s50, 0x111a1006
    s_mov_b32 s51, 0x2f2e241b
    s_mov_b32 s52, 0x3020138
    s_mov_b32 s53, 0xb090805
    s_mov_b32 s54, 0x120f0d0c
    s_mov_b32 s55, 0x17161513
    s_mov_b32 s56, 0x1f1d1c19
    s_mov_b32 s57, 0x26232120
    s_branch layerb1_kernel_pf_done
layerb1_kernel_pf_pw2:
    s_mov_b32 s50, 0x131c1208
    s_mov_b32 s51, 0x3130261d
    s_mov_b32 s52, 0x302013a
    s_mov_b32 s53, 0xb070605
    s_mov_b32 s54, 0x100f0d0c
    s_mov_b32 s55, 0x17161511
    s_mov_b32 s56, 0x1f1b1a19
    s_mov_b32 s57, 0x24232120
    s_branch layerb1_kernel_pf_done
layerb1_kernel_pf_g:
    s_sub_u32 s60, s98, 4
    s_lshl_b32 s60, s60, 5
    s_add_u32 s60, s60, s99
    s_mov_b32 s40, 512
    v_and_b32 v230, 31, v0
    v_lshrrev_b32 v231, 5, v0
    s_cmp_ge_u32 s60, 80
    s_cbranch_scc1 layerb1_kernel_pf_qk
    v_lshrrev_b32 v232, 3, v230
    v_and_b32 v233, 7, v230
    v_mul_u32_u24 v234, 20480, v232
    v_lshl_add_u32 v234, v233, 4, v234
    v_lshl_add_u32 v240, v231, 8, v234
    s_mul_i32 s61, s60, 327680
    s_mul_i32 s62, s13, 81920
    s_add_u32 s61, s61, s62
    s_add_u32 s58, s61, 27262976
    v_mov_b32 v241, v240
    s_add_u32 s59, s58, 128
    s_branch layerb1_kernel_pf_done
layerb1_kernel_pf_qk:
    s_sub_u32 s61, s60, 80
    s_cmp_ge_u32 s61, 24
    s_cselect_b32 s62, 1, 0
    s_cselect_b32 s63, 24, 0
    s_sub_u32 s61, s61, s63
    s_lshl_b32 s61, s61, 3
    s_lshl_b32 s63, s13, 1
    s_add_u32 s61, s61, s63
    s_add_u32 s63, s61, 0
    s_mul_i32 s64, s63, 171
    s_lshr_b32 s64, s64, 10
    s_mul_i32 s65, s64, 6
    s_sub_u32 s65, s63, s65
    s_lshl_b32 s65, s65, 5
    v_add_u32 v232, s65, v230
    v_and_b32 v233, 0xc1, v232
    v_and_b32 v234, 8, v232
    v_lshl_or_b32 v233, v234, 2, v233
    v_and_b32 v234, 32, v232
    v_lshrrev_b32 v234, 1, v234
    v_or_b32 v233, v233, v234
    v_and_b32 v234, 2, v232
    v_lshl_or_b32 v233, v234, 2, v233
    v_and_b32 v234, 16, v232
    v_lshrrev_b32 v234, 2, v234
    v_or_b32 v233, v233, v234
    v_and_b32 v234, 4, v232
    v_lshrrev_b32 v234, 1, v234
    v_or_b32 v233, v233, v234
    s_cmp_eq_u32 s62, 1
    s_cselect_b64 vcc, -1, 0
    s_nop 1
    v_cndmask_b32 v232, v232, v233, vcc
    v_lshrrev_b32 v234, 4, v232
    v_and_b32 v235, 3, v234
    v_mul_u32_u24 v235, 6, v235
    v_lshrrev_b32 v234, 2, v234
    v_add_u32 v234, v234, v235
    v_mul_u32_u24 v234, 20480, v234
    v_and_b32 v235, 15, v232
    v_lshl_add_u32 v233, v235, 4, v234
    v_lshl_add_u32 v240, v231, 8, v233
    s_xor_b32 s65, s62, 1
    s_mul_i32 s65, s65, 61440
    s_mul_i32 s66, s64, 491520
    s_add_u32 s65, s65, s66
    s_add_u32 s58, s65, 11534336
    s_add_u32 s63, s61, 1
    s_mul_i32 s64, s63, 171
    s_lshr_b32 s64, s64, 10
    s_mul_i32 s65, s64, 6
    s_sub_u32 s65, s63, s65
    s_lshl_b32 s65, s65, 5
    v_add_u32 v232, s65, v230
    v_and_b32 v233, 0xc1, v232
    v_and_b32 v234, 8, v232
    v_lshl_or_b32 v233, v234, 2, v233
    v_and_b32 v234, 32, v232
    v_lshrrev_b32 v234, 1, v234
    v_or_b32 v233, v233, v234
    v_and_b32 v234, 2, v232
    v_lshl_or_b32 v233, v234, 2, v233
    v_and_b32 v234, 16, v232
    v_lshrrev_b32 v234, 2, v234
    v_or_b32 v233, v233, v234
    v_and_b32 v234, 4, v232
    v_lshrrev_b32 v234, 1, v234
    v_or_b32 v233, v233, v234
    s_cmp_eq_u32 s62, 1
    s_cselect_b64 vcc, -1, 0
    s_nop 1
    v_cndmask_b32 v232, v232, v233, vcc
    v_lshrrev_b32 v234, 4, v232
    v_and_b32 v235, 3, v234
    v_mul_u32_u24 v235, 6, v235
    v_lshrrev_b32 v234, 2, v234
    v_add_u32 v234, v234, v235
    v_mul_u32_u24 v234, 20480, v234
    v_and_b32 v235, 15, v232
    v_lshl_add_u32 v233, v235, 4, v234
    v_lshl_add_u32 v241, v231, 8, v233
    s_xor_b32 s65, s62, 1
    s_mul_i32 s65, s65, 61440
    s_mul_i32 s66, s64, 491520
    s_add_u32 s65, s65, s66
    s_add_u32 s59, s65, 11534336
layerb1_kernel_pf_done:
    v_and_b32 v16, 31, v0
    v_lshrrev_b32 v17, 5, v0
    v_lshrrev_b32 v18, 1, v16
    v_and_b32 v18, 7, v18
    v_xor_b32 v18, v18, v17
    v_lshlrev_b32 v18, 4, v18
    v_lshl_add_u32 v18, v16, 7, v18
    s_lshl_b32 s28, s22, 13
    v_add_u32 v18, s28, v18
    v_xor_b32 v6, 0, v18
    v_add_u32 v10, 65536, v6
    v_xor_b32 v7, 32, v18
    v_add_u32 v11, 65536, v7
    v_xor_b32 v8, 64, v18
    v_add_u32 v12, 65536, v8
    v_xor_b32 v9, 96, v18
    v_add_u32 v13, 65536, v9
    s_lshl_b32 s28, s23, 13
    s_add_u32 s28, s28, 16384
    v_add_u32 v4, s28, v1
    v_add_u32 v5, 65536, v4
    v_mov_b32 v20, 0
    v_mov_b32 v21, 0
    v_mov_b32 v22, 0
    v_mov_b32 v23, 0
    s_waitcnt vmcnt(16)
    s_barrier
    ds_read_b128 v[32:35], v6 offset:0
    ds_read_b128 v[36:39], v6 offset:4096
    ds_read_b128 v[40:43], v4 offset:0
    ds_read_b128 v[44:47], v4 offset:1024
    s_cmp_eq_u32 s23, 1
    s_cbranch_scc1 layerb1_kernel_af_h1
    s_waitcnt lgkmcnt(0)
    v_mfma_f32_32x32x16_bf16 v[64:79], v[32:35], v[40:43], 0
    v_mfma_f32_4x4x4_16b_bf16 v[20:23], v[32:33], v[32:33], v[20:23]
    v_mfma_f32_32x32x16_bf16 v[96:111], v[32:35], v[44:47], 0
    ds_read_b128 v[48:51], v7 offset:0
    v_mfma_f32_32x32x16_bf16 v[128:143], v[44:47], v[32:35], 0
    ds_read_b128 v[52:55], v7 offset:4096
    v_mfma_f32_32x32x16_bf16 v[80:95], v[36:39], v[40:43], 0
    ds_read_b128 v[56:59], v4 offset:2048
    v_mfma_f32_32x32x16_bf16 v[112:127], v[36:39], v[44:47], 0
    v_mfma_f32_4x4x4_16b_bf16 v[20:23], v[34:35], v[34:35], v[20:23]
    ds_read_b128 v[60:63], v4 offset:3072
    v_mfma_f32_32x32x16_bf16 v[144:159], v[44:47], v[36:39], 0
    s_waitcnt lgkmcnt(0)
    v_mfma_f32_32x32x16_bf16 v[64:79], v[48:51], v[56:59], v[64:79]
    v_mfma_f32_4x4x4_16b_bf16 v[20:23], v[48:49], v[48:49], v[20:23]
    v_mfma_f32_32x32x16_bf16 v[96:111], v[48:51], v[60:63], v[96:111]
    ds_read_b128 v[32:35], v8 offset:0
    v_mfma_f32_32x32x16_bf16 v[128:143], v[60:63], v[48:51], v[128:143]
    ds_read_b128 v[36:39], v8 offset:4096
    v_mfma_f32_32x32x16_bf16 v[80:95], v[52:55], v[56:59], v[80:95]
    ds_read_b128 v[40:43], v4 offset:4096
    v_mfma_f32_32x32x16_bf16 v[112:127], v[52:55], v[60:63], v[112:127]
    v_mfma_f32_4x4x4_16b_bf16 v[20:23], v[50:51], v[50:51], v[20:23]
    ds_read_b128 v[44:47], v4 offset:5120
    v_mfma_f32_32x32x16_bf16 v[144:159], v[60:63], v[52:55], v[144:159]
    s_waitcnt lgkmcnt(0)
    v_mfma_f32_32x32x16_bf16 v[64:79], v[32:35], v[40:43], v[64:79]
    v_mfma_f32_4x4x4_16b_bf16 v[20:23], v[32:33], v[32:33], v[20:23]
    v_mfma_f32_32x32x16_bf16 v[96:111], v[32:35], v[44:47], v[96:111]
    ds_read_b128 v[48:51], v9 offset:0
    v_mfma_f32_32x32x16_bf16 v[128:143], v[44:47], v[32:35], v[128:143]
    ds_read_b128 v[52:55], v9 offset:4096
    v_mfma_f32_32x32x16_bf16 v[80:95], v[36:39], v[40:43], v[80:95]
    ds_read_b128 v[56:59], v4 offset:6144
    v_mfma_f32_32x32x16_bf16 v[112:127], v[36:39], v[44:47], v[112:127]
    v_mfma_f32_4x4x4_16b_bf16 v[20:23], v[34:35], v[34:35], v[20:23]
    ds_read_b128 v[60:63], v4 offset:7168
    v_mfma_f32_32x32x16_bf16 v[144:159], v[44:47], v[36:39], v[144:159]
    s_waitcnt vmcnt(8)
    s_barrier
    s_waitcnt lgkmcnt(0)
    v_mfma_f32_32x32x16_bf16 v[64:79], v[48:51], v[56:59], v[64:79]
    v_mfma_f32_4x4x4_16b_bf16 v[20:23], v[48:49], v[48:49], v[20:23]
    s_lshl_b32 s28, s13, 12
    s_add_u32 s28, s28, 98304
    s_mov_b32 m0, s28
    s_add_u32 s29, s24, 384
    buffer_load_dwordx4 v2, s[16:19], s29 offen offset:0 lds
    v_mfma_f32_32x32x16_bf16 v[96:111], v[48:51], v[60:63], v[96:111]
    ds_read_b128 v[32:35], v6 offset:32768
    s_add_u32 s29, s29, 9216
    buffer_load_dwordx4 v3, s[16:19], s29 offen offset:1024 lds
    v_mfma_f32_32x32x16_bf16 v[128:143], v[60:63], v[48:51], v[128:143]
    ds_read_b128 v[36:39], v6 offset:36864
    s_add_u32 s29, s29, 9216
    buffer_load_dwordx4 v2, s[16:19], s29 offen offset:2048 lds
    v_mfma_f32_32x32x16_bf16 v[80:95], v[52:55], v[56:59], v[80:95]
    ds_read_b128 v[40:43], v4 offset:32768
    s_add_u32 s29, s29, 9216
    buffer_load_dwordx4 v3, s[16:19], s29 offen offset:3072 lds
    v_mfma_f32_32x32x16_bf16 v[112:127], v[52:55], v[60:63], v[112:127]
    v_mfma_f32_4x4x4_16b_bf16 v[20:23], v[50:51], v[50:51], v[20:23]
    ds_read_b128 v[44:47], v4 offset:33792
    s_add_u32 s28, s28, 16384
    s_mov_b32 m0, s28
    s_add_u32 s29, s25, 24576
    buffer_load_dwordx4 v1, s[8:11], s29 offen offset:0 lds
    v_mfma_f32_32x32x16_bf16 v[144:159], v[60:63], v[52:55], v[144:159]
    buffer_load_dwordx4 v1, s[8:11], s29 offen offset:1024 lds
    s_waitcnt lgkmcnt(0)
    v_mfma_f32_32x32x16_bf16 v[64:79], v[32:35], v[40:43], v[64:79]
    v_mfma_f32_4x4x4_16b_bf16 v[20:23], v[32:33], v[32:33], v[20:23]
    buffer_load_dwordx4 v1, s[8:11], s29 offen offset:2048 lds
    v_mfma_f32_32x32x16_bf16 v[96:111], v[32:35], v[44:47], v[96:111]
    ds_read_b128 v[48:51], v7 offset:32768
    buffer_load_dwordx4 v1, s[8:11], s29 offen offset:3072 lds
    v_mfma_f32_32x32x16_bf16 v[128:143], v[44:47], v[32:35], v[128:143]
    ds_read_b128 v[52:55], v7 offset:36864
    s_bfe_u32 s41, s50, 524288
    s_mul_i32 s41, s41, s40
    s_add_u32 s42, s58, s41
    s_add_u32 s43, s59, s41
    buffer_load_dwordx4 a[0:3], v240, s[8:11], s42 offen
    v_mfma_f32_32x32x16_bf16 v[80:95], v[36:39], v[40:43], v[80:95]
    ds_read_b128 v[56:59], v4 offset:34816
    buffer_load_dwordx4 a[4:7], v241, s[8:11], s43 offen
    v_mfma_f32_32x32x16_bf16 v[112:127], v[36:39], v[44:47], v[112:127]
    v_mfma_f32_4x4x4_16b_bf16 v[20:23], v[34:35], v[34:35], v[20:23]
    ds_read_b128 v[60:63], v4 offset:35840
    s_bfe_u32 s41, s50, 524296
    s_mul_i32 s41, s41, s40
    s_add_u32 s42, s58, s41
    s_add_u32 s43, s59, s41
    buffer_load_dwordx4 a[8:11], v240, s[8:11], s42 offen
    v_mfma_f32_32x32x16_bf16 v[144:159], v[44:47], v[36:39], v[144:159]
    buffer_load_dwordx4 a[12:15], v241, s[8:11], s43 offen
    s_waitcnt lgkmcnt(0)
    v_mfma_f32_32x32x16_bf16 v[64:79], v[48:51], v[56:59], v[64:79]
    v_mfma_f32_4x4x4_16b_bf16 v[20:23], v[48:49], v[48:49], v[20:23]
    v_mfma_f32_32x32x16_bf16 v[96:111], v[48:51], v[60:63], v[96:111]
    ds_read_b128 v[32:35], v8 offset:32768
    v_mfma_f32_32x32x16_bf16 v[128:143], v[60:63], v[48:51], v[128:143]
    ds_read_b128 v[36:39], v8 offset:36864
    v_mfma_f32_32x32x16_bf16 v[80:95], v[52:55], v[56:59], v[80:95]
    ds_read_b128 v[40:43], v4 offset:36864
    v_mfma_f32_32x32x16_bf16 v[112:127], v[52:55], v[60:63], v[112:127]
    v_mfma_f32_4x4x4_16b_bf16 v[20:23], v[50:51], v[50:51], v[20:23]
    ds_read_b128 v[44:47], v4 offset:37888
    v_mfma_f32_32x32x16_bf16 v[144:159], v[60:63], v[52:55], v[144:159]
    s_waitcnt lgkmcnt(0)
    v_mfma_f32_32x32x16_bf16 v[64:79], v[32:35], v[40:43], v[64:79]
    v_mfma_f32_4x4x4_16b_bf16 v[20:23], v[32:33], v[32:33], v[20:23]
    v_mfma_f32_32x32x16_bf16 v[96:111], v[32:35], v[44:47], v[96:111]
    ds_read_b128 v[48:51], v9 offset:32768
    v_mfma_f32_32x32x16_bf16 v[128:143], v[44:47], v[32:35], v[128:143]
    ds_read_b128 v[52:55], v9 offset:36864
    v_mfma_f32_32x32x16_bf16 v[80:95], v[36:39], v[40:43], v[80:95]
    ds_read_b128 v[56:59], v4 offset:38912
    v_mfma_f32_32x32x16_bf16 v[112:127], v[36:39], v[44:47], v[112:127]
    v_mfma_f32_4x4x4_16b_bf16 v[20:23], v[34:35], v[34:35], v[20:23]
    ds_read_b128 v[60:63], v4 offset:39936
    v_mfma_f32_32x32x16_bf16 v[144:159], v[44:47], v[36:39], v[144:159]
    s_waitcnt vmcnt(12)
    s_barrier
    s_waitcnt lgkmcnt(0)
    v_mfma_f32_32x32x16_bf16 v[64:79], v[48:51], v[56:59], v[64:79]
    v_mfma_f32_4x4x4_16b_bf16 v[20:23], v[48:49], v[48:49], v[20:23]
    s_lshl_b32 s28, s13, 12
    s_mov_b32 m0, s28
    s_add_u32 s29, s24, 512
    buffer_load_dwordx4 v2, s[16:19], s29 offen offset:0 lds
    v_mfma_f32_32x32x16_bf16 v[96:111], v[48:51], v[60:63], v[96:111]
    ds_read_b128 v[32:35], v10 offset:0
    s_add_u32 s29, s29, 9216
    buffer_load_dwordx4 v3, s[16:19], s29 offen offset:1024 lds
    v_mfma_f32_32x32x16_bf16 v[128:143], v[60:63], v[48:51], v[128:143]
    ds_read_b128 v[36:39], v10 offset:4096
    s_add_u32 s29, s29, 9216
    buffer_load_dwordx4 v2, s[16:19], s29 offen offset:2048 lds
    v_mfma_f32_32x32x16_bf16 v[80:95], v[52:55], v[56:59], v[80:95]
    ds_read_b128 v[40:43], v5 offset:0
    s_add_u32 s29, s29, 9216
    buffer_load_dwordx4 v3, s[16:19], s29 offen offset:3072 lds
    v_mfma_f32_32x32x16_bf16 v[112:127], v[52:55], v[60:63], v[112:127]
    v_mfma_f32_4x4x4_16b_bf16 v[20:23], v[50:51], v[50:51], v[20:23]
    ds_read_b128 v[44:47], v5 offset:1024
    s_add_u32 s28, s28, 16384
    s_mov_b32 m0, s28
    s_add_u32 s29, s25, 32768
    buffer_load_dwordx4 v1, s[8:11], s29 offen offset:0 lds
    v_mfma_f32_32x32x16_bf16 v[144:159], v[60:63], v[52:55], v[144:159]
    buffer_load_dwordx4 v1, s[8:11], s29 offen offset:1024 lds
    s_waitcnt lgkmcnt(0)
    v_mfma_f32_32x32x16_bf16 v[64:79], v[32:35], v[40:43], v[64:79]
    v_mfma_f32_4x4x4_16b_bf16 v[20:23], v[32:33], v[32:33], v[20:23]
    buffer_load_dwordx4 v1, s[8:11], s29 offen offset:2048 lds
    v_mfma_f32_32x32x16_bf16 v[96:111], v[32:35], v[44:47], v[96:111]
    ds_read_b128 v[48:51], v11 offset:0
    buffer_load_dwordx4 v1, s[8:11], s29 offen offset:3072 lds
    v_mfma_f32_32x32x16_bf16 v[128:143], v[44:47], v[32:35], v[128:143]
    ds_read_b128 v[52:55], v11 offset:4096
    s_bfe_u32 s41, s50, 524304
    s_mul_i32 s41, s41, s40
    s_add_u32 s42, s58, s41
    s_add_u32 s43, s59, s41
    buffer_load_dwordx4 a[16:19], v240, s[8:11], s42 offen
    v_mfma_f32_32x32x16_bf16 v[80:95], v[36:39], v[40:43], v[80:95]
    ds_read_b128 v[56:59], v5 offset:2048
    buffer_load_dwordx4 a[20:23], v241, s[8:11], s43 offen
    v_mfma_f32_32x32x16_bf16 v[112:127], v[36:39], v[44:47], v[112:127]
    v_mfma_f32_4x4x4_16b_bf16 v[20:23], v[34:35], v[34:35], v[20:23]
    ds_read_b128 v[60:63], v5 offset:3072
    s_bfe_u32 s41, s50, 524312
    s_mul_i32 s41, s41, s40
    s_add_u32 s42, s58, s41
    s_add_u32 s43, s59, s41
    buffer_load_dwordx4 a[24:27], v240, s[8:11], s42 offen
    v_mfma_f32_32x32x16_bf16 v[144:159], v[44:47], v[36:39], v[144:159]
    buffer_load_dwordx4 a[28:31], v241, s[8:11], s43 offen
    s_waitcnt lgkmcnt(0)
    v_mfma_f32_32x32x16_bf16 v[64:79], v[48:51], v[56:59], v[64:79]
    v_mfma_f32_4x4x4_16b_bf16 v[20:23], v[48:49], v[48:49], v[20:23]
    v_mfma_f32_32x32x16_bf16 v[96:111], v[48:51], v[60:63], v[96:111]
    ds_read_b128 v[32:35], v12 offset:0
    v_mfma_f32_32x32x16_bf16 v[128:143], v[60:63], v[48:51], v[128:143]
    ds_read_b128 v[36:39], v12 offset:4096
    v_mfma_f32_32x32x16_bf16 v[80:95], v[52:55], v[56:59], v[80:95]
    ds_read_b128 v[40:43], v5 offset:4096
    v_mfma_f32_32x32x16_bf16 v[112:127], v[52:55], v[60:63], v[112:127]
    v_mfma_f32_4x4x4_16b_bf16 v[20:23], v[50:51], v[50:51], v[20:23]
    ds_read_b128 v[44:47], v5 offset:5120
    v_mfma_f32_32x32x16_bf16 v[144:159], v[60:63], v[52:55], v[144:159]
    s_waitcnt lgkmcnt(0)
    v_mfma_f32_32x32x16_bf16 v[64:79], v[32:35], v[40:43], v[64:79]
    v_mfma_f32_4x4x4_16b_bf16 v[20:23], v[32:33], v[32:33], v[20:23]
    v_mfma_f32_32x32x16_bf16 v[96:111], v[32:35], v[44:47], v[96:111]
    ds_read_b128 v[48:51], v13 offset:0
    v_mfma_f32_32x32x16_bf16 v[128:143], v[44:47], v[32:35], v[128:143]
    ds_read_b128 v[52:55], v13 offset:4096
    v_mfma_f32_32x32x16_bf16 v[80:95], v[36:39], v[40:43], v[80:95]
    ds_read_b128 v[56:59], v5 offset:6144
    v_mfma_f32_32x32x16_bf16 v[112:127], v[36:39], v[44:47], v[112:127]
    v_mfma_f32_4x4x4_16b_bf16 v[20:23], v[34:35], v[34:35], v[20:23]
    ds_read_b128 v[60:63], v5 offset:7168
    v_mfma_f32_32x32x16_bf16 v[144:159], v[44:47], v[36:39], v[144:159]
    s_waitcnt vmcnt(16)
    s_barrier
    s_waitcnt lgkmcnt(0)
    v_mfma_f32_32x32x16_bf16 v[64:79], v[48:51], v[56:59], v[64:79]
    v_mfma_f32_4x4x4_16b_bf16 v[20:23], v[48:49], v[48:49], v[20:23]
    s_lshl_b32 s28, s13, 12
    s_add_u32 s28, s28, 32768
    s_mov_b32 m0, s28
    s_add_u32 s29, s24, 640
    buffer_load_dwordx4 v2, s[16:19], s29 offen offset:0 lds
    v_mfma_f32_32x32x16_bf16 v[96:111], v[48:51], v[60:63], v[96:111]
    ds_read_b128 v[32:35], v10 offset:32768
    s_add_u32 s29, s29, 9216
    buffer_load_dwordx4 v3, s[16:19], s29 offen offset:1024 lds
    v_mfma_f32_32x32x16_bf16 v[128:143], v[60:63], v[48:51], v[128:143]
    ds_read_b128 v[36:39], v10 offset:36864
    s_add_u32 s29, s29, 9216
    buffer_load_dwordx4 v2, s[16:19], s29 offen offset:2048 lds
    v_mfma_f32_32x32x16_bf16 v[80:95], v[52:55], v[56:59], v[80:95]
    ds_read_b128 v[40:43], v5 offset:32768
    s_add_u32 s29, s29, 9216
    buffer_load_dwordx4 v3, s[16:19], s29 offen offset:3072 lds
    v_mfma_f32_32x32x16_bf16 v[112:127], v[52:55], v[60:63], v[112:127]
    v_mfma_f32_4x4x4_16b_bf16 v[20:23], v[50:51], v[50:51], v[20:23]
    ds_read_b128 v[44:47], v5 offset:33792
    s_add_u32 s28, s28, 16384
    s_mov_b32 m0, s28
    s_add_u32 s29, s25, 40960
    buffer_load_dwordx4 v1, s[8:11], s29 offen offset:0 lds
    v_mfma_f32_32x32x16_bf16 v[144:159], v[60:63], v[52:55], v[144:159]
    buffer_load_dwordx4 v1, s[8:11], s29 offen offset:1024 lds
    s_waitcnt lgkmcnt(0)
    v_mfma_f32_32x32x16_bf16 v[64:79], v[32:35], v[40:43], v[64:79]
    v_mfma_f32_4x4x4_16b_bf16 v[20:23], v[32:33], v[32:33], v[20:23]
    buffer_load_dwordx4 v1, s[8:11], s29 offen offset:2048 lds
    v_mfma_f32_32x32x16_bf16 v[96:111], v[32:35], v[44:47], v[96:111]
    ds_read_b128 v[48:51], v11 offset:32768
    buffer_load_dwordx4 v1, s[8:11], s29 offen offset:3072 lds
    v_mfma_f32_32x32x16_bf16 v[128:143], v[44:47], v[32:35], v[128:143]
    ds_read_b128 v[52:55], v11 offset:36864
    s_bfe_u32 s41, s51, 524288
    s_mul_i32 s41, s41, s40
    s_add_u32 s42, s58, s41
    s_add_u32 s43, s59, s41
    buffer_load_dwordx4 a[32:35], v240, s[8:11], s42 offen
    v_mfma_f32_32x32x16_bf16 v[80:95], v[36:39], v[40:43], v[80:95]
    ds_read_b128 v[56:59], v5 offset:34816
    buffer_load_dwordx4 a[36:39], v241, s[8:11], s43 offen
    v_mfma_f32_32x32x16_bf16 v[112:127], v[36:39], v[44:47], v[112:127]
    v_mfma_f32_4x4x4_16b_bf16 v[20:23], v[34:35], v[34:35], v[20:23]
    ds_read_b128 v[60:63], v5 offset:35840
    s_bfe_u32 s41, s51, 524296
    s_mul_i32 s41, s41, s40
    s_add_u32 s42, s58, s41
    s_add_u32 s43, s59, s41
    buffer_load_dwordx4 a[40:43], v240, s[8:11], s42 offen
    v_mfma_f32_32x32x16_bf16 v[144:159], v[44:47], v[36:39], v[144:159]
    buffer_load_dwordx4 a[44:47], v241, s[8:11], s43 offen
    s_waitcnt lgkmcnt(0)
    v_mfma_f32_32x32x16_bf16 v[64:79], v[48:51], v[56:59], v[64:79]
    v_mfma_f32_4x4x4_16b_bf16 v[20:23], v[48:49], v[48:49], v[20:23]
    v_mfma_f32_32x32x16_bf16 v[96:111], v[48:51], v[60:63], v[96:111]
    ds_read_b128 v[32:35], v12 offset:32768
    v_mfma_f32_32x32x16_bf16 v[128:143], v[60:63], v[48:51], v[128:143]
    ds_read_b128 v[36:39], v12 offset:36864
    v_mfma_f32_32x32x16_bf16 v[80:95], v[52:55], v[56:59], v[80:95]
    ds_read_b128 v[40:43], v5 offset:36864
    v_mfma_f32_32x32x16_bf16 v[112:127], v[52:55], v[60:63], v[112:127]
    v_mfma_f32_4x4x4_16b_bf16 v[20:23], v[50:51], v[50:51], v[20:23]
    ds_read_b128 v[44:47], v5 offset:37888
    v_mfma_f32_32x32x16_bf16 v[144:159], v[60:63], v[52:55], v[144:159]
    s_waitcnt lgkmcnt(0)
    v_mfma_f32_32x32x16_bf16 v[64:79], v[32:35], v[40:43], v[64:79]
    v_mfma_f32_4x4x4_16b_bf16 v[20:23], v[32:33], v[32:33], v[20:23]
    v_mfma_f32_32x32x16_bf16 v[96:111], v[32:35], v[44:47], v[96:111]
    ds_read_b128 v[48:51], v13 offset:32768
    v_mfma_f32_32x32x16_bf16 v[128:143], v[44:47], v[32:35], v[128:143]
    ds_read_b128 v[52:55], v13 offset:36864
    v_mfma_f32_32x32x16_bf16 v[80:95], v[36:39], v[40:43], v[80:95]
    ds_read_b128 v[56:59], v5 offset:38912
    v_mfma_f32_32x32x16_bf16 v[112:127], v[36:39], v[44:47], v[112:127]
    v_mfma_f32_4x4x4_16b_bf16 v[20:23], v[34:35], v[34:35], v[20:23]
    ds_read_b128 v[60:63], v5 offset:39936
    v_mfma_f32_32x32x16_bf16 v[144:159], v[44:47], v[36:39], v[144:159]
    s_waitcnt vmcnt(16)
    s_barrier
    s_waitcnt lgkmcnt(0)
    v_mfma_f32_32x32x16_bf16 v[64:79], v[48:51], v[56:59], v[64:79]
    v_mfma_f32_4x4x4_16b_bf16 v[20:23], v[48:49], v[48:49], v[20:23]
    s_lshl_b32 s28, s13, 12
    s_add_u32 s28, s28, 65536
    s_mov_b32 m0, s28
    s_add_u32 s29, s24, 768
    buffer_load_dwordx4 v2, s[16:19], s29 offen offset:0 lds
    v_mfma_f32_32x32x16_bf16 v[96:111], v[48:51], v[60:63], v[96:111]
    ds_read_b128 v[32:35], v6 offset:0
    s_add_u32 s29, s29, 9216
    buffer_load_dwordx4 v3, s[16:19], s29 offen offset:1024 lds
    v_mfma_f32_32x32x16_bf16 v[128:143], v[60:63], v[48:51], v[128:143]
    ds_read_b128 v[36:39], v6 offset:4096
    s_add_u32 s29, s29, 9216
    buffer_load_dwordx4 v2, s[16:19], s29 offen offset:2048 lds
    v_mfma_f32_32x32x16_bf16 v[80:95], v[52:55], v[56:59], v[80:95]
    ds_read_b128 v[40:43], v4 offset:0
    s_add_u32 s29, s29, 9216
    buffer_load_dwordx4 v3, s[16:19], s29 offen offset:3072 lds
    v_mfma_f32_32x32x16_bf16 v[112:127], v[52:55], v[60:63], v[112:127]
    v_mfma_f32_4x4x4_16b_bf16 v[20:23], v[50:51], v[50:51], v[20:23]
    ds_read_b128 v[44:47], v4 offset:1024
    s_add_u32 s28, s28, 16384
    s_mov_b32 m0, s28
    s_add_u32 s29, s25, 49152
    buffer_load_dwordx4 v1, s[8:11], s29 offen offset:0 lds
    v_mfma_f32_32x32x16_bf16 v[144:159], v[60:63], v[52:55], v[144:159]
    buffer_load_dwordx4 v1, s[8:11], s29 offen offset:1024 lds
    s_waitcnt lgkmcnt(0)
    v_mfma_f32_32x32x16_bf16 v[64:79], v[32:35], v[40:43], v[64:79]
    v_mfma_f32_4x4x4_16b_bf16 v[20:23], v[32:33], v[32:33], v[20:23]
    buffer_load_dwordx4 v1, s[8:11], s29 offen offset:2048 lds
    v_mfma_f32_32x32x16_bf16 v[96:111], v[32:35], v[44:47], v[96:111]
    ds_read_b128 v[48:51], v7 offset:0
    buffer_load_dwordx4 v1, s[8:11], s29 offen offset:3072 lds
    v_mfma_f32_32x32x16_bf16 v[128:143], v[44:47], v[32:35], v[128:143]
    ds_read_b128 v[52:55], v7 offset:4096
    s_bfe_u32 s41, s51, 524304
    s_mul_i32 s41, s41, s40
    s_add_u32 s42, s58, s41
    s_add_u32 s43, s59, s41
    buffer_load_dwordx4 a[48:51], v240, s[8:11], s42 offen
    v_mfma_f32_32x32x16_bf16 v[80:95], v[36:39], v[40:43], v[80:95]
    ds_read_b128 v[56:59], v4 offset:2048
    buffer_load_dwordx4 a[52:55], v241, s[8:11], s43 offen
    v_mfma_f32_32x32x16_bf16 v[112:127], v[36:39], v[44:47], v[112:127]
    v_mfma_f32_4x4x4_16b_bf16 v[20:23], v[34:35], v[34:35], v[20:23]
    ds_read_b128 v[60:63], v4 offset:3072
    s_bfe_u32 s41, s51, 524312
    s_mul_i32 s41, s41, s40
    s_add_u32 s42, s58, s41
    s_add_u32 s43, s59, s41
    buffer_load_dwordx4 a[56:59], v240, s[8:11], s42 offen
    v_mfma_f32_32x32x16_bf16 v[144:159], v[44:47], v[36:39], v[144:159]
    buffer_load_dwordx4 a[60:63], v241, s[8:11], s43 offen
    s_waitcnt lgkmcnt(0)
    v_mfma_f32_32x32x16_bf16 v[64:79], v[48:51], v[56:59], v[64:79]
    v_mfma_f32_4x4x4_16b_bf16 v[20:23], v[48:49], v[48:49], v[20:23]
    v_mfma_f32_32x32x16_bf16 v[96:111], v[48:51], v[60:63], v[96:111]
    ds_read_b128 v[32:35], v8 offset:0
    v_mfma_f32_32x32x16_bf16 v[128:143], v[60:63], v[48:51], v[128:143]
    ds_read_b128 v[36:39], v8 offset:4096
    v_mfma_f32_32x32x16_bf16 v[80:95], v[52:55], v[56:59], v[80:95]
    ds_read_b128 v[40:43], v4 offset:4096
    v_mfma_f32_32x32x16_bf16 v[112:127], v[52:55], v[60:63], v[112:127]
    v_mfma_f32_4x4x4_16b_bf16 v[20:23], v[50:51], v[50:51], v[20:23]
    ds_read_b128 v[44:47], v4 offset:5120
    v_mfma_f32_32x32x16_bf16 v[144:159], v[60:63], v[52:55], v[144:159]
    s_waitcnt lgkmcnt(0)
    v_mfma_f32_32x32x16_bf16 v[64:79], v[32:35], v[40:43], v[64:79]
    v_mfma_f32_4x4x4_16b_bf16 v[20:23], v[32:33], v[32:33], v[20:23]
    v_mfma_f32_32x32x16_bf16 v[96:111], v[32:35], v[44:47], v[96:111]
    ds_read_b128 v[48:51], v9 offset:0
    v_mfma_f32_32x32x16_bf16 v[128:143], v[44:47], v[32:35], v[128:143]
    ds_read_b128 v[52:55], v9 offset:4096
    v_mfma_f32_32x32x16_bf16 v[80:95], v[36:39], v[40:43], v[80:95]
    ds_read_b128 v[56:59], v4 offset:6144
    v_mfma_f32_32x32x16_bf16 v[112:127], v[36:39], v[44:47], v[112:127]
    v_mfma_f32_4x4x4_16b_bf16 v[20:23], v[34:35], v[34:35], v[20:23]
    ds_read_b128 v[60:63], v4 offset:7168
    v_mfma_f32_32x32x16_bf16 v[144:159], v[44:47], v[36:39], v[144:159]
    s_waitcnt vmcnt(16)
    s_barrier
    s_waitcnt lgkmcnt(0)
    v_mfma_f32_32x32x16_bf16 v[64:79], v[48:51], v[56:59], v[64:79]
    v_mfma_f32_4x4x4_16b_bf16 v[20:23], v[48:49], v[48:49], v[20:23]
    s_lshl_b32 s28, s13, 12
    s_add_u32 s28, s28, 98304
    s_mov_b32 m0, s28
    s_add_u32 s29, s24, 896
    buffer_load_dwordx4 v2, s[16:19], s29 offen offset:0 lds
    v_mfma_f32_32x32x16_bf16 v[96:111], v[48:51], v[60:63], v[96:111]
    ds_read_b128 v[32:35], v6 offset:32768
    s_add_u32 s29, s29, 9216
    buffer_load_dwordx4 v3, s[16:19], s29 offen offset:1024 lds
    v_mfma_f32_32x32x16_bf16 v[128:143], v[60:63], v[48:51], v[128:143]
    ds_read_b128 v[36:39], v6 offset:36864
    s_add_u32 s29, s29, 9216
    buffer_load_dwordx4 v2, s[16:19], s29 offen offset:2048 lds
    v_mfma_f32_32x32x16_bf16 v[80:95], v[52:55], v[56:59], v[80:95]
    ds_read_b128 v[40:43], v4 offset:32768
    s_add_u32 s29, s29, 9216
    buffer_load_dwordx4 v3, s[16:19], s29 offen offset:3072 lds
    v_mfma_f32_32x32x16_bf16 v[112:127], v[52:55], v[60:63], v[112:127]
    v_mfma_f32_4x4x4_16b_bf16 v[20:23], v[50:51], v[50:51], v[20:23]
    ds_read_b128 v[44:47], v4 offset:33792
    s_add_u32 s28, s28, 16384
    s_mov_b32 m0, s28
    s_add_u32 s29, s25, 57344
    buffer_load_dwordx4 v1, s[8:11], s29 offen offset:0 lds
    v_mfma_f32_32x32x16_bf16 v[144:159], v[60:63], v[52:55], v[144:159]
    buffer_load_dwordx4 v1, s[8:11], s29 offen offset:1024 lds
    s_waitcnt lgkmcnt(0)
    v_mfma_f32_32x32x16_bf16 v[64:79], v[32:35], v[40:43], v[64:79]
    v_mfma_f32_4x4x4_16b_bf16 v[20:23], v[32:33], v[32:33], v[20:23]
    buffer_load_dwordx4 v1, s[8:11], s29 offen offset:2048 lds
    v_mfma_f32_32x32x16_bf16 v[96:111], v[32:35], v[44:47], v[96:111]
    ds_read_b128 v[48:51], v7 offset:32768
    buffer_load_dwordx4 v1, s[8:11], s29 offen offset:3072 lds
    v_mfma_f32_32x32x16_bf16 v[128:143], v[44:47], v[32:35], v[128:143]
    ds_read_b128 v[52:55], v7 offset:36864
    s_bfe_u32 s41, s52, 524288
    s_mul_i32 s41, s41, s40
    s_add_u32 s42, s58, s41
    s_add_u32 s43, s59, s41
    buffer_load_dwordx4 a[64:67], v240, s[8:11], s42 offen
    v_mfma_f32_32x32x16_bf16 v[80:95], v[36:39], v[40:43], v[80:95]
    ds_read_b128 v[56:59], v4 offset:34816
    buffer_load_dwordx4 a[68:71], v241, s[8:11], s43 offen
    v_mfma_f32_32x32x16_bf16 v[112:127], v[36:39], v[44:47], v[112:127]
    v_mfma_f32_4x4x4_16b_bf16 v[20:23], v[34:35], v[34:35], v[20:23]
    ds_read_b128 v[60:63], v4 offset:35840
    s_bfe_u32 s41, s52, 524296
    s_mul_i32 s41, s41, s40
    s_add_u32 s42, s58, s41
    s_add_u32 s43, s59, s41
    buffer_load_dwordx4 a[72:75], v240, s[8:11], s42 offen
    v_mfma_f32_32x32x16_bf16 v[144:159], v[44:47], v[36:39], v[144:159]
    buffer_load_dwordx4 a[76:79], v241, s[8:11], s43 offen
    s_waitcnt lgkmcnt(0)
    v_mfma_f32_32x32x16_bf16 v[64:79], v[48:51], v[56:59], v[64:79]
    v_mfma_f32_4x4x4_16b_bf16 v[20:23], v[48:49], v[48:49], v[20:23]
    v_mfma_f32_32x32x16_bf16 v[96:111], v[48:51], v[60:63], v[96:111]
    ds_read_b128 v[32:35], v8 offset:32768
    v_mfma_f32_32x32x16_bf16 v[128:143], v[60:63], v[48:51], v[128:143]
    ds_read_b128 v[36:39], v8 offset:36864
    v_mfma_f32_32x32x16_bf16 v[80:95], v[52:55], v[56:59], v[80:95]
    ds_read_b128 v[40:43], v4 offset:36864
    v_mfma_f32_32x32x16_bf16 v[112:127], v[52:55], v[60:63], v[112:127]
    v_mfma_f32_4x4x4_16b_bf16 v[20:23], v[50:51], v[50:51], v[20:23]
    ds_read_b128 v[44:47], v4 offset:37888
    v_mfma_f32_32x32x16_bf16 v[144:159], v[60:63], v[52:55], v[144:159]
    s_waitcnt lgkmcnt(0)
    v_mfma_f32_32x32x16_bf16 v[64:79], v[32:35], v[40:43], v[64:79]
    v_mfma_f32_4x4x4_16b_bf16 v[20:23], v[32:33], v[32:33], v[20:23]
    v_mfma_f32_32x32x16_bf16 v[96:111], v[32:35], v[44:47], v[96:111]
    ds_read_b128 v[48:51], v9 offset:32768
    v_mfma_f32_32x32x16_bf16 v[128:143], v[44:47], v[32:35], v[128:143]
    ds_read_b128 v[52:55], v9 offset:36864
    v_mfma_f32_32x32x16_bf16 v[80:95], v[36:39], v[40:43], v[80:95]
    ds_read_b128 v[56:59], v4 offset:38912
    v_mfma_f32_32x32x16_bf16 v[112:127], v[36:39], v[44:47], v[112:127]
    v_mfma_f32_4x4x4_16b_bf16 v[20:23], v[34:35], v[34:35], v[20:23]
    ds_read_b128 v[60:63], v4 offset:39936
    v_mfma_f32_32x32x16_bf16 v[144:159], v[44:47], v[36:39], v[144:159]
    s_waitcnt vmcnt(16)
    s_barrier
    s_waitcnt lgkmcnt(0)
    v_mfma_f32_32x32x16_bf16 v[64:79], v[48:51], v[56:59], v[64:79]
    v_mfma_f32_4x4x4_16b_bf16 v[20:23], v[48:49], v[48:49], v[20:23]
    s_lshl_b32 s28, s13, 12
    s_mov_b32 m0, s28
    s_add_u32 s29, s24, 1024
    buffer_load_dwordx4 v2, s[16:19], s29 offen offset:0 lds
    v_mfma_f32_32x32x16_bf16 v[96:111], v[48:51], v[60:63], v[96:111]
    ds_read_b128 v[32:35], v10 offset:0
    s_add_u32 s29, s29, 9216
    buffer_load_dwordx4 v3, s[16:19], s29 offen offset:1024 lds
    v_mfma_f32_32x32x16_bf16 v[128:143], v[60:63], v[48:51], v[128:143]
    ds_read_b128 v[36:39], v10 offset:4096
    s_add_u32 s29, s29, 9216
    buffer_load_dwordx4 v2, s[16:19], s29 offen offset:2048 lds
    v_mfma_f32_32x32x16_bf16 v[80:95], v[52:55], v[56:59], v[80:95]
    ds_read_b128 v[40:43], v5 offset:0
    s_add_u32 s29, s29, 9216
    buffer_load_dwordx4 v3, s[16:19], s29 offen offset:3072 lds
    v_mfma_f32_32x32x16_bf16 v[112:127], v[52:55], v[60:63], v[112:127]
    v_mfma_f32_4x4x4_16b_bf16 v[20:23], v[50:51], v[50:51], v[20:23]
    ds_read_b128 v[44:47], v5 offset:1024
    s_add_u32 s28, s28, 16384
    s_mov_b32 m0, s28
    s_add_u32 s29, s25, 65536
    buffer_load_dwordx4 v1, s[8:11], s29 offen offset:0 lds
    v_mfma_f32_32x32x16_bf16 v[144:159], v[60:63], v[52:55], v[144:159]
    buffer_load_dwordx4 v1, s[8:11], s29 offen offset:1024 lds
    s_waitcnt lgkmcnt(0)
    v_mfma_f32_32x32x16_bf16 v[64:79], v[32:35], v[40:43], v[64:79]
    v_mfma_f32_4x4x4_16b_bf16 v[20:23], v[32:33], v[32:33], v[20:23]
    buffer_load_dwordx4 v1, s[8:11], s29 offen offset:2048 lds
    v_mfma_f32_32x32x16_bf16 v[96:111], v[32:35], v[44:47], v[96:111]
    ds_read_b128 v[48:51], v11 offset:0
    buffer_load_dwordx4 v1, s[8:11], s29 offen offset:3072 lds
    v_mfma_f32_32x32x16_bf16 v[128:143], v[44:47], v[32:35], v[128:143]
    ds_read_b128 v[52:55], v11 offset:4096
    s_bfe_u32 s41, s52, 524304
    s_mul_i32 s41, s41, s40
    s_add_u32 s42, s58, s41
    s_add_u32 s43, s59, s41
    buffer_load_dwordx4 a[80:83], v240, s[8:11], s42 offen
    v_mfma_f32_32x32x16_bf16 v[80:95], v[36:39], v[40:43], v[80:95]
    ds_read_b128 v[56:59], v5 offset:2048
    buffer_load_dwordx4 a[84:87], v241, s[8:11], s43 offen
    v_mfma_f32_32x32x16_bf16 v[112:127], v[36:39], v[44:47], v[112:127]
    v_mfma_f32_4x4x4_16b_bf16 v[20:23], v[34:35], v[34:35], v[20:23]
    ds_read_b128 v[60:63], v5 offset:3072
    s_bfe_u32 s41, s52, 524312
    s_mul_i32 s41, s41, s40
    s_add_u32 s42, s58, s41
    s_add_u32 s43, s59, s41
    buffer_load_dwordx4 a[88:91], v240, s[8:11], s42 offen
    v_mfma_f32_32x32x16_bf16 v[144:159], v[44:47], v[36:39], v[144:159]
    buffer_load_dwordx4 a[92:95], v241, s[8:11], s43 offen
    s_waitcnt lgkmcnt(0)
    v_mfma_f32_32x32x16_bf16 v[64:79], v[48:51], v[56:59], v[64:79]
    v_mfma_f32_4x4x4_16b_bf16 v[20:23], v[48:49], v[48:49], v[20:23]
    v_mfma_f32_32x32x16_bf16 v[96:111], v[48:51], v[60:63], v[96:111]
    ds_read_b128 v[32:35], v12 offset:0
    v_mfma_f32_32x32x16_bf16 v[128:143], v[60:63], v[48:51], v[128:143]
    ds_read_b128 v[36:39], v12 offset:4096
    v_mfma_f32_32x32x16_bf16 v[80:95], v[52:55], v[56:59], v[80:95]
    ds_read_b128 v[40:43], v5 offset:4096
    v_mfma_f32_32x32x16_bf16 v[112:127], v[52:55], v[60:63], v[112:127]
    v_mfma_f32_4x4x4_16b_bf16 v[20:23], v[50:51], v[50:51], v[20:23]
    ds_read_b128 v[44:47], v5 offset:5120
    v_mfma_f32_32x32x16_bf16 v[144:159], v[60:63], v[52:55], v[144:159]
    s_waitcnt lgkmcnt(0)
    v_mfma_f32_32x32x16_bf16 v[64:79], v[32:35], v[40:43], v[64:79]
    v_mfma_f32_4x4x4_16b_bf16 v[20:23], v[32:33], v[32:33], v[20:23]
    v_mfma_f32_32x32x16_bf16 v[96:111], v[32:35], v[44:47], v[96:111]
    ds_read_b128 v[48:51], v13 offset:0
    v_mfma_f32_32x32x16_bf16 v[128:143], v[44:47], v[32:35], v[128:143]
    ds_read_b128 v[52:55], v13 offset:4096
    v_mfma_f32_32x32x16_bf16 v[80:95], v[36:39], v[40:43], v[80:95]
    ds_read_b128 v[56:59], v5 offset:6144
    v_mfma_f32_32x32x16_bf16 v[112:127], v[36:39], v[44:47], v[112:127]
    v_mfma_f32_4x4x4_16b_bf16 v[20:23], v[34:35], v[34:35], v[20:23]
    ds_read_b128 v[60:63], v5 offset:7168
    v_mfma_f32_32x32x16_bf16 v[144:159], v[44:47], v[36:39], v[144:159]
    s_waitcnt vmcnt(16)
    s_barrier
    s_waitcnt lgkmcnt(0)
    v_mfma_f32_32x32x16_bf16 v[64:79], v[48:51], v[56:59], v[64:79]
    v_mfma_f32_4x4x4_16b_bf16 v[20:23], v[48:49], v[48:49], v[20:23]
    s_lshl_b32 s28, s13, 12
    s_add_u32 s28, s28, 32768
    s_mov_b32 m0, s28
    s_add_u32 s29, s24, 1152
    buffer_load_dwordx4 v2, s[16:19], s29 offen offset:0 lds
    v_mfma_f32_32x32x16_bf16 v[96:111], v[48:51], v[60:63], v[96:111]
    ds_read_b128 v[32:35], v10 offset:32768
    s_add_u32 s29, s29, 9216
    buffer_load_dwordx4 v3, s[16:19], s29 offen offset:1024 lds
    v_mfma_f32_32x32x16_bf16 v[128:143], v[60:63], v[48:51], v[128:143]
    ds_read_b128 v[36:39], v10 offset:36864
    s_add_u32 s29, s29, 9216
    buffer_load_dwordx4 v2, s[16:19], s29 offen offset:2048 lds
    v_mfma_f32_32x32x16_bf16 v[80:95], v[52:55], v[56:59], v[80:95]
    ds_read_b128 v[40:43], v5 offset:32768
    s_add_u32 s29, s29, 9216
    buffer_load_dwordx4 v3, s[16:19], s29 offen offset:3072 lds
    v_mfma_f32_32x32x16_bf16 v[112:127], v[52:55], v[60:63], v[112:127]
    v_mfma_f32_4x4x4_16b_bf16 v[20:23], v[50:51], v[50:51], v[20:23]
    ds_read_b128 v[44:47], v5 offset:33792
    s_add_u32 s28, s28, 16384
    s_mov_b32 m0, s28
    s_add_u32 s29, s25, 73728
    buffer_load_dwordx4 v1, s[8:11], s29 offen offset:0 lds
    v_mfma_f32_32x32x16_bf16 v[144:159], v[60:63], v[52:55], v[144:159]
    buffer_load_dwordx4 v1, s[8:11], s29 offen offset:1024 lds
    s_waitcnt lgkmcnt(0)
    v_mfma_f32_32x32x16_bf16 v[64:79], v[32:35], v[40:43], v[64:79]
    v_mfma_f32_4x4x4_16b_bf16 v[20:23], v[32:33], v[32:33], v[20:23]
    buffer_load_dwordx4 v1, s[8:11], s29 offen offset:2048 lds
    v_mfma_f32_32x32x16_bf16 v[96:111], v[32:35], v[44:47], v[96:111]
    ds_read_b128 v[48:51], v11 offset:32768
    buffer_load_dwordx4 v1, s[8:11], s29 offen offset:3072 lds
    v_mfma_f32_32x32x16_bf16 v[128:143], v[44:47], v[32:35], v[128:143]
    ds_read_b128 v[52:55], v11 offset:36864
    s_bfe_u32 s41, s53, 524288
    s_mul_i32 s41, s41, s40
    s_add_u32 s42, s58, s41
    s_add_u32 s43, s59, s41
    buffer_load_dwordx4 a[96:99], v240, s[8:11], s42 offen
    v_mfma_f32_32x32x16_bf16 v[80:95], v[36:39], v[40:43], v[80:95]
    ds_read_b128 v[56:59], v5 offset:34816
    buffer_load_dwordx4 a[100:103], v241, s[8:11], s43 offen
    v_mfma_f32_32x32x16_bf16 v[112:127], v[36:39], v[44:47], v[112:127]
    v_mfma_f32_4x4x4_16b_bf16 v[20:23], v[34:35], v[34:35], v[20:23]
    ds_read_b128 v[60:63], v5 offset:35840
    s_bfe_u32 s41, s53, 524296
    s_mul_i32 s41, s41, s40
    s_add_u32 s42, s58, s41
    s_add_u32 s43, s59, s41
    buffer_load_dwordx4 a[104:107], v240, s[8:11], s42 offen
    v_mfma_f32_32x32x16_bf16 v[144:159], v[44:47], v[36:39], v[144:159]
    buffer_load_dwordx4 a[108:111], v241, s[8:11], s43 offen
    s_waitcnt lgkmcnt(0)
    v_mfma_f32_32x32x16_bf16 v[64:79], v[48:51], v[56:59], v[64:79]
    v_mfma_f32_4x4x4_16b_bf16 v[20:23], v[48:49], v[48:49], v[20:23]
    v_mfma_f32_32x32x16_bf16 v[96:111], v[48:51], v[60:63], v[96:111]
    ds_read_b128 v[32:35], v12 offset:32768
    v_mfma_f32_32x32x16_bf16 v[128:143], v[60:63], v[48:51], v[128:143]
    ds_read_b128 v[36:39], v12 offset:36864
    v_mfma_f32_32x32x16_bf16 v[80:95], v[52:55], v[56:59], v[80:95]
    ds_read_b128 v[40:43], v5 offset:36864
    v_mfma_f32_32x32x16_bf16 v[112:127], v[52:55], v[60:63], v[112:127]
    v_mfma_f32_4x4x4_16b_bf16 v[20:23], v[50:51], v[50:51], v[20:23]
    ds_read_b128 v[44:47], v5 offset:37888
    v_mfma_f32_32x32x16_bf16 v[144:159], v[60:63], v[52:55], v[144:159]
    s_waitcnt lgkmcnt(0)
    v_mfma_f32_32x32x16_bf16 v[64:79], v[32:35], v[40:43], v[64:79]
    v_mfma_f32_4x4x4_16b_bf16 v[20:23], v[32:33], v[32:33], v[20:23]
    v_mfma_f32_32x32x16_bf16 v[96:111], v[32:35], v[44:47], v[96:111]
    ds_read_b128 v[48:51], v13 offset:32768
    v_mfma_f32_32x32x16_bf16 v[128:143], v[44:47], v[32:35], v[128:143]
    ds_read_b128 v[52:55], v13 offset:36864
    v_mfma_f32_32x32x16_bf16 v[80:95], v[36:39], v[40:43], v[80:95]
    ds_read_b128 v[56:59], v5 offset:38912
    v_mfma_f32_32x32x16_bf16 v[112:127], v[36:39], v[44:47], v[112:127]
    v_mfma_f32_4x4x4_16b_bf16 v[20:23], v[34:35], v[34:35], v[20:23]
    ds_read_b128 v[60:63], v5 offset:39936
    v_mfma_f32_32x32x16_bf16 v[144:159], v[44:47], v[36:39], v[144:159]
    s_waitcnt vmcnt(16)
    s_barrier
    s_waitcnt lgkmcnt(0)
    v_mfma_f32_32x32x16_bf16 v[64:79], v[48:51], v[56:59], v[64:79]
    v_mfma_f32_4x4x4_16b_bf16 v[20:23], v[48:49], v[48:49], v[20:23]
    s_bfe_u32 s41, s53, 524304
    s_mul_i32 s41, s41, s40
    s_add_u32 s42, s58, s41
    s_add_u32 s43, s59, s41
    buffer_load_dwordx4 a[112:115], v240, s[8:11], s42 offen
    v_mfma_f32_32x32x16_bf16 v[96:111], v[48:51], v[60:63], v[96:111]
    ds_read_b128 v[32:35], v6 offset:0
    buffer_load_dwordx4 a[116:119], v241, s[8:11], s43 offen
    v_mfma_f32_32x32x16_bf16 v[128:143], v[60:63], v[48:51], v[128:143]
    ds_read_b128 v[36:39], v6 offset:4096
    s_bfe_u32 s41, s53, 524312
    s_mul_i32 s41, s41, s40
    s_add_u32 s42, s58, s41
    s_add_u32 s43, s59, s41
    buffer_load_dwordx4 a[120:123], v240, s[8:11], s42 offen
    v_mfma_f32_32x32x16_bf16 v[80:95], v[52:55], v[56:59], v[80:95]
    ds_read_b128 v[40:43], v4 offset:0
    buffer_load_dwordx4 a[124:127], v241, s[8:11], s43 offen
    v_mfma_f32_32x32x16_bf16 v[112:127], v[52:55], v[60:63], v[112:127]
    v_mfma_f32_4x4x4_16b_bf16 v[20:23], v[50:51], v[50:51], v[20:23]
    ds_read_b128 v[44:47], v4 offset:1024
    v_mfma_f32_32x32x16_bf16 v[144:159], v[60:63], v[52:55], v[144:159]
    s_waitcnt lgkmcnt(0)
    v_mfma_f32_32x32x16_bf16 v[64:79], v[32:35], v[40:43], v[64:79]
    v_mfma_f32_4x4x4_16b_bf16 v[20:23], v[32:33], v[32:33], v[20:23]
    v_mfma_f32_32x32x16_bf16 v[96:111], v[32:35], v[44:47], v[96:111]
    ds_read_b128 v[48:51], v7 offset:0
    v_mfma_f32_32x32x16_bf16 v[128:143], v[44:47], v[32:35], v[128:143]
    ds_read_b128 v[52:55], v7 offset:4096
    v_mfma_f32_32x32x16_bf16 v[80:95], v[36:39], v[40:43], v[80:95]
    ds_read_b128 v[56:59], v4 offset:2048
    v_mfma_f32_32x32x16_bf16 v[112:127], v[36:39], v[44:47], v[112:127]
    v_mfma_f32_4x4x4_16b_bf16 v[20:23], v[34:35], v[34:35], v[20:23]
    ds_read_b128 v[60:63], v4 offset:3072
    v_mfma_f32_32x32x16_bf16 v[144:159], v[44:47], v[36:39], v[144:159]
    s_waitcnt lgkmcnt(0)
    v_mfma_f32_32x32x16_bf16 v[64:79], v[48:51], v[56:59], v[64:79]
    v_mfma_f32_4x4x4_16b_bf16 v[20:23], v[48:49], v[48:49], v[20:23]
    v_mfma_f32_32x32x16_bf16 v[96:111], v[48:51], v[60:63], v[96:111]
    ds_read_b128 v[32:35], v8 offset:0
    v_mfma_f32_32x32x16_bf16 v[128:143], v[60:63], v[48:51], v[128:143]
    ds_read_b128 v[36:39], v8 offset:4096
    v_mfma_f32_32x32x16_bf16 v[80:95], v[52:55], v[56:59], v[80:95]
    ds_read_b128 v[40:43], v4 offset:4096
    v_mfma_f32_32x32x16_bf16 v[112:127], v[52:55], v[60:63], v[112:127]
    v_mfma_f32_4x4x4_16b_bf16 v[20:23], v[50:51], v[50:51], v[20:23]
    ds_read_b128 v[44:47], v4 offset:5120
    v_mfma_f32_32x32x16_bf16 v[144:159], v[60:63], v[52:55], v[144:159]
    s_waitcnt lgkmcnt(0)
    v_mfma_f32_32x32x16_bf16 v[64:79], v[32:35], v[40:43], v[64:79]
    v_mfma_f32_4x4x4_16b_bf16 v[20:23], v[32:33], v[32:33], v[20:23]
    v_mfma_f32_32x32x16_bf16 v[96:111], v[32:35], v[44:47], v[96:111]
    ds_read_b128 v[48:51], v9 offset:0
    v_mfma_f32_32x32x16_bf16 v[128:143], v[44:47], v[32:35], v[128:143]
    ds_read_b128 v[52:55], v9 offset:4096
    v_mfma_f32_32x32x16_bf16 v[80:95], v[36:39], v[40:43], v[80:95]
    ds_read_b128 v[56:59], v4 offset:6144
    v_mfma_f32_32x32x16_bf16 v[112:127], v[36:39], v[44:47], v[112:127]
    v_mfma_f32_4x4x4_16b_bf16 v[20:23], v[34:35], v[34:35], v[20:23]
    ds_read_b128 v[60:63], v4 offset:7168
    v_mfma_f32_32x32x16_bf16 v[144:159], v[44:47], v[36:39], v[144:159]
    s_waitcnt vmcnt(8)
    s_barrier
    s_waitcnt lgkmcnt(0)
    v_mfma_f32_32x32x16_bf16 v[64:79], v[48:51], v[56:59], v[64:79]
    v_mfma_f32_4x4x4_16b_bf16 v[20:23], v[48:49], v[48:49], v[20:23]
    s_bfe_u32 s41, s54, 524288
    s_mul_i32 s41, s41, s40
    s_add_u32 s42, s58, s41
    s_add_u32 s43, s59, s41
    buffer_load_dwordx4 a[128:131], v240, s[8:11], s42 offen
    v_mfma_f32_32x32x16_bf16 v[96:111], v[48:51], v[60:63], v[96:111]
    ds_read_b128 v[32:35], v6 offset:32768
    buffer_load_dwordx4 a[132:135], v241, s[8:11], s43 offen
    v_mfma_f32_32x32x16_bf16 v[128:143], v[60:63], v[48:51], v[128:143]
    ds_read_b128 v[36:39], v6 offset:36864
    v_mfma_f32_32x32x16_bf16 v[80:95], v[52:55], v[56:59], v[80:95]
    ds_read_b128 v[40:43], v4 offset:32768
    v_mfma_f32_32x32x16_bf16 v[112:127], v[52:55], v[60:63], v[112:127]
    v_mfma_f32_4x4x4_16b_bf16 v[20:23], v[50:51], v[50:51], v[20:23]
    ds_read_b128 v[44:47], v4 offset:33792
    v_mfma_f32_32x32x16_bf16 v[144:159], v[60:63], v[52:55], v[144:159]
    s_waitcnt lgkmcnt(0)
    v_mfma_f32_32x32x16_bf16 v[64:79], v[32:35], v[40:43], v[64:79]
    v_mfma_f32_4x4x4_16b_bf16 v[20:23], v[32:33], v[32:33], v[20:23]
    v_mfma_f32_32x32x16_bf16 v[96:111], v[32:35], v[44:47], v[96:111]
    ds_read_b128 v[48:51], v7 offset:32768
    v_mfma_f32_32x32x16_bf16 v[128:143], v[44:47], v[32:35], v[128:143]
    ds_read_b128 v[52:55], v7 offset:36864
    v_mfma_f32_32x32x16_bf16 v[80:95], v[36:39], v[40:43], v[80:95]
    ds_read_b128 v[56:59], v4 offset:34816
    v_mfma_f32_32x32x16_bf16 v[112:127], v[36:39], v[44:47], v[112:127]
    v_mfma_f32_4x4x4_16b_bf16 v[20:23], v[34:35], v[34:35], v[20:23]
    ds_read_b128 v[60:63], v4 offset:35840
    v_mfma_f32_32x32x16_bf16 v[144:159], v[44:47], v[36:39], v[144:159]
    s_waitcnt lgkmcnt(0)
    v_mfma_f32_32x32x16_bf16 v[64:79], v[48:51], v[56:59], v[64:79]
    v_mfma_f32_4x4x4_16b_bf16 v[20:23], v[48:49], v[48:49], v[20:23]
    v_mfma_f32_32x32x16_bf16 v[96:111], v[48:51], v[60:63], v[96:111]
    ds_read_b128 v[32:35], v8 offset:32768
    v_mfma_f32_32x32x16_bf16 v[128:143], v[60:63], v[48:51], v[128:143]
    ds_read_b128 v[36:39], v8 offset:36864
    v_mfma_f32_32x32x16_bf16 v[80:95], v[52:55], v[56:59], v[80:95]
    ds_read_b128 v[40:43], v4 offset:36864
    v_mfma_f32_32x32x16_bf16 v[112:127], v[52:55], v[60:63], v[112:127]
    v_mfma_f32_4x4x4_16b_bf16 v[20:23], v[50:51], v[50:51], v[20:23]
    ds_read_b128 v[44:47], v4 offset:37888
    v_mfma_f32_32x32x16_bf16 v[144:159], v[60:63], v[52:55], v[144:159]
    s_waitcnt lgkmcnt(0)
    v_mfma_f32_32x32x16_bf16 v[64:79], v[32:35], v[40:43], v[64:79]
    v_mfma_f32_4x4x4_16b_bf16 v[20:23], v[32:33], v[32:33], v[20:23]
    v_mfma_f32_32x32x16_bf16 v[96:111], v[32:35], v[44:47], v[96:111]
    ds_read_b128 v[48:51], v9 offset:32768
    v_mfma_f32_32x32x16_bf16 v[128:143], v[44:47], v[32:35], v[128:143]
    ds_read_b128 v[52:55], v9 offset:36864
    v_mfma_f32_32x32x16_bf16 v[80:95], v[36:39], v[40:43], v[80:95]
    ds_read_b128 v[56:59], v4 offset:38912
    v_mfma_f32_32x32x16_bf16 v[112:127], v[36:39], v[44:47], v[112:127]
    v_mfma_f32_4x4x4_16b_bf16 v[20:23], v[34:35], v[34:35], v[20:23]
    ds_read_b128 v[60:63], v4 offset:39936
    v_mfma_f32_32x32x16_bf16 v[144:159], v[44:47], v[36:39], v[144:159]
    s_waitcnt lgkmcnt(0)
    v_mfma_f32_32x32x16_bf16 v[64:79], v[48:51], v[56:59], v[64:79]
    v_mfma_f32_4x4x4_16b_bf16 v[20:23], v[48:49], v[48:49], v[20:23]
    s_bfe_u32 s41, s54, 524296
    s_mul_i32 s41, s41, s40
    s_add_u32 s42, s58, s41
    s_add_u32 s43, s59, s41
    buffer_load_dwordx4 a[136:139], v240, s[8:11], s42 offen
    v_mfma_f32_32x32x16_bf16 v[96:111], v[48:51], v[60:63], v[96:111]
    buffer_load_dwordx4 a[140:143], v241, s[8:11], s43 offen
    v_mfma_f32_32x32x16_bf16 v[128:143], v[60:63], v[48:51], v[128:143]
    v_mfma_f32_32x32x16_bf16 v[80:95], v[52:55], v[56:59], v[80:95]
    v_mfma_f32_32x32x16_bf16 v[112:127], v[52:55], v[60:63], v[112:127]
    v_mfma_f32_4x4x4_16b_bf16 v[20:23], v[50:51], v[50:51], v[20:23]
    v_mfma_f32_32x32x16_bf16 v[144:159], v[60:63], v[52:55], v[144:159]
    s_branch layerb1_kernel_af_epi
layerb1_kernel_af_h1:
    s_waitcnt lgkmcnt(0)
    v_mfma_f32_32x32x16_bf16 v[64:79], v[32:35], v[40:43], 0
    v_mfma_f32_4x4x4_16b_bf16 v[20:23], v[36:37], v[36:37], v[20:23]
    v_mfma_f32_32x32x16_bf16 v[96:111], v[32:35], v[44:47], 0
    ds_read_b128 v[48:51], v7 offset:0
    v_mfma_f32_32x32x16_bf16 v[128:143], v[44:47], v[32:35], 0
    ds_read_b128 v[52:55], v7 offset:4096
    v_mfma_f32_32x32x16_bf16 v[80:95], v[36:39], v[40:43], 0
    ds_read_b128 v[56:59], v4 offset:2048
    v_mfma_f32_32x32x16_bf16 v[112:127], v[36:39], v[44:47], 0
    v_mfma_f32_4x4x4_16b_bf16 v[20:23], v[38:39], v[38:39], v[20:23]
    ds_read_b128 v[60:63], v4 offset:3072
    v_mfma_f32_32x32x16_bf16 v[144:159], v[44:47], v[36:39], 0
    s_waitcnt lgkmcnt(0)
    v_mfma_f32_32x32x16_bf16 v[64:79], v[48:51], v[56:59], v[64:79]
    v_mfma_f32_4x4x4_16b_bf16 v[20:23], v[52:53], v[52:53], v[20:23]
    v_mfma_f32_32x32x16_bf16 v[96:111], v[48:51], v[60:63], v[96:111]
    ds_read_b128 v[32:35], v8 offset:0
    v_mfma_f32_32x32x16_bf16 v[128:143], v[60:63], v[48:51], v[128:143]
    ds_read_b128 v[36:39], v8 offset:4096
    v_mfma_f32_32x32x16_bf16 v[80:95], v[52:55], v[56:59], v[80:95]
    ds_read_b128 v[40:43], v4 offset:4096
    v_mfma_f32_32x32x16_bf16 v[112:127], v[52:55], v[60:63], v[112:127]
    v_mfma_f32_4x4x4_16b_bf16 v[20:23], v[54:55], v[54:55], v[20:23]
    ds_read_b128 v[44:47], v4 offset:5120
    v_mfma_f32_32x32x16_bf16 v[144:159], v[60:63], v[52:55], v[144:159]
    s_waitcnt lgkmcnt(0)
    v_mfma_f32_32x32x16_bf16 v[64:79], v[32:35], v[40:43], v[64:79]
    v_mfma_f32_4x4x4_16b_bf16 v[20:23], v[36:37], v[36:37], v[20:23]
    v_mfma_f32_32x32x16_bf16 v[96:111], v[32:35], v[44:47], v[96:111]
    ds_read_b128 v[48:51], v9 offset:0
    v_mfma_f32_32x32x16_bf16 v[128:143], v[44:47], v[32:35], v[128:143]
    ds_read_b128 v[52:55], v9 offset:4096
    v_mfma_f32_32x32x16_bf16 v[80:95], v[36:39], v[40:43], v[80:95]
    ds_read_b128 v[56:59], v4 offset:6144
    v_mfma_f32_32x32x16_bf16 v[112:127], v[36:39], v[44:47], v[112:127]
    v_mfma_f32_4x4x4_16b_bf16 v[20:23], v[38:39], v[38:39], v[20:23]
    ds_read_b128 v[60:63], v4 offset:7168
    v_mfma_f32_32x32x16_bf16 v[144:159], v[44:47], v[36:39], v[144:159]
    s_waitcnt vmcnt(8)
    s_barrier
    s_waitcnt lgkmcnt(0)
    v_mfma_f32_32x32x16_bf16 v[64:79], v[48:51], v[56:59], v[64:79]
    v_mfma_f32_4x4x4_16b_bf16 v[20:23], v[52:53], v[52:53], v[20:23]
    s_lshl_b32 s28, s13, 12
    s_add_u32 s28, s28, 98304
    s_mov_b32 m0, s28
    s_add_u32 s29, s24, 384
    buffer_load_dwordx4 v2, s[16:19], s29 offen offset:0 lds
    v_mfma_f32_32x32x16_bf16 v[96:111], v[48:51], v[60:63], v[96:111]
    ds_read_b128 v[32:35], v6 offset:32768
    s_add_u32 s29, s29, 9216
    buffer_load_dwordx4 v3, s[16:19], s29 offen offset:1024 lds
    v_mfma_f32_32x32x16_bf16 v[128:143], v[60:63], v[48:51], v[128:143]
    ds_read_b128 v[36:39], v6 offset:36864
    s_add_u32 s29, s29, 9216
    buffer_load_dwordx4 v2, s[16:19], s29 offen offset:2048 lds
    v_mfma_f32_32x32x16_bf16 v[80:95], v[52:55], v[56:59], v[80:95]
    ds_read_b128 v[40:43], v4 offset:32768
    s_add_u32 s29, s29, 9216
    buffer_load_dwordx4 v3, s[16:19], s29 offen offset:3072 lds
    v_mfma_f32_32x32x16_bf16 v[112:127], v[52:55], v[60:63], v[112:127]
    v_mfma_f32_4x4x4_16b_bf16 v[20:23], v[54:55], v[54:55], v[20:23]
    ds_read_b128 v[44:47], v4 offset:33792
    s_add_u32 s28, s28, 16384
    s_mov_b32 m0, s28
    s_add_u32 s29, s25, 24576
    buffer_load_dwordx4 v1, s[8:11], s29 offen offset:0 lds
    v_mfma_f32_32x32x16_bf16 v[144:159], v[60:63], v[52:55], v[144:159]
    buffer_load_dwordx4 v1, s[8:11], s29 offen offset:1024 lds
    s_waitcnt lgkmcnt(0)
    v_mfma_f32_32x32x16_bf16 v[64:79], v[32:35], v[40:43], v[64:79]
    v_mfma_f32_4x4x4_16b_bf16 v[20:23], v[36:37], v[36:37], v[20:23]
    buffer_load_dwordx4 v1, s[8:11], s29 offen offset:2048 lds
    v_mfma_f32_32x32x16_bf16 v[96:111], v[32:35], v[44:47], v[96:111]
    ds_read_b128 v[48:51], v7 offset:32768
    buffer_load_dwordx4 v1, s[8:11], s29 offen offset:3072 lds
    v_mfma_f32_32x32x16_bf16 v[128:143], v[44:47], v[32:35], v[128:143]
    ds_read_b128 v[52:55], v7 offset:36864
    s_bfe_u32 s41, s50, 524288
    s_mul_i32 s41, s41, s40
    s_add_u32 s42, s58, s41
    s_add_u32 s43, s59, s41
    buffer_load_dwordx4 a[0:3], v240, s[8:11], s42 offen
    v_mfma_f32_32x32x16_bf16 v[80:95], v[36:39], v[40:43], v[80:95]
    ds_read_b128 v[56:59], v4 offset:34816
    buffer_load_dwordx4 a[4:7], v241, s[8:11], s43 offen
    v_mfma_f32_32x32x16_bf16 v[112:127], v[36:39], v[44:47], v[112:127]
    v_mfma_f32_4x4x4_16b_bf16 v[20:23], v[38:39], v[38:39], v[20:23]
    ds_read_b128 v[60:63], v4 offset:35840
    s_bfe_u32 s41, s50, 524296
    s_mul_i32 s41, s41, s40
    s_add_u32 s42, s58, s41
    s_add_u32 s43, s59, s41
    buffer_load_dwordx4 a[8:11], v240, s[8:11], s42 offen
    v_mfma_f32_32x32x16_bf16 v[144:159], v[44:47], v[36:39], v[144:159]
    buffer_load_dwordx4 a[12:15], v241, s[8:11], s43 offen
    s_waitcnt lgkmcnt(0)
    v_mfma_f32_32x32x16_bf16 v[64:79], v[48:51], v[56:59], v[64:79]
    v_mfma_f32_4x4x4_16b_bf16 v[20:23], v[52:53], v[52:53], v[20:23]
    v_mfma_f32_32x32x16_bf16 v[96:111], v[48:51], v[60:63], v[96:111]
    ds_read_b128 v[32:35], v8 offset:32768
    v_mfma_f32_32x32x16_bf16 v[128:143], v[60:63], v[48:51], v[128:143]
    ds_read_b128 v[36:39], v8 offset:36864
    v_mfma_f32_32x32x16_bf16 v[80:95], v[52:55], v[56:59], v[80:95]
    ds_read_b128 v[40:43], v4 offset:36864
    v_mfma_f32_32x32x16_bf16 v[112:127], v[52:55], v[60:63], v[112:127]
    v_mfma_f32_4x4x4_16b_bf16 v[20:23], v[54:55], v[54:55], v[20:23]
    ds_read_b128 v[44:47], v4 offset:37888
    v_mfma_f32_32x32x16_bf16 v[144:159], v[60:63], v[52:55], v[144:159]
    s_waitcnt lgkmcnt(0)
    v_mfma_f32_32x32x16_bf16 v[64:79], v[32:35], v[40:43], v[64:79]
    v_mfma_f32_4x4x4_16b_bf16 v[20:23], v[36:37], v[36:37], v[20:23]
    v_mfma_f32_32x32x16_bf16 v[96:111], v[32:35], v[44:47], v[96:111]
    ds_read_b128 v[48:51], v9 offset:32768
    v_mfma_f32_32x32x16_bf16 v[128:143], v[44:47], v[32:35], v[128:143]
    ds_read_b128 v[52:55], v9 offset:36864
    v_mfma_f32_32x32x16_bf16 v[80:95], v[36:39], v[40:43], v[80:95]
    ds_read_b128 v[56:59], v4 offset:38912
    v_mfma_f32_32x32x16_bf16 v[112:127], v[36:39], v[44:47], v[112:127]
    v_mfma_f32_4x4x4_16b_bf16 v[20:23], v[38:39], v[38:39], v[20:23]
    ds_read_b128 v[60:63], v4 offset:39936
    v_mfma_f32_32x32x16_bf16 v[144:159], v[44:47], v[36:39], v[144:159]
    s_waitcnt vmcnt(12)
    s_barrier
    s_waitcnt lgkmcnt(0)
    v_mfma_f32_32x32x16_bf16 v[64:79], v[48:51], v[56:59], v[64:79]
    v_mfma_f32_4x4x4_16b_bf16 v[20:23], v[52:53], v[52:53], v[20:23]
    s_lshl_b32 s28, s13, 12
    s_mov_b32 m0, s28
    s_add_u32 s29, s24, 512
    buffer_load_dwordx4 v2, s[16:19], s29 offen offset:0 lds
    v_mfma_f32_32x32x16_bf16 v[96:111], v[48:51], v[60:63], v[96:111]
    ds_read_b128 v[32:35], v10 offset:0
    s_add_u32 s29, s29, 9216
    buffer_load_dwordx4 v3, s[16:19], s29 offen offset:1024 lds
    v_mfma_f32_32x32x16_bf16 v[128:143], v[60:63], v[48:51], v[128:143]
    ds_read_b128 v[36:39], v10 offset:4096
    s_add_u32 s29, s29, 9216
    buffer_load_dwordx4 v2, s[16:19], s29 offen offset:2048 lds
    v_mfma_f32_32x32x16_bf16 v[80:95], v[52:55], v[56:59], v[80:95]
    ds_read_b128 v[40:43], v5 offset:0
    s_add_u32 s29, s29, 9216
    buffer_load_dwordx4 v3, s[16:19], s29 offen offset:3072 lds
    v_mfma_f32_32x32x16_bf16 v[112:127], v[52:55], v[60:63], v[112:127]
    v_mfma_f32_4x4x4_16b_bf16 v[20:23], v[54:55], v[54:55], v[20:23]
    ds_read_b128 v[44:47], v5 offset:1024
    s_add_u32 s28, s28, 16384
    s_mov_b32 m0, s28
    s_add_u32 s29, s25, 32768
    buffer_load_dwordx4 v1, s[8:11], s29 offen offset:0 lds
    v_mfma_f32_32x32x16_bf16 v[144:159], v[60:63], v[52:55], v[144:159]
    buffer_load_dwordx4 v1, s[8:11], s29 offen offset:1024 lds
    s_waitcnt lgkmcnt(0)
    v_mfma_f32_32x32x16_bf16 v[64:79], v[32:35], v[40:43], v[64:79]
    v_mfma_f32_4x4x4_16b_bf16 v[20:23], v[36:37], v[36:37], v[20:23]
    buffer_load_dwordx4 v1, s[8:11], s29 offen offset:2048 lds
    v_mfma_f32_32x32x16_bf16 v[96:111], v[32:35], v[44:47], v[96:111]
    ds_read_b128 v[48:51], v11 offset:0
    buffer_load_dwordx4 v1, s[8:11], s29 offen offset:3072 lds
    v_mfma_f32_32x32x16_bf16 v[128:143], v[44:47], v[32:35], v[128:143]
    ds_read_b128 v[52:55], v11 offset:4096
    s_bfe_u32 s41, s50, 524304
    s_mul_i32 s41, s41, s40
    s_add_u32 s42, s58, s41
    s_add_u32 s43, s59, s41
    buffer_load_dwordx4 a[16:19], v240, s[8:11], s42 offen
    v_mfma_f32_32x32x16_bf16 v[80:95], v[36:39], v[40:43], v[80:95]
    ds_read_b128 v[56:59], v5 offset:2048
    buffer_load_dwordx4 a[20:23], v241, s[8:11], s43 offen
    v_mfma_f32_32x32x16_bf16 v[112:127], v[36:39], v[44:47], v[112:127]
    v_mfma_f32_4x4x4_16b_bf16 v[20:23], v[38:39], v[38:39], v[20:23]
    ds_read_b128 v[60:63], v5 offset:3072
    s_bfe_u32 s41, s50, 524312
    s_mul_i32 s41, s41, s40
    s_add_u32 s42, s58, s41
    s_add_u32 s43, s59, s41
    buffer_load_dwordx4 a[24:27], v240, s[8:11], s42 offen
    v_mfma_f32_32x32x16_bf16 v[144:159], v[44:47], v[36:39], v[144:159]
    buffer_load_dwordx4 a[28:31], v241, s[8:11], s43 offen
    s_waitcnt lgkmcnt(0)
    v_mfma_f32_32x32x16_bf16 v[64:79], v[48:51], v[56:59], v[64:79]
    v_mfma_f32_4x4x4_16b_bf16 v[20:23], v[52:53], v[52:53], v[20:23]
    v_mfma_f32_32x32x16_bf16 v[96:111], v[48:51], v[60:63], v[96:111]
    ds_read_b128 v[32:35], v12 offset:0
    v_mfma_f32_32x32x16_bf16 v[128:143], v[60:63], v[48:51], v[128:143]
    ds_read_b128 v[36:39], v12 offset:4096
    v_mfma_f32_32x32x16_bf16 v[80:95], v[52:55], v[56:59], v[80:95]
    ds_read_b128 v[40:43], v5 offset:4096
    v_mfma_f32_32x32x16_bf16 v[112:127], v[52:55], v[60:63], v[112:127]
    v_mfma_f32_4x4x4_16b_bf16 v[20:23], v[54:55], v[54:55], v[20:23]
    ds_read_b128 v[44:47], v5 offset:5120
    v_mfma_f32_32x32x16_bf16 v[144:159], v[60:63], v[52:55], v[144:159]
    s_waitcnt lgkmcnt(0)
    v_mfma_f32_32x32x16_bf16 v[64:79], v[32:35], v[40:43], v[64:79]
    v_mfma_f32_4x4x4_16b_bf16 v[20:23], v[36:37], v[36:37], v[20:23]
    v_mfma_f32_32x32x16_bf16 v[96:111], v[32:35], v[44:47], v[96:111]
    ds_read_b128 v[48:51], v13 offset:0
    v_mfma_f32_32x32x16_bf16 v[128:143], v[44:47], v[32:35], v[128:143]
    ds_read_b128 v[52:55], v13 offset:4096
    v_mfma_f32_32x32x16_bf16 v[80:95], v[36:39], v[40:43], v[80:95]
    ds_read_b128 v[56:59], v5 offset:6144
    v_mfma_f32_32x32x16_bf16 v[112:127], v[36:39], v[44:47], v[112:127]
    v_mfma_f32_4x4x4_16b_bf16 v[20:23], v[38:39], v[38:39], v[20:23]
    ds_read_b128 v[60:63], v5 offset:7168
    v_mfma_f32_32x32x16_bf16 v[144:159], v[44:47], v[36:39], v[144:159]
    s_waitcnt vmcnt(16)
    s_barrier
    s_waitcnt lgkmcnt(0)
    v_mfma_f32_32x32x16_bf16 v[64:79], v[48:51], v[56:59], v[64:79]
    v_mfma_f32_4x4x4_16b_bf16 v[20:23], v[52:53], v[52:53], v[20:23]
    s_lshl_b32 s28, s13, 12
    s_add_u32 s28, s28, 32768
    s_mov_b32 m0, s28
    s_add_u32 s29, s24, 640
    buffer_load_dwordx4 v2, s[16:19], s29 offen offset:0 lds
    v_mfma_f32_32x32x16_bf16 v[96:111], v[48:51], v[60:63], v[96:111]
    ds_read_b128 v[32:35], v10 offset:32768
    s_add_u32 s29, s29, 9216
    buffer_load_dwordx4 v3, s[16:19], s29 offen offset:1024 lds
    v_mfma_f32_32x32x16_bf16 v[128:143], v[60:63], v[48:51], v[128:143]
    ds_read_b128 v[36:39], v10 offset:36864
    s_add_u32 s29, s29, 9216
    buffer_load_dwordx4 v2, s[16:19], s29 offen offset:2048 lds
    v_mfma_f32_32x32x16_bf16 v[80:95], v[52:55], v[56:59], v[80:95]
    ds_read_b128 v[40:43], v5 offset:32768
    s_add_u32 s29, s29, 9216
    buffer_load_dwordx4 v3, s[16:19], s29 offen offset:3072 lds
    v_mfma_f32_32x32x16_bf16 v[112:127], v[52:55], v[60:63], v[112:127]
    v_mfma_f32_4x4x4_16b_bf16 v[20:23], v[54:55], v[54:55], v[20:23]
    ds_read_b128 v[44:47], v5 offset:33792
    s_add_u32 s28, s28, 16384
    s_mov_b32 m0, s28
    s_add_u32 s29, s25, 40960
    buffer_load_dwordx4 v1, s[8:11], s29 offen offset:0 lds
    v_mfma_f32_32x32x16_bf16 v[144:159], v[60:63], v[52:55], v[144:159]
    buffer_load_dwordx4 v1, s[8:11], s29 offen offset:1024 lds
    s_waitcnt lgkmcnt(0)
    v_mfma_f32_32x32x16_bf16 v[64:79], v[32:35], v[40:43], v[64:79]
    v_mfma_f32_4x4x4_16b_bf16 v[20:23], v[36:37], v[36:37], v[20:23]
    buffer_load_dwordx4 v1, s[8:11], s29 offen offset:2048 lds
    v_mfma_f32_32x32x16_bf16 v[96:111], v[32:35], v[44:47], v[96:111]
    ds_read_b128 v[48:51], v11 offset:32768
    buffer_load_dwordx4 v1, s[8:11], s29 offen offset:3072 lds
    v_mfma_f32_32x32x16_bf16 v[128:143], v[44:47], v[32:35], v[128:143]
    ds_read_b128 v[52:55], v11 offset:36864
    s_bfe_u32 s41, s51, 524288
    s_mul_i32 s41, s41, s40
    s_add_u32 s42, s58, s41
    s_add_u32 s43, s59, s41
    buffer_load_dwordx4 a[32:35], v240, s[8:11], s42 offen
    v_mfma_f32_32x32x16_bf16 v[80:95], v[36:39], v[40:43], v[80:95]
    ds_read_b128 v[56:59], v5 offset:34816
    buffer_load_dwordx4 a[36:39], v241, s[8:11], s43 offen
    v_mfma_f32_32x32x16_bf16 v[112:127], v[36:39], v[44:47], v[112:127]
    v_mfma_f32_4x4x4_16b_bf16 v[20:23], v[38:39], v[38:39], v[20:23]
    ds_read_b128 v[60:63], v5 offset:35840
    s_bfe_u32 s41, s51, 524296
    s_mul_i32 s41, s41, s40
    s_add_u32 s42, s58, s41
    s_add_u32 s43, s59, s41
    buffer_load_dwordx4 a[40:43], v240, s[8:11], s42 offen
    v_mfma_f32_32x32x16_bf16 v[144:159], v[44:47], v[36:39], v[144:159]
    buffer_load_dwordx4 a[44:47], v241, s[8:11], s43 offen
    s_waitcnt lgkmcnt(0)
    v_mfma_f32_32x32x16_bf16 v[64:79], v[48:51], v[56:59], v[64:79]
    v_mfma_f32_4x4x4_16b_bf16 v[20:23], v[52:53], v[52:53], v[20:23]
    v_mfma_f32_32x32x16_bf16 v[96:111], v[48:51], v[60:63], v[96:111]
    ds_read_b128 v[32:35], v12 offset:32768
    v_mfma_f32_32x32x16_bf16 v[128:143], v[60:63], v[48:51], v[128:143]
    ds_read_b128 v[36:39], v12 offset:36864
    v_mfma_f32_32x32x16_bf16 v[80:95], v[52:55], v[56:59], v[80:95]
    ds_read_b128 v[40:43], v5 offset:36864
    v_mfma_f32_32x32x16_bf16 v[112:127], v[52:55], v[60:63], v[112:127]
    v_mfma_f32_4x4x4_16b_bf16 v[20:23], v[54:55], v[54:55], v[20:23]
    ds_read_b128 v[44:47], v5 offset:37888
    v_mfma_f32_32x32x16_bf16 v[144:159], v[60:63], v[52:55], v[144:159]
    s_waitcnt lgkmcnt(0)
    v_mfma_f32_32x32x16_bf16 v[64:79], v[32:35], v[40:43], v[64:79]
    v_mfma_f32_4x4x4_16b_bf16 v[20:23], v[36:37], v[36:37], v[20:23]
    v_mfma_f32_32x32x16_bf16 v[96:111], v[32:35], v[44:47], v[96:111]
    ds_read_b128 v[48:51], v13 offset:32768
    v_mfma_f32_32x32x16_bf16 v[128:143], v[44:47], v[32:35], v[128:143]
    ds_read_b128 v[52:55], v13 offset:36864
    v_mfma_f32_32x32x16_bf16 v[80:95], v[36:39], v[40:43], v[80:95]
    ds_read_b128 v[56:59], v5 offset:38912
    v_mfma_f32_32x32x16_bf16 v[112:127], v[36:39], v[44:47], v[112:127]
    v_mfma_f32_4x4x4_16b_bf16 v[20:23], v[38:39], v[38:39], v[20:23]
    ds_read_b128 v[60:63], v5 offset:39936
    v_mfma_f32_32x32x16_bf16 v[144:159], v[44:47], v[36:39], v[144:159]
    s_waitcnt vmcnt(16)
    s_barrier
    s_waitcnt lgkmcnt(0)
    v_mfma_f32_32x32x16_bf16 v[64:79], v[48:51], v[56:59], v[64:79]
    v_mfma_f32_4x4x4_16b_bf16 v[20:23], v[52:53], v[52:53], v[20:23]
    s_lshl_b32 s28, s13, 12
    s_add_u32 s28, s28, 65536
    s_mov_b32 m0, s28
    s_add_u32 s29, s24, 768
    buffer_load_dwordx4 v2, s[16:19], s29 offen offset:0 lds
    v_mfma_f32_32x32x16_bf16 v[96:111], v[48:51], v[60:63], v[96:111]
    ds_read_b128 v[32:35], v6 offset:0
    s_add_u32 s29, s29, 9216
    buffer_load_dwordx4 v3, s[16:19], s29 offen offset:1024 lds
    v_mfma_f32_32x32x16_bf16 v[128:143], v[60:63], v[48:51], v[128:143]
    ds_read_b128 v[36:39], v6 offset:4096
    s_add_u32 s29, s29, 9216
    buffer_load_dwordx4 v2, s[16:19], s29 offen offset:2048 lds
    v_mfma_f32_32x32x16_bf16 v[80:95], v[52:55], v[56:59], v[80:95]
    ds_read_b128 v[40:43], v4 offset:0
    s_add_u32 s29, s29, 9216
    buffer_load_dwordx4 v3, s[16:19], s29 offen offset:3072 lds
    v_mfma_f32_32x32x16_bf16 v[112:127], v[52:55], v[60:63], v[112:127]
    v_mfma_f32_4x4x4_16b_bf16 v[20:23], v[54:55], v[54:55], v[20:23]
    ds_read_b128 v[44:47], v4 offset:1024
    s_add_u32 s28, s28, 16384
    s_mov_b32 m0, s28
    s_add_u32 s29, s25, 49152
    buffer_load_dwordx4 v1, s[8:11], s29 offen offset:0 lds
    v_mfma_f32_32x32x16_bf16 v[144:159], v[60:63], v[52:55], v[144:159]
    buffer_load_dwordx4 v1, s[8:11], s29 offen offset:1024 lds
    s_waitcnt lgkmcnt(0)
    v_mfma_f32_32x32x16_bf16 v[64:79], v[32:35], v[40:43], v[64:79]
    v_mfma_f32_4x4x4_16b_bf16 v[20:23], v[36:37], v[36:37], v[20:23]
    buffer_load_dwordx4 v1, s[8:11], s29 offen offset:2048 lds
    v_mfma_f32_32x32x16_bf16 v[96:111], v[32:35], v[44:47], v[96:111]
    ds_read_b128 v[48:51], v7 offset:0
    buffer_load_dwordx4 v1, s[8:11], s29 offen offset:3072 lds
    v_mfma_f32_32x32x16_bf16 v[128:143], v[44:47], v[32:35], v[128:143]
    ds_read_b128 v[52:55], v7 offset:4096
    s_bfe_u32 s41, s51, 524304
    s_mul_i32 s41, s41, s40
    s_add_u32 s42, s58, s41
    s_add_u32 s43, s59, s41
    buffer_load_dwordx4 a[48:51], v240, s[8:11], s42 offen
    v_mfma_f32_32x32x16_bf16 v[80:95], v[36:39], v[40:43], v[80:95]
    ds_read_b128 v[56:59], v4 offset:2048
    buffer_load_dwordx4 a[52:55], v241, s[8:11], s43 offen
    v_mfma_f32_32x32x16_bf16 v[112:127], v[36:39], v[44:47], v[112:127]
    v_mfma_f32_4x4x4_16b_bf16 v[20:23], v[38:39], v[38:39], v[20:23]
    ds_read_b128 v[60:63], v4 offset:3072
    s_bfe_u32 s41, s51, 524312
    s_mul_i32 s41, s41, s40
    s_add_u32 s42, s58, s41
    s_add_u32 s43, s59, s41
    buffer_load_dwordx4 a[56:59], v240, s[8:11], s42 offen
    v_mfma_f32_32x32x16_bf16 v[144:159], v[44:47], v[36:39], v[144:159]
    buffer_load_dwordx4 a[60:63], v241, s[8:11], s43 offen
    s_waitcnt lgkmcnt(0)
    v_mfma_f32_32x32x16_bf16 v[64:79], v[48:51], v[56:59], v[64:79]
    v_mfma_f32_4x4x4_16b_bf16 v[20:23], v[52:53], v[52:53], v[20:23]
    v_mfma_f32_32x32x16_bf16 v[96:111], v[48:51], v[60:63], v[96:111]
    ds_read_b128 v[32:35], v8 offset:0
    v_mfma_f32_32x32x16_bf16 v[128:143], v[60:63], v[48:51], v[128:143]
    ds_read_b128 v[36:39], v8 offset:4096
    v_mfma_f32_32x32x16_bf16 v[80:95], v[52:55], v[56:59], v[80:95]
    ds_read_b128 v[40:43], v4 offset:4096
    v_mfma_f32_32x32x16_bf16 v[112:127], v[52:55], v[60:63], v[112:127]
    v_mfma_f32_4x4x4_16b_bf16 v[20:23], v[54:55], v[54:55], v[20:23]
    ds_read_b128 v[44:47], v4 offset:5120
    v_mfma_f32_32x32x16_bf16 v[144:159], v[60:63], v[52:55], v[144:159]
    s_waitcnt lgkmcnt(0)
    v_mfma_f32_32x32x16_bf16 v[64:79], v[32:35], v[40:43], v[64:79]
    v_mfma_f32_4x4x4_16b_bf16 v[20:23], v[36:37], v[36:37], v[20:23]
    v_mfma_f32_32x32x16_bf16 v[96:111], v[32:35], v[44:47], v[96:111]
    ds_read_b128 v[48:51], v9 offset:0
    v_mfma_f32_32x32x16_bf16 v[128:143], v[44:47], v[32:35], v[128:143]
    ds_read_b128 v[52:55], v9 offset:4096
    v_mfma_f32_32x32x16_bf16 v[80:95], v[36:39], v[40:43], v[80:95]
    ds_read_b128 v[56:59], v4 offset:6144
    v_mfma_f32_32x32x16_bf16 v[112:127], v[36:39], v[44:47], v[112:127]
    v_mfma_f32_4x4x4_16b_bf16 v[20:23], v[38:39], v[38:39], v[20:23]
    ds_read_b128 v[60:63], v4 offset:7168
    v_mfma_f32_32x32x16_bf16 v[144:159], v[44:47], v[36:39], v[144:159]
    s_waitcnt vmcnt(16)
    s_barrier
    s_waitcnt lgkmcnt(0)
    v_mfma_f32_32x32x16_bf16 v[64:79], v[48:51], v[56:59], v[64:79]
    v_mfma_f32_4x4x4_16b_bf16 v[20:23], v[52:53], v[52:53], v[20:23]
    s_lshl_b32 s28, s13, 12
    s_add_u32 s28, s28, 98304
    s_mov_b32 m0, s28
    s_add_u32 s29, s24, 896
    buffer_load_dwordx4 v2, s[16:19], s29 offen offset:0 lds
    v_mfma_f32_32x32x16_bf16 v[96:111], v[48:51], v[60:63], v[96:111]
    ds_read_b128 v[32:35], v6 offset:32768
    s_add_u32 s29, s29, 9216
    buffer_load_dwordx4 v3, s[16:19], s29 offen offset:1024 lds
    v_mfma_f32_32x32x16_bf16 v[128:143], v[60:63], v[48:51], v[128:143]
    ds_read_b128 v[36:39], v6 offset:36864
    s_add_u32 s29, s29, 9216
    buffer_load_dwordx4 v2, s[16:19], s29 offen offset:2048 lds
    v_mfma_f32_32x32x16_bf16 v[80:95], v[52:55], v[56:59], v[80:95]
    ds_read_b128 v[40:43], v4 offset:32768
    s_add_u32 s29, s29, 9216
    buffer_load_dwordx4 v3, s[16:19], s29 offen offset:3072 lds
    v_mfma_f32_32x32x16_bf16 v[112:127], v[52:55], v[60:63], v[112:127]
    v_mfma_f32_4x4x4_16b_bf16 v[20:23], v[54:55], v[54:55], v[20:23]
    ds_read_b128 v[44:47], v4 offset:33792
    s_add_u32 s28, s28, 16384
    s_mov_b32 m0, s28
    s_add_u32 s29, s25, 57344
    buffer_load_dwordx4 v1, s[8:11], s29 offen offset:0 lds
    v_mfma_f32_32x32x16_bf16 v[144:159], v[60:63], v[52:55], v[144:159]
    buffer_load_dwordx4 v1, s[8:11], s29 offen offset:1024 lds
    s_waitcnt lgkmcnt(0)
    v_mfma_f32_32x32x16_bf16 v[64:79], v[32:35], v[40:43], v[64:79]
    v_mfma_f32_4x4x4_16b_bf16 v[20:23], v[36:37], v[36:37], v[20:23]
    buffer_load_dwordx4 v1, s[8:11], s29 offen offset:2048 lds
    v_mfma_f32_32x32x16_bf16 v[96:111], v[32:35], v[44:47], v[96:111]
    ds_read_b128 v[48:51], v7 offset:32768
    buffer_load_dwordx4 v1, s[8:11], s29 offen offset:3072 lds
    v_mfma_f32_32x32x16_bf16 v[128:143], v[44:47], v[32:35], v[128:143]
    ds_read_b128 v[52:55], v7 offset:36864
    s_bfe_u32 s41, s52, 524288
    s_mul_i32 s41, s41, s40
    s_add_u32 s42, s58, s41
    s_add_u32 s43, s59, s41
    buffer_load_dwordx4 a[64:67], v240, s[8:11], s42 offen
    v_mfma_f32_32x32x16_bf16 v[80:95], v[36:39], v[40:43], v[80:95]
    ds_read_b128 v[56:59], v4 offset:34816
    buffer_load_dwordx4 a[68:71], v241, s[8:11], s43 offen
    v_mfma_f32_32x32x16_bf16 v[112:127], v[36:39], v[44:47], v[112:127]
    v_mfma_f32_4x4x4_16b_bf16 v[20:23], v[38:39], v[38:39], v[20:23]
    ds_read_b128 v[60:63], v4 offset:35840
    s_bfe_u32 s41, s52, 524296
    s_mul_i32 s41, s41, s40
    s_add_u32 s42, s58, s41
    s_add_u32 s43, s59, s41
    buffer_load_dwordx4 a[72:75], v240, s[8:11], s42 offen
    v_mfma_f32_32x32x16_bf16 v[144:159], v[44:47], v[36:39], v[144:159]
    buffer_load_dwordx4 a[76:79], v241, s[8:11], s43 offen
    s_waitcnt lgkmcnt(0)
    v_mfma_f32_32x32x16_bf16 v[64:79], v[48:51], v[56:59], v[64:79]
    v_mfma_f32_4x4x4_16b_bf16 v[20:23], v[52:53], v[52:53], v[20:23]
    v_mfma_f32_32x32x16_bf16 v[96:111], v[48:51], v[60:63], v[96:111]
    ds_read_b128 v[32:35], v8 offset:32768
    v_mfma_f32_32x32x16_bf16 v[128:143], v[60:63], v[48:51], v[128:143]
    ds_read_b128 v[36:39], v8 offset:36864
    v_mfma_f32_32x32x16_bf16 v[80:95], v[52:55], v[56:59], v[80:95]
    ds_read_b128 v[40:43], v4 offset:36864
    v_mfma_f32_32x32x16_bf16 v[112:127], v[52:55], v[60:63], v[112:127]
    v_mfma_f32_4x4x4_16b_bf16 v[20:23], v[54:55], v[54:55], v[20:23]
    ds_read_b128 v[44:47], v4 offset:37888
    v_mfma_f32_32x32x16_bf16 v[144:159], v[60:63], v[52:55], v[144:159]
    s_waitcnt lgkmcnt(0)
    v_mfma_f32_32x32x16_bf16 v[64:79], v[32:35], v[40:43], v[64:79]
    v_mfma_f32_4x4x4_16b_bf16 v[20:23], v[36:37], v[36:37], v[20:23]
    v_mfma_f32_32x32x16_bf16 v[96:111], v[32:35], v[44:47], v[96:111]
    ds_read_b128 v[48:51], v9 offset:32768
    v_mfma_f32_32x32x16_bf16 v[128:143], v[44:47], v[32:35], v[128:143]
    ds_read_b128 v[52:55], v9 offset:36864
    v_mfma_f32_32x32x16_bf16 v[80:95], v[36:39], v[40:43], v[80:95]
    ds_read_b128 v[56:59], v4 offset:38912
    v_mfma_f32_32x32x16_bf16 v[112:127], v[36:39], v[44:47], v[112:127]
    v_mfma_f32_4x4x4_16b_bf16 v[20:23], v[38:39], v[38:39], v[20:23]
    ds_read_b128 v[60:63], v4 offset:39936
    v_mfma_f32_32x32x16_bf16 v[144:159], v[44:47], v[36:39], v[144:159]
    s_waitcnt vmcnt(16)
    s_barrier
    s_waitcnt lgkmcnt(0)
    v_mfma_f32_32x32x16_bf16 v[64:79], v[48:51], v[56:59], v[64:79]
    v_mfma_f32_4x4x4_16b_bf16 v[20:23], v[52:53], v[52:53], v[20:23]
    s_lshl_b32 s28, s13, 12
    s_mov_b32 m0, s28
    s_add_u32 s29, s24, 1024
    buffer_load_dwordx4 v2, s[16:19], s29 offen offset:0 lds
    v_mfma_f32_32x32x16_bf16 v[96:111], v[48:51], v[60:63], v[96:111]
    ds_read_b128 v[32:35], v10 offset:0
    s_add_u32 s29, s29, 9216
    buffer_load_dwordx4 v3, s[16:19], s29 offen offset:1024 lds
    v_mfma_f32_32x32x16_bf16 v[128:143], v[60:63], v[48:51], v[128:143]
    ds_read_b128 v[36:39], v10 offset:4096
    s_add_u32 s29, s29, 9216
    buffer_load_dwordx4 v2, s[16:19], s29 offen offset:2048 lds
    v_mfma_f32_32x32x16_bf16 v[80:95], v[52:55], v[56:59], v[80:95]
    ds_read_b128 v[40:43], v5 offset:0
    s_add_u32 s29, s29, 9216
    buffer_load_dwordx4 v3, s[16:19], s29 offen offset:3072 lds
    v_mfma_f32_32x32x16_bf16 v[112:127], v[52:55], v[60:63], v[112:127]
    v_mfma_f32_4x4x4_16b_bf16 v[20:23], v[54:55], v[54:55], v[20:23]
    ds_read_b128 v[44:47], v5 offset:1024
    s_add_u32 s28, s28, 16384
    s_mov_b32 m0, s28
    s_add_u32 s29, s25, 65536
    buffer_load_dwordx4 v1, s[8:11], s29 offen offset:0 lds
    v_mfma_f32_32x32x16_bf16 v[144:159], v[60:63], v[52:55], v[144:159]
    buffer_load_dwordx4 v1, s[8:11], s29 offen offset:1024 lds
    s_waitcnt lgkmcnt(0)
    v_mfma_f32_32x32x16_bf16 v[64:79], v[32:35], v[40:43], v[64:79]
    v_mfma_f32_4x4x4_16b_bf16 v[20:23], v[36:37], v[36:37], v[20:23]
    buffer_load_dwordx4 v1, s[8:11], s29 offen offset:2048 lds
    v_mfma_f32_32x32x16_bf16 v[96:111], v[32:35], v[44:47], v[96:111]
    ds_read_b128 v[48:51], v11 offset:0
    buffer_load_dwordx4 v1, s[8:11], s29 offen offset:3072 lds
    v_mfma_f32_32x32x16_bf16 v[128:143], v[44:47], v[32:35], v[128:143]
    ds_read_b128 v[52:55], v11 offset:4096
    s_bfe_u32 s41, s52, 524304
    s_mul_i32 s41, s41, s40
    s_add_u32 s42, s58, s41
    s_add_u32 s43, s59, s41
    buffer_load_dwordx4 a[80:83], v240, s[8:11], s42 offen
    v_mfma_f32_32x32x16_bf16 v[80:95], v[36:39], v[40:43], v[80:95]
    ds_read_b128 v[56:59], v5 offset:2048
    buffer_load_dwordx4 a[84:87], v241, s[8:11], s43 offen
    v_mfma_f32_32x32x16_bf16 v[112:127], v[36:39], v[44:47], v[112:127]
    v_mfma_f32_4x4x4_16b_bf16 v[20:23], v[38:39], v[38:39], v[20:23]
    ds_read_b128 v[60:63], v5 offset:3072
    s_bfe_u32 s41, s52, 524312
    s_mul_i32 s41, s41, s40
    s_add_u32 s42, s58, s41
    s_add_u32 s43, s59, s41
    buffer_load_dwordx4 a[88:91], v240, s[8:11], s42 offen
    v_mfma_f32_32x32x16_bf16 v[144:159], v[44:47], v[36:39], v[144:159]
    buffer_load_dwordx4 a[92:95], v241, s[8:11], s43 offen
    s_waitcnt lgkmcnt(0)
    v_mfma_f32_32x32x16_bf16 v[64:79], v[48:51], v[56:59], v[64:79]
    v_mfma_f32_4x4x4_16b_bf16 v[20:23], v[52:53], v[52:53], v[20:23]
    v_mfma_f32_32x32x16_bf16 v[96:111], v[48:51], v[60:63], v[96:111]
    ds_read_b128 v[32:35], v12 offset:0
    v_mfma_f32_32x32x16_bf16 v[128:143], v[60:63], v[48:51], v[128:143]
    ds_read_b128 v[36:39], v12 offset:4096
    v_mfma_f32_32x32x16_bf16 v[80:95], v[52:55], v[56:59], v[80:95]
    ds_read_b128 v[40:43], v5 offset:4096
    v_mfma_f32_32x32x16_bf16 v[112:127], v[52:55], v[60:63], v[112:127]
    v_mfma_f32_4x4x4_16b_bf16 v[20:23], v[54:55], v[54:55], v[20:23]
    ds_read_b128 v[44:47], v5 offset:5120
    v_mfma_f32_32x32x16_bf16 v[144:159], v[60:63], v[52:55], v[144:159]
    s_waitcnt lgkmcnt(0)
    v_mfma_f32_32x32x16_bf16 v[64:79], v[32:35], v[40:43], v[64:79]
    v_mfma_f32_4x4x4_16b_bf16 v[20:23], v[36:37], v[36:37], v[20:23]
    v_mfma_f32_32x32x16_bf16 v[96:111], v[32:35], v[44:47], v[96:111]
    ds_read_b128 v[48:51], v13 offset:0
    v_mfma_f32_32x32x16_bf16 v[128:143], v[44:47], v[32:35], v[128:143]
    ds_read_b128 v[52:55], v13 offset:4096
    v_mfma_f32_32x32x16_bf16 v[80:95], v[36:39], v[40:43], v[80:95]
    ds_read_b128 v[56:59], v5 offset:6144
    v_mfma_f32_32x32x16_bf16 v[112:127], v[36:39], v[44:47], v[112:127]
    v_mfma_f32_4x4x4_16b_bf16 v[20:23], v[38:39], v[38:39], v[20:23]
    ds_read_b128 v[60:63], v5 offset:7168
    v_mfma_f32_32x32x16_bf16 v[144:159], v[44:47], v[36:39], v[144:159]
    s_waitcnt vmcnt(16)
    s_barrier
    s_waitcnt lgkmcnt(0)
    v_mfma_f32_32x32x16_bf16 v[64:79], v[48:51], v[56:59], v[64:79]
    v_mfma_f32_4x4x4_16b_bf16 v[20:23], v[52:53], v[52:53], v[20:23]
    s_lshl_b32 s28, s13, 12
    s_add_u32 s28, s28, 32768
    s_mov_b32 m0, s28
    s_add_u32 s29, s24, 1152
    buffer_load_dwordx4 v2, s[16:19], s29 offen offset:0 lds
    v_mfma_f32_32x32x16_bf16 v[96:111], v[48:51], v[60:63], v[96:111]
    ds_read_b128 v[32:35], v10 offset:32768
    s_add_u32 s29, s29, 9216
    buffer_load_dwordx4 v3, s[16:19], s29 offen offset:1024 lds
    v_mfma_f32_32x32x16_bf16 v[128:143], v[60:63], v[48:51], v[128:143]
    ds_read_b128 v[36:39], v10 offset:36864
    s_add_u32 s29, s29, 9216
    buffer_load_dwordx4 v2, s[16:19], s29 offen offset:2048 lds
    v_mfma_f32_32x32x16_bf16 v[80:95], v[52:55], v[56:59], v[80:95]
    ds_read_b128 v[40:43], v5 offset:32768
    s_add_u32 s29, s29, 9216
    buffer_load_dwordx4 v3, s[16:19], s29 offen offset:3072 lds
    v_mfma_f32_32x32x16_bf16 v[112:127], v[52:55], v[60:63], v[112:127]
    v_mfma_f32_4x4x4_16b_bf16 v[20:23], v[54:55], v[54:55], v[20:23]
    ds_read_b128 v[44:47], v5 offset:33792
    s_add_u32 s28, s28, 16384
    s_mov_b32 m0, s28
    s_add_u32 s29, s25, 73728
    buffer_load_dwordx4 v1, s[8:11], s29 offen offset:0 lds
    v_mfma_f32_32x32x16_bf16 v[144:159], v[60:63], v[52:55], v[144:159]
    buffer_load_dwordx4 v1, s[8:11], s29 offen offset:1024 lds
    s_waitcnt lgkmcnt(0)
    v_mfma_f32_32x32x16_bf16 v[64:79], v[32:35], v[40:43], v[64:79]
    v_mfma_f32_4x4x4_16b_bf16 v[20:23], v[36:37], v[36:37], v[20:23]
    buffer_load_dwordx4 v1, s[8:11], s29 offen offset:2048 lds
    v_mfma_f32_32x32x16_bf16 v[96:111], v[32:35], v[44:47], v[96:111]
    ds_read_b128 v[48:51], v11 offset:32768
    buffer_load_dwordx4 v1, s[8:11], s29 offen offset:3072 lds
    v_mfma_f32_32x32x16_bf16 v[128:143], v[44:47], v[32:35], v[128:143]
    ds_read_b128 v[52:55], v11 offset:36864
    s_bfe_u32 s41, s53, 524288
    s_mul_i32 s41, s41, s40
    s_add_u32 s42, s58, s41
    s_add_u32 s43, s59, s41
    buffer_load_dwordx4 a[96:99], v240, s[8:11], s42 offen
    v_mfma_f32_32x32x16_bf16 v[80:95], v[36:39], v[40:43], v[80:95]
    ds_read_b128 v[56:59], v5 offset:34816
    buffer_load_dwordx4 a[100:103], v241, s[8:11], s43 offen
    v_mfma_f32_32x32x16_bf16 v[112:127], v[36:39], v[44:47], v[112:127]
    v_mfma_f32_4x4x4_16b_bf16 v[20:23], v[38:39], v[38:39], v[20:23]
    ds_read_b128 v[60:63], v5 offset:35840
    s_bfe_u32 s41, s53, 524296
    s_mul_i32 s41, s41, s40
    s_add_u32 s42, s58, s41
    s_add_u32 s43, s59, s41
    buffer_load_dwordx4 a[104:107], v240, s[8:11], s42 offen
    v_mfma_f32_32x32x16_bf16 v[144:159], v[44:47], v[36:39], v[144:159]
    buffer_load_dwordx4 a[108:111], v241, s[8:11], s43 offen
    s_waitcnt lgkmcnt(0)
    v_mfma_f32_32x32x16_bf16 v[64:79], v[48:51], v[56:59], v[64:79]
    v_mfma_f32_4x4x4_16b_bf16 v[20:23], v[52:53], v[52:53], v[20:23]
    v_mfma_f32_32x32x16_bf16 v[96:111], v[48:51], v[60:63], v[96:111]
    ds_read_b128 v[32:35], v12 offset:32768
    v_mfma_f32_32x32x16_bf16 v[128:143], v[60:63], v[48:51], v[128:143]
    ds_read_b128 v[36:39], v12 offset:36864
    v_mfma_f32_32x32x16_bf16 v[80:95], v[52:55], v[56:59], v[80:95]
    ds_read_b128 v[40:43], v5 offset:36864
    v_mfma_f32_32x32x16_bf16 v[112:127], v[52:55], v[60:63], v[112:127]
    v_mfma_f32_4x4x4_16b_bf16 v[20:23], v[54:55], v[54:55], v[20:23]
    ds_read_b128 v[44:47], v5 offset:37888
    v_mfma_f32_32x32x16_bf16 v[144:159], v[60:63], v[52:55], v[144:159]
    s_waitcnt lgkmcnt(0)
    v_mfma_f32_32x32x16_bf16 v[64:79], v[32:35], v[40:43], v[64:79]
    v_mfma_f32_4x4x4_16b_bf16 v[20:23], v[36:37], v[36:37], v[20:23]
    v_mfma_f32_32x32x16_bf16 v[96:111], v[32:35], v[44:47], v[96:111]
    ds_read_b128 v[48:51], v13 offset:32768
    v_mfma_f32_32x32x16_bf16 v[128:143], v[44:47], v[32:35], v[128:143]
    ds_read_b128 v[52:55], v13 offset:36864
    v_mfma_f32_32x32x16_bf16 v[80:95], v[36:39], v[40:43], v[80:95]
    ds_read_b128 v[56:59], v5 offset:38912
    v_mfma_f32_32x32x16_bf16 v[112:127], v[36:39], v[44:47], v[112:127]
    v_mfma_f32_4x4x4_16b_bf16 v[20:23], v[38:39], v[38:39], v[20:23]
    ds_read_b128 v[60:63], v5 offset:39936
    v_mfma_f32_32x32x16_bf16 v[144:159], v[44:47], v[36:39], v[144:159]
    s_waitcnt vmcnt(16)
    s_barrier
    s_waitcnt lgkmcnt(0)
    v_mfma_f32_32x32x16_bf16 v[64:79], v[48:51], v[56:59], v[64:79]
    v_mfma_f32_4x4x4_16b_bf16 v[20:23], v[52:53], v[52:53], v[20:23]
    s_bfe_u32 s41, s53, 524304
    s_mul_i32 s41, s41, s40
    s_add_u32 s42, s58, s41
    s_add_u32 s43, s59, s41
    buffer_load_dwordx4 a[112:115], v240, s[8:11], s42 offen
    v_mfma_f32_32x32x16_bf16 v[96:111], v[48:51], v[60:63], v[96:111]
    ds_read_b128 v[32:35], v6 offset:0
    buffer_load_dwordx4 a[116:119], v241, s[8:11], s43 offen
    v_mfma_f32_32x32x16_bf16 v[128:143], v[60:63], v[48:51], v[128:143]
    ds_read_b128 v[36:39], v6 offset:4096
    s_bfe_u32 s41, s53, 524312
    s_mul_i32 s41, s41, s40
    s_add_u32 s42, s58, s41
    s_add_u32 s43, s59, s41
    buffer_load_dwordx4 a[120:123], v240, s[8:11], s42 offen
    v_mfma_f32_32x32x16_bf16 v[80:95], v[52:55], v[56:59], v[80:95]
    ds_read_b128 v[40:43], v4 offset:0
    buffer_load_dwordx4 a[124:127], v241, s[8:11], s43 offen
    v_mfma_f32_32x32x16_bf16 v[112:127], v[52:55], v[60:63], v[112:127]
    v_mfma_f32_4x4x4_16b_bf16 v[20:23], v[54:55], v[54:55], v[20:23]
    ds_read_b128 v[44:47], v4 offset:1024
    v_mfma_f32_32x32x16_bf16 v[144:159], v[60:63], v[52:55], v[144:159]
    s_waitcnt lgkmcnt(0)
    v_mfma_f32_32x32x16_bf16 v[64:79], v[32:35], v[40:43], v[64:79]
    v_mfma_f32_4x4x4_16b_bf16 v[20:23], v[36:37], v[36:37], v[20:23]
    v_mfma_f32_32x32x16_bf16 v[96:111], v[32:35], v[44:47], v[96:111]
    ds_read_b128 v[48:51], v7 offset:0
    v_mfma_f32_32x32x16_bf16 v[128:143], v[44:47], v[32:35], v[128:143]
    ds_read_b128 v[52:55], v7 offset:4096
    v_mfma_f32_32x32x16_bf16 v[80:95], v[36:39], v[40:43], v[80:95]
    ds_read_b128 v[56:59], v4 offset:2048
    v_mfma_f32_32x32x16_bf16 v[112:127], v[36:39], v[44:47], v[112:127]
    v_mfma_f32_4x4x4_16b_bf16 v[20:23], v[38:39], v[38:39], v[20:23]
    ds_read_b128 v[60:63], v4 offset:3072
    v_mfma_f32_32x32x16_bf16 v[144:159], v[44:47], v[36:39], v[144:159]
    s_waitcnt lgkmcnt(0)
    v_mfma_f32_32x32x16_bf16 v[64:79], v[48:51], v[56:59], v[64:79]
    v_mfma_f32_4x4x4_16b_bf16 v[20:23], v[52:53], v[52:53], v[20:23]
    v_mfma_f32_32x32x16_bf16 v[96:111], v[48:51], v[60:63], v[96:111]
    ds_read_b128 v[32:35], v8 offset:0
    v_mfma_f32_32x32x16_bf16 v[128:143], v[60:63], v[48:51], v[128:143]
    ds_read_b128 v[36:39], v8 offset:4096
    v_mfma_f32_32x32x16_bf16 v[80:95], v[52:55], v[56:59], v[80:95]
    ds_read_b128 v[40:43], v4 offset:4096
    v_mfma_f32_32x32x16_bf16 v[112:127], v[52:55], v[60:63], v[112:127]
    v_mfma_f32_4x4x4_16b_bf16 v[20:23], v[54:55], v[54:55], v[20:23]
    ds_read_b128 v[44:47], v4 offset:5120
    v_mfma_f32_32x32x16_bf16 v[144:159], v[60:63], v[52:55], v[144:159]
    s_waitcnt lgkmcnt(0)
    v_mfma_f32_32x32x16_bf16 v[64:79], v[32:35], v[40:43], v[64:79]
    v_mfma_f32_4x4x4_16b_bf16 v[20:23], v[36:37], v[36:37], v[20:23]
    v_mfma_f32_32x32x16_bf16 v[96:111], v[32:35], v[44:47], v[96:111]
    ds_read_b128 v[48:51], v9 offset:0
    v_mfma_f32_32x32x16_bf16 v[128:143], v[44:47], v[32:35], v[128:143]
    ds_read_b128 v[52:55], v9 offset:4096
    v_mfma_f32_32x32x16_bf16 v[80:95], v[36:39], v[40:43], v[80:95]
    ds_read_b128 v[56:59], v4 offset:6144
    v_mfma_f32_32x32x16_bf16 v[112:127], v[36:39], v[44:47], v[112:127]
    v_mfma_f32_4x4x4_16b_bf16 v[20:23], v[38:39], v[38:39], v[20:23]
    ds_read_b128 v[60:63], v4 offset:7168
    v_mfma_f32_32x32x16_bf16 v[144:159], v[44:47], v[36:39], v[144:159]
    s_waitcnt vmcnt(8)
    s_barrier
    s_waitcnt lgkmcnt(0)
    v_mfma_f32_32x32x16_bf16 v[64:79], v[48:51], v[56:59], v[64:79]
    v_mfma_f32_4x4x4_16b_bf16 v[20:23], v[52:53], v[52:53], v[20:23]
    s_bfe_u32 s41, s54, 524288
    s_mul_i32 s41, s41, s40
    s_add_u32 s42, s58, s41
    s_add_u32 s43, s59, s41
    buffer_load_dwordx4 a[128:131], v240, s[8:11], s42 offen
    v_mfma_f32_32x32x16_bf16 v[96:111], v[48:51], v[60:63], v[96:111]
    ds_read_b128 v[32:35], v6 offset:32768
    buffer_load_dwordx4 a[132:135], v241, s[8:11], s43 offen
    v_mfma_f32_32x32x16_bf16 v[128:143], v[60:63], v[48:51], v[128:143]
    ds_read_b128 v[36:39], v6 offset:36864
    v_mfma_f32_32x32x16_bf16 v[80:95], v[52:55], v[56:59], v[80:95]
    ds_read_b128 v[40:43], v4 offset:32768
    v_mfma_f32_32x32x16_bf16 v[112:127], v[52:55], v[60:63], v[112:127]
    v_mfma_f32_4x4x4_16b_bf16 v[20:23], v[54:55], v[54:55], v[20:23]
    ds_read_b128 v[44:47], v4 offset:33792
    v_mfma_f32_32x32x16_bf16 v[144:159], v[60:63], v[52:55], v[144:159]
    s_waitcnt lgkmcnt(0)
    v_mfma_f32_32x32x16_bf16 v[64:79], v[32:35], v[40:43], v[64:79]
    v_mfma_f32_4x4x4_16b_bf16 v[20:23], v[36:37], v[36:37], v[20:23]
    v_mfma_f32_32x32x16_bf16 v[96:111], v[32:35], v[44:47], v[96:111]
    ds_read_b128 v[48:51], v7 offset:32768
    v_mfma_f32_32x32x16_bf16 v[128:143], v[44:47], v[32:35], v[128:143]
    ds_read_b128 v[52:55], v7 offset:36864
    v_mfma_f32_32x32x16_bf16 v[80:95], v[36:39], v[40:43], v[80:95]
    ds_read_b128 v[56:59], v4 offset:34816
    v_mfma_f32_32x32x16_bf16 v[112:127], v[36:39], v[44:47], v[112:127]
    v_mfma_f32_4x4x4_16b_bf16 v[20:23], v[38:39], v[38:39], v[20:23]
    ds_read_b128 v[60:63], v4 offset:35840
    v_mfma_f32_32x32x16_bf16 v[144:159], v[44:47], v[36:39], v[144:159]
    s_waitcnt lgkmcnt(0)
    v_mfma_f32_32x32x16_bf16 v[64:79], v[48:51], v[56:59], v[64:79]
    v_mfma_f32_4x4x4_16b_bf16 v[20:23], v[52:53], v[52:53], v[20:23]
    v_mfma_f32_32x32x16_bf16 v[96:111], v[48:51], v[60:63], v[96:111]
    ds_read_b128 v[32:35], v8 offset:32768
    v_mfma_f32_32x32x16_bf16 v[128:143], v[60:63], v[48:51], v[128:143]
    ds_read_b128 v[36:39], v8 offset:36864
    v_mfma_f32_32x32x16_bf16 v[80:95], v[52:55], v[56:59], v[80:95]
    ds_read_b128 v[40:43], v4 offset:36864
    v_mfma_f32_32x32x16_bf16 v[112:127], v[52:55], v[60:63], v[112:127]
    v_mfma_f32_4x4x4_16b_bf16 v[20:23], v[54:55], v[54:55], v[20:23]
    ds_read_b128 v[44:47], v4 offset:37888
    v_mfma_f32_32x32x16_bf16 v[144:159], v[60:63], v[52:55], v[144:159]
    s_waitcnt lgkmcnt(0)
    v_mfma_f32_32x32x16_bf16 v[64:79], v[32:35], v[40:43], v[64:79]
    v_mfma_f32_4x4x4_16b_bf16 v[20:23], v[36:37], v[36:37], v[20:23]
    v_mfma_f32_32x32x16_bf16 v[96:111], v[32:35], v[44:47], v[96:111]
    ds_read_b128 v[48:51], v9 offset:32768
    v_mfma_f32_32x32x16_bf16 v[128:143], v[44:47], v[32:35], v[128:143]
    ds_read_b128 v[52:55], v9 offset:36864
    v_mfma_f32_32x32x16_bf16 v[80:95], v[36:39], v[40:43], v[80:95]
    ds_read_b128 v[56:59], v4 offset:38912
    v_mfma_f32_32x32x16_bf16 v[112:127], v[36:39], v[44:47], v[112:127]
    v_mfma_f32_4x4x4_16b_bf16 v[20:23], v[38:39], v[38:39], v[20:23]
    ds_read_b128 v[60:63], v4 offset:39936
    v_mfma_f32_32x32x16_bf16 v[144:159], v[44:47], v[36:39], v[144:159]
    s_waitcnt lgkmcnt(0)
    v_mfma_f32_32x32x16_bf16 v[64:79], v[48:51], v[56:59], v[64:79]
    v_mfma_f32_4x4x4_16b_bf16 v[20:23], v[52:53], v[52:53], v[20:23]
    s_bfe_u32 s41, s54, 524296
    s_mul_i32 s41, s41, s40
    s_add_u32 s42, s58, s41
    s_add_u32 s43, s59, s41
    buffer_load_dwordx4 a[136:139], v240, s[8:11], s42 offen
    v_mfma_f32_32x32x16_bf16 v[96:111], v[48:51], v[60:63], v[96:111]
    buffer_load_dwordx4 a[140:143], v241, s[8:11], s43 offen
    v_mfma_f32_32x32x16_bf16 v[128:143], v[60:63], v[48:51], v[128:143]
    v_mfma_f32_32x32x16_bf16 v[80:95], v[52:55], v[56:59], v[80:95]
    v_mfma_f32_32x32x16_bf16 v[112:127], v[52:55], v[60:63], v[112:127]
    v_mfma_f32_4x4x4_16b_bf16 v[20:23], v[54:55], v[54:55], v[20:23]
    v_mfma_f32_32x32x16_bf16 v[144:159], v[60:63], v[52:55], v[144:159]
layerb1_kernel_af_epi:
    s_cmp_eq_u32 s44, 2
    s_cbranch_scc1 layerb1_kernel_pf_post
    s_bfe_u32 s41, s54, 524304
    s_mul_i32 s41, s41, s40
    s_add_u32 s42, s58, s41
    s_add_u32 s43, s59, s41
    buffer_load_dwordx4 a[144:147], v240, s[8:11], s42 offen
    buffer_load_dwordx4 a[148:151], v241, s[8:11], s43 offen
    s_bfe_u32 s41, s54, 524312
    s_mul_i32 s41, s41, s40
    s_add_u32 s42, s58, s41
    s_add_u32 s43, s59, s41
    buffer_load_dwordx4 a[152:155], v240, s[8:11], s42 offen
    buffer_load_dwordx4 a[156:159], v241, s[8:11], s43 offen
    s_bfe_u32 s41, s55, 524288
    s_mul_i32 s41, s41, s40
    s_add_u32 s42, s58, s41
    s_add_u32 s43, s59, s41
    buffer_load_dwordx4 a[160:163], v240, s[8:11], s42 offen
    buffer_load_dwordx4 a[164:167], v241, s[8:11], s43 offen
    s_bfe_u32 s41, s55, 524296
    s_mul_i32 s41, s41, s40
    s_add_u32 s42, s58, s41
    s_add_u32 s43, s59, s41
    buffer_load_dwordx4 a[168:171], v240, s[8:11], s42 offen
    buffer_load_dwordx4 a[172:175], v241, s[8:11], s43 offen
    s_bfe_u32 s41, s55, 524304
    s_mul_i32 s41, s41, s40
    s_add_u32 s42, s58, s41
    s_add_u32 s43, s59, s41
    buffer_load_dwordx4 a[176:179], v240, s[8:11], s42 offen
    buffer_load_dwordx4 a[180:183], v241, s[8:11], s43 offen
    s_bfe_u32 s41, s55, 524312
    s_mul_i32 s41, s41, s40
    s_add_u32 s42, s58, s41
    s_add_u32 s43, s59, s41
    buffer_load_dwordx4 a[184:187], v240, s[8:11], s42 offen
    buffer_load_dwordx4 a[188:191], v241, s[8:11], s43 offen
layerb1_kernel_pf_post:
    s_mov_b32 s32, 0x22222222
    s_mov_b32 s33, 0x22222222
    s_mov_b32 s34, 0x44444444
    s_mov_b32 s35, 0x44444444
    s_mov_b32 s36, 0x88888888
    s_mov_b32 s37, 0x88888888
    s_cmp_eq_u32 s23, 1
    s_cselect_b64 vcc, -1, 0
    v_cndmask_b32 v20, v20, v21, s[32:33]
    v_cndmask_b32 v20, v20, v22, s[34:35]
    v_cndmask_b32 v20, v20, v23, s[36:37]
    v_mov_b32 v22, v20
    s_nop 1
    v_permlane32_swap_b32 v20, v22
    v_add_f32 v22, v20, v22
    v_cndmask_b32 v20, v133, v149, vcc
    v_mul_f32 v20, 0x3acccccd, v20
    v_mul_f32 v21, v20, v20
    v_mul_f32 v22, 0x3acccccd, v22
    v_sub_f32 v22, v22, v21
    v_max_f32 v22, 0, v22
    v_add_f32 v22, 0x3727c5ac, v22
    v_rsq_f32 v22, v22
    v_and_b32 v16, 31, v0
    s_lshl_b32 s28, s13, 7
    s_add_u32 s28, s28, 65536
    v_lshl_add_u32 v17, v16, 2, s28
    s_mov_b32 exec_hi, 0
    ds_write_b32 v17, v22
    s_mov_b32 exec_hi, -1
    s_waitcnt lgkmcnt(0)
    s_barrier
    s_lshl_b32 s28, s22, 8
    s_add_u32 s28, s28, 65536
    v_lshl_add_u32 v17, v16, 2, s28
    v_lshrrev_b32 v18, 5, v0
    v_lshlrev_b32 v18, 4, v18
    v_add_u32 v18, s28, v18
    ds_read_b32 v224, v17 offset:0
    ds_read_b128 v[192:195], v18 offset:0
    ds_read_b128 v[196:199], v18 offset:32
    ds_read_b128 v[200:203], v18 offset:64
    ds_read_b128 v[204:207], v18 offset:96
    ds_read_b32 v225, v17 offset:128
    ds_read_b128 v[208:211], v18 offset:128
    ds_read_b128 v[212:215], v18 offset:160
    ds_read_b128 v[216:219], v18 offset:192
    ds_read_b128 v[220:223], v18 offset:224
    v_and_b32 v16, 31, v0
    v_mov_b32 v228, 0x358637bd
    v_cmp_gt_u32 vcc, 20, v16
    s_mov_b64 s[30:31], vcc
    s_nop 0
    v_cndmask_b32 v226, 0, v228, vcc
    v_cmp_eq_u32 vcc, 8, v16
    s_nop 1
    v_cndmask_b32 v227, 0, 1.0, vcc
    s_waitcnt lgkmcnt(0)
    v_fma_f32 v64, v64, v192, v226
    v_mul_f32 v48, 0x3fb8aa3b, v64
    v_exp_f32 v48, v48 clamp
    v_max_f32 v49, v64, v228
    v_fma_f32 v96, v96, v192, v227
    v_add_f32 v48, v48, v49
    v_cndmask_b32 v64, v64, v48, s[30:31]
    v_fma_f32 v65, v65, v193, v226
    v_mul_f32 v50, 0x3fb8aa3b, v65
    v_exp_f32 v50, v50 clamp
    v_max_f32 v51, v65, v228
    v_fma_f32 v97, v97, v193, v227
    v_add_f32 v50, v50, v51
    v_cndmask_b32 v65, v65, v50, s[30:31]
    v_fma_f32 v66, v66, v194, v226
    v_mul_f32 v52, 0x3fb8aa3b, v66
    v_exp_f32 v52, v52 clamp
    v_max_f32 v53, v66, v228
    v_fma_f32 v98, v98, v194, v227
    v_add_f32 v52, v52, v53
    v_cndmask_b32 v66, v66, v52, s[30:31]
    v_fma_f32 v67, v67, v195, v226
    v_mul_f32 v54, 0x3fb8aa3b, v67
    v_exp_f32 v54, v54 clamp
    v_max_f32 v55, v67, v228
    v_fma_f32 v99, v99, v195, v227
    v_add_f32 v54, v54, v55
    v_cndmask_b32 v67, v67, v54, s[30:31]
    v_fma_f32 v68, v68, v196, v226
    v_mul_f32 v48, 0x3fb8aa3b, v68
    v_exp_f32 v48, v48 clamp
    v_max_f32 v49, v68, v228
    v_fma_f32 v100, v100, v196, v227
    v_add_f32 v48, v48, v49
    v_cndmask_b32 v68, v68, v48, s[30:31]
    v_fma_f32 v69, v69, v197, v226
    v_mul_f32 v50, 0x3fb8aa3b, v69
    v_exp_f32 v50, v50 clamp
    v_max_f32 v51, v69, v228
    v_fma_f32 v101, v101, v197, v227
    v_add_f32 v50, v50, v51
    v_cndmask_b32 v69, v69, v50, s[30:31]
    v_fma_f32 v70, v70, v198, v226
    v_mul_f32 v52, 0x3fb8aa3b, v70
    v_exp_f32 v52, v52 clamp
    v_max_f32 v53, v70, v228
    v_fma_f32 v102, v102, v198, v227
    v_add_f32 v52, v52, v53
    v_cndmask_b32 v70, v70, v52, s[30:31]
    v_fma_f32 v71, v71, v199, v226
    v_mul_f32 v54, 0x3fb8aa3b, v71
    v_exp_f32 v54, v54 clamp
    v_max_f32 v55, v71, v228
    v_fma_f32 v103, v103, v199, v227
    v_add_f32 v54, v54, v55
    v_cndmask_b32 v71, v71, v54, s[30:31]
    v_fma_f32 v72, v72, v200, v226
    v_mul_f32 v48, 0x3fb8aa3b, v72
    v_exp_f32 v48, v48 clamp
    v_max_f32 v49, v72, v228
    v_fma_f32 v104, v104, v200, v227
    v_add_f32 v48, v48, v49
    v_cndmask_b32 v72, v72, v48, s[30:31]
    v_fma_f32 v73, v73, v201, v226
    v_mul_f32 v50, 0x3fb8aa3b, v73
    v_exp_f32 v50, v50 clamp
    v_max_f32 v51, v73, v228
    v_fma_f32 v105, v105, v201, v227
    v_add_f32 v50, v50, v51
    v_cndmask_b32 v73, v73, v50, s[30:31]
    v_fma_f32 v74, v74, v202, v226
    v_mul_f32 v52, 0x3fb8aa3b, v74
    v_exp_f32 v52, v52 clamp
    v_max_f32 v53, v74, v228
    v_fma_f32 v106, v106, v202, v227
    v_add_f32 v52, v52, v53
    v_cndmask_b32 v74, v74, v52, s[30:31]
    v_fma_f32 v75, v75, v203, v226
    v_mul_f32 v54, 0x3fb8aa3b, v75
    v_exp_f32 v54, v54 clamp
    v_max_f32 v55, v75, v228
    v_fma_f32 v107, v107, v203, v227
    v_add_f32 v54, v54, v55
    v_cndmask_b32 v75, v75, v54, s[30:31]
    v_fma_f32 v76, v76, v204, v226
    v_mul_f32 v48, 0x3fb8aa3b, v76
    v_exp_f32 v48, v48 clamp
    v_max_f32 v49, v76, v228
    v_fma_f32 v108, v108, v204, v227
    v_add_f32 v48, v48, v49
    v_cndmask_b32 v76, v76, v48, s[30:31]
    v_fma_f32 v77, v77, v205, v226
    v_mul_f32 v50, 0x3fb8aa3b, v77
    v_exp_f32 v50, v50 clamp
    v_max_f32 v51, v77, v228
    v_fma_f32 v109, v109, v205, v227
    v_add_f32 v50, v50, v51
    v_cndmask_b32 v77, v77, v50, s[30:31]
    v_fma_f32 v78, v78, v206, v226
    v_mul_f32 v52, 0x3fb8aa3b, v78
    v_exp_f32 v52, v52 clamp
    v_max_f32 v53, v78, v228
    v_fma_f32 v110, v110, v206, v227
    v_add_f32 v52, v52, v53
    v_cndmask_b32 v78, v78, v52, s[30:31]
    v_fma_f32 v79, v79, v207, v226
    v_mul_f32 v54, 0x3fb8aa3b, v79
    v_exp_f32 v54, v54 clamp
    v_max_f32 v55, v79, v228
    v_fma_f32 v111, v111, v207, v227
    v_add_f32 v54, v54, v55
    v_cndmask_b32 v79, v79, v54, s[30:31]
    v_cvt_pk_bf16_f32 v32, v64, v65
    v_cvt_pk_bf16_f32 v40, v96, v97
    v_cvt_pk_bf16_f32 v33, v66, v67
    v_cvt_pk_bf16_f32 v41, v98, v99
    v_cvt_pk_bf16_f32 v34, v68, v69
    v_cvt_pk_bf16_f32 v42, v100, v101
    v_cvt_pk_bf16_f32 v35, v70, v71
    v_cvt_pk_bf16_f32 v43, v102, v103
    v_cvt_pk_bf16_f32 v36, v72, v73
    v_cvt_pk_bf16_f32 v44, v104, v105
    v_cvt_pk_bf16_f32 v37, v74, v75
    v_cvt_pk_bf16_f32 v45, v106, v107
    v_cvt_pk_bf16_f32 v38, v76, v77
    v_cvt_pk_bf16_f32 v46, v108, v109
    v_cvt_pk_bf16_f32 v39, v78, v79
    v_cvt_pk_bf16_f32 v47, v110, v111
    s_nop 1
    v_mfma_f32_32x32x16_bf16 v[160:175], v[32:35], v[32:35], 0
    v_mfma_f32_32x32x16_bf16 v[176:191], v[40:43], v[32:35], 0
    v_mfma_f32_32x32x16_bf16 v[160:175], v[36:39], v[36:39], v[160:175]
    v_mfma_f32_32x32x16_bf16 v[176:191], v[44:47], v[36:39], v[176:191]
    v_fma_f32 v80, v80, v208, v226
    v_mul_f32 v48, 0x3fb8aa3b, v80
    v_exp_f32 v48, v48 clamp
    v_max_f32 v49, v80, v228
    v_fma_f32 v112, v112, v208, v227
    v_add_f32 v48, v48, v49
    v_cndmask_b32 v80, v80, v48, s[30:31]
    v_fma_f32 v81, v81, v209, v226
    v_mul_f32 v50, 0x3fb8aa3b, v81
    v_exp_f32 v50, v50 clamp
    v_max_f32 v51, v81, v228
    v_fma_f32 v113, v113, v209, v227
    v_add_f32 v50, v50, v51
    v_cndmask_b32 v81, v81, v50, s[30:31]
    v_fma_f32 v82, v82, v210, v226
    v_mul_f32 v52, 0x3fb8aa3b, v82
    v_exp_f32 v52, v52 clamp
    v_max_f32 v53, v82, v228
    v_fma_f32 v114, v114, v210, v227
    v_add_f32 v52, v52, v53
    v_cndmask_b32 v82, v82, v52, s[30:31]
    v_fma_f32 v83, v83, v211, v226
    v_mul_f32 v54, 0x3fb8aa3b, v83
    v_exp_f32 v54, v54 clamp
    v_max_f32 v55, v83, v228
    v_fma_f32 v115, v115, v211, v227
    v_add_f32 v54, v54, v55
    v_cndmask_b32 v83, v83, v54, s[30:31]
    v_fma_f32 v84, v84, v212, v226
    v_mul_f32 v48, 0x3fb8aa3b, v84
    v_exp_f32 v48, v48 clamp
    v_max_f32 v49, v84, v228
    v_fma_f32 v116, v116, v212, v227
    v_add_f32 v48, v48, v49
    v_cndmask_b32 v84, v84, v48, s[30:31]
    v_fma_f32 v85, v85, v213, v226
    v_mul_f32 v50, 0x3fb8aa3b, v85
    v_exp_f32 v50, v50 clamp
    v_max_f32 v51, v85, v228
    v_fma_f32 v117, v117, v213, v227
    v_add_f32 v50, v50, v51
    v_cndmask_b32 v85, v85, v50, s[30:31]
    v_fma_f32 v86, v86, v214, v226
    v_mul_f32 v52, 0x3fb8aa3b, v86
    v_exp_f32 v52, v52 clamp
    v_max_f32 v53, v86, v228
    v_fma_f32 v118, v118, v214, v227
    v_add_f32 v52, v52, v53
    v_cndmask_b32 v86, v86, v52, s[30:31]
    v_fma_f32 v87, v87, v215, v226
    v_mul_f32 v54, 0x3fb8aa3b, v87
    v_exp_f32 v54, v54 clamp
    v_max_f32 v55, v87, v228
    v_fma_f32 v119, v119, v215, v227
    v_add_f32 v54, v54, v55
    v_cndmask_b32 v87, v87, v54, s[30:31]
    v_fma_f32 v88, v88, v216, v226
    v_mul_f32 v48, 0x3fb8aa3b, v88
    v_exp_f32 v48, v48 clamp
    v_max_f32 v49, v88, v228
    v_fma_f32 v120, v120, v216, v227
    v_add_f32 v48, v48, v49
    v_cndmask_b32 v88, v88, v48, s[30:31]
    v_fma_f32 v89, v89, v217, v226
    v_mul_f32 v50, 0x3fb8aa3b, v89
    v_exp_f32 v50, v50 clamp
    v_max_f32 v51, v89, v228
    v_fma_f32 v121, v121, v217, v227
    v_add_f32 v50, v50, v51
    v_cndmask_b32 v89, v89, v50, s[30:31]
    v_fma_f32 v90, v90, v218, v226
    v_mul_f32 v52, 0x3fb8aa3b, v90
    v_exp_f32 v52, v52 clamp
    v_max_f32 v53, v90, v228
    v_fma_f32 v122, v122, v218, v227
    v_add_f32 v52, v52, v53
    v_cndmask_b32 v90, v90, v52, s[30:31]
    v_fma_f32 v91, v91, v219, v226
    v_mul_f32 v54, 0x3fb8aa3b, v91
    v_exp_f32 v54, v54 clamp
    v_max_f32 v55, v91, v228
    v_fma_f32 v123, v123, v219, v227
    v_add_f32 v54, v54, v55
    v_cndmask_b32 v91, v91, v54, s[30:31]
    v_fma_f32 v92, v92, v220, v226
    v_mul_f32 v48, 0x3fb8aa3b, v92
    v_exp_f32 v48, v48 clamp
    v_max_f32 v49, v92, v228
    v_fma_f32 v124, v124, v220, v227
    v_add_f32 v48, v48, v49
    v_cndmask_b32 v92, v92, v48, s[30:31]
    v_fma_f32 v93, v93, v221, v226
    v_mul_f32 v50, 0x3fb8aa3b, v93
    v_exp_f32 v50, v50 clamp
    v_max_f32 v51, v93, v228
    v_fma_f32 v125, v125, v221, v227
    v_add_f32 v50, v50, v51
    v_cndmask_b32 v93, v93, v50, s[30:31]
    v_fma_f32 v94, v94, v222, v226
    v_mul_f32 v52, 0x3fb8aa3b, v94
    v_exp_f32 v52, v52 clamp
    v_max_f32 v53, v94, v228
    v_fma_f32 v126, v126, v222, v227
    v_add_f32 v52, v52, v53
    v_cndmask_b32 v94, v94, v52, s[30:31]
    v_fma_f32 v95, v95, v223, v226
    v_mul_f32 v54, 0x3fb8aa3b, v95
    v_exp_f32 v54, v54 clamp
    v_max_f32 v55, v95, v228
    v_fma_f32 v127, v127, v223, v227
    v_add_f32 v54, v54, v55
    v_cndmask_b32 v95, v95, v54, s[30:31]
    v_cvt_pk_bf16_f32 v32, v80, v81
    v_cvt_pk_bf16_f32 v40, v112, v113
    v_cvt_pk_bf16_f32 v33, v82, v83
    v_cvt_pk_bf16_f32 v41, v114, v115
    v_cvt_pk_bf16_f32 v34, v84, v85
    v_cvt_pk_bf16_f32 v42, v116, v117
    v_cvt_pk_bf16_f32 v35, v86, v87
    v_cvt_pk_bf16_f32 v43, v118, v119
    v_cvt_pk_bf16_f32 v36, v88, v89
    v_cvt_pk_bf16_f32 v44, v120, v121
    v_cvt_pk_bf16_f32 v37, v90, v91
    v_cvt_pk_bf16_f32 v45, v122, v123
    v_cvt_pk_bf16_f32 v38, v92, v93
    v_cvt_pk_bf16_f32 v46, v124, v125
    v_cvt_pk_bf16_f32 v39, v94, v95
    v_cvt_pk_bf16_f32 v47, v126, v127
    s_nop 1
    v_mfma_f32_32x32x16_bf16 v[160:175], v[32:35], v[32:35], v[160:175]
    v_mfma_f32_32x32x16_bf16 v[176:191], v[40:43], v[32:35], v[176:191]
    v_mfma_f32_32x32x16_bf16 v[160:175], v[36:39], v[36:39], v[160:175]
    v_mfma_f32_32x32x16_bf16 v[176:191], v[44:47], v[36:39], v[176:191]
    v_fma_f32 v132, v132, v224, v228
    v_mul_f32 v48, 0x3fb8aa3b, v132
    v_exp_f32 v48, v48 clamp
    v_max_f32 v49, v132, v228
    v_add_f32 v132, v48, v49
    v_fma_f32 v133, v133, v224, v228
    v_mul_f32 v50, 0x3fb8aa3b, v133
    v_exp_f32 v50, v50 clamp
    v_max_f32 v51, v133, v228
    v_add_f32 v133, v50, v51
    v_fma_f32 v134, v134, v224, v228
    v_mul_f32 v52, 0x3fb8aa3b, v134
    v_exp_f32 v52, v52 clamp
    v_max_f32 v53, v134, v228
    v_add_f32 v134, v52, v53
    v_fma_f32 v135, v135, v224, v228
    v_mul_f32 v54, 0x3fb8aa3b, v135
    v_exp_f32 v54, v54 clamp
    v_max_f32 v55, v135, v228
    v_add_f32 v135, v54, v55
    v_fma_f32 v136, v136, v224, v228
    v_mul_f32 v48, 0x3fb8aa3b, v136
    v_exp_f32 v48, v48 clamp
    v_max_f32 v49, v136, v228
    v_add_f32 v136, v48, v49
    v_fma_f32 v137, v137, v224, v228
    v_mul_f32 v50, 0x3fb8aa3b, v137
    v_exp_f32 v50, v50 clamp
    v_max_f32 v51, v137, v228
    v_add_f32 v137, v50, v51
    v_fma_f32 v138, v138, v224, v228
    v_mul_f32 v52, 0x3fb8aa3b, v138
    v_exp_f32 v52, v52 clamp
    v_max_f32 v53, v138, v228
    v_add_f32 v138, v52, v53
    v_fma_f32 v139, v139, v224, v228
    v_mul_f32 v54, 0x3fb8aa3b, v139
    v_exp_f32 v54, v54 clamp
    v_max_f32 v55, v139, v228
    v_add_f32 v139, v54, v55
    v_fma_f32 v140, v140, v224, v228
    v_mul_f32 v48, 0x3fb8aa3b, v140
    v_exp_f32 v48, v48 clamp
    v_max_f32 v49, v140, v228
    v_add_f32 v140, v48, v49
    v_fma_f32 v141, v141, v224, v228
    v_mul_f32 v50, 0x3fb8aa3b, v141
    v_exp_f32 v50, v50 clamp
    v_max_f32 v51, v141, v228
    v_add_f32 v141, v50, v51
    v_fma_f32 v142, v142, v224, v228
    v_mul_f32 v52, 0x3fb8aa3b, v142
    v_exp_f32 v52, v52 clamp
    v_max_f32 v53, v142, v228
    v_add_f32 v142, v52, v53
    v_fma_f32 v143, v143, v224, v228
    v_mul_f32 v54, 0x3fb8aa3b, v143
    v_exp_f32 v54, v54 clamp
    v_max_f32 v55, v143, v228
    v_add_f32 v143, v54, v55
    v_cvt_pk_bf16_f32 v130, v132, v133
    v_cvt_pk_bf16_f32 v131, v134, v135
    v_cvt_pk_bf16_f32 v132, v136, v137
    v_cvt_pk_bf16_f32 v133, v138, v139
    v_cvt_pk_bf16_f32 v134, v140, v141
    v_cvt_pk_bf16_f32 v135, v142, v143
    v_mov_b32 v128, 0
    v_mov_b32 v129, 0
    s_lshl_b32 s28, s13, 13
    s_add_u32 s28, s28, 66560
    v_add_u32 v17, s28, v1
    ds_write_b128 v17, v[160:163] offset:0
    ds_write_b128 v17, v[164:167] offset:1024
    ds_write_b128 v17, v[168:171] offset:2048
    ds_write_b128 v17, v[172:175] offset:3072
    ds_write_b128 v17, v[176:179] offset:4096
    ds_write_b128 v17, v[180:183] offset:5120
    ds_write_b128 v17, v[184:187] offset:6144
    ds_write_b128 v17, v[188:191] offset:7168
    s_lshl_b32 s28, s13, 6
    v_add_u32 v32, s28, v0
    v_cmp_le_u32 vcc, 105, v32
    s_nop 1
    v_cndmask_b32 v33, 0, 1, vcc
    v_mul_u32_u24 v34, 105, v33
    v_sub_u32 v34, v32, v34
    v_mul_u32_u24 v35, 13108, v34
    v_lshrrev_b32 v35, 16, v35
    v_mul_u32_u24 v36, 5, v35
    v_sub_u32 v36, v34, v36
    v_add_u32 v37, 20, v35
    v_subrev_u32 v38, 12, v35
    v_cmp_gt_u32 vcc, 12, v35
    s_nop 1
    v_cndmask_b32 v37, v38, v37, vcc
    v_cndmask_b32 v38, 1, 0, vcc
    v_lshlrev_b32 v38, 12, v38
    v_lshl_add_u32 v38, v33, 13, v38
    v_lshrrev_b32 v39, 3, v37
    v_lshl_add_u32 v38, v39, 10, v38
    v_bfe_u32 v39, v37, 2, 1
    v_lshlrev_b32 v39, 5, v39
    v_lshl_add_u32 v39, v36, 2, v39
    v_lshl_add_u32 v38, v39, 4, v38
    v_and_b32 v39, 3, v37
    v_lshl_add_u32 v38, v39, 2, v38
    v_min_u32 v38, 16320, v38
    v_add_u32 v38, 66560, v38
    s_waitcnt lgkmcnt(0)
    s_barrier
    ds_read_b32 v40, v38 offset:0
    ds_read_b32 v41, v38 offset:16
    ds_read_b32 v42, v38 offset:32
    ds_read_b32 v43, v38 offset:48
    ds_read_b32 v44, v38 offset:16384
    ds_read_b32 v45, v38 offset:16400
    ds_read_b32 v46, v38 offset:16416
    ds_read_b32 v47, v38 offset:16432
    s_lshl_b32 s28, s20, 4
    s_add_u32 s28, s28, s21
    s_lshl_b32 s28, s28, 12
    s_mul_i32 s39, s49, 1048576
    s_add_u32 s39, s39, 232783872
    s_add_u32 s28, s28, s39
    v_lshlrev_b32 v39, 4, v32
    v_cmp_gt_u32 vcc, 210, v32
    s_mov_b64 s[32:33], vcc
    s_waitcnt lgkmcnt(0)
    v_add_f32 v40, v40, v44
    v_add_f32 v41, v41, v45
    v_add_f32 v42, v42, v46
    v_add_f32 v43, v43, v47
    s_mov_b64 exec, s[32:33]
    buffer_store_dwordx4 v[40:43], v39, s[8:11], s28 offen sc1
    s_mov_b64 exec, -1
    v_fma_f32 v148, v148, v225, v228
    v_mul_f32 v48, 0x3fb8aa3b, v148
    v_exp_f32 v48, v48 clamp
    v_max_f32 v49, v148, v228
    v_add_f32 v148, v48, v49
    v_fma_f32 v149, v149, v225, v228
    v_mul_f32 v50, 0x3fb8aa3b, v149
    v_exp_f32 v50, v50 clamp
    v_max_f32 v51, v149, v228
    v_add_f32 v149, v50, v51
    v_fma_f32 v150, v150, v225, v228
    v_mul_f32 v52, 0x3fb8aa3b, v150
    v_exp_f32 v52, v52 clamp
    v_max_f32 v53, v150, v228
    v_add_f32 v150, v52, v53
    v_fma_f32 v151, v151, v225, v228
    v_mul_f32 v54, 0x3fb8aa3b, v151
    v_exp_f32 v54, v54 clamp
    v_max_f32 v55, v151, v228
    v_add_f32 v151, v54, v55
    v_fma_f32 v152, v152, v225, v228
    v_mul_f32 v48, 0x3fb8aa3b, v152
    v_exp_f32 v48, v48 clamp
    v_max_f32 v49, v152, v228
    v_add_f32 v152, v48, v49
    v_fma_f32 v153, v153, v225, v228
    v_mul_f32 v50, 0x3fb8aa3b, v153
    v_exp_f32 v50, v50 clamp
    v_max_f32 v51, v153, v228
    v_add_f32 v153, v50, v51
    v_fma_f32 v154, v154, v225, v228
    v_mul_f32 v52, 0x3fb8aa3b, v154
    v_exp_f32 v52, v52 clamp
    v_max_f32 v53, v154, v228
    v_add_f32 v154, v52, v53
    v_fma_f32 v155, v155, v225, v228
    v_mul_f32 v54, 0x3fb8aa3b, v155
    v_exp_f32 v54, v54 clamp
    v_max_f32 v55, v155, v228
    v_add_f32 v155, v54, v55
    v_fma_f32 v156, v156, v225, v228
    v_mul_f32 v48, 0x3fb8aa3b, v156
    v_exp_f32 v48, v48 clamp
    v_max_f32 v49, v156, v228
    v_add_f32 v156, v48, v49
    v_fma_f32 v157, v157, v225, v228
    v_mul_f32 v50, 0x3fb8aa3b, v157
    v_exp_f32 v50, v50 clamp
    v_max_f32 v51, v157, v228
    v_add_f32 v157, v50, v51
    v_fma_f32 v158, v158, v225, v228
    v_mul_f32 v52, 0x3fb8aa3b, v158
    v_exp_f32 v52, v52 clamp
    v_max_f32 v53, v158, v228
    v_add_f32 v158, v52, v53
    v_fma_f32 v159, v159, v225, v228
    v_mul_f32 v54, 0x3fb8aa3b, v159
    v_exp_f32 v54, v54 clamp
    v_max_f32 v55, v159, v228
    v_add_f32 v159, v54, v55
    v_cvt_pk_bf16_f32 v146, v148, v149
    v_cvt_pk_bf16_f32 v147, v150, v151
    v_cvt_pk_bf16_f32 v148, v152, v153
    v_cvt_pk_bf16_f32 v149, v154, v155
    v_cvt_pk_bf16_f32 v150, v156, v157
    v_cvt_pk_bf16_f32 v151, v158, v159
    v_mov_b32 v144, 0
    v_mov_b32 v145, 0
    s_mul_i32 s29, s26, 5
    v_lshrrev_b32 v17, 5, v0
    v_add_u32 v17, s29, v17
    v_lshrrev_b32 v18, 1, v17
    v_lshlrev_b32 v18, 9, v18
    v_and_b32 v17, 1, v17
    v_lshl_add_u32 v18, v17, 3, v18
    v_and_b32 v16, 31, v0
    v_lshl_add_u32 v14, v16, 4, v18
    v_mul_u32_u24 v15, 80, v16
    v_lshrrev_b32 v17, 5, v0
    v_lshl_add_u32 v15, v17, 4, v15
    s_mul_i32 s29, s23, 1680
    s_add_u32 s29, s29, 48
    v_add_u32 v15, s29, v15
    v_mov_b32 v48, 0
    v_mov_b32 v49, 0
    v_mov_b32 v50, 0
    v_mov_b32 v51, 0
    v_mov_b32 v52, 0
    v_mov_b32 v53, 0
    v_mov_b32 v54, 0
    v_mov_b32 v55, 0
    v_mov_b32 v56, 0
    v_mov_b32 v57, 0
    v_mov_b32 v58, 0
    v_mov_b32 v59, 0
    s_waitcnt vmcnt(0)
    s_barrier
    s_cmp_lg_u32 s13, 0
    s_cbranch_scc0 layerb1_kernel_af_w0
    s_cmp_eq_u32 s44, 2
    s_cbranch_scc1 layerb1_kernel_pf_wait
    s_bfe_u32 s41, s56, 524288
    s_mul_i32 s41, s41, s40
    s_add_u32 s42, s58, s41
    s_add_u32 s43, s59, s41
    buffer_load_dwordx4 a[192:195], v240, s[8:11], s42 offen
    buffer_load_dwordx4 a[196:199], v241, s[8:11], s43 offen
    s_bfe_u32 s41, s56, 524296
    s_mul_i32 s41, s41, s40
    s_add_u32 s42, s58, s41
    s_add_u32 s43, s59, s41
    buffer_load_dwordx4 a[200:203], v240, s[8:11], s42 offen
    buffer_load_dwordx4 a[204:207], v241, s[8:11], s43 offen
    s_bfe_u32 s41, s56, 524304
    s_mul_i32 s41, s41, s40
    s_add_u32 s42, s58, s41
    s_add_u32 s43, s59, s41
    buffer_load_dwordx4 a[208:211], v240, s[8:11], s42 offen
    buffer_load_dwordx4 a[212:215], v241, s[8:11], s43 offen
    s_bfe_u32 s41, s56, 524312
    s_mul_i32 s41, s41, s40
    s_add_u32 s42, s58, s41
    s_add_u32 s43, s59, s41
    buffer_load_dwordx4 a[216:219], v240, s[8:11], s42 offen
    buffer_load_dwordx4 a[220:223], v241, s[8:11], s43 offen
    s_bfe_u32 s41, s57, 524288
    s_mul_i32 s41, s41, s40
    s_add_u32 s42, s58, s41
    s_add_u32 s43, s59, s41
    buffer_load_dwordx4 a[224:227], v240, s[8:11], s42 offen
    buffer_load_dwordx4 a[228:231], v241, s[8:11], s43 offen
    s_bfe_u32 s41, s57, 524296
    s_mul_i32 s41, s41, s40
    s_add_u32 s42, s58, s41
    s_add_u32 s43, s59, s41
    buffer_load_dwordx4 a[232:235], v240, s[8:11], s42 offen
    buffer_load_dwordx4 a[236:239], v241, s[8:11], s43 offen
    s_bfe_u32 s41, s57, 524304
    s_mul_i32 s41, s41, s40
    s_add_u32 s42, s58, s41
    s_add_u32 s43, s59, s41
    buffer_load_dwordx4 a[240:243], v240, s[8:11], s42 offen
    buffer_load_dwordx4 a[244:247], v241, s[8:11], s43 offen
layerb1_kernel_pf_wait:
    s_branch layerb1_kernel_af_go
layerb1_kernel_af_w0:
    s_lshl_b32 s29, s20, 7
    s_add_u32 s29, s29, s48
    s_add_u32 s29, s29, 32768
    s_lshl_b32 s30, s21, 2
    v_mov_b32 v16, s30
    v_mov_b32 v17, 1
    s_mov_b64 exec, 1
    buffer_store_dword v17, v16, s[8:11], s29 offen sc1
    s_mov_b64 exec, 0xffff
    v_lshlrev_b32 v16, 2, v0
    s_mov_b32 s31, 400000
layerb1_kernel_af_poll:
    buffer_load_dword v17, v16, s[8:11], s29 offen sc1
    s_waitcnt vmcnt(0)
    v_cmp_eq_u32 vcc, 0, v17
    s_sub_u32 s31, s31, 1
    s_cbranch_scc1 layerb1_kernel_af_fail
    s_cbranch_vccnz layerb1_kernel_af_poll
    s_branch layerb1_kernel_af_ok
layerb1_kernel_af_fail:
    s_load_dwordx2 s[34:35], s[0:1], 88
    s_waitcnt lgkmcnt(0)
    s_mov_b32 s36, s34
    s_mov_b32 s37, s35
    s_mov_b32 s38, 256
    s_mov_b32 s39, 0x00020000
    s_mov_b64 exec, 1
    v_mov_b32 v16, 0
    v_mov_b32 v17, 0xdead
    buffer_store_dword v17, v16, s[36:39], 0 offen
layerb1_kernel_af_ok:
    s_mov_b64 exec, -1
layerb1_kernel_af_go:
    s_barrier
    s_lshl_b32 s28, s20, 16
    s_add_u32 s28, s28, s39
    s_mov_b64 exec, s[32:33]
    buffer_load_dwordx4 v[160:163], v39, s[8:11], s28 offen sc1
    s_add_u32 s28, s28, 4096
    buffer_load_dwordx4 v[164:167], v39, s[8:11], s28 offen sc1
    s_add_u32 s28, s28, 4096
    buffer_load_dwordx4 v[168:171], v39, s[8:11], s28 offen sc1
    s_add_u32 s28, s28, 4096
    buffer_load_dwordx4 v[172:175], v39, s[8:11], s28 offen sc1
    s_add_u32 s28, s28, 4096
    buffer_load_dwordx4 v[176:179], v39, s[8:11], s28 offen sc1
    s_add_u32 s28, s28, 4096
    buffer_load_dwordx4 v[180:183], v39, s[8:11], s28 offen sc1
    s_add_u32 s28, s28, 4096
    buffer_load_dwordx4 v[184:187], v39, s[8:11], s28 offen sc1
    s_add_u32 s28, s28, 4096
    buffer_load_dwordx4 v[188:191], v39, s[8:11], s28 offen sc1
    s_add_u32 s28, s28, 4096
    buffer_load_dwordx4 v[192:195], v39, s[8:11], s28 offen sc1
    s_add_u32 s28, s28, 4096
    buffer_load_dwordx4 v[196:199], v39, s[8:11], s28 offen sc1
    s_add_u32 s28, s28, 4096
    buffer_load_dwordx4 v[200:203], v39, s[8:11], s28 offen sc1
    s_add_u32 s28, s28, 4096
    buffer_load_dwordx4 v[204:207], v39, s[8:11], s28 offen sc1
    s_add_u32 s28, s28, 4096
    buffer_load_dwordx4 v[208:211], v39, s[8:11], s28 offen sc1
    s_add_u32 s28, s28, 4096
    buffer_load_dwordx4 v[212:215], v39, s[8:11], s28 offen sc1
    s_add_u32 s28, s28, 4096
    buffer_load_dwordx4 v[216:219], v39, s[8:11], s28 offen sc1
    s_add_u32 s28, s28, 4096
    buffer_load_dwordx4 v[220:223], v39, s[8:11], s28 offen sc1
    s_mov_b64 exec, -1
    s_waitcnt vmcnt(14)
    v_add_f32 v160, v160, v164
    v_add_f32 v161, v161, v165
    v_add_f32 v162, v162, v166
    v_add_f32 v163, v163, v167
    s_waitcnt vmcnt(12)
    v_add_f32 v168, v168, v172
    v_add_f32 v169, v169, v173
    v_add_f32 v170, v170, v174
    v_add_f32 v171, v171, v175
    s_waitcnt vmcnt(10)
    v_add_f32 v176, v176, v180
    v_add_f32 v177, v177, v181
    v_add_f32 v178, v178, v182
    v_add_f32 v179, v179, v183
    s_waitcnt vmcnt(8)
    v_add_f32 v184, v184, v188
    v_add_f32 v185, v185, v189
    v_add_f32 v186, v186, v190
    v_add_f32 v187, v187, v191
    s_waitcnt vmcnt(6)
    v_add_f32 v192, v192, v196
    v_add_f32 v193, v193, v197
    v_add_f32 v194, v194, v198
    v_add_f32 v195, v195, v199
    s_waitcnt vmcnt(4)
    v_add_f32 v200, v200, v204
    v_add_f32 v201, v201, v205
    v_add_f32 v202, v202, v206
    v_add_f32 v203, v203, v207
    s_waitcnt vmcnt(2)
    v_add_f32 v208, v208, v212
    v_add_f32 v209, v209, v213
    v_add_f32 v210, v210, v214
    v_add_f32 v211, v211, v215
    s_waitcnt vmcnt(0)
    v_add_f32 v216, v216, v220
    v_add_f32 v217, v217, v221
    v_add_f32 v218, v218, v222
    v_add_f32 v219, v219, v223
    v_add_f32 v160, v160, v168
    v_add_f32 v161, v161, v169
    v_add_f32 v162, v162, v170
    v_add_f32 v163, v163, v171
    v_add_f32 v176, v176, v184
    v_add_f32 v177, v177, v185
    v_add_f32 v178, v178, v186
    v_add_f32 v179, v179, v187
    v_add_f32 v192, v192, v200
    v_add_f32 v193, v193, v201
    v_add_f32 v194, v194, v202
    v_add_f32 v195, v195, v203
    v_add_f32 v208, v208, v216
    v_add_f32 v209, v209, v217
    v_add_f32 v210, v210, v218
    v_add_f32 v211, v211, v219
    v_add_f32 v160, v160, v176
    v_add_f32 v161, v161, v177
    v_add_f32 v162, v162, v178
    v_add_f32 v163, v163, v179
    v_add_f32 v192, v192, v208
    v_add_f32 v193, v193, v209
    v_add_f32 v194, v194, v210
    v_add_f32 v195, v195, v211
    v_add_f32 v160, v160, v192
    v_add_f32 v161, v161, v193
    v_add_f32 v162, v162, v194
    v_add_f32 v163, v163, v195
    v_add_u32 v39, 64, v39
    s_mov_b64 exec, s[32:33]
    ds_write_b128 v39, v[160:163]
    s_mov_b64 exec, -1
    s_waitcnt lgkmcnt(0)
    s_barrier
    s_mov_b32 exec_lo, 0x1fffff
    s_mov_b32 exec_hi, 0x1fffff
    ds_read_b128 v[52:55], v15 offset:32
    ds_read_b128 v[56:59], v15 offset:64
    s_mov_b32 exec_lo, 0
    ds_read_b128 v[48:51], v15
    s_mov_b64 exec, -1
    v_mov_b32 v32, 0
    v_mov_b32 v33, 0
    s_waitcnt lgkmcnt(0)
    v_cvt_pk_bf16_f32 v34, v48, v49
    v_cvt_pk_bf16_f32 v35, v50, v51
    v_cvt_pk_bf16_f32 v36, v52, v53
    v_cvt_pk_bf16_f32 v37, v54, v55
    v_cvt_pk_bf16_f32 v38, v56, v57
    v_cvt_pk_bf16_f32 v39, v58, v59
    s_nop 1
    v_mfma_f32_32x32x16_bf16 v[64:79], v[32:35], v[128:131], 0
    v_mfma_f32_32x32x16_bf16 v[64:79], v[36:39], v[132:135], v[64:79]
    v_mfma_f32_32x32x16_bf16 v[80:95], v[32:35], v[144:147], 0
    v_mfma_f32_32x32x16_bf16 v[80:95], v[36:39], v[148:151], v[80:95]
    s_lshl_b32 s28, s21, 2
    s_lshl_b32 s29, s22, 1
    s_add_u32 s28, s28, s29
    s_mul_i32 s28, s28, 40960
    s_add_u32 s28, s28, 229638144
    s_nop 7
    s_nop 3
    v_add_f32 v40, 0x358637bd, v72
    v_mov_b32 v41, v40
    s_nop 1
    v_permlane32_swap_b32 v40, v41
    v_rcp_f32 v41, v41
    s_nop 0
    v_mul_f32 v64, v64, v41
    v_mul_f32 v65, v65, v41
    v_mul_f32 v66, v66, v41
    v_mul_f32 v67, v67, v41
    v_mul_f32 v68, v68, v41
    v_mul_f32 v69, v69, v41
    v_mul_f32 v70, v70, v41
    v_mul_f32 v71, v71, v41
    v_mul_f32 v72, v72, v41
    v_mul_f32 v73, v73, v41
    v_mul_f32 v74, v74, v41
    v_mul_f32 v75, v75, v41
    v_cvt_pk_bf16_f32 v42, v64, v65
    v_cvt_pk_bf16_f32 v43, v66, v67
    v_cvt_pk_bf16_f32 v44, v68, v69
    v_cvt_pk_bf16_f32 v45, v70, v71
    v_cvt_pk_bf16_f32 v46, v72, v73
    v_cvt_pk_bf16_f32 v47, v74, v75
    buffer_store_dwordx2 v[42:43], v14, s[8:11], s28 offen offset:0 sc1
    buffer_store_dwordx2 v[44:45], v14, s[8:11], s28 offen offset:512 sc1
    s_mov_b32 exec_hi, 0
    buffer_store_dwordx2 v[46:47], v14, s[8:11], s28 offen offset:1024 sc1
    s_mov_b32 exec_hi, -1
    s_add_u32 s28, s28, 40960
    s_nop 7
    v_add_f32 v40, 0x358637bd, v88
    v_mov_b32 v41, v40
    s_nop 1
    v_permlane32_swap_b32 v40, v41
    v_rcp_f32 v41, v41
    s_nop 0
    v_mul_f32 v80, v80, v41
    v_mul_f32 v81, v81, v41
    v_mul_f32 v82, v82, v41
    v_mul_f32 v83, v83, v41
    v_mul_f32 v84, v84, v41
    v_mul_f32 v85, v85, v41
    v_mul_f32 v86, v86, v41
    v_mul_f32 v87, v87, v41
    v_mul_f32 v88, v88, v41
    v_mul_f32 v89, v89, v41
    v_mul_f32 v90, v90, v41
    v_mul_f32 v91, v91, v41
    v_cvt_pk_bf16_f32 v48, v80, v81
    v_cvt_pk_bf16_f32 v49, v82, v83
    v_cvt_pk_bf16_f32 v50, v84, v85
    v_cvt_pk_bf16_f32 v51, v86, v87
    v_cvt_pk_bf16_f32 v52, v88, v89
    v_cvt_pk_bf16_f32 v53, v90, v91
    buffer_store_dwordx2 v[48:49], v14, s[8:11], s28 offen offset:0 sc1
    buffer_store_dwordx2 v[50:51], v14, s[8:11], s28 offen offset:512 sc1
    s_mov_b32 exec_hi, 0
    buffer_store_dwordx2 v[52:53], v14, s[8:11], s28 offen offset:1024 sc1
    s_mov_b32 exec_hi, -1
    s_waitcnt vmcnt(0)
    s_barrier
    s_cmp_lg_u32 s13, 0
    s_cbranch_scc1 layerb1_kernel_af_pub
    s_lshl_b32 s28, s21, 4
    s_add_u32 s28, s28, s20
    s_lshl_b32 s28, s28, 2
    s_add_u32 s28, s28, s48
    s_add_u32 s28, s28, 49152
    v_mov_b32 v16, 0
    v_mov_b32 v17, 1
    s_mov_b64 exec, 1
    buffer_store_dword v17, v16, s[8:11], s28 offen sc1
    s_mov_b64 exec, -1
layerb1_kernel_af_pub:
    s_cmp_lg_u32 s44, 0
    s_cbranch_scc1 layerb1_kernel_pf_late
    s_cmp_lg_u32 s13, 0
    s_cbranch_scc1 layerb1_kernel_pf_late1
    s_bfe_u32 s41, s56, 524288
    s_mul_i32 s41, s41, s40
    s_add_u32 s42, s58, s41
    s_add_u32 s43, s59, s41
    buffer_load_dwordx4 a[192:195], v240, s[8:11], s42 offen
    buffer_load_dwordx4 a[196:199], v241, s[8:11], s43 offen
    s_bfe_u32 s41, s56, 524296
    s_mul_i32 s41, s41, s40
    s_add_u32 s42, s58, s41
    s_add_u32 s43, s59, s41
    buffer_load_dwordx4 a[200:203], v240, s[8:11], s42 offen
    buffer_load_dwordx4 a[204:207], v241, s[8:11], s43 offen
    s_bfe_u32 s41, s56, 524304
    s_mul_i32 s41, s41, s40
    s_add_u32 s42, s58, s41
    s_add_u32 s43, s59, s41
    buffer_load_dwordx4 a[208:211], v240, s[8:11], s42 offen
    buffer_load_dwordx4 a[212:215], v241, s[8:11], s43 offen
    s_bfe_u32 s41, s56, 524312
    s_mul_i32 s41, s41, s40
    s_add_u32 s42, s58, s41
    s_add_u32 s43, s59, s41
    buffer_load_dwordx4 a[216:219], v240, s[8:11], s42 offen
    buffer_load_dwordx4 a[220:223], v241, s[8:11], s43 offen
    s_bfe_u32 s41, s57, 524288
    s_mul_i32 s41, s41, s40
    s_add_u32 s42, s58, s41
    s_add_u32 s43, s59, s41
    buffer_load_dwordx4 a[224:227], v240, s[8:11], s42 offen
    buffer_load_dwordx4 a[228:231], v241, s[8:11], s43 offen
    s_bfe_u32 s41, s57, 524296
    s_mul_i32 s41, s41, s40
    s_add_u32 s42, s58, s41
    s_add_u32 s43, s59, s41
    buffer_load_dwordx4 a[232:235], v240, s[8:11], s42 offen
    buffer_load_dwordx4 a[236:239], v241, s[8:11], s43 offen
    s_bfe_u32 s41, s57, 524304
    s_mul_i32 s41, s41, s40
    s_add_u32 s42, s58, s41
    s_add_u32 s43, s59, s41
    buffer_load_dwordx4 a[240:243], v240, s[8:11], s42 offen
    buffer_load_dwordx4 a[244:247], v241, s[8:11], s43 offen
layerb1_kernel_pf_late1:
    s_bfe_u32 s41, s57, 524312
    s_mul_i32 s41, s41, s40
    s_add_u32 s42, s58, s41
    s_add_u32 s43, s59, s41
    buffer_load_dwordx4 a[248:251], v240, s[8:11], s42 offen
    buffer_load_dwordx4 a[252:255], v241, s[8:11], s43 offen
layerb1_kernel_pf_late:
    s_add_u32 s22, s4, 247463936
    s_addc_u32 s23, s5, 0
    s_cmp_eq_u32 s49, 0
    s_cselect_b32 s84, s22, s6
    s_cselect_b32 s85, s23, s7
    s_mov_b32 s86, 2621440
    s_mov_b32 s87, 0x00020000
    s_mov_b32 s20, s98
    s_mov_b32 s21, s99
    s_sub_u32 s22, 0, s4
    s_and_b32 s22, s22, 0x1fffff
    s_mov_b32 s24, 0
    s_mov_b32 s25, 0
    s_lshl_b32 s82, s24, 1
    s_sub_u32 s82, 8192, s82
    s_lshl_b32 s83, s25, 1
    s_sub_u32 s83, 8192, s83
    s_mul_i32 s23, s49, 4194304
    s_add_u32 s22, s22, s23
    s_add_u32 s16, s22, s24
    s_add_u32 s17, s22, s25
    s_add_u32 s17, s17, 2097152
    s_mov_b32 s40, 0x01010101
    s_mov_b32 s41, 0x01010101
    s_mov_b32 s42, 0x00010001
    s_mov_b32 s43, 0
    v_lshlrev_b32 v1, 4, v0
    v_and_b32 v16, 8, v0
    v_cmp_eq_u32 vcc, 0, v16
    v_mov_b32 v17, 0xeeeeeeee
    v_mov_b32 v18, 0x44444444
    v_cndmask_b32 v2, v17, v18, vcc
    s_cmp_eq_u32 s20, 0
    s_cbranch_scc0 layerb1_kernel_notp
    s_mov_b32 s12, s21
    s_cmp_eq_u32 s13, 0
    s_cbranch_scc1 layerb1_kernel_p0_start
    s_cmp_eq_u32 s13, 1
    s_cbranch_scc1 layerb1_kernel_p1_start
    s_cmp_eq_u32 s13, 2
    s_cbranch_scc1 layerb1_kernel_p2_start
    s_cmp_eq_u32 s13, 3
    s_cbranch_scc1 layerb1_kernel_p3_start
layerb1_kernel_notp:
    s_cmp_ge_u32 s20, 4
    s_cbranch_scc1 layerb1_kernel_proj
    s_cmp_ge_u32 s21, 27
    s_cbranch_scc1 layerb1_kernel_spare
    s_sub_u32 s22, s20, 1
    s_mul_i32 s22, s22, 27
    s_add_u32 s12, s22, s21
    s_cmp_ge_u32 s12, 80
    s_cbranch_scc1 layerb1_kernel_spare
    s_cmp_eq_u32 s13, 0
    s_cbranch_scc1 layerb1_kernel_y0_start
    s_cmp_eq_u32 s13, 1
    s_cbranch_scc1 layerb1_kernel_y1_start
    s_cmp_eq_u32 s13, 2
    s_cbranch_scc1 layerb1_kernel_y2_start
    s_cmp_eq_u32 s13, 3
    s_cbranch_scc1 layerb1_kernel_y3_start
    s_branch layerb1_kernel_end
layerb1_kernel_p0_start:
    v_lshrrev_b32 v16, 4, v0
    v_and_b32 v17, 15, v0
    v_and_b32 v18, 2, v0
    v_cmp_eq_u32 vcc, 0, v18
    v_mov_b32 v18, 0xeeeeeeee
    v_mov_b32 v19, 0x44444444
    v_cndmask_b32 v2, v18, v19, vcc
    v_lshrrev_b32 v20, 2, v17
    v_lshlrev_b32 v20, 1, v20
    v_and_b32 v21, 1, v17
    v_add_u32 v20, v20, v21
    v_bfe_u32 v21, v17, 1, 1
    v_lshl_add_u32 v18, v16, 1, v21
    v_lshlrev_b32 v18, 7, v18
    v_lshl_add_u32 v12, v20, 4, v18
    v_mul_u32_u24 v18, 400, v20
    v_lshl_add_u32 v18, v16, 5, v18
    v_lshl_add_u32 v18, v21, 4, v18
    v_add_u32 v4, 141312, v18
    v_mul_u32_u24 v18, 800, v16
    v_lshl_add_u32 v18, v17, 1, v18
    v_add_u32 v3, 141312, v18
    v_and_b32 v18, 7, v0
    v_mul_u32_u24 v18, 400, v18
    v_lshl_add_u32 v18, v16, 5, v18
    v_add_u32 v5, 144512, v18
    v_lshlrev_b32 v18, 3, v0
    v_add_u32 v6, 147712, v18
    v_lshlrev_b32 v18, 4, v16
    v_bfe_u32 v19, v17, 1, 2
    v_lshl_add_u32 v18, v19, 2, v18
    s_lshl_b32 s20, s12, 7
    s_add_u32 s20, s20, 0
    v_add_u32 v18, s20, v18
    v_lshrrev_b32 v19, 3, v17
    v_add_u32 v19, 1, v19
    v_lshrrev_b32 v20, 1, v19
    v_lshlrev_b32 v20, 14, v20
    v_and_b32 v19, 1, v19
    v_lshl_add_u32 v19, v19, 12, v20
    v_add_u32 v19, v19, v18
    v_mov_b32 v20, 0x7ffffff0
    v_and_b32 v21, 7, v0
    v_cmp_eq_u32 vcc, 4, v21
    v_subrev_u32 v21, 8, v18
    s_nop 0
    v_cndmask_b32 v7, v19, v21, vcc
    v_and_b32 v21, 0x29, v0
    v_cmp_eq_u32 vcc, 0, v21
    s_nop 1
    v_cndmask_b32 v8, v20, v18, vcc
    s_lshl_b32 s20, s12, 2
    v_lshlrev_b32 v18, 7, v0
    v_add_u32 v8, s20, v18
    v_lshlrev_b32 v18, 4, v17
    v_lshl_add_u32 v18, v16, 10, v18
    v_add_u32 v9, 0, v18
    v_add_u32 v18, 0, v0
    v_mul_u32_u24 v19, 2731, v18
    v_lshrrev_b32 v19, 16, v19
    v_mul_u32_u24 v20, 24, v19
    v_sub_u32 v20, v18, v20
    v_mul_u32_u24 v21, 400, v19
    v_lshl_add_u32 v21, v20, 4, v21
    v_add_u32 v10, 144512, v21
    v_lshlrev_b32 v21, 4, v19
    v_lshl_add_u32 v11, v20, 7, v21
    v_add_u32 v13, 0, v1
    v_add_u32 v14, 131072, v1
    s_mul_i32 s44, s12, 12288
    s_add_u32 s44, s44, 53477376
    s_mul_i32 s45, s12, 3072
    s_add_u32 s45, s45, 208666624
    s_mul_i32 s20, s12, 6
    s_add_u32 s21, s20, 5
    s_lshr_b32 s20, s20, 3
    s_lshr_b32 s21, s21, 3
    s_add_u32 s20, s20, 80
    s_add_u32 s21, s21, 80
    s_lshl_b32 s20, s20, 7
    s_lshl_b32 s21, s21, 7
    v_mov_b32 v255, s21
    v_mov_b32 v253, s20
    v_cmp_eq_u32 vcc, 0, v0
    s_nop 1
    v_cndmask_b32 v255, v255, v253, vcc
    s_mov_b32 s47, 0
    s_mul_i32 s20, s12, 491520
    s_add_u32 s20, s20, 11534336
    s_add_u32 s21, s20, 2048
    buffer_load_dwordx4 v[16:19], v1, s[8:11], s21 offen offset:0
    buffer_load_dwordx4 v[20:23], v1, s[8:11], s21 offen offset:1024
    s_add_u32 s21, s20, 24576
    buffer_load_dwordx4 v[24:27], v1, s[8:11], s21 offen offset:0
    buffer_load_dwordx4 v[28:31], v1, s[8:11], s21 offen offset:1024
    s_add_u32 s21, s20, 6144
    buffer_load_dwordx4 v[32:35], v1, s[8:11], s21 offen offset:0
    buffer_load_dwordx4 v[36:39], v1, s[8:11], s21 offen offset:1024
    s_add_u32 s21, s20, 14336
    buffer_load_dwordx4 v[40:43], v1, s[8:11], s21 offen offset:0
    buffer_load_dwordx4 v[44:47], v1, s[8:11], s21 offen offset:1024
    s_add_u32 s21, s20, 28672
    buffer_load_dwordx4 v[48:51], v1, s[8:11], s21 offen offset:0
    buffer_load_dwordx4 v[52:55], v1, s[8:11], s21 offen offset:1024
    s_add_u32 s21, s20, 36864
    buffer_load_dwordx4 v[56:59], v1, s[8:11], s21 offen offset:0
    buffer_load_dwordx4 v[60:63], v1, s[8:11], s21 offen offset:1024
    s_add_u32 s21, s20, 51200
    buffer_load_dwordx4 v[64:67], v1, s[8:11], s21 offen offset:0
    buffer_load_dwordx4 v[68:71], v1, s[8:11], s21 offen offset:1024
    s_add_u32 s21, s20, 59392
    buffer_load_dwordx4 v[72:75], v1, s[8:11], s21 offen offset:0
    buffer_load_dwordx4 v[76:79], v1, s[8:11], s21 offen offset:1024
    s_add_u32 s21, s20, 73728
    buffer_load_dwordx4 v[80:83], v1, s[8:11], s21 offen offset:0
    buffer_load_dwordx4 v[84:87], v1, s[8:11], s21 offen offset:1024
    s_add_u32 s21, s20, 65536
    buffer_load_dwordx4 v[88:91], v1, s[8:11], s21 offen offset:0
    buffer_load_dwordx4 v[92:95], v1, s[8:11], s21 offen offset:1024
    s_add_u32 s21, s20, 94208
    buffer_load_dwordx4 v[96:99], v1, s[8:11], s21 offen offset:0
    buffer_load_dwordx4 v[100:103], v1, s[8:11], s21 offen offset:1024
    s_add_u32 s21, s20, 81920
    buffer_load_dwordx4 v[104:107], v1, s[8:11], s21 offen offset:0
    buffer_load_dwordx4 v[108:111], v1, s[8:11], s21 offen offset:1024
    s_add_u32 s21, s20, 108544
    buffer_load_dwordx4 v[112:115], v1, s[8:11], s21 offen offset:0
    buffer_load_dwordx4 v[116:119], v1, s[8:11], s21 offen offset:1024
    s_add_u32 s21, s20, 114688
    buffer_load_dwordx4 v[120:123], v1, s[8:11], s21 offen offset:0
    buffer_load_dwordx4 v[124:127], v1, s[8:11], s21 offen offset:1024
    s_add_u32 s21, s20, 120832
    buffer_load_dwordx4 v[128:131], v1, s[8:11], s21 offen offset:0
    buffer_load_dwordx4 v[132:135], v1, s[8:11], s21 offen offset:1024
    s_add_u32 s21, s20, 104448
    buffer_load_dwordx4 v[136:139], v1, s[8:11], s21 offen offset:0
    buffer_load_dwordx4 v[140:143], v1, s[8:11], s21 offen offset:1024
    s_add_u32 s21, s20, 92160
    buffer_load_dwordx4 v[156:159], v1, s[8:11], s21 offen offset:0
    buffer_load_dwordx4 v[160:163], v1, s[8:11], s21 offen offset:1024
    s_add_u32 s21, s20, 96256
    buffer_load_dwordx4 v[164:167], v1, s[8:11], s21 offen offset:0
    buffer_load_dwordx4 v[168:171], v1, s[8:11], s21 offen offset:1024
    s_add_u32 s21, s20, 98304
    buffer_load_dwordx4 v[172:175], v1, s[8:11], s21 offen offset:0
    buffer_load_dwordx4 v[176:179], v1, s[8:11], s21 offen offset:1024
    s_add_u32 s21, s20, 100352
    buffer_load_dwordx4 v[180:183], v1, s[8:11], s21 offen offset:0
    buffer_load_dwordx4 v[184:187], v1, s[8:11], s21 offen offset:1024
    s_add_u32 s21, s20, 83968
    buffer_load_dwordx4 v[188:191], v1, s[8:11], s21 offen offset:0
    buffer_load_dwordx4 v[192:195], v1, s[8:11], s21 offen offset:1024
    s_add_u32 s21, s20, 86016
    buffer_load_dwordx4 v[196:199], v1, s[8:11], s21 offen offset:0
    buffer_load_dwordx4 v[200:203], v1, s[8:11], s21 offen offset:1024
    s_add_u32 s21, s20, 110592
    buffer_load_dwordx4 v[204:207], v1, s[8:11], s21 offen offset:0
    buffer_load_dwordx4 v[208:211], v1, s[8:11], s21 offen offset:1024
    s_add_u32 s21, s20, 112640
    buffer_load_dwordx4 v[212:215], v1, s[8:11], s21 offen offset:0
    buffer_load_dwordx4 v[216:219], v1, s[8:11], s21 offen offset:1024
    s_add_u32 s21, s20, 116736
    buffer_load_dwordx4 v[220:223], v1, s[8:11], s21 offen offset:0
    buffer_load_dwordx4 v[224:227], v1, s[8:11], s21 offen offset:1024
    s_add_u32 s21, s20, 118784
    buffer_load_dwordx4 v[228:231], v1, s[8:11], s21 offen offset:0
    buffer_load_dwordx4 v[232:235], v1, s[8:11], s21 offen offset:1024
    s_add_u32 s21, s20, 102400
    buffer_load_dwordx4 v[236:239], v1, s[8:11], s21 offen offset:0
    buffer_load_dwordx4 v[240:243], v1, s[8:11], s21 offen offset:1024
    s_add_u32 s21, s20, 106496
    buffer_load_dwordx4 v[244:247], v1, s[8:11], s21 offen offset:0
    buffer_load_dwordx4 v[248:251], v1, s[8:11], s21 offen offset:1024
    s_waitcnt vmcnt(24)
    ds_write_b128 v13, v[16:19] offset:0
    ds_write_b128 v13, v[20:23] offset:1024
    ds_write_b128 v13, v[24:27] offset:2048
    ds_write_b128 v13, v[28:31] offset:3072
    ds_write_b128 v13, v[32:35] offset:4096
    ds_write_b128 v13, v[36:39] offset:5120
    ds_write_b128 v13, v[40:43] offset:6144
    ds_write_b128 v13, v[44:47] offset:7168
    ds_write_b128 v13, v[48:51] offset:8192
    ds_write_b128 v13, v[52:55] offset:9216
    ds_write_b128 v13, v[56:59] offset:10240
    ds_write_b128 v13, v[60:63] offset:11264
    ds_write_b128 v13, v[64:67] offset:12288
    ds_write_b128 v13, v[68:71] offset:13312
    ds_write_b128 v13, v[72:75] offset:14336
    ds_write_b128 v13, v[76:79] offset:15360
    ds_write_b128 v13, v[80:83] offset:16384
    ds_write_b128 v13, v[84:87] offset:17408
    ds_write_b128 v13, v[88:91] offset:18432
    ds_write_b128 v13, v[92:95] offset:19456
    ds_write_b128 v13, v[96:99] offset:20480
    ds_write_b128 v13, v[100:103] offset:21504
    ds_write_b128 v13, v[104:107] offset:22528
    ds_write_b128 v13, v[108:111] offset:23552
    ds_write_b128 v13, v[112:115] offset:24576
    ds_write_b128 v13, v[116:119] offset:25600
    ds_write_b128 v13, v[120:123] offset:26624
    ds_write_b128 v13, v[124:127] offset:27648
    ds_write_b128 v13, v[128:131] offset:28672
    ds_write_b128 v13, v[132:135] offset:29696
    ds_write_b128 v13, v[136:139] offset:30720
    ds_write_b128 v13, v[140:143] offset:31744
    s_waitcnt lgkmcnt(0)
    s_add_u32 s20, s48, 51200
    s_mov_b64 exec, 3
    v_lshlrev_b32 v16, 2, v0
layerb1_kernel_p0_par:
    buffer_load_dword v17, v16, s[8:11], s20 offen sc1
    s_waitcnt vmcnt(0)
    v_cmp_eq_u32 vcc, 0, v17
    s_sub_u32 s15, s15, 1
    s_cbranch_scc1 layerb1_kernel_bail
    s_cbranch_vccnz layerb1_kernel_p0_par
    s_mov_b64 exec, -1
    v_readlane_b32 s20, v17, 0
    v_readlane_b32 s21, v17, 1
    s_nop 0
    s_and_b32 s20, s20, 8192
    s_and_b32 s21, s21, 8192
    s_add_u32 s16, s16, s20
    s_add_u32 s17, s17, s21
    s_mov_b32 s14, 0
    s_cmp_gt_u32 s47, s14
    s_cbranch_scc1 layerb1_kernel_p0_gw1_ok
layerb1_kernel_p0_gw1_lp:
    buffer_load_dword v253, v255, s[8:11], s48 offen sc1
    s_waitcnt vmcnt(0)
    v_readlane_b32 s47, v253, 0
    v_readlane_b32 s29, v253, 1
    s_nop 0
    s_min_u32 s47, s47, s29
    s_sub_u32 s15, s15, 1
    s_cbranch_scc1 layerb1_kernel_bail
    s_cmp_gt_u32 s47, s14
    s_cbranch_scc0 layerb1_kernel_p0_gw1_lp
layerb1_kernel_p0_gw1_ok:
    s_mul_i32 s20, s14, 393216
    s_add_u32 s20, s20, s44
    s_add_u32 s21, s20, 0
    buffer_load_dwordx4 v[100:103], v9, s[8:11], s21 offen offset:0 sc1
    buffer_load_dwordx4 v[104:107], v9, s[8:11], s21 offen offset:512 sc1
    s_add_u32 s21, s20, 4096
    buffer_load_dwordx4 v[108:111], v9, s[8:11], s21 offen offset:0 sc1
    buffer_load_dwordx4 v[112:115], v9, s[8:11], s21 offen offset:512 sc1
    s_add_u32 s21, s20, 8192
    buffer_load_dwordx4 v[116:119], v9, s[8:11], s21 offen offset:0 sc1
    buffer_load_dwordx4 v[120:123], v9, s[8:11], s21 offen offset:512 sc1
    v_mov_b32 v56, 0
    v_mov_b32 v57, 0
    v_mov_b32 v58, 0
    v_mov_b32 v59, 0
    v_mov_b32 v60, 0
    v_mov_b32 v61, 0
    v_mov_b32 v62, 0
    v_mov_b32 v63, 0
    v_mov_b32 v64, 0
    v_mov_b32 v65, 0
    v_mov_b32 v66, 0
    v_mov_b32 v67, 0
    v_mov_b32 v68, 0
    v_mov_b32 v69, 0
    v_mov_b32 v70, 0
    v_mov_b32 v71, 0
    v_mov_b32 v72, 0
    v_mov_b32 v73, 0
    v_mov_b32 v74, 0
    v_mov_b32 v75, 0
    v_mov_b32 v76, 0
    v_mov_b32 v77, 0
    v_mov_b32 v78, 0
    v_mov_b32 v79, 0
    v_mov_b32 v80, 0
    v_mov_b32 v81, 0
    v_mov_b32 v82, 0
    v_mov_b32 v83, 0
    v_mov_b32 v84, 0
    v_mov_b32 v85, 0
    v_mov_b32 v86, 0
    v_mov_b32 v87, 0
    ds_read_b128 v[124:127], v13 offset:0
    ds_read_b128 v[128:131], v13 offset:1024
    ds_read_b128 v[132:135], v13 offset:2048
    ds_read_b128 v[136:139], v13 offset:3072
    ds_read_b128 v[140:143], v13 offset:4096
    ds_read_b128 v[144:147], v13 offset:5120
    ds_read_b128 v[148:151], v13 offset:6144
    ds_read_b128 v[152:155], v13 offset:7168
    s_waitcnt lgkmcnt(0)
layerb1_kernel_p0_step:
    s_cmp_lt_u32 s14, 32
    s_cselect_b32 s18, s16, s17
    s_and_b32 s20, s14, 31
    s_lshl_b32 s20, s20, 16
    s_add_u32 s18, s18, s20
    s_add_u32 s69, s18, 55424
    s_add_u32 s22, s18, 36864
    s_add_u32 s23, s18, 37888
    s_add_u32 s24, s18, 38912
layerb1_kernel_p0_poll:
    buffer_load_dwordx4 v[16:19], v12, s[8:11], s22 offen sc1
    buffer_load_dwordx4 v[20:23], v12, s[8:11], s23 offen sc1
    buffer_load_dwordx4 v[24:27], v12, s[8:11], s24 offen sc1
    s_waitcnt vmcnt(0)
    ds_write_b128 v14, v[16:19] offset:0
    ds_write_b128 v14, v[20:23] offset:1024
    ds_write_b128 v14, v[24:27] offset:2048
    v_max3_u32 v88, v16, v17, v18
    v_max3_u32 v88, v88, v19, v20
    v_max3_u32 v88, v88, v21, v22
    v_max3_u32 v88, v88, v23, v24
    v_max3_u32 v88, v88, v25, v26
    v_max_u32 v88, v88, v27
    v_cmp_eq_u32 vcc, -1, v88
    s_sub_u32 s15, s15, 1
    s_cbranch_scc1 layerb1_kernel_bail
    s_cbranch_vccnz layerb1_kernel_p0_poll
    v_smfmac_f32_16x16x64_bf16 v[56:59], v[16:19], a[0:7], v2
    v_smfmac_f32_16x16x64_bf16 v[60:63], v[16:19], a[8:15], v2
    v_smfmac_f32_16x16x64_bf16 v[64:67], v[16:19], a[16:23], v2
    v_smfmac_f32_16x16x64_bf16 v[56:59], v[20:23], v[124:131], v2
    ds_read_b128 v[124:127], v13 offset:8192
    v_smfmac_f32_16x16x64_bf16 v[60:63], v[20:23], a[24:31], v2
    s_waitcnt lgkmcnt(1)
    s_barrier
    v_smfmac_f32_16x16x64_bf16 v[64:67], v[20:23], a[32:39], v2
    ds_read_b128 v[28:31], v14 offset:3072
    v_smfmac_f32_16x16x64_bf16 v[56:59], v[24:27], a[40:47], v2
    ds_read_b128 v[32:35], v14 offset:4096
    v_smfmac_f32_16x16x64_bf16 v[60:63], v[24:27], v[132:139], v2
    ds_read_b128 v[36:39], v14 offset:5120
    v_smfmac_f32_16x16x64_bf16 v[64:67], v[24:27], a[48:55], v2
    ds_read_b128 v[40:43], v14 offset:6144
    v_smfmac_f32_16x16x64_bf16 v[68:71], v[16:19], a[56:63], v2
    ds_read_b128 v[44:47], v14 offset:7168
    v_smfmac_f32_16x16x64_bf16 v[68:71], v[20:23], a[64:71], v2
    s_waitcnt lgkmcnt(4)
    ds_read_b128 v[48:51], v14 offset:8192
    v_smfmac_f32_16x16x64_bf16 v[56:59], v[28:31], v[140:147], v2
    s_waitcnt lgkmcnt(4)
    ds_read_b128 v[52:55], v14 offset:9216
    v_smfmac_f32_16x16x64_bf16 v[56:59], v[32:35], a[72:79], v2
    s_waitcnt lgkmcnt(4)
    ds_read_b128 v[128:131], v13 offset:9216
    v_smfmac_f32_16x16x64_bf16 v[56:59], v[36:39], a[80:87], v2
    s_waitcnt lgkmcnt(4)
    ds_read_b128 v[132:135], v13 offset:10240
    v_smfmac_f32_16x16x64_bf16 v[56:59], v[40:43], a[88:95], v2
    s_waitcnt lgkmcnt(4)
    ds_read_b128 v[136:139], v13 offset:11264
    v_smfmac_f32_16x16x64_bf16 v[56:59], v[44:47], v[148:155], v2
    s_waitcnt lgkmcnt(4)
    ds_read_b128 v[140:143], v13 offset:12288
    v_smfmac_f32_16x16x64_bf16 v[56:59], v[48:51], a[96:103], v2
    s_waitcnt lgkmcnt(4)
    ds_read_b128 v[144:147], v13 offset:13312
    v_smfmac_f32_16x16x64_bf16 v[56:59], v[52:55], a[104:111], v2
    ds_read_b128 v[148:151], v13 offset:14336
    v_smfmac_f32_16x16x64_bf16 v[60:63], v[28:31], a[112:119], v2
    s_waitcnt lgkmcnt(5)
    ds_read_b128 v[152:155], v13 offset:15360
    v_smfmac_f32_16x16x64_bf16 v[60:63], v[32:35], v[124:131], v2
    ds_read_b128 v[124:127], v13 offset:16384
    v_add_f32 v56, v56, v58
    v_smfmac_f32_16x16x64_bf16 v[60:63], v[36:39], a[120:127], v2
    ds_read_b128 v[128:131], v13 offset:17408
    v_add_f32 v57, v57, v59
    v_smfmac_f32_16x16x64_bf16 v[60:63], v[40:43], a[128:135], v2
    v_cvt_pk_bf16_f32 v56, v56, v57
    v_smfmac_f32_16x16x64_bf16 v[60:63], v[44:47], a[136:143], v2
    s_waitcnt lgkmcnt(6)
    ds_write_b16 v3, v56 offset:0
    v_smfmac_f32_16x16x64_bf16 v[60:63], v[48:51], v[132:139], v2
    ds_write_b16_d16_hi v3, v56 offset:400
    v_smfmac_f32_16x16x64_bf16 v[60:63], v[52:55], a[144:151], v2
    ds_read_b128 v[132:135], v13 offset:18432
    v_smfmac_f32_16x16x64_bf16 v[64:67], v[28:31], a[152:159], v2
    ds_read_b128 v[136:139], v13 offset:19456
    v_smfmac_f32_16x16x64_bf16 v[64:67], v[32:35], a[160:167], v2
    s_waitcnt lgkmcnt(8)
    v_add_f32 v60, v60, v62
    v_smfmac_f32_16x16x64_bf16 v[64:67], v[36:39], v[140:147], v2
    ds_read_b128 v[140:143], v13 offset:20480
    v_add_f32 v61, v61, v63
    v_smfmac_f32_16x16x64_bf16 v[64:67], v[40:43], a[168:175], v2
    ds_read_b128 v[144:147], v13 offset:21504
    v_cvt_pk_bf16_f32 v60, v60, v61
    v_smfmac_f32_16x16x64_bf16 v[64:67], v[44:47], a[176:183], v2
    ds_write_b16 v3, v60 offset:128
    v_smfmac_f32_16x16x64_bf16 v[64:67], v[48:51], a[184:191], v2
    s_waitcnt lgkmcnt(9)
    ds_write_b16_d16_hi v3, v60 offset:528
    v_smfmac_f32_16x16x64_bf16 v[64:67], v[52:55], v[148:155], v2
    ds_read_b128 v[148:151], v13 offset:22528
    v_smfmac_f32_16x16x64_bf16 v[68:71], v[28:31], a[192:199], v2
    ds_read_b128 v[152:155], v13 offset:23552
    v_smfmac_f32_16x16x64_bf16 v[68:71], v[32:35], a[200:207], v2
    v_add_f32 v64, v64, v66
    v_smfmac_f32_16x16x64_bf16 v[68:71], v[36:39], a[208:215], v2
    s_waitcnt lgkmcnt(10)
    v_add_f32 v65, v65, v67
    v_smfmac_f32_16x16x64_bf16 v[68:71], v[40:43], v[124:131], v2
    ds_read_b128 v[124:127], v13 offset:24576
    v_cvt_pk_bf16_f32 v64, v64, v65
    v_smfmac_f32_16x16x64_bf16 v[68:71], v[44:47], a[216:223], v2
    ds_write_b16 v3, v64 offset:256
    s_mov_b64 exec, 1
    buffer_store_dword v0, v8, s[8:11], s69 offen sc1
    s_mov_b64 exec, -1
    v_smfmac_f32_16x16x64_bf16 v[68:71], v[48:51], a[224:231], v2
    ds_write_b16_d16_hi v3, v64 offset:656
    v_smfmac_f32_16x16x64_bf16 v[68:71], v[52:55], a[232:239], v2
    s_waitcnt lgkmcnt(9)
    ds_read_b128 v[128:131], v13 offset:25600
    v_smfmac_f32_16x16x64_bf16 v[68:71], v[24:27], v[132:139], v2
    ds_read_b128 v[132:135], v13 offset:26624
    v_smfmac_f32_16x16x64_bf16 v[72:75], v[28:31], a[240:247], v2
    ds_read_b128 v[136:139], v13 offset:27648
    v_smfmac_f32_16x16x64_bf16 v[72:75], v[32:35], a[248:255], v2
    v_add_f32 v68, v68, v70
    v_smfmac_f32_16x16x64_bf16 v[72:75], v[36:39], v[156:163], v2
    s_waitcnt lgkmcnt(10)
    v_add_f32 v69, v69, v71
    v_smfmac_f32_16x16x64_bf16 v[72:75], v[40:43], v[140:147], v2
    ds_read_b128 v[140:143], v13 offset:28672
    v_cvt_pk_bf16_f32 v68, v68, v69
    v_smfmac_f32_16x16x64_bf16 v[72:75], v[44:47], v[164:171], v2
    s_waitcnt lgkmcnt(4)
    s_barrier
    v_smfmac_f32_16x16x64_bf16 v[72:75], v[48:51], v[172:179], v2
    ds_read_b128 v[88:91], v4 offset:0
    v_smfmac_f32_16x16x64_bf16 v[72:75], v[52:55], v[180:187], v2
    ds_read_b128 v[92:95], v4 offset:128
    v_smfmac_f32_16x16x64_bf16 v[72:75], v[16:19], v[148:155], v2
    ds_read_b128 v[96:99], v4 offset:256
    v_smfmac_f32_16x16x64_bf16 v[72:75], v[20:23], v[188:195], v2
    ds_write_b16 v3, v68 offset:3200
    v_smfmac_f32_16x16x64_bf16 v[72:75], v[24:27], v[196:203], v2
    s_waitcnt lgkmcnt(7)
    ds_write_b16_d16_hi v3, v68 offset:3600
    v_smfmac_f32_16x16x64_bf16 v[76:79], v[28:31], v[124:131], v2
    s_waitcnt lgkmcnt(4)
    ds_read_b128 v[144:147], v13 offset:29696
    v_smfmac_f32_16x16x64_bf16 v[80:83], v[88:91], v[100:107], v2
    s_waitcnt lgkmcnt(4)
    ds_read_b128 v[148:151], v13 offset:30720
    v_add_f32 v72, v72, v74
    v_smfmac_f32_16x16x64_bf16 v[80:83], v[92:95], v[108:115], v2
    s_waitcnt lgkmcnt(4)
    ds_read_b128 v[152:155], v13 offset:31744
    v_add_f32 v73, v73, v75
    v_smfmac_f32_16x16x64_bf16 v[80:83], v[96:99], v[116:123], v2
    v_cvt_pk_bf16_f32 v72, v72, v73
    v_smfmac_f32_16x16x64_bf16 v[76:79], v[32:35], v[204:211], v2
    ds_write_b16 v3, v72 offset:3328
    v_smfmac_f32_16x16x64_bf16 v[76:79], v[36:39], v[212:219], v2
    ds_write_b16_d16_hi v3, v72 offset:3728
    v_smfmac_f32_16x16x64_bf16 v[76:79], v[40:43], v[132:139], v2
    v_add_f32 v56, v80, v82
    v_smfmac_f32_16x16x64_bf16 v[76:79], v[44:47], v[220:227], v2
    v_mul_f32 v56, 0x3dd53b95, v56
    v_smfmac_f32_16x16x64_bf16 v[76:79], v[48:51], v[228:235], v2
    s_waitcnt lgkmcnt(4)
    v_max_f32_dpp v58, v56, v56 row_ror:8 row_mask:0xf bank_mask:0xf
    v_smfmac_f32_16x16x64_bf16 v[76:79], v[52:55], v[140:147], v2
    s_waitcnt lgkmcnt(0)
    s_barrier
    v_max_f32_dpp v58, v58, v58 row_ror:4 row_mask:0xf bank_mask:0xf
    v_smfmac_f32_16x16x64_bf16 v[76:79], v[16:19], v[236:243], v2
    ds_read_b128 v[100:103], v5 offset:0
    v_max_f32_dpp v58, v58, v58 row_ror:2 row_mask:0xf bank_mask:0xf
    v_smfmac_f32_16x16x64_bf16 v[76:79], v[20:23], v[148:155], v2
    ds_read_b128 v[104:107], v5 offset:16
    v_max_f32_dpp v58, v58, v58 row_ror:1 row_mask:0xf bank_mask:0xf
    v_smfmac_f32_16x16x64_bf16 v[76:79], v[24:27], v[244:251], v2
    ds_read_b128 v[108:111], v5 offset:128
    v_sub_f32 v60, v56, v58
    ds_read_b128 v[112:115], v5 offset:144
    v_exp_f32 v60, v60
    s_nop 1
    v_add_f32_dpp v59, v60, v60 row_ror:8 row_mask:0xf bank_mask:0xf
    s_nop 1
    v_add_f32_dpp v59, v59, v59 row_ror:4 row_mask:0xf bank_mask:0xf
    s_nop 1
    v_add_f32_dpp v59, v59, v59 row_ror:2 row_mask:0xf bank_mask:0xf
    s_nop 1
    v_add_f32_dpp v59, v59, v59 row_ror:1 row_mask:0xf bank_mask:0xf
    v_add_f32 v76, v76, v78
    v_add_f32 v77, v77, v79
    v_cvt_pk_bf16_f32 v76, v76, v77
    ds_write_b16 v3, v76 offset:3456
    ds_write_b16_d16_hi v3, v76 offset:3856
    ds_write_b64 v6, v[58:59] offset:0
    s_waitcnt lgkmcnt(5)
    v_smfmac_f32_16x16x64_bf16 v[84:87], v[88:91], v[100:107], v2
    s_waitcnt lgkmcnt(3)
    v_smfmac_f32_16x16x64_bf16 v[84:87], v[92:95], v[108:115], v2
    s_waitcnt lgkmcnt(0)
    s_barrier
    ds_read_b128 v[116:119], v5 offset:256
    ds_read_b128 v[120:123], v5 offset:272
    ds_read_b64 v[16:17], v6 offset:512
    s_waitcnt lgkmcnt(1)
    v_smfmac_f32_16x16x64_bf16 v[84:87], v[96:99], v[116:123], v2
    s_waitcnt lgkmcnt(0)
    v_max_f32 v18, v58, v16
    v_sub_f32 v19, v58, v18
    v_sub_f32 v20, v16, v18
    v_exp_f32 v19, v19
    v_exp_f32 v20, v20
    s_nop 0
    v_mul_f32 v21, v59, v19
    v_mul_f32 v60, v60, v19
    v_fmac_f32 v21, v17, v20
    v_add_f32 v22, v84, v86
    v_mul_f32 v22, 0x3dd53b95, v22
    v_max_f32 v23, v22, v18
    s_nop 0
    v_max_f32_dpp v24, v22, v23 row_ror:4 row_mask:0xf bank_mask:0xf
    s_nop 1
    v_max_f32_dpp v24, v24, v24 row_ror:2 row_mask:0xf bank_mask:0xf
    s_nop 1
    v_max_f32_dpp v24, v24, v24 row_ror:1 row_mask:0xf bank_mask:0xf
    v_sub_f32 v25, v22, v24
    v_sub_f32 v26, v18, v24
    v_exp_f32 v25, v25
    v_exp_f32 v26, v26
    s_nop 0
    v_add_f32_dpp v23, v25, v25 row_ror:4 row_mask:0xf bank_mask:0xf
    v_mul_f32 v60, v60, v26
    s_nop 0
    v_add_f32_dpp v23, v23, v23 row_ror:2 row_mask:0xf bank_mask:0xf
    s_nop 1
    v_add_f32_dpp v23, v23, v23 row_ror:1 row_mask:0xf bank_mask:0xf
    v_fmac_f32 v23, v26, v21
    v_rcp_f32 v27, v23
    s_nop 0
    v_mul_f32 v60, v60, v27
    v_mul_f32 v25, v25, v27
    s_nop 0
    v_mov_b32_dpp v19, v60 quad_perm:[1,0,3,2] row_mask:0xf bank_mask:0xf
    v_mov_b32_dpp v20, v25 quad_perm:[1,0,3,2] row_mask:0xf bank_mask:0xf
    v_cvt_pk_bf16_f32 v28, v60, v19
    v_cvt_pk_bf16_f32 v25, v25, v20
    s_nop 0
    v_mov_b32_dpp v29, v28 row_shl:2 row_mask:0xf bank_mask:0xf
    v_mov_b32_dpp v30, v28 row_shl:4 row_mask:0xf bank_mask:0xf
    v_mov_b32_dpp v31, v28 row_shl:6 row_mask:0xf bank_mask:0xf
    v_mov_b32_dpp v28, v25 row_shr:4 row_mask:0xf bank_mask:0x2
    v_mov_b32_dpp v29, v25 row_shr:2 row_mask:0xf bank_mask:0x2
    v_mov_b32_dpp v30, v25 quad_perm:[0,1,2,3] row_mask:0xf bank_mask:0x2
    v_mov_b32_dpp v31, v25 row_shl:2 row_mask:0xf bank_mask:0x2
    s_mov_b32 exec_lo, 0x1110111
    s_mov_b32 exec_hi, 0x1010101
    buffer_store_dwordx4 v[28:31], v7, s[8:11], s18 offen sc1
    s_mov_b64 exec, -1
    ds_read_b128 v[40:43], v10
    s_add_u32 s28, s14, 1
    s_min_u32 s28, s28, 63
    s_cmp_gt_u32 s47, s28
    s_cbranch_scc1 layerb1_kernel_p0_gw2_ok
layerb1_kernel_p0_gw2_lp:
    buffer_load_dword v253, v255, s[8:11], s48 offen sc1
    s_waitcnt vmcnt(0)
    v_readlane_b32 s47, v253, 0
    v_readlane_b32 s29, v253, 1
    s_nop 0
    s_min_u32 s47, s47, s29
    s_sub_u32 s15, s15, 1
    s_cbranch_scc1 layerb1_kernel_bail
    s_cmp_gt_u32 s47, s28
    s_cbranch_scc0 layerb1_kernel_p0_gw2_lp
layerb1_kernel_p0_gw2_ok:
    s_mul_i32 s20, s28, 393216
    s_add_u32 s20, s20, s44
    s_add_u32 s21, s20, 0
    buffer_load_dwordx4 v[100:103], v9, s[8:11], s21 offen offset:0 sc1
    buffer_load_dwordx4 v[104:107], v9, s[8:11], s21 offen offset:512 sc1
    s_add_u32 s21, s20, 4096
    buffer_load_dwordx4 v[108:111], v9, s[8:11], s21 offen offset:0 sc1
    buffer_load_dwordx4 v[112:115], v9, s[8:11], s21 offen offset:512 sc1
    s_add_u32 s21, s20, 8192
    buffer_load_dwordx4 v[116:119], v9, s[8:11], s21 offen offset:0 sc1
    buffer_load_dwordx4 v[120:123], v9, s[8:11], s21 offen offset:512 sc1
    v_mov_b32 v56, 0
    v_mov_b32 v57, 0
    v_mov_b32 v58, 0
    v_mov_b32 v59, 0
    v_mov_b32 v60, 0
    v_mov_b32 v61, 0
    v_mov_b32 v62, 0
    v_mov_b32 v63, 0
    v_mov_b32 v64, 0
    v_mov_b32 v65, 0
    v_mov_b32 v66, 0
    v_mov_b32 v67, 0
    v_mov_b32 v68, 0
    v_mov_b32 v69, 0
    v_mov_b32 v70, 0
    v_mov_b32 v71, 0
    v_mov_b32 v72, 0
    v_mov_b32 v73, 0
    v_mov_b32 v74, 0
    v_mov_b32 v75, 0
    v_mov_b32 v76, 0
    v_mov_b32 v77, 0
    v_mov_b32 v78, 0
    v_mov_b32 v79, 0
    v_mov_b32 v80, 0
    v_mov_b32 v81, 0
    v_mov_b32 v82, 0
    v_mov_b32 v83, 0
    v_mov_b32 v84, 0
    v_mov_b32 v85, 0
    v_mov_b32 v86, 0
    v_mov_b32 v87, 0
    s_waitcnt lgkmcnt(0)
    s_mul_i32 s20, s14, 98304
    s_add_u32 s20, s20, s45
    buffer_store_dwordx4 v[40:43], v11, s[8:11], s20 offen sc1
    ds_read_b128 v[124:127], v13 offset:0
    ds_read_b128 v[128:131], v13 offset:1024
    ds_read_b128 v[132:135], v13 offset:2048
    ds_read_b128 v[136:139], v13 offset:3072
    ds_read_b128 v[140:143], v13 offset:4096
    ds_read_b128 v[144:147], v13 offset:5120
    ds_read_b128 v[148:151], v13 offset:6144
    ds_read_b128 v[152:155], v13 offset:7168
    s_waitcnt lgkmcnt(0)
    s_add_u32 s14, s14, 1
    s_cmp_lt_u32 s14, 64
    s_cbranch_scc1 layerb1_kernel_p0_step
    s_waitcnt vmcnt(0)
    s_barrier
    s_branch layerb1_kernel_end
layerb1_kernel_p1_start:
    v_lshrrev_b32 v16, 4, v0
    v_and_b32 v17, 15, v0
    v_and_b32 v18, 2, v0
    v_cmp_eq_u32 vcc, 0, v18
    v_mov_b32 v18, 0xeeeeeeee
    v_mov_b32 v19, 0x44444444
    v_cndmask_b32 v2, v18, v19, vcc
    v_lshrrev_b32 v20, 2, v17
    v_lshlrev_b32 v20, 1, v20
    v_and_b32 v21, 1, v17
    v_add_u32 v20, v20, v21
    v_bfe_u32 v21, v17, 1, 1
    v_lshl_add_u32 v18, v16, 1, v21
    v_lshlrev_b32 v18, 7, v18
    v_lshl_add_u32 v12, v20, 4, v18
    v_mul_u32_u24 v18, 400, v20
    v_lshl_add_u32 v18, v16, 5, v18
    v_lshl_add_u32 v18, v21, 4, v18
    v_add_u32 v4, 141312, v18
    v_mul_u32_u24 v18, 800, v16
    v_lshl_add_u32 v18, v17, 1, v18
    v_add_u32 v3, 141344, v18
    v_and_b32 v18, 7, v0
    v_mul_u32_u24 v18, 400, v18
    v_lshl_add_u32 v18, v16, 5, v18
    v_add_u32 v5, 144512, v18
    v_lshlrev_b32 v18, 3, v0
    v_add_u32 v6, 147712, v18
    v_lshlrev_b32 v18, 4, v16
    v_bfe_u32 v19, v17, 1, 2
    v_lshl_add_u32 v18, v19, 2, v18
    s_lshl_b32 s20, s12, 7
    s_add_u32 s20, s20, 0
    v_add_u32 v18, s20, v18
    v_lshrrev_b32 v19, 3, v17
    v_add_u32 v19, 3, v19
    v_lshrrev_b32 v20, 1, v19
    v_lshlrev_b32 v20, 14, v20
    v_and_b32 v19, 1, v19
    v_lshl_add_u32 v19, v19, 12, v20
    v_add_u32 v19, v19, v18
    v_mov_b32 v20, 0x7ffffff0
    v_and_b32 v21, 7, v0
    v_cmp_eq_u32 vcc, 4, v21
    v_subrev_u32 v21, 8, v18
    s_nop 0
    v_cndmask_b32 v7, v19, v21, vcc
    v_and_b32 v21, 0x29, v0
    v_cmp_eq_u32 vcc, 32, v21
    s_nop 1
    v_cndmask_b32 v8, v20, v18, vcc
    s_lshl_b32 s20, s12, 2
    v_lshlrev_b32 v18, 7, v0
    v_add_u32 v8, s20, v18
    v_lshlrev_b32 v18, 4, v17
    v_lshl_add_u32 v18, v16, 10, v18
    v_add_u32 v9, 256, v18
    v_add_u32 v18, 64, v0
    v_mul_u32_u24 v19, 2731, v18
    v_lshrrev_b32 v19, 16, v19
    v_mul_u32_u24 v20, 24, v19
    v_sub_u32 v20, v18, v20
    v_mul_u32_u24 v21, 400, v19
    v_lshl_add_u32 v21, v20, 4, v21
    v_add_u32 v10, 144512, v21
    v_lshlrev_b32 v21, 4, v19
    v_lshl_add_u32 v11, v20, 7, v21
    v_add_u32 v13, 32768, v1
    v_add_u32 v14, 131072, v1
    s_mul_i32 s44, s12, 12288
    s_add_u32 s44, s44, 53477376
    s_mul_i32 s45, s12, 3072
    s_add_u32 s45, s45, 208666624
    s_mul_i32 s20, s12, 6
    s_add_u32 s21, s20, 5
    s_lshr_b32 s20, s20, 3
    s_lshr_b32 s21, s21, 3
    s_add_u32 s20, s20, 80
    s_add_u32 s21, s21, 80
    s_lshl_b32 s20, s20, 7
    s_lshl_b32 s21, s21, 7
    v_mov_b32 v255, s21
    v_mov_b32 v253, s20
    v_cmp_eq_u32 vcc, 0, v0
    s_nop 1
    v_cndmask_b32 v255, v255, v253, vcc
    s_mov_b32 s47, 0
    s_mul_i32 s20, s12, 491520
    s_add_u32 s20, s20, 11657216
    s_add_u32 s21, s20, 8192
    buffer_load_dwordx4 v[16:19], v1, s[8:11], s21 offen offset:0
    buffer_load_dwordx4 v[20:23], v1, s[8:11], s21 offen offset:1024
    s_add_u32 s21, s20, 30720
    buffer_load_dwordx4 v[24:27], v1, s[8:11], s21 offen offset:0
    buffer_load_dwordx4 v[28:31], v1, s[8:11], s21 offen offset:1024
    s_add_u32 s21, s20, 0
    buffer_load_dwordx4 v[32:35], v1, s[8:11], s21 offen offset:0
    buffer_load_dwordx4 v[36:39], v1, s[8:11], s21 offen offset:1024
    s_add_u32 s21, s20, 14336
    buffer_load_dwordx4 v[40:43], v1, s[8:11], s21 offen offset:0
    buffer_load_dwordx4 v[44:47], v1, s[8:11], s21 offen offset:1024
    s_add_u32 s21, s20, 22528
    buffer_load_dwordx4 v[48:51], v1, s[8:11], s21 offen offset:0
    buffer_load_dwordx4 v[52:55], v1, s[8:11], s21 offen offset:1024
    s_add_u32 s21, s20, 36864
    buffer_load_dwordx4 v[56:59], v1, s[8:11], s21 offen offset:0
    buffer_load_dwordx4 v[60:63], v1, s[8:11], s21 offen offset:1024
    s_add_u32 s21, s20, 45056
    buffer_load_dwordx4 v[64:67], v1, s[8:11], s21 offen offset:0
    buffer_load_dwordx4 v[68:71], v1, s[8:11], s21 offen offset:1024
    s_add_u32 s21, s20, 59392
    buffer_load_dwordx4 v[72:75], v1, s[8:11], s21 offen offset:0
    buffer_load_dwordx4 v[76:79], v1, s[8:11], s21 offen offset:1024
    s_add_u32 s21, s20, 73728
    buffer_load_dwordx4 v[80:83], v1, s[8:11], s21 offen offset:0
    buffer_load_dwordx4 v[84:87], v1, s[8:11], s21 offen offset:1024
    s_add_u32 s21, s20, 71680
    buffer_load_dwordx4 v[88:91], v1, s[8:11], s21 offen offset:0
    buffer_load_dwordx4 v[92:95], v1, s[8:11], s21 offen offset:1024
    s_add_u32 s21, s20, 94208
    buffer_load_dwordx4 v[96:99], v1, s[8:11], s21 offen offset:0
    buffer_load_dwordx4 v[100:103], v1, s[8:11], s21 offen offset:1024
    s_add_u32 s21, s20, 88064
    buffer_load_dwordx4 v[104:107], v1, s[8:11], s21 offen offset:0
    buffer_load_dwordx4 v[108:111], v1, s[8:11], s21 offen offset:1024
    s_add_u32 s21, s20, 102400
    buffer_load_dwordx4 v[112:115], v1, s[8:11], s21 offen offset:0
    buffer_load_dwordx4 v[116:119], v1, s[8:11], s21 offen offset:1024
    s_add_u32 s21, s20, 114688
    buffer_load_dwordx4 v[120:123], v1, s[8:11], s21 offen offset:0
    buffer_load_dwordx4 v[124:127], v1, s[8:11], s21 offen offset:1024
    s_add_u32 s21, s20, 120832
    buffer_load_dwordx4 v[128:131], v1, s[8:11], s21 offen offset:0
    buffer_load_dwordx4 v[132:135], v1, s[8:11], s21 offen offset:1024
    s_add_u32 s21, s20, 110592
    buffer_load_dwordx4 v[136:139], v1, s[8:11], s21 offen offset:0
    buffer_load_dwordx4 v[140:143], v1, s[8:11], s21 offen offset:1024
    s_add_u32 s21, s20, 86016
    buffer_load_dwordx4 v[156:159], v1, s[8:11], s21 offen offset:0
    buffer_load_dwordx4 v[160:163], v1, s[8:11], s21 offen offset:1024
    s_add_u32 s21, s20, 96256
    buffer_load_dwordx4 v[164:167], v1, s[8:11], s21 offen offset:0
    buffer_load_dwordx4 v[168:171], v1, s[8:11], s21 offen offset:1024
    s_add_u32 s21, s20, 98304
    buffer_load_dwordx4 v[172:175], v1, s[8:11], s21 offen offset:0
    buffer_load_dwordx4 v[176:179], v1, s[8:11], s21 offen offset:1024
    s_add_u32 s21, s20, 100352
    buffer_load_dwordx4 v[180:183], v1, s[8:11], s21 offen offset:0
    buffer_load_dwordx4 v[184:187], v1, s[8:11], s21 offen offset:1024
    s_add_u32 s21, s20, 90112
    buffer_load_dwordx4 v[188:191], v1, s[8:11], s21 offen offset:0
    buffer_load_dwordx4 v[192:195], v1, s[8:11], s21 offen offset:1024
    s_add_u32 s21, s20, 92160
    buffer_load_dwordx4 v[196:199], v1, s[8:11], s21 offen offset:0
    buffer_load_dwordx4 v[200:203], v1, s[8:11], s21 offen offset:1024
    s_add_u32 s21, s20, 104448
    buffer_load_dwordx4 v[204:207], v1, s[8:11], s21 offen offset:0
    buffer_load_dwordx4 v[208:211], v1, s[8:11], s21 offen offset:1024
    s_add_u32 s21, s20, 106496
    buffer_load_dwordx4 v[212:215], v1, s[8:11], s21 offen offset:0
    buffer_load_dwordx4 v[216:219], v1, s[8:11], s21 offen offset:1024
    s_add_u32 s21, s20, 116736
    buffer_load_dwordx4 v[220:223], v1, s[8:11], s21 offen offset:0
    buffer_load_dwordx4 v[224:227], v1, s[8:11], s21 offen offset:1024
    s_add_u32 s21, s20, 118784
    buffer_load_dwordx4 v[228:231], v1, s[8:11], s21 offen offset:0
    buffer_load_dwordx4 v[232:235], v1, s[8:11], s21 offen offset:1024
    s_add_u32 s21, s20, 108544
    buffer_load_dwordx4 v[236:239], v1, s[8:11], s21 offen offset:0
    buffer_load_dwordx4 v[240:243], v1, s[8:11], s21 offen offset:1024
    s_add_u32 s21, s20, 112640
    buffer_load_dwordx4 v[244:247], v1, s[8:11], s21 offen offset:0
    buffer_load_dwordx4 v[248:251], v1, s[8:11], s21 offen offset:1024
    s_waitcnt vmcnt(24)
    ds_write_b128 v13, v[16:19] offset:0
    ds_write_b128 v13, v[20:23] offset:1024
    ds_write_b128 v13, v[24:27] offset:2048
    ds_write_b128 v13, v[28:31] offset:3072
    ds_write_b128 v13, v[32:35] offset:4096
    ds_write_b128 v13, v[36:39] offset:5120
    ds_write_b128 v13, v[40:43] offset:6144
    ds_write_b128 v13, v[44:47] offset:7168
    ds_write_b128 v13, v[48:51] offset:8192
    ds_write_b128 v13, v[52:55] offset:9216
    ds_write_b128 v13, v[56:59] offset:10240
    ds_write_b128 v13, v[60:63] offset:11264
    ds_write_b128 v13, v[64:67] offset:12288
    ds_write_b128 v13, v[68:71] offset:13312
    ds_write_b128 v13, v[72:75] offset:14336
    ds_write_b128 v13, v[76:79] offset:15360
    ds_write_b128 v13, v[80:83] offset:16384
    ds_write_b128 v13, v[84:87] offset:17408
    ds_write_b128 v13, v[88:91] offset:18432
    ds_write_b128 v13, v[92:95] offset:19456
    ds_write_b128 v13, v[96:99] offset:20480
    ds_write_b128 v13, v[100:103] offset:21504
    ds_write_b128 v13, v[104:107] offset:22528
    ds_write_b128 v13, v[108:111] offset:23552
    ds_write_b128 v13, v[112:115] offset:24576
    ds_write_b128 v13, v[116:119] offset:25600
    ds_write_b128 v13, v[120:123] offset:26624
    ds_write_b128 v13, v[124:127] offset:27648
    ds_write_b128 v13, v[128:131] offset:28672
    ds_write_b128 v13, v[132:135] offset:29696
    ds_write_b128 v13, v[136:139] offset:30720
    ds_write_b128 v13, v[140:143] offset:31744
    s_waitcnt lgkmcnt(0)
    s_add_u32 s20, s48, 51200
    s_mov_b64 exec, 3
    v_lshlrev_b32 v16, 2, v0
layerb1_kernel_p1_par:
    buffer_load_dword v17, v16, s[8:11], s20 offen sc1
    s_waitcnt vmcnt(0)
    v_cmp_eq_u32 vcc, 0, v17
    s_sub_u32 s15, s15, 1
    s_cbranch_scc1 layerb1_kernel_bail
    s_cbranch_vccnz layerb1_kernel_p1_par
    s_mov_b64 exec, -1
    v_readlane_b32 s20, v17, 0
    v_readlane_b32 s21, v17, 1
    s_nop 0
    s_and_b32 s20, s20, 8192
    s_and_b32 s21, s21, 8192
    s_add_u32 s16, s16, s20
    s_add_u32 s17, s17, s21
    s_mov_b32 s14, 0
    s_cmp_gt_u32 s47, s14
    s_cbranch_scc1 layerb1_kernel_p1_gw1_ok
layerb1_kernel_p1_gw1_lp:
    buffer_load_dword v253, v255, s[8:11], s48 offen sc1
    s_waitcnt vmcnt(0)
    v_readlane_b32 s47, v253, 0
    v_readlane_b32 s29, v253, 1
    s_nop 0
    s_min_u32 s47, s47, s29
    s_sub_u32 s15, s15, 1
    s_cbranch_scc1 layerb1_kernel_bail
    s_cmp_gt_u32 s47, s14
    s_cbranch_scc0 layerb1_kernel_p1_gw1_lp
layerb1_kernel_p1_gw1_ok:
    s_mul_i32 s20, s14, 393216
    s_add_u32 s20, s20, s44
    s_add_u32 s21, s20, 0
    buffer_load_dwordx4 v[100:103], v9, s[8:11], s21 offen offset:0 sc1
    buffer_load_dwordx4 v[104:107], v9, s[8:11], s21 offen offset:512 sc1
    s_add_u32 s21, s20, 4096
    buffer_load_dwordx4 v[108:111], v9, s[8:11], s21 offen offset:0 sc1
    buffer_load_dwordx4 v[112:115], v9, s[8:11], s21 offen offset:512 sc1
    s_add_u32 s21, s20, 8192
    buffer_load_dwordx4 v[116:119], v9, s[8:11], s21 offen offset:0 sc1
    buffer_load_dwordx4 v[120:123], v9, s[8:11], s21 offen offset:512 sc1
    v_mov_b32 v56, 0
    v_mov_b32 v57, 0
    v_mov_b32 v58, 0
    v_mov_b32 v59, 0
    v_mov_b32 v60, 0
    v_mov_b32 v61, 0
    v_mov_b32 v62, 0
    v_mov_b32 v63, 0
    v_mov_b32 v64, 0
    v_mov_b32 v65, 0
    v_mov_b32 v66, 0
    v_mov_b32 v67, 0
    v_mov_b32 v68, 0
    v_mov_b32 v69, 0
    v_mov_b32 v70, 0
    v_mov_b32 v71, 0
    v_mov_b32 v72, 0
    v_mov_b32 v73, 0
    v_mov_b32 v74, 0
    v_mov_b32 v75, 0
    v_mov_b32 v76, 0
    v_mov_b32 v77, 0
    v_mov_b32 v78, 0
    v_mov_b32 v79, 0
    v_mov_b32 v80, 0
    v_mov_b32 v81, 0
    v_mov_b32 v82, 0
    v_mov_b32 v83, 0
    v_mov_b32 v84, 0
    v_mov_b32 v85, 0
    v_mov_b32 v86, 0
    v_mov_b32 v87, 0
    ds_read_b128 v[124:127], v13 offset:0
    ds_read_b128 v[128:131], v13 offset:1024
    ds_read_b128 v[132:135], v13 offset:2048
    ds_read_b128 v[136:139], v13 offset:3072
    ds_read_b128 v[140:143], v13 offset:4096
    ds_read_b128 v[144:147], v13 offset:5120
    ds_read_b128 v[148:151], v13 offset:6144
    ds_read_b128 v[152:155], v13 offset:7168
    s_waitcnt lgkmcnt(0)
layerb1_kernel_p1_step:
    s_cmp_lt_u32 s14, 32
    s_cselect_b32 s18, s16, s17
    s_and_b32 s20, s14, 31
    s_lshl_b32 s20, s20, 16
    s_add_u32 s18, s18, s20
    s_add_u32 s69, s18, 55424
    s_add_u32 s22, s18, 39936
    s_add_u32 s23, s18, 49152
    s_add_u32 s24, s18, 50176
layerb1_kernel_p1_poll:
    buffer_load_dwordx4 v[28:31], v12, s[8:11], s22 offen sc1
    buffer_load_dwordx4 v[32:35], v12, s[8:11], s23 offen sc1
    buffer_load_dwordx4 v[36:39], v12, s[8:11], s24 offen sc1
    s_waitcnt vmcnt(0)
    ds_write_b128 v14, v[28:31] offset:3072
    ds_write_b128 v14, v[32:35] offset:4096
    ds_write_b128 v14, v[36:39] offset:5120
    v_max3_u32 v88, v28, v29, v30
    v_max3_u32 v88, v88, v31, v32
    v_max3_u32 v88, v88, v33, v34
    v_max3_u32 v88, v88, v35, v36
    v_max3_u32 v88, v88, v37, v38
    v_max_u32 v88, v88, v39
    v_cmp_eq_u32 vcc, -1, v88
    s_sub_u32 s15, s15, 1
    s_cbranch_scc1 layerb1_kernel_bail
    s_cbranch_vccnz layerb1_kernel_p1_poll
    v_smfmac_f32_16x16x64_bf16 v[56:59], v[28:31], a[0:7], v2
    v_smfmac_f32_16x16x64_bf16 v[60:63], v[28:31], a[8:15], v2
    v_smfmac_f32_16x16x64_bf16 v[64:67], v[28:31], a[16:23], v2
    v_smfmac_f32_16x16x64_bf16 v[56:59], v[32:35], v[124:131], v2
    ds_read_b128 v[124:127], v13 offset:8192
    v_smfmac_f32_16x16x64_bf16 v[60:63], v[32:35], a[24:31], v2
    s_waitcnt lgkmcnt(1)
    s_barrier
    v_smfmac_f32_16x16x64_bf16 v[64:67], v[32:35], a[32:39], v2
    ds_read_b128 v[16:19], v14 offset:0
    v_smfmac_f32_16x16x64_bf16 v[56:59], v[36:39], a[40:47], v2
    ds_read_b128 v[20:23], v14 offset:1024
    v_smfmac_f32_16x16x64_bf16 v[60:63], v[36:39], v[132:139], v2
    ds_read_b128 v[24:27], v14 offset:2048
    v_smfmac_f32_16x16x64_bf16 v[64:67], v[36:39], a[48:55], v2
    ds_read_b128 v[40:43], v14 offset:6144
    v_smfmac_f32_16x16x64_bf16 v[68:71], v[28:31], a[56:63], v2
    ds_read_b128 v[44:47], v14 offset:7168
    v_smfmac_f32_16x16x64_bf16 v[68:71], v[32:35], a[64:71], v2
    s_waitcnt lgkmcnt(4)
    ds_read_b128 v[48:51], v14 offset:8192
    v_smfmac_f32_16x16x64_bf16 v[56:59], v[16:19], v[140:147], v2
    s_waitcnt lgkmcnt(4)
    ds_read_b128 v[52:55], v14 offset:9216
    v_smfmac_f32_16x16x64_bf16 v[56:59], v[20:23], a[72:79], v2
    s_waitcnt lgkmcnt(4)
    ds_read_b128 v[128:131], v13 offset:9216
    v_smfmac_f32_16x16x64_bf16 v[56:59], v[24:27], a[80:87], v2
    s_waitcnt lgkmcnt(4)
    ds_read_b128 v[132:135], v13 offset:10240
    v_smfmac_f32_16x16x64_bf16 v[56:59], v[40:43], a[88:95], v2
    s_waitcnt lgkmcnt(4)
    ds_read_b128 v[136:139], v13 offset:11264
    v_smfmac_f32_16x16x64_bf16 v[56:59], v[44:47], v[148:155], v2
    s_waitcnt lgkmcnt(4)
    ds_read_b128 v[140:143], v13 offset:12288
    v_smfmac_f32_16x16x64_bf16 v[56:59], v[48:51], a[96:103], v2
    s_waitcnt lgkmcnt(4)
    ds_read_b128 v[144:147], v13 offset:13312
    v_smfmac_f32_16x16x64_bf16 v[56:59], v[52:55], a[104:111], v2
    ds_read_b128 v[148:151], v13 offset:14336
    v_smfmac_f32_16x16x64_bf16 v[60:63], v[16:19], a[112:119], v2
    s_waitcnt lgkmcnt(5)
    ds_read_b128 v[152:155], v13 offset:15360
    v_smfmac_f32_16x16x64_bf16 v[60:63], v[20:23], v[124:131], v2
    ds_read_b128 v[124:127], v13 offset:16384
    v_add_f32 v56, v56, v58
    v_smfmac_f32_16x16x64_bf16 v[60:63], v[24:27], a[120:127], v2
    ds_read_b128 v[128:131], v13 offset:17408
    v_add_f32 v57, v57, v59
    v_smfmac_f32_16x16x64_bf16 v[60:63], v[40:43], a[128:135], v2
    v_cvt_pk_bf16_f32 v56, v56, v57
    v_smfmac_f32_16x16x64_bf16 v[60:63], v[44:47], a[136:143], v2
    s_waitcnt lgkmcnt(6)
    ds_write_b16 v3, v56 offset:0
    v_smfmac_f32_16x16x64_bf16 v[60:63], v[48:51], v[132:139], v2
    ds_write_b16_d16_hi v3, v56 offset:400
    v_smfmac_f32_16x16x64_bf16 v[60:63], v[52:55], a[144:151], v2
    ds_read_b128 v[132:135], v13 offset:18432
    v_smfmac_f32_16x16x64_bf16 v[64:67], v[16:19], a[152:159], v2
    ds_read_b128 v[136:139], v13 offset:19456
    v_smfmac_f32_16x16x64_bf16 v[64:67], v[20:23], a[160:167], v2
    s_waitcnt lgkmcnt(8)
    v_add_f32 v60, v60, v62
    v_smfmac_f32_16x16x64_bf16 v[64:67], v[24:27], v[140:147], v2
    ds_read_b128 v[140:143], v13 offset:20480
    v_add_f32 v61, v61, v63
    v_smfmac_f32_16x16x64_bf16 v[64:67], v[40:43], a[168:175], v2
    ds_read_b128 v[144:147], v13 offset:21504
    v_cvt_pk_bf16_f32 v60, v60, v61
    v_smfmac_f32_16x16x64_bf16 v[64:67], v[44:47], a[176:183], v2
    ds_write_b16 v3, v60 offset:128
    v_smfmac_f32_16x16x64_bf16 v[64:67], v[48:51], a[184:191], v2
    s_waitcnt lgkmcnt(9)
    ds_write_b16_d16_hi v3, v60 offset:528
    v_smfmac_f32_16x16x64_bf16 v[64:67], v[52:55], v[148:155], v2
    ds_read_b128 v[148:151], v13 offset:22528
    v_smfmac_f32_16x16x64_bf16 v[68:71], v[16:19], a[192:199], v2
    ds_read_b128 v[152:155], v13 offset:23552
    v_smfmac_f32_16x16x64_bf16 v[68:71], v[20:23], a[200:207], v2
    v_add_f32 v64, v64, v66
    v_smfmac_f32_16x16x64_bf16 v[68:71], v[24:27], a[208:215], v2
    s_waitcnt lgkmcnt(10)
    v_add_f32 v65, v65, v67
    v_smfmac_f32_16x16x64_bf16 v[68:71], v[40:43], v[124:131], v2
    ds_read_b128 v[124:127], v13 offset:24576
    v_cvt_pk_bf16_f32 v64, v64, v65
    v_smfmac_f32_16x16x64_bf16 v[68:71], v[44:47], a[216:223], v2
    ds_write_b16 v3, v64 offset:256
    v_smfmac_f32_16x16x64_bf16 v[68:71], v[48:51], a[224:231], v2
    ds_write_b16_d16_hi v3, v64 offset:656
    v_smfmac_f32_16x16x64_bf16 v[68:71], v[52:55], a[232:239], v2
    s_waitcnt lgkmcnt(9)
    ds_read_b128 v[128:131], v13 offset:25600
    v_smfmac_f32_16x16x64_bf16 v[68:71], v[36:39], v[132:139], v2
    ds_read_b128 v[132:135], v13 offset:26624
    v_smfmac_f32_16x16x64_bf16 v[72:75], v[16:19], a[240:247], v2
    ds_read_b128 v[136:139], v13 offset:27648
    v_smfmac_f32_16x16x64_bf16 v[72:75], v[20:23], a[248:255], v2
    v_add_f32 v68, v68, v70
    v_smfmac_f32_16x16x64_bf16 v[72:75], v[24:27], v[156:163], v2
    s_waitcnt lgkmcnt(10)
    v_add_f32 v69, v69, v71
    v_smfmac_f32_16x16x64_bf16 v[72:75], v[40:43], v[140:147], v2
    ds_read_b128 v[140:143], v13 offset:28672
    v_cvt_pk_bf16_f32 v68, v68, v69
    v_smfmac_f32_16x16x64_bf16 v[72:75], v[44:47], v[164:171], v2
    s_waitcnt lgkmcnt(4)
    s_barrier
    v_smfmac_f32_16x16x64_bf16 v[72:75], v[48:51], v[172:179], v2
    ds_read_b128 v[88:91], v4 offset:0
    v_smfmac_f32_16x16x64_bf16 v[72:75], v[52:55], v[180:187], v2
    ds_read_b128 v[92:95], v4 offset:128
    v_smfmac_f32_16x16x64_bf16 v[72:75], v[28:31], v[148:155], v2
    ds_read_b128 v[96:99], v4 offset:256
    v_smfmac_f32_16x16x64_bf16 v[72:75], v[32:35], v[188:195], v2
    ds_write_b16 v3, v68 offset:3200
    v_smfmac_f32_16x16x64_bf16 v[72:75], v[36:39], v[196:203], v2
    s_waitcnt lgkmcnt(7)
    ds_write_b16_d16_hi v3, v68 offset:3600
    v_smfmac_f32_16x16x64_bf16 v[76:79], v[16:19], v[124:131], v2
    s_waitcnt lgkmcnt(4)
    ds_read_b128 v[144:147], v13 offset:29696
    v_smfmac_f32_16x16x64_bf16 v[80:83], v[88:91], v[100:107], v2
    s_waitcnt lgkmcnt(4)
    ds_read_b128 v[148:151], v13 offset:30720
    v_add_f32 v72, v72, v74
    v_smfmac_f32_16x16x64_bf16 v[80:83], v[92:95], v[108:115], v2
    s_waitcnt lgkmcnt(4)
    ds_read_b128 v[152:155], v13 offset:31744
    v_add_f32 v73, v73, v75
    v_smfmac_f32_16x16x64_bf16 v[80:83], v[96:99], v[116:123], v2
    v_cvt_pk_bf16_f32 v72, v72, v73
    v_smfmac_f32_16x16x64_bf16 v[76:79], v[20:23], v[204:211], v2
    ds_write_b16 v3, v72 offset:3328
    v_smfmac_f32_16x16x64_bf16 v[76:79], v[24:27], v[212:219], v2
    ds_write_b16_d16_hi v3, v72 offset:3728
    v_smfmac_f32_16x16x64_bf16 v[76:79], v[40:43], v[132:139], v2
    v_add_f32 v56, v80, v82
    v_smfmac_f32_16x16x64_bf16 v[76:79], v[44:47], v[220:227], v2
    v_mul_f32 v56, 0x3dd53b95, v56
    v_smfmac_f32_16x16x64_bf16 v[76:79], v[48:51], v[228:235], v2
    s_waitcnt lgkmcnt(4)
    v_max_f32_dpp v58, v56, v56 row_ror:8 row_mask:0xf bank_mask:0xf
    v_smfmac_f32_16x16x64_bf16 v[76:79], v[52:55], v[140:147], v2
    s_waitcnt lgkmcnt(0)
    s_barrier
    v_max_f32_dpp v58, v58, v58 row_ror:4 row_mask:0xf bank_mask:0xf
    v_smfmac_f32_16x16x64_bf16 v[76:79], v[28:31], v[236:243], v2
    ds_read_b128 v[100:103], v5 offset:0
    v_max_f32_dpp v58, v58, v58 row_ror:2 row_mask:0xf bank_mask:0xf
    v_smfmac_f32_16x16x64_bf16 v[76:79], v[32:35], v[148:155], v2
    ds_read_b128 v[104:107], v5 offset:16
    v_max_f32_dpp v58, v58, v58 row_ror:1 row_mask:0xf bank_mask:0xf
    v_smfmac_f32_16x16x64_bf16 v[76:79], v[36:39], v[244:251], v2
    ds_read_b128 v[108:111], v5 offset:128
    v_sub_f32 v60, v56, v58
    ds_read_b128 v[112:115], v5 offset:144
    v_exp_f32 v60, v60
    s_nop 1
    v_add_f32_dpp v59, v60, v60 row_ror:8 row_mask:0xf bank_mask:0xf
    s_nop 1
    v_add_f32_dpp v59, v59, v59 row_ror:4 row_mask:0xf bank_mask:0xf
    s_nop 1
    v_add_f32_dpp v59, v59, v59 row_ror:2 row_mask:0xf bank_mask:0xf
    s_nop 1
    v_add_f32_dpp v59, v59, v59 row_ror:1 row_mask:0xf bank_mask:0xf
    v_add_f32 v76, v76, v78
    v_add_f32 v77, v77, v79
    v_cvt_pk_bf16_f32 v76, v76, v77
    ds_write_b16 v3, v76 offset:3456
    ds_write_b16_d16_hi v3, v76 offset:3856
    ds_write_b64 v6, v[58:59] offset:512
    s_waitcnt lgkmcnt(5)
    v_smfmac_f32_16x16x64_bf16 v[84:87], v[88:91], v[100:107], v2
    s_waitcnt lgkmcnt(3)
    v_smfmac_f32_16x16x64_bf16 v[84:87], v[92:95], v[108:115], v2
    s_waitcnt lgkmcnt(0)
    s_barrier
    ds_read_b128 v[116:119], v5 offset:256
    ds_read_b128 v[120:123], v5 offset:272
    ds_read_b64 v[16:17], v6 offset:0
    s_waitcnt lgkmcnt(1)
    v_smfmac_f32_16x16x64_bf16 v[84:87], v[96:99], v[116:123], v2
    s_waitcnt lgkmcnt(0)
    v_max_f32 v18, v58, v16
    v_sub_f32 v19, v58, v18
    v_sub_f32 v20, v16, v18
    v_exp_f32 v19, v19
    v_exp_f32 v20, v20
    s_nop 0
    v_mul_f32 v21, v59, v19
    v_mul_f32 v60, v60, v19
    v_fmac_f32 v21, v17, v20
    v_add_f32 v22, v84, v86
    v_mul_f32 v22, 0x3dd53b95, v22
    v_max_f32 v23, v22, v18
    s_nop 0
    v_max_f32_dpp v24, v22, v23 row_ror:4 row_mask:0xf bank_mask:0xf
    s_nop 1
    v_max_f32_dpp v24, v24, v24 row_ror:2 row_mask:0xf bank_mask:0xf
    s_nop 1
    v_max_f32_dpp v24, v24, v24 row_ror:1 row_mask:0xf bank_mask:0xf
    v_sub_f32 v25, v22, v24
    v_sub_f32 v26, v18, v24
    v_exp_f32 v25, v25
    v_exp_f32 v26, v26
    s_nop 0
    v_add_f32_dpp v23, v25, v25 row_ror:4 row_mask:0xf bank_mask:0xf
    v_mul_f32 v60, v60, v26
    s_nop 0
    v_add_f32_dpp v23, v23, v23 row_ror:2 row_mask:0xf bank_mask:0xf
    s_nop 1
    v_add_f32_dpp v23, v23, v23 row_ror:1 row_mask:0xf bank_mask:0xf
    v_fmac_f32 v23, v26, v21
    v_rcp_f32 v27, v23
    s_nop 0
    v_mul_f32 v60, v60, v27
    v_mul_f32 v25, v25, v27
    s_nop 0
    v_mov_b32_dpp v19, v60 quad_perm:[1,0,3,2] row_mask:0xf bank_mask:0xf
    v_mov_b32_dpp v20, v25 quad_perm:[1,0,3,2] row_mask:0xf bank_mask:0xf
    v_cvt_pk_bf16_f32 v28, v60, v19
    v_cvt_pk_bf16_f32 v25, v25, v20
    s_nop 0
    v_mov_b32_dpp v29, v28 row_shl:2 row_mask:0xf bank_mask:0xf
    v_mov_b32_dpp v30, v28 row_shl:4 row_mask:0xf bank_mask:0xf
    v_mov_b32_dpp v31, v28 row_shl:6 row_mask:0xf bank_mask:0xf
    v_mov_b32_dpp v28, v25 row_shr:4 row_mask:0xf bank_mask:0x2
    v_mov_b32_dpp v29, v25 row_shr:2 row_mask:0xf bank_mask:0x2
    v_mov_b32_dpp v30, v25 quad_perm:[0,1,2,3] row_mask:0xf bank_mask:0x2
    v_mov_b32_dpp v31, v25 row_shl:2 row_mask:0xf bank_mask:0x2
    s_mov_b32 exec_lo, 0x1010101
    s_mov_b32 exec_hi, 0x1110111
    buffer_store_dwordx4 v[28:31], v7, s[8:11], s18 offen sc1
    s_mov_b64 exec, -1
    ds_read_b128 v[40:43], v10
    s_add_u32 s28, s14, 1
    s_min_u32 s28, s28, 63
    s_cmp_gt_u32 s47, s28
    s_cbranch_scc1 layerb1_kernel_p1_gw2_ok
layerb1_kernel_p1_gw2_lp:
    buffer_load_dword v253, v255, s[8:11], s48 offen sc1
    s_waitcnt vmcnt(0)
    v_readlane_b32 s47, v253, 0
    v_readlane_b32 s29, v253, 1
    s_nop 0
    s_min_u32 s47, s47, s29
    s_sub_u32 s15, s15, 1
    s_cbranch_scc1 layerb1_kernel_bail
    s_cmp_gt_u32 s47, s28
    s_cbranch_scc0 layerb1_kernel_p1_gw2_lp
layerb1_kernel_p1_gw2_ok:
    s_mul_i32 s20, s28, 393216
    s_add_u32 s20, s20, s44
    s_add_u32 s21, s20, 0
    buffer_load_dwordx4 v[100:103], v9, s[8:11], s21 offen offset:0 sc1
    buffer_load_dwordx4 v[104:107], v9, s[8:11], s21 offen offset:512 sc1
    s_add_u32 s21, s20, 4096
    buffer_load_dwordx4 v[108:111], v9, s[8:11], s21 offen offset:0 sc1
    buffer_load_dwordx4 v[112:115], v9, s[8:11], s21 offen offset:512 sc1
    s_add_u32 s21, s20, 8192
    buffer_load_dwordx4 v[116:119], v9, s[8:11], s21 offen offset:0 sc1
    buffer_load_dwordx4 v[120:123], v9, s[8:11], s21 offen offset:512 sc1
    v_mov_b32 v56, 0
    v_mov_b32 v57, 0
    v_mov_b32 v58, 0
    v_mov_b32 v59, 0
    v_mov_b32 v60, 0
    v_mov_b32 v61, 0
    v_mov_b32 v62, 0
    v_mov_b32 v63, 0
    v_mov_b32 v64, 0
    v_mov_b32 v65, 0
    v_mov_b32 v66, 0
    v_mov_b32 v67, 0
    v_mov_b32 v68, 0
    v_mov_b32 v69, 0
    v_mov_b32 v70, 0
    v_mov_b32 v71, 0
    v_mov_b32 v72, 0
    v_mov_b32 v73, 0
    v_mov_b32 v74, 0
    v_mov_b32 v75, 0
    v_mov_b32 v76, 0
    v_mov_b32 v77, 0
    v_mov_b32 v78, 0
    v_mov_b32 v79, 0
    v_mov_b32 v80, 0
    v_mov_b32 v81, 0
    v_mov_b32 v82, 0
    v_mov_b32 v83, 0
    v_mov_b32 v84, 0
    v_mov_b32 v85, 0
    v_mov_b32 v86, 0
    v_mov_b32 v87, 0
    s_waitcnt lgkmcnt(0)
    s_mul_i32 s20, s14, 98304
    s_add_u32 s20, s20, s45
    buffer_store_dwordx4 v[40:43], v11, s[8:11], s20 offen sc1
    ds_read_b128 v[124:127], v13 offset:0
    ds_read_b128 v[128:131], v13 offset:1024
    ds_read_b128 v[132:135], v13 offset:2048
    ds_read_b128 v[136:139], v13 offset:3072
    ds_read_b128 v[140:143], v13 offset:4096
    ds_read_b128 v[144:147], v13 offset:5120
    ds_read_b128 v[148:151], v13 offset:6144
    ds_read_b128 v[152:155], v13 offset:7168
    s_waitcnt lgkmcnt(0)
    s_add_u32 s14, s14, 1
    s_cmp_lt_u32 s14, 64
    s_cbranch_scc1 layerb1_kernel_p1_step
    s_waitcnt vmcnt(0)
    s_barrier
    s_branch layerb1_kernel_end
layerb1_kernel_p2_start:
    v_lshrrev_b32 v16, 4, v0
    v_and_b32 v17, 15, v0
    v_and_b32 v18, 2, v0
    v_cmp_eq_u32 vcc, 0, v18
    v_mov_b32 v18, 0xeeeeeeee
    v_mov_b32 v19, 0x44444444
    v_cndmask_b32 v2, v18, v19, vcc
    v_lshrrev_b32 v20, 2, v17
    v_lshlrev_b32 v20, 1, v20
    v_and_b32 v21, 1, v17
    v_add_u32 v20, v20, v21
    v_bfe_u32 v21, v17, 1, 1
    v_lshl_add_u32 v18, v16, 1, v21
    v_lshlrev_b32 v18, 7, v18
    v_lshl_add_u32 v12, v20, 4, v18
    v_mul_u32_u24 v18, 400, v20
    v_lshl_add_u32 v18, v16, 5, v18
    v_lshl_add_u32 v18, v21, 4, v18
    v_add_u32 v4, 141312, v18
    v_mul_u32_u24 v18, 800, v16
    v_lshl_add_u32 v18, v17, 1, v18
    v_add_u32 v3, 141376, v18
    v_and_b32 v18, 7, v0
    v_mul_u32_u24 v18, 400, v18
    v_lshl_add_u32 v18, v16, 5, v18
    v_add_u32 v5, 144512, v18
    v_lshlrev_b32 v18, 3, v0
    v_add_u32 v6, 147712, v18
    v_lshlrev_b32 v18, 4, v16
    v_bfe_u32 v19, v17, 1, 2
    v_lshl_add_u32 v18, v19, 2, v18
    s_lshl_b32 s20, s12, 7
    s_add_u32 s20, s20, 64
    v_add_u32 v18, s20, v18
    v_lshrrev_b32 v19, 3, v17
    v_add_u32 v19, 1, v19
    v_lshrrev_b32 v20, 1, v19
    v_lshlrev_b32 v20, 14, v20
    v_and_b32 v19, 1, v19
    v_lshl_add_u32 v19, v19, 12, v20
    v_add_u32 v19, v19, v18
    v_mov_b32 v20, 0x7ffffff0
    v_and_b32 v21, 7, v0
    v_cmp_eq_u32 vcc, 4, v21
    v_subrev_u32 v21, 8, v18
    s_nop 0
    v_cndmask_b32 v7, v19, v21, vcc
    v_and_b32 v21, 0x29, v0
    v_cmp_eq_u32 vcc, 0, v21
    s_nop 1
    v_cndmask_b32 v8, v20, v18, vcc
    s_lshl_b32 s20, s12, 2
    v_lshlrev_b32 v18, 7, v0
    v_add_u32 v8, s20, v18
    v_lshlrev_b32 v18, 4, v17
    v_lshl_add_u32 v18, v16, 10, v18
    v_add_u32 v9, 0, v18
    v_add_u32 v18, 128, v0
    v_mul_u32_u24 v19, 2731, v18
    v_lshrrev_b32 v19, 16, v19
    v_mul_u32_u24 v20, 24, v19
    v_sub_u32 v20, v18, v20
    v_mul_u32_u24 v21, 400, v19
    v_lshl_add_u32 v21, v20, 4, v21
    v_add_u32 v10, 144512, v21
    v_lshlrev_b32 v21, 4, v19
    v_lshl_add_u32 v11, v20, 7, v21
    v_add_u32 v13, 65536, v1
    v_add_u32 v14, 131072, v1
    s_mul_i32 s44, s12, 12288
    s_add_u32 s44, s44, 53477376
    s_mul_i32 s45, s12, 3072
    s_add_u32 s45, s45, 208666624
    s_mul_i32 s20, s12, 6
    s_add_u32 s21, s20, 5
    s_lshr_b32 s20, s20, 3
    s_lshr_b32 s21, s21, 3
    s_add_u32 s20, s20, 80
    s_add_u32 s21, s21, 80
    s_lshl_b32 s20, s20, 7
    s_lshl_b32 s21, s21, 7
    v_mov_b32 v255, s21
    v_mov_b32 v253, s20
    v_cmp_eq_u32 vcc, 0, v0
    s_nop 1
    v_cndmask_b32 v255, v255, v253, vcc
    s_mov_b32 s47, 0
    s_mul_i32 s20, s12, 491520
    s_add_u32 s20, s20, 11780096
    s_add_u32 s21, s20, 14336
    buffer_load_dwordx4 v[16:19], v1, s[8:11], s21 offen offset:0
    buffer_load_dwordx4 v[20:23], v1, s[8:11], s21 offen offset:1024
    s_add_u32 s21, s20, 75776
    buffer_load_dwordx4 v[24:27], v1, s[8:11], s21 offen offset:0
    buffer_load_dwordx4 v[28:31], v1, s[8:11], s21 offen offset:1024
    s_add_u32 s21, s20, 0
    buffer_load_dwordx4 v[32:35], v1, s[8:11], s21 offen offset:0
    buffer_load_dwordx4 v[36:39], v1, s[8:11], s21 offen offset:1024
    s_add_u32 s21, s20, 8192
    buffer_load_dwordx4 v[40:43], v1, s[8:11], s21 offen offset:0
    buffer_load_dwordx4 v[44:47], v1, s[8:11], s21 offen offset:1024
    s_add_u32 s21, s20, 20480
    buffer_load_dwordx4 v[48:51], v1, s[8:11], s21 offen offset:0
    buffer_load_dwordx4 v[52:55], v1, s[8:11], s21 offen offset:1024
    s_add_u32 s21, s20, 28672
    buffer_load_dwordx4 v[56:59], v1, s[8:11], s21 offen offset:0
    buffer_load_dwordx4 v[60:63], v1, s[8:11], s21 offen offset:1024
    s_add_u32 s21, s20, 40960
    buffer_load_dwordx4 v[64:67], v1, s[8:11], s21 offen offset:0
    buffer_load_dwordx4 v[68:71], v1, s[8:11], s21 offen offset:1024
    s_add_u32 s21, s20, 49152
    buffer_load_dwordx4 v[72:75], v1, s[8:11], s21 offen offset:0
    buffer_load_dwordx4 v[76:79], v1, s[8:11], s21 offen offset:1024
    s_add_u32 s21, s20, 61440
    buffer_load_dwordx4 v[80:83], v1, s[8:11], s21 offen offset:0
    buffer_load_dwordx4 v[84:87], v1, s[8:11], s21 offen offset:1024
    s_add_u32 s21, s20, 69632
    buffer_load_dwordx4 v[88:91], v1, s[8:11], s21 offen offset:0
    buffer_load_dwordx4 v[92:95], v1, s[8:11], s21 offen offset:1024
    s_add_u32 s21, s20, 81920
    buffer_load_dwordx4 v[96:99], v1, s[8:11], s21 offen offset:0
    buffer_load_dwordx4 v[100:103], v1, s[8:11], s21 offen offset:1024
    s_add_u32 s21, s20, 90112
    buffer_load_dwordx4 v[104:107], v1, s[8:11], s21 offen offset:0
    buffer_load_dwordx4 v[108:111], v1, s[8:11], s21 offen offset:1024
    s_add_u32 s21, s20, 100352
    buffer_load_dwordx4 v[112:115], v1, s[8:11], s21 offen offset:0
    buffer_load_dwordx4 v[116:119], v1, s[8:11], s21 offen offset:1024
    s_add_u32 s21, s20, 106496
    buffer_load_dwordx4 v[120:123], v1, s[8:11], s21 offen offset:0
    buffer_load_dwordx4 v[124:127], v1, s[8:11], s21 offen offset:1024
    s_add_u32 s21, s20, 112640
    buffer_load_dwordx4 v[128:131], v1, s[8:11], s21 offen offset:0
    buffer_load_dwordx4 v[132:135], v1, s[8:11], s21 offen offset:1024
    s_add_u32 s21, s20, 120832
    buffer_load_dwordx4 v[136:139], v1, s[8:11], s21 offen offset:0
    buffer_load_dwordx4 v[140:143], v1, s[8:11], s21 offen offset:1024
    s_add_u32 s21, s20, 79872
    buffer_load_dwordx4 v[156:159], v1, s[8:11], s21 offen offset:0
    buffer_load_dwordx4 v[160:163], v1, s[8:11], s21 offen offset:1024
    s_add_u32 s21, s20, 83968
    buffer_load_dwordx4 v[164:167], v1, s[8:11], s21 offen offset:0
    buffer_load_dwordx4 v[168:171], v1, s[8:11], s21 offen offset:1024
    s_add_u32 s21, s20, 86016
    buffer_load_dwordx4 v[172:175], v1, s[8:11], s21 offen offset:0
    buffer_load_dwordx4 v[176:179], v1, s[8:11], s21 offen offset:1024
    s_add_u32 s21, s20, 88064
    buffer_load_dwordx4 v[180:183], v1, s[8:11], s21 offen offset:0
    buffer_load_dwordx4 v[184:187], v1, s[8:11], s21 offen offset:1024
    s_add_u32 s21, s20, 92160
    buffer_load_dwordx4 v[188:191], v1, s[8:11], s21 offen offset:0
    buffer_load_dwordx4 v[192:195], v1, s[8:11], s21 offen offset:1024
    s_add_u32 s21, s20, 98304
    buffer_load_dwordx4 v[196:199], v1, s[8:11], s21 offen offset:0
    buffer_load_dwordx4 v[200:203], v1, s[8:11], s21 offen offset:1024
    s_add_u32 s21, s20, 102400
    buffer_load_dwordx4 v[204:207], v1, s[8:11], s21 offen offset:0
    buffer_load_dwordx4 v[208:211], v1, s[8:11], s21 offen offset:1024
    s_add_u32 s21, s20, 104448
    buffer_load_dwordx4 v[212:215], v1, s[8:11], s21 offen offset:0
    buffer_load_dwordx4 v[216:219], v1, s[8:11], s21 offen offset:1024
    s_add_u32 s21, s20, 108544
    buffer_load_dwordx4 v[220:223], v1, s[8:11], s21 offen offset:0
    buffer_load_dwordx4 v[224:227], v1, s[8:11], s21 offen offset:1024
    s_add_u32 s21, s20, 110592
    buffer_load_dwordx4 v[228:231], v1, s[8:11], s21 offen offset:0
    buffer_load_dwordx4 v[232:235], v1, s[8:11], s21 offen offset:1024
    s_add_u32 s21, s20, 118784
    buffer_load_dwordx4 v[236:239], v1, s[8:11], s21 offen offset:0
    buffer_load_dwordx4 v[240:243], v1, s[8:11], s21 offen offset:1024
    s_add_u32 s21, s20, 116736
    buffer_load_dwordx4 v[244:247], v1, s[8:11], s21 offen offset:0
    buffer_load_dwordx4 v[248:251], v1, s[8:11], s21 offen offset:1024
    s_waitcnt vmcnt(24)
    ds_write_b128 v13, v[16:19] offset:0
    ds_write_b128 v13, v[20:23] offset:1024
    ds_write_b128 v13, v[24:27] offset:2048
    ds_write_b128 v13, v[28:31] offset:3072
    ds_write_b128 v13, v[32:35] offset:4096
    ds_write_b128 v13, v[36:39] offset:5120
    ds_write_b128 v13, v[40:43] offset:6144
    ds_write_b128 v13, v[44:47] offset:7168
    ds_write_b128 v13, v[48:51] offset:8192
    ds_write_b128 v13, v[52:55] offset:9216
    ds_write_b128 v13, v[56:59] offset:10240
    ds_write_b128 v13, v[60:63] offset:11264
    ds_write_b128 v13, v[64:67] offset:12288
    ds_write_b128 v13, v[68:71] offset:13312
    ds_write_b128 v13, v[72:75] offset:14336
    ds_write_b128 v13, v[76:79] offset:15360
    ds_write_b128 v13, v[80:83] offset:16384
    ds_write_b128 v13, v[84:87] offset:17408
    ds_write_b128 v13, v[88:91] offset:18432
    ds_write_b128 v13, v[92:95] offset:19456
    ds_write_b128 v13, v[96:99] offset:20480
    ds_write_b128 v13, v[100:103] offset:21504
    ds_write_b128 v13, v[104:107] offset:22528
    ds_write_b128 v13, v[108:111] offset:23552
    ds_write_b128 v13, v[112:115] offset:24576
    ds_write_b128 v13, v[116:119] offset:25600
    ds_write_b128 v13, v[120:123] offset:26624
    ds_write_b128 v13, v[124:127] offset:27648
    ds_write_b128 v13, v[128:131] offset:28672
    ds_write_b128 v13, v[132:135] offset:29696
    ds_write_b128 v13, v[136:139] offset:30720
    ds_write_b128 v13, v[140:143] offset:31744
    s_waitcnt lgkmcnt(0)
    s_add_u32 s20, s48, 51200
    s_mov_b64 exec, 3
    v_lshlrev_b32 v16, 2, v0
layerb1_kernel_p2_par:
    buffer_load_dword v17, v16, s[8:11], s20 offen sc1
    s_waitcnt vmcnt(0)
    v_cmp_eq_u32 vcc, 0, v17
    s_sub_u32 s15, s15, 1
    s_cbranch_scc1 layerb1_kernel_bail
    s_cbranch_vccnz layerb1_kernel_p2_par
    s_mov_b64 exec, -1
    v_readlane_b32 s20, v17, 0
    v_readlane_b32 s21, v17, 1
    s_nop 0
    s_and_b32 s20, s20, 8192
    s_and_b32 s21, s21, 8192
    s_add_u32 s16, s16, s20
    s_add_u32 s17, s17, s21
    s_mov_b32 s14, 0
    s_cmp_gt_u32 s47, s14
    s_cbranch_scc1 layerb1_kernel_p2_gw1_ok
layerb1_kernel_p2_gw1_lp:
    buffer_load_dword v253, v255, s[8:11], s48 offen sc1
    s_waitcnt vmcnt(0)
    v_readlane_b32 s47, v253, 0
    v_readlane_b32 s29, v253, 1
    s_nop 0
    s_min_u32 s47, s47, s29
    s_sub_u32 s15, s15, 1
    s_cbranch_scc1 layerb1_kernel_bail
    s_cmp_gt_u32 s47, s14
    s_cbranch_scc0 layerb1_kernel_p2_gw1_lp
layerb1_kernel_p2_gw1_ok:
    s_mul_i32 s20, s14, 393216
    s_add_u32 s20, s20, s44
    s_add_u32 s21, s20, 0
    buffer_load_dwordx4 v[100:103], v9, s[8:11], s21 offen offset:0 sc1
    buffer_load_dwordx4 v[104:107], v9, s[8:11], s21 offen offset:512 sc1
    s_add_u32 s21, s20, 4096
    buffer_load_dwordx4 v[108:111], v9, s[8:11], s21 offen offset:0 sc1
    buffer_load_dwordx4 v[112:115], v9, s[8:11], s21 offen offset:512 sc1
    s_add_u32 s21, s20, 8192
    buffer_load_dwordx4 v[116:119], v9, s[8:11], s21 offen offset:0 sc1
    buffer_load_dwordx4 v[120:123], v9, s[8:11], s21 offen offset:512 sc1
    v_mov_b32 v56, 0
    v_mov_b32 v57, 0
    v_mov_b32 v58, 0
    v_mov_b32 v59, 0
    v_mov_b32 v60, 0
    v_mov_b32 v61, 0
    v_mov_b32 v62, 0
    v_mov_b32 v63, 0
    v_mov_b32 v64, 0
    v_mov_b32 v65, 0
    v_mov_b32 v66, 0
    v_mov_b32 v67, 0
    v_mov_b32 v68, 0
    v_mov_b32 v69, 0
    v_mov_b32 v70, 0
    v_mov_b32 v71, 0
    v_mov_b32 v72, 0
    v_mov_b32 v73, 0
    v_mov_b32 v74, 0
    v_mov_b32 v75, 0
    v_mov_b32 v76, 0
    v_mov_b32 v77, 0
    v_mov_b32 v78, 0
    v_mov_b32 v79, 0
    v_mov_b32 v80, 0
    v_mov_b32 v81, 0
    v_mov_b32 v82, 0
    v_mov_b32 v83, 0
    v_mov_b32 v84, 0
    v_mov_b32 v85, 0
    v_mov_b32 v86, 0
    v_mov_b32 v87, 0
    ds_read_b128 v[124:127], v13 offset:0
    ds_read_b128 v[128:131], v13 offset:1024
    ds_read_b128 v[132:135], v13 offset:2048
    ds_read_b128 v[136:139], v13 offset:3072
    ds_read_b128 v[140:143], v13 offset:4096
    ds_read_b128 v[144:147], v13 offset:5120
    ds_read_b128 v[148:151], v13 offset:6144
    ds_read_b128 v[152:155], v13 offset:7168
    s_waitcnt lgkmcnt(0)
layerb1_kernel_p2_step:
    s_cmp_lt_u32 s14, 32
    s_cselect_b32 s18, s16, s17
    s_and_b32 s20, s14, 31
    s_lshl_b32 s20, s20, 16
    s_add_u32 s18, s18, s20
    s_add_u32 s69, s18, 55424
    s_add_u32 s22, s18, 51200
    s_add_u32 s23, s18, 52224
layerb1_kernel_p2_poll:
    buffer_load_dwordx4 v[40:43], v12, s[8:11], s22 offen sc1
    buffer_load_dwordx4 v[44:47], v12, s[8:11], s23 offen sc1
    s_waitcnt vmcnt(0)
    ds_write_b128 v14, v[40:43] offset:6144
    ds_write_b128 v14, v[44:47] offset:7168
    v_max3_u32 v88, v40, v41, v42
    v_max3_u32 v88, v88, v43, v44
    v_max3_u32 v88, v88, v45, v46
    v_max_u32 v88, v88, v47
    v_cmp_eq_u32 vcc, -1, v88
    s_sub_u32 s15, s15, 1
    s_cbranch_scc1 layerb1_kernel_bail
    s_cbranch_vccnz layerb1_kernel_p2_poll
    v_smfmac_f32_16x16x64_bf16 v[56:59], v[40:43], a[0:7], v2
    v_smfmac_f32_16x16x64_bf16 v[60:63], v[40:43], a[8:15], v2
    v_smfmac_f32_16x16x64_bf16 v[64:67], v[40:43], a[16:23], v2
    v_smfmac_f32_16x16x64_bf16 v[56:59], v[44:47], v[124:131], v2
    ds_read_b128 v[124:127], v13 offset:8192
    v_smfmac_f32_16x16x64_bf16 v[60:63], v[44:47], a[24:31], v2
    s_waitcnt lgkmcnt(1)
    s_barrier
    v_smfmac_f32_16x16x64_bf16 v[64:67], v[44:47], a[32:39], v2
    ds_read_b128 v[16:19], v14 offset:0
    v_smfmac_f32_16x16x64_bf16 v[68:71], v[40:43], a[40:47], v2
    ds_read_b128 v[20:23], v14 offset:1024
    v_smfmac_f32_16x16x64_bf16 v[68:71], v[44:47], v[132:139], v2
    ds_read_b128 v[24:27], v14 offset:2048
    v_smfmac_f32_16x16x64_bf16 v[72:75], v[40:43], a[48:55], v2
    ds_read_b128 v[28:31], v14 offset:3072
    v_smfmac_f32_16x16x64_bf16 v[72:75], v[44:47], a[56:63], v2
    ds_read_b128 v[32:35], v14 offset:4096
    v_smfmac_f32_16x16x64_bf16 v[76:79], v[40:43], a[64:71], v2
    s_waitcnt lgkmcnt(4)
    ds_read_b128 v[36:39], v14 offset:5120
    v_smfmac_f32_16x16x64_bf16 v[56:59], v[16:19], v[140:147], v2
    s_waitcnt lgkmcnt(4)
    ds_read_b128 v[48:51], v14 offset:8192
    v_smfmac_f32_16x16x64_bf16 v[56:59], v[20:23], a[72:79], v2
    s_waitcnt lgkmcnt(4)
    ds_read_b128 v[52:55], v14 offset:9216
    v_smfmac_f32_16x16x64_bf16 v[56:59], v[24:27], a[80:87], v2
    s_waitcnt lgkmcnt(4)
    ds_read_b128 v[128:131], v13 offset:9216
    v_smfmac_f32_16x16x64_bf16 v[56:59], v[28:31], a[88:95], v2
    s_waitcnt lgkmcnt(4)
    ds_read_b128 v[132:135], v13 offset:10240
    v_smfmac_f32_16x16x64_bf16 v[56:59], v[32:35], v[148:155], v2
    s_waitcnt lgkmcnt(4)
    ds_read_b128 v[136:139], v13 offset:11264
    v_smfmac_f32_16x16x64_bf16 v[56:59], v[36:39], a[96:103], v2
    s_waitcnt lgkmcnt(4)
    ds_read_b128 v[140:143], v13 offset:12288
    v_smfmac_f32_16x16x64_bf16 v[56:59], v[48:51], a[104:111], v2
    s_waitcnt lgkmcnt(4)
    ds_read_b128 v[144:147], v13 offset:13312
    v_smfmac_f32_16x16x64_bf16 v[56:59], v[52:55], a[112:119], v2
    s_waitcnt lgkmcnt(4)
    ds_read_b128 v[148:151], v13 offset:14336
    v_smfmac_f32_16x16x64_bf16 v[60:63], v[16:19], v[124:131], v2
    ds_read_b128 v[152:155], v13 offset:15360
    v_smfmac_f32_16x16x64_bf16 v[60:63], v[20:23], a[120:127], v2
    ds_read_b128 v[124:127], v13 offset:16384
    v_add_f32 v56, v56, v58
    v_smfmac_f32_16x16x64_bf16 v[60:63], v[24:27], a[128:135], v2
    ds_read_b128 v[128:131], v13 offset:17408
    v_add_f32 v57, v57, v59
    v_smfmac_f32_16x16x64_bf16 v[60:63], v[28:31], a[136:143], v2
    s_waitcnt lgkmcnt(6)
    v_cvt_pk_bf16_f32 v56, v56, v57
    v_smfmac_f32_16x16x64_bf16 v[60:63], v[32:35], v[132:139], v2
    ds_write_b16 v3, v56 offset:0
    v_smfmac_f32_16x16x64_bf16 v[60:63], v[36:39], a[144:151], v2
    ds_write_b16_d16_hi v3, v56 offset:400
    v_smfmac_f32_16x16x64_bf16 v[60:63], v[48:51], a[152:159], v2
    ds_read_b128 v[132:135], v13 offset:18432
    v_smfmac_f32_16x16x64_bf16 v[60:63], v[52:55], a[160:167], v2
    s_waitcnt lgkmcnt(7)
    ds_read_b128 v[136:139], v13 offset:19456
    v_smfmac_f32_16x16x64_bf16 v[64:67], v[16:19], v[140:147], v2
    ds_read_b128 v[140:143], v13 offset:20480
    v_smfmac_f32_16x16x64_bf16 v[64:67], v[20:23], a[168:175], v2
    ds_read_b128 v[144:147], v13 offset:21504
    v_add_f32 v60, v60, v62
    v_smfmac_f32_16x16x64_bf16 v[64:67], v[24:27], a[176:183], v2
    v_add_f32 v61, v61, v63
    v_smfmac_f32_16x16x64_bf16 v[64:67], v[28:31], a[184:191], v2
    s_waitcnt lgkmcnt(8)
    v_cvt_pk_bf16_f32 v60, v60, v61
    v_smfmac_f32_16x16x64_bf16 v[64:67], v[32:35], v[148:155], v2
    ds_write_b16 v3, v60 offset:128
    v_smfmac_f32_16x16x64_bf16 v[64:67], v[36:39], a[192:199], v2
    ds_write_b16_d16_hi v3, v60 offset:528
    v_smfmac_f32_16x16x64_bf16 v[64:67], v[48:51], a[200:207], v2
    ds_read_b128 v[148:151], v13 offset:22528
    v_smfmac_f32_16x16x64_bf16 v[64:67], v[52:55], a[208:215], v2
    s_waitcnt lgkmcnt(9)
    ds_read_b128 v[152:155], v13 offset:23552
    v_smfmac_f32_16x16x64_bf16 v[68:71], v[16:19], v[124:131], v2
    ds_read_b128 v[124:127], v13 offset:24576
    v_smfmac_f32_16x16x64_bf16 v[68:71], v[20:23], a[216:223], v2
    ds_read_b128 v[128:131], v13 offset:25600
    v_add_f32 v64, v64, v66
    v_smfmac_f32_16x16x64_bf16 v[68:71], v[24:27], a[224:231], v2
    v_add_f32 v65, v65, v67
    v_smfmac_f32_16x16x64_bf16 v[68:71], v[28:31], a[232:239], v2
    s_waitcnt lgkmcnt(8)
    v_cvt_pk_bf16_f32 v64, v64, v65
    v_smfmac_f32_16x16x64_bf16 v[68:71], v[32:35], v[132:139], v2
    ds_write_b16 v3, v64 offset:256
    v_smfmac_f32_16x16x64_bf16 v[68:71], v[36:39], a[240:247], v2
    ds_write_b16_d16_hi v3, v64 offset:656
    v_smfmac_f32_16x16x64_bf16 v[68:71], v[48:51], a[248:255], v2
    ds_read_b128 v[132:135], v13 offset:26624
    v_smfmac_f32_16x16x64_bf16 v[68:71], v[52:55], v[156:163], v2
    s_waitcnt lgkmcnt(9)
    ds_read_b128 v[136:139], v13 offset:27648
    v_smfmac_f32_16x16x64_bf16 v[72:75], v[16:19], v[140:147], v2
    ds_read_b128 v[140:143], v13 offset:28672
    v_smfmac_f32_16x16x64_bf16 v[72:75], v[20:23], v[164:171], v2
    s_waitcnt lgkmcnt(3)
    s_barrier
    v_add_f32 v68, v68, v70
    v_smfmac_f32_16x16x64_bf16 v[72:75], v[24:27], v[172:179], v2
    ds_read_b128 v[88:91], v4 offset:0
    v_add_f32 v69, v69, v71
    v_smfmac_f32_16x16x64_bf16 v[72:75], v[28:31], v[180:187], v2
    ds_read_b128 v[92:95], v4 offset:128
    v_cvt_pk_bf16_f32 v68, v68, v69
    v_smfmac_f32_16x16x64_bf16 v[72:75], v[32:35], v[148:155], v2
    ds_read_b128 v[96:99], v4 offset:256
    v_smfmac_f32_16x16x64_bf16 v[72:75], v[36:39], v[188:195], v2
    ds_write_b16 v3, v68 offset:3200
    v_smfmac_f32_16x16x64_bf16 v[72:75], v[48:51], v[196:203], v2
    ds_write_b16_d16_hi v3, v68 offset:3600
    v_smfmac_f32_16x16x64_bf16 v[72:75], v[52:55], v[124:131], v2
    s_waitcnt lgkmcnt(4)
    ds_read_b128 v[144:147], v13 offset:29696
    v_smfmac_f32_16x16x64_bf16 v[80:83], v[88:91], v[100:107], v2
    s_waitcnt lgkmcnt(4)
    ds_read_b128 v[148:151], v13 offset:30720
    v_smfmac_f32_16x16x64_bf16 v[80:83], v[92:95], v[108:115], v2
    s_waitcnt lgkmcnt(4)
    ds_read_b128 v[152:155], v13 offset:31744
    v_add_f32 v72, v72, v74
    v_smfmac_f32_16x16x64_bf16 v[80:83], v[96:99], v[116:123], v2
    v_add_f32 v73, v73, v75
    v_smfmac_f32_16x16x64_bf16 v[76:79], v[16:19], v[204:211], v2
    v_cvt_pk_bf16_f32 v72, v72, v73
    v_smfmac_f32_16x16x64_bf16 v[76:79], v[20:23], v[212:219], v2
    ds_write_b16 v3, v72 offset:3328
    v_smfmac_f32_16x16x64_bf16 v[76:79], v[24:27], v[132:139], v2
    ds_write_b16_d16_hi v3, v72 offset:3728
    v_smfmac_f32_16x16x64_bf16 v[76:79], v[28:31], v[220:227], v2
    v_add_f32 v56, v81, v83
    v_smfmac_f32_16x16x64_bf16 v[76:79], v[32:35], v[228:235], v2
    s_waitcnt lgkmcnt(4)
    v_mul_f32 v56, 0x3dd53b95, v56
    v_smfmac_f32_16x16x64_bf16 v[76:79], v[36:39], v[140:147], v2
    s_waitcnt lgkmcnt(0)
    s_barrier
    v_max_f32_dpp v58, v56, v56 row_ror:8 row_mask:0xf bank_mask:0xf
    v_smfmac_f32_16x16x64_bf16 v[76:79], v[48:51], v[236:243], v2
    ds_read_b128 v[100:103], v5 offset:0
    v_max_f32_dpp v58, v58, v58 row_ror:4 row_mask:0xf bank_mask:0xf
    v_smfmac_f32_16x16x64_bf16 v[76:79], v[52:55], v[148:155], v2
    ds_read_b128 v[104:107], v5 offset:16
    v_max_f32_dpp v58, v58, v58 row_ror:2 row_mask:0xf bank_mask:0xf
    v_smfmac_f32_16x16x64_bf16 v[76:79], v[44:47], v[244:251], v2
    ds_read_b128 v[108:111], v5 offset:128
    v_max_f32_dpp v58, v58, v58 row_ror:1 row_mask:0xf bank_mask:0xf
    ds_read_b128 v[112:115], v5 offset:144
    v_sub_f32 v60, v56, v58
    s_nop 1
    v_exp_f32 v60, v60
    s_nop 1
    v_add_f32_dpp v59, v60, v60 row_ror:8 row_mask:0xf bank_mask:0xf
    s_nop 1
    v_add_f32_dpp v59, v59, v59 row_ror:4 row_mask:0xf bank_mask:0xf
    s_nop 1
    v_add_f32_dpp v59, v59, v59 row_ror:2 row_mask:0xf bank_mask:0xf
    s_nop 1
    v_add_f32_dpp v59, v59, v59 row_ror:1 row_mask:0xf bank_mask:0xf
    v_add_f32 v76, v76, v78
    v_add_f32 v77, v77, v79
    v_cvt_pk_bf16_f32 v76, v76, v77
    ds_write_b16 v3, v76 offset:3456
    ds_write_b16_d16_hi v3, v76 offset:3856
    ds_write_b64 v6, v[58:59] offset:1024
    s_waitcnt lgkmcnt(5)
    v_smfmac_f32_16x16x64_bf16 v[84:87], v[88:91], v[100:107], v2
    s_waitcnt lgkmcnt(3)
    v_smfmac_f32_16x16x64_bf16 v[84:87], v[92:95], v[108:115], v2
    s_waitcnt lgkmcnt(0)
    s_barrier
    ds_read_b128 v[116:119], v5 offset:256
    ds_read_b128 v[120:123], v5 offset:272
    ds_read_b64 v[16:17], v6 offset:1536
    s_waitcnt lgkmcnt(1)
    v_smfmac_f32_16x16x64_bf16 v[84:87], v[96:99], v[116:123], v2
    s_waitcnt lgkmcnt(0)
    v_max_f32 v18, v58, v16
    v_sub_f32 v19, v58, v18
    v_sub_f32 v20, v16, v18
    v_exp_f32 v19, v19
    v_exp_f32 v20, v20
    s_nop 0
    v_mul_f32 v21, v59, v19
    v_mul_f32 v60, v60, v19
    v_fmac_f32 v21, v17, v20
    v_add_f32 v22, v85, v87
    v_mul_f32 v22, 0x3dd53b95, v22
    v_max_f32 v23, v22, v18
    s_nop 0
    v_max_f32_dpp v24, v22, v23 row_ror:4 row_mask:0xf bank_mask:0xf
    s_nop 1
    v_max_f32_dpp v24, v24, v24 row_ror:2 row_mask:0xf bank_mask:0xf
    s_nop 1
    v_max_f32_dpp v24, v24, v24 row_ror:1 row_mask:0xf bank_mask:0xf
    v_sub_f32 v25, v22, v24
    v_sub_f32 v26, v18, v24
    v_exp_f32 v25, v25
    v_exp_f32 v26, v26
    s_nop 0
    v_add_f32_dpp v23, v25, v25 row_ror:4 row_mask:0xf bank_mask:0xf
    v_mul_f32 v60, v60, v26
    s_nop 0
    v_add_f32_dpp v23, v23, v23 row_ror:2 row_mask:0xf bank_mask:0xf
    s_nop 1
    v_add_f32_dpp v23, v23, v23 row_ror:1 row_mask:0xf bank_mask:0xf
    v_fmac_f32 v23, v26, v21
    v_rcp_f32 v27, v23
    s_nop 0
    v_mul_f32 v60, v60, v27
    v_mul_f32 v25, v25, v27
    s_nop 0
    v_mov_b32_dpp v19, v60 quad_perm:[1,0,3,2] row_mask:0xf bank_mask:0xf
    v_mov_b32_dpp v20, v25 quad_perm:[1,0,3,2] row_mask:0xf bank_mask:0xf
    v_cvt_pk_bf16_f32 v28, v60, v19
    v_cvt_pk_bf16_f32 v25, v25, v20
    s_nop 0
    v_mov_b32_dpp v29, v28 row_shl:2 row_mask:0xf bank_mask:0xf
    v_mov_b32_dpp v30, v28 row_shl:4 row_mask:0xf bank_mask:0xf
    v_mov_b32_dpp v31, v28 row_shl:6 row_mask:0xf bank_mask:0xf
    v_mov_b32_dpp v28, v25 row_shr:4 row_mask:0xf bank_mask:0x2
    v_mov_b32_dpp v29, v25 row_shr:2 row_mask:0xf bank_mask:0x2
    v_mov_b32_dpp v30, v25 quad_perm:[0,1,2,3] row_mask:0xf bank_mask:0x2
    v_mov_b32_dpp v31, v25 row_shl:2 row_mask:0xf bank_mask:0x2
    s_mov_b32 exec_lo, 0x1110111
    s_mov_b32 exec_hi, 0x1010101
    buffer_store_dwordx4 v[28:31], v7, s[8:11], s18 offen sc1
    s_mov_b64 exec, -1
    ds_read_b128 v[40:43], v10
    s_add_u32 s28, s14, 1
    s_min_u32 s28, s28, 63
    s_cmp_gt_u32 s47, s28
    s_cbranch_scc1 layerb1_kernel_p2_gw2_ok
layerb1_kernel_p2_gw2_lp:
    buffer_load_dword v253, v255, s[8:11], s48 offen sc1
    s_waitcnt vmcnt(0)
    v_readlane_b32 s47, v253, 0
    v_readlane_b32 s29, v253, 1
    s_nop 0
    s_min_u32 s47, s47, s29
    s_sub_u32 s15, s15, 1
    s_cbranch_scc1 layerb1_kernel_bail
    s_cmp_gt_u32 s47, s28
    s_cbranch_scc0 layerb1_kernel_p2_gw2_lp
layerb1_kernel_p2_gw2_ok:
    s_mul_i32 s20, s28, 393216
    s_add_u32 s20, s20, s44
    s_add_u32 s21, s20, 0
    buffer_load_dwordx4 v[100:103], v9, s[8:11], s21 offen offset:0 sc1
    buffer_load_dwordx4 v[104:107], v9, s[8:11], s21 offen offset:512 sc1
    s_add_u32 s21, s20, 4096
    buffer_load_dwordx4 v[108:111], v9, s[8:11], s21 offen offset:0 sc1
    buffer_load_dwordx4 v[112:115], v9, s[8:11], s21 offen offset:512 sc1
    s_add_u32 s21, s20, 8192
    buffer_load_dwordx4 v[116:119], v9, s[8:11], s21 offen offset:0 sc1
    buffer_load_dwordx4 v[120:123], v9, s[8:11], s21 offen offset:512 sc1
    v_mov_b32 v56, 0
    v_mov_b32 v57, 0
    v_mov_b32 v58, 0
    v_mov_b32 v59, 0
    v_mov_b32 v60, 0
    v_mov_b32 v61, 0
    v_mov_b32 v62, 0
    v_mov_b32 v63, 0
    v_mov_b32 v64, 0
    v_mov_b32 v65, 0
    v_mov_b32 v66, 0
    v_mov_b32 v67, 0
    v_mov_b32 v68, 0
    v_mov_b32 v69, 0
    v_mov_b32 v70, 0
    v_mov_b32 v71, 0
    v_mov_b32 v72, 0
    v_mov_b32 v73, 0
    v_mov_b32 v74, 0
    v_mov_b32 v75, 0
    v_mov_b32 v76, 0
    v_mov_b32 v77, 0
    v_mov_b32 v78, 0
    v_mov_b32 v79, 0
    v_mov_b32 v80, 0
    v_mov_b32 v81, 0
    v_mov_b32 v82, 0
    v_mov_b32 v83, 0
    v_mov_b32 v84, 0
    v_mov_b32 v85, 0
    v_mov_b32 v86, 0
    v_mov_b32 v87, 0
    s_waitcnt lgkmcnt(0)
    s_mul_i32 s20, s14, 98304
    s_add_u32 s20, s20, s45
    buffer_store_dwordx4 v[40:43], v11, s[8:11], s20 offen sc1
    ds_read_b128 v[124:127], v13 offset:0
    ds_read_b128 v[128:131], v13 offset:1024
    ds_read_b128 v[132:135], v13 offset:2048
    ds_read_b128 v[136:139], v13 offset:3072
    ds_read_b128 v[140:143], v13 offset:4096
    ds_read_b128 v[144:147], v13 offset:5120
    ds_read_b128 v[148:151], v13 offset:6144
    ds_read_b128 v[152:155], v13 offset:7168
    s_waitcnt lgkmcnt(0)
    s_add_u32 s14, s14, 1
    s_cmp_lt_u32 s14, 64
    s_cbranch_scc1 layerb1_kernel_p2_step
    s_waitcnt vmcnt(0)
    s_barrier
    s_branch layerb1_kernel_end
layerb1_kernel_p3_start:
    v_lshrrev_b32 v16, 4, v0
    v_and_b32 v17, 15, v0
    v_and_b32 v18, 2, v0
    v_cmp_eq_u32 vcc, 0, v18
    v_mov_b32 v18, 0xeeeeeeee
    v_mov_b32 v19, 0x44444444
    v_cndmask_b32 v2, v18, v19, vcc
    v_lshrrev_b32 v20, 2, v17
    v_lshlrev_b32 v20, 1, v20
    v_and_b32 v21, 1, v17
    v_add_u32 v20, v20, v21
    v_bfe_u32 v21, v17, 1, 1
    v_lshl_add_u32 v18, v16, 1, v21
    v_lshlrev_b32 v18, 7, v18
    v_lshl_add_u32 v12, v20, 4, v18
    v_mul_u32_u24 v18, 400, v20
    v_lshl_add_u32 v18, v16, 5, v18
    v_lshl_add_u32 v18, v21, 4, v18
    v_add_u32 v4, 141312, v18
    v_mul_u32_u24 v18, 800, v16
    v_lshl_add_u32 v18, v17, 1, v18
    v_add_u32 v3, 141408, v18
    v_and_b32 v18, 7, v0
    v_mul_u32_u24 v18, 400, v18
    v_lshl_add_u32 v18, v16, 5, v18
    v_add_u32 v5, 144512, v18
    v_lshlrev_b32 v18, 3, v0
    v_add_u32 v6, 147712, v18
    v_lshlrev_b32 v18, 4, v16
    v_bfe_u32 v19, v17, 1, 2
    v_lshl_add_u32 v18, v19, 2, v18
    s_lshl_b32 s20, s12, 7
    s_add_u32 s20, s20, 64
    v_add_u32 v18, s20, v18
    v_lshrrev_b32 v19, 3, v17
    v_add_u32 v19, 3, v19
    v_lshrrev_b32 v20, 1, v19
    v_lshlrev_b32 v20, 14, v20
    v_and_b32 v19, 1, v19
    v_lshl_add_u32 v19, v19, 12, v20
    v_add_u32 v19, v19, v18
    v_mov_b32 v20, 0x7ffffff0
    v_and_b32 v21, 7, v0
    v_cmp_eq_u32 vcc, 4, v21
    v_subrev_u32 v21, 8, v18
    s_nop 0
    v_cndmask_b32 v7, v19, v21, vcc
    v_and_b32 v21, 0x29, v0
    v_cmp_eq_u32 vcc, 32, v21
    s_nop 1
    v_cndmask_b32 v8, v20, v18, vcc
    s_lshl_b32 s20, s12, 2
    v_lshlrev_b32 v18, 7, v0
    v_add_u32 v8, s20, v18
    v_lshlrev_b32 v18, 4, v17
    v_lshl_add_u32 v18, v16, 10, v18
    v_add_u32 v9, 256, v18
    v_add_u32 v18, 192, v0
    v_mul_u32_u24 v19, 2731, v18
    v_lshrrev_b32 v19, 16, v19
    v_mul_u32_u24 v20, 24, v19
    v_sub_u32 v20, v18, v20
    v_mul_u32_u24 v21, 400, v19
    v_lshl_add_u32 v21, v20, 4, v21
    v_add_u32 v10, 144512, v21
    v_lshlrev_b32 v21, 4, v19
    v_lshl_add_u32 v11, v20, 7, v21
    v_add_u32 v13, 98304, v1
    v_add_u32 v14, 131072, v1
    s_mul_i32 s44, s12, 12288
    s_add_u32 s44, s44, 53477376
    s_mul_i32 s45, s12, 3072
    s_add_u32 s45, s45, 208666624
    s_mul_i32 s20, s12, 6
    s_add_u32 s21, s20, 5
    s_lshr_b32 s20, s20, 3
    s_lshr_b32 s21, s21, 3
    s_add_u32 s20, s20, 80
    s_add_u32 s21, s21, 80
    s_lshl_b32 s20, s20, 7
    s_lshl_b32 s21, s21, 7
    v_mov_b32 v255, s21
    v_mov_b32 v253, s20
    v_cmp_eq_u32 vcc, 0, v0
    s_nop 1
    v_cndmask_b32 v255, v255, v253, vcc
    s_mov_b32 s47, 0
    s_mul_i32 s20, s12, 491520
    s_add_u32 s20, s20, 11902976
    s_add_u32 s21, s20, 18432
    buffer_load_dwordx4 v[16:19], v1, s[8:11], s21 offen offset:0
    buffer_load_dwordx4 v[20:23], v1, s[8:11], s21 offen offset:1024
    s_add_u32 s21, s20, 79872
    buffer_load_dwordx4 v[24:27], v1, s[8:11], s21 offen offset:0
    buffer_load_dwordx4 v[28:31], v1, s[8:11], s21 offen offset:1024
    s_add_u32 s21, s20, 0
    buffer_load_dwordx4 v[32:35], v1, s[8:11], s21 offen offset:0
    buffer_load_dwordx4 v[36:39], v1, s[8:11], s21 offen offset:1024
    s_add_u32 s21, s20, 8192
    buffer_load_dwordx4 v[40:43], v1, s[8:11], s21 offen offset:0
    buffer_load_dwordx4 v[44:47], v1, s[8:11], s21 offen offset:1024
    s_add_u32 s21, s20, 20480
    buffer_load_dwordx4 v[48:51], v1, s[8:11], s21 offen offset:0
    buffer_load_dwordx4 v[52:55], v1, s[8:11], s21 offen offset:1024
    s_add_u32 s21, s20, 28672
    buffer_load_dwordx4 v[56:59], v1, s[8:11], s21 offen offset:0
    buffer_load_dwordx4 v[60:63], v1, s[8:11], s21 offen offset:1024
    s_add_u32 s21, s20, 40960
    buffer_load_dwordx4 v[64:67], v1, s[8:11], s21 offen offset:0
    buffer_load_dwordx4 v[68:71], v1, s[8:11], s21 offen offset:1024
    s_add_u32 s21, s20, 49152
    buffer_load_dwordx4 v[72:75], v1, s[8:11], s21 offen offset:0
    buffer_load_dwordx4 v[76:79], v1, s[8:11], s21 offen offset:1024
    s_add_u32 s21, s20, 61440
    buffer_load_dwordx4 v[80:83], v1, s[8:11], s21 offen offset:0
    buffer_load_dwordx4 v[84:87], v1, s[8:11], s21 offen offset:1024
    s_add_u32 s21, s20, 69632
    buffer_load_dwordx4 v[88:91], v1, s[8:11], s21 offen offset:0
    buffer_load_dwordx4 v[92:95], v1, s[8:11], s21 offen offset:1024
    s_add_u32 s21, s20, 81920
    buffer_load_dwordx4 v[96:99], v1, s[8:11], s21 offen offset:0
    buffer_load_dwordx4 v[100:103], v1, s[8:11], s21 offen offset:1024
    s_add_u32 s21, s20, 90112
    buffer_load_dwordx4 v[104:107], v1, s[8:11], s21 offen offset:0
    buffer_load_dwordx4 v[108:111], v1, s[8:11], s21 offen offset:1024
    s_add_u32 s21, s20, 96256
    buffer_load_dwordx4 v[112:115], v1, s[8:11], s21 offen offset:0
    buffer_load_dwordx4 v[116:119], v1, s[8:11], s21 offen offset:1024
    s_add_u32 s21, s20, 106496
    buffer_load_dwordx4 v[120:123], v1, s[8:11], s21 offen offset:0
    buffer_load_dwordx4 v[124:127], v1, s[8:11], s21 offen offset:1024
    s_add_u32 s21, s20, 112640
    buffer_load_dwordx4 v[128:131], v1, s[8:11], s21 offen offset:0
    buffer_load_dwordx4 v[132:135], v1, s[8:11], s21 offen offset:1024
    s_add_u32 s21, s20, 116736
    buffer_load_dwordx4 v[136:139], v1, s[8:11], s21 offen offset:0
    buffer_load_dwordx4 v[140:143], v1, s[8:11], s21 offen offset:1024
    s_add_u32 s21, s20, 75776
    buffer_load_dwordx4 v[156:159], v1, s[8:11], s21 offen offset:0
    buffer_load_dwordx4 v[160:163], v1, s[8:11], s21 offen offset:1024
    s_add_u32 s21, s20, 83968
    buffer_load_dwordx4 v[164:167], v1, s[8:11], s21 offen offset:0
    buffer_load_dwordx4 v[168:171], v1, s[8:11], s21 offen offset:1024
    s_add_u32 s21, s20, 86016
    buffer_load_dwordx4 v[172:175], v1, s[8:11], s21 offen offset:0
    buffer_load_dwordx4 v[176:179], v1, s[8:11], s21 offen offset:1024
    s_add_u32 s21, s20, 88064
    buffer_load_dwordx4 v[180:183], v1, s[8:11], s21 offen offset:0
    buffer_load_dwordx4 v[184:187], v1, s[8:11], s21 offen offset:1024
    s_add_u32 s21, s20, 92160
    buffer_load_dwordx4 v[188:191], v1, s[8:11], s21 offen offset:0
    buffer_load_dwordx4 v[192:195], v1, s[8:11], s21 offen offset:1024
    s_add_u32 s21, s20, 94208
    buffer_load_dwordx4 v[196:199], v1, s[8:11], s21 offen offset:0
    buffer_load_dwordx4 v[200:203], v1, s[8:11], s21 offen offset:1024
    s_add_u32 s21, s20, 102400
    buffer_load_dwordx4 v[204:207], v1, s[8:11], s21 offen offset:0
    buffer_load_dwordx4 v[208:211], v1, s[8:11], s21 offen offset:1024
    s_add_u32 s21, s20, 104448
    buffer_load_dwordx4 v[212:215], v1, s[8:11], s21 offen offset:0
    buffer_load_dwordx4 v[216:219], v1, s[8:11], s21 offen offset:1024
    s_add_u32 s21, s20, 108544
    buffer_load_dwordx4 v[220:223], v1, s[8:11], s21 offen offset:0
    buffer_load_dwordx4 v[224:227], v1, s[8:11], s21 offen offset:1024
    s_add_u32 s21, s20, 110592
    buffer_load_dwordx4 v[228:231], v1, s[8:11], s21 offen offset:0
    buffer_load_dwordx4 v[232:235], v1, s[8:11], s21 offen offset:1024
    s_add_u32 s21, s20, 114688
    buffer_load_dwordx4 v[236:239], v1, s[8:11], s21 offen offset:0
    buffer_load_dwordx4 v[240:243], v1, s[8:11], s21 offen offset:1024
    s_add_u32 s21, s20, 120832
    buffer_load_dwordx4 v[244:247], v1, s[8:11], s21 offen offset:0
    buffer_load_dwordx4 v[248:251], v1, s[8:11], s21 offen offset:1024
    s_waitcnt vmcnt(24)
    ds_write_b128 v13, v[16:19] offset:0
    ds_write_b128 v13, v[20:23] offset:1024
    ds_write_b128 v13, v[24:27] offset:2048
    ds_write_b128 v13, v[28:31] offset:3072
    ds_write_b128 v13, v[32:35] offset:4096
    ds_write_b128 v13, v[36:39] offset:5120
    ds_write_b128 v13, v[40:43] offset:6144
    ds_write_b128 v13, v[44:47] offset:7168
    ds_write_b128 v13, v[48:51] offset:8192
    ds_write_b128 v13, v[52:55] offset:9216
    ds_write_b128 v13, v[56:59] offset:10240
    ds_write_b128 v13, v[60:63] offset:11264
    ds_write_b128 v13, v[64:67] offset:12288
    ds_write_b128 v13, v[68:71] offset:13312
    ds_write_b128 v13, v[72:75] offset:14336
    ds_write_b128 v13, v[76:79] offset:15360
    ds_write_b128 v13, v[80:83] offset:16384
    ds_write_b128 v13, v[84:87] offset:17408
    ds_write_b128 v13, v[88:91] offset:18432
    ds_write_b128 v13, v[92:95] offset:19456
    ds_write_b128 v13, v[96:99] offset:20480
    ds_write_b128 v13, v[100:103] offset:21504
    ds_write_b128 v13, v[104:107] offset:22528
    ds_write_b128 v13, v[108:111] offset:23552
    ds_write_b128 v13, v[112:115] offset:24576
    ds_write_b128 v13, v[116:119] offset:25600
    ds_write_b128 v13, v[120:123] offset:26624
    ds_write_b128 v13, v[124:127] offset:27648
    ds_write_b128 v13, v[128:131] offset:28672
    ds_write_b128 v13, v[132:135] offset:29696
    ds_write_b128 v13, v[136:139] offset:30720
    ds_write_b128 v13, v[140:143] offset:31744
    s_waitcnt lgkmcnt(0)
    s_add_u32 s20, s48, 51200
    s_mov_b64 exec, 3
    v_lshlrev_b32 v16, 2, v0
layerb1_kernel_p3_par:
    buffer_load_dword v17, v16, s[8:11], s20 offen sc1
    s_waitcnt vmcnt(0)
    v_cmp_eq_u32 vcc, 0, v17
    s_sub_u32 s15, s15, 1
    s_cbranch_scc1 layerb1_kernel_bail
    s_cbranch_vccnz layerb1_kernel_p3_par
    s_mov_b64 exec, -1
    v_readlane_b32 s20, v17, 0
    v_readlane_b32 s21, v17, 1
    s_nop 0
    s_and_b32 s20, s20, 8192
    s_and_b32 s21, s21, 8192
    s_add_u32 s16, s16, s20
    s_add_u32 s17, s17, s21
    s_mov_b32 s14, 0
    s_cmp_gt_u32 s47, s14
    s_cbranch_scc1 layerb1_kernel_p3_gw1_ok
layerb1_kernel_p3_gw1_lp:
    buffer_load_dword v253, v255, s[8:11], s48 offen sc1
    s_waitcnt vmcnt(0)
    v_readlane_b32 s47, v253, 0
    v_readlane_b32 s29, v253, 1
    s_nop 0
    s_min_u32 s47, s47, s29
    s_sub_u32 s15, s15, 1
    s_cbranch_scc1 layerb1_kernel_bail
    s_cmp_gt_u32 s47, s14
    s_cbranch_scc0 layerb1_kernel_p3_gw1_lp
layerb1_kernel_p3_gw1_ok:
    s_mul_i32 s20, s14, 393216
    s_add_u32 s20, s20, s44
    s_add_u32 s21, s20, 0
    buffer_load_dwordx4 v[100:103], v9, s[8:11], s21 offen offset:0 sc1
    buffer_load_dwordx4 v[104:107], v9, s[8:11], s21 offen offset:512 sc1
    s_add_u32 s21, s20, 4096
    buffer_load_dwordx4 v[108:111], v9, s[8:11], s21 offen offset:0 sc1
    buffer_load_dwordx4 v[112:115], v9, s[8:11], s21 offen offset:512 sc1
    s_add_u32 s21, s20, 8192
    buffer_load_dwordx4 v[116:119], v9, s[8:11], s21 offen offset:0 sc1
    buffer_load_dwordx4 v[120:123], v9, s[8:11], s21 offen offset:512 sc1
    v_mov_b32 v56, 0
    v_mov_b32 v57, 0
    v_mov_b32 v58, 0
    v_mov_b32 v59, 0
    v_mov_b32 v60, 0
    v_mov_b32 v61, 0
    v_mov_b32 v62, 0
    v_mov_b32 v63, 0
    v_mov_b32 v64, 0
    v_mov_b32 v65, 0
    v_mov_b32 v66, 0
    v_mov_b32 v67, 0
    v_mov_b32 v68, 0
    v_mov_b32 v69, 0
    v_mov_b32 v70, 0
    v_mov_b32 v71, 0
    v_mov_b32 v72, 0
    v_mov_b32 v73, 0
    v_mov_b32 v74, 0
    v_mov_b32 v75, 0
    v_mov_b32 v76, 0
    v_mov_b32 v77, 0
    v_mov_b32 v78, 0
    v_mov_b32 v79, 0
    v_mov_b32 v80, 0
    v_mov_b32 v81, 0
    v_mov_b32 v82, 0
    v_mov_b32 v83, 0
    v_mov_b32 v84, 0
    v_mov_b32 v85, 0
    v_mov_b32 v86, 0
    v_mov_b32 v87, 0
    ds_read_b128 v[124:127], v13 offset:0
    ds_read_b128 v[128:131], v13 offset:1024
    ds_read_b128 v[132:135], v13 offset:2048
    ds_read_b128 v[136:139], v13 offset:3072
    ds_read_b128 v[140:143], v13 offset:4096
    ds_read_b128 v[144:147], v13 offset:5120
    ds_read_b128 v[148:151], v13 offset:6144
    ds_read_b128 v[152:155], v13 offset:7168
    s_waitcnt lgkmcnt(0)
layerb1_kernel_p3_step:
    s_cmp_lt_u32 s14, 32
    s_cselect_b32 s18, s16, s17
    s_and_b32 s20, s14, 31
    s_lshl_b32 s20, s20, 16
    s_add_u32 s18, s18, s20
    s_add_u32 s69, s18, 55424
    s_add_u32 s22, s18, 53248
    s_add_u32 s23, s18, 54272
layerb1_kernel_p3_poll:
    buffer_load_dwordx4 v[48:51], v12, s[8:11], s22 offen sc1
    buffer_load_dwordx4 v[52:55], v12, s[8:11], s23 offen sc1
    s_waitcnt vmcnt(0)
    ds_write_b128 v14, v[48:51] offset:8192
    ds_write_b128 v14, v[52:55] offset:9216
    v_max3_u32 v88, v48, v49, v50
    v_max3_u32 v88, v88, v51, v52
    v_max3_u32 v88, v88, v53, v54
    v_max_u32 v88, v88, v55
    v_cmp_eq_u32 vcc, -1, v88
    s_sub_u32 s15, s15, 1
    s_cbranch_scc1 layerb1_kernel_bail
    s_cbranch_vccnz layerb1_kernel_p3_poll
    v_smfmac_f32_16x16x64_bf16 v[56:59], v[48:51], a[0:7], v2
    v_smfmac_f32_16x16x64_bf16 v[60:63], v[48:51], a[8:15], v2
    v_smfmac_f32_16x16x64_bf16 v[64:67], v[48:51], a[16:23], v2
    v_smfmac_f32_16x16x64_bf16 v[56:59], v[52:55], v[124:131], v2
    ds_read_b128 v[124:127], v13 offset:8192
    v_smfmac_f32_16x16x64_bf16 v[60:63], v[52:55], a[24:31], v2
    s_waitcnt lgkmcnt(1)
    s_barrier
    v_smfmac_f32_16x16x64_bf16 v[64:67], v[52:55], a[32:39], v2
    ds_read_b128 v[16:19], v14 offset:0
    v_smfmac_f32_16x16x64_bf16 v[68:71], v[48:51], a[40:47], v2
    ds_read_b128 v[20:23], v14 offset:1024
    v_smfmac_f32_16x16x64_bf16 v[68:71], v[52:55], v[132:139], v2
    ds_read_b128 v[24:27], v14 offset:2048
    v_smfmac_f32_16x16x64_bf16 v[72:75], v[48:51], a[48:55], v2
    ds_read_b128 v[28:31], v14 offset:3072
    v_smfmac_f32_16x16x64_bf16 v[72:75], v[52:55], a[56:63], v2
    ds_read_b128 v[32:35], v14 offset:4096
    v_smfmac_f32_16x16x64_bf16 v[76:79], v[48:51], a[64:71], v2
    s_waitcnt lgkmcnt(4)
    ds_read_b128 v[36:39], v14 offset:5120
    v_smfmac_f32_16x16x64_bf16 v[56:59], v[16:19], v[140:147], v2
    s_waitcnt lgkmcnt(4)
    ds_read_b128 v[40:43], v14 offset:6144
    v_smfmac_f32_16x16x64_bf16 v[56:59], v[20:23], a[72:79], v2
    s_waitcnt lgkmcnt(4)
    ds_read_b128 v[44:47], v14 offset:7168
    v_smfmac_f32_16x16x64_bf16 v[56:59], v[24:27], a[80:87], v2
    s_waitcnt lgkmcnt(4)
    ds_read_b128 v[128:131], v13 offset:9216
    v_smfmac_f32_16x16x64_bf16 v[56:59], v[28:31], a[88:95], v2
    s_waitcnt lgkmcnt(4)
    ds_read_b128 v[132:135], v13 offset:10240
    v_smfmac_f32_16x16x64_bf16 v[56:59], v[32:35], v[148:155], v2
    s_waitcnt lgkmcnt(4)
    ds_read_b128 v[136:139], v13 offset:11264
    v_smfmac_f32_16x16x64_bf16 v[56:59], v[36:39], a[96:103], v2
    s_waitcnt lgkmcnt(4)
    ds_read_b128 v[140:143], v13 offset:12288
    v_smfmac_f32_16x16x64_bf16 v[56:59], v[40:43], a[104:111], v2
    s_waitcnt lgkmcnt(4)
    ds_read_b128 v[144:147], v13 offset:13312
    v_smfmac_f32_16x16x64_bf16 v[56:59], v[44:47], a[112:119], v2
    s_waitcnt lgkmcnt(4)
    ds_read_b128 v[148:151], v13 offset:14336
    v_smfmac_f32_16x16x64_bf16 v[60:63], v[16:19], v[124:131], v2
    ds_read_b128 v[152:155], v13 offset:15360
    v_smfmac_f32_16x16x64_bf16 v[60:63], v[20:23], a[120:127], v2
    ds_read_b128 v[124:127], v13 offset:16384
    v_add_f32 v56, v56, v58
    v_smfmac_f32_16x16x64_bf16 v[60:63], v[24:27], a[128:135], v2
    ds_read_b128 v[128:131], v13 offset:17408
    v_add_f32 v57, v57, v59
    v_smfmac_f32_16x16x64_bf16 v[60:63], v[28:31], a[136:143], v2
    s_waitcnt lgkmcnt(6)
    v_cvt_pk_bf16_f32 v56, v56, v57
    v_smfmac_f32_16x16x64_bf16 v[60:63], v[32:35], v[132:139], v2
    ds_write_b16 v3, v56 offset:0
    v_smfmac_f32_16x16x64_bf16 v[60:63], v[36:39], a[144:151], v2
    ds_write_b16_d16_hi v3, v56 offset:400
    v_smfmac_f32_16x16x64_bf16 v[60:63], v[40:43], a[152:159], v2
    ds_read_b128 v[132:135], v13 offset:18432
    v_smfmac_f32_16x16x64_bf16 v[60:63], v[44:47], a[160:167], v2
    s_waitcnt lgkmcnt(7)
    ds_read_b128 v[136:139], v13 offset:19456
    v_smfmac_f32_16x16x64_bf16 v[64:67], v[16:19], v[140:147], v2
    ds_read_b128 v[140:143], v13 offset:20480
    v_smfmac_f32_16x16x64_bf16 v[64:67], v[20:23], a[168:175], v2
    ds_read_b128 v[144:147], v13 offset:21504
    v_add_f32 v60, v60, v62
    v_smfmac_f32_16x16x64_bf16 v[64:67], v[24:27], a[176:183], v2
    v_add_f32 v61, v61, v63
    v_smfmac_f32_16x16x64_bf16 v[64:67], v[28:31], a[184:191], v2
    s_waitcnt lgkmcnt(8)
    v_cvt_pk_bf16_f32 v60, v60, v61
    v_smfmac_f32_16x16x64_bf16 v[64:67], v[32:35], v[148:155], v2
    ds_write_b16 v3, v60 offset:128
    v_smfmac_f32_16x16x64_bf16 v[64:67], v[36:39], a[192:199], v2
    ds_write_b16_d16_hi v3, v60 offset:528
    v_smfmac_f32_16x16x64_bf16 v[64:67], v[40:43], a[200:207], v2
    ds_read_b128 v[148:151], v13 offset:22528
    v_smfmac_f32_16x16x64_bf16 v[64:67], v[44:47], a[208:215], v2
    s_waitcnt lgkmcnt(9)
    ds_read_b128 v[152:155], v13 offset:23552
    v_smfmac_f32_16x16x64_bf16 v[68:71], v[16:19], v[124:131], v2
    ds_read_b128 v[124:127], v13 offset:24576
    v_smfmac_f32_16x16x64_bf16 v[68:71], v[20:23], a[216:223], v2
    ds_read_b128 v[128:131], v13 offset:25600
    v_add_f32 v64, v64, v66
    v_smfmac_f32_16x16x64_bf16 v[68:71], v[24:27], a[224:231], v2
    v_add_f32 v65, v65, v67
    v_smfmac_f32_16x16x64_bf16 v[68:71], v[28:31], a[232:239], v2
    s_waitcnt lgkmcnt(8)
    v_cvt_pk_bf16_f32 v64, v64, v65
    v_smfmac_f32_16x16x64_bf16 v[68:71], v[32:35], v[132:139], v2
    ds_write_b16 v3, v64 offset:256
    v_smfmac_f32_16x16x64_bf16 v[68:71], v[36:39], a[240:247], v2
    ds_write_b16_d16_hi v3, v64 offset:656
    v_smfmac_f32_16x16x64_bf16 v[68:71], v[40:43], a[248:255], v2
    ds_read_b128 v[132:135], v13 offset:26624
    v_smfmac_f32_16x16x64_bf16 v[68:71], v[44:47], v[156:163], v2
    s_waitcnt lgkmcnt(9)
    ds_read_b128 v[136:139], v13 offset:27648
    v_smfmac_f32_16x16x64_bf16 v[72:75], v[16:19], v[140:147], v2
    ds_read_b128 v[140:143], v13 offset:28672
    v_smfmac_f32_16x16x64_bf16 v[72:75], v[20:23], v[164:171], v2
    s_waitcnt lgkmcnt(3)
    s_barrier
    v_add_f32 v68, v68, v70
    v_smfmac_f32_16x16x64_bf16 v[72:75], v[24:27], v[172:179], v2
    ds_read_b128 v[88:91], v4 offset:0
    v_add_f32 v69, v69, v71
    v_smfmac_f32_16x16x64_bf16 v[72:75], v[28:31], v[180:187], v2
    ds_read_b128 v[92:95], v4 offset:128
    v_cvt_pk_bf16_f32 v68, v68, v69
    v_smfmac_f32_16x16x64_bf16 v[72:75], v[32:35], v[148:155], v2
    ds_read_b128 v[96:99], v4 offset:256
    v_smfmac_f32_16x16x64_bf16 v[72:75], v[36:39], v[188:195], v2
    ds_write_b16 v3, v68 offset:3200
    v_smfmac_f32_16x16x64_bf16 v[72:75], v[40:43], v[196:203], v2
    ds_write_b16_d16_hi v3, v68 offset:3600
    v_smfmac_f32_16x16x64_bf16 v[72:75], v[44:47], v[124:131], v2
    s_waitcnt lgkmcnt(4)
    ds_read_b128 v[144:147], v13 offset:29696
    v_smfmac_f32_16x16x64_bf16 v[80:83], v[88:91], v[100:107], v2
    s_waitcnt lgkmcnt(4)
    ds_read_b128 v[148:151], v13 offset:30720
    v_smfmac_f32_16x16x64_bf16 v[80:83], v[92:95], v[108:115], v2
    s_waitcnt lgkmcnt(4)
    ds_read_b128 v[152:155], v13 offset:31744
    v_add_f32 v72, v72, v74
    v_smfmac_f32_16x16x64_bf16 v[80:83], v[96:99], v[116:123], v2
    v_add_f32 v73, v73, v75
    v_smfmac_f32_16x16x64_bf16 v[76:79], v[16:19], v[204:211], v2
    v_cvt_pk_bf16_f32 v72, v72, v73
    v_smfmac_f32_16x16x64_bf16 v[76:79], v[20:23], v[212:219], v2
    ds_write_b16 v3, v72 offset:3328
    v_smfmac_f32_16x16x64_bf16 v[76:79], v[24:27], v[132:139], v2
    ds_write_b16_d16_hi v3, v72 offset:3728
    v_smfmac_f32_16x16x64_bf16 v[76:79], v[28:31], v[220:227], v2
    v_add_f32 v56, v81, v83
    v_smfmac_f32_16x16x64_bf16 v[76:79], v[32:35], v[228:235], v2
    s_waitcnt lgkmcnt(4)
    v_mul_f32 v56, 0x3dd53b95, v56
    v_smfmac_f32_16x16x64_bf16 v[76:79], v[36:39], v[140:147], v2
    s_waitcnt lgkmcnt(0)
    s_barrier
    v_max_f32_dpp v58, v56, v56 row_ror:8 row_mask:0xf bank_mask:0xf
    v_smfmac_f32_16x16x64_bf16 v[76:79], v[40:43], v[236:243], v2
    ds_read_b128 v[100:103], v5 offset:0
    v_max_f32_dpp v58, v58, v58 row_ror:4 row_mask:0xf bank_mask:0xf
    v_smfmac_f32_16x16x64_bf16 v[76:79], v[44:47], v[148:155], v2
    ds_read_b128 v[104:107], v5 offset:16
    v_max_f32_dpp v58, v58, v58 row_ror:2 row_mask:0xf bank_mask:0xf
    v_smfmac_f32_16x16x64_bf16 v[76:79], v[52:55], v[244:251], v2
    ds_read_b128 v[108:111], v5 offset:128
    v_max_f32_dpp v58, v58, v58 row_ror:1 row_mask:0xf bank_mask:0xf
    ds_read_b128 v[112:115], v5 offset:144
    v_sub_f32 v60, v56, v58
    s_nop 1
    v_exp_f32 v60, v60
    s_nop 1
    v_add_f32_dpp v59, v60, v60 row_ror:8 row_mask:0xf bank_mask:0xf
    s_nop 1
    v_add_f32_dpp v59, v59, v59 row_ror:4 row_mask:0xf bank_mask:0xf
    s_nop 1
    v_add_f32_dpp v59, v59, v59 row_ror:2 row_mask:0xf bank_mask:0xf
    s_nop 1
    v_add_f32_dpp v59, v59, v59 row_ror:1 row_mask:0xf bank_mask:0xf
    v_add_f32 v76, v76, v78
    v_add_f32 v77, v77, v79
    v_cvt_pk_bf16_f32 v76, v76, v77
    ds_write_b16 v3, v76 offset:3456
    ds_write_b16_d16_hi v3, v76 offset:3856
    ds_write_b64 v6, v[58:59] offset:1536
    s_waitcnt lgkmcnt(5)
    v_smfmac_f32_16x16x64_bf16 v[84:87], v[88:91], v[100:107], v2
    s_waitcnt lgkmcnt(3)
    v_smfmac_f32_16x16x64_bf16 v[84:87], v[92:95], v[108:115], v2
    s_waitcnt lgkmcnt(0)
    s_barrier
    ds_read_b128 v[116:119], v5 offset:256
    ds_read_b128 v[120:123], v5 offset:272
    ds_read_b64 v[16:17], v6 offset:1024
    s_waitcnt lgkmcnt(1)
    v_smfmac_f32_16x16x64_bf16 v[84:87], v[96:99], v[116:123], v2
    s_waitcnt lgkmcnt(0)
    v_max_f32 v18, v58, v16
    v_sub_f32 v19, v58, v18
    v_sub_f32 v20, v16, v18
    v_exp_f32 v19, v19
    v_exp_f32 v20, v20
    s_nop 0
    v_mul_f32 v21, v59, v19
    v_mul_f32 v60, v60, v19
    v_fmac_f32 v21, v17, v20
    v_add_f32 v22, v85, v87
    v_mul_f32 v22, 0x3dd53b95, v22
    v_max_f32 v23, v22, v18
    s_nop 0
    v_max_f32_dpp v24, v22, v23 row_ror:4 row_mask:0xf bank_mask:0xf
    s_nop 1
    v_max_f32_dpp v24, v24, v24 row_ror:2 row_mask:0xf bank_mask:0xf
    s_nop 1
    v_max_f32_dpp v24, v24, v24 row_ror:1 row_mask:0xf bank_mask:0xf
    v_sub_f32 v25, v22, v24
    v_sub_f32 v26, v18, v24
    v_exp_f32 v25, v25
    v_exp_f32 v26, v26
    s_nop 0
    v_add_f32_dpp v23, v25, v25 row_ror:4 row_mask:0xf bank_mask:0xf
    v_mul_f32 v60, v60, v26
    s_nop 0
    v_add_f32_dpp v23, v23, v23 row_ror:2 row_mask:0xf bank_mask:0xf
    s_nop 1
    v_add_f32_dpp v23, v23, v23 row_ror:1 row_mask:0xf bank_mask:0xf
    v_fmac_f32 v23, v26, v21
    v_rcp_f32 v27, v23
    s_nop 0
    v_mul_f32 v60, v60, v27
    v_mul_f32 v25, v25, v27
    s_nop 0
    v_mov_b32_dpp v19, v60 quad_perm:[1,0,3,2] row_mask:0xf bank_mask:0xf
    v_mov_b32_dpp v20, v25 quad_perm:[1,0,3,2] row_mask:0xf bank_mask:0xf
    v_cvt_pk_bf16_f32 v28, v60, v19
    v_cvt_pk_bf16_f32 v25, v25, v20
    s_nop 0
    v_mov_b32_dpp v29, v28 row_shl:2 row_mask:0xf bank_mask:0xf
    v_mov_b32_dpp v30, v28 row_shl:4 row_mask:0xf bank_mask:0xf
    v_mov_b32_dpp v31, v28 row_shl:6 row_mask:0xf bank_mask:0xf
    v_mov_b32_dpp v28, v25 row_shr:4 row_mask:0xf bank_mask:0x2
    v_mov_b32_dpp v29, v25 row_shr:2 row_mask:0xf bank_mask:0x2
    v_mov_b32_dpp v30, v25 quad_perm:[0,1,2,3] row_mask:0xf bank_mask:0x2
    v_mov_b32_dpp v31, v25 row_shl:2 row_mask:0xf bank_mask:0x2
    s_mov_b32 exec_lo, 0x1010101
    s_mov_b32 exec_hi, 0x1110111
    buffer_store_dwordx4 v[28:31], v7, s[8:11], s18 offen sc1
    s_mov_b64 exec, -1
    s_add_u32 s28, s14, 1
    s_min_u32 s28, s28, 63
    s_cmp_gt_u32 s47, s28
    s_cbranch_scc1 layerb1_kernel_p3_gw2_ok
layerb1_kernel_p3_gw2_lp:
    buffer_load_dword v253, v255, s[8:11], s48 offen sc1
    s_waitcnt vmcnt(0)
    v_readlane_b32 s47, v253, 0
    v_readlane_b32 s29, v253, 1
    s_nop 0
    s_min_u32 s47, s47, s29
    s_sub_u32 s15, s15, 1
    s_cbranch_scc1 layerb1_kernel_bail
    s_cmp_gt_u32 s47, s28
    s_cbranch_scc0 layerb1_kernel_p3_gw2_lp
layerb1_kernel_p3_gw2_ok:
    s_mul_i32 s20, s28, 393216
    s_add_u32 s20, s20, s44
    s_add_u32 s21, s20, 0
    buffer_load_dwordx4 v[100:103], v9, s[8:11], s21 offen offset:0 sc1
    buffer_load_dwordx4 v[104:107], v9, s[8:11], s21 offen offset:512 sc1
    s_add_u32 s21, s20, 4096
    buffer_load_dwordx4 v[108:111], v9, s[8:11], s21 offen offset:0 sc1
    buffer_load_dwordx4 v[112:115], v9, s[8:11], s21 offen offset:512 sc1
    s_add_u32 s21, s20, 8192
    buffer_load_dwordx4 v[116:119], v9, s[8:11], s21 offen offset:0 sc1
    buffer_load_dwordx4 v[120:123], v9, s[8:11], s21 offen offset:512 sc1
    v_mov_b32 v56, 0
    v_mov_b32 v57, 0
    v_mov_b32 v58, 0
    v_mov_b32 v59, 0
    v_mov_b32 v60, 0
    v_mov_b32 v61, 0
    v_mov_b32 v62, 0
    v_mov_b32 v63, 0
    v_mov_b32 v64, 0
    v_mov_b32 v65, 0
    v_mov_b32 v66, 0
    v_mov_b32 v67, 0
    v_mov_b32 v68, 0
    v_mov_b32 v69, 0
    v_mov_b32 v70, 0
    v_mov_b32 v71, 0
    v_mov_b32 v72, 0
    v_mov_b32 v73, 0
    v_mov_b32 v74, 0
    v_mov_b32 v75, 0
    v_mov_b32 v76, 0
    v_mov_b32 v77, 0
    v_mov_b32 v78, 0
    v_mov_b32 v79, 0
    v_mov_b32 v80, 0
    v_mov_b32 v81, 0
    v_mov_b32 v82, 0
    v_mov_b32 v83, 0
    v_mov_b32 v84, 0
    v_mov_b32 v85, 0
    v_mov_b32 v86, 0
    v_mov_b32 v87, 0
    s_lshl_b32 s20, s12, 7
    s_add_u32 s20, s20, 16384
    s_mov_b64 exec, 1
    v_mov_b32 v253, s20
    v_mov_b32 v254, s14
    buffer_store_dword v254, v253, s[8:11], s48 offen sc1
    s_mov_b64 exec, -1
    ds_read_b128 v[124:127], v13 offset:0
    ds_read_b128 v[128:131], v13 offset:1024
    ds_read_b128 v[132:135], v13 offset:2048
    ds_read_b128 v[136:139], v13 offset:3072
    ds_read_b128 v[140:143], v13 offset:4096
    ds_read_b128 v[144:147], v13 offset:5120
    ds_read_b128 v[148:151], v13 offset:6144
    ds_read_b128 v[152:155], v13 offset:7168
    s_waitcnt lgkmcnt(0)
    s_add_u32 s14, s14, 1
    s_cmp_lt_u32 s14, 64
    s_cbranch_scc1 layerb1_kernel_p3_step
    s_waitcnt vmcnt(0)
    s_barrier
    s_lshl_b32 s20, s12, 7
    s_add_u32 s20, s20, 16384
    s_mov_b64 exec, 1
    v_mov_b32 v253, s20
    v_mov_b32 v254, s14
    buffer_store_dword v254, v253, s[8:11], s48 offen sc1
    s_mov_b64 exec, -1
    s_branch layerb1_kernel_end
layerb1_kernel_y0_start:
    v_lshrrev_b32 v16, 4, v0
    v_and_b32 v17, 7, v0
    v_lshrrev_b32 v18, 3, v0
    v_and_b32 v18, 1, v18
    v_lshl_add_u32 v19, v18, 2, v16
    v_add_u32 v19, 0, v19
    v_mul_u32_u24 v20, 640, v19
    v_lshl_add_u32 v4, v17, 4, v20
    v_and_b32 v20, 1, v17
    v_lshlrev_b32 v20, 2, v20
    v_lshrrev_b32 v21, 1, v17
    v_add_u32 v20, v20, v21
    v_lshlrev_b32 v20, 4, v20
    v_lshl_add_u32 v5, v19, 7, v20
    v_add_u32 v3, 0, v1
    v_lshrrev_b32 v20, 1, v17
    v_lshlrev_b32 v20, 7, v20
    v_and_b32 v21, 1, v17
    v_lshl_add_u32 v20, v21, 2, v20
    v_add_u32 v10, 0, v20
    v_and_b32 v10, 31, v0
    v_lshlrev_b32 v10, 2, v10
    v_lshlrev_b32 v20, 8, v18
    v_lshl_add_u32 v20, v17, 5, v20
    v_and_b32 v21, 1, v16
    v_lshl_add_u32 v20, v21, 4, v20
    v_add_u32 v20, 10240, v20
    v_add_u32 v21, 12288, v1
    v_lshrrev_b32 v22, 1, v16
    v_cmp_eq_u32 vcc, v22, v18
    s_nop 1
    v_cndmask_b32 v6, v21, v20, vcc
    v_lshrrev_b32 v20, 3, v0
    v_lshlrev_b32 v20, 2, v20
    v_lshl_add_u32 v20, v17, 5, v20
    v_add_u32 v7, 10240, v20
    s_lshl_b32 s20, s12, 7
    s_add_u32 s20, s20, 20480
    s_lshr_b32 s21, s20, 13
    s_lshl_b32 s21, s21, 14
    s_and_b32 s20, s20, 8191
    s_add_u32 s20, s20, s21
    v_lshrrev_b32 v20, 3, v0
    v_lshlrev_b32 v20, 4, v20
    v_add_u32 v8, s20, v20
    s_mul_i32 s46, s12, 20480
    s_add_u32 s46, s46, 103809024
    s_mul_i32 s20, s12, 327680
    s_add_u32 s20, s20, 27262976
    s_add_u32 s21, s20, 65536
    buffer_load_dwordx4 v[176:179], v1, s[8:11], s21 offen offset:0
    buffer_load_dwordx4 v[180:183], v1, s[8:11], s21 offen offset:1024
    s_add_u32 s21, s20, 67584
    buffer_load_dwordx4 v[184:187], v1, s[8:11], s21 offen offset:0
    buffer_load_dwordx4 v[188:191], v1, s[8:11], s21 offen offset:1024
    s_add_u32 s21, s20, 69632
    buffer_load_dwordx4 v[192:195], v1, s[8:11], s21 offen offset:0
    buffer_load_dwordx4 v[196:199], v1, s[8:11], s21 offen offset:1024
    s_add_u32 s21, s20, 71680
    buffer_load_dwordx4 v[200:203], v1, s[8:11], s21 offen offset:0
    buffer_load_dwordx4 v[204:207], v1, s[8:11], s21 offen offset:1024
    s_add_u32 s21, s20, 73728
    buffer_load_dwordx4 v[208:211], v1, s[8:11], s21 offen offset:0
    buffer_load_dwordx4 v[212:215], v1, s[8:11], s21 offen offset:1024
    s_add_u32 s21, s20, 75776
    buffer_load_dwordx4 v[216:219], v1, s[8:11], s21 offen offset:0
    buffer_load_dwordx4 v[220:223], v1, s[8:11], s21 offen offset:1024
    s_add_u32 s21, s20, 77824
    buffer_load_dwordx4 v[224:227], v1, s[8:11], s21 offen offset:0
    buffer_load_dwordx4 v[228:231], v1, s[8:11], s21 offen offset:1024
    s_add_u32 s21, s20, 79872
    buffer_load_dwordx4 v[232:235], v1, s[8:11], s21 offen offset:0
    buffer_load_dwordx4 v[236:239], v1, s[8:11], s21 offen offset:1024
    s_add_u32 s20, s48, 51200
    s_mov_b64 exec, 3
    v_lshlrev_b32 v16, 2, v0
layerb1_kernel_y0_par:
    buffer_load_dword v17, v16, s[8:11], s20 offen sc1
    s_waitcnt vmcnt(0)
    v_cmp_eq_u32 vcc, 0, v17
    s_sub_u32 s15, s15, 1
    s_cbranch_scc1 layerb1_kernel_bail
    s_cbranch_vccnz layerb1_kernel_y0_par
    s_mov_b64 exec, -1
    v_readlane_b32 s20, v17, 0
    v_readlane_b32 s21, v17, 1
    s_nop 0
    s_and_b32 s20, s20, 8192
    s_and_b32 s21, s21, 8192
    s_add_u32 s16, s16, s20
    s_add_u32 s17, s17, s21
    s_mov_b32 s14, 0
    s_lshl_b32 s20, s12, 7
    v_mov_b32 v9, s20
    s_mov_b32 s47, 0
layerb1_kernel_y0_step:
    s_cmp_lt_u32 s14, 32
    s_cselect_b32 s18, s16, s17
    s_and_b32 s20, s14, 31
    s_lshl_b32 s20, s20, 16
    s_add_u32 s18, s18, s20
    s_mul_i32 s28, s14, 1638400
    s_add_u32 s28, s28, s46
    v_mov_b32 v56, 0
    v_mov_b32 v57, 0
    v_mov_b32 v58, 0
    v_mov_b32 v59, 0
    v_mov_b32 v60, 0
    v_mov_b32 v61, 0
    v_mov_b32 v62, 0
    v_mov_b32 v63, 0
    v_mov_b32 v64, 0
    v_mov_b32 v65, 0
    v_mov_b32 v66, 0
    v_mov_b32 v67, 0
    v_mov_b32 v68, 0
    v_mov_b32 v69, 0
    v_mov_b32 v70, 0
    v_mov_b32 v71, 0
    s_add_u32 s22, s18, 36864
    s_add_u32 s23, s18, 37888
    s_add_u32 s24, s18, 38912
layerb1_kernel_y0_poll:
    buffer_load_dwordx4 v[16:19], v1, s[8:11], s22 offen sc1
    buffer_load_dwordx4 v[20:23], v1, s[8:11], s23 offen sc1
    buffer_load_dwordx4 v[24:27], v1, s[8:11], s24 offen sc1
    s_waitcnt vmcnt(0)
    ds_write_b128 v3, v[16:19] offset:0
    ds_write_b128 v3, v[20:23] offset:1024
    ds_write_b128 v3, v[24:27] offset:2048
    v_max3_u32 v116, v16, v17, v18
    v_max3_u32 v116, v116, v19, v20
    v_max3_u32 v116, v116, v21, v22
    v_max3_u32 v116, v116, v23, v24
    v_max3_u32 v116, v116, v25, v26
    v_max_u32 v116, v116, v27
    v_cmp_eq_u32 vcc, -1, v116
    s_sub_u32 s15, s15, 1
    s_cbranch_scc1 layerb1_kernel_bail
    s_cbranch_vccnz layerb1_kernel_y0_poll
    s_waitcnt lgkmcnt(0)
    s_barrier
    ds_read_b128 v[28:31], v3 offset:3072
    ds_read_b128 v[32:35], v3 offset:4096
    ds_read_b128 v[36:39], v3 offset:5120
    ds_read_b128 v[40:43], v3 offset:6144
    ds_read_b128 v[44:47], v3 offset:7168
    ds_read_b128 v[48:51], v3 offset:8192
    ds_read_b128 v[52:55], v3 offset:9216
    s_cmp_gt_u32 s47, s14
    s_cbranch_scc1 layerb1_kernel_y0_gw_ok
layerb1_kernel_y0_gw_lp:
    buffer_load_dword v116, v9, s[8:11], s48 offen sc1
    s_waitcnt vmcnt(0)
    v_readlane_b32 s47, v116, 0
    s_nop 0
    s_sub_u32 s15, s15, 1
    s_cbranch_scc1 layerb1_kernel_bail
    s_cmp_gt_u32 s47, s14
    s_cbranch_scc0 layerb1_kernel_y0_gw_lp
layerb1_kernel_y0_gw_ok:
    buffer_load_dwordx4 v[76:79], v4, s[8:11], s28 offen offset:128 sc1
    buffer_load_dwordx4 v[80:83], v4, s[8:11], s28 offen offset:256 sc1
    buffer_load_dwordx4 v[84:87], v4, s[8:11], s28 offen offset:384 sc1
    buffer_load_dwordx4 v[88:91], v4, s[8:11], s28 offen offset:512 sc1
    v_smfmac_f32_16x16x64_bf16 v[56:59], v[16:19], a[0:7], v2
    v_smfmac_f32_16x16x64_bf16 v[60:63], v[16:19], a[80:87], v2
    v_smfmac_f32_16x16x64_bf16 v[64:67], v[16:19], a[160:167], v2
    v_smfmac_f32_16x16x64_bf16 v[68:71], v[16:19], a[240:247], v2
    v_smfmac_f32_16x16x64_bf16 v[56:59], v[20:23], a[8:15], v2
    v_smfmac_f32_16x16x64_bf16 v[60:63], v[20:23], a[88:95], v2
    v_smfmac_f32_16x16x64_bf16 v[64:67], v[20:23], a[168:175], v2
    v_smfmac_f32_16x16x64_bf16 v[68:71], v[20:23], a[248:255], v2
    v_smfmac_f32_16x16x64_bf16 v[56:59], v[24:27], a[16:23], v2
    v_smfmac_f32_16x16x64_bf16 v[60:63], v[24:27], a[96:103], v2
    v_smfmac_f32_16x16x64_bf16 v[64:67], v[24:27], a[176:183], v2
    v_smfmac_f32_16x16x64_bf16 v[68:71], v[24:27], v[176:183], v2
    s_waitcnt lgkmcnt(6)
    v_smfmac_f32_16x16x64_bf16 v[56:59], v[28:31], a[24:31], v2
    v_smfmac_f32_16x16x64_bf16 v[60:63], v[28:31], a[104:111], v2
    v_smfmac_f32_16x16x64_bf16 v[64:67], v[28:31], a[184:191], v2
    v_smfmac_f32_16x16x64_bf16 v[68:71], v[28:31], v[184:191], v2
    s_waitcnt lgkmcnt(5)
    v_smfmac_f32_16x16x64_bf16 v[56:59], v[32:35], a[32:39], v2
    v_smfmac_f32_16x16x64_bf16 v[60:63], v[32:35], a[112:119], v2
    v_smfmac_f32_16x16x64_bf16 v[64:67], v[32:35], a[192:199], v2
    v_smfmac_f32_16x16x64_bf16 v[68:71], v[32:35], v[192:199], v2
    s_waitcnt lgkmcnt(4)
    v_smfmac_f32_16x16x64_bf16 v[56:59], v[36:39], a[40:47], v2
    v_smfmac_f32_16x16x64_bf16 v[60:63], v[36:39], a[120:127], v2
    v_smfmac_f32_16x16x64_bf16 v[64:67], v[36:39], a[200:207], v2
    v_smfmac_f32_16x16x64_bf16 v[68:71], v[36:39], v[200:207], v2
    s_waitcnt lgkmcnt(3)
    v_smfmac_f32_16x16x64_bf16 v[56:59], v[40:43], a[48:55], v2
    v_smfmac_f32_16x16x64_bf16 v[60:63], v[40:43], a[128:135], v2
    v_smfmac_f32_16x16x64_bf16 v[64:67], v[40:43], a[208:215], v2
    v_smfmac_f32_16x16x64_bf16 v[68:71], v[40:43], v[208:215], v2
    s_waitcnt lgkmcnt(2)
    v_smfmac_f32_16x16x64_bf16 v[56:59], v[44:47], a[56:63], v2
    v_smfmac_f32_16x16x64_bf16 v[60:63], v[44:47], a[136:143], v2
    v_smfmac_f32_16x16x64_bf16 v[64:67], v[44:47], a[216:223], v2
    v_smfmac_f32_16x16x64_bf16 v[68:71], v[44:47], v[216:223], v2
    s_waitcnt lgkmcnt(1)
    v_smfmac_f32_16x16x64_bf16 v[56:59], v[48:51], a[64:71], v2
    v_smfmac_f32_16x16x64_bf16 v[60:63], v[48:51], a[144:151], v2
    v_smfmac_f32_16x16x64_bf16 v[64:67], v[48:51], a[224:231], v2
    v_smfmac_f32_16x16x64_bf16 v[68:71], v[48:51], v[224:231], v2
    s_waitcnt lgkmcnt(0)
    v_smfmac_f32_16x16x64_bf16 v[56:59], v[52:55], a[72:79], v2
    v_smfmac_f32_16x16x64_bf16 v[60:63], v[52:55], a[152:159], v2
    v_smfmac_f32_16x16x64_bf16 v[64:67], v[52:55], a[232:239], v2
    v_smfmac_f32_16x16x64_bf16 v[68:71], v[52:55], v[232:239], v2
    s_nop 7
    v_permlane32_swap_b32 v56, v64
    v_permlane32_swap_b32 v60, v68
    v_permlane32_swap_b32 v57, v65
    v_permlane32_swap_b32 v61, v69
    v_permlane32_swap_b32 v58, v66
    v_permlane32_swap_b32 v62, v70
    v_permlane32_swap_b32 v59, v67
    v_permlane32_swap_b32 v63, v71
    v_add_f32 v56, v56, v64
    v_add_f32 v60, v60, v68
    v_add_f32 v57, v57, v65
    v_add_f32 v61, v61, v69
    v_add_f32 v58, v58, v66
    v_add_f32 v62, v62, v70
    v_add_f32 v59, v59, v67
    v_add_f32 v63, v63, v71
    s_nop 1
    v_permlane16_swap_b32 v56, v60
    v_permlane16_swap_b32 v57, v61
    v_permlane16_swap_b32 v58, v62
    v_permlane16_swap_b32 v59, v63
    s_nop 1
    v_cvt_pk_bf16_f32 v72, v56, v57
    v_cvt_pk_bf16_f32 v73, v58, v59
    v_cvt_pk_bf16_f32 v74, v60, v61
    v_cvt_pk_bf16_f32 v75, v62, v63
    buffer_store_dwordx4 v[72:75], v4, s[8:11], s28 offen sc1
    s_cmp_eq_u32 s14, 63
    s_cbranch_scc1 layerb1_kernel_y0_last
    s_add_u32 s30, s18, 0
    s_add_u32 s31, s18, 4096
    s_add_u32 s32, s18, 16384
    s_add_u32 s33, s18, 20480
    s_add_u32 s34, s18, 32768
    s_add_u32 s29, s14, 1
    s_cmp_lt_u32 s29, 32
    s_cselect_b32 s19, s16, s17
    s_and_b32 s20, s29, 31
    s_lshl_b32 s20, s20, 16
    s_add_u32 s19, s19, s20
    s_and_b32 s69, s12, 0
    s_lshl_b32 s69, s69, 7
    s_add_u32 s69, s69, s18
    s_add_u32 s69, s69, 55424
    s_mov_b32 exec_lo, -1
    s_mov_b32 exec_hi, 0
layerb1_kernel_y0_hpoll:
    buffer_load_dword v116, v10, s[8:11], s69 offen sc1
    s_waitcnt vmcnt(0)
    v_cmp_eq_u32 vcc, -1, v116
    s_sub_u32 s15, s15, 1
    s_cbranch_scc1 layerb1_kernel_bail
    s_cbranch_vccnz layerb1_kernel_y0_hpoll
    s_mov_b64 exec, -1
    s_barrier
    buffer_load_dwordx4 v[92:95], v5, s[8:11], s30 offen sc1
    buffer_load_dwordx4 v[96:99], v5, s[8:11], s31 offen sc1
    buffer_load_dwordx4 v[100:103], v5, s[8:11], s32 offen sc1
    buffer_load_dwordx4 v[104:107], v5, s[8:11], s33 offen sc1
    buffer_load_dwordx4 v[108:111], v5, s[8:11], s34 offen sc1
    s_waitcnt vmcnt(0)
    v_mfma_f32_16x16x32_bf16 v[112:115], v[92:95], v[72:75], 0
    v_mfma_f32_16x16x32_bf16 v[112:115], v[96:99], v[76:79], v[112:115]
    v_mfma_f32_16x16x32_bf16 v[112:115], v[100:103], v[80:83], v[112:115]
    v_mfma_f32_16x16x32_bf16 v[112:115], v[104:107], v[84:87], v[112:115]
    v_mfma_f32_16x16x32_bf16 v[112:115], v[108:111], v[88:91], v[112:115]
    v_max3_u32 v116, v92, v93, v94
    v_max3_u32 v116, v116, v95, v96
    v_max3_u32 v116, v116, v97, v98
    v_max3_u32 v116, v116, v99, v100
    v_max3_u32 v116, v116, v101, v102
    v_max3_u32 v116, v116, v103, v104
    v_max3_u32 v116, v116, v105, v106
    v_max3_u32 v116, v116, v107, v108
    v_max3_u32 v116, v116, v109, v110
    v_max_u32 v116, v116, v111
    v_cmp_eq_u32 vcc, -1, v116
    s_cbranch_vccz layerb1_kernel_y0_ppz
layerb1_kernel_y0_ppoll:
    buffer_load_dwordx4 v[92:95], v5, s[8:11], s30 offen sc1
    buffer_load_dwordx4 v[96:99], v5, s[8:11], s31 offen sc1
    buffer_load_dwordx4 v[100:103], v5, s[8:11], s32 offen sc1
    buffer_load_dwordx4 v[104:107], v5, s[8:11], s33 offen sc1
    buffer_load_dwordx4 v[108:111], v5, s[8:11], s34 offen sc1
    s_waitcnt vmcnt(0)
    v_mfma_f32_16x16x32_bf16 v[112:115], v[92:95], v[72:75], 0
    v_mfma_f32_16x16x32_bf16 v[112:115], v[96:99], v[76:79], v[112:115]
    v_mfma_f32_16x16x32_bf16 v[112:115], v[100:103], v[80:83], v[112:115]
    v_mfma_f32_16x16x32_bf16 v[112:115], v[104:107], v[84:87], v[112:115]
    v_mfma_f32_16x16x32_bf16 v[112:115], v[108:111], v[88:91], v[112:115]
    v_max3_u32 v116, v92, v93, v94
    v_max3_u32 v116, v116, v95, v96
    v_max3_u32 v116, v116, v97, v98
    v_max3_u32 v116, v116, v99, v100
    v_max3_u32 v116, v116, v101, v102
    v_max3_u32 v116, v116, v103, v104
    v_max3_u32 v116, v116, v105, v106
    v_max3_u32 v116, v116, v107, v108
    v_max3_u32 v116, v116, v109, v110
    v_max_u32 v116, v116, v111
    v_cmp_eq_u32 vcc, -1, v116
    s_sub_u32 s15, s15, 1
    s_cbranch_scc1 layerb1_kernel_bail
    s_cbranch_vccnz layerb1_kernel_y0_ppoll
layerb1_kernel_y0_ppz:
    ds_write_b128 v6, v[112:115]
    s_waitcnt lgkmcnt(0)
    s_barrier
    ds_read2st64_b32 v[116:117], v7 offset0:0 offset1:1
    ds_read2st64_b32 v[118:119], v7 offset0:2 offset1:3
    ds_read2st64_b32 v[120:121], v7 offset0:4 offset1:5
    ds_read2st64_b32 v[122:123], v7 offset0:6 offset1:7
    s_waitcnt lgkmcnt(2)
    v_add_f32 v116, v116, v117
    v_add_f32 v118, v118, v119
    s_waitcnt lgkmcnt(0)
    v_add_f32 v120, v120, v121
    v_add_f32 v122, v122, v123
    v_add_f32 v116, v116, v118
    v_add_f32 v120, v120, v122
    v_add_f32 v116, v116, v120
    s_nop 1
    v_mov_b32_dpp v117, v116 quad_perm:[1,0,3,2] row_mask:0xf bank_mask:0xf
    v_cvt_pk_bf16_f32 v124, v116, v117
    s_nop 1
    v_mov_b32_dpp v125, v124 row_shl:2 row_mask:0xf bank_mask:0xf
    v_mov_b32_dpp v126, v124 row_shl:4 row_mask:0xf bank_mask:0xf
    v_mov_b32_dpp v127, v124 row_shl:6 row_mask:0xf bank_mask:0xf
    s_mov_b64 exec, s[40:41]
    buffer_store_dwordx4 v[124:127], v8, s[8:11], s19 offen sc1
    s_mov_b64 exec, -1
    s_lshl_b32 s20, s12, 7
    s_add_u32 s20, s20, 20480
    s_mov_b64 exec, 1
    v_mov_b32 v116, s20
    v_mov_b32 v117, s29
    buffer_store_dword v117, v116, s[8:11], s48 offen sc1
    s_mov_b64 exec, -1
    s_waitcnt vmcnt(0)
    s_barrier
    s_add_u32 s14, s14, 1
    s_branch layerb1_kernel_y0_step
layerb1_kernel_y0_last:
    s_waitcnt vmcnt(0)
    s_barrier
    s_lshl_b32 s20, s12, 7
    s_add_u32 s20, s20, 20480
    s_mov_b32 s29, 64
    s_mov_b64 exec, 1
    v_mov_b32 v116, s20
    v_mov_b32 v117, s29
    buffer_store_dword v117, v116, s[8:11], s48 offen sc1
    s_mov_b64 exec, -1
    s_branch layerb1_kernel_end
layerb1_kernel_y1_start:
    v_lshrrev_b32 v16, 4, v0
    v_and_b32 v17, 7, v0
    v_lshrrev_b32 v18, 3, v0
    v_and_b32 v18, 1, v18
    v_lshl_add_u32 v19, v18, 2, v16
    v_add_u32 v19, 8, v19
    v_mul_u32_u24 v20, 640, v19
    v_lshl_add_u32 v4, v17, 4, v20
    v_and_b32 v20, 1, v17
    v_lshlrev_b32 v20, 2, v20
    v_lshrrev_b32 v21, 1, v17
    v_add_u32 v20, v20, v21
    v_lshlrev_b32 v20, 4, v20
    v_lshl_add_u32 v5, v19, 7, v20
    v_add_u32 v3, 0, v1
    v_lshrrev_b32 v20, 1, v17
    v_lshlrev_b32 v20, 7, v20
    v_and_b32 v21, 1, v17
    v_lshl_add_u32 v20, v21, 2, v20
    v_add_u32 v10, 512, v20
    v_and_b32 v10, 31, v0
    v_lshlrev_b32 v10, 2, v10
    v_lshlrev_b32 v20, 8, v18
    v_lshl_add_u32 v20, v17, 5, v20
    v_and_b32 v21, 1, v16
    v_lshl_add_u32 v20, v21, 4, v20
    v_add_u32 v20, 10752, v20
    v_add_u32 v21, 12288, v1
    v_lshrrev_b32 v22, 1, v16
    v_cmp_eq_u32 vcc, v22, v18
    s_nop 1
    v_cndmask_b32 v6, v21, v20, vcc
    v_lshrrev_b32 v20, 3, v0
    v_lshlrev_b32 v20, 2, v20
    v_lshl_add_u32 v20, v17, 5, v20
    v_add_u32 v7, 10240, v20
    s_lshl_b32 s20, s12, 7
    s_add_u32 s20, s20, 20480
    s_lshr_b32 s21, s20, 13
    s_lshl_b32 s21, s21, 14
    s_and_b32 s20, s20, 8191
    s_add_u32 s20, s20, s21
    v_lshrrev_b32 v20, 3, v0
    v_lshlrev_b32 v20, 4, v20
    v_add_u32 v8, s20, v20
    s_mul_i32 s46, s12, 20480
    s_add_u32 s46, s46, 103809024
    s_mul_i32 s20, s12, 327680
    s_add_u32 s20, s20, 27344896
    s_add_u32 s21, s20, 65536
    buffer_load_dwordx4 v[176:179], v1, s[8:11], s21 offen offset:0
    buffer_load_dwordx4 v[180:183], v1, s[8:11], s21 offen offset:1024
    s_add_u32 s21, s20, 67584
    buffer_load_dwordx4 v[184:187], v1, s[8:11], s21 offen offset:0
    buffer_load_dwordx4 v[188:191], v1, s[8:11], s21 offen offset:1024
    s_add_u32 s21, s20, 69632
    buffer_load_dwordx4 v[192:195], v1, s[8:11], s21 offen offset:0
    buffer_load_dwordx4 v[196:199], v1, s[8:11], s21 offen offset:1024
    s_add_u32 s21, s20, 71680
    buffer_load_dwordx4 v[200:203], v1, s[8:11], s21 offen offset:0
    buffer_load_dwordx4 v[204:207], v1, s[8:11], s21 offen offset:1024
    s_add_u32 s21, s20, 73728
    buffer_load_dwordx4 v[208:211], v1, s[8:11], s21 offen offset:0
    buffer_load_dwordx4 v[212:215], v1, s[8:11], s21 offen offset:1024
    s_add_u32 s21, s20, 75776
    buffer_load_dwordx4 v[216:219], v1, s[8:11], s21 offen offset:0
    buffer_load_dwordx4 v[220:223], v1, s[8:11], s21 offen offset:1024
    s_add_u32 s21, s20, 77824
    buffer_load_dwordx4 v[224:227], v1, s[8:11], s21 offen offset:0
    buffer_load_dwordx4 v[228:231], v1, s[8:11], s21 offen offset:1024
    s_add_u32 s21, s20, 79872
    buffer_load_dwordx4 v[232:235], v1, s[8:11], s21 offen offset:0
    buffer_load_dwordx4 v[236:239], v1, s[8:11], s21 offen offset:1024
    s_add_u32 s20, s48, 51200
    s_mov_b64 exec, 3
    v_lshlrev_b32 v16, 2, v0
layerb1_kernel_y1_par:
    buffer_load_dword v17, v16, s[8:11], s20 offen sc1
    s_waitcnt vmcnt(0)
    v_cmp_eq_u32 vcc, 0, v17
    s_sub_u32 s15, s15, 1
    s_cbranch_scc1 layerb1_kernel_bail
    s_cbranch_vccnz layerb1_kernel_y1_par
    s_mov_b64 exec, -1
    v_readlane_b32 s20, v17, 0
    v_readlane_b32 s21, v17, 1
    s_nop 0
    s_and_b32 s20, s20, 8192
    s_and_b32 s21, s21, 8192
    s_add_u32 s16, s16, s20
    s_add_u32 s17, s17, s21
    s_mov_b32 s14, 0
    s_lshl_b32 s20, s12, 7
    v_mov_b32 v9, s20
    s_mov_b32 s47, 0
layerb1_kernel_y1_step:
    s_cmp_lt_u32 s14, 32
    s_cselect_b32 s18, s16, s17
    s_and_b32 s20, s14, 31
    s_lshl_b32 s20, s20, 16
    s_add_u32 s18, s18, s20
    s_mul_i32 s28, s14, 1638400
    s_add_u32 s28, s28, s46
    v_mov_b32 v56, 0
    v_mov_b32 v57, 0
    v_mov_b32 v58, 0
    v_mov_b32 v59, 0
    v_mov_b32 v60, 0
    v_mov_b32 v61, 0
    v_mov_b32 v62, 0
    v_mov_b32 v63, 0
    v_mov_b32 v64, 0
    v_mov_b32 v65, 0
    v_mov_b32 v66, 0
    v_mov_b32 v67, 0
    v_mov_b32 v68, 0
    v_mov_b32 v69, 0
    v_mov_b32 v70, 0
    v_mov_b32 v71, 0
    s_add_u32 s22, s18, 39936
    s_add_u32 s23, s18, 49152
    s_add_u32 s24, s18, 50176
layerb1_kernel_y1_poll:
    buffer_load_dwordx4 v[28:31], v1, s[8:11], s22 offen sc1
    buffer_load_dwordx4 v[32:35], v1, s[8:11], s23 offen sc1
    buffer_load_dwordx4 v[36:39], v1, s[8:11], s24 offen sc1
    s_waitcnt vmcnt(0)
    ds_write_b128 v3, v[28:31] offset:3072
    ds_write_b128 v3, v[32:35] offset:4096
    ds_write_b128 v3, v[36:39] offset:5120
    v_max3_u32 v116, v28, v29, v30
    v_max3_u32 v116, v116, v31, v32
    v_max3_u32 v116, v116, v33, v34
    v_max3_u32 v116, v116, v35, v36
    v_max3_u32 v116, v116, v37, v38
    v_max_u32 v116, v116, v39
    v_cmp_eq_u32 vcc, -1, v116
    s_sub_u32 s15, s15, 1
    s_cbranch_scc1 layerb1_kernel_bail
    s_cbranch_vccnz layerb1_kernel_y1_poll
    s_waitcnt lgkmcnt(0)
    s_barrier
    ds_read_b128 v[16:19], v3 offset:0
    ds_read_b128 v[20:23], v3 offset:1024
    ds_read_b128 v[24:27], v3 offset:2048
    ds_read_b128 v[40:43], v3 offset:6144
    ds_read_b128 v[44:47], v3 offset:7168
    ds_read_b128 v[48:51], v3 offset:8192
    ds_read_b128 v[52:55], v3 offset:9216
    s_cmp_gt_u32 s47, s14
    s_cbranch_scc1 layerb1_kernel_y1_gw_ok
layerb1_kernel_y1_gw_lp:
    buffer_load_dword v116, v9, s[8:11], s48 offen sc1
    s_waitcnt vmcnt(0)
    v_readlane_b32 s47, v116, 0
    s_nop 0
    s_sub_u32 s15, s15, 1
    s_cbranch_scc1 layerb1_kernel_bail
    s_cmp_gt_u32 s47, s14
    s_cbranch_scc0 layerb1_kernel_y1_gw_lp
layerb1_kernel_y1_gw_ok:
    buffer_load_dwordx4 v[76:79], v4, s[8:11], s28 offen offset:128 sc1
    buffer_load_dwordx4 v[80:83], v4, s[8:11], s28 offen offset:256 sc1
    buffer_load_dwordx4 v[84:87], v4, s[8:11], s28 offen offset:384 sc1
    buffer_load_dwordx4 v[88:91], v4, s[8:11], s28 offen offset:512 sc1
    v_smfmac_f32_16x16x64_bf16 v[56:59], v[28:31], a[24:31], v2
    v_smfmac_f32_16x16x64_bf16 v[60:63], v[28:31], a[104:111], v2
    v_smfmac_f32_16x16x64_bf16 v[64:67], v[28:31], a[184:191], v2
    v_smfmac_f32_16x16x64_bf16 v[68:71], v[28:31], v[184:191], v2
    v_smfmac_f32_16x16x64_bf16 v[56:59], v[32:35], a[32:39], v2
    v_smfmac_f32_16x16x64_bf16 v[60:63], v[32:35], a[112:119], v2
    v_smfmac_f32_16x16x64_bf16 v[64:67], v[32:35], a[192:199], v2
    v_smfmac_f32_16x16x64_bf16 v[68:71], v[32:35], v[192:199], v2
    v_smfmac_f32_16x16x64_bf16 v[56:59], v[36:39], a[40:47], v2
    v_smfmac_f32_16x16x64_bf16 v[60:63], v[36:39], a[120:127], v2
    v_smfmac_f32_16x16x64_bf16 v[64:67], v[36:39], a[200:207], v2
    v_smfmac_f32_16x16x64_bf16 v[68:71], v[36:39], v[200:207], v2
    s_waitcnt lgkmcnt(6)
    v_smfmac_f32_16x16x64_bf16 v[56:59], v[16:19], a[0:7], v2
    v_smfmac_f32_16x16x64_bf16 v[60:63], v[16:19], a[80:87], v2
    v_smfmac_f32_16x16x64_bf16 v[64:67], v[16:19], a[160:167], v2
    v_smfmac_f32_16x16x64_bf16 v[68:71], v[16:19], a[240:247], v2
    s_waitcnt lgkmcnt(5)
    v_smfmac_f32_16x16x64_bf16 v[56:59], v[20:23], a[8:15], v2
    v_smfmac_f32_16x16x64_bf16 v[60:63], v[20:23], a[88:95], v2
    v_smfmac_f32_16x16x64_bf16 v[64:67], v[20:23], a[168:175], v2
    v_smfmac_f32_16x16x64_bf16 v[68:71], v[20:23], a[248:255], v2
    s_waitcnt lgkmcnt(4)
    v_smfmac_f32_16x16x64_bf16 v[56:59], v[24:27], a[16:23], v2
    v_smfmac_f32_16x16x64_bf16 v[60:63], v[24:27], a[96:103], v2
    v_smfmac_f32_16x16x64_bf16 v[64:67], v[24:27], a[176:183], v2
    v_smfmac_f32_16x16x64_bf16 v[68:71], v[24:27], v[176:183], v2
    s_waitcnt lgkmcnt(3)
    v_smfmac_f32_16x16x64_bf16 v[56:59], v[40:43], a[48:55], v2
    v_smfmac_f32_16x16x64_bf16 v[60:63], v[40:43], a[128:135], v2
    v_smfmac_f32_16x16x64_bf16 v[64:67], v[40:43], a[208:215], v2
    v_smfmac_f32_16x16x64_bf16 v[68:71], v[40:43], v[208:215], v2
    s_waitcnt lgkmcnt(2)
    v_smfmac_f32_16x16x64_bf16 v[56:59], v[44:47], a[56:63], v2
    v_smfmac_f32_16x16x64_bf16 v[60:63], v[44:47], a[136:143], v2
    v_smfmac_f32_16x16x64_bf16 v[64:67], v[44:47], a[216:223], v2
    v_smfmac_f32_16x16x64_bf16 v[68:71], v[44:47], v[216:223], v2
    s_waitcnt lgkmcnt(1)
    v_smfmac_f32_16x16x64_bf16 v[56:59], v[48:51], a[64:71], v2
    v_smfmac_f32_16x16x64_bf16 v[60:63], v[48:51], a[144:151], v2
    v_smfmac_f32_16x16x64_bf16 v[64:67], v[48:51], a[224:231], v2
    v_smfmac_f32_16x16x64_bf16 v[68:71], v[48:51], v[224:231], v2
    s_waitcnt lgkmcnt(0)
    v_smfmac_f32_16x16x64_bf16 v[56:59], v[52:55], a[72:79], v2
    v_smfmac_f32_16x16x64_bf16 v[60:63], v[52:55], a[152:159], v2
    v_smfmac_f32_16x16x64_bf16 v[64:67], v[52:55], a[232:239], v2
    v_smfmac_f32_16x16x64_bf16 v[68:71], v[52:55], v[232:239], v2
    s_nop 7
    v_permlane32_swap_b32 v56, v64
    v_permlane32_swap_b32 v60, v68
    v_permlane32_swap_b32 v57, v65
    v_permlane32_swap_b32 v61, v69
    v_permlane32_swap_b32 v58, v66
    v_permlane32_swap_b32 v62, v70
    v_permlane32_swap_b32 v59, v67
    v_permlane32_swap_b32 v63, v71
    v_add_f32 v56, v56, v64
    v_add_f32 v60, v60, v68
    v_add_f32 v57, v57, v65
    v_add_f32 v61, v61, v69
    v_add_f32 v58, v58, v66
    v_add_f32 v62, v62, v70
    v_add_f32 v59, v59, v67
    v_add_f32 v63, v63, v71
    s_nop 1
    v_permlane16_swap_b32 v56, v60
    v_permlane16_swap_b32 v57, v61
    v_permlane16_swap_b32 v58, v62
    v_permlane16_swap_b32 v59, v63
    s_nop 1
    v_cvt_pk_bf16_f32 v72, v56, v57
    v_cvt_pk_bf16_f32 v73, v58, v59
    v_cvt_pk_bf16_f32 v74, v60, v61
    v_cvt_pk_bf16_f32 v75, v62, v63
    buffer_store_dwordx4 v[72:75], v4, s[8:11], s28 offen sc1
    s_cmp_eq_u32 s14, 63
    s_cbranch_scc1 layerb1_kernel_y1_last
    s_add_u32 s30, s18, 0
    s_add_u32 s31, s18, 4096
    s_add_u32 s32, s18, 16384
    s_add_u32 s33, s18, 20480
    s_add_u32 s34, s18, 32768
    s_add_u32 s29, s14, 1
    s_cmp_lt_u32 s29, 32
    s_cselect_b32 s19, s16, s17
    s_and_b32 s20, s29, 31
    s_lshl_b32 s20, s20, 16
    s_add_u32 s19, s19, s20
    s_barrier
    buffer_load_dwordx4 v[92:95], v5, s[8:11], s30 offen sc1
    buffer_load_dwordx4 v[96:99], v5, s[8:11], s31 offen sc1
    buffer_load_dwordx4 v[100:103], v5, s[8:11], s32 offen sc1
    buffer_load_dwordx4 v[104:107], v5, s[8:11], s33 offen sc1
    buffer_load_dwordx4 v[108:111], v5, s[8:11], s34 offen sc1
    s_waitcnt vmcnt(0)
    v_mfma_f32_16x16x32_bf16 v[112:115], v[92:95], v[72:75], 0
    v_mfma_f32_16x16x32_bf16 v[112:115], v[96:99], v[76:79], v[112:115]
    v_mfma_f32_16x16x32_bf16 v[112:115], v[100:103], v[80:83], v[112:115]
    v_mfma_f32_16x16x32_bf16 v[112:115], v[104:107], v[84:87], v[112:115]
    v_mfma_f32_16x16x32_bf16 v[112:115], v[108:111], v[88:91], v[112:115]
    v_max3_u32 v116, v92, v93, v94
    v_max3_u32 v116, v116, v95, v96
    v_max3_u32 v116, v116, v97, v98
    v_max3_u32 v116, v116, v99, v100
    v_max3_u32 v116, v116, v101, v102
    v_max3_u32 v116, v116, v103, v104
    v_max3_u32 v116, v116, v105, v106
    v_max3_u32 v116, v116, v107, v108
    v_max3_u32 v116, v116, v109, v110
    v_max_u32 v116, v116, v111
    v_cmp_eq_u32 vcc, -1, v116
    s_cbranch_vccz layerb1_kernel_y1_ppz
layerb1_kernel_y1_ppoll:
    buffer_load_dwordx4 v[92:95], v5, s[8:11], s30 offen sc1
    buffer_load_dwordx4 v[96:99], v5, s[8:11], s31 offen sc1
    buffer_load_dwordx4 v[100:103], v5, s[8:11], s32 offen sc1
    buffer_load_dwordx4 v[104:107], v5, s[8:11], s33 offen sc1
    buffer_load_dwordx4 v[108:111], v5, s[8:11], s34 offen sc1
    s_waitcnt vmcnt(0)
    v_mfma_f32_16x16x32_bf16 v[112:115], v[92:95], v[72:75], 0
    v_mfma_f32_16x16x32_bf16 v[112:115], v[96:99], v[76:79], v[112:115]
    v_mfma_f32_16x16x32_bf16 v[112:115], v[100:103], v[80:83], v[112:115]
    v_mfma_f32_16x16x32_bf16 v[112:115], v[104:107], v[84:87], v[112:115]
    v_mfma_f32_16x16x32_bf16 v[112:115], v[108:111], v[88:91], v[112:115]
    v_max3_u32 v116, v92, v93, v94
    v_max3_u32 v116, v116, v95, v96
    v_max3_u32 v116, v116, v97, v98
    v_max3_u32 v116, v116, v99, v100
    v_max3_u32 v116, v116, v101, v102
    v_max3_u32 v116, v116, v103, v104
    v_max3_u32 v116, v116, v105, v106
    v_max3_u32 v116, v116, v107, v108
    v_max3_u32 v116, v116, v109, v110
    v_max_u32 v116, v116, v111
    v_cmp_eq_u32 vcc, -1, v116
    s_sub_u32 s15, s15, 1
    s_cbranch_scc1 layerb1_kernel_bail
    s_cbranch_vccnz layerb1_kernel_y1_ppoll
layerb1_kernel_y1_ppz:
    ds_write_b128 v6, v[112:115]
    s_waitcnt lgkmcnt(0)
    s_barrier
    s_barrier
    s_add_u32 s14, s14, 1
    s_branch layerb1_kernel_y1_step
layerb1_kernel_y1_last:
    s_waitcnt vmcnt(0)
    s_barrier
    s_branch layerb1_kernel_end
layerb1_kernel_y2_start:
    v_lshrrev_b32 v16, 4, v0
    v_and_b32 v17, 7, v0
    v_lshrrev_b32 v18, 3, v0
    v_and_b32 v18, 1, v18
    v_lshl_add_u32 v19, v18, 2, v16
    v_add_u32 v19, 16, v19
    v_mul_u32_u24 v20, 640, v19
    v_lshl_add_u32 v4, v17, 4, v20
    v_and_b32 v20, 1, v17
    v_lshlrev_b32 v20, 2, v20
    v_lshrrev_b32 v21, 1, v17
    v_add_u32 v20, v20, v21
    v_lshlrev_b32 v20, 4, v20
    v_lshl_add_u32 v5, v19, 7, v20
    v_add_u32 v3, 0, v1
    v_lshrrev_b32 v20, 1, v17
    v_lshlrev_b32 v20, 7, v20
    v_and_b32 v21, 1, v17
    v_lshl_add_u32 v20, v21, 2, v20
    v_add_u32 v10, 1024, v20
    v_and_b32 v10, 31, v0
    v_lshlrev_b32 v10, 2, v10
    v_lshlrev_b32 v20, 8, v18
    v_lshl_add_u32 v20, v17, 5, v20
    v_and_b32 v21, 1, v16
    v_lshl_add_u32 v20, v21, 4, v20
    v_add_u32 v20, 11264, v20
    v_add_u32 v21, 12288, v1
    v_lshrrev_b32 v22, 1, v16
    v_cmp_eq_u32 vcc, v22, v18
    s_nop 1
    v_cndmask_b32 v6, v21, v20, vcc
    v_lshrrev_b32 v20, 3, v0
    v_lshlrev_b32 v20, 2, v20
    v_lshl_add_u32 v20, v17, 5, v20
    v_add_u32 v7, 10240, v20
    s_lshl_b32 s20, s12, 7
    s_add_u32 s20, s20, 20480
    s_lshr_b32 s21, s20, 13
    s_lshl_b32 s21, s21, 14
    s_and_b32 s20, s20, 8191
    s_add_u32 s20, s20, s21
    v_lshrrev_b32 v20, 3, v0
    v_lshlrev_b32 v20, 4, v20
    v_add_u32 v8, s20, v20
    s_mul_i32 s46, s12, 20480
    s_add_u32 s46, s46, 103809024
    s_mul_i32 s20, s12, 327680
    s_add_u32 s20, s20, 27426816
    s_add_u32 s21, s20, 65536
    buffer_load_dwordx4 v[176:179], v1, s[8:11], s21 offen offset:0
    buffer_load_dwordx4 v[180:183], v1, s[8:11], s21 offen offset:1024
    s_add_u32 s21, s20, 67584
    buffer_load_dwordx4 v[184:187], v1, s[8:11], s21 offen offset:0
    buffer_load_dwordx4 v[188:191], v1, s[8:11], s21 offen offset:1024
    s_add_u32 s21, s20, 69632
    buffer_load_dwordx4 v[192:195], v1, s[8:11], s21 offen offset:0
    buffer_load_dwordx4 v[196:199], v1, s[8:11], s21 offen offset:1024
    s_add_u32 s21, s20, 71680
    buffer_load_dwordx4 v[200:203], v1, s[8:11], s21 offen offset:0
    buffer_load_dwordx4 v[204:207], v1, s[8:11], s21 offen offset:1024
    s_add_u32 s21, s20, 73728
    buffer_load_dwordx4 v[208:211], v1, s[8:11], s21 offen offset:0
    buffer_load_dwordx4 v[212:215], v1, s[8:11], s21 offen offset:1024
    s_add_u32 s21, s20, 75776
    buffer_load_dwordx4 v[216:219], v1, s[8:11], s21 offen offset:0
    buffer_load_dwordx4 v[220:223], v1, s[8:11], s21 offen offset:1024
    s_add_u32 s21, s20, 77824
    buffer_load_dwordx4 v[224:227], v1, s[8:11], s21 offen offset:0
    buffer_load_dwordx4 v[228:231], v1, s[8:11], s21 offen offset:1024
    s_add_u32 s21, s20, 79872
    buffer_load_dwordx4 v[232:235], v1, s[8:11], s21 offen offset:0
    buffer_load_dwordx4 v[236:239], v1, s[8:11], s21 offen offset:1024
    s_add_u32 s20, s48, 51200
    s_mov_b64 exec, 3
    v_lshlrev_b32 v16, 2, v0
layerb1_kernel_y2_par:
    buffer_load_dword v17, v16, s[8:11], s20 offen sc1
    s_waitcnt vmcnt(0)
    v_cmp_eq_u32 vcc, 0, v17
    s_sub_u32 s15, s15, 1
    s_cbranch_scc1 layerb1_kernel_bail
    s_cbranch_vccnz layerb1_kernel_y2_par
    s_mov_b64 exec, -1
    v_readlane_b32 s20, v17, 0
    v_readlane_b32 s21, v17, 1
    s_nop 0
    s_and_b32 s20, s20, 8192
    s_and_b32 s21, s21, 8192
    s_add_u32 s16, s16, s20
    s_add_u32 s17, s17, s21
    s_mov_b32 s14, 0
    s_lshl_b32 s20, s12, 7
    v_mov_b32 v9, s20
    s_mov_b32 s47, 0
layerb1_kernel_y2_step:
    s_cmp_lt_u32 s14, 32
    s_cselect_b32 s18, s16, s17
    s_and_b32 s20, s14, 31
    s_lshl_b32 s20, s20, 16
    s_add_u32 s18, s18, s20
    s_mul_i32 s28, s14, 1638400
    s_add_u32 s28, s28, s46
    v_mov_b32 v56, 0
    v_mov_b32 v57, 0
    v_mov_b32 v58, 0
    v_mov_b32 v59, 0
    v_mov_b32 v60, 0
    v_mov_b32 v61, 0
    v_mov_b32 v62, 0
    v_mov_b32 v63, 0
    v_mov_b32 v64, 0
    v_mov_b32 v65, 0
    v_mov_b32 v66, 0
    v_mov_b32 v67, 0
    v_mov_b32 v68, 0
    v_mov_b32 v69, 0
    v_mov_b32 v70, 0
    v_mov_b32 v71, 0
    s_add_u32 s22, s18, 51200
    s_add_u32 s23, s18, 52224
layerb1_kernel_y2_poll:
    buffer_load_dwordx4 v[40:43], v1, s[8:11], s22 offen sc1
    buffer_load_dwordx4 v[44:47], v1, s[8:11], s23 offen sc1
    s_waitcnt vmcnt(0)
    ds_write_b128 v3, v[40:43] offset:6144
    ds_write_b128 v3, v[44:47] offset:7168
    v_max3_u32 v116, v40, v41, v42
    v_max3_u32 v116, v116, v43, v44
    v_max3_u32 v116, v116, v45, v46
    v_max_u32 v116, v116, v47
    v_cmp_eq_u32 vcc, -1, v116
    s_sub_u32 s15, s15, 1
    s_cbranch_scc1 layerb1_kernel_bail
    s_cbranch_vccnz layerb1_kernel_y2_poll
    s_waitcnt lgkmcnt(0)
    s_barrier
    ds_read_b128 v[16:19], v3 offset:0
    ds_read_b128 v[20:23], v3 offset:1024
    ds_read_b128 v[24:27], v3 offset:2048
    ds_read_b128 v[28:31], v3 offset:3072
    ds_read_b128 v[32:35], v3 offset:4096
    ds_read_b128 v[36:39], v3 offset:5120
    ds_read_b128 v[48:51], v3 offset:8192
    ds_read_b128 v[52:55], v3 offset:9216
    s_cmp_gt_u32 s47, s14
    s_cbranch_scc1 layerb1_kernel_y2_gw_ok
layerb1_kernel_y2_gw_lp:
    buffer_load_dword v116, v9, s[8:11], s48 offen sc1
    s_waitcnt vmcnt(0)
    v_readlane_b32 s47, v116, 0
    s_nop 0
    s_sub_u32 s15, s15, 1
    s_cbranch_scc1 layerb1_kernel_bail
    s_cmp_gt_u32 s47, s14
    s_cbranch_scc0 layerb1_kernel_y2_gw_lp
layerb1_kernel_y2_gw_ok:
    buffer_load_dwordx4 v[76:79], v4, s[8:11], s28 offen offset:128 sc1
    buffer_load_dwordx4 v[80:83], v4, s[8:11], s28 offen offset:256 sc1
    buffer_load_dwordx4 v[84:87], v4, s[8:11], s28 offen offset:384 sc1
    buffer_load_dwordx4 v[88:91], v4, s[8:11], s28 offen offset:512 sc1
    v_smfmac_f32_16x16x64_bf16 v[56:59], v[40:43], a[48:55], v2
    v_smfmac_f32_16x16x64_bf16 v[60:63], v[40:43], a[128:135], v2
    v_smfmac_f32_16x16x64_bf16 v[64:67], v[40:43], a[208:215], v2
    v_smfmac_f32_16x16x64_bf16 v[68:71], v[40:43], v[208:215], v2
    v_smfmac_f32_16x16x64_bf16 v[56:59], v[44:47], a[56:63], v2
    v_smfmac_f32_16x16x64_bf16 v[60:63], v[44:47], a[136:143], v2
    v_smfmac_f32_16x16x64_bf16 v[64:67], v[44:47], a[216:223], v2
    v_smfmac_f32_16x16x64_bf16 v[68:71], v[44:47], v[216:223], v2
    s_waitcnt lgkmcnt(7)
    v_smfmac_f32_16x16x64_bf16 v[56:59], v[16:19], a[0:7], v2
    v_smfmac_f32_16x16x64_bf16 v[60:63], v[16:19], a[80:87], v2
    v_smfmac_f32_16x16x64_bf16 v[64:67], v[16:19], a[160:167], v2
    v_smfmac_f32_16x16x64_bf16 v[68:71], v[16:19], a[240:247], v2
    s_waitcnt lgkmcnt(6)
    v_smfmac_f32_16x16x64_bf16 v[56:59], v[20:23], a[8:15], v2
    v_smfmac_f32_16x16x64_bf16 v[60:63], v[20:23], a[88:95], v2
    v_smfmac_f32_16x16x64_bf16 v[64:67], v[20:23], a[168:175], v2
    v_smfmac_f32_16x16x64_bf16 v[68:71], v[20:23], a[248:255], v2
    s_waitcnt lgkmcnt(5)
    v_smfmac_f32_16x16x64_bf16 v[56:59], v[24:27], a[16:23], v2
    v_smfmac_f32_16x16x64_bf16 v[60:63], v[24:27], a[96:103], v2
    v_smfmac_f32_16x16x64_bf16 v[64:67], v[24:27], a[176:183], v2
    v_smfmac_f32_16x16x64_bf16 v[68:71], v[24:27], v[176:183], v2
    s_waitcnt lgkmcnt(4)
    v_smfmac_f32_16x16x64_bf16 v[56:59], v[28:31], a[24:31], v2
    v_smfmac_f32_16x16x64_bf16 v[60:63], v[28:31], a[104:111], v2
    v_smfmac_f32_16x16x64_bf16 v[64:67], v[28:31], a[184:191], v2
    v_smfmac_f32_16x16x64_bf16 v[68:71], v[28:31], v[184:191], v2
    s_waitcnt lgkmcnt(3)
    v_smfmac_f32_16x16x64_bf16 v[56:59], v[32:35], a[32:39], v2
    v_smfmac_f32_16x16x64_bf16 v[60:63], v[32:35], a[112:119], v2
    v_smfmac_f32_16x16x64_bf16 v[64:67], v[32:35], a[192:199], v2
    v_smfmac_f32_16x16x64_bf16 v[68:71], v[32:35], v[192:199], v2
    s_waitcnt lgkmcnt(2)
    v_smfmac_f32_16x16x64_bf16 v[56:59], v[36:39], a[40:47], v2
    v_smfmac_f32_16x16x64_bf16 v[60:63], v[36:39], a[120:127], v2
    v_smfmac_f32_16x16x64_bf16 v[64:67], v[36:39], a[200:207], v2
    v_smfmac_f32_16x16x64_bf16 v[68:71], v[36:39], v[200:207], v2
    s_waitcnt lgkmcnt(1)
    v_smfmac_f32_16x16x64_bf16 v[56:59], v[48:51], a[64:71], v2
    v_smfmac_f32_16x16x64_bf16 v[60:63], v[48:51], a[144:151], v2
    v_smfmac_f32_16x16x64_bf16 v[64:67], v[48:51], a[224:231], v2
    v_smfmac_f32_16x16x64_bf16 v[68:71], v[48:51], v[224:231], v2
    s_waitcnt lgkmcnt(0)
    v_smfmac_f32_16x16x64_bf16 v[56:59], v[52:55], a[72:79], v2
    v_smfmac_f32_16x16x64_bf16 v[60:63], v[52:55], a[152:159], v2
    v_smfmac_f32_16x16x64_bf16 v[64:67], v[52:55], a[232:239], v2
    v_smfmac_f32_16x16x64_bf16 v[68:71], v[52:55], v[232:239], v2
    s_nop 7
    v_permlane32_swap_b32 v56, v64
    v_permlane32_swap_b32 v60, v68
    v_permlane32_swap_b32 v57, v65
    v_permlane32_swap_b32 v61, v69
    v_permlane32_swap_b32 v58, v66
    v_permlane32_swap_b32 v62, v70
    v_permlane32_swap_b32 v59, v67
    v_permlane32_swap_b32 v63, v71
    v_add_f32 v56, v56, v64
    v_add_f32 v60, v60, v68
    v_add_f32 v57, v57, v65
    v_add_f32 v61, v61, v69
    v_add_f32 v58, v58, v66
    v_add_f32 v62, v62, v70
    v_add_f32 v59, v59, v67
    v_add_f32 v63, v63, v71
    s_nop 1
    v_permlane16_swap_b32 v56, v60
    v_permlane16_swap_b32 v57, v61
    v_permlane16_swap_b32 v58, v62
    v_permlane16_swap_b32 v59, v63
    s_nop 1
    v_cvt_pk_bf16_f32 v72, v56, v57
    v_cvt_pk_bf16_f32 v73, v58, v59
    v_cvt_pk_bf16_f32 v74, v60, v61
    v_cvt_pk_bf16_f32 v75, v62, v63
    buffer_store_dwordx4 v[72:75], v4, s[8:11], s28 offen sc1
    s_cmp_eq_u32 s14, 63
    s_cbranch_scc1 layerb1_kernel_y2_last
    s_add_u32 s30, s18, 0
    s_add_u32 s31, s18, 4096
    s_add_u32 s32, s18, 16384
    s_add_u32 s33, s18, 20480
    s_add_u32 s34, s18, 32768
    s_add_u32 s29, s14, 1
    s_cmp_lt_u32 s29, 32
    s_cselect_b32 s19, s16, s17
    s_and_b32 s20, s29, 31
    s_lshl_b32 s20, s20, 16
    s_add_u32 s19, s19, s20
    s_barrier
    buffer_load_dwordx4 v[92:95], v5, s[8:11], s30 offen sc1
    buffer_load_dwordx4 v[96:99], v5, s[8:11], s31 offen sc1
    buffer_load_dwordx4 v[100:103], v5, s[8:11], s32 offen sc1
    buffer_load_dwordx4 v[104:107], v5, s[8:11], s33 offen sc1
    buffer_load_dwordx4 v[108:111], v5, s[8:11], s34 offen sc1
    s_waitcnt vmcnt(0)
    v_mfma_f32_16x16x32_bf16 v[112:115], v[92:95], v[72:75], 0
    v_mfma_f32_16x16x32_bf16 v[112:115], v[96:99], v[76:79], v[112:115]
    v_mfma_f32_16x16x32_bf16 v[112:115], v[100:103], v[80:83], v[112:115]
    v_mfma_f32_16x16x32_bf16 v[112:115], v[104:107], v[84:87], v[112:115]
    v_mfma_f32_16x16x32_bf16 v[112:115], v[108:111], v[88:91], v[112:115]
    v_max3_u32 v116, v92, v93, v94
    v_max3_u32 v116, v116, v95, v96
    v_max3_u32 v116, v116, v97, v98
    v_max3_u32 v116, v116, v99, v100
    v_max3_u32 v116, v116, v101, v102
    v_max3_u32 v116, v116, v103, v104
    v_max3_u32 v116, v116, v105, v106
    v_max3_u32 v116, v116, v107, v108
    v_max3_u32 v116, v116, v109, v110
    v_max_u32 v116, v116, v111
    v_cmp_eq_u32 vcc, -1, v116
    s_cbranch_vccz layerb1_kernel_y2_ppz
layerb1_kernel_y2_ppoll:
    buffer_load_dwordx4 v[92:95], v5, s[8:11], s30 offen sc1
    buffer_load_dwordx4 v[96:99], v5, s[8:11], s31 offen sc1
    buffer_load_dwordx4 v[100:103], v5, s[8:11], s32 offen sc1
    buffer_load_dwordx4 v[104:107], v5, s[8:11], s33 offen sc1
    buffer_load_dwordx4 v[108:111], v5, s[8:11], s34 offen sc1
    s_waitcnt vmcnt(0)
    v_mfma_f32_16x16x32_bf16 v[112:115], v[92:95], v[72:75], 0
    v_mfma_f32_16x16x32_bf16 v[112:115], v[96:99], v[76:79], v[112:115]
    v_mfma_f32_16x16x32_bf16 v[112:115], v[100:103], v[80:83], v[112:115]
    v_mfma_f32_16x16x32_bf16 v[112:115], v[104:107], v[84:87], v[112:115]
    v_mfma_f32_16x16x32_bf16 v[112:115], v[108:111], v[88:91], v[112:115]
    v_max3_u32 v116, v92, v93, v94
    v_max3_u32 v116, v116, v95, v96
    v_max3_u32 v116, v116, v97, v98
    v_max3_u32 v116, v116, v99, v100
    v_max3_u32 v116, v116, v101, v102
    v_max3_u32 v116, v116, v103, v104
    v_max3_u32 v116, v116, v105, v106
    v_max3_u32 v116, v116, v107, v108
    v_max3_u32 v116, v116, v109, v110
    v_max_u32 v116, v116, v111
    v_cmp_eq_u32 vcc, -1, v116
    s_sub_u32 s15, s15, 1
    s_cbranch_scc1 layerb1_kernel_bail
    s_cbranch_vccnz layerb1_kernel_y2_ppoll
layerb1_kernel_y2_ppz:
    ds_write_b128 v6, v[112:115]
    s_waitcnt lgkmcnt(0)
    s_barrier
    s_barrier
    s_add_u32 s14, s14, 1
    s_branch layerb1_kernel_y2_step
layerb1_kernel_y2_last:
    s_waitcnt vmcnt(0)
    s_barrier
    s_branch layerb1_kernel_end
layerb1_kernel_y3_start:
    v_lshrrev_b32 v16, 4, v0
    v_and_b32 v17, 7, v0
    v_lshrrev_b32 v18, 3, v0
    v_and_b32 v18, 1, v18
    v_lshl_add_u32 v19, v18, 2, v16
    v_add_u32 v19, 24, v19
    v_mul_u32_u24 v20, 640, v19
    v_lshl_add_u32 v4, v17, 4, v20
    v_and_b32 v20, 1, v17
    v_lshlrev_b32 v20, 2, v20
    v_lshrrev_b32 v21, 1, v17
    v_add_u32 v20, v20, v21
    v_lshlrev_b32 v20, 4, v20
    v_lshl_add_u32 v5, v19, 7, v20
    v_add_u32 v3, 0, v1
    v_lshrrev_b32 v20, 1, v17
    v_lshlrev_b32 v20, 7, v20
    v_and_b32 v21, 1, v17
    v_lshl_add_u32 v20, v21, 2, v20
    v_add_u32 v10, 1536, v20
    v_and_b32 v10, 31, v0
    v_lshlrev_b32 v10, 2, v10
    v_lshlrev_b32 v20, 8, v18
    v_lshl_add_u32 v20, v17, 5, v20
    v_and_b32 v21, 1, v16
    v_lshl_add_u32 v20, v21, 4, v20
    v_add_u32 v20, 11776, v20
    v_add_u32 v21, 12288, v1
    v_lshrrev_b32 v22, 1, v16
    v_cmp_eq_u32 vcc, v22, v18
    s_nop 1
    v_cndmask_b32 v6, v21, v20, vcc
    v_lshrrev_b32 v20, 3, v0
    v_lshlrev_b32 v20, 2, v20
    v_lshl_add_u32 v20, v17, 5, v20
    v_add_u32 v7, 10240, v20
    s_lshl_b32 s20, s12, 7
    s_add_u32 s20, s20, 20480
    s_lshr_b32 s21, s20, 13
    s_lshl_b32 s21, s21, 14
    s_and_b32 s20, s20, 8191
    s_add_u32 s20, s20, s21
    v_lshrrev_b32 v20, 3, v0
    v_lshlrev_b32 v20, 4, v20
    v_add_u32 v8, s20, v20
    s_mul_i32 s46, s12, 20480
    s_add_u32 s46, s46, 103809024
    s_mul_i32 s20, s12, 327680
    s_add_u32 s20, s20, 27508736
    s_add_u32 s21, s20, 65536
    buffer_load_dwordx4 v[176:179], v1, s[8:11], s21 offen offset:0
    buffer_load_dwordx4 v[180:183], v1, s[8:11], s21 offen offset:1024
    s_add_u32 s21, s20, 67584
    buffer_load_dwordx4 v[184:187], v1, s[8:11], s21 offen offset:0
    buffer_load_dwordx4 v[188:191], v1, s[8:11], s21 offen offset:1024
    s_add_u32 s21, s20, 69632
    buffer_load_dwordx4 v[192:195], v1, s[8:11], s21 offen offset:0
    buffer_load_dwordx4 v[196:199], v1, s[8:11], s21 offen offset:1024
    s_add_u32 s21, s20, 71680
    buffer_load_dwordx4 v[200:203], v1, s[8:11], s21 offen offset:0
    buffer_load_dwordx4 v[204:207], v1, s[8:11], s21 offen offset:1024
    s_add_u32 s21, s20, 73728
    buffer_load_dwordx4 v[208:211], v1, s[8:11], s21 offen offset:0
    buffer_load_dwordx4 v[212:215], v1, s[8:11], s21 offen offset:1024
    s_add_u32 s21, s20, 75776
    buffer_load_dwordx4 v[216:219], v1, s[8:11], s21 offen offset:0
    buffer_load_dwordx4 v[220:223], v1, s[8:11], s21 offen offset:1024
    s_add_u32 s21, s20, 77824
    buffer_load_dwordx4 v[224:227], v1, s[8:11], s21 offen offset:0
    buffer_load_dwordx4 v[228:231], v1, s[8:11], s21 offen offset:1024
    s_add_u32 s21, s20, 79872
    buffer_load_dwordx4 v[232:235], v1, s[8:11], s21 offen offset:0
    buffer_load_dwordx4 v[236:239], v1, s[8:11], s21 offen offset:1024
    s_add_u32 s20, s48, 51200
    s_mov_b64 exec, 3
    v_lshlrev_b32 v16, 2, v0
layerb1_kernel_y3_par:
    buffer_load_dword v17, v16, s[8:11], s20 offen sc1
    s_waitcnt vmcnt(0)
    v_cmp_eq_u32 vcc, 0, v17
    s_sub_u32 s15, s15, 1
    s_cbranch_scc1 layerb1_kernel_bail
    s_cbranch_vccnz layerb1_kernel_y3_par
    s_mov_b64 exec, -1
    v_readlane_b32 s20, v17, 0
    v_readlane_b32 s21, v17, 1
    s_nop 0
    s_and_b32 s20, s20, 8192
    s_and_b32 s21, s21, 8192
    s_add_u32 s16, s16, s20
    s_add_u32 s17, s17, s21
    s_mov_b32 s14, 0
    s_lshl_b32 s20, s12, 7
    v_mov_b32 v9, s20
    s_mov_b32 s47, 0
layerb1_kernel_y3_step:
    s_cmp_lt_u32 s14, 32
    s_cselect_b32 s18, s16, s17
    s_and_b32 s20, s14, 31
    s_lshl_b32 s20, s20, 16
    s_add_u32 s18, s18, s20
    s_mul_i32 s28, s14, 1638400
    s_add_u32 s28, s28, s46
    v_mov_b32 v56, 0
    v_mov_b32 v57, 0
    v_mov_b32 v58, 0
    v_mov_b32 v59, 0
    v_mov_b32 v60, 0
    v_mov_b32 v61, 0
    v_mov_b32 v62, 0
    v_mov_b32 v63, 0
    v_mov_b32 v64, 0
    v_mov_b32 v65, 0
    v_mov_b32 v66, 0
    v_mov_b32 v67, 0
    v_mov_b32 v68, 0
    v_mov_b32 v69, 0
    v_mov_b32 v70, 0
    v_mov_b32 v71, 0
    s_add_u32 s22, s18, 53248
    s_add_u32 s23, s18, 54272
layerb1_kernel_y3_poll:
    buffer_load_dwordx4 v[48:51], v1, s[8:11], s22 offen sc1
    buffer_load_dwordx4 v[52:55], v1, s[8:11], s23 offen sc1
    s_waitcnt vmcnt(0)
    ds_write_b128 v3, v[48:51] offset:8192
    ds_write_b128 v3, v[52:55] offset:9216
    v_max3_u32 v116, v48, v49, v50
    v_max3_u32 v116, v116, v51, v52
    v_max3_u32 v116, v116, v53, v54
    v_max_u32 v116, v116, v55
    v_cmp_eq_u32 vcc, -1, v116
    s_sub_u32 s15, s15, 1
    s_cbranch_scc1 layerb1_kernel_bail
    s_cbranch_vccnz layerb1_kernel_y3_poll
    s_waitcnt lgkmcnt(0)
    s_barrier
    ds_read_b128 v[16:19], v3 offset:0
    ds_read_b128 v[20:23], v3 offset:1024
    ds_read_b128 v[24:27], v3 offset:2048
    ds_read_b128 v[28:31], v3 offset:3072
    ds_read_b128 v[32:35], v3 offset:4096
    ds_read_b128 v[36:39], v3 offset:5120
    ds_read_b128 v[40:43], v3 offset:6144
    ds_read_b128 v[44:47], v3 offset:7168
    s_cmp_gt_u32 s47, s14
    s_cbranch_scc1 layerb1_kernel_y3_gw_ok
layerb1_kernel_y3_gw_lp:
    buffer_load_dword v116, v9, s[8:11], s48 offen sc1
    s_waitcnt vmcnt(0)
    v_readlane_b32 s47, v116, 0
    s_nop 0
    s_sub_u32 s15, s15, 1
    s_cbranch_scc1 layerb1_kernel_bail
    s_cmp_gt_u32 s47, s14
    s_cbranch_scc0 layerb1_kernel_y3_gw_lp
layerb1_kernel_y3_gw_ok:
    buffer_load_dwordx4 v[76:79], v4, s[8:11], s28 offen offset:128 sc1
    buffer_load_dwordx4 v[80:83], v4, s[8:11], s28 offen offset:256 sc1
    buffer_load_dwordx4 v[84:87], v4, s[8:11], s28 offen offset:384 sc1
    buffer_load_dwordx4 v[88:91], v4, s[8:11], s28 offen offset:512 sc1
    v_smfmac_f32_16x16x64_bf16 v[56:59], v[48:51], a[64:71], v2
    v_smfmac_f32_16x16x64_bf16 v[60:63], v[48:51], a[144:151], v2
    v_smfmac_f32_16x16x64_bf16 v[64:67], v[48:51], a[224:231], v2
    v_smfmac_f32_16x16x64_bf16 v[68:71], v[48:51], v[224:231], v2
    v_smfmac_f32_16x16x64_bf16 v[56:59], v[52:55], a[72:79], v2
    v_smfmac_f32_16x16x64_bf16 v[60:63], v[52:55], a[152:159], v2
    v_smfmac_f32_16x16x64_bf16 v[64:67], v[52:55], a[232:239], v2
    v_smfmac_f32_16x16x64_bf16 v[68:71], v[52:55], v[232:239], v2
    s_waitcnt lgkmcnt(7)
    v_smfmac_f32_16x16x64_bf16 v[56:59], v[16:19], a[0:7], v2
    v_smfmac_f32_16x16x64_bf16 v[60:63], v[16:19], a[80:87], v2
    v_smfmac_f32_16x16x64_bf16 v[64:67], v[16:19], a[160:167], v2
    v_smfmac_f32_16x16x64_bf16 v[68:71], v[16:19], a[240:247], v2
    s_waitcnt lgkmcnt(6)
    v_smfmac_f32_16x16x64_bf16 v[56:59], v[20:23], a[8:15], v2
    v_smfmac_f32_16x16x64_bf16 v[60:63], v[20:23], a[88:95], v2
    v_smfmac_f32_16x16x64_bf16 v[64:67], v[20:23], a[168:175], v2
    v_smfmac_f32_16x16x64_bf16 v[68:71], v[20:23], a[248:255], v2
    s_waitcnt lgkmcnt(5)
    v_smfmac_f32_16x16x64_bf16 v[56:59], v[24:27], a[16:23], v2
    v_smfmac_f32_16x16x64_bf16 v[60:63], v[24:27], a[96:103], v2
    v_smfmac_f32_16x16x64_bf16 v[64:67], v[24:27], a[176:183], v2
    v_smfmac_f32_16x16x64_bf16 v[68:71], v[24:27], v[176:183], v2
    s_waitcnt lgkmcnt(4)
    v_smfmac_f32_16x16x64_bf16 v[56:59], v[28:31], a[24:31], v2
    v_smfmac_f32_16x16x64_bf16 v[60:63], v[28:31], a[104:111], v2
    v_smfmac_f32_16x16x64_bf16 v[64:67], v[28:31], a[184:191], v2
    v_smfmac_f32_16x16x64_bf16 v[68:71], v[28:31], v[184:191], v2
    s_waitcnt lgkmcnt(3)
    v_smfmac_f32_16x16x64_bf16 v[56:59], v[32:35], a[32:39], v2
    v_smfmac_f32_16x16x64_bf16 v[60:63], v[32:35], a[112:119], v2
    v_smfmac_f32_16x16x64_bf16 v[64:67], v[32:35], a[192:199], v2
    v_smfmac_f32_16x16x64_bf16 v[68:71], v[32:35], v[192:199], v2
    s_waitcnt lgkmcnt(2)
    v_smfmac_f32_16x16x64_bf16 v[56:59], v[36:39], a[40:47], v2
    v_smfmac_f32_16x16x64_bf16 v[60:63], v[36:39], a[120:127], v2
    v_smfmac_f32_16x16x64_bf16 v[64:67], v[36:39], a[200:207], v2
    v_smfmac_f32_16x16x64_bf16 v[68:71], v[36:39], v[200:207], v2
    s_waitcnt lgkmcnt(1)
    v_smfmac_f32_16x16x64_bf16 v[56:59], v[40:43], a[48:55], v2
    v_smfmac_f32_16x16x64_bf16 v[60:63], v[40:43], a[128:135], v2
    v_smfmac_f32_16x16x64_bf16 v[64:67], v[40:43], a[208:215], v2
    v_smfmac_f32_16x16x64_bf16 v[68:71], v[40:43], v[208:215], v2
    s_waitcnt lgkmcnt(0)
    v_smfmac_f32_16x16x64_bf16 v[56:59], v[44:47], a[56:63], v2
    v_smfmac_f32_16x16x64_bf16 v[60:63], v[44:47], a[136:143], v2
    v_smfmac_f32_16x16x64_bf16 v[64:67], v[44:47], a[216:223], v2
    v_smfmac_f32_16x16x64_bf16 v[68:71], v[44:47], v[216:223], v2
    s_nop 7
    v_permlane32_swap_b32 v56, v64
    v_permlane32_swap_b32 v60, v68
    v_permlane32_swap_b32 v57, v65
    v_permlane32_swap_b32 v61, v69
    v_permlane32_swap_b32 v58, v66
    v_permlane32_swap_b32 v62, v70
    v_permlane32_swap_b32 v59, v67
    v_permlane32_swap_b32 v63, v71
    v_add_f32 v56, v56, v64
    v_add_f32 v60, v60, v68
    v_add_f32 v57, v57, v65
    v_add_f32 v61, v61, v69
    v_add_f32 v58, v58, v66
    v_add_f32 v62, v62, v70
    v_add_f32 v59, v59, v67
    v_add_f32 v63, v63, v71
    s_nop 1
    v_permlane16_swap_b32 v56, v60
    v_permlane16_swap_b32 v57, v61
    v_permlane16_swap_b32 v58, v62
    v_permlane16_swap_b32 v59, v63
    s_nop 1
    v_cvt_pk_bf16_f32 v72, v56, v57
    v_cvt_pk_bf16_f32 v73, v58, v59
    v_cvt_pk_bf16_f32 v74, v60, v61
    v_cvt_pk_bf16_f32 v75, v62, v63
    buffer_store_dwordx4 v[72:75], v4, s[8:11], s28 offen sc1
    s_cmp_eq_u32 s14, 63
    s_cbranch_scc1 layerb1_kernel_y3_last
    s_add_u32 s30, s18, 0
    s_add_u32 s31, s18, 4096
    s_add_u32 s32, s18, 16384
    s_add_u32 s33, s18, 20480
    s_add_u32 s34, s18, 32768
    s_add_u32 s29, s14, 1
    s_cmp_lt_u32 s29, 32
    s_cselect_b32 s19, s16, s17
    s_and_b32 s20, s29, 31
    s_lshl_b32 s20, s20, 16
    s_add_u32 s19, s19, s20
    s_barrier
    buffer_load_dwordx4 v[92:95], v5, s[8:11], s30 offen sc1
    buffer_load_dwordx4 v[96:99], v5, s[8:11], s31 offen sc1
    buffer_load_dwordx4 v[100:103], v5, s[8:11], s32 offen sc1
    buffer_load_dwordx4 v[104:107], v5, s[8:11], s33 offen sc1
    buffer_load_dwordx4 v[108:111], v5, s[8:11], s34 offen sc1
    s_waitcnt vmcnt(0)
    v_mfma_f32_16x16x32_bf16 v[112:115], v[92:95], v[72:75], 0
    v_mfma_f32_16x16x32_bf16 v[112:115], v[96:99], v[76:79], v[112:115]
    v_mfma_f32_16x16x32_bf16 v[112:115], v[100:103], v[80:83], v[112:115]
    v_mfma_f32_16x16x32_bf16 v[112:115], v[104:107], v[84:87], v[112:115]
    v_mfma_f32_16x16x32_bf16 v[112:115], v[108:111], v[88:91], v[112:115]
    v_max3_u32 v116, v92, v93, v94
    v_max3_u32 v116, v116, v95, v96
    v_max3_u32 v116, v116, v97, v98
    v_max3_u32 v116, v116, v99, v100
    v_max3_u32 v116, v116, v101, v102
    v_max3_u32 v116, v116, v103, v104
    v_max3_u32 v116, v116, v105, v106
    v_max3_u32 v116, v116, v107, v108
    v_max3_u32 v116, v116, v109, v110
    v_max_u32 v116, v116, v111
    v_cmp_eq_u32 vcc, -1, v116
    s_cbranch_vccz layerb1_kernel_y3_ppz
layerb1_kernel_y3_ppoll:
    buffer_load_dwordx4 v[92:95], v5, s[8:11], s30 offen sc1
    buffer_load_dwordx4 v[96:99], v5, s[8:11], s31 offen sc1
    buffer_load_dwordx4 v[100:103], v5, s[8:11], s32 offen sc1
    buffer_load_dwordx4 v[104:107], v5, s[8:11], s33 offen sc1
    buffer_load_dwordx4 v[108:111], v5, s[8:11], s34 offen sc1
    s_waitcnt vmcnt(0)
    v_mfma_f32_16x16x32_bf16 v[112:115], v[92:95], v[72:75], 0
    v_mfma_f32_16x16x32_bf16 v[112:115], v[96:99], v[76:79], v[112:115]
    v_mfma_f32_16x16x32_bf16 v[112:115], v[100:103], v[80:83], v[112:115]
    v_mfma_f32_16x16x32_bf16 v[112:115], v[104:107], v[84:87], v[112:115]
    v_mfma_f32_16x16x32_bf16 v[112:115], v[108:111], v[88:91], v[112:115]
    v_max3_u32 v116, v92, v93, v94
    v_max3_u32 v116, v116, v95, v96
    v_max3_u32 v116, v116, v97, v98
    v_max3_u32 v116, v116, v99, v100
    v_max3_u32 v116, v116, v101, v102
    v_max3_u32 v116, v116, v103, v104
    v_max3_u32 v116, v116, v105, v106
    v_max3_u32 v116, v116, v107, v108
    v_max3_u32 v116, v116, v109, v110
    v_max_u32 v116, v116, v111
    v_cmp_eq_u32 vcc, -1, v116
    s_sub_u32 s15, s15, 1
    s_cbranch_scc1 layerb1_kernel_bail
    s_cbranch_vccnz layerb1_kernel_y3_ppoll
layerb1_kernel_y3_ppz:
    ds_write_b128 v6, v[112:115]
    s_waitcnt lgkmcnt(0)
    s_barrier
    s_barrier
    s_add_u32 s14, s14, 1
    s_branch layerb1_kernel_y3_step
layerb1_kernel_y3_last:
    s_waitcnt vmcnt(0)
    s_barrier
    s_branch layerb1_kernel_end
layerb1_kernel_proj:
    s_sub_u32 s22, s20, 4
    s_lshl_b32 s22, s22, 5
    s_add_u32 s12, s22, s21
    s_mov_b32 s14, 0
    s_mov_b32 s15, 64
    v_lshlrev_b32 v1, 4, v0
    v_and_b32 v8, 31, v0
    v_lshrrev_b32 v9, 5, v0
    s_cmp_ge_u32 s12, 80
    s_cbranch_scc1 layerb1_kernel_g_qk
    v_lshrrev_b32 v10, 3, v8
    v_and_b32 v11, 7, v8
    v_mul_u32_u24 v12, 20480, v10
    v_lshl_add_u32 v12, v11, 4, v12
    v_lshl_add_u32 v4, v9, 8, v12
    s_mul_i32 s24, s12, 327680
    s_mul_i32 s25, s13, 81920
    s_add_u32 s24, s24, s25
    s_add_u32 s24, s24, 27262976
    s_add_u32 s24, s24, 3584
    s_add_u32 s24, s24, 3584
    s_add_u32 s24, s24, 3584
    s_add_u32 s24, s24, 3584
    buffer_load_dwordx4 v[192:195], v4, s[8:11], s24 offen offset:2048
    buffer_load_dwordx4 v[196:199], v4, s[8:11], s24 offen offset:2176
    buffer_load_dwordx4 v[200:203], v4, s[8:11], s24 offen offset:2560
    buffer_load_dwordx4 v[204:207], v4, s[8:11], s24 offen offset:2688
    buffer_load_dwordx4 v[208:211], v4, s[8:11], s24 offen offset:3072
    buffer_load_dwordx4 v[212:215], v4, s[8:11], s24 offen offset:3200
    s_add_u32 s24, s24, 3584
    buffer_load_dwordx4 v[216:219], v4, s[8:11], s24 offen offset:0
    buffer_load_dwordx4 v[220:223], v4, s[8:11], s24 offen offset:128
    buffer_load_dwordx4 v[224:227], v4, s[8:11], s24 offen offset:512
    buffer_load_dwordx4 v[228:231], v4, s[8:11], s24 offen offset:640
    buffer_load_dwordx4 v[232:235], v4, s[8:11], s24 offen offset:1024
    buffer_load_dwordx4 v[236:239], v4, s[8:11], s24 offen offset:1152
    buffer_load_dwordx4 v[240:243], v4, s[8:11], s24 offen offset:1536
    buffer_load_dwordx4 v[244:247], v4, s[8:11], s24 offen offset:1664
    buffer_load_dwordx4 v[248:251], v4, s[8:11], s24 offen offset:2048
    buffer_load_dwordx4 v[252:255], v4, s[8:11], s24 offen offset:2176
    s_lshl_b32 s25, s13, 3
    v_add_u32 v10, s25, v10
    v_mul_u32_u24 v10, 640, v10
    v_lshl_add_u32 v10, v9, 7, v10
    v_lshl_add_u32 v10, v11, 4, v10
    v_add_u32 v3, 128, v10
    s_mul_i32 s17, s12, 20480
    s_mul_i32 s25, s14, 1638400
    s_add_u32 s17, s17, s25
    s_add_u32 s17, s17, 103809024
    s_mov_b32 s20, 1638400
    s_mul_i32 s19, s13, 10240
    s_add_u32 s19, s19, 220200960
    s_mov_b32 s22, 0
    s_mov_b32 s56, 0
    s_mov_b32 s58, 400000
    s_add_u32 s57, s48, 45056
    s_cmp_lg_u32 s13, 0
    s_cbranch_scc1 layerb1_kernel_gu_lw1
    s_min_u32 s28, s14, 63
    s_cmp_gt_u32 s56, s28
    s_cbranch_scc1 layerb1_kernel_gu_lw1
layerb1_kernel_gu_lp1:
    buffer_load_dwordx4 v[124:127], v1, s[8:11], s57 offen sc1
    s_waitcnt vmcnt(0)
    v_min_u32 v124, v124, v125
    v_min_u32 v126, v126, v127
    v_min_u32 v124, v124, v126
    v_cmp_eq_u32 vcc, 0, v124
    s_nop 1
    s_ff1_i32_b64 s56, vcc
    s_min_u32 s56, s56, 64
    s_sub_u32 s58, s58, 1
    s_cbranch_scc1 layerb1_kernel_bail
    s_cmp_gt_u32 s56, s28
    s_cbranch_scc0 layerb1_kernel_gu_lp1
layerb1_kernel_gu_lw1:
    s_barrier
    s_min_u32 s24, s14, 63
    s_mul_i32 s24, s24, 40960
    s_add_u32 s24, s24, s19
    s_mul_i32 s25, s13, 10240
    s_add_u32 s25, s25, s22
    s_mov_b32 m0, s25
    s_nop 0
    buffer_load_dwordx4 v1, s[8:11], s24 offen offset:0 sc1 lds
    buffer_load_dwordx4 v1, s[8:11], s24 offen offset:1024 sc1 lds
    buffer_load_dwordx4 v1, s[8:11], s24 offen offset:2048 sc1 lds
    buffer_load_dwordx4 v1, s[8:11], s24 offen offset:3072 sc1 lds
    s_add_u32 s24, s24, 4096
    s_add_u32 s25, s25, 4096
    s_mov_b32 m0, s25
    s_nop 0
    buffer_load_dwordx4 v1, s[8:11], s24 offen offset:0 sc1 lds
    buffer_load_dwordx4 v1, s[8:11], s24 offen offset:1024 sc1 lds
    buffer_load_dwordx4 v1, s[8:11], s24 offen offset:2048 sc1 lds
    buffer_load_dwordx4 v1, s[8:11], s24 offen offset:3072 sc1 lds
    s_add_u32 s24, s24, 4096
    s_add_u32 s25, s25, 4096
    s_mov_b32 m0, s25
    s_nop 0
    buffer_load_dwordx4 v1, s[8:11], s24 offen offset:0 sc1 lds
    buffer_load_dwordx4 v1, s[8:11], s24 offen offset:1024 sc1 lds
    s_mov_b32 s22, 40960
    s_mov_b32 s16, 0
    s_waitcnt vmcnt(0)
    s_barrier
    v_mov_b32 v2, v1
    ds_read_b128 v[8:11], v2 offset:0
    ds_read_b128 v[12:15], v2 offset:1024
    ds_read_b128 v[16:19], v2 offset:2048
    ds_read_b128 v[20:23], v2 offset:3072
    ds_read_b128 v[24:27], v2 offset:4096
    ds_read_b128 v[28:31], v2 offset:5120
layerb1_kernel_gu_solo:
    ds_read_b128 v[32:35], v2 offset:6144
    s_waitcnt lgkmcnt(6)
    v_mfma_f32_32x32x16_bf16 v[40:55], v[8:11], a[0:3], 0
    v_mfma_f32_32x32x16_bf16 v[56:71], v[8:11], a[4:7], 0
    ds_read_b128 v[36:39], v2 offset:7168
    s_waitcnt lgkmcnt(6)
    v_mfma_f32_32x32x16_bf16 v[40:55], v[12:15], a[8:11], v[40:55]
    v_mfma_f32_32x32x16_bf16 v[56:71], v[12:15], a[12:15], v[56:71]
    ds_read_b128 v[8:11], v2 offset:8192
    s_waitcnt lgkmcnt(6)
    v_mfma_f32_32x32x16_bf16 v[40:55], v[16:19], a[16:19], v[40:55]
    v_mfma_f32_32x32x16_bf16 v[56:71], v[16:19], a[20:23], v[56:71]
    ds_read_b128 v[12:15], v2 offset:9216
    s_waitcnt lgkmcnt(6)
    v_mfma_f32_32x32x16_bf16 v[40:55], v[20:23], a[24:27], v[40:55]
    v_mfma_f32_32x32x16_bf16 v[56:71], v[20:23], a[28:31], v[56:71]
    ds_read_b128 v[16:19], v2 offset:10240
    s_waitcnt lgkmcnt(6)
    v_mfma_f32_32x32x16_bf16 v[40:55], v[24:27], a[32:35], v[40:55]
    v_mfma_f32_32x32x16_bf16 v[56:71], v[24:27], a[36:39], v[56:71]
    ds_read_b128 v[20:23], v2 offset:11264
    s_waitcnt lgkmcnt(6)
    v_mfma_f32_32x32x16_bf16 v[40:55], v[28:31], a[40:43], v[40:55]
    v_mfma_f32_32x32x16_bf16 v[56:71], v[28:31], a[44:47], v[56:71]
    ds_read_b128 v[24:27], v2 offset:12288
    s_waitcnt lgkmcnt(6)
    v_mfma_f32_32x32x16_bf16 v[40:55], v[32:35], a[48:51], v[40:55]
    v_mfma_f32_32x32x16_bf16 v[56:71], v[32:35], a[52:55], v[56:71]
    ds_read_b128 v[28:31], v2 offset:13312
    s_waitcnt lgkmcnt(6)
    v_mfma_f32_32x32x16_bf16 v[40:55], v[36:39], a[56:59], v[40:55]
    v_mfma_f32_32x32x16_bf16 v[56:71], v[36:39], a[60:63], v[56:71]
    ds_read_b128 v[32:35], v2 offset:14336
    s_waitcnt lgkmcnt(6)
    v_mfma_f32_32x32x16_bf16 v[40:55], v[8:11], a[64:67], v[40:55]
    v_mfma_f32_32x32x16_bf16 v[56:71], v[8:11], a[68:71], v[56:71]
    ds_read_b128 v[36:39], v2 offset:15360
    s_waitcnt lgkmcnt(6)
    v_mfma_f32_32x32x16_bf16 v[40:55], v[12:15], a[72:75], v[40:55]
    v_mfma_f32_32x32x16_bf16 v[56:71], v[12:15], a[76:79], v[56:71]
    ds_read_b128 v[8:11], v2 offset:16384
    s_waitcnt lgkmcnt(6)
    v_mfma_f32_32x32x16_bf16 v[40:55], v[16:19], a[80:83], v[40:55]
    v_mfma_f32_32x32x16_bf16 v[56:71], v[16:19], a[84:87], v[56:71]
    ds_read_b128 v[12:15], v2 offset:17408
    s_waitcnt lgkmcnt(6)
    v_mfma_f32_32x32x16_bf16 v[40:55], v[20:23], a[88:91], v[40:55]
    v_mfma_f32_32x32x16_bf16 v[56:71], v[20:23], a[92:95], v[56:71]
    ds_read_b128 v[16:19], v2 offset:18432
    s_waitcnt lgkmcnt(6)
    v_mfma_f32_32x32x16_bf16 v[40:55], v[24:27], a[96:99], v[40:55]
    v_mfma_f32_32x32x16_bf16 v[56:71], v[24:27], a[100:103], v[56:71]
    ds_read_b128 v[20:23], v2 offset:19456
    s_waitcnt lgkmcnt(6)
    v_mfma_f32_32x32x16_bf16 v[40:55], v[28:31], a[104:107], v[40:55]
    v_mfma_f32_32x32x16_bf16 v[56:71], v[28:31], a[108:111], v[56:71]
    ds_read_b128 v[24:27], v2 offset:20480
    s_waitcnt lgkmcnt(6)
    v_mfma_f32_32x32x16_bf16 v[40:55], v[32:35], a[112:115], v[40:55]
    v_mfma_f32_32x32x16_bf16 v[56:71], v[32:35], a[116:119], v[56:71]
    ds_read_b128 v[28:31], v2 offset:21504
    s_waitcnt lgkmcnt(6)
    v_mfma_f32_32x32x16_bf16 v[40:55], v[36:39], a[120:123], v[40:55]
    v_mfma_f32_32x32x16_bf16 v[56:71], v[36:39], a[124:127], v[56:71]
    ds_read_b128 v[32:35], v2 offset:22528
    s_waitcnt lgkmcnt(6)
    v_mfma_f32_32x32x16_bf16 v[40:55], v[8:11], a[128:131], v[40:55]
    v_mfma_f32_32x32x16_bf16 v[56:71], v[8:11], a[132:135], v[56:71]
    ds_read_b128 v[36:39], v2 offset:23552
    s_waitcnt lgkmcnt(6)
    v_mfma_f32_32x32x16_bf16 v[40:55], v[12:15], a[136:139], v[40:55]
    v_mfma_f32_32x32x16_bf16 v[56:71], v[12:15], a[140:143], v[56:71]
    ds_read_b128 v[8:11], v2 offset:24576
    s_waitcnt lgkmcnt(6)
    v_mfma_f32_32x32x16_bf16 v[40:55], v[16:19], a[144:147], v[40:55]
    v_mfma_f32_32x32x16_bf16 v[56:71], v[16:19], a[148:151], v[56:71]
    ds_read_b128 v[12:15], v2 offset:25600
    s_waitcnt lgkmcnt(6)
    v_mfma_f32_32x32x16_bf16 v[40:55], v[20:23], a[152:155], v[40:55]
    v_mfma_f32_32x32x16_bf16 v[56:71], v[20:23], a[156:159], v[56:71]
    ds_read_b128 v[16:19], v2 offset:26624
    s_waitcnt lgkmcnt(6)
    v_mfma_f32_32x32x16_bf16 v[40:55], v[24:27], a[160:163], v[40:55]
    v_mfma_f32_32x32x16_bf16 v[56:71], v[24:27], a[164:167], v[56:71]
    ds_read_b128 v[20:23], v2 offset:27648
    s_waitcnt lgkmcnt(6)
    v_mfma_f32_32x32x16_bf16 v[40:55], v[28:31], a[168:171], v[40:55]
    v_mfma_f32_32x32x16_bf16 v[56:71], v[28:31], a[172:175], v[56:71]
    ds_read_b128 v[24:27], v2 offset:28672
    s_waitcnt lgkmcnt(6)
    v_mfma_f32_32x32x16_bf16 v[40:55], v[32:35], a[176:179], v[40:55]
    v_mfma_f32_32x32x16_bf16 v[56:71], v[32:35], a[180:183], v[56:71]
    ds_read_b128 v[28:31], v2 offset:29696
    s_waitcnt lgkmcnt(6)
    v_mfma_f32_32x32x16_bf16 v[40:55], v[36:39], a[184:187], v[40:55]
    v_mfma_f32_32x32x16_bf16 v[56:71], v[36:39], a[188:191], v[56:71]
    ds_read_b128 v[32:35], v2 offset:30720
    s_waitcnt lgkmcnt(6)
    v_mfma_f32_32x32x16_bf16 v[40:55], v[8:11], a[192:195], v[40:55]
    v_mfma_f32_32x32x16_bf16 v[56:71], v[8:11], a[196:199], v[56:71]
    ds_read_b128 v[36:39], v2 offset:31744
    s_waitcnt lgkmcnt(6)
    v_mfma_f32_32x32x16_bf16 v[40:55], v[12:15], a[200:203], v[40:55]
    v_mfma_f32_32x32x16_bf16 v[56:71], v[12:15], a[204:207], v[56:71]
    ds_read_b128 v[8:11], v2 offset:32768
    s_waitcnt lgkmcnt(6)
    v_mfma_f32_32x32x16_bf16 v[40:55], v[16:19], a[208:211], v[40:55]
    v_mfma_f32_32x32x16_bf16 v[56:71], v[16:19], a[212:215], v[56:71]
    ds_read_b128 v[12:15], v2 offset:33792
    s_waitcnt lgkmcnt(6)
    v_mfma_f32_32x32x16_bf16 v[40:55], v[20:23], a[216:219], v[40:55]
    v_mfma_f32_32x32x16_bf16 v[56:71], v[20:23], a[220:223], v[56:71]
    ds_read_b128 v[16:19], v2 offset:34816
    s_waitcnt lgkmcnt(6)
    v_mfma_f32_32x32x16_bf16 v[40:55], v[24:27], a[224:227], v[40:55]
    v_mfma_f32_32x32x16_bf16 v[56:71], v[24:27], a[228:231], v[56:71]
    ds_read_b128 v[20:23], v2 offset:35840
    s_waitcnt lgkmcnt(6)
    v_mfma_f32_32x32x16_bf16 v[40:55], v[28:31], a[232:235], v[40:55]
    v_mfma_f32_32x32x16_bf16 v[56:71], v[28:31], a[236:239], v[56:71]
    ds_read_b128 v[24:27], v2 offset:36864
    s_waitcnt lgkmcnt(6)
    buffer_load_dwordx4 v[124:127], v1, s[8:11], s57 offen sc1
    v_mfma_f32_32x32x16_bf16 v[40:55], v[32:35], a[240:243], v[40:55]
    v_mfma_f32_32x32x16_bf16 v[56:71], v[32:35], a[244:247], v[56:71]
    ds_read_b128 v[28:31], v2 offset:37888
    s_waitcnt lgkmcnt(6)
    v_mfma_f32_32x32x16_bf16 v[40:55], v[36:39], a[248:251], v[40:55]
    v_mfma_f32_32x32x16_bf16 v[56:71], v[36:39], a[252:255], v[56:71]
    ds_read_b128 v[32:35], v2 offset:38912
    s_waitcnt lgkmcnt(6)
    v_mfma_f32_32x32x16_bf16 v[40:55], v[8:11], v[192:195], v[40:55]
    v_mfma_f32_32x32x16_bf16 v[56:71], v[8:11], v[196:199], v[56:71]
    ds_read_b128 v[36:39], v2 offset:39936
    s_waitcnt lgkmcnt(6)
    v_mfma_f32_32x32x16_bf16 v[40:55], v[12:15], v[200:203], v[40:55]
    v_mfma_f32_32x32x16_bf16 v[56:71], v[12:15], v[204:207], v[56:71]
    s_waitcnt lgkmcnt(5)
    v_mfma_f32_32x32x16_bf16 v[40:55], v[16:19], v[208:211], v[40:55]
    v_mfma_f32_32x32x16_bf16 v[56:71], v[16:19], v[212:215], v[56:71]
    s_waitcnt lgkmcnt(4)
    v_mfma_f32_32x32x16_bf16 v[40:55], v[20:23], v[216:219], v[40:55]
    v_mfma_f32_32x32x16_bf16 v[56:71], v[20:23], v[220:223], v[56:71]
    s_waitcnt lgkmcnt(3)
    v_mfma_f32_32x32x16_bf16 v[40:55], v[24:27], v[224:227], v[40:55]
    v_mfma_f32_32x32x16_bf16 v[56:71], v[24:27], v[228:231], v[56:71]
    s_waitcnt lgkmcnt(2)
    v_mfma_f32_32x32x16_bf16 v[40:55], v[28:31], v[232:235], v[40:55]
    v_mfma_f32_32x32x16_bf16 v[56:71], v[28:31], v[236:239], v[56:71]
    s_waitcnt lgkmcnt(1)
    v_mfma_f32_32x32x16_bf16 v[40:55], v[32:35], v[240:243], v[40:55]
    v_mfma_f32_32x32x16_bf16 v[56:71], v[32:35], v[244:247], v[56:71]
    s_waitcnt lgkmcnt(0)
    v_mfma_f32_32x32x16_bf16 v[40:55], v[36:39], v[248:251], v[40:55]
    v_mfma_f32_32x32x16_bf16 v[56:71], v[36:39], v[252:255], v[56:71]
    s_add_u32 s14, s14, 1
    s_nop 7
    s_nop 7
    v_cvt_pk_bf16_f32 v104, v40, v41
    v_cvt_pk_bf16_f32 v105, v42, v43
    v_cvt_pk_bf16_f32 v106, v44, v45
    v_cvt_pk_bf16_f32 v107, v46, v47
    s_nop 1
    v_permlane32_swap_b32 v104, v106
    v_permlane32_swap_b32 v105, v107
    buffer_store_dwordx4 v[104:107], v3, s[8:11], s17 offen offset:0 sc1
    v_cvt_pk_bf16_f32 v108, v48, v49
    v_cvt_pk_bf16_f32 v109, v50, v51
    v_cvt_pk_bf16_f32 v110, v52, v53
    v_cvt_pk_bf16_f32 v111, v54, v55
    s_nop 1
    v_permlane32_swap_b32 v108, v110
    v_permlane32_swap_b32 v109, v111
    buffer_store_dwordx4 v[108:111], v3, s[8:11], s17 offen offset:256 sc1
    v_cvt_pk_bf16_f32 v112, v56, v57
    v_cvt_pk_bf16_f32 v113, v58, v59
    v_cvt_pk_bf16_f32 v114, v60, v61
    v_cvt_pk_bf16_f32 v115, v62, v63
    s_nop 1
    v_permlane32_swap_b32 v112, v114
    v_permlane32_swap_b32 v113, v115
    buffer_store_dwordx4 v[112:115], v3, s[8:11], s17 offen offset:2560 sc1
    v_cvt_pk_bf16_f32 v116, v64, v65
    v_cvt_pk_bf16_f32 v117, v66, v67
    v_cvt_pk_bf16_f32 v118, v68, v69
    v_cvt_pk_bf16_f32 v119, v70, v71
    s_nop 1
    v_permlane32_swap_b32 v116, v118
    v_permlane32_swap_b32 v117, v119
    buffer_store_dwordx4 v[116:119], v3, s[8:11], s17 offen offset:2816 sc1
    s_add_u32 s17, s17, s20
    s_add_u32 s18, s18, s20
    s_waitcnt vmcnt(0)
    s_barrier
    s_cmp_lg_u32 s13, 0
    s_cbranch_scc1 layerb1_kernel_gu_fl2
    s_mov_b64 exec, 1
    s_lshl_b32 s26, s12, 7
    v_mov_b32 v7, s26
    v_mov_b32 v120, s14
    buffer_store_dword v120, v7, s[8:11], s48 offen sc1
    s_mov_b64 exec, -1
layerb1_kernel_gu_fl2:
layerb1_kernel_gu_spoll:
    v_min_u32 v124, v124, v125
    v_min_u32 v126, v126, v127
    v_min_u32 v124, v124, v126
    v_cmp_eq_u32 vcc, 0, v124
    s_nop 1
    s_ff1_i32_b64 s56, vcc
    s_min_u32 s56, s56, 64
    s_cmp_gt_u32 s56, s14
    s_cbranch_scc1 layerb1_kernel_gu_sok
    s_sub_u32 s58, s58, 1
    s_cbranch_scc1 layerb1_kernel_bail
    buffer_load_dwordx4 v[124:127], v1, s[8:11], s57 offen sc1
    s_waitcnt vmcnt(0)
    s_branch layerb1_kernel_gu_spoll
layerb1_kernel_gu_sok:
    s_min_u32 s24, s14, 63
    s_mul_i32 s24, s24, 40960
    s_add_u32 s24, s24, s19
    s_mul_i32 s25, s13, 10240
    s_add_u32 s25, s25, s22
    s_mov_b32 m0, s25
    s_nop 0
    buffer_load_dwordx4 v1, s[8:11], s24 offen offset:0 sc1 lds
    buffer_load_dwordx4 v1, s[8:11], s24 offen offset:1024 sc1 lds
    buffer_load_dwordx4 v1, s[8:11], s24 offen offset:2048 sc1 lds
    buffer_load_dwordx4 v1, s[8:11], s24 offen offset:3072 sc1 lds
    s_add_u32 s24, s24, 4096
    s_add_u32 s25, s25, 4096
    s_mov_b32 m0, s25
    s_nop 0
    buffer_load_dwordx4 v1, s[8:11], s24 offen offset:0 sc1 lds
    buffer_load_dwordx4 v1, s[8:11], s24 offen offset:1024 sc1 lds
    buffer_load_dwordx4 v1, s[8:11], s24 offen offset:2048 sc1 lds
    buffer_load_dwordx4 v1, s[8:11], s24 offen offset:3072 sc1 lds
    s_add_u32 s24, s24, 4096
    s_add_u32 s25, s25, 4096
    s_mov_b32 m0, s25
    s_nop 0
    buffer_load_dwordx4 v1, s[8:11], s24 offen offset:0 sc1 lds
    buffer_load_dwordx4 v1, s[8:11], s24 offen offset:1024 sc1 lds
    s_mov_b32 s16, s22
    s_add_u32 s22, s22, 40960
    s_cmp_eq_u32 s22, 122880
    s_cselect_b32 s22, 0, s22
    v_add_u32 v2, s16, v1
    s_waitcnt vmcnt(0)
    s_barrier
    ds_read_b128 v[8:11], v2 offset:0
    ds_read_b128 v[12:15], v2 offset:1024
    ds_read_b128 v[16:19], v2 offset:2048
    ds_read_b128 v[20:23], v2 offset:3072
    ds_read_b128 v[24:27], v2 offset:4096
    ds_read_b128 v[28:31], v2 offset:5120
    s_cmp_lt_u32 s14, 3
    s_cbranch_scc1 layerb1_kernel_gu_solo
    ds_read_b128 v[32:35], v2 offset:6144
    s_waitcnt lgkmcnt(6)
    v_mfma_f32_32x32x16_bf16 v[72:87], v[8:11], a[0:3], 0
    v_mfma_f32_32x32x16_bf16 v[88:103], v[8:11], a[4:7], 0
    ds_read_b128 v[36:39], v2 offset:7168
    s_waitcnt lgkmcnt(6)
    v_mfma_f32_32x32x16_bf16 v[72:87], v[12:15], a[8:11], v[72:87]
    v_mfma_f32_32x32x16_bf16 v[88:103], v[12:15], a[12:15], v[88:103]
    ds_read_b128 v[8:11], v2 offset:8192
    s_waitcnt lgkmcnt(6)
    v_mfma_f32_32x32x16_bf16 v[72:87], v[16:19], a[16:19], v[72:87]
    v_mfma_f32_32x32x16_bf16 v[88:103], v[16:19], a[20:23], v[88:103]
    s_add_u32 s23, s14, 1
    s_cmp_lg_u32 s13, 0
    s_cbranch_scc1 layerb1_kernel_gu_lw3
    s_min_u32 s28, s23, 63
    s_cmp_gt_u32 s56, s28
    s_cbranch_scc1 layerb1_kernel_gu_lw3
layerb1_kernel_gu_lp3:
    buffer_load_dwordx4 v[124:127], v1, s[8:11], s57 offen sc1
    s_waitcnt vmcnt(0)
    v_min_u32 v124, v124, v125
    v_min_u32 v126, v126, v127
    v_min_u32 v124, v124, v126
    v_cmp_eq_u32 vcc, 0, v124
    s_nop 1
    s_ff1_i32_b64 s56, vcc
    s_min_u32 s56, s56, 64
    s_sub_u32 s58, s58, 1
    s_cbranch_scc1 layerb1_kernel_bail
    s_cmp_gt_u32 s56, s28
    s_cbranch_scc0 layerb1_kernel_gu_lp3
layerb1_kernel_gu_lw3:
    s_barrier
    s_min_u32 s24, s23, 63
    s_mul_i32 s24, s24, 40960
    s_add_u32 s24, s24, s19
    s_mul_i32 s25, s13, 10240
    s_add_u32 s25, s25, s22
    s_add_u32 s22, s22, 40960
    s_cmp_eq_u32 s22, 122880
    s_cselect_b32 s22, 0, s22
    ds_read_b128 v[12:15], v2 offset:9216
    s_waitcnt lgkmcnt(6)
    v_mfma_f32_32x32x16_bf16 v[72:87], v[20:23], a[24:27], v[72:87]
    s_mov_b32 m0, s25
    s_nop 0
    buffer_load_dwordx4 v1, s[8:11], s24 offen offset:0 sc1 lds
    v_mfma_f32_32x32x16_bf16 v[88:103], v[20:23], a[28:31], v[88:103]
    ds_read_b128 v[16:19], v2 offset:10240
    s_waitcnt lgkmcnt(6)
    v_mfma_f32_32x32x16_bf16 v[72:87], v[24:27], a[32:35], v[72:87]
    buffer_load_dwordx4 v1, s[8:11], s24 offen offset:1024 sc1 lds
    v_mfma_f32_32x32x16_bf16 v[88:103], v[24:27], a[36:39], v[88:103]
    ds_read_b128 v[20:23], v2 offset:11264
    s_waitcnt lgkmcnt(6)
    v_mfma_f32_32x32x16_bf16 v[72:87], v[28:31], a[40:43], v[72:87]
    buffer_load_dwordx4 v1, s[8:11], s24 offen offset:2048 sc1 lds
    v_mfma_f32_32x32x16_bf16 v[88:103], v[28:31], a[44:47], v[88:103]
    ds_read_b128 v[24:27], v2 offset:12288
    s_waitcnt lgkmcnt(6)
    v_mfma_f32_32x32x16_bf16 v[72:87], v[32:35], a[48:51], v[72:87]
    buffer_load_dwordx4 v1, s[8:11], s24 offen offset:3072 sc1 lds
    v_mfma_f32_32x32x16_bf16 v[88:103], v[32:35], a[52:55], v[88:103]
    ds_read_b128 v[28:31], v2 offset:13312
    s_waitcnt lgkmcnt(6)
    v_mfma_f32_32x32x16_bf16 v[72:87], v[36:39], a[56:59], v[72:87]
    s_add_u32 s24, s24, 4096
    s_add_u32 s25, s25, 4096
    s_mov_b32 m0, s25
    s_nop 0
    buffer_load_dwordx4 v1, s[8:11], s24 offen offset:0 sc1 lds
    v_mfma_f32_32x32x16_bf16 v[88:103], v[36:39], a[60:63], v[88:103]
    ds_read_b128 v[32:35], v2 offset:14336
    s_waitcnt lgkmcnt(6)
    v_mfma_f32_32x32x16_bf16 v[72:87], v[8:11], a[64:67], v[72:87]
    buffer_load_dwordx4 v1, s[8:11], s24 offen offset:1024 sc1 lds
    v_mfma_f32_32x32x16_bf16 v[88:103], v[8:11], a[68:71], v[88:103]
    ds_read_b128 v[36:39], v2 offset:15360
    s_waitcnt lgkmcnt(6)
    v_mfma_f32_32x32x16_bf16 v[72:87], v[12:15], a[72:75], v[72:87]
    buffer_load_dwordx4 v1, s[8:11], s24 offen offset:2048 sc1 lds
    v_mfma_f32_32x32x16_bf16 v[88:103], v[12:15], a[76:79], v[88:103]
    ds_read_b128 v[8:11], v2 offset:16384
    s_waitcnt lgkmcnt(6)
    v_mfma_f32_32x32x16_bf16 v[72:87], v[16:19], a[80:83], v[72:87]
    buffer_load_dwordx4 v1, s[8:11], s24 offen offset:3072 sc1 lds
    v_mfma_f32_32x32x16_bf16 v[88:103], v[16:19], a[84:87], v[88:103]
    ds_read_b128 v[12:15], v2 offset:17408
    s_waitcnt lgkmcnt(6)
    v_mfma_f32_32x32x16_bf16 v[72:87], v[20:23], a[88:91], v[72:87]
    s_add_u32 s24, s24, 4096
    s_add_u32 s25, s25, 4096
    s_mov_b32 m0, s25
    s_nop 0
    buffer_load_dwordx4 v1, s[8:11], s24 offen offset:0 sc1 lds
    v_mfma_f32_32x32x16_bf16 v[88:103], v[20:23], a[92:95], v[88:103]
    ds_read_b128 v[16:19], v2 offset:18432
    s_waitcnt lgkmcnt(6)
    v_mfma_f32_32x32x16_bf16 v[72:87], v[24:27], a[96:99], v[72:87]
    buffer_load_dwordx4 v1, s[8:11], s24 offen offset:1024 sc1 lds
    v_mfma_f32_32x32x16_bf16 v[88:103], v[24:27], a[100:103], v[88:103]
    ds_read_b128 v[20:23], v2 offset:19456
    s_waitcnt lgkmcnt(6)
    v_mfma_f32_32x32x16_bf16 v[72:87], v[28:31], a[104:107], v[72:87]
    v_mfma_f32_32x32x16_bf16 v[88:103], v[28:31], a[108:111], v[88:103]
    ds_read_b128 v[24:27], v2 offset:20480
    s_waitcnt lgkmcnt(6)
    v_mfma_f32_32x32x16_bf16 v[72:87], v[32:35], a[112:115], v[72:87]
    v_mfma_f32_32x32x16_bf16 v[88:103], v[32:35], a[116:119], v[88:103]
    ds_read_b128 v[28:31], v2 offset:21504
    s_waitcnt lgkmcnt(6)
    v_mfma_f32_32x32x16_bf16 v[72:87], v[36:39], a[120:123], v[72:87]
    v_mfma_f32_32x32x16_bf16 v[88:103], v[36:39], a[124:127], v[88:103]
    ds_read_b128 v[32:35], v2 offset:22528
    s_waitcnt lgkmcnt(6)
    v_mfma_f32_32x32x16_bf16 v[72:87], v[8:11], a[128:131], v[72:87]
    v_mfma_f32_32x32x16_bf16 v[88:103], v[8:11], a[132:135], v[88:103]
    ds_read_b128 v[36:39], v2 offset:23552
    s_waitcnt lgkmcnt(6)
    v_mfma_f32_32x32x16_bf16 v[72:87], v[12:15], a[136:139], v[72:87]
    v_mfma_f32_32x32x16_bf16 v[88:103], v[12:15], a[140:143], v[88:103]
    ds_read_b128 v[8:11], v2 offset:24576
    s_waitcnt lgkmcnt(6)
    v_mfma_f32_32x32x16_bf16 v[72:87], v[16:19], a[144:147], v[72:87]
    v_mfma_f32_32x32x16_bf16 v[88:103], v[16:19], a[148:151], v[88:103]
    ds_read_b128 v[12:15], v2 offset:25600
    s_waitcnt lgkmcnt(6)
    v_mfma_f32_32x32x16_bf16 v[72:87], v[20:23], a[152:155], v[72:87]
    v_mfma_f32_32x32x16_bf16 v[88:103], v[20:23], a[156:159], v[88:103]
    ds_read_b128 v[16:19], v2 offset:26624
    s_waitcnt lgkmcnt(6)
    v_mfma_f32_32x32x16_bf16 v[72:87], v[24:27], a[160:163], v[72:87]
    v_mfma_f32_32x32x16_bf16 v[88:103], v[24:27], a[164:167], v[88:103]
    ds_read_b128 v[20:23], v2 offset:27648
    s_waitcnt lgkmcnt(6)
    v_mfma_f32_32x32x16_bf16 v[72:87], v[28:31], a[168:171], v[72:87]
    v_mfma_f32_32x32x16_bf16 v[88:103], v[28:31], a[172:175], v[88:103]
    ds_read_b128 v[24:27], v2 offset:28672
    s_waitcnt lgkmcnt(6)
    v_mfma_f32_32x32x16_bf16 v[72:87], v[32:35], a[176:179], v[72:87]
    v_mfma_f32_32x32x16_bf16 v[88:103], v[32:35], a[180:183], v[88:103]
    ds_read_b128 v[28:31], v2 offset:29696
    s_waitcnt lgkmcnt(6)
    v_mfma_f32_32x32x16_bf16 v[72:87], v[36:39], a[184:187], v[72:87]
    v_mfma_f32_32x32x16_bf16 v[88:103], v[36:39], a[188:191], v[88:103]
    ds_read_b128 v[32:35], v2 offset:30720
    s_waitcnt lgkmcnt(6)
    v_mfma_f32_32x32x16_bf16 v[72:87], v[8:11], a[192:195], v[72:87]
    v_mfma_f32_32x32x16_bf16 v[88:103], v[8:11], a[196:199], v[88:103]
    ds_read_b128 v[36:39], v2 offset:31744
    s_waitcnt lgkmcnt(6)
    v_mfma_f32_32x32x16_bf16 v[72:87], v[12:15], a[200:203], v[72:87]
    v_mfma_f32_32x32x16_bf16 v[88:103], v[12:15], a[204:207], v[88:103]
    ds_read_b128 v[8:11], v2 offset:32768
    s_waitcnt lgkmcnt(6)
    v_mfma_f32_32x32x16_bf16 v[72:87], v[16:19], a[208:211], v[72:87]
    v_mfma_f32_32x32x16_bf16 v[88:103], v[16:19], a[212:215], v[88:103]
    ds_read_b128 v[12:15], v2 offset:33792
    s_waitcnt lgkmcnt(6)
    v_mfma_f32_32x32x16_bf16 v[72:87], v[20:23], a[216:219], v[72:87]
    v_mfma_f32_32x32x16_bf16 v[88:103], v[20:23], a[220:223], v[88:103]
    ds_read_b128 v[16:19], v2 offset:34816
    s_waitcnt lgkmcnt(6)
    v_mfma_f32_32x32x16_bf16 v[72:87], v[24:27], a[224:227], v[72:87]
    v_mfma_f32_32x32x16_bf16 v[88:103], v[24:27], a[228:231], v[88:103]
    s_add_u32 s23, s14, 2
    s_cmp_lg_u32 s13, 0
    s_cbranch_scc1 layerb1_kernel_gu_lw4
    s_min_u32 s28, s23, 63
    s_cmp_gt_u32 s56, s28
    s_cbranch_scc1 layerb1_kernel_gu_lw4
layerb1_kernel_gu_lp4:
    buffer_load_dwordx4 v[124:127], v1, s[8:11], s57 offen sc1
    s_waitcnt vmcnt(0)
    v_min_u32 v124, v124, v125
    v_min_u32 v126, v126, v127
    v_min_u32 v124, v124, v126
    v_cmp_eq_u32 vcc, 0, v124
    s_nop 1
    s_ff1_i32_b64 s56, vcc
    s_min_u32 s56, s56, 64
    s_sub_u32 s58, s58, 1
    s_cbranch_scc1 layerb1_kernel_bail
    s_cmp_gt_u32 s56, s28
    s_cbranch_scc0 layerb1_kernel_gu_lp4
layerb1_kernel_gu_lw4:
    s_waitcnt vmcnt(0)
    s_barrier
    s_add_u32 s21, s16, 40960
    s_cmp_eq_u32 s21, 122880
    s_cselect_b32 s21, 0, s21
    s_add_u32 s23, s14, 2
    s_min_u32 s24, s23, 63
    s_mul_i32 s24, s24, 40960
    s_add_u32 s24, s24, s19
    s_mul_i32 s25, s13, 10240
    s_add_u32 s25, s25, s22
    s_add_u32 s22, s22, 40960
    s_cmp_eq_u32 s22, 122880
    s_cselect_b32 s22, 0, s22
    ds_read_b128 v[20:23], v2 offset:35840
    s_waitcnt lgkmcnt(6)
    v_mfma_f32_32x32x16_bf16 v[72:87], v[28:31], a[232:235], v[72:87]
    s_mov_b32 m0, s25
    s_nop 0
    buffer_load_dwordx4 v1, s[8:11], s24 offen offset:0 sc1 lds
    v_mfma_f32_32x32x16_bf16 v[88:103], v[28:31], a[236:239], v[88:103]
    ds_read_b128 v[24:27], v2 offset:36864
    s_waitcnt lgkmcnt(6)
    v_mfma_f32_32x32x16_bf16 v[72:87], v[32:35], a[240:243], v[72:87]
    buffer_load_dwordx4 v1, s[8:11], s24 offen offset:1024 sc1 lds
    v_mfma_f32_32x32x16_bf16 v[88:103], v[32:35], a[244:247], v[88:103]
    ds_read_b128 v[28:31], v2 offset:37888
    s_waitcnt lgkmcnt(6)
    v_mfma_f32_32x32x16_bf16 v[72:87], v[36:39], a[248:251], v[72:87]
    buffer_load_dwordx4 v1, s[8:11], s24 offen offset:2048 sc1 lds
    v_mfma_f32_32x32x16_bf16 v[88:103], v[36:39], a[252:255], v[88:103]
    ds_read_b128 v[32:35], v2 offset:38912
    s_waitcnt lgkmcnt(6)
    v_mfma_f32_32x32x16_bf16 v[72:87], v[8:11], v[192:195], v[72:87]
    buffer_load_dwordx4 v1, s[8:11], s24 offen offset:3072 sc1 lds
    v_mfma_f32_32x32x16_bf16 v[88:103], v[8:11], v[196:199], v[88:103]
    ds_read_b128 v[36:39], v2 offset:39936
    s_waitcnt lgkmcnt(6)
    v_mfma_f32_32x32x16_bf16 v[72:87], v[12:15], v[200:203], v[72:87]
    s_add_u32 s24, s24, 4096
    s_add_u32 s25, s25, 4096
    s_mov_b32 m0, s25
    s_nop 0
    buffer_load_dwordx4 v1, s[8:11], s24 offen offset:0 sc1 lds
    v_mfma_f32_32x32x16_bf16 v[88:103], v[12:15], v[204:207], v[88:103]
    v_add_u32 v6, s21, v1
    ds_read_b128 v[8:11], v6 offset:0
    s_waitcnt lgkmcnt(6)
    v_mfma_f32_32x32x16_bf16 v[72:87], v[16:19], v[208:211], v[72:87]
    buffer_load_dwordx4 v1, s[8:11], s24 offen offset:1024 sc1 lds
    v_mfma_f32_32x32x16_bf16 v[88:103], v[16:19], v[212:215], v[88:103]
    ds_read_b128 v[12:15], v6 offset:1024
    s_waitcnt lgkmcnt(6)
    v_mfma_f32_32x32x16_bf16 v[72:87], v[20:23], v[216:219], v[72:87]
    buffer_load_dwordx4 v1, s[8:11], s24 offen offset:2048 sc1 lds
    v_mfma_f32_32x32x16_bf16 v[88:103], v[20:23], v[220:223], v[88:103]
    ds_read_b128 v[16:19], v6 offset:2048
    s_waitcnt lgkmcnt(6)
    v_mfma_f32_32x32x16_bf16 v[72:87], v[24:27], v[224:227], v[72:87]
    buffer_load_dwordx4 v1, s[8:11], s24 offen offset:3072 sc1 lds
    v_mfma_f32_32x32x16_bf16 v[88:103], v[24:27], v[228:231], v[88:103]
    ds_read_b128 v[20:23], v6 offset:3072
    s_waitcnt lgkmcnt(6)
    v_mfma_f32_32x32x16_bf16 v[72:87], v[28:31], v[232:235], v[72:87]
    s_add_u32 s24, s24, 4096
    s_add_u32 s25, s25, 4096
    s_mov_b32 m0, s25
    s_nop 0
    buffer_load_dwordx4 v1, s[8:11], s24 offen offset:0 sc1 lds
    v_mfma_f32_32x32x16_bf16 v[88:103], v[28:31], v[236:239], v[88:103]
    ds_read_b128 v[24:27], v6 offset:4096
    s_waitcnt lgkmcnt(6)
    v_mfma_f32_32x32x16_bf16 v[72:87], v[32:35], v[240:243], v[72:87]
    buffer_load_dwordx4 v1, s[8:11], s24 offen offset:1024 sc1 lds
    v_mfma_f32_32x32x16_bf16 v[88:103], v[32:35], v[244:247], v[88:103]
    ds_read_b128 v[28:31], v6 offset:5120
    s_waitcnt lgkmcnt(6)
    v_mfma_f32_32x32x16_bf16 v[72:87], v[36:39], v[248:251], v[72:87]
    v_mfma_f32_32x32x16_bf16 v[88:103], v[36:39], v[252:255], v[88:103]
    v_mov_b32 v2, v6
    s_mov_b32 s16, s21
    s_add_u32 s14, s14, 1
layerb1_kernel_gu_loop:
    ds_read_b128 v[32:35], v2 offset:6144
    s_waitcnt lgkmcnt(6)
    v_mfma_f32_32x32x16_bf16 v[40:55], v[8:11], a[0:3], 0
    v_mfma_f32_32x32x16_bf16 v[56:71], v[8:11], a[4:7], 0
    ds_read_b128 v[36:39], v2 offset:7168
    s_waitcnt lgkmcnt(6)
    v_mfma_f32_32x32x16_bf16 v[40:55], v[12:15], a[8:11], v[40:55]
    v_mfma_f32_32x32x16_bf16 v[56:71], v[12:15], a[12:15], v[56:71]
    ds_read_b128 v[8:11], v2 offset:8192
    s_waitcnt lgkmcnt(6)
    v_mfma_f32_32x32x16_bf16 v[40:55], v[16:19], a[16:19], v[40:55]
    v_cvt_pk_bf16_f32 v104, v72, v73
    v_mfma_f32_32x32x16_bf16 v[56:71], v[16:19], a[20:23], v[56:71]
    v_cvt_pk_bf16_f32 v105, v74, v75
    ds_read_b128 v[12:15], v2 offset:9216
    s_waitcnt lgkmcnt(6)
    v_mfma_f32_32x32x16_bf16 v[40:55], v[20:23], a[24:27], v[40:55]
    v_cvt_pk_bf16_f32 v106, v76, v77
    v_mfma_f32_32x32x16_bf16 v[56:71], v[20:23], a[28:31], v[56:71]
    v_cvt_pk_bf16_f32 v107, v78, v79
    ds_read_b128 v[16:19], v2 offset:10240
    s_waitcnt lgkmcnt(6)
    v_mfma_f32_32x32x16_bf16 v[40:55], v[24:27], a[32:35], v[40:55]
    s_nop 1
    v_mfma_f32_32x32x16_bf16 v[56:71], v[24:27], a[36:39], v[56:71]
    v_permlane32_swap_b32 v104, v106
    ds_read_b128 v[20:23], v2 offset:11264
    s_waitcnt lgkmcnt(6)
    v_mfma_f32_32x32x16_bf16 v[40:55], v[28:31], a[40:43], v[40:55]
    v_permlane32_swap_b32 v105, v107
    v_mfma_f32_32x32x16_bf16 v[56:71], v[28:31], a[44:47], v[56:71]
    buffer_store_dwordx4 v[104:107], v3, s[8:11], s17 offen offset:0 sc1
    ds_read_b128 v[24:27], v2 offset:12288
    s_waitcnt lgkmcnt(6)
    v_mfma_f32_32x32x16_bf16 v[40:55], v[32:35], a[48:51], v[40:55]
    v_cvt_pk_bf16_f32 v108, v80, v81
    v_mfma_f32_32x32x16_bf16 v[56:71], v[32:35], a[52:55], v[56:71]
    v_cvt_pk_bf16_f32 v109, v82, v83
    ds_read_b128 v[28:31], v2 offset:13312
    s_waitcnt lgkmcnt(6)
    v_mfma_f32_32x32x16_bf16 v[40:55], v[36:39], a[56:59], v[40:55]
    v_cvt_pk_bf16_f32 v110, v84, v85
    v_mfma_f32_32x32x16_bf16 v[56:71], v[36:39], a[60:63], v[56:71]
    v_cvt_pk_bf16_f32 v111, v86, v87
    ds_read_b128 v[32:35], v2 offset:14336
    s_waitcnt lgkmcnt(6)
    v_mfma_f32_32x32x16_bf16 v[40:55], v[8:11], a[64:67], v[40:55]
    s_nop 1
    v_mfma_f32_32x32x16_bf16 v[56:71], v[8:11], a[68:71], v[56:71]
    v_permlane32_swap_b32 v108, v110
    ds_read_b128 v[36:39], v2 offset:15360
    s_waitcnt lgkmcnt(6)
    v_mfma_f32_32x32x16_bf16 v[40:55], v[12:15], a[72:75], v[40:55]
    v_permlane32_swap_b32 v109, v111
    v_mfma_f32_32x32x16_bf16 v[56:71], v[12:15], a[76:79], v[56:71]
    buffer_store_dwordx4 v[108:111], v3, s[8:11], s17 offen offset:256 sc1
    ds_read_b128 v[8:11], v2 offset:16384
    s_waitcnt lgkmcnt(6)
    v_mfma_f32_32x32x16_bf16 v[40:55], v[16:19], a[80:83], v[40:55]
    v_cvt_pk_bf16_f32 v112, v88, v89
    v_mfma_f32_32x32x16_bf16 v[56:71], v[16:19], a[84:87], v[56:71]
    v_cvt_pk_bf16_f32 v113, v90, v91
    ds_read_b128 v[12:15], v2 offset:17408
    s_waitcnt lgkmcnt(6)
    v_mfma_f32_32x32x16_bf16 v[40:55], v[20:23], a[88:91], v[40:55]
    v_cvt_pk_bf16_f32 v114, v92, v93
    v_mfma_f32_32x32x16_bf16 v[56:71], v[20:23], a[92:95], v[56:71]
    v_cvt_pk_bf16_f32 v115, v94, v95
    ds_read_b128 v[16:19], v2 offset:18432
    s_waitcnt lgkmcnt(6)
    v_mfma_f32_32x32x16_bf16 v[40:55], v[24:27], a[96:99], v[40:55]
    s_nop 1
    v_mfma_f32_32x32x16_bf16 v[56:71], v[24:27], a[100:103], v[56:71]
    v_permlane32_swap_b32 v112, v114
    ds_read_b128 v[20:23], v2 offset:19456
    s_waitcnt lgkmcnt(6)
    v_mfma_f32_32x32x16_bf16 v[40:55], v[28:31], a[104:107], v[40:55]
    v_permlane32_swap_b32 v113, v115
    v_mfma_f32_32x32x16_bf16 v[56:71], v[28:31], a[108:111], v[56:71]
    buffer_store_dwordx4 v[112:115], v3, s[8:11], s17 offen offset:2560 sc1
    ds_read_b128 v[24:27], v2 offset:20480
    s_waitcnt lgkmcnt(6)
    v_mfma_f32_32x32x16_bf16 v[40:55], v[32:35], a[112:115], v[40:55]
    v_cvt_pk_bf16_f32 v116, v96, v97
    v_mfma_f32_32x32x16_bf16 v[56:71], v[32:35], a[116:119], v[56:71]
    v_cvt_pk_bf16_f32 v117, v98, v99
    ds_read_b128 v[28:31], v2 offset:21504
    s_waitcnt lgkmcnt(6)
    v_mfma_f32_32x32x16_bf16 v[40:55], v[36:39], a[120:123], v[40:55]
    v_cvt_pk_bf16_f32 v118, v100, v101
    v_mfma_f32_32x32x16_bf16 v[56:71], v[36:39], a[124:127], v[56:71]
    v_cvt_pk_bf16_f32 v119, v102, v103
    ds_read_b128 v[32:35], v2 offset:22528
    s_waitcnt lgkmcnt(6)
    v_mfma_f32_32x32x16_bf16 v[40:55], v[8:11], a[128:131], v[40:55]
    s_nop 1
    v_mfma_f32_32x32x16_bf16 v[56:71], v[8:11], a[132:135], v[56:71]
    v_permlane32_swap_b32 v116, v118
    ds_read_b128 v[36:39], v2 offset:23552
    s_waitcnt lgkmcnt(6)
    v_mfma_f32_32x32x16_bf16 v[40:55], v[12:15], a[136:139], v[40:55]
    v_permlane32_swap_b32 v117, v119
    v_mfma_f32_32x32x16_bf16 v[56:71], v[12:15], a[140:143], v[56:71]
    buffer_store_dwordx4 v[116:119], v3, s[8:11], s17 offen offset:2816 sc1
    ds_read_b128 v[8:11], v2 offset:24576
    s_waitcnt lgkmcnt(6)
    v_mfma_f32_32x32x16_bf16 v[40:55], v[16:19], a[144:147], v[40:55]
    s_add_u32 s17, s17, s20
    v_mfma_f32_32x32x16_bf16 v[56:71], v[16:19], a[148:151], v[56:71]
    s_add_u32 s18, s18, s20
    ds_read_b128 v[12:15], v2 offset:25600
    s_waitcnt lgkmcnt(6)
    v_mfma_f32_32x32x16_bf16 v[40:55], v[20:23], a[152:155], v[40:55]
    v_mfma_f32_32x32x16_bf16 v[56:71], v[20:23], a[156:159], v[56:71]
    ds_read_b128 v[16:19], v2 offset:26624
    s_waitcnt lgkmcnt(6)
    v_mfma_f32_32x32x16_bf16 v[40:55], v[24:27], a[160:163], v[40:55]
    v_mfma_f32_32x32x16_bf16 v[56:71], v[24:27], a[164:167], v[56:71]
    ds_read_b128 v[20:23], v2 offset:27648
    s_waitcnt lgkmcnt(6)
    v_mfma_f32_32x32x16_bf16 v[40:55], v[28:31], a[168:171], v[40:55]
    v_mfma_f32_32x32x16_bf16 v[56:71], v[28:31], a[172:175], v[56:71]
    ds_read_b128 v[24:27], v2 offset:28672
    s_waitcnt lgkmcnt(6)
    v_mfma_f32_32x32x16_bf16 v[40:55], v[32:35], a[176:179], v[40:55]
    v_mfma_f32_32x32x16_bf16 v[56:71], v[32:35], a[180:183], v[56:71]
    ds_read_b128 v[28:31], v2 offset:29696
    s_waitcnt lgkmcnt(6)
    v_mfma_f32_32x32x16_bf16 v[40:55], v[36:39], a[184:187], v[40:55]
    v_mfma_f32_32x32x16_bf16 v[56:71], v[36:39], a[188:191], v[56:71]
    ds_read_b128 v[32:35], v2 offset:30720
    s_waitcnt lgkmcnt(6)
    v_mfma_f32_32x32x16_bf16 v[40:55], v[8:11], a[192:195], v[40:55]
    v_mfma_f32_32x32x16_bf16 v[56:71], v[8:11], a[196:199], v[56:71]
    ds_read_b128 v[36:39], v2 offset:31744
    s_waitcnt lgkmcnt(6)
    v_mfma_f32_32x32x16_bf16 v[40:55], v[12:15], a[200:203], v[40:55]
    v_mfma_f32_32x32x16_bf16 v[56:71], v[12:15], a[204:207], v[56:71]
    ds_read_b128 v[8:11], v2 offset:32768
    s_waitcnt lgkmcnt(6)
    v_mfma_f32_32x32x16_bf16 v[40:55], v[16:19], a[208:211], v[40:55]
    v_mfma_f32_32x32x16_bf16 v[56:71], v[16:19], a[212:215], v[56:71]
    ds_read_b128 v[12:15], v2 offset:33792
    s_waitcnt lgkmcnt(6)
    v_mfma_f32_32x32x16_bf16 v[40:55], v[20:23], a[216:219], v[40:55]
    v_mfma_f32_32x32x16_bf16 v[56:71], v[20:23], a[220:223], v[56:71]
    ds_read_b128 v[16:19], v2 offset:34816
    s_waitcnt lgkmcnt(6)
    v_mfma_f32_32x32x16_bf16 v[40:55], v[24:27], a[224:227], v[40:55]
    v_mfma_f32_32x32x16_bf16 v[56:71], v[24:27], a[228:231], v[56:71]
    s_add_u32 s23, s14, 2
    s_cmp_lg_u32 s13, 0
    s_cbranch_scc1 layerb1_kernel_gu_lw5
    s_min_u32 s28, s23, 63
    s_cmp_gt_u32 s56, s28
    s_cbranch_scc1 layerb1_kernel_gu_lw5
layerb1_kernel_gu_lp5:
    buffer_load_dwordx4 v[124:127], v1, s[8:11], s57 offen sc1
    s_waitcnt vmcnt(0)
    v_min_u32 v124, v124, v125
    v_min_u32 v126, v126, v127
    v_min_u32 v124, v124, v126
    v_cmp_eq_u32 vcc, 0, v124
    s_nop 1
    s_ff1_i32_b64 s56, vcc
    s_min_u32 s56, s56, 64
    s_sub_u32 s58, s58, 1
    s_cbranch_scc1 layerb1_kernel_bail
    s_cmp_gt_u32 s56, s28
    s_cbranch_scc0 layerb1_kernel_gu_lp5
layerb1_kernel_gu_lw5:
    s_cmp_gt_u32 s14, 5
    s_cbranch_scc1 layerb1_kernel_gu_dr6
    s_waitcnt vmcnt(0)
    s_mov_b32 s27, s14
    s_branch layerb1_kernel_gu_dq6
layerb1_kernel_gu_dr6:
    s_waitcnt vmcnt(4)
    s_sub_u32 s27, s14, 1
layerb1_kernel_gu_dq6:
    s_barrier
    s_cmp_lg_u32 s13, 0
    s_cbranch_scc1 layerb1_kernel_gu_fl7
    s_mov_b64 exec, 1
    s_lshl_b32 s26, s12, 7
    v_mov_b32 v7, s26
    v_mov_b32 v120, s27
    buffer_store_dword v120, v7, s[8:11], s48 offen sc1
    s_mov_b64 exec, -1
layerb1_kernel_gu_fl7:
    s_add_u32 s21, s16, 40960
    s_cmp_eq_u32 s21, 122880
    s_cselect_b32 s21, 0, s21
    s_add_u32 s23, s14, 2
    s_min_u32 s24, s23, 63
    s_mul_i32 s24, s24, 40960
    s_add_u32 s24, s24, s19
    s_mul_i32 s25, s13, 10240
    s_add_u32 s25, s25, s22
    s_add_u32 s22, s22, 40960
    s_cmp_eq_u32 s22, 122880
    s_cselect_b32 s22, 0, s22
    ds_read_b128 v[20:23], v2 offset:35840
    s_waitcnt lgkmcnt(6)
    v_mfma_f32_32x32x16_bf16 v[40:55], v[28:31], a[232:235], v[40:55]
    s_mov_b32 m0, s25
    s_nop 0
    buffer_load_dwordx4 v1, s[8:11], s24 offen offset:0 sc1 lds
    v_mfma_f32_32x32x16_bf16 v[56:71], v[28:31], a[236:239], v[56:71]
    ds_read_b128 v[24:27], v2 offset:36864
    s_waitcnt lgkmcnt(6)
    v_mfma_f32_32x32x16_bf16 v[40:55], v[32:35], a[240:243], v[40:55]
    buffer_load_dwordx4 v1, s[8:11], s24 offen offset:1024 sc1 lds
    v_mfma_f32_32x32x16_bf16 v[56:71], v[32:35], a[244:247], v[56:71]
    ds_read_b128 v[28:31], v2 offset:37888
    s_waitcnt lgkmcnt(6)
    v_mfma_f32_32x32x16_bf16 v[40:55], v[36:39], a[248:251], v[40:55]
    buffer_load_dwordx4 v1, s[8:11], s24 offen offset:2048 sc1 lds
    v_mfma_f32_32x32x16_bf16 v[56:71], v[36:39], a[252:255], v[56:71]
    ds_read_b128 v[32:35], v2 offset:38912
    s_waitcnt lgkmcnt(6)
    v_mfma_f32_32x32x16_bf16 v[40:55], v[8:11], v[192:195], v[40:55]
    buffer_load_dwordx4 v1, s[8:11], s24 offen offset:3072 sc1 lds
    v_mfma_f32_32x32x16_bf16 v[56:71], v[8:11], v[196:199], v[56:71]
    ds_read_b128 v[36:39], v2 offset:39936
    s_waitcnt lgkmcnt(6)
    v_mfma_f32_32x32x16_bf16 v[40:55], v[12:15], v[200:203], v[40:55]
    s_add_u32 s24, s24, 4096
    s_add_u32 s25, s25, 4096
    s_mov_b32 m0, s25
    s_nop 0
    buffer_load_dwordx4 v1, s[8:11], s24 offen offset:0 sc1 lds
    v_mfma_f32_32x32x16_bf16 v[56:71], v[12:15], v[204:207], v[56:71]
    v_add_u32 v6, s21, v1
    ds_read_b128 v[8:11], v6 offset:0
    s_waitcnt lgkmcnt(6)
    v_mfma_f32_32x32x16_bf16 v[40:55], v[16:19], v[208:211], v[40:55]
    buffer_load_dwordx4 v1, s[8:11], s24 offen offset:1024 sc1 lds
    v_mfma_f32_32x32x16_bf16 v[56:71], v[16:19], v[212:215], v[56:71]
    ds_read_b128 v[12:15], v6 offset:1024
    s_waitcnt lgkmcnt(6)
    v_mfma_f32_32x32x16_bf16 v[40:55], v[20:23], v[216:219], v[40:55]
    buffer_load_dwordx4 v1, s[8:11], s24 offen offset:2048 sc1 lds
    v_mfma_f32_32x32x16_bf16 v[56:71], v[20:23], v[220:223], v[56:71]
    ds_read_b128 v[16:19], v6 offset:2048
    s_waitcnt lgkmcnt(6)
    v_mfma_f32_32x32x16_bf16 v[40:55], v[24:27], v[224:227], v[40:55]
    buffer_load_dwordx4 v1, s[8:11], s24 offen offset:3072 sc1 lds
    v_mfma_f32_32x32x16_bf16 v[56:71], v[24:27], v[228:231], v[56:71]
    ds_read_b128 v[20:23], v6 offset:3072
    s_waitcnt lgkmcnt(6)
    v_mfma_f32_32x32x16_bf16 v[40:55], v[28:31], v[232:235], v[40:55]
    s_add_u32 s24, s24, 4096
    s_add_u32 s25, s25, 4096
    s_mov_b32 m0, s25
    s_nop 0
    buffer_load_dwordx4 v1, s[8:11], s24 offen offset:0 sc1 lds
    v_mfma_f32_32x32x16_bf16 v[56:71], v[28:31], v[236:239], v[56:71]
    ds_read_b128 v[24:27], v6 offset:4096
    s_waitcnt lgkmcnt(6)
    v_mfma_f32_32x32x16_bf16 v[40:55], v[32:35], v[240:243], v[40:55]
    buffer_load_dwordx4 v1, s[8:11], s24 offen offset:1024 sc1 lds
    v_mfma_f32_32x32x16_bf16 v[56:71], v[32:35], v[244:247], v[56:71]
    ds_read_b128 v[28:31], v6 offset:5120
    s_waitcnt lgkmcnt(6)
    v_mfma_f32_32x32x16_bf16 v[40:55], v[36:39], v[248:251], v[40:55]
    v_mfma_f32_32x32x16_bf16 v[56:71], v[36:39], v[252:255], v[56:71]
    v_mov_b32 v2, v6
    s_mov_b32 s16, s21
    s_add_u32 s14, s14, 1
    s_cmp_ge_u32 s14, s15
    s_cbranch_scc1 layerb1_kernel_gu_fin0
    ds_read_b128 v[32:35], v2 offset:6144
    s_waitcnt lgkmcnt(6)
    v_mfma_f32_32x32x16_bf16 v[72:87], v[8:11], a[0:3], 0
    v_mfma_f32_32x32x16_bf16 v[88:103], v[8:11], a[4:7], 0
    ds_read_b128 v[36:39], v2 offset:7168
    s_waitcnt lgkmcnt(6)
    v_mfma_f32_32x32x16_bf16 v[72:87], v[12:15], a[8:11], v[72:87]
    v_mfma_f32_32x32x16_bf16 v[88:103], v[12:15], a[12:15], v[88:103]
    ds_read_b128 v[8:11], v2 offset:8192
    s_waitcnt lgkmcnt(6)
    v_mfma_f32_32x32x16_bf16 v[72:87], v[16:19], a[16:19], v[72:87]
    v_cvt_pk_bf16_f32 v104, v40, v41
    v_mfma_f32_32x32x16_bf16 v[88:103], v[16:19], a[20:23], v[88:103]
    v_cvt_pk_bf16_f32 v105, v42, v43
    ds_read_b128 v[12:15], v2 offset:9216
    s_waitcnt lgkmcnt(6)
    v_mfma_f32_32x32x16_bf16 v[72:87], v[20:23], a[24:27], v[72:87]
    v_cvt_pk_bf16_f32 v106, v44, v45
    v_mfma_f32_32x32x16_bf16 v[88:103], v[20:23], a[28:31], v[88:103]
    v_cvt_pk_bf16_f32 v107, v46, v47
    ds_read_b128 v[16:19], v2 offset:10240
    s_waitcnt lgkmcnt(6)
    v_mfma_f32_32x32x16_bf16 v[72:87], v[24:27], a[32:35], v[72:87]
    s_nop 1
    v_mfma_f32_32x32x16_bf16 v[88:103], v[24:27], a[36:39], v[88:103]
    v_permlane32_swap_b32 v104, v106
    ds_read_b128 v[20:23], v2 offset:11264
    s_waitcnt lgkmcnt(6)
    v_mfma_f32_32x32x16_bf16 v[72:87], v[28:31], a[40:43], v[72:87]
    v_permlane32_swap_b32 v105, v107
    v_mfma_f32_32x32x16_bf16 v[88:103], v[28:31], a[44:47], v[88:103]
    buffer_store_dwordx4 v[104:107], v3, s[8:11], s17 offen offset:0 sc1
    ds_read_b128 v[24:27], v2 offset:12288
    s_waitcnt lgkmcnt(6)
    v_mfma_f32_32x32x16_bf16 v[72:87], v[32:35], a[48:51], v[72:87]
    v_cvt_pk_bf16_f32 v108, v48, v49
    v_mfma_f32_32x32x16_bf16 v[88:103], v[32:35], a[52:55], v[88:103]
    v_cvt_pk_bf16_f32 v109, v50, v51
    ds_read_b128 v[28:31], v2 offset:13312
    s_waitcnt lgkmcnt(6)
    v_mfma_f32_32x32x16_bf16 v[72:87], v[36:39], a[56:59], v[72:87]
    v_cvt_pk_bf16_f32 v110, v52, v53
    v_mfma_f32_32x32x16_bf16 v[88:103], v[36:39], a[60:63], v[88:103]
    v_cvt_pk_bf16_f32 v111, v54, v55
    ds_read_b128 v[32:35], v2 offset:14336
    s_waitcnt lgkmcnt(6)
    v_mfma_f32_32x32x16_bf16 v[72:87], v[8:11], a[64:67], v[72:87]
    s_nop 1
    v_mfma_f32_32x32x16_bf16 v[88:103], v[8:11], a[68:71], v[88:103]
    v_permlane32_swap_b32 v108, v110
    ds_read_b128 v[36:39], v2 offset:15360
    s_waitcnt lgkmcnt(6)
    v_mfma_f32_32x32x16_bf16 v[72:87], v[12:15], a[72:75], v[72:87]
    v_permlane32_swap_b32 v109, v111
    v_mfma_f32_32x32x16_bf16 v[88:103], v[12:15], a[76:79], v[88:103]
    buffer_store_dwordx4 v[108:111], v3, s[8:11], s17 offen offset:256 sc1
    ds_read_b128 v[8:11], v2 offset:16384
    s_waitcnt lgkmcnt(6)
    v_mfma_f32_32x32x16_bf16 v[72:87], v[16:19], a[80:83], v[72:87]
    v_cvt_pk_bf16_f32 v112, v56, v57
    v_mfma_f32_32x32x16_bf16 v[88:103], v[16:19], a[84:87], v[88:103]
    v_cvt_pk_bf16_f32 v113, v58, v59
    ds_read_b128 v[12:15], v2 offset:17408
    s_waitcnt lgkmcnt(6)
    v_mfma_f32_32x32x16_bf16 v[72:87], v[20:23], a[88:91], v[72:87]
    v_cvt_pk_bf16_f32 v114, v60, v61
    v_mfma_f32_32x32x16_bf16 v[88:103], v[20:23], a[92:95], v[88:103]
    v_cvt_pk_bf16_f32 v115, v62, v63
    ds_read_b128 v[16:19], v2 offset:18432
    s_waitcnt lgkmcnt(6)
    v_mfma_f32_32x32x16_bf16 v[72:87], v[24:27], a[96:99], v[72:87]
    s_nop 1
    v_mfma_f32_32x32x16_bf16 v[88:103], v[24:27], a[100:103], v[88:103]
    v_permlane32_swap_b32 v112, v114
    ds_read_b128 v[20:23], v2 offset:19456
    s_waitcnt lgkmcnt(6)
    v_mfma_f32_32x32x16_bf16 v[72:87], v[28:31], a[104:107], v[72:87]
    v_permlane32_swap_b32 v113, v115
    v_mfma_f32_32x32x16_bf16 v[88:103], v[28:31], a[108:111], v[88:103]
    buffer_store_dwordx4 v[112:115], v3, s[8:11], s17 offen offset:2560 sc1
    ds_read_b128 v[24:27], v2 offset:20480
    s_waitcnt lgkmcnt(6)
    v_mfma_f32_32x32x16_bf16 v[72:87], v[32:35], a[112:115], v[72:87]
    v_cvt_pk_bf16_f32 v116, v64, v65
    v_mfma_f32_32x32x16_bf16 v[88:103], v[32:35], a[116:119], v[88:103]
    v_cvt_pk_bf16_f32 v117, v66, v67
    ds_read_b128 v[28:31], v2 offset:21504
    s_waitcnt lgkmcnt(6)
    v_mfma_f32_32x32x16_bf16 v[72:87], v[36:39], a[120:123], v[72:87]
    v_cvt_pk_bf16_f32 v118, v68, v69
    v_mfma_f32_32x32x16_bf16 v[88:103], v[36:39], a[124:127], v[88:103]
    v_cvt_pk_bf16_f32 v119, v70, v71
    ds_read_b128 v[32:35], v2 offset:22528
    s_waitcnt lgkmcnt(6)
    v_mfma_f32_32x32x16_bf16 v[72:87], v[8:11], a[128:131], v[72:87]
    s_nop 1
    v_mfma_f32_32x32x16_bf16 v[88:103], v[8:11], a[132:135], v[88:103]
    v_permlane32_swap_b32 v116, v118
    ds_read_b128 v[36:39], v2 offset:23552
    s_waitcnt lgkmcnt(6)
    v_mfma_f32_32x32x16_bf16 v[72:87], v[12:15], a[136:139], v[72:87]
    v_permlane32_swap_b32 v117, v119
    v_mfma_f32_32x32x16_bf16 v[88:103], v[12:15], a[140:143], v[88:103]
    buffer_store_dwordx4 v[116:119], v3, s[8:11], s17 offen offset:2816 sc1
    ds_read_b128 v[8:11], v2 offset:24576
    s_waitcnt lgkmcnt(6)
    v_mfma_f32_32x32x16_bf16 v[72:87], v[16:19], a[144:147], v[72:87]
    s_add_u32 s17, s17, s20
    v_mfma_f32_32x32x16_bf16 v[88:103], v[16:19], a[148:151], v[88:103]
    s_add_u32 s18, s18, s20
    ds_read_b128 v[12:15], v2 offset:25600
    s_waitcnt lgkmcnt(6)
    v_mfma_f32_32x32x16_bf16 v[72:87], v[20:23], a[152:155], v[72:87]
    v_mfma_f32_32x32x16_bf16 v[88:103], v[20:23], a[156:159], v[88:103]
    ds_read_b128 v[16:19], v2 offset:26624
    s_waitcnt lgkmcnt(6)
    v_mfma_f32_32x32x16_bf16 v[72:87], v[24:27], a[160:163], v[72:87]
    v_mfma_f32_32x32x16_bf16 v[88:103], v[24:27], a[164:167], v[88:103]
    ds_read_b128 v[20:23], v2 offset:27648
    s_waitcnt lgkmcnt(6)
    v_mfma_f32_32x32x16_bf16 v[72:87], v[28:31], a[168:171], v[72:87]
    v_mfma_f32_32x32x16_bf16 v[88:103], v[28:31], a[172:175], v[88:103]
    ds_read_b128 v[24:27], v2 offset:28672
    s_waitcnt lgkmcnt(6)
    v_mfma_f32_32x32x16_bf16 v[72:87], v[32:35], a[176:179], v[72:87]
    v_mfma_f32_32x32x16_bf16 v[88:103], v[32:35], a[180:183], v[88:103]
    ds_read_b128 v[28:31], v2 offset:29696
    s_waitcnt lgkmcnt(6)
    v_mfma_f32_32x32x16_bf16 v[72:87], v[36:39], a[184:187], v[72:87]
    v_mfma_f32_32x32x16_bf16 v[88:103], v[36:39], a[188:191], v[88:103]
    ds_read_b128 v[32:35], v2 offset:30720
    s_waitcnt lgkmcnt(6)
    v_mfma_f32_32x32x16_bf16 v[72:87], v[8:11], a[192:195], v[72:87]
    v_mfma_f32_32x32x16_bf16 v[88:103], v[8:11], a[196:199], v[88:103]
    ds_read_b128 v[36:39], v2 offset:31744
    s_waitcnt lgkmcnt(6)
    v_mfma_f32_32x32x16_bf16 v[72:87], v[12:15], a[200:203], v[72:87]
    v_mfma_f32_32x32x16_bf16 v[88:103], v[12:15], a[204:207], v[88:103]
    ds_read_b128 v[8:11], v2 offset:32768
    s_waitcnt lgkmcnt(6)
    v_mfma_f32_32x32x16_bf16 v[72:87], v[16:19], a[208:211], v[72:87]
    v_mfma_f32_32x32x16_bf16 v[88:103], v[16:19], a[212:215], v[88:103]
    ds_read_b128 v[12:15], v2 offset:33792
    s_waitcnt lgkmcnt(6)
    v_mfma_f32_32x32x16_bf16 v[72:87], v[20:23], a[216:219], v[72:87]
    v_mfma_f32_32x32x16_bf16 v[88:103], v[20:23], a[220:223], v[88:103]
    ds_read_b128 v[16:19], v2 offset:34816
    s_waitcnt lgkmcnt(6)
    v_mfma_f32_32x32x16_bf16 v[72:87], v[24:27], a[224:227], v[72:87]
    v_mfma_f32_32x32x16_bf16 v[88:103], v[24:27], a[228:231], v[88:103]
    s_add_u32 s23, s14, 2
    s_cmp_lg_u32 s13, 0
    s_cbranch_scc1 layerb1_kernel_gu_lw8
    s_min_u32 s28, s23, 63
    s_cmp_gt_u32 s56, s28
    s_cbranch_scc1 layerb1_kernel_gu_lw8
layerb1_kernel_gu_lp8:
    buffer_load_dwordx4 v[124:127], v1, s[8:11], s57 offen sc1
    s_waitcnt vmcnt(0)
    v_min_u32 v124, v124, v125
    v_min_u32 v126, v126, v127
    v_min_u32 v124, v124, v126
    v_cmp_eq_u32 vcc, 0, v124
    s_nop 1
    s_ff1_i32_b64 s56, vcc
    s_min_u32 s56, s56, 64
    s_sub_u32 s58, s58, 1
    s_cbranch_scc1 layerb1_kernel_bail
    s_cmp_gt_u32 s56, s28
    s_cbranch_scc0 layerb1_kernel_gu_lp8
layerb1_kernel_gu_lw8:
    s_cmp_gt_u32 s14, 5
    s_cbranch_scc1 layerb1_kernel_gu_dr9
    s_waitcnt vmcnt(0)
    s_mov_b32 s27, s14
    s_branch layerb1_kernel_gu_dq9
layerb1_kernel_gu_dr9:
    s_waitcnt vmcnt(4)
    s_sub_u32 s27, s14, 1
layerb1_kernel_gu_dq9:
    s_barrier
    s_cmp_lg_u32 s13, 0
    s_cbranch_scc1 layerb1_kernel_gu_fl10
    s_mov_b64 exec, 1
    s_lshl_b32 s26, s12, 7
    v_mov_b32 v7, s26
    v_mov_b32 v120, s27
    buffer_store_dword v120, v7, s[8:11], s48 offen sc1
    s_mov_b64 exec, -1
layerb1_kernel_gu_fl10:
    s_add_u32 s21, s16, 40960
    s_cmp_eq_u32 s21, 122880
    s_cselect_b32 s21, 0, s21
    s_add_u32 s23, s14, 2
    s_min_u32 s24, s23, 63
    s_mul_i32 s24, s24, 40960
    s_add_u32 s24, s24, s19
    s_mul_i32 s25, s13, 10240
    s_add_u32 s25, s25, s22
    s_add_u32 s22, s22, 40960
    s_cmp_eq_u32 s22, 122880
    s_cselect_b32 s22, 0, s22
    ds_read_b128 v[20:23], v2 offset:35840
    s_waitcnt lgkmcnt(6)
    v_mfma_f32_32x32x16_bf16 v[72:87], v[28:31], a[232:235], v[72:87]
    s_mov_b32 m0, s25
    s_nop 0
    buffer_load_dwordx4 v1, s[8:11], s24 offen offset:0 sc1 lds
    v_mfma_f32_32x32x16_bf16 v[88:103], v[28:31], a[236:239], v[88:103]
    ds_read_b128 v[24:27], v2 offset:36864
    s_waitcnt lgkmcnt(6)
    v_mfma_f32_32x32x16_bf16 v[72:87], v[32:35], a[240:243], v[72:87]
    buffer_load_dwordx4 v1, s[8:11], s24 offen offset:1024 sc1 lds
    v_mfma_f32_32x32x16_bf16 v[88:103], v[32:35], a[244:247], v[88:103]
    ds_read_b128 v[28:31], v2 offset:37888
    s_waitcnt lgkmcnt(6)
    v_mfma_f32_32x32x16_bf16 v[72:87], v[36:39], a[248:251], v[72:87]
    buffer_load_dwordx4 v1, s[8:11], s24 offen offset:2048 sc1 lds
    v_mfma_f32_32x32x16_bf16 v[88:103], v[36:39], a[252:255], v[88:103]
    ds_read_b128 v[32:35], v2 offset:38912
    s_waitcnt lgkmcnt(6)
    v_mfma_f32_32x32x16_bf16 v[72:87], v[8:11], v[192:195], v[72:87]
    buffer_load_dwordx4 v1, s[8:11], s24 offen offset:3072 sc1 lds
    v_mfma_f32_32x32x16_bf16 v[88:103], v[8:11], v[196:199], v[88:103]
    ds_read_b128 v[36:39], v2 offset:39936
    s_waitcnt lgkmcnt(6)
    v_mfma_f32_32x32x16_bf16 v[72:87], v[12:15], v[200:203], v[72:87]
    s_add_u32 s24, s24, 4096
    s_add_u32 s25, s25, 4096
    s_mov_b32 m0, s25
    s_nop 0
    buffer_load_dwordx4 v1, s[8:11], s24 offen offset:0 sc1 lds
    v_mfma_f32_32x32x16_bf16 v[88:103], v[12:15], v[204:207], v[88:103]
    v_add_u32 v6, s21, v1
    ds_read_b128 v[8:11], v6 offset:0
    s_waitcnt lgkmcnt(6)
    v_mfma_f32_32x32x16_bf16 v[72:87], v[16:19], v[208:211], v[72:87]
    buffer_load_dwordx4 v1, s[8:11], s24 offen offset:1024 sc1 lds
    v_mfma_f32_32x32x16_bf16 v[88:103], v[16:19], v[212:215], v[88:103]
    ds_read_b128 v[12:15], v6 offset:1024
    s_waitcnt lgkmcnt(6)
    v_mfma_f32_32x32x16_bf16 v[72:87], v[20:23], v[216:219], v[72:87]
    buffer_load_dwordx4 v1, s[8:11], s24 offen offset:2048 sc1 lds
    v_mfma_f32_32x32x16_bf16 v[88:103], v[20:23], v[220:223], v[88:103]
    ds_read_b128 v[16:19], v6 offset:2048
    s_waitcnt lgkmcnt(6)
    v_mfma_f32_32x32x16_bf16 v[72:87], v[24:27], v[224:227], v[72:87]
    buffer_load_dwordx4 v1, s[8:11], s24 offen offset:3072 sc1 lds
    v_mfma_f32_32x32x16_bf16 v[88:103], v[24:27], v[228:231], v[88:103]
    ds_read_b128 v[20:23], v6 offset:3072
    s_waitcnt lgkmcnt(6)
    v_mfma_f32_32x32x16_bf16 v[72:87], v[28:31], v[232:235], v[72:87]
    s_add_u32 s24, s24, 4096
    s_add_u32 s25, s25, 4096
    s_mov_b32 m0, s25
    s_nop 0
    buffer_load_dwordx4 v1, s[8:11], s24 offen offset:0 sc1 lds
    v_mfma_f32_32x32x16_bf16 v[88:103], v[28:31], v[236:239], v[88:103]
    ds_read_b128 v[24:27], v6 offset:4096
    s_waitcnt lgkmcnt(6)
    v_mfma_f32_32x32x16_bf16 v[72:87], v[32:35], v[240:243], v[72:87]
    buffer_load_dwordx4 v1, s[8:11], s24 offen offset:1024 sc1 lds
    v_mfma_f32_32x32x16_bf16 v[88:103], v[32:35], v[244:247], v[88:103]
    ds_read_b128 v[28:31], v6 offset:5120
    s_waitcnt lgkmcnt(6)
    v_mfma_f32_32x32x16_bf16 v[72:87], v[36:39], v[248:251], v[72:87]
    v_mfma_f32_32x32x16_bf16 v[88:103], v[36:39], v[252:255], v[88:103]
    v_mov_b32 v2, v6
    s_mov_b32 s16, s21
    s_add_u32 s14, s14, 1
    s_cmp_lt_u32 s14, s15
    s_cbranch_scc1 layerb1_kernel_gu_loop
    s_branch layerb1_kernel_gu_fin1
layerb1_kernel_gu_fin0:
    s_nop 7
    s_nop 7
    v_cvt_pk_bf16_f32 v104, v40, v41
    v_cvt_pk_bf16_f32 v105, v42, v43
    v_cvt_pk_bf16_f32 v106, v44, v45
    v_cvt_pk_bf16_f32 v107, v46, v47
    s_nop 1
    v_permlane32_swap_b32 v104, v106
    v_permlane32_swap_b32 v105, v107
    buffer_store_dwordx4 v[104:107], v3, s[8:11], s17 offen offset:0 sc1
    v_cvt_pk_bf16_f32 v108, v48, v49
    v_cvt_pk_bf16_f32 v109, v50, v51
    v_cvt_pk_bf16_f32 v110, v52, v53
    v_cvt_pk_bf16_f32 v111, v54, v55
    s_nop 1
    v_permlane32_swap_b32 v108, v110
    v_permlane32_swap_b32 v109, v111
    buffer_store_dwordx4 v[108:111], v3, s[8:11], s17 offen offset:256 sc1
    v_cvt_pk_bf16_f32 v112, v56, v57
    v_cvt_pk_bf16_f32 v113, v58, v59
    v_cvt_pk_bf16_f32 v114, v60, v61
    v_cvt_pk_bf16_f32 v115, v62, v63
    s_nop 1
    v_permlane32_swap_b32 v112, v114
    v_permlane32_swap_b32 v113, v115
    buffer_store_dwordx4 v[112:115], v3, s[8:11], s17 offen offset:2560 sc1
    v_cvt_pk_bf16_f32 v116, v64, v65
    v_cvt_pk_bf16_f32 v117, v66, v67
    v_cvt_pk_bf16_f32 v118, v68, v69
    v_cvt_pk_bf16_f32 v119, v70, v71
    s_nop 1
    v_permlane32_swap_b32 v116, v118
    v_permlane32_swap_b32 v117, v119
    buffer_store_dwordx4 v[116:119], v3, s[8:11], s17 offen offset:2816 sc1
    s_add_u32 s17, s17, s20
    s_add_u32 s18, s18, s20
    s_branch layerb1_kernel_gu_done
layerb1_kernel_gu_fin1:
    s_nop 7
    s_nop 7
    v_cvt_pk_bf16_f32 v104, v72, v73
    v_cvt_pk_bf16_f32 v105, v74, v75
    v_cvt_pk_bf16_f32 v106, v76, v77
    v_cvt_pk_bf16_f32 v107, v78, v79
    s_nop 1
    v_permlane32_swap_b32 v104, v106
    v_permlane32_swap_b32 v105, v107
    buffer_store_dwordx4 v[104:107], v3, s[8:11], s17 offen offset:0 sc1
    v_cvt_pk_bf16_f32 v108, v80, v81
    v_cvt_pk_bf16_f32 v109, v82, v83
    v_cvt_pk_bf16_f32 v110, v84, v85
    v_cvt_pk_bf16_f32 v111, v86, v87
    s_nop 1
    v_permlane32_swap_b32 v108, v110
    v_permlane32_swap_b32 v109, v111
    buffer_store_dwordx4 v[108:111], v3, s[8:11], s17 offen offset:256 sc1
    v_cvt_pk_bf16_f32 v112, v88, v89
    v_cvt_pk_bf16_f32 v113, v90, v91
    v_cvt_pk_bf16_f32 v114, v92, v93
    v_cvt_pk_bf16_f32 v115, v94, v95
    s_nop 1
    v_permlane32_swap_b32 v112, v114
    v_permlane32_swap_b32 v113, v115
    buffer_store_dwordx4 v[112:115], v3, s[8:11], s17 offen offset:2560 sc1
    v_cvt_pk_bf16_f32 v116, v96, v97
    v_cvt_pk_bf16_f32 v117, v98, v99
    v_cvt_pk_bf16_f32 v118, v100, v101
    v_cvt_pk_bf16_f32 v119, v102, v103
    s_nop 1
    v_permlane32_swap_b32 v116, v118
    v_permlane32_swap_b32 v117, v119
    buffer_store_dwordx4 v[116:119], v3, s[8:11], s17 offen offset:2816 sc1
    s_add_u32 s17, s17, s20
    s_add_u32 s18, s18, s20
layerb1_kernel_gu_done:
    s_waitcnt vmcnt(0) lgkmcnt(0)
    s_barrier
    s_cmp_lg_u32 s13, 0
    s_cbranch_scc1 layerb1_kernel_gu_fl11
    s_mov_b64 exec, 1
    s_lshl_b32 s26, s12, 7
    v_mov_b32 v7, s26
    v_mov_b32 v120, s14
    buffer_store_dword v120, v7, s[8:11], s48 offen sc1
    s_mov_b64 exec, -1
layerb1_kernel_gu_fl11:
    s_branch layerb1_kernel_g_done
layerb1_kernel_g_qk:
    s_sub_u32 s26, s12, 80
    s_cmp_ge_u32 s26, 24
    s_cselect_b32 s27, 1, 0
    s_cselect_b32 s28, 24, 0
    s_sub_u32 s26, s26, s28
    s_lshl_b32 s26, s26, 3
    s_lshl_b32 s28, s13, 1
    s_add_u32 s26, s26, s28
    s_add_u32 s28, s26, 0
    s_mul_i32 s29, s28, 171
    s_lshr_b32 s29, s29, 10
    s_mul_i32 s30, s29, 6
    s_sub_u32 s30, s28, s30
    s_mul_i32 s31, s29, 12288
    s_lshl_b32 s32, s30, 11
    s_add_u32 s31, s31, s32
    s_mul_i32 s32, s14, 393216
    s_add_u32 s31, s31, s32
    s_mul_i32 s32, s27, 25165824
    s_add_u32 s31, s31, s32
    s_add_u32 s17, s31, 53477376
    s_lshl_b32 s30, s30, 5
    v_add_u32 v10, s30, v8
    v_and_b32 v11, 0xc1, v10
    v_and_b32 v12, 8, v10
    v_lshl_or_b32 v11, v12, 2, v11
    v_and_b32 v12, 32, v10
    v_lshrrev_b32 v12, 1, v12
    v_or_b32 v11, v11, v12
    v_and_b32 v12, 2, v10
    v_lshl_or_b32 v11, v12, 2, v11
    v_and_b32 v12, 16, v10
    v_lshrrev_b32 v12, 2, v12
    v_or_b32 v11, v11, v12
    v_and_b32 v12, 4, v10
    v_lshrrev_b32 v12, 1, v12
    v_or_b32 v11, v11, v12
    s_cmp_eq_u32 s27, 1
    s_cselect_b64 vcc, -1, 0
    s_nop 1
    v_cndmask_b32 v10, v10, v11, vcc
    v_lshrrev_b32 v12, 4, v10
    v_and_b32 v13, 3, v12
    v_mul_u32_u24 v13, 6, v13
    v_lshrrev_b32 v12, 2, v12
    v_add_u32 v12, v12, v13
    v_mul_u32_u24 v12, 20480, v12
    v_and_b32 v13, 15, v10
    v_lshl_add_u32 v11, v13, 4, v12
    v_lshl_add_u32 v4, v9, 8, v11
    s_xor_b32 s30, s27, 1
    s_mul_i32 s30, s30, 61440
    s_mul_i32 s31, s29, 491520
    s_add_u32 s30, s30, s31
    s_add_u32 s34, s30, 11534336
    s_add_u32 s28, s26, 1
    s_mul_i32 s29, s28, 171
    s_lshr_b32 s29, s29, 10
    s_mul_i32 s30, s29, 6
    s_sub_u32 s30, s28, s30
    s_mul_i32 s31, s29, 12288
    s_lshl_b32 s32, s30, 11
    s_add_u32 s31, s31, s32
    s_mul_i32 s32, s14, 393216
    s_add_u32 s31, s31, s32
    s_mul_i32 s32, s27, 25165824
    s_add_u32 s31, s31, s32
    s_add_u32 s18, s31, 53477376
    s_lshl_b32 s30, s30, 5
    v_add_u32 v10, s30, v8
    v_and_b32 v11, 0xc1, v10
    v_and_b32 v12, 8, v10
    v_lshl_or_b32 v11, v12, 2, v11
    v_and_b32 v12, 32, v10
    v_lshrrev_b32 v12, 1, v12
    v_or_b32 v11, v11, v12
    v_and_b32 v12, 2, v10
    v_lshl_or_b32 v11, v12, 2, v11
    v_and_b32 v12, 16, v10
    v_lshrrev_b32 v12, 2, v12
    v_or_b32 v11, v11, v12
    v_and_b32 v12, 4, v10
    v_lshrrev_b32 v12, 1, v12
    v_or_b32 v11, v11, v12
    s_cmp_eq_u32 s27, 1
    s_cselect_b64 vcc, -1, 0
    s_nop 1
    v_cndmask_b32 v10, v10, v11, vcc
    v_lshrrev_b32 v12, 4, v10
    v_and_b32 v13, 3, v12
    v_mul_u32_u24 v13, 6, v13
    v_lshrrev_b32 v12, 2, v12
    v_add_u32 v12, v12, v13
    v_mul_u32_u24 v12, 20480, v12
    v_and_b32 v13, 15, v10
    v_lshl_add_u32 v11, v13, 4, v12
    v_lshl_add_u32 v5, v9, 8, v11
    s_xor_b32 s30, s27, 1
    s_mul_i32 s30, s30, 61440
    s_mul_i32 s31, s29, 491520
    s_add_u32 s30, s30, s31
    s_add_u32 s35, s30, 11534336
    s_add_u32 s34, s34, 4096
    s_add_u32 s35, s35, 4096
    s_add_u32 s34, s34, 4096
    s_add_u32 s35, s35, 4096
    s_add_u32 s34, s34, 4096
    s_add_u32 s35, s35, 4096
    s_add_u32 s34, s34, 4096
    s_add_u32 s35, s35, 4096
    buffer_load_dwordx4 v[192:195], v4, s[8:11], s34 offen offset:0
    buffer_load_dwordx4 v[196:199], v5, s[8:11], s35 offen offset:0
    buffer_load_dwordx4 v[200:203], v4, s[8:11], s34 offen offset:512
    buffer_load_dwordx4 v[204:207], v5, s[8:11], s35 offen offset:512
    buffer_load_dwordx4 v[208:211], v4, s[8:11], s34 offen offset:1024
    buffer_load_dwordx4 v[212:215], v5, s[8:11], s35 offen offset:1024
    buffer_load_dwordx4 v[216:219], v4, s[8:11], s34 offen offset:1536
    buffer_load_dwordx4 v[220:223], v5, s[8:11], s35 offen offset:1536
    buffer_load_dwordx4 v[224:227], v4, s[8:11], s34 offen offset:2048
    buffer_load_dwordx4 v[228:231], v5, s[8:11], s35 offen offset:2048
    buffer_load_dwordx4 v[232:235], v4, s[8:11], s34 offen offset:2560
    buffer_load_dwordx4 v[236:239], v5, s[8:11], s35 offen offset:2560
    buffer_load_dwordx4 v[240:243], v4, s[8:11], s34 offen offset:3072
    buffer_load_dwordx4 v[244:247], v5, s[8:11], s35 offen offset:3072
    buffer_load_dwordx4 v[248:251], v4, s[8:11], s34 offen offset:3584
    buffer_load_dwordx4 v[252:255], v5, s[8:11], s35 offen offset:3584
    v_mov_b32 v3, v1
    s_mov_b32 s20, 393216
    s_mul_i32 s19, s13, 10240
    s_add_u32 s19, s19, 220200960
    s_mov_b32 s22, 0
    s_mov_b32 s56, 0
    s_mov_b32 s58, 400000
    s_add_u32 s57, s48, 45056
    s_cmp_lg_u32 s13, 0
    s_cbranch_scc1 layerb1_kernel_gk_lw1
    s_min_u32 s28, s14, 63
    s_cmp_gt_u32 s56, s28
    s_cbranch_scc1 layerb1_kernel_gk_lw1
layerb1_kernel_gk_lp1:
    buffer_load_dwordx4 v[124:127], v1, s[8:11], s57 offen sc1
    s_waitcnt vmcnt(0)
    v_min_u32 v124, v124, v125
    v_min_u32 v126, v126, v127
    v_min_u32 v124, v124, v126
    v_cmp_eq_u32 vcc, 0, v124
    s_nop 1
    s_ff1_i32_b64 s56, vcc
    s_min_u32 s56, s56, 64
    s_sub_u32 s58, s58, 1
    s_cbranch_scc1 layerb1_kernel_bail
    s_cmp_gt_u32 s56, s28
    s_cbranch_scc0 layerb1_kernel_gk_lp1
layerb1_kernel_gk_lw1:
    s_barrier
    s_min_u32 s24, s14, 63
    s_mul_i32 s24, s24, 40960
    s_add_u32 s24, s24, s19
    s_mul_i32 s25, s13, 10240
    s_add_u32 s25, s25, s22
    s_mov_b32 m0, s25
    s_nop 0
    buffer_load_dwordx4 v1, s[8:11], s24 offen offset:0 sc1 lds
    buffer_load_dwordx4 v1, s[8:11], s24 offen offset:1024 sc1 lds
    buffer_load_dwordx4 v1, s[8:11], s24 offen offset:2048 sc1 lds
    buffer_load_dwordx4 v1, s[8:11], s24 offen offset:3072 sc1 lds
    s_add_u32 s24, s24, 4096
    s_add_u32 s25, s25, 4096
    s_mov_b32 m0, s25
    s_nop 0
    buffer_load_dwordx4 v1, s[8:11], s24 offen offset:0 sc1 lds
    buffer_load_dwordx4 v1, s[8:11], s24 offen offset:1024 sc1 lds
    buffer_load_dwordx4 v1, s[8:11], s24 offen offset:2048 sc1 lds
    buffer_load_dwordx4 v1, s[8:11], s24 offen offset:3072 sc1 lds
    s_add_u32 s24, s24, 4096
    s_add_u32 s25, s25, 4096
    s_mov_b32 m0, s25
    s_nop 0
    buffer_load_dwordx4 v1, s[8:11], s24 offen offset:0 sc1 lds
    buffer_load_dwordx4 v1, s[8:11], s24 offen offset:1024 sc1 lds
    s_mov_b32 s22, 40960
    s_mov_b32 s16, 0
    s_waitcnt vmcnt(0)
    s_barrier
    v_mov_b32 v2, v1
    ds_read_b128 v[8:11], v2 offset:0
    ds_read_b128 v[12:15], v2 offset:1024
    ds_read_b128 v[16:19], v2 offset:2048
    ds_read_b128 v[20:23], v2 offset:3072
    ds_read_b128 v[24:27], v2 offset:4096
    ds_read_b128 v[28:31], v2 offset:5120
layerb1_kernel_gk_solo:
    ds_read_b128 v[32:35], v2 offset:6144
    s_waitcnt lgkmcnt(6)
    v_mfma_f32_32x32x16_bf16 v[40:55], a[0:3], v[8:11], 0
    v_mfma_f32_32x32x16_bf16 v[56:71], a[4:7], v[8:11], 0
    ds_read_b128 v[36:39], v2 offset:7168
    s_waitcnt lgkmcnt(6)
    v_mfma_f32_32x32x16_bf16 v[40:55], a[8:11], v[12:15], v[40:55]
    v_mfma_f32_32x32x16_bf16 v[56:71], a[12:15], v[12:15], v[56:71]
    ds_read_b128 v[8:11], v2 offset:8192
    s_waitcnt lgkmcnt(6)
    v_mfma_f32_32x32x16_bf16 v[40:55], a[16:19], v[16:19], v[40:55]
    v_mfma_f32_32x32x16_bf16 v[56:71], a[20:23], v[16:19], v[56:71]
    ds_read_b128 v[12:15], v2 offset:9216
    s_waitcnt lgkmcnt(6)
    v_mfma_f32_32x32x16_bf16 v[40:55], a[24:27], v[20:23], v[40:55]
    v_mfma_f32_32x32x16_bf16 v[56:71], a[28:31], v[20:23], v[56:71]
    ds_read_b128 v[16:19], v2 offset:10240
    s_waitcnt lgkmcnt(6)
    v_mfma_f32_32x32x16_bf16 v[40:55], a[32:35], v[24:27], v[40:55]
    v_mfma_f32_32x32x16_bf16 v[56:71], a[36:39], v[24:27], v[56:71]
    ds_read_b128 v[20:23], v2 offset:11264
    s_waitcnt lgkmcnt(6)
    v_mfma_f32_32x32x16_bf16 v[40:55], a[40:43], v[28:31], v[40:55]
    v_mfma_f32_32x32x16_bf16 v[56:71], a[44:47], v[28:31], v[56:71]
    ds_read_b128 v[24:27], v2 offset:12288
    s_waitcnt lgkmcnt(6)
    v_mfma_f32_32x32x16_bf16 v[40:55], a[48:51], v[32:35], v[40:55]
    v_mfma_f32_32x32x16_bf16 v[56:71], a[52:55], v[32:35], v[56:71]
    ds_read_b128 v[28:31], v2 offset:13312
    s_waitcnt lgkmcnt(6)
    v_mfma_f32_32x32x16_bf16 v[40:55], a[56:59], v[36:39], v[40:55]
    v_mfma_f32_32x32x16_bf16 v[56:71], a[60:63], v[36:39], v[56:71]
    ds_read_b128 v[32:35], v2 offset:14336
    s_waitcnt lgkmcnt(6)
    v_mfma_f32_32x32x16_bf16 v[40:55], a[64:67], v[8:11], v[40:55]
    v_mfma_f32_32x32x16_bf16 v[56:71], a[68:71], v[8:11], v[56:71]
    ds_read_b128 v[36:39], v2 offset:15360
    s_waitcnt lgkmcnt(6)
    v_mfma_f32_32x32x16_bf16 v[40:55], a[72:75], v[12:15], v[40:55]
    v_mfma_f32_32x32x16_bf16 v[56:71], a[76:79], v[12:15], v[56:71]
    ds_read_b128 v[8:11], v2 offset:16384
    s_waitcnt lgkmcnt(6)
    v_mfma_f32_32x32x16_bf16 v[40:55], a[80:83], v[16:19], v[40:55]
    v_mfma_f32_32x32x16_bf16 v[56:71], a[84:87], v[16:19], v[56:71]
    ds_read_b128 v[12:15], v2 offset:17408
    s_waitcnt lgkmcnt(6)
    v_mfma_f32_32x32x16_bf16 v[40:55], a[88:91], v[20:23], v[40:55]
    v_mfma_f32_32x32x16_bf16 v[56:71], a[92:95], v[20:23], v[56:71]
    ds_read_b128 v[16:19], v2 offset:18432
    s_waitcnt lgkmcnt(6)
    v_mfma_f32_32x32x16_bf16 v[40:55], a[96:99], v[24:27], v[40:55]
    v_mfma_f32_32x32x16_bf16 v[56:71], a[100:103], v[24:27], v[56:71]
    ds_read_b128 v[20:23], v2 offset:19456
    s_waitcnt lgkmcnt(6)
    v_mfma_f32_32x32x16_bf16 v[40:55], a[104:107], v[28:31], v[40:55]
    v_mfma_f32_32x32x16_bf16 v[56:71], a[108:111], v[28:31], v[56:71]
    ds_read_b128 v[24:27], v2 offset:20480
    s_waitcnt lgkmcnt(6)
    v_mfma_f32_32x32x16_bf16 v[40:55], a[112:115], v[32:35], v[40:55]
    v_mfma_f32_32x32x16_bf16 v[56:71], a[116:119], v[32:35], v[56:71]
    ds_read_b128 v[28:31], v2 offset:21504
    s_waitcnt lgkmcnt(6)
    v_mfma_f32_32x32x16_bf16 v[40:55], a[120:123], v[36:39], v[40:55]
    v_mfma_f32_32x32x16_bf16 v[56:71], a[124:127], v[36:39], v[56:71]
    ds_read_b128 v[32:35], v2 offset:22528
    s_waitcnt lgkmcnt(6)
    v_mfma_f32_32x32x16_bf16 v[40:55], a[128:131], v[8:11], v[40:55]
    v_mfma_f32_32x32x16_bf16 v[56:71], a[132:135], v[8:11], v[56:71]
    ds_read_b128 v[36:39], v2 offset:23552
    s_waitcnt lgkmcnt(6)
    v_mfma_f32_32x32x16_bf16 v[40:55], a[136:139], v[12:15], v[40:55]
    v_mfma_f32_32x32x16_bf16 v[56:71], a[140:143], v[12:15], v[56:71]
    ds_read_b128 v[8:11], v2 offset:24576
    s_waitcnt lgkmcnt(6)
    v_mfma_f32_32x32x16_bf16 v[40:55], a[144:147], v[16:19], v[40:55]
    v_mfma_f32_32x32x16_bf16 v[56:71], a[148:151], v[16:19], v[56:71]
    ds_read_b128 v[12:15], v2 offset:25600
    s_waitcnt lgkmcnt(6)
    v_mfma_f32_32x32x16_bf16 v[40:55], a[152:155], v[20:23], v[40:55]
    v_mfma_f32_32x32x16_bf16 v[56:71], a[156:159], v[20:23], v[56:71]
    ds_read_b128 v[16:19], v2 offset:26624
    s_waitcnt lgkmcnt(6)
    v_mfma_f32_32x32x16_bf16 v[40:55], a[160:163], v[24:27], v[40:55]
    v_mfma_f32_32x32x16_bf16 v[56:71], a[164:167], v[24:27], v[56:71]
    ds_read_b128 v[20:23], v2 offset:27648
    s_waitcnt lgkmcnt(6)
    v_mfma_f32_32x32x16_bf16 v[40:55], a[168:171], v[28:31], v[40:55]
    v_mfma_f32_32x32x16_bf16 v[56:71], a[172:175], v[28:31], v[56:71]
    ds_read_b128 v[24:27], v2 offset:28672
    s_waitcnt lgkmcnt(6)
    v_mfma_f32_32x32x16_bf16 v[40:55], a[176:179], v[32:35], v[40:55]
    v_mfma_f32_32x32x16_bf16 v[56:71], a[180:183], v[32:35], v[56:71]
    ds_read_b128 v[28:31], v2 offset:29696
    s_waitcnt lgkmcnt(6)
    v_mfma_f32_32x32x16_bf16 v[40:55], a[184:187], v[36:39], v[40:55]
    v_mfma_f32_32x32x16_bf16 v[56:71], a[188:191], v[36:39], v[56:71]
    ds_read_b128 v[32:35], v2 offset:30720
    s_waitcnt lgkmcnt(6)
    v_mfma_f32_32x32x16_bf16 v[40:55], a[192:195], v[8:11], v[40:55]
    v_mfma_f32_32x32x16_bf16 v[56:71], a[196:199], v[8:11], v[56:71]
    ds_read_b128 v[36:39], v2 offset:31744
    s_waitcnt lgkmcnt(6)
    v_mfma_f32_32x32x16_bf16 v[40:55], a[200:203], v[12:15], v[40:55]
    v_mfma_f32_32x32x16_bf16 v[56:71], a[204:207], v[12:15], v[56:71]
    ds_read_b128 v[8:11], v2 offset:32768
    s_waitcnt lgkmcnt(6)
    v_mfma_f32_32x32x16_bf16 v[40:55], a[208:211], v[16:19], v[40:55]
    v_mfma_f32_32x32x16_bf16 v[56:71], a[212:215], v[16:19], v[56:71]
    ds_read_b128 v[12:15], v2 offset:33792
    s_waitcnt lgkmcnt(6)
    v_mfma_f32_32x32x16_bf16 v[40:55], a[216:219], v[20:23], v[40:55]
    v_mfma_f32_32x32x16_bf16 v[56:71], a[220:223], v[20:23], v[56:71]
    ds_read_b128 v[16:19], v2 offset:34816
    s_waitcnt lgkmcnt(6)
    v_mfma_f32_32x32x16_bf16 v[40:55], a[224:227], v[24:27], v[40:55]
    v_mfma_f32_32x32x16_bf16 v[56:71], a[228:231], v[24:27], v[56:71]
    ds_read_b128 v[20:23], v2 offset:35840
    s_waitcnt lgkmcnt(6)
    v_mfma_f32_32x32x16_bf16 v[40:55], a[232:235], v[28:31], v[40:55]
    v_mfma_f32_32x32x16_bf16 v[56:71], a[236:239], v[28:31], v[56:71]
    ds_read_b128 v[24:27], v2 offset:36864
    s_waitcnt lgkmcnt(6)
    buffer_load_dwordx4 v[124:127], v1, s[8:11], s57 offen sc1
    v_mfma_f32_32x32x16_bf16 v[40:55], a[240:243], v[32:35], v[40:55]
    v_mfma_f32_32x32x16_bf16 v[56:71], a[244:247], v[32:35], v[56:71]
    ds_read_b128 v[28:31], v2 offset:37888
    s_waitcnt lgkmcnt(6)
    v_mfma_f32_32x32x16_bf16 v[40:55], a[248:251], v[36:39], v[40:55]
    v_mfma_f32_32x32x16_bf16 v[56:71], a[252:255], v[36:39], v[56:71]
    ds_read_b128 v[32:35], v2 offset:38912
    s_waitcnt lgkmcnt(6)
    v_mfma_f32_32x32x16_bf16 v[40:55], v[192:195], v[8:11], v[40:55]
    v_mfma_f32_32x32x16_bf16 v[56:71], v[196:199], v[8:11], v[56:71]
    ds_read_b128 v[36:39], v2 offset:39936
    s_waitcnt lgkmcnt(6)
    v_mfma_f32_32x32x16_bf16 v[40:55], v[200:203], v[12:15], v[40:55]
    v_mfma_f32_32x32x16_bf16 v[56:71], v[204:207], v[12:15], v[56:71]
    s_waitcnt lgkmcnt(5)
    v_mfma_f32_32x32x16_bf16 v[40:55], v[208:211], v[16:19], v[40:55]
    v_mfma_f32_32x32x16_bf16 v[56:71], v[212:215], v[16:19], v[56:71]
    s_waitcnt lgkmcnt(4)
    v_mfma_f32_32x32x16_bf16 v[40:55], v[216:219], v[20:23], v[40:55]
    v_mfma_f32_32x32x16_bf16 v[56:71], v[220:223], v[20:23], v[56:71]
    s_waitcnt lgkmcnt(3)
    v_mfma_f32_32x32x16_bf16 v[40:55], v[224:227], v[24:27], v[40:55]
    v_mfma_f32_32x32x16_bf16 v[56:71], v[228:231], v[24:27], v[56:71]
    s_waitcnt lgkmcnt(2)
    v_mfma_f32_32x32x16_bf16 v[40:55], v[232:235], v[28:31], v[40:55]
    v_mfma_f32_32x32x16_bf16 v[56:71], v[236:239], v[28:31], v[56:71]
    s_waitcnt lgkmcnt(1)
    v_mfma_f32_32x32x16_bf16 v[40:55], v[240:243], v[32:35], v[40:55]
    v_mfma_f32_32x32x16_bf16 v[56:71], v[244:247], v[32:35], v[56:71]
    s_waitcnt lgkmcnt(0)
    v_mfma_f32_32x32x16_bf16 v[40:55], v[248:251], v[36:39], v[40:55]
    v_mfma_f32_32x32x16_bf16 v[56:71], v[252:255], v[36:39], v[56:71]
    s_add_u32 s14, s14, 1
    s_nop 7
    s_nop 7
    v_cvt_pk_bf16_f32 v104, v40, v41
    v_cvt_pk_bf16_f32 v105, v42, v43
    v_cvt_pk_bf16_f32 v106, v44, v45
    v_cvt_pk_bf16_f32 v107, v46, v47
    s_nop 1
    v_permlane32_swap_b32 v104, v106
    v_permlane32_swap_b32 v105, v107
    buffer_store_dwordx4 v[104:107], v3, s[8:11], s17 offen offset:0 sc1
    v_cvt_pk_bf16_f32 v108, v48, v49
    v_cvt_pk_bf16_f32 v109, v50, v51
    v_cvt_pk_bf16_f32 v110, v52, v53
    v_cvt_pk_bf16_f32 v111, v54, v55
    s_nop 1
    v_permlane32_swap_b32 v108, v110
    v_permlane32_swap_b32 v109, v111
    buffer_store_dwordx4 v[108:111], v3, s[8:11], s17 offen offset:1024 sc1
    v_cvt_pk_bf16_f32 v112, v56, v57
    v_cvt_pk_bf16_f32 v113, v58, v59
    v_cvt_pk_bf16_f32 v114, v60, v61
    v_cvt_pk_bf16_f32 v115, v62, v63
    s_nop 1
    v_permlane32_swap_b32 v112, v114
    v_permlane32_swap_b32 v113, v115
    buffer_store_dwordx4 v[112:115], v3, s[8:11], s18 offen offset:0 sc1
    v_cvt_pk_bf16_f32 v116, v64, v65
    v_cvt_pk_bf16_f32 v117, v66, v67
    v_cvt_pk_bf16_f32 v118, v68, v69
    v_cvt_pk_bf16_f32 v119, v70, v71
    s_nop 1
    v_permlane32_swap_b32 v116, v118
    v_permlane32_swap_b32 v117, v119
    buffer_store_dwordx4 v[116:119], v3, s[8:11], s18 offen offset:1024 sc1
    s_add_u32 s17, s17, s20
    s_add_u32 s18, s18, s20
    s_waitcnt vmcnt(0)
    s_barrier
    s_cmp_lg_u32 s13, 0
    s_cbranch_scc1 layerb1_kernel_gk_fl2
    s_mov_b64 exec, 1
    s_lshl_b32 s26, s12, 7
    v_mov_b32 v7, s26
    v_mov_b32 v120, s14
    buffer_store_dword v120, v7, s[8:11], s48 offen sc1
    s_mov_b64 exec, -1
layerb1_kernel_gk_fl2:
layerb1_kernel_gk_spoll:
    v_min_u32 v124, v124, v125
    v_min_u32 v126, v126, v127
    v_min_u32 v124, v124, v126
    v_cmp_eq_u32 vcc, 0, v124
    s_nop 1
    s_ff1_i32_b64 s56, vcc
    s_min_u32 s56, s56, 64
    s_cmp_gt_u32 s56, s14
    s_cbranch_scc1 layerb1_kernel_gk_sok
    s_sub_u32 s58, s58, 1
    s_cbranch_scc1 layerb1_kernel_bail
    buffer_load_dwordx4 v[124:127], v1, s[8:11], s57 offen sc1
    s_waitcnt vmcnt(0)
    s_branch layerb1_kernel_gk_spoll
layerb1_kernel_gk_sok:
    s_min_u32 s24, s14, 63
    s_mul_i32 s24, s24, 40960
    s_add_u32 s24, s24, s19
    s_mul_i32 s25, s13, 10240
    s_add_u32 s25, s25, s22
    s_mov_b32 m0, s25
    s_nop 0
    buffer_load_dwordx4 v1, s[8:11], s24 offen offset:0 sc1 lds
    buffer_load_dwordx4 v1, s[8:11], s24 offen offset:1024 sc1 lds
    buffer_load_dwordx4 v1, s[8:11], s24 offen offset:2048 sc1 lds
    buffer_load_dwordx4 v1, s[8:11], s24 offen offset:3072 sc1 lds
    s_add_u32 s24, s24, 4096
    s_add_u32 s25, s25, 4096
    s_mov_b32 m0, s25
    s_nop 0
    buffer_load_dwordx4 v1, s[8:11], s24 offen offset:0 sc1 lds
    buffer_load_dwordx4 v1, s[8:11], s24 offen offset:1024 sc1 lds
    buffer_load_dwordx4 v1, s[8:11], s24 offen offset:2048 sc1 lds
    buffer_load_dwordx4 v1, s[8:11], s24 offen offset:3072 sc1 lds
    s_add_u32 s24, s24, 4096
    s_add_u32 s25, s25, 4096
    s_mov_b32 m0, s25
    s_nop 0
    buffer_load_dwordx4 v1, s[8:11], s24 offen offset:0 sc1 lds
    buffer_load_dwordx4 v1, s[8:11], s24 offen offset:1024 sc1 lds
    s_mov_b32 s16, s22
    s_add_u32 s22, s22, 40960
    s_cmp_eq_u32 s22, 122880
    s_cselect_b32 s22, 0, s22
    v_add_u32 v2, s16, v1
    s_waitcnt vmcnt(0)
    s_barrier
    ds_read_b128 v[8:11], v2 offset:0
    ds_read_b128 v[12:15], v2 offset:1024
    ds_read_b128 v[16:19], v2 offset:2048
    ds_read_b128 v[20:23], v2 offset:3072
    ds_read_b128 v[24:27], v2 offset:4096
    ds_read_b128 v[28:31], v2 offset:5120
    s_cmp_lt_u32 s14, 3
    s_cbranch_scc1 layerb1_kernel_gk_solo
    ds_read_b128 v[32:35], v2 offset:6144
    s_waitcnt lgkmcnt(6)
    v_mfma_f32_32x32x16_bf16 v[72:87], a[0:3], v[8:11], 0
    v_mfma_f32_32x32x16_bf16 v[88:103], a[4:7], v[8:11], 0
    ds_read_b128 v[36:39], v2 offset:7168
    s_waitcnt lgkmcnt(6)
    v_mfma_f32_32x32x16_bf16 v[72:87], a[8:11], v[12:15], v[72:87]
    v_mfma_f32_32x32x16_bf16 v[88:103], a[12:15], v[12:15], v[88:103]
    ds_read_b128 v[8:11], v2 offset:8192
    s_waitcnt lgkmcnt(6)
    v_mfma_f32_32x32x16_bf16 v[72:87], a[16:19], v[16:19], v[72:87]
    v_mfma_f32_32x32x16_bf16 v[88:103], a[20:23], v[16:19], v[88:103]
    s_add_u32 s23, s14, 1
    s_cmp_lg_u32 s13, 0
    s_cbranch_scc1 layerb1_kernel_gk_lw3
    s_min_u32 s28, s23, 63
    s_cmp_gt_u32 s56, s28
    s_cbranch_scc1 layerb1_kernel_gk_lw3
layerb1_kernel_gk_lp3:
    buffer_load_dwordx4 v[124:127], v1, s[8:11], s57 offen sc1
    s_waitcnt vmcnt(0)
    v_min_u32 v124, v124, v125
    v_min_u32 v126, v126, v127
    v_min_u32 v124, v124, v126
    v_cmp_eq_u32 vcc, 0, v124
    s_nop 1
    s_ff1_i32_b64 s56, vcc
    s_min_u32 s56, s56, 64
    s_sub_u32 s58, s58, 1
    s_cbranch_scc1 layerb1_kernel_bail
    s_cmp_gt_u32 s56, s28
    s_cbranch_scc0 layerb1_kernel_gk_lp3
layerb1_kernel_gk_lw3:
    s_barrier
    s_min_u32 s24, s23, 63
    s_mul_i32 s24, s24, 40960
    s_add_u32 s24, s24, s19
    s_mul_i32 s25, s13, 10240
    s_add_u32 s25, s25, s22
    s_add_u32 s22, s22, 40960
    s_cmp_eq_u32 s22, 122880
    s_cselect_b32 s22, 0, s22
    ds_read_b128 v[12:15], v2 offset:9216
    s_waitcnt lgkmcnt(6)
    v_mfma_f32_32x32x16_bf16 v[72:87], a[24:27], v[20:23], v[72:87]
    s_mov_b32 m0, s25
    s_nop 0
    buffer_load_dwordx4 v1, s[8:11], s24 offen offset:0 sc1 lds
    v_mfma_f32_32x32x16_bf16 v[88:103], a[28:31], v[20:23], v[88:103]
    ds_read_b128 v[16:19], v2 offset:10240
    s_waitcnt lgkmcnt(6)
    v_mfma_f32_32x32x16_bf16 v[72:87], a[32:35], v[24:27], v[72:87]
    buffer_load_dwordx4 v1, s[8:11], s24 offen offset:1024 sc1 lds
    v_mfma_f32_32x32x16_bf16 v[88:103], a[36:39], v[24:27], v[88:103]
    ds_read_b128 v[20:23], v2 offset:11264
    s_waitcnt lgkmcnt(6)
    v_mfma_f32_32x32x16_bf16 v[72:87], a[40:43], v[28:31], v[72:87]
    buffer_load_dwordx4 v1, s[8:11], s24 offen offset:2048 sc1 lds
    v_mfma_f32_32x32x16_bf16 v[88:103], a[44:47], v[28:31], v[88:103]
    ds_read_b128 v[24:27], v2 offset:12288
    s_waitcnt lgkmcnt(6)
    v_mfma_f32_32x32x16_bf16 v[72:87], a[48:51], v[32:35], v[72:87]
    buffer_load_dwordx4 v1, s[8:11], s24 offen offset:3072 sc1 lds
    v_mfma_f32_32x32x16_bf16 v[88:103], a[52:55], v[32:35], v[88:103]
    ds_read_b128 v[28:31], v2 offset:13312
    s_waitcnt lgkmcnt(6)
    v_mfma_f32_32x32x16_bf16 v[72:87], a[56:59], v[36:39], v[72:87]
    s_add_u32 s24, s24, 4096
    s_add_u32 s25, s25, 4096
    s_mov_b32 m0, s25
    s_nop 0
    buffer_load_dwordx4 v1, s[8:11], s24 offen offset:0 sc1 lds
    v_mfma_f32_32x32x16_bf16 v[88:103], a[60:63], v[36:39], v[88:103]
    ds_read_b128 v[32:35], v2 offset:14336
    s_waitcnt lgkmcnt(6)
    v_mfma_f32_32x32x16_bf16 v[72:87], a[64:67], v[8:11], v[72:87]
    buffer_load_dwordx4 v1, s[8:11], s24 offen offset:1024 sc1 lds
    v_mfma_f32_32x32x16_bf16 v[88:103], a[68:71], v[8:11], v[88:103]
    ds_read_b128 v[36:39], v2 offset:15360
    s_waitcnt lgkmcnt(6)
    v_mfma_f32_32x32x16_bf16 v[72:87], a[72:75], v[12:15], v[72:87]
    buffer_load_dwordx4 v1, s[8:11], s24 offen offset:2048 sc1 lds
    v_mfma_f32_32x32x16_bf16 v[88:103], a[76:79], v[12:15], v[88:103]
    ds_read_b128 v[8:11], v2 offset:16384
    s_waitcnt lgkmcnt(6)
    v_mfma_f32_32x32x16_bf16 v[72:87], a[80:83], v[16:19], v[72:87]
    buffer_load_dwordx4 v1, s[8:11], s24 offen offset:3072 sc1 lds
    v_mfma_f32_32x32x16_bf16 v[88:103], a[84:87], v[16:19], v[88:103]
    ds_read_b128 v[12:15], v2 offset:17408
    s_waitcnt lgkmcnt(6)
    v_mfma_f32_32x32x16_bf16 v[72:87], a[88:91], v[20:23], v[72:87]
    s_add_u32 s24, s24, 4096
    s_add_u32 s25, s25, 4096
    s_mov_b32 m0, s25
    s_nop 0
    buffer_load_dwordx4 v1, s[8:11], s24 offen offset:0 sc1 lds
    v_mfma_f32_32x32x16_bf16 v[88:103], a[92:95], v[20:23], v[88:103]
    ds_read_b128 v[16:19], v2 offset:18432
    s_waitcnt lgkmcnt(6)
    v_mfma_f32_32x32x16_bf16 v[72:87], a[96:99], v[24:27], v[72:87]
    buffer_load_dwordx4 v1, s[8:11], s24 offen offset:1024 sc1 lds
    v_mfma_f32_32x32x16_bf16 v[88:103], a[100:103], v[24:27], v[88:103]
    ds_read_b128 v[20:23], v2 offset:19456
    s_waitcnt lgkmcnt(6)
    v_mfma_f32_32x32x16_bf16 v[72:87], a[104:107], v[28:31], v[72:87]
    v_mfma_f32_32x32x16_bf16 v[88:103], a[108:111], v[28:31], v[88:103]
    ds_read_b128 v[24:27], v2 offset:20480
    s_waitcnt lgkmcnt(6)
    v_mfma_f32_32x32x16_bf16 v[72:87], a[112:115], v[32:35], v[72:87]
    v_mfma_f32_32x32x16_bf16 v[88:103], a[116:119], v[32:35], v[88:103]
    ds_read_b128 v[28:31], v2 offset:21504
    s_waitcnt lgkmcnt(6)
    v_mfma_f32_32x32x16_bf16 v[72:87], a[120:123], v[36:39], v[72:87]
    v_mfma_f32_32x32x16_bf16 v[88:103], a[124:127], v[36:39], v[88:103]
    ds_read_b128 v[32:35], v2 offset:22528
    s_waitcnt lgkmcnt(6)
    v_mfma_f32_32x32x16_bf16 v[72:87], a[128:131], v[8:11], v[72:87]
    v_mfma_f32_32x32x16_bf16 v[88:103], a[132:135], v[8:11], v[88:103]
    ds_read_b128 v[36:39], v2 offset:23552
    s_waitcnt lgkmcnt(6)
    v_mfma_f32_32x32x16_bf16 v[72:87], a[136:139], v[12:15], v[72:87]
    v_mfma_f32_32x32x16_bf16 v[88:103], a[140:143], v[12:15], v[88:103]
    ds_read_b128 v[8:11], v2 offset:24576
    s_waitcnt lgkmcnt(6)
    v_mfma_f32_32x32x16_bf16 v[72:87], a[144:147], v[16:19], v[72:87]
    v_mfma_f32_32x32x16_bf16 v[88:103], a[148:151], v[16:19], v[88:103]
    ds_read_b128 v[12:15], v2 offset:25600
    s_waitcnt lgkmcnt(6)
    v_mfma_f32_32x32x16_bf16 v[72:87], a[152:155], v[20:23], v[72:87]
    v_mfma_f32_32x32x16_bf16 v[88:103], a[156:159], v[20:23], v[88:103]
    ds_read_b128 v[16:19], v2 offset:26624
    s_waitcnt lgkmcnt(6)
    v_mfma_f32_32x32x16_bf16 v[72:87], a[160:163], v[24:27], v[72:87]
    v_mfma_f32_32x32x16_bf16 v[88:103], a[164:167], v[24:27], v[88:103]
    ds_read_b128 v[20:23], v2 offset:27648
    s_waitcnt lgkmcnt(6)
    v_mfma_f32_32x32x16_bf16 v[72:87], a[168:171], v[28:31], v[72:87]
    v_mfma_f32_32x32x16_bf16 v[88:103], a[172:175], v[28:31], v[88:103]
    ds_read_b128 v[24:27], v2 offset:28672
    s_waitcnt lgkmcnt(6)
    v_mfma_f32_32x32x16_bf16 v[72:87], a[176:179], v[32:35], v[72:87]
    v_mfma_f32_32x32x16_bf16 v[88:103], a[180:183], v[32:35], v[88:103]
    ds_read_b128 v[28:31], v2 offset:29696
    s_waitcnt lgkmcnt(6)
    v_mfma_f32_32x32x16_bf16 v[72:87], a[184:187], v[36:39], v[72:87]
    v_mfma_f32_32x32x16_bf16 v[88:103], a[188:191], v[36:39], v[88:103]
    ds_read_b128 v[32:35], v2 offset:30720
    s_waitcnt lgkmcnt(6)
    v_mfma_f32_32x32x16_bf16 v[72:87], a[192:195], v[8:11], v[72:87]
    v_mfma_f32_32x32x16_bf16 v[88:103], a[196:199], v[8:11], v[88:103]
    ds_read_b128 v[36:39], v2 offset:31744
    s_waitcnt lgkmcnt(6)
    v_mfma_f32_32x32x16_bf16 v[72:87], a[200:203], v[12:15], v[72:87]
    v_mfma_f32_32x32x16_bf16 v[88:103], a[204:207], v[12:15], v[88:103]
    ds_read_b128 v[8:11], v2 offset:32768
    s_waitcnt lgkmcnt(6)
    v_mfma_f32_32x32x16_bf16 v[72:87], a[208:211], v[16:19], v[72:87]
    v_mfma_f32_32x32x16_bf16 v[88:103], a[212:215], v[16:19], v[88:103]
    ds_read_b128 v[12:15], v2 offset:33792
    s_waitcnt lgkmcnt(6)
    v_mfma_f32_32x32x16_bf16 v[72:87], a[216:219], v[20:23], v[72:87]
    v_mfma_f32_32x32x16_bf16 v[88:103], a[220:223], v[20:23], v[88:103]
    ds_read_b128 v[16:19], v2 offset:34816
    s_waitcnt lgkmcnt(6)
    v_mfma_f32_32x32x16_bf16 v[72:87], a[224:227], v[24:27], v[72:87]
    v_mfma_f32_32x32x16_bf16 v[88:103], a[228:231], v[24:27], v[88:103]
    s_add_u32 s23, s14, 2
    s_cmp_lg_u32 s13, 0
    s_cbranch_scc1 layerb1_kernel_gk_lw4
    s_min_u32 s28, s23, 63
    s_cmp_gt_u32 s56, s28
    s_cbranch_scc1 layerb1_kernel_gk_lw4
layerb1_kernel_gk_lp4:
    buffer_load_dwordx4 v[124:127], v1, s[8:11], s57 offen sc1
    s_waitcnt vmcnt(0)
    v_min_u32 v124, v124, v125
    v_min_u32 v126, v126, v127
    v_min_u32 v124, v124, v126
    v_cmp_eq_u32 vcc, 0, v124
    s_nop 1
    s_ff1_i32_b64 s56, vcc
    s_min_u32 s56, s56, 64
    s_sub_u32 s58, s58, 1
    s_cbranch_scc1 layerb1_kernel_bail
    s_cmp_gt_u32 s56, s28
    s_cbranch_scc0 layerb1_kernel_gk_lp4
layerb1_kernel_gk_lw4:
    s_waitcnt vmcnt(0)
    s_barrier
    s_add_u32 s21, s16, 40960
    s_cmp_eq_u32 s21, 122880
    s_cselect_b32 s21, 0, s21
    s_add_u32 s23, s14, 2
    s_min_u32 s24, s23, 63
    s_mul_i32 s24, s24, 40960
    s_add_u32 s24, s24, s19
    s_mul_i32 s25, s13, 10240
    s_add_u32 s25, s25, s22
    s_add_u32 s22, s22, 40960
    s_cmp_eq_u32 s22, 122880
    s_cselect_b32 s22, 0, s22
    ds_read_b128 v[20:23], v2 offset:35840
    s_waitcnt lgkmcnt(6)
    v_mfma_f32_32x32x16_bf16 v[72:87], a[232:235], v[28:31], v[72:87]
    s_mov_b32 m0, s25
    s_nop 0
    buffer_load_dwordx4 v1, s[8:11], s24 offen offset:0 sc1 lds
    v_mfma_f32_32x32x16_bf16 v[88:103], a[236:239], v[28:31], v[88:103]
    ds_read_b128 v[24:27], v2 offset:36864
    s_waitcnt lgkmcnt(6)
    v_mfma_f32_32x32x16_bf16 v[72:87], a[240:243], v[32:35], v[72:87]
    buffer_load_dwordx4 v1, s[8:11], s24 offen offset:1024 sc1 lds
    v_mfma_f32_32x32x16_bf16 v[88:103], a[244:247], v[32:35], v[88:103]
    ds_read_b128 v[28:31], v2 offset:37888
    s_waitcnt lgkmcnt(6)
    v_mfma_f32_32x32x16_bf16 v[72:87], a[248:251], v[36:39], v[72:87]
    buffer_load_dwordx4 v1, s[8:11], s24 offen offset:2048 sc1 lds
    v_mfma_f32_32x32x16_bf16 v[88:103], a[252:255], v[36:39], v[88:103]
    ds_read_b128 v[32:35], v2 offset:38912
    s_waitcnt lgkmcnt(6)
    v_mfma_f32_32x32x16_bf16 v[72:87], v[192:195], v[8:11], v[72:87]
    buffer_load_dwordx4 v1, s[8:11], s24 offen offset:3072 sc1 lds
    v_mfma_f32_32x32x16_bf16 v[88:103], v[196:199], v[8:11], v[88:103]
    ds_read_b128 v[36:39], v2 offset:39936
    s_waitcnt lgkmcnt(6)
    v_mfma_f32_32x32x16_bf16 v[72:87], v[200:203], v[12:15], v[72:87]
    s_add_u32 s24, s24, 4096
    s_add_u32 s25, s25, 4096
    s_mov_b32 m0, s25
    s_nop 0
    buffer_load_dwordx4 v1, s[8:11], s24 offen offset:0 sc1 lds
    v_mfma_f32_32x32x16_bf16 v[88:103], v[204:207], v[12:15], v[88:103]
    v_add_u32 v6, s21, v1
    ds_read_b128 v[8:11], v6 offset:0
    s_waitcnt lgkmcnt(6)
    v_mfma_f32_32x32x16_bf16 v[72:87], v[208:211], v[16:19], v[72:87]
    buffer_load_dwordx4 v1, s[8:11], s24 offen offset:1024 sc1 lds
    v_mfma_f32_32x32x16_bf16 v[88:103], v[212:215], v[16:19], v[88:103]
    ds_read_b128 v[12:15], v6 offset:1024
    s_waitcnt lgkmcnt(6)
    v_mfma_f32_32x32x16_bf16 v[72:87], v[216:219], v[20:23], v[72:87]
    buffer_load_dwordx4 v1, s[8:11], s24 offen offset:2048 sc1 lds
    v_mfma_f32_32x32x16_bf16 v[88:103], v[220:223], v[20:23], v[88:103]
    ds_read_b128 v[16:19], v6 offset:2048
    s_waitcnt lgkmcnt(6)
    v_mfma_f32_32x32x16_bf16 v[72:87], v[224:227], v[24:27], v[72:87]
    buffer_load_dwordx4 v1, s[8:11], s24 offen offset:3072 sc1 lds
    v_mfma_f32_32x32x16_bf16 v[88:103], v[228:231], v[24:27], v[88:103]
    ds_read_b128 v[20:23], v6 offset:3072
    s_waitcnt lgkmcnt(6)
    v_mfma_f32_32x32x16_bf16 v[72:87], v[232:235], v[28:31], v[72:87]
    s_add_u32 s24, s24, 4096
    s_add_u32 s25, s25, 4096
    s_mov_b32 m0, s25
    s_nop 0
    buffer_load_dwordx4 v1, s[8:11], s24 offen offset:0 sc1 lds
    v_mfma_f32_32x32x16_bf16 v[88:103], v[236:239], v[28:31], v[88:103]
    ds_read_b128 v[24:27], v6 offset:4096
    s_waitcnt lgkmcnt(6)
    v_mfma_f32_32x32x16_bf16 v[72:87], v[240:243], v[32:35], v[72:87]
    buffer_load_dwordx4 v1, s[8:11], s24 offen offset:1024 sc1 lds
    v_mfma_f32_32x32x16_bf16 v[88:103], v[244:247], v[32:35], v[88:103]
    ds_read_b128 v[28:31], v6 offset:5120
    s_waitcnt lgkmcnt(6)
    v_mfma_f32_32x32x16_bf16 v[72:87], v[248:251], v[36:39], v[72:87]
    v_mfma_f32_32x32x16_bf16 v[88:103], v[252:255], v[36:39], v[88:103]
    v_mov_b32 v2, v6
    s_mov_b32 s16, s21
    s_add_u32 s14, s14, 1
layerb1_kernel_gk_loop:
    ds_read_b128 v[32:35], v2 offset:6144
    s_waitcnt lgkmcnt(6)
    v_mfma_f32_32x32x16_bf16 v[40:55], a[0:3], v[8:11], 0
    v_mfma_f32_32x32x16_bf16 v[56:71], a[4:7], v[8:11], 0
    ds_read_b128 v[36:39], v2 offset:7168
    s_waitcnt lgkmcnt(6)
    v_mfma_f32_32x32x16_bf16 v[40:55], a[8:11], v[12:15], v[40:55]
    v_mfma_f32_32x32x16_bf16 v[56:71], a[12:15], v[12:15], v[56:71]
    ds_read_b128 v[8:11], v2 offset:8192
    s_waitcnt lgkmcnt(6)
    v_mfma_f32_32x32x16_bf16 v[40:55], a[16:19], v[16:19], v[40:55]
    v_cvt_pk_bf16_f32 v104, v72, v73
    v_mfma_f32_32x32x16_bf16 v[56:71], a[20:23], v[16:19], v[56:71]
    v_cvt_pk_bf16_f32 v105, v74, v75
    ds_read_b128 v[12:15], v2 offset:9216
    s_waitcnt lgkmcnt(6)
    v_mfma_f32_32x32x16_bf16 v[40:55], a[24:27], v[20:23], v[40:55]
    v_cvt_pk_bf16_f32 v106, v76, v77
    v_mfma_f32_32x32x16_bf16 v[56:71], a[28:31], v[20:23], v[56:71]
    v_cvt_pk_bf16_f32 v107, v78, v79
    ds_read_b128 v[16:19], v2 offset:10240
    s_waitcnt lgkmcnt(6)
    v_mfma_f32_32x32x16_bf16 v[40:55], a[32:35], v[24:27], v[40:55]
    s_nop 1
    v_mfma_f32_32x32x16_bf16 v[56:71], a[36:39], v[24:27], v[56:71]
    v_permlane32_swap_b32 v104, v106
    ds_read_b128 v[20:23], v2 offset:11264
    s_waitcnt lgkmcnt(6)
    v_mfma_f32_32x32x16_bf16 v[40:55], a[40:43], v[28:31], v[40:55]
    v_permlane32_swap_b32 v105, v107
    v_mfma_f32_32x32x16_bf16 v[56:71], a[44:47], v[28:31], v[56:71]
    buffer_store_dwordx4 v[104:107], v3, s[8:11], s17 offen offset:0 sc1
    ds_read_b128 v[24:27], v2 offset:12288
    s_waitcnt lgkmcnt(6)
    v_mfma_f32_32x32x16_bf16 v[40:55], a[48:51], v[32:35], v[40:55]
    v_cvt_pk_bf16_f32 v108, v80, v81
    v_mfma_f32_32x32x16_bf16 v[56:71], a[52:55], v[32:35], v[56:71]
    v_cvt_pk_bf16_f32 v109, v82, v83
    ds_read_b128 v[28:31], v2 offset:13312
    s_waitcnt lgkmcnt(6)
    v_mfma_f32_32x32x16_bf16 v[40:55], a[56:59], v[36:39], v[40:55]
    v_cvt_pk_bf16_f32 v110, v84, v85
    v_mfma_f32_32x32x16_bf16 v[56:71], a[60:63], v[36:39], v[56:71]
    v_cvt_pk_bf16_f32 v111, v86, v87
    ds_read_b128 v[32:35], v2 offset:14336
    s_waitcnt lgkmcnt(6)
    v_mfma_f32_32x32x16_bf16 v[40:55], a[64:67], v[8:11], v[40:55]
    s_nop 1
    v_mfma_f32_32x32x16_bf16 v[56:71], a[68:71], v[8:11], v[56:71]
    v_permlane32_swap_b32 v108, v110
    ds_read_b128 v[36:39], v2 offset:15360
    s_waitcnt lgkmcnt(6)
    v_mfma_f32_32x32x16_bf16 v[40:55], a[72:75], v[12:15], v[40:55]
    v_permlane32_swap_b32 v109, v111
    v_mfma_f32_32x32x16_bf16 v[56:71], a[76:79], v[12:15], v[56:71]
    buffer_store_dwordx4 v[108:111], v3, s[8:11], s17 offen offset:1024 sc1
    ds_read_b128 v[8:11], v2 offset:16384
    s_waitcnt lgkmcnt(6)
    v_mfma_f32_32x32x16_bf16 v[40:55], a[80:83], v[16:19], v[40:55]
    v_cvt_pk_bf16_f32 v112, v88, v89
    v_mfma_f32_32x32x16_bf16 v[56:71], a[84:87], v[16:19], v[56:71]
    v_cvt_pk_bf16_f32 v113, v90, v91
    ds_read_b128 v[12:15], v2 offset:17408
    s_waitcnt lgkmcnt(6)
    v_mfma_f32_32x32x16_bf16 v[40:55], a[88:91], v[20:23], v[40:55]
    v_cvt_pk_bf16_f32 v114, v92, v93
    v_mfma_f32_32x32x16_bf16 v[56:71], a[92:95], v[20:23], v[56:71]
    v_cvt_pk_bf16_f32 v115, v94, v95
    ds_read_b128 v[16:19], v2 offset:18432
    s_waitcnt lgkmcnt(6)
    v_mfma_f32_32x32x16_bf16 v[40:55], a[96:99], v[24:27], v[40:55]
    s_nop 1
    v_mfma_f32_32x32x16_bf16 v[56:71], a[100:103], v[24:27], v[56:71]
    v_permlane32_swap_b32 v112, v114
    ds_read_b128 v[20:23], v2 offset:19456
    s_waitcnt lgkmcnt(6)
    v_mfma_f32_32x32x16_bf16 v[40:55], a[104:107], v[28:31], v[40:55]
    v_permlane32_swap_b32 v113, v115
    v_mfma_f32_32x32x16_bf16 v[56:71], a[108:111], v[28:31], v[56:71]
    buffer_store_dwordx4 v[112:115], v3, s[8:11], s18 offen offset:0 sc1
    ds_read_b128 v[24:27], v2 offset:20480
    s_waitcnt lgkmcnt(6)
    v_mfma_f32_32x32x16_bf16 v[40:55], a[112:115], v[32:35], v[40:55]
    v_cvt_pk_bf16_f32 v116, v96, v97
    v_mfma_f32_32x32x16_bf16 v[56:71], a[116:119], v[32:35], v[56:71]
    v_cvt_pk_bf16_f32 v117, v98, v99
    ds_read_b128 v[28:31], v2 offset:21504
    s_waitcnt lgkmcnt(6)
    v_mfma_f32_32x32x16_bf16 v[40:55], a[120:123], v[36:39], v[40:55]
    v_cvt_pk_bf16_f32 v118, v100, v101
    v_mfma_f32_32x32x16_bf16 v[56:71], a[124:127], v[36:39], v[56:71]
    v_cvt_pk_bf16_f32 v119, v102, v103
    ds_read_b128 v[32:35], v2 offset:22528
    s_waitcnt lgkmcnt(6)
    v_mfma_f32_32x32x16_bf16 v[40:55], a[128:131], v[8:11], v[40:55]
    s_nop 1
    v_mfma_f32_32x32x16_bf16 v[56:71], a[132:135], v[8:11], v[56:71]
    v_permlane32_swap_b32 v116, v118
    ds_read_b128 v[36:39], v2 offset:23552
    s_waitcnt lgkmcnt(6)
    v_mfma_f32_32x32x16_bf16 v[40:55], a[136:139], v[12:15], v[40:55]
    v_permlane32_swap_b32 v117, v119
    v_mfma_f32_32x32x16_bf16 v[56:71], a[140:143], v[12:15], v[56:71]
    buffer_store_dwordx4 v[116:119], v3, s[8:11], s18 offen offset:1024 sc1
    ds_read_b128 v[8:11], v2 offset:24576
    s_waitcnt lgkmcnt(6)
    v_mfma_f32_32x32x16_bf16 v[40:55], a[144:147], v[16:19], v[40:55]
    s_add_u32 s17, s17, s20
    v_mfma_f32_32x32x16_bf16 v[56:71], a[148:151], v[16:19], v[56:71]
    s_add_u32 s18, s18, s20
    ds_read_b128 v[12:15], v2 offset:25600
    s_waitcnt lgkmcnt(6)
    v_mfma_f32_32x32x16_bf16 v[40:55], a[152:155], v[20:23], v[40:55]
    v_mfma_f32_32x32x16_bf16 v[56:71], a[156:159], v[20:23], v[56:71]
    ds_read_b128 v[16:19], v2 offset:26624
    s_waitcnt lgkmcnt(6)
    v_mfma_f32_32x32x16_bf16 v[40:55], a[160:163], v[24:27], v[40:55]
    v_mfma_f32_32x32x16_bf16 v[56:71], a[164:167], v[24:27], v[56:71]
    ds_read_b128 v[20:23], v2 offset:27648
    s_waitcnt lgkmcnt(6)
    v_mfma_f32_32x32x16_bf16 v[40:55], a[168:171], v[28:31], v[40:55]
    v_mfma_f32_32x32x16_bf16 v[56:71], a[172:175], v[28:31], v[56:71]
    ds_read_b128 v[24:27], v2 offset:28672
    s_waitcnt lgkmcnt(6)
    v_mfma_f32_32x32x16_bf16 v[40:55], a[176:179], v[32:35], v[40:55]
    v_mfma_f32_32x32x16_bf16 v[56:71], a[180:183], v[32:35], v[56:71]
    ds_read_b128 v[28:31], v2 offset:29696
    s_waitcnt lgkmcnt(6)
    v_mfma_f32_32x32x16_bf16 v[40:55], a[184:187], v[36:39], v[40:55]
    v_mfma_f32_32x32x16_bf16 v[56:71], a[188:191], v[36:39], v[56:71]
    ds_read_b128 v[32:35], v2 offset:30720
    s_waitcnt lgkmcnt(6)
    v_mfma_f32_32x32x16_bf16 v[40:55], a[192:195], v[8:11], v[40:55]
    v_mfma_f32_32x32x16_bf16 v[56:71], a[196:199], v[8:11], v[56:71]
    ds_read_b128 v[36:39], v2 offset:31744
    s_waitcnt lgkmcnt(6)
    v_mfma_f32_32x32x16_bf16 v[40:55], a[200:203], v[12:15], v[40:55]
    v_mfma_f32_32x32x16_bf16 v[56:71], a[204:207], v[12:15], v[56:71]
    ds_read_b128 v[8:11], v2 offset:32768
    s_waitcnt lgkmcnt(6)
    v_mfma_f32_32x32x16_bf16 v[40:55], a[208:211], v[16:19], v[40:55]
    v_mfma_f32_32x32x16_bf16 v[56:71], a[212:215], v[16:19], v[56:71]
    ds_read_b128 v[12:15], v2 offset:33792
    s_waitcnt lgkmcnt(6)
    v_mfma_f32_32x32x16_bf16 v[40:55], a[216:219], v[20:23], v[40:55]
    v_mfma_f32_32x32x16_bf16 v[56:71], a[220:223], v[20:23], v[56:71]
    ds_read_b128 v[16:19], v2 offset:34816
    s_waitcnt lgkmcnt(6)
    v_mfma_f32_32x32x16_bf16 v[40:55], a[224:227], v[24:27], v[40:55]
    v_mfma_f32_32x32x16_bf16 v[56:71], a[228:231], v[24:27], v[56:71]
    s_add_u32 s23, s14, 2
    s_cmp_lg_u32 s13, 0
    s_cbranch_scc1 layerb1_kernel_gk_lw5
    s_min_u32 s28, s23, 63
    s_cmp_gt_u32 s56, s28
    s_cbranch_scc1 layerb1_kernel_gk_lw5
layerb1_kernel_gk_lp5:
    buffer_load_dwordx4 v[124:127], v1, s[8:11], s57 offen sc1
    s_waitcnt vmcnt(0)
    v_min_u32 v124, v124, v125
    v_min_u32 v126, v126, v127
    v_min_u32 v124, v124, v126
    v_cmp_eq_u32 vcc, 0, v124
    s_nop 1
    s_ff1_i32_b64 s56, vcc
    s_min_u32 s56, s56, 64
    s_sub_u32 s58, s58, 1
    s_cbranch_scc1 layerb1_kernel_bail
    s_cmp_gt_u32 s56, s28
    s_cbranch_scc0 layerb1_kernel_gk_lp5
layerb1_kernel_gk_lw5:
    s_cmp_gt_u32 s14, 5
    s_cbranch_scc1 layerb1_kernel_gk_dr6
    s_waitcnt vmcnt(0)
    s_mov_b32 s27, s14
    s_branch layerb1_kernel_gk_dq6
layerb1_kernel_gk_dr6:
    s_waitcnt vmcnt(4)
    s_sub_u32 s27, s14, 1
layerb1_kernel_gk_dq6:
    s_barrier
    s_cmp_lg_u32 s13, 0
    s_cbranch_scc1 layerb1_kernel_gk_fl7
    s_mov_b64 exec, 1
    s_lshl_b32 s26, s12, 7
    v_mov_b32 v7, s26
    v_mov_b32 v120, s27
    buffer_store_dword v120, v7, s[8:11], s48 offen sc1
    s_mov_b64 exec, -1
layerb1_kernel_gk_fl7:
    s_add_u32 s21, s16, 40960
    s_cmp_eq_u32 s21, 122880
    s_cselect_b32 s21, 0, s21
    s_add_u32 s23, s14, 2
    s_min_u32 s24, s23, 63
    s_mul_i32 s24, s24, 40960
    s_add_u32 s24, s24, s19
    s_mul_i32 s25, s13, 10240
    s_add_u32 s25, s25, s22
    s_add_u32 s22, s22, 40960
    s_cmp_eq_u32 s22, 122880
    s_cselect_b32 s22, 0, s22
    ds_read_b128 v[20:23], v2 offset:35840
    s_waitcnt lgkmcnt(6)
    v_mfma_f32_32x32x16_bf16 v[40:55], a[232:235], v[28:31], v[40:55]
    s_mov_b32 m0, s25
    s_nop 0
    buffer_load_dwordx4 v1, s[8:11], s24 offen offset:0 sc1 lds
    v_mfma_f32_32x32x16_bf16 v[56:71], a[236:239], v[28:31], v[56:71]
    ds_read_b128 v[24:27], v2 offset:36864
    s_waitcnt lgkmcnt(6)
    v_mfma_f32_32x32x16_bf16 v[40:55], a[240:243], v[32:35], v[40:55]
    buffer_load_dwordx4 v1, s[8:11], s24 offen offset:1024 sc1 lds
    v_mfma_f32_32x32x16_bf16 v[56:71], a[244:247], v[32:35], v[56:71]
    ds_read_b128 v[28:31], v2 offset:37888
    s_waitcnt lgkmcnt(6)
    v_mfma_f32_32x32x16_bf16 v[40:55], a[248:251], v[36:39], v[40:55]
    buffer_load_dwordx4 v1, s[8:11], s24 offen offset:2048 sc1 lds
    v_mfma_f32_32x32x16_bf16 v[56:71], a[252:255], v[36:39], v[56:71]
    ds_read_b128 v[32:35], v2 offset:38912
    s_waitcnt lgkmcnt(6)
    v_mfma_f32_32x32x16_bf16 v[40:55], v[192:195], v[8:11], v[40:55]
    buffer_load_dwordx4 v1, s[8:11], s24 offen offset:3072 sc1 lds
    v_mfma_f32_32x32x16_bf16 v[56:71], v[196:199], v[8:11], v[56:71]
    ds_read_b128 v[36:39], v2 offset:39936
    s_waitcnt lgkmcnt(6)
    v_mfma_f32_32x32x16_bf16 v[40:55], v[200:203], v[12:15], v[40:55]
    s_add_u32 s24, s24, 4096
    s_add_u32 s25, s25, 4096
    s_mov_b32 m0, s25
    s_nop 0
    buffer_load_dwordx4 v1, s[8:11], s24 offen offset:0 sc1 lds
    v_mfma_f32_32x32x16_bf16 v[56:71], v[204:207], v[12:15], v[56:71]
    v_add_u32 v6, s21, v1
    ds_read_b128 v[8:11], v6 offset:0
    s_waitcnt lgkmcnt(6)
    v_mfma_f32_32x32x16_bf16 v[40:55], v[208:211], v[16:19], v[40:55]
    buffer_load_dwordx4 v1, s[8:11], s24 offen offset:1024 sc1 lds
    v_mfma_f32_32x32x16_bf16 v[56:71], v[212:215], v[16:19], v[56:71]
    ds_read_b128 v[12:15], v6 offset:1024
    s_waitcnt lgkmcnt(6)
    v_mfma_f32_32x32x16_bf16 v[40:55], v[216:219], v[20:23], v[40:55]
    buffer_load_dwordx4 v1, s[8:11], s24 offen offset:2048 sc1 lds
    v_mfma_f32_32x32x16_bf16 v[56:71], v[220:223], v[20:23], v[56:71]
    ds_read_b128 v[16:19], v6 offset:2048
    s_waitcnt lgkmcnt(6)
    v_mfma_f32_32x32x16_bf16 v[40:55], v[224:227], v[24:27], v[40:55]
    buffer_load_dwordx4 v1, s[8:11], s24 offen offset:3072 sc1 lds
    v_mfma_f32_32x32x16_bf16 v[56:71], v[228:231], v[24:27], v[56:71]
    ds_read_b128 v[20:23], v6 offset:3072
    s_waitcnt lgkmcnt(6)
    v_mfma_f32_32x32x16_bf16 v[40:55], v[232:235], v[28:31], v[40:55]
    s_add_u32 s24, s24, 4096
    s_add_u32 s25, s25, 4096
    s_mov_b32 m0, s25
    s_nop 0
    buffer_load_dwordx4 v1, s[8:11], s24 offen offset:0 sc1 lds
    v_mfma_f32_32x32x16_bf16 v[56:71], v[236:239], v[28:31], v[56:71]
    ds_read_b128 v[24:27], v6 offset:4096
    s_waitcnt lgkmcnt(6)
    v_mfma_f32_32x32x16_bf16 v[40:55], v[240:243], v[32:35], v[40:55]
    buffer_load_dwordx4 v1, s[8:11], s24 offen offset:1024 sc1 lds
    v_mfma_f32_32x32x16_bf16 v[56:71], v[244:247], v[32:35], v[56:71]
    ds_read_b128 v[28:31], v6 offset:5120
    s_waitcnt lgkmcnt(6)
    v_mfma_f32_32x32x16_bf16 v[40:55], v[248:251], v[36:39], v[40:55]
    v_mfma_f32_32x32x16_bf16 v[56:71], v[252:255], v[36:39], v[56:71]
    v_mov_b32 v2, v6
    s_mov_b32 s16, s21
    s_add_u32 s14, s14, 1
    s_cmp_ge_u32 s14, s15
    s_cbranch_scc1 layerb1_kernel_gk_fin0
    ds_read_b128 v[32:35], v2 offset:6144
    s_waitcnt lgkmcnt(6)
    v_mfma_f32_32x32x16_bf16 v[72:87], a[0:3], v[8:11], 0
    v_mfma_f32_32x32x16_bf16 v[88:103], a[4:7], v[8:11], 0
    ds_read_b128 v[36:39], v2 offset:7168
    s_waitcnt lgkmcnt(6)
    v_mfma_f32_32x32x16_bf16 v[72:87], a[8:11], v[12:15], v[72:87]
    v_mfma_f32_32x32x16_bf16 v[88:103], a[12:15], v[12:15], v[88:103]
    ds_read_b128 v[8:11], v2 offset:8192
    s_waitcnt lgkmcnt(6)
    v_mfma_f32_32x32x16_bf16 v[72:87], a[16:19], v[16:19], v[72:87]
    v_cvt_pk_bf16_f32 v104, v40, v41
    v_mfma_f32_32x32x16_bf16 v[88:103], a[20:23], v[16:19], v[88:103]
    v_cvt_pk_bf16_f32 v105, v42, v43
    ds_read_b128 v[12:15], v2 offset:9216
    s_waitcnt lgkmcnt(6)
    v_mfma_f32_32x32x16_bf16 v[72:87], a[24:27], v[20:23], v[72:87]
    v_cvt_pk_bf16_f32 v106, v44, v45
    v_mfma_f32_32x32x16_bf16 v[88:103], a[28:31], v[20:23], v[88:103]
    v_cvt_pk_bf16_f32 v107, v46, v47
    ds_read_b128 v[16:19], v2 offset:10240
    s_waitcnt lgkmcnt(6)
    v_mfma_f32_32x32x16_bf16 v[72:87], a[32:35], v[24:27], v[72:87]
    s_nop 1
    v_mfma_f32_32x32x16_bf16 v[88:103], a[36:39], v[24:27], v[88:103]
    v_permlane32_swap_b32 v104, v106
    ds_read_b128 v[20:23], v2 offset:11264
    s_waitcnt lgkmcnt(6)
    v_mfma_f32_32x32x16_bf16 v[72:87], a[40:43], v[28:31], v[72:87]
    v_permlane32_swap_b32 v105, v107
    v_mfma_f32_32x32x16_bf16 v[88:103], a[44:47], v[28:31], v[88:103]
    buffer_store_dwordx4 v[104:107], v3, s[8:11], s17 offen offset:0 sc1
    ds_read_b128 v[24:27], v2 offset:12288
    s_waitcnt lgkmcnt(6)
    v_mfma_f32_32x32x16_bf16 v[72:87], a[48:51], v[32:35], v[72:87]
    v_cvt_pk_bf16_f32 v108, v48, v49
    v_mfma_f32_32x32x16_bf16 v[88:103], a[52:55], v[32:35], v[88:103]
    v_cvt_pk_bf16_f32 v109, v50, v51
    ds_read_b128 v[28:31], v2 offset:13312
    s_waitcnt lgkmcnt(6)
    v_mfma_f32_32x32x16_bf16 v[72:87], a[56:59], v[36:39], v[72:87]
    v_cvt_pk_bf16_f32 v110, v52, v53
    v_mfma_f32_32x32x16_bf16 v[88:103], a[60:63], v[36:39], v[88:103]
    v_cvt_pk_bf16_f32 v111, v54, v55
    ds_read_b128 v[32:35], v2 offset:14336
    s_waitcnt lgkmcnt(6)
    v_mfma_f32_32x32x16_bf16 v[72:87], a[64:67], v[8:11], v[72:87]
    s_nop 1
    v_mfma_f32_32x32x16_bf16 v[88:103], a[68:71], v[8:11], v[88:103]
    v_permlane32_swap_b32 v108, v110
    ds_read_b128 v[36:39], v2 offset:15360
    s_waitcnt lgkmcnt(6)
    v_mfma_f32_32x32x16_bf16 v[72:87], a[72:75], v[12:15], v[72:87]
    v_permlane32_swap_b32 v109, v111
    v_mfma_f32_32x32x16_bf16 v[88:103], a[76:79], v[12:15], v[88:103]
    buffer_store_dwordx4 v[108:111], v3, s[8:11], s17 offen offset:1024 sc1
    ds_read_b128 v[8:11], v2 offset:16384
    s_waitcnt lgkmcnt(6)
    v_mfma_f32_32x32x16_bf16 v[72:87], a[80:83], v[16:19], v[72:87]
    v_cvt_pk_bf16_f32 v112, v56, v57
    v_mfma_f32_32x32x16_bf16 v[88:103], a[84:87], v[16:19], v[88:103]
    v_cvt_pk_bf16_f32 v113, v58, v59
    ds_read_b128 v[12:15], v2 offset:17408
    s_waitcnt lgkmcnt(6)
    v_mfma_f32_32x32x16_bf16 v[72:87], a[88:91], v[20:23], v[72:87]
    v_cvt_pk_bf16_f32 v114, v60, v61
    v_mfma_f32_32x32x16_bf16 v[88:103], a[92:95], v[20:23], v[88:103]
    v_cvt_pk_bf16_f32 v115, v62, v63
    ds_read_b128 v[16:19], v2 offset:18432
    s_waitcnt lgkmcnt(6)
    v_mfma_f32_32x32x16_bf16 v[72:87], a[96:99], v[24:27], v[72:87]
    s_nop 1
    v_mfma_f32_32x32x16_bf16 v[88:103], a[100:103], v[24:27], v[88:103]
    v_permlane32_swap_b32 v112, v114
    ds_read_b128 v[20:23], v2 offset:19456
    s_waitcnt lgkmcnt(6)
    v_mfma_f32_32x32x16_bf16 v[72:87], a[104:107], v[28:31], v[72:87]
    v_permlane32_swap_b32 v113, v115
    v_mfma_f32_32x32x16_bf16 v[88:103], a[108:111], v[28:31], v[88:103]
    buffer_store_dwordx4 v[112:115], v3, s[8:11], s18 offen offset:0 sc1
    ds_read_b128 v[24:27], v2 offset:20480
    s_waitcnt lgkmcnt(6)
    v_mfma_f32_32x32x16_bf16 v[72:87], a[112:115], v[32:35], v[72:87]
    v_cvt_pk_bf16_f32 v116, v64, v65
    v_mfma_f32_32x32x16_bf16 v[88:103], a[116:119], v[32:35], v[88:103]
    v_cvt_pk_bf16_f32 v117, v66, v67
    ds_read_b128 v[28:31], v2 offset:21504
    s_waitcnt lgkmcnt(6)
    v_mfma_f32_32x32x16_bf16 v[72:87], a[120:123], v[36:39], v[72:87]
    v_cvt_pk_bf16_f32 v118, v68, v69
    v_mfma_f32_32x32x16_bf16 v[88:103], a[124:127], v[36:39], v[88:103]
    v_cvt_pk_bf16_f32 v119, v70, v71
    ds_read_b128 v[32:35], v2 offset:22528
    s_waitcnt lgkmcnt(6)
    v_mfma_f32_32x32x16_bf16 v[72:87], a[128:131], v[8:11], v[72:87]
    s_nop 1
    v_mfma_f32_32x32x16_bf16 v[88:103], a[132:135], v[8:11], v[88:103]
    v_permlane32_swap_b32 v116, v118
    ds_read_b128 v[36:39], v2 offset:23552
    s_waitcnt lgkmcnt(6)
    v_mfma_f32_32x32x16_bf16 v[72:87], a[136:139], v[12:15], v[72:87]
    v_permlane32_swap_b32 v117, v119
    v_mfma_f32_32x32x16_bf16 v[88:103], a[140:143], v[12:15], v[88:103]
    buffer_store_dwordx4 v[116:119], v3, s[8:11], s18 offen offset:1024 sc1
    ds_read_b128 v[8:11], v2 offset:24576
    s_waitcnt lgkmcnt(6)
    v_mfma_f32_32x32x16_bf16 v[72:87], a[144:147], v[16:19], v[72:87]
    s_add_u32 s17, s17, s20
    v_mfma_f32_32x32x16_bf16 v[88:103], a[148:151], v[16:19], v[88:103]
    s_add_u32 s18, s18, s20
    ds_read_b128 v[12:15], v2 offset:25600
    s_waitcnt lgkmcnt(6)
    v_mfma_f32_32x32x16_bf16 v[72:87], a[152:155], v[20:23], v[72:87]
    v_mfma_f32_32x32x16_bf16 v[88:103], a[156:159], v[20:23], v[88:103]
    ds_read_b128 v[16:19], v2 offset:26624
    s_waitcnt lgkmcnt(6)
    v_mfma_f32_32x32x16_bf16 v[72:87], a[160:163], v[24:27], v[72:87]
    v_mfma_f32_32x32x16_bf16 v[88:103], a[164:167], v[24:27], v[88:103]
    ds_read_b128 v[20:23], v2 offset:27648
    s_waitcnt lgkmcnt(6)
    v_mfma_f32_32x32x16_bf16 v[72:87], a[168:171], v[28:31], v[72:87]
    v_mfma_f32_32x32x16_bf16 v[88:103], a[172:175], v[28:31], v[88:103]
    ds_read_b128 v[24:27], v2 offset:28672
    s_waitcnt lgkmcnt(6)
    v_mfma_f32_32x32x16_bf16 v[72:87], a[176:179], v[32:35], v[72:87]
    v_mfma_f32_32x32x16_bf16 v[88:103], a[180:183], v[32:35], v[88:103]
    ds_read_b128 v[28:31], v2 offset:29696
    s_waitcnt lgkmcnt(6)
    v_mfma_f32_32x32x16_bf16 v[72:87], a[184:187], v[36:39], v[72:87]
    v_mfma_f32_32x32x16_bf16 v[88:103], a[188:191], v[36:39], v[88:103]
    ds_read_b128 v[32:35], v2 offset:30720
    s_waitcnt lgkmcnt(6)
    v_mfma_f32_32x32x16_bf16 v[72:87], a[192:195], v[8:11], v[72:87]
    v_mfma_f32_32x32x16_bf16 v[88:103], a[196:199], v[8:11], v[88:103]
    ds_read_b128 v[36:39], v2 offset:31744
    s_waitcnt lgkmcnt(6)
    v_mfma_f32_32x32x16_bf16 v[72:87], a[200:203], v[12:15], v[72:87]
    v_mfma_f32_32x32x16_bf16 v[88:103], a[204:207], v[12:15], v[88:103]
    ds_read_b128 v[8:11], v2 offset:32768
    s_waitcnt lgkmcnt(6)
    v_mfma_f32_32x32x16_bf16 v[72:87], a[208:211], v[16:19], v[72:87]
    v_mfma_f32_32x32x16_bf16 v[88:103], a[212:215], v[16:19], v[88:103]
    ds_read_b128 v[12:15], v2 offset:33792
    s_waitcnt lgkmcnt(6)
    v_mfma_f32_32x32x16_bf16 v[72:87], a[216:219], v[20:23], v[72:87]
    v_mfma_f32_32x32x16_bf16 v[88:103], a[220:223], v[20:23], v[88:103]
    ds_read_b128 v[16:19], v2 offset:34816
    s_waitcnt lgkmcnt(6)
    v_mfma_f32_32x32x16_bf16 v[72:87], a[224:227], v[24:27], v[72:87]
    v_mfma_f32_32x32x16_bf16 v[88:103], a[228:231], v[24:27], v[88:103]
    s_add_u32 s23, s14, 2
    s_cmp_lg_u32 s13, 0
    s_cbranch_scc1 layerb1_kernel_gk_lw8
    s_min_u32 s28, s23, 63
    s_cmp_gt_u32 s56, s28
    s_cbranch_scc1 layerb1_kernel_gk_lw8
layerb1_kernel_gk_lp8:
    buffer_load_dwordx4 v[124:127], v1, s[8:11], s57 offen sc1
    s_waitcnt vmcnt(0)
    v_min_u32 v124, v124, v125
    v_min_u32 v126, v126, v127
    v_min_u32 v124, v124, v126
    v_cmp_eq_u32 vcc, 0, v124
    s_nop 1
    s_ff1_i32_b64 s56, vcc
    s_min_u32 s56, s56, 64
    s_sub_u32 s58, s58, 1
    s_cbranch_scc1 layerb1_kernel_bail
    s_cmp_gt_u32 s56, s28
    s_cbranch_scc0 layerb1_kernel_gk_lp8
layerb1_kernel_gk_lw8:
    s_cmp_gt_u32 s14, 5
    s_cbranch_scc1 layerb1_kernel_gk_dr9
    s_waitcnt vmcnt(0)
    s_mov_b32 s27, s14
    s_branch layerb1_kernel_gk_dq9
layerb1_kernel_gk_dr9:
    s_waitcnt vmcnt(4)
    s_sub_u32 s27, s14, 1
layerb1_kernel_gk_dq9:
    s_barrier
    s_cmp_lg_u32 s13, 0
    s_cbranch_scc1 layerb1_kernel_gk_fl10
    s_mov_b64 exec, 1
    s_lshl_b32 s26, s12, 7
    v_mov_b32 v7, s26
    v_mov_b32 v120, s27
    buffer_store_dword v120, v7, s[8:11], s48 offen sc1
    s_mov_b64 exec, -1
layerb1_kernel_gk_fl10:
    s_add_u32 s21, s16, 40960
    s_cmp_eq_u32 s21, 122880
    s_cselect_b32 s21, 0, s21
    s_add_u32 s23, s14, 2
    s_min_u32 s24, s23, 63
    s_mul_i32 s24, s24, 40960
    s_add_u32 s24, s24, s19
    s_mul_i32 s25, s13, 10240
    s_add_u32 s25, s25, s22
    s_add_u32 s22, s22, 40960
    s_cmp_eq_u32 s22, 122880
    s_cselect_b32 s22, 0, s22
    ds_read_b128 v[20:23], v2 offset:35840
    s_waitcnt lgkmcnt(6)
    v_mfma_f32_32x32x16_bf16 v[72:87], a[232:235], v[28:31], v[72:87]
    s_mov_b32 m0, s25
    s_nop 0
    buffer_load_dwordx4 v1, s[8:11], s24 offen offset:0 sc1 lds
    v_mfma_f32_32x32x16_bf16 v[88:103], a[236:239], v[28:31], v[88:103]
    ds_read_b128 v[24:27], v2 offset:36864
    s_waitcnt lgkmcnt(6)
    v_mfma_f32_32x32x16_bf16 v[72:87], a[240:243], v[32:35], v[72:87]
    buffer_load_dwordx4 v1, s[8:11], s24 offen offset:1024 sc1 lds
    v_mfma_f32_32x32x16_bf16 v[88:103], a[244:247], v[32:35], v[88:103]
    ds_read_b128 v[28:31], v2 offset:37888
    s_waitcnt lgkmcnt(6)
    v_mfma_f32_32x32x16_bf16 v[72:87], a[248:251], v[36:39], v[72:87]
    buffer_load_dwordx4 v1, s[8:11], s24 offen offset:2048 sc1 lds
    v_mfma_f32_32x32x16_bf16 v[88:103], a[252:255], v[36:39], v[88:103]
    ds_read_b128 v[32:35], v2 offset:38912
    s_waitcnt lgkmcnt(6)
    v_mfma_f32_32x32x16_bf16 v[72:87], v[192:195], v[8:11], v[72:87]
    buffer_load_dwordx4 v1, s[8:11], s24 offen offset:3072 sc1 lds
    v_mfma_f32_32x32x16_bf16 v[88:103], v[196:199], v[8:11], v[88:103]
    ds_read_b128 v[36:39], v2 offset:39936
    s_waitcnt lgkmcnt(6)
    v_mfma_f32_32x32x16_bf16 v[72:87], v[200:203], v[12:15], v[72:87]
    s_add_u32 s24, s24, 4096
    s_add_u32 s25, s25, 4096
    s_mov_b32 m0, s25
    s_nop 0
    buffer_load_dwordx4 v1, s[8:11], s24 offen offset:0 sc1 lds
    v_mfma_f32_32x32x16_bf16 v[88:103], v[204:207], v[12:15], v[88:103]
    v_add_u32 v6, s21, v1
    ds_read_b128 v[8:11], v6 offset:0
    s_waitcnt lgkmcnt(6)
    v_mfma_f32_32x32x16_bf16 v[72:87], v[208:211], v[16:19], v[72:87]
    buffer_load_dwordx4 v1, s[8:11], s24 offen offset:1024 sc1 lds
    v_mfma_f32_32x32x16_bf16 v[88:103], v[212:215], v[16:19], v[88:103]
    ds_read_b128 v[12:15], v6 offset:1024
    s_waitcnt lgkmcnt(6)
    v_mfma_f32_32x32x16_bf16 v[72:87], v[216:219], v[20:23], v[72:87]
    buffer_load_dwordx4 v1, s[8:11], s24 offen offset:2048 sc1 lds
    v_mfma_f32_32x32x16_bf16 v[88:103], v[220:223], v[20:23], v[88:103]
    ds_read_b128 v[16:19], v6 offset:2048
    s_waitcnt lgkmcnt(6)
    v_mfma_f32_32x32x16_bf16 v[72:87], v[224:227], v[24:27], v[72:87]
    buffer_load_dwordx4 v1, s[8:11], s24 offen offset:3072 sc1 lds
    v_mfma_f32_32x32x16_bf16 v[88:103], v[228:231], v[24:27], v[88:103]
    ds_read_b128 v[20:23], v6 offset:3072
    s_waitcnt lgkmcnt(6)
    v_mfma_f32_32x32x16_bf16 v[72:87], v[232:235], v[28:31], v[72:87]
    s_add_u32 s24, s24, 4096
    s_add_u32 s25, s25, 4096
    s_mov_b32 m0, s25
    s_nop 0
    buffer_load_dwordx4 v1, s[8:11], s24 offen offset:0 sc1 lds
    v_mfma_f32_32x32x16_bf16 v[88:103], v[236:239], v[28:31], v[88:103]
    ds_read_b128 v[24:27], v6 offset:4096
    s_waitcnt lgkmcnt(6)
    v_mfma_f32_32x32x16_bf16 v[72:87], v[240:243], v[32:35], v[72:87]
    buffer_load_dwordx4 v1, s[8:11], s24 offen offset:1024 sc1 lds
    v_mfma_f32_32x32x16_bf16 v[88:103], v[244:247], v[32:35], v[88:103]
    ds_read_b128 v[28:31], v6 offset:5120
    s_waitcnt lgkmcnt(6)
    v_mfma_f32_32x32x16_bf16 v[72:87], v[248:251], v[36:39], v[72:87]
    v_mfma_f32_32x32x16_bf16 v[88:103], v[252:255], v[36:39], v[88:103]
    v_mov_b32 v2, v6
    s_mov_b32 s16, s21
    s_add_u32 s14, s14, 1
    s_cmp_lt_u32 s14, s15
    s_cbranch_scc1 layerb1_kernel_gk_loop
    s_branch layerb1_kernel_gk_fin1
layerb1_kernel_gk_fin0:
    s_nop 7
    s_nop 7
    v_cvt_pk_bf16_f32 v104, v40, v41
    v_cvt_pk_bf16_f32 v105, v42, v43
    v_cvt_pk_bf16_f32 v106, v44, v45
    v_cvt_pk_bf16_f32 v107, v46, v47
    s_nop 1
    v_permlane32_swap_b32 v104, v106
    v_permlane32_swap_b32 v105, v107
    buffer_store_dwordx4 v[104:107], v3, s[8:11], s17 offen offset:0 sc1
    v_cvt_pk_bf16_f32 v108, v48, v49
    v_cvt_pk_bf16_f32 v109, v50, v51
    v_cvt_pk_bf16_f32 v110, v52, v53
    v_cvt_pk_bf16_f32 v111, v54, v55
    s_nop 1
    v_permlane32_swap_b32 v108, v110
    v_permlane32_swap_b32 v109, v111
    buffer_store_dwordx4 v[108:111], v3, s[8:11], s17 offen offset:1024 sc1
    v_cvt_pk_bf16_f32 v112, v56, v57
    v_cvt_pk_bf16_f32 v113, v58, v59
    v_cvt_pk_bf16_f32 v114, v60, v61
    v_cvt_pk_bf16_f32 v115, v62, v63
    s_nop 1
    v_permlane32_swap_b32 v112, v114
    v_permlane32_swap_b32 v113, v115
    buffer_store_dwordx4 v[112:115], v3, s[8:11], s18 offen offset:0 sc1
    v_cvt_pk_bf16_f32 v116, v64, v65
    v_cvt_pk_bf16_f32 v117, v66, v67
    v_cvt_pk_bf16_f32 v118, v68, v69
    v_cvt_pk_bf16_f32 v119, v70, v71
    s_nop 1
    v_permlane32_swap_b32 v116, v118
    v_permlane32_swap_b32 v117, v119
    buffer_store_dwordx4 v[116:119], v3, s[8:11], s18 offen offset:1024 sc1
    s_add_u32 s17, s17, s20
    s_add_u32 s18, s18, s20
    s_branch layerb1_kernel_gk_done
layerb1_kernel_gk_fin1:
    s_nop 7
    s_nop 7
    v_cvt_pk_bf16_f32 v104, v72, v73
    v_cvt_pk_bf16_f32 v105, v74, v75
    v_cvt_pk_bf16_f32 v106, v76, v77
    v_cvt_pk_bf16_f32 v107, v78, v79
    s_nop 1
    v_permlane32_swap_b32 v104, v106
    v_permlane32_swap_b32 v105, v107
    buffer_store_dwordx4 v[104:107], v3, s[8:11], s17 offen offset:0 sc1
    v_cvt_pk_bf16_f32 v108, v80, v81
    v_cvt_pk_bf16_f32 v109, v82, v83
    v_cvt_pk_bf16_f32 v110, v84, v85
    v_cvt_pk_bf16_f32 v111, v86, v87
    s_nop 1
    v_permlane32_swap_b32 v108, v110
    v_permlane32_swap_b32 v109, v111
    buffer_store_dwordx4 v[108:111], v3, s[8:11], s17 offen offset:1024 sc1
    v_cvt_pk_bf16_f32 v112, v88, v89
    v_cvt_pk_bf16_f32 v113, v90, v91
    v_cvt_pk_bf16_f32 v114, v92, v93
    v_cvt_pk_bf16_f32 v115, v94, v95
    s_nop 1
    v_permlane32_swap_b32 v112, v114
    v_permlane32_swap_b32 v113, v115
    buffer_store_dwordx4 v[112:115], v3, s[8:11], s18 offen offset:0 sc1
    v_cvt_pk_bf16_f32 v116, v96, v97
    v_cvt_pk_bf16_f32 v117, v98, v99
    v_cvt_pk_bf16_f32 v118, v100, v101
    v_cvt_pk_bf16_f32 v119, v102, v103
    s_nop 1
    v_permlane32_swap_b32 v116, v118
    v_permlane32_swap_b32 v117, v119
    buffer_store_dwordx4 v[116:119], v3, s[8:11], s18 offen offset:1024 sc1
    s_add_u32 s17, s17, s20
    s_add_u32 s18, s18, s20
layerb1_kernel_gk_done:
    s_waitcnt vmcnt(0) lgkmcnt(0)
    s_barrier
    s_cmp_lg_u32 s13, 0
    s_cbranch_scc1 layerb1_kernel_gk_fl11
    s_mov_b64 exec, 1
    s_lshl_b32 s26, s12, 7
    v_mov_b32 v7, s26
    v_mov_b32 v120, s14
    buffer_store_dword v120, v7, s[8:11], s48 offen sc1
    s_mov_b64 exec, -1
layerb1_kernel_gk_fl11:
layerb1_kernel_g_done:
    s_branch layerb1_kernel_w3
layerb1_kernel_spare:
    s_sub_u32 s22, s20, 1
    s_mul_i32 s22, s22, 5
    s_add_u32 s22, s22, s21
    s_sub_u32 s22, s22, 27
    s_cmp_ge_u32 s21, 27
    s_cselect_b32 s22, s22, 15
    s_cmp_lt_u32 s22, 5
    s_cbranch_scc1 layerb1_kernel_sp_ab
    s_cmp_lt_u32 s22, 9
    s_cbranch_scc1 layerb1_kernel_sp_ln
    s_cmp_eq_u32 s22, 10
    s_cbranch_scc0 layerb1_kernel_sp_n10
    s_cmp_lg_u32 s13, 0
    s_cbranch_scc1 layerb1_kernel_cal1x
    s_add_u32 s24, s17, 2086912
    s_getreg_b32 s25, hwreg(HW_REG_XCC_ID)
    s_bfe_u32 s25, s25, 0x10002
    s_mov_b64 exec, 1
    v_mov_b32 v1, 0
    v_mov_b32 v2, 0
    s_mov_b32 s30, -1
    s_mov_b32 s31, -1
    s_mov_b32 s26, 8
    s_waitcnt vmcnt(0)
layerb1_kernel_cal1:
    s_and_b32 s27, s26, 15
    s_lshl_b32 s27, s27, 7
    s_add_u32 s27, s27, s24
    s_memtime s[28:29]
    s_waitcnt lgkmcnt(0)
    buffer_atomic_add v2, v1, s[8:11], s27 offen sc0 sc1
    s_waitcnt vmcnt(0)
    s_memtime s[32:33]
    v_mov_b32 v2, 0
    s_waitcnt lgkmcnt(0)
    s_sub_u32 s28, s32, s28
    s_min_u32 s30, s30, s28
    s_and_b32 s27, s26, 15
    s_lshl_b32 s27, s27, 7
    s_add_u32 s27, s27, s24
    s_add_u32 s27, s27, 8192
    s_memtime s[28:29]
    s_waitcnt lgkmcnt(0)
    buffer_atomic_add v2, v1, s[8:11], s27 offen sc0 sc1
    s_waitcnt vmcnt(0)
    s_memtime s[32:33]
    v_mov_b32 v2, 0
    s_waitcnt lgkmcnt(0)
    s_sub_u32 s28, s32, s28
    s_min_u32 s31, s31, s28
    s_sub_u32 s26, s26, 1
    s_cmp_lg_u32 s26, 0
    s_cbranch_scc1 layerb1_kernel_cal1
    s_cmp_lt_u32 s31, s30
    s_cselect_b32 s27, 1, 0
    s_xor_b32 s27, s27, s25
    s_lshl_b32 s27, s27, 13
    s_or_b32 s27, s27, 1
    v_mov_b32 v3, s27
    s_add_u32 s27, s48, 51204
    buffer_store_dword v3, v1, s[8:11], s27 offen sc1
    s_lshl_b32 s28, s30, 16
    s_or_b32 s28, s28, s31
    v_mov_b32 v3, s28
    buffer_store_dword v3, v1, s[8:11], s27 offen offset:8 sc1
    s_mov_b64 exec, -1
    s_waitcnt vmcnt(0)
layerb1_kernel_cal1x:
    s_barrier
    s_branch layerb1_kernel_w3
layerb1_kernel_sp_n10:
    s_cmp_eq_u32 s22, 9
    s_cbranch_scc0 layerb1_kernel_w3
    s_cmp_lg_u32 s13, 0
    s_cbranch_scc1 layerb1_kernel_cal0x
    s_add_u32 s24, s16, 2086912
    s_getreg_b32 s25, hwreg(HW_REG_XCC_ID)
    s_bfe_u32 s25, s25, 0x10002
    s_mov_b64 exec, 1
    v_mov_b32 v1, 0
    v_mov_b32 v2, 0
    s_mov_b32 s30, -1
    s_mov_b32 s31, -1
    s_mov_b32 s26, 8
    s_waitcnt vmcnt(0)
layerb1_kernel_cal0:
    s_and_b32 s27, s26, 15
    s_lshl_b32 s27, s27, 7
    s_add_u32 s27, s27, s24
    s_memtime s[28:29]
    s_waitcnt lgkmcnt(0)
    buffer_atomic_add v2, v1, s[8:11], s27 offen sc0 sc1
    s_waitcnt vmcnt(0)
    s_memtime s[32:33]
    v_mov_b32 v2, 0
    s_waitcnt lgkmcnt(0)
    s_sub_u32 s28, s32, s28
    s_min_u32 s30, s30, s28
    s_and_b32 s27, s26, 15
    s_lshl_b32 s27, s27, 7
    s_add_u32 s27, s27, s24
    s_add_u32 s27, s27, 8192
    s_memtime s[28:29]
    s_waitcnt lgkmcnt(0)
    buffer_atomic_add v2, v1, s[8:11], s27 offen sc0 sc1
    s_waitcnt vmcnt(0)
    s_memtime s[32:33]
    v_mov_b32 v2, 0
    s_waitcnt lgkmcnt(0)
    s_sub_u32 s28, s32, s28
    s_min_u32 s31, s31, s28
    s_sub_u32 s26, s26, 1
    s_cmp_lg_u32 s26, 0
    s_cbranch_scc1 layerb1_kernel_cal0
    s_cmp_lt_u32 s31, s30
    s_cselect_b32 s27, 1, 0
    s_xor_b32 s27, s27, s25
    s_lshl_b32 s27, s27, 13
    s_or_b32 s27, s27, 1
    v_mov_b32 v3, s27
    s_add_u32 s27, s48, 51200
    buffer_store_dword v3, v1, s[8:11], s27 offen sc1
    s_lshl_b32 s28, s30, 16
    s_or_b32 s28, s28, s31
    v_mov_b32 v3, s28
    buffer_store_dword v3, v1, s[8:11], s27 offen offset:8 sc1
    s_mov_b64 exec, -1
    s_waitcnt vmcnt(0)
layerb1_kernel_cal0x:
    s_barrier
    s_add_u32 s20, s48, 51200
    s_mov_b64 exec, 3
    v_lshlrev_b32 v16, 2, v0
layerb1_kernel_m0_par:
    buffer_load_dword v17, v16, s[8:11], s20 offen sc1
    s_waitcnt vmcnt(0)
    v_cmp_eq_u32 vcc, 0, v17
    s_sub_u32 s15, s15, 1
    s_cbranch_scc1 layerb1_kernel_bail
    s_cbranch_vccnz layerb1_kernel_m0_par
    s_mov_b64 exec, -1
    v_readlane_b32 s20, v17, 0
    v_readlane_b32 s21, v17, 1
    s_nop 0
    s_and_b32 s20, s20, 8192
    s_and_b32 s21, s21, 8192
    s_add_u32 s16, s16, s20
    s_add_u32 s17, s17, s21
    s_load_dwordx2 s[24:25], s[0:1], 32
    s_lshl_b32 s26, s13, 6
    v_add_u32 v1, s26, v0
    s_waitcnt lgkmcnt(0)
    s_mov_b32 s28, s24
    s_mov_b32 s29, s25
    s_mov_b32 s30, 10240
    s_mov_b32 s31, 0x00020000
    v_add_u32 v2, 0, v1
    v_and_b32 v3, 7, v2
    v_mul_u32_u24 v3, 1280, v3
    v_lshrrev_b32 v4, 3, v2
    v_lshl_add_u32 v3, v4, 4, v3
    v_lshlrev_b32 v5, 4, v2
    v_add_u32 v5, 20480, v5
    v_lshrrev_b32 v6, 13, v5
    v_lshlrev_b32 v6, 14, v6
    v_and_b32 v5, 8191, v5
    v_add_u32 v5, v5, v6
    v_cmp_gt_u32 vcc, 640, v2
    s_and_saveexec_b64 s[32:33], vcc
    s_cbranch_execz layerb1_kernel_m0s0
    buffer_load_dwordx4 v[8:11], v3, s[28:31], 0 offen
    s_waitcnt vmcnt(0)
    buffer_store_dwordx4 v[8:11], v5, s[8:11], s16 offen sc1
layerb1_kernel_m0s0:
    s_mov_b64 exec, s[32:33]
    v_add_u32 v2, 256, v1
    v_and_b32 v3, 7, v2
    v_mul_u32_u24 v3, 1280, v3
    v_lshrrev_b32 v4, 3, v2
    v_lshl_add_u32 v3, v4, 4, v3
    v_lshlrev_b32 v5, 4, v2
    v_add_u32 v5, 20480, v5
    v_lshrrev_b32 v6, 13, v5
    v_lshlrev_b32 v6, 14, v6
    v_and_b32 v5, 8191, v5
    v_add_u32 v5, v5, v6
    v_cmp_gt_u32 vcc, 640, v2
    s_and_saveexec_b64 s[32:33], vcc
    s_cbranch_execz layerb1_kernel_m0s1
    buffer_load_dwordx4 v[8:11], v3, s[28:31], 0 offen
    s_waitcnt vmcnt(0)
    buffer_store_dwordx4 v[8:11], v5, s[8:11], s16 offen sc1
layerb1_kernel_m0s1:
    s_mov_b64 exec, s[32:33]
    v_add_u32 v2, 512, v1
    v_and_b32 v3, 7, v2
    v_mul_u32_u24 v3, 1280, v3
    v_lshrrev_b32 v4, 3, v2
    v_lshl_add_u32 v3, v4, 4, v3
    v_lshlrev_b32 v5, 4, v2
    v_add_u32 v5, 20480, v5
    v_lshrrev_b32 v6, 13, v5
    v_lshlrev_b32 v6, 14, v6
    v_and_b32 v5, 8191, v5
    v_add_u32 v5, v5, v6
    v_cmp_gt_u32 vcc, 640, v2
    s_and_saveexec_b64 s[32:33], vcc
    s_cbranch_execz layerb1_kernel_m0s2
    buffer_load_dwordx4 v[8:11], v3, s[28:31], 0 offen
    s_waitcnt vmcnt(0)
    buffer_store_dwordx4 v[8:11], v5, s[8:11], s16 offen sc1
layerb1_kernel_m0s2:
    s_mov_b64 exec, s[32:33]
    s_waitcnt vmcnt(0)
    s_branch layerb1_kernel_w3
layerb1_kernel_sp_ab:
    s_mov_b32 s12, s22
    s_mov_b32 s14, 0
    s_mov_b32 s15, 64
    s_load_dwordx2 s[52:53], s[0:1], 0
    v_lshlrev_b32 v1, 4, v0
    s_lshl_b32 s21, s12, 2
    s_add_u32 s21, s21, s13
    s_add_u32 s24, s4, 247463936
    s_addc_u32 s25, s5, 0
    s_waitcnt lgkmcnt(0)
    s_cmp_eq_u32 s49, 0
    s_cselect_b32 s52, s52, s24
    s_cselect_b32 s53, s53, s25
    s_mov_b32 s54, 2621440
    s_mov_b32 s55, 0x00020000
    v_and_b32 v6, 31, v0
    v_lshrrev_b32 v7, 5, v0
    v_mul_u32_u24 v6, 1280, v6
    v_lshl_add_u32 v3, v7, 4, v6
    s_mul_i32 s19, s14, 40960
    s_lshl_b32 s24, s21, 6
    s_add_u32 s19, s19, s24
    s_lshl_b32 s20, s14, 7
    s_lshl_b32 s24, s21, 2
    s_add_u32 s20, s20, s24
    s_add_u32 s20, s20, 36864
    v_mov_b32 v5, 1
    v_mov_b32 v4, 0
    s_mul_i32 s18, s13, 10240
    s_add_u32 s18, s18, 229638144
    s_mov_b32 s17, 0
    buffer_load_dwordx4 v[96:99], v3, s[52:55], s19 offen offset:0
    buffer_load_dwordx4 v[100:103], v3, s[52:55], s19 offen offset:32
    s_mul_i32 s24, s21, 40960
    s_add_u32 s24, s24, 246415360
    s_add_u32 s24, s24, 4096
    s_add_u32 s24, s24, 4096
    s_add_u32 s24, s24, 4096
    s_add_u32 s24, s24, 4096
    s_add_u32 s24, s24, 4096
    s_add_u32 s24, s24, 4096
    s_add_u32 s24, s24, 4096
    s_add_u32 s24, s24, 4096
    s_add_u32 s24, s24, 4096
    s_mov_b32 s22, 0
    s_mov_b32 s30, 400000
    s_add_u32 s29, s48, 49152
    v_lshlrev_b32 v112, 3, v0
    s_cmp_lg_u32 s13, 0
    s_cbranch_scc1 layerb1_kernel_ab_ow1
    s_min_u32 s28, s14, 63
    s_cmp_gt_u32 s22, s28
    s_cbranch_scc1 layerb1_kernel_ab_ow1
layerb1_kernel_ab_op1:
    buffer_load_dwordx4 v[116:119], v1, s[8:11], s29 offen sc1
    s_waitcnt vmcnt(0)
    v_min_u32 v116, v116, v117
    v_min_u32 v118, v118, v119
    v_min_u32 v114, v116, v118
    v_cmp_eq_u32 vcc, 0, v114
    s_nop 1
    s_ff1_i32_b64 s22, vcc
    s_min_u32 s22, s22, 64
    s_and_b32 s22, s22, 0x7c
    s_sub_u32 s30, s30, 1
    s_cbranch_scc1 layerb1_kernel_bail
    s_cmp_gt_u32 s22, s28
    s_cbranch_scc0 layerb1_kernel_ab_op1
layerb1_kernel_ab_ow1:
    s_barrier
    s_min_u32 s24, s14, 63
    s_mul_i32 s24, s24, 40960
    s_add_u32 s24, s24, s18
    s_mul_i32 s25, s13, 10240
    s_add_u32 s25, s25, s17
    s_mov_b32 m0, s25
    s_nop 0
    buffer_load_dwordx4 v1, s[8:11], s24 offen offset:0 sc1 lds
    buffer_load_dwordx4 v1, s[8:11], s24 offen offset:1024 sc1 lds
    buffer_load_dwordx4 v1, s[8:11], s24 offen offset:2048 sc1 lds
    buffer_load_dwordx4 v1, s[8:11], s24 offen offset:3072 sc1 lds
    s_add_u32 s24, s24, 4096
    s_add_u32 s25, s25, 4096
    s_mov_b32 m0, s25
    s_nop 0
    buffer_load_dwordx4 v1, s[8:11], s24 offen offset:0 sc1 lds
    buffer_load_dwordx4 v1, s[8:11], s24 offen offset:1024 sc1 lds
    buffer_load_dwordx4 v1, s[8:11], s24 offen offset:2048 sc1 lds
    buffer_load_dwordx4 v1, s[8:11], s24 offen offset:3072 sc1 lds
    s_add_u32 s24, s24, 4096
    s_add_u32 s25, s25, 4096
    s_mov_b32 m0, s25
    s_nop 0
    buffer_load_dwordx4 v1, s[8:11], s24 offen offset:0 sc1 lds
    buffer_load_dwordx4 v1, s[8:11], s24 offen offset:1024 sc1 lds
    s_mov_b32 s17, 40960
    s_add_u32 s23, s14, 1
    s_cmp_lg_u32 s13, 0
    s_cbranch_scc1 layerb1_kernel_ab_ow2
    s_min_u32 s28, s23, 63
    s_cmp_gt_u32 s22, s28
    s_cbranch_scc1 layerb1_kernel_ab_ow2
layerb1_kernel_ab_op2:
    buffer_load_dwordx4 v[116:119], v1, s[8:11], s29 offen sc1
    s_waitcnt vmcnt(0)
    v_min_u32 v116, v116, v117
    v_min_u32 v118, v118, v119
    v_min_u32 v114, v116, v118
    v_cmp_eq_u32 vcc, 0, v114
    s_nop 1
    s_ff1_i32_b64 s22, vcc
    s_min_u32 s22, s22, 64
    s_and_b32 s22, s22, 0x7c
    s_sub_u32 s30, s30, 1
    s_cbranch_scc1 layerb1_kernel_bail
    s_cmp_gt_u32 s22, s28
    s_cbranch_scc0 layerb1_kernel_ab_op2
layerb1_kernel_ab_ow2:
    s_barrier
    s_min_u32 s24, s23, 63
    s_mul_i32 s24, s24, 40960
    s_add_u32 s24, s24, s18
    s_mul_i32 s25, s13, 10240
    s_add_u32 s25, s25, s17
    s_mov_b32 m0, s25
    s_nop 0
    buffer_load_dwordx4 v1, s[8:11], s24 offen offset:0 sc1 lds
    buffer_load_dwordx4 v1, s[8:11], s24 offen offset:1024 sc1 lds
    buffer_load_dwordx4 v1, s[8:11], s24 offen offset:2048 sc1 lds
    buffer_load_dwordx4 v1, s[8:11], s24 offen offset:3072 sc1 lds
    s_add_u32 s24, s24, 4096
    s_add_u32 s25, s25, 4096
    s_mov_b32 m0, s25
    s_nop 0
    buffer_load_dwordx4 v1, s[8:11], s24 offen offset:0 sc1 lds
    buffer_load_dwordx4 v1, s[8:11], s24 offen offset:1024 sc1 lds
    buffer_load_dwordx4 v1, s[8:11], s24 offen offset:2048 sc1 lds
    buffer_load_dwordx4 v1, s[8:11], s24 offen offset:3072 sc1 lds
    s_add_u32 s24, s24, 4096
    s_add_u32 s25, s25, 4096
    s_mov_b32 m0, s25
    s_nop 0
    buffer_load_dwordx4 v1, s[8:11], s24 offen offset:0 sc1 lds
    buffer_load_dwordx4 v1, s[8:11], s24 offen offset:1024 sc1 lds
    s_mov_b32 s17, 81920
    s_mov_b32 s16, 0
    s_waitcnt vmcnt(10)
    s_add_u32 s23, s14, 2
    s_cmp_lg_u32 s13, 0
    s_cbranch_scc1 layerb1_kernel_ab_ow3
    s_min_u32 s28, s23, 63
    s_cmp_gt_u32 s22, s28
    s_cbranch_scc1 layerb1_kernel_ab_ow3
layerb1_kernel_ab_op3:
    buffer_load_dwordx4 v[116:119], v1, s[8:11], s29 offen sc1
    s_waitcnt vmcnt(0)
    v_min_u32 v116, v116, v117
    v_min_u32 v118, v118, v119
    v_min_u32 v114, v116, v118
    v_cmp_eq_u32 vcc, 0, v114
    s_nop 1
    s_ff1_i32_b64 s22, vcc
    s_min_u32 s22, s22, 64
    s_and_b32 s22, s22, 0x7c
    s_sub_u32 s30, s30, 1
    s_cbranch_scc1 layerb1_kernel_bail
    s_cmp_gt_u32 s22, s28
    s_cbranch_scc0 layerb1_kernel_ab_op3
layerb1_kernel_ab_ow3:
    s_barrier
    v_add_u32 v2, s16, v1
    ds_read_b128 v[16:19], v2 offset:0
    ds_read_b128 v[20:23], v2 offset:1024
    ds_read_b128 v[24:27], v2 offset:2048
    ds_read_b128 v[28:31], v2 offset:3072
    ds_read_b128 v[32:35], v2 offset:4096
    ds_read_b128 v[36:39], v2 offset:5120
    s_add_u32 s27, s19, 40960
    s_cmp_ge_u32 s14, 63
    s_cselect_b32 s27, s19, s27
    buffer_load_dwordx4 v[104:107], v3, s[52:55], s27 offen offset:0
    buffer_load_dwordx4 v[108:111], v3, s[52:55], s27 offen offset:32
    s_add_u32 s23, s14, 2
    s_min_u32 s24, s23, 63
    s_mul_i32 s24, s24, 40960
    s_add_u32 s24, s24, s18
    s_mul_i32 s25, s13, 10240
    s_add_u32 s25, s25, s17
    s_add_u32 s17, s17, 40960
    s_cmp_eq_u32 s17, 122880
    s_cselect_b32 s17, 0, s17
    ds_read_b128 v[40:43], v2 offset:6144
    s_waitcnt lgkmcnt(6)
    v_mfma_f32_32x32x16_bf16 v[48:63], a[0:3], v[16:19], 0
    ds_read_b128 v[44:47], v2 offset:7168
    s_waitcnt lgkmcnt(6)
    v_mfma_f32_32x32x16_bf16 v[64:79], a[4:7], v[20:23], 0
    s_mov_b32 m0, s25
    s_nop 0
    buffer_load_dwordx4 v1, s[8:11], s24 offen offset:0 sc1 lds
    ds_read_b128 v[16:19], v2 offset:8192
    s_waitcnt lgkmcnt(6)
    v_mfma_f32_32x32x16_bf16 v[48:63], a[8:11], v[24:27], v[48:63]
    ds_read_b128 v[20:23], v2 offset:9216
    s_waitcnt lgkmcnt(6)
    v_mfma_f32_32x32x16_bf16 v[64:79], a[12:15], v[28:31], v[64:79]
    ds_read_b128 v[24:27], v2 offset:10240
    s_waitcnt lgkmcnt(6)
    v_mfma_f32_32x32x16_bf16 v[48:63], a[16:19], v[32:35], v[48:63]
    buffer_load_dwordx4 v1, s[8:11], s24 offen offset:1024 sc1 lds
    ds_read_b128 v[28:31], v2 offset:11264
    s_waitcnt lgkmcnt(6)
    v_mfma_f32_32x32x16_bf16 v[64:79], a[20:23], v[36:39], v[64:79]
    ds_read_b128 v[32:35], v2 offset:12288
    s_waitcnt lgkmcnt(6)
    v_mfma_f32_32x32x16_bf16 v[48:63], a[24:27], v[40:43], v[48:63]
    ds_read_b128 v[36:39], v2 offset:13312
    s_waitcnt lgkmcnt(6)
    v_mfma_f32_32x32x16_bf16 v[64:79], a[28:31], v[44:47], v[64:79]
    buffer_load_dwordx4 v1, s[8:11], s24 offen offset:2048 sc1 lds
    ds_read_b128 v[40:43], v2 offset:14336
    s_waitcnt lgkmcnt(6)
    v_mfma_f32_32x32x16_bf16 v[48:63], a[32:35], v[16:19], v[48:63]
    ds_read_b128 v[44:47], v2 offset:15360
    s_waitcnt lgkmcnt(6)
    v_mfma_f32_32x32x16_bf16 v[64:79], a[36:39], v[20:23], v[64:79]
    ds_read_b128 v[16:19], v2 offset:16384
    s_waitcnt lgkmcnt(6)
    v_mfma_f32_32x32x16_bf16 v[48:63], a[40:43], v[24:27], v[48:63]
    buffer_load_dwordx4 v1, s[8:11], s24 offen offset:3072 sc1 lds
    ds_read_b128 v[20:23], v2 offset:17408
    s_waitcnt lgkmcnt(6)
    v_mfma_f32_32x32x16_bf16 v[64:79], a[44:47], v[28:31], v[64:79]
    ds_read_b128 v[24:27], v2 offset:18432
    s_waitcnt lgkmcnt(6)
    v_mfma_f32_32x32x16_bf16 v[48:63], a[48:51], v[32:35], v[48:63]
    ds_read_b128 v[28:31], v2 offset:19456
    s_waitcnt lgkmcnt(6)
    v_mfma_f32_32x32x16_bf16 v[64:79], a[52:55], v[36:39], v[64:79]
    s_add_u32 s24, s24, 4096
    s_add_u32 s25, s25, 4096
    s_mov_b32 m0, s25
    s_nop 0
    buffer_load_dwordx4 v1, s[8:11], s24 offen offset:0 sc1 lds
    ds_read_b128 v[32:35], v2 offset:20480
    s_waitcnt lgkmcnt(6)
    v_mfma_f32_32x32x16_bf16 v[48:63], a[56:59], v[40:43], v[48:63]
    ds_read_b128 v[36:39], v2 offset:21504
    s_waitcnt lgkmcnt(6)
    v_mfma_f32_32x32x16_bf16 v[64:79], a[60:63], v[44:47], v[64:79]
    ds_read_b128 v[40:43], v2 offset:22528
    s_waitcnt lgkmcnt(6)
    v_mfma_f32_32x32x16_bf16 v[48:63], a[64:67], v[16:19], v[48:63]
    buffer_load_dwordx4 v1, s[8:11], s24 offen offset:1024 sc1 lds
    ds_read_b128 v[44:47], v2 offset:23552
    s_waitcnt lgkmcnt(6)
    v_mfma_f32_32x32x16_bf16 v[64:79], a[68:71], v[20:23], v[64:79]
    ds_read_b128 v[16:19], v2 offset:24576
    s_waitcnt lgkmcnt(6)
    v_mfma_f32_32x32x16_bf16 v[48:63], a[72:75], v[24:27], v[48:63]
    ds_read_b128 v[20:23], v2 offset:25600
    s_waitcnt lgkmcnt(6)
    v_mfma_f32_32x32x16_bf16 v[64:79], a[76:79], v[28:31], v[64:79]
    buffer_load_dwordx4 v1, s[8:11], s24 offen offset:2048 sc1 lds
    ds_read_b128 v[24:27], v2 offset:26624
    s_waitcnt lgkmcnt(6)
    v_mfma_f32_32x32x16_bf16 v[48:63], a[80:83], v[32:35], v[48:63]
    ds_read_b128 v[28:31], v2 offset:27648
    s_waitcnt lgkmcnt(6)
    v_mfma_f32_32x32x16_bf16 v[64:79], a[84:87], v[36:39], v[64:79]
    ds_read_b128 v[32:35], v2 offset:28672
    s_waitcnt lgkmcnt(6)
    v_mfma_f32_32x32x16_bf16 v[48:63], a[88:91], v[40:43], v[48:63]
    buffer_load_dwordx4 v1, s[8:11], s24 offen offset:3072 sc1 lds
    ds_read_b128 v[36:39], v2 offset:29696
    s_waitcnt lgkmcnt(6)
    v_mfma_f32_32x32x16_bf16 v[64:79], a[92:95], v[44:47], v[64:79]
    ds_read_b128 v[40:43], v2 offset:30720
    s_waitcnt lgkmcnt(6)
    v_mfma_f32_32x32x16_bf16 v[48:63], a[96:99], v[16:19], v[48:63]
    ds_read_b128 v[44:47], v2 offset:31744
    s_waitcnt lgkmcnt(6)
    v_mfma_f32_32x32x16_bf16 v[64:79], a[100:103], v[20:23], v[64:79]
    s_add_u32 s24, s24, 4096
    s_add_u32 s25, s25, 4096
    s_mov_b32 m0, s25
    s_nop 0
    buffer_load_dwordx4 v1, s[8:11], s24 offen offset:0 sc1 lds
    ds_read_b128 v[16:19], v2 offset:32768
    s_waitcnt lgkmcnt(6)
    v_mfma_f32_32x32x16_bf16 v[48:63], a[104:107], v[24:27], v[48:63]
    ds_read_b128 v[20:23], v2 offset:33792
    s_waitcnt lgkmcnt(6)
    v_mfma_f32_32x32x16_bf16 v[64:79], a[108:111], v[28:31], v[64:79]
    ds_read_b128 v[24:27], v2 offset:34816
    s_waitcnt lgkmcnt(6)
    v_mfma_f32_32x32x16_bf16 v[48:63], a[112:115], v[32:35], v[48:63]
    buffer_load_dwordx4 v1, s[8:11], s24 offen offset:1024 sc1 lds
    ds_read_b128 v[28:31], v2 offset:35840
    s_waitcnt lgkmcnt(6)
    v_mfma_f32_32x32x16_bf16 v[64:79], a[116:119], v[36:39], v[64:79]
    ds_read_b128 v[32:35], v2 offset:36864
    s_waitcnt lgkmcnt(6)
    v_mfma_f32_32x32x16_bf16 v[48:63], a[120:123], v[40:43], v[48:63]
    ds_read_b128 v[36:39], v2 offset:37888
    s_waitcnt lgkmcnt(6)
    v_mfma_f32_32x32x16_bf16 v[64:79], a[124:127], v[44:47], v[64:79]
    ds_read_b128 v[40:43], v2 offset:38912
    s_waitcnt lgkmcnt(6)
    v_mfma_f32_32x32x16_bf16 v[48:63], a[128:131], v[16:19], v[48:63]
    ds_read_b128 v[44:47], v2 offset:39936
    s_waitcnt lgkmcnt(6)
    v_mfma_f32_32x32x16_bf16 v[64:79], a[132:135], v[20:23], v[64:79]
    s_waitcnt lgkmcnt(5)
    v_mfma_f32_32x32x16_bf16 v[48:63], a[136:139], v[24:27], v[48:63]
    s_waitcnt lgkmcnt(4)
    v_mfma_f32_32x32x16_bf16 v[64:79], a[140:143], v[28:31], v[64:79]
    s_waitcnt lgkmcnt(3)
    v_mfma_f32_32x32x16_bf16 v[48:63], a[144:147], v[32:35], v[48:63]
    s_waitcnt lgkmcnt(2)
    v_mfma_f32_32x32x16_bf16 v[64:79], a[148:151], v[36:39], v[64:79]
    s_waitcnt lgkmcnt(1)
    v_mfma_f32_32x32x16_bf16 v[48:63], a[152:155], v[40:43], v[48:63]
    s_waitcnt lgkmcnt(0)
    v_mfma_f32_32x32x16_bf16 v[64:79], a[156:159], v[44:47], v[64:79]
    s_waitcnt vmcnt(12)
    s_nop 7
    s_nop 3
    v_add_f32 v48, v48, v64
    v_add_f32 v49, v49, v65
    v_add_f32 v50, v50, v66
    v_add_f32 v51, v51, v67
    v_add_f32 v52, v52, v68
    v_add_f32 v53, v53, v69
    v_add_f32 v54, v54, v70
    v_add_f32 v55, v55, v71
    v_add_f32 v56, v56, v72
    v_add_f32 v57, v57, v73
    v_add_f32 v58, v58, v74
    v_add_f32 v59, v59, v75
    v_add_f32 v60, v60, v76
    v_add_f32 v61, v61, v77
    v_add_f32 v62, v62, v78
    v_add_f32 v63, v63, v79
    s_add_u32 s26, s19, 226492416
    v_cvt_pk_bf16_f32 v80, v48, v49
    v_cvt_pk_bf16_f32 v81, v50, v51
    v_cvt_pk_bf16_f32 v82, v52, v53
    v_cvt_pk_bf16_f32 v83, v54, v55
    s_nop 1
    v_permlane32_swap_b32 v80, v82
    v_permlane32_swap_b32 v81, v83
    s_nop 1
    v_lshlrev_b32 v88, 16, v80
    v_and_b32 v89, 0xffff0000, v80
    v_lshlrev_b32 v90, 16, v96
    v_and_b32 v91, 0xffff0000, v96
    v_add_f32 v88, v88, v90
    v_add_f32 v89, v89, v91
    v_cvt_pk_bf16_f32 v80, v88, v89
    v_lshlrev_b32 v92, 16, v81
    v_and_b32 v93, 0xffff0000, v81
    v_lshlrev_b32 v94, 16, v97
    v_and_b32 v95, 0xffff0000, v97
    v_add_f32 v92, v92, v94
    v_add_f32 v93, v93, v95
    v_cvt_pk_bf16_f32 v81, v92, v93
    v_lshlrev_b32 v88, 16, v82
    v_and_b32 v89, 0xffff0000, v82
    v_lshlrev_b32 v90, 16, v98
    v_and_b32 v91, 0xffff0000, v98
    v_add_f32 v88, v88, v90
    v_add_f32 v89, v89, v91
    v_cvt_pk_bf16_f32 v82, v88, v89
    v_lshlrev_b32 v92, 16, v83
    v_and_b32 v93, 0xffff0000, v83
    v_lshlrev_b32 v94, 16, v99
    v_and_b32 v95, 0xffff0000, v99
    v_add_f32 v92, v92, v94
    v_add_f32 v93, v93, v95
    v_cvt_pk_bf16_f32 v83, v92, v93
    buffer_store_dwordx4 v[80:83], v3, s[8:11], s26 offen offset:0 sc1
    v_cvt_pk_bf16_f32 v84, v56, v57
    v_cvt_pk_bf16_f32 v85, v58, v59
    v_cvt_pk_bf16_f32 v86, v60, v61
    v_cvt_pk_bf16_f32 v87, v62, v63
    s_nop 1
    v_permlane32_swap_b32 v84, v86
    v_permlane32_swap_b32 v85, v87
    s_nop 1
    v_lshlrev_b32 v88, 16, v84
    v_and_b32 v89, 0xffff0000, v84
    v_lshlrev_b32 v90, 16, v100
    v_and_b32 v91, 0xffff0000, v100
    v_add_f32 v88, v88, v90
    v_add_f32 v89, v89, v91
    v_cvt_pk_bf16_f32 v84, v88, v89
    v_lshlrev_b32 v92, 16, v85
    v_and_b32 v93, 0xffff0000, v85
    v_lshlrev_b32 v94, 16, v101
    v_and_b32 v95, 0xffff0000, v101
    v_add_f32 v92, v92, v94
    v_add_f32 v93, v93, v95
    v_cvt_pk_bf16_f32 v85, v92, v93
    v_lshlrev_b32 v88, 16, v86
    v_and_b32 v89, 0xffff0000, v86
    v_lshlrev_b32 v90, 16, v102
    v_and_b32 v91, 0xffff0000, v102
    v_add_f32 v88, v88, v90
    v_add_f32 v89, v89, v91
    v_cvt_pk_bf16_f32 v86, v88, v89
    v_lshlrev_b32 v92, 16, v87
    v_and_b32 v93, 0xffff0000, v87
    v_lshlrev_b32 v94, 16, v103
    v_and_b32 v95, 0xffff0000, v103
    v_add_f32 v92, v92, v94
    v_add_f32 v93, v93, v95
    v_cvt_pk_bf16_f32 v87, v92, v93
    buffer_store_dwordx4 v[84:87], v3, s[8:11], s26 offen offset:32 sc1
    s_waitcnt vmcnt(0)
    s_mov_b64 exec, 1
    s_add_u32 s26, s48, s20
    buffer_store_dword v5, v4, s[8:11], s26 offen sc1
    s_mov_b64 exec, -1
    s_add_u32 s20, s20, 128
    s_add_u32 s19, s19, 40960
    s_add_u32 s16, s16, 40960
    s_cmp_eq_u32 s16, 122880
    s_cselect_b32 s16, 0, s16
    s_add_u32 s14, s14, 1
    s_cmp_ge_u32 s14, s15
    s_cbranch_scc1 layerb1_kernel_ab_fin
    s_add_u32 s23, s14, 2
    s_cmp_lg_u32 s13, 0
    s_cbranch_scc1 layerb1_kernel_ab_ow4
    s_min_u32 s28, s23, 63
    s_cmp_gt_u32 s22, s28
    s_cbranch_scc1 layerb1_kernel_ab_ow4
layerb1_kernel_ab_op4:
    buffer_load_dwordx4 v[116:119], v1, s[8:11], s29 offen sc1
    s_waitcnt vmcnt(0)
    v_min_u32 v116, v116, v117
    v_min_u32 v118, v118, v119
    v_min_u32 v114, v116, v118
    v_cmp_eq_u32 vcc, 0, v114
    s_nop 1
    s_ff1_i32_b64 s22, vcc
    s_min_u32 s22, s22, 64
    s_and_b32 s22, s22, 0x7c
    s_sub_u32 s30, s30, 1
    s_cbranch_scc1 layerb1_kernel_bail
    s_cmp_gt_u32 s22, s28
    s_cbranch_scc0 layerb1_kernel_ab_op4
layerb1_kernel_ab_ow4:
    s_barrier
    v_add_u32 v2, s16, v1
    ds_read_b128 v[16:19], v2 offset:0
    ds_read_b128 v[20:23], v2 offset:1024
    ds_read_b128 v[24:27], v2 offset:2048
    ds_read_b128 v[28:31], v2 offset:3072
    ds_read_b128 v[32:35], v2 offset:4096
    ds_read_b128 v[36:39], v2 offset:5120
    s_add_u32 s27, s19, 40960
    s_cmp_ge_u32 s14, 63
    s_cselect_b32 s27, s19, s27
    buffer_load_dwordx4 v[96:99], v3, s[52:55], s27 offen offset:0
    buffer_load_dwordx4 v[100:103], v3, s[52:55], s27 offen offset:32
    s_add_u32 s23, s14, 2
    s_min_u32 s24, s23, 63
    s_mul_i32 s24, s24, 40960
    s_add_u32 s24, s24, s18
    s_mul_i32 s25, s13, 10240
    s_add_u32 s25, s25, s17
    s_add_u32 s17, s17, 40960
    s_cmp_eq_u32 s17, 122880
    s_cselect_b32 s17, 0, s17
    ds_read_b128 v[40:43], v2 offset:6144
    s_waitcnt lgkmcnt(6)
    v_mfma_f32_32x32x16_bf16 v[48:63], a[0:3], v[16:19], 0
    ds_read_b128 v[44:47], v2 offset:7168
    s_waitcnt lgkmcnt(6)
    v_mfma_f32_32x32x16_bf16 v[64:79], a[4:7], v[20:23], 0
    s_mov_b32 m0, s25
    s_nop 0
    buffer_load_dwordx4 v1, s[8:11], s24 offen offset:0 sc1 lds
    ds_read_b128 v[16:19], v2 offset:8192
    s_waitcnt lgkmcnt(6)
    v_mfma_f32_32x32x16_bf16 v[48:63], a[8:11], v[24:27], v[48:63]
    ds_read_b128 v[20:23], v2 offset:9216
    s_waitcnt lgkmcnt(6)
    v_mfma_f32_32x32x16_bf16 v[64:79], a[12:15], v[28:31], v[64:79]
    ds_read_b128 v[24:27], v2 offset:10240
    s_waitcnt lgkmcnt(6)
    v_mfma_f32_32x32x16_bf16 v[48:63], a[16:19], v[32:35], v[48:63]
    buffer_load_dwordx4 v1, s[8:11], s24 offen offset:1024 sc1 lds
    ds_read_b128 v[28:31], v2 offset:11264
    s_waitcnt lgkmcnt(6)
    v_mfma_f32_32x32x16_bf16 v[64:79], a[20:23], v[36:39], v[64:79]
    ds_read_b128 v[32:35], v2 offset:12288
    s_waitcnt lgkmcnt(6)
    v_mfma_f32_32x32x16_bf16 v[48:63], a[24:27], v[40:43], v[48:63]
    ds_read_b128 v[36:39], v2 offset:13312
    s_waitcnt lgkmcnt(6)
    v_mfma_f32_32x32x16_bf16 v[64:79], a[28:31], v[44:47], v[64:79]
    buffer_load_dwordx4 v1, s[8:11], s24 offen offset:2048 sc1 lds
    ds_read_b128 v[40:43], v2 offset:14336
    s_waitcnt lgkmcnt(6)
    v_mfma_f32_32x32x16_bf16 v[48:63], a[32:35], v[16:19], v[48:63]
    ds_read_b128 v[44:47], v2 offset:15360
    s_waitcnt lgkmcnt(6)
    v_mfma_f32_32x32x16_bf16 v[64:79], a[36:39], v[20:23], v[64:79]
    ds_read_b128 v[16:19], v2 offset:16384
    s_waitcnt lgkmcnt(6)
    v_mfma_f32_32x32x16_bf16 v[48:63], a[40:43], v[24:27], v[48:63]
    buffer_load_dwordx4 v1, s[8:11], s24 offen offset:3072 sc1 lds
    ds_read_b128 v[20:23], v2 offset:17408
    s_waitcnt lgkmcnt(6)
    v_mfma_f32_32x32x16_bf16 v[64:79], a[44:47], v[28:31], v[64:79]
    ds_read_b128 v[24:27], v2 offset:18432
    s_waitcnt lgkmcnt(6)
    v_mfma_f32_32x32x16_bf16 v[48:63], a[48:51], v[32:35], v[48:63]
    ds_read_b128 v[28:31], v2 offset:19456
    s_waitcnt lgkmcnt(6)
    v_mfma_f32_32x32x16_bf16 v[64:79], a[52:55], v[36:39], v[64:79]
    s_add_u32 s24, s24, 4096
    s_add_u32 s25, s25, 4096
    s_mov_b32 m0, s25
    s_nop 0
    buffer_load_dwordx4 v1, s[8:11], s24 offen offset:0 sc1 lds
    ds_read_b128 v[32:35], v2 offset:20480
    s_waitcnt lgkmcnt(6)
    v_mfma_f32_32x32x16_bf16 v[48:63], a[56:59], v[40:43], v[48:63]
    ds_read_b128 v[36:39], v2 offset:21504
    s_waitcnt lgkmcnt(6)
    v_mfma_f32_32x32x16_bf16 v[64:79], a[60:63], v[44:47], v[64:79]
    ds_read_b128 v[40:43], v2 offset:22528
    s_waitcnt lgkmcnt(6)
    v_mfma_f32_32x32x16_bf16 v[48:63], a[64:67], v[16:19], v[48:63]
    buffer_load_dwordx4 v1, s[8:11], s24 offen offset:1024 sc1 lds
    ds_read_b128 v[44:47], v2 offset:23552
    s_waitcnt lgkmcnt(6)
    v_mfma_f32_32x32x16_bf16 v[64:79], a[68:71], v[20:23], v[64:79]
    ds_read_b128 v[16:19], v2 offset:24576
    s_waitcnt lgkmcnt(6)
    v_mfma_f32_32x32x16_bf16 v[48:63], a[72:75], v[24:27], v[48:63]
    ds_read_b128 v[20:23], v2 offset:25600
    s_waitcnt lgkmcnt(6)
    v_mfma_f32_32x32x16_bf16 v[64:79], a[76:79], v[28:31], v[64:79]
    buffer_load_dwordx4 v1, s[8:11], s24 offen offset:2048 sc1 lds
    ds_read_b128 v[24:27], v2 offset:26624
    s_waitcnt lgkmcnt(6)
    v_mfma_f32_32x32x16_bf16 v[48:63], a[80:83], v[32:35], v[48:63]
    ds_read_b128 v[28:31], v2 offset:27648
    s_waitcnt lgkmcnt(6)
    v_mfma_f32_32x32x16_bf16 v[64:79], a[84:87], v[36:39], v[64:79]
    ds_read_b128 v[32:35], v2 offset:28672
    s_waitcnt lgkmcnt(6)
    v_mfma_f32_32x32x16_bf16 v[48:63], a[88:91], v[40:43], v[48:63]
    buffer_load_dwordx4 v1, s[8:11], s24 offen offset:3072 sc1 lds
    ds_read_b128 v[36:39], v2 offset:29696
    s_waitcnt lgkmcnt(6)
    v_mfma_f32_32x32x16_bf16 v[64:79], a[92:95], v[44:47], v[64:79]
    ds_read_b128 v[40:43], v2 offset:30720
    s_waitcnt lgkmcnt(6)
    v_mfma_f32_32x32x16_bf16 v[48:63], a[96:99], v[16:19], v[48:63]
    ds_read_b128 v[44:47], v2 offset:31744
    s_waitcnt lgkmcnt(6)
    v_mfma_f32_32x32x16_bf16 v[64:79], a[100:103], v[20:23], v[64:79]
    s_add_u32 s24, s24, 4096
    s_add_u32 s25, s25, 4096
    s_mov_b32 m0, s25
    s_nop 0
    buffer_load_dwordx4 v1, s[8:11], s24 offen offset:0 sc1 lds
    ds_read_b128 v[16:19], v2 offset:32768
    s_waitcnt lgkmcnt(6)
    v_mfma_f32_32x32x16_bf16 v[48:63], a[104:107], v[24:27], v[48:63]
    ds_read_b128 v[20:23], v2 offset:33792
    s_waitcnt lgkmcnt(6)
    v_mfma_f32_32x32x16_bf16 v[64:79], a[108:111], v[28:31], v[64:79]
    ds_read_b128 v[24:27], v2 offset:34816
    s_waitcnt lgkmcnt(6)
    v_mfma_f32_32x32x16_bf16 v[48:63], a[112:115], v[32:35], v[48:63]
    buffer_load_dwordx4 v1, s[8:11], s24 offen offset:1024 sc1 lds
    ds_read_b128 v[28:31], v2 offset:35840
    s_waitcnt lgkmcnt(6)
    v_mfma_f32_32x32x16_bf16 v[64:79], a[116:119], v[36:39], v[64:79]
    ds_read_b128 v[32:35], v2 offset:36864
    s_waitcnt lgkmcnt(6)
    v_mfma_f32_32x32x16_bf16 v[48:63], a[120:123], v[40:43], v[48:63]
    ds_read_b128 v[36:39], v2 offset:37888
    s_waitcnt lgkmcnt(6)
    v_mfma_f32_32x32x16_bf16 v[64:79], a[124:127], v[44:47], v[64:79]
    ds_read_b128 v[40:43], v2 offset:38912
    s_waitcnt lgkmcnt(6)
    v_mfma_f32_32x32x16_bf16 v[48:63], a[128:131], v[16:19], v[48:63]
    ds_read_b128 v[44:47], v2 offset:39936
    s_waitcnt lgkmcnt(6)
    v_mfma_f32_32x32x16_bf16 v[64:79], a[132:135], v[20:23], v[64:79]
    s_waitcnt lgkmcnt(5)
    v_mfma_f32_32x32x16_bf16 v[48:63], a[136:139], v[24:27], v[48:63]
    s_waitcnt lgkmcnt(4)
    v_mfma_f32_32x32x16_bf16 v[64:79], a[140:143], v[28:31], v[64:79]
    s_waitcnt lgkmcnt(3)
    v_mfma_f32_32x32x16_bf16 v[48:63], a[144:147], v[32:35], v[48:63]
    s_waitcnt lgkmcnt(2)
    v_mfma_f32_32x32x16_bf16 v[64:79], a[148:151], v[36:39], v[64:79]
    s_waitcnt lgkmcnt(1)
    v_mfma_f32_32x32x16_bf16 v[48:63], a[152:155], v[40:43], v[48:63]
    s_waitcnt lgkmcnt(0)
    v_mfma_f32_32x32x16_bf16 v[64:79], a[156:159], v[44:47], v[64:79]
    s_waitcnt vmcnt(12)
    s_nop 7
    s_nop 3
    v_add_f32 v48, v48, v64
    v_add_f32 v49, v49, v65
    v_add_f32 v50, v50, v66
    v_add_f32 v51, v51, v67
    v_add_f32 v52, v52, v68
    v_add_f32 v53, v53, v69
    v_add_f32 v54, v54, v70
    v_add_f32 v55, v55, v71
    v_add_f32 v56, v56, v72
    v_add_f32 v57, v57, v73
    v_add_f32 v58, v58, v74
    v_add_f32 v59, v59, v75
    v_add_f32 v60, v60, v76
    v_add_f32 v61, v61, v77
    v_add_f32 v62, v62, v78
    v_add_f32 v63, v63, v79
    s_add_u32 s26, s19, 226492416
    v_cvt_pk_bf16_f32 v80, v48, v49
    v_cvt_pk_bf16_f32 v81, v50, v51
    v_cvt_pk_bf16_f32 v82, v52, v53
    v_cvt_pk_bf16_f32 v83, v54, v55
    s_nop 1
    v_permlane32_swap_b32 v80, v82
    v_permlane32_swap_b32 v81, v83
    s_nop 1
    v_lshlrev_b32 v88, 16, v80
    v_and_b32 v89, 0xffff0000, v80
    v_lshlrev_b32 v90, 16, v104
    v_and_b32 v91, 0xffff0000, v104
    v_add_f32 v88, v88, v90
    v_add_f32 v89, v89, v91
    v_cvt_pk_bf16_f32 v80, v88, v89
    v_lshlrev_b32 v92, 16, v81
    v_and_b32 v93, 0xffff0000, v81
    v_lshlrev_b32 v94, 16, v105
    v_and_b32 v95, 0xffff0000, v105
    v_add_f32 v92, v92, v94
    v_add_f32 v93, v93, v95
    v_cvt_pk_bf16_f32 v81, v92, v93
    v_lshlrev_b32 v88, 16, v82
    v_and_b32 v89, 0xffff0000, v82
    v_lshlrev_b32 v90, 16, v106
    v_and_b32 v91, 0xffff0000, v106
    v_add_f32 v88, v88, v90
    v_add_f32 v89, v89, v91
    v_cvt_pk_bf16_f32 v82, v88, v89
    v_lshlrev_b32 v92, 16, v83
    v_and_b32 v93, 0xffff0000, v83
    v_lshlrev_b32 v94, 16, v107
    v_and_b32 v95, 0xffff0000, v107
    v_add_f32 v92, v92, v94
    v_add_f32 v93, v93, v95
    v_cvt_pk_bf16_f32 v83, v92, v93
    buffer_store_dwordx4 v[80:83], v3, s[8:11], s26 offen offset:0 sc1
    v_cvt_pk_bf16_f32 v84, v56, v57
    v_cvt_pk_bf16_f32 v85, v58, v59
    v_cvt_pk_bf16_f32 v86, v60, v61
    v_cvt_pk_bf16_f32 v87, v62, v63
    s_nop 1
    v_permlane32_swap_b32 v84, v86
    v_permlane32_swap_b32 v85, v87
    s_nop 1
    v_lshlrev_b32 v88, 16, v84
    v_and_b32 v89, 0xffff0000, v84
    v_lshlrev_b32 v90, 16, v108
    v_and_b32 v91, 0xffff0000, v108
    v_add_f32 v88, v88, v90
    v_add_f32 v89, v89, v91
    v_cvt_pk_bf16_f32 v84, v88, v89
    v_lshlrev_b32 v92, 16, v85
    v_and_b32 v93, 0xffff0000, v85
    v_lshlrev_b32 v94, 16, v109
    v_and_b32 v95, 0xffff0000, v109
    v_add_f32 v92, v92, v94
    v_add_f32 v93, v93, v95
    v_cvt_pk_bf16_f32 v85, v92, v93
    v_lshlrev_b32 v88, 16, v86
    v_and_b32 v89, 0xffff0000, v86
    v_lshlrev_b32 v90, 16, v110
    v_and_b32 v91, 0xffff0000, v110
    v_add_f32 v88, v88, v90
    v_add_f32 v89, v89, v91
    v_cvt_pk_bf16_f32 v86, v88, v89
    v_lshlrev_b32 v92, 16, v87
    v_and_b32 v93, 0xffff0000, v87
    v_lshlrev_b32 v94, 16, v111
    v_and_b32 v95, 0xffff0000, v111
    v_add_f32 v92, v92, v94
    v_add_f32 v93, v93, v95
    v_cvt_pk_bf16_f32 v87, v92, v93
    buffer_store_dwordx4 v[84:87], v3, s[8:11], s26 offen offset:32 sc1
    s_waitcnt vmcnt(0)
    s_mov_b64 exec, 1
    s_add_u32 s26, s48, s20
    buffer_store_dword v5, v4, s[8:11], s26 offen sc1
    s_mov_b64 exec, -1
    s_add_u32 s20, s20, 128
    s_add_u32 s19, s19, 40960
    s_add_u32 s16, s16, 40960
    s_cmp_eq_u32 s16, 122880
    s_cselect_b32 s16, 0, s16
    s_add_u32 s14, s14, 1
    s_cmp_ge_u32 s14, s15
    s_cbranch_scc1 layerb1_kernel_ab_fin
    s_add_u32 s23, s14, 2
    s_cmp_lg_u32 s13, 0
    s_cbranch_scc1 layerb1_kernel_ab_ow5
    s_min_u32 s28, s23, 63
    s_cmp_gt_u32 s22, s28
    s_cbranch_scc1 layerb1_kernel_ab_ow5
layerb1_kernel_ab_op5:
    buffer_load_dwordx4 v[116:119], v1, s[8:11], s29 offen sc1
    s_waitcnt vmcnt(0)
    v_min_u32 v116, v116, v117
    v_min_u32 v118, v118, v119
    v_min_u32 v114, v116, v118
    v_cmp_eq_u32 vcc, 0, v114
    s_nop 1
    s_ff1_i32_b64 s22, vcc
    s_min_u32 s22, s22, 64
    s_and_b32 s22, s22, 0x7c
    s_sub_u32 s30, s30, 1
    s_cbranch_scc1 layerb1_kernel_bail
    s_cmp_gt_u32 s22, s28
    s_cbranch_scc0 layerb1_kernel_ab_op5
layerb1_kernel_ab_ow5:
    s_barrier
    v_add_u32 v2, s16, v1
    ds_read_b128 v[16:19], v2 offset:0
    ds_read_b128 v[20:23], v2 offset:1024
    ds_read_b128 v[24:27], v2 offset:2048
    ds_read_b128 v[28:31], v2 offset:3072
    ds_read_b128 v[32:35], v2 offset:4096
    ds_read_b128 v[36:39], v2 offset:5120
    s_add_u32 s27, s19, 40960
    s_cmp_ge_u32 s14, 63
    s_cselect_b32 s27, s19, s27
    buffer_load_dwordx4 v[104:107], v3, s[52:55], s27 offen offset:0
    buffer_load_dwordx4 v[108:111], v3, s[52:55], s27 offen offset:32
    s_add_u32 s23, s14, 2
    s_min_u32 s24, s23, 63
    s_mul_i32 s24, s24, 40960
    s_add_u32 s24, s24, s18
    s_mul_i32 s25, s13, 10240
    s_add_u32 s25, s25, s17
    s_add_u32 s17, s17, 40960
    s_cmp_eq_u32 s17, 122880
    s_cselect_b32 s17, 0, s17
    ds_read_b128 v[40:43], v2 offset:6144
    s_waitcnt lgkmcnt(6)
    v_mfma_f32_32x32x16_bf16 v[48:63], a[0:3], v[16:19], 0
    ds_read_b128 v[44:47], v2 offset:7168
    s_waitcnt lgkmcnt(6)
    v_mfma_f32_32x32x16_bf16 v[64:79], a[4:7], v[20:23], 0
    s_mov_b32 m0, s25
    s_nop 0
    buffer_load_dwordx4 v1, s[8:11], s24 offen offset:0 sc1 lds
    ds_read_b128 v[16:19], v2 offset:8192
    s_waitcnt lgkmcnt(6)
    v_mfma_f32_32x32x16_bf16 v[48:63], a[8:11], v[24:27], v[48:63]
    ds_read_b128 v[20:23], v2 offset:9216
    s_waitcnt lgkmcnt(6)
    v_mfma_f32_32x32x16_bf16 v[64:79], a[12:15], v[28:31], v[64:79]
    ds_read_b128 v[24:27], v2 offset:10240
    s_waitcnt lgkmcnt(6)
    v_mfma_f32_32x32x16_bf16 v[48:63], a[16:19], v[32:35], v[48:63]
    buffer_load_dwordx4 v1, s[8:11], s24 offen offset:1024 sc1 lds
    ds_read_b128 v[28:31], v2 offset:11264
    s_waitcnt lgkmcnt(6)
    v_mfma_f32_32x32x16_bf16 v[64:79], a[20:23], v[36:39], v[64:79]
    ds_read_b128 v[32:35], v2 offset:12288
    s_waitcnt lgkmcnt(6)
    v_mfma_f32_32x32x16_bf16 v[48:63], a[24:27], v[40:43], v[48:63]
    ds_read_b128 v[36:39], v2 offset:13312
    s_waitcnt lgkmcnt(6)
    v_mfma_f32_32x32x16_bf16 v[64:79], a[28:31], v[44:47], v[64:79]
    buffer_load_dwordx4 v1, s[8:11], s24 offen offset:2048 sc1 lds
    ds_read_b128 v[40:43], v2 offset:14336
    s_waitcnt lgkmcnt(6)
    v_mfma_f32_32x32x16_bf16 v[48:63], a[32:35], v[16:19], v[48:63]
    ds_read_b128 v[44:47], v2 offset:15360
    s_waitcnt lgkmcnt(6)
    v_mfma_f32_32x32x16_bf16 v[64:79], a[36:39], v[20:23], v[64:79]
    ds_read_b128 v[16:19], v2 offset:16384
    s_waitcnt lgkmcnt(6)
    v_mfma_f32_32x32x16_bf16 v[48:63], a[40:43], v[24:27], v[48:63]
    buffer_load_dwordx4 v1, s[8:11], s24 offen offset:3072 sc1 lds
    ds_read_b128 v[20:23], v2 offset:17408
    s_waitcnt lgkmcnt(6)
    v_mfma_f32_32x32x16_bf16 v[64:79], a[44:47], v[28:31], v[64:79]
    ds_read_b128 v[24:27], v2 offset:18432
    s_waitcnt lgkmcnt(6)
    v_mfma_f32_32x32x16_bf16 v[48:63], a[48:51], v[32:35], v[48:63]
    ds_read_b128 v[28:31], v2 offset:19456
    s_waitcnt lgkmcnt(6)
    v_mfma_f32_32x32x16_bf16 v[64:79], a[52:55], v[36:39], v[64:79]
    s_add_u32 s24, s24, 4096
    s_add_u32 s25, s25, 4096
    s_mov_b32 m0, s25
    s_nop 0
    buffer_load_dwordx4 v1, s[8:11], s24 offen offset:0 sc1 lds
    ds_read_b128 v[32:35], v2 offset:20480
    s_waitcnt lgkmcnt(6)
    v_mfma_f32_32x32x16_bf16 v[48:63], a[56:59], v[40:43], v[48:63]
    ds_read_b128 v[36:39], v2 offset:21504
    s_waitcnt lgkmcnt(6)
    v_mfma_f32_32x32x16_bf16 v[64:79], a[60:63], v[44:47], v[64:79]
    ds_read_b128 v[40:43], v2 offset:22528
    s_waitcnt lgkmcnt(6)
    v_mfma_f32_32x32x16_bf16 v[48:63], a[64:67], v[16:19], v[48:63]
    buffer_load_dwordx4 v1, s[8:11], s24 offen offset:1024 sc1 lds
    ds_read_b128 v[44:47], v2 offset:23552
    s_waitcnt lgkmcnt(6)
    v_mfma_f32_32x32x16_bf16 v[64:79], a[68:71], v[20:23], v[64:79]
    ds_read_b128 v[16:19], v2 offset:24576
    s_waitcnt lgkmcnt(6)
    v_mfma_f32_32x32x16_bf16 v[48:63], a[72:75], v[24:27], v[48:63]
    ds_read_b128 v[20:23], v2 offset:25600
    s_waitcnt lgkmcnt(6)
    v_mfma_f32_32x32x16_bf16 v[64:79], a[76:79], v[28:31], v[64:79]
    buffer_load_dwordx4 v1, s[8:11], s24 offen offset:2048 sc1 lds
    ds_read_b128 v[24:27], v2 offset:26624
    s_waitcnt lgkmcnt(6)
    v_mfma_f32_32x32x16_bf16 v[48:63], a[80:83], v[32:35], v[48:63]
    ds_read_b128 v[28:31], v2 offset:27648
    s_waitcnt lgkmcnt(6)
    v_mfma_f32_32x32x16_bf16 v[64:79], a[84:87], v[36:39], v[64:79]
    ds_read_b128 v[32:35], v2 offset:28672
    s_waitcnt lgkmcnt(6)
    v_mfma_f32_32x32x16_bf16 v[48:63], a[88:91], v[40:43], v[48:63]
    buffer_load_dwordx4 v1, s[8:11], s24 offen offset:3072 sc1 lds
    ds_read_b128 v[36:39], v2 offset:29696
    s_waitcnt lgkmcnt(6)
    v_mfma_f32_32x32x16_bf16 v[64:79], a[92:95], v[44:47], v[64:79]
    ds_read_b128 v[40:43], v2 offset:30720
    s_waitcnt lgkmcnt(6)
    v_mfma_f32_32x32x16_bf16 v[48:63], a[96:99], v[16:19], v[48:63]
    ds_read_b128 v[44:47], v2 offset:31744
    s_waitcnt lgkmcnt(6)
    v_mfma_f32_32x32x16_bf16 v[64:79], a[100:103], v[20:23], v[64:79]
    s_add_u32 s24, s24, 4096
    s_add_u32 s25, s25, 4096
    s_mov_b32 m0, s25
    s_nop 0
    buffer_load_dwordx4 v1, s[8:11], s24 offen offset:0 sc1 lds
    ds_read_b128 v[16:19], v2 offset:32768
    s_waitcnt lgkmcnt(6)
    v_mfma_f32_32x32x16_bf16 v[48:63], a[104:107], v[24:27], v[48:63]
    ds_read_b128 v[20:23], v2 offset:33792
    s_waitcnt lgkmcnt(6)
    v_mfma_f32_32x32x16_bf16 v[64:79], a[108:111], v[28:31], v[64:79]
    ds_read_b128 v[24:27], v2 offset:34816
    s_waitcnt lgkmcnt(6)
    v_mfma_f32_32x32x16_bf16 v[48:63], a[112:115], v[32:35], v[48:63]
    buffer_load_dwordx4 v1, s[8:11], s24 offen offset:1024 sc1 lds
    ds_read_b128 v[28:31], v2 offset:35840
    s_waitcnt lgkmcnt(6)
    v_mfma_f32_32x32x16_bf16 v[64:79], a[116:119], v[36:39], v[64:79]
    ds_read_b128 v[32:35], v2 offset:36864
    s_waitcnt lgkmcnt(6)
    v_mfma_f32_32x32x16_bf16 v[48:63], a[120:123], v[40:43], v[48:63]
    ds_read_b128 v[36:39], v2 offset:37888
    s_waitcnt lgkmcnt(6)
    v_mfma_f32_32x32x16_bf16 v[64:79], a[124:127], v[44:47], v[64:79]
    ds_read_b128 v[40:43], v2 offset:38912
    s_waitcnt lgkmcnt(6)
    v_mfma_f32_32x32x16_bf16 v[48:63], a[128:131], v[16:19], v[48:63]
    ds_read_b128 v[44:47], v2 offset:39936
    s_waitcnt lgkmcnt(6)
    v_mfma_f32_32x32x16_bf16 v[64:79], a[132:135], v[20:23], v[64:79]
    s_waitcnt lgkmcnt(5)
    v_mfma_f32_32x32x16_bf16 v[48:63], a[136:139], v[24:27], v[48:63]
    s_waitcnt lgkmcnt(4)
    v_mfma_f32_32x32x16_bf16 v[64:79], a[140:143], v[28:31], v[64:79]
    s_waitcnt lgkmcnt(3)
    v_mfma_f32_32x32x16_bf16 v[48:63], a[144:147], v[32:35], v[48:63]
    s_waitcnt lgkmcnt(2)
    v_mfma_f32_32x32x16_bf16 v[64:79], a[148:151], v[36:39], v[64:79]
    s_waitcnt lgkmcnt(1)
    v_mfma_f32_32x32x16_bf16 v[48:63], a[152:155], v[40:43], v[48:63]
    s_waitcnt lgkmcnt(0)
    v_mfma_f32_32x32x16_bf16 v[64:79], a[156:159], v[44:47], v[64:79]
    s_waitcnt vmcnt(12)
    s_nop 7
    s_nop 3
    v_add_f32 v48, v48, v64
    v_add_f32 v49, v49, v65
    v_add_f32 v50, v50, v66
    v_add_f32 v51, v51, v67
    v_add_f32 v52, v52, v68
    v_add_f32 v53, v53, v69
    v_add_f32 v54, v54, v70
    v_add_f32 v55, v55, v71
    v_add_f32 v56, v56, v72
    v_add_f32 v57, v57, v73
    v_add_f32 v58, v58, v74
    v_add_f32 v59, v59, v75
    v_add_f32 v60, v60, v76
    v_add_f32 v61, v61, v77
    v_add_f32 v62, v62, v78
    v_add_f32 v63, v63, v79
    s_add_u32 s26, s19, 226492416
    v_cvt_pk_bf16_f32 v80, v48, v49
    v_cvt_pk_bf16_f32 v81, v50, v51
    v_cvt_pk_bf16_f32 v82, v52, v53
    v_cvt_pk_bf16_f32 v83, v54, v55
    s_nop 1
    v_permlane32_swap_b32 v80, v82
    v_permlane32_swap_b32 v81, v83
    s_nop 1
    v_lshlrev_b32 v88, 16, v80
    v_and_b32 v89, 0xffff0000, v80
    v_lshlrev_b32 v90, 16, v96
    v_and_b32 v91, 0xffff0000, v96
    v_add_f32 v88, v88, v90
    v_add_f32 v89, v89, v91
    v_cvt_pk_bf16_f32 v80, v88, v89
    v_lshlrev_b32 v92, 16, v81
    v_and_b32 v93, 0xffff0000, v81
    v_lshlrev_b32 v94, 16, v97
    v_and_b32 v95, 0xffff0000, v97
    v_add_f32 v92, v92, v94
    v_add_f32 v93, v93, v95
    v_cvt_pk_bf16_f32 v81, v92, v93
    v_lshlrev_b32 v88, 16, v82
    v_and_b32 v89, 0xffff0000, v82
    v_lshlrev_b32 v90, 16, v98
    v_and_b32 v91, 0xffff0000, v98
    v_add_f32 v88, v88, v90
    v_add_f32 v89, v89, v91
    v_cvt_pk_bf16_f32 v82, v88, v89
    v_lshlrev_b32 v92, 16, v83
    v_and_b32 v93, 0xffff0000, v83
    v_lshlrev_b32 v94, 16, v99
    v_and_b32 v95, 0xffff0000, v99
    v_add_f32 v92, v92, v94
    v_add_f32 v93, v93, v95
    v_cvt_pk_bf16_f32 v83, v92, v93
    buffer_store_dwordx4 v[80:83], v3, s[8:11], s26 offen offset:0 sc1
    v_cvt_pk_bf16_f32 v84, v56, v57
    v_cvt_pk_bf16_f32 v85, v58, v59
    v_cvt_pk_bf16_f32 v86, v60, v61
    v_cvt_pk_bf16_f32 v87, v62, v63
    s_nop 1
    v_permlane32_swap_b32 v84, v86
    v_permlane32_swap_b32 v85, v87
    s_nop 1
    v_lshlrev_b32 v88, 16, v84
    v_and_b32 v89, 0xffff0000, v84
    v_lshlrev_b32 v90, 16, v100
    v_and_b32 v91, 0xffff0000, v100
    v_add_f32 v88, v88, v90
    v_add_f32 v89, v89, v91
    v_cvt_pk_bf16_f32 v84, v88, v89
    v_lshlrev_b32 v92, 16, v85
    v_and_b32 v93, 0xffff0000, v85
    v_lshlrev_b32 v94, 16, v101
    v_and_b32 v95, 0xffff0000, v101
    v_add_f32 v92, v92, v94
    v_add_f32 v93, v93, v95
    v_cvt_pk_bf16_f32 v85, v92, v93
    v_lshlrev_b32 v88, 16, v86
    v_and_b32 v89, 0xffff0000, v86
    v_lshlrev_b32 v90, 16, v102
    v_and_b32 v91, 0xffff0000, v102
    v_add_f32 v88, v88, v90
    v_add_f32 v89, v89, v91
    v_cvt_pk_bf16_f32 v86, v88, v89
    v_lshlrev_b32 v92, 16, v87
    v_and_b32 v93, 0xffff0000, v87
    v_lshlrev_b32 v94, 16, v103
    v_and_b32 v95, 0xffff0000, v103
    v_add_f32 v92, v92, v94
    v_add_f32 v93, v93, v95
    v_cvt_pk_bf16_f32 v87, v92, v93
    buffer_store_dwordx4 v[84:87], v3, s[8:11], s26 offen offset:32 sc1
    s_waitcnt vmcnt(0)
    s_mov_b64 exec, 1
    s_add_u32 s26, s48, s20
    buffer_store_dword v5, v4, s[8:11], s26 offen sc1
    s_mov_b64 exec, -1
    s_add_u32 s20, s20, 128
    s_add_u32 s19, s19, 40960
    s_add_u32 s16, s16, 40960
    s_cmp_eq_u32 s16, 122880
    s_cselect_b32 s16, 0, s16
    s_add_u32 s14, s14, 1
    s_cmp_ge_u32 s14, s15
    s_cbranch_scc1 layerb1_kernel_ab_fin
    s_add_u32 s23, s14, 2
    s_cmp_lg_u32 s13, 0
    s_cbranch_scc1 layerb1_kernel_ab_ow6
    s_min_u32 s28, s23, 63
    s_cmp_gt_u32 s22, s28
    s_cbranch_scc1 layerb1_kernel_ab_ow6
layerb1_kernel_ab_op6:
    buffer_load_dwordx4 v[116:119], v1, s[8:11], s29 offen sc1
    s_waitcnt vmcnt(0)
    v_min_u32 v116, v116, v117
    v_min_u32 v118, v118, v119
    v_min_u32 v114, v116, v118
    v_cmp_eq_u32 vcc, 0, v114
    s_nop 1
    s_ff1_i32_b64 s22, vcc
    s_min_u32 s22, s22, 64
    s_and_b32 s22, s22, 0x7c
    s_sub_u32 s30, s30, 1
    s_cbranch_scc1 layerb1_kernel_bail
    s_cmp_gt_u32 s22, s28
    s_cbranch_scc0 layerb1_kernel_ab_op6
layerb1_kernel_ab_ow6:
    s_barrier
    v_add_u32 v2, s16, v1
    ds_read_b128 v[16:19], v2 offset:0
    ds_read_b128 v[20:23], v2 offset:1024
    ds_read_b128 v[24:27], v2 offset:2048
    ds_read_b128 v[28:31], v2 offset:3072
    ds_read_b128 v[32:35], v2 offset:4096
    ds_read_b128 v[36:39], v2 offset:5120
    s_add_u32 s27, s19, 40960
    s_cmp_ge_u32 s14, 63
    s_cselect_b32 s27, s19, s27
    buffer_load_dwordx4 v[96:99], v3, s[52:55], s27 offen offset:0
    buffer_load_dwordx4 v[100:103], v3, s[52:55], s27 offen offset:32
    s_add_u32 s23, s14, 2
    s_min_u32 s24, s23, 63
    s_mul_i32 s24, s24, 40960
    s_add_u32 s24, s24, s18
    s_mul_i32 s25, s13, 10240
    s_add_u32 s25, s25, s17
    s_add_u32 s17, s17, 40960
    s_cmp_eq_u32 s17, 122880
    s_cselect_b32 s17, 0, s17
    ds_read_b128 v[40:43], v2 offset:6144
    s_waitcnt lgkmcnt(6)
    v_mfma_f32_32x32x16_bf16 v[48:63], a[0:3], v[16:19], 0
    ds_read_b128 v[44:47], v2 offset:7168
    s_waitcnt lgkmcnt(6)
    v_mfma_f32_32x32x16_bf16 v[64:79], a[4:7], v[20:23], 0
    s_mov_b32 m0, s25
    s_nop 0
    buffer_load_dwordx4 v1, s[8:11], s24 offen offset:0 sc1 lds
    ds_read_b128 v[16:19], v2 offset:8192
    s_waitcnt lgkmcnt(6)
    v_mfma_f32_32x32x16_bf16 v[48:63], a[8:11], v[24:27], v[48:63]
    ds_read_b128 v[20:23], v2 offset:9216
    s_waitcnt lgkmcnt(6)
    v_mfma_f32_32x32x16_bf16 v[64:79], a[12:15], v[28:31], v[64:79]
    ds_read_b128 v[24:27], v2 offset:10240
    s_waitcnt lgkmcnt(6)
    v_mfma_f32_32x32x16_bf16 v[48:63], a[16:19], v[32:35], v[48:63]
    buffer_load_dwordx4 v1, s[8:11], s24 offen offset:1024 sc1 lds
    ds_read_b128 v[28:31], v2 offset:11264
    s_waitcnt lgkmcnt(6)
    v_mfma_f32_32x32x16_bf16 v[64:79], a[20:23], v[36:39], v[64:79]
    ds_read_b128 v[32:35], v2 offset:12288
    s_waitcnt lgkmcnt(6)
    v_mfma_f32_32x32x16_bf16 v[48:63], a[24:27], v[40:43], v[48:63]
    ds_read_b128 v[36:39], v2 offset:13312
    s_waitcnt lgkmcnt(6)
    v_mfma_f32_32x32x16_bf16 v[64:79], a[28:31], v[44:47], v[64:79]
    buffer_load_dwordx4 v1, s[8:11], s24 offen offset:2048 sc1 lds
    ds_read_b128 v[40:43], v2 offset:14336
    s_waitcnt lgkmcnt(6)
    v_mfma_f32_32x32x16_bf16 v[48:63], a[32:35], v[16:19], v[48:63]
    ds_read_b128 v[44:47], v2 offset:15360
    s_waitcnt lgkmcnt(6)
    v_mfma_f32_32x32x16_bf16 v[64:79], a[36:39], v[20:23], v[64:79]
    ds_read_b128 v[16:19], v2 offset:16384
    s_waitcnt lgkmcnt(6)
    v_mfma_f32_32x32x16_bf16 v[48:63], a[40:43], v[24:27], v[48:63]
    buffer_load_dwordx4 v1, s[8:11], s24 offen offset:3072 sc1 lds
    ds_read_b128 v[20:23], v2 offset:17408
    s_waitcnt lgkmcnt(6)
    v_mfma_f32_32x32x16_bf16 v[64:79], a[44:47], v[28:31], v[64:79]
    ds_read_b128 v[24:27], v2 offset:18432
    s_waitcnt lgkmcnt(6)
    v_mfma_f32_32x32x16_bf16 v[48:63], a[48:51], v[32:35], v[48:63]
    ds_read_b128 v[28:31], v2 offset:19456
    s_waitcnt lgkmcnt(6)
    v_mfma_f32_32x32x16_bf16 v[64:79], a[52:55], v[36:39], v[64:79]
    s_add_u32 s24, s24, 4096
    s_add_u32 s25, s25, 4096
    s_mov_b32 m0, s25
    s_nop 0
    buffer_load_dwordx4 v1, s[8:11], s24 offen offset:0 sc1 lds
    ds_read_b128 v[32:35], v2 offset:20480
    s_waitcnt lgkmcnt(6)
    v_mfma_f32_32x32x16_bf16 v[48:63], a[56:59], v[40:43], v[48:63]
    ds_read_b128 v[36:39], v2 offset:21504
    s_waitcnt lgkmcnt(6)
    v_mfma_f32_32x32x16_bf16 v[64:79], a[60:63], v[44:47], v[64:79]
    ds_read_b128 v[40:43], v2 offset:22528
    s_waitcnt lgkmcnt(6)
    v_mfma_f32_32x32x16_bf16 v[48:63], a[64:67], v[16:19], v[48:63]
    buffer_load_dwordx4 v1, s[8:11], s24 offen offset:1024 sc1 lds
    ds_read_b128 v[44:47], v2 offset:23552
    s_waitcnt lgkmcnt(6)
    v_mfma_f32_32x32x16_bf16 v[64:79], a[68:71], v[20:23], v[64:79]
    ds_read_b128 v[16:19], v2 offset:24576
    s_waitcnt lgkmcnt(6)
    v_mfma_f32_32x32x16_bf16 v[48:63], a[72:75], v[24:27], v[48:63]
    ds_read_b128 v[20:23], v2 offset:25600
    s_waitcnt lgkmcnt(6)
    v_mfma_f32_32x32x16_bf16 v[64:79], a[76:79], v[28:31], v[64:79]
    buffer_load_dwordx4 v1, s[8:11], s24 offen offset:2048 sc1 lds
    ds_read_b128 v[24:27], v2 offset:26624
    s_waitcnt lgkmcnt(6)
    v_mfma_f32_32x32x16_bf16 v[48:63], a[80:83], v[32:35], v[48:63]
    ds_read_b128 v[28:31], v2 offset:27648
    s_waitcnt lgkmcnt(6)
    v_mfma_f32_32x32x16_bf16 v[64:79], a[84:87], v[36:39], v[64:79]
    ds_read_b128 v[32:35], v2 offset:28672
    s_waitcnt lgkmcnt(6)
    v_mfma_f32_32x32x16_bf16 v[48:63], a[88:91], v[40:43], v[48:63]
    buffer_load_dwordx4 v1, s[8:11], s24 offen offset:3072 sc1 lds
    ds_read_b128 v[36:39], v2 offset:29696
    s_waitcnt lgkmcnt(6)
    v_mfma_f32_32x32x16_bf16 v[64:79], a[92:95], v[44:47], v[64:79]
    ds_read_b128 v[40:43], v2 offset:30720
    s_waitcnt lgkmcnt(6)
    v_mfma_f32_32x32x16_bf16 v[48:63], a[96:99], v[16:19], v[48:63]
    ds_read_b128 v[44:47], v2 offset:31744
    s_waitcnt lgkmcnt(6)
    v_mfma_f32_32x32x16_bf16 v[64:79], a[100:103], v[20:23], v[64:79]
    s_add_u32 s24, s24, 4096
    s_add_u32 s25, s25, 4096
    s_mov_b32 m0, s25
    s_nop 0
    buffer_load_dwordx4 v1, s[8:11], s24 offen offset:0 sc1 lds
    ds_read_b128 v[16:19], v2 offset:32768
    s_waitcnt lgkmcnt(6)
    v_mfma_f32_32x32x16_bf16 v[48:63], a[104:107], v[24:27], v[48:63]
    ds_read_b128 v[20:23], v2 offset:33792
    s_waitcnt lgkmcnt(6)
    v_mfma_f32_32x32x16_bf16 v[64:79], a[108:111], v[28:31], v[64:79]
    ds_read_b128 v[24:27], v2 offset:34816
    s_waitcnt lgkmcnt(6)
    v_mfma_f32_32x32x16_bf16 v[48:63], a[112:115], v[32:35], v[48:63]
    buffer_load_dwordx4 v1, s[8:11], s24 offen offset:1024 sc1 lds
    ds_read_b128 v[28:31], v2 offset:35840
    s_waitcnt lgkmcnt(6)
    v_mfma_f32_32x32x16_bf16 v[64:79], a[116:119], v[36:39], v[64:79]
    ds_read_b128 v[32:35], v2 offset:36864
    s_waitcnt lgkmcnt(6)
    v_mfma_f32_32x32x16_bf16 v[48:63], a[120:123], v[40:43], v[48:63]
    ds_read_b128 v[36:39], v2 offset:37888
    s_waitcnt lgkmcnt(6)
    v_mfma_f32_32x32x16_bf16 v[64:79], a[124:127], v[44:47], v[64:79]
    ds_read_b128 v[40:43], v2 offset:38912
    s_waitcnt lgkmcnt(6)
    v_mfma_f32_32x32x16_bf16 v[48:63], a[128:131], v[16:19], v[48:63]
    ds_read_b128 v[44:47], v2 offset:39936
    s_waitcnt lgkmcnt(6)
    v_mfma_f32_32x32x16_bf16 v[64:79], a[132:135], v[20:23], v[64:79]
    s_waitcnt lgkmcnt(5)
    v_mfma_f32_32x32x16_bf16 v[48:63], a[136:139], v[24:27], v[48:63]
    s_waitcnt lgkmcnt(4)
    v_mfma_f32_32x32x16_bf16 v[64:79], a[140:143], v[28:31], v[64:79]
    s_waitcnt lgkmcnt(3)
    v_mfma_f32_32x32x16_bf16 v[48:63], a[144:147], v[32:35], v[48:63]
    s_waitcnt lgkmcnt(2)
    v_mfma_f32_32x32x16_bf16 v[64:79], a[148:151], v[36:39], v[64:79]
    s_waitcnt lgkmcnt(1)
    v_mfma_f32_32x32x16_bf16 v[48:63], a[152:155], v[40:43], v[48:63]
    s_waitcnt lgkmcnt(0)
    v_mfma_f32_32x32x16_bf16 v[64:79], a[156:159], v[44:47], v[64:79]
    s_waitcnt vmcnt(12)
    s_nop 7
    s_nop 3
    v_add_f32 v48, v48, v64
    v_add_f32 v49, v49, v65
    v_add_f32 v50, v50, v66
    v_add_f32 v51, v51, v67
    v_add_f32 v52, v52, v68
    v_add_f32 v53, v53, v69
    v_add_f32 v54, v54, v70
    v_add_f32 v55, v55, v71
    v_add_f32 v56, v56, v72
    v_add_f32 v57, v57, v73
    v_add_f32 v58, v58, v74
    v_add_f32 v59, v59, v75
    v_add_f32 v60, v60, v76
    v_add_f32 v61, v61, v77
    v_add_f32 v62, v62, v78
    v_add_f32 v63, v63, v79
    s_add_u32 s26, s19, 226492416
    v_cvt_pk_bf16_f32 v80, v48, v49
    v_cvt_pk_bf16_f32 v81, v50, v51
    v_cvt_pk_bf16_f32 v82, v52, v53
    v_cvt_pk_bf16_f32 v83, v54, v55
    s_nop 1
    v_permlane32_swap_b32 v80, v82
    v_permlane32_swap_b32 v81, v83
    s_nop 1
    v_lshlrev_b32 v88, 16, v80
    v_and_b32 v89, 0xffff0000, v80
    v_lshlrev_b32 v90, 16, v104
    v_and_b32 v91, 0xffff0000, v104
    v_add_f32 v88, v88, v90
    v_add_f32 v89, v89, v91
    v_cvt_pk_bf16_f32 v80, v88, v89
    v_lshlrev_b32 v92, 16, v81
    v_and_b32 v93, 0xffff0000, v81
    v_lshlrev_b32 v94, 16, v105
    v_and_b32 v95, 0xffff0000, v105
    v_add_f32 v92, v92, v94
    v_add_f32 v93, v93, v95
    v_cvt_pk_bf16_f32 v81, v92, v93
    v_lshlrev_b32 v88, 16, v82
    v_and_b32 v89, 0xffff0000, v82
    v_lshlrev_b32 v90, 16, v106
    v_and_b32 v91, 0xffff0000, v106
    v_add_f32 v88, v88, v90
    v_add_f32 v89, v89, v91
    v_cvt_pk_bf16_f32 v82, v88, v89
    v_lshlrev_b32 v92, 16, v83
    v_and_b32 v93, 0xffff0000, v83
    v_lshlrev_b32 v94, 16, v107
    v_and_b32 v95, 0xffff0000, v107
    v_add_f32 v92, v92, v94
    v_add_f32 v93, v93, v95
    v_cvt_pk_bf16_f32 v83, v92, v93
    buffer_store_dwordx4 v[80:83], v3, s[8:11], s26 offen offset:0 sc1
    v_cvt_pk_bf16_f32 v84, v56, v57
    v_cvt_pk_bf16_f32 v85, v58, v59
    v_cvt_pk_bf16_f32 v86, v60, v61
    v_cvt_pk_bf16_f32 v87, v62, v63
    s_nop 1
    v_permlane32_swap_b32 v84, v86
    v_permlane32_swap_b32 v85, v87
    s_nop 1
    v_lshlrev_b32 v88, 16, v84
    v_and_b32 v89, 0xffff0000, v84
    v_lshlrev_b32 v90, 16, v108
    v_and_b32 v91, 0xffff0000, v108
    v_add_f32 v88, v88, v90
    v_add_f32 v89, v89, v91
    v_cvt_pk_bf16_f32 v84, v88, v89
    v_lshlrev_b32 v92, 16, v85
    v_and_b32 v93, 0xffff0000, v85
    v_lshlrev_b32 v94, 16, v109
    v_and_b32 v95, 0xffff0000, v109
    v_add_f32 v92, v92, v94
    v_add_f32 v93, v93, v95
    v_cvt_pk_bf16_f32 v85, v92, v93
    v_lshlrev_b32 v88, 16, v86
    v_and_b32 v89, 0xffff0000, v86
    v_lshlrev_b32 v90, 16, v110
    v_and_b32 v91, 0xffff0000, v110
    v_add_f32 v88, v88, v90
    v_add_f32 v89, v89, v91
    v_cvt_pk_bf16_f32 v86, v88, v89
    v_lshlrev_b32 v92, 16, v87
    v_and_b32 v93, 0xffff0000, v87
    v_lshlrev_b32 v94, 16, v111
    v_and_b32 v95, 0xffff0000, v111
    v_add_f32 v92, v92, v94
    v_add_f32 v93, v93, v95
    v_cvt_pk_bf16_f32 v87, v92, v93
    buffer_store_dwordx4 v[84:87], v3, s[8:11], s26 offen offset:32 sc1
    s_waitcnt vmcnt(0)
    s_mov_b64 exec, 1
    s_add_u32 s26, s48, s20
    buffer_store_dword v5, v4, s[8:11], s26 offen sc1
    s_mov_b64 exec, -1
    s_add_u32 s20, s20, 128
    s_add_u32 s19, s19, 40960
    s_add_u32 s16, s16, 40960
    s_cmp_eq_u32 s16, 122880
    s_cselect_b32 s16, 0, s16
    s_add_u32 s14, s14, 1
    s_cmp_ge_u32 s14, s15
    s_cbranch_scc1 layerb1_kernel_ab_fin
    s_add_u32 s23, s14, 2
    s_cmp_lg_u32 s13, 0
    s_cbranch_scc1 layerb1_kernel_ab_ow7
    s_min_u32 s28, s23, 63
    s_cmp_gt_u32 s22, s28
    s_cbranch_scc1 layerb1_kernel_ab_ow7
layerb1_kernel_ab_op7:
    buffer_load_dwordx4 v[116:119], v1, s[8:11], s29 offen sc1
    s_waitcnt vmcnt(0)
    v_min_u32 v116, v116, v117
    v_min_u32 v118, v118, v119
    v_min_u32 v114, v116, v118
    v_cmp_eq_u32 vcc, 0, v114
    s_nop 1
    s_ff1_i32_b64 s22, vcc
    s_min_u32 s22, s22, 64
    s_and_b32 s22, s22, 0x7c
    s_sub_u32 s30, s30, 1
    s_cbranch_scc1 layerb1_kernel_bail
    s_cmp_gt_u32 s22, s28
    s_cbranch_scc0 layerb1_kernel_ab_op7
layerb1_kernel_ab_ow7:
    s_barrier
    v_add_u32 v2, s16, v1
    ds_read_b128 v[16:19], v2 offset:0
    ds_read_b128 v[20:23], v2 offset:1024
    ds_read_b128 v[24:27], v2 offset:2048
    ds_read_b128 v[28:31], v2 offset:3072
    ds_read_b128 v[32:35], v2 offset:4096
    ds_read_b128 v[36:39], v2 offset:5120
    s_add_u32 s27, s19, 40960
    s_cmp_ge_u32 s14, 63
    s_cselect_b32 s27, s19, s27
    buffer_load_dwordx4 v[104:107], v3, s[52:55], s27 offen offset:0
    buffer_load_dwordx4 v[108:111], v3, s[52:55], s27 offen offset:32
    s_add_u32 s23, s14, 2
    s_min_u32 s24, s23, 63
    s_mul_i32 s24, s24, 40960
    s_add_u32 s24, s24, s18
    s_mul_i32 s25, s13, 10240
    s_add_u32 s25, s25, s17
    s_add_u32 s17, s17, 40960
    s_cmp_eq_u32 s17, 122880
    s_cselect_b32 s17, 0, s17
    ds_read_b128 v[40:43], v2 offset:6144
    s_waitcnt lgkmcnt(6)
    v_mfma_f32_32x32x16_bf16 v[48:63], a[0:3], v[16:19], 0
    ds_read_b128 v[44:47], v2 offset:7168
    s_waitcnt lgkmcnt(6)
    v_mfma_f32_32x32x16_bf16 v[64:79], a[4:7], v[20:23], 0
    s_mov_b32 m0, s25
    s_nop 0
    buffer_load_dwordx4 v1, s[8:11], s24 offen offset:0 sc1 lds
    ds_read_b128 v[16:19], v2 offset:8192
    s_waitcnt lgkmcnt(6)
    v_mfma_f32_32x32x16_bf16 v[48:63], a[8:11], v[24:27], v[48:63]
    ds_read_b128 v[20:23], v2 offset:9216
    s_waitcnt lgkmcnt(6)
    v_mfma_f32_32x32x16_bf16 v[64:79], a[12:15], v[28:31], v[64:79]
    ds_read_b128 v[24:27], v2 offset:10240
    s_waitcnt lgkmcnt(6)
    v_mfma_f32_32x32x16_bf16 v[48:63], a[16:19], v[32:35], v[48:63]
    buffer_load_dwordx4 v1, s[8:11], s24 offen offset:1024 sc1 lds
    ds_read_b128 v[28:31], v2 offset:11264
    s_waitcnt lgkmcnt(6)
    v_mfma_f32_32x32x16_bf16 v[64:79], a[20:23], v[36:39], v[64:79]
    ds_read_b128 v[32:35], v2 offset:12288
    s_waitcnt lgkmcnt(6)
    v_mfma_f32_32x32x16_bf16 v[48:63], a[24:27], v[40:43], v[48:63]
    ds_read_b128 v[36:39], v2 offset:13312
    s_waitcnt lgkmcnt(6)
    v_mfma_f32_32x32x16_bf16 v[64:79], a[28:31], v[44:47], v[64:79]
    buffer_load_dwordx4 v1, s[8:11], s24 offen offset:2048 sc1 lds
    ds_read_b128 v[40:43], v2 offset:14336
    s_waitcnt lgkmcnt(6)
    v_mfma_f32_32x32x16_bf16 v[48:63], a[32:35], v[16:19], v[48:63]
    ds_read_b128 v[44:47], v2 offset:15360
    s_waitcnt lgkmcnt(6)
    v_mfma_f32_32x32x16_bf16 v[64:79], a[36:39], v[20:23], v[64:79]
    ds_read_b128 v[16:19], v2 offset:16384
    s_waitcnt lgkmcnt(6)
    v_mfma_f32_32x32x16_bf16 v[48:63], a[40:43], v[24:27], v[48:63]
    buffer_load_dwordx4 v1, s[8:11], s24 offen offset:3072 sc1 lds
    ds_read_b128 v[20:23], v2 offset:17408
    s_waitcnt lgkmcnt(6)
    v_mfma_f32_32x32x16_bf16 v[64:79], a[44:47], v[28:31], v[64:79]
    ds_read_b128 v[24:27], v2 offset:18432
    s_waitcnt lgkmcnt(6)
    v_mfma_f32_32x32x16_bf16 v[48:63], a[48:51], v[32:35], v[48:63]
    ds_read_b128 v[28:31], v2 offset:19456
    s_waitcnt lgkmcnt(6)
    v_mfma_f32_32x32x16_bf16 v[64:79], a[52:55], v[36:39], v[64:79]
    s_add_u32 s24, s24, 4096
    s_add_u32 s25, s25, 4096
    s_mov_b32 m0, s25
    s_nop 0
    buffer_load_dwordx4 v1, s[8:11], s24 offen offset:0 sc1 lds
    ds_read_b128 v[32:35], v2 offset:20480
    s_waitcnt lgkmcnt(6)
    v_mfma_f32_32x32x16_bf16 v[48:63], a[56:59], v[40:43], v[48:63]
    ds_read_b128 v[36:39], v2 offset:21504
    s_waitcnt lgkmcnt(6)
    v_mfma_f32_32x32x16_bf16 v[64:79], a[60:63], v[44:47], v[64:79]
    ds_read_b128 v[40:43], v2 offset:22528
    s_waitcnt lgkmcnt(6)
    v_mfma_f32_32x32x16_bf16 v[48:63], a[64:67], v[16:19], v[48:63]
    buffer_load_dwordx4 v1, s[8:11], s24 offen offset:1024 sc1 lds
    ds_read_b128 v[44:47], v2 offset:23552
    s_waitcnt lgkmcnt(6)
    v_mfma_f32_32x32x16_bf16 v[64:79], a[68:71], v[20:23], v[64:79]
    ds_read_b128 v[16:19], v2 offset:24576
    s_waitcnt lgkmcnt(6)
    v_mfma_f32_32x32x16_bf16 v[48:63], a[72:75], v[24:27], v[48:63]
    ds_read_b128 v[20:23], v2 offset:25600
    s_waitcnt lgkmcnt(6)
    v_mfma_f32_32x32x16_bf16 v[64:79], a[76:79], v[28:31], v[64:79]
    buffer_load_dwordx4 v1, s[8:11], s24 offen offset:2048 sc1 lds
    ds_read_b128 v[24:27], v2 offset:26624
    s_waitcnt lgkmcnt(6)
    v_mfma_f32_32x32x16_bf16 v[48:63], a[80:83], v[32:35], v[48:63]
    ds_read_b128 v[28:31], v2 offset:27648
    s_waitcnt lgkmcnt(6)
    v_mfma_f32_32x32x16_bf16 v[64:79], a[84:87], v[36:39], v[64:79]
    ds_read_b128 v[32:35], v2 offset:28672
    s_waitcnt lgkmcnt(6)
    v_mfma_f32_32x32x16_bf16 v[48:63], a[88:91], v[40:43], v[48:63]
    buffer_load_dwordx4 v1, s[8:11], s24 offen offset:3072 sc1 lds
    ds_read_b128 v[36:39], v2 offset:29696
    s_waitcnt lgkmcnt(6)
    v_mfma_f32_32x32x16_bf16 v[64:79], a[92:95], v[44:47], v[64:79]
    ds_read_b128 v[40:43], v2 offset:30720
    s_waitcnt lgkmcnt(6)
    v_mfma_f32_32x32x16_bf16 v[48:63], a[96:99], v[16:19], v[48:63]
    ds_read_b128 v[44:47], v2 offset:31744
    s_waitcnt lgkmcnt(6)
    v_mfma_f32_32x32x16_bf16 v[64:79], a[100:103], v[20:23], v[64:79]
    s_add_u32 s24, s24, 4096
    s_add_u32 s25, s25, 4096
    s_mov_b32 m0, s25
    s_nop 0
    buffer_load_dwordx4 v1, s[8:11], s24 offen offset:0 sc1 lds
    ds_read_b128 v[16:19], v2 offset:32768
    s_waitcnt lgkmcnt(6)
    v_mfma_f32_32x32x16_bf16 v[48:63], a[104:107], v[24:27], v[48:63]
    ds_read_b128 v[20:23], v2 offset:33792
    s_waitcnt lgkmcnt(6)
    v_mfma_f32_32x32x16_bf16 v[64:79], a[108:111], v[28:31], v[64:79]
    ds_read_b128 v[24:27], v2 offset:34816
    s_waitcnt lgkmcnt(6)
    v_mfma_f32_32x32x16_bf16 v[48:63], a[112:115], v[32:35], v[48:63]
    buffer_load_dwordx4 v1, s[8:11], s24 offen offset:1024 sc1 lds
    ds_read_b128 v[28:31], v2 offset:35840
    s_waitcnt lgkmcnt(6)
    v_mfma_f32_32x32x16_bf16 v[64:79], a[116:119], v[36:39], v[64:79]
    ds_read_b128 v[32:35], v2 offset:36864
    s_waitcnt lgkmcnt(6)
    v_mfma_f32_32x32x16_bf16 v[48:63], a[120:123], v[40:43], v[48:63]
    ds_read_b128 v[36:39], v2 offset:37888
    s_waitcnt lgkmcnt(6)
    v_mfma_f32_32x32x16_bf16 v[64:79], a[124:127], v[44:47], v[64:79]
    ds_read_b128 v[40:43], v2 offset:38912
    s_waitcnt lgkmcnt(6)
    v_mfma_f32_32x32x16_bf16 v[48:63], a[128:131], v[16:19], v[48:63]
    ds_read_b128 v[44:47], v2 offset:39936
    s_waitcnt lgkmcnt(6)
    v_mfma_f32_32x32x16_bf16 v[64:79], a[132:135], v[20:23], v[64:79]
    s_waitcnt lgkmcnt(5)
    v_mfma_f32_32x32x16_bf16 v[48:63], a[136:139], v[24:27], v[48:63]
    s_waitcnt lgkmcnt(4)
    v_mfma_f32_32x32x16_bf16 v[64:79], a[140:143], v[28:31], v[64:79]
    s_waitcnt lgkmcnt(3)
    v_mfma_f32_32x32x16_bf16 v[48:63], a[144:147], v[32:35], v[48:63]
    s_waitcnt lgkmcnt(2)
    v_mfma_f32_32x32x16_bf16 v[64:79], a[148:151], v[36:39], v[64:79]
    s_waitcnt lgkmcnt(1)
    v_mfma_f32_32x32x16_bf16 v[48:63], a[152:155], v[40:43], v[48:63]
    s_waitcnt lgkmcnt(0)
    v_mfma_f32_32x32x16_bf16 v[64:79], a[156:159], v[44:47], v[64:79]
    s_waitcnt vmcnt(12)
    s_nop 7
    s_nop 3
    v_add_f32 v48, v48, v64
    v_add_f32 v49, v49, v65
    v_add_f32 v50, v50, v66
    v_add_f32 v51, v51, v67
    v_add_f32 v52, v52, v68
    v_add_f32 v53, v53, v69
    v_add_f32 v54, v54, v70
    v_add_f32 v55, v55, v71
    v_add_f32 v56, v56, v72
    v_add_f32 v57, v57, v73
    v_add_f32 v58, v58, v74
    v_add_f32 v59, v59, v75
    v_add_f32 v60, v60, v76
    v_add_f32 v61, v61, v77
    v_add_f32 v62, v62, v78
    v_add_f32 v63, v63, v79
    s_add_u32 s26, s19, 226492416
    v_cvt_pk_bf16_f32 v80, v48, v49
    v_cvt_pk_bf16_f32 v81, v50, v51
    v_cvt_pk_bf16_f32 v82, v52, v53
    v_cvt_pk_bf16_f32 v83, v54, v55
    s_nop 1
    v_permlane32_swap_b32 v80, v82
    v_permlane32_swap_b32 v81, v83
    s_nop 1
    v_lshlrev_b32 v88, 16, v80
    v_and_b32 v89, 0xffff0000, v80
    v_lshlrev_b32 v90, 16, v96
    v_and_b32 v91, 0xffff0000, v96
    v_add_f32 v88, v88, v90
    v_add_f32 v89, v89, v91
    v_cvt_pk_bf16_f32 v80, v88, v89
    v_lshlrev_b32 v92, 16, v81
    v_and_b32 v93, 0xffff0000, v81
    v_lshlrev_b32 v94, 16, v97
    v_and_b32 v95, 0xffff0000, v97
    v_add_f32 v92, v92, v94
    v_add_f32 v93, v93, v95
    v_cvt_pk_bf16_f32 v81, v92, v93
    v_lshlrev_b32 v88, 16, v82
    v_and_b32 v89, 0xffff0000, v82
    v_lshlrev_b32 v90, 16, v98
    v_and_b32 v91, 0xffff0000, v98
    v_add_f32 v88, v88, v90
    v_add_f32 v89, v89, v91
    v_cvt_pk_bf16_f32 v82, v88, v89
    v_lshlrev_b32 v92, 16, v83
    v_and_b32 v93, 0xffff0000, v83
    v_lshlrev_b32 v94, 16, v99
    v_and_b32 v95, 0xffff0000, v99
    v_add_f32 v92, v92, v94
    v_add_f32 v93, v93, v95
    v_cvt_pk_bf16_f32 v83, v92, v93
    buffer_store_dwordx4 v[80:83], v3, s[8:11], s26 offen offset:0 sc1
    v_cvt_pk_bf16_f32 v84, v56, v57
    v_cvt_pk_bf16_f32 v85, v58, v59
    v_cvt_pk_bf16_f32 v86, v60, v61
    v_cvt_pk_bf16_f32 v87, v62, v63
    s_nop 1
    v_permlane32_swap_b32 v84, v86
    v_permlane32_swap_b32 v85, v87
    s_nop 1
    v_lshlrev_b32 v88, 16, v84
    v_and_b32 v89, 0xffff0000, v84
    v_lshlrev_b32 v90, 16, v100
    v_and_b32 v91, 0xffff0000, v100
    v_add_f32 v88, v88, v90
    v_add_f32 v89, v89, v91
    v_cvt_pk_bf16_f32 v84, v88, v89
    v_lshlrev_b32 v92, 16, v85
    v_and_b32 v93, 0xffff0000, v85
    v_lshlrev_b32 v94, 16, v101
    v_and_b32 v95, 0xffff0000, v101
    v_add_f32 v92, v92, v94
    v_add_f32 v93, v93, v95
    v_cvt_pk_bf16_f32 v85, v92, v93
    v_lshlrev_b32 v88, 16, v86
    v_and_b32 v89, 0xffff0000, v86
    v_lshlrev_b32 v90, 16, v102
    v_and_b32 v91, 0xffff0000, v102
    v_add_f32 v88, v88, v90
    v_add_f32 v89, v89, v91
    v_cvt_pk_bf16_f32 v86, v88, v89
    v_lshlrev_b32 v92, 16, v87
    v_and_b32 v93, 0xffff0000, v87
    v_lshlrev_b32 v94, 16, v103
    v_and_b32 v95, 0xffff0000, v103
    v_add_f32 v92, v92, v94
    v_add_f32 v93, v93, v95
    v_cvt_pk_bf16_f32 v87, v92, v93
    buffer_store_dwordx4 v[84:87], v3, s[8:11], s26 offen offset:32 sc1
    s_waitcnt vmcnt(0)
    s_mov_b64 exec, 1
    s_add_u32 s26, s48, s20
    buffer_store_dword v5, v4, s[8:11], s26 offen sc1
    s_mov_b64 exec, -1
    s_add_u32 s20, s20, 128
    s_add_u32 s19, s19, 40960
    s_add_u32 s16, s16, 40960
    s_cmp_eq_u32 s16, 122880
    s_cselect_b32 s16, 0, s16
    s_add_u32 s14, s14, 1
    s_cmp_ge_u32 s14, s15
    s_cbranch_scc1 layerb1_kernel_ab_fin
    s_add_u32 s23, s14, 2
    s_cmp_lg_u32 s13, 0
    s_cbranch_scc1 layerb1_kernel_ab_ow8
    s_min_u32 s28, s23, 63
    s_cmp_gt_u32 s22, s28
    s_cbranch_scc1 layerb1_kernel_ab_ow8
layerb1_kernel_ab_op8:
    buffer_load_dwordx4 v[116:119], v1, s[8:11], s29 offen sc1
    s_waitcnt vmcnt(0)
    v_min_u32 v116, v116, v117
    v_min_u32 v118, v118, v119
    v_min_u32 v114, v116, v118
    v_cmp_eq_u32 vcc, 0, v114
    s_nop 1
    s_ff1_i32_b64 s22, vcc
    s_min_u32 s22, s22, 64
    s_and_b32 s22, s22, 0x7c
    s_sub_u32 s30, s30, 1
    s_cbranch_scc1 layerb1_kernel_bail
    s_cmp_gt_u32 s22, s28
    s_cbranch_scc0 layerb1_kernel_ab_op8
layerb1_kernel_ab_ow8:
    s_barrier
    v_add_u32 v2, s16, v1
    ds_read_b128 v[16:19], v2 offset:0
    ds_read_b128 v[20:23], v2 offset:1024
    ds_read_b128 v[24:27], v2 offset:2048
    ds_read_b128 v[28:31], v2 offset:3072
    ds_read_b128 v[32:35], v2 offset:4096
    ds_read_b128 v[36:39], v2 offset:5120
    s_add_u32 s27, s19, 40960
    s_cmp_ge_u32 s14, 63
    s_cselect_b32 s27, s19, s27
    buffer_load_dwordx4 v[96:99], v3, s[52:55], s27 offen offset:0
    buffer_load_dwordx4 v[100:103], v3, s[52:55], s27 offen offset:32
    s_add_u32 s23, s14, 2
    s_min_u32 s24, s23, 63
    s_mul_i32 s24, s24, 40960
    s_add_u32 s24, s24, s18
    s_mul_i32 s25, s13, 10240
    s_add_u32 s25, s25, s17
    s_add_u32 s17, s17, 40960
    s_cmp_eq_u32 s17, 122880
    s_cselect_b32 s17, 0, s17
    ds_read_b128 v[40:43], v2 offset:6144
    s_waitcnt lgkmcnt(6)
    v_mfma_f32_32x32x16_bf16 v[48:63], a[0:3], v[16:19], 0
    ds_read_b128 v[44:47], v2 offset:7168
    s_waitcnt lgkmcnt(6)
    v_mfma_f32_32x32x16_bf16 v[64:79], a[4:7], v[20:23], 0
    s_mov_b32 m0, s25
    s_nop 0
    buffer_load_dwordx4 v1, s[8:11], s24 offen offset:0 sc1 lds
    ds_read_b128 v[16:19], v2 offset:8192
    s_waitcnt lgkmcnt(6)
    v_mfma_f32_32x32x16_bf16 v[48:63], a[8:11], v[24:27], v[48:63]
    ds_read_b128 v[20:23], v2 offset:9216
    s_waitcnt lgkmcnt(6)
    v_mfma_f32_32x32x16_bf16 v[64:79], a[12:15], v[28:31], v[64:79]
    ds_read_b128 v[24:27], v2 offset:10240
    s_waitcnt lgkmcnt(6)
    v_mfma_f32_32x32x16_bf16 v[48:63], a[16:19], v[32:35], v[48:63]
    buffer_load_dwordx4 v1, s[8:11], s24 offen offset:1024 sc1 lds
    ds_read_b128 v[28:31], v2 offset:11264
    s_waitcnt lgkmcnt(6)
    v_mfma_f32_32x32x16_bf16 v[64:79], a[20:23], v[36:39], v[64:79]
    ds_read_b128 v[32:35], v2 offset:12288
    s_waitcnt lgkmcnt(6)
    v_mfma_f32_32x32x16_bf16 v[48:63], a[24:27], v[40:43], v[48:63]
    ds_read_b128 v[36:39], v2 offset:13312
    s_waitcnt lgkmcnt(6)
    v_mfma_f32_32x32x16_bf16 v[64:79], a[28:31], v[44:47], v[64:79]
    buffer_load_dwordx4 v1, s[8:11], s24 offen offset:2048 sc1 lds
    ds_read_b128 v[40:43], v2 offset:14336
    s_waitcnt lgkmcnt(6)
    v_mfma_f32_32x32x16_bf16 v[48:63], a[32:35], v[16:19], v[48:63]
    ds_read_b128 v[44:47], v2 offset:15360
    s_waitcnt lgkmcnt(6)
    v_mfma_f32_32x32x16_bf16 v[64:79], a[36:39], v[20:23], v[64:79]
    ds_read_b128 v[16:19], v2 offset:16384
    s_waitcnt lgkmcnt(6)
    v_mfma_f32_32x32x16_bf16 v[48:63], a[40:43], v[24:27], v[48:63]
    buffer_load_dwordx4 v1, s[8:11], s24 offen offset:3072 sc1 lds
    ds_read_b128 v[20:23], v2 offset:17408
    s_waitcnt lgkmcnt(6)
    v_mfma_f32_32x32x16_bf16 v[64:79], a[44:47], v[28:31], v[64:79]
    ds_read_b128 v[24:27], v2 offset:18432
    s_waitcnt lgkmcnt(6)
    v_mfma_f32_32x32x16_bf16 v[48:63], a[48:51], v[32:35], v[48:63]
    ds_read_b128 v[28:31], v2 offset:19456
    s_waitcnt lgkmcnt(6)
    v_mfma_f32_32x32x16_bf16 v[64:79], a[52:55], v[36:39], v[64:79]
    s_add_u32 s24, s24, 4096
    s_add_u32 s25, s25, 4096
    s_mov_b32 m0, s25
    s_nop 0
    buffer_load_dwordx4 v1, s[8:11], s24 offen offset:0 sc1 lds
    ds_read_b128 v[32:35], v2 offset:20480
    s_waitcnt lgkmcnt(6)
    v_mfma_f32_32x32x16_bf16 v[48:63], a[56:59], v[40:43], v[48:63]
    ds_read_b128 v[36:39], v2 offset:21504
    s_waitcnt lgkmcnt(6)
    v_mfma_f32_32x32x16_bf16 v[64:79], a[60:63], v[44:47], v[64:79]
    ds_read_b128 v[40:43], v2 offset:22528
    s_waitcnt lgkmcnt(6)
    v_mfma_f32_32x32x16_bf16 v[48:63], a[64:67], v[16:19], v[48:63]
    buffer_load_dwordx4 v1, s[8:11], s24 offen offset:1024 sc1 lds
    ds_read_b128 v[44:47], v2 offset:23552
    s_waitcnt lgkmcnt(6)
    v_mfma_f32_32x32x16_bf16 v[64:79], a[68:71], v[20:23], v[64:79]
    ds_read_b128 v[16:19], v2 offset:24576
    s_waitcnt lgkmcnt(6)
    v_mfma_f32_32x32x16_bf16 v[48:63], a[72:75], v[24:27], v[48:63]
    ds_read_b128 v[20:23], v2 offset:25600
    s_waitcnt lgkmcnt(6)
    v_mfma_f32_32x32x16_bf16 v[64:79], a[76:79], v[28:31], v[64:79]
    buffer_load_dwordx4 v1, s[8:11], s24 offen offset:2048 sc1 lds
    ds_read_b128 v[24:27], v2 offset:26624
    s_waitcnt lgkmcnt(6)
    v_mfma_f32_32x32x16_bf16 v[48:63], a[80:83], v[32:35], v[48:63]
    ds_read_b128 v[28:31], v2 offset:27648
    s_waitcnt lgkmcnt(6)
    v_mfma_f32_32x32x16_bf16 v[64:79], a[84:87], v[36:39], v[64:79]
    ds_read_b128 v[32:35], v2 offset:28672
    s_waitcnt lgkmcnt(6)
    v_mfma_f32_32x32x16_bf16 v[48:63], a[88:91], v[40:43], v[48:63]
    buffer_load_dwordx4 v1, s[8:11], s24 offen offset:3072 sc1 lds
    ds_read_b128 v[36:39], v2 offset:29696
    s_waitcnt lgkmcnt(6)
    v_mfma_f32_32x32x16_bf16 v[64:79], a[92:95], v[44:47], v[64:79]
    ds_read_b128 v[40:43], v2 offset:30720
    s_waitcnt lgkmcnt(6)
    v_mfma_f32_32x32x16_bf16 v[48:63], a[96:99], v[16:19], v[48:63]
    ds_read_b128 v[44:47], v2 offset:31744
    s_waitcnt lgkmcnt(6)
    v_mfma_f32_32x32x16_bf16 v[64:79], a[100:103], v[20:23], v[64:79]
    s_add_u32 s24, s24, 4096
    s_add_u32 s25, s25, 4096
    s_mov_b32 m0, s25
    s_nop 0
    buffer_load_dwordx4 v1, s[8:11], s24 offen offset:0 sc1 lds
    ds_read_b128 v[16:19], v2 offset:32768
    s_waitcnt lgkmcnt(6)
    v_mfma_f32_32x32x16_bf16 v[48:63], a[104:107], v[24:27], v[48:63]
    ds_read_b128 v[20:23], v2 offset:33792
    s_waitcnt lgkmcnt(6)
    v_mfma_f32_32x32x16_bf16 v[64:79], a[108:111], v[28:31], v[64:79]
    ds_read_b128 v[24:27], v2 offset:34816
    s_waitcnt lgkmcnt(6)
    v_mfma_f32_32x32x16_bf16 v[48:63], a[112:115], v[32:35], v[48:63]
    buffer_load_dwordx4 v1, s[8:11], s24 offen offset:1024 sc1 lds
    ds_read_b128 v[28:31], v2 offset:35840
    s_waitcnt lgkmcnt(6)
    v_mfma_f32_32x32x16_bf16 v[64:79], a[116:119], v[36:39], v[64:79]
    ds_read_b128 v[32:35], v2 offset:36864
    s_waitcnt lgkmcnt(6)
    v_mfma_f32_32x32x16_bf16 v[48:63], a[120:123], v[40:43], v[48:63]
    ds_read_b128 v[36:39], v2 offset:37888
    s_waitcnt lgkmcnt(6)
    v_mfma_f32_32x32x16_bf16 v[64:79], a[124:127], v[44:47], v[64:79]
    ds_read_b128 v[40:43], v2 offset:38912
    s_waitcnt lgkmcnt(6)
    v_mfma_f32_32x32x16_bf16 v[48:63], a[128:131], v[16:19], v[48:63]
    ds_read_b128 v[44:47], v2 offset:39936
    s_waitcnt lgkmcnt(6)
    v_mfma_f32_32x32x16_bf16 v[64:79], a[132:135], v[20:23], v[64:79]
    s_waitcnt lgkmcnt(5)
    v_mfma_f32_32x32x16_bf16 v[48:63], a[136:139], v[24:27], v[48:63]
    s_waitcnt lgkmcnt(4)
    v_mfma_f32_32x32x16_bf16 v[64:79], a[140:143], v[28:31], v[64:79]
    s_waitcnt lgkmcnt(3)
    v_mfma_f32_32x32x16_bf16 v[48:63], a[144:147], v[32:35], v[48:63]
    s_waitcnt lgkmcnt(2)
    v_mfma_f32_32x32x16_bf16 v[64:79], a[148:151], v[36:39], v[64:79]
    s_waitcnt lgkmcnt(1)
    v_mfma_f32_32x32x16_bf16 v[48:63], a[152:155], v[40:43], v[48:63]
    s_waitcnt lgkmcnt(0)
    v_mfma_f32_32x32x16_bf16 v[64:79], a[156:159], v[44:47], v[64:79]
    s_waitcnt vmcnt(12)
    s_nop 7
    s_nop 3
    v_add_f32 v48, v48, v64
    v_add_f32 v49, v49, v65
    v_add_f32 v50, v50, v66
    v_add_f32 v51, v51, v67
    v_add_f32 v52, v52, v68
    v_add_f32 v53, v53, v69
    v_add_f32 v54, v54, v70
    v_add_f32 v55, v55, v71
    v_add_f32 v56, v56, v72
    v_add_f32 v57, v57, v73
    v_add_f32 v58, v58, v74
    v_add_f32 v59, v59, v75
    v_add_f32 v60, v60, v76
    v_add_f32 v61, v61, v77
    v_add_f32 v62, v62, v78
    v_add_f32 v63, v63, v79
    s_add_u32 s26, s19, 226492416
    v_cvt_pk_bf16_f32 v80, v48, v49
    v_cvt_pk_bf16_f32 v81, v50, v51
    v_cvt_pk_bf16_f32 v82, v52, v53
    v_cvt_pk_bf16_f32 v83, v54, v55
    s_nop 1
    v_permlane32_swap_b32 v80, v82
    v_permlane32_swap_b32 v81, v83
    s_nop 1
    v_lshlrev_b32 v88, 16, v80
    v_and_b32 v89, 0xffff0000, v80
    v_lshlrev_b32 v90, 16, v104
    v_and_b32 v91, 0xffff0000, v104
    v_add_f32 v88, v88, v90
    v_add_f32 v89, v89, v91
    v_cvt_pk_bf16_f32 v80, v88, v89
    v_lshlrev_b32 v92, 16, v81
    v_and_b32 v93, 0xffff0000, v81
    v_lshlrev_b32 v94, 16, v105
    v_and_b32 v95, 0xffff0000, v105
    v_add_f32 v92, v92, v94
    v_add_f32 v93, v93, v95
    v_cvt_pk_bf16_f32 v81, v92, v93
    v_lshlrev_b32 v88, 16, v82
    v_and_b32 v89, 0xffff0000, v82
    v_lshlrev_b32 v90, 16, v106
    v_and_b32 v91, 0xffff0000, v106
    v_add_f32 v88, v88, v90
    v_add_f32 v89, v89, v91
    v_cvt_pk_bf16_f32 v82, v88, v89
    v_lshlrev_b32 v92, 16, v83
    v_and_b32 v93, 0xffff0000, v83
    v_lshlrev_b32 v94, 16, v107
    v_and_b32 v95, 0xffff0000, v107
    v_add_f32 v92, v92, v94
    v_add_f32 v93, v93, v95
    v_cvt_pk_bf16_f32 v83, v92, v93
    buffer_store_dwordx4 v[80:83], v3, s[8:11], s26 offen offset:0 sc1
    v_cvt_pk_bf16_f32 v84, v56, v57
    v_cvt_pk_bf16_f32 v85, v58, v59
    v_cvt_pk_bf16_f32 v86, v60, v61
    v_cvt_pk_bf16_f32 v87, v62, v63
    s_nop 1
    v_permlane32_swap_b32 v84, v86
    v_permlane32_swap_b32 v85, v87
    s_nop 1
    v_lshlrev_b32 v88, 16, v84
    v_and_b32 v89, 0xffff0000, v84
    v_lshlrev_b32 v90, 16, v108
    v_and_b32 v91, 0xffff0000, v108
    v_add_f32 v88, v88, v90
    v_add_f32 v89, v89, v91
    v_cvt_pk_bf16_f32 v84, v88, v89
    v_lshlrev_b32 v92, 16, v85
    v_and_b32 v93, 0xffff0000, v85
    v_lshlrev_b32 v94, 16, v109
    v_and_b32 v95, 0xffff0000, v109
    v_add_f32 v92, v92, v94
    v_add_f32 v93, v93, v95
    v_cvt_pk_bf16_f32 v85, v92, v93
    v_lshlrev_b32 v88, 16, v86
    v_and_b32 v89, 0xffff0000, v86
    v_lshlrev_b32 v90, 16, v110
    v_and_b32 v91, 0xffff0000, v110
    v_add_f32 v88, v88, v90
    v_add_f32 v89, v89, v91
    v_cvt_pk_bf16_f32 v86, v88, v89
    v_lshlrev_b32 v92, 16, v87
    v_and_b32 v93, 0xffff0000, v87
    v_lshlrev_b32 v94, 16, v111
    v_and_b32 v95, 0xffff0000, v111
    v_add_f32 v92, v92, v94
    v_add_f32 v93, v93, v95
    v_cvt_pk_bf16_f32 v87, v92, v93
    buffer_store_dwordx4 v[84:87], v3, s[8:11], s26 offen offset:32 sc1
    s_waitcnt vmcnt(0)
    s_mov_b64 exec, 1
    s_add_u32 s26, s48, s20
    buffer_store_dword v5, v4, s[8:11], s26 offen sc1
    s_mov_b64 exec, -1
    s_add_u32 s20, s20, 128
    s_add_u32 s19, s19, 40960
    s_add_u32 s16, s16, 40960
    s_cmp_eq_u32 s16, 122880
    s_cselect_b32 s16, 0, s16
    s_add_u32 s14, s14, 1
    s_cmp_ge_u32 s14, s15
    s_cbranch_scc1 layerb1_kernel_ab_fin
    s_sub_u32 s20, s20, 128
layerb1_kernel_ab_loop:
    s_add_u32 s23, s14, 2
    s_cmp_lg_u32 s13, 0
    s_cbranch_scc1 layerb1_kernel_ab_ow9
    s_min_u32 s28, s23, 63
    s_cmp_gt_u32 s22, s28
    s_cbranch_scc1 layerb1_kernel_ab_ow9
layerb1_kernel_ab_op9:
    buffer_load_dwordx4 v[116:119], v1, s[8:11], s29 offen sc1
    s_waitcnt vmcnt(0)
    v_min_u32 v116, v116, v117
    v_min_u32 v118, v118, v119
    v_min_u32 v114, v116, v118
    v_cmp_eq_u32 vcc, 0, v114
    s_nop 1
    s_ff1_i32_b64 s22, vcc
    s_min_u32 s22, s22, 64
    s_and_b32 s22, s22, 0x7c
    s_sub_u32 s30, s30, 1
    s_cbranch_scc1 layerb1_kernel_bail
    s_cmp_gt_u32 s22, s28
    s_cbranch_scc0 layerb1_kernel_ab_op9
layerb1_kernel_ab_ow9:
    s_barrier
    v_add_u32 v2, s16, v1
    ds_read_b128 v[16:19], v2 offset:0
    ds_read_b128 v[20:23], v2 offset:1024
    ds_read_b128 v[24:27], v2 offset:2048
    ds_read_b128 v[28:31], v2 offset:3072
    ds_read_b128 v[32:35], v2 offset:4096
    ds_read_b128 v[36:39], v2 offset:5120
    s_add_u32 s27, s19, 40960
    s_cmp_ge_u32 s14, 63
    s_cselect_b32 s27, s19, s27
    buffer_load_dwordx4 v[104:107], v3, s[52:55], s27 offen offset:0
    buffer_load_dwordx4 v[108:111], v3, s[52:55], s27 offen offset:32
    s_add_u32 s23, s14, 2
    s_min_u32 s24, s23, 63
    s_mul_i32 s24, s24, 40960
    s_add_u32 s24, s24, s18
    s_mul_i32 s25, s13, 10240
    s_add_u32 s25, s25, s17
    s_add_u32 s17, s17, 40960
    s_cmp_eq_u32 s17, 122880
    s_cselect_b32 s17, 0, s17
    ds_read_b128 v[40:43], v2 offset:6144
    s_waitcnt lgkmcnt(6)
    v_mfma_f32_32x32x16_bf16 v[48:63], a[0:3], v[16:19], 0
    ds_read_b128 v[44:47], v2 offset:7168
    s_waitcnt lgkmcnt(6)
    v_mfma_f32_32x32x16_bf16 v[64:79], a[4:7], v[20:23], 0
    s_mov_b32 m0, s25
    s_nop 0
    buffer_load_dwordx4 v1, s[8:11], s24 offen offset:0 sc1 lds
    ds_read_b128 v[16:19], v2 offset:8192
    s_waitcnt lgkmcnt(6)
    v_mfma_f32_32x32x16_bf16 v[48:63], a[8:11], v[24:27], v[48:63]
    ds_read_b128 v[20:23], v2 offset:9216
    s_waitcnt lgkmcnt(6)
    v_mfma_f32_32x32x16_bf16 v[64:79], a[12:15], v[28:31], v[64:79]
    ds_read_b128 v[24:27], v2 offset:10240
    s_waitcnt lgkmcnt(6)
    v_mfma_f32_32x32x16_bf16 v[48:63], a[16:19], v[32:35], v[48:63]
    buffer_load_dwordx4 v1, s[8:11], s24 offen offset:1024 sc1 lds
    ds_read_b128 v[28:31], v2 offset:11264
    s_waitcnt lgkmcnt(6)
    v_mfma_f32_32x32x16_bf16 v[64:79], a[20:23], v[36:39], v[64:79]
    ds_read_b128 v[32:35], v2 offset:12288
    s_waitcnt lgkmcnt(6)
    v_mfma_f32_32x32x16_bf16 v[48:63], a[24:27], v[40:43], v[48:63]
    ds_read_b128 v[36:39], v2 offset:13312
    s_waitcnt lgkmcnt(6)
    v_mfma_f32_32x32x16_bf16 v[64:79], a[28:31], v[44:47], v[64:79]
    buffer_load_dwordx4 v1, s[8:11], s24 offen offset:2048 sc1 lds
    ds_read_b128 v[40:43], v2 offset:14336
    s_waitcnt lgkmcnt(6)
    v_mfma_f32_32x32x16_bf16 v[48:63], a[32:35], v[16:19], v[48:63]
    ds_read_b128 v[44:47], v2 offset:15360
    s_waitcnt lgkmcnt(6)
    v_mfma_f32_32x32x16_bf16 v[64:79], a[36:39], v[20:23], v[64:79]
    ds_read_b128 v[16:19], v2 offset:16384
    s_waitcnt lgkmcnt(6)
    v_mfma_f32_32x32x16_bf16 v[48:63], a[40:43], v[24:27], v[48:63]
    buffer_load_dwordx4 v1, s[8:11], s24 offen offset:3072 sc1 lds
    ds_read_b128 v[20:23], v2 offset:17408
    s_waitcnt lgkmcnt(6)
    v_mfma_f32_32x32x16_bf16 v[64:79], a[44:47], v[28:31], v[64:79]
    ds_read_b128 v[24:27], v2 offset:18432
    s_waitcnt lgkmcnt(6)
    v_mfma_f32_32x32x16_bf16 v[48:63], a[48:51], v[32:35], v[48:63]
    ds_read_b128 v[28:31], v2 offset:19456
    s_waitcnt lgkmcnt(6)
    v_mfma_f32_32x32x16_bf16 v[64:79], a[52:55], v[36:39], v[64:79]
    s_add_u32 s24, s24, 4096
    s_add_u32 s25, s25, 4096
    s_mov_b32 m0, s25
    s_nop 0
    buffer_load_dwordx4 v1, s[8:11], s24 offen offset:0 sc1 lds
    ds_read_b128 v[32:35], v2 offset:20480
    s_waitcnt lgkmcnt(6)
    v_mfma_f32_32x32x16_bf16 v[48:63], a[56:59], v[40:43], v[48:63]
    ds_read_b128 v[36:39], v2 offset:21504
    s_waitcnt lgkmcnt(6)
    v_mfma_f32_32x32x16_bf16 v[64:79], a[60:63], v[44:47], v[64:79]
    ds_read_b128 v[40:43], v2 offset:22528
    s_waitcnt lgkmcnt(6)
    v_mfma_f32_32x32x16_bf16 v[48:63], a[64:67], v[16:19], v[48:63]
    buffer_load_dwordx4 v1, s[8:11], s24 offen offset:1024 sc1 lds
    ds_read_b128 v[44:47], v2 offset:23552
    s_waitcnt lgkmcnt(6)
    v_mfma_f32_32x32x16_bf16 v[64:79], a[68:71], v[20:23], v[64:79]
    ds_read_b128 v[16:19], v2 offset:24576
    s_waitcnt lgkmcnt(6)
    v_mfma_f32_32x32x16_bf16 v[48:63], a[72:75], v[24:27], v[48:63]
    ds_read_b128 v[20:23], v2 offset:25600
    s_waitcnt lgkmcnt(6)
    v_mfma_f32_32x32x16_bf16 v[64:79], a[76:79], v[28:31], v[64:79]
    buffer_load_dwordx4 v1, s[8:11], s24 offen offset:2048 sc1 lds
    ds_read_b128 v[24:27], v2 offset:26624
    s_waitcnt lgkmcnt(6)
    v_mfma_f32_32x32x16_bf16 v[48:63], a[80:83], v[32:35], v[48:63]
    ds_read_b128 v[28:31], v2 offset:27648
    s_waitcnt lgkmcnt(6)
    v_mfma_f32_32x32x16_bf16 v[64:79], a[84:87], v[36:39], v[64:79]
    ds_read_b128 v[32:35], v2 offset:28672
    s_waitcnt lgkmcnt(6)
    v_mfma_f32_32x32x16_bf16 v[48:63], a[88:91], v[40:43], v[48:63]
    buffer_load_dwordx4 v1, s[8:11], s24 offen offset:3072 sc1 lds
    ds_read_b128 v[36:39], v2 offset:29696
    s_waitcnt lgkmcnt(6)
    v_mfma_f32_32x32x16_bf16 v[64:79], a[92:95], v[44:47], v[64:79]
    ds_read_b128 v[40:43], v2 offset:30720
    s_waitcnt lgkmcnt(6)
    v_mfma_f32_32x32x16_bf16 v[48:63], a[96:99], v[16:19], v[48:63]
    ds_read_b128 v[44:47], v2 offset:31744
    s_waitcnt lgkmcnt(6)
    v_mfma_f32_32x32x16_bf16 v[64:79], a[100:103], v[20:23], v[64:79]
    s_add_u32 s24, s24, 4096
    s_add_u32 s25, s25, 4096
    s_mov_b32 m0, s25
    s_nop 0
    buffer_load_dwordx4 v1, s[8:11], s24 offen offset:0 sc1 lds
    ds_read_b128 v[16:19], v2 offset:32768
    s_waitcnt lgkmcnt(6)
    v_mfma_f32_32x32x16_bf16 v[48:63], a[104:107], v[24:27], v[48:63]
    ds_read_b128 v[20:23], v2 offset:33792
    s_waitcnt lgkmcnt(6)
    v_mfma_f32_32x32x16_bf16 v[64:79], a[108:111], v[28:31], v[64:79]
    ds_read_b128 v[24:27], v2 offset:34816
    s_waitcnt lgkmcnt(6)
    v_mfma_f32_32x32x16_bf16 v[48:63], a[112:115], v[32:35], v[48:63]
    buffer_load_dwordx4 v1, s[8:11], s24 offen offset:1024 sc1 lds
    ds_read_b128 v[28:31], v2 offset:35840
    s_waitcnt lgkmcnt(6)
    v_mfma_f32_32x32x16_bf16 v[64:79], a[116:119], v[36:39], v[64:79]
    ds_read_b128 v[32:35], v2 offset:36864
    s_waitcnt lgkmcnt(6)
    v_mfma_f32_32x32x16_bf16 v[48:63], a[120:123], v[40:43], v[48:63]
    ds_read_b128 v[36:39], v2 offset:37888
    s_waitcnt lgkmcnt(6)
    v_mfma_f32_32x32x16_bf16 v[64:79], a[124:127], v[44:47], v[64:79]
    ds_read_b128 v[40:43], v2 offset:38912
    s_waitcnt lgkmcnt(6)
    v_mfma_f32_32x32x16_bf16 v[48:63], a[128:131], v[16:19], v[48:63]
    ds_read_b128 v[44:47], v2 offset:39936
    s_waitcnt lgkmcnt(6)
    v_mfma_f32_32x32x16_bf16 v[64:79], a[132:135], v[20:23], v[64:79]
    s_waitcnt lgkmcnt(5)
    v_mfma_f32_32x32x16_bf16 v[48:63], a[136:139], v[24:27], v[48:63]
    s_waitcnt lgkmcnt(4)
    v_mfma_f32_32x32x16_bf16 v[64:79], a[140:143], v[28:31], v[64:79]
    s_waitcnt lgkmcnt(3)
    v_mfma_f32_32x32x16_bf16 v[48:63], a[144:147], v[32:35], v[48:63]
    s_waitcnt lgkmcnt(2)
    v_mfma_f32_32x32x16_bf16 v[64:79], a[148:151], v[36:39], v[64:79]
    s_waitcnt lgkmcnt(1)
    v_mfma_f32_32x32x16_bf16 v[48:63], a[152:155], v[40:43], v[48:63]
    s_waitcnt lgkmcnt(0)
    v_mfma_f32_32x32x16_bf16 v[64:79], a[156:159], v[44:47], v[64:79]
    s_waitcnt vmcnt(15)
    s_nop 7
    s_nop 3
    v_add_f32 v48, v48, v64
    v_add_f32 v49, v49, v65
    v_add_f32 v50, v50, v66
    v_add_f32 v51, v51, v67
    v_add_f32 v52, v52, v68
    v_add_f32 v53, v53, v69
    v_add_f32 v54, v54, v70
    v_add_f32 v55, v55, v71
    v_add_f32 v56, v56, v72
    v_add_f32 v57, v57, v73
    v_add_f32 v58, v58, v74
    v_add_f32 v59, v59, v75
    v_add_f32 v60, v60, v76
    v_add_f32 v61, v61, v77
    v_add_f32 v62, v62, v78
    v_add_f32 v63, v63, v79
    s_add_u32 s26, s19, 226492416
    v_cvt_pk_bf16_f32 v80, v48, v49
    v_cvt_pk_bf16_f32 v81, v50, v51
    v_cvt_pk_bf16_f32 v82, v52, v53
    v_cvt_pk_bf16_f32 v83, v54, v55
    s_nop 1
    v_permlane32_swap_b32 v80, v82
    v_permlane32_swap_b32 v81, v83
    s_nop 1
    v_lshlrev_b32 v88, 16, v80
    v_and_b32 v89, 0xffff0000, v80
    v_lshlrev_b32 v90, 16, v96
    v_and_b32 v91, 0xffff0000, v96
    v_add_f32 v88, v88, v90
    v_add_f32 v89, v89, v91
    v_cvt_pk_bf16_f32 v80, v88, v89
    v_lshlrev_b32 v92, 16, v81
    v_and_b32 v93, 0xffff0000, v81
    v_lshlrev_b32 v94, 16, v97
    v_and_b32 v95, 0xffff0000, v97
    v_add_f32 v92, v92, v94
    v_add_f32 v93, v93, v95
    v_cvt_pk_bf16_f32 v81, v92, v93
    v_lshlrev_b32 v88, 16, v82
    v_and_b32 v89, 0xffff0000, v82
    v_lshlrev_b32 v90, 16, v98
    v_and_b32 v91, 0xffff0000, v98
    v_add_f32 v88, v88, v90
    v_add_f32 v89, v89, v91
    v_cvt_pk_bf16_f32 v82, v88, v89
    v_lshlrev_b32 v92, 16, v83
    v_and_b32 v93, 0xffff0000, v83
    v_lshlrev_b32 v94, 16, v99
    v_and_b32 v95, 0xffff0000, v99
    v_add_f32 v92, v92, v94
    v_add_f32 v93, v93, v95
    v_cvt_pk_bf16_f32 v83, v92, v93
    buffer_store_dwordx4 v[80:83], v3, s[8:11], s26 offen offset:0 sc1
    v_cvt_pk_bf16_f32 v84, v56, v57
    v_cvt_pk_bf16_f32 v85, v58, v59
    v_cvt_pk_bf16_f32 v86, v60, v61
    v_cvt_pk_bf16_f32 v87, v62, v63
    s_nop 1
    v_permlane32_swap_b32 v84, v86
    v_permlane32_swap_b32 v85, v87
    s_nop 1
    v_lshlrev_b32 v88, 16, v84
    v_and_b32 v89, 0xffff0000, v84
    v_lshlrev_b32 v90, 16, v100
    v_and_b32 v91, 0xffff0000, v100
    v_add_f32 v88, v88, v90
    v_add_f32 v89, v89, v91
    v_cvt_pk_bf16_f32 v84, v88, v89
    v_lshlrev_b32 v92, 16, v85
    v_and_b32 v93, 0xffff0000, v85
    v_lshlrev_b32 v94, 16, v101
    v_and_b32 v95, 0xffff0000, v101
    v_add_f32 v92, v92, v94
    v_add_f32 v93, v93, v95
    v_cvt_pk_bf16_f32 v85, v92, v93
    v_lshlrev_b32 v88, 16, v86
    v_and_b32 v89, 0xffff0000, v86
    v_lshlrev_b32 v90, 16, v102
    v_and_b32 v91, 0xffff0000, v102
    v_add_f32 v88, v88, v90
    v_add_f32 v89, v89, v91
    v_cvt_pk_bf16_f32 v86, v88, v89
    v_lshlrev_b32 v92, 16, v87
    v_and_b32 v93, 0xffff0000, v87
    v_lshlrev_b32 v94, 16, v103
    v_and_b32 v95, 0xffff0000, v103
    v_add_f32 v92, v92, v94
    v_add_f32 v93, v93, v95
    v_cvt_pk_bf16_f32 v87, v92, v93
    buffer_store_dwordx4 v[84:87], v3, s[8:11], s26 offen offset:32 sc1
    s_waitcnt vmcnt(15)
    s_mov_b64 exec, 1
    s_add_u32 s26, s48, s20
    buffer_store_dword v5, v4, s[8:11], s26 offen sc1
    s_mov_b64 exec, -1
    s_add_u32 s20, s20, 128
    s_add_u32 s19, s19, 40960
    s_add_u32 s16, s16, 40960
    s_cmp_eq_u32 s16, 122880
    s_cselect_b32 s16, 0, s16
    s_add_u32 s14, s14, 1
    s_cmp_ge_u32 s14, s15
    s_cbranch_scc1 layerb1_kernel_ab_fin
    s_add_u32 s23, s14, 2
    s_cmp_lg_u32 s13, 0
    s_cbranch_scc1 layerb1_kernel_ab_ow10
    s_min_u32 s28, s23, 63
    s_cmp_gt_u32 s22, s28
    s_cbranch_scc1 layerb1_kernel_ab_ow10
layerb1_kernel_ab_op10:
    buffer_load_dwordx4 v[116:119], v1, s[8:11], s29 offen sc1
    s_waitcnt vmcnt(0)
    v_min_u32 v116, v116, v117
    v_min_u32 v118, v118, v119
    v_min_u32 v114, v116, v118
    v_cmp_eq_u32 vcc, 0, v114
    s_nop 1
    s_ff1_i32_b64 s22, vcc
    s_min_u32 s22, s22, 64
    s_and_b32 s22, s22, 0x7c
    s_sub_u32 s30, s30, 1
    s_cbranch_scc1 layerb1_kernel_bail
    s_cmp_gt_u32 s22, s28
    s_cbranch_scc0 layerb1_kernel_ab_op10
layerb1_kernel_ab_ow10:
    s_barrier
    v_add_u32 v2, s16, v1
    ds_read_b128 v[16:19], v2 offset:0
    ds_read_b128 v[20:23], v2 offset:1024
    ds_read_b128 v[24:27], v2 offset:2048
    ds_read_b128 v[28:31], v2 offset:3072
    ds_read_b128 v[32:35], v2 offset:4096
    ds_read_b128 v[36:39], v2 offset:5120
    s_add_u32 s27, s19, 40960
    s_cmp_ge_u32 s14, 63
    s_cselect_b32 s27, s19, s27
    buffer_load_dwordx4 v[96:99], v3, s[52:55], s27 offen offset:0
    buffer_load_dwordx4 v[100:103], v3, s[52:55], s27 offen offset:32
    s_add_u32 s23, s14, 2
    s_min_u32 s24, s23, 63
    s_mul_i32 s24, s24, 40960
    s_add_u32 s24, s24, s18
    s_mul_i32 s25, s13, 10240
    s_add_u32 s25, s25, s17
    s_add_u32 s17, s17, 40960
    s_cmp_eq_u32 s17, 122880
    s_cselect_b32 s17, 0, s17
    ds_read_b128 v[40:43], v2 offset:6144
    s_waitcnt lgkmcnt(6)
    v_mfma_f32_32x32x16_bf16 v[48:63], a[0:3], v[16:19], 0
    ds_read_b128 v[44:47], v2 offset:7168
    s_waitcnt lgkmcnt(6)
    v_mfma_f32_32x32x16_bf16 v[64:79], a[4:7], v[20:23], 0
    s_mov_b32 m0, s25
    s_nop 0
    buffer_load_dwordx4 v1, s[8:11], s24 offen offset:0 sc1 lds
    ds_read_b128 v[16:19], v2 offset:8192
    s_waitcnt lgkmcnt(6)
    v_mfma_f32_32x32x16_bf16 v[48:63], a[8:11], v[24:27], v[48:63]
    ds_read_b128 v[20:23], v2 offset:9216
    s_waitcnt lgkmcnt(6)
    v_mfma_f32_32x32x16_bf16 v[64:79], a[12:15], v[28:31], v[64:79]
    ds_read_b128 v[24:27], v2 offset:10240
    s_waitcnt lgkmcnt(6)
    v_mfma_f32_32x32x16_bf16 v[48:63], a[16:19], v[32:35], v[48:63]
    buffer_load_dwordx4 v1, s[8:11], s24 offen offset:1024 sc1 lds
    ds_read_b128 v[28:31], v2 offset:11264
    s_waitcnt lgkmcnt(6)
    v_mfma_f32_32x32x16_bf16 v[64:79], a[20:23], v[36:39], v[64:79]
    ds_read_b128 v[32:35], v2 offset:12288
    s_waitcnt lgkmcnt(6)
    v_mfma_f32_32x32x16_bf16 v[48:63], a[24:27], v[40:43], v[48:63]
    ds_read_b128 v[36:39], v2 offset:13312
    s_waitcnt lgkmcnt(6)
    v_mfma_f32_32x32x16_bf16 v[64:79], a[28:31], v[44:47], v[64:79]
    buffer_load_dwordx4 v1, s[8:11], s24 offen offset:2048 sc1 lds
    ds_read_b128 v[40:43], v2 offset:14336
    s_waitcnt lgkmcnt(6)
    v_mfma_f32_32x32x16_bf16 v[48:63], a[32:35], v[16:19], v[48:63]
    ds_read_b128 v[44:47], v2 offset:15360
    s_waitcnt lgkmcnt(6)
    v_mfma_f32_32x32x16_bf16 v[64:79], a[36:39], v[20:23], v[64:79]
    ds_read_b128 v[16:19], v2 offset:16384
    s_waitcnt lgkmcnt(6)
    v_mfma_f32_32x32x16_bf16 v[48:63], a[40:43], v[24:27], v[48:63]
    buffer_load_dwordx4 v1, s[8:11], s24 offen offset:3072 sc1 lds
    ds_read_b128 v[20:23], v2 offset:17408
    s_waitcnt lgkmcnt(6)
    v_mfma_f32_32x32x16_bf16 v[64:79], a[44:47], v[28:31], v[64:79]
    ds_read_b128 v[24:27], v2 offset:18432
    s_waitcnt lgkmcnt(6)
    v_mfma_f32_32x32x16_bf16 v[48:63], a[48:51], v[32:35], v[48:63]
    ds_read_b128 v[28:31], v2 offset:19456
    s_waitcnt lgkmcnt(6)
    v_mfma_f32_32x32x16_bf16 v[64:79], a[52:55], v[36:39], v[64:79]
    s_add_u32 s24, s24, 4096
    s_add_u32 s25, s25, 4096
    s_mov_b32 m0, s25
    s_nop 0
    buffer_load_dwordx4 v1, s[8:11], s24 offen offset:0 sc1 lds
    ds_read_b128 v[32:35], v2 offset:20480
    s_waitcnt lgkmcnt(6)
    v_mfma_f32_32x32x16_bf16 v[48:63], a[56:59], v[40:43], v[48:63]
    ds_read_b128 v[36:39], v2 offset:21504
    s_waitcnt lgkmcnt(6)
    v_mfma_f32_32x32x16_bf16 v[64:79], a[60:63], v[44:47], v[64:79]
    ds_read_b128 v[40:43], v2 offset:22528
    s_waitcnt lgkmcnt(6)
    v_mfma_f32_32x32x16_bf16 v[48:63], a[64:67], v[16:19], v[48:63]
    buffer_load_dwordx4 v1, s[8:11], s24 offen offset:1024 sc1 lds
    ds_read_b128 v[44:47], v2 offset:23552
    s_waitcnt lgkmcnt(6)
    v_mfma_f32_32x32x16_bf16 v[64:79], a[68:71], v[20:23], v[64:79]
    ds_read_b128 v[16:19], v2 offset:24576
    s_waitcnt lgkmcnt(6)
    v_mfma_f32_32x32x16_bf16 v[48:63], a[72:75], v[24:27], v[48:63]
    ds_read_b128 v[20:23], v2 offset:25600
    s_waitcnt lgkmcnt(6)
    v_mfma_f32_32x32x16_bf16 v[64:79], a[76:79], v[28:31], v[64:79]
    buffer_load_dwordx4 v1, s[8:11], s24 offen offset:2048 sc1 lds
    ds_read_b128 v[24:27], v2 offset:26624
    s_waitcnt lgkmcnt(6)
    v_mfma_f32_32x32x16_bf16 v[48:63], a[80:83], v[32:35], v[48:63]
    ds_read_b128 v[28:31], v2 offset:27648
    s_waitcnt lgkmcnt(6)
    v_mfma_f32_32x32x16_bf16 v[64:79], a[84:87], v[36:39], v[64:79]
    ds_read_b128 v[32:35], v2 offset:28672
    s_waitcnt lgkmcnt(6)
    v_mfma_f32_32x32x16_bf16 v[48:63], a[88:91], v[40:43], v[48:63]
    buffer_load_dwordx4 v1, s[8:11], s24 offen offset:3072 sc1 lds
    ds_read_b128 v[36:39], v2 offset:29696
    s_waitcnt lgkmcnt(6)
    v_mfma_f32_32x32x16_bf16 v[64:79], a[92:95], v[44:47], v[64:79]
    ds_read_b128 v[40:43], v2 offset:30720
    s_waitcnt lgkmcnt(6)
    v_mfma_f32_32x32x16_bf16 v[48:63], a[96:99], v[16:19], v[48:63]
    ds_read_b128 v[44:47], v2 offset:31744
    s_waitcnt lgkmcnt(6)
    v_mfma_f32_32x32x16_bf16 v[64:79], a[100:103], v[20:23], v[64:79]
    s_add_u32 s24, s24, 4096
    s_add_u32 s25, s25, 4096
    s_mov_b32 m0, s25
    s_nop 0
    buffer_load_dwordx4 v1, s[8:11], s24 offen offset:0 sc1 lds
    ds_read_b128 v[16:19], v2 offset:32768
    s_waitcnt lgkmcnt(6)
    v_mfma_f32_32x32x16_bf16 v[48:63], a[104:107], v[24:27], v[48:63]
    ds_read_b128 v[20:23], v2 offset:33792
    s_waitcnt lgkmcnt(6)
    v_mfma_f32_32x32x16_bf16 v[64:79], a[108:111], v[28:31], v[64:79]
    ds_read_b128 v[24:27], v2 offset:34816
    s_waitcnt lgkmcnt(6)
    v_mfma_f32_32x32x16_bf16 v[48:63], a[112:115], v[32:35], v[48:63]
    buffer_load_dwordx4 v1, s[8:11], s24 offen offset:1024 sc1 lds
    ds_read_b128 v[28:31], v2 offset:35840
    s_waitcnt lgkmcnt(6)
    v_mfma_f32_32x32x16_bf16 v[64:79], a[116:119], v[36:39], v[64:79]
    ds_read_b128 v[32:35], v2 offset:36864
    s_waitcnt lgkmcnt(6)
    v_mfma_f32_32x32x16_bf16 v[48:63], a[120:123], v[40:43], v[48:63]
    ds_read_b128 v[36:39], v2 offset:37888
    s_waitcnt lgkmcnt(6)
    v_mfma_f32_32x32x16_bf16 v[64:79], a[124:127], v[44:47], v[64:79]
    ds_read_b128 v[40:43], v2 offset:38912
    s_waitcnt lgkmcnt(6)
    v_mfma_f32_32x32x16_bf16 v[48:63], a[128:131], v[16:19], v[48:63]
    ds_read_b128 v[44:47], v2 offset:39936
    s_waitcnt lgkmcnt(6)
    v_mfma_f32_32x32x16_bf16 v[64:79], a[132:135], v[20:23], v[64:79]
    s_waitcnt lgkmcnt(5)
    v_mfma_f32_32x32x16_bf16 v[48:63], a[136:139], v[24:27], v[48:63]
    s_waitcnt lgkmcnt(4)
    v_mfma_f32_32x32x16_bf16 v[64:79], a[140:143], v[28:31], v[64:79]
    s_waitcnt lgkmcnt(3)
    v_mfma_f32_32x32x16_bf16 v[48:63], a[144:147], v[32:35], v[48:63]
    s_waitcnt lgkmcnt(2)
    v_mfma_f32_32x32x16_bf16 v[64:79], a[148:151], v[36:39], v[64:79]
    s_waitcnt lgkmcnt(1)
    v_mfma_f32_32x32x16_bf16 v[48:63], a[152:155], v[40:43], v[48:63]
    s_waitcnt lgkmcnt(0)
    v_mfma_f32_32x32x16_bf16 v[64:79], a[156:159], v[44:47], v[64:79]
    s_waitcnt vmcnt(15)
    s_nop 7
    s_nop 3
    v_add_f32 v48, v48, v64
    v_add_f32 v49, v49, v65
    v_add_f32 v50, v50, v66
    v_add_f32 v51, v51, v67
    v_add_f32 v52, v52, v68
    v_add_f32 v53, v53, v69
    v_add_f32 v54, v54, v70
    v_add_f32 v55, v55, v71
    v_add_f32 v56, v56, v72
    v_add_f32 v57, v57, v73
    v_add_f32 v58, v58, v74
    v_add_f32 v59, v59, v75
    v_add_f32 v60, v60, v76
    v_add_f32 v61, v61, v77
    v_add_f32 v62, v62, v78
    v_add_f32 v63, v63, v79
    s_add_u32 s26, s19, 226492416
    v_cvt_pk_bf16_f32 v80, v48, v49
    v_cvt_pk_bf16_f32 v81, v50, v51
    v_cvt_pk_bf16_f32 v82, v52, v53
    v_cvt_pk_bf16_f32 v83, v54, v55
    s_nop 1
    v_permlane32_swap_b32 v80, v82
    v_permlane32_swap_b32 v81, v83
    s_nop 1
    v_lshlrev_b32 v88, 16, v80
    v_and_b32 v89, 0xffff0000, v80
    v_lshlrev_b32 v90, 16, v104
    v_and_b32 v91, 0xffff0000, v104
    v_add_f32 v88, v88, v90
    v_add_f32 v89, v89, v91
    v_cvt_pk_bf16_f32 v80, v88, v89
    v_lshlrev_b32 v92, 16, v81
    v_and_b32 v93, 0xffff0000, v81
    v_lshlrev_b32 v94, 16, v105
    v_and_b32 v95, 0xffff0000, v105
    v_add_f32 v92, v92, v94
    v_add_f32 v93, v93, v95
    v_cvt_pk_bf16_f32 v81, v92, v93
    v_lshlrev_b32 v88, 16, v82
    v_and_b32 v89, 0xffff0000, v82
    v_lshlrev_b32 v90, 16, v106
    v_and_b32 v91, 0xffff0000, v106
    v_add_f32 v88, v88, v90
    v_add_f32 v89, v89, v91
    v_cvt_pk_bf16_f32 v82, v88, v89
    v_lshlrev_b32 v92, 16, v83
    v_and_b32 v93, 0xffff0000, v83
    v_lshlrev_b32 v94, 16, v107
    v_and_b32 v95, 0xffff0000, v107
    v_add_f32 v92, v92, v94
    v_add_f32 v93, v93, v95
    v_cvt_pk_bf16_f32 v83, v92, v93
    buffer_store_dwordx4 v[80:83], v3, s[8:11], s26 offen offset:0 sc1
    v_cvt_pk_bf16_f32 v84, v56, v57
    v_cvt_pk_bf16_f32 v85, v58, v59
    v_cvt_pk_bf16_f32 v86, v60, v61
    v_cvt_pk_bf16_f32 v87, v62, v63
    s_nop 1
    v_permlane32_swap_b32 v84, v86
    v_permlane32_swap_b32 v85, v87
    s_nop 1
    v_lshlrev_b32 v88, 16, v84
    v_and_b32 v89, 0xffff0000, v84
    v_lshlrev_b32 v90, 16, v108
    v_and_b32 v91, 0xffff0000, v108
    v_add_f32 v88, v88, v90
    v_add_f32 v89, v89, v91
    v_cvt_pk_bf16_f32 v84, v88, v89
    v_lshlrev_b32 v92, 16, v85
    v_and_b32 v93, 0xffff0000, v85
    v_lshlrev_b32 v94, 16, v109
    v_and_b32 v95, 0xffff0000, v109
    v_add_f32 v92, v92, v94
    v_add_f32 v93, v93, v95
    v_cvt_pk_bf16_f32 v85, v92, v93
    v_lshlrev_b32 v88, 16, v86
    v_and_b32 v89, 0xffff0000, v86
    v_lshlrev_b32 v90, 16, v110
    v_and_b32 v91, 0xffff0000, v110
    v_add_f32 v88, v88, v90
    v_add_f32 v89, v89, v91
    v_cvt_pk_bf16_f32 v86, v88, v89
    v_lshlrev_b32 v92, 16, v87
    v_and_b32 v93, 0xffff0000, v87
    v_lshlrev_b32 v94, 16, v111
    v_and_b32 v95, 0xffff0000, v111
    v_add_f32 v92, v92, v94
    v_add_f32 v93, v93, v95
    v_cvt_pk_bf16_f32 v87, v92, v93
    buffer_store_dwordx4 v[84:87], v3, s[8:11], s26 offen offset:32 sc1
    s_waitcnt vmcnt(15)
    s_mov_b64 exec, 1
    s_add_u32 s26, s48, s20
    buffer_store_dword v5, v4, s[8:11], s26 offen sc1
    s_mov_b64 exec, -1
    s_add_u32 s20, s20, 128
    s_add_u32 s19, s19, 40960
    s_add_u32 s16, s16, 40960
    s_cmp_eq_u32 s16, 122880
    s_cselect_b32 s16, 0, s16
    s_add_u32 s14, s14, 1
    s_cmp_lt_u32 s14, s15
    s_cbranch_scc1 layerb1_kernel_ab_loop
layerb1_kernel_ab_fin:
    s_waitcnt vmcnt(0) lgkmcnt(0)
    s_mov_b64 exec, 1
    s_add_u32 s26, s48, s20
    buffer_store_dword v5, v4, s[8:11], s26 offen sc1
    s_mov_b64 exec, -1
    s_add_u32 s20, s20, 128
    s_barrier
    s_branch layerb1_kernel_w3
layerb1_kernel_sp_ln:
    s_sub_u32 s12, s22, 5
    s_mov_b32 s14, s12
    s_mov_b32 s16, 0x3f803f80
    v_lshrrev_b32 v6, 3, v0
    v_and_b32 v7, 7, v0
    v_mul_u32_u24 v1, 1280, v6
    v_lshl_add_u32 v1, v7, 5, v1
    v_lshlrev_b32 v2, 10, v7
    v_lshl_add_u32 v2, v6, 4, v2
    v_lshlrev_b32 v3, 2, v0
    v_mov_b32 v4, 1
layerb1_kernel_ln_seg:
    s_lshl_b32 s17, s14, 7
    s_add_u32 s17, s17, s48
    s_add_u32 s17, s17, 36864
    s_mov_b64 exec, 0xfffff
layerb1_kernel_ln_poll:
    buffer_load_dword v5, v3, s[8:11], s17 offen sc1
    s_waitcnt vmcnt(0)
    v_cmp_eq_u32 vcc, 0, v5
    s_sub_u32 s15, s15, 1
    s_cbranch_scc1 layerb1_kernel_bail
    s_cbranch_vccnz layerb1_kernel_ln_poll
    s_mov_b64 exec, -1
    s_lshl_b32 s18, s14, 5
    s_lshl_b32 s19, s13, 3
    s_add_u32 s18, s18, s19
    s_mul_i32 s18, s18, 1280
    s_add_u32 s18, s18, 226492416
    buffer_load_dwordx4 v[16:19], v1, s[8:11], s18 offen offset:0 sc1
    buffer_load_dwordx4 v[20:23], v1, s[8:11], s18 offen offset:16 sc1
    buffer_load_dwordx4 v[24:27], v1, s[8:11], s18 offen offset:256 sc1
    buffer_load_dwordx4 v[28:31], v1, s[8:11], s18 offen offset:272 sc1
    buffer_load_dwordx4 v[32:35], v1, s[8:11], s18 offen offset:512 sc1
    buffer_load_dwordx4 v[36:39], v1, s[8:11], s18 offen offset:528 sc1
    buffer_load_dwordx4 v[40:43], v1, s[8:11], s18 offen offset:768 sc1
    buffer_load_dwordx4 v[44:47], v1, s[8:11], s18 offen offset:784 sc1
    buffer_load_dwordx4 v[48:51], v1, s[8:11], s18 offen offset:1024 sc1
    buffer_load_dwordx4 v[52:55], v1, s[8:11], s18 offen offset:1040 sc1
    v_mov_b32 v8, 0
    v_mov_b32 v9, 0
    v_mov_b32 v10, 0
    v_mov_b32 v11, 0
    s_waitcnt vmcnt(9)
    v_dot2c_f32_bf16 v8, s16, v16
    v_dot2c_f32_bf16 v10, v16, v16
    v_dot2c_f32_bf16 v9, s16, v17
    v_dot2c_f32_bf16 v11, v17, v17
    v_dot2c_f32_bf16 v8, s16, v18
    v_dot2c_f32_bf16 v10, v18, v18
    v_dot2c_f32_bf16 v9, s16, v19
    v_dot2c_f32_bf16 v11, v19, v19
    s_waitcnt vmcnt(8)
    v_dot2c_f32_bf16 v8, s16, v20
    v_dot2c_f32_bf16 v10, v20, v20
    v_dot2c_f32_bf16 v9, s16, v21
    v_dot2c_f32_bf16 v11, v21, v21
    v_dot2c_f32_bf16 v8, s16, v22
    v_dot2c_f32_bf16 v10, v22, v22
    v_dot2c_f32_bf16 v9, s16, v23
    v_dot2c_f32_bf16 v11, v23, v23
    s_waitcnt vmcnt(7)
    v_dot2c_f32_bf16 v8, s16, v24
    v_dot2c_f32_bf16 v10, v24, v24
    v_dot2c_f32_bf16 v9, s16, v25
    v_dot2c_f32_bf16 v11, v25, v25
    v_dot2c_f32_bf16 v8, s16, v26
    v_dot2c_f32_bf16 v10, v26, v26
    v_dot2c_f32_bf16 v9, s16, v27
    v_dot2c_f32_bf16 v11, v27, v27
    s_waitcnt vmcnt(6)
    v_dot2c_f32_bf16 v8, s16, v28
    v_dot2c_f32_bf16 v10, v28, v28
    v_dot2c_f32_bf16 v9, s16, v29
    v_dot2c_f32_bf16 v11, v29, v29
    v_dot2c_f32_bf16 v8, s16, v30
    v_dot2c_f32_bf16 v10, v30, v30
    v_dot2c_f32_bf16 v9, s16, v31
    v_dot2c_f32_bf16 v11, v31, v31
    s_waitcnt vmcnt(5)
    v_dot2c_f32_bf16 v8, s16, v32
    v_dot2c_f32_bf16 v10, v32, v32
    v_dot2c_f32_bf16 v9, s16, v33
    v_dot2c_f32_bf16 v11, v33, v33
    v_dot2c_f32_bf16 v8, s16, v34
    v_dot2c_f32_bf16 v10, v34, v34
    v_dot2c_f32_bf16 v9, s16, v35
    v_dot2c_f32_bf16 v11, v35, v35
    s_waitcnt vmcnt(4)
    v_dot2c_f32_bf16 v8, s16, v36
    v_dot2c_f32_bf16 v10, v36, v36
    v_dot2c_f32_bf16 v9, s16, v37
    v_dot2c_f32_bf16 v11, v37, v37
    v_dot2c_f32_bf16 v8, s16, v38
    v_dot2c_f32_bf16 v10, v38, v38
    v_dot2c_f32_bf16 v9, s16, v39
    v_dot2c_f32_bf16 v11, v39, v39
    s_waitcnt vmcnt(3)
    v_dot2c_f32_bf16 v8, s16, v40
    v_dot2c_f32_bf16 v10, v40, v40
    v_dot2c_f32_bf16 v9, s16, v41
    v_dot2c_f32_bf16 v11, v41, v41
    v_dot2c_f32_bf16 v8, s16, v42
    v_dot2c_f32_bf16 v10, v42, v42
    v_dot2c_f32_bf16 v9, s16, v43
    v_dot2c_f32_bf16 v11, v43, v43
    s_waitcnt vmcnt(2)
    v_dot2c_f32_bf16 v8, s16, v44
    v_dot2c_f32_bf16 v10, v44, v44
    v_dot2c_f32_bf16 v9, s16, v45
    v_dot2c_f32_bf16 v11, v45, v45
    v_dot2c_f32_bf16 v8, s16, v46
    v_dot2c_f32_bf16 v10, v46, v46
    v_dot2c_f32_bf16 v9, s16, v47
    v_dot2c_f32_bf16 v11, v47, v47
    s_waitcnt vmcnt(1)
    v_dot2c_f32_bf16 v8, s16, v48
    v_dot2c_f32_bf16 v10, v48, v48
    v_dot2c_f32_bf16 v9, s16, v49
    v_dot2c_f32_bf16 v11, v49, v49
    v_dot2c_f32_bf16 v8, s16, v50
    v_dot2c_f32_bf16 v10, v50, v50
    v_dot2c_f32_bf16 v9, s16, v51
    v_dot2c_f32_bf16 v11, v51, v51
    s_waitcnt vmcnt(0)
    v_dot2c_f32_bf16 v8, s16, v52
    v_dot2c_f32_bf16 v10, v52, v52
    v_dot2c_f32_bf16 v9, s16, v53
    v_dot2c_f32_bf16 v11, v53, v53
    v_dot2c_f32_bf16 v8, s16, v54
    v_dot2c_f32_bf16 v10, v54, v54
    v_dot2c_f32_bf16 v9, s16, v55
    v_dot2c_f32_bf16 v11, v55, v55
    s_nop 3
    v_add_f32 v8, v8, v9
    v_add_f32 v10, v10, v11
    s_nop 1
    v_add_f32_dpp v8, v8, v8 quad_perm:[1,0,3,2] row_mask:0xf bank_mask:0xf
    v_add_f32_dpp v10, v10, v10 quad_perm:[1,0,3,2] row_mask:0xf bank_mask:0xf
    s_nop 1
    v_add_f32_dpp v8, v8, v8 quad_perm:[2,3,0,1] row_mask:0xf bank_mask:0xf
    v_add_f32_dpp v10, v10, v10 quad_perm:[2,3,0,1] row_mask:0xf bank_mask:0xf
    s_nop 1
    v_add_f32_dpp v8, v8, v8 row_half_mirror row_mask:0xf bank_mask:0xf
    v_add_f32_dpp v10, v10, v10 row_half_mirror row_mask:0xf bank_mask:0xf
    v_mul_f32 v8, 0x3acccccd, v8
    v_mul_f32 v9, v8, v8
    v_mul_f32 v10, 0x3acccccd, v10
    v_sub_f32 v10, v10, v9
    v_max_f32 v10, 0, v10
    v_add_f32 v10, 0x3727c5ac, v10
    v_rsq_f32 v10, v10
    s_nop 0
    v_mul_f32 v8, v8, v10
    v_sub_f32 v8, 0, v8
    s_mul_i32 s18, s14, 40960
    s_lshl_b32 s19, s13, 7
    s_add_u32 s18, s18, s19
    s_add_u32 s18, s18, 220200960
    v_lshlrev_b32 v64, 16, v16
    v_and_b32 v65, 0xffff0000, v16
    v_fma_f32 v64, v64, v10, v8
    v_fma_f32 v65, v65, v10, v8
    v_cvt_pk_bf16_f32 v72, v64, v65
    v_lshlrev_b32 v66, 16, v17
    v_and_b32 v67, 0xffff0000, v17
    v_fma_f32 v66, v66, v10, v8
    v_fma_f32 v67, v67, v10, v8
    v_cvt_pk_bf16_f32 v74, v66, v67
    v_lshlrev_b32 v68, 16, v18
    v_and_b32 v69, 0xffff0000, v18
    v_fma_f32 v68, v68, v10, v8
    v_fma_f32 v69, v69, v10, v8
    v_cvt_pk_bf16_f32 v76, v68, v69
    v_lshlrev_b32 v70, 16, v19
    v_and_b32 v71, 0xffff0000, v19
    v_fma_f32 v70, v70, v10, v8
    v_fma_f32 v71, v71, v10, v8
    v_cvt_pk_bf16_f32 v78, v70, v71
    v_lshlrev_b32 v64, 16, v20
    v_and_b32 v65, 0xffff0000, v20
    v_fma_f32 v64, v64, v10, v8
    v_fma_f32 v65, v65, v10, v8
    v_cvt_pk_bf16_f32 v73, v64, v65
    v_lshlrev_b32 v66, 16, v21
    v_and_b32 v67, 0xffff0000, v21
    v_fma_f32 v66, v66, v10, v8
    v_fma_f32 v67, v67, v10, v8
    v_cvt_pk_bf16_f32 v75, v66, v67
    v_lshlrev_b32 v68, 16, v22
    v_and_b32 v69, 0xffff0000, v22
    v_fma_f32 v68, v68, v10, v8
    v_fma_f32 v69, v69, v10, v8
    v_cvt_pk_bf16_f32 v77, v68, v69
    v_lshlrev_b32 v70, 16, v23
    v_and_b32 v71, 0xffff0000, v23
    v_fma_f32 v70, v70, v10, v8
    v_fma_f32 v71, v71, v10, v8
    v_cvt_pk_bf16_f32 v79, v70, v71
    buffer_store_dwordx4 v[72:75], v2, s[8:11], s18 offen offset:0 sc1
    buffer_store_dwordx4 v[76:79], v2, s[8:11], s18 offen offset:512 sc1
    s_add_u32 s18, s18, 8192
    v_lshlrev_b32 v64, 16, v24
    v_and_b32 v65, 0xffff0000, v24
    v_fma_f32 v64, v64, v10, v8
    v_fma_f32 v65, v65, v10, v8
    v_cvt_pk_bf16_f32 v80, v64, v65
    v_lshlrev_b32 v66, 16, v25
    v_and_b32 v67, 0xffff0000, v25
    v_fma_f32 v66, v66, v10, v8
    v_fma_f32 v67, v67, v10, v8
    v_cvt_pk_bf16_f32 v82, v66, v67
    v_lshlrev_b32 v68, 16, v26
    v_and_b32 v69, 0xffff0000, v26
    v_fma_f32 v68, v68, v10, v8
    v_fma_f32 v69, v69, v10, v8
    v_cvt_pk_bf16_f32 v84, v68, v69
    v_lshlrev_b32 v70, 16, v27
    v_and_b32 v71, 0xffff0000, v27
    v_fma_f32 v70, v70, v10, v8
    v_fma_f32 v71, v71, v10, v8
    v_cvt_pk_bf16_f32 v86, v70, v71
    v_lshlrev_b32 v64, 16, v28
    v_and_b32 v65, 0xffff0000, v28
    v_fma_f32 v64, v64, v10, v8
    v_fma_f32 v65, v65, v10, v8
    v_cvt_pk_bf16_f32 v81, v64, v65
    v_lshlrev_b32 v66, 16, v29
    v_and_b32 v67, 0xffff0000, v29
    v_fma_f32 v66, v66, v10, v8
    v_fma_f32 v67, v67, v10, v8
    v_cvt_pk_bf16_f32 v83, v66, v67
    v_lshlrev_b32 v68, 16, v30
    v_and_b32 v69, 0xffff0000, v30
    v_fma_f32 v68, v68, v10, v8
    v_fma_f32 v69, v69, v10, v8
    v_cvt_pk_bf16_f32 v85, v68, v69
    v_lshlrev_b32 v70, 16, v31
    v_and_b32 v71, 0xffff0000, v31
    v_fma_f32 v70, v70, v10, v8
    v_fma_f32 v71, v71, v10, v8
    v_cvt_pk_bf16_f32 v87, v70, v71
    buffer_store_dwordx4 v[80:83], v2, s[8:11], s18 offen offset:0 sc1
    buffer_store_dwordx4 v[84:87], v2, s[8:11], s18 offen offset:512 sc1
    s_add_u32 s18, s18, 8192
    v_lshlrev_b32 v64, 16, v32
    v_and_b32 v65, 0xffff0000, v32
    v_fma_f32 v64, v64, v10, v8
    v_fma_f32 v65, v65, v10, v8
    v_cvt_pk_bf16_f32 v72, v64, v65
    v_lshlrev_b32 v66, 16, v33
    v_and_b32 v67, 0xffff0000, v33
    v_fma_f32 v66, v66, v10, v8
    v_fma_f32 v67, v67, v10, v8
    v_cvt_pk_bf16_f32 v74, v66, v67
    v_lshlrev_b32 v68, 16, v34
    v_and_b32 v69, 0xffff0000, v34
    v_fma_f32 v68, v68, v10, v8
    v_fma_f32 v69, v69, v10, v8
    v_cvt_pk_bf16_f32 v76, v68, v69
    v_lshlrev_b32 v70, 16, v35
    v_and_b32 v71, 0xffff0000, v35
    v_fma_f32 v70, v70, v10, v8
    v_fma_f32 v71, v71, v10, v8
    v_cvt_pk_bf16_f32 v78, v70, v71
    v_lshlrev_b32 v64, 16, v36
    v_and_b32 v65, 0xffff0000, v36
    v_fma_f32 v64, v64, v10, v8
    v_fma_f32 v65, v65, v10, v8
    v_cvt_pk_bf16_f32 v73, v64, v65
    v_lshlrev_b32 v66, 16, v37
    v_and_b32 v67, 0xffff0000, v37
    v_fma_f32 v66, v66, v10, v8
    v_fma_f32 v67, v67, v10, v8
    v_cvt_pk_bf16_f32 v75, v66, v67
    v_lshlrev_b32 v68, 16, v38
    v_and_b32 v69, 0xffff0000, v38
    v_fma_f32 v68, v68, v10, v8
    v_fma_f32 v69, v69, v10, v8
    v_cvt_pk_bf16_f32 v77, v68, v69
    v_lshlrev_b32 v70, 16, v39
    v_and_b32 v71, 0xffff0000, v39
    v_fma_f32 v70, v70, v10, v8
    v_fma_f32 v71, v71, v10, v8
    v_cvt_pk_bf16_f32 v79, v70, v71
    buffer_store_dwordx4 v[72:75], v2, s[8:11], s18 offen offset:0 sc1
    buffer_store_dwordx4 v[76:79], v2, s[8:11], s18 offen offset:512 sc1
    s_add_u32 s18, s18, 8192
    v_lshlrev_b32 v64, 16, v40
    v_and_b32 v65, 0xffff0000, v40
    v_fma_f32 v64, v64, v10, v8
    v_fma_f32 v65, v65, v10, v8
    v_cvt_pk_bf16_f32 v80, v64, v65
    v_lshlrev_b32 v66, 16, v41
    v_and_b32 v67, 0xffff0000, v41
    v_fma_f32 v66, v66, v10, v8
    v_fma_f32 v67, v67, v10, v8
    v_cvt_pk_bf16_f32 v82, v66, v67
    v_lshlrev_b32 v68, 16, v42
    v_and_b32 v69, 0xffff0000, v42
    v_fma_f32 v68, v68, v10, v8
    v_fma_f32 v69, v69, v10, v8
    v_cvt_pk_bf16_f32 v84, v68, v69
    v_lshlrev_b32 v70, 16, v43
    v_and_b32 v71, 0xffff0000, v43
    v_fma_f32 v70, v70, v10, v8
    v_fma_f32 v71, v71, v10, v8
    v_cvt_pk_bf16_f32 v86, v70, v71
    v_lshlrev_b32 v64, 16, v44
    v_and_b32 v65, 0xffff0000, v44
    v_fma_f32 v64, v64, v10, v8
    v_fma_f32 v65, v65, v10, v8
    v_cvt_pk_bf16_f32 v81, v64, v65
    v_lshlrev_b32 v66, 16, v45
    v_and_b32 v67, 0xffff0000, v45
    v_fma_f32 v66, v66, v10, v8
    v_fma_f32 v67, v67, v10, v8
    v_cvt_pk_bf16_f32 v83, v66, v67
    v_lshlrev_b32 v68, 16, v46
    v_and_b32 v69, 0xffff0000, v46
    v_fma_f32 v68, v68, v10, v8
    v_fma_f32 v69, v69, v10, v8
    v_cvt_pk_bf16_f32 v85, v68, v69
    v_lshlrev_b32 v70, 16, v47
    v_and_b32 v71, 0xffff0000, v47
    v_fma_f32 v70, v70, v10, v8
    v_fma_f32 v71, v71, v10, v8
    v_cvt_pk_bf16_f32 v87, v70, v71
    buffer_store_dwordx4 v[80:83], v2, s[8:11], s18 offen offset:0 sc1
    buffer_store_dwordx4 v[84:87], v2, s[8:11], s18 offen offset:512 sc1
    s_add_u32 s18, s18, 8192
    v_lshlrev_b32 v64, 16, v48
    v_and_b32 v65, 0xffff0000, v48
    v_fma_f32 v64, v64, v10, v8
    v_fma_f32 v65, v65, v10, v8
    v_cvt_pk_bf16_f32 v72, v64, v65
    v_lshlrev_b32 v66, 16, v49
    v_and_b32 v67, 0xffff0000, v49
    v_fma_f32 v66, v66, v10, v8
    v_fma_f32 v67, v67, v10, v8
    v_cvt_pk_bf16_f32 v74, v66, v67
    v_lshlrev_b32 v68, 16, v50
    v_and_b32 v69, 0xffff0000, v50
    v_fma_f32 v68, v68, v10, v8
    v_fma_f32 v69, v69, v10, v8
    v_cvt_pk_bf16_f32 v76, v68, v69
    v_lshlrev_b32 v70, 16, v51
    v_and_b32 v71, 0xffff0000, v51
    v_fma_f32 v70, v70, v10, v8
    v_fma_f32 v71, v71, v10, v8
    v_cvt_pk_bf16_f32 v78, v70, v71
    v_lshlrev_b32 v64, 16, v52
    v_and_b32 v65, 0xffff0000, v52
    v_fma_f32 v64, v64, v10, v8
    v_fma_f32 v65, v65, v10, v8
    v_cvt_pk_bf16_f32 v73, v64, v65
    v_lshlrev_b32 v66, 16, v53
    v_and_b32 v67, 0xffff0000, v53
    v_fma_f32 v66, v66, v10, v8
    v_fma_f32 v67, v67, v10, v8
    v_cvt_pk_bf16_f32 v75, v66, v67
    v_lshlrev_b32 v68, 16, v54
    v_and_b32 v69, 0xffff0000, v54
    v_fma_f32 v68, v68, v10, v8
    v_fma_f32 v69, v69, v10, v8
    v_cvt_pk_bf16_f32 v77, v68, v69
    v_lshlrev_b32 v70, 16, v55
    v_and_b32 v71, 0xffff0000, v55
    v_fma_f32 v70, v70, v10, v8
    v_fma_f32 v71, v71, v10, v8
    v_cvt_pk_bf16_f32 v79, v70, v71
    buffer_store_dwordx4 v[72:75], v2, s[8:11], s18 offen offset:0 sc1
    buffer_store_dwordx4 v[76:79], v2, s[8:11], s18 offen offset:512 sc1
    s_waitcnt vmcnt(0)
    s_lshl_b32 s17, s14, 4
    s_lshl_b32 s19, s13, 2
    s_add_u32 s17, s17, s19
    s_add_u32 s17, s17, s48
    s_add_u32 s17, s17, 45056
    v_mov_b32 v5, 0
    s_mov_b64 exec, 1
    buffer_store_dword v4, v5, s[8:11], s17 offen sc1
    s_mov_b64 exec, -1
    s_add_u32 s14, s14, 4
    s_cmp_lt_u32 s14, 64
    s_cbranch_scc1 layerb1_kernel_ln_seg
    s_waitcnt vmcnt(0)
    s_barrier
layerb1_kernel_w3:
    s_mov_b32 s15, 400000
    s_mov_b32 s43, 32768
layerb1_kernel_j_next:
    s_xor_b32 s43, s43, 4
    s_cmp_lg_u32 s13, 0
    s_cbranch_scc1 layerb1_kernel_j_rel
    s_mov_b64 exec, 1
    v_mov_b32 v2, 31744
    v_mov_b32 v3, 1
    buffer_atomic_add v3, v2, s[8:11], s48 offen sc0 sc1
    s_waitcnt vmcnt(0)
    s_mov_b64 exec, -1
    s_nop 0
    v_readfirstlane_b32 s38, v3
    s_cmp_ge_u32 s38, 1152
    s_cbranch_scc1 layerb1_kernel_j_pub
    s_mul_i32 s39, s38, 58255
    s_lshr_b32 s40, s39, 20
    s_mul_i32 s39, s40, 18
    s_sub_u32 s41, s38, s39
    s_add_u32 s42, s40, 1
    v_mov_b32 v4, s42
    v_lshlrev_b32 v2, 7, v0
    s_cmp_ge_u32 s41, 8
    s_cbranch_scc1 layerb1_kernel_j_dep_b
    s_lshl_b32 s24, s41, 9
    s_add_u32 s24, s24, 16384
    v_add_u32 v2, s24, v2
    s_mul_i32 s25, s41, 384
    s_add_u32 s26, s25, 10240
    v_writelane_b32 v2, s26, 4
    s_add_u32 s26, s25, 10368
    v_writelane_b32 v2, s26, 5
    s_add_u32 s26, s25, 10496
    v_writelane_b32 v2, s26, 6
    s_add_u32 s26, s25, 13312
    v_writelane_b32 v2, s26, 7
    s_add_u32 s26, s25, 13440
    v_writelane_b32 v2, s26, 8
    s_add_u32 s26, s25, 13568
    v_writelane_b32 v2, s26, 9
    s_mov_b64 exec, 0x3ff
    s_mov_b32 s44, 0xf
    s_branch layerb1_kernel_j_poll
layerb1_kernel_j_dep_b:
    s_sub_u32 s24, s41, 8
    s_lshl_b32 s24, s24, 10
    v_add_u32 v2, s24, v2
    v_cmp_gt_u32 vcc, 8, v0
    v_mov_b32 v5, 20480
    v_mov_b32 v6, -1024
    v_cndmask_b32 v5, v6, v5, vcc
    v_add_u32 v2, v5, v2
    s_lshl_b32 s25, s40, 7
    s_add_u32 s25, s25, 53184
    v_lshl_add_u32 v5, v0, 2, s25
    v_cmp_le_u32 vcc, 16, v0
    s_nop 1
    v_cndmask_b32 v2, v2, v5, vcc
    v_cndmask_b32 v4, v4, 1, vcc
    s_mov_b32 exec_lo, -1
    s_mov_b32 exec_hi, 0xffff
    s_mov_b32 s44, 0xffff00ff
layerb1_kernel_j_poll:
    buffer_load_dword v3, v2, s[8:11], s48 offen sc1
    s_waitcnt vmcnt(0)
    v_cmp_gt_u32 vcc, v4, v3
    s_sub_u32 s15, s15, 1
    s_cbranch_scc1 layerb1_kernel_j_giveup
    s_andn2_b32 s24, vcc_lo, s44
    s_cbranch_scc1 layerb1_kernel_j_poll
    s_mov_b64 exec, -1
    s_and_b32 s24, vcc_lo, s44
    s_or_b32 s25, s24, vcc_hi
    s_cselect_b32 s25, 0xf, 0
    s_cmp_ge_u32 s41, 8
    s_cselect_b32 s24, s25, s24
    s_lshl_b32 s24, s24, 11
    s_or_b32 s38, s38, s24
layerb1_kernel_j_pub:
    v_mov_b32 v2, s43
    v_mov_b32 v3, s38
    ds_write_b32 v2, v3
    s_waitcnt lgkmcnt(0)
layerb1_kernel_j_rel:
    s_barrier
    v_mov_b32 v2, s43
    ds_read_b32 v3, v2
    s_waitcnt lgkmcnt(0)
    v_readfirstlane_b32 s38, v3
    s_cmp_eq_u32 s38, -1
    s_cbranch_scc1 layerb1_kernel_j_done
    s_lshr_b32 s44, s38, 11
    s_and_b32 s38, s38, 0x7ff
    s_cmp_ge_u32 s38, 1152
    s_cbranch_scc1 layerb1_kernel_j_done
    s_lshr_b32 s44, s44, s13
    s_and_b32 s44, s44, 1
    s_mul_i32 s39, s38, 58255
    s_lshr_b32 s40, s39, 20
    s_mul_i32 s39, s40, 18
    s_sub_u32 s41, s38, s39
    s_add_u32 s42, s40, 1
    s_cmp_ge_u32 s41, 8
    s_cbranch_scc1 layerb1_kernel_j_b
    s_lshl_b32 s41, s41, 2
    s_add_u32 s41, s41, s13
    v_lshlrev_b32 v1, 4, v0
    v_and_b32 v2, 31, v0
    v_lshrrev_b32 v3, 5, v0
    s_lshl_b32 s24, s40, 5
    s_add_u32 s24, s24, s41
    s_mul_i32 s25, s24, 12288
    s_add_u32 s26, s25, 78643200
    s_add_u32 s27, s25, 53477376
    s_mul_i32 s28, s24, 3072
    s_add_u32 s28, s28, 208666624
    v_and_b32 v4, 7, v0
    v_lshlrev_b32 v4, 4, v4
    v_lshl_add_u32 v4, v3, 7, v4
    buffer_load_dwordx4 v[16:19], v1, s[8:11], s26 offen offset:0 sc1
    buffer_load_dwordx4 v[64:67], v1, s[8:11], s27 offen offset:0 sc1
    buffer_load_dwordx4 v[20:23], v1, s[8:11], s26 offen offset:1024 sc1
    buffer_load_dwordx4 v[68:71], v1, s[8:11], s27 offen offset:1024 sc1
    buffer_load_dwordx4 v[24:27], v1, s[8:11], s26 offen offset:2048 sc1
    buffer_load_dwordx4 v[72:75], v1, s[8:11], s27 offen offset:2048 sc1
    buffer_load_dwordx4 v[28:31], v1, s[8:11], s26 offen offset:3072 sc1
    buffer_load_dwordx4 v[76:79], v1, s[8:11], s27 offen offset:3072 sc1
    s_add_u32 s26, s26, 4096
    s_add_u32 s27, s27, 4096
    buffer_load_dwordx4 v[32:35], v1, s[8:11], s26 offen offset:0 sc1
    buffer_load_dwordx4 v[80:83], v1, s[8:11], s27 offen offset:0 sc1
    buffer_load_dwordx4 v[36:39], v1, s[8:11], s26 offen offset:1024 sc1
    buffer_load_dwordx4 v[84:87], v1, s[8:11], s27 offen offset:1024 sc1
    buffer_load_dwordx4 v[40:43], v1, s[8:11], s26 offen offset:2048 sc1
    buffer_load_dwordx4 v[88:91], v1, s[8:11], s27 offen offset:2048 sc1
    buffer_load_dwordx4 v[44:47], v1, s[8:11], s26 offen offset:3072 sc1
    buffer_load_dwordx4 v[92:95], v1, s[8:11], s27 offen offset:3072 sc1
    s_add_u32 s26, s26, 4096
    s_add_u32 s27, s27, 4096
    buffer_load_dwordx4 v[48:51], v1, s[8:11], s26 offen offset:0 sc1
    buffer_load_dwordx4 v[96:99], v1, s[8:11], s27 offen offset:0 sc1
    buffer_load_dwordx4 v[52:55], v1, s[8:11], s26 offen offset:1024 sc1
    buffer_load_dwordx4 v[100:103], v1, s[8:11], s27 offen offset:1024 sc1
    buffer_load_dwordx4 v[56:59], v1, s[8:11], s26 offen offset:2048 sc1
    buffer_load_dwordx4 v[104:107], v1, s[8:11], s27 offen offset:2048 sc1
    buffer_load_dwordx4 v[60:63], v1, s[8:11], s26 offen offset:3072 sc1
    buffer_load_dwordx4 v[108:111], v1, s[8:11], s27 offen offset:3072 sc1
    s_cmp_eq_u32 s44, 1
    s_cbranch_scc1 layerb1_kernel_w3a_nf
    buffer_load_dwordx4 v[112:115], v4, s[8:11], s28 offen offset:0 sc1
    buffer_load_dwordx4 v[116:119], v4, s[8:11], s28 offen offset:256 sc1
    buffer_load_dwordx4 v[120:123], v4, s[8:11], s28 offen offset:512 sc1
    buffer_load_dwordx4 v[124:127], v4, s[8:11], s28 offen offset:768 sc1
    buffer_load_dwordx4 v[128:131], v4, s[8:11], s28 offen offset:1024 sc1
    buffer_load_dwordx4 v[132:135], v4, s[8:11], s28 offen offset:1280 sc1
    buffer_load_dwordx4 v[136:139], v4, s[8:11], s28 offen offset:1536 sc1
    buffer_load_dwordx4 v[140:143], v4, s[8:11], s28 offen offset:1792 sc1
    buffer_load_dwordx4 v[144:147], v4, s[8:11], s28 offen offset:2048 sc1
    buffer_load_dwordx4 v[148:151], v4, s[8:11], s28 offen offset:2304 sc1
    buffer_load_dwordx4 v[152:155], v4, s[8:11], s28 offen offset:2560 sc1
    buffer_load_dwordx4 v[156:159], v4, s[8:11], s28 offen offset:2816 sc1
layerb1_kernel_w3a_nf:
    v_lshlrev_b32 v5, 2, v3
    v_sub_u32 v5, v2, v5
    v_mov_b32 v6, 0xf149f2ca
    v_cmp_gt_i32 vcc, 0, v5
    s_nop 1
    v_cndmask_b32 v192, 0, v6, vcc
    v_cmp_gt_i32 vcc, 1, v5
    s_nop 1
    v_cndmask_b32 v193, 0, v6, vcc
    v_cmp_gt_i32 vcc, 2, v5
    s_nop 1
    v_cndmask_b32 v194, 0, v6, vcc
    v_cmp_gt_i32 vcc, 3, v5
    s_nop 1
    v_cndmask_b32 v195, 0, v6, vcc
    v_cmp_gt_i32 vcc, 8, v5
    s_nop 1
    v_cndmask_b32 v196, 0, v6, vcc
    v_cmp_gt_i32 vcc, 9, v5
    s_nop 1
    v_cndmask_b32 v197, 0, v6, vcc
    v_cmp_gt_i32 vcc, 10, v5
    s_nop 1
    v_cndmask_b32 v198, 0, v6, vcc
    v_cmp_gt_i32 vcc, 11, v5
    s_nop 1
    v_cndmask_b32 v199, 0, v6, vcc
    v_cmp_gt_i32 vcc, 16, v5
    s_nop 1
    v_cndmask_b32 v200, 0, v6, vcc
    v_cmp_gt_i32 vcc, 17, v5
    s_nop 1
    v_cndmask_b32 v201, 0, v6, vcc
    v_cmp_gt_i32 vcc, 18, v5
    s_nop 1
    v_cndmask_b32 v202, 0, v6, vcc
    v_cmp_gt_i32 vcc, 19, v5
    s_nop 1
    v_cndmask_b32 v203, 0, v6, vcc
    v_cmp_gt_i32 vcc, 24, v5
    s_nop 1
    v_cndmask_b32 v204, 0, v6, vcc
    v_cmp_gt_i32 vcc, 25, v5
    s_nop 1
    v_cndmask_b32 v205, 0, v6, vcc
    v_cmp_gt_i32 vcc, 26, v5
    s_nop 1
    v_cndmask_b32 v206, 0, v6, vcc
    v_cmp_gt_i32 vcc, 27, v5
    s_nop 1
    v_cndmask_b32 v207, 0, v6, vcc
    s_waitcnt vmcnt(22)
    v_mfma_f32_32x32x16_bf16 v[160:175], v[64:67], v[16:19], 0
    s_waitcnt vmcnt(20)
    v_mfma_f32_32x32x16_bf16 v[160:175], v[68:71], v[20:23], v[160:175]
    s_waitcnt vmcnt(18)
    v_mfma_f32_32x32x16_bf16 v[160:175], v[72:75], v[24:27], v[160:175]
    s_waitcnt vmcnt(16)
    v_mfma_f32_32x32x16_bf16 v[160:175], v[76:79], v[28:31], v[160:175]
    s_waitcnt vmcnt(14)
    v_mfma_f32_32x32x16_bf16 v[160:175], v[80:83], v[32:35], v[160:175]
    s_waitcnt vmcnt(12)
    v_mfma_f32_32x32x16_bf16 v[160:175], v[84:87], v[36:39], v[160:175]
    s_waitcnt vmcnt(10)
    v_mfma_f32_32x32x16_bf16 v[160:175], v[88:91], v[40:43], v[160:175]
    s_waitcnt vmcnt(8)
    v_mfma_f32_32x32x16_bf16 v[160:175], v[92:95], v[44:47], v[160:175]
    s_waitcnt vmcnt(6)
    v_mfma_f32_32x32x16_bf16 v[160:175], v[96:99], v[48:51], v[160:175]
    s_waitcnt vmcnt(4)
    v_mfma_f32_32x32x16_bf16 v[160:175], v[100:103], v[52:55], v[160:175]
    s_waitcnt vmcnt(2)
    v_mfma_f32_32x32x16_bf16 v[160:175], v[104:107], v[56:59], v[160:175]
    s_waitcnt vmcnt(0)
    v_mfma_f32_32x32x16_bf16 v[160:175], v[108:111], v[60:63], v[160:175]
    s_cmp_eq_u32 s44, 0
    s_cbranch_scc1 layerb1_kernel_w3a_f
    s_lshl_b32 s31, s41, 7
    s_add_u32 s31, s31, 16384
    v_mov_b32 v212, s31
    v_mov_b32 v215, s42
    v_mov_b32 v214, -1
    s_mov_b32 exec_lo, 0x1
    s_mov_b32 exec_hi, 0x0
layerb1_kernel_j_la:
    buffer_load_dword v213, v212, s[8:11], s48 offen sc1
    s_waitcnt vmcnt(0)
    v_and_b32 v213, v213, v214
    v_cmp_gt_u32 vcc, v215, v213
    s_sub_u32 s15, s15, 1
    s_cbranch_scc1 layerb1_kernel_bail
    s_cbranch_vccnz layerb1_kernel_j_la
    s_mov_b64 exec, -1
    buffer_load_dwordx4 v[112:115], v4, s[8:11], s28 offen offset:0 sc1
    buffer_load_dwordx4 v[116:119], v4, s[8:11], s28 offen offset:256 sc1
    buffer_load_dwordx4 v[120:123], v4, s[8:11], s28 offen offset:512 sc1
    buffer_load_dwordx4 v[124:127], v4, s[8:11], s28 offen offset:768 sc1
    buffer_load_dwordx4 v[128:131], v4, s[8:11], s28 offen offset:1024 sc1
    buffer_load_dwordx4 v[132:135], v4, s[8:11], s28 offen offset:1280 sc1
    buffer_load_dwordx4 v[136:139], v4, s[8:11], s28 offen offset:1536 sc1
    buffer_load_dwordx4 v[140:143], v4, s[8:11], s28 offen offset:1792 sc1
    buffer_load_dwordx4 v[144:147], v4, s[8:11], s28 offen offset:2048 sc1
    buffer_load_dwordx4 v[148:151], v4, s[8:11], s28 offen offset:2304 sc1
    buffer_load_dwordx4 v[152:155], v4, s[8:11], s28 offen offset:2560 sc1
    buffer_load_dwordx4 v[156:159], v4, s[8:11], s28 offen offset:2816 sc1
layerb1_kernel_w3a_f:
    s_waitcnt vmcnt(11)
    v_mfma_f32_32x32x16_bf16 v[176:191], v[112:115], v[16:19], 0
    s_waitcnt vmcnt(10)
    v_mfma_f32_32x32x16_bf16 v[176:191], v[116:119], v[20:23], v[176:191]
    s_waitcnt vmcnt(9)
    v_mfma_f32_32x32x16_bf16 v[176:191], v[120:123], v[24:27], v[176:191]
    s_waitcnt vmcnt(8)
    v_mfma_f32_32x32x16_bf16 v[176:191], v[124:127], v[28:31], v[176:191]
    s_waitcnt vmcnt(7)
    v_mfma_f32_32x32x16_bf16 v[176:191], v[128:131], v[32:35], v[176:191]
    s_waitcnt vmcnt(6)
    v_mfma_f32_32x32x16_bf16 v[176:191], v[132:135], v[36:39], v[176:191]
    s_waitcnt vmcnt(5)
    v_mfma_f32_32x32x16_bf16 v[176:191], v[136:139], v[40:43], v[176:191]
    s_waitcnt vmcnt(4)
    v_mfma_f32_32x32x16_bf16 v[176:191], v[140:143], v[44:47], v[176:191]
    s_waitcnt vmcnt(3)
    v_mfma_f32_32x32x16_bf16 v[176:191], v[144:147], v[48:51], v[176:191]
    s_waitcnt vmcnt(2)
    v_mfma_f32_32x32x16_bf16 v[176:191], v[148:151], v[52:55], v[176:191]
    s_waitcnt vmcnt(1)
    v_mfma_f32_32x32x16_bf16 v[176:191], v[152:155], v[56:59], v[176:191]
    s_waitcnt vmcnt(0)
    v_mfma_f32_32x32x16_bf16 v[176:191], v[156:159], v[60:63], v[176:191]
    s_nop 7
    s_nop 7
    v_mov_b32 v7, 0x3dd53b95
    v_fma_f32 v160, v160, v7, v192
    v_fma_f32 v161, v161, v7, v193
    v_fma_f32 v162, v162, v7, v194
    v_fma_f32 v163, v163, v7, v195
    v_fma_f32 v164, v164, v7, v196
    v_fma_f32 v165, v165, v7, v197
    v_fma_f32 v166, v166, v7, v198
    v_fma_f32 v167, v167, v7, v199
    v_fma_f32 v168, v168, v7, v200
    v_fma_f32 v169, v169, v7, v201
    v_fma_f32 v170, v170, v7, v202
    v_fma_f32 v171, v171, v7, v203
    v_fma_f32 v172, v172, v7, v204
    v_fma_f32 v173, v173, v7, v205
    v_fma_f32 v174, v174, v7, v206
    v_fma_f32 v175, v175, v7, v207
    v_mul_f32 v176, v176, v7
    v_mul_f32 v177, v177, v7
    v_mul_f32 v178, v178, v7
    v_mul_f32 v179, v179, v7
    v_max3_f32 v208, v160, v161, v162
    v_max3_f32 v208, v208, v163, v164
    v_max3_f32 v208, v208, v165, v166
    v_max3_f32 v208, v208, v167, v168
    v_max3_f32 v208, v208, v169, v170
    v_max3_f32 v208, v208, v171, v172
    v_max3_f32 v208, v208, v173, v174
    v_max3_f32 v208, v208, v175, v176
    v_max3_f32 v208, v208, v177, v178
    v_max_f32 v208, v208, v179
    v_mov_b32 v209, v208
    s_nop 1
    v_permlane32_swap_b32 v208, v209
    v_max_f32 v208, v208, v209
    v_sub_f32 v160, v160, v208
    v_sub_f32 v161, v161, v208
    v_sub_f32 v162, v162, v208
    v_sub_f32 v163, v163, v208
    v_sub_f32 v164, v164, v208
    v_sub_f32 v165, v165, v208
    v_sub_f32 v166, v166, v208
    v_sub_f32 v167, v167, v208
    v_sub_f32 v168, v168, v208
    v_sub_f32 v169, v169, v208
    v_sub_f32 v170, v170, v208
    v_sub_f32 v171, v171, v208
    v_sub_f32 v172, v172, v208
    v_sub_f32 v173, v173, v208
    v_sub_f32 v174, v174, v208
    v_sub_f32 v175, v175, v208
    v_sub_f32 v176, v176, v208
    v_sub_f32 v177, v177, v208
    v_sub_f32 v178, v178, v208
    v_sub_f32 v179, v179, v208
    v_exp_f32 v160, v160
    v_exp_f32 v161, v161
    v_exp_f32 v162, v162
    v_exp_f32 v163, v163
    v_exp_f32 v164, v164
    v_exp_f32 v165, v165
    v_exp_f32 v166, v166
    v_exp_f32 v167, v167
    v_exp_f32 v168, v168
    v_exp_f32 v169, v169
    v_exp_f32 v170, v170
    v_exp_f32 v171, v171
    v_exp_f32 v172, v172
    v_exp_f32 v173, v173
    v_exp_f32 v174, v174
    v_exp_f32 v175, v175
    v_exp_f32 v176, v176
    v_exp_f32 v177, v177
    v_exp_f32 v178, v178
    v_exp_f32 v179, v179
    s_nop 0
    v_add_f32 v210, v160, v161
    v_add_f32 v210, v210, v162
    v_add_f32 v210, v210, v163
    v_add_f32 v210, v210, v164
    v_add_f32 v210, v210, v165
    v_add_f32 v210, v210, v166
    v_add_f32 v210, v210, v167
    v_add_f32 v210, v210, v168
    v_add_f32 v210, v210, v169
    v_add_f32 v210, v210, v170
    v_add_f32 v210, v210, v171
    v_add_f32 v210, v210, v172
    v_add_f32 v210, v210, v173
    v_add_f32 v210, v210, v174
    v_add_f32 v210, v210, v175
    v_add_f32 v210, v210, v176
    v_add_f32 v210, v210, v177
    v_add_f32 v210, v210, v178
    v_add_f32 v210, v210, v179
    v_mov_b32 v209, v210
    s_nop 1
    v_permlane32_swap_b32 v210, v209
    v_add_f32 v210, v210, v209
    v_rcp_f32 v210, v210
    s_nop 0
    v_mul_f32 v160, v160, v210
    v_mul_f32 v161, v161, v210
    v_mul_f32 v162, v162, v210
    v_mul_f32 v163, v163, v210
    v_mul_f32 v164, v164, v210
    v_mul_f32 v165, v165, v210
    v_mul_f32 v166, v166, v210
    v_mul_f32 v167, v167, v210
    v_mul_f32 v168, v168, v210
    v_mul_f32 v169, v169, v210
    v_mul_f32 v170, v170, v210
    v_mul_f32 v171, v171, v210
    v_mul_f32 v172, v172, v210
    v_mul_f32 v173, v173, v210
    v_mul_f32 v174, v174, v210
    v_mul_f32 v175, v175, v210
    v_mul_f32 v176, v176, v210
    v_mul_f32 v177, v177, v210
    v_mul_f32 v178, v178, v210
    v_mul_f32 v179, v179, v210
    s_mul_i32 s25, s40, 81920
    s_mul_i32 s26, s41, 2560
    s_add_u32 s25, s25, s26
    s_add_u32 s25, s25, 214958080
    v_cvt_pk_bf16_f32 v16, v160, v161
    v_cvt_pk_bf16_f32 v17, v162, v163
    v_cvt_pk_bf16_f32 v18, v164, v165
    v_cvt_pk_bf16_f32 v19, v166, v167
    s_nop 1
    v_permlane32_swap_b32 v16, v18
    v_permlane32_swap_b32 v17, v19
    buffer_store_dwordx4 v[16:19], v1, s[8:11], s25 offen offset:512 sc1
    v_cvt_pk_bf16_f32 v20, v168, v169
    v_cvt_pk_bf16_f32 v21, v170, v171
    v_cvt_pk_bf16_f32 v22, v172, v173
    v_cvt_pk_bf16_f32 v23, v174, v175
    s_nop 1
    v_permlane32_swap_b32 v20, v22
    v_permlane32_swap_b32 v21, v23
    buffer_store_dwordx4 v[20:23], v1, s[8:11], s25 offen offset:1536 sc1
    v_cvt_pk_bf16_f32 v24, v176, v177
    v_cvt_pk_bf16_f32 v25, v178, v179
    v_lshlrev_b32 v4, 4, v2
    v_lshl_add_u32 v4, v3, 3, v4
    buffer_store_dwordx2 v[24:25], v4, s[8:11], s25 offen sc1
    s_waitcnt vmcnt(0)
    s_mov_b64 exec, 1
    s_lshl_b32 s24, s40, 7
    s_lshl_b32 s25, s41, 2
    s_add_u32 s24, s24, s25
    s_add_u32 s24, s24, 53248
    v_mov_b32 v2, s24
    v_mov_b32 v3, 1
    buffer_store_dword v3, v2, s[8:11], s48 offen sc1
    s_mov_b64 exec, -1
    s_branch layerb1_kernel_j_next
layerb1_kernel_j_b:
    s_sub_u32 s41, s41, 8
    v_lshlrev_b32 v1, 4, v0
    v_and_b32 v2, 31, v0
    v_lshrrev_b32 v3, 5, v0
    v_lshrrev_b32 v4, 3, v2
    v_mul_u32_u24 v4, 20480, v4
    v_and_b32 v5, 7, v2
    v_lshl_add_u32 v4, v5, 4, v4
    v_lshl_add_u32 v4, v3, 7, v4
    s_mul_i32 s24, s40, 1638400
    s_mul_i32 s25, s41, 163840
    s_add_u32 s24, s24, s25
    s_mul_i32 s25, s13, 5120
    s_add_u32 s24, s24, s25
    s_add_u32 s24, s24, 103809024
    s_add_u32 s28, s24, 81920
    s_mul_i32 s25, s40, 81920
    s_mul_i32 s26, s13, 20480
    s_add_u32 s25, s25, s26
    s_add_u32 s25, s25, 214958080
    v_mul_u32_u24 v6, 1280, v2
    v_lshl_add_u32 v6, v3, 4, v6
    s_mul_i32 s26, s40, 40960
    s_lshl_b32 s27, s41, 7
    s_add_u32 s26, s26, s27
    s_lshl_b32 s27, s13, 5
    s_add_u32 s26, s26, s27
    s_add_u32 s27, s26, 226492416
    buffer_load_dwordx4 v[8:11], v6, s[8:11], s27 offen sc1
    s_add_u32 s29, s24, 4096
    s_add_u32 s30, s28, 4096
    s_mov_b32 exec_lo, 0
    s_mov_b32 exec_hi, -1
    buffer_load_dwordx4 a[0:3], v4, s[8:11], s24 offen offset:0 sc1
    buffer_load_dwordx4 a[80:83], v4, s[8:11], s28 offen offset:0 sc1
    s_mov_b64 exec, -1
    buffer_load_dwordx4 a[4:7], v4, s[8:11], s24 offen offset:256 sc1
    buffer_load_dwordx4 a[84:87], v4, s[8:11], s28 offen offset:256 sc1
    s_mov_b32 exec_lo, -1
    s_mov_b32 exec_hi, 0
    buffer_load_dwordx4 a[8:11], v4, s[8:11], s24 offen offset:512 sc1
    buffer_load_dwordx4 a[88:91], v4, s[8:11], s28 offen offset:512 sc1
    s_mov_b64 exec, -1
    buffer_load_dwordx4 a[12:15], v4, s[8:11], s24 offen offset:768 sc1
    buffer_load_dwordx4 a[92:95], v4, s[8:11], s28 offen offset:768 sc1
    buffer_load_dwordx4 a[16:19], v4, s[8:11], s24 offen offset:1024 sc1
    buffer_load_dwordx4 a[96:99], v4, s[8:11], s28 offen offset:1024 sc1
    s_mov_b32 exec_lo, 0
    s_mov_b32 exec_hi, -1
    buffer_load_dwordx4 a[20:23], v4, s[8:11], s24 offen offset:1280 sc1
    buffer_load_dwordx4 a[100:103], v4, s[8:11], s28 offen offset:1280 sc1
    s_mov_b64 exec, -1
    buffer_load_dwordx4 a[24:27], v4, s[8:11], s24 offen offset:1536 sc1
    buffer_load_dwordx4 a[104:107], v4, s[8:11], s28 offen offset:1536 sc1
    s_mov_b32 exec_lo, -1
    s_mov_b32 exec_hi, 0
    buffer_load_dwordx4 a[28:31], v4, s[8:11], s24 offen offset:1792 sc1
    buffer_load_dwordx4 a[108:111], v4, s[8:11], s28 offen offset:1792 sc1
    s_mov_b64 exec, -1
    buffer_load_dwordx4 a[32:35], v4, s[8:11], s24 offen offset:2048 sc1
    buffer_load_dwordx4 a[112:115], v4, s[8:11], s28 offen offset:2048 sc1
    buffer_load_dwordx4 a[36:39], v4, s[8:11], s24 offen offset:2304 sc1
    buffer_load_dwordx4 a[116:119], v4, s[8:11], s28 offen offset:2304 sc1
    s_mov_b32 exec_lo, 0
    s_mov_b32 exec_hi, -1
    buffer_load_dwordx4 a[40:43], v4, s[8:11], s24 offen offset:2560 sc1
    buffer_load_dwordx4 a[120:123], v4, s[8:11], s28 offen offset:2560 sc1
    s_mov_b64 exec, -1
    buffer_load_dwordx4 a[44:47], v4, s[8:11], s24 offen offset:2816 sc1
    buffer_load_dwordx4 a[124:127], v4, s[8:11], s28 offen offset:2816 sc1
    s_mov_b32 exec_lo, -1
    s_mov_b32 exec_hi, 0
    buffer_load_dwordx4 a[48:51], v4, s[8:11], s24 offen offset:3072 sc1
    buffer_load_dwordx4 a[128:131], v4, s[8:11], s28 offen offset:3072 sc1
    s_mov_b64 exec, -1
    buffer_load_dwordx4 a[52:55], v4, s[8:11], s24 offen offset:3328 sc1
    buffer_load_dwordx4 a[132:135], v4, s[8:11], s28 offen offset:3328 sc1
    buffer_load_dwordx4 a[56:59], v4, s[8:11], s24 offen offset:3584 sc1
    buffer_load_dwordx4 a[136:139], v4, s[8:11], s28 offen offset:3584 sc1
    s_mov_b32 exec_lo, 0
    s_mov_b32 exec_hi, -1
    buffer_load_dwordx4 a[60:63], v4, s[8:11], s24 offen offset:3840 sc1
    buffer_load_dwordx4 a[140:143], v4, s[8:11], s28 offen offset:3840 sc1
    s_mov_b64 exec, -1
    buffer_load_dwordx4 a[64:67], v4, s[8:11], s29 offen offset:0 sc1
    buffer_load_dwordx4 a[144:147], v4, s[8:11], s30 offen offset:0 sc1
    s_mov_b32 exec_lo, -1
    s_mov_b32 exec_hi, 0
    buffer_load_dwordx4 a[68:71], v4, s[8:11], s29 offen offset:256 sc1
    buffer_load_dwordx4 a[148:151], v4, s[8:11], s30 offen offset:256 sc1
    s_mov_b64 exec, -1
    buffer_load_dwordx4 a[72:75], v4, s[8:11], s29 offen offset:512 sc1
    buffer_load_dwordx4 a[152:155], v4, s[8:11], s30 offen offset:512 sc1
    buffer_load_dwordx4 a[76:79], v4, s[8:11], s29 offen offset:768 sc1
    buffer_load_dwordx4 a[156:159], v4, s[8:11], s30 offen offset:768 sc1
    s_cmp_eq_u32 s44, 0
    s_cbranch_scc1 layerb1_kernel_j_bf
    s_cmp_lg_u32 s13, 0
    s_cbranch_scc1 layerb1_kernel_j_bw
    s_lshl_b32 s31, s41, 10
    s_add_u32 s31, s31, 20480
    v_lshlrev_b32 v212, 7, v0
    v_add_u32 v212, s31, v212
    v_mov_b32 v215, s42
    v_mov_b32 v214, -1
    s_lshl_b32 s31, s40, 7
    s_add_u32 s31, s31, 53216
    v_lshl_add_u32 v213, v0, 2, s31
    v_cmp_le_u32 vcc, 8, v0
    s_nop 1
    v_cndmask_b32 v212, v212, v213, vcc
    v_cndmask_b32 v215, v215, 1, vcc
    s_mov_b32 exec_lo, 0xffffffff
    s_mov_b32 exec_hi, 0xff
layerb1_kernel_j_lb:
    buffer_load_dword v213, v212, s[8:11], s48 offen sc1
    s_waitcnt vmcnt(0)
    v_and_b32 v213, v213, v214
    v_cmp_gt_u32 vcc, v215, v213
    s_sub_u32 s15, s15, 1
    s_cbranch_scc1 layerb1_kernel_bail
    s_cbranch_vccnz layerb1_kernel_j_lb
    s_mov_b64 exec, -1
layerb1_kernel_j_bw:
    s_barrier
layerb1_kernel_j_bf:
    buffer_load_dwordx4 a[160:163], v1, s[8:11], s25 offen offset:0 sc1
    s_mov_b32 exec_lo, -1
    s_mov_b32 exec_hi, 0
    buffer_load_dwordx4 a[0:3], v4, s[8:11], s24 offen offset:0 sc1
    buffer_load_dwordx4 a[80:83], v4, s[8:11], s28 offen offset:0 sc1
    s_mov_b64 exec, -1
    buffer_load_dwordx4 a[164:167], v1, s[8:11], s25 offen offset:1024 sc1
    buffer_load_dwordx4 a[168:171], v1, s[8:11], s25 offen offset:2048 sc1
    s_mov_b32 exec_lo, 0
    s_mov_b32 exec_hi, -1
    buffer_load_dwordx4 a[8:11], v4, s[8:11], s24 offen offset:512 sc1
    buffer_load_dwordx4 a[88:91], v4, s[8:11], s28 offen offset:512 sc1
    s_mov_b64 exec, -1
    buffer_load_dwordx4 a[172:175], v1, s[8:11], s25 offen offset:3072 sc1
    s_add_u32 s25, s25, 4096
    buffer_load_dwordx4 a[176:179], v1, s[8:11], s25 offen offset:0 sc1
    buffer_load_dwordx4 a[180:183], v1, s[8:11], s25 offen offset:1024 sc1
    s_mov_b32 exec_lo, -1
    s_mov_b32 exec_hi, 0
    buffer_load_dwordx4 a[20:23], v4, s[8:11], s24 offen offset:1280 sc1
    buffer_load_dwordx4 a[100:103], v4, s[8:11], s28 offen offset:1280 sc1
    s_mov_b64 exec, -1
    buffer_load_dwordx4 a[184:187], v1, s[8:11], s25 offen offset:2048 sc1
    buffer_load_dwordx4 a[188:191], v1, s[8:11], s25 offen offset:3072 sc1
    s_mov_b32 exec_lo, 0
    s_mov_b32 exec_hi, -1
    buffer_load_dwordx4 a[28:31], v4, s[8:11], s24 offen offset:1792 sc1
    buffer_load_dwordx4 a[108:111], v4, s[8:11], s28 offen offset:1792 sc1
    s_mov_b64 exec, -1
    s_add_u32 s25, s25, 4096
    buffer_load_dwordx4 a[192:195], v1, s[8:11], s25 offen offset:0 sc1
    buffer_load_dwordx4 a[196:199], v1, s[8:11], s25 offen offset:1024 sc1
    buffer_load_dwordx4 a[200:203], v1, s[8:11], s25 offen offset:2048 sc1
    s_mov_b32 exec_lo, -1
    s_mov_b32 exec_hi, 0
    buffer_load_dwordx4 a[40:43], v4, s[8:11], s24 offen offset:2560 sc1
    buffer_load_dwordx4 a[120:123], v4, s[8:11], s28 offen offset:2560 sc1
    s_mov_b64 exec, -1
    buffer_load_dwordx4 a[204:207], v1, s[8:11], s25 offen offset:3072 sc1
    s_add_u32 s25, s25, 4096
    buffer_load_dwordx4 a[208:211], v1, s[8:11], s25 offen offset:0 sc1
    s_mov_b32 exec_lo, 0
    s_mov_b32 exec_hi, -1
    buffer_load_dwordx4 a[48:51], v4, s[8:11], s24 offen offset:3072 sc1
    buffer_load_dwordx4 a[128:131], v4, s[8:11], s28 offen offset:3072 sc1
    s_mov_b64 exec, -1
    buffer_load_dwordx4 a[212:215], v1, s[8:11], s25 offen offset:1024 sc1
    buffer_load_dwordx4 a[216:219], v1, s[8:11], s25 offen offset:2048 sc1
    buffer_load_dwordx4 a[220:223], v1, s[8:11], s25 offen offset:3072 sc1
    s_mov_b32 exec_lo, -1
    s_mov_b32 exec_hi, 0
    buffer_load_dwordx4 a[60:63], v4, s[8:11], s24 offen offset:3840 sc1
    buffer_load_dwordx4 a[140:143], v4, s[8:11], s28 offen offset:3840 sc1
    s_mov_b64 exec, -1
    s_add_u32 s25, s25, 4096
    buffer_load_dwordx4 a[224:227], v1, s[8:11], s25 offen offset:0 sc1
    buffer_load_dwordx4 a[228:231], v1, s[8:11], s25 offen offset:1024 sc1
    s_mov_b32 exec_lo, 0
    s_mov_b32 exec_hi, -1
    buffer_load_dwordx4 a[68:71], v4, s[8:11], s29 offen offset:256 sc1
    buffer_load_dwordx4 a[148:151], v4, s[8:11], s30 offen offset:256 sc1
    s_mov_b64 exec, -1
    buffer_load_dwordx4 a[232:235], v1, s[8:11], s25 offen offset:2048 sc1
    buffer_load_dwordx4 a[236:239], v1, s[8:11], s25 offen offset:3072 sc1
    s_nop 3
    s_waitcnt vmcnt(33)
    v_mfma_f32_32x32x16_bf16 v[16:31], a[0:3], a[160:163], 0
    v_mfma_f32_32x32x16_bf16 v[32:47], a[80:83], a[160:163], 0
    s_waitcnt vmcnt(32)
    v_mfma_f32_32x32x16_bf16 v[16:31], a[4:7], a[164:167], v[16:31]
    v_mfma_f32_32x32x16_bf16 v[32:47], a[84:87], a[164:167], v[32:47]
    s_waitcnt vmcnt(29)
    v_mfma_f32_32x32x16_bf16 v[16:31], a[8:11], a[168:171], v[16:31]
    v_mfma_f32_32x32x16_bf16 v[32:47], a[88:91], a[168:171], v[32:47]
    s_waitcnt vmcnt(28)
    v_mfma_f32_32x32x16_bf16 v[16:31], a[12:15], a[172:175], v[16:31]
    v_mfma_f32_32x32x16_bf16 v[32:47], a[92:95], a[172:175], v[32:47]
    s_waitcnt vmcnt(27)
    v_mfma_f32_32x32x16_bf16 v[16:31], a[16:19], a[176:179], v[16:31]
    v_mfma_f32_32x32x16_bf16 v[32:47], a[96:99], a[176:179], v[32:47]
    s_waitcnt vmcnt(24)
    v_mfma_f32_32x32x16_bf16 v[16:31], a[20:23], a[180:183], v[16:31]
    v_mfma_f32_32x32x16_bf16 v[32:47], a[100:103], a[180:183], v[32:47]
    s_waitcnt vmcnt(23)
    v_mfma_f32_32x32x16_bf16 v[16:31], a[24:27], a[184:187], v[16:31]
    v_mfma_f32_32x32x16_bf16 v[32:47], a[104:107], a[184:187], v[32:47]
    s_waitcnt vmcnt(20)
    v_mfma_f32_32x32x16_bf16 v[16:31], a[28:31], a[188:191], v[16:31]
    v_mfma_f32_32x32x16_bf16 v[32:47], a[108:111], a[188:191], v[32:47]
    s_waitcnt vmcnt(19)
    v_mfma_f32_32x32x16_bf16 v[16:31], a[32:35], a[192:195], v[16:31]
    v_mfma_f32_32x32x16_bf16 v[32:47], a[112:115], a[192:195], v[32:47]
    s_waitcnt vmcnt(18)
    v_mfma_f32_32x32x16_bf16 v[16:31], a[36:39], a[196:199], v[16:31]
    v_mfma_f32_32x32x16_bf16 v[32:47], a[116:119], a[196:199], v[32:47]
    s_waitcnt vmcnt(15)
    v_mfma_f32_32x32x16_bf16 v[16:31], a[40:43], a[200:203], v[16:31]
    v_mfma_f32_32x32x16_bf16 v[32:47], a[120:123], a[200:203], v[32:47]
    s_waitcnt vmcnt(14)
    v_mfma_f32_32x32x16_bf16 v[16:31], a[44:47], a[204:207], v[16:31]
    v_mfma_f32_32x32x16_bf16 v[32:47], a[124:127], a[204:207], v[32:47]
    s_waitcnt vmcnt(11)
    v_mfma_f32_32x32x16_bf16 v[16:31], a[48:51], a[208:211], v[16:31]
    v_mfma_f32_32x32x16_bf16 v[32:47], a[128:131], a[208:211], v[32:47]
    s_waitcnt vmcnt(10)
    v_mfma_f32_32x32x16_bf16 v[16:31], a[52:55], a[212:215], v[16:31]
    v_mfma_f32_32x32x16_bf16 v[32:47], a[132:135], a[212:215], v[32:47]
    s_waitcnt vmcnt(9)
    v_mfma_f32_32x32x16_bf16 v[16:31], a[56:59], a[216:219], v[16:31]
    v_mfma_f32_32x32x16_bf16 v[32:47], a[136:139], a[216:219], v[32:47]
    s_waitcnt vmcnt(6)
    v_mfma_f32_32x32x16_bf16 v[16:31], a[60:63], a[220:223], v[16:31]
    v_mfma_f32_32x32x16_bf16 v[32:47], a[140:143], a[220:223], v[32:47]
    s_waitcnt vmcnt(5)
    v_mfma_f32_32x32x16_bf16 v[16:31], a[64:67], a[224:227], v[16:31]
    v_mfma_f32_32x32x16_bf16 v[32:47], a[144:147], a[224:227], v[32:47]
    s_waitcnt vmcnt(2)
    v_mfma_f32_32x32x16_bf16 v[16:31], a[68:71], a[228:231], v[16:31]
    v_mfma_f32_32x32x16_bf16 v[32:47], a[148:151], a[228:231], v[32:47]
    s_waitcnt vmcnt(1)
    v_mfma_f32_32x32x16_bf16 v[16:31], a[72:75], a[232:235], v[16:31]
    v_mfma_f32_32x32x16_bf16 v[32:47], a[152:155], a[232:235], v[32:47]
    s_waitcnt vmcnt(0)
    v_mfma_f32_32x32x16_bf16 v[16:31], a[76:79], a[236:239], v[16:31]
    v_mfma_f32_32x32x16_bf16 v[32:47], a[156:159], a[236:239], v[32:47]
    s_lshl_b32 s27, s13, 11
    v_add_u32 v7, s27, v1
    s_nop 7
    s_nop 7
    ds_write_b128 v7, v[16:19] offset:0
    ds_write_b128 v7, v[20:23] offset:1024
    ds_write_b128 v7, v[24:27] offset:8192
    ds_write_b128 v7, v[28:31] offset:9216
    ds_write_b128 v7, v[32:35] offset:16384
    ds_write_b128 v7, v[36:39] offset:17408
    ds_write_b128 v7, v[40:43] offset:24576
    ds_write_b128 v7, v[44:47] offset:25600
    s_waitcnt lgkmcnt(0)
    s_barrier
    s_lshl_b32 s27, s13, 13
    v_add_u32 v7, s27, v1
    ds_read_b128 v[48:51], v7 offset:0
    ds_read_b128 v[52:55], v7 offset:1024
    ds_read_b128 v[56:59], v7 offset:2048
    ds_read_b128 v[60:63], v7 offset:3072
    ds_read_b128 v[64:67], v7 offset:4096
    ds_read_b128 v[68:71], v7 offset:5120
    ds_read_b128 v[72:75], v7 offset:6144
    ds_read_b128 v[76:79], v7 offset:7168
    s_waitcnt lgkmcnt(4)
    v_add_f32 v48, v48, v56
    v_add_f32 v49, v49, v57
    v_add_f32 v50, v50, v58
    v_add_f32 v51, v51, v59
    v_add_f32 v52, v52, v60
    v_add_f32 v53, v53, v61
    v_add_f32 v54, v54, v62
    v_add_f32 v55, v55, v63
    s_waitcnt lgkmcnt(0)
    v_add_f32 v64, v64, v72
    v_add_f32 v65, v65, v73
    v_add_f32 v66, v66, v74
    v_add_f32 v67, v67, v75
    v_add_f32 v68, v68, v76
    v_add_f32 v69, v69, v77
    v_add_f32 v70, v70, v78
    v_add_f32 v71, v71, v79
    v_add_f32 v48, v48, v64
    v_add_f32 v49, v49, v65
    v_add_f32 v50, v50, v66
    v_add_f32 v51, v51, v67
    v_add_f32 v52, v52, v68
    v_add_f32 v53, v53, v69
    v_add_f32 v54, v54, v70
    v_add_f32 v55, v55, v71
    v_cvt_pk_bf16_f32 v16, v48, v49
    v_cvt_pk_bf16_f32 v17, v50, v51
    v_cvt_pk_bf16_f32 v18, v52, v53
    v_cvt_pk_bf16_f32 v19, v54, v55
    s_nop 1
    v_permlane32_swap_b32 v16, v18
    v_permlane32_swap_b32 v17, v19
    s_nop 1
    v_lshlrev_b32 v48, 16, v16
    v_and_b32 v49, 0xffff0000, v16
    v_lshlrev_b32 v50, 16, v8
    v_and_b32 v51, 0xffff0000, v8
    v_add_f32 v48, v48, v50
    v_add_f32 v49, v49, v51
    v_cvt_pk_bf16_f32 v16, v48, v49
    v_lshlrev_b32 v48, 16, v17
    v_and_b32 v49, 0xffff0000, v17
    v_lshlrev_b32 v50, 16, v9
    v_and_b32 v51, 0xffff0000, v9
    v_add_f32 v48, v48, v50
    v_add_f32 v49, v49, v51
    v_cvt_pk_bf16_f32 v17, v48, v49
    v_lshlrev_b32 v48, 16, v18
    v_and_b32 v49, 0xffff0000, v18
    v_lshlrev_b32 v50, 16, v10
    v_and_b32 v51, 0xffff0000, v10
    v_add_f32 v48, v48, v50
    v_add_f32 v49, v49, v51
    v_cvt_pk_bf16_f32 v18, v48, v49
    v_lshlrev_b32 v48, 16, v19
    v_and_b32 v49, 0xffff0000, v19
    v_lshlrev_b32 v50, 16, v11
    v_and_b32 v51, 0xffff0000, v11
    v_add_f32 v48, v48, v50
    v_add_f32 v49, v49, v51
    v_cvt_pk_bf16_f32 v19, v48, v49
    buffer_store_dwordx4 v[16:19], v6, s[84:87], s26 offen
    s_branch layerb1_kernel_j_next
layerb1_kernel_j_giveup:
    s_mov_b64 exec, -1
    v_mov_b32 v2, s43
    v_mov_b32 v3, -1
    ds_write_b32 v2, v3
    s_waitcnt lgkmcnt(0)
    s_barrier
    s_branch layerb1_kernel_bail
layerb1_kernel_j_done:
    s_branch layerb1_kernel_end
layerb1_kernel_bail:
    s_mov_b64 exec, 1
    s_load_dwordx2 s[6:7], s[0:1], 88
    s_waitcnt lgkmcnt(0)
    s_mov_b32 s24, s6
    s_mov_b32 s25, s7
    s_mov_b32 s26, 256
    s_mov_b32 s27, 0x00020000
    v_mov_b32 v1, 0xdead
    v_mov_b32 v2, s14
    v_mov_b32 v3, 0
    buffer_store_dword v1, v3, s[24:27], 0 offen
    buffer_store_dword v2, v3, s[24:27], 0 offen offset:4
layerb1_kernel_end:
layerb1_kernel_end0:
    s_endpgm
.section .rodata,"a"
.p2align 6
.amdhsa_kernel layerb1_kernel
  .amdhsa_next_free_vgpr 512
  .amdhsa_next_free_sgpr 100
  .amdhsa_accum_offset 256
  .amdhsa_group_segment_fixed_size 0
  .amdhsa_kernarg_size 104
  .amdhsa_user_sgpr_count 2
  .amdhsa_user_sgpr_kernarg_segment_ptr 1
  .amdhsa_system_sgpr_workgroup_id_x 1
.end_amdhsa_kernel
```

```asm
; @launch kernel=prep_kernel grid=(736,1,1) block=(256,1,1) lds=49152
; @launch kernel=layerb1_kernel grid=(256,1,1) block=(256,1,1) lds=149760
; @launch kernel=layerb2_kernel grid=(256,1,1) block=(256,1,1) lds=149760
.amdgcn_target "amdgcn-amd-amdhsa--gfx950"
.text
.globl prep_kernel
.p2align 8
.type prep_kernel,@function
prep_kernel:
    s_cmp_ge_u32 s2, 736
    s_cbranch_scc1 prep_kernel_end
    s_load_dwordx2 s[4:5], s[0:1], 96
    v_lshrrev_b32 v1, 6, v0
    v_and_b32 v0, 63, v0
    s_nop 0
    v_readfirstlane_b32 s13, v1
    s_waitcnt lgkmcnt(0)
    s_mov_b32 s8, s4
    s_mov_b32 s9, s5
    s_mov_b32 s10, 268435456
    s_mov_b32 s11, 0x00020000
    s_cmp_ge_u32 s2, 64
    s_cbranch_scc1 prep_kernel_ord1
    s_sub_u32 s20, s2, 0
    s_branch prep_kernel_r_pwa
prep_kernel_ord1:
    s_cmp_ge_u32 s2, 65
    s_cbranch_scc1 prep_kernel_ord2
    s_sub_u32 s20, s2, 64
    s_branch prep_kernel_r_zero
prep_kernel_ord2:
    s_cmp_ge_u32 s2, 72
    s_cbranch_scc1 prep_kernel_ord3
    s_sub_u32 s20, s2, 65
    s_branch prep_kernel_r_pad
prep_kernel_ord3:
    s_cmp_ge_u32 s2, 112
    s_cbranch_scc1 prep_kernel_ord4
    s_sub_u32 s20, s2, 72
    s_branch prep_kernel_r_pwo
prep_kernel_ord4:
    s_cmp_ge_u32 s2, 432
    s_cbranch_scc1 prep_kernel_ord5
    s_sub_u32 s20, s2, 112
    s_branch prep_kernel_r_wvx
prep_kernel_ord5:
    s_cmp_ge_u32 s2, 672
    s_cbranch_scc1 prep_kernel_ord6
    s_sub_u32 s20, s2, 432
    s_branch prep_kernel_r_pwp
prep_kernel_ord6:
    s_cmp_ge_u32 s2, 736
    s_cbranch_scc1 prep_kernel_ord7
    s_sub_u32 s20, s2, 672
    s_branch prep_kernel_r_clr
prep_kernel_ord7:
prep_kernel_r_pad:
    s_branch prep_kernel_end
prep_kernel_r_wvx:
    s_lshr_b32 s21, s20, 3
    s_mul_i32 s22, s21, 6554
    s_lshr_b32 s22, s22, 16
    s_mul_i32 s23, s22, 10
    s_sub_u32 s21, s21, s23
    s_lshl_b32 s22, s22, 3
    s_and_b32 s20, s20, 7
    s_add_u32 s20, s20, s22
    s_mul_i32 s20, s20, 10
    s_add_u32 s20, s20, s21
    s_branch prep_kernel_r_wvo
    s_mov_b32 s20, s2
    s_cmp_lt_u32 s2, 4
    s_cbranch_scc1 prep_kernel_r_cal
    s_cmp_eq_u32 s2, 4
    s_cbranch_scc1 prep_kernel_r_zero
    s_sub_u32 s20, s2, 5
    s_cmp_lt_u32 s20, 64
    s_cbranch_scc1 prep_kernel_r_pwa
    s_sub_u32 s20, s20, 64
    s_cmp_lt_u32 s20, 40
    s_cbranch_scc1 prep_kernel_r_pwo
    s_sub_u32 s20, s20, 40
    s_cmp_lt_u32 s20, 320
    s_cbranch_scc1 prep_kernel_r_wvo
    s_sub_u32 s20, s20, 320
    s_cmp_lt_u32 s20, 240
    s_cbranch_scc1 prep_kernel_r_pwp
    s_sub_u32 s20, s20, 240
prep_kernel_r_clr:
    s_sub_u32 s21, 0, s4
    s_and_b32 s21, s21, 0x1fffff
    s_mul_i32 s22, s20, 131072
    s_add_u32 s21, s21, s22
    s_lshl_b32 s22, s13, 10
    s_add_u32 s21, s21, s22
    v_lshlrev_b32 v1, 4, v0
    v_mov_b32 v4, -1
    v_mov_b32 v5, -1
    v_mov_b32 v6, -1
    v_mov_b32 v7, -1
    s_mov_b32 s22, 32
prep_kernel_clr_loop:
    buffer_store_dwordx4 v[4:7], v1, s[8:11], s21 offen
    s_add_u32 s21, s21, 4096
    s_sub_u32 s22, s22, 1
    s_cmp_lg_u32 s22, 0
    s_cbranch_scc1 prep_kernel_clr_loop
    s_mul_i32 s21, s20, 98304
    s_add_u32 s21, s21, 208666624
    s_lshl_b32 s22, s13, 10
    s_add_u32 s21, s21, s22
    s_mov_b32 s22, 24
prep_kernel_clr_loop0:
    buffer_store_dwordx4 v[4:7], v1, s[8:11], s21 offen
    s_add_u32 s21, s21, 4096
    s_sub_u32 s22, s22, 1
    s_cmp_lg_u32 s22, 0
    s_cbranch_scc1 prep_kernel_clr_loop0
    s_mul_i32 s21, s20, 81920
    s_add_u32 s21, s21, 214958080
    s_lshl_b32 s22, s13, 10
    s_add_u32 s21, s21, s22
    s_mov_b32 s22, 20
prep_kernel_clr_loop1:
    buffer_store_dwordx4 v[4:7], v1, s[8:11], s21 offen
    s_add_u32 s21, s21, 4096
    s_sub_u32 s22, s22, 1
    s_cmp_lg_u32 s22, 0
    s_cbranch_scc1 prep_kernel_clr_loop1
    s_branch prep_kernel_end
prep_kernel_r_cal:
    s_branch prep_kernel_end
    s_cmp_lg_u32 s13, 0
    s_cbranch_scc1 prep_kernel_end
    s_sub_u32 s22, 0, s4
    s_and_b32 s22, s22, 0x1fffff
    s_getreg_b32 s23, hwreg(HW_REG_XCC_ID)
    s_bfe_u32 s23, s23, 0x10002
    s_mov_b64 exec, 1
    v_mov_b32 v1, 0
    s_mul_i32 s24, s20, 2097152
    s_add_u32 s22, s22, s24
    s_add_u32 s22, s22, 2086912
    s_mov_b32 s30, -1
    s_mov_b32 s31, -1
    s_mov_b32 s25, 8
    v_mov_b32 v2, 0
prep_kernel_cal:
    s_and_b32 s24, s25, 15
    s_lshl_b32 s24, s24, 7
    s_add_u32 s24, s24, s22
    s_memtime s[26:27]
    s_waitcnt lgkmcnt(0)
    buffer_atomic_add v2, v1, s[8:11], s24 offen sc0 sc1
    s_waitcnt vmcnt(0)
    s_memtime s[28:29]
    v_mov_b32 v2, 0
    s_waitcnt lgkmcnt(0)
    s_sub_u32 s26, s28, s26
    s_min_u32 s30, s30, s26
    s_and_b32 s24, s25, 15
    s_lshl_b32 s24, s24, 7
    s_add_u32 s24, s24, s22
    s_add_u32 s24, s24, 8192
    s_memtime s[26:27]
    s_waitcnt lgkmcnt(0)
    buffer_atomic_add v2, v1, s[8:11], s24 offen sc0 sc1
    s_waitcnt vmcnt(0)
    s_memtime s[28:29]
    v_mov_b32 v2, 0
    s_waitcnt lgkmcnt(0)
    s_sub_u32 s26, s28, s26
    s_min_u32 s31, s31, s26
    s_sub_u32 s25, s25, 1
    s_cmp_lg_u32 s25, 0
    s_cbranch_scc1 prep_kernel_cal
    s_cmp_lt_u32 s31, s30
    s_cselect_b32 s24, 1, 0
    s_xor_b32 s24, s24, s23
    s_lshl_b32 s24, s24, 13
    v_mov_b32 v3, s24
    s_lshl_b32 s25, s20, 2
    s_add_u32 s25, s25, 10551296
    buffer_store_dword v3, v1, s[8:11], s25 offen
    s_lshl_b32 s26, s30, 16
    s_or_b32 s26, s26, s31
    v_mov_b32 v3, s26
    buffer_store_dword v3, v1, s[8:11], s25 offen offset:64
    s_branch prep_kernel_end
prep_kernel_r_zero:
    v_lshlrev_b32 v1, 4, v0
    v_mov_b32 v4, 0
    v_mov_b32 v5, 0
    v_mov_b32 v6, 0
    v_mov_b32 v7, 0
    s_lshl_b32 s21, s13, 10
    s_add_u32 s21, s21, 10485760
    buffer_store_dwordx4 v[4:7], v1, s[8:11], s21 offen
    s_lshl_b32 s21, s13, 15
    s_add_u32 s21, s21, 10616832
    buffer_store_dwordx4 v[4:7], v1, s[8:11], s21 offen offset:0
    buffer_store_dwordx4 v[4:7], v1, s[8:11], s21 offen offset:1024
    buffer_store_dwordx4 v[4:7], v1, s[8:11], s21 offen offset:2048
    buffer_store_dwordx4 v[4:7], v1, s[8:11], s21 offen offset:3072
    s_add_u32 s21, s21, 4096
    buffer_store_dwordx4 v[4:7], v1, s[8:11], s21 offen offset:0
    buffer_store_dwordx4 v[4:7], v1, s[8:11], s21 offen offset:1024
    buffer_store_dwordx4 v[4:7], v1, s[8:11], s21 offen offset:2048
    buffer_store_dwordx4 v[4:7], v1, s[8:11], s21 offen offset:3072
    s_add_u32 s21, s21, 4096
    buffer_store_dwordx4 v[4:7], v1, s[8:11], s21 offen offset:0
    buffer_store_dwordx4 v[4:7], v1, s[8:11], s21 offen offset:1024
    buffer_store_dwordx4 v[4:7], v1, s[8:11], s21 offen offset:2048
    buffer_store_dwordx4 v[4:7], v1, s[8:11], s21 offen offset:3072
    s_add_u32 s21, s21, 4096
    buffer_store_dwordx4 v[4:7], v1, s[8:11], s21 offen offset:0
    buffer_store_dwordx4 v[4:7], v1, s[8:11], s21 offen offset:1024
    buffer_store_dwordx4 v[4:7], v1, s[8:11], s21 offen offset:2048
    buffer_store_dwordx4 v[4:7], v1, s[8:11], s21 offen offset:3072
    s_add_u32 s21, s21, 4096
    buffer_store_dwordx4 v[4:7], v1, s[8:11], s21 offen offset:0
    buffer_store_dwordx4 v[4:7], v1, s[8:11], s21 offen offset:1024
    buffer_store_dwordx4 v[4:7], v1, s[8:11], s21 offen offset:2048
    buffer_store_dwordx4 v[4:7], v1, s[8:11], s21 offen offset:3072
    s_add_u32 s21, s21, 4096
    buffer_store_dwordx4 v[4:7], v1, s[8:11], s21 offen offset:0
    buffer_store_dwordx4 v[4:7], v1, s[8:11], s21 offen offset:1024
    buffer_store_dwordx4 v[4:7], v1, s[8:11], s21 offen offset:2048
    buffer_store_dwordx4 v[4:7], v1, s[8:11], s21 offen offset:3072
    s_add_u32 s21, s21, 4096
    buffer_store_dwordx4 v[4:7], v1, s[8:11], s21 offen offset:0
    buffer_store_dwordx4 v[4:7], v1, s[8:11], s21 offen offset:1024
    buffer_store_dwordx4 v[4:7], v1, s[8:11], s21 offen offset:2048
    buffer_store_dwordx4 v[4:7], v1, s[8:11], s21 offen offset:3072
    s_add_u32 s21, s21, 4096
    buffer_store_dwordx4 v[4:7], v1, s[8:11], s21 offen offset:0
    buffer_store_dwordx4 v[4:7], v1, s[8:11], s21 offen offset:1024
    buffer_store_dwordx4 v[4:7], v1, s[8:11], s21 offen offset:2048
    buffer_store_dwordx4 v[4:7], v1, s[8:11], s21 offen offset:3072
    s_add_u32 s21, s21, 4096
    s_lshl_b32 s21, s13, 15
    s_add_u32 s21, s21, 10747904
    buffer_store_dwordx4 v[4:7], v1, s[8:11], s21 offen offset:0
    buffer_store_dwordx4 v[4:7], v1, s[8:11], s21 offen offset:1024
    buffer_store_dwordx4 v[4:7], v1, s[8:11], s21 offen offset:2048
    buffer_store_dwordx4 v[4:7], v1, s[8:11], s21 offen offset:3072
    s_add_u32 s21, s21, 4096
    buffer_store_dwordx4 v[4:7], v1, s[8:11], s21 offen offset:0
    buffer_store_dwordx4 v[4:7], v1, s[8:11], s21 offen offset:1024
    buffer_store_dwordx4 v[4:7], v1, s[8:11], s21 offen offset:2048
    buffer_store_dwordx4 v[4:7], v1, s[8:11], s21 offen offset:3072
    s_add_u32 s21, s21, 4096
    buffer_store_dwordx4 v[4:7], v1, s[8:11], s21 offen offset:0
    buffer_store_dwordx4 v[4:7], v1, s[8:11], s21 offen offset:1024
    buffer_store_dwordx4 v[4:7], v1, s[8:11], s21 offen offset:2048
    buffer_store_dwordx4 v[4:7], v1, s[8:11], s21 offen offset:3072
    s_add_u32 s21, s21, 4096
    buffer_store_dwordx4 v[4:7], v1, s[8:11], s21 offen offset:0
    buffer_store_dwordx4 v[4:7], v1, s[8:11], s21 offen offset:1024
    buffer_store_dwordx4 v[4:7], v1, s[8:11], s21 offen offset:2048
    buffer_store_dwordx4 v[4:7], v1, s[8:11], s21 offen offset:3072
    s_add_u32 s21, s21, 4096
    buffer_store_dwordx4 v[4:7], v1, s[8:11], s21 offen offset:0
    buffer_store_dwordx4 v[4:7], v1, s[8:11], s21 offen offset:1024
    buffer_store_dwordx4 v[4:7], v1, s[8:11], s21 offen offset:2048
    buffer_store_dwordx4 v[4:7], v1, s[8:11], s21 offen offset:3072
    s_add_u32 s21, s21, 4096
    buffer_store_dwordx4 v[4:7], v1, s[8:11], s21 offen offset:0
    buffer_store_dwordx4 v[4:7], v1, s[8:11], s21 offen offset:1024
    buffer_store_dwordx4 v[4:7], v1, s[8:11], s21 offen offset:2048
    buffer_store_dwordx4 v[4:7], v1, s[8:11], s21 offen offset:3072
    s_add_u32 s21, s21, 4096
    buffer_store_dwordx4 v[4:7], v1, s[8:11], s21 offen offset:0
    buffer_store_dwordx4 v[4:7], v1, s[8:11], s21 offen offset:1024
    buffer_store_dwordx4 v[4:7], v1, s[8:11], s21 offen offset:2048
    buffer_store_dwordx4 v[4:7], v1, s[8:11], s21 offen offset:3072
    s_add_u32 s21, s21, 4096
    buffer_store_dwordx4 v[4:7], v1, s[8:11], s21 offen offset:0
    buffer_store_dwordx4 v[4:7], v1, s[8:11], s21 offen offset:1024
    buffer_store_dwordx4 v[4:7], v1, s[8:11], s21 offen offset:2048
    buffer_store_dwordx4 v[4:7], v1, s[8:11], s21 offen offset:3072
    s_add_u32 s21, s21, 4096
    s_branch prep_kernel_end
prep_kernel_r_wvo:
    s_load_dwordx2 s[24:25], s[0:1], 56
    s_load_dwordx2 s[26:27], s[0:1], 64
    s_mul_i32 s23, s20, 6554
    s_lshr_b32 s23, s23, 16
    s_mul_i32 s28, s23, 10
    s_sub_u32 s22, s20, s28
    s_and_b32 s21, s22, 1
    s_lshr_b32 s22, s22, 1
    s_waitcnt lgkmcnt(0)
    s_mov_b32 s32, s24
    s_mov_b32 s33, s25
    s_mov_b32 s34, 7864320
    s_mov_b32 s35, 0x00020000
    s_mov_b32 s36, s26
    s_mov_b32 s37, s27
    s_mov_b32 s38, 7864320
    s_mov_b32 s39, 0x00020000
    v_and_b32 v1, 31, v0
    v_lshrrev_b32 v2, 5, v0
    v_lshrrev_b32 v11, 3, v0
    v_mul_u32_u24 v3, 1280, v11
    v_bfe_u32 v12, v0, 4, 1
    v_lshlrev_b32 v12, 2, v12
    v_and_b32 v13, 7, v0
    v_xor_b32 v13, v13, v12
    v_lshl_add_u32 v3, v13, 4, v3
    s_mul_i32 s28, s23, 192
    s_mul_i32 s29, s13, 48
    s_add_u32 s28, s28, s29
    s_mul_i32 s28, s28, 1280
    s_mul_i32 s29, s21, 640
    s_add_u32 s28, s28, s29
    s_mul_i32 s29, s13, 6144
    v_bfe_u32 v11, v0, 2, 2
    v_lshl_add_u32 v12, v2, 3, v11
    v_lshlrev_b32 v12, 7, v12
    v_bfe_u32 v13, v0, 4, 1
    v_lshlrev_b32 v13, 1, v13
    v_bfe_u32 v14, v0, 1, 1
    v_add_u32 v13, v13, v14
    v_lshl_add_u32 v12, v13, 4, v12
    v_and_b32 v13, 1, v0
    v_lshl_add_u32 v12, v13, 3, v12
    v_bfe_u32 v13, v0, 3, 1
    v_lshl_add_u32 v4, v13, 6, v12
    v_xor_b32 v13, 1, v13
    v_lshl_add_u32 v5, v13, 6, v12
    v_lshrrev_b32 v6, 3, v1
    v_lshrrev_b32 v7, 2, v6
    v_lshlrev_b32 v7, 5, v7
    v_and_b32 v8, 2, v6
    v_lshl_add_u32 v7, v8, 3, v7
    v_and_b32 v8, 1, v6
    v_lshl_add_u32 v7, v8, 2, v7
    v_and_b32 v8, 7, v1
    v_and_b32 v9, 1, v8
    v_add_u32 v7, v7, v9
    v_and_b32 v9, 2, v8
    v_lshl_add_u32 v7, v9, 2, v7
    v_lshrrev_b32 v9, 2, v8
    v_lshl_add_u32 v7, v9, 1, v7
    v_mul_u32_u24 v7, 12288, v7
    v_lshl_add_u32 v7, v2, 4, v7
    s_lshl_b32 s30, s22, 2
    s_add_u32 s30, s30, s13
    s_mul_i32 s31, s30, 393216
    s_mul_i32 s40, s23, 384
    s_add_u32 s31, s31, s40
    v_lshrrev_b32 v10, 3, v1
    v_mul_u32_u24 v10, 20480, v10
    v_lshlrev_b32 v10, 4, v10
    v_and_b32 v11, 7, v1
    v_lshl_add_u32 v10, v11, 4, v10
    v_lshl_add_u32 v10, v2, 8, v10
    s_mul_i32 s41, s21, 13107200
    s_lshr_b32 s40, s23, 3
    s_mul_i32 s40, s40, 81920
    s_add_u32 s41, s41, s40
    s_and_b32 s40, s23, 3
    s_mul_i32 s40, s40, 20480
    s_add_u32 s41, s41, s40
    s_bfe_u32 s40, s23, 0x10002
    s_lshl_b32 s40, s40, 7
    s_add_u32 s41, s41, s40
    s_lshl_b32 s40, s30, 10
    s_add_u32 s41, s41, s40
    s_add_u32 s41, s41, 27262976
    buffer_load_dwordx4 v[16:19], v7, s[32:35], s31 offen offset:0
    buffer_load_dwordx4 v[20:23], v7, s[32:35], s31 offen offset:32
    buffer_load_dwordx4 v[24:27], v7, s[32:35], s31 offen offset:64
    buffer_load_dwordx4 v[28:31], v7, s[32:35], s31 offen offset:96
    buffer_load_dwordx4 v[32:35], v7, s[32:35], s31 offen offset:128
    buffer_load_dwordx4 v[36:39], v7, s[32:35], s31 offen offset:160
    buffer_load_dwordx4 v[40:43], v7, s[32:35], s31 offen offset:192
    buffer_load_dwordx4 v[44:47], v7, s[32:35], s31 offen offset:224
    buffer_load_dwordx4 v[48:51], v7, s[32:35], s31 offen offset:256
    buffer_load_dwordx4 v[52:55], v7, s[32:35], s31 offen offset:288
    buffer_load_dwordx4 v[56:59], v7, s[32:35], s31 offen offset:320
    buffer_load_dwordx4 v[60:63], v7, s[32:35], s31 offen offset:352
    s_add_u32 s42, s29, 0
    s_mov_b32 m0, s42
    s_add_u32 s43, s28, 0
    buffer_load_dwordx4 v3, s[36:39], s43 offen lds
    s_add_u32 s42, s29, 1024
    s_mov_b32 m0, s42
    s_add_u32 s43, s28, 10240
    buffer_load_dwordx4 v3, s[36:39], s43 offen lds
    s_add_u32 s42, s29, 2048
    s_mov_b32 m0, s42
    s_add_u32 s43, s28, 20480
    buffer_load_dwordx4 v3, s[36:39], s43 offen lds
    s_add_u32 s42, s29, 3072
    s_mov_b32 m0, s42
    s_add_u32 s43, s28, 30720
    buffer_load_dwordx4 v3, s[36:39], s43 offen lds
    s_add_u32 s42, s29, 4096
    s_mov_b32 m0, s42
    s_add_u32 s43, s28, 40960
    buffer_load_dwordx4 v3, s[36:39], s43 offen lds
    s_add_u32 s42, s29, 5120
    s_mov_b32 m0, s42
    s_add_u32 s43, s28, 51200
    buffer_load_dwordx4 v3, s[36:39], s43 offen lds
    s_add_u32 s42, s29, 24576
    s_mov_b32 m0, s42
    s_add_u32 s43, s28, 128
    buffer_load_dwordx4 v3, s[36:39], s43 offen lds
    s_add_u32 s42, s29, 25600
    s_mov_b32 m0, s42
    s_add_u32 s43, s28, 10368
    buffer_load_dwordx4 v3, s[36:39], s43 offen lds
    s_add_u32 s42, s29, 26624
    s_mov_b32 m0, s42
    s_add_u32 s43, s28, 20608
    buffer_load_dwordx4 v3, s[36:39], s43 offen lds
    s_add_u32 s42, s29, 27648
    s_mov_b32 m0, s42
    s_add_u32 s43, s28, 30848
    buffer_load_dwordx4 v3, s[36:39], s43 offen lds
    s_add_u32 s42, s29, 28672
    s_mov_b32 m0, s42
    s_add_u32 s43, s28, 41088
    buffer_load_dwordx4 v3, s[36:39], s43 offen lds
    s_add_u32 s42, s29, 29696
    s_mov_b32 m0, s42
    s_add_u32 s43, s28, 51328
    buffer_load_dwordx4 v3, s[36:39], s43 offen lds
    v_add_u32 v152, 0, v4
    v_add_u32 v153, 0, v5
    v_add_u32 v154, 24576, v4
    v_add_u32 v155, 24576, v5
    s_waitcnt vmcnt(6)
    s_barrier
    ds_read_b64_tr_b16 v[64:65], v152 offset:0
    ds_read_b64_tr_b16 v[66:67], v152 offset:512
    ds_read_b64_tr_b16 v[68:69], v152 offset:2048
    ds_read_b64_tr_b16 v[70:71], v152 offset:2560
    ds_read_b64_tr_b16 v[72:73], v152 offset:4096
    ds_read_b64_tr_b16 v[74:75], v152 offset:4608
    ds_read_b64_tr_b16 v[76:77], v152 offset:6144
    ds_read_b64_tr_b16 v[78:79], v152 offset:6656
    ds_read_b64_tr_b16 v[80:81], v152 offset:8192
    ds_read_b64_tr_b16 v[82:83], v152 offset:8704
    ds_read_b64_tr_b16 v[84:85], v152 offset:10240
    ds_read_b64_tr_b16 v[86:87], v152 offset:10752
    s_waitcnt lgkmcnt(0)
    ds_read_b64_tr_b16 v[88:89], v152 offset:12288
    ds_read_b64_tr_b16 v[90:91], v152 offset:12800
    ds_read_b64_tr_b16 v[92:93], v152 offset:14336
    ds_read_b64_tr_b16 v[94:95], v152 offset:14848
    ds_read_b64_tr_b16 v[96:97], v152 offset:16384
    ds_read_b64_tr_b16 v[98:99], v152 offset:16896
    ds_read_b64_tr_b16 v[100:101], v152 offset:18432
    ds_read_b64_tr_b16 v[102:103], v152 offset:18944
    ds_read_b64_tr_b16 v[104:105], v152 offset:20480
    ds_read_b64_tr_b16 v[106:107], v152 offset:20992
    ds_read_b64_tr_b16 v[108:109], v152 offset:22528
    ds_read_b64_tr_b16 v[110:111], v152 offset:23040
    s_waitcnt lgkmcnt(0)
    v_mfma_f32_32x32x16_bf16 v[112:127], v[16:19], v[64:67], 0
    ds_read_b64_tr_b16 v[64:65], v153 offset:0
    ds_read_b64_tr_b16 v[66:67], v153 offset:512
    v_mfma_f32_32x32x16_bf16 v[112:127], v[20:23], v[68:71], v[112:127]
    ds_read_b64_tr_b16 v[68:69], v153 offset:2048
    ds_read_b64_tr_b16 v[70:71], v153 offset:2560
    v_mfma_f32_32x32x16_bf16 v[112:127], v[24:27], v[72:75], v[112:127]
    ds_read_b64_tr_b16 v[72:73], v153 offset:4096
    ds_read_b64_tr_b16 v[74:75], v153 offset:4608
    v_mfma_f32_32x32x16_bf16 v[112:127], v[28:31], v[76:79], v[112:127]
    ds_read_b64_tr_b16 v[76:77], v153 offset:6144
    ds_read_b64_tr_b16 v[78:79], v153 offset:6656
    v_mfma_f32_32x32x16_bf16 v[112:127], v[32:35], v[80:83], v[112:127]
    ds_read_b64_tr_b16 v[80:81], v153 offset:8192
    ds_read_b64_tr_b16 v[82:83], v153 offset:8704
    v_mfma_f32_32x32x16_bf16 v[112:127], v[36:39], v[84:87], v[112:127]
    ds_read_b64_tr_b16 v[84:85], v153 offset:10240
    ds_read_b64_tr_b16 v[86:87], v153 offset:10752
    v_mfma_f32_32x32x16_bf16 v[112:127], v[40:43], v[88:91], v[112:127]
    ds_read_b64_tr_b16 v[88:89], v153 offset:12288
    ds_read_b64_tr_b16 v[90:91], v153 offset:12800
    v_mfma_f32_32x32x16_bf16 v[112:127], v[44:47], v[92:95], v[112:127]
    ds_read_b64_tr_b16 v[92:93], v153 offset:14336
    ds_read_b64_tr_b16 v[94:95], v153 offset:14848
    v_mfma_f32_32x32x16_bf16 v[112:127], v[48:51], v[96:99], v[112:127]
    ds_read_b64_tr_b16 v[96:97], v153 offset:16384
    ds_read_b64_tr_b16 v[98:99], v153 offset:16896
    v_mfma_f32_32x32x16_bf16 v[112:127], v[52:55], v[100:103], v[112:127]
    ds_read_b64_tr_b16 v[100:101], v153 offset:18432
    ds_read_b64_tr_b16 v[102:103], v153 offset:18944
    v_mfma_f32_32x32x16_bf16 v[112:127], v[56:59], v[104:107], v[112:127]
    ds_read_b64_tr_b16 v[104:105], v153 offset:20480
    ds_read_b64_tr_b16 v[106:107], v153 offset:20992
    v_mfma_f32_32x32x16_bf16 v[112:127], v[60:63], v[108:111], v[112:127]
    ds_read_b64_tr_b16 v[108:109], v153 offset:22528
    ds_read_b64_tr_b16 v[110:111], v153 offset:23040
    s_waitcnt lgkmcnt(0)
    s_waitcnt vmcnt(0)
    s_barrier
    s_add_u32 s42, s29, 0
    s_mov_b32 m0, s42
    s_add_u32 s43, s28, 256
    buffer_load_dwordx4 v3, s[36:39], s43 offen lds
    s_add_u32 s42, s29, 1024
    s_mov_b32 m0, s42
    s_add_u32 s43, s28, 10496
    buffer_load_dwordx4 v3, s[36:39], s43 offen lds
    s_add_u32 s42, s29, 2048
    s_mov_b32 m0, s42
    s_add_u32 s43, s28, 20736
    buffer_load_dwordx4 v3, s[36:39], s43 offen lds
    s_add_u32 s42, s29, 3072
    s_mov_b32 m0, s42
    s_add_u32 s43, s28, 30976
    buffer_load_dwordx4 v3, s[36:39], s43 offen lds
    s_add_u32 s42, s29, 4096
    s_mov_b32 m0, s42
    s_add_u32 s43, s28, 41216
    buffer_load_dwordx4 v3, s[36:39], s43 offen lds
    s_add_u32 s42, s29, 5120
    s_mov_b32 m0, s42
    s_add_u32 s43, s28, 51456
    buffer_load_dwordx4 v3, s[36:39], s43 offen lds
    v_mfma_f32_32x32x16_bf16 v[128:143], v[16:19], v[64:67], 0
    ds_read_b64_tr_b16 v[64:65], v154 offset:0
    ds_read_b64_tr_b16 v[66:67], v154 offset:512
    v_mfma_f32_32x32x16_bf16 v[128:143], v[20:23], v[68:71], v[128:143]
    ds_read_b64_tr_b16 v[68:69], v154 offset:2048
    ds_read_b64_tr_b16 v[70:71], v154 offset:2560
    v_mfma_f32_32x32x16_bf16 v[128:143], v[24:27], v[72:75], v[128:143]
    ds_read_b64_tr_b16 v[72:73], v154 offset:4096
    ds_read_b64_tr_b16 v[74:75], v154 offset:4608
    s_add_u32 s42, s41, 0
    v_cvt_pk_bf16_f32 v144, v112, v113
    v_cvt_pk_bf16_f32 v145, v114, v115
    v_mfma_f32_32x32x16_bf16 v[128:143], v[28:31], v[76:79], v[128:143]
    ds_read_b64_tr_b16 v[76:77], v154 offset:6144
    ds_read_b64_tr_b16 v[78:79], v154 offset:6656
    v_cvt_pk_bf16_f32 v146, v116, v117
    v_cvt_pk_bf16_f32 v147, v118, v119
    s_nop 1
    v_mfma_f32_32x32x16_bf16 v[128:143], v[32:35], v[80:83], v[128:143]
    ds_read_b64_tr_b16 v[80:81], v154 offset:8192
    ds_read_b64_tr_b16 v[82:83], v154 offset:8704
    v_permlane32_swap_b32 v144, v146
    v_permlane32_swap_b32 v145, v147
    buffer_store_dwordx4 v[144:147], v10, s[8:11], s42 offen offset:0
    v_mfma_f32_32x32x16_bf16 v[128:143], v[36:39], v[84:87], v[128:143]
    ds_read_b64_tr_b16 v[84:85], v154 offset:10240
    ds_read_b64_tr_b16 v[86:87], v154 offset:10752
    v_cvt_pk_bf16_f32 v148, v120, v121
    v_cvt_pk_bf16_f32 v149, v122, v123
    v_cvt_pk_bf16_f32 v150, v124, v125
    v_mfma_f32_32x32x16_bf16 v[128:143], v[40:43], v[88:91], v[128:143]
    ds_read_b64_tr_b16 v[88:89], v154 offset:12288
    ds_read_b64_tr_b16 v[90:91], v154 offset:12800
    v_cvt_pk_bf16_f32 v151, v126, v127
    s_nop 1
    v_permlane32_swap_b32 v148, v150
    v_mfma_f32_32x32x16_bf16 v[128:143], v[44:47], v[92:95], v[128:143]
    ds_read_b64_tr_b16 v[92:93], v154 offset:14336
    ds_read_b64_tr_b16 v[94:95], v154 offset:14848
    v_permlane32_swap_b32 v149, v151
    buffer_store_dwordx4 v[148:151], v10, s[8:11], s42 offen offset:512
    v_mfma_f32_32x32x16_bf16 v[128:143], v[48:51], v[96:99], v[128:143]
    ds_read_b64_tr_b16 v[96:97], v154 offset:16384
    ds_read_b64_tr_b16 v[98:99], v154 offset:16896
    v_mfma_f32_32x32x16_bf16 v[128:143], v[52:55], v[100:103], v[128:143]
    ds_read_b64_tr_b16 v[100:101], v154 offset:18432
    ds_read_b64_tr_b16 v[102:103], v154 offset:18944
    v_mfma_f32_32x32x16_bf16 v[128:143], v[56:59], v[104:107], v[128:143]
    ds_read_b64_tr_b16 v[104:105], v154 offset:20480
    ds_read_b64_tr_b16 v[106:107], v154 offset:20992
    v_mfma_f32_32x32x16_bf16 v[128:143], v[60:63], v[108:111], v[128:143]
    ds_read_b64_tr_b16 v[108:109], v154 offset:22528
    ds_read_b64_tr_b16 v[110:111], v154 offset:23040
    s_waitcnt lgkmcnt(0)
    v_mfma_f32_32x32x16_bf16 v[112:127], v[16:19], v[64:67], 0
    ds_read_b64_tr_b16 v[64:65], v155 offset:0
    ds_read_b64_tr_b16 v[66:67], v155 offset:512
    v_mfma_f32_32x32x16_bf16 v[112:127], v[20:23], v[68:71], v[112:127]
    ds_read_b64_tr_b16 v[68:69], v155 offset:2048
    ds_read_b64_tr_b16 v[70:71], v155 offset:2560
    v_mfma_f32_32x32x16_bf16 v[112:127], v[24:27], v[72:75], v[112:127]
    ds_read_b64_tr_b16 v[72:73], v155 offset:4096
    ds_read_b64_tr_b16 v[74:75], v155 offset:4608
    s_add_u32 s42, s41, 1310720
    v_cvt_pk_bf16_f32 v144, v128, v129
    v_cvt_pk_bf16_f32 v145, v130, v131
    v_mfma_f32_32x32x16_bf16 v[112:127], v[28:31], v[76:79], v[112:127]
    ds_read_b64_tr_b16 v[76:77], v155 offset:6144
    ds_read_b64_tr_b16 v[78:79], v155 offset:6656
    v_cvt_pk_bf16_f32 v146, v132, v133
    v_cvt_pk_bf16_f32 v147, v134, v135
    s_nop 1
    v_mfma_f32_32x32x16_bf16 v[112:127], v[32:35], v[80:83], v[112:127]
    ds_read_b64_tr_b16 v[80:81], v155 offset:8192
    ds_read_b64_tr_b16 v[82:83], v155 offset:8704
    v_permlane32_swap_b32 v144, v146
    v_permlane32_swap_b32 v145, v147
    buffer_store_dwordx4 v[144:147], v10, s[8:11], s42 offen offset:0
    v_mfma_f32_32x32x16_bf16 v[112:127], v[36:39], v[84:87], v[112:127]
    ds_read_b64_tr_b16 v[84:85], v155 offset:10240
    ds_read_b64_tr_b16 v[86:87], v155 offset:10752
    v_cvt_pk_bf16_f32 v148, v136, v137
    v_cvt_pk_bf16_f32 v149, v138, v139
    v_cvt_pk_bf16_f32 v150, v140, v141
    v_mfma_f32_32x32x16_bf16 v[112:127], v[40:43], v[88:91], v[112:127]
    ds_read_b64_tr_b16 v[88:89], v155 offset:12288
    ds_read_b64_tr_b16 v[90:91], v155 offset:12800
    v_cvt_pk_bf16_f32 v151, v142, v143
    s_nop 1
    v_permlane32_swap_b32 v148, v150
    v_mfma_f32_32x32x16_bf16 v[112:127], v[44:47], v[92:95], v[112:127]
    ds_read_b64_tr_b16 v[92:93], v155 offset:14336
    ds_read_b64_tr_b16 v[94:95], v155 offset:14848
    v_permlane32_swap_b32 v149, v151
    buffer_store_dwordx4 v[148:151], v10, s[8:11], s42 offen offset:512
    v_mfma_f32_32x32x16_bf16 v[112:127], v[48:51], v[96:99], v[112:127]
    ds_read_b64_tr_b16 v[96:97], v155 offset:16384
    ds_read_b64_tr_b16 v[98:99], v155 offset:16896
    v_mfma_f32_32x32x16_bf16 v[112:127], v[52:55], v[100:103], v[112:127]
    ds_read_b64_tr_b16 v[100:101], v155 offset:18432
    ds_read_b64_tr_b16 v[102:103], v155 offset:18944
    v_mfma_f32_32x32x16_bf16 v[112:127], v[56:59], v[104:107], v[112:127]
    ds_read_b64_tr_b16 v[104:105], v155 offset:20480
    ds_read_b64_tr_b16 v[106:107], v155 offset:20992
    v_mfma_f32_32x32x16_bf16 v[112:127], v[60:63], v[108:111], v[112:127]
    ds_read_b64_tr_b16 v[108:109], v155 offset:22528
    ds_read_b64_tr_b16 v[110:111], v155 offset:23040
    s_waitcnt lgkmcnt(0)
    s_waitcnt vmcnt(4)
    s_barrier
    s_add_u32 s42, s29, 24576
    s_mov_b32 m0, s42
    s_add_u32 s43, s28, 384
    buffer_load_dwordx4 v3, s[36:39], s43 offen lds
    s_add_u32 s42, s29, 25600
    s_mov_b32 m0, s42
    s_add_u32 s43, s28, 10624
    buffer_load_dwordx4 v3, s[36:39], s43 offen lds
    s_add_u32 s42, s29, 26624
    s_mov_b32 m0, s42
    s_add_u32 s43, s28, 20864
    buffer_load_dwordx4 v3, s[36:39], s43 offen lds
    s_add_u32 s42, s29, 27648
    s_mov_b32 m0, s42
    s_add_u32 s43, s28, 31104
    buffer_load_dwordx4 v3, s[36:39], s43 offen lds
    s_add_u32 s42, s29, 28672
    s_mov_b32 m0, s42
    s_add_u32 s43, s28, 41344
    buffer_load_dwordx4 v3, s[36:39], s43 offen lds
    s_add_u32 s42, s29, 29696
    s_mov_b32 m0, s42
    s_add_u32 s43, s28, 51584
    buffer_load_dwordx4 v3, s[36:39], s43 offen lds
    v_mfma_f32_32x32x16_bf16 v[128:143], v[16:19], v[64:67], 0
    ds_read_b64_tr_b16 v[64:65], v152 offset:0
    ds_read_b64_tr_b16 v[66:67], v152 offset:512
    v_mfma_f32_32x32x16_bf16 v[128:143], v[20:23], v[68:71], v[128:143]
    ds_read_b64_tr_b16 v[68:69], v152 offset:2048
    ds_read_b64_tr_b16 v[70:71], v152 offset:2560
    v_mfma_f32_32x32x16_bf16 v[128:143], v[24:27], v[72:75], v[128:143]
    ds_read_b64_tr_b16 v[72:73], v152 offset:4096
    ds_read_b64_tr_b16 v[74:75], v152 offset:4608
    s_add_u32 s42, s41, 2621440
    v_cvt_pk_bf16_f32 v144, v112, v113
    v_cvt_pk_bf16_f32 v145, v114, v115
    v_mfma_f32_32x32x16_bf16 v[128:143], v[28:31], v[76:79], v[128:143]
    ds_read_b64_tr_b16 v[76:77], v152 offset:6144
    ds_read_b64_tr_b16 v[78:79], v152 offset:6656
    v_cvt_pk_bf16_f32 v146, v116, v117
    v_cvt_pk_bf16_f32 v147, v118, v119
    s_nop 1
    v_mfma_f32_32x32x16_bf16 v[128:143], v[32:35], v[80:83], v[128:143]
    ds_read_b64_tr_b16 v[80:81], v152 offset:8192
    ds_read_b64_tr_b16 v[82:83], v152 offset:8704
    v_permlane32_swap_b32 v144, v146
    v_permlane32_swap_b32 v145, v147
    buffer_store_dwordx4 v[144:147], v10, s[8:11], s42 offen offset:0
    v_mfma_f32_32x32x16_bf16 v[128:143], v[36:39], v[84:87], v[128:143]
    ds_read_b64_tr_b16 v[84:85], v152 offset:10240
    ds_read_b64_tr_b16 v[86:87], v152 offset:10752
    v_cvt_pk_bf16_f32 v148, v120, v121
    v_cvt_pk_bf16_f32 v149, v122, v123
    v_cvt_pk_bf16_f32 v150, v124, v125
    v_mfma_f32_32x32x16_bf16 v[128:143], v[40:43], v[88:91], v[128:143]
    ds_read_b64_tr_b16 v[88:89], v152 offset:12288
    ds_read_b64_tr_b16 v[90:91], v152 offset:12800
    v_cvt_pk_bf16_f32 v151, v126, v127
    s_nop 1
    v_permlane32_swap_b32 v148, v150
    v_mfma_f32_32x32x16_bf16 v[128:143], v[44:47], v[92:95], v[128:143]
    ds_read_b64_tr_b16 v[92:93], v152 offset:14336
    ds_read_b64_tr_b16 v[94:95], v152 offset:14848
    v_permlane32_swap_b32 v149, v151
    buffer_store_dwordx4 v[148:151], v10, s[8:11], s42 offen offset:512
    v_mfma_f32_32x32x16_bf16 v[128:143], v[48:51], v[96:99], v[128:143]
    ds_read_b64_tr_b16 v[96:97], v152 offset:16384
    ds_read_b64_tr_b16 v[98:99], v152 offset:16896
    v_mfma_f32_32x32x16_bf16 v[128:143], v[52:55], v[100:103], v[128:143]
    ds_read_b64_tr_b16 v[100:101], v152 offset:18432
    ds_read_b64_tr_b16 v[102:103], v152 offset:18944
    v_mfma_f32_32x32x16_bf16 v[128:143], v[56:59], v[104:107], v[128:143]
    ds_read_b64_tr_b16 v[104:105], v152 offset:20480
    ds_read_b64_tr_b16 v[106:107], v152 offset:20992
    v_mfma_f32_32x32x16_bf16 v[128:143], v[60:63], v[108:111], v[128:143]
    ds_read_b64_tr_b16 v[108:109], v152 offset:22528
    ds_read_b64_tr_b16 v[110:111], v152 offset:23040
    s_waitcnt lgkmcnt(0)
    v_mfma_f32_32x32x16_bf16 v[112:127], v[16:19], v[64:67], 0
    ds_read_b64_tr_b16 v[64:65], v153 offset:0
    ds_read_b64_tr_b16 v[66:67], v153 offset:512
    v_mfma_f32_32x32x16_bf16 v[112:127], v[20:23], v[68:71], v[112:127]
    ds_read_b64_tr_b16 v[68:69], v153 offset:2048
    ds_read_b64_tr_b16 v[70:71], v153 offset:2560
    v_mfma_f32_32x32x16_bf16 v[112:127], v[24:27], v[72:75], v[112:127]
    ds_read_b64_tr_b16 v[72:73], v153 offset:4096
    ds_read_b64_tr_b16 v[74:75], v153 offset:4608
    s_add_u32 s42, s41, 3932160
    v_cvt_pk_bf16_f32 v144, v128, v129
    v_cvt_pk_bf16_f32 v145, v130, v131
    v_mfma_f32_32x32x16_bf16 v[112:127], v[28:31], v[76:79], v[112:127]
    ds_read_b64_tr_b16 v[76:77], v153 offset:6144
    ds_read_b64_tr_b16 v[78:79], v153 offset:6656
    v_cvt_pk_bf16_f32 v146, v132, v133
    v_cvt_pk_bf16_f32 v147, v134, v135
    s_nop 1
    v_mfma_f32_32x32x16_bf16 v[112:127], v[32:35], v[80:83], v[112:127]
    ds_read_b64_tr_b16 v[80:81], v153 offset:8192
    ds_read_b64_tr_b16 v[82:83], v153 offset:8704
    v_permlane32_swap_b32 v144, v146
    v_permlane32_swap_b32 v145, v147
    buffer_store_dwordx4 v[144:147], v10, s[8:11], s42 offen offset:0
    v_mfma_f32_32x32x16_bf16 v[112:127], v[36:39], v[84:87], v[112:127]
    ds_read_b64_tr_b16 v[84:85], v153 offset:10240
    ds_read_b64_tr_b16 v[86:87], v153 offset:10752
    v_cvt_pk_bf16_f32 v148, v136, v137
    v_cvt_pk_bf16_f32 v149, v138, v139
    v_cvt_pk_bf16_f32 v150, v140, v141
    v_mfma_f32_32x32x16_bf16 v[112:127], v[40:43], v[88:91], v[112:127]
    ds_read_b64_tr_b16 v[88:89], v153 offset:12288
    ds_read_b64_tr_b16 v[90:91], v153 offset:12800
    v_cvt_pk_bf16_f32 v151, v142, v143
    s_nop 1
    v_permlane32_swap_b32 v148, v150
    v_mfma_f32_32x32x16_bf16 v[112:127], v[44:47], v[92:95], v[112:127]
    ds_read_b64_tr_b16 v[92:93], v153 offset:14336
    ds_read_b64_tr_b16 v[94:95], v153 offset:14848
    v_permlane32_swap_b32 v149, v151
    buffer_store_dwordx4 v[148:151], v10, s[8:11], s42 offen offset:512
    v_mfma_f32_32x32x16_bf16 v[112:127], v[48:51], v[96:99], v[112:127]
    ds_read_b64_tr_b16 v[96:97], v153 offset:16384
    ds_read_b64_tr_b16 v[98:99], v153 offset:16896
    v_mfma_f32_32x32x16_bf16 v[112:127], v[52:55], v[100:103], v[112:127]
    ds_read_b64_tr_b16 v[100:101], v153 offset:18432
    ds_read_b64_tr_b16 v[102:103], v153 offset:18944
    v_mfma_f32_32x32x16_bf16 v[112:127], v[56:59], v[104:107], v[112:127]
    ds_read_b64_tr_b16 v[104:105], v153 offset:20480
    ds_read_b64_tr_b16 v[106:107], v153 offset:20992
    v_mfma_f32_32x32x16_bf16 v[112:127], v[60:63], v[108:111], v[112:127]
    ds_read_b64_tr_b16 v[108:109], v153 offset:22528
    ds_read_b64_tr_b16 v[110:111], v153 offset:23040
    s_waitcnt lgkmcnt(0)
    s_waitcnt vmcnt(4)
    s_barrier
    s_add_u32 s42, s29, 0
    s_mov_b32 m0, s42
    s_add_u32 s43, s28, 512
    buffer_load_dwordx4 v3, s[36:39], s43 offen lds
    s_add_u32 s42, s29, 1024
    s_mov_b32 m0, s42
    s_add_u32 s43, s28, 10752
    buffer_load_dwordx4 v3, s[36:39], s43 offen lds
    s_add_u32 s42, s29, 2048
    s_mov_b32 m0, s42
    s_add_u32 s43, s28, 20992
    buffer_load_dwordx4 v3, s[36:39], s43 offen lds
    s_add_u32 s42, s29, 3072
    s_mov_b32 m0, s42
    s_add_u32 s43, s28, 31232
    buffer_load_dwordx4 v3, s[36:39], s43 offen lds
    s_add_u32 s42, s29, 4096
    s_mov_b32 m0, s42
    s_add_u32 s43, s28, 41472
    buffer_load_dwordx4 v3, s[36:39], s43 offen lds
    s_add_u32 s42, s29, 5120
    s_mov_b32 m0, s42
    s_add_u32 s43, s28, 51712
    buffer_load_dwordx4 v3, s[36:39], s43 offen lds
    v_mfma_f32_32x32x16_bf16 v[128:143], v[16:19], v[64:67], 0
    ds_read_b64_tr_b16 v[64:65], v154 offset:0
    ds_read_b64_tr_b16 v[66:67], v154 offset:512
    v_mfma_f32_32x32x16_bf16 v[128:143], v[20:23], v[68:71], v[128:143]
    ds_read_b64_tr_b16 v[68:69], v154 offset:2048
    ds_read_b64_tr_b16 v[70:71], v154 offset:2560
    v_mfma_f32_32x32x16_bf16 v[128:143], v[24:27], v[72:75], v[128:143]
    ds_read_b64_tr_b16 v[72:73], v154 offset:4096
    ds_read_b64_tr_b16 v[74:75], v154 offset:4608
    s_add_u32 s42, s41, 5242880
    v_cvt_pk_bf16_f32 v144, v112, v113
    v_cvt_pk_bf16_f32 v145, v114, v115
    v_mfma_f32_32x32x16_bf16 v[128:143], v[28:31], v[76:79], v[128:143]
    ds_read_b64_tr_b16 v[76:77], v154 offset:6144
    ds_read_b64_tr_b16 v[78:79], v154 offset:6656
    v_cvt_pk_bf16_f32 v146, v116, v117
    v_cvt_pk_bf16_f32 v147, v118, v119
    s_nop 1
    v_mfma_f32_32x32x16_bf16 v[128:143], v[32:35], v[80:83], v[128:143]
    ds_read_b64_tr_b16 v[80:81], v154 offset:8192
    ds_read_b64_tr_b16 v[82:83], v154 offset:8704
    v_permlane32_swap_b32 v144, v146
    v_permlane32_swap_b32 v145, v147
    buffer_store_dwordx4 v[144:147], v10, s[8:11], s42 offen offset:0
    v_mfma_f32_32x32x16_bf16 v[128:143], v[36:39], v[84:87], v[128:143]
    ds_read_b64_tr_b16 v[84:85], v154 offset:10240
    ds_read_b64_tr_b16 v[86:87], v154 offset:10752
    v_cvt_pk_bf16_f32 v148, v120, v121
    v_cvt_pk_bf16_f32 v149, v122, v123
    v_cvt_pk_bf16_f32 v150, v124, v125
    v_mfma_f32_32x32x16_bf16 v[128:143], v[40:43], v[88:91], v[128:143]
    ds_read_b64_tr_b16 v[88:89], v154 offset:12288
    ds_read_b64_tr_b16 v[90:91], v154 offset:12800
    v_cvt_pk_bf16_f32 v151, v126, v127
    s_nop 1
    v_permlane32_swap_b32 v148, v150
    v_mfma_f32_32x32x16_bf16 v[128:143], v[44:47], v[92:95], v[128:143]
    ds_read_b64_tr_b16 v[92:93], v154 offset:14336
    ds_read_b64_tr_b16 v[94:95], v154 offset:14848
    v_permlane32_swap_b32 v149, v151
    buffer_store_dwordx4 v[148:151], v10, s[8:11], s42 offen offset:512
    v_mfma_f32_32x32x16_bf16 v[128:143], v[48:51], v[96:99], v[128:143]
    ds_read_b64_tr_b16 v[96:97], v154 offset:16384
    ds_read_b64_tr_b16 v[98:99], v154 offset:16896
    v_mfma_f32_32x32x16_bf16 v[128:143], v[52:55], v[100:103], v[128:143]
    ds_read_b64_tr_b16 v[100:101], v154 offset:18432
    ds_read_b64_tr_b16 v[102:103], v154 offset:18944
    v_mfma_f32_32x32x16_bf16 v[128:143], v[56:59], v[104:107], v[128:143]
    ds_read_b64_tr_b16 v[104:105], v154 offset:20480
    ds_read_b64_tr_b16 v[106:107], v154 offset:20992
    v_mfma_f32_32x32x16_bf16 v[128:143], v[60:63], v[108:111], v[128:143]
    ds_read_b64_tr_b16 v[108:109], v154 offset:22528
    ds_read_b64_tr_b16 v[110:111], v154 offset:23040
    s_waitcnt lgkmcnt(0)
    v_mfma_f32_32x32x16_bf16 v[112:127], v[16:19], v[64:67], 0
    ds_read_b64_tr_b16 v[64:65], v155 offset:0
    ds_read_b64_tr_b16 v[66:67], v155 offset:512
    v_mfma_f32_32x32x16_bf16 v[112:127], v[20:23], v[68:71], v[112:127]
    ds_read_b64_tr_b16 v[68:69], v155 offset:2048
    ds_read_b64_tr_b16 v[70:71], v155 offset:2560
    v_mfma_f32_32x32x16_bf16 v[112:127], v[24:27], v[72:75], v[112:127]
    ds_read_b64_tr_b16 v[72:73], v155 offset:4096
    ds_read_b64_tr_b16 v[74:75], v155 offset:4608
    s_add_u32 s42, s41, 6553600
    v_cvt_pk_bf16_f32 v144, v128, v129
    v_cvt_pk_bf16_f32 v145, v130, v131
    v_mfma_f32_32x32x16_bf16 v[112:127], v[28:31], v[76:79], v[112:127]
    ds_read_b64_tr_b16 v[76:77], v155 offset:6144
    ds_read_b64_tr_b16 v[78:79], v155 offset:6656
    v_cvt_pk_bf16_f32 v146, v132, v133
    v_cvt_pk_bf16_f32 v147, v134, v135
    s_nop 1
    v_mfma_f32_32x32x16_bf16 v[112:127], v[32:35], v[80:83], v[112:127]
    ds_read_b64_tr_b16 v[80:81], v155 offset:8192
    ds_read_b64_tr_b16 v[82:83], v155 offset:8704
    v_permlane32_swap_b32 v144, v146
    v_permlane32_swap_b32 v145, v147
    buffer_store_dwordx4 v[144:147], v10, s[8:11], s42 offen offset:0
    v_mfma_f32_32x32x16_bf16 v[112:127], v[36:39], v[84:87], v[112:127]
    ds_read_b64_tr_b16 v[84:85], v155 offset:10240
    ds_read_b64_tr_b16 v[86:87], v155 offset:10752
    v_cvt_pk_bf16_f32 v148, v136, v137
    v_cvt_pk_bf16_f32 v149, v138, v139
    v_cvt_pk_bf16_f32 v150, v140, v141
    v_mfma_f32_32x32x16_bf16 v[112:127], v[40:43], v[88:91], v[112:127]
    ds_read_b64_tr_b16 v[88:89], v155 offset:12288
    ds_read_b64_tr_b16 v[90:91], v155 offset:12800
    v_cvt_pk_bf16_f32 v151, v142, v143
    s_nop 1
    v_permlane32_swap_b32 v148, v150
    v_mfma_f32_32x32x16_bf16 v[112:127], v[44:47], v[92:95], v[112:127]
    ds_read_b64_tr_b16 v[92:93], v155 offset:14336
    ds_read_b64_tr_b16 v[94:95], v155 offset:14848
    v_permlane32_swap_b32 v149, v151
    buffer_store_dwordx4 v[148:151], v10, s[8:11], s42 offen offset:512
    v_mfma_f32_32x32x16_bf16 v[112:127], v[48:51], v[96:99], v[112:127]
    ds_read_b64_tr_b16 v[96:97], v155 offset:16384
    ds_read_b64_tr_b16 v[98:99], v155 offset:16896
    v_mfma_f32_32x32x16_bf16 v[112:127], v[52:55], v[100:103], v[112:127]
    ds_read_b64_tr_b16 v[100:101], v155 offset:18432
    ds_read_b64_tr_b16 v[102:103], v155 offset:18944
    v_mfma_f32_32x32x16_bf16 v[112:127], v[56:59], v[104:107], v[112:127]
    ds_read_b64_tr_b16 v[104:105], v155 offset:20480
    ds_read_b64_tr_b16 v[106:107], v155 offset:20992
    v_mfma_f32_32x32x16_bf16 v[112:127], v[60:63], v[108:111], v[112:127]
    ds_read_b64_tr_b16 v[108:109], v155 offset:22528
    ds_read_b64_tr_b16 v[110:111], v155 offset:23040
    s_waitcnt lgkmcnt(0)
    s_waitcnt vmcnt(4)
    s_barrier
    v_mfma_f32_32x32x16_bf16 v[128:143], v[16:19], v[64:67], 0
    ds_read_b64_tr_b16 v[64:65], v152 offset:0
    ds_read_b64_tr_b16 v[66:67], v152 offset:512
    v_mfma_f32_32x32x16_bf16 v[128:143], v[20:23], v[68:71], v[128:143]
    ds_read_b64_tr_b16 v[68:69], v152 offset:2048
    ds_read_b64_tr_b16 v[70:71], v152 offset:2560
    v_mfma_f32_32x32x16_bf16 v[128:143], v[24:27], v[72:75], v[128:143]
    ds_read_b64_tr_b16 v[72:73], v152 offset:4096
    ds_read_b64_tr_b16 v[74:75], v152 offset:4608
    s_add_u32 s42, s41, 7864320
    v_cvt_pk_bf16_f32 v144, v112, v113
    v_cvt_pk_bf16_f32 v145, v114, v115
    v_mfma_f32_32x32x16_bf16 v[128:143], v[28:31], v[76:79], v[128:143]
    ds_read_b64_tr_b16 v[76:77], v152 offset:6144
    ds_read_b64_tr_b16 v[78:79], v152 offset:6656
    v_cvt_pk_bf16_f32 v146, v116, v117
    v_cvt_pk_bf16_f32 v147, v118, v119
    s_nop 1
    v_mfma_f32_32x32x16_bf16 v[128:143], v[32:35], v[80:83], v[128:143]
    ds_read_b64_tr_b16 v[80:81], v152 offset:8192
    ds_read_b64_tr_b16 v[82:83], v152 offset:8704
    v_permlane32_swap_b32 v144, v146
    v_permlane32_swap_b32 v145, v147
    buffer_store_dwordx4 v[144:147], v10, s[8:11], s42 offen offset:0
    v_mfma_f32_32x32x16_bf16 v[128:143], v[36:39], v[84:87], v[128:143]
    ds_read_b64_tr_b16 v[84:85], v152 offset:10240
    ds_read_b64_tr_b16 v[86:87], v152 offset:10752
    v_cvt_pk_bf16_f32 v148, v120, v121
    v_cvt_pk_bf16_f32 v149, v122, v123
    v_cvt_pk_bf16_f32 v150, v124, v125
    v_mfma_f32_32x32x16_bf16 v[128:143], v[40:43], v[88:91], v[128:143]
    ds_read_b64_tr_b16 v[88:89], v152 offset:12288
    ds_read_b64_tr_b16 v[90:91], v152 offset:12800
    v_cvt_pk_bf16_f32 v151, v126, v127
    s_nop 1
    v_permlane32_swap_b32 v148, v150
    v_mfma_f32_32x32x16_bf16 v[128:143], v[44:47], v[92:95], v[128:143]
    ds_read_b64_tr_b16 v[92:93], v152 offset:14336
    ds_read_b64_tr_b16 v[94:95], v152 offset:14848
    v_permlane32_swap_b32 v149, v151
    buffer_store_dwordx4 v[148:151], v10, s[8:11], s42 offen offset:512
    v_mfma_f32_32x32x16_bf16 v[128:143], v[48:51], v[96:99], v[128:143]
    ds_read_b64_tr_b16 v[96:97], v152 offset:16384
    ds_read_b64_tr_b16 v[98:99], v152 offset:16896
    v_mfma_f32_32x32x16_bf16 v[128:143], v[52:55], v[100:103], v[128:143]
    ds_read_b64_tr_b16 v[100:101], v152 offset:18432
    ds_read_b64_tr_b16 v[102:103], v152 offset:18944
    v_mfma_f32_32x32x16_bf16 v[128:143], v[56:59], v[104:107], v[128:143]
    ds_read_b64_tr_b16 v[104:105], v152 offset:20480
    ds_read_b64_tr_b16 v[106:107], v152 offset:20992
    v_mfma_f32_32x32x16_bf16 v[128:143], v[60:63], v[108:111], v[128:143]
    ds_read_b64_tr_b16 v[108:109], v152 offset:22528
    ds_read_b64_tr_b16 v[110:111], v152 offset:23040
    s_waitcnt lgkmcnt(0)
    v_mfma_f32_32x32x16_bf16 v[112:127], v[16:19], v[64:67], 0
    ds_read_b64_tr_b16 v[64:65], v153 offset:0
    ds_read_b64_tr_b16 v[66:67], v153 offset:512
    v_mfma_f32_32x32x16_bf16 v[112:127], v[20:23], v[68:71], v[112:127]
    ds_read_b64_tr_b16 v[68:69], v153 offset:2048
    ds_read_b64_tr_b16 v[70:71], v153 offset:2560
    v_mfma_f32_32x32x16_bf16 v[112:127], v[24:27], v[72:75], v[112:127]
    ds_read_b64_tr_b16 v[72:73], v153 offset:4096
    ds_read_b64_tr_b16 v[74:75], v153 offset:4608
    s_add_u32 s42, s41, 9175040
    v_cvt_pk_bf16_f32 v144, v128, v129
    v_cvt_pk_bf16_f32 v145, v130, v131
    v_mfma_f32_32x32x16_bf16 v[112:127], v[28:31], v[76:79], v[112:127]
    ds_read_b64_tr_b16 v[76:77], v153 offset:6144
    ds_read_b64_tr_b16 v[78:79], v153 offset:6656
    v_cvt_pk_bf16_f32 v146, v132, v133
    v_cvt_pk_bf16_f32 v147, v134, v135
    s_nop 1
    v_mfma_f32_32x32x16_bf16 v[112:127], v[32:35], v[80:83], v[112:127]
    ds_read_b64_tr_b16 v[80:81], v153 offset:8192
    ds_read_b64_tr_b16 v[82:83], v153 offset:8704
    v_permlane32_swap_b32 v144, v146
    v_permlane32_swap_b32 v145, v147
    buffer_store_dwordx4 v[144:147], v10, s[8:11], s42 offen offset:0
    v_mfma_f32_32x32x16_bf16 v[112:127], v[36:39], v[84:87], v[112:127]
    ds_read_b64_tr_b16 v[84:85], v153 offset:10240
    ds_read_b64_tr_b16 v[86:87], v153 offset:10752
    v_cvt_pk_bf16_f32 v148, v136, v137
    v_cvt_pk_bf16_f32 v149, v138, v139
    v_cvt_pk_bf16_f32 v150, v140, v141
    v_mfma_f32_32x32x16_bf16 v[112:127], v[40:43], v[88:91], v[112:127]
    ds_read_b64_tr_b16 v[88:89], v153 offset:12288
    ds_read_b64_tr_b16 v[90:91], v153 offset:12800
    v_cvt_pk_bf16_f32 v151, v142, v143
    s_nop 1
    v_permlane32_swap_b32 v148, v150
    v_mfma_f32_32x32x16_bf16 v[112:127], v[44:47], v[92:95], v[112:127]
    ds_read_b64_tr_b16 v[92:93], v153 offset:14336
    ds_read_b64_tr_b16 v[94:95], v153 offset:14848
    v_permlane32_swap_b32 v149, v151
    buffer_store_dwordx4 v[148:151], v10, s[8:11], s42 offen offset:512
    v_mfma_f32_32x32x16_bf16 v[112:127], v[48:51], v[96:99], v[112:127]
    ds_read_b64_tr_b16 v[96:97], v153 offset:16384
    ds_read_b64_tr_b16 v[98:99], v153 offset:16896
    v_mfma_f32_32x32x16_bf16 v[112:127], v[52:55], v[100:103], v[112:127]
    ds_read_b64_tr_b16 v[100:101], v153 offset:18432
    ds_read_b64_tr_b16 v[102:103], v153 offset:18944
    v_mfma_f32_32x32x16_bf16 v[112:127], v[56:59], v[104:107], v[112:127]
    ds_read_b64_tr_b16 v[104:105], v153 offset:20480
    ds_read_b64_tr_b16 v[106:107], v153 offset:20992
    v_mfma_f32_32x32x16_bf16 v[112:127], v[60:63], v[108:111], v[112:127]
    ds_read_b64_tr_b16 v[108:109], v153 offset:22528
    ds_read_b64_tr_b16 v[110:111], v153 offset:23040
    s_waitcnt lgkmcnt(0)
    s_barrier
    v_mfma_f32_32x32x16_bf16 v[128:143], v[16:19], v[64:67], 0
    v_mfma_f32_32x32x16_bf16 v[128:143], v[20:23], v[68:71], v[128:143]
    v_mfma_f32_32x32x16_bf16 v[128:143], v[24:27], v[72:75], v[128:143]
    s_add_u32 s42, s41, 10485760
    v_cvt_pk_bf16_f32 v144, v112, v113
    v_cvt_pk_bf16_f32 v145, v114, v115
    v_mfma_f32_32x32x16_bf16 v[128:143], v[28:31], v[76:79], v[128:143]
    v_cvt_pk_bf16_f32 v146, v116, v117
    v_cvt_pk_bf16_f32 v147, v118, v119
    s_nop 1
    v_mfma_f32_32x32x16_bf16 v[128:143], v[32:35], v[80:83], v[128:143]
    v_permlane32_swap_b32 v144, v146
    v_permlane32_swap_b32 v145, v147
    buffer_store_dwordx4 v[144:147], v10, s[8:11], s42 offen offset:0
    v_mfma_f32_32x32x16_bf16 v[128:143], v[36:39], v[84:87], v[128:143]
    v_cvt_pk_bf16_f32 v148, v120, v121
    v_cvt_pk_bf16_f32 v149, v122, v123
    v_cvt_pk_bf16_f32 v150, v124, v125
    v_mfma_f32_32x32x16_bf16 v[128:143], v[40:43], v[88:91], v[128:143]
    v_cvt_pk_bf16_f32 v151, v126, v127
    s_nop 1
    v_permlane32_swap_b32 v148, v150
    v_mfma_f32_32x32x16_bf16 v[128:143], v[44:47], v[92:95], v[128:143]
    v_permlane32_swap_b32 v149, v151
    buffer_store_dwordx4 v[148:151], v10, s[8:11], s42 offen offset:512
    v_mfma_f32_32x32x16_bf16 v[128:143], v[48:51], v[96:99], v[128:143]
    v_mfma_f32_32x32x16_bf16 v[128:143], v[52:55], v[100:103], v[128:143]
    v_mfma_f32_32x32x16_bf16 v[128:143], v[56:59], v[104:107], v[128:143]
    v_mfma_f32_32x32x16_bf16 v[128:143], v[60:63], v[108:111], v[128:143]
    s_nop 7
    s_nop 7
    s_nop 7
    s_add_u32 s42, s41, 11796480
    v_cvt_pk_bf16_f32 v144, v128, v129
    v_cvt_pk_bf16_f32 v145, v130, v131
    v_cvt_pk_bf16_f32 v146, v132, v133
    v_cvt_pk_bf16_f32 v147, v134, v135
    s_nop 1
    v_permlane32_swap_b32 v144, v146
    v_permlane32_swap_b32 v145, v147
    buffer_store_dwordx4 v[144:147], v10, s[8:11], s42 offen offset:0
    v_cvt_pk_bf16_f32 v148, v136, v137
    v_cvt_pk_bf16_f32 v149, v138, v139
    v_cvt_pk_bf16_f32 v150, v140, v141
    v_cvt_pk_bf16_f32 v151, v142, v143
    s_nop 1
    v_permlane32_swap_b32 v148, v150
    v_permlane32_swap_b32 v149, v151
    buffer_store_dwordx4 v[148:151], v10, s[8:11], s42 offen offset:512
    s_branch prep_kernel_end
prep_kernel_r_pwp:
    s_lshl_b32 s20, s20, 2
    s_add_u32 s20, s20, s13
    s_mul_i32 s21, s20, 13108
    s_lshr_b32 s21, s21, 16
    s_mul_i32 s22, s21, 5
    s_sub_u32 s22, s20, s22
    s_mul_i32 s23, s21, 21846
    s_lshr_b32 s23, s23, 16
    s_mul_i32 s28, s23, 3
    s_sub_u32 s21, s21, s28
    s_lshr_b32 s29, s23, 5
    s_and_b32 s23, s23, 31
    s_cmp_eq_u32 s29, 0
    s_cbranch_scc0 prep_kernel_pwp_k
    s_load_dwordx2 s[24:25], s[0:1], 40
    s_branch prep_kernel_pwp_go
prep_kernel_pwp_k:
    s_load_dwordx2 s[24:25], s[0:1], 48
prep_kernel_pwp_go:
    v_and_b32 v1, 31, v0
    v_lshrrev_b32 v2, 5, v0
    s_lshl_b32 s28, s21, 6
    v_lshlrev_b32 v3, 1, v1
    v_add_u32 v3, s28, v3
    v_and_b32 v4, 0xc1, v3
    v_and_b32 v5, 8, v3
    v_lshl_or_b32 v4, v5, 2, v4
    v_and_b32 v5, 32, v3
    v_lshrrev_b32 v5, 1, v5
    v_or_b32 v4, v4, v5
    v_and_b32 v5, 2, v3
    v_lshl_or_b32 v4, v5, 2, v4
    v_and_b32 v5, 16, v3
    v_lshrrev_b32 v5, 2, v5
    v_or_b32 v4, v4, v5
    v_and_b32 v5, 4, v3
    v_lshrrev_b32 v5, 1, v5
    v_or_b32 v4, v4, v5
    s_cmp_eq_u32 s29, 0
    s_cselect_b64 vcc, -1, 0
    s_nop 1
    v_cndmask_b32 v4, v4, v3, vcc
    v_lshrrev_b32 v5, 4, v3
    v_and_b32 v6, 3, v5
    v_mul_u32_u24 v6, 6, v6
    v_lshrrev_b32 v5, 2, v5
    v_add_u32 v5, v5, v6
    v_mul_u32_u24 v5, 20480, v5
    v_and_b32 v6, 15, v3
    v_lshl_add_u32 v7, v6, 4, v5
    s_mul_i32 s30, s29, 61440
    s_mul_i32 s31, s23, 491520
    s_add_u32 s30, s30, s31
    s_add_u32 s30, s30, 11534336
    s_lshl_b32 s31, s22, 4
    v_add_u32 v8, s31, v2
    s_waitcnt lgkmcnt(0)
    s_mov_b32 s32, s24
    s_mov_b32 s33, s25
    s_mov_b32 s34, 7864320
    s_mov_b32 s35, 0x00020000
    s_mul_i32 s28, s23, 384
    v_add_u32 v9, 0, v8
    v_lshrrev_b32 v10, 2, v9
    v_lshlrev_b32 v10, 5, v10
    v_and_b32 v11, 2, v9
    v_lshl_add_u32 v10, v11, 3, v10
    v_and_b32 v11, 1, v9
    v_lshl_add_u32 v10, v11, 2, v10
    v_mul_u32_u24 v10, 12288, v10
    v_lshl_add_u32 v10, v4, 1, v10
    s_add_u32 s31, s28, 0
    buffer_load_dword v16, v10, s[32:35], s31 offen
    s_add_u32 s31, s28, 12288
    buffer_load_dword v17, v10, s[32:35], s31 offen
    s_add_u32 s31, s28, 98304
    buffer_load_dword v18, v10, s[32:35], s31 offen
    s_add_u32 s31, s28, 110592
    buffer_load_dword v19, v10, s[32:35], s31 offen
    s_add_u32 s31, s28, 24576
    buffer_load_dword v20, v10, s[32:35], s31 offen
    s_add_u32 s31, s28, 36864
    buffer_load_dword v21, v10, s[32:35], s31 offen
    s_add_u32 s31, s28, 122880
    buffer_load_dword v22, v10, s[32:35], s31 offen
    s_add_u32 s31, s28, 135168
    buffer_load_dword v23, v10, s[32:35], s31 offen
    v_add_u32 v9, 2, v8
    v_lshrrev_b32 v10, 2, v9
    v_lshlrev_b32 v10, 5, v10
    v_and_b32 v11, 2, v9
    v_lshl_add_u32 v10, v11, 3, v10
    v_and_b32 v11, 1, v9
    v_lshl_add_u32 v10, v11, 2, v10
    v_mul_u32_u24 v10, 12288, v10
    v_lshl_add_u32 v10, v4, 1, v10
    s_add_u32 s31, s28, 0
    buffer_load_dword v24, v10, s[32:35], s31 offen
    s_add_u32 s31, s28, 12288
    buffer_load_dword v25, v10, s[32:35], s31 offen
    s_add_u32 s31, s28, 98304
    buffer_load_dword v26, v10, s[32:35], s31 offen
    s_add_u32 s31, s28, 110592
    buffer_load_dword v27, v10, s[32:35], s31 offen
    s_add_u32 s31, s28, 24576
    buffer_load_dword v28, v10, s[32:35], s31 offen
    s_add_u32 s31, s28, 36864
    buffer_load_dword v29, v10, s[32:35], s31 offen
    s_add_u32 s31, s28, 122880
    buffer_load_dword v30, v10, s[32:35], s31 offen
    s_add_u32 s31, s28, 135168
    buffer_load_dword v31, v10, s[32:35], s31 offen
    v_add_u32 v9, 4, v8
    v_lshrrev_b32 v10, 2, v9
    v_lshlrev_b32 v10, 5, v10
    v_and_b32 v11, 2, v9
    v_lshl_add_u32 v10, v11, 3, v10
    v_and_b32 v11, 1, v9
    v_lshl_add_u32 v10, v11, 2, v10
    v_mul_u32_u24 v10, 12288, v10
    v_lshl_add_u32 v10, v4, 1, v10
    s_add_u32 s31, s28, 0
    buffer_load_dword v32, v10, s[32:35], s31 offen
    s_add_u32 s31, s28, 12288
    buffer_load_dword v33, v10, s[32:35], s31 offen
    s_add_u32 s31, s28, 98304
    buffer_load_dword v34, v10, s[32:35], s31 offen
    s_add_u32 s31, s28, 110592
    buffer_load_dword v35, v10, s[32:35], s31 offen
    s_add_u32 s31, s28, 24576
    buffer_load_dword v36, v10, s[32:35], s31 offen
    s_add_u32 s31, s28, 36864
    buffer_load_dword v37, v10, s[32:35], s31 offen
    s_add_u32 s31, s28, 122880
    buffer_load_dword v38, v10, s[32:35], s31 offen
    s_add_u32 s31, s28, 135168
    buffer_load_dword v39, v10, s[32:35], s31 offen
    v_add_u32 v9, 6, v8
    v_lshrrev_b32 v10, 2, v9
    v_lshlrev_b32 v10, 5, v10
    v_and_b32 v11, 2, v9
    v_lshl_add_u32 v10, v11, 3, v10
    v_and_b32 v11, 1, v9
    v_lshl_add_u32 v10, v11, 2, v10
    v_mul_u32_u24 v10, 12288, v10
    v_lshl_add_u32 v10, v4, 1, v10
    s_add_u32 s31, s28, 0
    buffer_load_dword v40, v10, s[32:35], s31 offen
    s_add_u32 s31, s28, 12288
    buffer_load_dword v41, v10, s[32:35], s31 offen
    s_add_u32 s31, s28, 98304
    buffer_load_dword v42, v10, s[32:35], s31 offen
    s_add_u32 s31, s28, 110592
    buffer_load_dword v43, v10, s[32:35], s31 offen
    s_add_u32 s31, s28, 24576
    buffer_load_dword v44, v10, s[32:35], s31 offen
    s_add_u32 s31, s28, 36864
    buffer_load_dword v45, v10, s[32:35], s31 offen
    s_add_u32 s31, s28, 122880
    buffer_load_dword v46, v10, s[32:35], s31 offen
    s_add_u32 s31, s28, 135168
    buffer_load_dword v47, v10, s[32:35], s31 offen
    v_add_u32 v9, 8, v8
    v_lshrrev_b32 v10, 2, v9
    v_lshlrev_b32 v10, 5, v10
    v_and_b32 v11, 2, v9
    v_lshl_add_u32 v10, v11, 3, v10
    v_and_b32 v11, 1, v9
    v_lshl_add_u32 v10, v11, 2, v10
    v_mul_u32_u24 v10, 12288, v10
    v_lshl_add_u32 v10, v4, 1, v10
    s_add_u32 s31, s28, 0
    buffer_load_dword v48, v10, s[32:35], s31 offen
    s_add_u32 s31, s28, 12288
    buffer_load_dword v49, v10, s[32:35], s31 offen
    s_add_u32 s31, s28, 98304
    buffer_load_dword v50, v10, s[32:35], s31 offen
    s_add_u32 s31, s28, 110592
    buffer_load_dword v51, v10, s[32:35], s31 offen
    s_add_u32 s31, s28, 24576
    buffer_load_dword v52, v10, s[32:35], s31 offen
    s_add_u32 s31, s28, 36864
    buffer_load_dword v53, v10, s[32:35], s31 offen
    s_add_u32 s31, s28, 122880
    buffer_load_dword v54, v10, s[32:35], s31 offen
    s_add_u32 s31, s28, 135168
    buffer_load_dword v55, v10, s[32:35], s31 offen
    v_add_u32 v9, 10, v8
    v_lshrrev_b32 v10, 2, v9
    v_lshlrev_b32 v10, 5, v10
    v_and_b32 v11, 2, v9
    v_lshl_add_u32 v10, v11, 3, v10
    v_and_b32 v11, 1, v9
    v_lshl_add_u32 v10, v11, 2, v10
    v_mul_u32_u24 v10, 12288, v10
    v_lshl_add_u32 v10, v4, 1, v10
    s_add_u32 s31, s28, 0
    buffer_load_dword v56, v10, s[32:35], s31 offen
    s_add_u32 s31, s28, 12288
    buffer_load_dword v57, v10, s[32:35], s31 offen
    s_add_u32 s31, s28, 98304
    buffer_load_dword v58, v10, s[32:35], s31 offen
    s_add_u32 s31, s28, 110592
    buffer_load_dword v59, v10, s[32:35], s31 offen
    s_add_u32 s31, s28, 24576
    buffer_load_dword v60, v10, s[32:35], s31 offen
    s_add_u32 s31, s28, 36864
    buffer_load_dword v61, v10, s[32:35], s31 offen
    s_add_u32 s31, s28, 122880
    buffer_load_dword v62, v10, s[32:35], s31 offen
    s_add_u32 s31, s28, 135168
    buffer_load_dword v63, v10, s[32:35], s31 offen
    v_add_u32 v9, 12, v8
    v_lshrrev_b32 v10, 2, v9
    v_lshlrev_b32 v10, 5, v10
    v_and_b32 v11, 2, v9
    v_lshl_add_u32 v10, v11, 3, v10
    v_and_b32 v11, 1, v9
    v_lshl_add_u32 v10, v11, 2, v10
    v_mul_u32_u24 v10, 12288, v10
    v_lshl_add_u32 v10, v4, 1, v10
    s_add_u32 s31, s28, 0
    buffer_load_dword v64, v10, s[32:35], s31 offen
    s_add_u32 s31, s28, 12288
    buffer_load_dword v65, v10, s[32:35], s31 offen
    s_add_u32 s31, s28, 98304
    buffer_load_dword v66, v10, s[32:35], s31 offen
    s_add_u32 s31, s28, 110592
    buffer_load_dword v67, v10, s[32:35], s31 offen
    s_add_u32 s31, s28, 24576
    buffer_load_dword v68, v10, s[32:35], s31 offen
    s_add_u32 s31, s28, 36864
    buffer_load_dword v69, v10, s[32:35], s31 offen
    s_add_u32 s31, s28, 122880
    buffer_load_dword v70, v10, s[32:35], s31 offen
    s_add_u32 s31, s28, 135168
    buffer_load_dword v71, v10, s[32:35], s31 offen
    v_add_u32 v9, 14, v8
    v_lshrrev_b32 v10, 2, v9
    v_lshlrev_b32 v10, 5, v10
    v_and_b32 v11, 2, v9
    v_lshl_add_u32 v10, v11, 3, v10
    v_and_b32 v11, 1, v9
    v_lshl_add_u32 v10, v11, 2, v10
    v_mul_u32_u24 v10, 12288, v10
    v_lshl_add_u32 v10, v4, 1, v10
    s_add_u32 s31, s28, 0
    buffer_load_dword v72, v10, s[32:35], s31 offen
    s_add_u32 s31, s28, 12288
    buffer_load_dword v73, v10, s[32:35], s31 offen
    s_add_u32 s31, s28, 98304
    buffer_load_dword v74, v10, s[32:35], s31 offen
    s_add_u32 s31, s28, 110592
    buffer_load_dword v75, v10, s[32:35], s31 offen
    s_add_u32 s31, s28, 24576
    buffer_load_dword v76, v10, s[32:35], s31 offen
    s_add_u32 s31, s28, 36864
    buffer_load_dword v77, v10, s[32:35], s31 offen
    s_add_u32 s31, s28, 122880
    buffer_load_dword v78, v10, s[32:35], s31 offen
    s_add_u32 s31, s28, 135168
    buffer_load_dword v79, v10, s[32:35], s31 offen
    v_lshl_add_u32 v7, v8, 8, v7
    v_mov_b32 v4, 0x05040100
    v_mov_b32 v5, 0x07060302
    s_waitcnt vmcnt(56)
    v_perm_b32 v80, v17, v16, v4
    v_perm_b32 v84, v17, v16, v5
    v_perm_b32 v81, v19, v18, v4
    v_perm_b32 v85, v19, v18, v5
    v_perm_b32 v82, v21, v20, v4
    v_perm_b32 v86, v21, v20, v5
    v_perm_b32 v83, v23, v22, v4
    v_perm_b32 v87, v23, v22, v5
    buffer_store_dwordx4 v[80:83], v7, s[8:11], s30 offen offset:0
    buffer_store_dwordx4 v[84:87], v7, s[8:11], s30 offen offset:16
    s_waitcnt vmcnt(48)
    v_perm_b32 v88, v25, v24, v4
    v_perm_b32 v92, v25, v24, v5
    v_perm_b32 v89, v27, v26, v4
    v_perm_b32 v93, v27, v26, v5
    v_perm_b32 v90, v29, v28, v4
    v_perm_b32 v94, v29, v28, v5
    v_perm_b32 v91, v31, v30, v4
    v_perm_b32 v95, v31, v30, v5
    buffer_store_dwordx4 v[88:91], v7, s[8:11], s30 offen offset:512
    buffer_store_dwordx4 v[92:95], v7, s[8:11], s30 offen offset:528
    s_nop 0
    s_waitcnt vmcnt(40)
    v_perm_b32 v80, v33, v32, v4
    v_perm_b32 v84, v33, v32, v5
    v_perm_b32 v81, v35, v34, v4
    v_perm_b32 v85, v35, v34, v5
    v_perm_b32 v82, v37, v36, v4
    v_perm_b32 v86, v37, v36, v5
    v_perm_b32 v83, v39, v38, v4
    v_perm_b32 v87, v39, v38, v5
    buffer_store_dwordx4 v[80:83], v7, s[8:11], s30 offen offset:1024
    buffer_store_dwordx4 v[84:87], v7, s[8:11], s30 offen offset:1040
    s_nop 0
    s_waitcnt vmcnt(32)
    v_perm_b32 v88, v41, v40, v4
    v_perm_b32 v92, v41, v40, v5
    v_perm_b32 v89, v43, v42, v4
    v_perm_b32 v93, v43, v42, v5
    v_perm_b32 v90, v45, v44, v4
    v_perm_b32 v94, v45, v44, v5
    v_perm_b32 v91, v47, v46, v4
    v_perm_b32 v95, v47, v46, v5
    buffer_store_dwordx4 v[88:91], v7, s[8:11], s30 offen offset:1536
    buffer_store_dwordx4 v[92:95], v7, s[8:11], s30 offen offset:1552
    s_nop 0
    s_waitcnt vmcnt(24)
    v_perm_b32 v80, v49, v48, v4
    v_perm_b32 v84, v49, v48, v5
    v_perm_b32 v81, v51, v50, v4
    v_perm_b32 v85, v51, v50, v5
    v_perm_b32 v82, v53, v52, v4
    v_perm_b32 v86, v53, v52, v5
    v_perm_b32 v83, v55, v54, v4
    v_perm_b32 v87, v55, v54, v5
    buffer_store_dwordx4 v[80:83], v7, s[8:11], s30 offen offset:2048
    buffer_store_dwordx4 v[84:87], v7, s[8:11], s30 offen offset:2064
    s_nop 0
    s_waitcnt vmcnt(16)
    v_perm_b32 v88, v57, v56, v4
    v_perm_b32 v92, v57, v56, v5
    v_perm_b32 v89, v59, v58, v4
    v_perm_b32 v93, v59, v58, v5
    v_perm_b32 v90, v61, v60, v4
    v_perm_b32 v94, v61, v60, v5
    v_perm_b32 v91, v63, v62, v4
    v_perm_b32 v95, v63, v62, v5
    buffer_store_dwordx4 v[88:91], v7, s[8:11], s30 offen offset:2560
    buffer_store_dwordx4 v[92:95], v7, s[8:11], s30 offen offset:2576
    s_nop 0
    s_waitcnt vmcnt(8)
    v_perm_b32 v80, v65, v64, v4
    v_perm_b32 v84, v65, v64, v5
    v_perm_b32 v81, v67, v66, v4
    v_perm_b32 v85, v67, v66, v5
    v_perm_b32 v82, v69, v68, v4
    v_perm_b32 v86, v69, v68, v5
    v_perm_b32 v83, v71, v70, v4
    v_perm_b32 v87, v71, v70, v5
    buffer_store_dwordx4 v[80:83], v7, s[8:11], s30 offen offset:3072
    buffer_store_dwordx4 v[84:87], v7, s[8:11], s30 offen offset:3088
    s_nop 0
    s_waitcnt vmcnt(0)
    v_perm_b32 v88, v73, v72, v4
    v_perm_b32 v92, v73, v72, v5
    v_perm_b32 v89, v75, v74, v4
    v_perm_b32 v93, v75, v74, v5
    v_perm_b32 v90, v77, v76, v4
    v_perm_b32 v94, v77, v76, v5
    v_perm_b32 v91, v79, v78, v4
    v_perm_b32 v95, v79, v78, v5
    buffer_store_dwordx4 v[88:91], v7, s[8:11], s30 offen offset:3584
    buffer_store_dwordx4 v[92:95], v7, s[8:11], s30 offen offset:3600
    s_nop 0
    s_branch prep_kernel_end
prep_kernel_r_pwa:
    s_load_dwordx2 s[24:25], s[0:1], 8
    s_lshr_b32 s21, s20, 1
    s_and_b32 s22, s20, 1
    v_and_b32 v1, 31, v0
    v_lshrrev_b32 v2, 5, v0
    s_mul_i32 s23, s21, 20
    v_add_u32 v3, 640, v1
    v_add_u32 v4, 1260, v1
    v_cmp_gt_u32 vcc, 20, v1
    s_nop 1
    v_cndmask_b32 v3, v4, v3, vcc
    v_add_u32 v4, 1292, v1
    v_subrev_u32 v5, 12, v1
    v_cmp_gt_u32 vcc, 8, v1
    s_nop 1
    v_cndmask_b32 v4, v5, v4, vcc
    s_cmp_eq_u32 s22, 0
    s_cselect_b64 vcc, -1, 0
    s_nop 1
    v_cndmask_b32 v3, v4, v3, vcc
    v_add_u32 v3, s23, v3
    v_lshlrev_b32 v3, 1, v3
    v_mul_u32_u24 v4, 30720, v2
    v_add_u32 v3, v3, v4
    s_mov_b32 s26, 0xfffff0ff
    s_cmp_eq_u32 s22, 0
    s_cselect_b32 s26, -1, s26
    s_mov_b32 s27, s26
    v_mov_b32 v16, 0
    v_mov_b32 v17, 0
    v_mov_b32 v18, 0
    v_mov_b32 v19, 0
    v_mov_b32 v20, 0
    v_mov_b32 v21, 0
    v_mov_b32 v22, 0
    v_mov_b32 v23, 0
    v_mov_b32 v24, 0
    v_mov_b32 v25, 0
    v_mov_b32 v26, 0
    v_mov_b32 v27, 0
    v_mov_b32 v28, 0
    v_mov_b32 v29, 0
    v_mov_b32 v30, 0
    v_mov_b32 v31, 0
    v_mov_b32 v32, 0
    v_mov_b32 v33, 0
    v_mov_b32 v34, 0
    v_mov_b32 v35, 0
    v_mov_b32 v36, 0
    v_mov_b32 v37, 0
    v_mov_b32 v38, 0
    v_mov_b32 v39, 0
    v_mov_b32 v40, 0
    v_mov_b32 v41, 0
    v_mov_b32 v42, 0
    v_mov_b32 v43, 0
    v_mov_b32 v44, 0
    v_mov_b32 v45, 0
    v_mov_b32 v46, 0
    v_mov_b32 v47, 0
    v_mov_b32 v48, 0
    v_mov_b32 v49, 0
    v_mov_b32 v50, 0
    v_mov_b32 v51, 0
    v_mov_b32 v52, 0
    v_mov_b32 v53, 0
    v_mov_b32 v54, 0
    v_mov_b32 v55, 0
    v_mov_b32 v56, 0
    v_mov_b32 v57, 0
    v_mov_b32 v58, 0
    v_mov_b32 v59, 0
    v_mov_b32 v60, 0
    v_mov_b32 v61, 0
    v_mov_b32 v62, 0
    v_mov_b32 v63, 0
    v_mov_b32 v64, 0
    v_mov_b32 v65, 0
    v_mov_b32 v66, 0
    v_mov_b32 v67, 0
    v_mov_b32 v68, 0
    v_mov_b32 v69, 0
    v_mov_b32 v70, 0
    v_mov_b32 v71, 0
    v_mov_b32 v72, 0
    v_mov_b32 v73, 0
    v_mov_b32 v74, 0
    v_mov_b32 v75, 0
    v_mov_b32 v76, 0
    v_mov_b32 v77, 0
    v_mov_b32 v78, 0
    v_mov_b32 v79, 0
    v_mov_b32 v80, 0
    v_mov_b32 v81, 0
    v_mov_b32 v82, 0
    v_mov_b32 v83, 0
    v_mov_b32 v84, 0
    v_mov_b32 v85, 0
    v_mov_b32 v86, 0
    v_mov_b32 v87, 0
    v_mov_b32 v88, 0
    v_mov_b32 v89, 0
    v_mov_b32 v90, 0
    v_mov_b32 v91, 0
    v_mov_b32 v92, 0
    v_mov_b32 v93, 0
    v_mov_b32 v94, 0
    v_mov_b32 v95, 0
    s_waitcnt lgkmcnt(0)
    s_mov_b32 s32, s24
    s_mov_b32 s33, s25
    s_mov_b32 s34, 2457600
    s_mov_b32 s35, 0x00020000
    s_mul_i32 s28, s13, 614400
    s_mov_b64 exec, s[26:27]
    s_add_u32 s29, s28, 0
    buffer_load_short_d16_hi v16, v3, s[32:35], s29 offen
    s_add_u32 s29, s28, 3840
    buffer_load_short_d16_hi v17, v3, s[32:35], s29 offen
    s_add_u32 s29, s28, 7680
    buffer_load_short_d16_hi v18, v3, s[32:35], s29 offen
    s_add_u32 s29, s28, 11520
    buffer_load_short_d16_hi v19, v3, s[32:35], s29 offen
    s_add_u32 s29, s28, 15360
    buffer_load_short_d16_hi v20, v3, s[32:35], s29 offen
    s_add_u32 s29, s28, 19200
    buffer_load_short_d16_hi v21, v3, s[32:35], s29 offen
    s_add_u32 s29, s28, 23040
    buffer_load_short_d16_hi v22, v3, s[32:35], s29 offen
    s_add_u32 s29, s28, 26880
    buffer_load_short_d16_hi v23, v3, s[32:35], s29 offen
    s_add_u32 s29, s28, 61440
    buffer_load_short_d16_hi v24, v3, s[32:35], s29 offen
    s_add_u32 s29, s28, 65280
    buffer_load_short_d16_hi v25, v3, s[32:35], s29 offen
    s_add_u32 s29, s28, 69120
    buffer_load_short_d16_hi v26, v3, s[32:35], s29 offen
    s_add_u32 s29, s28, 72960
    buffer_load_short_d16_hi v27, v3, s[32:35], s29 offen
    s_add_u32 s29, s28, 76800
    buffer_load_short_d16_hi v28, v3, s[32:35], s29 offen
    s_add_u32 s29, s28, 80640
    buffer_load_short_d16_hi v29, v3, s[32:35], s29 offen
    s_add_u32 s29, s28, 84480
    buffer_load_short_d16_hi v30, v3, s[32:35], s29 offen
    s_add_u32 s29, s28, 88320
    buffer_load_short_d16_hi v31, v3, s[32:35], s29 offen
    s_add_u32 s29, s28, 122880
    buffer_load_short_d16_hi v32, v3, s[32:35], s29 offen
    s_add_u32 s29, s28, 126720
    buffer_load_short_d16_hi v33, v3, s[32:35], s29 offen
    s_add_u32 s29, s28, 130560
    buffer_load_short_d16_hi v34, v3, s[32:35], s29 offen
    s_add_u32 s29, s28, 134400
    buffer_load_short_d16_hi v35, v3, s[32:35], s29 offen
    s_add_u32 s29, s28, 138240
    buffer_load_short_d16_hi v36, v3, s[32:35], s29 offen
    s_add_u32 s29, s28, 142080
    buffer_load_short_d16_hi v37, v3, s[32:35], s29 offen
    s_add_u32 s29, s28, 145920
    buffer_load_short_d16_hi v38, v3, s[32:35], s29 offen
    s_add_u32 s29, s28, 149760
    buffer_load_short_d16_hi v39, v3, s[32:35], s29 offen
    s_add_u32 s29, s28, 184320
    buffer_load_short_d16_hi v40, v3, s[32:35], s29 offen
    s_add_u32 s29, s28, 188160
    buffer_load_short_d16_hi v41, v3, s[32:35], s29 offen
    s_add_u32 s29, s28, 192000
    buffer_load_short_d16_hi v42, v3, s[32:35], s29 offen
    s_add_u32 s29, s28, 195840
    buffer_load_short_d16_hi v43, v3, s[32:35], s29 offen
    s_add_u32 s29, s28, 199680
    buffer_load_short_d16_hi v44, v3, s[32:35], s29 offen
    s_add_u32 s29, s28, 203520
    buffer_load_short_d16_hi v45, v3, s[32:35], s29 offen
    s_add_u32 s29, s28, 207360
    buffer_load_short_d16_hi v46, v3, s[32:35], s29 offen
    s_add_u32 s29, s28, 211200
    buffer_load_short_d16_hi v47, v3, s[32:35], s29 offen
    s_add_u32 s29, s28, 245760
    buffer_load_short_d16_hi v48, v3, s[32:35], s29 offen
    s_add_u32 s29, s28, 249600
    buffer_load_short_d16_hi v49, v3, s[32:35], s29 offen
    s_add_u32 s29, s28, 253440
    buffer_load_short_d16_hi v50, v3, s[32:35], s29 offen
    s_add_u32 s29, s28, 257280
    buffer_load_short_d16_hi v51, v3, s[32:35], s29 offen
    s_add_u32 s29, s28, 261120
    buffer_load_short_d16_hi v52, v3, s[32:35], s29 offen
    s_add_u32 s29, s28, 264960
    buffer_load_short_d16_hi v53, v3, s[32:35], s29 offen
    s_add_u32 s29, s28, 268800
    buffer_load_short_d16_hi v54, v3, s[32:35], s29 offen
    s_add_u32 s29, s28, 272640
    buffer_load_short_d16_hi v55, v3, s[32:35], s29 offen
    s_add_u32 s29, s28, 307200
    buffer_load_short_d16_hi v56, v3, s[32:35], s29 offen
    s_add_u32 s29, s28, 311040
    buffer_load_short_d16_hi v57, v3, s[32:35], s29 offen
    s_add_u32 s29, s28, 314880
    buffer_load_short_d16_hi v58, v3, s[32:35], s29 offen
    s_add_u32 s29, s28, 318720
    buffer_load_short_d16_hi v59, v3, s[32:35], s29 offen
    s_add_u32 s29, s28, 322560
    buffer_load_short_d16_hi v60, v3, s[32:35], s29 offen
    s_add_u32 s29, s28, 326400
    buffer_load_short_d16_hi v61, v3, s[32:35], s29 offen
    s_add_u32 s29, s28, 330240
    buffer_load_short_d16_hi v62, v3, s[32:35], s29 offen
    s_add_u32 s29, s28, 334080
    buffer_load_short_d16_hi v63, v3, s[32:35], s29 offen
    s_add_u32 s29, s28, 368640
    buffer_load_short_d16_hi v64, v3, s[32:35], s29 offen
    s_add_u32 s29, s28, 372480
    buffer_load_short_d16_hi v65, v3, s[32:35], s29 offen
    s_add_u32 s29, s28, 376320
    buffer_load_short_d16_hi v66, v3, s[32:35], s29 offen
    s_add_u32 s29, s28, 380160
    buffer_load_short_d16_hi v67, v3, s[32:35], s29 offen
    s_add_u32 s29, s28, 384000
    buffer_load_short_d16_hi v68, v3, s[32:35], s29 offen
    s_add_u32 s29, s28, 387840
    buffer_load_short_d16_hi v69, v3, s[32:35], s29 offen
    s_add_u32 s29, s28, 391680
    buffer_load_short_d16_hi v70, v3, s[32:35], s29 offen
    s_add_u32 s29, s28, 395520
    buffer_load_short_d16_hi v71, v3, s[32:35], s29 offen
    s_add_u32 s29, s28, 430080
    buffer_load_short_d16_hi v72, v3, s[32:35], s29 offen
    s_add_u32 s29, s28, 433920
    buffer_load_short_d16_hi v73, v3, s[32:35], s29 offen
    s_add_u32 s29, s28, 437760
    buffer_load_short_d16_hi v74, v3, s[32:35], s29 offen
    s_add_u32 s29, s28, 441600
    buffer_load_short_d16_hi v75, v3, s[32:35], s29 offen
    s_add_u32 s29, s28, 445440
    buffer_load_short_d16_hi v76, v3, s[32:35], s29 offen
    s_add_u32 s29, s28, 449280
    buffer_load_short_d16_hi v77, v3, s[32:35], s29 offen
    s_add_u32 s29, s28, 453120
    buffer_load_short_d16_hi v78, v3, s[32:35], s29 offen
    s_add_u32 s29, s28, 456960
    buffer_load_short_d16_hi v79, v3, s[32:35], s29 offen
    s_add_u32 s29, s28, 491520
    buffer_load_short_d16_hi v80, v3, s[32:35], s29 offen
    s_add_u32 s29, s28, 495360
    buffer_load_short_d16_hi v81, v3, s[32:35], s29 offen
    s_add_u32 s29, s28, 499200
    buffer_load_short_d16_hi v82, v3, s[32:35], s29 offen
    s_add_u32 s29, s28, 503040
    buffer_load_short_d16_hi v83, v3, s[32:35], s29 offen
    s_add_u32 s29, s28, 506880
    buffer_load_short_d16_hi v84, v3, s[32:35], s29 offen
    s_add_u32 s29, s28, 510720
    buffer_load_short_d16_hi v85, v3, s[32:35], s29 offen
    s_add_u32 s29, s28, 514560
    buffer_load_short_d16_hi v86, v3, s[32:35], s29 offen
    s_add_u32 s29, s28, 518400
    buffer_load_short_d16_hi v87, v3, s[32:35], s29 offen
    s_add_u32 s29, s28, 552960
    buffer_load_short_d16_hi v88, v3, s[32:35], s29 offen
    s_add_u32 s29, s28, 556800
    buffer_load_short_d16_hi v89, v3, s[32:35], s29 offen
    s_add_u32 s29, s28, 560640
    buffer_load_short_d16_hi v90, v3, s[32:35], s29 offen
    s_add_u32 s29, s28, 564480
    buffer_load_short_d16_hi v91, v3, s[32:35], s29 offen
    s_add_u32 s29, s28, 568320
    buffer_load_short_d16_hi v92, v3, s[32:35], s29 offen
    s_add_u32 s29, s28, 572160
    buffer_load_short_d16_hi v93, v3, s[32:35], s29 offen
    s_add_u32 s29, s28, 576000
    buffer_load_short_d16_hi v94, v3, s[32:35], s29 offen
    s_add_u32 s29, s28, 579840
    buffer_load_short_d16_hi v95, v3, s[32:35], s29 offen
    s_mov_b64 exec, -1
    s_waitcnt vmcnt(0)
    v_add_f32 v5, v16, v17
    v_add_f32 v5, v5, v18
    v_add_f32 v5, v5, v19
    v_add_f32 v5, v5, v20
    v_add_f32 v5, v5, v21
    v_add_f32 v5, v5, v22
    v_add_f32 v5, v5, v23
    v_add_f32 v5, v5, v24
    v_add_f32 v5, v5, v25
    v_add_f32 v5, v5, v26
    v_add_f32 v5, v5, v27
    v_add_f32 v5, v5, v28
    v_add_f32 v5, v5, v29
    v_add_f32 v5, v5, v30
    v_add_f32 v5, v5, v31
    v_add_f32 v5, v5, v32
    v_add_f32 v5, v5, v33
    v_add_f32 v5, v5, v34
    v_add_f32 v5, v5, v35
    v_add_f32 v5, v5, v36
    v_add_f32 v5, v5, v37
    v_add_f32 v5, v5, v38
    v_add_f32 v5, v5, v39
    v_add_f32 v5, v5, v40
    v_add_f32 v5, v5, v41
    v_add_f32 v5, v5, v42
    v_add_f32 v5, v5, v43
    v_add_f32 v5, v5, v44
    v_add_f32 v5, v5, v45
    v_add_f32 v5, v5, v46
    v_add_f32 v5, v5, v47
    v_add_f32 v5, v5, v48
    v_add_f32 v5, v5, v49
    v_add_f32 v5, v5, v50
    v_add_f32 v5, v5, v51
    v_add_f32 v5, v5, v52
    v_add_f32 v5, v5, v53
    v_add_f32 v5, v5, v54
    v_add_f32 v5, v5, v55
    v_add_f32 v5, v5, v56
    v_add_f32 v5, v5, v57
    v_add_f32 v5, v5, v58
    v_add_f32 v5, v5, v59
    v_add_f32 v5, v5, v60
    v_add_f32 v5, v5, v61
    v_add_f32 v5, v5, v62
    v_add_f32 v5, v5, v63
    v_add_f32 v5, v5, v64
    v_add_f32 v5, v5, v65
    v_add_f32 v5, v5, v66
    v_add_f32 v5, v5, v67
    v_add_f32 v5, v5, v68
    v_add_f32 v5, v5, v69
    v_add_f32 v5, v5, v70
    v_add_f32 v5, v5, v71
    v_add_f32 v5, v5, v72
    v_add_f32 v5, v5, v73
    v_add_f32 v5, v5, v74
    v_add_f32 v5, v5, v75
    v_add_f32 v5, v5, v76
    v_add_f32 v5, v5, v77
    v_add_f32 v5, v5, v78
    v_add_f32 v5, v5, v79
    v_add_f32 v5, v5, v80
    v_add_f32 v5, v5, v81
    v_add_f32 v5, v5, v82
    v_add_f32 v5, v5, v83
    v_add_f32 v5, v5, v84
    v_add_f32 v5, v5, v85
    v_add_f32 v5, v5, v86
    v_add_f32 v5, v5, v87
    v_add_f32 v5, v5, v88
    v_add_f32 v5, v5, v89
    v_add_f32 v5, v5, v90
    v_add_f32 v5, v5, v91
    v_add_f32 v5, v5, v92
    v_add_f32 v5, v5, v93
    v_add_f32 v5, v5, v94
    v_add_f32 v5, v5, v95
    v_mov_b32 v6, v5
    s_nop 1
    v_permlane32_swap_b32 v5, v6
    v_add_f32 v5, v5, v6
    s_lshl_b32 s29, s13, 8
    v_lshlrev_b32 v7, 2, v0
    v_add_u32 v8, s29, v7
    ds_write_b32 v8, v5
    s_waitcnt lgkmcnt(0)
    s_barrier
    ds_read_b32 v8, v7 offset:0
    ds_read_b32 v9, v7 offset:256
    ds_read_b32 v10, v7 offset:512
    ds_read_b32 v11, v7 offset:768
    s_waitcnt lgkmcnt(0)
    v_add_f32 v8, v8, v9
    v_add_f32 v10, v10, v11
    v_add_f32 v8, v8, v10
    v_mul_f32 v8, 0x3acccccd, v8
    v_sub_f32 v16, v16, v8
    v_sub_f32 v17, v17, v8
    v_sub_f32 v18, v18, v8
    v_sub_f32 v19, v19, v8
    v_sub_f32 v20, v20, v8
    v_sub_f32 v21, v21, v8
    v_sub_f32 v22, v22, v8
    v_sub_f32 v23, v23, v8
    v_sub_f32 v24, v24, v8
    v_sub_f32 v25, v25, v8
    v_sub_f32 v26, v26, v8
    v_sub_f32 v27, v27, v8
    v_sub_f32 v28, v28, v8
    v_sub_f32 v29, v29, v8
    v_sub_f32 v30, v30, v8
    v_sub_f32 v31, v31, v8
    v_sub_f32 v32, v32, v8
    v_sub_f32 v33, v33, v8
    v_sub_f32 v34, v34, v8
    v_sub_f32 v35, v35, v8
    v_sub_f32 v36, v36, v8
    v_sub_f32 v37, v37, v8
    v_sub_f32 v38, v38, v8
    v_sub_f32 v39, v39, v8
    v_sub_f32 v40, v40, v8
    v_sub_f32 v41, v41, v8
    v_sub_f32 v42, v42, v8
    v_sub_f32 v43, v43, v8
    v_sub_f32 v44, v44, v8
    v_sub_f32 v45, v45, v8
    v_sub_f32 v46, v46, v8
    v_sub_f32 v47, v47, v8
    v_sub_f32 v48, v48, v8
    v_sub_f32 v49, v49, v8
    v_sub_f32 v50, v50, v8
    v_sub_f32 v51, v51, v8
    v_sub_f32 v52, v52, v8
    v_sub_f32 v53, v53, v8
    v_sub_f32 v54, v54, v8
    v_sub_f32 v55, v55, v8
    v_sub_f32 v56, v56, v8
    v_sub_f32 v57, v57, v8
    v_sub_f32 v58, v58, v8
    v_sub_f32 v59, v59, v8
    v_sub_f32 v60, v60, v8
    v_sub_f32 v61, v61, v8
    v_sub_f32 v62, v62, v8
    v_sub_f32 v63, v63, v8
    v_sub_f32 v64, v64, v8
    v_sub_f32 v65, v65, v8
    v_sub_f32 v66, v66, v8
    v_sub_f32 v67, v67, v8
    v_sub_f32 v68, v68, v8
    v_sub_f32 v69, v69, v8
    v_sub_f32 v70, v70, v8
    v_sub_f32 v71, v71, v8
    v_sub_f32 v72, v72, v8
    v_sub_f32 v73, v73, v8
    v_sub_f32 v74, v74, v8
    v_sub_f32 v75, v75, v8
    v_sub_f32 v76, v76, v8
    v_sub_f32 v77, v77, v8
    v_sub_f32 v78, v78, v8
    v_sub_f32 v79, v79, v8
    v_sub_f32 v80, v80, v8
    v_sub_f32 v81, v81, v8
    v_sub_f32 v82, v82, v8
    v_sub_f32 v83, v83, v8
    v_sub_f32 v84, v84, v8
    v_sub_f32 v85, v85, v8
    v_sub_f32 v86, v86, v8
    v_sub_f32 v87, v87, v8
    v_sub_f32 v88, v88, v8
    v_sub_f32 v89, v89, v8
    v_sub_f32 v90, v90, v8
    v_sub_f32 v91, v91, v8
    v_sub_f32 v92, v92, v8
    v_sub_f32 v93, v93, v8
    v_sub_f32 v94, v94, v8
    v_sub_f32 v95, v95, v8
    s_lshl_b32 s26, s22, 9
    s_mov_b32 s27, s26
    v_cndmask_b32 v16, v16, 1.0, s[26:27]
    v_cndmask_b32 v17, v17, 1.0, s[26:27]
    v_cndmask_b32 v18, v18, 1.0, s[26:27]
    v_cndmask_b32 v19, v19, 1.0, s[26:27]
    v_cndmask_b32 v20, v20, 1.0, s[26:27]
    v_cndmask_b32 v21, v21, 1.0, s[26:27]
    v_cndmask_b32 v22, v22, 1.0, s[26:27]
    v_cndmask_b32 v23, v23, 1.0, s[26:27]
    v_cndmask_b32 v24, v24, 1.0, s[26:27]
    v_cndmask_b32 v25, v25, 1.0, s[26:27]
    v_cndmask_b32 v26, v26, 1.0, s[26:27]
    v_cndmask_b32 v27, v27, 1.0, s[26:27]
    v_cndmask_b32 v28, v28, 1.0, s[26:27]
    v_cndmask_b32 v29, v29, 1.0, s[26:27]
    v_cndmask_b32 v30, v30, 1.0, s[26:27]
    v_cndmask_b32 v31, v31, 1.0, s[26:27]
    v_cndmask_b32 v32, v32, 1.0, s[26:27]
    v_cndmask_b32 v33, v33, 1.0, s[26:27]
    v_cndmask_b32 v34, v34, 1.0, s[26:27]
    v_cndmask_b32 v35, v35, 1.0, s[26:27]
    v_cndmask_b32 v36, v36, 1.0, s[26:27]
    v_cndmask_b32 v37, v37, 1.0, s[26:27]
    v_cndmask_b32 v38, v38, 1.0, s[26:27]
    v_cndmask_b32 v39, v39, 1.0, s[26:27]
    v_cndmask_b32 v40, v40, 1.0, s[26:27]
    v_cndmask_b32 v41, v41, 1.0, s[26:27]
    v_cndmask_b32 v42, v42, 1.0, s[26:27]
    v_cndmask_b32 v43, v43, 1.0, s[26:27]
    v_cndmask_b32 v44, v44, 1.0, s[26:27]
    v_cndmask_b32 v45, v45, 1.0, s[26:27]
    v_cndmask_b32 v46, v46, 1.0, s[26:27]
    v_cndmask_b32 v47, v47, 1.0, s[26:27]
    v_cndmask_b32 v48, v48, 1.0, s[26:27]
    v_cndmask_b32 v49, v49, 1.0, s[26:27]
    v_cndmask_b32 v50, v50, 1.0, s[26:27]
    v_cndmask_b32 v51, v51, 1.0, s[26:27]
    v_cndmask_b32 v52, v52, 1.0, s[26:27]
    v_cndmask_b32 v53, v53, 1.0, s[26:27]
    v_cndmask_b32 v54, v54, 1.0, s[26:27]
    v_cndmask_b32 v55, v55, 1.0, s[26:27]
    v_cndmask_b32 v56, v56, 1.0, s[26:27]
    v_cndmask_b32 v57, v57, 1.0, s[26:27]
    v_cndmask_b32 v58, v58, 1.0, s[26:27]
    v_cndmask_b32 v59, v59, 1.0, s[26:27]
    v_cndmask_b32 v60, v60, 1.0, s[26:27]
    v_cndmask_b32 v61, v61, 1.0, s[26:27]
    v_cndmask_b32 v62, v62, 1.0, s[26:27]
    v_cndmask_b32 v63, v63, 1.0, s[26:27]
    v_cndmask_b32 v64, v64, 1.0, s[26:27]
    v_cndmask_b32 v65, v65, 1.0, s[26:27]
    v_cndmask_b32 v66, v66, 1.0, s[26:27]
    v_cndmask_b32 v67, v67, 1.0, s[26:27]
    v_cndmask_b32 v68, v68, 1.0, s[26:27]
    v_cndmask_b32 v69, v69, 1.0, s[26:27]
    v_cndmask_b32 v70, v70, 1.0, s[26:27]
    v_cndmask_b32 v71, v71, 1.0, s[26:27]
    v_cndmask_b32 v72, v72, 1.0, s[26:27]
    v_cndmask_b32 v73, v73, 1.0, s[26:27]
    v_cndmask_b32 v74, v74, 1.0, s[26:27]
    v_cndmask_b32 v75, v75, 1.0, s[26:27]
    v_cndmask_b32 v76, v76, 1.0, s[26:27]
    v_cndmask_b32 v77, v77, 1.0, s[26:27]
    v_cndmask_b32 v78, v78, 1.0, s[26:27]
    v_cndmask_b32 v79, v79, 1.0, s[26:27]
    v_cndmask_b32 v80, v80, 1.0, s[26:27]
    v_cndmask_b32 v81, v81, 1.0, s[26:27]
    v_cndmask_b32 v82, v82, 1.0, s[26:27]
    v_cndmask_b32 v83, v83, 1.0, s[26:27]
    v_cndmask_b32 v84, v84, 1.0, s[26:27]
    v_cndmask_b32 v85, v85, 1.0, s[26:27]
    v_cndmask_b32 v86, v86, 1.0, s[26:27]
    v_cndmask_b32 v87, v87, 1.0, s[26:27]
    v_cndmask_b32 v88, v88, 1.0, s[26:27]
    v_cndmask_b32 v89, v89, 1.0, s[26:27]
    v_cndmask_b32 v90, v90, 1.0, s[26:27]
    v_cndmask_b32 v91, v91, 1.0, s[26:27]
    v_cndmask_b32 v92, v92, 1.0, s[26:27]
    v_cndmask_b32 v93, v93, 1.0, s[26:27]
    v_cndmask_b32 v94, v94, 1.0, s[26:27]
    v_cndmask_b32 v95, v95, 1.0, s[26:27]
    s_mul_i32 s29, s21, 81920
    s_lshl_b32 s30, s22, 10
    s_add_u32 s29, s29, s30
    s_mul_i32 s30, s13, 20480
    s_add_u32 s29, s29, s30
    s_add_u32 s29, s29, 243269632
    v_lshlrev_b32 v7, 4, v0
    v_cvt_pk_bf16_f32 v100, v16, v17
    v_cvt_pk_bf16_f32 v101, v18, v19
    v_cvt_pk_bf16_f32 v102, v20, v21
    v_cvt_pk_bf16_f32 v103, v22, v23
    buffer_store_dwordx4 v[100:103], v7, s[8:11], s29 offen
    s_add_u32 s29, s29, 2048
    v_cvt_pk_bf16_f32 v104, v24, v25
    v_cvt_pk_bf16_f32 v105, v26, v27
    v_cvt_pk_bf16_f32 v106, v28, v29
    v_cvt_pk_bf16_f32 v107, v30, v31
    buffer_store_dwordx4 v[104:107], v7, s[8:11], s29 offen
    s_add_u32 s29, s29, 2048
    v_cvt_pk_bf16_f32 v100, v32, v33
    v_cvt_pk_bf16_f32 v101, v34, v35
    v_cvt_pk_bf16_f32 v102, v36, v37
    v_cvt_pk_bf16_f32 v103, v38, v39
    buffer_store_dwordx4 v[100:103], v7, s[8:11], s29 offen
    s_add_u32 s29, s29, 2048
    v_cvt_pk_bf16_f32 v104, v40, v41
    v_cvt_pk_bf16_f32 v105, v42, v43
    v_cvt_pk_bf16_f32 v106, v44, v45
    v_cvt_pk_bf16_f32 v107, v46, v47
    buffer_store_dwordx4 v[104:107], v7, s[8:11], s29 offen
    s_add_u32 s29, s29, 2048
    v_cvt_pk_bf16_f32 v100, v48, v49
    v_cvt_pk_bf16_f32 v101, v50, v51
    v_cvt_pk_bf16_f32 v102, v52, v53
    v_cvt_pk_bf16_f32 v103, v54, v55
    buffer_store_dwordx4 v[100:103], v7, s[8:11], s29 offen
    s_add_u32 s29, s29, 2048
    v_cvt_pk_bf16_f32 v104, v56, v57
    v_cvt_pk_bf16_f32 v105, v58, v59
    v_cvt_pk_bf16_f32 v106, v60, v61
    v_cvt_pk_bf16_f32 v107, v62, v63
    buffer_store_dwordx4 v[104:107], v7, s[8:11], s29 offen
    s_add_u32 s29, s29, 2048
    v_cvt_pk_bf16_f32 v100, v64, v65
    v_cvt_pk_bf16_f32 v101, v66, v67
    v_cvt_pk_bf16_f32 v102, v68, v69
    v_cvt_pk_bf16_f32 v103, v70, v71
    buffer_store_dwordx4 v[100:103], v7, s[8:11], s29 offen
    s_add_u32 s29, s29, 2048
    v_cvt_pk_bf16_f32 v104, v72, v73
    v_cvt_pk_bf16_f32 v105, v74, v75
    v_cvt_pk_bf16_f32 v106, v76, v77
    v_cvt_pk_bf16_f32 v107, v78, v79
    buffer_store_dwordx4 v[104:107], v7, s[8:11], s29 offen
    s_add_u32 s29, s29, 2048
    v_cvt_pk_bf16_f32 v100, v80, v81
    v_cvt_pk_bf16_f32 v101, v82, v83
    v_cvt_pk_bf16_f32 v102, v84, v85
    v_cvt_pk_bf16_f32 v103, v86, v87
    buffer_store_dwordx4 v[100:103], v7, s[8:11], s29 offen
    s_add_u32 s29, s29, 2048
    v_cvt_pk_bf16_f32 v104, v88, v89
    v_cvt_pk_bf16_f32 v105, v90, v91
    v_cvt_pk_bf16_f32 v106, v92, v93
    v_cvt_pk_bf16_f32 v107, v94, v95
    buffer_store_dwordx4 v[104:107], v7, s[8:11], s29 offen
    s_add_u32 s29, s29, 2048
    s_branch prep_kernel_end
prep_kernel_r_pwo:
    s_lshl_b32 s20, s20, 2
    s_add_u32 s20, s20, s13
    s_load_dwordx2 s[24:25], s[0:1], 16
    s_lshr_b32 s21, s20, 3
    s_and_b32 s22, s20, 7
    v_and_b32 v1, 31, v0
    v_lshrrev_b32 v2, 5, v0
    v_lshlrev_b32 v3, 1, v1
    v_mul_u32_u24 v4, 10240, v2
    v_add_u32 v3, v3, v4
    s_lshl_b32 s29, s21, 6
    s_mul_i32 s30, s22, 102400
    s_add_u32 s29, s29, s30
    s_waitcnt lgkmcnt(0)
    s_mov_b32 s32, s24
    s_mov_b32 s33, s25
    s_mov_b32 s34, 819200
    s_mov_b32 s35, 0x00020000
    s_add_u32 s30, s29, 0
    buffer_load_ushort v16, v3, s[32:35], s30 offen
    s_add_u32 s30, s29, 1280
    buffer_load_ushort v17, v3, s[32:35], s30 offen
    s_add_u32 s30, s29, 2560
    buffer_load_ushort v18, v3, s[32:35], s30 offen
    s_add_u32 s30, s29, 3840
    buffer_load_ushort v19, v3, s[32:35], s30 offen
    s_add_u32 s30, s29, 5120
    buffer_load_ushort v20, v3, s[32:35], s30 offen
    s_add_u32 s30, s29, 6400
    buffer_load_ushort v21, v3, s[32:35], s30 offen
    s_add_u32 s30, s29, 7680
    buffer_load_ushort v22, v3, s[32:35], s30 offen
    s_add_u32 s30, s29, 8960
    buffer_load_ushort v23, v3, s[32:35], s30 offen
    s_add_u32 s30, s29, 20480
    buffer_load_ushort v24, v3, s[32:35], s30 offen
    s_add_u32 s30, s29, 21760
    buffer_load_ushort v25, v3, s[32:35], s30 offen
    s_add_u32 s30, s29, 23040
    buffer_load_ushort v26, v3, s[32:35], s30 offen
    s_add_u32 s30, s29, 24320
    buffer_load_ushort v27, v3, s[32:35], s30 offen
    s_add_u32 s30, s29, 25600
    buffer_load_ushort v28, v3, s[32:35], s30 offen
    s_add_u32 s30, s29, 26880
    buffer_load_ushort v29, v3, s[32:35], s30 offen
    s_add_u32 s30, s29, 28160
    buffer_load_ushort v30, v3, s[32:35], s30 offen
    s_add_u32 s30, s29, 29440
    buffer_load_ushort v31, v3, s[32:35], s30 offen
    s_add_u32 s30, s29, 40960
    buffer_load_ushort v32, v3, s[32:35], s30 offen
    s_add_u32 s30, s29, 42240
    buffer_load_ushort v33, v3, s[32:35], s30 offen
    s_add_u32 s30, s29, 43520
    buffer_load_ushort v34, v3, s[32:35], s30 offen
    s_add_u32 s30, s29, 44800
    buffer_load_ushort v35, v3, s[32:35], s30 offen
    s_add_u32 s30, s29, 46080
    buffer_load_ushort v36, v3, s[32:35], s30 offen
    s_add_u32 s30, s29, 47360
    buffer_load_ushort v37, v3, s[32:35], s30 offen
    s_add_u32 s30, s29, 48640
    buffer_load_ushort v38, v3, s[32:35], s30 offen
    s_add_u32 s30, s29, 49920
    buffer_load_ushort v39, v3, s[32:35], s30 offen
    s_add_u32 s30, s29, 61440
    buffer_load_ushort v40, v3, s[32:35], s30 offen
    s_add_u32 s30, s29, 62720
    buffer_load_ushort v41, v3, s[32:35], s30 offen
    s_add_u32 s30, s29, 64000
    buffer_load_ushort v42, v3, s[32:35], s30 offen
    s_add_u32 s30, s29, 65280
    buffer_load_ushort v43, v3, s[32:35], s30 offen
    s_add_u32 s30, s29, 66560
    buffer_load_ushort v44, v3, s[32:35], s30 offen
    s_add_u32 s30, s29, 67840
    buffer_load_ushort v45, v3, s[32:35], s30 offen
    s_add_u32 s30, s29, 69120
    buffer_load_ushort v46, v3, s[32:35], s30 offen
    s_add_u32 s30, s29, 70400
    buffer_load_ushort v47, v3, s[32:35], s30 offen
    s_add_u32 s30, s29, 81920
    buffer_load_ushort v48, v3, s[32:35], s30 offen
    s_add_u32 s30, s29, 83200
    buffer_load_ushort v49, v3, s[32:35], s30 offen
    s_add_u32 s30, s29, 84480
    buffer_load_ushort v50, v3, s[32:35], s30 offen
    s_add_u32 s30, s29, 85760
    buffer_load_ushort v51, v3, s[32:35], s30 offen
    s_add_u32 s30, s29, 87040
    buffer_load_ushort v52, v3, s[32:35], s30 offen
    s_add_u32 s30, s29, 88320
    buffer_load_ushort v53, v3, s[32:35], s30 offen
    s_add_u32 s30, s29, 89600
    buffer_load_ushort v54, v3, s[32:35], s30 offen
    s_add_u32 s30, s29, 90880
    buffer_load_ushort v55, v3, s[32:35], s30 offen
    s_mul_i32 s29, s20, 5120
    s_add_u32 s29, s29, 246415360
    v_lshlrev_b32 v7, 4, v0
    s_waitcnt vmcnt(32)
    v_lshl_or_b32 v64, v17, 16, v16
    v_lshl_or_b32 v65, v19, 16, v18
    v_lshl_or_b32 v66, v21, 16, v20
    v_lshl_or_b32 v67, v23, 16, v22
    buffer_store_dwordx4 v[64:67], v7, s[8:11], s29 offen offset:0
    s_waitcnt vmcnt(25)
    v_lshl_or_b32 v68, v25, 16, v24
    v_lshl_or_b32 v69, v27, 16, v26
    v_lshl_or_b32 v70, v29, 16, v28
    v_lshl_or_b32 v71, v31, 16, v30
    buffer_store_dwordx4 v[68:71], v7, s[8:11], s29 offen offset:1024
    s_waitcnt vmcnt(18)
    v_lshl_or_b32 v72, v33, 16, v32
    v_lshl_or_b32 v73, v35, 16, v34
    v_lshl_or_b32 v74, v37, 16, v36
    v_lshl_or_b32 v75, v39, 16, v38
    buffer_store_dwordx4 v[72:75], v7, s[8:11], s29 offen offset:2048
    s_waitcnt vmcnt(11)
    v_lshl_or_b32 v76, v41, 16, v40
    v_lshl_or_b32 v77, v43, 16, v42
    v_lshl_or_b32 v78, v45, 16, v44
    v_lshl_or_b32 v79, v47, 16, v46
    buffer_store_dwordx4 v[76:79], v7, s[8:11], s29 offen offset:3072
    s_add_u32 s29, s29, 4096
    s_waitcnt vmcnt(4)
    v_lshl_or_b32 v80, v49, 16, v48
    v_lshl_or_b32 v81, v51, 16, v50
    v_lshl_or_b32 v82, v53, 16, v52
    v_lshl_or_b32 v83, v55, 16, v54
    buffer_store_dwordx4 v[80:83], v7, s[8:11], s29 offen offset:0
    s_branch prep_kernel_end
prep_kernel_end:
    s_endpgm
.section .rodata,"a"
.p2align 6
.amdhsa_kernel prep_kernel
  .amdhsa_next_free_vgpr 160
  .amdhsa_next_free_sgpr 64
  .amdhsa_accum_offset 160
  .amdhsa_group_segment_fixed_size 0
  .amdhsa_kernarg_size 104
  .amdhsa_user_sgpr_count 2
  .amdhsa_user_sgpr_kernarg_segment_ptr 1
  .amdhsa_system_sgpr_workgroup_id_x 1
.end_amdhsa_kernel
.text
.globl layerb2_kernel
.p2align 8
.type layerb2_kernel,@function
layerb2_kernel:
    s_mov_b32 s49, 1
    s_branch layerb1_kernel_body
    s_endpgm
.section .rodata,"a"
.p2align 6
.amdhsa_kernel layerb2_kernel
  .amdhsa_next_free_vgpr 512
  .amdhsa_next_free_sgpr 100
  .amdhsa_accum_offset 256
  .amdhsa_group_segment_fixed_size 0
  .amdhsa_kernarg_size 104
  .amdhsa_user_sgpr_count 2
  .amdhsa_user_sgpr_kernarg_segment_ptr 1
  .amdhsa_system_sgpr_workgroup_id_x 1
.end_amdhsa_kernel
.text
.globl layerb1_kernel
.p2align 8
.type layerb1_kernel,@function
layerb1_kernel:
    s_mov_b32 s49, 0
layerb1_kernel_body:
    s_cmp_ge_u32 s2, 256
    s_cbranch_scc1 layerb1_kernel_end0
    s_load_dwordx2 s[4:5], s[0:1], 96
    s_load_dwordx2 s[6:7], s[0:1], 80
    v_lshrrev_b32 v1, 6, v0
    v_and_b32 v0, 63, v0
    s_nop 0
    v_readfirstlane_b32 s13, v1
    s_mov_b32 s15, 400000
    s_waitcnt lgkmcnt(0)
    s_mov_b32 s8, s4
    s_mov_b32 s9, s5
    s_mov_b32 s10, 268435456
    s_mov_b32 s11, 0x00020000
    s_mul_i32 s48, s49, 65536
    s_add_u32 s48, s48, 10616832
    s_lshl_b32 s60, s49, 11
    s_add_u32 s60, s60, 10485760
    s_getreg_b32 s61, hwreg(HW_REG_XCC_ID)
    s_and_b32 s61, s61, 7
    s_cmp_lg_u32 s13, 0
    s_cbranch_scc1 layerb1_kernel_tk_p1
    s_lshl_b32 s63, s61, 8
    s_add_u32 s63, s63, s60
    s_mov_b64 exec, 1
    v_mov_b32 v230, 0
    v_mov_b32 v231, 1
    buffer_atomic_add v231, v230, s[8:11], s63 offen sc0 sc1
    s_mov_b64 exec, -1
layerb1_kernel_tk_p1:
    s_load_dwordx2 s[16:17], s[0:1], 0
    s_add_u32 s28, s4, 247463936
    s_addc_u32 s29, s5, 0
    s_waitcnt lgkmcnt(0)
    s_cmp_eq_u32 s49, 0
    s_cselect_b32 s16, s16, s28
    s_cselect_b32 s17, s17, s29
    s_mov_b32 s18, 2621440
    s_mov_b32 s19, 0x00020000
    s_and_b32 s28, s2, 7
    s_lshr_b32 s29, s2, 3
    s_and_b32 s30, s28, 3
    s_lshl_b32 s30, s30, 2
    s_and_b32 s31, s29, 3
    s_add_u32 s20, s30, s31
    s_lshr_b32 s30, s28, 2
    s_lshl_b32 s30, s30, 3
    s_lshr_b32 s31, s29, 2
    s_add_u32 s21, s30, s31
    s_lshr_b32 s22, s13, 1
    s_and_b32 s23, s13, 1
    s_lshl_b32 s26, s20, 1
    s_add_u32 s26, s26, s23
    s_mov_b32 s27, 0x3f803f80
    s_lshl_b32 s28, s21, 7
    s_lshl_b32 s29, s13, 5
    s_add_u32 s28, s28, s29
    s_mul_i32 s24, s28, 1280
    s_lshl_b32 s28, s20, 1
    s_add_u32 s28, s28, s22
    s_mul_i32 s25, s28, 81920
    s_lshl_b32 s29, s23, 12
    s_add_u32 s25, s25, s29
    s_add_u32 s25, s25, 243269632
    v_lshlrev_b32 v1, 4, v0
    v_lshrrev_b32 v16, 3, v0
    v_mul_u32_u24 v16, 1280, v16
    v_and_b32 v17, 7, v0
    v_lshrrev_b32 v18, 4, v0
    v_xor_b32 v19, v17, v18
    v_lshl_add_u32 v2, v19, 4, v16
    v_xor_b32 v19, 4, v19
    v_lshl_add_u32 v3, v19, 4, v16
    s_lshl_b32 s28, s13, 12
    s_mov_b32 m0, s28
    s_add_u32 s29, s24, 0
    buffer_load_dwordx4 v2, s[16:19], s29 offen offset:0 lds
    s_add_u32 s29, s29, 9216
    buffer_load_dwordx4 v3, s[16:19], s29 offen offset:1024 lds
    s_add_u32 s29, s29, 9216
    buffer_load_dwordx4 v2, s[16:19], s29 offen offset:2048 lds
    s_add_u32 s29, s29, 9216
    buffer_load_dwordx4 v3, s[16:19], s29 offen offset:3072 lds
    s_add_u32 s28, s28, 16384
    s_mov_b32 m0, s28
    s_add_u32 s29, s25, 0
    buffer_load_dwordx4 v1, s[8:11], s29 offen offset:0 lds
    buffer_load_dwordx4 v1, s[8:11], s29 offen offset:1024 lds
    buffer_load_dwordx4 v1, s[8:11], s29 offen offset:2048 lds
    buffer_load_dwordx4 v1, s[8:11], s29 offen offset:3072 lds
    s_lshl_b32 s28, s13, 12
    s_add_u32 s28, s28, 32768
    s_mov_b32 m0, s28
    s_add_u32 s29, s24, 128
    buffer_load_dwordx4 v2, s[16:19], s29 offen offset:0 lds
    s_add_u32 s29, s29, 9216
    buffer_load_dwordx4 v3, s[16:19], s29 offen offset:1024 lds
    s_add_u32 s29, s29, 9216
    buffer_load_dwordx4 v2, s[16:19], s29 offen offset:2048 lds
    s_add_u32 s29, s29, 9216
    buffer_load_dwordx4 v3, s[16:19], s29 offen offset:3072 lds
    s_add_u32 s28, s28, 16384
    s_mov_b32 m0, s28
    s_add_u32 s29, s25, 8192
    buffer_load_dwordx4 v1, s[8:11], s29 offen offset:0 lds
    buffer_load_dwordx4 v1, s[8:11], s29 offen offset:1024 lds
    buffer_load_dwordx4 v1, s[8:11], s29 offen offset:2048 lds
    buffer_load_dwordx4 v1, s[8:11], s29 offen offset:3072 lds
    s_lshl_b32 s28, s13, 12
    s_add_u32 s28, s28, 65536
    s_mov_b32 m0, s28
    s_add_u32 s29, s24, 256
    buffer_load_dwordx4 v2, s[16:19], s29 offen offset:0 lds
    s_add_u32 s29, s29, 9216
    buffer_load_dwordx4 v3, s[16:19], s29 offen offset:1024 lds
    s_add_u32 s29, s29, 9216
    buffer_load_dwordx4 v2, s[16:19], s29 offen offset:2048 lds
    s_add_u32 s29, s29, 9216
    buffer_load_dwordx4 v3, s[16:19], s29 offen offset:3072 lds
    s_add_u32 s28, s28, 16384
    s_mov_b32 m0, s28
    s_add_u32 s29, s25, 16384
    buffer_load_dwordx4 v1, s[8:11], s29 offen offset:0 lds
    buffer_load_dwordx4 v1, s[8:11], s29 offen offset:1024 lds
    buffer_load_dwordx4 v1, s[8:11], s29 offen offset:2048 lds
    buffer_load_dwordx4 v1, s[8:11], s29 offen offset:3072 lds
    s_cmp_lg_u32 s13, 0
    s_cbranch_scc1 layerb1_kernel_tk_wait
    s_waitcnt vmcnt(24)
    s_nop 0
    v_readfirstlane_b32 s62, v231
    s_cmp_lt_u32 s62, 32
    s_cbranch_scc1 layerb1_kernel_tk_pub
    v_lshlrev_b32 v230, 8, v0
    v_and_b32 v230, 0x7ff, v230
    s_mov_b32 s63, s60
layerb1_kernel_tk_poll:
    buffer_load_dword v231, v230, s[8:11], s63 offen sc1
    s_waitcnt vmcnt(0)
    s_mov_b32 s64, 0
    v_readlane_b32 s65, v231, 0
    s_nop 0
    s_add_u32 s64, s64, s65
    v_readlane_b32 s66, v231, 1
    s_nop 0
    s_add_u32 s64, s64, s66
    v_readlane_b32 s67, v231, 2
    s_nop 0
    s_add_u32 s64, s64, s67
    v_readlane_b32 s68, v231, 3
    s_nop 0
    s_add_u32 s64, s64, s68
    v_readlane_b32 s69, v231, 4
    s_nop 0
    s_add_u32 s64, s64, s69
    v_readlane_b32 s70, v231, 5
    s_nop 0
    s_add_u32 s64, s64, s70
    v_readlane_b32 s71, v231, 6
    s_nop 0
    s_add_u32 s64, s64, s71
    v_readlane_b32 s72, v231, 7
    s_nop 0
    s_add_u32 s64, s64, s72
    s_sub_u32 s15, s15, 1
    s_cbranch_scc1 layerb1_kernel_bail
    s_cmp_lt_u32 s64, 256
    s_cbranch_scc1 layerb1_kernel_tk_poll
    s_sub_u32 s62, s62, 32
    s_max_u32 s64, s65, 32
    s_sub_u32 s64, s64, 32
    s_cmp_gt_u32 s61, 0
    s_cselect_b32 s64, s64, 0
    s_add_u32 s62, s62, s64
    s_max_u32 s64, s66, 32
    s_sub_u32 s64, s64, 32
    s_cmp_gt_u32 s61, 1
    s_cselect_b32 s64, s64, 0
    s_add_u32 s62, s62, s64
    s_max_u32 s64, s67, 32
    s_sub_u32 s64, s64, 32
    s_cmp_gt_u32 s61, 2
    s_cselect_b32 s64, s64, 0
    s_add_u32 s62, s62, s64
    s_max_u32 s64, s68, 32
    s_sub_u32 s64, s64, 32
    s_cmp_gt_u32 s61, 3
    s_cselect_b32 s64, s64, 0
    s_add_u32 s62, s62, s64
    s_max_u32 s64, s69, 32
    s_sub_u32 s64, s64, 32
    s_cmp_gt_u32 s61, 4
    s_cselect_b32 s64, s64, 0
    s_add_u32 s62, s62, s64
    s_max_u32 s64, s70, 32
    s_sub_u32 s64, s64, 32
    s_cmp_gt_u32 s61, 5
    s_cselect_b32 s64, s64, 0
    s_add_u32 s62, s62, s64
    s_max_u32 s64, s71, 32
    s_sub_u32 s64, s64, 32
    s_cmp_gt_u32 s61, 6
    s_cselect_b32 s64, s64, 0
    s_add_u32 s62, s62, s64
    s_min_u32 s64, s65, 32
    s_sub_u32 s63, 32, s64
    s_cmp_lt_u32 s62, s63
    s_cbranch_scc0 layerb1_kernel_tk_n0
    s_mov_b32 s61, 0
    s_add_u32 s62, s62, s64
    s_branch layerb1_kernel_tk_pub
layerb1_kernel_tk_n0:
    s_sub_u32 s62, s62, s63
    s_min_u32 s64, s66, 32
    s_sub_u32 s63, 32, s64
    s_cmp_lt_u32 s62, s63
    s_cbranch_scc0 layerb1_kernel_tk_n1
    s_mov_b32 s61, 1
    s_add_u32 s62, s62, s64
    s_branch layerb1_kernel_tk_pub
layerb1_kernel_tk_n1:
    s_sub_u32 s62, s62, s63
    s_min_u32 s64, s67, 32
    s_sub_u32 s63, 32, s64
    s_cmp_lt_u32 s62, s63
    s_cbranch_scc0 layerb1_kernel_tk_n2
    s_mov_b32 s61, 2
    s_add_u32 s62, s62, s64
    s_branch layerb1_kernel_tk_pub
layerb1_kernel_tk_n2:
    s_sub_u32 s62, s62, s63
    s_min_u32 s64, s68, 32
    s_sub_u32 s63, 32, s64
    s_cmp_lt_u32 s62, s63
    s_cbranch_scc0 layerb1_kernel_tk_n3
    s_mov_b32 s61, 3
    s_add_u32 s62, s62, s64
    s_branch layerb1_kernel_tk_pub
layerb1_kernel_tk_n3:
    s_sub_u32 s62, s62, s63
    s_min_u32 s64, s69, 32
    s_sub_u32 s63, 32, s64
    s_cmp_lt_u32 s62, s63
    s_cbranch_scc0 layerb1_kernel_tk_n4
    s_mov_b32 s61, 4
    s_add_u32 s62, s62, s64
    s_branch layerb1_kernel_tk_pub
layerb1_kernel_tk_n4:
    s_sub_u32 s62, s62, s63
    s_min_u32 s64, s70, 32
    s_sub_u32 s63, 32, s64
    s_cmp_lt_u32 s62, s63
    s_cbranch_scc0 layerb1_kernel_tk_n5
    s_mov_b32 s61, 5
    s_add_u32 s62, s62, s64
    s_branch layerb1_kernel_tk_pub
layerb1_kernel_tk_n5:
    s_sub_u32 s62, s62, s63
    s_min_u32 s64, s71, 32
    s_sub_u32 s63, 32, s64
    s_cmp_lt_u32 s62, s63
    s_cbranch_scc0 layerb1_kernel_tk_n6
    s_mov_b32 s61, 6
    s_add_u32 s62, s62, s64
    s_branch layerb1_kernel_tk_pub
layerb1_kernel_tk_n6:
    s_sub_u32 s62, s62, s63
    s_min_u32 s64, s72, 32
    s_sub_u32 s63, 32, s64
    s_cmp_lt_u32 s62, s63
    s_cbranch_scc0 layerb1_kernel_tk_n7
    s_mov_b32 s61, 7
    s_add_u32 s62, s62, s64
    s_branch layerb1_kernel_tk_pub
layerb1_kernel_tk_n7:
    s_sub_u32 s62, s62, s63
    s_branch layerb1_kernel_bail
layerb1_kernel_tk_pub:
    s_lshl_b32 s63, s61, 8
    s_or_b32 s63, s63, s62
    v_mov_b32 v230, 131136
    v_mov_b32 v231, s63
    ds_write_b32 v230, v231
    s_waitcnt lgkmcnt(0)
layerb1_kernel_tk_wait:
    s_barrier
    v_mov_b32 v230, 131136
    ds_read_b32 v231, v230
    s_waitcnt lgkmcnt(0)
    v_readfirstlane_b32 s63, v231
    s_lshr_b32 s61, s63, 8
    s_and_b32 s62, s63, 255
    s_mov_b32 s98, s61
    s_mov_b32 s99, s62
    v_lshlrev_b32 v240, 4, v0
    v_mov_b32 v241, v240
    s_mov_b32 s50, 0x3020100
    s_mov_b32 s51, 0x7060504
    s_mov_b32 s52, 0xb0a0908
    s_mov_b32 s53, 0xf0e0d0c
    s_mov_b32 s54, 0x13121110
    s_mov_b32 s55, 0x17161514
    s_mov_b32 s56, 0x1b1a1918
    s_mov_b32 s57, 0x1f1e1d1c
    s_mov_b32 s40, 2048
    s_mov_b32 s44, 0
    s_cmp_eq_u32 s98, 0
    s_cbranch_scc1 layerb1_kernel_pf_p
    s_cmp_ge_u32 s98, 4
    s_cbranch_scc1 layerb1_kernel_pf_g
    s_sub_u32 s60, s98, 1
    s_cmp_ge_u32 s99, 27
    s_cbranch_scc1 layerb1_kernel_pf_sp
    s_mul_i32 s61, s60, 27
    s_add_u32 s61, s61, s99
    s_cmp_ge_u32 s61, 80
    s_cbranch_scc1 layerb1_kernel_pf_no
    s_mul_i32 s61, s61, 327680
    s_mul_i32 s62, s13, 81920
    s_add_u32 s61, s61, s62
    s_add_u32 s58, s61, 27262976
    s_add_u32 s59, s58, 1024
    s_branch layerb1_kernel_pf_done
layerb1_kernel_pf_sp:
    s_mul_i32 s61, s60, 5
    s_add_u32 s61, s61, s99
    s_sub_u32 s61, s61, 27
    s_cmp_lt_u32 s61, 5
    s_cbranch_scc0 layerb1_kernel_pf_no
    s_mov_b32 s44, 1
    s_lshl_b32 s61, s61, 2
    s_add_u32 s61, s61, s13
    s_mul_i32 s61, s61, 40960
    s_add_u32 s58, s61, 246415360
    s_add_u32 s59, s58, 1024
    s_branch layerb1_kernel_pf_done
layerb1_kernel_pf_no:
    s_mov_b32 s44, 2
    s_mov_b32 s58, 27262976
    s_mov_b32 s59, 27262976
    s_mov_b32 s40, 0
    s_branch layerb1_kernel_pf_done
layerb1_kernel_pf_p:
    s_mul_i32 s61, s99, 491520
    s_mul_i32 s62, s13, 122880
    s_add_u32 s61, s61, s62
    s_add_u32 s58, s61, 11534336
    s_add_u32 s59, s58, 1024
    s_cmp_lg_u32 s13, 0
    s_cbranch_scc1 layerb1_kernel_pf_pw0
    s_mov_b32 s50, 0xb140a00
    s_mov_b32 s51, 0x1e160215
    s_mov_b32 s52, 0x605041f
    s_mov_b32 s53, 0xf0d0908
    s_mov_b32 s54, 0x17131110
    s_mov_b32 s55, 0x1c1b1a18
    s_mov_b32 s56, 0x25232221
    s_mov_b32 s57, 0x2c2b2726
    s_branch layerb1_kernel_pf_done
layerb1_kernel_pf_pw0:
    s_cmp_lg_u32 s13, 1
    s_cbranch_scc1 layerb1_kernel_pf_pw1
    s_mov_b32 s50, 0xe170d03
    s_mov_b32 s51, 0x21190518
    s_mov_b32 s52, 0x6020122
    s_mov_b32 s53, 0xc0a0908
    s_mov_b32 s54, 0x14131110
    s_mov_b32 s55, 0x1c1b1a15
    s_mov_b32 s56, 0x25201f1e
    s_mov_b32 s57, 0x29282726
    s_branch layerb1_kernel_pf_done
layerb1_kernel_pf_pw1:
    s_cmp_lg_u32 s13, 2
    s_cbranch_scc1 layerb1_kernel_pf_pw2
    s_mov_b32 s50, 0x111a1006
    s_mov_b32 s51, 0x2f2e241b
    s_mov_b32 s52, 0x3020138
    s_mov_b32 s53, 0xb090805
    s_mov_b32 s54, 0x120f0d0c
    s_mov_b32 s55, 0x17161513
    s_mov_b32 s56, 0x1f1d1c19
    s_mov_b32 s57, 0x26232120
    s_branch layerb1_kernel_pf_done
layerb1_kernel_pf_pw2:
    s_mov_b32 s50, 0x131c1208
    s_mov_b32 s51, 0x3130261d
    s_mov_b32 s52, 0x302013a
    s_mov_b32 s53, 0xb070605
    s_mov_b32 s54, 0x100f0d0c
    s_mov_b32 s55, 0x17161511
    s_mov_b32 s56, 0x1f1b1a19
    s_mov_b32 s57, 0x24232120
    s_branch layerb1_kernel_pf_done
layerb1_kernel_pf_g:
    s_sub_u32 s60, s98, 4
    s_lshl_b32 s60, s60, 5
    s_add_u32 s60, s60, s99
    s_mov_b32 s40, 512
    v_and_b32 v230, 31, v0
    v_lshrrev_b32 v231, 5, v0
    s_cmp_ge_u32 s60, 80
    s_cbranch_scc1 layerb1_kernel_pf_qk
    v_lshrrev_b32 v232, 3, v230
    v_and_b32 v233, 7, v230
    v_mul_u32_u24 v234, 20480, v232
    v_lshl_add_u32 v234, v233, 4, v234
    v_lshl_add_u32 v240, v231, 8, v234
    s_mul_i32 s61, s60, 327680
    s_mul_i32 s62, s13, 81920
    s_add_u32 s61, s61, s62
    s_add_u32 s58, s61, 27262976
    v_mov_b32 v241, v240
    s_add_u32 s59, s58, 128
    s_branch layerb1_kernel_pf_done
layerb1_kernel_pf_qk:
    s_sub_u32 s61, s60, 80
    s_cmp_ge_u32 s61, 24
    s_cselect_b32 s62, 1, 0
    s_cselect_b32 s63, 24, 0
    s_sub_u32 s61, s61, s63
    s_lshl_b32 s61, s61, 3
    s_lshl_b32 s63, s13, 1
    s_add_u32 s61, s61, s63
    s_add_u32 s63, s61, 0
    s_mul_i32 s64, s63, 171
    s_lshr_b32 s64, s64, 10
    s_mul_i32 s65, s64, 6
    s_sub_u32 s65, s63, s65
    s_lshl_b32 s65, s65, 5
    v_add_u32 v232, s65, v230
    v_and_b32 v233, 0xc1, v232
    v_and_b32 v234, 8, v232
    v_lshl_or_b32 v233, v234, 2, v233
    v_and_b32 v234, 32, v232
    v_lshrrev_b32 v234, 1, v234
    v_or_b32 v233, v233, v234
    v_and_b32 v234, 2, v232
    v_lshl_or_b32 v233, v234, 2, v233
    v_and_b32 v234, 16, v232
    v_lshrrev_b32 v234, 2, v234
    v_or_b32 v233, v233, v234
    v_and_b32 v234, 4, v232
    v_lshrrev_b32 v234, 1, v234
    v_or_b32 v233, v233, v234
    s_cmp_eq_u32 s62, 1
    s_cselect_b64 vcc, -1, 0
    s_nop 1
    v_cndmask_b32 v232, v232, v233, vcc
    v_lshrrev_b32 v234, 4, v232
    v_and_b32 v235, 3, v234
    v_mul_u32_u24 v235, 6, v235
    v_lshrrev_b32 v234, 2, v234
    v_add_u32 v234, v234, v235
    v_mul_u32_u24 v234, 20480, v234
    v_and_b32 v235, 15, v232
    v_lshl_add_u32 v233, v235, 4, v234
    v_lshl_add_u32 v240, v231, 8, v233
    s_xor_b32 s65, s62, 1
    s_mul_i32 s65, s65, 61440
    s_mul_i32 s66, s64, 491520
    s_add_u32 s65, s65, s66
    s_add_u32 s58, s65, 11534336
    s_add_u32 s63, s61, 1
    s_mul_i32 s64, s63, 171
    s_lshr_b32 s64, s64, 10
    s_mul_i32 s65, s64, 6
    s_sub_u32 s65, s63, s65
    s_lshl_b32 s65, s65, 5
    v_add_u32 v232, s65, v230
    v_and_b32 v233, 0xc1, v232
    v_and_b32 v234, 8, v232
    v_lshl_or_b32 v233, v234, 2, v233
    v_and_b32 v234, 32, v232
    v_lshrrev_b32 v234, 1, v234
    v_or_b32 v233, v233, v234
    v_and_b32 v234, 2, v232
    v_lshl_or_b32 v233, v234, 2, v233
    v_and_b32 v234, 16, v232
    v_lshrrev_b32 v234, 2, v234
    v_or_b32 v233, v233, v234
    v_and_b32 v234, 4, v232
    v_lshrrev_b32 v234, 1, v234
    v_or_b32 v233, v233, v234
    s_cmp_eq_u32 s62, 1
    s_cselect_b64 vcc, -1, 0
    s_nop 1
    v_cndmask_b32 v232, v232, v233, vcc
    v_lshrrev_b32 v234, 4, v232
    v_and_b32 v235, 3, v234
    v_mul_u32_u24 v235, 6, v235
    v_lshrrev_b32 v234, 2, v234
    v_add_u32 v234, v234, v235
    v_mul_u32_u24 v234, 20480, v234
    v_and_b32 v235, 15, v232
    v_lshl_add_u32 v233, v235, 4, v234
    v_lshl_add_u32 v241, v231, 8, v233
    s_xor_b32 s65, s62, 1
    s_mul_i32 s65, s65, 61440
    s_mul_i32 s66, s64, 491520
    s_add_u32 s65, s65, s66
    s_add_u32 s59, s65, 11534336
layerb1_kernel_pf_done:
    v_and_b32 v16, 31, v0
    v_lshrrev_b32 v17, 5, v0
    v_lshrrev_b32 v18, 1, v16
    v_and_b32 v18, 7, v18
    v_xor_b32 v18, v18, v17
    v_lshlrev_b32 v18, 4, v18
    v_lshl_add_u32 v18, v16, 7, v18
    s_lshl_b32 s28, s22, 13
    v_add_u32 v18, s28, v18
    v_xor_b32 v6, 0, v18
    v_add_u32 v10, 65536, v6
    v_xor_b32 v7, 32, v18
    v_add_u32 v11, 65536, v7
    v_xor_b32 v8, 64, v18
    v_add_u32 v12, 65536, v8
    v_xor_b32 v9, 96, v18
    v_add_u32 v13, 65536, v9
    s_lshl_b32 s28, s23, 13
    s_add_u32 s28, s28, 16384
    v_add_u32 v4, s28, v1
    v_add_u32 v5, 65536, v4
    v_mov_b32 v20, 0
    v_mov_b32 v21, 0
    v_mov_b32 v22, 0
    v_mov_b32 v23, 0
    s_waitcnt vmcnt(16)
    s_barrier
    ds_read_b128 v[32:35], v6 offset:0
    ds_read_b128 v[36:39], v6 offset:4096
    ds_read_b128 v[40:43], v4 offset:0
    ds_read_b128 v[44:47], v4 offset:1024
    s_cmp_eq_u32 s23, 1
    s_cbranch_scc1 layerb1_kernel_af_h1
    s_waitcnt lgkmcnt(0)
    v_mfma_f32_32x32x16_bf16 v[64:79], v[32:35], v[40:43], 0
    v_mfma_f32_4x4x4_16b_bf16 v[20:23], v[32:33], v[32:33], v[20:23]
    v_mfma_f32_32x32x16_bf16 v[96:111], v[32:35], v[44:47], 0
    ds_read_b128 v[48:51], v7 offset:0
    v_mfma_f32_32x32x16_bf16 v[128:143], v[44:47], v[32:35], 0
    ds_read_b128 v[52:55], v7 offset:4096
    v_mfma_f32_32x32x16_bf16 v[80:95], v[36:39], v[40:43], 0
    ds_read_b128 v[56:59], v4 offset:2048
    v_mfma_f32_32x32x16_bf16 v[112:127], v[36:39], v[44:47], 0
    v_mfma_f32_4x4x4_16b_bf16 v[20:23], v[34:35], v[34:35], v[20:23]
    ds_read_b128 v[60:63], v4 offset:3072
    v_mfma_f32_32x32x16_bf16 v[144:159], v[44:47], v[36:39], 0
    s_waitcnt lgkmcnt(0)
    v_mfma_f32_32x32x16_bf16 v[64:79], v[48:51], v[56:59], v[64:79]
    v_mfma_f32_4x4x4_16b_bf16 v[20:23], v[48:49], v[48:49], v[20:23]
    v_mfma_f32_32x32x16_bf16 v[96:111], v[48:51], v[60:63], v[96:111]
    ds_read_b128 v[32:35], v8 offset:0
    v_mfma_f32_32x32x16_bf16 v[128:143], v[60:63], v[48:51], v[128:143]
    ds_read_b128 v[36:39], v8 offset:4096
    v_mfma_f32_32x32x16_bf16 v[80:95], v[52:55], v[56:59], v[80:95]
    ds_read_b128 v[40:43], v4 offset:4096
    v_mfma_f32_32x32x16_bf16 v[112:127], v[52:55], v[60:63], v[112:127]
    v_mfma_f32_4x4x4_16b_bf16 v[20:23], v[50:51], v[50:51], v[20:23]
    ds_read_b128 v[44:47], v4 offset:5120
    v_mfma_f32_32x32x16_bf16 v[144:159], v[60:63], v[52:55], v[144:159]
    s_waitcnt lgkmcnt(0)
    v_mfma_f32_32x32x16_bf16 v[64:79], v[32:35], v[40:43], v[64:79]
    v_mfma_f32_4x4x4_16b_bf16 v[20:23], v[32:33], v[32:33], v[20:23]
    v_mfma_f32_32x32x16_bf16 v[96:111], v[32:35], v[44:47], v[96:111]
    ds_read_b128 v[48:51], v9 offset:0
    v_mfma_f32_32x32x16_bf16 v[128:143], v[44:47], v[32:35], v[128:143]
    ds_read_b128 v[52:55], v9 offset:4096
    v_mfma_f32_32x32x16_bf16 v[80:95], v[36:39], v[40:43], v[80:95]
    ds_read_b128 v[56:59], v4 offset:6144
    v_mfma_f32_32x32x16_bf16 v[112:127], v[36:39], v[44:47], v[112:127]
    v_mfma_f32_4x4x4_16b_bf16 v[20:23], v[34:35], v[34:35], v[20:23]
    ds_read_b128 v[60:63], v4 offset:7168
    v_mfma_f32_32x32x16_bf16 v[144:159], v[44:47], v[36:39], v[144:159]
    s_waitcnt vmcnt(8)
    s_barrier
    s_waitcnt lgkmcnt(0)
    v_mfma_f32_32x32x16_bf16 v[64:79], v[48:51], v[56:59], v[64:79]
    v_mfma_f32_4x4x4_16b_bf16 v[20:23], v[48:49], v[48:49], v[20:23]
    s_lshl_b32 s28, s13, 12
    s_add_u32 s28, s28, 98304
    s_mov_b32 m0, s28
    s_add_u32 s29, s24, 384
    buffer_load_dwordx4 v2, s[16:19], s29 offen offset:0 lds
    v_mfma_f32_32x32x16_bf16 v[96:111], v[48:51], v[60:63], v[96:111]
    ds_read_b128 v[32:35], v6 offset:32768
    s_add_u32 s29, s29, 9216
    buffer_load_dwordx4 v3, s[16:19], s29 offen offset:1024 lds
    v_mfma_f32_32x32x16_bf16 v[128:143], v[60:63], v[48:51], v[128:143]
    ds_read_b128 v[36:39], v6 offset:36864
    s_add_u32 s29, s29, 9216
    buffer_load_dwordx4 v2, s[16:19], s29 offen offset:2048 lds
    v_mfma_f32_32x32x16_bf16 v[80:95], v[52:55], v[56:59], v[80:95]
    ds_read_b128 v[40:43], v4 offset:32768
    s_add_u32 s29, s29, 9216
    buffer_load_dwordx4 v3, s[16:19], s29 offen offset:3072 lds
    v_mfma_f32_32x32x16_bf16 v[112:127], v[52:55], v[60:63], v[112:127]
    v_mfma_f32_4x4x4_16b_bf16 v[20:23], v[50:51], v[50:51], v[20:23]
    ds_read_b128 v[44:47], v4 offset:33792
    s_add_u32 s28, s28, 16384
    s_mov_b32 m0, s28
    s_add_u32 s29, s25, 24576
    buffer_load_dwordx4 v1, s[8:11], s29 offen offset:0 lds
    v_mfma_f32_32x32x16_bf16 v[144:159], v[60:63], v[52:55], v[144:159]
    buffer_load_dwordx4 v1, s[8:11], s29 offen offset:1024 lds
    s_waitcnt lgkmcnt(0)
    v_mfma_f32_32x32x16_bf16 v[64:79], v[32:35], v[40:43], v[64:79]
    v_mfma_f32_4x4x4_16b_bf16 v[20:23], v[32:33], v[32:33], v[20:23]
    buffer_load_dwordx4 v1, s[8:11], s29 offen offset:2048 lds
    v_mfma_f32_32x32x16_bf16 v[96:111], v[32:35], v[44:47], v[96:111]
    ds_read_b128 v[48:51], v7 offset:32768
    buffer_load_dwordx4 v1, s[8:11], s29 offen offset:3072 lds
    v_mfma_f32_32x32x16_bf16 v[128:143], v[44:47], v[32:35], v[128:143]
    ds_read_b128 v[52:55], v7 offset:36864
    s_bfe_u32 s41, s50, 524288
    s_mul_i32 s41, s41, s40
    s_add_u32 s42, s58, s41
    s_add_u32 s43, s59, s41
    buffer_load_dwordx4 a[0:3], v240, s[8:11], s42 offen
    v_mfma_f32_32x32x16_bf16 v[80:95], v[36:39], v[40:43], v[80:95]
    ds_read_b128 v[56:59], v4 offset:34816
    buffer_load_dwordx4 a[4:7], v241, s[8:11], s43 offen
    v_mfma_f32_32x32x16_bf16 v[112:127], v[36:39], v[44:47], v[112:127]
    v_mfma_f32_4x4x4_16b_bf16 v[20:23], v[34:35], v[34:35], v[20:23]
    ds_read_b128 v[60:63], v4 offset:35840
    s_bfe_u32 s41, s50, 524296
    s_mul_i32 s41, s41, s40
    s_add_u32 s42, s58, s41
    s_add_u32 s43, s59, s41
    buffer_load_dwordx4 a[8:11], v240, s[8:11], s42 offen
    v_mfma_f32_32x32x16_bf16 v[144:159], v[44:47], v[36:39], v[144:159]
    buffer_load_dwordx4 a[12:15], v241, s[8:11], s43 offen
    s_waitcnt lgkmcnt(0)
    v_mfma_f32_32x32x16_bf16 v[64:79], v[48:51], v[56:59], v[64:79]
    v_mfma_f32_4x4x4_16b_bf16 v[20:23], v[48:49], v[48:49], v[20:23]
    v_mfma_f32_32x32x16_bf16 v[96:111], v[48:51], v[60:63], v[96:111]
    ds_read_b128 v[32:35], v8 offset:32768
    v_mfma_f32_32x32x16_bf16 v[128:143], v[60:63], v[48:51], v[128:143]
    ds_read_b128 v[36:39], v8 offset:36864
    v_mfma_f32_32x32x16_bf16 v[80:95], v[52:55], v[56:59], v[80:95]
    ds_read_b128 v[40:43], v4 offset:36864
    v_mfma_f32_32x32x16_bf16 v[112:127], v[52:55], v[60:63], v[112:127]
    v_mfma_f32_4x4x4_16b_bf16 v[20:23], v[50:51], v[50:51], v[20:23]
    ds_read_b128 v[44:47], v4 offset:37888
    v_mfma_f32_32x32x16_bf16 v[144:159], v[60:63], v[52:55], v[144:159]
    s_waitcnt lgkmcnt(0)
    v_mfma_f32_32x32x16_bf16 v[64:79], v[32:35], v[40:43], v[64:79]
    v_mfma_f32_4x4x4_16b_bf16 v[20:23], v[32:33], v[32:33], v[20:23]
    v_mfma_f32_32x32x16_bf16 v[96:111], v[32:35], v[44:47], v[96:111]
    ds_read_b128 v[48:51], v9 offset:32768
    v_mfma_f32_32x32x16_bf16 v[128:143], v[44:47], v[32:35], v[128:143]
    ds_read_b128 v[52:55], v9 offset:36864
    v_mfma_f32_32x32x16_bf16 v[80:95], v[36:39], v[40:43], v[80:95]
    ds_read_b128 v[56:59], v4 offset:38912
    v_mfma_f32_32x32x16_bf16 v[112:127], v[36:39], v[44:47], v[112:127]
    v_mfma_f32_4x4x4_16b_bf16 v[20:23], v[34:35], v[34:35], v[20:23]
    ds_read_b128 v[60:63], v4 offset:39936
    v_mfma_f32_32x32x16_bf16 v[144:159], v[44:47], v[36:39], v[144:159]
    s_waitcnt vmcnt(12)
    s_barrier
    s_waitcnt lgkmcnt(0)
    v_mfma_f32_32x32x16_bf16 v[64:79], v[48:51], v[56:59], v[64:79]
    v_mfma_f32_4x4x4_16b_bf16 v[20:23], v[48:49], v[48:49], v[20:23]
    s_lshl_b32 s28, s13, 12
    s_mov_b32 m0, s28
    s_add_u32 s29, s24, 512
    buffer_load_dwordx4 v2, s[16:19], s29 offen offset:0 lds
    v_mfma_f32_32x32x16_bf16 v[96:111], v[48:51], v[60:63], v[96:111]
    ds_read_b128 v[32:35], v10 offset:0
    s_add_u32 s29, s29, 9216
    buffer_load_dwordx4 v3, s[16:19], s29 offen offset:1024 lds
    v_mfma_f32_32x32x16_bf16 v[128:143], v[60:63], v[48:51], v[128:143]
    ds_read_b128 v[36:39], v10 offset:4096
    s_add_u32 s29, s29, 9216
    buffer_load_dwordx4 v2, s[16:19], s29 offen offset:2048 lds
    v_mfma_f32_32x32x16_bf16 v[80:95], v[52:55], v[56:59], v[80:95]
    ds_read_b128 v[40:43], v5 offset:0
    s_add_u32 s29, s29, 9216
    buffer_load_dwordx4 v3, s[16:19], s29 offen offset:3072 lds
    v_mfma_f32_32x32x16_bf16 v[112:127], v[52:55], v[60:63], v[112:127]
    v_mfma_f32_4x4x4_16b_bf16 v[20:23], v[50:51], v[50:51], v[20:23]
    ds_read_b128 v[44:47], v5 offset:1024
    s_add_u32 s28, s28, 16384
    s_mov_b32 m0, s28
    s_add_u32 s29, s25, 32768
    buffer_load_dwordx4 v1, s[8:11], s29 offen offset:0 lds
    v_mfma_f32_32x32x16_bf16 v[144:159], v[60:63], v[52:55], v[144:159]
    buffer_load_dwordx4 v1, s[8:11], s29 offen offset:1024 lds
    s_waitcnt lgkmcnt(0)
    v_mfma_f32_32x32x16_bf16 v[64:79], v[32:35], v[40:43], v[64:79]
    v_mfma_f32_4x4x4_16b_bf16 v[20:23], v[32:33], v[32:33], v[20:23]
    buffer_load_dwordx4 v1, s[8:11], s29 offen offset:2048 lds
    v_mfma_f32_32x32x16_bf16 v[96:111], v[32:35], v[44:47], v[96:111]
    ds_read_b128 v[48:51], v11 offset:0
    buffer_load_dwordx4 v1, s[8:11], s29 offen offset:3072 lds
    v_mfma_f32_32x32x16_bf16 v[128:143], v[44:47], v[32:35], v[128:143]
    ds_read_b128 v[52:55], v11 offset:4096
    s_bfe_u32 s41, s50, 524304
    s_mul_i32 s41, s41, s40
    s_add_u32 s42, s58, s41
    s_add_u32 s43, s59, s41
    buffer_load_dwordx4 a[16:19], v240, s[8:11], s42 offen
    v_mfma_f32_32x32x16_bf16 v[80:95], v[36:39], v[40:43], v[80:95]
    ds_read_b128 v[56:59], v5 offset:2048
    buffer_load_dwordx4 a[20:23], v241, s[8:11], s43 offen
    v_mfma_f32_32x32x16_bf16 v[112:127], v[36:39], v[44:47], v[112:127]
    v_mfma_f32_4x4x4_16b_bf16 v[20:23], v[34:35], v[34:35], v[20:23]
    ds_read_b128 v[60:63], v5 offset:3072
    s_bfe_u32 s41, s50, 524312
    s_mul_i32 s41, s41, s40
    s_add_u32 s42, s58, s41
    s_add_u32 s43, s59, s41
    buffer_load_dwordx4 a[24:27], v240, s[8:11], s42 offen
    v_mfma_f32_32x32x16_bf16 v[144:159], v[44:47], v[36:39], v[144:159]
    buffer_load_dwordx4 a[28:31], v241, s[8:11], s43 offen
    s_waitcnt lgkmcnt(0)
    v_mfma_f32_32x32x16_bf16 v[64:79], v[48:51], v[56:59], v[64:79]
    v_mfma_f32_4x4x4_16b_bf16 v[20:23], v[48:49], v[48:49], v[20:23]
    v_mfma_f32_32x32x16_bf16 v[96:111], v[48:51], v[60:63], v[96:111]
    ds_read_b128 v[32:35], v12 offset:0
    v_mfma_f32_32x32x16_bf16 v[128:143], v[60:63], v[48:51], v[128:143]
    ds_read_b128 v[36:39], v12 offset:4096
    v_mfma_f32_32x32x16_bf16 v[80:95], v[52:55], v[56:59], v[80:95]
    ds_read_b128 v[40:43], v5 offset:4096
    v_mfma_f32_32x32x16_bf16 v[112:127], v[52:55], v[60:63], v[112:127]
    v_mfma_f32_4x4x4_16b_bf16 v[20:23], v[50:51], v[50:51], v[20:23]
    ds_read_b128 v[44:47], v5 offset:5120
    v_mfma_f32_32x32x16_bf16 v[144:159], v[60:63], v[52:55], v[144:159]
    s_waitcnt lgkmcnt(0)
    v_mfma_f32_32x32x16_bf16 v[64:79], v[32:35], v[40:43], v[64:79]
    v_mfma_f32_4x4x4_16b_bf16 v[20:23], v[32:33], v[32:33], v[20:23]
    v_mfma_f32_32x32x16_bf16 v[96:111], v[32:35], v[44:47], v[96:111]
    ds_read_b128 v[48:51], v13 offset:0
    v_mfma_f32_32x32x16_bf16 v[128:143], v[44:47], v[32:35], v[128:143]
    ds_read_b128 v[52:55], v13 offset:4096
    v_mfma_f32_32x32x16_bf16 v[80:95], v[36:39], v[40:43], v[80:95]
    ds_read_b128 v[56:59], v5 offset:6144
    v_mfma_f32_32x32x16_bf16 v[112:127], v[36:39], v[44:47], v[112:127]
    v_mfma_f32_4x4x4_16b_bf16 v[20:23], v[34:35], v[34:35], v[20:23]
    ds_read_b128 v[60:63], v5 offset:7168
    v_mfma_f32_32x32x16_bf16 v[144:159], v[44:47], v[36:39], v[144:159]
    s_waitcnt vmcnt(16)
    s_barrier
    s_waitcnt lgkmcnt(0)
    v_mfma_f32_32x32x16_bf16 v[64:79], v[48:51], v[56:59], v[64:79]
    v_mfma_f32_4x4x4_16b_bf16 v[20:23], v[48:49], v[48:49], v[20:23]
    s_lshl_b32 s28, s13, 12
    s_add_u32 s28, s28, 32768
    s_mov_b32 m0, s28
    s_add_u32 s29, s24, 640
    buffer_load_dwordx4 v2, s[16:19], s29 offen offset:0 lds
    v_mfma_f32_32x32x16_bf16 v[96:111], v[48:51], v[60:63], v[96:111]
    ds_read_b128 v[32:35], v10 offset:32768
    s_add_u32 s29, s29, 9216
    buffer_load_dwordx4 v3, s[16:19], s29 offen offset:1024 lds
    v_mfma_f32_32x32x16_bf16 v[128:143], v[60:63], v[48:51], v[128:143]
    ds_read_b128 v[36:39], v10 offset:36864
    s_add_u32 s29, s29, 9216
    buffer_load_dwordx4 v2, s[16:19], s29 offen offset:2048 lds
    v_mfma_f32_32x32x16_bf16 v[80:95], v[52:55], v[56:59], v[80:95]
    ds_read_b128 v[40:43], v5 offset:32768
    s_add_u32 s29, s29, 9216
    buffer_load_dwordx4 v3, s[16:19], s29 offen offset:3072 lds
    v_mfma_f32_32x32x16_bf16 v[112:127], v[52:55], v[60:63], v[112:127]
    v_mfma_f32_4x4x4_16b_bf16 v[20:23], v[50:51], v[50:51], v[20:23]
    ds_read_b128 v[44:47], v5 offset:33792
    s_add_u32 s28, s28, 16384
    s_mov_b32 m0, s28
    s_add_u32 s29, s25, 40960
    buffer_load_dwordx4 v1, s[8:11], s29 offen offset:0 lds
    v_mfma_f32_32x32x16_bf16 v[144:159], v[60:63], v[52:55], v[144:159]
    buffer_load_dwordx4 v1, s[8:11], s29 offen offset:1024 lds
    s_waitcnt lgkmcnt(0)
    v_mfma_f32_32x32x16_bf16 v[64:79], v[32:35], v[40:43], v[64:79]
    v_mfma_f32_4x4x4_16b_bf16 v[20:23], v[32:33], v[32:33], v[20:23]
    buffer_load_dwordx4 v1, s[8:11], s29 offen offset:2048 lds
    v_mfma_f32_32x32x16_bf16 v[96:111], v[32:35], v[44:47], v[96:111]
    ds_read_b128 v[48:51], v11 offset:32768
    buffer_load_dwordx4 v1, s[8:11], s29 offen offset:3072 lds
    v_mfma_f32_32x32x16_bf16 v[128:143], v[44:47], v[32:35], v[128:143]
    ds_read_b128 v[52:55], v11 offset:36864
    s_bfe_u32 s41, s51, 524288
    s_mul_i32 s41, s41, s40
    s_add_u32 s42, s58, s41
    s_add_u32 s43, s59, s41
    buffer_load_dwordx4 a[32:35], v240, s[8:11], s42 offen
    v_mfma_f32_32x32x16_bf16 v[80:95], v[36:39], v[40:43], v[80:95]
    ds_read_b128 v[56:59], v5 offset:34816
    buffer_load_dwordx4 a[36:39], v241, s[8:11], s43 offen
    v_mfma_f32_32x32x16_bf16 v[112:127], v[36:39], v[44:47], v[112:127]
    v_mfma_f32_4x4x4_16b_bf16 v[20:23], v[34:35], v[34:35], v[20:23]
    ds_read_b128 v[60:63], v5 offset:35840
    s_bfe_u32 s41, s51, 524296
    s_mul_i32 s41, s41, s40
    s_add_u32 s42, s58, s41
    s_add_u32 s43, s59, s41
    buffer_load_dwordx4 a[40:43], v240, s[8:11], s42 offen
    v_mfma_f32_32x32x16_bf16 v[144:159], v[44:47], v[36:39], v[144:159]
    buffer_load_dwordx4 a[44:47], v241, s[8:11], s43 offen
    s_waitcnt lgkmcnt(0)
    v_mfma_f32_32x32x16_bf16 v[64:79], v[48:51], v[56:59], v[64:79]
    v_mfma_f32_4x4x4_16b_bf16 v[20:23], v[48:49], v[48:49], v[20:23]
    v_mfma_f32_32x32x16_bf16 v[96:111], v[48:51], v[60:63], v[96:111]
    ds_read_b128 v[32:35], v12 offset:32768
    v_mfma_f32_32x32x16_bf16 v[128:143], v[60:63], v[48:51], v[128:143]
    ds_read_b128 v[36:39], v12 offset:36864
    v_mfma_f32_32x32x16_bf16 v[80:95], v[52:55], v[56:59], v[80:95]
    ds_read_b128 v[40:43], v5 offset:36864
    v_mfma_f32_32x32x16_bf16 v[112:127], v[52:55], v[60:63], v[112:127]
    v_mfma_f32_4x4x4_16b_bf16 v[20:23], v[50:51], v[50:51], v[20:23]
    ds_read_b128 v[44:47], v5 offset:37888
    v_mfma_f32_32x32x16_bf16 v[144:159], v[60:63], v[52:55], v[144:159]
    s_waitcnt lgkmcnt(0)
    v_mfma_f32_32x32x16_bf16 v[64:79], v[32:35], v[40:43], v[64:79]
    v_mfma_f32_4x4x4_16b_bf16 v[20:23], v[32:33], v[32:33], v[20:23]
    v_mfma_f32_32x32x16_bf16 v[96:111], v[32:35], v[44:47], v[96:111]
    ds_read_b128 v[48:51], v13 offset:32768
    v_mfma_f32_32x32x16_bf16 v[128:143], v[44:47], v[32:35], v[128:143]
    ds_read_b128 v[52:55], v13 offset:36864
    v_mfma_f32_32x32x16_bf16 v[80:95], v[36:39], v[40:43], v[80:95]
    ds_read_b128 v[56:59], v5 offset:38912
    v_mfma_f32_32x32x16_bf16 v[112:127], v[36:39], v[44:47], v[112:127]
    v_mfma_f32_4x4x4_16b_bf16 v[20:23], v[34:35], v[34:35], v[20:23]
    ds_read_b128 v[60:63], v5 offset:39936
    v_mfma_f32_32x32x16_bf16 v[144:159], v[44:47], v[36:39], v[144:159]
    s_waitcnt vmcnt(16)
    s_barrier
    s_waitcnt lgkmcnt(0)
    v_mfma_f32_32x32x16_bf16 v[64:79], v[48:51], v[56:59], v[64:79]
    v_mfma_f32_4x4x4_16b_bf16 v[20:23], v[48:49], v[48:49], v[20:23]
    s_lshl_b32 s28, s13, 12
    s_add_u32 s28, s28, 65536
    s_mov_b32 m0, s28
    s_add_u32 s29, s24, 768
    buffer_load_dwordx4 v2, s[16:19], s29 offen offset:0 lds
    v_mfma_f32_32x32x16_bf16 v[96:111], v[48:51], v[60:63], v[96:111]
    ds_read_b128 v[32:35], v6 offset:0
    s_add_u32 s29, s29, 9216
    buffer_load_dwordx4 v3, s[16:19], s29 offen offset:1024 lds
    v_mfma_f32_32x32x16_bf16 v[128:143], v[60:63], v[48:51], v[128:143]
    ds_read_b128 v[36:39], v6 offset:4096
    s_add_u32 s29, s29, 9216
    buffer_load_dwordx4 v2, s[16:19], s29 offen offset:2048 lds
    v_mfma_f32_32x32x16_bf16 v[80:95], v[52:55], v[56:59], v[80:95]
    ds_read_b128 v[40:43], v4 offset:0
    s_add_u32 s29, s29, 9216
    buffer_load_dwordx4 v3, s[16:19], s29 offen offset:3072 lds
    v_mfma_f32_32x32x16_bf16 v[112:127], v[52:55], v[60:63], v[112:127]
    v_mfma_f32_4x4x4_16b_bf16 v[20:23], v[50:51], v[50:51], v[20:23]
    ds_read_b128 v[44:47], v4 offset:1024
    s_add_u32 s28, s28, 16384
    s_mov_b32 m0, s28
    s_add_u32 s29, s25, 49152
    buffer_load_dwordx4 v1, s[8:11], s29 offen offset:0 lds
    v_mfma_f32_32x32x16_bf16 v[144:159], v[60:63], v[52:55], v[144:159]
    buffer_load_dwordx4 v1, s[8:11], s29 offen offset:1024 lds
    s_waitcnt lgkmcnt(0)
    v_mfma_f32_32x32x16_bf16 v[64:79], v[32:35], v[40:43], v[64:79]
    v_mfma_f32_4x4x4_16b_bf16 v[20:23], v[32:33], v[32:33], v[20:23]
    buffer_load_dwordx4 v1, s[8:11], s29 offen offset:2048 lds
    v_mfma_f32_32x32x16_bf16 v[96:111], v[32:35], v[44:47], v[96:111]
    ds_read_b128 v[48:51], v7 offset:0
    buffer_load_dwordx4 v1, s[8:11], s29 offen offset:3072 lds
    v_mfma_f32_32x32x16_bf16 v[128:143], v[44:47], v[32:35], v[128:143]
    ds_read_b128 v[52:55], v7 offset:4096
    s_bfe_u32 s41, s51, 524304
    s_mul_i32 s41, s41, s40
    s_add_u32 s42, s58, s41
    s_add_u32 s43, s59, s41
    buffer_load_dwordx4 a[48:51], v240, s[8:11], s42 offen
    v_mfma_f32_32x32x16_bf16 v[80:95], v[36:39], v[40:43], v[80:95]
    ds_read_b128 v[56:59], v4 offset:2048
    buffer_load_dwordx4 a[52:55], v241, s[8:11], s43 offen
    v_mfma_f32_32x32x16_bf16 v[112:127], v[36:39], v[44:47], v[112:127]
    v_mfma_f32_4x4x4_16b_bf16 v[20:23], v[34:35], v[34:35], v[20:23]
    ds_read_b128 v[60:63], v4 offset:3072
    s_bfe_u32 s41, s51, 524312
    s_mul_i32 s41, s41, s40
    s_add_u32 s42, s58, s41
    s_add_u32 s43, s59, s41
    buffer_load_dwordx4 a[56:59], v240, s[8:11], s42 offen
    v_mfma_f32_32x32x16_bf16 v[144:159], v[44:47], v[36:39], v[144:159]
    buffer_load_dwordx4 a[60:63], v241, s[8:11], s43 offen
    s_waitcnt lgkmcnt(0)
    v_mfma_f32_32x32x16_bf16 v[64:79], v[48:51], v[56:59], v[64:79]
    v_mfma_f32_4x4x4_16b_bf16 v[20:23], v[48:49], v[48:49], v[20:23]
    v_mfma_f32_32x32x16_bf16 v[96:111], v[48:51], v[60:63], v[96:111]
    ds_read_b128 v[32:35], v8 offset:0
    v_mfma_f32_32x32x16_bf16 v[128:143], v[60:63], v[48:51], v[128:143]
    ds_read_b128 v[36:39], v8 offset:4096
    v_mfma_f32_32x32x16_bf16 v[80:95], v[52:55], v[56:59], v[80:95]
    ds_read_b128 v[40:43], v4 offset:4096
    v_mfma_f32_32x32x16_bf16 v[112:127], v[52:55], v[60:63], v[112:127]
    v_mfma_f32_4x4x4_16b_bf16 v[20:23], v[50:51], v[50:51], v[20:23]
    ds_read_b128 v[44:47], v4 offset:5120
    v_mfma_f32_32x32x16_bf16 v[144:159], v[60:63], v[52:55], v[144:159]
    s_waitcnt lgkmcnt(0)
    v_mfma_f32_32x32x16_bf16 v[64:79], v[32:35], v[40:43], v[64:79]
    v_mfma_f32_4x4x4_16b_bf16 v[20:23], v[32:33], v[32:33], v[20:23]
    v_mfma_f32_32x32x16_bf16 v[96:111], v[32:35], v[44:47], v[96:111]
    ds_read_b128 v[48:51], v9 offset:0
    v_mfma_f32_32x32x16_bf16 v[128:143], v[44:47], v[32:35], v[128:143]
    ds_read_b128 v[52:55], v9 offset:4096
    v_mfma_f32_32x32x16_bf16 v[80:95], v[36:39], v[40:43], v[80:95]
    ds_read_b128 v[56:59], v4 offset:6144
    v_mfma_f32_32x32x16_bf16 v[112:127], v[36:39], v[44:47], v[112:127]
    v_mfma_f32_4x4x4_16b_bf16 v[20:23], v[34:35], v[34:35], v[20:23]
    ds_read_b128 v[60:63], v4 offset:7168
    v_mfma_f32_32x32x16_bf16 v[144:159], v[44:47], v[36:39], v[144:159]
    s_waitcnt vmcnt(16)
    s_barrier
    s_waitcnt lgkmcnt(0)
    v_mfma_f32_32x32x16_bf16 v[64:79], v[48:51], v[56:59], v[64:79]
    v_mfma_f32_4x4x4_16b_bf16 v[20:23], v[48:49], v[48:49], v[20:23]
    s_lshl_b32 s28, s13, 12
    s_add_u32 s28, s28, 98304
    s_mov_b32 m0, s28
    s_add_u32 s29, s24, 896
    buffer_load_dwordx4 v2, s[16:19], s29 offen offset:0 lds
    v_mfma_f32_32x32x16_bf16 v[96:111], v[48:51], v[60:63], v[96:111]
    ds_read_b128 v[32:35], v6 offset:32768
    s_add_u32 s29, s29, 9216
    buffer_load_dwordx4 v3, s[16:19], s29 offen offset:1024 lds
    v_mfma_f32_32x32x16_bf16 v[128:143], v[60:63], v[48:51], v[128:143]
    ds_read_b128 v[36:39], v6 offset:36864
    s_add_u32 s29, s29, 9216
    buffer_load_dwordx4 v2, s[16:19], s29 offen offset:2048 lds
    v_mfma_f32_32x32x16_bf16 v[80:95], v[52:55], v[56:59], v[80:95]
    ds_read_b128 v[40:43], v4 offset:32768
    s_add_u32 s29, s29, 9216
    buffer_load_dwordx4 v3, s[16:19], s29 offen offset:3072 lds
    v_mfma_f32_32x32x16_bf16 v[112:127], v[52:55], v[60:63], v[112:127]
    v_mfma_f32_4x4x4_16b_bf16 v[20:23], v[50:51], v[50:51], v[20:23]
    ds_read_b128 v[44:47], v4 offset:33792
    s_add_u32 s28, s28, 16384
    s_mov_b32 m0, s28
    s_add_u32 s29, s25, 57344
    buffer_load_dwordx4 v1, s[8:11], s29 offen offset:0 lds
    v_mfma_f32_32x32x16_bf16 v[144:159], v[60:63], v[52:55], v[144:159]
    buffer_load_dwordx4 v1, s[8:11], s29 offen offset:1024 lds
    s_waitcnt lgkmcnt(0)
    v_mfma_f32_32x32x16_bf16 v[64:79], v[32:35], v[40:43], v[64:79]
    v_mfma_f32_4x4x4_16b_bf16 v[20:23], v[32:33], v[32:33], v[20:23]
    buffer_load_dwordx4 v1, s[8:11], s29 offen offset:2048 lds
    v_mfma_f32_32x32x16_bf16 v[96:111], v[32:35], v[44:47], v[96:111]
    ds_read_b128 v[48:51], v7 offset:32768
    buffer_load_dwordx4 v1, s[8:11], s29 offen offset:3072 lds
    v_mfma_f32_32x32x16_bf16 v[128:143], v[44:47], v[32:35], v[128:143]
    ds_read_b128 v[52:55], v7 offset:36864
    s_bfe_u32 s41, s52, 524288
    s_mul_i32 s41, s41, s40
    s_add_u32 s42, s58, s41
    s_add_u32 s43, s59, s41
    buffer_load_dwordx4 a[64:67], v240, s[8:11], s42 offen
    v_mfma_f32_32x32x16_bf16 v[80:95], v[36:39], v[40:43], v[80:95]
    ds_read_b128 v[56:59], v4 offset:34816
    buffer_load_dwordx4 a[68:71], v241, s[8:11], s43 offen
    v_mfma_f32_32x32x16_bf16 v[112:127], v[36:39], v[44:47], v[112:127]
    v_mfma_f32_4x4x4_16b_bf16 v[20:23], v[34:35], v[34:35], v[20:23]
    ds_read_b128 v[60:63], v4 offset:35840
    s_bfe_u32 s41, s52, 524296
    s_mul_i32 s41, s41, s40
    s_add_u32 s42, s58, s41
    s_add_u32 s43, s59, s41
    buffer_load_dwordx4 a[72:75], v240, s[8:11], s42 offen
    v_mfma_f32_32x32x16_bf16 v[144:159], v[44:47], v[36:39], v[144:159]
    buffer_load_dwordx4 a[76:79], v241, s[8:11], s43 offen
    s_waitcnt lgkmcnt(0)
    v_mfma_f32_32x32x16_bf16 v[64:79], v[48:51], v[56:59], v[64:79]
    v_mfma_f32_4x4x4_16b_bf16 v[20:23], v[48:49], v[48:49], v[20:23]
    v_mfma_f32_32x32x16_bf16 v[96:111], v[48:51], v[60:63], v[96:111]
    ds_read_b128 v[32:35], v8 offset:32768
    v_mfma_f32_32x32x16_bf16 v[128:143], v[60:63], v[48:51], v[128:143]
    ds_read_b128 v[36:39], v8 offset:36864
    v_mfma_f32_32x32x16_bf16 v[80:95], v[52:55], v[56:59], v[80:95]
    ds_read_b128 v[40:43], v4 offset:36864
    v_mfma_f32_32x32x16_bf16 v[112:127], v[52:55], v[60:63], v[112:127]
    v_mfma_f32_4x4x4_16b_bf16 v[20:23], v[50:51], v[50:51], v[20:23]
    ds_read_b128 v[44:47], v4 offset:37888
    v_mfma_f32_32x32x16_bf16 v[144:159], v[60:63], v[52:55], v[144:159]
    s_waitcnt lgkmcnt(0)
    v_mfma_f32_32x32x16_bf16 v[64:79], v[32:35], v[40:43], v[64:79]
    v_mfma_f32_4x4x4_16b_bf16 v[20:23], v[32:33], v[32:33], v[20:23]
    v_mfma_f32_32x32x16_bf16 v[96:111], v[32:35], v[44:47], v[96:111]
    ds_read_b128 v[48:51], v9 offset:32768
    v_mfma_f32_32x32x16_bf16 v[128:143], v[44:47], v[32:35], v[128:143]
    ds_read_b128 v[52:55], v9 offset:36864
    v_mfma_f32_32x32x16_bf16 v[80:95], v[36:39], v[40:43], v[80:95]
    ds_read_b128 v[56:59], v4 offset:38912
    v_mfma_f32_32x32x16_bf16 v[112:127], v[36:39], v[44:47], v[112:127]
    v_mfma_f32_4x4x4_16b_bf16 v[20:23], v[34:35], v[34:35], v[20:23]
    ds_read_b128 v[60:63], v4 offset:39936
    v_mfma_f32_32x32x16_bf16 v[144:159], v[44:47], v[36:39], v[144:159]
    s_waitcnt vmcnt(16)
    s_barrier
    s_waitcnt lgkmcnt(0)
    v_mfma_f32_32x32x16_bf16 v[64:79], v[48:51], v[56:59], v[64:79]
    v_mfma_f32_4x4x4_16b_bf16 v[20:23], v[48:49], v[48:49], v[20:23]
    s_lshl_b32 s28, s13, 12
    s_mov_b32 m0, s28
    s_add_u32 s29, s24, 1024
    buffer_load_dwordx4 v2, s[16:19], s29 offen offset:0 lds
    v_mfma_f32_32x32x16_bf16 v[96:111], v[48:51], v[60:63], v[96:111]
    ds_read_b128 v[32:35], v10 offset:0
    s_add_u32 s29, s29, 9216
    buffer_load_dwordx4 v3, s[16:19], s29 offen offset:1024 lds
    v_mfma_f32_32x32x16_bf16 v[128:143], v[60:63], v[48:51], v[128:143]
    ds_read_b128 v[36:39], v10 offset:4096
    s_add_u32 s29, s29, 9216
    buffer_load_dwordx4 v2, s[16:19], s29 offen offset:2048 lds
    v_mfma_f32_32x32x16_bf16 v[80:95], v[52:55], v[56:59], v[80:95]
    ds_read_b128 v[40:43], v5 offset:0
    s_add_u32 s29, s29, 9216
    buffer_load_dwordx4 v3, s[16:19], s29 offen offset:3072 lds
    v_mfma_f32_32x32x16_bf16 v[112:127], v[52:55], v[60:63], v[112:127]
    v_mfma_f32_4x4x4_16b_bf16 v[20:23], v[50:51], v[50:51], v[20:23]
    ds_read_b128 v[44:47], v5 offset:1024
    s_add_u32 s28, s28, 16384
    s_mov_b32 m0, s28
    s_add_u32 s29, s25, 65536
    buffer_load_dwordx4 v1, s[8:11], s29 offen offset:0 lds
    v_mfma_f32_32x32x16_bf16 v[144:159], v[60:63], v[52:55], v[144:159]
    buffer_load_dwordx4 v1, s[8:11], s29 offen offset:1024 lds
    s_waitcnt lgkmcnt(0)
    v_mfma_f32_32x32x16_bf16 v[64:79], v[32:35], v[40:43], v[64:79]
    v_mfma_f32_4x4x4_16b_bf16 v[20:23], v[32:33], v[32:33], v[20:23]
    buffer_load_dwordx4 v1, s[8:11], s29 offen offset:2048 lds
    v_mfma_f32_32x32x16_bf16 v[96:111], v[32:35], v[44:47], v[96:111]
    ds_read_b128 v[48:51], v11 offset:0
    buffer_load_dwordx4 v1, s[8:11], s29 offen offset:3072 lds
    v_mfma_f32_32x32x16_bf16 v[128:143], v[44:47], v[32:35], v[128:143]
    ds_read_b128 v[52:55], v11 offset:4096
    s_bfe_u32 s41, s52, 524304
    s_mul_i32 s41, s41, s40
    s_add_u32 s42, s58, s41
    s_add_u32 s43, s59, s41
    buffer_load_dwordx4 a[80:83], v240, s[8:11], s42 offen
    v_mfma_f32_32x32x16_bf16 v[80:95], v[36:39], v[40:43], v[80:95]
    ds_read_b128 v[56:59], v5 offset:2048
    buffer_load_dwordx4 a[84:87], v241, s[8:11], s43 offen
    v_mfma_f32_32x32x16_bf16 v[112:127], v[36:39], v[44:47], v[112:127]
    v_mfma_f32_4x4x4_16b_bf16 v[20:23], v[34:35], v[34:35], v[20:23]
    ds_read_b128 v[60:63], v5 offset:3072
    s_bfe_u32 s41, s52, 524312
    s_mul_i32 s41, s41, s40
    s_add_u32 s42, s58, s41
    s_add_u32 s43, s59, s41
    buffer_load_dwordx4 a[88:91], v240, s[8:11], s42 offen
    v_mfma_f32_32x32x16_bf16 v[144:159], v[44:47], v[36:39], v[144:159]
    buffer_load_dwordx4 a[92:95], v241, s[8:11], s43 offen
    s_waitcnt lgkmcnt(0)
    v_mfma_f32_32x32x16_bf16 v[64:79], v[48:51], v[56:59], v[64:79]
    v_mfma_f32_4x4x4_16b_bf16 v[20:23], v[48:49], v[48:49], v[20:23]
    v_mfma_f32_32x32x16_bf16 v[96:111], v[48:51], v[60:63], v[96:111]
    ds_read_b128 v[32:35], v12 offset:0
    v_mfma_f32_32x32x16_bf16 v[128:143], v[60:63], v[48:51], v[128:143]
    ds_read_b128 v[36:39], v12 offset:4096
    v_mfma_f32_32x32x16_bf16 v[80:95], v[52:55], v[56:59], v[80:95]
    ds_read_b128 v[40:43], v5 offset:4096
    v_mfma_f32_32x32x16_bf16 v[112:127], v[52:55], v[60:63], v[112:127]
    v_mfma_f32_4x4x4_16b_bf16 v[20:23], v[50:51], v[50:51], v[20:23]
    ds_read_b128 v[44:47], v5 offset:5120
    v_mfma_f32_32x32x16_bf16 v[144:159], v[60:63], v[52:55], v[144:159]
    s_waitcnt lgkmcnt(0)
    v_mfma_f32_32x32x16_bf16 v[64:79], v[32:35], v[40:43], v[64:79]
    v_mfma_f32_4x4x4_16b_bf16 v[20:23], v[32:33], v[32:33], v[20:23]
    v_mfma_f32_32x32x16_bf16 v[96:111], v[32:35], v[44:47], v[96:111]
    ds_read_b128 v[48:51], v13 offset:0
    v_mfma_f32_32x32x16_bf16 v[128:143], v[44:47], v[32:35], v[128:143]
    ds_read_b128 v[52:55], v13 offset:4096
    v_mfma_f32_32x32x16_bf16 v[80:95], v[36:39], v[40:43], v[80:95]
    ds_read_b128 v[56:59], v5 offset:6144
    v_mfma_f32_32x32x16_bf16 v[112:127], v[36:39], v[44:47], v[112:127]
    v_mfma_f32_4x4x4_16b_bf16 v[20:23], v[34:35], v[34:35], v[20:23]
    ds_read_b128 v[60:63], v5 offset:7168
    v_mfma_f32_32x32x16_bf16 v[144:159], v[44:47], v[36:39], v[144:159]
    s_waitcnt vmcnt(16)
    s_barrier
    s_waitcnt lgkmcnt(0)
    v_mfma_f32_32x32x16_bf16 v[64:79], v[48:51], v[56:59], v[64:79]
    v_mfma_f32_4x4x4_16b_bf16 v[20:23], v[48:49], v[48:49], v[20:23]
    s_lshl_b32 s28, s13, 12
    s_add_u32 s28, s28, 32768
    s_mov_b32 m0, s28
    s_add_u32 s29, s24, 1152
    buffer_load_dwordx4 v2, s[16:19], s29 offen offset:0 lds
    v_mfma_f32_32x32x16_bf16 v[96:111], v[48:51], v[60:63], v[96:111]
    ds_read_b128 v[32:35], v10 offset:32768
    s_add_u32 s29, s29, 9216
    buffer_load_dwordx4 v3, s[16:19], s29 offen offset:1024 lds
    v_mfma_f32_32x32x16_bf16 v[128:143], v[60:63], v[48:51], v[128:143]
    ds_read_b128 v[36:39], v10 offset:36864
    s_add_u32 s29, s29, 9216
    buffer_load_dwordx4 v2, s[16:19], s29 offen offset:2048 lds
    v_mfma_f32_32x32x16_bf16 v[80:95], v[52:55], v[56:59], v[80:95]
    ds_read_b128 v[40:43], v5 offset:32768
    s_add_u32 s29, s29, 9216
    buffer_load_dwordx4 v3, s[16:19], s29 offen offset:3072 lds
    v_mfma_f32_32x32x16_bf16 v[112:127], v[52:55], v[60:63], v[112:127]
    v_mfma_f32_4x4x4_16b_bf16 v[20:23], v[50:51], v[50:51], v[20:23]
    ds_read_b128 v[44:47], v5 offset:33792
    s_add_u32 s28, s28, 16384
    s_mov_b32 m0, s28
    s_add_u32 s29, s25, 73728
    buffer_load_dwordx4 v1, s[8:11], s29 offen offset:0 lds
    v_mfma_f32_32x32x16_bf16 v[144:159], v[60:63], v[52:55], v[144:159]
    buffer_load_dwordx4 v1, s[8:11], s29 offen offset:1024 lds
    s_waitcnt lgkmcnt(0)
    v_mfma_f32_32x32x16_bf16 v[64:79], v[32:35], v[40:43], v[64:79]
    v_mfma_f32_4x4x4_16b_bf16 v[20:23], v[32:33], v[32:33], v[20:23]
    buffer_load_dwordx4 v1, s[8:11], s29 offen offset:2048 lds
    v_mfma_f32_32x32x16_bf16 v[96:111], v[32:35], v[44:47], v[96:111]
    ds_read_b128 v[48:51], v11 offset:32768
    buffer_load_dwordx4 v1, s[8:11], s29 offen offset:3072 lds
    v_mfma_f32_32x32x16_bf16 v[128:143], v[44:47], v[32:35], v[128:143]
    ds_read_b128 v[52:55], v11 offset:36864
    s_bfe_u32 s41, s53, 524288
    s_mul_i32 s41, s41, s40
    s_add_u32 s42, s58, s41
    s_add_u32 s43, s59, s41
    buffer_load_dwordx4 a[96:99], v240, s[8:11], s42 offen
    v_mfma_f32_32x32x16_bf16 v[80:95], v[36:39], v[40:43], v[80:95]
    ds_read_b128 v[56:59], v5 offset:34816
    buffer_load_dwordx4 a[100:103], v241, s[8:11], s43 offen
    v_mfma_f32_32x32x16_bf16 v[112:127], v[36:39], v[44:47], v[112:127]
    v_mfma_f32_4x4x4_16b_bf16 v[20:23], v[34:35], v[34:35], v[20:23]
    ds_read_b128 v[60:63], v5 offset:35840
    s_bfe_u32 s41, s53, 524296
    s_mul_i32 s41, s41, s40
    s_add_u32 s42, s58, s41
    s_add_u32 s43, s59, s41
    buffer_load_dwordx4 a[104:107], v240, s[8:11], s42 offen
    v_mfma_f32_32x32x16_bf16 v[144:159], v[44:47], v[36:39], v[144:159]
    buffer_load_dwordx4 a[108:111], v241, s[8:11], s43 offen
    s_waitcnt lgkmcnt(0)
    v_mfma_f32_32x32x16_bf16 v[64:79], v[48:51], v[56:59], v[64:79]
    v_mfma_f32_4x4x4_16b_bf16 v[20:23], v[48:49], v[48:49], v[20:23]
    v_mfma_f32_32x32x16_bf16 v[96:111], v[48:51], v[60:63], v[96:111]
    ds_read_b128 v[32:35], v12 offset:32768
    v_mfma_f32_32x32x16_bf16 v[128:143], v[60:63], v[48:51], v[128:143]
    ds_read_b128 v[36:39], v12 offset:36864
    v_mfma_f32_32x32x16_bf16 v[80:95], v[52:55], v[56:59], v[80:95]
    ds_read_b128 v[40:43], v5 offset:36864
    v_mfma_f32_32x32x16_bf16 v[112:127], v[52:55], v[60:63], v[112:127]
    v_mfma_f32_4x4x4_16b_bf16 v[20:23], v[50:51], v[50:51], v[20:23]
    ds_read_b128 v[44:47], v5 offset:37888
    v_mfma_f32_32x32x16_bf16 v[144:159], v[60:63], v[52:55], v[144:159]
    s_waitcnt lgkmcnt(0)
    v_mfma_f32_32x32x16_bf16 v[64:79], v[32:35], v[40:43], v[64:79]
    v_mfma_f32_4x4x4_16b_bf16 v[20:23], v[32:33], v[32:33], v[20:23]
    v_mfma_f32_32x32x16_bf16 v[96:111], v[32:35], v[44:47], v[96:111]
    ds_read_b128 v[48:51], v13 offset:32768
    v_mfma_f32_32x32x16_bf16 v[128:143], v[44:47], v[32:35], v[128:143]
    ds_read_b128 v[52:55], v13 offset:36864
    v_mfma_f32_32x32x16_bf16 v[80:95], v[36:39], v[40:43], v[80:95]
    ds_read_b128 v[56:59], v5 offset:38912
    v_mfma_f32_32x32x16_bf16 v[112:127], v[36:39], v[44:47], v[112:127]
    v_mfma_f32_4x4x4_16b_bf16 v[20:23], v[34:35], v[34:35], v[20:23]
    ds_read_b128 v[60:63], v5 offset:39936
    v_mfma_f32_32x32x16_bf16 v[144:159], v[44:47], v[36:39], v[144:159]
    s_waitcnt vmcnt(16)
    s_barrier
    s_waitcnt lgkmcnt(0)
    v_mfma_f32_32x32x16_bf16 v[64:79], v[48:51], v[56:59], v[64:79]
    v_mfma_f32_4x4x4_16b_bf16 v[20:23], v[48:49], v[48:49], v[20:23]
    s_bfe_u32 s41, s53, 524304
    s_mul_i32 s41, s41, s40
    s_add_u32 s42, s58, s41
    s_add_u32 s43, s59, s41
    buffer_load_dwordx4 a[112:115], v240, s[8:11], s42 offen
    v_mfma_f32_32x32x16_bf16 v[96:111], v[48:51], v[60:63], v[96:111]
    ds_read_b128 v[32:35], v6 offset:0
    buffer_load_dwordx4 a[116:119], v241, s[8:11], s43 offen
    v_mfma_f32_32x32x16_bf16 v[128:143], v[60:63], v[48:51], v[128:143]
    ds_read_b128 v[36:39], v6 offset:4096
    s_bfe_u32 s41, s53, 524312
    s_mul_i32 s41, s41, s40
    s_add_u32 s42, s58, s41
    s_add_u32 s43, s59, s41
    buffer_load_dwordx4 a[120:123], v240, s[8:11], s42 offen
    v_mfma_f32_32x32x16_bf16 v[80:95], v[52:55], v[56:59], v[80:95]
    ds_read_b128 v[40:43], v4 offset:0
    buffer_load_dwordx4 a[124:127], v241, s[8:11], s43 offen
    v_mfma_f32_32x32x16_bf16 v[112:127], v[52:55], v[60:63], v[112:127]
    v_mfma_f32_4x4x4_16b_bf16 v[20:23], v[50:51], v[50:51], v[20:23]
    ds_read_b128 v[44:47], v4 offset:1024
    v_mfma_f32_32x32x16_bf16 v[144:159], v[60:63], v[52:55], v[144:159]
    s_waitcnt lgkmcnt(0)
    v_mfma_f32_32x32x16_bf16 v[64:79], v[32:35], v[40:43], v[64:79]
    v_mfma_f32_4x4x4_16b_bf16 v[20:23], v[32:33], v[32:33], v[20:23]
    v_mfma_f32_32x32x16_bf16 v[96:111], v[32:35], v[44:47], v[96:111]
    ds_read_b128 v[48:51], v7 offset:0
    v_mfma_f32_32x32x16_bf16 v[128:143], v[44:47], v[32:35], v[128:143]
    ds_read_b128 v[52:55], v7 offset:4096
    v_mfma_f32_32x32x16_bf16 v[80:95], v[36:39], v[40:43], v[80:95]
    ds_read_b128 v[56:59], v4 offset:2048
    v_mfma_f32_32x32x16_bf16 v[112:127], v[36:39], v[44:47], v[112:127]
    v_mfma_f32_4x4x4_16b_bf16 v[20:23], v[34:35], v[34:35], v[20:23]
    ds_read_b128 v[60:63], v4 offset:3072
    v_mfma_f32_32x32x16_bf16 v[144:159], v[44:47], v[36:39], v[144:159]
    s_waitcnt lgkmcnt(0)
    v_mfma_f32_32x32x16_bf16 v[64:79], v[48:51], v[56:59], v[64:79]
    v_mfma_f32_4x4x4_16b_bf16 v[20:23], v[48:49], v[48:49], v[20:23]
    v_mfma_f32_32x32x16_bf16 v[96:111], v[48:51], v[60:63], v[96:111]
    ds_read_b128 v[32:35], v8 offset:0
    v_mfma_f32_32x32x16_bf16 v[128:143], v[60:63], v[48:51], v[128:143]
    ds_read_b128 v[36:39], v8 offset:4096
    v_mfma_f32_32x32x16_bf16 v[80:95], v[52:55], v[56:59], v[80:95]
    ds_read_b128 v[40:43], v4 offset:4096
    v_mfma_f32_32x32x16_bf16 v[112:127], v[52:55], v[60:63], v[112:127]
    v_mfma_f32_4x4x4_16b_bf16 v[20:23], v[50:51], v[50:51], v[20:23]
    ds_read_b128 v[44:47], v4 offset:5120
    v_mfma_f32_32x32x16_bf16 v[144:159], v[60:63], v[52:55], v[144:159]
    s_waitcnt lgkmcnt(0)
    v_mfma_f32_32x32x16_bf16 v[64:79], v[32:35], v[40:43], v[64:79]
    v_mfma_f32_4x4x4_16b_bf16 v[20:23], v[32:33], v[32:33], v[20:23]
    v_mfma_f32_32x32x16_bf16 v[96:111], v[32:35], v[44:47], v[96:111]
    ds_read_b128 v[48:51], v9 offset:0
    v_mfma_f32_32x32x16_bf16 v[128:143], v[44:47], v[32:35], v[128:143]
    ds_read_b128 v[52:55], v9 offset:4096
    v_mfma_f32_32x32x16_bf16 v[80:95], v[36:39], v[40:43], v[80:95]
    ds_read_b128 v[56:59], v4 offset:6144
    v_mfma_f32_32x32x16_bf16 v[112:127], v[36:39], v[44:47], v[112:127]
    v_mfma_f32_4x4x4_16b_bf16 v[20:23], v[34:35], v[34:35], v[20:23]
    ds_read_b128 v[60:63], v4 offset:7168
    v_mfma_f32_32x32x16_bf16 v[144:159], v[44:47], v[36:39], v[144:159]
    s_waitcnt vmcnt(8)
    s_barrier
    s_waitcnt lgkmcnt(0)
    v_mfma_f32_32x32x16_bf16 v[64:79], v[48:51], v[56:59], v[64:79]
    v_mfma_f32_4x4x4_16b_bf16 v[20:23], v[48:49], v[48:49], v[20:23]
    s_bfe_u32 s41, s54, 524288
    s_mul_i32 s41, s41, s40
    s_add_u32 s42, s58, s41
    s_add_u32 s43, s59, s41
    buffer_load_dwordx4 a[128:131], v240, s[8:11], s42 offen
    v_mfma_f32_32x32x16_bf16 v[96:111], v[48:51], v[60:63], v[96:111]
    ds_read_b128 v[32:35], v6 offset:32768
    buffer_load_dwordx4 a[132:135], v241, s[8:11], s43 offen
    v_mfma_f32_32x32x16_bf16 v[128:143], v[60:63], v[48:51], v[128:143]
    ds_read_b128 v[36:39], v6 offset:36864
    v_mfma_f32_32x32x16_bf16 v[80:95], v[52:55], v[56:59], v[80:95]
    ds_read_b128 v[40:43], v4 offset:32768
    v_mfma_f32_32x32x16_bf16 v[112:127], v[52:55], v[60:63], v[112:127]
    v_mfma_f32_4x4x4_16b_bf16 v[20:23], v[50:51], v[50:51], v[20:23]
    ds_read_b128 v[44:47], v4 offset:33792
    v_mfma_f32_32x32x16_bf16 v[144:159], v[60:63], v[52:55], v[144:159]
    s_waitcnt lgkmcnt(0)
    v_mfma_f32_32x32x16_bf16 v[64:79], v[32:35], v[40:43], v[64:79]
    v_mfma_f32_4x4x4_16b_bf16 v[20:23], v[32:33], v[32:33], v[20:23]
    v_mfma_f32_32x32x16_bf16 v[96:111], v[32:35], v[44:47], v[96:111]
    ds_read_b128 v[48:51], v7 offset:32768
    v_mfma_f32_32x32x16_bf16 v[128:143], v[44:47], v[32:35], v[128:143]
    ds_read_b128 v[52:55], v7 offset:36864
    v_mfma_f32_32x32x16_bf16 v[80:95], v[36:39], v[40:43], v[80:95]
    ds_read_b128 v[56:59], v4 offset:34816
    v_mfma_f32_32x32x16_bf16 v[112:127], v[36:39], v[44:47], v[112:127]
    v_mfma_f32_4x4x4_16b_bf16 v[20:23], v[34:35], v[34:35], v[20:23]
    ds_read_b128 v[60:63], v4 offset:35840
    v_mfma_f32_32x32x16_bf16 v[144:159], v[44:47], v[36:39], v[144:159]
    s_waitcnt lgkmcnt(0)
    v_mfma_f32_32x32x16_bf16 v[64:79], v[48:51], v[56:59], v[64:79]
    v_mfma_f32_4x4x4_16b_bf16 v[20:23], v[48:49], v[48:49], v[20:23]
    v_mfma_f32_32x32x16_bf16 v[96:111], v[48:51], v[60:63], v[96:111]
    ds_read_b128 v[32:35], v8 offset:32768
    v_mfma_f32_32x32x16_bf16 v[128:143], v[60:63], v[48:51], v[128:143]
    ds_read_b128 v[36:39], v8 offset:36864
    v_mfma_f32_32x32x16_bf16 v[80:95], v[52:55], v[56:59], v[80:95]
    ds_read_b128 v[40:43], v4 offset:36864
    v_mfma_f32_32x32x16_bf16 v[112:127], v[52:55], v[60:63], v[112:127]
    v_mfma_f32_4x4x4_16b_bf16 v[20:23], v[50:51], v[50:51], v[20:23]
    ds_read_b128 v[44:47], v4 offset:37888
    v_mfma_f32_32x32x16_bf16 v[144:159], v[60:63], v[52:55], v[144:159]
    s_waitcnt lgkmcnt(0)
    v_mfma_f32_32x32x16_bf16 v[64:79], v[32:35], v[40:43], v[64:79]
    v_mfma_f32_4x4x4_16b_bf16 v[20:23], v[32:33], v[32:33], v[20:23]
    v_mfma_f32_32x32x16_bf16 v[96:111], v[32:35], v[44:47], v[96:111]
    ds_read_b128 v[48:51], v9 offset:32768
    v_mfma_f32_32x32x16_bf16 v[128:143], v[44:47], v[32:35], v[128:143]
    ds_read_b128 v[52:55], v9 offset:36864
    v_mfma_f32_32x32x16_bf16 v[80:95], v[36:39], v[40:43], v[80:95]
    ds_read_b128 v[56:59], v4 offset:38912
    v_mfma_f32_32x32x16_bf16 v[112:127], v[36:39], v[44:47], v[112:127]
    v_mfma_f32_4x4x4_16b_bf16 v[20:23], v[34:35], v[34:35], v[20:23]
    ds_read_b128 v[60:63], v4 offset:39936
    v_mfma_f32_32x32x16_bf16 v[144:159], v[44:47], v[36:39], v[144:159]
    s_waitcnt lgkmcnt(0)
    v_mfma_f32_32x32x16_bf16 v[64:79], v[48:51], v[56:59], v[64:79]
    v_mfma_f32_4x4x4_16b_bf16 v[20:23], v[48:49], v[48:49], v[20:23]
    s_bfe_u32 s41, s54, 524296
    s_mul_i32 s41, s41, s40
    s_add_u32 s42, s58, s41
    s_add_u32 s43, s59, s41
    buffer_load_dwordx4 a[136:139], v240, s[8:11], s42 offen
    v_mfma_f32_32x32x16_bf16 v[96:111], v[48:51], v[60:63], v[96:111]
    buffer_load_dwordx4 a[140:143], v241, s[8:11], s43 offen
    v_mfma_f32_32x32x16_bf16 v[128:143], v[60:63], v[48:51], v[128:143]
    v_mfma_f32_32x32x16_bf16 v[80:95], v[52:55], v[56:59], v[80:95]
    v_mfma_f32_32x32x16_bf16 v[112:127], v[52:55], v[60:63], v[112:127]
    v_mfma_f32_4x4x4_16b_bf16 v[20:23], v[50:51], v[50:51], v[20:23]
    v_mfma_f32_32x32x16_bf16 v[144:159], v[60:63], v[52:55], v[144:159]
    s_branch layerb1_kernel_af_epi
layerb1_kernel_af_h1:
    s_waitcnt lgkmcnt(0)
    v_mfma_f32_32x32x16_bf16 v[64:79], v[32:35], v[40:43], 0
    v_mfma_f32_4x4x4_16b_bf16 v[20:23], v[36:37], v[36:37], v[20:23]
    v_mfma_f32_32x32x16_bf16 v[96:111], v[32:35], v[44:47], 0
    ds_read_b128 v[48:51], v7 offset:0
    v_mfma_f32_32x32x16_bf16 v[128:143], v[44:47], v[32:35], 0
    ds_read_b128 v[52:55], v7 offset:4096
    v_mfma_f32_32x32x16_bf16 v[80:95], v[36:39], v[40:43], 0
    ds_read_b128 v[56:59], v4 offset:2048
    v_mfma_f32_32x32x16_bf16 v[112:127], v[36:39], v[44:47], 0
    v_mfma_f32_4x4x4_16b_bf16 v[20:23], v[38:39], v[38:39], v[20:23]
    ds_read_b128 v[60:63], v4 offset:3072
    v_mfma_f32_32x32x16_bf16 v[144:159], v[44:47], v[36:39], 0
    s_waitcnt lgkmcnt(0)
    v_mfma_f32_32x32x16_bf16 v[64:79], v[48:51], v[56:59], v[64:79]
    v_mfma_f32_4x4x4_16b_bf16 v[20:23], v[52:53], v[52:53], v[20:23]
    v_mfma_f32_32x32x16_bf16 v[96:111], v[48:51], v[60:63], v[96:111]
    ds_read_b128 v[32:35], v8 offset:0
    v_mfma_f32_32x32x16_bf16 v[128:143], v[60:63], v[48:51], v[128:143]
    ds_read_b128 v[36:39], v8 offset:4096
    v_mfma_f32_32x32x16_bf16 v[80:95], v[52:55], v[56:59], v[80:95]
    ds_read_b128 v[40:43], v4 offset:4096
    v_mfma_f32_32x32x16_bf16 v[112:127], v[52:55], v[60:63], v[112:127]
    v_mfma_f32_4x4x4_16b_bf16 v[20:23], v[54:55], v[54:55], v[20:23]
    ds_read_b128 v[44:47], v4 offset:5120
    v_mfma_f32_32x32x16_bf16 v[144:159], v[60:63], v[52:55], v[144:159]
    s_waitcnt lgkmcnt(0)
    v_mfma_f32_32x32x16_bf16 v[64:79], v[32:35], v[40:43], v[64:79]
    v_mfma_f32_4x4x4_16b_bf16 v[20:23], v[36:37], v[36:37], v[20:23]
    v_mfma_f32_32x32x16_bf16 v[96:111], v[32:35], v[44:47], v[96:111]
    ds_read_b128 v[48:51], v9 offset:0
    v_mfma_f32_32x32x16_bf16 v[128:143], v[44:47], v[32:35], v[128:143]
    ds_read_b128 v[52:55], v9 offset:4096
    v_mfma_f32_32x32x16_bf16 v[80:95], v[36:39], v[40:43], v[80:95]
    ds_read_b128 v[56:59], v4 offset:6144
    v_mfma_f32_32x32x16_bf16 v[112:127], v[36:39], v[44:47], v[112:127]
    v_mfma_f32_4x4x4_16b_bf16 v[20:23], v[38:39], v[38:39], v[20:23]
    ds_read_b128 v[60:63], v4 offset:7168
    v_mfma_f32_32x32x16_bf16 v[144:159], v[44:47], v[36:39], v[144:159]
    s_waitcnt vmcnt(8)
    s_barrier
    s_waitcnt lgkmcnt(0)
    v_mfma_f32_32x32x16_bf16 v[64:79], v[48:51], v[56:59], v[64:79]
    v_mfma_f32_4x4x4_16b_bf16 v[20:23], v[52:53], v[52:53], v[20:23]
    s_lshl_b32 s28, s13, 12
    s_add_u32 s28, s28, 98304
    s_mov_b32 m0, s28
    s_add_u32 s29, s24, 384
    buffer_load_dwordx4 v2, s[16:19], s29 offen offset:0 lds
    v_mfma_f32_32x32x16_bf16 v[96:111], v[48:51], v[60:63], v[96:111]
    ds_read_b128 v[32:35], v6 offset:32768
    s_add_u32 s29, s29, 9216
    buffer_load_dwordx4 v3, s[16:19], s29 offen offset:1024 lds
    v_mfma_f32_32x32x16_bf16 v[128:143], v[60:63], v[48:51], v[128:143]
    ds_read_b128 v[36:39], v6 offset:36864
    s_add_u32 s29, s29, 9216
    buffer_load_dwordx4 v2, s[16:19], s29 offen offset:2048 lds
    v_mfma_f32_32x32x16_bf16 v[80:95], v[52:55], v[56:59], v[80:95]
    ds_read_b128 v[40:43], v4 offset:32768
    s_add_u32 s29, s29, 9216
    buffer_load_dwordx4 v3, s[16:19], s29 offen offset:3072 lds
    v_mfma_f32_32x32x16_bf16 v[112:127], v[52:55], v[60:63], v[112:127]
    v_mfma_f32_4x4x4_16b_bf16 v[20:23], v[54:55], v[54:55], v[20:23]
    ds_read_b128 v[44:47], v4 offset:33792
    s_add_u32 s28, s28, 16384
    s_mov_b32 m0, s28
    s_add_u32 s29, s25, 24576
    buffer_load_dwordx4 v1, s[8:11], s29 offen offset:0 lds
    v_mfma_f32_32x32x16_bf16 v[144:159], v[60:63], v[52:55], v[144:159]
    buffer_load_dwordx4 v1, s[8:11], s29 offen offset:1024 lds
    s_waitcnt lgkmcnt(0)
    v_mfma_f32_32x32x16_bf16 v[64:79], v[32:35], v[40:43], v[64:79]
    v_mfma_f32_4x4x4_16b_bf16 v[20:23], v[36:37], v[36:37], v[20:23]
    buffer_load_dwordx4 v1, s[8:11], s29 offen offset:2048 lds
    v_mfma_f32_32x32x16_bf16 v[96:111], v[32:35], v[44:47], v[96:111]
    ds_read_b128 v[48:51], v7 offset:32768
    buffer_load_dwordx4 v1, s[8:11], s29 offen offset:3072 lds
    v_mfma_f32_32x32x16_bf16 v[128:143], v[44:47], v[32:35], v[128:143]
    ds_read_b128 v[52:55], v7 offset:36864
    s_bfe_u32 s41, s50, 524288
    s_mul_i32 s41, s41, s40
    s_add_u32 s42, s58, s41
    s_add_u32 s43, s59, s41
    buffer_load_dwordx4 a[0:3], v240, s[8:11], s42 offen
    v_mfma_f32_32x32x16_bf16 v[80:95], v[36:39], v[40:43], v[80:95]
    ds_read_b128 v[56:59], v4 offset:34816
    buffer_load_dwordx4 a[4:7], v241, s[8:11], s43 offen
    v_mfma_f32_32x32x16_bf16 v[112:127], v[36:39], v[44:47], v[112:127]
    v_mfma_f32_4x4x4_16b_bf16 v[20:23], v[38:39], v[38:39], v[20:23]
    ds_read_b128 v[60:63], v4 offset:35840
    s_bfe_u32 s41, s50, 524296
    s_mul_i32 s41, s41, s40
    s_add_u32 s42, s58, s41
    s_add_u32 s43, s59, s41
    buffer_load_dwordx4 a[8:11], v240, s[8:11], s42 offen
    v_mfma_f32_32x32x16_bf16 v[144:159], v[44:47], v[36:39], v[144:159]
    buffer_load_dwordx4 a[12:15], v241, s[8:11], s43 offen
    s_waitcnt lgkmcnt(0)
    v_mfma_f32_32x32x16_bf16 v[64:79], v[48:51], v[56:59], v[64:79]
    v_mfma_f32_4x4x4_16b_bf16 v[20:23], v[52:53], v[52:53], v[20:23]
    v_mfma_f32_32x32x16_bf16 v[96:111], v[48:51], v[60:63], v[96:111]
    ds_read_b128 v[32:35], v8 offset:32768
    v_mfma_f32_32x32x16_bf16 v[128:143], v[60:63], v[48:51], v[128:143]
    ds_read_b128 v[36:39], v8 offset:36864
    v_mfma_f32_32x32x16_bf16 v[80:95], v[52:55], v[56:59], v[80:95]
    ds_read_b128 v[40:43], v4 offset:36864
    v_mfma_f32_32x32x16_bf16 v[112:127], v[52:55], v[60:63], v[112:127]
    v_mfma_f32_4x4x4_16b_bf16 v[20:23], v[54:55], v[54:55], v[20:23]
    ds_read_b128 v[44:47], v4 offset:37888
    v_mfma_f32_32x32x16_bf16 v[144:159], v[60:63], v[52:55], v[144:159]
    s_waitcnt lgkmcnt(0)
    v_mfma_f32_32x32x16_bf16 v[64:79], v[32:35], v[40:43], v[64:79]
    v_mfma_f32_4x4x4_16b_bf16 v[20:23], v[36:37], v[36:37], v[20:23]
    v_mfma_f32_32x32x16_bf16 v[96:111], v[32:35], v[44:47], v[96:111]
    ds_read_b128 v[48:51], v9 offset:32768
    v_mfma_f32_32x32x16_bf16 v[128:143], v[44:47], v[32:35], v[128:143]
    ds_read_b128 v[52:55], v9 offset:36864
    v_mfma_f32_32x32x16_bf16 v[80:95], v[36:39], v[40:43], v[80:95]
    ds_read_b128 v[56:59], v4 offset:38912
    v_mfma_f32_32x32x16_bf16 v[112:127], v[36:39], v[44:47], v[112:127]
    v_mfma_f32_4x4x4_16b_bf16 v[20:23], v[38:39], v[38:39], v[20:23]
    ds_read_b128 v[60:63], v4 offset:39936
    v_mfma_f32_32x32x16_bf16 v[144:159], v[44:47], v[36:39], v[144:159]
    s_waitcnt vmcnt(12)
    s_barrier
    s_waitcnt lgkmcnt(0)
    v_mfma_f32_32x32x16_bf16 v[64:79], v[48:51], v[56:59], v[64:79]
    v_mfma_f32_4x4x4_16b_bf16 v[20:23], v[52:53], v[52:53], v[20:23]
    s_lshl_b32 s28, s13, 12
    s_mov_b32 m0, s28
    s_add_u32 s29, s24, 512
    buffer_load_dwordx4 v2, s[16:19], s29 offen offset:0 lds
    v_mfma_f32_32x32x16_bf16 v[96:111], v[48:51], v[60:63], v[96:111]
    ds_read_b128 v[32:35], v10 offset:0
    s_add_u32 s29, s29, 9216
    buffer_load_dwordx4 v3, s[16:19], s29 offen offset:1024 lds
    v_mfma_f32_32x32x16_bf16 v[128:143], v[60:63], v[48:51], v[128:143]
    ds_read_b128 v[36:39], v10 offset:4096
    s_add_u32 s29, s29, 9216
    buffer_load_dwordx4 v2, s[16:19], s29 offen offset:2048 lds
    v_mfma_f32_32x32x16_bf16 v[80:95], v[52:55], v[56:59], v[80:95]
    ds_read_b128 v[40:43], v5 offset:0
    s_add_u32 s29, s29, 9216
    buffer_load_dwordx4 v3, s[16:19], s29 offen offset:3072 lds
    v_mfma_f32_32x32x16_bf16 v[112:127], v[52:55], v[60:63], v[112:127]
    v_mfma_f32_4x4x4_16b_bf16 v[20:23], v[54:55], v[54:55], v[20:23]
    ds_read_b128 v[44:47], v5 offset:1024
    s_add_u32 s28, s28, 16384
    s_mov_b32 m0, s28
    s_add_u32 s29, s25, 32768
    buffer_load_dwordx4 v1, s[8:11], s29 offen offset:0 lds
    v_mfma_f32_32x32x16_bf16 v[144:159], v[60:63], v[52:55], v[144:159]
    buffer_load_dwordx4 v1, s[8:11], s29 offen offset:1024 lds
    s_waitcnt lgkmcnt(0)
    v_mfma_f32_32x32x16_bf16 v[64:79], v[32:35], v[40:43], v[64:79]
    v_mfma_f32_4x4x4_16b_bf16 v[20:23], v[36:37], v[36:37], v[20:23]
    buffer_load_dwordx4 v1, s[8:11], s29 offen offset:2048 lds
    v_mfma_f32_32x32x16_bf16 v[96:111], v[32:35], v[44:47], v[96:111]
    ds_read_b128 v[48:51], v11 offset:0
    buffer_load_dwordx4 v1, s[8:11], s29 offen offset:3072 lds
    v_mfma_f32_32x32x16_bf16 v[128:143], v[44:47], v[32:35], v[128:143]
    ds_read_b128 v[52:55], v11 offset:4096
    s_bfe_u32 s41, s50, 524304
    s_mul_i32 s41, s41, s40
    s_add_u32 s42, s58, s41
    s_add_u32 s43, s59, s41
    buffer_load_dwordx4 a[16:19], v240, s[8:11], s42 offen
    v_mfma_f32_32x32x16_bf16 v[80:95], v[36:39], v[40:43], v[80:95]
    ds_read_b128 v[56:59], v5 offset:2048
    buffer_load_dwordx4 a[20:23], v241, s[8:11], s43 offen
    v_mfma_f32_32x32x16_bf16 v[112:127], v[36:39], v[44:47], v[112:127]
    v_mfma_f32_4x4x4_16b_bf16 v[20:23], v[38:39], v[38:39], v[20:23]
    ds_read_b128 v[60:63], v5 offset:3072
    s_bfe_u32 s41, s50, 524312
    s_mul_i32 s41, s41, s40
    s_add_u32 s42, s58, s41
    s_add_u32 s43, s59, s41
    buffer_load_dwordx4 a[24:27], v240, s[8:11], s42 offen
    v_mfma_f32_32x32x16_bf16 v[144:159], v[44:47], v[36:39], v[144:159]
    buffer_load_dwordx4 a[28:31], v241, s[8:11], s43 offen
    s_waitcnt lgkmcnt(0)
    v_mfma_f32_32x32x16_bf16 v[64:79], v[48:51], v[56:59], v[64:79]
    v_mfma_f32_4x4x4_16b_bf16 v[20:23], v[52:53], v[52:53], v[20:23]
    v_mfma_f32_32x32x16_bf16 v[96:111], v[48:51], v[60:63], v[96:111]
    ds_read_b128 v[32:35], v12 offset:0
    v_mfma_f32_32x32x16_bf16 v[128:143], v[60:63], v[48:51], v[128:143]
    ds_read_b128 v[36:39], v12 offset:4096
    v_mfma_f32_32x32x16_bf16 v[80:95], v[52:55], v[56:59], v[80:95]
    ds_read_b128 v[40:43], v5 offset:4096
    v_mfma_f32_32x32x16_bf16 v[112:127], v[52:55], v[60:63], v[112:127]
    v_mfma_f32_4x4x4_16b_bf16 v[20:23], v[54:55], v[54:55], v[20:23]
    ds_read_b128 v[44:47], v5 offset:5120
    v_mfma_f32_32x32x16_bf16 v[144:159], v[60:63], v[52:55], v[144:159]
    s_waitcnt lgkmcnt(0)
    v_mfma_f32_32x32x16_bf16 v[64:79], v[32:35], v[40:43], v[64:79]
    v_mfma_f32_4x4x4_16b_bf16 v[20:23], v[36:37], v[36:37], v[20:23]
    v_mfma_f32_32x32x16_bf16 v[96:111], v[32:35], v[44:47], v[96:111]
    ds_read_b128 v[48:51], v13 offset:0
    v_mfma_f32_32x32x16_bf16 v[128:143], v[44:47], v[32:35], v[128:143]
    ds_read_b128 v[52:55], v13 offset:4096
    v_mfma_f32_32x32x16_bf16 v[80:95], v[36:39], v[40:43], v[80:95]
    ds_read_b128 v[56:59], v5 offset:6144
    v_mfma_f32_32x32x16_bf16 v[112:127], v[36:39], v[44:47], v[112:127]
    v_mfma_f32_4x4x4_16b_bf16 v[20:23], v[38:39], v[38:39], v[20:23]
    ds_read_b128 v[60:63], v5 offset:7168
    v_mfma_f32_32x32x16_bf16 v[144:159], v[44:47], v[36:39], v[144:159]
    s_waitcnt vmcnt(16)
    s_barrier
    s_waitcnt lgkmcnt(0)
    v_mfma_f32_32x32x16_bf16 v[64:79], v[48:51], v[56:59], v[64:79]
    v_mfma_f32_4x4x4_16b_bf16 v[20:23], v[52:53], v[52:53], v[20:23]
    s_lshl_b32 s28, s13, 12
    s_add_u32 s28, s28, 32768
    s_mov_b32 m0, s28
    s_add_u32 s29, s24, 640
    buffer_load_dwordx4 v2, s[16:19], s29 offen offset:0 lds
    v_mfma_f32_32x32x16_bf16 v[96:111], v[48:51], v[60:63], v[96:111]
    ds_read_b128 v[32:35], v10 offset:32768
    s_add_u32 s29, s29, 9216
    buffer_load_dwordx4 v3, s[16:19], s29 offen offset:1024 lds
    v_mfma_f32_32x32x16_bf16 v[128:143], v[60:63], v[48:51], v[128:143]
    ds_read_b128 v[36:39], v10 offset:36864
    s_add_u32 s29, s29, 9216
    buffer_load_dwordx4 v2, s[16:19], s29 offen offset:2048 lds
    v_mfma_f32_32x32x16_bf16 v[80:95], v[52:55], v[56:59], v[80:95]
    ds_read_b128 v[40:43], v5 offset:32768
    s_add_u32 s29, s29, 9216
    buffer_load_dwordx4 v3, s[16:19], s29 offen offset:3072 lds
    v_mfma_f32_32x32x16_bf16 v[112:127], v[52:55], v[60:63], v[112:127]
    v_mfma_f32_4x4x4_16b_bf16 v[20:23], v[54:55], v[54:55], v[20:23]
    ds_read_b128 v[44:47], v5 offset:33792
    s_add_u32 s28, s28, 16384
    s_mov_b32 m0, s28
    s_add_u32 s29, s25, 40960
    buffer_load_dwordx4 v1, s[8:11], s29 offen offset:0 lds
    v_mfma_f32_32x32x16_bf16 v[144:159], v[60:63], v[52:55], v[144:159]
    buffer_load_dwordx4 v1, s[8:11], s29 offen offset:1024 lds
    s_waitcnt lgkmcnt(0)
    v_mfma_f32_32x32x16_bf16 v[64:79], v[32:35], v[40:43], v[64:79]
    v_mfma_f32_4x4x4_16b_bf16 v[20:23], v[36:37], v[36:37], v[20:23]
    buffer_load_dwordx4 v1, s[8:11], s29 offen offset:2048 lds
    v_mfma_f32_32x32x16_bf16 v[96:111], v[32:35], v[44:47], v[96:111]
    ds_read_b128 v[48:51], v11 offset:32768
    buffer_load_dwordx4 v1, s[8:11], s29 offen offset:3072 lds
    v_mfma_f32_32x32x16_bf16 v[128:143], v[44:47], v[32:35], v[128:143]
    ds_read_b128 v[52:55], v11 offset:36864
    s_bfe_u32 s41, s51, 524288
    s_mul_i32 s41, s41, s40
    s_add_u32 s42, s58, s41
    s_add_u32 s43, s59, s41
    buffer_load_dwordx4 a[32:35], v240, s[8:11], s42 offen
    v_mfma_f32_32x32x16_bf16 v[80:95], v[36:39], v[40:43], v[80:95]
    ds_read_b128 v[56:59], v5 offset:34816
    buffer_load_dwordx4 a[36:39], v241, s[8:11], s43 offen
    v_mfma_f32_32x32x16_bf16 v[112:127], v[36:39], v[44:47], v[112:127]
    v_mfma_f32_4x4x4_16b_bf16 v[20:23], v[38:39], v[38:39], v[20:23]
    ds_read_b128 v[60:63], v5 offset:35840
    s_bfe_u32 s41, s51, 524296
    s_mul_i32 s41, s41, s40
    s_add_u32 s42, s58, s41
    s_add_u32 s43, s59, s41
    buffer_load_dwordx4 a[40:43], v240, s[8:11], s42 offen
    v_mfma_f32_32x32x16_bf16 v[144:159], v[44:47], v[36:39], v[144:159]
    buffer_load_dwordx4 a[44:47], v241, s[8:11], s43 offen
    s_waitcnt lgkmcnt(0)
    v_mfma_f32_32x32x16_bf16 v[64:79], v[48:51], v[56:59], v[64:79]
    v_mfma_f32_4x4x4_16b_bf16 v[20:23], v[52:53], v[52:53], v[20:23]
    v_mfma_f32_32x32x16_bf16 v[96:111], v[48:51], v[60:63], v[96:111]
    ds_read_b128 v[32:35], v12 offset:32768
    v_mfma_f32_32x32x16_bf16 v[128:143], v[60:63], v[48:51], v[128:143]
    ds_read_b128 v[36:39], v12 offset:36864
    v_mfma_f32_32x32x16_bf16 v[80:95], v[52:55], v[56:59], v[80:95]
    ds_read_b128 v[40:43], v5 offset:36864
    v_mfma_f32_32x32x16_bf16 v[112:127], v[52:55], v[60:63], v[112:127]
    v_mfma_f32_4x4x4_16b_bf16 v[20:23], v[54:55], v[54:55], v[20:23]
    ds_read_b128 v[44:47], v5 offset:37888
    v_mfma_f32_32x32x16_bf16 v[144:159], v[60:63], v[52:55], v[144:159]
    s_waitcnt lgkmcnt(0)
    v_mfma_f32_32x32x16_bf16 v[64:79], v[32:35], v[40:43], v[64:79]
    v_mfma_f32_4x4x4_16b_bf16 v[20:23], v[36:37], v[36:37], v[20:23]
    v_mfma_f32_32x32x16_bf16 v[96:111], v[32:35], v[44:47], v[96:111]
    ds_read_b128 v[48:51], v13 offset:32768
    v_mfma_f32_32x32x16_bf16 v[128:143], v[44:47], v[32:35], v[128:143]
    ds_read_b128 v[52:55], v13 offset:36864
    v_mfma_f32_32x32x16_bf16 v[80:95], v[36:39], v[40:43], v[80:95]
    ds_read_b128 v[56:59], v5 offset:38912
    v_mfma_f32_32x32x16_bf16 v[112:127], v[36:39], v[44:47], v[112:127]
    v_mfma_f32_4x4x4_16b_bf16 v[20:23], v[38:39], v[38:39], v[20:23]
    ds_read_b128 v[60:63], v5 offset:39936
    v_mfma_f32_32x32x16_bf16 v[144:159], v[44:47], v[36:39], v[144:159]
    s_waitcnt vmcnt(16)
    s_barrier
    s_waitcnt lgkmcnt(0)
    v_mfma_f32_32x32x16_bf16 v[64:79], v[48:51], v[56:59], v[64:79]
    v_mfma_f32_4x4x4_16b_bf16 v[20:23], v[52:53], v[52:53], v[20:23]
    s_lshl_b32 s28, s13, 12
    s_add_u32 s28, s28, 65536
    s_mov_b32 m0, s28
    s_add_u32 s29, s24, 768
    buffer_load_dwordx4 v2, s[16:19], s29 offen offset:0 lds
    v_mfma_f32_32x32x16_bf16 v[96:111], v[48:51], v[60:63], v[96:111]
    ds_read_b128 v[32:35], v6 offset:0
    s_add_u32 s29, s29, 9216
    buffer_load_dwordx4 v3, s[16:19], s29 offen offset:1024 lds
    v_mfma_f32_32x32x16_bf16 v[128:143], v[60:63], v[48:51], v[128:143]
    ds_read_b128 v[36:39], v6 offset:4096
    s_add_u32 s29, s29, 9216
    buffer_load_dwordx4 v2, s[16:19], s29 offen offset:2048 lds
    v_mfma_f32_32x32x16_bf16 v[80:95], v[52:55], v[56:59], v[80:95]
    ds_read_b128 v[40:43], v4 offset:0
    s_add_u32 s29, s29, 9216
    buffer_load_dwordx4 v3, s[16:19], s29 offen offset:3072 lds
    v_mfma_f32_32x32x16_bf16 v[112:127], v[52:55], v[60:63], v[112:127]
    v_mfma_f32_4x4x4_16b_bf16 v[20:23], v[54:55], v[54:55], v[20:23]
    ds_read_b128 v[44:47], v4 offset:1024
    s_add_u32 s28, s28, 16384
    s_mov_b32 m0, s28
    s_add_u32 s29, s25, 49152
    buffer_load_dwordx4 v1, s[8:11], s29 offen offset:0 lds
    v_mfma_f32_32x32x16_bf16 v[144:159], v[60:63], v[52:55], v[144:159]
    buffer_load_dwordx4 v1, s[8:11], s29 offen offset:1024 lds
    s_waitcnt lgkmcnt(0)
    v_mfma_f32_32x32x16_bf16 v[64:79], v[32:35], v[40:43], v[64:79]
    v_mfma_f32_4x4x4_16b_bf16 v[20:23], v[36:37], v[36:37], v[20:23]
    buffer_load_dwordx4 v1, s[8:11], s29 offen offset:2048 lds
    v_mfma_f32_32x32x16_bf16 v[96:111], v[32:35], v[44:47], v[96:111]
    ds_read_b128 v[48:51], v7 offset:0
    buffer_load_dwordx4 v1, s[8:11], s29 offen offset:3072 lds
    v_mfma_f32_32x32x16_bf16 v[128:143], v[44:47], v[32:35], v[128:143]
    ds_read_b128 v[52:55], v7 offset:4096
    s_bfe_u32 s41, s51, 524304
    s_mul_i32 s41, s41, s40
    s_add_u32 s42, s58, s41
    s_add_u32 s43, s59, s41
    buffer_load_dwordx4 a[48:51], v240, s[8:11], s42 offen
    v_mfma_f32_32x32x16_bf16 v[80:95], v[36:39], v[40:43], v[80:95]
    ds_read_b128 v[56:59], v4 offset:2048
    buffer_load_dwordx4 a[52:55], v241, s[8:11], s43 offen
    v_mfma_f32_32x32x16_bf16 v[112:127], v[36:39], v[44:47], v[112:127]
    v_mfma_f32_4x4x4_16b_bf16 v[20:23], v[38:39], v[38:39], v[20:23]
    ds_read_b128 v[60:63], v4 offset:3072
    s_bfe_u32 s41, s51, 524312
    s_mul_i32 s41, s41, s40
    s_add_u32 s42, s58, s41
    s_add_u32 s43, s59, s41
    buffer_load_dwordx4 a[56:59], v240, s[8:11], s42 offen
    v_mfma_f32_32x32x16_bf16 v[144:159], v[44:47], v[36:39], v[144:159]
    buffer_load_dwordx4 a[60:63], v241, s[8:11], s43 offen
    s_waitcnt lgkmcnt(0)
    v_mfma_f32_32x32x16_bf16 v[64:79], v[48:51], v[56:59], v[64:79]
    v_mfma_f32_4x4x4_16b_bf16 v[20:23], v[52:53], v[52:53], v[20:23]
    v_mfma_f32_32x32x16_bf16 v[96:111], v[48:51], v[60:63], v[96:111]
    ds_read_b128 v[32:35], v8 offset:0
    v_mfma_f32_32x32x16_bf16 v[128:143], v[60:63], v[48:51], v[128:143]
    ds_read_b128 v[36:39], v8 offset:4096
    v_mfma_f32_32x32x16_bf16 v[80:95], v[52:55], v[56:59], v[80:95]
    ds_read_b128 v[40:43], v4 offset:4096
    v_mfma_f32_32x32x16_bf16 v[112:127], v[52:55], v[60:63], v[112:127]
    v_mfma_f32_4x4x4_16b_bf16 v[20:23], v[54:55], v[54:55], v[20:23]
    ds_read_b128 v[44:47], v4 offset:5120
    v_mfma_f32_32x32x16_bf16 v[144:159], v[60:63], v[52:55], v[144:159]
    s_waitcnt lgkmcnt(0)
    v_mfma_f32_32x32x16_bf16 v[64:79], v[32:35], v[40:43], v[64:79]
    v_mfma_f32_4x4x4_16b_bf16 v[20:23], v[36:37], v[36:37], v[20:23]
    v_mfma_f32_32x32x16_bf16 v[96:111], v[32:35], v[44:47], v[96:111]
    ds_read_b128 v[48:51], v9 offset:0
    v_mfma_f32_32x32x16_bf16 v[128:143], v[44:47], v[32:35], v[128:143]
    ds_read_b128 v[52:55], v9 offset:4096
    v_mfma_f32_32x32x16_bf16 v[80:95], v[36:39], v[40:43], v[80:95]
    ds_read_b128 v[56:59], v4 offset:6144
    v_mfma_f32_32x32x16_bf16 v[112:127], v[36:39], v[44:47], v[112:127]
    v_mfma_f32_4x4x4_16b_bf16 v[20:23], v[38:39], v[38:39], v[20:23]
    ds_read_b128 v[60:63], v4 offset:7168
    v_mfma_f32_32x32x16_bf16 v[144:159], v[44:47], v[36:39], v[144:159]
    s_waitcnt vmcnt(16)
    s_barrier
    s_waitcnt lgkmcnt(0)
    v_mfma_f32_32x32x16_bf16 v[64:79], v[48:51], v[56:59], v[64:79]
    v_mfma_f32_4x4x4_16b_bf16 v[20:23], v[52:53], v[52:53], v[20:23]
    s_lshl_b32 s28, s13, 12
    s_add_u32 s28, s28, 98304
    s_mov_b32 m0, s28
    s_add_u32 s29, s24, 896
    buffer_load_dwordx4 v2, s[16:19], s29 offen offset:0 lds
    v_mfma_f32_32x32x16_bf16 v[96:111], v[48:51], v[60:63], v[96:111]
    ds_read_b128 v[32:35], v6 offset:32768
    s_add_u32 s29, s29, 9216
    buffer_load_dwordx4 v3, s[16:19], s29 offen offset:1024 lds
    v_mfma_f32_32x32x16_bf16 v[128:143], v[60:63], v[48:51], v[128:143]
    ds_read_b128 v[36:39], v6 offset:36864
    s_add_u32 s29, s29, 9216
    buffer_load_dwordx4 v2, s[16:19], s29 offen offset:2048 lds
    v_mfma_f32_32x32x16_bf16 v[80:95], v[52:55], v[56:59], v[80:95]
    ds_read_b128 v[40:43], v4 offset:32768
    s_add_u32 s29, s29, 9216
    buffer_load_dwordx4 v3, s[16:19], s29 offen offset:3072 lds
    v_mfma_f32_32x32x16_bf16 v[112:127], v[52:55], v[60:63], v[112:127]
    v_mfma_f32_4x4x4_16b_bf16 v[20:23], v[54:55], v[54:55], v[20:23]
    ds_read_b128 v[44:47], v4 offset:33792
    s_add_u32 s28, s28, 16384
    s_mov_b32 m0, s28
    s_add_u32 s29, s25, 57344
    buffer_load_dwordx4 v1, s[8:11], s29 offen offset:0 lds
    v_mfma_f32_32x32x16_bf16 v[144:159], v[60:63], v[52:55], v[144:159]
    buffer_load_dwordx4 v1, s[8:11], s29 offen offset:1024 lds
    s_waitcnt lgkmcnt(0)
    v_mfma_f32_32x32x16_bf16 v[64:79], v[32:35], v[40:43], v[64:79]
    v_mfma_f32_4x4x4_16b_bf16 v[20:23], v[36:37], v[36:37], v[20:23]
    buffer_load_dwordx4 v1, s[8:11], s29 offen offset:2048 lds
    v_mfma_f32_32x32x16_bf16 v[96:111], v[32:35], v[44:47], v[96:111]
    ds_read_b128 v[48:51], v7 offset:32768
    buffer_load_dwordx4 v1, s[8:11], s29 offen offset:3072 lds
    v_mfma_f32_32x32x16_bf16 v[128:143], v[44:47], v[32:35], v[128:143]
    ds_read_b128 v[52:55], v7 offset:36864
    s_bfe_u32 s41, s52, 524288
    s_mul_i32 s41, s41, s40
    s_add_u32 s42, s58, s41
    s_add_u32 s43, s59, s41
    buffer_load_dwordx4 a[64:67], v240, s[8:11], s42 offen
    v_mfma_f32_32x32x16_bf16 v[80:95], v[36:39], v[40:43], v[80:95]
    ds_read_b128 v[56:59], v4 offset:34816
    buffer_load_dwordx4 a[68:71], v241, s[8:11], s43 offen
    v_mfma_f32_32x32x16_bf16 v[112:127], v[36:39], v[44:47], v[112:127]
    v_mfma_f32_4x4x4_16b_bf16 v[20:23], v[38:39], v[38:39], v[20:23]
    ds_read_b128 v[60:63], v4 offset:35840
    s_bfe_u32 s41, s52, 524296
    s_mul_i32 s41, s41, s40
    s_add_u32 s42, s58, s41
    s_add_u32 s43, s59, s41
    buffer_load_dwordx4 a[72:75], v240, s[8:11], s42 offen
    v_mfma_f32_32x32x16_bf16 v[144:159], v[44:47], v[36:39], v[144:159]
    buffer_load_dwordx4 a[76:79], v241, s[8:11], s43 offen
    s_waitcnt lgkmcnt(0)
    v_mfma_f32_32x32x16_bf16 v[64:79], v[48:51], v[56:59], v[64:79]
    v_mfma_f32_4x4x4_16b_bf16 v[20:23], v[52:53], v[52:53], v[20:23]
    v_mfma_f32_32x32x16_bf16 v[96:111], v[48:51], v[60:63], v[96:111]
    ds_read_b128 v[32:35], v8 offset:32768
    v_mfma_f32_32x32x16_bf16 v[128:143], v[60:63], v[48:51], v[128:143]
    ds_read_b128 v[36:39], v8 offset:36864
    v_mfma_f32_32x32x16_bf16 v[80:95], v[52:55], v[56:59], v[80:95]
    ds_read_b128 v[40:43], v4 offset:36864
    v_mfma_f32_32x32x16_bf16 v[112:127], v[52:55], v[60:63], v[112:127]
    v_mfma_f32_4x4x4_16b_bf16 v[20:23], v[54:55], v[54:55], v[20:23]
    ds_read_b128 v[44:47], v4 offset:37888
    v_mfma_f32_32x32x16_bf16 v[144:159], v[60:63], v[52:55], v[144:159]
    s_waitcnt lgkmcnt(0)
    v_mfma_f32_32x32x16_bf16 v[64:79], v[32:35], v[40:43], v[64:79]
    v_mfma_f32_4x4x4_16b_bf16 v[20:23], v[36:37], v[36:37], v[20:23]
    v_mfma_f32_32x32x16_bf16 v[96:111], v[32:35], v[44:47], v[96:111]
    ds_read_b128 v[48:51], v9 offset:32768
    v_mfma_f32_32x32x16_bf16 v[128:143], v[44:47], v[32:35], v[128:143]
    ds_read_b128 v[52:55], v9 offset:36864
    v_mfma_f32_32x32x16_bf16 v[80:95], v[36:39], v[40:43], v[80:95]
    ds_read_b128 v[56:59], v4 offset:38912
    v_mfma_f32_32x32x16_bf16 v[112:127], v[36:39], v[44:47], v[112:127]
    v_mfma_f32_4x4x4_16b_bf16 v[20:23], v[38:39], v[38:39], v[20:23]
    ds_read_b128 v[60:63], v4 offset:39936
    v_mfma_f32_32x32x16_bf16 v[144:159], v[44:47], v[36:39], v[144:159]
    s_waitcnt vmcnt(16)
    s_barrier
    s_waitcnt lgkmcnt(0)
    v_mfma_f32_32x32x16_bf16 v[64:79], v[48:51], v[56:59], v[64:79]
    v_mfma_f32_4x4x4_16b_bf16 v[20:23], v[52:53], v[52:53], v[20:23]
    s_lshl_b32 s28, s13, 12
    s_mov_b32 m0, s28
    s_add_u32 s29, s24, 1024
    buffer_load_dwordx4 v2, s[16:19], s29 offen offset:0 lds
    v_mfma_f32_32x32x16_bf16 v[96:111], v[48:51], v[60:63], v[96:111]
    ds_read_b128 v[32:35], v10 offset:0
    s_add_u32 s29, s29, 9216
    buffer_load_dwordx4 v3, s[16:19], s29 offen offset:1024 lds
    v_mfma_f32_32x32x16_bf16 v[128:143], v[60:63], v[48:51], v[128:143]
    ds_read_b128 v[36:39], v10 offset:4096
    s_add_u32 s29, s29, 9216
    buffer_load_dwordx4 v2, s[16:19], s29 offen offset:2048 lds
    v_mfma_f32_32x32x16_bf16 v[80:95], v[52:55], v[56:59], v[80:95]
    ds_read_b128 v[40:43], v5 offset:0
    s_add_u32 s29, s29, 9216
    buffer_load_dwordx4 v3, s[16:19], s29 offen offset:3072 lds
    v_mfma_f32_32x32x16_bf16 v[112:127], v[52:55], v[60:63], v[112:127]
    v_mfma_f32_4x4x4_16b_bf16 v[20:23], v[54:55], v[54:55], v[20:23]
    ds_read_b128 v[44:47], v5 offset:1024
    s_add_u32 s28, s28, 16384
    s_mov_b32 m0, s28
    s_add_u32 s29, s25, 65536
    buffer_load_dwordx4 v1, s[8:11], s29 offen offset:0 lds
    v_mfma_f32_32x32x16_bf16 v[144:159], v[60:63], v[52:55], v[144:159]
    buffer_load_dwordx4 v1, s[8:11], s29 offen offset:1024 lds
    s_waitcnt lgkmcnt(0)
    v_mfma_f32_32x32x16_bf16 v[64:79], v[32:35], v[40:43], v[64:79]
    v_mfma_f32_4x4x4_16b_bf16 v[20:23], v[36:37], v[36:37], v[20:23]
    buffer_load_dwordx4 v1, s[8:11], s29 offen offset:2048 lds
    v_mfma_f32_32x32x16_bf16 v[96:111], v[32:35], v[44:47], v[96:111]
    ds_read_b128 v[48:51], v11 offset:0
    buffer_load_dwordx4 v1, s[8:11], s29 offen offset:3072 lds
    v_mfma_f32_32x32x16_bf16 v[128:143], v[44:47], v[32:35], v[128:143]
    ds_read_b128 v[52:55], v11 offset:4096
    s_bfe_u32 s41, s52, 524304
    s_mul_i32 s41, s41, s40
    s_add_u32 s42, s58, s41
    s_add_u32 s43, s59, s41
    buffer_load_dwordx4 a[80:83], v240, s[8:11], s42 offen
    v_mfma_f32_32x32x16_bf16 v[80:95], v[36:39], v[40:43], v[80:95]
    ds_read_b128 v[56:59], v5 offset:2048
    buffer_load_dwordx4 a[84:87], v241, s[8:11], s43 offen
    v_mfma_f32_32x32x16_bf16 v[112:127], v[36:39], v[44:47], v[112:127]
    v_mfma_f32_4x4x4_16b_bf16 v[20:23], v[38:39], v[38:39], v[20:23]
    ds_read_b128 v[60:63], v5 offset:3072
    s_bfe_u32 s41, s52, 524312
    s_mul_i32 s41, s41, s40
    s_add_u32 s42, s58, s41
    s_add_u32 s43, s59, s41
    buffer_load_dwordx4 a[88:91], v240, s[8:11], s42 offen
    v_mfma_f32_32x32x16_bf16 v[144:159], v[44:47], v[36:39], v[144:159]
    buffer_load_dwordx4 a[92:95], v241, s[8:11], s43 offen
    s_waitcnt lgkmcnt(0)
    v_mfma_f32_32x32x16_bf16 v[64:79], v[48:51], v[56:59], v[64:79]
    v_mfma_f32_4x4x4_16b_bf16 v[20:23], v[52:53], v[52:53], v[20:23]
    v_mfma_f32_32x32x16_bf16 v[96:111], v[48:51], v[60:63], v[96:111]
    ds_read_b128 v[32:35], v12 offset:0
    v_mfma_f32_32x32x16_bf16 v[128:143], v[60:63], v[48:51], v[128:143]
    ds_read_b128 v[36:39], v12 offset:4096
    v_mfma_f32_32x32x16_bf16 v[80:95], v[52:55], v[56:59], v[80:95]
    ds_read_b128 v[40:43], v5 offset:4096
    v_mfma_f32_32x32x16_bf16 v[112:127], v[52:55], v[60:63], v[112:127]
    v_mfma_f32_4x4x4_16b_bf16 v[20:23], v[54:55], v[54:55], v[20:23]
    ds_read_b128 v[44:47], v5 offset:5120
    v_mfma_f32_32x32x16_bf16 v[144:159], v[60:63], v[52:55], v[144:159]
    s_waitcnt lgkmcnt(0)
    v_mfma_f32_32x32x16_bf16 v[64:79], v[32:35], v[40:43], v[64:79]
    v_mfma_f32_4x4x4_16b_bf16 v[20:23], v[36:37], v[36:37], v[20:23]
    v_mfma_f32_32x32x16_bf16 v[96:111], v[32:35], v[44:47], v[96:111]
    ds_read_b128 v[48:51], v13 offset:0
    v_mfma_f32_32x32x16_bf16 v[128:143], v[44:47], v[32:35], v[128:143]
    ds_read_b128 v[52:55], v13 offset:4096
    v_mfma_f32_32x32x16_bf16 v[80:95], v[36:39], v[40:43], v[80:95]
    ds_read_b128 v[56:59], v5 offset:6144
    v_mfma_f32_32x32x16_bf16 v[112:127], v[36:39], v[44:47], v[112:127]
    v_mfma_f32_4x4x4_16b_bf16 v[20:23], v[38:39], v[38:39], v[20:23]
    ds_read_b128 v[60:63], v5 offset:7168
    v_mfma_f32_32x32x16_bf16 v[144:159], v[44:47], v[36:39], v[144:159]
    s_waitcnt vmcnt(16)
    s_barrier
    s_waitcnt lgkmcnt(0)
    v_mfma_f32_32x32x16_bf16 v[64:79], v[48:51], v[56:59], v[64:79]
    v_mfma_f32_4x4x4_16b_bf16 v[20:23], v[52:53], v[52:53], v[20:23]
    s_lshl_b32 s28, s13, 12
    s_add_u32 s28, s28, 32768
    s_mov_b32 m0, s28
    s_add_u32 s29, s24, 1152
    buffer_load_dwordx4 v2, s[16:19], s29 offen offset:0 lds
    v_mfma_f32_32x32x16_bf16 v[96:111], v[48:51], v[60:63], v[96:111]
    ds_read_b128 v[32:35], v10 offset:32768
    s_add_u32 s29, s29, 9216
    buffer_load_dwordx4 v3, s[16:19], s29 offen offset:1024 lds
    v_mfma_f32_32x32x16_bf16 v[128:143], v[60:63], v[48:51], v[128:143]
    ds_read_b128 v[36:39], v10 offset:36864
    s_add_u32 s29, s29, 9216
    buffer_load_dwordx4 v2, s[16:19], s29 offen offset:2048 lds
    v_mfma_f32_32x32x16_bf16 v[80:95], v[52:55], v[56:59], v[80:95]
    ds_read_b128 v[40:43], v5 offset:32768
    s_add_u32 s29, s29, 9216
    buffer_load_dwordx4 v3, s[16:19], s29 offen offset:3072 lds
    v_mfma_f32_32x32x16_bf16 v[112:127], v[52:55], v[60:63], v[112:127]
    v_mfma_f32_4x4x4_16b_bf16 v[20:23], v[54:55], v[54:55], v[20:23]
    ds_read_b128 v[44:47], v5 offset:33792
    s_add_u32 s28, s28, 16384
    s_mov_b32 m0, s28
    s_add_u32 s29, s25, 73728
    buffer_load_dwordx4 v1, s[8:11], s29 offen offset:0 lds
    v_mfma_f32_32x32x16_bf16 v[144:159], v[60:63], v[52:55], v[144:159]
    buffer_load_dwordx4 v1, s[8:11], s29 offen offset:1024 lds
    s_waitcnt lgkmcnt(0)
    v_mfma_f32_32x32x16_bf16 v[64:79], v[32:35], v[40:43], v[64:79]
    v_mfma_f32_4x4x4_16b_bf16 v[20:23], v[36:37], v[36:37], v[20:23]
    buffer_load_dwordx4 v1, s[8:11], s29 offen offset:2048 lds
    v_mfma_f32_32x32x16_bf16 v[96:111], v[32:35], v[44:47], v[96:111]
    ds_read_b128 v[48:51], v11 offset:32768
    buffer_load_dwordx4 v1, s[8:11], s29 offen offset:3072 lds
    v_mfma_f32_32x32x16_bf16 v[128:143], v[44:47], v[32:35], v[128:143]
    ds_read_b128 v[52:55], v11 offset:36864
    s_bfe_u32 s41, s53, 524288
    s_mul_i32 s41, s41, s40
    s_add_u32 s42, s58, s41
    s_add_u32 s43, s59, s41
    buffer_load_dwordx4 a[96:99], v240, s[8:11], s42 offen
    v_mfma_f32_32x32x16_bf16 v[80:95], v[36:39], v[40:43], v[80:95]
    ds_read_b128 v[56:59], v5 offset:34816
    buffer_load_dwordx4 a[100:103], v241, s[8:11], s43 offen
    v_mfma_f32_32x32x16_bf16 v[112:127], v[36:39], v[44:47], v[112:127]
    v_mfma_f32_4x4x4_16b_bf16 v[20:23], v[38:39], v[38:39], v[20:23]
    ds_read_b128 v[60:63], v5 offset:35840
    s_bfe_u32 s41, s53, 524296
    s_mul_i32 s41, s41, s40
    s_add_u32 s42, s58, s41
    s_add_u32 s43, s59, s41
    buffer_load_dwordx4 a[104:107], v240, s[8:11], s42 offen
    v_mfma_f32_32x32x16_bf16 v[144:159], v[44:47], v[36:39], v[144:159]
    buffer_load_dwordx4 a[108:111], v241, s[8:11], s43 offen
    s_waitcnt lgkmcnt(0)
    v_mfma_f32_32x32x16_bf16 v[64:79], v[48:51], v[56:59], v[64:79]
    v_mfma_f32_4x4x4_16b_bf16 v[20:23], v[52:53], v[52:53], v[20:23]
    v_mfma_f32_32x32x16_bf16 v[96:111], v[48:51], v[60:63], v[96:111]
    ds_read_b128 v[32:35], v12 offset:32768
    v_mfma_f32_32x32x16_bf16 v[128:143], v[60:63], v[48:51], v[128:143]
    ds_read_b128 v[36:39], v12 offset:36864
    v_mfma_f32_32x32x16_bf16 v[80:95], v[52:55], v[56:59], v[80:95]
    ds_read_b128 v[40:43], v5 offset:36864
    v_mfma_f32_32x32x16_bf16 v[112:127], v[52:55], v[60:63], v[112:127]
    v_mfma_f32_4x4x4_16b_bf16 v[20:23], v[54:55], v[54:55], v[20:23]
    ds_read_b128 v[44:47], v5 offset:37888
    v_mfma_f32_32x32x16_bf16 v[144:159], v[60:63], v[52:55], v[144:159]
    s_waitcnt lgkmcnt(0)
    v_mfma_f32_32x32x16_bf16 v[64:79], v[32:35], v[40:43], v[64:79]
    v_mfma_f32_4x4x4_16b_bf16 v[20:23], v[36:37], v[36:37], v[20:23]
    v_mfma_f32_32x32x16_bf16 v[96:111], v[32:35], v[44:47], v[96:111]
    ds_read_b128 v[48:51], v13 offset:32768
    v_mfma_f32_32x32x16_bf16 v[128:143], v[44:47], v[32:35], v[128:143]
    ds_read_b128 v[52:55], v13 offset:36864
    v_mfma_f32_32x32x16_bf16 v[80:95], v[36:39], v[40:43], v[80:95]
    ds_read_b128 v[56:59], v5 offset:38912
    v_mfma_f32_32x32x16_bf16 v[112:127], v[36:39], v[44:47], v[112:127]
    v_mfma_f32_4x4x4_16b_bf16 v[20:23], v[38:39], v[38:39], v[20:23]
    ds_read_b128 v[60:63], v5 offset:39936
    v_mfma_f32_32x32x16_bf16 v[144:159], v[44:47], v[36:39], v[144:159]
    s_waitcnt vmcnt(16)
    s_barrier
    s_waitcnt lgkmcnt(0)
    v_mfma_f32_32x32x16_bf16 v[64:79], v[48:51], v[56:59], v[64:79]
    v_mfma_f32_4x4x4_16b_bf16 v[20:23], v[52:53], v[52:53], v[20:23]
    s_bfe_u32 s41, s53, 524304
    s_mul_i32 s41, s41, s40
    s_add_u32 s42, s58, s41
    s_add_u32 s43, s59, s41
    buffer_load_dwordx4 a[112:115], v240, s[8:11], s42 offen
    v_mfma_f32_32x32x16_bf16 v[96:111], v[48:51], v[60:63], v[96:111]
    ds_read_b128 v[32:35], v6 offset:0
    buffer_load_dwordx4 a[116:119], v241, s[8:11], s43 offen
    v_mfma_f32_32x32x16_bf16 v[128:143], v[60:63], v[48:51], v[128:143]
    ds_read_b128 v[36:39], v6 offset:4096
    s_bfe_u32 s41, s53, 524312
    s_mul_i32 s41, s41, s40
    s_add_u32 s42, s58, s41
    s_add_u32 s43, s59, s41
    buffer_load_dwordx4 a[120:123], v240, s[8:11], s42 offen
    v_mfma_f32_32x32x16_bf16 v[80:95], v[52:55], v[56:59], v[80:95]
    ds_read_b128 v[40:43], v4 offset:0
    buffer_load_dwordx4 a[124:127], v241, s[8:11], s43 offen
    v_mfma_f32_32x32x16_bf16 v[112:127], v[52:55], v[60:63], v[112:127]
    v_mfma_f32_4x4x4_16b_bf16 v[20:23], v[54:55], v[54:55], v[20:23]
    ds_read_b128 v[44:47], v4 offset:1024
    v_mfma_f32_32x32x16_bf16 v[144:159], v[60:63], v[52:55], v[144:159]
    s_waitcnt lgkmcnt(0)
    v_mfma_f32_32x32x16_bf16 v[64:79], v[32:35], v[40:43], v[64:79]
    v_mfma_f32_4x4x4_16b_bf16 v[20:23], v[36:37], v[36:37], v[20:23]
    v_mfma_f32_32x32x16_bf16 v[96:111], v[32:35], v[44:47], v[96:111]
    ds_read_b128 v[48:51], v7 offset:0
    v_mfma_f32_32x32x16_bf16 v[128:143], v[44:47], v[32:35], v[128:143]
    ds_read_b128 v[52:55], v7 offset:4096
    v_mfma_f32_32x32x16_bf16 v[80:95], v[36:39], v[40:43], v[80:95]
    ds_read_b128 v[56:59], v4 offset:2048
    v_mfma_f32_32x32x16_bf16 v[112:127], v[36:39], v[44:47], v[112:127]
    v_mfma_f32_4x4x4_16b_bf16 v[20:23], v[38:39], v[38:39], v[20:23]
    ds_read_b128 v[60:63], v4 offset:3072
    v_mfma_f32_32x32x16_bf16 v[144:159], v[44:47], v[36:39], v[144:159]
    s_waitcnt lgkmcnt(0)
    v_mfma_f32_32x32x16_bf16 v[64:79], v[48:51], v[56:59], v[64:79]
    v_mfma_f32_4x4x4_16b_bf16 v[20:23], v[52:53], v[52:53], v[20:23]
    v_mfma_f32_32x32x16_bf16 v[96:111], v[48:51], v[60:63], v[96:111]
    ds_read_b128 v[32:35], v8 offset:0
    v_mfma_f32_32x32x16_bf16 v[128:143], v[60:63], v[48:51], v[128:143]
    ds_read_b128 v[36:39], v8 offset:4096
    v_mfma_f32_32x32x16_bf16 v[80:95], v[52:55], v[56:59], v[80:95]
    ds_read_b128 v[40:43], v4 offset:4096
    v_mfma_f32_32x32x16_bf16 v[112:127], v[52:55], v[60:63], v[112:127]
    v_mfma_f32_4x4x4_16b_bf16 v[20:23], v[54:55], v[54:55], v[20:23]
    ds_read_b128 v[44:47], v4 offset:5120
    v_mfma_f32_32x32x16_bf16 v[144:159], v[60:63], v[52:55], v[144:159]
    s_waitcnt lgkmcnt(0)
    v_mfma_f32_32x32x16_bf16 v[64:79], v[32:35], v[40:43], v[64:79]
    v_mfma_f32_4x4x4_16b_bf16 v[20:23], v[36:37], v[36:37], v[20:23]
    v_mfma_f32_32x32x16_bf16 v[96:111], v[32:35], v[44:47], v[96:111]
    ds_read_b128 v[48:51], v9 offset:0
    v_mfma_f32_32x32x16_bf16 v[128:143], v[44:47], v[32:35], v[128:143]
    ds_read_b128 v[52:55], v9 offset:4096
    v_mfma_f32_32x32x16_bf16 v[80:95], v[36:39], v[40:43], v[80:95]
    ds_read_b128 v[56:59], v4 offset:6144
    v_mfma_f32_32x32x16_bf16 v[112:127], v[36:39], v[44:47], v[112:127]
    v_mfma_f32_4x4x4_16b_bf16 v[20:23], v[38:39], v[38:39], v[20:23]
    ds_read_b128 v[60:63], v4 offset:7168
    v_mfma_f32_32x32x16_bf16 v[144:159], v[44:47], v[36:39], v[144:159]
    s_waitcnt vmcnt(8)
    s_barrier
    s_waitcnt lgkmcnt(0)
    v_mfma_f32_32x32x16_bf16 v[64:79], v[48:51], v[56:59], v[64:79]
    v_mfma_f32_4x4x4_16b_bf16 v[20:23], v[52:53], v[52:53], v[20:23]
    s_bfe_u32 s41, s54, 524288
    s_mul_i32 s41, s41, s40
    s_add_u32 s42, s58, s41
    s_add_u32 s43, s59, s41
    buffer_load_dwordx4 a[128:131], v240, s[8:11], s42 offen
    v_mfma_f32_32x32x16_bf16 v[96:111], v[48:51], v[60:63], v[96:111]
    ds_read_b128 v[32:35], v6 offset:32768
    buffer_load_dwordx4 a[132:135], v241, s[8:11], s43 offen
    v_mfma_f32_32x32x16_bf16 v[128:143], v[60:63], v[48:51], v[128:143]
    ds_read_b128 v[36:39], v6 offset:36864
    v_mfma_f32_32x32x16_bf16 v[80:95], v[52:55], v[56:59], v[80:95]
    ds_read_b128 v[40:43], v4 offset:32768
    v_mfma_f32_32x32x16_bf16 v[112:127], v[52:55], v[60:63], v[112:127]
    v_mfma_f32_4x4x4_16b_bf16 v[20:23], v[54:55], v[54:55], v[20:23]
    ds_read_b128 v[44:47], v4 offset:33792
    v_mfma_f32_32x32x16_bf16 v[144:159], v[60:63], v[52:55], v[144:159]
    s_waitcnt lgkmcnt(0)
    v_mfma_f32_32x32x16_bf16 v[64:79], v[32:35], v[40:43], v[64:79]
    v_mfma_f32_4x4x4_16b_bf16 v[20:23], v[36:37], v[36:37], v[20:23]
    v_mfma_f32_32x32x16_bf16 v[96:111], v[32:35], v[44:47], v[96:111]
    ds_read_b128 v[48:51], v7 offset:32768
    v_mfma_f32_32x32x16_bf16 v[128:143], v[44:47], v[32:35], v[128:143]
    ds_read_b128 v[52:55], v7 offset:36864
    v_mfma_f32_32x32x16_bf16 v[80:95], v[36:39], v[40:43], v[80:95]
    ds_read_b128 v[56:59], v4 offset:34816
    v_mfma_f32_32x32x16_bf16 v[112:127], v[36:39], v[44:47], v[112:127]
    v_mfma_f32_4x4x4_16b_bf16 v[20:23], v[38:39], v[38:39], v[20:23]
    ds_read_b128 v[60:63], v4 offset:35840
    v_mfma_f32_32x32x16_bf16 v[144:159], v[44:47], v[36:39], v[144:159]
    s_waitcnt lgkmcnt(0)
    v_mfma_f32_32x32x16_bf16 v[64:79], v[48:51], v[56:59], v[64:79]
    v_mfma_f32_4x4x4_16b_bf16 v[20:23], v[52:53], v[52:53], v[20:23]
    v_mfma_f32_32x32x16_bf16 v[96:111], v[48:51], v[60:63], v[96:111]
    ds_read_b128 v[32:35], v8 offset:32768
    v_mfma_f32_32x32x16_bf16 v[128:143], v[60:63], v[48:51], v[128:143]
    ds_read_b128 v[36:39], v8 offset:36864
    v_mfma_f32_32x32x16_bf16 v[80:95], v[52:55], v[56:59], v[80:95]
    ds_read_b128 v[40:43], v4 offset:36864
    v_mfma_f32_32x32x16_bf16 v[112:127], v[52:55], v[60:63], v[112:127]
    v_mfma_f32_4x4x4_16b_bf16 v[20:23], v[54:55], v[54:55], v[20:23]
    ds_read_b128 v[44:47], v4 offset:37888
    v_mfma_f32_32x32x16_bf16 v[144:159], v[60:63], v[52:55], v[144:159]
    s_waitcnt lgkmcnt(0)
    v_mfma_f32_32x32x16_bf16 v[64:79], v[32:35], v[40:43], v[64:79]
    v_mfma_f32_4x4x4_16b_bf16 v[20:23], v[36:37], v[36:37], v[20:23]
    v_mfma_f32_32x32x16_bf16 v[96:111], v[32:35], v[44:47], v[96:111]
    ds_read_b128 v[48:51], v9 offset:32768
    v_mfma_f32_32x32x16_bf16 v[128:143], v[44:47], v[32:35], v[128:143]
    ds_read_b128 v[52:55], v9 offset:36864
    v_mfma_f32_32x32x16_bf16 v[80:95], v[36:39], v[40:43], v[80:95]
    ds_read_b128 v[56:59], v4 offset:38912
    v_mfma_f32_32x32x16_bf16 v[112:127], v[36:39], v[44:47], v[112:127]
    v_mfma_f32_4x4x4_16b_bf16 v[20:23], v[38:39], v[38:39], v[20:23]
    ds_read_b128 v[60:63], v4 offset:39936
    v_mfma_f32_32x32x16_bf16 v[144:159], v[44:47], v[36:39], v[144:159]
    s_waitcnt lgkmcnt(0)
    v_mfma_f32_32x32x16_bf16 v[64:79], v[48:51], v[56:59], v[64:79]
    v_mfma_f32_4x4x4_16b_bf16 v[20:23], v[52:53], v[52:53], v[20:23]
    s_bfe_u32 s41, s54, 524296
    s_mul_i32 s41, s41, s40
    s_add_u32 s42, s58, s41
    s_add_u32 s43, s59, s41
    buffer_load_dwordx4 a[136:139], v240, s[8:11], s42 offen
    v_mfma_f32_32x32x16_bf16 v[96:111], v[48:51], v[60:63], v[96:111]
    buffer_load_dwordx4 a[140:143], v241, s[8:11], s43 offen
    v_mfma_f32_32x32x16_bf16 v[128:143], v[60:63], v[48:51], v[128:143]
    v_mfma_f32_32x32x16_bf16 v[80:95], v[52:55], v[56:59], v[80:95]
    v_mfma_f32_32x32x16_bf16 v[112:127], v[52:55], v[60:63], v[112:127]
    v_mfma_f32_4x4x4_16b_bf16 v[20:23], v[54:55], v[54:55], v[20:23]
    v_mfma_f32_32x32x16_bf16 v[144:159], v[60:63], v[52:55], v[144:159]
layerb1_kernel_af_epi:
    s_cmp_eq_u32 s44, 2
    s_cbranch_scc1 layerb1_kernel_pf_post
    s_bfe_u32 s41, s54, 524304
    s_mul_i32 s41, s41, s40
    s_add_u32 s42, s58, s41
    s_add_u32 s43, s59, s41
    buffer_load_dwordx4 a[144:147], v240, s[8:11], s42 offen
    buffer_load_dwordx4 a[148:151], v241, s[8:11], s43 offen
    s_bfe_u32 s41, s54, 524312
    s_mul_i32 s41, s41, s40
    s_add_u32 s42, s58, s41
    s_add_u32 s43, s59, s41
    buffer_load_dwordx4 a[152:155], v240, s[8:11], s42 offen
    buffer_load_dwordx4 a[156:159], v241, s[8:11], s43 offen
    s_bfe_u32 s41, s55, 524288
    s_mul_i32 s41, s41, s40
    s_add_u32 s42, s58, s41
    s_add_u32 s43, s59, s41
    buffer_load_dwordx4 a[160:163], v240, s[8:11], s42 offen
    buffer_load_dwordx4 a[164:167], v241, s[8:11], s43 offen
    s_bfe_u32 s41, s55, 524296
    s_mul_i32 s41, s41, s40
    s_add_u32 s42, s58, s41
    s_add_u32 s43, s59, s41
    buffer_load_dwordx4 a[168:171], v240, s[8:11], s42 offen
    buffer_load_dwordx4 a[172:175], v241, s[8:11], s43 offen
    s_bfe_u32 s41, s55, 524304
    s_mul_i32 s41, s41, s40
    s_add_u32 s42, s58, s41
    s_add_u32 s43, s59, s41
    buffer_load_dwordx4 a[176:179], v240, s[8:11], s42 offen
    buffer_load_dwordx4 a[180:183], v241, s[8:11], s43 offen
    s_bfe_u32 s41, s55, 524312
    s_mul_i32 s41, s41, s40
    s_add_u32 s42, s58, s41
    s_add_u32 s43, s59, s41
    buffer_load_dwordx4 a[184:187], v240, s[8:11], s42 offen
    buffer_load_dwordx4 a[188:191], v241, s[8:11], s43 offen
layerb1_kernel_pf_post:
    s_mov_b32 s32, 0x22222222
    s_mov_b32 s33, 0x22222222
    s_mov_b32 s34, 0x44444444
    s_mov_b32 s35, 0x44444444
    s_mov_b32 s36, 0x88888888
    s_mov_b32 s37, 0x88888888
    s_cmp_eq_u32 s23, 1
    s_cselect_b64 vcc, -1, 0
    v_cndmask_b32 v20, v20, v21, s[32:33]
    v_cndmask_b32 v20, v20, v22, s[34:35]
    v_cndmask_b32 v20, v20, v23, s[36:37]
    v_mov_b32 v22, v20
    s_nop 1
    v_permlane32_swap_b32 v20, v22
    v_add_f32 v22, v20, v22
    v_cndmask_b32 v20, v133, v149, vcc
    v_mul_f32 v20, 0x3acccccd, v20
    v_mul_f32 v21, v20, v20
    v_mul_f32 v22, 0x3acccccd, v22
    v_sub_f32 v22, v22, v21
    v_max_f32 v22, 0, v22
    v_add_f32 v22, 0x3727c5ac, v22
    v_rsq_f32 v22, v22
    v_and_b32 v16, 31, v0
    s_lshl_b32 s28, s13, 7
    s_add_u32 s28, s28, 65536
    v_lshl_add_u32 v17, v16, 2, s28
    s_mov_b32 exec_hi, 0
    ds_write_b32 v17, v22
    s_mov_b32 exec_hi, -1
    s_waitcnt lgkmcnt(0)
    s_barrier
    s_lshl_b32 s28, s22, 8
    s_add_u32 s28, s28, 65536
    v_lshl_add_u32 v17, v16, 2, s28
    v_lshrrev_b32 v18, 5, v0
    v_lshlrev_b32 v18, 4, v18
    v_add_u32 v18, s28, v18
    ds_read_b32 v224, v17 offset:0
    ds_read_b128 v[192:195], v18 offset:0
    ds_read_b128 v[196:199], v18 offset:32
    ds_read_b128 v[200:203], v18 offset:64
    ds_read_b128 v[204:207], v18 offset:96
    ds_read_b32 v225, v17 offset:128
    ds_read_b128 v[208:211], v18 offset:128
    ds_read_b128 v[212:215], v18 offset:160
    ds_read_b128 v[216:219], v18 offset:192
    ds_read_b128 v[220:223], v18 offset:224
    v_and_b32 v16, 31, v0
    v_mov_b32 v228, 0x358637bd
    v_cmp_gt_u32 vcc, 20, v16
    s_mov_b64 s[30:31], vcc
    s_nop 0
    v_cndmask_b32 v226, 0, v228, vcc
    v_cmp_eq_u32 vcc, 8, v16
    s_nop 1
    v_cndmask_b32 v227, 0, 1.0, vcc
    s_waitcnt lgkmcnt(0)
    v_fma_f32 v64, v64, v192, v226
    v_mul_f32 v48, 0x3fb8aa3b, v64
    v_exp_f32 v48, v48 clamp
    v_max_f32 v49, v64, v228
    v_fma_f32 v96, v96, v192, v227
    v_add_f32 v48, v48, v49
    v_cndmask_b32 v64, v64, v48, s[30:31]
    v_fma_f32 v65, v65, v193, v226
    v_mul_f32 v50, 0x3fb8aa3b, v65
    v_exp_f32 v50, v50 clamp
    v_max_f32 v51, v65, v228
    v_fma_f32 v97, v97, v193, v227
    v_add_f32 v50, v50, v51
    v_cndmask_b32 v65, v65, v50, s[30:31]
    v_fma_f32 v66, v66, v194, v226
    v_mul_f32 v52, 0x3fb8aa3b, v66
    v_exp_f32 v52, v52 clamp
    v_max_f32 v53, v66, v228
    v_fma_f32 v98, v98, v194, v227
    v_add_f32 v52, v52, v53
    v_cndmask_b32 v66, v66, v52, s[30:31]
    v_fma_f32 v67, v67, v195, v226
    v_mul_f32 v54, 0x3fb8aa3b, v67
    v_exp_f32 v54, v54 clamp
    v_max_f32 v55, v67, v228
    v_fma_f32 v99, v99, v195, v227
    v_add_f32 v54, v54, v55
    v_cndmask_b32 v67, v67, v54, s[30:31]
    v_fma_f32 v68, v68, v196, v226
    v_mul_f32 v48, 0x3fb8aa3b, v68
    v_exp_f32 v48, v48 clamp
    v_max_f32 v49, v68, v228
    v_fma_f32 v100, v100, v196, v227
    v_add_f32 v48, v48, v49
    v_cndmask_b32 v68, v68, v48, s[30:31]
    v_fma_f32 v69, v69, v197, v226
    v_mul_f32 v50, 0x3fb8aa3b, v69
    v_exp_f32 v50, v50 clamp
    v_max_f32 v51, v69, v228
    v_fma_f32 v101, v101, v197, v227
    v_add_f32 v50, v50, v51
    v_cndmask_b32 v69, v69, v50, s[30:31]
    v_fma_f32 v70, v70, v198, v226
    v_mul_f32 v52, 0x3fb8aa3b, v70
    v_exp_f32 v52, v52 clamp
    v_max_f32 v53, v70, v228
    v_fma_f32 v102, v102, v198, v227
    v_add_f32 v52, v52, v53
    v_cndmask_b32 v70, v70, v52, s[30:31]
    v_fma_f32 v71, v71, v199, v226
    v_mul_f32 v54, 0x3fb8aa3b, v71
    v_exp_f32 v54, v54 clamp
    v_max_f32 v55, v71, v228
    v_fma_f32 v103, v103, v199, v227
    v_add_f32 v54, v54, v55
    v_cndmask_b32 v71, v71, v54, s[30:31]
    v_fma_f32 v72, v72, v200, v226
    v_mul_f32 v48, 0x3fb8aa3b, v72
    v_exp_f32 v48, v48 clamp
    v_max_f32 v49, v72, v228
    v_fma_f32 v104, v104, v200, v227
    v_add_f32 v48, v48, v49
    v_cndmask_b32 v72, v72, v48, s[30:31]
    v_fma_f32 v73, v73, v201, v226
    v_mul_f32 v50, 0x3fb8aa3b, v73
    v_exp_f32 v50, v50 clamp
    v_max_f32 v51, v73, v228
    v_fma_f32 v105, v105, v201, v227
    v_add_f32 v50, v50, v51
    v_cndmask_b32 v73, v73, v50, s[30:31]
    v_fma_f32 v74, v74, v202, v226
    v_mul_f32 v52, 0x3fb8aa3b, v74
    v_exp_f32 v52, v52 clamp
    v_max_f32 v53, v74, v228
    v_fma_f32 v106, v106, v202, v227
    v_add_f32 v52, v52, v53
    v_cndmask_b32 v74, v74, v52, s[30:31]
    v_fma_f32 v75, v75, v203, v226
    v_mul_f32 v54, 0x3fb8aa3b, v75
    v_exp_f32 v54, v54 clamp
    v_max_f32 v55, v75, v228
    v_fma_f32 v107, v107, v203, v227
    v_add_f32 v54, v54, v55
    v_cndmask_b32 v75, v75, v54, s[30:31]
    v_fma_f32 v76, v76, v204, v226
    v_mul_f32 v48, 0x3fb8aa3b, v76
    v_exp_f32 v48, v48 clamp
    v_max_f32 v49, v76, v228
    v_fma_f32 v108, v108, v204, v227
    v_add_f32 v48, v48, v49
    v_cndmask_b32 v76, v76, v48, s[30:31]
    v_fma_f32 v77, v77, v205, v226
    v_mul_f32 v50, 0x3fb8aa3b, v77
    v_exp_f32 v50, v50 clamp
    v_max_f32 v51, v77, v228
    v_fma_f32 v109, v109, v205, v227
    v_add_f32 v50, v50, v51
    v_cndmask_b32 v77, v77, v50, s[30:31]
    v_fma_f32 v78, v78, v206, v226
    v_mul_f32 v52, 0x3fb8aa3b, v78
    v_exp_f32 v52, v52 clamp
    v_max_f32 v53, v78, v228
    v_fma_f32 v110, v110, v206, v227
    v_add_f32 v52, v52, v53
    v_cndmask_b32 v78, v78, v52, s[30:31]
    v_fma_f32 v79, v79, v207, v226
    v_mul_f32 v54, 0x3fb8aa3b, v79
    v_exp_f32 v54, v54 clamp
    v_max_f32 v55, v79, v228
    v_fma_f32 v111, v111, v207, v227
    v_add_f32 v54, v54, v55
    v_cndmask_b32 v79, v79, v54, s[30:31]
    v_cvt_pk_bf16_f32 v32, v64, v65
    v_cvt_pk_bf16_f32 v40, v96, v97
    v_cvt_pk_bf16_f32 v33, v66, v67
    v_cvt_pk_bf16_f32 v41, v98, v99
    v_cvt_pk_bf16_f32 v34, v68, v69
    v_cvt_pk_bf16_f32 v42, v100, v101
    v_cvt_pk_bf16_f32 v35, v70, v71
    v_cvt_pk_bf16_f32 v43, v102, v103
    v_cvt_pk_bf16_f32 v36, v72, v73
    v_cvt_pk_bf16_f32 v44, v104, v105
    v_cvt_pk_bf16_f32 v37, v74, v75
    v_cvt_pk_bf16_f32 v45, v106, v107
    v_cvt_pk_bf16_f32 v38, v76, v77
    v_cvt_pk_bf16_f32 v46, v108, v109
    v_cvt_pk_bf16_f32 v39, v78, v79
    v_cvt_pk_bf16_f32 v47, v110, v111
    s_nop 1
    v_mfma_f32_32x32x16_bf16 v[160:175], v[32:35], v[32:35], 0
    v_mfma_f32_32x32x16_bf16 v[176:191], v[40:43], v[32:35], 0
    v_mfma_f32_32x32x16_bf16 v[160:175], v[36:39], v[36:39], v[160:175]
    v_mfma_f32_32x32x16_bf16 v[176:191], v[44:47], v[36:39], v[176:191]
    v_fma_f32 v80, v80, v208, v226
    v_mul_f32 v48, 0x3fb8aa3b, v80
    v_exp_f32 v48, v48 clamp
    v_max_f32 v49, v80, v228
    v_fma_f32 v112, v112, v208, v227
    v_add_f32 v48, v48, v49
    v_cndmask_b32 v80, v80, v48, s[30:31]
    v_fma_f32 v81, v81, v209, v226
    v_mul_f32 v50, 0x3fb8aa3b, v81
    v_exp_f32 v50, v50 clamp
    v_max_f32 v51, v81, v228
    v_fma_f32 v113, v113, v209, v227
    v_add_f32 v50, v50, v51
    v_cndmask_b32 v81, v81, v50, s[30:31]
    v_fma_f32 v82, v82, v210, v226
    v_mul_f32 v52, 0x3fb8aa3b, v82
    v_exp_f32 v52, v52 clamp
    v_max_f32 v53, v82, v228
    v_fma_f32 v114, v114, v210, v227
    v_add_f32 v52, v52, v53
    v_cndmask_b32 v82, v82, v52, s[30:31]
    v_fma_f32 v83, v83, v211, v226
    v_mul_f32 v54, 0x3fb8aa3b, v83
    v_exp_f32 v54, v54 clamp
    v_max_f32 v55, v83, v228
    v_fma_f32 v115, v115, v211, v227
    v_add_f32 v54, v54, v55
    v_cndmask_b32 v83, v83, v54, s[30:31]
    v_fma_f32 v84, v84, v212, v226
    v_mul_f32 v48, 0x3fb8aa3b, v84
    v_exp_f32 v48, v48 clamp
    v_max_f32 v49, v84, v228
    v_fma_f32 v116, v116, v212, v227
    v_add_f32 v48, v48, v49
    v_cndmask_b32 v84, v84, v48, s[30:31]
    v_fma_f32 v85, v85, v213, v226
    v_mul_f32 v50, 0x3fb8aa3b, v85
    v_exp_f32 v50, v50 clamp
    v_max_f32 v51, v85, v228
    v_fma_f32 v117, v117, v213, v227
    v_add_f32 v50, v50, v51
    v_cndmask_b32 v85, v85, v50, s[30:31]
    v_fma_f32 v86, v86, v214, v226
    v_mul_f32 v52, 0x3fb8aa3b, v86
    v_exp_f32 v52, v52 clamp
    v_max_f32 v53, v86, v228
    v_fma_f32 v118, v118, v214, v227
    v_add_f32 v52, v52, v53
    v_cndmask_b32 v86, v86, v52, s[30:31]
    v_fma_f32 v87, v87, v215, v226
    v_mul_f32 v54, 0x3fb8aa3b, v87
    v_exp_f32 v54, v54 clamp
    v_max_f32 v55, v87, v228
    v_fma_f32 v119, v119, v215, v227
    v_add_f32 v54, v54, v55
    v_cndmask_b32 v87, v87, v54, s[30:31]
    v_fma_f32 v88, v88, v216, v226
    v_mul_f32 v48, 0x3fb8aa3b, v88
    v_exp_f32 v48, v48 clamp
    v_max_f32 v49, v88, v228
    v_fma_f32 v120, v120, v216, v227
    v_add_f32 v48, v48, v49
    v_cndmask_b32 v88, v88, v48, s[30:31]
    v_fma_f32 v89, v89, v217, v226
    v_mul_f32 v50, 0x3fb8aa3b, v89
    v_exp_f32 v50, v50 clamp
    v_max_f32 v51, v89, v228
    v_fma_f32 v121, v121, v217, v227
    v_add_f32 v50, v50, v51
    v_cndmask_b32 v89, v89, v50, s[30:31]
    v_fma_f32 v90, v90, v218, v226
    v_mul_f32 v52, 0x3fb8aa3b, v90
    v_exp_f32 v52, v52 clamp
    v_max_f32 v53, v90, v228
    v_fma_f32 v122, v122, v218, v227
    v_add_f32 v52, v52, v53
    v_cndmask_b32 v90, v90, v52, s[30:31]
    v_fma_f32 v91, v91, v219, v226
    v_mul_f32 v54, 0x3fb8aa3b, v91
    v_exp_f32 v54, v54 clamp
    v_max_f32 v55, v91, v228
    v_fma_f32 v123, v123, v219, v227
    v_add_f32 v54, v54, v55
    v_cndmask_b32 v91, v91, v54, s[30:31]
    v_fma_f32 v92, v92, v220, v226
    v_mul_f32 v48, 0x3fb8aa3b, v92
    v_exp_f32 v48, v48 clamp
    v_max_f32 v49, v92, v228
    v_fma_f32 v124, v124, v220, v227
    v_add_f32 v48, v48, v49
    v_cndmask_b32 v92, v92, v48, s[30:31]
    v_fma_f32 v93, v93, v221, v226
    v_mul_f32 v50, 0x3fb8aa3b, v93
    v_exp_f32 v50, v50 clamp
    v_max_f32 v51, v93, v228
    v_fma_f32 v125, v125, v221, v227
    v_add_f32 v50, v50, v51
    v_cndmask_b32 v93, v93, v50, s[30:31]
    v_fma_f32 v94, v94, v222, v226
    v_mul_f32 v52, 0x3fb8aa3b, v94
    v_exp_f32 v52, v52 clamp
    v_max_f32 v53, v94, v228
    v_fma_f32 v126, v126, v222, v227
    v_add_f32 v52, v52, v53
    v_cndmask_b32 v94, v94, v52, s[30:31]
    v_fma_f32 v95, v95, v223, v226
    v_mul_f32 v54, 0x3fb8aa3b, v95
    v_exp_f32 v54, v54 clamp
    v_max_f32 v55, v95, v228
    v_fma_f32 v127, v127, v223, v227
    v_add_f32 v54, v54, v55
    v_cndmask_b32 v95, v95, v54, s[30:31]
    v_cvt_pk_bf16_f32 v32, v80, v81
    v_cvt_pk_bf16_f32 v40, v112, v113
    v_cvt_pk_bf16_f32 v33, v82, v83
    v_cvt_pk_bf16_f32 v41, v114, v115
    v_cvt_pk_bf16_f32 v34, v84, v85
    v_cvt_pk_bf16_f32 v42, v116, v117
    v_cvt_pk_bf16_f32 v35, v86, v87
    v_cvt_pk_bf16_f32 v43, v118, v119
    v_cvt_pk_bf16_f32 v36, v88, v89
    v_cvt_pk_bf16_f32 v44, v120, v121
    v_cvt_pk_bf16_f32 v37, v90, v91
    v_cvt_pk_bf16_f32 v45, v122, v123
    v_cvt_pk_bf16_f32 v38, v92, v93
    v_cvt_pk_bf16_f32 v46, v124, v125
    v_cvt_pk_bf16_f32 v39, v94, v95
    v_cvt_pk_bf16_f32 v47, v126, v127
    s_nop 1
    v_mfma_f32_32x32x16_bf16 v[160:175], v[32:35], v[32:35], v[160:175]
    v_mfma_f32_32x32x16_bf16 v[176:191], v[40:43], v[32:35], v[176:191]
    v_mfma_f32_32x32x16_bf16 v[160:175], v[36:39], v[36:39], v[160:175]
    v_mfma_f32_32x32x16_bf16 v[176:191], v[44:47], v[36:39], v[176:191]
    v_fma_f32 v132, v132, v224, v228
    v_mul_f32 v48, 0x3fb8aa3b, v132
    v_exp_f32 v48, v48 clamp
    v_max_f32 v49, v132, v228
    v_add_f32 v132, v48, v49
    v_fma_f32 v133, v133, v224, v228
    v_mul_f32 v50, 0x3fb8aa3b, v133
    v_exp_f32 v50, v50 clamp
    v_max_f32 v51, v133, v228
    v_add_f32 v133, v50, v51
    v_fma_f32 v134, v134, v224, v228
    v_mul_f32 v52, 0x3fb8aa3b, v134
    v_exp_f32 v52, v52 clamp
    v_max_f32 v53, v134, v228
    v_add_f32 v134, v52, v53
    v_fma_f32 v135, v135, v224, v228
    v_mul_f32 v54, 0x3fb8aa3b, v135
    v_exp_f32 v54, v54 clamp
    v_max_f32 v55, v135, v228
    v_add_f32 v135, v54, v55
    v_fma_f32 v136, v136, v224, v228
    v_mul_f32 v48, 0x3fb8aa3b, v136
    v_exp_f32 v48, v48 clamp
    v_max_f32 v49, v136, v228
    v_add_f32 v136, v48, v49
    v_fma_f32 v137, v137, v224, v228
    v_mul_f32 v50, 0x3fb8aa3b, v137
    v_exp_f32 v50, v50 clamp
    v_max_f32 v51, v137, v228
    v_add_f32 v137, v50, v51
    v_fma_f32 v138, v138, v224, v228
    v_mul_f32 v52, 0x3fb8aa3b, v138
    v_exp_f32 v52, v52 clamp
    v_max_f32 v53, v138, v228
    v_add_f32 v138, v52, v53
    v_fma_f32 v139, v139, v224, v228
    v_mul_f32 v54, 0x3fb8aa3b, v139
    v_exp_f32 v54, v54 clamp
    v_max_f32 v55, v139, v228
    v_add_f32 v139, v54, v55
    v_fma_f32 v140, v140, v224, v228
    v_mul_f32 v48, 0x3fb8aa3b, v140
    v_exp_f32 v48, v48 clamp
    v_max_f32 v49, v140, v228
    v_add_f32 v140, v48, v49
    v_fma_f32 v141, v141, v224, v228
    v_mul_f32 v50, 0x3fb8aa3b, v141
    v_exp_f32 v50, v50 clamp
    v_max_f32 v51, v141, v228
    v_add_f32 v141, v50, v51
    v_fma_f32 v142, v142, v224, v228
    v_mul_f32 v52, 0x3fb8aa3b, v142
    v_exp_f32 v52, v52 clamp
    v_max_f32 v53, v142, v228
    v_add_f32 v142, v52, v53
    v_fma_f32 v143, v143, v224, v228
    v_mul_f32 v54, 0x3fb8aa3b, v143
    v_exp_f32 v54, v54 clamp
    v_max_f32 v55, v143, v228
    v_add_f32 v143, v54, v55
    v_cvt_pk_bf16_f32 v130, v132, v133
    v_cvt_pk_bf16_f32 v131, v134, v135
    v_cvt_pk_bf16_f32 v132, v136, v137
    v_cvt_pk_bf16_f32 v133, v138, v139
    v_cvt_pk_bf16_f32 v134, v140, v141
    v_cvt_pk_bf16_f32 v135, v142, v143
    v_mov_b32 v128, 0
    v_mov_b32 v129, 0
    s_lshl_b32 s28, s13, 13
    s_add_u32 s28, s28, 66560
    v_add_u32 v17, s28, v1
    ds_write_b128 v17, v[160:163] offset:0
    ds_write_b128 v17, v[164:167] offset:1024
    ds_write_b128 v17, v[168:171] offset:2048
    ds_write_b128 v17, v[172:175] offset:3072
    ds_write_b128 v17, v[176:179] offset:4096
    ds_write_b128 v17, v[180:183] offset:5120
    ds_write_b128 v17, v[184:187] offset:6144
    ds_write_b128 v17, v[188:191] offset:7168
    s_lshl_b32 s28, s13, 6
    v_add_u32 v32, s28, v0
    v_cmp_le_u32 vcc, 105, v32
    s_nop 1
    v_cndmask_b32 v33, 0, 1, vcc
    v_mul_u32_u24 v34, 105, v33
    v_sub_u32 v34, v32, v34
    v_mul_u32_u24 v35, 13108, v34
    v_lshrrev_b32 v35, 16, v35
    v_mul_u32_u24 v36, 5, v35
    v_sub_u32 v36, v34, v36
    v_add_u32 v37, 20, v35
    v_subrev_u32 v38, 12, v35
    v_cmp_gt_u32 vcc, 12, v35
    s_nop 1
    v_cndmask_b32 v37, v38, v37, vcc
    v_cndmask_b32 v38, 1, 0, vcc
    v_lshlrev_b32 v38, 12, v38
    v_lshl_add_u32 v38, v33, 13, v38
    v_lshrrev_b32 v39, 3, v37
    v_lshl_add_u32 v38, v39, 10, v38
    v_bfe_u32 v39, v37, 2, 1
    v_lshlrev_b32 v39, 5, v39
    v_lshl_add_u32 v39, v36, 2, v39
    v_lshl_add_u32 v38, v39, 4, v38
    v_and_b32 v39, 3, v37
    v_lshl_add_u32 v38, v39, 2, v38
    v_min_u32 v38, 16320, v38
    v_add_u32 v38, 66560, v38
    s_waitcnt lgkmcnt(0)
    s_barrier
    ds_read_b32 v40, v38 offset:0
    ds_read_b32 v41, v38 offset:16
    ds_read_b32 v42, v38 offset:32
    ds_read_b32 v43, v38 offset:48
    ds_read_b32 v44, v38 offset:16384
    ds_read_b32 v45, v38 offset:16400
    ds_read_b32 v46, v38 offset:16416
    ds_read_b32 v47, v38 offset:16432
    s_lshl_b32 s28, s20, 4
    s_add_u32 s28, s28, s21
    s_lshl_b32 s28, s28, 12
    s_mul_i32 s39, s49, 1048576
    s_add_u32 s39, s39, 232783872
    s_add_u32 s28, s28, s39
    v_lshlrev_b32 v39, 4, v32
    v_cmp_gt_u32 vcc, 210, v32
    s_mov_b64 s[32:33], vcc
    s_waitcnt lgkmcnt(0)
    v_add_f32 v40, v40, v44
    v_add_f32 v41, v41, v45
    v_add_f32 v42, v42, v46
    v_add_f32 v43, v43, v47
    s_mov_b64 exec, s[32:33]
    buffer_store_dwordx4 v[40:43], v39, s[8:11], s28 offen sc1
    s_mov_b64 exec, -1
    v_fma_f32 v148, v148, v225, v228
    v_mul_f32 v48, 0x3fb8aa3b, v148
    v_exp_f32 v48, v48 clamp
    v_max_f32 v49, v148, v228
    v_add_f32 v148, v48, v49
    v_fma_f32 v149, v149, v225, v228
    v_mul_f32 v50, 0x3fb8aa3b, v149
    v_exp_f32 v50, v50 clamp
    v_max_f32 v51, v149, v228
    v_add_f32 v149, v50, v51
    v_fma_f32 v150, v150, v225, v228
    v_mul_f32 v52, 0x3fb8aa3b, v150
    v_exp_f32 v52, v52 clamp
    v_max_f32 v53, v150, v228
    v_add_f32 v150, v52, v53
    v_fma_f32 v151, v151, v225, v228
    v_mul_f32 v54, 0x3fb8aa3b, v151
    v_exp_f32 v54, v54 clamp
    v_max_f32 v55, v151, v228
    v_add_f32 v151, v54, v55
    v_fma_f32 v152, v152, v225, v228
    v_mul_f32 v48, 0x3fb8aa3b, v152
    v_exp_f32 v48, v48 clamp
    v_max_f32 v49, v152, v228
    v_add_f32 v152, v48, v49
    v_fma_f32 v153, v153, v225, v228
    v_mul_f32 v50, 0x3fb8aa3b, v153
    v_exp_f32 v50, v50 clamp
    v_max_f32 v51, v153, v228
    v_add_f32 v153, v50, v51
    v_fma_f32 v154, v154, v225, v228
    v_mul_f32 v52, 0x3fb8aa3b, v154
    v_exp_f32 v52, v52 clamp
    v_max_f32 v53, v154, v228
    v_add_f32 v154, v52, v53
    v_fma_f32 v155, v155, v225, v228
    v_mul_f32 v54, 0x3fb8aa3b, v155
    v_exp_f32 v54, v54 clamp
    v_max_f32 v55, v155, v228
    v_add_f32 v155, v54, v55
    v_fma_f32 v156, v156, v225, v228
    v_mul_f32 v48, 0x3fb8aa3b, v156
    v_exp_f32 v48, v48 clamp
    v_max_f32 v49, v156, v228
    v_add_f32 v156, v48, v49
    v_fma_f32 v157, v157, v225, v228
    v_mul_f32 v50, 0x3fb8aa3b, v157
    v_exp_f32 v50, v50 clamp
    v_max_f32 v51, v157, v228
    v_add_f32 v157, v50, v51
    v_fma_f32 v158, v158, v225, v228
    v_mul_f32 v52, 0x3fb8aa3b, v158
    v_exp_f32 v52, v52 clamp
    v_max_f32 v53, v158, v228
    v_add_f32 v158, v52, v53
    v_fma_f32 v159, v159, v225, v228
    v_mul_f32 v54, 0x3fb8aa3b, v159
    v_exp_f32 v54, v54 clamp
    v_max_f32 v55, v159, v228
    v_add_f32 v159, v54, v55
    v_cvt_pk_bf16_f32 v146, v148, v149
    v_cvt_pk_bf16_f32 v147, v150, v151
    v_cvt_pk_bf16_f32 v148, v152, v153
    v_cvt_pk_bf16_f32 v149, v154, v155
    v_cvt_pk_bf16_f32 v150, v156, v157
    v_cvt_pk_bf16_f32 v151, v158, v159
    v_mov_b32 v144, 0
    v_mov_b32 v145, 0
    s_mul_i32 s29, s26, 5
    v_lshrrev_b32 v17, 5, v0
    v_add_u32 v17, s29, v17
    v_lshrrev_b32 v18, 1, v17
    v_lshlrev_b32 v18, 9, v18
    v_and_b32 v17, 1, v17
    v_lshl_add_u32 v18, v17, 3, v18
    v_and_b32 v16, 31, v0
    v_lshl_add_u32 v14, v16, 4, v18
    v_mul_u32_u24 v15, 80, v16
    v_lshrrev_b32 v17, 5, v0
    v_lshl_add_u32 v15, v17, 4, v15
    s_mul_i32 s29, s23, 1680
    s_add_u32 s29, s29, 48
    v_add_u32 v15, s29, v15
    v_mov_b32 v48, 0
    v_mov_b32 v49, 0
    v_mov_b32 v50, 0
    v_mov_b32 v51, 0
    v_mov_b32 v52, 0
    v_mov_b32 v53, 0
    v_mov_b32 v54, 0
    v_mov_b32 v55, 0
    v_mov_b32 v56, 0
    v_mov_b32 v57, 0
    v_mov_b32 v58, 0
    v_mov_b32 v59, 0
    s_waitcnt vmcnt(0)
    s_barrier
    s_cmp_lg_u32 s13, 0
    s_cbranch_scc0 layerb1_kernel_af_w0
    s_cmp_eq_u32 s44, 2
    s_cbranch_scc1 layerb1_kernel_pf_wait
    s_bfe_u32 s41, s56, 524288
    s_mul_i32 s41, s41, s40
    s_add_u32 s42, s58, s41
    s_add_u32 s43, s59, s41
    buffer_load_dwordx4 a[192:195], v240, s[8:11], s42 offen
    buffer_load_dwordx4 a[196:199], v241, s[8:11], s43 offen
    s_bfe_u32 s41, s56, 524296
    s_mul_i32 s41, s41, s40
    s_add_u32 s42, s58, s41
    s_add_u32 s43, s59, s41
    buffer_load_dwordx4 a[200:203], v240, s[8:11], s42 offen
    buffer_load_dwordx4 a[204:207], v241, s[8:11], s43 offen
    s_bfe_u32 s41, s56, 524304
    s_mul_i32 s41, s41, s40
    s_add_u32 s42, s58, s41
    s_add_u32 s43, s59, s41
    buffer_load_dwordx4 a[208:211], v240, s[8:11], s42 offen
    buffer_load_dwordx4 a[212:215], v241, s[8:11], s43 offen
    s_bfe_u32 s41, s56, 524312
    s_mul_i32 s41, s41, s40
    s_add_u32 s42, s58, s41
    s_add_u32 s43, s59, s41
    buffer_load_dwordx4 a[216:219], v240, s[8:11], s42 offen
    buffer_load_dwordx4 a[220:223], v241, s[8:11], s43 offen
    s_bfe_u32 s41, s57, 524288
    s_mul_i32 s41, s41, s40
    s_add_u32 s42, s58, s41
    s_add_u32 s43, s59, s41
    buffer_load_dwordx4 a[224:227], v240, s[8:11], s42 offen
    buffer_load_dwordx4 a[228:231], v241, s[8:11], s43 offen
    s_bfe_u32 s41, s57, 524296
    s_mul_i32 s41, s41, s40
    s_add_u32 s42, s58, s41
    s_add_u32 s43, s59, s41
    buffer_load_dwordx4 a[232:235], v240, s[8:11], s42 offen
    buffer_load_dwordx4 a[236:239], v241, s[8:11], s43 offen
    s_bfe_u32 s41, s57, 524304
    s_mul_i32 s41, s41, s40
    s_add_u32 s42, s58, s41
    s_add_u32 s43, s59, s41
    buffer_load_dwordx4 a[240:243], v240, s[8:11], s42 offen
    buffer_load_dwordx4 a[244:247], v241, s[8:11], s43 offen
layerb1_kernel_pf_wait:
    s_branch layerb1_kernel_af_go
layerb1_kernel_af_w0:
    s_lshl_b32 s29, s20, 7
    s_add_u32 s29, s29, s48
    s_add_u32 s29, s29, 32768
    s_lshl_b32 s30, s21, 2
    v_mov_b32 v16, s30
    v_mov_b32 v17, 1
    s_mov_b64 exec, 1
    buffer_store_dword v17, v16, s[8:11], s29 offen sc1
    s_mov_b64 exec, 0xffff
    v_lshlrev_b32 v16, 2, v0
    s_mov_b32 s31, 400000
layerb1_kernel_af_poll:
    buffer_load_dword v17, v16, s[8:11], s29 offen sc1
    s_waitcnt vmcnt(0)
    v_cmp_eq_u32 vcc, 0, v17
    s_sub_u32 s31, s31, 1
    s_cbranch_scc1 layerb1_kernel_af_fail
    s_cbranch_vccnz layerb1_kernel_af_poll
    s_branch layerb1_kernel_af_ok
layerb1_kernel_af_fail:
    s_load_dwordx2 s[34:35], s[0:1], 88
    s_waitcnt lgkmcnt(0)
    s_mov_b32 s36, s34
    s_mov_b32 s37, s35
    s_mov_b32 s38, 256
    s_mov_b32 s39, 0x00020000
    s_mov_b64 exec, 1
    v_mov_b32 v16, 0
    v_mov_b32 v17, 0xdead
    buffer_store_dword v17, v16, s[36:39], 0 offen
layerb1_kernel_af_ok:
    s_mov_b64 exec, -1
layerb1_kernel_af_go:
    s_barrier
    s_lshl_b32 s28, s20, 16
    s_add_u32 s28, s28, s39
    s_mov_b64 exec, s[32:33]
    buffer_load_dwordx4 v[160:163], v39, s[8:11], s28 offen sc1
    s_add_u32 s28, s28, 4096
    buffer_load_dwordx4 v[164:167], v39, s[8:11], s28 offen sc1
    s_add_u32 s28, s28, 4096
    buffer_load_dwordx4 v[168:171], v39, s[8:11], s28 offen sc1
    s_add_u32 s28, s28, 4096
    buffer_load_dwordx4 v[172:175], v39, s[8:11], s28 offen sc1
    s_add_u32 s28, s28, 4096
    buffer_load_dwordx4 v[176:179], v39, s[8:11], s28 offen sc1
    s_add_u32 s28, s28, 4096
    buffer_load_dwordx4 v[180:183], v39, s[8:11], s28 offen sc1
    s_add_u32 s28, s28, 4096
    buffer_load_dwordx4 v[184:187], v39, s[8:11], s28 offen sc1
    s_add_u32 s28, s28, 4096
    buffer_load_dwordx4 v[188:191], v39, s[8:11], s28 offen sc1
    s_add_u32 s28, s28, 4096
    buffer_load_dwordx4 v[192:195], v39, s[8:11], s28 offen sc1
    s_add_u32 s28, s28, 4096
    buffer_load_dwordx4 v[196:199], v39, s[8:11], s28 offen sc1
    s_add_u32 s28, s28, 4096
    buffer_load_dwordx4 v[200:203], v39, s[8:11], s28 offen sc1
    s_add_u32 s28, s28, 4096
    buffer_load_dwordx4 v[204:207], v39, s[8:11], s28 offen sc1
    s_add_u32 s28, s28, 4096
    buffer_load_dwordx4 v[208:211], v39, s[8:11], s28 offen sc1
    s_add_u32 s28, s28, 4096
    buffer_load_dwordx4 v[212:215], v39, s[8:11], s28 offen sc1
    s_add_u32 s28, s28, 4096
    buffer_load_dwordx4 v[216:219], v39, s[8:11], s28 offen sc1
    s_add_u32 s28, s28, 4096
    buffer_load_dwordx4 v[220:223], v39, s[8:11], s28 offen sc1
    s_mov_b64 exec, -1
    s_waitcnt vmcnt(14)
    v_add_f32 v160, v160, v164
    v_add_f32 v161, v161, v165
    v_add_f32 v162, v162, v166
    v_add_f32 v163, v163, v167
    s_waitcnt vmcnt(12)
    v_add_f32 v168, v168, v172
    v_add_f32 v169, v169, v173
    v_add_f32 v170, v170, v174
    v_add_f32 v171, v171, v175
    s_waitcnt vmcnt(10)
    v_add_f32 v176, v176, v180
    v_add_f32 v177, v177, v181
    v_add_f32 v178, v178, v182
    v_add_f32 v179, v179, v183
    s_waitcnt vmcnt(8)
    v_add_f32 v184, v184, v188
    v_add_f32 v185, v185, v189
    v_add_f32 v186, v186, v190
    v_add_f32 v187, v187, v191
    s_waitcnt vmcnt(6)
    v_add_f32 v192, v192, v196
    v_add_f32 v193, v193, v197
    v_add_f32 v194, v194, v198
    v_add_f32 v195, v195, v199
    s_waitcnt vmcnt(4)
    v_add_f32 v200, v200, v204
    v_add_f32 v201, v201, v205
    v_add_f32 v202, v202, v206
    v_add_f32 v203, v203, v207
    s_waitcnt vmcnt(2)
    v_add_f32 v208, v208, v212
    v_add_f32 v209, v209, v213
    v_add_f32 v210, v210, v214
    v_add_f32 v211, v211, v215
    s_waitcnt vmcnt(0)
    v_add_f32 v216, v216, v220
    v_add_f32 v217, v217, v221
    v_add_f32 v218, v218, v222
    v_add_f32 v219, v219, v223
    v_add_f32 v160, v160, v168
    v_add_f32 v161, v161, v169
    v_add_f32 v162, v162, v170
    v_add_f32 v163, v163, v171
    v_add_f32 v176, v176, v184
    v_add_f32 v177, v177, v185
    v_add_f32 v178, v178, v186
    v_add_f32 v179, v179, v187
    v_add_f32 v192, v192, v200
    v_add_f32 v193, v193, v201
    v_add_f32 v194, v194, v202
    v_add_f32 v195, v195, v203
    v_add_f32 v208, v208, v216
    v_add_f32 v209, v209, v217
    v_add_f32 v210, v210, v218
    v_add_f32 v211, v211, v219
    v_add_f32 v160, v160, v176
    v_add_f32 v161, v161, v177
    v_add_f32 v162, v162, v178
    v_add_f32 v163, v163, v179
    v_add_f32 v192, v192, v208
    v_add_f32 v193, v193, v209
    v_add_f32 v194, v194, v210
    v_add_f32 v195, v195, v211
    v_add_f32 v160, v160, v192
    v_add_f32 v161, v161, v193
    v_add_f32 v162, v162, v194
    v_add_f32 v163, v163, v195
    v_add_u32 v39, 64, v39
    s_mov_b64 exec, s[32:33]
    ds_write_b128 v39, v[160:163]
    s_mov_b64 exec, -1
    s_waitcnt lgkmcnt(0)
    s_barrier
    s_mov_b32 exec_lo, 0x1fffff
    s_mov_b32 exec_hi, 0x1fffff
    ds_read_b128 v[52:55], v15 offset:32
    ds_read_b128 v[56:59], v15 offset:64
    s_mov_b32 exec_lo, 0
    ds_read_b128 v[48:51], v15
    s_mov_b64 exec, -1
    v_mov_b32 v32, 0
    v_mov_b32 v33, 0
    s_waitcnt lgkmcnt(0)
    v_cvt_pk_bf16_f32 v34, v48, v49
    v_cvt_pk_bf16_f32 v35, v50, v51
    v_cvt_pk_bf16_f32 v36, v52, v53
    v_cvt_pk_bf16_f32 v37, v54, v55
    v_cvt_pk_bf16_f32 v38, v56, v57
    v_cvt_pk_bf16_f32 v39, v58, v59
    s_nop 1
    v_mfma_f32_32x32x16_bf16 v[64:79], v[32:35], v[128:131], 0
    v_mfma_f32_32x32x16_bf16 v[64:79], v[36:39], v[132:135], v[64:79]
    v_mfma_f32_32x32x16_bf16 v[80:95], v[32:35], v[144:147], 0
    v_mfma_f32_32x32x16_bf16 v[80:95], v[36:39], v[148:151], v[80:95]
    s_lshl_b32 s28, s21, 2
    s_lshl_b32 s29, s22, 1
    s_add_u32 s28, s28, s29
    s_mul_i32 s28, s28, 40960
    s_add_u32 s28, s28, 229638144
    s_nop 7
    s_nop 3
    v_add_f32 v40, 0x358637bd, v72
    v_mov_b32 v41, v40
    s_nop 1
    v_permlane32_swap_b32 v40, v41
    v_rcp_f32 v41, v41
    s_nop 0
    v_mul_f32 v64, v64, v41
    v_mul_f32 v65, v65, v41
    v_mul_f32 v66, v66, v41
    v_mul_f32 v67, v67, v41
    v_mul_f32 v68, v68, v41
    v_mul_f32 v69, v69, v41
    v_mul_f32 v70, v70, v41
    v_mul_f32 v71, v71, v41
    v_mul_f32 v72, v72, v41
    v_mul_f32 v73, v73, v41
    v_mul_f32 v74, v74, v41
    v_mul_f32 v75, v75, v41
    v_cvt_pk_bf16_f32 v42, v64, v65
    v_cvt_pk_bf16_f32 v43, v66, v67
    v_cvt_pk_bf16_f32 v44, v68, v69
    v_cvt_pk_bf16_f32 v45, v70, v71
    v_cvt_pk_bf16_f32 v46, v72, v73
    v_cvt_pk_bf16_f32 v47, v74, v75
    buffer_store_dwordx2 v[42:43], v14, s[8:11], s28 offen offset:0 sc1
    buffer_store_dwordx2 v[44:45], v14, s[8:11], s28 offen offset:512 sc1
    s_mov_b32 exec_hi, 0
    buffer_store_dwordx2 v[46:47], v14, s[8:11], s28 offen offset:1024 sc1
    s_mov_b32 exec_hi, -1
    s_add_u32 s28, s28, 40960
    s_nop 7
    v_add_f32 v40, 0x358637bd, v88
    v_mov_b32 v41, v40
    s_nop 1
    v_permlane32_swap_b32 v40, v41
    v_rcp_f32 v41, v41
    s_nop 0
    v_mul_f32 v80, v80, v41
    v_mul_f32 v81, v81, v41
    v_mul_f32 v82, v82, v41
    v_mul_f32 v83, v83, v41
    v_mul_f32 v84, v84, v41
    v_mul_f32 v85, v85, v41
    v_mul_f32 v86, v86, v41
    v_mul_f32 v87, v87, v41
    v_mul_f32 v88, v88, v41
    v_mul_f32 v89, v89, v41
    v_mul_f32 v90, v90, v41
    v_mul_f32 v91, v91, v41
    v_cvt_pk_bf16_f32 v48, v80, v81
    v_cvt_pk_bf16_f32 v49, v82, v83
    v_cvt_pk_bf16_f32 v50, v84, v85
    v_cvt_pk_bf16_f32 v51, v86, v87
    v_cvt_pk_bf16_f32 v52, v88, v89
    v_cvt_pk_bf16_f32 v53, v90, v91
    buffer_store_dwordx2 v[48:49], v14, s[8:11], s28 offen offset:0 sc1
    buffer_store_dwordx2 v[50:51], v14, s[8:11], s28 offen offset:512 sc1
    s_mov_b32 exec_hi, 0
    buffer_store_dwordx2 v[52:53], v14, s[8:11], s28 offen offset:1024 sc1
    s_mov_b32 exec_hi, -1
    s_waitcnt vmcnt(0)
    s_barrier
    s_cmp_lg_u32 s13, 0
    s_cbranch_scc1 layerb1_kernel_af_pub
    s_lshl_b32 s28, s21, 4
    s_add_u32 s28, s28, s20
    s_lshl_b32 s28, s28, 2
    s_add_u32 s28, s28, s48
    s_add_u32 s28, s28, 49152
    v_mov_b32 v16, 0
    v_mov_b32 v17, 1
    s_mov_b64 exec, 1
    buffer_store_dword v17, v16, s[8:11], s28 offen sc1
    s_mov_b64 exec, -1
layerb1_kernel_af_pub:
    s_cmp_lg_u32 s44, 0
    s_cbranch_scc1 layerb1_kernel_pf_late
    s_cmp_lg_u32 s13, 0
    s_cbranch_scc1 layerb1_kernel_pf_late1
    s_bfe_u32 s41, s56, 524288
    s_mul_i32 s41, s41, s40
    s_add_u32 s42, s58, s41
    s_add_u32 s43, s59, s41
    buffer_load_dwordx4 a[192:195], v240, s[8:11], s42 offen
    buffer_load_dwordx4 a[196:199], v241, s[8:11], s43 offen
    s_bfe_u32 s41, s56, 524296
    s_mul_i32 s41, s41, s40
    s_add_u32 s42, s58, s41
    s_add_u32 s43, s59, s41
    buffer_load_dwordx4 a[200:203], v240, s[8:11], s42 offen
    buffer_load_dwordx4 a[204:207], v241, s[8:11], s43 offen
    s_bfe_u32 s41, s56, 524304
    s_mul_i32 s41, s41, s40
    s_add_u32 s42, s58, s41
    s_add_u32 s43, s59, s41
    buffer_load_dwordx4 a[208:211], v240, s[8:11], s42 offen
    buffer_load_dwordx4 a[212:215], v241, s[8:11], s43 offen
    s_bfe_u32 s41, s56, 524312
    s_mul_i32 s41, s41, s40
    s_add_u32 s42, s58, s41
    s_add_u32 s43, s59, s41
    buffer_load_dwordx4 a[216:219], v240, s[8:11], s42 offen
    buffer_load_dwordx4 a[220:223], v241, s[8:11], s43 offen
    s_bfe_u32 s41, s57, 524288
    s_mul_i32 s41, s41, s40
    s_add_u32 s42, s58, s41
    s_add_u32 s43, s59, s41
    buffer_load_dwordx4 a[224:227], v240, s[8:11], s42 offen
    buffer_load_dwordx4 a[228:231], v241, s[8:11], s43 offen
    s_bfe_u32 s41, s57, 524296
    s_mul_i32 s41, s41, s40
    s_add_u32 s42, s58, s41
    s_add_u32 s43, s59, s41
    buffer_load_dwordx4 a[232:235], v240, s[8:11], s42 offen
    buffer_load_dwordx4 a[236:239], v241, s[8:11], s43 offen
    s_bfe_u32 s41, s57, 524304
    s_mul_i32 s41, s41, s40
    s_add_u32 s42, s58, s41
    s_add_u32 s43, s59, s41
    buffer_load_dwordx4 a[240:243], v240, s[8:11], s42 offen
    buffer_load_dwordx4 a[244:247], v241, s[8:11], s43 offen
layerb1_kernel_pf_late1:
    s_bfe_u32 s41, s57, 524312
    s_mul_i32 s41, s41, s40
    s_add_u32 s42, s58, s41
    s_add_u32 s43, s59, s41
    buffer_load_dwordx4 a[248:251], v240, s[8:11], s42 offen
    buffer_load_dwordx4 a[252:255], v241, s[8:11], s43 offen
layerb1_kernel_pf_late:
    s_add_u32 s22, s4, 247463936
    s_addc_u32 s23, s5, 0
    s_cmp_eq_u32 s49, 0
    s_cselect_b32 s84, s22, s6
    s_cselect_b32 s85, s23, s7
    s_mov_b32 s86, 2621440
    s_mov_b32 s87, 0x00020000
    s_mov_b32 s20, s98
    s_mov_b32 s21, s99
    s_sub_u32 s22, 0, s4
    s_and_b32 s22, s22, 0x1fffff
    s_mov_b32 s24, 0
    s_mov_b32 s25, 0
    s_lshl_b32 s82, s24, 1
    s_sub_u32 s82, 8192, s82
    s_lshl_b32 s83, s25, 1
    s_sub_u32 s83, 8192, s83
    s_mul_i32 s23, s49, 4194304
    s_add_u32 s22, s22, s23
    s_add_u32 s16, s22, s24
    s_add_u32 s17, s22, s25
    s_add_u32 s17, s17, 2097152
    s_mov_b32 s40, 0x01010101
    s_mov_b32 s41, 0x01010101
    s_mov_b32 s42, 0x00010001
    s_mov_b32 s43, 0
    v_lshlrev_b32 v1, 4, v0
    v_and_b32 v16, 8, v0
    v_cmp_eq_u32 vcc, 0, v16
    v_mov_b32 v17, 0xeeeeeeee
    v_mov_b32 v18, 0x44444444
    v_cndmask_b32 v2, v17, v18, vcc
    s_cmp_eq_u32 s20, 0
    s_cbranch_scc0 layerb1_kernel_notp
    s_mov_b32 s12, s21
    s_cmp_eq_u32 s13, 0
    s_cbranch_scc1 layerb1_kernel_p0_start
    s_cmp_eq_u32 s13, 1
    s_cbranch_scc1 layerb1_kernel_p1_start
    s_cmp_eq_u32 s13, 2
    s_cbranch_scc1 layerb1_kernel_p2_start
    s_cmp_eq_u32 s13, 3
    s_cbranch_scc1 layerb1_kernel_p3_start
layerb1_kernel_notp:
    s_cmp_ge_u32 s20, 4
    s_cbranch_scc1 layerb1_kernel_proj
    s_cmp_ge_u32 s21, 27
    s_cbranch_scc1 layerb1_kernel_spare
    s_sub_u32 s22, s20, 1
    s_mul_i32 s22, s22, 27
    s_add_u32 s12, s22, s21
    s_cmp_ge_u32 s12, 80
    s_cbranch_scc1 layerb1_kernel_spare
    s_cmp_eq_u32 s13, 0
    s_cbranch_scc1 layerb1_kernel_y0_start
    s_cmp_eq_u32 s13, 1
    s_cbranch_scc1 layerb1_kernel_y1_start
    s_cmp_eq_u32 s13, 2
    s_cbranch_scc1 layerb1_kernel_y2_start
    s_cmp_eq_u32 s13, 3
    s_cbranch_scc1 layerb1_kernel_y3_start
    s_branch layerb1_kernel_end
layerb1_kernel_p0_start:
    v_lshrrev_b32 v16, 4, v0
    v_and_b32 v17, 15, v0
    v_and_b32 v18, 2, v0
    v_cmp_eq_u32 vcc, 0, v18
    v_mov_b32 v18, 0xeeeeeeee
    v_mov_b32 v19, 0x44444444
    v_cndmask_b32 v2, v18, v19, vcc
    v_lshrrev_b32 v20, 2, v17
    v_lshlrev_b32 v20, 1, v20
    v_and_b32 v21, 1, v17
    v_add_u32 v20, v20, v21
    v_bfe_u32 v21, v17, 1, 1
    v_lshl_add_u32 v18, v16, 1, v21
    v_lshlrev_b32 v18, 7, v18
    v_lshl_add_u32 v12, v20, 4, v18
    v_mul_u32_u24 v18, 400, v20
    v_lshl_add_u32 v18, v16, 5, v18
    v_lshl_add_u32 v18, v21, 4, v18
    v_add_u32 v4, 141312, v18
    v_mul_u32_u24 v18, 800, v16
    v_lshl_add_u32 v18, v17, 1, v18
    v_add_u32 v3, 141312, v18
    v_and_b32 v18, 7, v0
    v_mul_u32_u24 v18, 400, v18
    v_lshl_add_u32 v18, v16, 5, v18
    v_add_u32 v5, 144512, v18
    v_lshlrev_b32 v18, 3, v0
    v_add_u32 v6, 147712, v18
    v_lshlrev_b32 v18, 4, v16
    v_bfe_u32 v19, v17, 1, 2
    v_lshl_add_u32 v18, v19, 2, v18
    s_lshl_b32 s20, s12, 7
    s_add_u32 s20, s20, 0
    v_add_u32 v18, s20, v18
    v_lshrrev_b32 v19, 3, v17
    v_add_u32 v19, 1, v19
    v_lshrrev_b32 v20, 1, v19
    v_lshlrev_b32 v20, 14, v20
    v_and_b32 v19, 1, v19
    v_lshl_add_u32 v19, v19, 12, v20
    v_add_u32 v19, v19, v18
    v_mov_b32 v20, 0x7ffffff0
    v_and_b32 v21, 7, v0
    v_cmp_eq_u32 vcc, 4, v21
    v_subrev_u32 v21, 8, v18
    s_nop 0
    v_cndmask_b32 v7, v19, v21, vcc
    v_and_b32 v21, 0x29, v0
    v_cmp_eq_u32 vcc, 0, v21
    s_nop 1
    v_cndmask_b32 v8, v20, v18, vcc
    s_lshl_b32 s20, s12, 2
    v_lshlrev_b32 v18, 7, v0
    v_add_u32 v8, s20, v18
    v_lshlrev_b32 v18, 4, v17
    v_lshl_add_u32 v18, v16, 10, v18
    v_add_u32 v9, 0, v18
    v_add_u32 v18, 0, v0
    v_mul_u32_u24 v19, 2731, v18
    v_lshrrev_b32 v19, 16, v19
    v_mul_u32_u24 v20, 24, v19
    v_sub_u32 v20, v18, v20
    v_mul_u32_u24 v21, 400, v19
    v_lshl_add_u32 v21, v20, 4, v21
    v_add_u32 v10, 144512, v21
    v_lshlrev_b32 v21, 4, v19
    v_lshl_add_u32 v11, v20, 7, v21
    v_add_u32 v13, 0, v1
    v_add_u32 v14, 131072, v1
    s_mul_i32 s44, s12, 12288
    s_add_u32 s44, s44, 53477376
    s_mul_i32 s45, s12, 3072
    s_add_u32 s45, s45, 208666624
    s_mul_i32 s20, s12, 6
    s_add_u32 s21, s20, 5
    s_lshr_b32 s20, s20, 3
    s_lshr_b32 s21, s21, 3
    s_add_u32 s20, s20, 80
    s_add_u32 s21, s21, 80
    s_lshl_b32 s20, s20, 7
    s_lshl_b32 s21, s21, 7
    v_mov_b32 v255, s21
    v_mov_b32 v253, s20
    v_cmp_eq_u32 vcc, 0, v0
    s_nop 1
    v_cndmask_b32 v255, v255, v253, vcc
    s_mov_b32 s47, 0
    s_mul_i32 s20, s12, 491520
    s_add_u32 s20, s20, 11534336
    s_add_u32 s21, s20, 2048
    buffer_load_dwordx4 v[16:19], v1, s[8:11], s21 offen offset:0
    buffer_load_dwordx4 v[20:23], v1, s[8:11], s21 offen offset:1024
    s_add_u32 s21, s20, 24576
    buffer_load_dwordx4 v[24:27], v1, s[8:11], s21 offen offset:0
    buffer_load_dwordx4 v[28:31], v1, s[8:11], s21 offen offset:1024
    s_add_u32 s21, s20, 6144
    buffer_load_dwordx4 v[32:35], v1, s[8:11], s21 offen offset:0
    buffer_load_dwordx4 v[36:39], v1, s[8:11], s21 offen offset:1024
    s_add_u32 s21, s20, 14336
    buffer_load_dwordx4 v[40:43], v1, s[8:11], s21 offen offset:0
    buffer_load_dwordx4 v[44:47], v1, s[8:11], s21 offen offset:1024
    s_add_u32 s21, s20, 28672
    buffer_load_dwordx4 v[48:51], v1, s[8:11], s21 offen offset:0
    buffer_load_dwordx4 v[52:55], v1, s[8:11], s21 offen offset:1024
    s_add_u32 s21, s20, 36864
    buffer_load_dwordx4 v[56:59], v1, s[8:11], s21 offen offset:0
    buffer_load_dwordx4 v[60:63], v1, s[8:11], s21 offen offset:1024
    s_add_u32 s21, s20, 51200
    buffer_load_dwordx4 v[64:67], v1, s[8:11], s21 offen offset:0
    buffer_load_dwordx4 v[68:71], v1, s[8:11], s21 offen offset:1024
    s_add_u32 s21, s20, 59392
    buffer_load_dwordx4 v[72:75], v1, s[8:11], s21 offen offset:0
    buffer_load_dwordx4 v[76:79], v1, s[8:11], s21 offen offset:1024
    s_add_u32 s21, s20, 73728
    buffer_load_dwordx4 v[80:83], v1, s[8:11], s21 offen offset:0
    buffer_load_dwordx4 v[84:87], v1, s[8:11], s21 offen offset:1024
    s_add_u32 s21, s20, 65536
    buffer_load_dwordx4 v[88:91], v1, s[8:11], s21 offen offset:0
    buffer_load_dwordx4 v[92:95], v1, s[8:11], s21 offen offset:1024
    s_add_u32 s21, s20, 94208
    buffer_load_dwordx4 v[96:99], v1, s[8:11], s21 offen offset:0
    buffer_load_dwordx4 v[100:103], v1, s[8:11], s21 offen offset:1024
    s_add_u32 s21, s20, 81920
    buffer_load_dwordx4 v[104:107], v1, s[8:11], s21 offen offset:0
    buffer_load_dwordx4 v[108:111], v1, s[8:11], s21 offen offset:1024
    s_add_u32 s21, s20, 108544
    buffer_load_dwordx4 v[112:115], v1, s[8:11], s21 offen offset:0
    buffer_load_dwordx4 v[116:119], v1, s[8:11], s21 offen offset:1024
    s_add_u32 s21, s20, 114688
    buffer_load_dwordx4 v[120:123], v1, s[8:11], s21 offen offset:0
    buffer_load_dwordx4 v[124:127], v1, s[8:11], s21 offen offset:1024
    s_add_u32 s21, s20, 120832
    buffer_load_dwordx4 v[128:131], v1, s[8:11], s21 offen offset:0
    buffer_load_dwordx4 v[132:135], v1, s[8:11], s21 offen offset:1024
    s_add_u32 s21, s20, 104448
    buffer_load_dwordx4 v[136:139], v1, s[8:11], s21 offen offset:0
    buffer_load_dwordx4 v[140:143], v1, s[8:11], s21 offen offset:1024
    s_add_u32 s21, s20, 92160
    buffer_load_dwordx4 v[156:159], v1, s[8:11], s21 offen offset:0
    buffer_load_dwordx4 v[160:163], v1, s[8:11], s21 offen offset:1024
    s_add_u32 s21, s20, 96256
    buffer_load_dwordx4 v[164:167], v1, s[8:11], s21 offen offset:0
    buffer_load_dwordx4 v[168:171], v1, s[8:11], s21 offen offset:1024
    s_add_u32 s21, s20, 98304
    buffer_load_dwordx4 v[172:175], v1, s[8:11], s21 offen offset:0
    buffer_load_dwordx4 v[176:179], v1, s[8:11], s21 offen offset:1024
    s_add_u32 s21, s20, 100352
    buffer_load_dwordx4 v[180:183], v1, s[8:11], s21 offen offset:0
    buffer_load_dwordx4 v[184:187], v1, s[8:11], s21 offen offset:1024
    s_add_u32 s21, s20, 83968
    buffer_load_dwordx4 v[188:191], v1, s[8:11], s21 offen offset:0
    buffer_load_dwordx4 v[192:195], v1, s[8:11], s21 offen offset:1024
    s_add_u32 s21, s20, 86016
    buffer_load_dwordx4 v[196:199], v1, s[8:11], s21 offen offset:0
    buffer_load_dwordx4 v[200:203], v1, s[8:11], s21 offen offset:1024
    s_add_u32 s21, s20, 110592
    buffer_load_dwordx4 v[204:207], v1, s[8:11], s21 offen offset:0
    buffer_load_dwordx4 v[208:211], v1, s[8:11], s21 offen offset:1024
    s_add_u32 s21, s20, 112640
    buffer_load_dwordx4 v[212:215], v1, s[8:11], s21 offen offset:0
    buffer_load_dwordx4 v[216:219], v1, s[8:11], s21 offen offset:1024
    s_add_u32 s21, s20, 116736
    buffer_load_dwordx4 v[220:223], v1, s[8:11], s21 offen offset:0
    buffer_load_dwordx4 v[224:227], v1, s[8:11], s21 offen offset:1024
    s_add_u32 s21, s20, 118784
    buffer_load_dwordx4 v[228:231], v1, s[8:11], s21 offen offset:0
    buffer_load_dwordx4 v[232:235], v1, s[8:11], s21 offen offset:1024
    s_add_u32 s21, s20, 102400
    buffer_load_dwordx4 v[236:239], v1, s[8:11], s21 offen offset:0
    buffer_load_dwordx4 v[240:243], v1, s[8:11], s21 offen offset:1024
    s_add_u32 s21, s20, 106496
    buffer_load_dwordx4 v[244:247], v1, s[8:11], s21 offen offset:0
    buffer_load_dwordx4 v[248:251], v1, s[8:11], s21 offen offset:1024
    s_waitcnt vmcnt(24)
    ds_write_b128 v13, v[16:19] offset:0
    ds_write_b128 v13, v[20:23] offset:1024
    ds_write_b128 v13, v[24:27] offset:2048
    ds_write_b128 v13, v[28:31] offset:3072
    ds_write_b128 v13, v[32:35] offset:4096
    ds_write_b128 v13, v[36:39] offset:5120
    ds_write_b128 v13, v[40:43] offset:6144
    ds_write_b128 v13, v[44:47] offset:7168
    ds_write_b128 v13, v[48:51] offset:8192
    ds_write_b128 v13, v[52:55] offset:9216
    ds_write_b128 v13, v[56:59] offset:10240
    ds_write_b128 v13, v[60:63] offset:11264
    ds_write_b128 v13, v[64:67] offset:12288
    ds_write_b128 v13, v[68:71] offset:13312
    ds_write_b128 v13, v[72:75] offset:14336
    ds_write_b128 v13, v[76:79] offset:15360
    ds_write_b128 v13, v[80:83] offset:16384
    ds_write_b128 v13, v[84:87] offset:17408
    ds_write_b128 v13, v[88:91] offset:18432
    ds_write_b128 v13, v[92:95] offset:19456
    ds_write_b128 v13, v[96:99] offset:20480
    ds_write_b128 v13, v[100:103] offset:21504
    ds_write_b128 v13, v[104:107] offset:22528
    ds_write_b128 v13, v[108:111] offset:23552
    ds_write_b128 v13, v[112:115] offset:24576
    ds_write_b128 v13, v[116:119] offset:25600
    ds_write_b128 v13, v[120:123] offset:26624
    ds_write_b128 v13, v[124:127] offset:27648
    ds_write_b128 v13, v[128:131] offset:28672
    ds_write_b128 v13, v[132:135] offset:29696
    ds_write_b128 v13, v[136:139] offset:30720
    ds_write_b128 v13, v[140:143] offset:31744
    s_waitcnt lgkmcnt(0)
    s_add_u32 s20, s48, 51200
    s_mov_b64 exec, 3
    v_lshlrev_b32 v16, 2, v0
layerb1_kernel_p0_par:
    buffer_load_dword v17, v16, s[8:11], s20 offen sc1
    s_waitcnt vmcnt(0)
    v_cmp_eq_u32 vcc, 0, v17
    s_sub_u32 s15, s15, 1
    s_cbranch_scc1 layerb1_kernel_bail
    s_cbranch_vccnz layerb1_kernel_p0_par
    s_mov_b64 exec, -1
    v_readlane_b32 s20, v17, 0
    v_readlane_b32 s21, v17, 1
    s_nop 0
    s_and_b32 s20, s20, 8192
    s_and_b32 s21, s21, 8192
    s_add_u32 s16, s16, s20
    s_add_u32 s17, s17, s21
    s_mov_b32 s14, 0
    s_cmp_gt_u32 s47, s14
    s_cbranch_scc1 layerb1_kernel_p0_gw1_ok
layerb1_kernel_p0_gw1_lp:
    buffer_load_dword v253, v255, s[8:11], s48 offen sc1
    s_waitcnt vmcnt(0)
    v_readlane_b32 s47, v253, 0
    v_readlane_b32 s29, v253, 1
    s_nop 0
    s_min_u32 s47, s47, s29
    s_sub_u32 s15, s15, 1
    s_cbranch_scc1 layerb1_kernel_bail
    s_cmp_gt_u32 s47, s14
    s_cbranch_scc0 layerb1_kernel_p0_gw1_lp
layerb1_kernel_p0_gw1_ok:
    s_mul_i32 s20, s14, 393216
    s_add_u32 s20, s20, s44
    s_add_u32 s21, s20, 0
    buffer_load_dwordx4 v[100:103], v9, s[8:11], s21 offen offset:0 sc1
    buffer_load_dwordx4 v[104:107], v9, s[8:11], s21 offen offset:512 sc1
    s_add_u32 s21, s20, 4096
    buffer_load_dwordx4 v[108:111], v9, s[8:11], s21 offen offset:0 sc1
    buffer_load_dwordx4 v[112:115], v9, s[8:11], s21 offen offset:512 sc1
    s_add_u32 s21, s20, 8192
    buffer_load_dwordx4 v[116:119], v9, s[8:11], s21 offen offset:0 sc1
    buffer_load_dwordx4 v[120:123], v9, s[8:11], s21 offen offset:512 sc1
    v_mov_b32 v56, 0
    v_mov_b32 v57, 0
    v_mov_b32 v58, 0
    v_mov_b32 v59, 0
    v_mov_b32 v60, 0
    v_mov_b32 v61, 0
    v_mov_b32 v62, 0
    v_mov_b32 v63, 0
    v_mov_b32 v64, 0
    v_mov_b32 v65, 0
    v_mov_b32 v66, 0
    v_mov_b32 v67, 0
    v_mov_b32 v68, 0
    v_mov_b32 v69, 0
    v_mov_b32 v70, 0
    v_mov_b32 v71, 0
    v_mov_b32 v72, 0
    v_mov_b32 v73, 0
    v_mov_b32 v74, 0
    v_mov_b32 v75, 0
    v_mov_b32 v76, 0
    v_mov_b32 v77, 0
    v_mov_b32 v78, 0
    v_mov_b32 v79, 0
    v_mov_b32 v80, 0
    v_mov_b32 v81, 0
    v_mov_b32 v82, 0
    v_mov_b32 v83, 0
    v_mov_b32 v84, 0
    v_mov_b32 v85, 0
    v_mov_b32 v86, 0
    v_mov_b32 v87, 0
    ds_read_b128 v[124:127], v13 offset:0
    ds_read_b128 v[128:131], v13 offset:1024
    ds_read_b128 v[132:135], v13 offset:2048
    ds_read_b128 v[136:139], v13 offset:3072
    ds_read_b128 v[140:143], v13 offset:4096
    ds_read_b128 v[144:147], v13 offset:5120
    ds_read_b128 v[148:151], v13 offset:6144
    ds_read_b128 v[152:155], v13 offset:7168
    s_waitcnt lgkmcnt(0)
layerb1_kernel_p0_step:
    s_cmp_lt_u32 s14, 32
    s_cselect_b32 s18, s16, s17
    s_and_b32 s20, s14, 31
    s_lshl_b32 s20, s20, 16
    s_add_u32 s18, s18, s20
    s_add_u32 s69, s18, 55424
    s_add_u32 s22, s18, 36864
    s_add_u32 s23, s18, 37888
    s_add_u32 s24, s18, 38912
layerb1_kernel_p0_poll:
    buffer_load_dwordx4 v[16:19], v12, s[8:11], s22 offen sc1
    buffer_load_dwordx4 v[20:23], v12, s[8:11], s23 offen sc1
    buffer_load_dwordx4 v[24:27], v12, s[8:11], s24 offen sc1
    s_waitcnt vmcnt(0)
    ds_write_b128 v14, v[16:19] offset:0
    ds_write_b128 v14, v[20:23] offset:1024
    ds_write_b128 v14, v[24:27] offset:2048
    v_max3_u32 v88, v16, v17, v18
    v_max3_u32 v88, v88, v19, v20
    v_max3_u32 v88, v88, v21, v22
    v_max3_u32 v88, v88, v23, v24
    v_max3_u32 v88, v88, v25, v26
    v_max_u32 v88, v88, v27
    v_cmp_eq_u32 vcc, -1, v88
    s_sub_u32 s15, s15, 1
    s_cbranch_scc1 layerb1_kernel_bail
    s_cbranch_vccnz layerb1_kernel_p0_poll
    v_smfmac_f32_16x16x64_bf16 v[56:59], v[16:19], a[0:7], v2
    v_smfmac_f32_16x16x64_bf16 v[60:63], v[16:19], a[8:15], v2
    v_smfmac_f32_16x16x64_bf16 v[64:67], v[16:19], a[16:23], v2
    v_smfmac_f32_16x16x64_bf16 v[56:59], v[20:23], v[124:131], v2
    ds_read_b128 v[124:127], v13 offset:8192
    v_smfmac_f32_16x16x64_bf16 v[60:63], v[20:23], a[24:31], v2
    s_waitcnt lgkmcnt(1)
    s_barrier
    v_smfmac_f32_16x16x64_bf16 v[64:67], v[20:23], a[32:39], v2
    ds_read_b128 v[28:31], v14 offset:3072
    v_smfmac_f32_16x16x64_bf16 v[56:59], v[24:27], a[40:47], v2
    ds_read_b128 v[32:35], v14 offset:4096
    v_smfmac_f32_16x16x64_bf16 v[60:63], v[24:27], v[132:139], v2
    ds_read_b128 v[36:39], v14 offset:5120
    v_smfmac_f32_16x16x64_bf16 v[64:67], v[24:27], a[48:55], v2
    ds_read_b128 v[40:43], v14 offset:6144
    v_smfmac_f32_16x16x64_bf16 v[68:71], v[16:19], a[56:63], v2
    ds_read_b128 v[44:47], v14 offset:7168
    v_smfmac_f32_16x16x64_bf16 v[68:71], v[20:23], a[64:71], v2
    s_waitcnt lgkmcnt(4)
    ds_read_b128 v[48:51], v14 offset:8192
    v_smfmac_f32_16x16x64_bf16 v[56:59], v[28:31], v[140:147], v2
    s_waitcnt lgkmcnt(4)
    ds_read_b128 v[52:55], v14 offset:9216
    v_smfmac_f32_16x16x64_bf16 v[56:59], v[32:35], a[72:79], v2
    s_waitcnt lgkmcnt(4)
    ds_read_b128 v[128:131], v13 offset:9216
    v_smfmac_f32_16x16x64_bf16 v[56:59], v[36:39], a[80:87], v2
    s_waitcnt lgkmcnt(4)
    ds_read_b128 v[132:135], v13 offset:10240
    v_smfmac_f32_16x16x64_bf16 v[56:59], v[40:43], a[88:95], v2
    s_waitcnt lgkmcnt(4)
    ds_read_b128 v[136:139], v13 offset:11264
    v_smfmac_f32_16x16x64_bf16 v[56:59], v[44:47], v[148:155], v2
    s_waitcnt lgkmcnt(4)
    ds_read_b128 v[140:143], v13 offset:12288
    v_smfmac_f32_16x16x64_bf16 v[56:59], v[48:51], a[96:103], v2
    s_waitcnt lgkmcnt(4)
    ds_read_b128 v[144:147], v13 offset:13312
    v_smfmac_f32_16x16x64_bf16 v[56:59], v[52:55], a[104:111], v2
    ds_read_b128 v[148:151], v13 offset:14336
    v_smfmac_f32_16x16x64_bf16 v[60:63], v[28:31], a[112:119], v2
    s_waitcnt lgkmcnt(5)
    ds_read_b128 v[152:155], v13 offset:15360
    v_smfmac_f32_16x16x64_bf16 v[60:63], v[32:35], v[124:131], v2
    ds_read_b128 v[124:127], v13 offset:16384
    v_add_f32 v56, v56, v58
    v_smfmac_f32_16x16x64_bf16 v[60:63], v[36:39], a[120:127], v2
    ds_read_b128 v[128:131], v13 offset:17408
    v_add_f32 v57, v57, v59
    v_smfmac_f32_16x16x64_bf16 v[60:63], v[40:43], a[128:135], v2
    v_cvt_pk_bf16_f32 v56, v56, v57
    v_smfmac_f32_16x16x64_bf16 v[60:63], v[44:47], a[136:143], v2
    s_waitcnt lgkmcnt(6)
    ds_write_b16 v3, v56 offset:0
    v_smfmac_f32_16x16x64_bf16 v[60:63], v[48:51], v[132:139], v2
    ds_write_b16_d16_hi v3, v56 offset:400
    v_smfmac_f32_16x16x64_bf16 v[60:63], v[52:55], a[144:151], v2
    ds_read_b128 v[132:135], v13 offset:18432
    v_smfmac_f32_16x16x64_bf16 v[64:67], v[28:31], a[152:159], v2
    ds_read_b128 v[136:139], v13 offset:19456
    v_smfmac_f32_16x16x64_bf16 v[64:67], v[32:35], a[160:167], v2
    s_waitcnt lgkmcnt(8)
    v_add_f32 v60, v60, v62
    v_smfmac_f32_16x16x64_bf16 v[64:67], v[36:39], v[140:147], v2
    ds_read_b128 v[140:143], v13 offset:20480
    v_add_f32 v61, v61, v63
    v_smfmac_f32_16x16x64_bf16 v[64:67], v[40:43], a[168:175], v2
    ds_read_b128 v[144:147], v13 offset:21504
    v_cvt_pk_bf16_f32 v60, v60, v61
    v_smfmac_f32_16x16x64_bf16 v[64:67], v[44:47], a[176:183], v2
    ds_write_b16 v3, v60 offset:128
    v_smfmac_f32_16x16x64_bf16 v[64:67], v[48:51], a[184:191], v2
    s_waitcnt lgkmcnt(9)
    ds_write_b16_d16_hi v3, v60 offset:528
    v_smfmac_f32_16x16x64_bf16 v[64:67], v[52:55], v[148:155], v2
    ds_read_b128 v[148:151], v13 offset:22528
    v_smfmac_f32_16x16x64_bf16 v[68:71], v[28:31], a[192:199], v2
    ds_read_b128 v[152:155], v13 offset:23552
    v_smfmac_f32_16x16x64_bf16 v[68:71], v[32:35], a[200:207], v2
    v_add_f32 v64, v64, v66
    v_smfmac_f32_16x16x64_bf16 v[68:71], v[36:39], a[208:215], v2
    s_waitcnt lgkmcnt(10)
    v_add_f32 v65, v65, v67
    v_smfmac_f32_16x16x64_bf16 v[68:71], v[40:43], v[124:131], v2
    ds_read_b128 v[124:127], v13 offset:24576
    v_cvt_pk_bf16_f32 v64, v64, v65
    v_smfmac_f32_16x16x64_bf16 v[68:71], v[44:47], a[216:223], v2
    ds_write_b16 v3, v64 offset:256
    s_mov_b64 exec, 1
    buffer_store_dword v0, v8, s[8:11], s69 offen sc1
    s_mov_b64 exec, -1
    v_smfmac_f32_16x16x64_bf16 v[68:71], v[48:51], a[224:231], v2
    ds_write_b16_d16_hi v3, v64 offset:656
    v_smfmac_f32_16x16x64_bf16 v[68:71], v[52:55], a[232:239], v2
    s_waitcnt lgkmcnt(9)
    ds_read_b128 v[128:131], v13 offset:25600
    v_smfmac_f32_16x16x64_bf16 v[68:71], v[24:27], v[132:139], v2
    ds_read_b128 v[132:135], v13 offset:26624
    v_smfmac_f32_16x16x64_bf16 v[72:75], v[28:31], a[240:247], v2
    ds_read_b128 v[136:139], v13 offset:27648
    v_smfmac_f32_16x16x64_bf16 v[72:75], v[32:35], a[248:255], v2
    v_add_f32 v68, v68, v70
    v_smfmac_f32_16x16x64_bf16 v[72:75], v[36:39], v[156:163], v2
    s_waitcnt lgkmcnt(10)
    v_add_f32 v69, v69, v71
    v_smfmac_f32_16x16x64_bf16 v[72:75], v[40:43], v[140:147], v2
    ds_read_b128 v[140:143], v13 offset:28672
    v_cvt_pk_bf16_f32 v68, v68, v69
    v_smfmac_f32_16x16x64_bf16 v[72:75], v[44:47], v[164:171], v2
    s_waitcnt lgkmcnt(4)
    s_barrier
    v_smfmac_f32_16x16x64_bf16 v[72:75], v[48:51], v[172:179], v2
    ds_read_b128 v[88:91], v4 offset:0
    v_smfmac_f32_16x16x64_bf16 v[72:75], v[52:55], v[180:187], v2
    ds_read_b128 v[92:95], v4 offset:128
    v_smfmac_f32_16x16x64_bf16 v[72:75], v[16:19], v[148:155], v2
    ds_read_b128 v[96:99], v4 offset:256
    v_smfmac_f32_16x16x64_bf16 v[72:75], v[20:23], v[188:195], v2
    ds_write_b16 v3, v68 offset:3200
    v_smfmac_f32_16x16x64_bf16 v[72:75], v[24:27], v[196:203], v2
    s_waitcnt lgkmcnt(7)
    ds_write_b16_d16_hi v3, v68 offset:3600
    v_smfmac_f32_16x16x64_bf16 v[76:79], v[28:31], v[124:131], v2
    s_waitcnt lgkmcnt(4)
    ds_read_b128 v[144:147], v13 offset:29696
    v_smfmac_f32_16x16x64_bf16 v[80:83], v[88:91], v[100:107], v2
    s_waitcnt lgkmcnt(4)
    ds_read_b128 v[148:151], v13 offset:30720
    v_add_f32 v72, v72, v74
    v_smfmac_f32_16x16x64_bf16 v[80:83], v[92:95], v[108:115], v2
    s_waitcnt lgkmcnt(4)
    ds_read_b128 v[152:155], v13 offset:31744
    v_add_f32 v73, v73, v75
    v_smfmac_f32_16x16x64_bf16 v[80:83], v[96:99], v[116:123], v2
    v_cvt_pk_bf16_f32 v72, v72, v73
    v_smfmac_f32_16x16x64_bf16 v[76:79], v[32:35], v[204:211], v2
    ds_write_b16 v3, v72 offset:3328
    v_smfmac_f32_16x16x64_bf16 v[76:79], v[36:39], v[212:219], v2
    ds_write_b16_d16_hi v3, v72 offset:3728
    v_smfmac_f32_16x16x64_bf16 v[76:79], v[40:43], v[132:139], v2
    v_add_f32 v56, v80, v82
    v_smfmac_f32_16x16x64_bf16 v[76:79], v[44:47], v[220:227], v2
    v_mul_f32 v56, 0x3dd53b95, v56
    v_smfmac_f32_16x16x64_bf16 v[76:79], v[48:51], v[228:235], v2
    s_waitcnt lgkmcnt(4)
    v_max_f32_dpp v58, v56, v56 row_ror:8 row_mask:0xf bank_mask:0xf
    v_smfmac_f32_16x16x64_bf16 v[76:79], v[52:55], v[140:147], v2
    s_waitcnt lgkmcnt(0)
    s_barrier
    v_max_f32_dpp v58, v58, v58 row_ror:4 row_mask:0xf bank_mask:0xf
    v_smfmac_f32_16x16x64_bf16 v[76:79], v[16:19], v[236:243], v2
    ds_read_b128 v[100:103], v5 offset:0
    v_max_f32_dpp v58, v58, v58 row_ror:2 row_mask:0xf bank_mask:0xf
    v_smfmac_f32_16x16x64_bf16 v[76:79], v[20:23], v[148:155], v2
    ds_read_b128 v[104:107], v5 offset:16
    v_max_f32_dpp v58, v58, v58 row_ror:1 row_mask:0xf bank_mask:0xf
    v_smfmac_f32_16x16x64_bf16 v[76:79], v[24:27], v[244:251], v2
    ds_read_b128 v[108:111], v5 offset:128
    v_sub_f32 v60, v56, v58
    ds_read_b128 v[112:115], v5 offset:144
    v_exp_f32 v60, v60
    s_nop 1
    v_add_f32_dpp v59, v60, v60 row_ror:8 row_mask:0xf bank_mask:0xf
    s_nop 1
    v_add_f32_dpp v59, v59, v59 row_ror:4 row_mask:0xf bank_mask:0xf
    s_nop 1
    v_add_f32_dpp v59, v59, v59 row_ror:2 row_mask:0xf bank_mask:0xf
    s_nop 1
    v_add_f32_dpp v59, v59, v59 row_ror:1 row_mask:0xf bank_mask:0xf
    v_add_f32 v76, v76, v78
    v_add_f32 v77, v77, v79
    v_cvt_pk_bf16_f32 v76, v76, v77
    ds_write_b16 v3, v76 offset:3456
    ds_write_b16_d16_hi v3, v76 offset:3856
    ds_write_b64 v6, v[58:59] offset:0
    s_waitcnt lgkmcnt(5)
    v_smfmac_f32_16x16x64_bf16 v[84:87], v[88:91], v[100:107], v2
    s_waitcnt lgkmcnt(3)
    v_smfmac_f32_16x16x64_bf16 v[84:87], v[92:95], v[108:115], v2
    s_waitcnt lgkmcnt(0)
    s_barrier
    ds_read_b128 v[116:119], v5 offset:256
    ds_read_b128 v[120:123], v5 offset:272
    ds_read_b64 v[16:17], v6 offset:512
    s_waitcnt lgkmcnt(1)
    v_smfmac_f32_16x16x64_bf16 v[84:87], v[96:99], v[116:123], v2
    s_waitcnt lgkmcnt(0)
    v_max_f32 v18, v58, v16
    v_sub_f32 v19, v58, v18
    v_sub_f32 v20, v16, v18
    v_exp_f32 v19, v19
    v_exp_f32 v20, v20
    s_nop 0
    v_mul_f32 v21, v59, v19
    v_mul_f32 v60, v60, v19
    v_fmac_f32 v21, v17, v20
    v_add_f32 v22, v84, v86
    v_mul_f32 v22, 0x3dd53b95, v22
    v_max_f32 v23, v22, v18
    s_nop 0
    v_max_f32_dpp v24, v22, v23 row_ror:4 row_mask:0xf bank_mask:0xf
    s_nop 1
    v_max_f32_dpp v24, v24, v24 row_ror:2 row_mask:0xf bank_mask:0xf
    s_nop 1
    v_max_f32_dpp v24, v24, v24 row_ror:1 row_mask:0xf bank_mask:0xf
    v_sub_f32 v25, v22, v24
    v_sub_f32 v26, v18, v24
    v_exp_f32 v25, v25
    v_exp_f32 v26, v26
    s_nop 0
    v_add_f32_dpp v23, v25, v25 row_ror:4 row_mask:0xf bank_mask:0xf
    v_mul_f32 v60, v60, v26
    s_nop 0
    v_add_f32_dpp v23, v23, v23 row_ror:2 row_mask:0xf bank_mask:0xf
    s_nop 1
    v_add_f32_dpp v23, v23, v23 row_ror:1 row_mask:0xf bank_mask:0xf
    v_fmac_f32 v23, v26, v21
    v_rcp_f32 v27, v23
    s_nop 0
    v_mul_f32 v60, v60, v27
    v_mul_f32 v25, v25, v27
    s_nop 0
    v_mov_b32_dpp v19, v60 quad_perm:[1,0,3,2] row_mask:0xf bank_mask:0xf
    v_mov_b32_dpp v20, v25 quad_perm:[1,0,3,2] row_mask:0xf bank_mask:0xf
    v_cvt_pk_bf16_f32 v28, v60, v19
    v_cvt_pk_bf16_f32 v25, v25, v20
    s_nop 0
    v_mov_b32_dpp v29, v28 row_shl:2 row_mask:0xf bank_mask:0xf
    v_mov_b32_dpp v30, v28 row_shl:4 row_mask:0xf bank_mask:0xf
    v_mov_b32_dpp v31, v28 row_shl:6 row_mask:0xf bank_mask:0xf
    v_mov_b32_dpp v28, v25 row_shr:4 row_mask:0xf bank_mask:0x2
    v_mov_b32_dpp v29, v25 row_shr:2 row_mask:0xf bank_mask:0x2
    v_mov_b32_dpp v30, v25 quad_perm:[0,1,2,3] row_mask:0xf bank_mask:0x2
    v_mov_b32_dpp v31, v25 row_shl:2 row_mask:0xf bank_mask:0x2
    s_mov_b32 exec_lo, 0x1110111
    s_mov_b32 exec_hi, 0x1010101
    buffer_store_dwordx4 v[28:31], v7, s[8:11], s18 offen sc1
    s_mov_b64 exec, -1
    ds_read_b128 v[40:43], v10
    s_add_u32 s28, s14, 1
    s_min_u32 s28, s28, 63
    s_cmp_gt_u32 s47, s28
    s_cbranch_scc1 layerb1_kernel_p0_gw2_ok
layerb1_kernel_p0_gw2_lp:
    buffer_load_dword v253, v255, s[8:11], s48 offen sc1
    s_waitcnt vmcnt(0)
    v_readlane_b32 s47, v253, 0
    v_readlane_b32 s29, v253, 1
    s_nop 0
    s_min_u32 s47, s47, s29
    s_sub_u32 s15, s15, 1
    s_cbranch_scc1 layerb1_kernel_bail
    s_cmp_gt_u32 s47, s28
    s_cbranch_scc0 layerb1_kernel_p0_gw2_lp
layerb1_kernel_p0_gw2_ok:
    s_mul_i32 s20, s28, 393216
    s_add_u32 s20, s20, s44
    s_add_u32 s21, s20, 0
    buffer_load_dwordx4 v[100:103], v9, s[8:11], s21 offen offset:0 sc1
    buffer_load_dwordx4 v[104:107], v9, s[8:11], s21 offen offset:512 sc1
    s_add_u32 s21, s20, 4096
    buffer_load_dwordx4 v[108:111], v9, s[8:11], s21 offen offset:0 sc1
    buffer_load_dwordx4 v[112:115], v9, s[8:11], s21 offen offset:512 sc1
    s_add_u32 s21, s20, 8192
    buffer_load_dwordx4 v[116:119], v9, s[8:11], s21 offen offset:0 sc1
    buffer_load_dwordx4 v[120:123], v9, s[8:11], s21 offen offset:512 sc1
    v_mov_b32 v56, 0
    v_mov_b32 v57, 0
    v_mov_b32 v58, 0
    v_mov_b32 v59, 0
    v_mov_b32 v60, 0
    v_mov_b32 v61, 0
    v_mov_b32 v62, 0
    v_mov_b32 v63, 0
    v_mov_b32 v64, 0
    v_mov_b32 v65, 0
    v_mov_b32 v66, 0
    v_mov_b32 v67, 0
    v_mov_b32 v68, 0
    v_mov_b32 v69, 0
    v_mov_b32 v70, 0
    v_mov_b32 v71, 0
    v_mov_b32 v72, 0
    v_mov_b32 v73, 0
    v_mov_b32 v74, 0
    v_mov_b32 v75, 0
    v_mov_b32 v76, 0
    v_mov_b32 v77, 0
    v_mov_b32 v78, 0
    v_mov_b32 v79, 0
    v_mov_b32 v80, 0
    v_mov_b32 v81, 0
    v_mov_b32 v82, 0
    v_mov_b32 v83, 0
    v_mov_b32 v84, 0
    v_mov_b32 v85, 0
    v_mov_b32 v86, 0
    v_mov_b32 v87, 0
    s_waitcnt lgkmcnt(0)
    s_mul_i32 s20, s14, 98304
    s_add_u32 s20, s20, s45
    buffer_store_dwordx4 v[40:43], v11, s[8:11], s20 offen sc1
    ds_read_b128 v[124:127], v13 offset:0
    ds_read_b128 v[128:131], v13 offset:1024
    ds_read_b128 v[132:135], v13 offset:2048
    ds_read_b128 v[136:139], v13 offset:3072
    ds_read_b128 v[140:143], v13 offset:4096
    ds_read_b128 v[144:147], v13 offset:5120
    ds_read_b128 v[148:151], v13 offset:6144
    ds_read_b128 v[152:155], v13 offset:7168
    s_waitcnt lgkmcnt(0)
    s_add_u32 s14, s14, 1
    s_cmp_lt_u32 s14, 64
    s_cbranch_scc1 layerb1_kernel_p0_step
    s_waitcnt vmcnt(0)
    s_barrier
    s_branch layerb1_kernel_end
layerb1_kernel_p1_start:
    v_lshrrev_b32 v16, 4, v0
    v_and_b32 v17, 15, v0
    v_and_b32 v18, 2, v0
    v_cmp_eq_u32 vcc, 0, v18
    v_mov_b32 v18, 0xeeeeeeee
    v_mov_b32 v19, 0x44444444
    v_cndmask_b32 v2, v18, v19, vcc
    v_lshrrev_b32 v20, 2, v17
    v_lshlrev_b32 v20, 1, v20
    v_and_b32 v21, 1, v17
    v_add_u32 v20, v20, v21
    v_bfe_u32 v21, v17, 1, 1
    v_lshl_add_u32 v18, v16, 1, v21
    v_lshlrev_b32 v18, 7, v18
    v_lshl_add_u32 v12, v20, 4, v18
    v_mul_u32_u24 v18, 400, v20
    v_lshl_add_u32 v18, v16, 5, v18
    v_lshl_add_u32 v18, v21, 4, v18
    v_add_u32 v4, 141312, v18
    v_mul_u32_u24 v18, 800, v16
    v_lshl_add_u32 v18, v17, 1, v18
    v_add_u32 v3, 141344, v18
    v_and_b32 v18, 7, v0
    v_mul_u32_u24 v18, 400, v18
    v_lshl_add_u32 v18, v16, 5, v18
    v_add_u32 v5, 144512, v18
    v_lshlrev_b32 v18, 3, v0
    v_add_u32 v6, 147712, v18
    v_lshlrev_b32 v18, 4, v16
    v_bfe_u32 v19, v17, 1, 2
    v_lshl_add_u32 v18, v19, 2, v18
    s_lshl_b32 s20, s12, 7
    s_add_u32 s20, s20, 0
    v_add_u32 v18, s20, v18
    v_lshrrev_b32 v19, 3, v17
    v_add_u32 v19, 3, v19
    v_lshrrev_b32 v20, 1, v19
    v_lshlrev_b32 v20, 14, v20
    v_and_b32 v19, 1, v19
    v_lshl_add_u32 v19, v19, 12, v20
    v_add_u32 v19, v19, v18
    v_mov_b32 v20, 0x7ffffff0
    v_and_b32 v21, 7, v0
    v_cmp_eq_u32 vcc, 4, v21
    v_subrev_u32 v21, 8, v18
    s_nop 0
    v_cndmask_b32 v7, v19, v21, vcc
    v_and_b32 v21, 0x29, v0
    v_cmp_eq_u32 vcc, 32, v21
    s_nop 1
    v_cndmask_b32 v8, v20, v18, vcc
    s_lshl_b32 s20, s12, 2
    v_lshlrev_b32 v18, 7, v0
    v_add_u32 v8, s20, v18
    v_lshlrev_b32 v18, 4, v17
    v_lshl_add_u32 v18, v16, 10, v18
    v_add_u32 v9, 256, v18
    v_add_u32 v18, 64, v0
    v_mul_u32_u24 v19, 2731, v18
    v_lshrrev_b32 v19, 16, v19
    v_mul_u32_u24 v20, 24, v19
    v_sub_u32 v20, v18, v20
    v_mul_u32_u24 v21, 400, v19
    v_lshl_add_u32 v21, v20, 4, v21
    v_add_u32 v10, 144512, v21
    v_lshlrev_b32 v21, 4, v19
    v_lshl_add_u32 v11, v20, 7, v21
    v_add_u32 v13, 32768, v1
    v_add_u32 v14, 131072, v1
    s_mul_i32 s44, s12, 12288
    s_add_u32 s44, s44, 53477376
    s_mul_i32 s45, s12, 3072
    s_add_u32 s45, s45, 208666624
    s_mul_i32 s20, s12, 6
    s_add_u32 s21, s20, 5
    s_lshr_b32 s20, s20, 3
    s_lshr_b32 s21, s21, 3
    s_add_u32 s20, s20, 80
    s_add_u32 s21, s21, 80
    s_lshl_b32 s20, s20, 7
    s_lshl_b32 s21, s21, 7
    v_mov_b32 v255, s21
    v_mov_b32 v253, s20
    v_cmp_eq_u32 vcc, 0, v0
    s_nop 1
    v_cndmask_b32 v255, v255, v253, vcc
    s_mov_b32 s47, 0
    s_mul_i32 s20, s12, 491520
    s_add_u32 s20, s20, 11657216
    s_add_u32 s21, s20, 8192
    buffer_load_dwordx4 v[16:19], v1, s[8:11], s21 offen offset:0
    buffer_load_dwordx4 v[20:23], v1, s[8:11], s21 offen offset:1024
    s_add_u32 s21, s20, 30720
    buffer_load_dwordx4 v[24:27], v1, s[8:11], s21 offen offset:0
    buffer_load_dwordx4 v[28:31], v1, s[8:11], s21 offen offset:1024
    s_add_u32 s21, s20, 0
    buffer_load_dwordx4 v[32:35], v1, s[8:11], s21 offen offset:0
    buffer_load_dwordx4 v[36:39], v1, s[8:11], s21 offen offset:1024
    s_add_u32 s21, s20, 14336
    buffer_load_dwordx4 v[40:43], v1, s[8:11], s21 offen offset:0
    buffer_load_dwordx4 v[44:47], v1, s[8:11], s21 offen offset:1024
    s_add_u32 s21, s20, 22528
    buffer_load_dwordx4 v[48:51], v1, s[8:11], s21 offen offset:0
    buffer_load_dwordx4 v[52:55], v1, s[8:11], s21 offen offset:1024
    s_add_u32 s21, s20, 36864
    buffer_load_dwordx4 v[56:59], v1, s[8:11], s21 offen offset:0
    buffer_load_dwordx4 v[60:63], v1, s[8:11], s21 offen offset:1024
    s_add_u32 s21, s20, 45056
    buffer_load_dwordx4 v[64:67], v1, s[8:11], s21 offen offset:0
    buffer_load_dwordx4 v[68:71], v1, s[8:11], s21 offen offset:1024
    s_add_u32 s21, s20, 59392
    buffer_load_dwordx4 v[72:75], v1, s[8:11], s21 offen offset:0
    buffer_load_dwordx4 v[76:79], v1, s[8:11], s21 offen offset:1024
    s_add_u32 s21, s20, 73728
    buffer_load_dwordx4 v[80:83], v1, s[8:11], s21 offen offset:0
    buffer_load_dwordx4 v[84:87], v1, s[8:11], s21 offen offset:1024
    s_add_u32 s21, s20, 71680
    buffer_load_dwordx4 v[88:91], v1, s[8:11], s21 offen offset:0
    buffer_load_dwordx4 v[92:95], v1, s[8:11], s21 offen offset:1024
    s_add_u32 s21, s20, 94208
    buffer_load_dwordx4 v[96:99], v1, s[8:11], s21 offen offset:0
    buffer_load_dwordx4 v[100:103], v1, s[8:11], s21 offen offset:1024
    s_add_u32 s21, s20, 88064
    buffer_load_dwordx4 v[104:107], v1, s[8:11], s21 offen offset:0
    buffer_load_dwordx4 v[108:111], v1, s[8:11], s21 offen offset:1024
    s_add_u32 s21, s20, 102400
    buffer_load_dwordx4 v[112:115], v1, s[8:11], s21 offen offset:0
    buffer_load_dwordx4 v[116:119], v1, s[8:11], s21 offen offset:1024
    s_add_u32 s21, s20, 114688
    buffer_load_dwordx4 v[120:123], v1, s[8:11], s21 offen offset:0
    buffer_load_dwordx4 v[124:127], v1, s[8:11], s21 offen offset:1024
    s_add_u32 s21, s20, 120832
    buffer_load_dwordx4 v[128:131], v1, s[8:11], s21 offen offset:0
    buffer_load_dwordx4 v[132:135], v1, s[8:11], s21 offen offset:1024
    s_add_u32 s21, s20, 110592
    buffer_load_dwordx4 v[136:139], v1, s[8:11], s21 offen offset:0
    buffer_load_dwordx4 v[140:143], v1, s[8:11], s21 offen offset:1024
    s_add_u32 s21, s20, 86016
    buffer_load_dwordx4 v[156:159], v1, s[8:11], s21 offen offset:0
    buffer_load_dwordx4 v[160:163], v1, s[8:11], s21 offen offset:1024
    s_add_u32 s21, s20, 96256
    buffer_load_dwordx4 v[164:167], v1, s[8:11], s21 offen offset:0
    buffer_load_dwordx4 v[168:171], v1, s[8:11], s21 offen offset:1024
    s_add_u32 s21, s20, 98304
    buffer_load_dwordx4 v[172:175], v1, s[8:11], s21 offen offset:0
    buffer_load_dwordx4 v[176:179], v1, s[8:11], s21 offen offset:1024
    s_add_u32 s21, s20, 100352
    buffer_load_dwordx4 v[180:183], v1, s[8:11], s21 offen offset:0
    buffer_load_dwordx4 v[184:187], v1, s[8:11], s21 offen offset:1024
    s_add_u32 s21, s20, 90112
    buffer_load_dwordx4 v[188:191], v1, s[8:11], s21 offen offset:0
    buffer_load_dwordx4 v[192:195], v1, s[8:11], s21 offen offset:1024
    s_add_u32 s21, s20, 92160
    buffer_load_dwordx4 v[196:199], v1, s[8:11], s21 offen offset:0
    buffer_load_dwordx4 v[200:203], v1, s[8:11], s21 offen offset:1024
    s_add_u32 s21, s20, 104448
    buffer_load_dwordx4 v[204:207], v1, s[8:11], s21 offen offset:0
    buffer_load_dwordx4 v[208:211], v1, s[8:11], s21 offen offset:1024
    s_add_u32 s21, s20, 106496
    buffer_load_dwordx4 v[212:215], v1, s[8:11], s21 offen offset:0
    buffer_load_dwordx4 v[216:219], v1, s[8:11], s21 offen offset:1024
    s_add_u32 s21, s20, 116736
    buffer_load_dwordx4 v[220:223], v1, s[8:11], s21 offen offset:0
    buffer_load_dwordx4 v[224:227], v1, s[8:11], s21 offen offset:1024
    s_add_u32 s21, s20, 118784
    buffer_load_dwordx4 v[228:231], v1, s[8:11], s21 offen offset:0
    buffer_load_dwordx4 v[232:235], v1, s[8:11], s21 offen offset:1024
    s_add_u32 s21, s20, 108544
    buffer_load_dwordx4 v[236:239], v1, s[8:11], s21 offen offset:0
    buffer_load_dwordx4 v[240:243], v1, s[8:11], s21 offen offset:1024
    s_add_u32 s21, s20, 112640
    buffer_load_dwordx4 v[244:247], v1, s[8:11], s21 offen offset:0
    buffer_load_dwordx4 v[248:251], v1, s[8:11], s21 offen offset:1024
    s_waitcnt vmcnt(24)
    ds_write_b128 v13, v[16:19] offset:0
    ds_write_b128 v13, v[20:23] offset:1024
    ds_write_b128 v13, v[24:27] offset:2048
    ds_write_b128 v13, v[28:31] offset:3072
    ds_write_b128 v13, v[32:35] offset:4096
    ds_write_b128 v13, v[36:39] offset:5120
    ds_write_b128 v13, v[40:43] offset:6144
    ds_write_b128 v13, v[44:47] offset:7168
    ds_write_b128 v13, v[48:51] offset:8192
    ds_write_b128 v13, v[52:55] offset:9216
    ds_write_b128 v13, v[56:59] offset:10240
    ds_write_b128 v13, v[60:63] offset:11264
    ds_write_b128 v13, v[64:67] offset:12288
    ds_write_b128 v13, v[68:71] offset:13312
    ds_write_b128 v13, v[72:75] offset:14336
    ds_write_b128 v13, v[76:79] offset:15360
    ds_write_b128 v13, v[80:83] offset:16384
    ds_write_b128 v13, v[84:87] offset:17408
    ds_write_b128 v13, v[88:91] offset:18432
    ds_write_b128 v13, v[92:95] offset:19456
    ds_write_b128 v13, v[96:99] offset:20480
    ds_write_b128 v13, v[100:103] offset:21504
    ds_write_b128 v13, v[104:107] offset:22528
    ds_write_b128 v13, v[108:111] offset:23552
    ds_write_b128 v13, v[112:115] offset:24576
    ds_write_b128 v13, v[116:119] offset:25600
    ds_write_b128 v13, v[120:123] offset:26624
    ds_write_b128 v13, v[124:127] offset:27648
    ds_write_b128 v13, v[128:131] offset:28672
    ds_write_b128 v13, v[132:135] offset:29696
    ds_write_b128 v13, v[136:139] offset:30720
    ds_write_b128 v13, v[140:143] offset:31744
    s_waitcnt lgkmcnt(0)
    s_add_u32 s20, s48, 51200
    s_mov_b64 exec, 3
    v_lshlrev_b32 v16, 2, v0
layerb1_kernel_p1_par:
    buffer_load_dword v17, v16, s[8:11], s20 offen sc1
    s_waitcnt vmcnt(0)
    v_cmp_eq_u32 vcc, 0, v17
    s_sub_u32 s15, s15, 1
    s_cbranch_scc1 layerb1_kernel_bail
    s_cbranch_vccnz layerb1_kernel_p1_par
    s_mov_b64 exec, -1
    v_readlane_b32 s20, v17, 0
    v_readlane_b32 s21, v17, 1
    s_nop 0
    s_and_b32 s20, s20, 8192
    s_and_b32 s21, s21, 8192
    s_add_u32 s16, s16, s20
    s_add_u32 s17, s17, s21
    s_mov_b32 s14, 0
    s_cmp_gt_u32 s47, s14
    s_cbranch_scc1 layerb1_kernel_p1_gw1_ok
layerb1_kernel_p1_gw1_lp:
    buffer_load_dword v253, v255, s[8:11], s48 offen sc1
    s_waitcnt vmcnt(0)
    v_readlane_b32 s47, v253, 0
    v_readlane_b32 s29, v253, 1
    s_nop 0
    s_min_u32 s47, s47, s29
    s_sub_u32 s15, s15, 1
    s_cbranch_scc1 layerb1_kernel_bail
    s_cmp_gt_u32 s47, s14
    s_cbranch_scc0 layerb1_kernel_p1_gw1_lp
layerb1_kernel_p1_gw1_ok:
    s_mul_i32 s20, s14, 393216
    s_add_u32 s20, s20, s44
    s_add_u32 s21, s20, 0
    buffer_load_dwordx4 v[100:103], v9, s[8:11], s21 offen offset:0 sc1
    buffer_load_dwordx4 v[104:107], v9, s[8:11], s21 offen offset:512 sc1
    s_add_u32 s21, s20, 4096
    buffer_load_dwordx4 v[108:111], v9, s[8:11], s21 offen offset:0 sc1
    buffer_load_dwordx4 v[112:115], v9, s[8:11], s21 offen offset:512 sc1
    s_add_u32 s21, s20, 8192
    buffer_load_dwordx4 v[116:119], v9, s[8:11], s21 offen offset:0 sc1
    buffer_load_dwordx4 v[120:123], v9, s[8:11], s21 offen offset:512 sc1
    v_mov_b32 v56, 0
    v_mov_b32 v57, 0
    v_mov_b32 v58, 0
    v_mov_b32 v59, 0
    v_mov_b32 v60, 0
    v_mov_b32 v61, 0
    v_mov_b32 v62, 0
    v_mov_b32 v63, 0
    v_mov_b32 v64, 0
    v_mov_b32 v65, 0
    v_mov_b32 v66, 0
    v_mov_b32 v67, 0
    v_mov_b32 v68, 0
    v_mov_b32 v69, 0
    v_mov_b32 v70, 0
    v_mov_b32 v71, 0
    v_mov_b32 v72, 0
    v_mov_b32 v73, 0
    v_mov_b32 v74, 0
    v_mov_b32 v75, 0
    v_mov_b32 v76, 0
    v_mov_b32 v77, 0
    v_mov_b32 v78, 0
    v_mov_b32 v79, 0
    v_mov_b32 v80, 0
    v_mov_b32 v81, 0
    v_mov_b32 v82, 0
    v_mov_b32 v83, 0
    v_mov_b32 v84, 0
    v_mov_b32 v85, 0
    v_mov_b32 v86, 0
    v_mov_b32 v87, 0
    ds_read_b128 v[124:127], v13 offset:0
    ds_read_b128 v[128:131], v13 offset:1024
    ds_read_b128 v[132:135], v13 offset:2048
    ds_read_b128 v[136:139], v13 offset:3072
    ds_read_b128 v[140:143], v13 offset:4096
    ds_read_b128 v[144:147], v13 offset:5120
    ds_read_b128 v[148:151], v13 offset:6144
    ds_read_b128 v[152:155], v13 offset:7168
    s_waitcnt lgkmcnt(0)
layerb1_kernel_p1_step:
    s_cmp_lt_u32 s14, 32
    s_cselect_b32 s18, s16, s17
    s_and_b32 s20, s14, 31
    s_lshl_b32 s20, s20, 16
    s_add_u32 s18, s18, s20
    s_add_u32 s69, s18, 55424
    s_add_u32 s22, s18, 39936
    s_add_u32 s23, s18, 49152
    s_add_u32 s24, s18, 50176
layerb1_kernel_p1_poll:
    buffer_load_dwordx4 v[28:31], v12, s[8:11], s22 offen sc1
    buffer_load_dwordx4 v[32:35], v12, s[8:11], s23 offen sc1
    buffer_load_dwordx4 v[36:39], v12, s[8:11], s24 offen sc1
    s_waitcnt vmcnt(0)
    ds_write_b128 v14, v[28:31] offset:3072
    ds_write_b128 v14, v[32:35] offset:4096
    ds_write_b128 v14, v[36:39] offset:5120
    v_max3_u32 v88, v28, v29, v30
    v_max3_u32 v88, v88, v31, v32
    v_max3_u32 v88, v88, v33, v34
    v_max3_u32 v88, v88, v35, v36
    v_max3_u32 v88, v88, v37, v38
    v_max_u32 v88, v88, v39
    v_cmp_eq_u32 vcc, -1, v88
    s_sub_u32 s15, s15, 1
    s_cbranch_scc1 layerb1_kernel_bail
    s_cbranch_vccnz layerb1_kernel_p1_poll
    v_smfmac_f32_16x16x64_bf16 v[56:59], v[28:31], a[0:7], v2
    v_smfmac_f32_16x16x64_bf16 v[60:63], v[28:31], a[8:15], v2
    v_smfmac_f32_16x16x64_bf16 v[64:67], v[28:31], a[16:23], v2
    v_smfmac_f32_16x16x64_bf16 v[56:59], v[32:35], v[124:131], v2
    ds_read_b128 v[124:127], v13 offset:8192
    v_smfmac_f32_16x16x64_bf16 v[60:63], v[32:35], a[24:31], v2
    s_waitcnt lgkmcnt(1)
    s_barrier
    v_smfmac_f32_16x16x64_bf16 v[64:67], v[32:35], a[32:39], v2
    ds_read_b128 v[16:19], v14 offset:0
    v_smfmac_f32_16x16x64_bf16 v[56:59], v[36:39], a[40:47], v2
    ds_read_b128 v[20:23], v14 offset:1024
    v_smfmac_f32_16x16x64_bf16 v[60:63], v[36:39], v[132:139], v2
    ds_read_b128 v[24:27], v14 offset:2048
    v_smfmac_f32_16x16x64_bf16 v[64:67], v[36:39], a[48:55], v2
    ds_read_b128 v[40:43], v14 offset:6144
    v_smfmac_f32_16x16x64_bf16 v[68:71], v[28:31], a[56:63], v2
    ds_read_b128 v[44:47], v14 offset:7168
    v_smfmac_f32_16x16x64_bf16 v[68:71], v[32:35], a[64:71], v2
    s_waitcnt lgkmcnt(4)
    ds_read_b128 v[48:51], v14 offset:8192
    v_smfmac_f32_16x16x64_bf16 v[56:59], v[16:19], v[140:147], v2
    s_waitcnt lgkmcnt(4)
    ds_read_b128 v[52:55], v14 offset:9216
    v_smfmac_f32_16x16x64_bf16 v[56:59], v[20:23], a[72:79], v2
    s_waitcnt lgkmcnt(4)
    ds_read_b128 v[128:131], v13 offset:9216
    v_smfmac_f32_16x16x64_bf16 v[56:59], v[24:27], a[80:87], v2
    s_waitcnt lgkmcnt(4)
    ds_read_b128 v[132:135], v13 offset:10240
    v_smfmac_f32_16x16x64_bf16 v[56:59], v[40:43], a[88:95], v2
    s_waitcnt lgkmcnt(4)
    ds_read_b128 v[136:139], v13 offset:11264
    v_smfmac_f32_16x16x64_bf16 v[56:59], v[44:47], v[148:155], v2
    s_waitcnt lgkmcnt(4)
    ds_read_b128 v[140:143], v13 offset:12288
    v_smfmac_f32_16x16x64_bf16 v[56:59], v[48:51], a[96:103], v2
    s_waitcnt lgkmcnt(4)
    ds_read_b128 v[144:147], v13 offset:13312
    v_smfmac_f32_16x16x64_bf16 v[56:59], v[52:55], a[104:111], v2
    ds_read_b128 v[148:151], v13 offset:14336
    v_smfmac_f32_16x16x64_bf16 v[60:63], v[16:19], a[112:119], v2
    s_waitcnt lgkmcnt(5)
    ds_read_b128 v[152:155], v13 offset:15360
    v_smfmac_f32_16x16x64_bf16 v[60:63], v[20:23], v[124:131], v2
    ds_read_b128 v[124:127], v13 offset:16384
    v_add_f32 v56, v56, v58
    v_smfmac_f32_16x16x64_bf16 v[60:63], v[24:27], a[120:127], v2
    ds_read_b128 v[128:131], v13 offset:17408
    v_add_f32 v57, v57, v59
    v_smfmac_f32_16x16x64_bf16 v[60:63], v[40:43], a[128:135], v2
    v_cvt_pk_bf16_f32 v56, v56, v57
    v_smfmac_f32_16x16x64_bf16 v[60:63], v[44:47], a[136:143], v2
    s_waitcnt lgkmcnt(6)
    ds_write_b16 v3, v56 offset:0
    v_smfmac_f32_16x16x64_bf16 v[60:63], v[48:51], v[132:139], v2
    ds_write_b16_d16_hi v3, v56 offset:400
    v_smfmac_f32_16x16x64_bf16 v[60:63], v[52:55], a[144:151], v2
    ds_read_b128 v[132:135], v13 offset:18432
    v_smfmac_f32_16x16x64_bf16 v[64:67], v[16:19], a[152:159], v2
    ds_read_b128 v[136:139], v13 offset:19456
    v_smfmac_f32_16x16x64_bf16 v[64:67], v[20:23], a[160:167], v2
    s_waitcnt lgkmcnt(8)
    v_add_f32 v60, v60, v62
    v_smfmac_f32_16x16x64_bf16 v[64:67], v[24:27], v[140:147], v2
    ds_read_b128 v[140:143], v13 offset:20480
    v_add_f32 v61, v61, v63
    v_smfmac_f32_16x16x64_bf16 v[64:67], v[40:43], a[168:175], v2
    ds_read_b128 v[144:147], v13 offset:21504
    v_cvt_pk_bf16_f32 v60, v60, v61
    v_smfmac_f32_16x16x64_bf16 v[64:67], v[44:47], a[176:183], v2
    ds_write_b16 v3, v60 offset:128
    v_smfmac_f32_16x16x64_bf16 v[64:67], v[48:51], a[184:191], v2
    s_waitcnt lgkmcnt(9)
    ds_write_b16_d16_hi v3, v60 offset:528
    v_smfmac_f32_16x16x64_bf16 v[64:67], v[52:55], v[148:155], v2
    ds_read_b128 v[148:151], v13 offset:22528
    v_smfmac_f32_16x16x64_bf16 v[68:71], v[16:19], a[192:199], v2
    ds_read_b128 v[152:155], v13 offset:23552
    v_smfmac_f32_16x16x64_bf16 v[68:71], v[20:23], a[200:207], v2
    v_add_f32 v64, v64, v66
    v_smfmac_f32_16x16x64_bf16 v[68:71], v[24:27], a[208:215], v2
    s_waitcnt lgkmcnt(10)
    v_add_f32 v65, v65, v67
    v_smfmac_f32_16x16x64_bf16 v[68:71], v[40:43], v[124:131], v2
    ds_read_b128 v[124:127], v13 offset:24576
    v_cvt_pk_bf16_f32 v64, v64, v65
    v_smfmac_f32_16x16x64_bf16 v[68:71], v[44:47], a[216:223], v2
    ds_write_b16 v3, v64 offset:256
    v_smfmac_f32_16x16x64_bf16 v[68:71], v[48:51], a[224:231], v2
    ds_write_b16_d16_hi v3, v64 offset:656
    v_smfmac_f32_16x16x64_bf16 v[68:71], v[52:55], a[232:239], v2
    s_waitcnt lgkmcnt(9)
    ds_read_b128 v[128:131], v13 offset:25600
    v_smfmac_f32_16x16x64_bf16 v[68:71], v[36:39], v[132:139], v2
    ds_read_b128 v[132:135], v13 offset:26624
    v_smfmac_f32_16x16x64_bf16 v[72:75], v[16:19], a[240:247], v2
    ds_read_b128 v[136:139], v13 offset:27648
    v_smfmac_f32_16x16x64_bf16 v[72:75], v[20:23], a[248:255], v2
    v_add_f32 v68, v68, v70
    v_smfmac_f32_16x16x64_bf16 v[72:75], v[24:27], v[156:163], v2
    s_waitcnt lgkmcnt(10)
    v_add_f32 v69, v69, v71
    v_smfmac_f32_16x16x64_bf16 v[72:75], v[40:43], v[140:147], v2
    ds_read_b128 v[140:143], v13 offset:28672
    v_cvt_pk_bf16_f32 v68, v68, v69
    v_smfmac_f32_16x16x64_bf16 v[72:75], v[44:47], v[164:171], v2
    s_waitcnt lgkmcnt(4)
    s_barrier
    v_smfmac_f32_16x16x64_bf16 v[72:75], v[48:51], v[172:179], v2
    ds_read_b128 v[88:91], v4 offset:0
    v_smfmac_f32_16x16x64_bf16 v[72:75], v[52:55], v[180:187], v2
    ds_read_b128 v[92:95], v4 offset:128
    v_smfmac_f32_16x16x64_bf16 v[72:75], v[28:31], v[148:155], v2
    ds_read_b128 v[96:99], v4 offset:256
    v_smfmac_f32_16x16x64_bf16 v[72:75], v[32:35], v[188:195], v2
    ds_write_b16 v3, v68 offset:3200
    v_smfmac_f32_16x16x64_bf16 v[72:75], v[36:39], v[196:203], v2
    s_waitcnt lgkmcnt(7)
    ds_write_b16_d16_hi v3, v68 offset:3600
    v_smfmac_f32_16x16x64_bf16 v[76:79], v[16:19], v[124:131], v2
    s_waitcnt lgkmcnt(4)
    ds_read_b128 v[144:147], v13 offset:29696
    v_smfmac_f32_16x16x64_bf16 v[80:83], v[88:91], v[100:107], v2
    s_waitcnt lgkmcnt(4)
    ds_read_b128 v[148:151], v13 offset:30720
    v_add_f32 v72, v72, v74
    v_smfmac_f32_16x16x64_bf16 v[80:83], v[92:95], v[108:115], v2
    s_waitcnt lgkmcnt(4)
    ds_read_b128 v[152:155], v13 offset:31744
    v_add_f32 v73, v73, v75
    v_smfmac_f32_16x16x64_bf16 v[80:83], v[96:99], v[116:123], v2
    v_cvt_pk_bf16_f32 v72, v72, v73
    v_smfmac_f32_16x16x64_bf16 v[76:79], v[20:23], v[204:211], v2
    ds_write_b16 v3, v72 offset:3328
    v_smfmac_f32_16x16x64_bf16 v[76:79], v[24:27], v[212:219], v2
    ds_write_b16_d16_hi v3, v72 offset:3728
    v_smfmac_f32_16x16x64_bf16 v[76:79], v[40:43], v[132:139], v2
    v_add_f32 v56, v80, v82
    v_smfmac_f32_16x16x64_bf16 v[76:79], v[44:47], v[220:227], v2
    v_mul_f32 v56, 0x3dd53b95, v56
    v_smfmac_f32_16x16x64_bf16 v[76:79], v[48:51], v[228:235], v2
    s_waitcnt lgkmcnt(4)
    v_max_f32_dpp v58, v56, v56 row_ror:8 row_mask:0xf bank_mask:0xf
    v_smfmac_f32_16x16x64_bf16 v[76:79], v[52:55], v[140:147], v2
    s_waitcnt lgkmcnt(0)
    s_barrier
    v_max_f32_dpp v58, v58, v58 row_ror:4 row_mask:0xf bank_mask:0xf
    v_smfmac_f32_16x16x64_bf16 v[76:79], v[28:31], v[236:243], v2
    ds_read_b128 v[100:103], v5 offset:0
    v_max_f32_dpp v58, v58, v58 row_ror:2 row_mask:0xf bank_mask:0xf
    v_smfmac_f32_16x16x64_bf16 v[76:79], v[32:35], v[148:155], v2
    ds_read_b128 v[104:107], v5 offset:16
    v_max_f32_dpp v58, v58, v58 row_ror:1 row_mask:0xf bank_mask:0xf
    v_smfmac_f32_16x16x64_bf16 v[76:79], v[36:39], v[244:251], v2
    ds_read_b128 v[108:111], v5 offset:128
    v_sub_f32 v60, v56, v58
    ds_read_b128 v[112:115], v5 offset:144
    v_exp_f32 v60, v60
    s_nop 1
    v_add_f32_dpp v59, v60, v60 row_ror:8 row_mask:0xf bank_mask:0xf
    s_nop 1
    v_add_f32_dpp v59, v59, v59 row_ror:4 row_mask:0xf bank_mask:0xf
    s_nop 1
    v_add_f32_dpp v59, v59, v59 row_ror:2 row_mask:0xf bank_mask:0xf
    s_nop 1
    v_add_f32_dpp v59, v59, v59 row_ror:1 row_mask:0xf bank_mask:0xf
    v_add_f32 v76, v76, v78
    v_add_f32 v77, v77, v79
    v_cvt_pk_bf16_f32 v76, v76, v77
    ds_write_b16 v3, v76 offset:3456
    ds_write_b16_d16_hi v3, v76 offset:3856
    ds_write_b64 v6, v[58:59] offset:512
    s_waitcnt lgkmcnt(5)
    v_smfmac_f32_16x16x64_bf16 v[84:87], v[88:91], v[100:107], v2
    s_waitcnt lgkmcnt(3)
    v_smfmac_f32_16x16x64_bf16 v[84:87], v[92:95], v[108:115], v2
    s_waitcnt lgkmcnt(0)
    s_barrier
    ds_read_b128 v[116:119], v5 offset:256
    ds_read_b128 v[120:123], v5 offset:272
    ds_read_b64 v[16:17], v6 offset:0
    s_waitcnt lgkmcnt(1)
    v_smfmac_f32_16x16x64_bf16 v[84:87], v[96:99], v[116:123], v2
    s_waitcnt lgkmcnt(0)
    v_max_f32 v18, v58, v16
    v_sub_f32 v19, v58, v18
    v_sub_f32 v20, v16, v18
    v_exp_f32 v19, v19
    v_exp_f32 v20, v20
    s_nop 0
    v_mul_f32 v21, v59, v19
    v_mul_f32 v60, v60, v19
    v_fmac_f32 v21, v17, v20
    v_add_f32 v22, v84, v86
    v_mul_f32 v22, 0x3dd53b95, v22
    v_max_f32 v23, v22, v18
    s_nop 0
    v_max_f32_dpp v24, v22, v23 row_ror:4 row_mask:0xf bank_mask:0xf
    s_nop 1
    v_max_f32_dpp v24, v24, v24 row_ror:2 row_mask:0xf bank_mask:0xf
    s_nop 1
    v_max_f32_dpp v24, v24, v24 row_ror:1 row_mask:0xf bank_mask:0xf
    v_sub_f32 v25, v22, v24
    v_sub_f32 v26, v18, v24
    v_exp_f32 v25, v25
    v_exp_f32 v26, v26
    s_nop 0
    v_add_f32_dpp v23, v25, v25 row_ror:4 row_mask:0xf bank_mask:0xf
    v_mul_f32 v60, v60, v26
    s_nop 0
    v_add_f32_dpp v23, v23, v23 row_ror:2 row_mask:0xf bank_mask:0xf
    s_nop 1
    v_add_f32_dpp v23, v23, v23 row_ror:1 row_mask:0xf bank_mask:0xf
    v_fmac_f32 v23, v26, v21
    v_rcp_f32 v27, v23
    s_nop 0
    v_mul_f32 v60, v60, v27
    v_mul_f32 v25, v25, v27
    s_nop 0
    v_mov_b32_dpp v19, v60 quad_perm:[1,0,3,2] row_mask:0xf bank_mask:0xf
    v_mov_b32_dpp v20, v25 quad_perm:[1,0,3,2] row_mask:0xf bank_mask:0xf
    v_cvt_pk_bf16_f32 v28, v60, v19
    v_cvt_pk_bf16_f32 v25, v25, v20
    s_nop 0
    v_mov_b32_dpp v29, v28 row_shl:2 row_mask:0xf bank_mask:0xf
    v_mov_b32_dpp v30, v28 row_shl:4 row_mask:0xf bank_mask:0xf
    v_mov_b32_dpp v31, v28 row_shl:6 row_mask:0xf bank_mask:0xf
    v_mov_b32_dpp v28, v25 row_shr:4 row_mask:0xf bank_mask:0x2
    v_mov_b32_dpp v29, v25 row_shr:2 row_mask:0xf bank_mask:0x2
    v_mov_b32_dpp v30, v25 quad_perm:[0,1,2,3] row_mask:0xf bank_mask:0x2
    v_mov_b32_dpp v31, v25 row_shl:2 row_mask:0xf bank_mask:0x2
    s_mov_b32 exec_lo, 0x1010101
    s_mov_b32 exec_hi, 0x1110111
    buffer_store_dwordx4 v[28:31], v7, s[8:11], s18 offen sc1
    s_mov_b64 exec, -1
    ds_read_b128 v[40:43], v10
    s_add_u32 s28, s14, 1
    s_min_u32 s28, s28, 63
    s_cmp_gt_u32 s47, s28
    s_cbranch_scc1 layerb1_kernel_p1_gw2_ok
layerb1_kernel_p1_gw2_lp:
    buffer_load_dword v253, v255, s[8:11], s48 offen sc1
    s_waitcnt vmcnt(0)
    v_readlane_b32 s47, v253, 0
    v_readlane_b32 s29, v253, 1
    s_nop 0
    s_min_u32 s47, s47, s29
    s_sub_u32 s15, s15, 1
    s_cbranch_scc1 layerb1_kernel_bail
    s_cmp_gt_u32 s47, s28
    s_cbranch_scc0 layerb1_kernel_p1_gw2_lp
layerb1_kernel_p1_gw2_ok:
    s_mul_i32 s20, s28, 393216
    s_add_u32 s20, s20, s44
    s_add_u32 s21, s20, 0
    buffer_load_dwordx4 v[100:103], v9, s[8:11], s21 offen offset:0 sc1
    buffer_load_dwordx4 v[104:107], v9, s[8:11], s21 offen offset:512 sc1
    s_add_u32 s21, s20, 4096
    buffer_load_dwordx4 v[108:111], v9, s[8:11], s21 offen offset:0 sc1
    buffer_load_dwordx4 v[112:115], v9, s[8:11], s21 offen offset:512 sc1
    s_add_u32 s21, s20, 8192
    buffer_load_dwordx4 v[116:119], v9, s[8:11], s21 offen offset:0 sc1
    buffer_load_dwordx4 v[120:123], v9, s[8:11], s21 offen offset:512 sc1
    v_mov_b32 v56, 0
    v_mov_b32 v57, 0
    v_mov_b32 v58, 0
    v_mov_b32 v59, 0
    v_mov_b32 v60, 0
    v_mov_b32 v61, 0
    v_mov_b32 v62, 0
    v_mov_b32 v63, 0
    v_mov_b32 v64, 0
    v_mov_b32 v65, 0
    v_mov_b32 v66, 0
    v_mov_b32 v67, 0
    v_mov_b32 v68, 0
    v_mov_b32 v69, 0
    v_mov_b32 v70, 0
    v_mov_b32 v71, 0
    v_mov_b32 v72, 0
    v_mov_b32 v73, 0
    v_mov_b32 v74, 0
    v_mov_b32 v75, 0
    v_mov_b32 v76, 0
    v_mov_b32 v77, 0
    v_mov_b32 v78, 0
    v_mov_b32 v79, 0
    v_mov_b32 v80, 0
    v_mov_b32 v81, 0
    v_mov_b32 v82, 0
    v_mov_b32 v83, 0
    v_mov_b32 v84, 0
    v_mov_b32 v85, 0
    v_mov_b32 v86, 0
    v_mov_b32 v87, 0
    s_waitcnt lgkmcnt(0)
    s_mul_i32 s20, s14, 98304
    s_add_u32 s20, s20, s45
    buffer_store_dwordx4 v[40:43], v11, s[8:11], s20 offen sc1
    ds_read_b128 v[124:127], v13 offset:0
    ds_read_b128 v[128:131], v13 offset:1024
    ds_read_b128 v[132:135], v13 offset:2048
    ds_read_b128 v[136:139], v13 offset:3072
    ds_read_b128 v[140:143], v13 offset:4096
    ds_read_b128 v[144:147], v13 offset:5120
    ds_read_b128 v[148:151], v13 offset:6144
    ds_read_b128 v[152:155], v13 offset:7168
    s_waitcnt lgkmcnt(0)
    s_add_u32 s14, s14, 1
    s_cmp_lt_u32 s14, 64
    s_cbranch_scc1 layerb1_kernel_p1_step
    s_waitcnt vmcnt(0)
    s_barrier
    s_branch layerb1_kernel_end
layerb1_kernel_p2_start:
    v_lshrrev_b32 v16, 4, v0
    v_and_b32 v17, 15, v0
    v_and_b32 v18, 2, v0
    v_cmp_eq_u32 vcc, 0, v18
    v_mov_b32 v18, 0xeeeeeeee
    v_mov_b32 v19, 0x44444444
    v_cndmask_b32 v2, v18, v19, vcc
    v_lshrrev_b32 v20, 2, v17
    v_lshlrev_b32 v20, 1, v20
    v_and_b32 v21, 1, v17
    v_add_u32 v20, v20, v21
    v_bfe_u32 v21, v17, 1, 1
    v_lshl_add_u32 v18, v16, 1, v21
    v_lshlrev_b32 v18, 7, v18
    v_lshl_add_u32 v12, v20, 4, v18
    v_mul_u32_u24 v18, 400, v20
    v_lshl_add_u32 v18, v16, 5, v18
    v_lshl_add_u32 v18, v21, 4, v18
    v_add_u32 v4, 141312, v18
    v_mul_u32_u24 v18, 800, v16
    v_lshl_add_u32 v18, v17, 1, v18
    v_add_u32 v3, 141376, v18
    v_and_b32 v18, 7, v0
    v_mul_u32_u24 v18, 400, v18
    v_lshl_add_u32 v18, v16, 5, v18
    v_add_u32 v5, 144512, v18
    v_lshlrev_b32 v18, 3, v0
    v_add_u32 v6, 147712, v18
    v_lshlrev_b32 v18, 4, v16
    v_bfe_u32 v19, v17, 1, 2
    v_lshl_add_u32 v18, v19, 2, v18
    s_lshl_b32 s20, s12, 7
    s_add_u32 s20, s20, 64
    v_add_u32 v18, s20, v18
    v_lshrrev_b32 v19, 3, v17
    v_add_u32 v19, 1, v19
    v_lshrrev_b32 v20, 1, v19
    v_lshlrev_b32 v20, 14, v20
    v_and_b32 v19, 1, v19
    v_lshl_add_u32 v19, v19, 12, v20
    v_add_u32 v19, v19, v18
    v_mov_b32 v20, 0x7ffffff0
    v_and_b32 v21, 7, v0
    v_cmp_eq_u32 vcc, 4, v21
    v_subrev_u32 v21, 8, v18
    s_nop 0
    v_cndmask_b32 v7, v19, v21, vcc
    v_and_b32 v21, 0x29, v0
    v_cmp_eq_u32 vcc, 0, v21
    s_nop 1
    v_cndmask_b32 v8, v20, v18, vcc
    s_lshl_b32 s20, s12, 2
    v_lshlrev_b32 v18, 7, v0
    v_add_u32 v8, s20, v18
    v_lshlrev_b32 v18, 4, v17
    v_lshl_add_u32 v18, v16, 10, v18
    v_add_u32 v9, 0, v18
    v_add_u32 v18, 128, v0
    v_mul_u32_u24 v19, 2731, v18
    v_lshrrev_b32 v19, 16, v19
    v_mul_u32_u24 v20, 24, v19
    v_sub_u32 v20, v18, v20
    v_mul_u32_u24 v21, 400, v19
    v_lshl_add_u32 v21, v20, 4, v21
    v_add_u32 v10, 144512, v21
    v_lshlrev_b32 v21, 4, v19
    v_lshl_add_u32 v11, v20, 7, v21
    v_add_u32 v13, 65536, v1
    v_add_u32 v14, 131072, v1
    s_mul_i32 s44, s12, 12288
    s_add_u32 s44, s44, 53477376
    s_mul_i32 s45, s12, 3072
    s_add_u32 s45, s45, 208666624
    s_mul_i32 s20, s12, 6
    s_add_u32 s21, s20, 5
    s_lshr_b32 s20, s20, 3
    s_lshr_b32 s21, s21, 3
    s_add_u32 s20, s20, 80
    s_add_u32 s21, s21, 80
    s_lshl_b32 s20, s20, 7
    s_lshl_b32 s21, s21, 7
    v_mov_b32 v255, s21
    v_mov_b32 v253, s20
    v_cmp_eq_u32 vcc, 0, v0
    s_nop 1
    v_cndmask_b32 v255, v255, v253, vcc
    s_mov_b32 s47, 0
    s_mul_i32 s20, s12, 491520
    s_add_u32 s20, s20, 11780096
    s_add_u32 s21, s20, 14336
    buffer_load_dwordx4 v[16:19], v1, s[8:11], s21 offen offset:0
    buffer_load_dwordx4 v[20:23], v1, s[8:11], s21 offen offset:1024
    s_add_u32 s21, s20, 75776
    buffer_load_dwordx4 v[24:27], v1, s[8:11], s21 offen offset:0
    buffer_load_dwordx4 v[28:31], v1, s[8:11], s21 offen offset:1024
    s_add_u32 s21, s20, 0
    buffer_load_dwordx4 v[32:35], v1, s[8:11], s21 offen offset:0
    buffer_load_dwordx4 v[36:39], v1, s[8:11], s21 offen offset:1024
    s_add_u32 s21, s20, 8192
    buffer_load_dwordx4 v[40:43], v1, s[8:11], s21 offen offset:0
    buffer_load_dwordx4 v[44:47], v1, s[8:11], s21 offen offset:1024
    s_add_u32 s21, s20, 20480
    buffer_load_dwordx4 v[48:51], v1, s[8:11], s21 offen offset:0
    buffer_load_dwordx4 v[52:55], v1, s[8:11], s21 offen offset:1024
    s_add_u32 s21, s20, 28672
    buffer_load_dwordx4 v[56:59], v1, s[8:11], s21 offen offset:0
    buffer_load_dwordx4 v[60:63], v1, s[8:11], s21 offen offset:1024
    s_add_u32 s21, s20, 40960
    buffer_load_dwordx4 v[64:67], v1, s[8:11], s21 offen offset:0
    buffer_load_dwordx4 v[68:71], v1, s[8:11], s21 offen offset:1024
    s_add_u32 s21, s20, 49152
    buffer_load_dwordx4 v[72:75], v1, s[8:11], s21 offen offset:0
    buffer_load_dwordx4 v[76:79], v1, s[8:11], s21 offen offset:1024
    s_add_u32 s21, s20, 61440
    buffer_load_dwordx4 v[80:83], v1, s[8:11], s21 offen offset:0
    buffer_load_dwordx4 v[84:87], v1, s[8:11], s21 offen offset:1024
    s_add_u32 s21, s20, 69632
    buffer_load_dwordx4 v[88:91], v1, s[8:11], s21 offen offset:0
    buffer_load_dwordx4 v[92:95], v1, s[8:11], s21 offen offset:1024
    s_add_u32 s21, s20, 81920
    buffer_load_dwordx4 v[96:99], v1, s[8:11], s21 offen offset:0
    buffer_load_dwordx4 v[100:103], v1, s[8:11], s21 offen offset:1024
    s_add_u32 s21, s20, 90112
    buffer_load_dwordx4 v[104:107], v1, s[8:11], s21 offen offset:0
    buffer_load_dwordx4 v[108:111], v1, s[8:11], s21 offen offset:1024
    s_add_u32 s21, s20, 100352
    buffer_load_dwordx4 v[112:115], v1, s[8:11], s21 offen offset:0
    buffer_load_dwordx4 v[116:119], v1, s[8:11], s21 offen offset:1024
    s_add_u32 s21, s20, 106496
    buffer_load_dwordx4 v[120:123], v1, s[8:11], s21 offen offset:0
    buffer_load_dwordx4 v[124:127], v1, s[8:11], s21 offen offset:1024
    s_add_u32 s21, s20, 112640
    buffer_load_dwordx4 v[128:131], v1, s[8:11], s21 offen offset:0
    buffer_load_dwordx4 v[132:135], v1, s[8:11], s21 offen offset:1024
    s_add_u32 s21, s20, 120832
    buffer_load_dwordx4 v[136:139], v1, s[8:11], s21 offen offset:0
    buffer_load_dwordx4 v[140:143], v1, s[8:11], s21 offen offset:1024
    s_add_u32 s21, s20, 79872
    buffer_load_dwordx4 v[156:159], v1, s[8:11], s21 offen offset:0
    buffer_load_dwordx4 v[160:163], v1, s[8:11], s21 offen offset:1024
    s_add_u32 s21, s20, 83968
    buffer_load_dwordx4 v[164:167], v1, s[8:11], s21 offen offset:0
    buffer_load_dwordx4 v[168:171], v1, s[8:11], s21 offen offset:1024
    s_add_u32 s21, s20, 86016
    buffer_load_dwordx4 v[172:175], v1, s[8:11], s21 offen offset:0
    buffer_load_dwordx4 v[176:179], v1, s[8:11], s21 offen offset:1024
    s_add_u32 s21, s20, 88064
    buffer_load_dwordx4 v[180:183], v1, s[8:11], s21 offen offset:0
    buffer_load_dwordx4 v[184:187], v1, s[8:11], s21 offen offset:1024
    s_add_u32 s21, s20, 92160
    buffer_load_dwordx4 v[188:191], v1, s[8:11], s21 offen offset:0
    buffer_load_dwordx4 v[192:195], v1, s[8:11], s21 offen offset:1024
    s_add_u32 s21, s20, 98304
    buffer_load_dwordx4 v[196:199], v1, s[8:11], s21 offen offset:0
    buffer_load_dwordx4 v[200:203], v1, s[8:11], s21 offen offset:1024
    s_add_u32 s21, s20, 102400
    buffer_load_dwordx4 v[204:207], v1, s[8:11], s21 offen offset:0
    buffer_load_dwordx4 v[208:211], v1, s[8:11], s21 offen offset:1024
    s_add_u32 s21, s20, 104448
    buffer_load_dwordx4 v[212:215], v1, s[8:11], s21 offen offset:0
    buffer_load_dwordx4 v[216:219], v1, s[8:11], s21 offen offset:1024
    s_add_u32 s21, s20, 108544
    buffer_load_dwordx4 v[220:223], v1, s[8:11], s21 offen offset:0
    buffer_load_dwordx4 v[224:227], v1, s[8:11], s21 offen offset:1024
    s_add_u32 s21, s20, 110592
    buffer_load_dwordx4 v[228:231], v1, s[8:11], s21 offen offset:0
    buffer_load_dwordx4 v[232:235], v1, s[8:11], s21 offen offset:1024
    s_add_u32 s21, s20, 118784
    buffer_load_dwordx4 v[236:239], v1, s[8:11], s21 offen offset:0
    buffer_load_dwordx4 v[240:243], v1, s[8:11], s21 offen offset:1024
    s_add_u32 s21, s20, 116736
    buffer_load_dwordx4 v[244:247], v1, s[8:11], s21 offen offset:0
    buffer_load_dwordx4 v[248:251], v1, s[8:11], s21 offen offset:1024
    s_waitcnt vmcnt(24)
    ds_write_b128 v13, v[16:19] offset:0
    ds_write_b128 v13, v[20:23] offset:1024
    ds_write_b128 v13, v[24:27] offset:2048
    ds_write_b128 v13, v[28:31] offset:3072
    ds_write_b128 v13, v[32:35] offset:4096
    ds_write_b128 v13, v[36:39] offset:5120
    ds_write_b128 v13, v[40:43] offset:6144
    ds_write_b128 v13, v[44:47] offset:7168
    ds_write_b128 v13, v[48:51] offset:8192
    ds_write_b128 v13, v[52:55] offset:9216
    ds_write_b128 v13, v[56:59] offset:10240
    ds_write_b128 v13, v[60:63] offset:11264
    ds_write_b128 v13, v[64:67] offset:12288
    ds_write_b128 v13, v[68:71] offset:13312
    ds_write_b128 v13, v[72:75] offset:14336
    ds_write_b128 v13, v[76:79] offset:15360
    ds_write_b128 v13, v[80:83] offset:16384
    ds_write_b128 v13, v[84:87] offset:17408
    ds_write_b128 v13, v[88:91] offset:18432
    ds_write_b128 v13, v[92:95] offset:19456
    ds_write_b128 v13, v[96:99] offset:20480
    ds_write_b128 v13, v[100:103] offset:21504
    ds_write_b128 v13, v[104:107] offset:22528
    ds_write_b128 v13, v[108:111] offset:23552
    ds_write_b128 v13, v[112:115] offset:24576
    ds_write_b128 v13, v[116:119] offset:25600
    ds_write_b128 v13, v[120:123] offset:26624
    ds_write_b128 v13, v[124:127] offset:27648
    ds_write_b128 v13, v[128:131] offset:28672
    ds_write_b128 v13, v[132:135] offset:29696
    ds_write_b128 v13, v[136:139] offset:30720
    ds_write_b128 v13, v[140:143] offset:31744
    s_waitcnt lgkmcnt(0)
    s_add_u32 s20, s48, 51200
    s_mov_b64 exec, 3
    v_lshlrev_b32 v16, 2, v0
layerb1_kernel_p2_par:
    buffer_load_dword v17, v16, s[8:11], s20 offen sc1
    s_waitcnt vmcnt(0)
    v_cmp_eq_u32 vcc, 0, v17
    s_sub_u32 s15, s15, 1
    s_cbranch_scc1 layerb1_kernel_bail
    s_cbranch_vccnz layerb1_kernel_p2_par
    s_mov_b64 exec, -1
    v_readlane_b32 s20, v17, 0
    v_readlane_b32 s21, v17, 1
    s_nop 0
    s_and_b32 s20, s20, 8192
    s_and_b32 s21, s21, 8192
    s_add_u32 s16, s16, s20
    s_add_u32 s17, s17, s21
    s_mov_b32 s14, 0
    s_cmp_gt_u32 s47, s14
    s_cbranch_scc1 layerb1_kernel_p2_gw1_ok
layerb1_kernel_p2_gw1_lp:
    buffer_load_dword v253, v255, s[8:11], s48 offen sc1
    s_waitcnt vmcnt(0)
    v_readlane_b32 s47, v253, 0
    v_readlane_b32 s29, v253, 1
    s_nop 0
    s_min_u32 s47, s47, s29
    s_sub_u32 s15, s15, 1
    s_cbranch_scc1 layerb1_kernel_bail
    s_cmp_gt_u32 s47, s14
    s_cbranch_scc0 layerb1_kernel_p2_gw1_lp
layerb1_kernel_p2_gw1_ok:
    s_mul_i32 s20, s14, 393216
    s_add_u32 s20, s20, s44
    s_add_u32 s21, s20, 0
    buffer_load_dwordx4 v[100:103], v9, s[8:11], s21 offen offset:0 sc1
    buffer_load_dwordx4 v[104:107], v9, s[8:11], s21 offen offset:512 sc1
    s_add_u32 s21, s20, 4096
    buffer_load_dwordx4 v[108:111], v9, s[8:11], s21 offen offset:0 sc1
    buffer_load_dwordx4 v[112:115], v9, s[8:11], s21 offen offset:512 sc1
    s_add_u32 s21, s20, 8192
    buffer_load_dwordx4 v[116:119], v9, s[8:11], s21 offen offset:0 sc1
    buffer_load_dwordx4 v[120:123], v9, s[8:11], s21 offen offset:512 sc1
    v_mov_b32 v56, 0
    v_mov_b32 v57, 0
    v_mov_b32 v58, 0
    v_mov_b32 v59, 0
    v_mov_b32 v60, 0
    v_mov_b32 v61, 0
    v_mov_b32 v62, 0
    v_mov_b32 v63, 0
    v_mov_b32 v64, 0
    v_mov_b32 v65, 0
    v_mov_b32 v66, 0
    v_mov_b32 v67, 0
    v_mov_b32 v68, 0
    v_mov_b32 v69, 0
    v_mov_b32 v70, 0
    v_mov_b32 v71, 0
    v_mov_b32 v72, 0
    v_mov_b32 v73, 0
    v_mov_b32 v74, 0
    v_mov_b32 v75, 0
    v_mov_b32 v76, 0
    v_mov_b32 v77, 0
    v_mov_b32 v78, 0
    v_mov_b32 v79, 0
    v_mov_b32 v80, 0
    v_mov_b32 v81, 0
    v_mov_b32 v82, 0
    v_mov_b32 v83, 0
    v_mov_b32 v84, 0
    v_mov_b32 v85, 0
    v_mov_b32 v86, 0
    v_mov_b32 v87, 0
    ds_read_b128 v[124:127], v13 offset:0
    ds_read_b128 v[128:131], v13 offset:1024
    ds_read_b128 v[132:135], v13 offset:2048
    ds_read_b128 v[136:139], v13 offset:3072
    ds_read_b128 v[140:143], v13 offset:4096
    ds_read_b128 v[144:147], v13 offset:5120
    ds_read_b128 v[148:151], v13 offset:6144
    ds_read_b128 v[152:155], v13 offset:7168
    s_waitcnt lgkmcnt(0)
layerb1_kernel_p2_step:
    s_cmp_lt_u32 s14, 32
    s_cselect_b32 s18, s16, s17
    s_and_b32 s20, s14, 31
    s_lshl_b32 s20, s20, 16
    s_add_u32 s18, s18, s20
    s_add_u32 s69, s18, 55424
    s_add_u32 s22, s18, 51200
    s_add_u32 s23, s18, 52224
layerb1_kernel_p2_poll:
    buffer_load_dwordx4 v[40:43], v12, s[8:11], s22 offen sc1
    buffer_load_dwordx4 v[44:47], v12, s[8:11], s23 offen sc1
    s_waitcnt vmcnt(0)
    ds_write_b128 v14, v[40:43] offset:6144
    ds_write_b128 v14, v[44:47] offset:7168
    v_max3_u32 v88, v40, v41, v42
    v_max3_u32 v88, v88, v43, v44
    v_max3_u32 v88, v88, v45, v46
    v_max_u32 v88, v88, v47
    v_cmp_eq_u32 vcc, -1, v88
    s_sub_u32 s15, s15, 1
    s_cbranch_scc1 layerb1_kernel_bail
    s_cbranch_vccnz layerb1_kernel_p2_poll
    v_smfmac_f32_16x16x64_bf16 v[56:59], v[40:43], a[0:7], v2
    v_smfmac_f32_16x16x64_bf16 v[60:63], v[40:43], a[8:15], v2
    v_smfmac_f32_16x16x64_bf16 v[64:67], v[40:43], a[16:23], v2
    v_smfmac_f32_16x16x64_bf16 v[56:59], v[44:47], v[124:131], v2
    ds_read_b128 v[124:127], v13 offset:8192
    v_smfmac_f32_16x16x64_bf16 v[60:63], v[44:47], a[24:31], v2
    s_waitcnt lgkmcnt(1)
    s_barrier
    v_smfmac_f32_16x16x64_bf16 v[64:67], v[44:47], a[32:39], v2
    ds_read_b128 v[16:19], v14 offset:0
    v_smfmac_f32_16x16x64_bf16 v[68:71], v[40:43], a[40:47], v2
    ds_read_b128 v[20:23], v14 offset:1024
    v_smfmac_f32_16x16x64_bf16 v[68:71], v[44:47], v[132:139], v2
    ds_read_b128 v[24:27], v14 offset:2048
    v_smfmac_f32_16x16x64_bf16 v[72:75], v[40:43], a[48:55], v2
    ds_read_b128 v[28:31], v14 offset:3072
    v_smfmac_f32_16x16x64_bf16 v[72:75], v[44:47], a[56:63], v2
    ds_read_b128 v[32:35], v14 offset:4096
    v_smfmac_f32_16x16x64_bf16 v[76:79], v[40:43], a[64:71], v2
    s_waitcnt lgkmcnt(4)
    ds_read_b128 v[36:39], v14 offset:5120
    v_smfmac_f32_16x16x64_bf16 v[56:59], v[16:19], v[140:147], v2
    s_waitcnt lgkmcnt(4)
    ds_read_b128 v[48:51], v14 offset:8192
    v_smfmac_f32_16x16x64_bf16 v[56:59], v[20:23], a[72:79], v2
    s_waitcnt lgkmcnt(4)
    ds_read_b128 v[52:55], v14 offset:9216
    v_smfmac_f32_16x16x64_bf16 v[56:59], v[24:27], a[80:87], v2
    s_waitcnt lgkmcnt(4)
    ds_read_b128 v[128:131], v13 offset:9216
    v_smfmac_f32_16x16x64_bf16 v[56:59], v[28:31], a[88:95], v2
    s_waitcnt lgkmcnt(4)
    ds_read_b128 v[132:135], v13 offset:10240
    v_smfmac_f32_16x16x64_bf16 v[56:59], v[32:35], v[148:155], v2
    s_waitcnt lgkmcnt(4)
    ds_read_b128 v[136:139], v13 offset:11264
    v_smfmac_f32_16x16x64_bf16 v[56:59], v[36:39], a[96:103], v2
    s_waitcnt lgkmcnt(4)
    ds_read_b128 v[140:143], v13 offset:12288
    v_smfmac_f32_16x16x64_bf16 v[56:59], v[48:51], a[104:111], v2
    s_waitcnt lgkmcnt(4)
    ds_read_b128 v[144:147], v13 offset:13312
    v_smfmac_f32_16x16x64_bf16 v[56:59], v[52:55], a[112:119], v2
    s_waitcnt lgkmcnt(4)
    ds_read_b128 v[148:151], v13 offset:14336
    v_smfmac_f32_16x16x64_bf16 v[60:63], v[16:19], v[124:131], v2
    ds_read_b128 v[152:155], v13 offset:15360
    v_smfmac_f32_16x16x64_bf16 v[60:63], v[20:23], a[120:127], v2
    ds_read_b128 v[124:127], v13 offset:16384
    v_add_f32 v56, v56, v58
    v_smfmac_f32_16x16x64_bf16 v[60:63], v[24:27], a[128:135], v2
    ds_read_b128 v[128:131], v13 offset:17408
    v_add_f32 v57, v57, v59
    v_smfmac_f32_16x16x64_bf16 v[60:63], v[28:31], a[136:143], v2
    s_waitcnt lgkmcnt(6)
    v_cvt_pk_bf16_f32 v56, v56, v57
    v_smfmac_f32_16x16x64_bf16 v[60:63], v[32:35], v[132:139], v2
    ds_write_b16 v3, v56 offset:0
    v_smfmac_f32_16x16x64_bf16 v[60:63], v[36:39], a[144:151], v2
    ds_write_b16_d16_hi v3, v56 offset:400
    v_smfmac_f32_16x16x64_bf16 v[60:63], v[48:51], a[152:159], v2
    ds_read_b128 v[132:135], v13 offset:18432
    v_smfmac_f32_16x16x64_bf16 v[60:63], v[52:55], a[160:167], v2
    s_waitcnt lgkmcnt(7)
    ds_read_b128 v[136:139], v13 offset:19456
    v_smfmac_f32_16x16x64_bf16 v[64:67], v[16:19], v[140:147], v2
    ds_read_b128 v[140:143], v13 offset:20480
    v_smfmac_f32_16x16x64_bf16 v[64:67], v[20:23], a[168:175], v2
    ds_read_b128 v[144:147], v13 offset:21504
    v_add_f32 v60, v60, v62
    v_smfmac_f32_16x16x64_bf16 v[64:67], v[24:27], a[176:183], v2
    v_add_f32 v61, v61, v63
    v_smfmac_f32_16x16x64_bf16 v[64:67], v[28:31], a[184:191], v2
    s_waitcnt lgkmcnt(8)
    v_cvt_pk_bf16_f32 v60, v60, v61
    v_smfmac_f32_16x16x64_bf16 v[64:67], v[32:35], v[148:155], v2
    ds_write_b16 v3, v60 offset:128
    v_smfmac_f32_16x16x64_bf16 v[64:67], v[36:39], a[192:199], v2
    ds_write_b16_d16_hi v3, v60 offset:528
    v_smfmac_f32_16x16x64_bf16 v[64:67], v[48:51], a[200:207], v2
    ds_read_b128 v[148:151], v13 offset:22528
    v_smfmac_f32_16x16x64_bf16 v[64:67], v[52:55], a[208:215], v2
    s_waitcnt lgkmcnt(9)
    ds_read_b128 v[152:155], v13 offset:23552
    v_smfmac_f32_16x16x64_bf16 v[68:71], v[16:19], v[124:131], v2
    ds_read_b128 v[124:127], v13 offset:24576
    v_smfmac_f32_16x16x64_bf16 v[68:71], v[20:23], a[216:223], v2
    ds_read_b128 v[128:131], v13 offset:25600
    v_add_f32 v64, v64, v66
    v_smfmac_f32_16x16x64_bf16 v[68:71], v[24:27], a[224:231], v2
    v_add_f32 v65, v65, v67
    v_smfmac_f32_16x16x64_bf16 v[68:71], v[28:31], a[232:239], v2
    s_waitcnt lgkmcnt(8)
    v_cvt_pk_bf16_f32 v64, v64, v65
    v_smfmac_f32_16x16x64_bf16 v[68:71], v[32:35], v[132:139], v2
    ds_write_b16 v3, v64 offset:256
    v_smfmac_f32_16x16x64_bf16 v[68:71], v[36:39], a[240:247], v2
    ds_write_b16_d16_hi v3, v64 offset:656
    v_smfmac_f32_16x16x64_bf16 v[68:71], v[48:51], a[248:255], v2
    ds_read_b128 v[132:135], v13 offset:26624
    v_smfmac_f32_16x16x64_bf16 v[68:71], v[52:55], v[156:163], v2
    s_waitcnt lgkmcnt(9)
    ds_read_b128 v[136:139], v13 offset:27648
    v_smfmac_f32_16x16x64_bf16 v[72:75], v[16:19], v[140:147], v2
    ds_read_b128 v[140:143], v13 offset:28672
    v_smfmac_f32_16x16x64_bf16 v[72:75], v[20:23], v[164:171], v2
    s_waitcnt lgkmcnt(3)
    s_barrier
    v_add_f32 v68, v68, v70
    v_smfmac_f32_16x16x64_bf16 v[72:75], v[24:27], v[172:179], v2
    ds_read_b128 v[88:91], v4 offset:0
    v_add_f32 v69, v69, v71
    v_smfmac_f32_16x16x64_bf16 v[72:75], v[28:31], v[180:187], v2
    ds_read_b128 v[92:95], v4 offset:128
    v_cvt_pk_bf16_f32 v68, v68, v69
    v_smfmac_f32_16x16x64_bf16 v[72:75], v[32:35], v[148:155], v2
    ds_read_b128 v[96:99], v4 offset:256
    v_smfmac_f32_16x16x64_bf16 v[72:75], v[36:39], v[188:195], v2
    ds_write_b16 v3, v68 offset:3200
    v_smfmac_f32_16x16x64_bf16 v[72:75], v[48:51], v[196:203], v2
    ds_write_b16_d16_hi v3, v68 offset:3600
    v_smfmac_f32_16x16x64_bf16 v[72:75], v[52:55], v[124:131], v2
    s_waitcnt lgkmcnt(4)
    ds_read_b128 v[144:147], v13 offset:29696
    v_smfmac_f32_16x16x64_bf16 v[80:83], v[88:91], v[100:107], v2
    s_waitcnt lgkmcnt(4)
    ds_read_b128 v[148:151], v13 offset:30720
    v_smfmac_f32_16x16x64_bf16 v[80:83], v[92:95], v[108:115], v2
    s_waitcnt lgkmcnt(4)
    ds_read_b128 v[152:155], v13 offset:31744
    v_add_f32 v72, v72, v74
    v_smfmac_f32_16x16x64_bf16 v[80:83], v[96:99], v[116:123], v2
    v_add_f32 v73, v73, v75
    v_smfmac_f32_16x16x64_bf16 v[76:79], v[16:19], v[204:211], v2
    v_cvt_pk_bf16_f32 v72, v72, v73
    v_smfmac_f32_16x16x64_bf16 v[76:79], v[20:23], v[212:219], v2
    ds_write_b16 v3, v72 offset:3328
    v_smfmac_f32_16x16x64_bf16 v[76:79], v[24:27], v[132:139], v2
    ds_write_b16_d16_hi v3, v72 offset:3728
    v_smfmac_f32_16x16x64_bf16 v[76:79], v[28:31], v[220:227], v2
    v_add_f32 v56, v81, v83
    v_smfmac_f32_16x16x64_bf16 v[76:79], v[32:35], v[228:235], v2
    s_waitcnt lgkmcnt(4)
    v_mul_f32 v56, 0x3dd53b95, v56
    v_smfmac_f32_16x16x64_bf16 v[76:79], v[36:39], v[140:147], v2
    s_waitcnt lgkmcnt(0)
    s_barrier
    v_max_f32_dpp v58, v56, v56 row_ror:8 row_mask:0xf bank_mask:0xf
    v_smfmac_f32_16x16x64_bf16 v[76:79], v[48:51], v[236:243], v2
    ds_read_b128 v[100:103], v5 offset:0
    v_max_f32_dpp v58, v58, v58 row_ror:4 row_mask:0xf bank_mask:0xf
    v_smfmac_f32_16x16x64_bf16 v[76:79], v[52:55], v[148:155], v2
    ds_read_b128 v[104:107], v5 offset:16
    v_max_f32_dpp v58, v58, v58 row_ror:2 row_mask:0xf bank_mask:0xf
    v_smfmac_f32_16x16x64_bf16 v[76:79], v[44:47], v[244:251], v2
    ds_read_b128 v[108:111], v5 offset:128
    v_max_f32_dpp v58, v58, v58 row_ror:1 row_mask:0xf bank_mask:0xf
    ds_read_b128 v[112:115], v5 offset:144
    v_sub_f32 v60, v56, v58
    s_nop 1
    v_exp_f32 v60, v60
    s_nop 1
    v_add_f32_dpp v59, v60, v60 row_ror:8 row_mask:0xf bank_mask:0xf
    s_nop 1
    v_add_f32_dpp v59, v59, v59 row_ror:4 row_mask:0xf bank_mask:0xf
    s_nop 1
    v_add_f32_dpp v59, v59, v59 row_ror:2 row_mask:0xf bank_mask:0xf
    s_nop 1
    v_add_f32_dpp v59, v59, v59 row_ror:1 row_mask:0xf bank_mask:0xf
    v_add_f32 v76, v76, v78
    v_add_f32 v77, v77, v79
    v_cvt_pk_bf16_f32 v76, v76, v77
    ds_write_b16 v3, v76 offset:3456
    ds_write_b16_d16_hi v3, v76 offset:3856
    ds_write_b64 v6, v[58:59] offset:1024
    s_waitcnt lgkmcnt(5)
    v_smfmac_f32_16x16x64_bf16 v[84:87], v[88:91], v[100:107], v2
    s_waitcnt lgkmcnt(3)
    v_smfmac_f32_16x16x64_bf16 v[84:87], v[92:95], v[108:115], v2
    s_waitcnt lgkmcnt(0)
    s_barrier
    ds_read_b128 v[116:119], v5 offset:256
    ds_read_b128 v[120:123], v5 offset:272
    ds_read_b64 v[16:17], v6 offset:1536
    s_waitcnt lgkmcnt(1)
    v_smfmac_f32_16x16x64_bf16 v[84:87], v[96:99], v[116:123], v2
    s_waitcnt lgkmcnt(0)
    v_max_f32 v18, v58, v16
    v_sub_f32 v19, v58, v18
    v_sub_f32 v20, v16, v18
    v_exp_f32 v19, v19
    v_exp_f32 v20, v20
    s_nop 0
    v_mul_f32 v21, v59, v19
    v_mul_f32 v60, v60, v19
    v_fmac_f32 v21, v17, v20
    v_add_f32 v22, v85, v87
    v_mul_f32 v22, 0x3dd53b95, v22
    v_max_f32 v23, v22, v18
    s_nop 0
    v_max_f32_dpp v24, v22, v23 row_ror:4 row_mask:0xf bank_mask:0xf
    s_nop 1
    v_max_f32_dpp v24, v24, v24 row_ror:2 row_mask:0xf bank_mask:0xf
    s_nop 1
    v_max_f32_dpp v24, v24, v24 row_ror:1 row_mask:0xf bank_mask:0xf
    v_sub_f32 v25, v22, v24
    v_sub_f32 v26, v18, v24
    v_exp_f32 v25, v25
    v_exp_f32 v26, v26
    s_nop 0
    v_add_f32_dpp v23, v25, v25 row_ror:4 row_mask:0xf bank_mask:0xf
    v_mul_f32 v60, v60, v26
    s_nop 0
    v_add_f32_dpp v23, v23, v23 row_ror:2 row_mask:0xf bank_mask:0xf
    s_nop 1
    v_add_f32_dpp v23, v23, v23 row_ror:1 row_mask:0xf bank_mask:0xf
    v_fmac_f32 v23, v26, v21
    v_rcp_f32 v27, v23
    s_nop 0
    v_mul_f32 v60, v60, v27
    v_mul_f32 v25, v25, v27
    s_nop 0
    v_mov_b32_dpp v19, v60 quad_perm:[1,0,3,2] row_mask:0xf bank_mask:0xf
    v_mov_b32_dpp v20, v25 quad_perm:[1,0,3,2] row_mask:0xf bank_mask:0xf
    v_cvt_pk_bf16_f32 v28, v60, v19
    v_cvt_pk_bf16_f32 v25, v25, v20
    s_nop 0
    v_mov_b32_dpp v29, v28 row_shl:2 row_mask:0xf bank_mask:0xf
    v_mov_b32_dpp v30, v28 row_shl:4 row_mask:0xf bank_mask:0xf
    v_mov_b32_dpp v31, v28 row_shl:6 row_mask:0xf bank_mask:0xf
    v_mov_b32_dpp v28, v25 row_shr:4 row_mask:0xf bank_mask:0x2
    v_mov_b32_dpp v29, v25 row_shr:2 row_mask:0xf bank_mask:0x2
    v_mov_b32_dpp v30, v25 quad_perm:[0,1,2,3] row_mask:0xf bank_mask:0x2
    v_mov_b32_dpp v31, v25 row_shl:2 row_mask:0xf bank_mask:0x2
    s_mov_b32 exec_lo, 0x1110111
    s_mov_b32 exec_hi, 0x1010101
    buffer_store_dwordx4 v[28:31], v7, s[8:11], s18 offen sc1
    s_mov_b64 exec, -1
    ds_read_b128 v[40:43], v10
    s_add_u32 s28, s14, 1
    s_min_u32 s28, s28, 63
    s_cmp_gt_u32 s47, s28
    s_cbranch_scc1 layerb1_kernel_p2_gw2_ok
layerb1_kernel_p2_gw2_lp:
    buffer_load_dword v253, v255, s[8:11], s48 offen sc1
    s_waitcnt vmcnt(0)
    v_readlane_b32 s47, v253, 0
    v_readlane_b32 s29, v253, 1
    s_nop 0
    s_min_u32 s47, s47, s29
    s_sub_u32 s15, s15, 1
    s_cbranch_scc1 layerb1_kernel_bail
    s_cmp_gt_u32 s47, s28
    s_cbranch_scc0 layerb1_kernel_p2_gw2_lp
layerb1_kernel_p2_gw2_ok:
    s_mul_i32 s20, s28, 393216
    s_add_u32 s20, s20, s44
    s_add_u32 s21, s20, 0
    buffer_load_dwordx4 v[100:103], v9, s[8:11], s21 offen offset:0 sc1
    buffer_load_dwordx4 v[104:107], v9, s[8:11], s21 offen offset:512 sc1
    s_add_u32 s21, s20, 4096
    buffer_load_dwordx4 v[108:111], v9, s[8:11], s21 offen offset:0 sc1
    buffer_load_dwordx4 v[112:115], v9, s[8:11], s21 offen offset:512 sc1
    s_add_u32 s21, s20, 8192
    buffer_load_dwordx4 v[116:119], v9, s[8:11], s21 offen offset:0 sc1
    buffer_load_dwordx4 v[120:123], v9, s[8:11], s21 offen offset:512 sc1
    v_mov_b32 v56, 0
    v_mov_b32 v57, 0
    v_mov_b32 v58, 0
    v_mov_b32 v59, 0
    v_mov_b32 v60, 0
    v_mov_b32 v61, 0
    v_mov_b32 v62, 0
    v_mov_b32 v63, 0
    v_mov_b32 v64, 0
    v_mov_b32 v65, 0
    v_mov_b32 v66, 0
    v_mov_b32 v67, 0
    v_mov_b32 v68, 0
    v_mov_b32 v69, 0
    v_mov_b32 v70, 0
    v_mov_b32 v71, 0
    v_mov_b32 v72, 0
    v_mov_b32 v73, 0
    v_mov_b32 v74, 0
    v_mov_b32 v75, 0
    v_mov_b32 v76, 0
    v_mov_b32 v77, 0
    v_mov_b32 v78, 0
    v_mov_b32 v79, 0
    v_mov_b32 v80, 0
    v_mov_b32 v81, 0
    v_mov_b32 v82, 0
    v_mov_b32 v83, 0
    v_mov_b32 v84, 0
    v_mov_b32 v85, 0
    v_mov_b32 v86, 0
    v_mov_b32 v87, 0
    s_waitcnt lgkmcnt(0)
    s_mul_i32 s20, s14, 98304
    s_add_u32 s20, s20, s45
    buffer_store_dwordx4 v[40:43], v11, s[8:11], s20 offen sc1
    ds_read_b128 v[124:127], v13 offset:0
    ds_read_b128 v[128:131], v13 offset:1024
    ds_read_b128 v[132:135], v13 offset:2048
    ds_read_b128 v[136:139], v13 offset:3072
    ds_read_b128 v[140:143], v13 offset:4096
    ds_read_b128 v[144:147], v13 offset:5120
    ds_read_b128 v[148:151], v13 offset:6144
    ds_read_b128 v[152:155], v13 offset:7168
    s_waitcnt lgkmcnt(0)
    s_add_u32 s14, s14, 1
    s_cmp_lt_u32 s14, 64
    s_cbranch_scc1 layerb1_kernel_p2_step
    s_waitcnt vmcnt(0)
    s_barrier
    s_branch layerb1_kernel_end
layerb1_kernel_p3_start:
    v_lshrrev_b32 v16, 4, v0
    v_and_b32 v17, 15, v0
    v_and_b32 v18, 2, v0
    v_cmp_eq_u32 vcc, 0, v18
    v_mov_b32 v18, 0xeeeeeeee
    v_mov_b32 v19, 0x44444444
    v_cndmask_b32 v2, v18, v19, vcc
    v_lshrrev_b32 v20, 2, v17
    v_lshlrev_b32 v20, 1, v20
    v_and_b32 v21, 1, v17
    v_add_u32 v20, v20, v21
    v_bfe_u32 v21, v17, 1, 1
    v_lshl_add_u32 v18, v16, 1, v21
    v_lshlrev_b32 v18, 7, v18
    v_lshl_add_u32 v12, v20, 4, v18
    v_mul_u32_u24 v18, 400, v20
    v_lshl_add_u32 v18, v16, 5, v18
    v_lshl_add_u32 v18, v21, 4, v18
    v_add_u32 v4, 141312, v18
    v_mul_u32_u24 v18, 800, v16
    v_lshl_add_u32 v18, v17, 1, v18
    v_add_u32 v3, 141408, v18
    v_and_b32 v18, 7, v0
    v_mul_u32_u24 v18, 400, v18
    v_lshl_add_u32 v18, v16, 5, v18
    v_add_u32 v5, 144512, v18
    v_lshlrev_b32 v18, 3, v0
    v_add_u32 v6, 147712, v18
    v_lshlrev_b32 v18, 4, v16
    v_bfe_u32 v19, v17, 1, 2
    v_lshl_add_u32 v18, v19, 2, v18
    s_lshl_b32 s20, s12, 7
    s_add_u32 s20, s20, 64
    v_add_u32 v18, s20, v18
    v_lshrrev_b32 v19, 3, v17
    v_add_u32 v19, 3, v19
    v_lshrrev_b32 v20, 1, v19
    v_lshlrev_b32 v20, 14, v20
    v_and_b32 v19, 1, v19
    v_lshl_add_u32 v19, v19, 12, v20
    v_add_u32 v19, v19, v18
    v_mov_b32 v20, 0x7ffffff0
    v_and_b32 v21, 7, v0
    v_cmp_eq_u32 vcc, 4, v21
    v_subrev_u32 v21, 8, v18
    s_nop 0
    v_cndmask_b32 v7, v19, v21, vcc
    v_and_b32 v21, 0x29, v0
    v_cmp_eq_u32 vcc, 32, v21
    s_nop 1
    v_cndmask_b32 v8, v20, v18, vcc
    s_lshl_b32 s20, s12, 2
    v_lshlrev_b32 v18, 7, v0
    v_add_u32 v8, s20, v18
    v_lshlrev_b32 v18, 4, v17
    v_lshl_add_u32 v18, v16, 10, v18
    v_add_u32 v9, 256, v18
    v_add_u32 v18, 192, v0
    v_mul_u32_u24 v19, 2731, v18
    v_lshrrev_b32 v19, 16, v19
    v_mul_u32_u24 v20, 24, v19
    v_sub_u32 v20, v18, v20
    v_mul_u32_u24 v21, 400, v19
    v_lshl_add_u32 v21, v20, 4, v21
    v_add_u32 v10, 144512, v21
    v_lshlrev_b32 v21, 4, v19
    v_lshl_add_u32 v11, v20, 7, v21
    v_add_u32 v13, 98304, v1
    v_add_u32 v14, 131072, v1
    s_mul_i32 s44, s12, 12288
    s_add_u32 s44, s44, 53477376
    s_mul_i32 s45, s12, 3072
    s_add_u32 s45, s45, 208666624
    s_mul_i32 s20, s12, 6
    s_add_u32 s21, s20, 5
    s_lshr_b32 s20, s20, 3
    s_lshr_b32 s21, s21, 3
    s_add_u32 s20, s20, 80
    s_add_u32 s21, s21, 80
    s_lshl_b32 s20, s20, 7
    s_lshl_b32 s21, s21, 7
    v_mov_b32 v255, s21
    v_mov_b32 v253, s20
    v_cmp_eq_u32 vcc, 0, v0
    s_nop 1
    v_cndmask_b32 v255, v255, v253, vcc
    s_mov_b32 s47, 0
    s_mul_i32 s20, s12, 491520
    s_add_u32 s20, s20, 11902976
    s_add_u32 s21, s20, 18432
    buffer_load_dwordx4 v[16:19], v1, s[8:11], s21 offen offset:0
    buffer_load_dwordx4 v[20:23], v1, s[8:11], s21 offen offset:1024
    s_add_u32 s21, s20, 79872
    buffer_load_dwordx4 v[24:27], v1, s[8:11], s21 offen offset:0
    buffer_load_dwordx4 v[28:31], v1, s[8:11], s21 offen offset:1024
    s_add_u32 s21, s20, 0
    buffer_load_dwordx4 v[32:35], v1, s[8:11], s21 offen offset:0
    buffer_load_dwordx4 v[36:39], v1, s[8:11], s21 offen offset:1024
    s_add_u32 s21, s20, 8192
    buffer_load_dwordx4 v[40:43], v1, s[8:11], s21 offen offset:0
    buffer_load_dwordx4 v[44:47], v1, s[8:11], s21 offen offset:1024
    s_add_u32 s21, s20, 20480
    buffer_load_dwordx4 v[48:51], v1, s[8:11], s21 offen offset:0
    buffer_load_dwordx4 v[52:55], v1, s[8:11], s21 offen offset:1024
    s_add_u32 s21, s20, 28672
    buffer_load_dwordx4 v[56:59], v1, s[8:11], s21 offen offset:0
    buffer_load_dwordx4 v[60:63], v1, s[8:11], s21 offen offset:1024
    s_add_u32 s21, s20, 40960
    buffer_load_dwordx4 v[64:67], v1, s[8:11], s21 offen offset:0
    buffer_load_dwordx4 v[68:71], v1, s[8:11], s21 offen offset:1024
    s_add_u32 s21, s20, 49152
    buffer_load_dwordx4 v[72:75], v1, s[8:11], s21 offen offset:0
    buffer_load_dwordx4 v[76:79], v1, s[8:11], s21 offen offset:1024
    s_add_u32 s21, s20, 61440
    buffer_load_dwordx4 v[80:83], v1, s[8:11], s21 offen offset:0
    buffer_load_dwordx4 v[84:87], v1, s[8:11], s21 offen offset:1024
    s_add_u32 s21, s20, 69632
    buffer_load_dwordx4 v[88:91], v1, s[8:11], s21 offen offset:0
    buffer_load_dwordx4 v[92:95], v1, s[8:11], s21 offen offset:1024
    s_add_u32 s21, s20, 81920
    buffer_load_dwordx4 v[96:99], v1, s[8:11], s21 offen offset:0
    buffer_load_dwordx4 v[100:103], v1, s[8:11], s21 offen offset:1024
    s_add_u32 s21, s20, 90112
    buffer_load_dwordx4 v[104:107], v1, s[8:11], s21 offen offset:0
    buffer_load_dwordx4 v[108:111], v1, s[8:11], s21 offen offset:1024
    s_add_u32 s21, s20, 96256
    buffer_load_dwordx4 v[112:115], v1, s[8:11], s21 offen offset:0
    buffer_load_dwordx4 v[116:119], v1, s[8:11], s21 offen offset:1024
    s_add_u32 s21, s20, 106496
    buffer_load_dwordx4 v[120:123], v1, s[8:11], s21 offen offset:0
    buffer_load_dwordx4 v[124:127], v1, s[8:11], s21 offen offset:1024
    s_add_u32 s21, s20, 112640
    buffer_load_dwordx4 v[128:131], v1, s[8:11], s21 offen offset:0
    buffer_load_dwordx4 v[132:135], v1, s[8:11], s21 offen offset:1024
    s_add_u32 s21, s20, 116736
    buffer_load_dwordx4 v[136:139], v1, s[8:11], s21 offen offset:0
    buffer_load_dwordx4 v[140:143], v1, s[8:11], s21 offen offset:1024
    s_add_u32 s21, s20, 75776
    buffer_load_dwordx4 v[156:159], v1, s[8:11], s21 offen offset:0
    buffer_load_dwordx4 v[160:163], v1, s[8:11], s21 offen offset:1024
    s_add_u32 s21, s20, 83968
    buffer_load_dwordx4 v[164:167], v1, s[8:11], s21 offen offset:0
    buffer_load_dwordx4 v[168:171], v1, s[8:11], s21 offen offset:1024
    s_add_u32 s21, s20, 86016
    buffer_load_dwordx4 v[172:175], v1, s[8:11], s21 offen offset:0
    buffer_load_dwordx4 v[176:179], v1, s[8:11], s21 offen offset:1024
    s_add_u32 s21, s20, 88064
    buffer_load_dwordx4 v[180:183], v1, s[8:11], s21 offen offset:0
    buffer_load_dwordx4 v[184:187], v1, s[8:11], s21 offen offset:1024
    s_add_u32 s21, s20, 92160
    buffer_load_dwordx4 v[188:191], v1, s[8:11], s21 offen offset:0
    buffer_load_dwordx4 v[192:195], v1, s[8:11], s21 offen offset:1024
    s_add_u32 s21, s20, 94208
    buffer_load_dwordx4 v[196:199], v1, s[8:11], s21 offen offset:0
    buffer_load_dwordx4 v[200:203], v1, s[8:11], s21 offen offset:1024
    s_add_u32 s21, s20, 102400
    buffer_load_dwordx4 v[204:207], v1, s[8:11], s21 offen offset:0
    buffer_load_dwordx4 v[208:211], v1, s[8:11], s21 offen offset:1024
    s_add_u32 s21, s20, 104448
    buffer_load_dwordx4 v[212:215], v1, s[8:11], s21 offen offset:0
    buffer_load_dwordx4 v[216:219], v1, s[8:11], s21 offen offset:1024
    s_add_u32 s21, s20, 108544
    buffer_load_dwordx4 v[220:223], v1, s[8:11], s21 offen offset:0
    buffer_load_dwordx4 v[224:227], v1, s[8:11], s21 offen offset:1024
    s_add_u32 s21, s20, 110592
    buffer_load_dwordx4 v[228:231], v1, s[8:11], s21 offen offset:0
    buffer_load_dwordx4 v[232:235], v1, s[8:11], s21 offen offset:1024
    s_add_u32 s21, s20, 114688
    buffer_load_dwordx4 v[236:239], v1, s[8:11], s21 offen offset:0
    buffer_load_dwordx4 v[240:243], v1, s[8:11], s21 offen offset:1024
    s_add_u32 s21, s20, 120832
    buffer_load_dwordx4 v[244:247], v1, s[8:11], s21 offen offset:0
    buffer_load_dwordx4 v[248:251], v1, s[8:11], s21 offen offset:1024
    s_waitcnt vmcnt(24)
    ds_write_b128 v13, v[16:19] offset:0
    ds_write_b128 v13, v[20:23] offset:1024
    ds_write_b128 v13, v[24:27] offset:2048
    ds_write_b128 v13, v[28:31] offset:3072
    ds_write_b128 v13, v[32:35] offset:4096
    ds_write_b128 v13, v[36:39] offset:5120
    ds_write_b128 v13, v[40:43] offset:6144
    ds_write_b128 v13, v[44:47] offset:7168
    ds_write_b128 v13, v[48:51] offset:8192
    ds_write_b128 v13, v[52:55] offset:9216
    ds_write_b128 v13, v[56:59] offset:10240
    ds_write_b128 v13, v[60:63] offset:11264
    ds_write_b128 v13, v[64:67] offset:12288
    ds_write_b128 v13, v[68:71] offset:13312
    ds_write_b128 v13, v[72:75] offset:14336
    ds_write_b128 v13, v[76:79] offset:15360
    ds_write_b128 v13, v[80:83] offset:16384
    ds_write_b128 v13, v[84:87] offset:17408
    ds_write_b128 v13, v[88:91] offset:18432
    ds_write_b128 v13, v[92:95] offset:19456
    ds_write_b128 v13, v[96:99] offset:20480
    ds_write_b128 v13, v[100:103] offset:21504
    ds_write_b128 v13, v[104:107] offset:22528
    ds_write_b128 v13, v[108:111] offset:23552
    ds_write_b128 v13, v[112:115] offset:24576
    ds_write_b128 v13, v[116:119] offset:25600
    ds_write_b128 v13, v[120:123] offset:26624
    ds_write_b128 v13, v[124:127] offset:27648
    ds_write_b128 v13, v[128:131] offset:28672
    ds_write_b128 v13, v[132:135] offset:29696
    ds_write_b128 v13, v[136:139] offset:30720
    ds_write_b128 v13, v[140:143] offset:31744
    s_waitcnt lgkmcnt(0)
    s_add_u32 s20, s48, 51200
    s_mov_b64 exec, 3
    v_lshlrev_b32 v16, 2, v0
layerb1_kernel_p3_par:
    buffer_load_dword v17, v16, s[8:11], s20 offen sc1
    s_waitcnt vmcnt(0)
    v_cmp_eq_u32 vcc, 0, v17
    s_sub_u32 s15, s15, 1
    s_cbranch_scc1 layerb1_kernel_bail
    s_cbranch_vccnz layerb1_kernel_p3_par
    s_mov_b64 exec, -1
    v_readlane_b32 s20, v17, 0
    v_readlane_b32 s21, v17, 1
    s_nop 0
    s_and_b32 s20, s20, 8192
    s_and_b32 s21, s21, 8192
    s_add_u32 s16, s16, s20
    s_add_u32 s17, s17, s21
    s_mov_b32 s14, 0
    s_cmp_gt_u32 s47, s14
    s_cbranch_scc1 layerb1_kernel_p3_gw1_ok
layerb1_kernel_p3_gw1_lp:
    buffer_load_dword v253, v255, s[8:11], s48 offen sc1
    s_waitcnt vmcnt(0)
    v_readlane_b32 s47, v253, 0
    v_readlane_b32 s29, v253, 1
    s_nop 0
    s_min_u32 s47, s47, s29
    s_sub_u32 s15, s15, 1
    s_cbranch_scc1 layerb1_kernel_bail
    s_cmp_gt_u32 s47, s14
    s_cbranch_scc0 layerb1_kernel_p3_gw1_lp
layerb1_kernel_p3_gw1_ok:
    s_mul_i32 s20, s14, 393216
    s_add_u32 s20, s20, s44
    s_add_u32 s21, s20, 0
    buffer_load_dwordx4 v[100:103], v9, s[8:11], s21 offen offset:0 sc1
    buffer_load_dwordx4 v[104:107], v9, s[8:11], s21 offen offset:512 sc1
    s_add_u32 s21, s20, 4096
    buffer_load_dwordx4 v[108:111], v9, s[8:11], s21 offen offset:0 sc1
    buffer_load_dwordx4 v[112:115], v9, s[8:11], s21 offen offset:512 sc1
    s_add_u32 s21, s20, 8192
    buffer_load_dwordx4 v[116:119], v9, s[8:11], s21 offen offset:0 sc1
    buffer_load_dwordx4 v[120:123], v9, s[8:11], s21 offen offset:512 sc1
    v_mov_b32 v56, 0
    v_mov_b32 v57, 0
    v_mov_b32 v58, 0
    v_mov_b32 v59, 0
    v_mov_b32 v60, 0
    v_mov_b32 v61, 0
    v_mov_b32 v62, 0
    v_mov_b32 v63, 0
    v_mov_b32 v64, 0
    v_mov_b32 v65, 0
    v_mov_b32 v66, 0
    v_mov_b32 v67, 0
    v_mov_b32 v68, 0
    v_mov_b32 v69, 0
    v_mov_b32 v70, 0
    v_mov_b32 v71, 0
    v_mov_b32 v72, 0
    v_mov_b32 v73, 0
    v_mov_b32 v74, 0
    v_mov_b32 v75, 0
    v_mov_b32 v76, 0
    v_mov_b32 v77, 0
    v_mov_b32 v78, 0
    v_mov_b32 v79, 0
    v_mov_b32 v80, 0
    v_mov_b32 v81, 0
    v_mov_b32 v82, 0
    v_mov_b32 v83, 0
    v_mov_b32 v84, 0
    v_mov_b32 v85, 0
    v_mov_b32 v86, 0
    v_mov_b32 v87, 0
    ds_read_b128 v[124:127], v13 offset:0
    ds_read_b128 v[128:131], v13 offset:1024
    ds_read_b128 v[132:135], v13 offset:2048
    ds_read_b128 v[136:139], v13 offset:3072
    ds_read_b128 v[140:143], v13 offset:4096
    ds_read_b128 v[144:147], v13 offset:5120
    ds_read_b128 v[148:151], v13 offset:6144
    ds_read_b128 v[152:155], v13 offset:7168
    s_waitcnt lgkmcnt(0)
layerb1_kernel_p3_step:
    s_cmp_lt_u32 s14, 32
    s_cselect_b32 s18, s16, s17
    s_and_b32 s20, s14, 31
    s_lshl_b32 s20, s20, 16
    s_add_u32 s18, s18, s20
    s_add_u32 s69, s18, 55424
    s_add_u32 s22, s18, 53248
    s_add_u32 s23, s18, 54272
layerb1_kernel_p3_poll:
    buffer_load_dwordx4 v[48:51], v12, s[8:11], s22 offen sc1
    buffer_load_dwordx4 v[52:55], v12, s[8:11], s23 offen sc1
    s_waitcnt vmcnt(0)
    ds_write_b128 v14, v[48:51] offset:8192
    ds_write_b128 v14, v[52:55] offset:9216
    v_max3_u32 v88, v48, v49, v50
    v_max3_u32 v88, v88, v51, v52
    v_max3_u32 v88, v88, v53, v54
    v_max_u32 v88, v88, v55
    v_cmp_eq_u32 vcc, -1, v88
    s_sub_u32 s15, s15, 1
    s_cbranch_scc1 layerb1_kernel_bail
    s_cbranch_vccnz layerb1_kernel_p3_poll
    v_smfmac_f32_16x16x64_bf16 v[56:59], v[48:51], a[0:7], v2
    v_smfmac_f32_16x16x64_bf16 v[60:63], v[48:51], a[8:15], v2
    v_smfmac_f32_16x16x64_bf16 v[64:67], v[48:51], a[16:23], v2
    v_smfmac_f32_16x16x64_bf16 v[56:59], v[52:55], v[124:131], v2
    ds_read_b128 v[124:127], v13 offset:8192
    v_smfmac_f32_16x16x64_bf16 v[60:63], v[52:55], a[24:31], v2
    s_waitcnt lgkmcnt(1)
    s_barrier
    v_smfmac_f32_16x16x64_bf16 v[64:67], v[52:55], a[32:39], v2
    ds_read_b128 v[16:19], v14 offset:0
    v_smfmac_f32_16x16x64_bf16 v[68:71], v[48:51], a[40:47], v2
    ds_read_b128 v[20:23], v14 offset:1024
    v_smfmac_f32_16x16x64_bf16 v[68:71], v[52:55], v[132:139], v2
    ds_read_b128 v[24:27], v14 offset:2048
    v_smfmac_f32_16x16x64_bf16 v[72:75], v[48:51], a[48:55], v2
    ds_read_b128 v[28:31], v14 offset:3072
    v_smfmac_f32_16x16x64_bf16 v[72:75], v[52:55], a[56:63], v2
    ds_read_b128 v[32:35], v14 offset:4096
    v_smfmac_f32_16x16x64_bf16 v[76:79], v[48:51], a[64:71], v2
    s_waitcnt lgkmcnt(4)
    ds_read_b128 v[36:39], v14 offset:5120
    v_smfmac_f32_16x16x64_bf16 v[56:59], v[16:19], v[140:147], v2
    s_waitcnt lgkmcnt(4)
    ds_read_b128 v[40:43], v14 offset:6144
    v_smfmac_f32_16x16x64_bf16 v[56:59], v[20:23], a[72:79], v2
    s_waitcnt lgkmcnt(4)
    ds_read_b128 v[44:47], v14 offset:7168
    v_smfmac_f32_16x16x64_bf16 v[56:59], v[24:27], a[80:87], v2
    s_waitcnt lgkmcnt(4)
    ds_read_b128 v[128:131], v13 offset:9216
    v_smfmac_f32_16x16x64_bf16 v[56:59], v[28:31], a[88:95], v2
    s_waitcnt lgkmcnt(4)
    ds_read_b128 v[132:135], v13 offset:10240
    v_smfmac_f32_16x16x64_bf16 v[56:59], v[32:35], v[148:155], v2
    s_waitcnt lgkmcnt(4)
    ds_read_b128 v[136:139], v13 offset:11264
    v_smfmac_f32_16x16x64_bf16 v[56:59], v[36:39], a[96:103], v2
    s_waitcnt lgkmcnt(4)
    ds_read_b128 v[140:143], v13 offset:12288
    v_smfmac_f32_16x16x64_bf16 v[56:59], v[40:43], a[104:111], v2
    s_waitcnt lgkmcnt(4)
    ds_read_b128 v[144:147], v13 offset:13312
    v_smfmac_f32_16x16x64_bf16 v[56:59], v[44:47], a[112:119], v2
    s_waitcnt lgkmcnt(4)
    ds_read_b128 v[148:151], v13 offset:14336
    v_smfmac_f32_16x16x64_bf16 v[60:63], v[16:19], v[124:131], v2
    ds_read_b128 v[152:155], v13 offset:15360
    v_smfmac_f32_16x16x64_bf16 v[60:63], v[20:23], a[120:127], v2
    ds_read_b128 v[124:127], v13 offset:16384
    v_add_f32 v56, v56, v58
    v_smfmac_f32_16x16x64_bf16 v[60:63], v[24:27], a[128:135], v2
    ds_read_b128 v[128:131], v13 offset:17408
    v_add_f32 v57, v57, v59
    v_smfmac_f32_16x16x64_bf16 v[60:63], v[28:31], a[136:143], v2
    s_waitcnt lgkmcnt(6)
    v_cvt_pk_bf16_f32 v56, v56, v57
    v_smfmac_f32_16x16x64_bf16 v[60:63], v[32:35], v[132:139], v2
    ds_write_b16 v3, v56 offset:0
    v_smfmac_f32_16x16x64_bf16 v[60:63], v[36:39], a[144:151], v2
    ds_write_b16_d16_hi v3, v56 offset:400
    v_smfmac_f32_16x16x64_bf16 v[60:63], v[40:43], a[152:159], v2
    ds_read_b128 v[132:135], v13 offset:18432
    v_smfmac_f32_16x16x64_bf16 v[60:63], v[44:47], a[160:167], v2
    s_waitcnt lgkmcnt(7)
    ds_read_b128 v[136:139], v13 offset:19456
    v_smfmac_f32_16x16x64_bf16 v[64:67], v[16:19], v[140:147], v2
    ds_read_b128 v[140:143], v13 offset:20480
    v_smfmac_f32_16x16x64_bf16 v[64:67], v[20:23], a[168:175], v2
    ds_read_b128 v[144:147], v13 offset:21504
    v_add_f32 v60, v60, v62
    v_smfmac_f32_16x16x64_bf16 v[64:67], v[24:27], a[176:183], v2
    v_add_f32 v61, v61, v63
    v_smfmac_f32_16x16x64_bf16 v[64:67], v[28:31], a[184:191], v2
    s_waitcnt lgkmcnt(8)
    v_cvt_pk_bf16_f32 v60, v60, v61
    v_smfmac_f32_16x16x64_bf16 v[64:67], v[32:35], v[148:155], v2
    ds_write_b16 v3, v60 offset:128
    v_smfmac_f32_16x16x64_bf16 v[64:67], v[36:39], a[192:199], v2
    ds_write_b16_d16_hi v3, v60 offset:528
    v_smfmac_f32_16x16x64_bf16 v[64:67], v[40:43], a[200:207], v2
    ds_read_b128 v[148:151], v13 offset:22528
    v_smfmac_f32_16x16x64_bf16 v[64:67], v[44:47], a[208:215], v2
    s_waitcnt lgkmcnt(9)
    ds_read_b128 v[152:155], v13 offset:23552
    v_smfmac_f32_16x16x64_bf16 v[68:71], v[16:19], v[124:131], v2
    ds_read_b128 v[124:127], v13 offset:24576
    v_smfmac_f32_16x16x64_bf16 v[68:71], v[20:23], a[216:223], v2
    ds_read_b128 v[128:131], v13 offset:25600
    v_add_f32 v64, v64, v66
    v_smfmac_f32_16x16x64_bf16 v[68:71], v[24:27], a[224:231], v2
    v_add_f32 v65, v65, v67
    v_smfmac_f32_16x16x64_bf16 v[68:71], v[28:31], a[232:239], v2
    s_waitcnt lgkmcnt(8)
    v_cvt_pk_bf16_f32 v64, v64, v65
    v_smfmac_f32_16x16x64_bf16 v[68:71], v[32:35], v[132:139], v2
    ds_write_b16 v3, v64 offset:256
    v_smfmac_f32_16x16x64_bf16 v[68:71], v[36:39], a[240:247], v2
    ds_write_b16_d16_hi v3, v64 offset:656
    v_smfmac_f32_16x16x64_bf16 v[68:71], v[40:43], a[248:255], v2
    ds_read_b128 v[132:135], v13 offset:26624
    v_smfmac_f32_16x16x64_bf16 v[68:71], v[44:47], v[156:163], v2
    s_waitcnt lgkmcnt(9)
    ds_read_b128 v[136:139], v13 offset:27648
    v_smfmac_f32_16x16x64_bf16 v[72:75], v[16:19], v[140:147], v2
    ds_read_b128 v[140:143], v13 offset:28672
    v_smfmac_f32_16x16x64_bf16 v[72:75], v[20:23], v[164:171], v2
    s_waitcnt lgkmcnt(3)
    s_barrier
    v_add_f32 v68, v68, v70
    v_smfmac_f32_16x16x64_bf16 v[72:75], v[24:27], v[172:179], v2
    ds_read_b128 v[88:91], v4 offset:0
    v_add_f32 v69, v69, v71
    v_smfmac_f32_16x16x64_bf16 v[72:75], v[28:31], v[180:187], v2
    ds_read_b128 v[92:95], v4 offset:128
    v_cvt_pk_bf16_f32 v68, v68, v69
    v_smfmac_f32_16x16x64_bf16 v[72:75], v[32:35], v[148:155], v2
    ds_read_b128 v[96:99], v4 offset:256
    v_smfmac_f32_16x16x64_bf16 v[72:75], v[36:39], v[188:195], v2
    ds_write_b16 v3, v68 offset:3200
    v_smfmac_f32_16x16x64_bf16 v[72:75], v[40:43], v[196:203], v2
    ds_write_b16_d16_hi v3, v68 offset:3600
    v_smfmac_f32_16x16x64_bf16 v[72:75], v[44:47], v[124:131], v2
    s_waitcnt lgkmcnt(4)
    ds_read_b128 v[144:147], v13 offset:29696
    v_smfmac_f32_16x16x64_bf16 v[80:83], v[88:91], v[100:107], v2
    s_waitcnt lgkmcnt(4)
    ds_read_b128 v[148:151], v13 offset:30720
    v_smfmac_f32_16x16x64_bf16 v[80:83], v[92:95], v[108:115], v2
    s_waitcnt lgkmcnt(4)
    ds_read_b128 v[152:155], v13 offset:31744
    v_add_f32 v72, v72, v74
    v_smfmac_f32_16x16x64_bf16 v[80:83], v[96:99], v[116:123], v2
    v_add_f32 v73, v73, v75
    v_smfmac_f32_16x16x64_bf16 v[76:79], v[16:19], v[204:211], v2
    v_cvt_pk_bf16_f32 v72, v72, v73
    v_smfmac_f32_16x16x64_bf16 v[76:79], v[20:23], v[212:219], v2
    ds_write_b16 v3, v72 offset:3328
    v_smfmac_f32_16x16x64_bf16 v[76:79], v[24:27], v[132:139], v2
    ds_write_b16_d16_hi v3, v72 offset:3728
    v_smfmac_f32_16x16x64_bf16 v[76:79], v[28:31], v[220:227], v2
    v_add_f32 v56, v81, v83
    v_smfmac_f32_16x16x64_bf16 v[76:79], v[32:35], v[228:235], v2
    s_waitcnt lgkmcnt(4)
    v_mul_f32 v56, 0x3dd53b95, v56
    v_smfmac_f32_16x16x64_bf16 v[76:79], v[36:39], v[140:147], v2
    s_waitcnt lgkmcnt(0)
    s_barrier
    v_max_f32_dpp v58, v56, v56 row_ror:8 row_mask:0xf bank_mask:0xf
    v_smfmac_f32_16x16x64_bf16 v[76:79], v[40:43], v[236:243], v2
    ds_read_b128 v[100:103], v5 offset:0
    v_max_f32_dpp v58, v58, v58 row_ror:4 row_mask:0xf bank_mask:0xf
    v_smfmac_f32_16x16x64_bf16 v[76:79], v[44:47], v[148:155], v2
    ds_read_b128 v[104:107], v5 offset:16
    v_max_f32_dpp v58, v58, v58 row_ror:2 row_mask:0xf bank_mask:0xf
    v_smfmac_f32_16x16x64_bf16 v[76:79], v[52:55], v[244:251], v2
    ds_read_b128 v[108:111], v5 offset:128
    v_max_f32_dpp v58, v58, v58 row_ror:1 row_mask:0xf bank_mask:0xf
    ds_read_b128 v[112:115], v5 offset:144
    v_sub_f32 v60, v56, v58
    s_nop 1
    v_exp_f32 v60, v60
    s_nop 1
    v_add_f32_dpp v59, v60, v60 row_ror:8 row_mask:0xf bank_mask:0xf
    s_nop 1
    v_add_f32_dpp v59, v59, v59 row_ror:4 row_mask:0xf bank_mask:0xf
    s_nop 1
    v_add_f32_dpp v59, v59, v59 row_ror:2 row_mask:0xf bank_mask:0xf
    s_nop 1
    v_add_f32_dpp v59, v59, v59 row_ror:1 row_mask:0xf bank_mask:0xf
    v_add_f32 v76, v76, v78
    v_add_f32 v77, v77, v79
    v_cvt_pk_bf16_f32 v76, v76, v77
    ds_write_b16 v3, v76 offset:3456
    ds_write_b16_d16_hi v3, v76 offset:3856
    ds_write_b64 v6, v[58:59] offset:1536
    s_waitcnt lgkmcnt(5)
    v_smfmac_f32_16x16x64_bf16 v[84:87], v[88:91], v[100:107], v2
    s_waitcnt lgkmcnt(3)
    v_smfmac_f32_16x16x64_bf16 v[84:87], v[92:95], v[108:115], v2
    s_waitcnt lgkmcnt(0)
    s_barrier
    ds_read_b128 v[116:119], v5 offset:256
    ds_read_b128 v[120:123], v5 offset:272
    ds_read_b64 v[16:17], v6 offset:1024
    s_waitcnt lgkmcnt(1)
    v_smfmac_f32_16x16x64_bf16 v[84:87], v[96:99], v[116:123], v2
    s_waitcnt lgkmcnt(0)
    v_max_f32 v18, v58, v16
    v_sub_f32 v19, v58, v18
    v_sub_f32 v20, v16, v18
    v_exp_f32 v19, v19
    v_exp_f32 v20, v20
    s_nop 0
    v_mul_f32 v21, v59, v19
    v_mul_f32 v60, v60, v19
    v_fmac_f32 v21, v17, v20
    v_add_f32 v22, v85, v87
    v_mul_f32 v22, 0x3dd53b95, v22
    v_max_f32 v23, v22, v18
    s_nop 0
    v_max_f32_dpp v24, v22, v23 row_ror:4 row_mask:0xf bank_mask:0xf
    s_nop 1
    v_max_f32_dpp v24, v24, v24 row_ror:2 row_mask:0xf bank_mask:0xf
    s_nop 1
    v_max_f32_dpp v24, v24, v24 row_ror:1 row_mask:0xf bank_mask:0xf
    v_sub_f32 v25, v22, v24
    v_sub_f32 v26, v18, v24
    v_exp_f32 v25, v25
    v_exp_f32 v26, v26
    s_nop 0
    v_add_f32_dpp v23, v25, v25 row_ror:4 row_mask:0xf bank_mask:0xf
    v_mul_f32 v60, v60, v26
    s_nop 0
    v_add_f32_dpp v23, v23, v23 row_ror:2 row_mask:0xf bank_mask:0xf
    s_nop 1
    v_add_f32_dpp v23, v23, v23 row_ror:1 row_mask:0xf bank_mask:0xf
    v_fmac_f32 v23, v26, v21
    v_rcp_f32 v27, v23
    s_nop 0
    v_mul_f32 v60, v60, v27
    v_mul_f32 v25, v25, v27
    s_nop 0
    v_mov_b32_dpp v19, v60 quad_perm:[1,0,3,2] row_mask:0xf bank_mask:0xf
    v_mov_b32_dpp v20, v25 quad_perm:[1,0,3,2] row_mask:0xf bank_mask:0xf
    v_cvt_pk_bf16_f32 v28, v60, v19
    v_cvt_pk_bf16_f32 v25, v25, v20
    s_nop 0
    v_mov_b32_dpp v29, v28 row_shl:2 row_mask:0xf bank_mask:0xf
    v_mov_b32_dpp v30, v28 row_shl:4 row_mask:0xf bank_mask:0xf
    v_mov_b32_dpp v31, v28 row_shl:6 row_mask:0xf bank_mask:0xf
    v_mov_b32_dpp v28, v25 row_shr:4 row_mask:0xf bank_mask:0x2
    v_mov_b32_dpp v29, v25 row_shr:2 row_mask:0xf bank_mask:0x2
    v_mov_b32_dpp v30, v25 quad_perm:[0,1,2,3] row_mask:0xf bank_mask:0x2
    v_mov_b32_dpp v31, v25 row_shl:2 row_mask:0xf bank_mask:0x2
    s_mov_b32 exec_lo, 0x1010101
    s_mov_b32 exec_hi, 0x1110111
    buffer_store_dwordx4 v[28:31], v7, s[8:11], s18 offen sc1
    s_mov_b64 exec, -1
    s_add_u32 s28, s14, 1
    s_min_u32 s28, s28, 63
    s_cmp_gt_u32 s47, s28
    s_cbranch_scc1 layerb1_kernel_p3_gw2_ok
layerb1_kernel_p3_gw2_lp:
    buffer_load_dword v253, v255, s[8:11], s48 offen sc1
    s_waitcnt vmcnt(0)
    v_readlane_b32 s47, v253, 0
    v_readlane_b32 s29, v253, 1
    s_nop 0
    s_min_u32 s47, s47, s29
    s_sub_u32 s15, s15, 1
    s_cbranch_scc1 layerb1_kernel_bail
    s_cmp_gt_u32 s47, s28
    s_cbranch_scc0 layerb1_kernel_p3_gw2_lp
layerb1_kernel_p3_gw2_ok:
    s_mul_i32 s20, s28, 393216
    s_add_u32 s20, s20, s44
    s_add_u32 s21, s20, 0
    buffer_load_dwordx4 v[100:103], v9, s[8:11], s21 offen offset:0 sc1
    buffer_load_dwordx4 v[104:107], v9, s[8:11], s21 offen offset:512 sc1
    s_add_u32 s21, s20, 4096
    buffer_load_dwordx4 v[108:111], v9, s[8:11], s21 offen offset:0 sc1
    buffer_load_dwordx4 v[112:115], v9, s[8:11], s21 offen offset:512 sc1
    s_add_u32 s21, s20, 8192
    buffer_load_dwordx4 v[116:119], v9, s[8:11], s21 offen offset:0 sc1
    buffer_load_dwordx4 v[120:123], v9, s[8:11], s21 offen offset:512 sc1
    v_mov_b32 v56, 0
    v_mov_b32 v57, 0
    v_mov_b32 v58, 0
    v_mov_b32 v59, 0
    v_mov_b32 v60, 0
    v_mov_b32 v61, 0
    v_mov_b32 v62, 0
    v_mov_b32 v63, 0
    v_mov_b32 v64, 0
    v_mov_b32 v65, 0
    v_mov_b32 v66, 0
    v_mov_b32 v67, 0
    v_mov_b32 v68, 0
    v_mov_b32 v69, 0
    v_mov_b32 v70, 0
    v_mov_b32 v71, 0
    v_mov_b32 v72, 0
    v_mov_b32 v73, 0
    v_mov_b32 v74, 0
    v_mov_b32 v75, 0
    v_mov_b32 v76, 0
    v_mov_b32 v77, 0
    v_mov_b32 v78, 0
    v_mov_b32 v79, 0
    v_mov_b32 v80, 0
    v_mov_b32 v81, 0
    v_mov_b32 v82, 0
    v_mov_b32 v83, 0
    v_mov_b32 v84, 0
    v_mov_b32 v85, 0
    v_mov_b32 v86, 0
    v_mov_b32 v87, 0
    s_lshl_b32 s20, s12, 7
    s_add_u32 s20, s20, 16384
    s_mov_b64 exec, 1
    v_mov_b32 v253, s20
    v_mov_b32 v254, s14
    buffer_store_dword v254, v253, s[8:11], s48 offen sc1
    s_mov_b64 exec, -1
    ds_read_b128 v[124:127], v13 offset:0
    ds_read_b128 v[128:131], v13 offset:1024
    ds_read_b128 v[132:135], v13 offset:2048
    ds_read_b128 v[136:139], v13 offset:3072
    ds_read_b128 v[140:143], v13 offset:4096
    ds_read_b128 v[144:147], v13 offset:5120
    ds_read_b128 v[148:151], v13 offset:6144
    ds_read_b128 v[152:155], v13 offset:7168
    s_waitcnt lgkmcnt(0)
    s_add_u32 s14, s14, 1
    s_cmp_lt_u32 s14, 64
    s_cbranch_scc1 layerb1_kernel_p3_step
    s_waitcnt vmcnt(0)
    s_barrier
    s_lshl_b32 s20, s12, 7
    s_add_u32 s20, s20, 16384
    s_mov_b64 exec, 1
    v_mov_b32 v253, s20
    v_mov_b32 v254, s14
    buffer_store_dword v254, v253, s[8:11], s48 offen sc1
    s_mov_b64 exec, -1
    s_branch layerb1_kernel_end
layerb1_kernel_y0_start:
    v_lshrrev_b32 v16, 4, v0
    v_and_b32 v17, 7, v0
    v_lshrrev_b32 v18, 3, v0
    v_and_b32 v18, 1, v18
    v_lshl_add_u32 v19, v18, 2, v16
    v_add_u32 v19, 0, v19
    v_mul_u32_u24 v20, 640, v19
    v_lshl_add_u32 v4, v17, 4, v20
    v_and_b32 v20, 1, v17
    v_lshlrev_b32 v20, 2, v20
    v_lshrrev_b32 v21, 1, v17
    v_add_u32 v20, v20, v21
    v_lshlrev_b32 v20, 4, v20
    v_lshl_add_u32 v5, v19, 7, v20
    v_add_u32 v3, 0, v1
    v_lshrrev_b32 v20, 1, v17
    v_lshlrev_b32 v20, 7, v20
    v_and_b32 v21, 1, v17
    v_lshl_add_u32 v20, v21, 2, v20
    v_add_u32 v10, 0, v20
    v_and_b32 v10, 31, v0
    v_lshlrev_b32 v10, 2, v10
    v_lshlrev_b32 v20, 8, v18
    v_lshl_add_u32 v20, v17, 5, v20
    v_and_b32 v21, 1, v16
    v_lshl_add_u32 v20, v21, 4, v20
    v_add_u32 v20, 10240, v20
    v_add_u32 v21, 12288, v1
    v_lshrrev_b32 v22, 1, v16
    v_cmp_eq_u32 vcc, v22, v18
    s_nop 1
    v_cndmask_b32 v6, v21, v20, vcc
    v_lshrrev_b32 v20, 3, v0
    v_lshlrev_b32 v20, 2, v20
    v_lshl_add_u32 v20, v17, 5, v20
    v_add_u32 v7, 10240, v20
    s_lshl_b32 s20, s12, 7
    s_add_u32 s20, s20, 20480
    s_lshr_b32 s21, s20, 13
    s_lshl_b32 s21, s21, 14
    s_and_b32 s20, s20, 8191
    s_add_u32 s20, s20, s21
    v_lshrrev_b32 v20, 3, v0
    v_lshlrev_b32 v20, 4, v20
    v_add_u32 v8, s20, v20
    s_mul_i32 s46, s12, 20480
    s_add_u32 s46, s46, 103809024
    s_mul_i32 s20, s12, 327680
    s_add_u32 s20, s20, 27262976
    s_add_u32 s21, s20, 65536
    buffer_load_dwordx4 v[176:179], v1, s[8:11], s21 offen offset:0
    buffer_load_dwordx4 v[180:183], v1, s[8:11], s21 offen offset:1024
    s_add_u32 s21, s20, 67584
    buffer_load_dwordx4 v[184:187], v1, s[8:11], s21 offen offset:0
    buffer_load_dwordx4 v[188:191], v1, s[8:11], s21 offen offset:1024
    s_add_u32 s21, s20, 69632
    buffer_load_dwordx4 v[192:195], v1, s[8:11], s21 offen offset:0
    buffer_load_dwordx4 v[196:199], v1, s[8:11], s21 offen offset:1024
    s_add_u32 s21, s20, 71680
    buffer_load_dwordx4 v[200:203], v1, s[8:11], s21 offen offset:0
    buffer_load_dwordx4 v[204:207], v1, s[8:11], s21 offen offset:1024
    s_add_u32 s21, s20, 73728
    buffer_load_dwordx4 v[208:211], v1, s[8:11], s21 offen offset:0
    buffer_load_dwordx4 v[212:215], v1, s[8:11], s21 offen offset:1024
    s_add_u32 s21, s20, 75776
    buffer_load_dwordx4 v[216:219], v1, s[8:11], s21 offen offset:0
    buffer_load_dwordx4 v[220:223], v1, s[8:11], s21 offen offset:1024
    s_add_u32 s21, s20, 77824
    buffer_load_dwordx4 v[224:227], v1, s[8:11], s21 offen offset:0
    buffer_load_dwordx4 v[228:231], v1, s[8:11], s21 offen offset:1024
    s_add_u32 s21, s20, 79872
    buffer_load_dwordx4 v[232:235], v1, s[8:11], s21 offen offset:0
    buffer_load_dwordx4 v[236:239], v1, s[8:11], s21 offen offset:1024
    s_add_u32 s20, s48, 51200
    s_mov_b64 exec, 3
    v_lshlrev_b32 v16, 2, v0
layerb1_kernel_y0_par:
    buffer_load_dword v17, v16, s[8:11], s20 offen sc1
    s_waitcnt vmcnt(0)
    v_cmp_eq_u32 vcc, 0, v17
    s_sub_u32 s15, s15, 1
    s_cbranch_scc1 layerb1_kernel_bail
    s_cbranch_vccnz layerb1_kernel_y0_par
    s_mov_b64 exec, -1
    v_readlane_b32 s20, v17, 0
    v_readlane_b32 s21, v17, 1
    s_nop 0
    s_and_b32 s20, s20, 8192
    s_and_b32 s21, s21, 8192
    s_add_u32 s16, s16, s20
    s_add_u32 s17, s17, s21
    s_mov_b32 s14, 0
    s_lshl_b32 s20, s12, 7
    v_mov_b32 v9, s20
    s_mov_b32 s47, 0
layerb1_kernel_y0_step:
    s_cmp_lt_u32 s14, 32
    s_cselect_b32 s18, s16, s17
    s_and_b32 s20, s14, 31
    s_lshl_b32 s20, s20, 16
    s_add_u32 s18, s18, s20
    s_mul_i32 s28, s14, 1638400
    s_add_u32 s28, s28, s46
    v_mov_b32 v56, 0
    v_mov_b32 v57, 0
    v_mov_b32 v58, 0
    v_mov_b32 v59, 0
    v_mov_b32 v60, 0
    v_mov_b32 v61, 0
    v_mov_b32 v62, 0
    v_mov_b32 v63, 0
    v_mov_b32 v64, 0
    v_mov_b32 v65, 0
    v_mov_b32 v66, 0
    v_mov_b32 v67, 0
    v_mov_b32 v68, 0
    v_mov_b32 v69, 0
    v_mov_b32 v70, 0
    v_mov_b32 v71, 0
    s_add_u32 s22, s18, 36864
    s_add_u32 s23, s18, 37888
    s_add_u32 s24, s18, 38912
layerb1_kernel_y0_poll:
    buffer_load_dwordx4 v[16:19], v1, s[8:11], s22 offen sc1
    buffer_load_dwordx4 v[20:23], v1, s[8:11], s23 offen sc1
    buffer_load_dwordx4 v[24:27], v1, s[8:11], s24 offen sc1
    s_waitcnt vmcnt(0)
    ds_write_b128 v3, v[16:19] offset:0
    ds_write_b128 v3, v[20:23] offset:1024
    ds_write_b128 v3, v[24:27] offset:2048
    v_max3_u32 v116, v16, v17, v18
    v_max3_u32 v116, v116, v19, v20
    v_max3_u32 v116, v116, v21, v22
    v_max3_u32 v116, v116, v23, v24
    v_max3_u32 v116, v116, v25, v26
    v_max_u32 v116, v116, v27
    v_cmp_eq_u32 vcc, -1, v116
    s_sub_u32 s15, s15, 1
    s_cbranch_scc1 layerb1_kernel_bail
    s_cbranch_vccnz layerb1_kernel_y0_poll
    s_waitcnt lgkmcnt(0)
    s_barrier
    ds_read_b128 v[28:31], v3 offset:3072
    ds_read_b128 v[32:35], v3 offset:4096
    ds_read_b128 v[36:39], v3 offset:5120
    ds_read_b128 v[40:43], v3 offset:6144
    ds_read_b128 v[44:47], v3 offset:7168
    ds_read_b128 v[48:51], v3 offset:8192
    ds_read_b128 v[52:55], v3 offset:9216
    s_cmp_gt_u32 s47, s14
    s_cbranch_scc1 layerb1_kernel_y0_gw_ok
layerb1_kernel_y0_gw_lp:
    buffer_load_dword v116, v9, s[8:11], s48 offen sc1
    s_waitcnt vmcnt(0)
    v_readlane_b32 s47, v116, 0
    s_nop 0
    s_sub_u32 s15, s15, 1
    s_cbranch_scc1 layerb1_kernel_bail
    s_cmp_gt_u32 s47, s14
    s_cbranch_scc0 layerb1_kernel_y0_gw_lp
layerb1_kernel_y0_gw_ok:
    buffer_load_dwordx4 v[76:79], v4, s[8:11], s28 offen offset:128 sc1
    buffer_load_dwordx4 v[80:83], v4, s[8:11], s28 offen offset:256 sc1
    buffer_load_dwordx4 v[84:87], v4, s[8:11], s28 offen offset:384 sc1
    buffer_load_dwordx4 v[88:91], v4, s[8:11], s28 offen offset:512 sc1
    v_smfmac_f32_16x16x64_bf16 v[56:59], v[16:19], a[0:7], v2
    v_smfmac_f32_16x16x64_bf16 v[60:63], v[16:19], a[80:87], v2
    v_smfmac_f32_16x16x64_bf16 v[64:67], v[16:19], a[160:167], v2
    v_smfmac_f32_16x16x64_bf16 v[68:71], v[16:19], a[240:247], v2
    v_smfmac_f32_16x16x64_bf16 v[56:59], v[20:23], a[8:15], v2
    v_smfmac_f32_16x16x64_bf16 v[60:63], v[20:23], a[88:95], v2
    v_smfmac_f32_16x16x64_bf16 v[64:67], v[20:23], a[168:175], v2
    v_smfmac_f32_16x16x64_bf16 v[68:71], v[20:23], a[248:255], v2
    v_smfmac_f32_16x16x64_bf16 v[56:59], v[24:27], a[16:23], v2
    v_smfmac_f32_16x16x64_bf16 v[60:63], v[24:27], a[96:103], v2
    v_smfmac_f32_16x16x64_bf16 v[64:67], v[24:27], a[176:183], v2
    v_smfmac_f32_16x16x64_bf16 v[68:71], v[24:27], v[176:183], v2
    s_waitcnt lgkmcnt(6)
    v_smfmac_f32_16x16x64_bf16 v[56:59], v[28:31], a[24:31], v2
    v_smfmac_f32_16x16x64_bf16 v[60:63], v[28:31], a[104:111], v2
    v_smfmac_f32_16x16x64_bf16 v[64:67], v[28:31], a[184:191], v2
    v_smfmac_f32_16x16x64_bf16 v[68:71], v[28:31], v[184:191], v2
    s_waitcnt lgkmcnt(5)
    v_smfmac_f32_16x16x64_bf16 v[56:59], v[32:35], a[32:39], v2
    v_smfmac_f32_16x16x64_bf16 v[60:63], v[32:35], a[112:119], v2
    v_smfmac_f32_16x16x64_bf16 v[64:67], v[32:35], a[192:199], v2
    v_smfmac_f32_16x16x64_bf16 v[68:71], v[32:35], v[192:199], v2
    s_waitcnt lgkmcnt(4)
    v_smfmac_f32_16x16x64_bf16 v[56:59], v[36:39], a[40:47], v2
    v_smfmac_f32_16x16x64_bf16 v[60:63], v[36:39], a[120:127], v2
    v_smfmac_f32_16x16x64_bf16 v[64:67], v[36:39], a[200:207], v2
    v_smfmac_f32_16x16x64_bf16 v[68:71], v[36:39], v[200:207], v2
    s_waitcnt lgkmcnt(3)
    v_smfmac_f32_16x16x64_bf16 v[56:59], v[40:43], a[48:55], v2
    v_smfmac_f32_16x16x64_bf16 v[60:63], v[40:43], a[128:135], v2
    v_smfmac_f32_16x16x64_bf16 v[64:67], v[40:43], a[208:215], v2
    v_smfmac_f32_16x16x64_bf16 v[68:71], v[40:43], v[208:215], v2
    s_waitcnt lgkmcnt(2)
    v_smfmac_f32_16x16x64_bf16 v[56:59], v[44:47], a[56:63], v2
    v_smfmac_f32_16x16x64_bf16 v[60:63], v[44:47], a[136:143], v2
    v_smfmac_f32_16x16x64_bf16 v[64:67], v[44:47], a[216:223], v2
    v_smfmac_f32_16x16x64_bf16 v[68:71], v[44:47], v[216:223], v2
    s_waitcnt lgkmcnt(1)
    v_smfmac_f32_16x16x64_bf16 v[56:59], v[48:51], a[64:71], v2
    v_smfmac_f32_16x16x64_bf16 v[60:63], v[48:51], a[144:151], v2
    v_smfmac_f32_16x16x64_bf16 v[64:67], v[48:51], a[224:231], v2
    v_smfmac_f32_16x16x64_bf16 v[68:71], v[48:51], v[224:231], v2
    s_waitcnt lgkmcnt(0)
    v_smfmac_f32_16x16x64_bf16 v[56:59], v[52:55], a[72:79], v2
    v_smfmac_f32_16x16x64_bf16 v[60:63], v[52:55], a[152:159], v2
    v_smfmac_f32_16x16x64_bf16 v[64:67], v[52:55], a[232:239], v2
    v_smfmac_f32_16x16x64_bf16 v[68:71], v[52:55], v[232:239], v2
    s_nop 7
    v_permlane32_swap_b32 v56, v64
    v_permlane32_swap_b32 v60, v68
    v_permlane32_swap_b32 v57, v65
    v_permlane32_swap_b32 v61, v69
    v_permlane32_swap_b32 v58, v66
    v_permlane32_swap_b32 v62, v70
    v_permlane32_swap_b32 v59, v67
    v_permlane32_swap_b32 v63, v71
    v_add_f32 v56, v56, v64
    v_add_f32 v60, v60, v68
    v_add_f32 v57, v57, v65
    v_add_f32 v61, v61, v69
    v_add_f32 v58, v58, v66
    v_add_f32 v62, v62, v70
    v_add_f32 v59, v59, v67
    v_add_f32 v63, v63, v71
    s_nop 1
    v_permlane16_swap_b32 v56, v60
    v_permlane16_swap_b32 v57, v61
    v_permlane16_swap_b32 v58, v62
    v_permlane16_swap_b32 v59, v63
    s_nop 1
    v_cvt_pk_bf16_f32 v72, v56, v57
    v_cvt_pk_bf16_f32 v73, v58, v59
    v_cvt_pk_bf16_f32 v74, v60, v61
    v_cvt_pk_bf16_f32 v75, v62, v63
    buffer_store_dwordx4 v[72:75], v4, s[8:11], s28 offen sc1
    s_cmp_eq_u32 s14, 63
    s_cbranch_scc1 layerb1_kernel_y0_last
    s_add_u32 s30, s18, 0
    s_add_u32 s31, s18, 4096
    s_add_u32 s32, s18, 16384
    s_add_u32 s33, s18, 20480
    s_add_u32 s34, s18, 32768
    s_add_u32 s29, s14, 1
    s_cmp_lt_u32 s29, 32
    s_cselect_b32 s19, s16, s17
    s_and_b32 s20, s29, 31
    s_lshl_b32 s20, s20, 16
    s_add_u32 s19, s19, s20
    s_and_b32 s69, s12, 0
    s_lshl_b32 s69, s69, 7
    s_add_u32 s69, s69, s18
    s_add_u32 s69, s69, 55424
    s_mov_b32 exec_lo, -1
    s_mov_b32 exec_hi, 0
layerb1_kernel_y0_hpoll:
    buffer_load_dword v116, v10, s[8:11], s69 offen sc1
    s_waitcnt vmcnt(0)
    v_cmp_eq_u32 vcc, -1, v116
    s_sub_u32 s15, s15, 1
    s_cbranch_scc1 layerb1_kernel_bail
    s_cbranch_vccnz layerb1_kernel_y0_hpoll
    s_mov_b64 exec, -1
    s_barrier
    buffer_load_dwordx4 v[92:95], v5, s[8:11], s30 offen sc1
    buffer_load_dwordx4 v[96:99], v5, s[8:11], s31 offen sc1
    buffer_load_dwordx4 v[100:103], v5, s[8:11], s32 offen sc1
    buffer_load_dwordx4 v[104:107], v5, s[8:11], s33 offen sc1
    buffer_load_dwordx4 v[108:111], v5, s[8:11], s34 offen sc1
    s_waitcnt vmcnt(0)
    v_mfma_f32_16x16x32_bf16 v[112:115], v[92:95], v[72:75], 0
    v_mfma_f32_16x16x32_bf16 v[112:115], v[96:99], v[76:79], v[112:115]
    v_mfma_f32_16x16x32_bf16 v[112:115], v[100:103], v[80:83], v[112:115]
    v_mfma_f32_16x16x32_bf16 v[112:115], v[104:107], v[84:87], v[112:115]
    v_mfma_f32_16x16x32_bf16 v[112:115], v[108:111], v[88:91], v[112:115]
    v_max3_u32 v116, v92, v93, v94
    v_max3_u32 v116, v116, v95, v96
    v_max3_u32 v116, v116, v97, v98
    v_max3_u32 v116, v116, v99, v100
    v_max3_u32 v116, v116, v101, v102
    v_max3_u32 v116, v116, v103, v104
    v_max3_u32 v116, v116, v105, v106
    v_max3_u32 v116, v116, v107, v108
    v_max3_u32 v116, v116, v109, v110
    v_max_u32 v116, v116, v111
    v_cmp_eq_u32 vcc, -1, v116
    s_cbranch_vccz layerb1_kernel_y0_ppz
layerb1_kernel_y0_ppoll:
    buffer_load_dwordx4 v[92:95], v5, s[8:11], s30 offen sc1
    buffer_load_dwordx4 v[96:99], v5, s[8:11], s31 offen sc1
    buffer_load_dwordx4 v[100:103], v5, s[8:11], s32 offen sc1
    buffer_load_dwordx4 v[104:107], v5, s[8:11], s33 offen sc1
    buffer_load_dwordx4 v[108:111], v5, s[8:11], s34 offen sc1
    s_waitcnt vmcnt(0)
    v_mfma_f32_16x16x32_bf16 v[112:115], v[92:95], v[72:75], 0
    v_mfma_f32_16x16x32_bf16 v[112:115], v[96:99], v[76:79], v[112:115]
    v_mfma_f32_16x16x32_bf16 v[112:115], v[100:103], v[80:83], v[112:115]
    v_mfma_f32_16x16x32_bf16 v[112:115], v[104:107], v[84:87], v[112:115]
    v_mfma_f32_16x16x32_bf16 v[112:115], v[108:111], v[88:91], v[112:115]
    v_max3_u32 v116, v92, v93, v94
    v_max3_u32 v116, v116, v95, v96
    v_max3_u32 v116, v116, v97, v98
    v_max3_u32 v116, v116, v99, v100
    v_max3_u32 v116, v116, v101, v102
    v_max3_u32 v116, v116, v103, v104
    v_max3_u32 v116, v116, v105, v106
    v_max3_u32 v116, v116, v107, v108
    v_max3_u32 v116, v116, v109, v110
    v_max_u32 v116, v116, v111
    v_cmp_eq_u32 vcc, -1, v116
    s_sub_u32 s15, s15, 1
    s_cbranch_scc1 layerb1_kernel_bail
    s_cbranch_vccnz layerb1_kernel_y0_ppoll
layerb1_kernel_y0_ppz:
    ds_write_b128 v6, v[112:115]
    s_waitcnt lgkmcnt(0)
    s_barrier
    ds_read2st64_b32 v[116:117], v7 offset0:0 offset1:1
    ds_read2st64_b32 v[118:119], v7 offset0:2 offset1:3
    ds_read2st64_b32 v[120:121], v7 offset0:4 offset1:5
    ds_read2st64_b32 v[122:123], v7 offset0:6 offset1:7
    s_waitcnt lgkmcnt(2)
    v_add_f32 v116, v116, v117
    v_add_f32 v118, v118, v119
    s_waitcnt lgkmcnt(0)
    v_add_f32 v120, v120, v121
    v_add_f32 v122, v122, v123
    v_add_f32 v116, v116, v118
    v_add_f32 v120, v120, v122
    v_add_f32 v116, v116, v120
    s_nop 1
    v_mov_b32_dpp v117, v116 quad_perm:[1,0,3,2] row_mask:0xf bank_mask:0xf
    v_cvt_pk_bf16_f32 v124, v116, v117
    s_nop 1
    v_mov_b32_dpp v125, v124 row_shl:2 row_mask:0xf bank_mask:0xf
    v_mov_b32_dpp v126, v124 row_shl:4 row_mask:0xf bank_mask:0xf
    v_mov_b32_dpp v127, v124 row_shl:6 row_mask:0xf bank_mask:0xf
    s_mov_b64 exec, s[40:41]
    buffer_store_dwordx4 v[124:127], v8, s[8:11], s19 offen sc1
    s_mov_b64 exec, -1
    s_lshl_b32 s20, s12, 7
    s_add_u32 s20, s20, 20480
    s_mov_b64 exec, 1
    v_mov_b32 v116, s20
    v_mov_b32 v117, s29
    buffer_store_dword v117, v116, s[8:11], s48 offen sc1
    s_mov_b64 exec, -1
    s_waitcnt vmcnt(0)
    s_barrier
    s_add_u32 s14, s14, 1
    s_branch layerb1_kernel_y0_step
layerb1_kernel_y0_last:
    s_waitcnt vmcnt(0)
    s_barrier
    s_lshl_b32 s20, s12, 7
    s_add_u32 s20, s20, 20480
    s_mov_b32 s29, 64
    s_mov_b64 exec, 1
    v_mov_b32 v116, s20
    v_mov_b32 v117, s29
    buffer_store_dword v117, v116, s[8:11], s48 offen sc1
    s_mov_b64 exec, -1
    s_branch layerb1_kernel_end
layerb1_kernel_y1_start:
    v_lshrrev_b32 v16, 4, v0
    v_and_b32 v17, 7, v0
    v_lshrrev_b32 v18, 3, v0
    v_and_b32 v18, 1, v18
    v_lshl_add_u32 v19, v18, 2, v16
    v_add_u32 v19, 8, v19
    v_mul_u32_u24 v20, 640, v19
    v_lshl_add_u32 v4, v17, 4, v20
    v_and_b32 v20, 1, v17
    v_lshlrev_b32 v20, 2, v20
    v_lshrrev_b32 v21, 1, v17
    v_add_u32 v20, v20, v21
    v_lshlrev_b32 v20, 4, v20
    v_lshl_add_u32 v5, v19, 7, v20
    v_add_u32 v3, 0, v1
    v_lshrrev_b32 v20, 1, v17
    v_lshlrev_b32 v20, 7, v20
    v_and_b32 v21, 1, v17
    v_lshl_add_u32 v20, v21, 2, v20
    v_add_u32 v10, 512, v20
    v_and_b32 v10, 31, v0
    v_lshlrev_b32 v10, 2, v10
    v_lshlrev_b32 v20, 8, v18
    v_lshl_add_u32 v20, v17, 5, v20
    v_and_b32 v21, 1, v16
    v_lshl_add_u32 v20, v21, 4, v20
    v_add_u32 v20, 10752, v20
    v_add_u32 v21, 12288, v1
    v_lshrrev_b32 v22, 1, v16
    v_cmp_eq_u32 vcc, v22, v18
    s_nop 1
    v_cndmask_b32 v6, v21, v20, vcc
    v_lshrrev_b32 v20, 3, v0
    v_lshlrev_b32 v20, 2, v20
    v_lshl_add_u32 v20, v17, 5, v20
    v_add_u32 v7, 10240, v20
    s_lshl_b32 s20, s12, 7
    s_add_u32 s20, s20, 20480
    s_lshr_b32 s21, s20, 13
    s_lshl_b32 s21, s21, 14
    s_and_b32 s20, s20, 8191
    s_add_u32 s20, s20, s21
    v_lshrrev_b32 v20, 3, v0
    v_lshlrev_b32 v20, 4, v20
    v_add_u32 v8, s20, v20
    s_mul_i32 s46, s12, 20480
    s_add_u32 s46, s46, 103809024
    s_mul_i32 s20, s12, 327680
    s_add_u32 s20, s20, 27344896
    s_add_u32 s21, s20, 65536
    buffer_load_dwordx4 v[176:179], v1, s[8:11], s21 offen offset:0
    buffer_load_dwordx4 v[180:183], v1, s[8:11], s21 offen offset:1024
    s_add_u32 s21, s20, 67584
    buffer_load_dwordx4 v[184:187], v1, s[8:11], s21 offen offset:0
    buffer_load_dwordx4 v[188:191], v1, s[8:11], s21 offen offset:1024
    s_add_u32 s21, s20, 69632
    buffer_load_dwordx4 v[192:195], v1, s[8:11], s21 offen offset:0
    buffer_load_dwordx4 v[196:199], v1, s[8:11], s21 offen offset:1024
    s_add_u32 s21, s20, 71680
    buffer_load_dwordx4 v[200:203], v1, s[8:11], s21 offen offset:0
    buffer_load_dwordx4 v[204:207], v1, s[8:11], s21 offen offset:1024
    s_add_u32 s21, s20, 73728
    buffer_load_dwordx4 v[208:211], v1, s[8:11], s21 offen offset:0
    buffer_load_dwordx4 v[212:215], v1, s[8:11], s21 offen offset:1024
    s_add_u32 s21, s20, 75776
    buffer_load_dwordx4 v[216:219], v1, s[8:11], s21 offen offset:0
    buffer_load_dwordx4 v[220:223], v1, s[8:11], s21 offen offset:1024
    s_add_u32 s21, s20, 77824
    buffer_load_dwordx4 v[224:227], v1, s[8:11], s21 offen offset:0
    buffer_load_dwordx4 v[228:231], v1, s[8:11], s21 offen offset:1024
    s_add_u32 s21, s20, 79872
    buffer_load_dwordx4 v[232:235], v1, s[8:11], s21 offen offset:0
    buffer_load_dwordx4 v[236:239], v1, s[8:11], s21 offen offset:1024
    s_add_u32 s20, s48, 51200
    s_mov_b64 exec, 3
    v_lshlrev_b32 v16, 2, v0
layerb1_kernel_y1_par:
    buffer_load_dword v17, v16, s[8:11], s20 offen sc1
    s_waitcnt vmcnt(0)
    v_cmp_eq_u32 vcc, 0, v17
    s_sub_u32 s15, s15, 1
    s_cbranch_scc1 layerb1_kernel_bail
    s_cbranch_vccnz layerb1_kernel_y1_par
    s_mov_b64 exec, -1
    v_readlane_b32 s20, v17, 0
    v_readlane_b32 s21, v17, 1
    s_nop 0
    s_and_b32 s20, s20, 8192
    s_and_b32 s21, s21, 8192
    s_add_u32 s16, s16, s20
    s_add_u32 s17, s17, s21
    s_mov_b32 s14, 0
    s_lshl_b32 s20, s12, 7
    v_mov_b32 v9, s20
    s_mov_b32 s47, 0
layerb1_kernel_y1_step:
    s_cmp_lt_u32 s14, 32
    s_cselect_b32 s18, s16, s17
    s_and_b32 s20, s14, 31
    s_lshl_b32 s20, s20, 16
    s_add_u32 s18, s18, s20
    s_mul_i32 s28, s14, 1638400
    s_add_u32 s28, s28, s46
    v_mov_b32 v56, 0
    v_mov_b32 v57, 0
    v_mov_b32 v58, 0
    v_mov_b32 v59, 0
    v_mov_b32 v60, 0
    v_mov_b32 v61, 0
    v_mov_b32 v62, 0
    v_mov_b32 v63, 0
    v_mov_b32 v64, 0
    v_mov_b32 v65, 0
    v_mov_b32 v66, 0
    v_mov_b32 v67, 0
    v_mov_b32 v68, 0
    v_mov_b32 v69, 0
    v_mov_b32 v70, 0
    v_mov_b32 v71, 0
    s_add_u32 s22, s18, 39936
    s_add_u32 s23, s18, 49152
    s_add_u32 s24, s18, 50176
layerb1_kernel_y1_poll:
    buffer_load_dwordx4 v[28:31], v1, s[8:11], s22 offen sc1
    buffer_load_dwordx4 v[32:35], v1, s[8:11], s23 offen sc1
    buffer_load_dwordx4 v[36:39], v1, s[8:11], s24 offen sc1
    s_waitcnt vmcnt(0)
    ds_write_b128 v3, v[28:31] offset:3072
    ds_write_b128 v3, v[32:35] offset:4096
    ds_write_b128 v3, v[36:39] offset:5120
    v_max3_u32 v116, v28, v29, v30
    v_max3_u32 v116, v116, v31, v32
    v_max3_u32 v116, v116, v33, v34
    v_max3_u32 v116, v116, v35, v36
    v_max3_u32 v116, v116, v37, v38
    v_max_u32 v116, v116, v39
    v_cmp_eq_u32 vcc, -1, v116
    s_sub_u32 s15, s15, 1
    s_cbranch_scc1 layerb1_kernel_bail
    s_cbranch_vccnz layerb1_kernel_y1_poll
    s_waitcnt lgkmcnt(0)
    s_barrier
    ds_read_b128 v[16:19], v3 offset:0
    ds_read_b128 v[20:23], v3 offset:1024
    ds_read_b128 v[24:27], v3 offset:2048
    ds_read_b128 v[40:43], v3 offset:6144
    ds_read_b128 v[44:47], v3 offset:7168
    ds_read_b128 v[48:51], v3 offset:8192
    ds_read_b128 v[52:55], v3 offset:9216
    s_cmp_gt_u32 s47, s14
    s_cbranch_scc1 layerb1_kernel_y1_gw_ok
layerb1_kernel_y1_gw_lp:
    buffer_load_dword v116, v9, s[8:11], s48 offen sc1
    s_waitcnt vmcnt(0)
    v_readlane_b32 s47, v116, 0
    s_nop 0
    s_sub_u32 s15, s15, 1
    s_cbranch_scc1 layerb1_kernel_bail
    s_cmp_gt_u32 s47, s14
    s_cbranch_scc0 layerb1_kernel_y1_gw_lp
layerb1_kernel_y1_gw_ok:
    buffer_load_dwordx4 v[76:79], v4, s[8:11], s28 offen offset:128 sc1
    buffer_load_dwordx4 v[80:83], v4, s[8:11], s28 offen offset:256 sc1
    buffer_load_dwordx4 v[84:87], v4, s[8:11], s28 offen offset:384 sc1
    buffer_load_dwordx4 v[88:91], v4, s[8:11], s28 offen offset:512 sc1
    v_smfmac_f32_16x16x64_bf16 v[56:59], v[28:31], a[24:31], v2
    v_smfmac_f32_16x16x64_bf16 v[60:63], v[28:31], a[104:111], v2
    v_smfmac_f32_16x16x64_bf16 v[64:67], v[28:31], a[184:191], v2
    v_smfmac_f32_16x16x64_bf16 v[68:71], v[28:31], v[184:191], v2
    v_smfmac_f32_16x16x64_bf16 v[56:59], v[32:35], a[32:39], v2
    v_smfmac_f32_16x16x64_bf16 v[60:63], v[32:35], a[112:119], v2
    v_smfmac_f32_16x16x64_bf16 v[64:67], v[32:35], a[192:199], v2
    v_smfmac_f32_16x16x64_bf16 v[68:71], v[32:35], v[192:199], v2
    v_smfmac_f32_16x16x64_bf16 v[56:59], v[36:39], a[40:47], v2
    v_smfmac_f32_16x16x64_bf16 v[60:63], v[36:39], a[120:127], v2
    v_smfmac_f32_16x16x64_bf16 v[64:67], v[36:39], a[200:207], v2
    v_smfmac_f32_16x16x64_bf16 v[68:71], v[36:39], v[200:207], v2
    s_waitcnt lgkmcnt(6)
    v_smfmac_f32_16x16x64_bf16 v[56:59], v[16:19], a[0:7], v2
    v_smfmac_f32_16x16x64_bf16 v[60:63], v[16:19], a[80:87], v2
    v_smfmac_f32_16x16x64_bf16 v[64:67], v[16:19], a[160:167], v2
    v_smfmac_f32_16x16x64_bf16 v[68:71], v[16:19], a[240:247], v2
    s_waitcnt lgkmcnt(5)
    v_smfmac_f32_16x16x64_bf16 v[56:59], v[20:23], a[8:15], v2
    v_smfmac_f32_16x16x64_bf16 v[60:63], v[20:23], a[88:95], v2
    v_smfmac_f32_16x16x64_bf16 v[64:67], v[20:23], a[168:175], v2
    v_smfmac_f32_16x16x64_bf16 v[68:71], v[20:23], a[248:255], v2
    s_waitcnt lgkmcnt(4)
    v_smfmac_f32_16x16x64_bf16 v[56:59], v[24:27], a[16:23], v2
    v_smfmac_f32_16x16x64_bf16 v[60:63], v[24:27], a[96:103], v2
    v_smfmac_f32_16x16x64_bf16 v[64:67], v[24:27], a[176:183], v2
    v_smfmac_f32_16x16x64_bf16 v[68:71], v[24:27], v[176:183], v2
    s_waitcnt lgkmcnt(3)
    v_smfmac_f32_16x16x64_bf16 v[56:59], v[40:43], a[48:55], v2
    v_smfmac_f32_16x16x64_bf16 v[60:63], v[40:43], a[128:135], v2
    v_smfmac_f32_16x16x64_bf16 v[64:67], v[40:43], a[208:215], v2
    v_smfmac_f32_16x16x64_bf16 v[68:71], v[40:43], v[208:215], v2
    s_waitcnt lgkmcnt(2)
    v_smfmac_f32_16x16x64_bf16 v[56:59], v[44:47], a[56:63], v2
    v_smfmac_f32_16x16x64_bf16 v[60:63], v[44:47], a[136:143], v2
    v_smfmac_f32_16x16x64_bf16 v[64:67], v[44:47], a[216:223], v2
    v_smfmac_f32_16x16x64_bf16 v[68:71], v[44:47], v[216:223], v2
    s_waitcnt lgkmcnt(1)
    v_smfmac_f32_16x16x64_bf16 v[56:59], v[48:51], a[64:71], v2
    v_smfmac_f32_16x16x64_bf16 v[60:63], v[48:51], a[144:151], v2
    v_smfmac_f32_16x16x64_bf16 v[64:67], v[48:51], a[224:231], v2
    v_smfmac_f32_16x16x64_bf16 v[68:71], v[48:51], v[224:231], v2
    s_waitcnt lgkmcnt(0)
    v_smfmac_f32_16x16x64_bf16 v[56:59], v[52:55], a[72:79], v2
    v_smfmac_f32_16x16x64_bf16 v[60:63], v[52:55], a[152:159], v2
    v_smfmac_f32_16x16x64_bf16 v[64:67], v[52:55], a[232:239], v2
    v_smfmac_f32_16x16x64_bf16 v[68:71], v[52:55], v[232:239], v2
    s_nop 7
    v_permlane32_swap_b32 v56, v64
    v_permlane32_swap_b32 v60, v68
    v_permlane32_swap_b32 v57, v65
    v_permlane32_swap_b32 v61, v69
    v_permlane32_swap_b32 v58, v66
    v_permlane32_swap_b32 v62, v70
    v_permlane32_swap_b32 v59, v67
    v_permlane32_swap_b32 v63, v71
    v_add_f32 v56, v56, v64
    v_add_f32 v60, v60, v68
    v_add_f32 v57, v57, v65
    v_add_f32 v61, v61, v69
    v_add_f32 v58, v58, v66
    v_add_f32 v62, v62, v70
    v_add_f32 v59, v59, v67
    v_add_f32 v63, v63, v71
    s_nop 1
    v_permlane16_swap_b32 v56, v60
    v_permlane16_swap_b32 v57, v61
    v_permlane16_swap_b32 v58, v62
    v_permlane16_swap_b32 v59, v63
    s_nop 1
    v_cvt_pk_bf16_f32 v72, v56, v57
    v_cvt_pk_bf16_f32 v73, v58, v59
    v_cvt_pk_bf16_f32 v74, v60, v61
    v_cvt_pk_bf16_f32 v75, v62, v63
    buffer_store_dwordx4 v[72:75], v4, s[8:11], s28 offen sc1
    s_cmp_eq_u32 s14, 63
    s_cbranch_scc1 layerb1_kernel_y1_last
    s_add_u32 s30, s18, 0
    s_add_u32 s31, s18, 4096
    s_add_u32 s32, s18, 16384
    s_add_u32 s33, s18, 20480
    s_add_u32 s34, s18, 32768
    s_add_u32 s29, s14, 1
    s_cmp_lt_u32 s29, 32
    s_cselect_b32 s19, s16, s17
    s_and_b32 s20, s29, 31
    s_lshl_b32 s20, s20, 16
    s_add_u32 s19, s19, s20
    s_barrier
    buffer_load_dwordx4 v[92:95], v5, s[8:11], s30 offen sc1
    buffer_load_dwordx4 v[96:99], v5, s[8:11], s31 offen sc1
    buffer_load_dwordx4 v[100:103], v5, s[8:11], s32 offen sc1
    buffer_load_dwordx4 v[104:107], v5, s[8:11], s33 offen sc1
    buffer_load_dwordx4 v[108:111], v5, s[8:11], s34 offen sc1
    s_waitcnt vmcnt(0)
    v_mfma_f32_16x16x32_bf16 v[112:115], v[92:95], v[72:75], 0
    v_mfma_f32_16x16x32_bf16 v[112:115], v[96:99], v[76:79], v[112:115]
    v_mfma_f32_16x16x32_bf16 v[112:115], v[100:103], v[80:83], v[112:115]
    v_mfma_f32_16x16x32_bf16 v[112:115], v[104:107], v[84:87], v[112:115]
    v_mfma_f32_16x16x32_bf16 v[112:115], v[108:111], v[88:91], v[112:115]
    v_max3_u32 v116, v92, v93, v94
    v_max3_u32 v116, v116, v95, v96
    v_max3_u32 v116, v116, v97, v98
    v_max3_u32 v116, v116, v99, v100
    v_max3_u32 v116, v116, v101, v102
    v_max3_u32 v116, v116, v103, v104
    v_max3_u32 v116, v116, v105, v106
    v_max3_u32 v116, v116, v107, v108
    v_max3_u32 v116, v116, v109, v110
    v_max_u32 v116, v116, v111
    v_cmp_eq_u32 vcc, -1, v116
    s_cbranch_vccz layerb1_kernel_y1_ppz
layerb1_kernel_y1_ppoll:
    buffer_load_dwordx4 v[92:95], v5, s[8:11], s30 offen sc1
    buffer_load_dwordx4 v[96:99], v5, s[8:11], s31 offen sc1
    buffer_load_dwordx4 v[100:103], v5, s[8:11], s32 offen sc1
    buffer_load_dwordx4 v[104:107], v5, s[8:11], s33 offen sc1
    buffer_load_dwordx4 v[108:111], v5, s[8:11], s34 offen sc1
    s_waitcnt vmcnt(0)
    v_mfma_f32_16x16x32_bf16 v[112:115], v[92:95], v[72:75], 0
    v_mfma_f32_16x16x32_bf16 v[112:115], v[96:99], v[76:79], v[112:115]
    v_mfma_f32_16x16x32_bf16 v[112:115], v[100:103], v[80:83], v[112:115]
    v_mfma_f32_16x16x32_bf16 v[112:115], v[104:107], v[84:87], v[112:115]
    v_mfma_f32_16x16x32_bf16 v[112:115], v[108:111], v[88:91], v[112:115]
    v_max3_u32 v116, v92, v93, v94
    v_max3_u32 v116, v116, v95, v96
    v_max3_u32 v116, v116, v97, v98
    v_max3_u32 v116, v116, v99, v100
    v_max3_u32 v116, v116, v101, v102
    v_max3_u32 v116, v116, v103, v104
    v_max3_u32 v116, v116, v105, v106
    v_max3_u32 v116, v116, v107, v108
    v_max3_u32 v116, v116, v109, v110
    v_max_u32 v116, v116, v111
    v_cmp_eq_u32 vcc, -1, v116
    s_sub_u32 s15, s15, 1
    s_cbranch_scc1 layerb1_kernel_bail
    s_cbranch_vccnz layerb1_kernel_y1_ppoll
layerb1_kernel_y1_ppz:
    ds_write_b128 v6, v[112:115]
    s_waitcnt lgkmcnt(0)
    s_barrier
    s_barrier
    s_add_u32 s14, s14, 1
    s_branch layerb1_kernel_y1_step
layerb1_kernel_y1_last:
    s_waitcnt vmcnt(0)
    s_barrier
    s_branch layerb1_kernel_end
layerb1_kernel_y2_start:
    v_lshrrev_b32 v16, 4, v0
    v_and_b32 v17, 7, v0
    v_lshrrev_b32 v18, 3, v0
    v_and_b32 v18, 1, v18
    v_lshl_add_u32 v19, v18, 2, v16
    v_add_u32 v19, 16, v19
    v_mul_u32_u24 v20, 640, v19
    v_lshl_add_u32 v4, v17, 4, v20
    v_and_b32 v20, 1, v17
    v_lshlrev_b32 v20, 2, v20
    v_lshrrev_b32 v21, 1, v17
    v_add_u32 v20, v20, v21
    v_lshlrev_b32 v20, 4, v20
    v_lshl_add_u32 v5, v19, 7, v20
    v_add_u32 v3, 0, v1
    v_lshrrev_b32 v20, 1, v17
    v_lshlrev_b32 v20, 7, v20
    v_and_b32 v21, 1, v17
    v_lshl_add_u32 v20, v21, 2, v20
    v_add_u32 v10, 1024, v20
    v_and_b32 v10, 31, v0
    v_lshlrev_b32 v10, 2, v10
    v_lshlrev_b32 v20, 8, v18
    v_lshl_add_u32 v20, v17, 5, v20
    v_and_b32 v21, 1, v16
    v_lshl_add_u32 v20, v21, 4, v20
    v_add_u32 v20, 11264, v20
    v_add_u32 v21, 12288, v1
    v_lshrrev_b32 v22, 1, v16
    v_cmp_eq_u32 vcc, v22, v18
    s_nop 1
    v_cndmask_b32 v6, v21, v20, vcc
    v_lshrrev_b32 v20, 3, v0
    v_lshlrev_b32 v20, 2, v20
    v_lshl_add_u32 v20, v17, 5, v20
    v_add_u32 v7, 10240, v20
    s_lshl_b32 s20, s12, 7
    s_add_u32 s20, s20, 20480
    s_lshr_b32 s21, s20, 13
    s_lshl_b32 s21, s21, 14
    s_and_b32 s20, s20, 8191
    s_add_u32 s20, s20, s21
    v_lshrrev_b32 v20, 3, v0
    v_lshlrev_b32 v20, 4, v20
    v_add_u32 v8, s20, v20
    s_mul_i32 s46, s12, 20480
    s_add_u32 s46, s46, 103809024
    s_mul_i32 s20, s12, 327680
    s_add_u32 s20, s20, 27426816
    s_add_u32 s21, s20, 65536
    buffer_load_dwordx4 v[176:179], v1, s[8:11], s21 offen offset:0
    buffer_load_dwordx4 v[180:183], v1, s[8:11], s21 offen offset:1024
    s_add_u32 s21, s20, 67584
    buffer_load_dwordx4 v[184:187], v1, s[8:11], s21 offen offset:0
    buffer_load_dwordx4 v[188:191], v1, s[8:11], s21 offen offset:1024
    s_add_u32 s21, s20, 69632
    buffer_load_dwordx4 v[192:195], v1, s[8:11], s21 offen offset:0
    buffer_load_dwordx4 v[196:199], v1, s[8:11], s21 offen offset:1024
    s_add_u32 s21, s20, 71680
    buffer_load_dwordx4 v[200:203], v1, s[8:11], s21 offen offset:0
    buffer_load_dwordx4 v[204:207], v1, s[8:11], s21 offen offset:1024
    s_add_u32 s21, s20, 73728
    buffer_load_dwordx4 v[208:211], v1, s[8:11], s21 offen offset:0
    buffer_load_dwordx4 v[212:215], v1, s[8:11], s21 offen offset:1024
    s_add_u32 s21, s20, 75776
    buffer_load_dwordx4 v[216:219], v1, s[8:11], s21 offen offset:0
    buffer_load_dwordx4 v[220:223], v1, s[8:11], s21 offen offset:1024
    s_add_u32 s21, s20, 77824
    buffer_load_dwordx4 v[224:227], v1, s[8:11], s21 offen offset:0
    buffer_load_dwordx4 v[228:231], v1, s[8:11], s21 offen offset:1024
    s_add_u32 s21, s20, 79872
    buffer_load_dwordx4 v[232:235], v1, s[8:11], s21 offen offset:0
    buffer_load_dwordx4 v[236:239], v1, s[8:11], s21 offen offset:1024
    s_add_u32 s20, s48, 51200
    s_mov_b64 exec, 3
    v_lshlrev_b32 v16, 2, v0
layerb1_kernel_y2_par:
    buffer_load_dword v17, v16, s[8:11], s20 offen sc1
    s_waitcnt vmcnt(0)
    v_cmp_eq_u32 vcc, 0, v17
    s_sub_u32 s15, s15, 1
    s_cbranch_scc1 layerb1_kernel_bail
    s_cbranch_vccnz layerb1_kernel_y2_par
    s_mov_b64 exec, -1
    v_readlane_b32 s20, v17, 0
    v_readlane_b32 s21, v17, 1
    s_nop 0
    s_and_b32 s20, s20, 8192
    s_and_b32 s21, s21, 8192
    s_add_u32 s16, s16, s20
    s_add_u32 s17, s17, s21
    s_mov_b32 s14, 0
    s_lshl_b32 s20, s12, 7
    v_mov_b32 v9, s20
    s_mov_b32 s47, 0
layerb1_kernel_y2_step:
    s_cmp_lt_u32 s14, 32
    s_cselect_b32 s18, s16, s17
    s_and_b32 s20, s14, 31
    s_lshl_b32 s20, s20, 16
    s_add_u32 s18, s18, s20
    s_mul_i32 s28, s14, 1638400
    s_add_u32 s28, s28, s46
    v_mov_b32 v56, 0
    v_mov_b32 v57, 0
    v_mov_b32 v58, 0
    v_mov_b32 v59, 0
    v_mov_b32 v60, 0
    v_mov_b32 v61, 0
    v_mov_b32 v62, 0
    v_mov_b32 v63, 0
    v_mov_b32 v64, 0
    v_mov_b32 v65, 0
    v_mov_b32 v66, 0
    v_mov_b32 v67, 0
    v_mov_b32 v68, 0
    v_mov_b32 v69, 0
    v_mov_b32 v70, 0
    v_mov_b32 v71, 0
    s_add_u32 s22, s18, 51200
    s_add_u32 s23, s18, 52224
layerb1_kernel_y2_poll:
    buffer_load_dwordx4 v[40:43], v1, s[8:11], s22 offen sc1
    buffer_load_dwordx4 v[44:47], v1, s[8:11], s23 offen sc1
    s_waitcnt vmcnt(0)
    ds_write_b128 v3, v[40:43] offset:6144
    ds_write_b128 v3, v[44:47] offset:7168
    v_max3_u32 v116, v40, v41, v42
    v_max3_u32 v116, v116, v43, v44
    v_max3_u32 v116, v116, v45, v46
    v_max_u32 v116, v116, v47
    v_cmp_eq_u32 vcc, -1, v116
    s_sub_u32 s15, s15, 1
    s_cbranch_scc1 layerb1_kernel_bail
    s_cbranch_vccnz layerb1_kernel_y2_poll
    s_waitcnt lgkmcnt(0)
    s_barrier
    ds_read_b128 v[16:19], v3 offset:0
    ds_read_b128 v[20:23], v3 offset:1024
    ds_read_b128 v[24:27], v3 offset:2048
    ds_read_b128 v[28:31], v3 offset:3072
    ds_read_b128 v[32:35], v3 offset:4096
    ds_read_b128 v[36:39], v3 offset:5120
    ds_read_b128 v[48:51], v3 offset:8192
    ds_read_b128 v[52:55], v3 offset:9216
    s_cmp_gt_u32 s47, s14
    s_cbranch_scc1 layerb1_kernel_y2_gw_ok
layerb1_kernel_y2_gw_lp:
    buffer_load_dword v116, v9, s[8:11], s48 offen sc1
    s_waitcnt vmcnt(0)
    v_readlane_b32 s47, v116, 0
    s_nop 0
    s_sub_u32 s15, s15, 1
    s_cbranch_scc1 layerb1_kernel_bail
    s_cmp_gt_u32 s47, s14
    s_cbranch_scc0 layerb1_kernel_y2_gw_lp
layerb1_kernel_y2_gw_ok:
    buffer_load_dwordx4 v[76:79], v4, s[8:11], s28 offen offset:128 sc1
    buffer_load_dwordx4 v[80:83], v4, s[8:11], s28 offen offset:256 sc1
    buffer_load_dwordx4 v[84:87], v4, s[8:11], s28 offen offset:384 sc1
    buffer_load_dwordx4 v[88:91], v4, s[8:11], s28 offen offset:512 sc1
    v_smfmac_f32_16x16x64_bf16 v[56:59], v[40:43], a[48:55], v2
    v_smfmac_f32_16x16x64_bf16 v[60:63], v[40:43], a[128:135], v2
    v_smfmac_f32_16x16x64_bf16 v[64:67], v[40:43], a[208:215], v2
    v_smfmac_f32_16x16x64_bf16 v[68:71], v[40:43], v[208:215], v2
    v_smfmac_f32_16x16x64_bf16 v[56:59], v[44:47], a[56:63], v2
    v_smfmac_f32_16x16x64_bf16 v[60:63], v[44:47], a[136:143], v2
    v_smfmac_f32_16x16x64_bf16 v[64:67], v[44:47], a[216:223], v2
    v_smfmac_f32_16x16x64_bf16 v[68:71], v[44:47], v[216:223], v2
    s_waitcnt lgkmcnt(7)
    v_smfmac_f32_16x16x64_bf16 v[56:59], v[16:19], a[0:7], v2
    v_smfmac_f32_16x16x64_bf16 v[60:63], v[16:19], a[80:87], v2
    v_smfmac_f32_16x16x64_bf16 v[64:67], v[16:19], a[160:167], v2
    v_smfmac_f32_16x16x64_bf16 v[68:71], v[16:19], a[240:247], v2
    s_waitcnt lgkmcnt(6)
    v_smfmac_f32_16x16x64_bf16 v[56:59], v[20:23], a[8:15], v2
    v_smfmac_f32_16x16x64_bf16 v[60:63], v[20:23], a[88:95], v2
    v_smfmac_f32_16x16x64_bf16 v[64:67], v[20:23], a[168:175], v2
    v_smfmac_f32_16x16x64_bf16 v[68:71], v[20:23], a[248:255], v2
    s_waitcnt lgkmcnt(5)
    v_smfmac_f32_16x16x64_bf16 v[56:59], v[24:27], a[16:23], v2
    v_smfmac_f32_16x16x64_bf16 v[60:63], v[24:27], a[96:103], v2
    v_smfmac_f32_16x16x64_bf16 v[64:67], v[24:27], a[176:183], v2
    v_smfmac_f32_16x16x64_bf16 v[68:71], v[24:27], v[176:183], v2
    s_waitcnt lgkmcnt(4)
    v_smfmac_f32_16x16x64_bf16 v[56:59], v[28:31], a[24:31], v2
    v_smfmac_f32_16x16x64_bf16 v[60:63], v[28:31], a[104:111], v2
    v_smfmac_f32_16x16x64_bf16 v[64:67], v[28:31], a[184:191], v2
    v_smfmac_f32_16x16x64_bf16 v[68:71], v[28:31], v[184:191], v2
    s_waitcnt lgkmcnt(3)
    v_smfmac_f32_16x16x64_bf16 v[56:59], v[32:35], a[32:39], v2
    v_smfmac_f32_16x16x64_bf16 v[60:63], v[32:35], a[112:119], v2
    v_smfmac_f32_16x16x64_bf16 v[64:67], v[32:35], a[192:199], v2
    v_smfmac_f32_16x16x64_bf16 v[68:71], v[32:35], v[192:199], v2
    s_waitcnt lgkmcnt(2)
    v_smfmac_f32_16x16x64_bf16 v[56:59], v[36:39], a[40:47], v2
    v_smfmac_f32_16x16x64_bf16 v[60:63], v[36:39], a[120:127], v2
    v_smfmac_f32_16x16x64_bf16 v[64:67], v[36:39], a[200:207], v2
    v_smfmac_f32_16x16x64_bf16 v[68:71], v[36:39], v[200:207], v2
    s_waitcnt lgkmcnt(1)
    v_smfmac_f32_16x16x64_bf16 v[56:59], v[48:51], a[64:71], v2
    v_smfmac_f32_16x16x64_bf16 v[60:63], v[48:51], a[144:151], v2
    v_smfmac_f32_16x16x64_bf16 v[64:67], v[48:51], a[224:231], v2
    v_smfmac_f32_16x16x64_bf16 v[68:71], v[48:51], v[224:231], v2
    s_waitcnt lgkmcnt(0)
    v_smfmac_f32_16x16x64_bf16 v[56:59], v[52:55], a[72:79], v2
    v_smfmac_f32_16x16x64_bf16 v[60:63], v[52:55], a[152:159], v2
    v_smfmac_f32_16x16x64_bf16 v[64:67], v[52:55], a[232:239], v2
    v_smfmac_f32_16x16x64_bf16 v[68:71], v[52:55], v[232:239], v2
    s_nop 7
    v_permlane32_swap_b32 v56, v64
    v_permlane32_swap_b32 v60, v68
    v_permlane32_swap_b32 v57, v65
    v_permlane32_swap_b32 v61, v69
    v_permlane32_swap_b32 v58, v66
    v_permlane32_swap_b32 v62, v70
    v_permlane32_swap_b32 v59, v67
    v_permlane32_swap_b32 v63, v71
    v_add_f32 v56, v56, v64
    v_add_f32 v60, v60, v68
    v_add_f32 v57, v57, v65
    v_add_f32 v61, v61, v69
    v_add_f32 v58, v58, v66
    v_add_f32 v62, v62, v70
    v_add_f32 v59, v59, v67
    v_add_f32 v63, v63, v71
    s_nop 1
    v_permlane16_swap_b32 v56, v60
    v_permlane16_swap_b32 v57, v61
    v_permlane16_swap_b32 v58, v62
    v_permlane16_swap_b32 v59, v63
    s_nop 1
    v_cvt_pk_bf16_f32 v72, v56, v57
    v_cvt_pk_bf16_f32 v73, v58, v59
    v_cvt_pk_bf16_f32 v74, v60, v61
    v_cvt_pk_bf16_f32 v75, v62, v63
    buffer_store_dwordx4 v[72:75], v4, s[8:11], s28 offen sc1
    s_cmp_eq_u32 s14, 63
    s_cbranch_scc1 layerb1_kernel_y2_last
    s_add_u32 s30, s18, 0
    s_add_u32 s31, s18, 4096
    s_add_u32 s32, s18, 16384
    s_add_u32 s33, s18, 20480
    s_add_u32 s34, s18, 32768
    s_add_u32 s29, s14, 1
    s_cmp_lt_u32 s29, 32
    s_cselect_b32 s19, s16, s17
    s_and_b32 s20, s29, 31
    s_lshl_b32 s20, s20, 16
    s_add_u32 s19, s19, s20
    s_barrier
    buffer_load_dwordx4 v[92:95], v5, s[8:11], s30 offen sc1
    buffer_load_dwordx4 v[96:99], v5, s[8:11], s31 offen sc1
    buffer_load_dwordx4 v[100:103], v5, s[8:11], s32 offen sc1
    buffer_load_dwordx4 v[104:107], v5, s[8:11], s33 offen sc1
    buffer_load_dwordx4 v[108:111], v5, s[8:11], s34 offen sc1
    s_waitcnt vmcnt(0)
    v_mfma_f32_16x16x32_bf16 v[112:115], v[92:95], v[72:75], 0
    v_mfma_f32_16x16x32_bf16 v[112:115], v[96:99], v[76:79], v[112:115]
    v_mfma_f32_16x16x32_bf16 v[112:115], v[100:103], v[80:83], v[112:115]
    v_mfma_f32_16x16x32_bf16 v[112:115], v[104:107], v[84:87], v[112:115]
    v_mfma_f32_16x16x32_bf16 v[112:115], v[108:111], v[88:91], v[112:115]
    v_max3_u32 v116, v92, v93, v94
    v_max3_u32 v116, v116, v95, v96
    v_max3_u32 v116, v116, v97, v98
    v_max3_u32 v116, v116, v99, v100
    v_max3_u32 v116, v116, v101, v102
    v_max3_u32 v116, v116, v103, v104
    v_max3_u32 v116, v116, v105, v106
    v_max3_u32 v116, v116, v107, v108
    v_max3_u32 v116, v116, v109, v110
    v_max_u32 v116, v116, v111
    v_cmp_eq_u32 vcc, -1, v116
    s_cbranch_vccz layerb1_kernel_y2_ppz
layerb1_kernel_y2_ppoll:
    buffer_load_dwordx4 v[92:95], v5, s[8:11], s30 offen sc1
    buffer_load_dwordx4 v[96:99], v5, s[8:11], s31 offen sc1
    buffer_load_dwordx4 v[100:103], v5, s[8:11], s32 offen sc1
    buffer_load_dwordx4 v[104:107], v5, s[8:11], s33 offen sc1
    buffer_load_dwordx4 v[108:111], v5, s[8:11], s34 offen sc1
    s_waitcnt vmcnt(0)
    v_mfma_f32_16x16x32_bf16 v[112:115], v[92:95], v[72:75], 0
    v_mfma_f32_16x16x32_bf16 v[112:115], v[96:99], v[76:79], v[112:115]
    v_mfma_f32_16x16x32_bf16 v[112:115], v[100:103], v[80:83], v[112:115]
    v_mfma_f32_16x16x32_bf16 v[112:115], v[104:107], v[84:87], v[112:115]
    v_mfma_f32_16x16x32_bf16 v[112:115], v[108:111], v[88:91], v[112:115]
    v_max3_u32 v116, v92, v93, v94
    v_max3_u32 v116, v116, v95, v96
    v_max3_u32 v116, v116, v97, v98
    v_max3_u32 v116, v116, v99, v100
    v_max3_u32 v116, v116, v101, v102
    v_max3_u32 v116, v116, v103, v104
    v_max3_u32 v116, v116, v105, v106
    v_max3_u32 v116, v116, v107, v108
    v_max3_u32 v116, v116, v109, v110
    v_max_u32 v116, v116, v111
    v_cmp_eq_u32 vcc, -1, v116
    s_sub_u32 s15, s15, 1
    s_cbranch_scc1 layerb1_kernel_bail
    s_cbranch_vccnz layerb1_kernel_y2_ppoll
layerb1_kernel_y2_ppz:
    ds_write_b128 v6, v[112:115]
    s_waitcnt lgkmcnt(0)
    s_barrier
    s_barrier
    s_add_u32 s14, s14, 1
    s_branch layerb1_kernel_y2_step
layerb1_kernel_y2_last:
    s_waitcnt vmcnt(0)
    s_barrier
    s_branch layerb1_kernel_end
layerb1_kernel_y3_start:
    v_lshrrev_b32 v16, 4, v0
    v_and_b32 v17, 7, v0
    v_lshrrev_b32 v18, 3, v0
    v_and_b32 v18, 1, v18
    v_lshl_add_u32 v19, v18, 2, v16
    v_add_u32 v19, 24, v19
    v_mul_u32_u24 v20, 640, v19
    v_lshl_add_u32 v4, v17, 4, v20
    v_and_b32 v20, 1, v17
    v_lshlrev_b32 v20, 2, v20
    v_lshrrev_b32 v21, 1, v17
    v_add_u32 v20, v20, v21
    v_lshlrev_b32 v20, 4, v20
    v_lshl_add_u32 v5, v19, 7, v20
    v_add_u32 v3, 0, v1
    v_lshrrev_b32 v20, 1, v17
    v_lshlrev_b32 v20, 7, v20
    v_and_b32 v21, 1, v17
    v_lshl_add_u32 v20, v21, 2, v20
    v_add_u32 v10, 1536, v20
    v_and_b32 v10, 31, v0
    v_lshlrev_b32 v10, 2, v10
    v_lshlrev_b32 v20, 8, v18
    v_lshl_add_u32 v20, v17, 5, v20
    v_and_b32 v21, 1, v16
    v_lshl_add_u32 v20, v21, 4, v20
    v_add_u32 v20, 11776, v20
    v_add_u32 v21, 12288, v1
    v_lshrrev_b32 v22, 1, v16
    v_cmp_eq_u32 vcc, v22, v18
    s_nop 1
    v_cndmask_b32 v6, v21, v20, vcc
    v_lshrrev_b32 v20, 3, v0
    v_lshlrev_b32 v20, 2, v20
    v_lshl_add_u32 v20, v17, 5, v20
    v_add_u32 v7, 10240, v20
    s_lshl_b32 s20, s12, 7
    s_add_u32 s20, s20, 20480
    s_lshr_b32 s21, s20, 13
    s_lshl_b32 s21, s21, 14
    s_and_b32 s20, s20, 8191
    s_add_u32 s20, s20, s21
    v_lshrrev_b32 v20, 3, v0
    v_lshlrev_b32 v20, 4, v20
    v_add_u32 v8, s20, v20
    s_mul_i32 s46, s12, 20480
    s_add_u32 s46, s46, 103809024
    s_mul_i32 s20, s12, 327680
    s_add_u32 s20, s20, 27508736
    s_add_u32 s21, s20, 65536
    buffer_load_dwordx4 v[176:179], v1, s[8:11], s21 offen offset:0
    buffer_load_dwordx4 v[180:183], v1, s[8:11], s21 offen offset:1024
    s_add_u32 s21, s20, 67584
    buffer_load_dwordx4 v[184:187], v1, s[8:11], s21 offen offset:0
    buffer_load_dwordx4 v[188:191], v1, s[8:11], s21 offen offset:1024
    s_add_u32 s21, s20, 69632
    buffer_load_dwordx4 v[192:195], v1, s[8:11], s21 offen offset:0
    buffer_load_dwordx4 v[196:199], v1, s[8:11], s21 offen offset:1024
    s_add_u32 s21, s20, 71680
    buffer_load_dwordx4 v[200:203], v1, s[8:11], s21 offen offset:0
    buffer_load_dwordx4 v[204:207], v1, s[8:11], s21 offen offset:1024
    s_add_u32 s21, s20, 73728
    buffer_load_dwordx4 v[208:211], v1, s[8:11], s21 offen offset:0
    buffer_load_dwordx4 v[212:215], v1, s[8:11], s21 offen offset:1024
    s_add_u32 s21, s20, 75776
    buffer_load_dwordx4 v[216:219], v1, s[8:11], s21 offen offset:0
    buffer_load_dwordx4 v[220:223], v1, s[8:11], s21 offen offset:1024
    s_add_u32 s21, s20, 77824
    buffer_load_dwordx4 v[224:227], v1, s[8:11], s21 offen offset:0
    buffer_load_dwordx4 v[228:231], v1, s[8:11], s21 offen offset:1024
    s_add_u32 s21, s20, 79872
    buffer_load_dwordx4 v[232:235], v1, s[8:11], s21 offen offset:0
    buffer_load_dwordx4 v[236:239], v1, s[8:11], s21 offen offset:1024
    s_add_u32 s20, s48, 51200
    s_mov_b64 exec, 3
    v_lshlrev_b32 v16, 2, v0
layerb1_kernel_y3_par:
    buffer_load_dword v17, v16, s[8:11], s20 offen sc1
    s_waitcnt vmcnt(0)
    v_cmp_eq_u32 vcc, 0, v17
    s_sub_u32 s15, s15, 1
    s_cbranch_scc1 layerb1_kernel_bail
    s_cbranch_vccnz layerb1_kernel_y3_par
    s_mov_b64 exec, -1
    v_readlane_b32 s20, v17, 0
    v_readlane_b32 s21, v17, 1
    s_nop 0
    s_and_b32 s20, s20, 8192
    s_and_b32 s21, s21, 8192
    s_add_u32 s16, s16, s20
    s_add_u32 s17, s17, s21
    s_mov_b32 s14, 0
    s_lshl_b32 s20, s12, 7
    v_mov_b32 v9, s20
    s_mov_b32 s47, 0
layerb1_kernel_y3_step:
    s_cmp_lt_u32 s14, 32
    s_cselect_b32 s18, s16, s17
    s_and_b32 s20, s14, 31
    s_lshl_b32 s20, s20, 16
    s_add_u32 s18, s18, s20
    s_mul_i32 s28, s14, 1638400
    s_add_u32 s28, s28, s46
    v_mov_b32 v56, 0
    v_mov_b32 v57, 0
    v_mov_b32 v58, 0
    v_mov_b32 v59, 0
    v_mov_b32 v60, 0
    v_mov_b32 v61, 0
    v_mov_b32 v62, 0
    v_mov_b32 v63, 0
    v_mov_b32 v64, 0
    v_mov_b32 v65, 0
    v_mov_b32 v66, 0
    v_mov_b32 v67, 0
    v_mov_b32 v68, 0
    v_mov_b32 v69, 0
    v_mov_b32 v70, 0
    v_mov_b32 v71, 0
    s_add_u32 s22, s18, 53248
    s_add_u32 s23, s18, 54272
layerb1_kernel_y3_poll:
    buffer_load_dwordx4 v[48:51], v1, s[8:11], s22 offen sc1
    buffer_load_dwordx4 v[52:55], v1, s[8:11], s23 offen sc1
    s_waitcnt vmcnt(0)
    ds_write_b128 v3, v[48:51] offset:8192
    ds_write_b128 v3, v[52:55] offset:9216
    v_max3_u32 v116, v48, v49, v50
    v_max3_u32 v116, v116, v51, v52
    v_max3_u32 v116, v116, v53, v54
    v_max_u32 v116, v116, v55
    v_cmp_eq_u32 vcc, -1, v116
    s_sub_u32 s15, s15, 1
    s_cbranch_scc1 layerb1_kernel_bail
    s_cbranch_vccnz layerb1_kernel_y3_poll
    s_waitcnt lgkmcnt(0)
    s_barrier
    ds_read_b128 v[16:19], v3 offset:0
    ds_read_b128 v[20:23], v3 offset:1024
    ds_read_b128 v[24:27], v3 offset:2048
    ds_read_b128 v[28:31], v3 offset:3072
    ds_read_b128 v[32:35], v3 offset:4096
    ds_read_b128 v[36:39], v3 offset:5120
    ds_read_b128 v[40:43], v3 offset:6144
    ds_read_b128 v[44:47], v3 offset:7168
    s_cmp_gt_u32 s47, s14
    s_cbranch_scc1 layerb1_kernel_y3_gw_ok
layerb1_kernel_y3_gw_lp:
    buffer_load_dword v116, v9, s[8:11], s48 offen sc1
    s_waitcnt vmcnt(0)
    v_readlane_b32 s47, v116, 0
    s_nop 0
    s_sub_u32 s15, s15, 1
    s_cbranch_scc1 layerb1_kernel_bail
    s_cmp_gt_u32 s47, s14
    s_cbranch_scc0 layerb1_kernel_y3_gw_lp
layerb1_kernel_y3_gw_ok:
    buffer_load_dwordx4 v[76:79], v4, s[8:11], s28 offen offset:128 sc1
    buffer_load_dwordx4 v[80:83], v4, s[8:11], s28 offen offset:256 sc1
    buffer_load_dwordx4 v[84:87], v4, s[8:11], s28 offen offset:384 sc1
    buffer_load_dwordx4 v[88:91], v4, s[8:11], s28 offen offset:512 sc1
    v_smfmac_f32_16x16x64_bf16 v[56:59], v[48:51], a[64:71], v2
    v_smfmac_f32_16x16x64_bf16 v[60:63], v[48:51], a[144:151], v2
    v_smfmac_f32_16x16x64_bf16 v[64:67], v[48:51], a[224:231], v2
    v_smfmac_f32_16x16x64_bf16 v[68:71], v[48:51], v[224:231], v2
    v_smfmac_f32_16x16x64_bf16 v[56:59], v[52:55], a[72:79], v2
    v_smfmac_f32_16x16x64_bf16 v[60:63], v[52:55], a[152:159], v2
    v_smfmac_f32_16x16x64_bf16 v[64:67], v[52:55], a[232:239], v2
    v_smfmac_f32_16x16x64_bf16 v[68:71], v[52:55], v[232:239], v2
    s_waitcnt lgkmcnt(7)
    v_smfmac_f32_16x16x64_bf16 v[56:59], v[16:19], a[0:7], v2
    v_smfmac_f32_16x16x64_bf16 v[60:63], v[16:19], a[80:87], v2
    v_smfmac_f32_16x16x64_bf16 v[64:67], v[16:19], a[160:167], v2
    v_smfmac_f32_16x16x64_bf16 v[68:71], v[16:19], a[240:247], v2
    s_waitcnt lgkmcnt(6)
    v_smfmac_f32_16x16x64_bf16 v[56:59], v[20:23], a[8:15], v2
    v_smfmac_f32_16x16x64_bf16 v[60:63], v[20:23], a[88:95], v2
    v_smfmac_f32_16x16x64_bf16 v[64:67], v[20:23], a[168:175], v2
    v_smfmac_f32_16x16x64_bf16 v[68:71], v[20:23], a[248:255], v2
    s_waitcnt lgkmcnt(5)
    v_smfmac_f32_16x16x64_bf16 v[56:59], v[24:27], a[16:23], v2
    v_smfmac_f32_16x16x64_bf16 v[60:63], v[24:27], a[96:103], v2
    v_smfmac_f32_16x16x64_bf16 v[64:67], v[24:27], a[176:183], v2
    v_smfmac_f32_16x16x64_bf16 v[68:71], v[24:27], v[176:183], v2
    s_waitcnt lgkmcnt(4)
    v_smfmac_f32_16x16x64_bf16 v[56:59], v[28:31], a[24:31], v2
    v_smfmac_f32_16x16x64_bf16 v[60:63], v[28:31], a[104:111], v2
    v_smfmac_f32_16x16x64_bf16 v[64:67], v[28:31], a[184:191], v2
    v_smfmac_f32_16x16x64_bf16 v[68:71], v[28:31], v[184:191], v2
    s_waitcnt lgkmcnt(3)
    v_smfmac_f32_16x16x64_bf16 v[56:59], v[32:35], a[32:39], v2
    v_smfmac_f32_16x16x64_bf16 v[60:63], v[32:35], a[112:119], v2
    v_smfmac_f32_16x16x64_bf16 v[64:67], v[32:35], a[192:199], v2
    v_smfmac_f32_16x16x64_bf16 v[68:71], v[32:35], v[192:199], v2
    s_waitcnt lgkmcnt(2)
    v_smfmac_f32_16x16x64_bf16 v[56:59], v[36:39], a[40:47], v2
    v_smfmac_f32_16x16x64_bf16 v[60:63], v[36:39], a[120:127], v2
    v_smfmac_f32_16x16x64_bf16 v[64:67], v[36:39], a[200:207], v2
    v_smfmac_f32_16x16x64_bf16 v[68:71], v[36:39], v[200:207], v2
    s_waitcnt lgkmcnt(1)
    v_smfmac_f32_16x16x64_bf16 v[56:59], v[40:43], a[48:55], v2
    v_smfmac_f32_16x16x64_bf16 v[60:63], v[40:43], a[128:135], v2
    v_smfmac_f32_16x16x64_bf16 v[64:67], v[40:43], a[208:215], v2
    v_smfmac_f32_16x16x64_bf16 v[68:71], v[40:43], v[208:215], v2
    s_waitcnt lgkmcnt(0)
    v_smfmac_f32_16x16x64_bf16 v[56:59], v[44:47], a[56:63], v2
    v_smfmac_f32_16x16x64_bf16 v[60:63], v[44:47], a[136:143], v2
    v_smfmac_f32_16x16x64_bf16 v[64:67], v[44:47], a[216:223], v2
    v_smfmac_f32_16x16x64_bf16 v[68:71], v[44:47], v[216:223], v2
    s_nop 7
    v_permlane32_swap_b32 v56, v64
    v_permlane32_swap_b32 v60, v68
    v_permlane32_swap_b32 v57, v65
    v_permlane32_swap_b32 v61, v69
    v_permlane32_swap_b32 v58, v66
    v_permlane32_swap_b32 v62, v70
    v_permlane32_swap_b32 v59, v67
    v_permlane32_swap_b32 v63, v71
    v_add_f32 v56, v56, v64
    v_add_f32 v60, v60, v68
    v_add_f32 v57, v57, v65
    v_add_f32 v61, v61, v69
    v_add_f32 v58, v58, v66
    v_add_f32 v62, v62, v70
    v_add_f32 v59, v59, v67
    v_add_f32 v63, v63, v71
    s_nop 1
    v_permlane16_swap_b32 v56, v60
    v_permlane16_swap_b32 v57, v61
    v_permlane16_swap_b32 v58, v62
    v_permlane16_swap_b32 v59, v63
    s_nop 1
    v_cvt_pk_bf16_f32 v72, v56, v57
    v_cvt_pk_bf16_f32 v73, v58, v59
    v_cvt_pk_bf16_f32 v74, v60, v61
    v_cvt_pk_bf16_f32 v75, v62, v63
    buffer_store_dwordx4 v[72:75], v4, s[8:11], s28 offen sc1
    s_cmp_eq_u32 s14, 63
    s_cbranch_scc1 layerb1_kernel_y3_last
    s_add_u32 s30, s18, 0
    s_add_u32 s31, s18, 4096
    s_add_u32 s32, s18, 16384
    s_add_u32 s33, s18, 20480
    s_add_u32 s34, s18, 32768
    s_add_u32 s29, s14, 1
    s_cmp_lt_u32 s29, 32
    s_cselect_b32 s19, s16, s17
    s_and_b32 s20, s29, 31
    s_lshl_b32 s20, s20, 16
    s_add_u32 s19, s19, s20
    s_barrier
    buffer_load_dwordx4 v[92:95], v5, s[8:11], s30 offen sc1
    buffer_load_dwordx4 v[96:99], v5, s[8:11], s31 offen sc1
    buffer_load_dwordx4 v[100:103], v5, s[8:11], s32 offen sc1
    buffer_load_dwordx4 v[104:107], v5, s[8:11], s33 offen sc1
    buffer_load_dwordx4 v[108:111], v5, s[8:11], s34 offen sc1
    s_waitcnt vmcnt(0)
    v_mfma_f32_16x16x32_bf16 v[112:115], v[92:95], v[72:75], 0
    v_mfma_f32_16x16x32_bf16 v[112:115], v[96:99], v[76:79], v[112:115]
    v_mfma_f32_16x16x32_bf16 v[112:115], v[100:103], v[80:83], v[112:115]
    v_mfma_f32_16x16x32_bf16 v[112:115], v[104:107], v[84:87], v[112:115]
    v_mfma_f32_16x16x32_bf16 v[112:115], v[108:111], v[88:91], v[112:115]
    v_max3_u32 v116, v92, v93, v94
    v_max3_u32 v116, v116, v95, v96
    v_max3_u32 v116, v116, v97, v98
    v_max3_u32 v116, v116, v99, v100
    v_max3_u32 v116, v116, v101, v102
    v_max3_u32 v116, v116, v103, v104
    v_max3_u32 v116, v116, v105, v106
    v_max3_u32 v116, v116, v107, v108
    v_max3_u32 v116, v116, v109, v110
    v_max_u32 v116, v116, v111
    v_cmp_eq_u32 vcc, -1, v116
    s_cbranch_vccz layerb1_kernel_y3_ppz
layerb1_kernel_y3_ppoll:
    buffer_load_dwordx4 v[92:95], v5, s[8:11], s30 offen sc1
    buffer_load_dwordx4 v[96:99], v5, s[8:11], s31 offen sc1
    buffer_load_dwordx4 v[100:103], v5, s[8:11], s32 offen sc1
    buffer_load_dwordx4 v[104:107], v5, s[8:11], s33 offen sc1
    buffer_load_dwordx4 v[108:111], v5, s[8:11], s34 offen sc1
    s_waitcnt vmcnt(0)
    v_mfma_f32_16x16x32_bf16 v[112:115], v[92:95], v[72:75], 0
    v_mfma_f32_16x16x32_bf16 v[112:115], v[96:99], v[76:79], v[112:115]
    v_mfma_f32_16x16x32_bf16 v[112:115], v[100:103], v[80:83], v[112:115]
    v_mfma_f32_16x16x32_bf16 v[112:115], v[104:107], v[84:87], v[112:115]
    v_mfma_f32_16x16x32_bf16 v[112:115], v[108:111], v[88:91], v[112:115]
    v_max3_u32 v116, v92, v93, v94
    v_max3_u32 v116, v116, v95, v96
    v_max3_u32 v116, v116, v97, v98
    v_max3_u32 v116, v116, v99, v100
    v_max3_u32 v116, v116, v101, v102
    v_max3_u32 v116, v116, v103, v104
    v_max3_u32 v116, v116, v105, v106
    v_max3_u32 v116, v116, v107, v108
    v_max3_u32 v116, v116, v109, v110
    v_max_u32 v116, v116, v111
    v_cmp_eq_u32 vcc, -1, v116
    s_sub_u32 s15, s15, 1
    s_cbranch_scc1 layerb1_kernel_bail
    s_cbranch_vccnz layerb1_kernel_y3_ppoll
layerb1_kernel_y3_ppz:
    ds_write_b128 v6, v[112:115]
    s_waitcnt lgkmcnt(0)
    s_barrier
    s_barrier
    s_add_u32 s14, s14, 1
    s_branch layerb1_kernel_y3_step
layerb1_kernel_y3_last:
    s_waitcnt vmcnt(0)
    s_barrier
    s_branch layerb1_kernel_end
layerb1_kernel_proj:
    s_sub_u32 s22, s20, 4
    s_lshl_b32 s22, s22, 5
    s_add_u32 s12, s22, s21
    s_mov_b32 s14, 0
    s_mov_b32 s15, 64
    v_lshlrev_b32 v1, 4, v0
    v_and_b32 v8, 31, v0
    v_lshrrev_b32 v9, 5, v0
    s_cmp_ge_u32 s12, 80
    s_cbranch_scc1 layerb1_kernel_g_qk
    v_lshrrev_b32 v10, 3, v8
    v_and_b32 v11, 7, v8
    v_mul_u32_u24 v12, 20480, v10
    v_lshl_add_u32 v12, v11, 4, v12
    v_lshl_add_u32 v4, v9, 8, v12
    s_mul_i32 s24, s12, 327680
    s_mul_i32 s25, s13, 81920
    s_add_u32 s24, s24, s25
    s_add_u32 s24, s24, 27262976
    s_add_u32 s24, s24, 3584
    s_add_u32 s24, s24, 3584
    s_add_u32 s24, s24, 3584
    s_add_u32 s24, s24, 3584
    buffer_load_dwordx4 v[192:195], v4, s[8:11], s24 offen offset:2048
    buffer_load_dwordx4 v[196:199], v4, s[8:11], s24 offen offset:2176
    buffer_load_dwordx4 v[200:203], v4, s[8:11], s24 offen offset:2560
    buffer_load_dwordx4 v[204:207], v4, s[8:11], s24 offen offset:2688
    buffer_load_dwordx4 v[208:211], v4, s[8:11], s24 offen offset:3072
    buffer_load_dwordx4 v[212:215], v4, s[8:11], s24 offen offset:3200
    s_add_u32 s24, s24, 3584
    buffer_load_dwordx4 v[216:219], v4, s[8:11], s24 offen offset:0
    buffer_load_dwordx4 v[220:223], v4, s[8:11], s24 offen offset:128
    buffer_load_dwordx4 v[224:227], v4, s[8:11], s24 offen offset:512
    buffer_load_dwordx4 v[228:231], v4, s[8:11], s24 offen offset:640
    buffer_load_dwordx4 v[232:235], v4, s[8:11], s24 offen offset:1024
    buffer_load_dwordx4 v[236:239], v4, s[8:11], s24 offen offset:1152
    buffer_load_dwordx4 v[240:243], v4, s[8:11], s24 offen offset:1536
    buffer_load_dwordx4 v[244:247], v4, s[8:11], s24 offen offset:1664
    buffer_load_dwordx4 v[248:251], v4, s[8:11], s24 offen offset:2048
    buffer_load_dwordx4 v[252:255], v4, s[8:11], s24 offen offset:2176
    s_lshl_b32 s25, s13, 3
    v_add_u32 v10, s25, v10
    v_mul_u32_u24 v10, 640, v10
    v_lshl_add_u32 v10, v9, 7, v10
    v_lshl_add_u32 v10, v11, 4, v10
    v_add_u32 v3, 128, v10
    s_mul_i32 s17, s12, 20480
    s_mul_i32 s25, s14, 1638400
    s_add_u32 s17, s17, s25
    s_add_u32 s17, s17, 103809024
    s_mov_b32 s20, 1638400
    s_mul_i32 s19, s13, 10240
    s_add_u32 s19, s19, 220200960
    s_mov_b32 s22, 0
    s_mov_b32 s56, 0
    s_mov_b32 s58, 400000
    s_add_u32 s57, s48, 45056
    s_cmp_lg_u32 s13, 0
    s_cbranch_scc1 layerb1_kernel_gu_lw1
    s_min_u32 s28, s14, 63
    s_cmp_gt_u32 s56, s28
    s_cbranch_scc1 layerb1_kernel_gu_lw1
layerb1_kernel_gu_lp1:
    buffer_load_dwordx4 v[124:127], v1, s[8:11], s57 offen sc1
    s_waitcnt vmcnt(0)
    v_min_u32 v124, v124, v125
    v_min_u32 v126, v126, v127
    v_min_u32 v124, v124, v126
    v_cmp_eq_u32 vcc, 0, v124
    s_nop 1
    s_ff1_i32_b64 s56, vcc
    s_min_u32 s56, s56, 64
    s_sub_u32 s58, s58, 1
    s_cbranch_scc1 layerb1_kernel_bail
    s_cmp_gt_u32 s56, s28
    s_cbranch_scc0 layerb1_kernel_gu_lp1
layerb1_kernel_gu_lw1:
    s_barrier
    s_min_u32 s24, s14, 63
    s_mul_i32 s24, s24, 40960
    s_add_u32 s24, s24, s19
    s_mul_i32 s25, s13, 10240
    s_add_u32 s25, s25, s22
    s_mov_b32 m0, s25
    s_nop 0
    buffer_load_dwordx4 v1, s[8:11], s24 offen offset:0 sc1 lds
    buffer_load_dwordx4 v1, s[8:11], s24 offen offset:1024 sc1 lds
    buffer_load_dwordx4 v1, s[8:11], s24 offen offset:2048 sc1 lds
    buffer_load_dwordx4 v1, s[8:11], s24 offen offset:3072 sc1 lds
    s_add_u32 s24, s24, 4096
    s_add_u32 s25, s25, 4096
    s_mov_b32 m0, s25
    s_nop 0
    buffer_load_dwordx4 v1, s[8:11], s24 offen offset:0 sc1 lds
    buffer_load_dwordx4 v1, s[8:11], s24 offen offset:1024 sc1 lds
    buffer_load_dwordx4 v1, s[8:11], s24 offen offset:2048 sc1 lds
    buffer_load_dwordx4 v1, s[8:11], s24 offen offset:3072 sc1 lds
    s_add_u32 s24, s24, 4096
    s_add_u32 s25, s25, 4096
    s_mov_b32 m0, s25
    s_nop 0
    buffer_load_dwordx4 v1, s[8:11], s24 offen offset:0 sc1 lds
    buffer_load_dwordx4 v1, s[8:11], s24 offen offset:1024 sc1 lds
    s_mov_b32 s22, 40960
    s_mov_b32 s16, 0
    s_waitcnt vmcnt(0)
    s_barrier
    v_mov_b32 v2, v1
    ds_read_b128 v[8:11], v2 offset:0
    ds_read_b128 v[12:15], v2 offset:1024
    ds_read_b128 v[16:19], v2 offset:2048
    ds_read_b128 v[20:23], v2 offset:3072
    ds_read_b128 v[24:27], v2 offset:4096
    ds_read_b128 v[28:31], v2 offset:5120
    s_mov_b32 s55, 0
    v_mov_b32 v121, 122880
    ds_read_b128 v[32:35], v2 offset:6144
    s_waitcnt lgkmcnt(6)
    v_mfma_f32_32x32x16_bf16 v[40:55], v[8:11], a[0:3], 0
    v_mfma_f32_32x32x16_bf16 v[56:71], v[8:11], a[4:7], 0
    ds_read_b128 v[36:39], v2 offset:7168
    s_waitcnt lgkmcnt(6)
    v_mfma_f32_32x32x16_bf16 v[40:55], v[12:15], a[8:11], v[40:55]
    v_mfma_f32_32x32x16_bf16 v[56:71], v[12:15], a[12:15], v[56:71]
    ds_read_b128 v[8:11], v2 offset:8192
    s_waitcnt lgkmcnt(6)
    v_mfma_f32_32x32x16_bf16 v[40:55], v[16:19], a[16:19], v[40:55]
    v_mfma_f32_32x32x16_bf16 v[56:71], v[16:19], a[20:23], v[56:71]
    ds_read_b128 v[12:15], v2 offset:9216
    s_waitcnt lgkmcnt(6)
    v_mfma_f32_32x32x16_bf16 v[40:55], v[20:23], a[24:27], v[40:55]
    v_mfma_f32_32x32x16_bf16 v[56:71], v[20:23], a[28:31], v[56:71]
    ds_read_b128 v[16:19], v2 offset:10240
    s_waitcnt lgkmcnt(6)
    v_mfma_f32_32x32x16_bf16 v[40:55], v[24:27], a[32:35], v[40:55]
    v_mfma_f32_32x32x16_bf16 v[56:71], v[24:27], a[36:39], v[56:71]
    ds_read_b128 v[20:23], v2 offset:11264
    s_waitcnt lgkmcnt(6)
    v_mfma_f32_32x32x16_bf16 v[40:55], v[28:31], a[40:43], v[40:55]
    v_mfma_f32_32x32x16_bf16 v[56:71], v[28:31], a[44:47], v[56:71]
    ds_read_b128 v[24:27], v2 offset:12288
    s_waitcnt lgkmcnt(6)
    v_mfma_f32_32x32x16_bf16 v[40:55], v[32:35], a[48:51], v[40:55]
    v_mfma_f32_32x32x16_bf16 v[56:71], v[32:35], a[52:55], v[56:71]
    ds_read_b128 v[28:31], v2 offset:13312
    s_waitcnt lgkmcnt(6)
    v_mfma_f32_32x32x16_bf16 v[40:55], v[36:39], a[56:59], v[40:55]
    v_mfma_f32_32x32x16_bf16 v[56:71], v[36:39], a[60:63], v[56:71]
    ds_read_b128 v[32:35], v2 offset:14336
    s_waitcnt lgkmcnt(6)
    v_mfma_f32_32x32x16_bf16 v[40:55], v[8:11], a[64:67], v[40:55]
    v_mfma_f32_32x32x16_bf16 v[56:71], v[8:11], a[68:71], v[56:71]
    ds_read_b128 v[36:39], v2 offset:15360
    s_waitcnt lgkmcnt(6)
    v_mfma_f32_32x32x16_bf16 v[40:55], v[12:15], a[72:75], v[40:55]
    v_mfma_f32_32x32x16_bf16 v[56:71], v[12:15], a[76:79], v[56:71]
    ds_read_b128 v[8:11], v2 offset:16384
    s_waitcnt lgkmcnt(6)
    v_mfma_f32_32x32x16_bf16 v[40:55], v[16:19], a[80:83], v[40:55]
    v_mfma_f32_32x32x16_bf16 v[56:71], v[16:19], a[84:87], v[56:71]
    ds_read_b128 v[12:15], v2 offset:17408
    s_waitcnt lgkmcnt(6)
    v_mfma_f32_32x32x16_bf16 v[40:55], v[20:23], a[88:91], v[40:55]
    v_mfma_f32_32x32x16_bf16 v[56:71], v[20:23], a[92:95], v[56:71]
    ds_read_b128 v[16:19], v2 offset:18432
    s_waitcnt lgkmcnt(6)
    v_mfma_f32_32x32x16_bf16 v[40:55], v[24:27], a[96:99], v[40:55]
    v_mfma_f32_32x32x16_bf16 v[56:71], v[24:27], a[100:103], v[56:71]
    ds_read_b128 v[20:23], v2 offset:19456
    s_waitcnt lgkmcnt(6)
    v_mfma_f32_32x32x16_bf16 v[40:55], v[28:31], a[104:107], v[40:55]
    v_mfma_f32_32x32x16_bf16 v[56:71], v[28:31], a[108:111], v[56:71]
    ds_read_b128 v[24:27], v2 offset:20480
    s_waitcnt lgkmcnt(6)
    v_mfma_f32_32x32x16_bf16 v[40:55], v[32:35], a[112:115], v[40:55]
    v_mfma_f32_32x32x16_bf16 v[56:71], v[32:35], a[116:119], v[56:71]
    ds_read_b128 v[28:31], v2 offset:21504
    s_waitcnt lgkmcnt(6)
    v_mfma_f32_32x32x16_bf16 v[40:55], v[36:39], a[120:123], v[40:55]
    v_mfma_f32_32x32x16_bf16 v[56:71], v[36:39], a[124:127], v[56:71]
    ds_read_b128 v[32:35], v2 offset:22528
    s_waitcnt lgkmcnt(6)
    v_mfma_f32_32x32x16_bf16 v[40:55], v[8:11], a[128:131], v[40:55]
    v_mfma_f32_32x32x16_bf16 v[56:71], v[8:11], a[132:135], v[56:71]
    ds_read_b128 v[36:39], v2 offset:23552
    s_waitcnt lgkmcnt(6)
    v_mfma_f32_32x32x16_bf16 v[40:55], v[12:15], a[136:139], v[40:55]
    v_mfma_f32_32x32x16_bf16 v[56:71], v[12:15], a[140:143], v[56:71]
    ds_read_b128 v[8:11], v2 offset:24576
    s_waitcnt lgkmcnt(6)
    v_mfma_f32_32x32x16_bf16 v[40:55], v[16:19], a[144:147], v[40:55]
    v_mfma_f32_32x32x16_bf16 v[56:71], v[16:19], a[148:151], v[56:71]
    ds_read_b128 v[12:15], v2 offset:25600
    s_waitcnt lgkmcnt(6)
    v_mfma_f32_32x32x16_bf16 v[40:55], v[20:23], a[152:155], v[40:55]
    v_mfma_f32_32x32x16_bf16 v[56:71], v[20:23], a[156:159], v[56:71]
    ds_read_b128 v[16:19], v2 offset:26624
    s_waitcnt lgkmcnt(6)
    v_mfma_f32_32x32x16_bf16 v[40:55], v[24:27], a[160:163], v[40:55]
    v_mfma_f32_32x32x16_bf16 v[56:71], v[24:27], a[164:167], v[56:71]
    ds_read_b128 v[20:23], v2 offset:27648
    s_waitcnt lgkmcnt(6)
    v_mfma_f32_32x32x16_bf16 v[40:55], v[28:31], a[168:171], v[40:55]
    v_mfma_f32_32x32x16_bf16 v[56:71], v[28:31], a[172:175], v[56:71]
    ds_read_b128 v[24:27], v2 offset:28672
    s_waitcnt lgkmcnt(6)
    v_mfma_f32_32x32x16_bf16 v[40:55], v[32:35], a[176:179], v[40:55]
    v_mfma_f32_32x32x16_bf16 v[56:71], v[32:35], a[180:183], v[56:71]
    ds_read_b128 v[28:31], v2 offset:29696
    s_waitcnt lgkmcnt(6)
    buffer_load_dwordx4 v[124:127], v1, s[8:11], s57 offen sc1
    v_mfma_f32_32x32x16_bf16 v[40:55], v[36:39], a[184:187], v[40:55]
    v_mfma_f32_32x32x16_bf16 v[56:71], v[36:39], a[188:191], v[56:71]
    ds_read_b128 v[32:35], v2 offset:30720
    s_waitcnt lgkmcnt(6)
    v_mfma_f32_32x32x16_bf16 v[40:55], v[8:11], a[192:195], v[40:55]
    v_mfma_f32_32x32x16_bf16 v[56:71], v[8:11], a[196:199], v[56:71]
    ds_read_b128 v[36:39], v2 offset:31744
    s_waitcnt lgkmcnt(6)
    v_mfma_f32_32x32x16_bf16 v[40:55], v[12:15], a[200:203], v[40:55]
    v_mfma_f32_32x32x16_bf16 v[56:71], v[12:15], a[204:207], v[56:71]
    ds_read_b128 v[8:11], v2 offset:32768
    s_waitcnt lgkmcnt(6)
    v_mfma_f32_32x32x16_bf16 v[40:55], v[16:19], a[208:211], v[40:55]
    v_mfma_f32_32x32x16_bf16 v[56:71], v[16:19], a[212:215], v[56:71]
    ds_read_b128 v[12:15], v2 offset:33792
    s_waitcnt lgkmcnt(6)
    v_mfma_f32_32x32x16_bf16 v[40:55], v[20:23], a[216:219], v[40:55]
    v_mfma_f32_32x32x16_bf16 v[56:71], v[20:23], a[220:223], v[56:71]
    ds_read_b128 v[16:19], v2 offset:34816
    s_waitcnt lgkmcnt(6)
    v_mfma_f32_32x32x16_bf16 v[40:55], v[24:27], a[224:227], v[40:55]
    v_mfma_f32_32x32x16_bf16 v[56:71], v[24:27], a[228:231], v[56:71]
    ds_read_b128 v[20:23], v2 offset:35840
    s_waitcnt lgkmcnt(6)
    v_mfma_f32_32x32x16_bf16 v[40:55], v[28:31], a[232:235], v[40:55]
    v_mfma_f32_32x32x16_bf16 v[56:71], v[28:31], a[236:239], v[56:71]
    ds_read_b128 v[24:27], v2 offset:36864
    s_waitcnt lgkmcnt(6)
    v_mfma_f32_32x32x16_bf16 v[40:55], v[32:35], a[240:243], v[40:55]
    v_mfma_f32_32x32x16_bf16 v[56:71], v[32:35], a[244:247], v[56:71]
    ds_read_b128 v[28:31], v2 offset:37888
    s_waitcnt lgkmcnt(6)
    v_mfma_f32_32x32x16_bf16 v[40:55], v[36:39], a[248:251], v[40:55]
    v_mfma_f32_32x32x16_bf16 v[56:71], v[36:39], a[252:255], v[56:71]
    ds_read_b128 v[32:35], v2 offset:38912
    s_waitcnt lgkmcnt(6)
    v_mfma_f32_32x32x16_bf16 v[40:55], v[8:11], v[192:195], v[40:55]
    v_mfma_f32_32x32x16_bf16 v[56:71], v[8:11], v[196:199], v[56:71]
    ds_read_b128 v[36:39], v2 offset:39936
    s_waitcnt lgkmcnt(6)
    v_mfma_f32_32x32x16_bf16 v[40:55], v[12:15], v[200:203], v[40:55]
    v_mfma_f32_32x32x16_bf16 v[56:71], v[12:15], v[204:207], v[56:71]
    s_waitcnt lgkmcnt(5)
    s_waitcnt vmcnt(0)
    v_min_u32 v124, v124, v125
    v_min_u32 v126, v126, v127
    v_min_u32 v124, v124, v126
    v_cmp_eq_u32 vcc, 0, v124
    s_add_u32 s23, s14, 1
    s_nop 0
    s_ff1_i32_b64 s56, vcc
    s_min_u32 s56, s56, 64
    s_cmp_gt_u32 s56, s23
    s_cselect_b32 s59, 1, 0
    s_min_u32 s24, s23, 63
    s_mul_i32 s24, s24, 40960
    s_add_u32 s24, s24, s19
    s_mul_i32 s25, s13, 10240
    s_add_u32 s25, s25, s22
    v_mfma_f32_32x32x16_bf16 v[40:55], v[16:19], v[208:211], v[40:55]
    v_mfma_f32_32x32x16_bf16 v[56:71], v[16:19], v[212:215], v[56:71]
    s_mov_b32 m0, s25
    s_nop 0
    buffer_load_dwordx4 v1, s[8:11], s24 offen offset:0 sc1 lds
    s_waitcnt lgkmcnt(4)
    v_mfma_f32_32x32x16_bf16 v[40:55], v[20:23], v[216:219], v[40:55]
    buffer_load_dwordx4 v1, s[8:11], s24 offen offset:1024 sc1 lds
    v_mfma_f32_32x32x16_bf16 v[56:71], v[20:23], v[220:223], v[56:71]
    buffer_load_dwordx4 v1, s[8:11], s24 offen offset:2048 sc1 lds
    s_waitcnt lgkmcnt(3)
    v_mfma_f32_32x32x16_bf16 v[40:55], v[24:27], v[224:227], v[40:55]
    buffer_load_dwordx4 v1, s[8:11], s24 offen offset:3072 sc1 lds
    v_mfma_f32_32x32x16_bf16 v[56:71], v[24:27], v[228:231], v[56:71]
    s_add_u32 s24, s24, 4096
    s_add_u32 s25, s25, 4096
    s_mov_b32 m0, s25
    s_nop 0
    buffer_load_dwordx4 v1, s[8:11], s24 offen offset:0 sc1 lds
    s_waitcnt lgkmcnt(2)
    v_mfma_f32_32x32x16_bf16 v[40:55], v[28:31], v[232:235], v[40:55]
    buffer_load_dwordx4 v1, s[8:11], s24 offen offset:1024 sc1 lds
    v_mfma_f32_32x32x16_bf16 v[56:71], v[28:31], v[236:239], v[56:71]
    buffer_load_dwordx4 v1, s[8:11], s24 offen offset:2048 sc1 lds
    s_waitcnt lgkmcnt(1)
    v_mfma_f32_32x32x16_bf16 v[40:55], v[32:35], v[240:243], v[40:55]
    buffer_load_dwordx4 v1, s[8:11], s24 offen offset:3072 sc1 lds
    v_mfma_f32_32x32x16_bf16 v[56:71], v[32:35], v[244:247], v[56:71]
    s_add_u32 s24, s24, 4096
    s_add_u32 s25, s25, 4096
    s_mov_b32 m0, s25
    s_nop 0
    buffer_load_dwordx4 v1, s[8:11], s24 offen offset:0 sc1 lds
    s_waitcnt lgkmcnt(0)
    v_mfma_f32_32x32x16_bf16 v[40:55], v[36:39], v[248:251], v[40:55]
    buffer_load_dwordx4 v1, s[8:11], s24 offen offset:1024 sc1 lds
    v_mfma_f32_32x32x16_bf16 v[56:71], v[36:39], v[252:255], v[56:71]
    s_add_u32 s14, s14, 1
    s_nop 7
    s_nop 7
    v_cvt_pk_bf16_f32 v104, v40, v41
    v_cvt_pk_bf16_f32 v105, v42, v43
    v_cvt_pk_bf16_f32 v106, v44, v45
    v_cvt_pk_bf16_f32 v107, v46, v47
    s_nop 1
    v_permlane32_swap_b32 v104, v106
    v_permlane32_swap_b32 v105, v107
    buffer_store_dwordx4 v[104:107], v3, s[8:11], s17 offen offset:0 sc1
    v_cvt_pk_bf16_f32 v108, v48, v49
    v_cvt_pk_bf16_f32 v109, v50, v51
    v_cvt_pk_bf16_f32 v110, v52, v53
    v_cvt_pk_bf16_f32 v111, v54, v55
    s_nop 1
    v_permlane32_swap_b32 v108, v110
    v_permlane32_swap_b32 v109, v111
    buffer_store_dwordx4 v[108:111], v3, s[8:11], s17 offen offset:256 sc1
    v_cvt_pk_bf16_f32 v112, v56, v57
    v_cvt_pk_bf16_f32 v113, v58, v59
    v_cvt_pk_bf16_f32 v114, v60, v61
    v_cvt_pk_bf16_f32 v115, v62, v63
    s_nop 1
    v_permlane32_swap_b32 v112, v114
    v_permlane32_swap_b32 v113, v115
    buffer_store_dwordx4 v[112:115], v3, s[8:11], s17 offen offset:2560 sc1
    v_cvt_pk_bf16_f32 v116, v64, v65
    v_cvt_pk_bf16_f32 v117, v66, v67
    v_cvt_pk_bf16_f32 v118, v68, v69
    v_cvt_pk_bf16_f32 v119, v70, v71
    s_nop 1
    v_permlane32_swap_b32 v116, v118
    v_permlane32_swap_b32 v117, v119
    buffer_store_dwordx4 v[116:119], v3, s[8:11], s17 offen offset:2816 sc1
    s_add_u32 s17, s17, s20
    s_add_u32 s18, s18, s20
    s_branch layerb1_kernel_gu_epnow
    s_waitcnt vmcnt(4)
    v_min_u32 v124, v124, v125
    v_min_u32 v126, v126, v127
    v_min_u32 v124, v124, v126
    v_cmp_eq_u32 vcc, 0, v124
    s_mov_b32 s59, 0
    s_nop 0
    s_ff1_i32_b64 s56, vcc
    s_min_u32 s56, s56, 64
    s_cmp_gt_u32 s56, s14
    s_cbranch_scc0 layerb1_kernel_gu_epnow
    s_min_u32 s24, s14, 63
    s_mul_i32 s24, s24, 40960
    s_add_u32 s24, s24, s19
    s_mul_i32 s25, s13, 10240
    s_add_u32 s25, s25, s22
    s_mov_b32 m0, s25
    s_nop 0
    buffer_load_dwordx4 v1, s[8:11], s24 offen offset:0 sc1 lds
    buffer_load_dwordx4 v1, s[8:11], s24 offen offset:1024 sc1 lds
    buffer_load_dwordx4 v1, s[8:11], s24 offen offset:2048 sc1 lds
    buffer_load_dwordx4 v1, s[8:11], s24 offen offset:3072 sc1 lds
    s_add_u32 s24, s24, 4096
    s_add_u32 s25, s25, 4096
    s_mov_b32 m0, s25
    s_nop 0
    buffer_load_dwordx4 v1, s[8:11], s24 offen offset:0 sc1 lds
    buffer_load_dwordx4 v1, s[8:11], s24 offen offset:1024 sc1 lds
    buffer_load_dwordx4 v1, s[8:11], s24 offen offset:2048 sc1 lds
    buffer_load_dwordx4 v1, s[8:11], s24 offen offset:3072 sc1 lds
    s_add_u32 s24, s24, 4096
    s_add_u32 s25, s25, 4096
    s_mov_b32 m0, s25
    s_nop 0
    buffer_load_dwordx4 v1, s[8:11], s24 offen offset:0 sc1 lds
    buffer_load_dwordx4 v1, s[8:11], s24 offen offset:1024 sc1 lds
    s_waitcnt vmcnt(10)
    s_barrier
    s_cmp_lg_u32 s13, 0
    s_cbranch_scc1 layerb1_kernel_gu_fl2
    s_mov_b64 exec, 1
    s_lshl_b32 s26, s12, 7
    v_mov_b32 v7, s26
    v_mov_b32 v120, s14
    buffer_store_dword v120, v7, s[8:11], s48 offen sc1
    s_mov_b64 exec, -1
layerb1_kernel_gu_fl2:
    s_cmp_eq_u32 s13, 0
    s_cbranch_scc1 layerb1_kernel_gu_epx1
    s_waitcnt vmcnt(0)
layerb1_kernel_gu_epx1:
    s_waitcnt vmcnt(1)
    s_branch layerb1_kernel_gu_ephave
layerb1_kernel_gu_ep:
    ds_read_b128 v[32:35], v2 offset:6144
    s_waitcnt lgkmcnt(6)
    v_mfma_f32_32x32x16_bf16 v[40:55], v[8:11], a[0:3], 0
    v_mfma_f32_32x32x16_bf16 v[56:71], v[8:11], a[4:7], 0
    ds_read_b128 v[36:39], v2 offset:7168
    s_waitcnt lgkmcnt(6)
    v_mfma_f32_32x32x16_bf16 v[40:55], v[12:15], a[8:11], v[40:55]
    v_mfma_f32_32x32x16_bf16 v[56:71], v[12:15], a[12:15], v[56:71]
    ds_read_b128 v[8:11], v2 offset:8192
    s_waitcnt lgkmcnt(6)
    v_mfma_f32_32x32x16_bf16 v[40:55], v[16:19], a[16:19], v[40:55]
    v_mfma_f32_32x32x16_bf16 v[56:71], v[16:19], a[20:23], v[56:71]
    ds_read_b128 v[12:15], v2 offset:9216
    s_waitcnt lgkmcnt(6)
    v_mfma_f32_32x32x16_bf16 v[40:55], v[20:23], a[24:27], v[40:55]
    v_mfma_f32_32x32x16_bf16 v[56:71], v[20:23], a[28:31], v[56:71]
    ds_read_b128 v[16:19], v2 offset:10240
    s_waitcnt lgkmcnt(6)
    v_mfma_f32_32x32x16_bf16 v[40:55], v[24:27], a[32:35], v[40:55]
    v_mfma_f32_32x32x16_bf16 v[56:71], v[24:27], a[36:39], v[56:71]
    ds_read_b128 v[20:23], v2 offset:11264
    s_waitcnt lgkmcnt(6)
    v_mfma_f32_32x32x16_bf16 v[40:55], v[28:31], a[40:43], v[40:55]
    v_mfma_f32_32x32x16_bf16 v[56:71], v[28:31], a[44:47], v[56:71]
    ds_read_b128 v[24:27], v2 offset:12288
    s_waitcnt lgkmcnt(6)
    s_cmp_lg_u32 s13, 1
    s_cbranch_scc1 layerb1_kernel_gu_eplTrue
    buffer_load_dwordx4 v[124:127], v1, s[8:11], s57 offen sc1
layerb1_kernel_gu_eplTrue:
    v_mfma_f32_32x32x16_bf16 v[40:55], v[32:35], a[48:51], v[40:55]
    v_mfma_f32_32x32x16_bf16 v[56:71], v[32:35], a[52:55], v[56:71]
    ds_read_b128 v[28:31], v2 offset:13312
    s_waitcnt lgkmcnt(6)
    v_mfma_f32_32x32x16_bf16 v[40:55], v[36:39], a[56:59], v[40:55]
    v_mfma_f32_32x32x16_bf16 v[56:71], v[36:39], a[60:63], v[56:71]
    ds_read_b128 v[32:35], v2 offset:14336
    s_waitcnt lgkmcnt(6)
    v_mfma_f32_32x32x16_bf16 v[40:55], v[8:11], a[64:67], v[40:55]
    v_mfma_f32_32x32x16_bf16 v[56:71], v[8:11], a[68:71], v[56:71]
    ds_read_b128 v[36:39], v2 offset:15360
    s_waitcnt lgkmcnt(6)
    v_mfma_f32_32x32x16_bf16 v[40:55], v[12:15], a[72:75], v[40:55]
    v_mfma_f32_32x32x16_bf16 v[56:71], v[12:15], a[76:79], v[56:71]
    ds_read_b128 v[8:11], v2 offset:16384
    s_waitcnt lgkmcnt(6)
    v_mfma_f32_32x32x16_bf16 v[40:55], v[16:19], a[80:83], v[40:55]
    v_mfma_f32_32x32x16_bf16 v[56:71], v[16:19], a[84:87], v[56:71]
    ds_read_b128 v[12:15], v2 offset:17408
    s_waitcnt lgkmcnt(6)
    v_mfma_f32_32x32x16_bf16 v[40:55], v[20:23], a[88:91], v[40:55]
    v_mfma_f32_32x32x16_bf16 v[56:71], v[20:23], a[92:95], v[56:71]
    ds_read_b128 v[16:19], v2 offset:18432
    s_waitcnt lgkmcnt(6)
    v_mfma_f32_32x32x16_bf16 v[40:55], v[24:27], a[96:99], v[40:55]
    v_mfma_f32_32x32x16_bf16 v[56:71], v[24:27], a[100:103], v[56:71]
    ds_read_b128 v[20:23], v2 offset:19456
    s_waitcnt lgkmcnt(6)
    v_mfma_f32_32x32x16_bf16 v[40:55], v[28:31], a[104:107], v[40:55]
    v_mfma_f32_32x32x16_bf16 v[56:71], v[28:31], a[108:111], v[56:71]
    ds_read_b128 v[24:27], v2 offset:20480
    s_waitcnt lgkmcnt(6)
    s_cmp_eq_u32 s55, 0
    s_cbranch_scc1 layerb1_kernel_gu_epq
    s_cmp_lg_u32 s13, 1
    s_cbranch_scc1 layerb1_kernel_gu_epq0
    s_waitcnt vmcnt(1)
    s_branch layerb1_kernel_gu_epq1
layerb1_kernel_gu_epq0:
    s_waitcnt vmcnt(0)
layerb1_kernel_gu_epq1:
    s_barrier
    s_cmp_lg_u32 s13, 0
    s_cbranch_scc1 layerb1_kernel_gu_fl3
    s_mov_b64 exec, 1
    s_lshl_b32 s26, s12, 7
    v_mov_b32 v7, s26
    v_mov_b32 v120, s14
    buffer_store_dword v120, v7, s[8:11], s48 offen sc1
    s_mov_b64 exec, -1
layerb1_kernel_gu_fl3:
    s_mov_b32 s55, 0
layerb1_kernel_gu_epq:
    v_mfma_f32_32x32x16_bf16 v[40:55], v[32:35], a[112:115], v[40:55]
    v_mfma_f32_32x32x16_bf16 v[56:71], v[32:35], a[116:119], v[56:71]
    ds_read_b128 v[28:31], v2 offset:21504
    s_waitcnt lgkmcnt(6)
    v_mfma_f32_32x32x16_bf16 v[40:55], v[36:39], a[120:123], v[40:55]
    v_mfma_f32_32x32x16_bf16 v[56:71], v[36:39], a[124:127], v[56:71]
    ds_read_b128 v[32:35], v2 offset:22528
    s_waitcnt lgkmcnt(6)
    v_mfma_f32_32x32x16_bf16 v[40:55], v[8:11], a[128:131], v[40:55]
    v_mfma_f32_32x32x16_bf16 v[56:71], v[8:11], a[132:135], v[56:71]
    ds_read_b128 v[36:39], v2 offset:23552
    s_waitcnt lgkmcnt(6)
    v_mfma_f32_32x32x16_bf16 v[40:55], v[12:15], a[136:139], v[40:55]
    v_mfma_f32_32x32x16_bf16 v[56:71], v[12:15], a[140:143], v[56:71]
    ds_read_b128 v[8:11], v2 offset:24576
    s_waitcnt lgkmcnt(6)
    s_cmp_lg_u32 s13, 1
    s_cbranch_scc1 layerb1_kernel_gu_epwTrue
    s_waitcnt vmcnt(0)
    v_min_u32 v124, v124, v125
    v_min_u32 v126, v126, v127
    v_min_u32 v124, v124, v126
    v_cmp_eq_u32 vcc, 0, v124
    s_nop 1
    s_ff1_i32_b64 s56, vcc
    s_min_u32 s56, s56, 64
    v_mov_b32 v122, s56
    ds_write_b32 v121, v122
    s_waitcnt lgkmcnt(0)
layerb1_kernel_gu_epwTrue:
    s_barrier
    ds_read_b32 v122, v121
    s_add_u32 s23, s14, 1
    s_min_u32 s24, s23, 63
    s_mul_i32 s24, s24, 40960
    s_add_u32 s24, s24, s19
    s_mul_i32 s25, s13, 10240
    s_add_u32 s25, s25, s22
    v_mfma_f32_32x32x16_bf16 v[40:55], v[16:19], a[144:147], v[40:55]
    v_mfma_f32_32x32x16_bf16 v[56:71], v[16:19], a[148:151], v[56:71]
    s_mov_b32 m0, s25
    s_nop 0
    buffer_load_dwordx4 v1, s[8:11], s24 offen offset:0 sc1 lds
    ds_read_b128 v[12:15], v2 offset:25600
    s_waitcnt lgkmcnt(6)
    v_mfma_f32_32x32x16_bf16 v[40:55], v[20:23], a[152:155], v[40:55]
    buffer_load_dwordx4 v1, s[8:11], s24 offen offset:1024 sc1 lds
    v_mfma_f32_32x32x16_bf16 v[56:71], v[20:23], a[156:159], v[56:71]
    buffer_load_dwordx4 v1, s[8:11], s24 offen offset:2048 sc1 lds
    ds_read_b128 v[16:19], v2 offset:26624
    s_waitcnt lgkmcnt(6)
    v_mfma_f32_32x32x16_bf16 v[40:55], v[24:27], a[160:163], v[40:55]
    buffer_load_dwordx4 v1, s[8:11], s24 offen offset:3072 sc1 lds
    v_mfma_f32_32x32x16_bf16 v[56:71], v[24:27], a[164:167], v[56:71]
    s_add_u32 s24, s24, 4096
    s_add_u32 s25, s25, 4096
    s_mov_b32 m0, s25
    s_nop 0
    buffer_load_dwordx4 v1, s[8:11], s24 offen offset:0 sc1 lds
    ds_read_b128 v[20:23], v2 offset:27648
    s_waitcnt lgkmcnt(6)
    v_mfma_f32_32x32x16_bf16 v[40:55], v[28:31], a[168:171], v[40:55]
    buffer_load_dwordx4 v1, s[8:11], s24 offen offset:1024 sc1 lds
    v_mfma_f32_32x32x16_bf16 v[56:71], v[28:31], a[172:175], v[56:71]
    buffer_load_dwordx4 v1, s[8:11], s24 offen offset:2048 sc1 lds
    ds_read_b128 v[24:27], v2 offset:28672
    s_waitcnt lgkmcnt(6)
    v_mfma_f32_32x32x16_bf16 v[40:55], v[32:35], a[176:179], v[40:55]
    buffer_load_dwordx4 v1, s[8:11], s24 offen offset:3072 sc1 lds
    v_mfma_f32_32x32x16_bf16 v[56:71], v[32:35], a[180:183], v[56:71]
    s_add_u32 s24, s24, 4096
    s_add_u32 s25, s25, 4096
    s_mov_b32 m0, s25
    s_nop 0
    buffer_load_dwordx4 v1, s[8:11], s24 offen offset:0 sc1 lds
    ds_read_b128 v[28:31], v2 offset:29696
    s_waitcnt lgkmcnt(6)
    v_mfma_f32_32x32x16_bf16 v[40:55], v[36:39], a[184:187], v[40:55]
    buffer_load_dwordx4 v1, s[8:11], s24 offen offset:1024 sc1 lds
    v_mfma_f32_32x32x16_bf16 v[56:71], v[36:39], a[188:191], v[56:71]
    ds_read_b128 v[32:35], v2 offset:30720
    s_waitcnt lgkmcnt(6)
    v_mfma_f32_32x32x16_bf16 v[40:55], v[8:11], a[192:195], v[40:55]
    v_mfma_f32_32x32x16_bf16 v[56:71], v[8:11], a[196:199], v[56:71]
    ds_read_b128 v[36:39], v2 offset:31744
    s_waitcnt lgkmcnt(6)
    v_mfma_f32_32x32x16_bf16 v[40:55], v[12:15], a[200:203], v[40:55]
    v_mfma_f32_32x32x16_bf16 v[56:71], v[12:15], a[204:207], v[56:71]
    ds_read_b128 v[8:11], v2 offset:32768
    s_waitcnt lgkmcnt(6)
    v_mfma_f32_32x32x16_bf16 v[40:55], v[16:19], a[208:211], v[40:55]
    v_mfma_f32_32x32x16_bf16 v[56:71], v[16:19], a[212:215], v[56:71]
    ds_read_b128 v[12:15], v2 offset:33792
    s_waitcnt lgkmcnt(6)
    v_mfma_f32_32x32x16_bf16 v[40:55], v[20:23], a[216:219], v[40:55]
    v_mfma_f32_32x32x16_bf16 v[56:71], v[20:23], a[220:223], v[56:71]
    ds_read_b128 v[16:19], v2 offset:34816
    s_waitcnt lgkmcnt(6)
    v_mfma_f32_32x32x16_bf16 v[40:55], v[24:27], a[224:227], v[40:55]
    v_mfma_f32_32x32x16_bf16 v[56:71], v[24:27], a[228:231], v[56:71]
    ds_read_b128 v[20:23], v2 offset:35840
    s_waitcnt lgkmcnt(6)
    v_mfma_f32_32x32x16_bf16 v[40:55], v[28:31], a[232:235], v[40:55]
    v_mfma_f32_32x32x16_bf16 v[56:71], v[28:31], a[236:239], v[56:71]
    ds_read_b128 v[24:27], v2 offset:36864
    s_waitcnt lgkmcnt(6)
    v_mfma_f32_32x32x16_bf16 v[40:55], v[32:35], a[240:243], v[40:55]
    v_mfma_f32_32x32x16_bf16 v[56:71], v[32:35], a[244:247], v[56:71]
    ds_read_b128 v[28:31], v2 offset:37888
    s_waitcnt lgkmcnt(6)
    v_mfma_f32_32x32x16_bf16 v[40:55], v[36:39], a[248:251], v[40:55]
    v_mfma_f32_32x32x16_bf16 v[56:71], v[36:39], a[252:255], v[56:71]
    ds_read_b128 v[32:35], v2 offset:38912
    s_waitcnt lgkmcnt(6)
    v_mfma_f32_32x32x16_bf16 v[40:55], v[8:11], v[192:195], v[40:55]
    v_mfma_f32_32x32x16_bf16 v[56:71], v[8:11], v[196:199], v[56:71]
    ds_read_b128 v[36:39], v2 offset:39936
    s_waitcnt lgkmcnt(6)
    v_mfma_f32_32x32x16_bf16 v[40:55], v[12:15], v[200:203], v[40:55]
    v_mfma_f32_32x32x16_bf16 v[56:71], v[12:15], v[204:207], v[56:71]
    s_waitcnt lgkmcnt(5)
    v_mfma_f32_32x32x16_bf16 v[40:55], v[16:19], v[208:211], v[40:55]
    v_mfma_f32_32x32x16_bf16 v[56:71], v[16:19], v[212:215], v[56:71]
    s_waitcnt lgkmcnt(4)
    v_mfma_f32_32x32x16_bf16 v[40:55], v[20:23], v[216:219], v[40:55]
    v_mfma_f32_32x32x16_bf16 v[56:71], v[20:23], v[220:223], v[56:71]
    s_waitcnt lgkmcnt(3)
    v_mfma_f32_32x32x16_bf16 v[40:55], v[24:27], v[224:227], v[40:55]
    v_mfma_f32_32x32x16_bf16 v[56:71], v[24:27], v[228:231], v[56:71]
    s_waitcnt lgkmcnt(2)
    v_mfma_f32_32x32x16_bf16 v[40:55], v[28:31], v[232:235], v[40:55]
    v_mfma_f32_32x32x16_bf16 v[56:71], v[28:31], v[236:239], v[56:71]
    s_waitcnt lgkmcnt(1)
    v_mfma_f32_32x32x16_bf16 v[40:55], v[32:35], v[240:243], v[40:55]
    v_mfma_f32_32x32x16_bf16 v[56:71], v[32:35], v[244:247], v[56:71]
    s_waitcnt lgkmcnt(0)
    v_mfma_f32_32x32x16_bf16 v[40:55], v[36:39], v[248:251], v[40:55]
    v_mfma_f32_32x32x16_bf16 v[56:71], v[36:39], v[252:255], v[56:71]
    s_add_u32 s14, s14, 1
    v_readfirstlane_b32 s56, v122
    s_mov_b32 s59, 0
    s_nop 0
    s_cmp_gt_u32 s56, s14
    s_cselect_b32 s59, 1, 0
    s_nop 7
    s_nop 7
    v_cvt_pk_bf16_f32 v104, v40, v41
    v_cvt_pk_bf16_f32 v105, v42, v43
    v_cvt_pk_bf16_f32 v106, v44, v45
    v_cvt_pk_bf16_f32 v107, v46, v47
    s_nop 1
    v_permlane32_swap_b32 v104, v106
    v_permlane32_swap_b32 v105, v107
    buffer_store_dwordx4 v[104:107], v3, s[8:11], s17 offen offset:0 sc1
    v_cvt_pk_bf16_f32 v108, v48, v49
    v_cvt_pk_bf16_f32 v109, v50, v51
    v_cvt_pk_bf16_f32 v110, v52, v53
    v_cvt_pk_bf16_f32 v111, v54, v55
    s_nop 1
    v_permlane32_swap_b32 v108, v110
    v_permlane32_swap_b32 v109, v111
    buffer_store_dwordx4 v[108:111], v3, s[8:11], s17 offen offset:256 sc1
    v_cvt_pk_bf16_f32 v112, v56, v57
    v_cvt_pk_bf16_f32 v113, v58, v59
    v_cvt_pk_bf16_f32 v114, v60, v61
    v_cvt_pk_bf16_f32 v115, v62, v63
    s_nop 1
    v_permlane32_swap_b32 v112, v114
    v_permlane32_swap_b32 v113, v115
    buffer_store_dwordx4 v[112:115], v3, s[8:11], s17 offen offset:2560 sc1
    v_cvt_pk_bf16_f32 v116, v64, v65
    v_cvt_pk_bf16_f32 v117, v66, v67
    v_cvt_pk_bf16_f32 v118, v68, v69
    v_cvt_pk_bf16_f32 v119, v70, v71
    s_nop 1
    v_permlane32_swap_b32 v116, v118
    v_permlane32_swap_b32 v117, v119
    buffer_store_dwordx4 v[116:119], v3, s[8:11], s17 offen offset:2816 sc1
    s_add_u32 s17, s17, s20
    s_add_u32 s18, s18, s20
    s_cmp_le_u32 s14, 0
    s_cbranch_scc1 layerb1_kernel_gu_epnow
    s_cmp_ge_u32 s14, 6
    s_cbranch_scc1 layerb1_kernel_gu_epnow
    s_cmp_eq_u32 s59, 0
    s_cbranch_scc1 layerb1_kernel_gu_epnow
    s_waitcnt vmcnt(4)
    s_mov_b32 s55, 1
    s_branch layerb1_kernel_gu_ephave
layerb1_kernel_gu_epnow:
    s_waitcnt vmcnt(0)
    s_barrier
    s_cmp_lg_u32 s13, 0
    s_cbranch_scc1 layerb1_kernel_gu_fl4
    s_mov_b64 exec, 1
    s_lshl_b32 s26, s12, 7
    v_mov_b32 v7, s26
    v_mov_b32 v120, s14
    buffer_store_dword v120, v7, s[8:11], s48 offen sc1
    s_mov_b64 exec, -1
layerb1_kernel_gu_fl4:
    s_mov_b32 s55, 0
    s_cmp_eq_u32 s59, 1
    s_cbranch_scc1 layerb1_kernel_gu_ephave
layerb1_kernel_gu_eppoll:
    buffer_load_dwordx4 v[124:127], v1, s[8:11], s57 offen sc1
    s_waitcnt vmcnt(0)
    v_min_u32 v124, v124, v125
    v_min_u32 v126, v126, v127
    v_min_u32 v124, v124, v126
    v_cmp_eq_u32 vcc, 0, v124
    s_nop 1
    s_ff1_i32_b64 s56, vcc
    s_min_u32 s56, s56, 64
    s_cmp_gt_u32 s56, s14
    s_cbranch_scc1 layerb1_kernel_gu_epok
    s_sub_u32 s58, s58, 1
    s_cbranch_scc1 layerb1_kernel_bail
    s_branch layerb1_kernel_gu_eppoll
layerb1_kernel_gu_epok:
    s_min_u32 s24, s14, 63
    s_mul_i32 s24, s24, 40960
    s_add_u32 s24, s24, s19
    s_mul_i32 s25, s13, 10240
    s_add_u32 s25, s25, s22
    s_mov_b32 m0, s25
    s_nop 0
    buffer_load_dwordx4 v1, s[8:11], s24 offen offset:0 sc1 lds
    buffer_load_dwordx4 v1, s[8:11], s24 offen offset:1024 sc1 lds
    buffer_load_dwordx4 v1, s[8:11], s24 offen offset:2048 sc1 lds
    buffer_load_dwordx4 v1, s[8:11], s24 offen offset:3072 sc1 lds
    s_add_u32 s24, s24, 4096
    s_add_u32 s25, s25, 4096
    s_mov_b32 m0, s25
    s_nop 0
    buffer_load_dwordx4 v1, s[8:11], s24 offen offset:0 sc1 lds
    buffer_load_dwordx4 v1, s[8:11], s24 offen offset:1024 sc1 lds
    buffer_load_dwordx4 v1, s[8:11], s24 offen offset:2048 sc1 lds
    buffer_load_dwordx4 v1, s[8:11], s24 offen offset:3072 sc1 lds
    s_add_u32 s24, s24, 4096
    s_add_u32 s25, s25, 4096
    s_mov_b32 m0, s25
    s_nop 0
    buffer_load_dwordx4 v1, s[8:11], s24 offen offset:0 sc1 lds
    buffer_load_dwordx4 v1, s[8:11], s24 offen offset:1024 sc1 lds
    s_waitcnt vmcnt(0)
layerb1_kernel_gu_ephave:
    s_mov_b32 s16, s22
    s_add_u32 s22, s22, 40960
    s_cmp_eq_u32 s22, 122880
    s_cselect_b32 s22, 0, s22
    v_add_u32 v2, s16, v1
    s_barrier
    ds_read_b128 v[8:11], v2 offset:0
    ds_read_b128 v[12:15], v2 offset:1024
    ds_read_b128 v[16:19], v2 offset:2048
    ds_read_b128 v[20:23], v2 offset:3072
    ds_read_b128 v[24:27], v2 offset:4096
    ds_read_b128 v[28:31], v2 offset:5120
    s_cmp_lt_u32 s14, 6
    s_cbranch_scc1 layerb1_kernel_gu_ep
    ds_read_b128 v[32:35], v2 offset:6144
    s_waitcnt lgkmcnt(6)
    v_mfma_f32_32x32x16_bf16 v[72:87], v[8:11], a[0:3], 0
    v_mfma_f32_32x32x16_bf16 v[88:103], v[8:11], a[4:7], 0
    ds_read_b128 v[36:39], v2 offset:7168
    s_waitcnt lgkmcnt(6)
    v_mfma_f32_32x32x16_bf16 v[72:87], v[12:15], a[8:11], v[72:87]
    v_mfma_f32_32x32x16_bf16 v[88:103], v[12:15], a[12:15], v[88:103]
    ds_read_b128 v[8:11], v2 offset:8192
    s_waitcnt lgkmcnt(6)
    v_mfma_f32_32x32x16_bf16 v[72:87], v[16:19], a[16:19], v[72:87]
    v_mfma_f32_32x32x16_bf16 v[88:103], v[16:19], a[20:23], v[88:103]
    s_add_u32 s23, s14, 1
    s_cmp_lg_u32 s13, 0
    s_cbranch_scc1 layerb1_kernel_gu_lw5
    s_min_u32 s28, s23, 63
    s_cmp_gt_u32 s56, s28
    s_cbranch_scc1 layerb1_kernel_gu_lw5
layerb1_kernel_gu_lp5:
    buffer_load_dwordx4 v[124:127], v1, s[8:11], s57 offen sc1
    s_waitcnt vmcnt(0)
    v_min_u32 v124, v124, v125
    v_min_u32 v126, v126, v127
    v_min_u32 v124, v124, v126
    v_cmp_eq_u32 vcc, 0, v124
    s_nop 1
    s_ff1_i32_b64 s56, vcc
    s_min_u32 s56, s56, 64
    s_sub_u32 s58, s58, 1
    s_cbranch_scc1 layerb1_kernel_bail
    s_cmp_gt_u32 s56, s28
    s_cbranch_scc0 layerb1_kernel_gu_lp5
layerb1_kernel_gu_lw5:
    s_barrier
    s_min_u32 s24, s23, 63
    s_mul_i32 s24, s24, 40960
    s_add_u32 s24, s24, s19
    s_mul_i32 s25, s13, 10240
    s_add_u32 s25, s25, s22
    s_add_u32 s22, s22, 40960
    s_cmp_eq_u32 s22, 122880
    s_cselect_b32 s22, 0, s22
    ds_read_b128 v[12:15], v2 offset:9216
    s_waitcnt lgkmcnt(6)
    v_mfma_f32_32x32x16_bf16 v[72:87], v[20:23], a[24:27], v[72:87]
    s_mov_b32 m0, s25
    s_nop 0
    buffer_load_dwordx4 v1, s[8:11], s24 offen offset:0 sc1 lds
    v_mfma_f32_32x32x16_bf16 v[88:103], v[20:23], a[28:31], v[88:103]
    ds_read_b128 v[16:19], v2 offset:10240
    s_waitcnt lgkmcnt(6)
    v_mfma_f32_32x32x16_bf16 v[72:87], v[24:27], a[32:35], v[72:87]
    buffer_load_dwordx4 v1, s[8:11], s24 offen offset:1024 sc1 lds
    v_mfma_f32_32x32x16_bf16 v[88:103], v[24:27], a[36:39], v[88:103]
    ds_read_b128 v[20:23], v2 offset:11264
    s_waitcnt lgkmcnt(6)
    v_mfma_f32_32x32x16_bf16 v[72:87], v[28:31], a[40:43], v[72:87]
    buffer_load_dwordx4 v1, s[8:11], s24 offen offset:2048 sc1 lds
    v_mfma_f32_32x32x16_bf16 v[88:103], v[28:31], a[44:47], v[88:103]
    ds_read_b128 v[24:27], v2 offset:12288
    s_waitcnt lgkmcnt(6)
    v_mfma_f32_32x32x16_bf16 v[72:87], v[32:35], a[48:51], v[72:87]
    buffer_load_dwordx4 v1, s[8:11], s24 offen offset:3072 sc1 lds
    v_mfma_f32_32x32x16_bf16 v[88:103], v[32:35], a[52:55], v[88:103]
    ds_read_b128 v[28:31], v2 offset:13312
    s_waitcnt lgkmcnt(6)
    v_mfma_f32_32x32x16_bf16 v[72:87], v[36:39], a[56:59], v[72:87]
    s_add_u32 s24, s24, 4096
    s_add_u32 s25, s25, 4096
    s_mov_b32 m0, s25
    s_nop 0
    buffer_load_dwordx4 v1, s[8:11], s24 offen offset:0 sc1 lds
    v_mfma_f32_32x32x16_bf16 v[88:103], v[36:39], a[60:63], v[88:103]
    ds_read_b128 v[32:35], v2 offset:14336
    s_waitcnt lgkmcnt(6)
    v_mfma_f32_32x32x16_bf16 v[72:87], v[8:11], a[64:67], v[72:87]
    buffer_load_dwordx4 v1, s[8:11], s24 offen offset:1024 sc1 lds
    v_mfma_f32_32x32x16_bf16 v[88:103], v[8:11], a[68:71], v[88:103]
    ds_read_b128 v[36:39], v2 offset:15360
    s_waitcnt lgkmcnt(6)
    v_mfma_f32_32x32x16_bf16 v[72:87], v[12:15], a[72:75], v[72:87]
    buffer_load_dwordx4 v1, s[8:11], s24 offen offset:2048 sc1 lds
    v_mfma_f32_32x32x16_bf16 v[88:103], v[12:15], a[76:79], v[88:103]
    ds_read_b128 v[8:11], v2 offset:16384
    s_waitcnt lgkmcnt(6)
    v_mfma_f32_32x32x16_bf16 v[72:87], v[16:19], a[80:83], v[72:87]
    buffer_load_dwordx4 v1, s[8:11], s24 offen offset:3072 sc1 lds
    v_mfma_f32_32x32x16_bf16 v[88:103], v[16:19], a[84:87], v[88:103]
    ds_read_b128 v[12:15], v2 offset:17408
    s_waitcnt lgkmcnt(6)
    v_mfma_f32_32x32x16_bf16 v[72:87], v[20:23], a[88:91], v[72:87]
    s_add_u32 s24, s24, 4096
    s_add_u32 s25, s25, 4096
    s_mov_b32 m0, s25
    s_nop 0
    buffer_load_dwordx4 v1, s[8:11], s24 offen offset:0 sc1 lds
    v_mfma_f32_32x32x16_bf16 v[88:103], v[20:23], a[92:95], v[88:103]
    ds_read_b128 v[16:19], v2 offset:18432
    s_waitcnt lgkmcnt(6)
    v_mfma_f32_32x32x16_bf16 v[72:87], v[24:27], a[96:99], v[72:87]
    buffer_load_dwordx4 v1, s[8:11], s24 offen offset:1024 sc1 lds
    v_mfma_f32_32x32x16_bf16 v[88:103], v[24:27], a[100:103], v[88:103]
    ds_read_b128 v[20:23], v2 offset:19456
    s_waitcnt lgkmcnt(6)
    v_mfma_f32_32x32x16_bf16 v[72:87], v[28:31], a[104:107], v[72:87]
    v_mfma_f32_32x32x16_bf16 v[88:103], v[28:31], a[108:111], v[88:103]
    ds_read_b128 v[24:27], v2 offset:20480
    s_waitcnt lgkmcnt(6)
    v_mfma_f32_32x32x16_bf16 v[72:87], v[32:35], a[112:115], v[72:87]
    v_mfma_f32_32x32x16_bf16 v[88:103], v[32:35], a[116:119], v[88:103]
    ds_read_b128 v[28:31], v2 offset:21504
    s_waitcnt lgkmcnt(6)
    v_mfma_f32_32x32x16_bf16 v[72:87], v[36:39], a[120:123], v[72:87]
    v_mfma_f32_32x32x16_bf16 v[88:103], v[36:39], a[124:127], v[88:103]
    ds_read_b128 v[32:35], v2 offset:22528
    s_waitcnt lgkmcnt(6)
    v_mfma_f32_32x32x16_bf16 v[72:87], v[8:11], a[128:131], v[72:87]
    v_mfma_f32_32x32x16_bf16 v[88:103], v[8:11], a[132:135], v[88:103]
    ds_read_b128 v[36:39], v2 offset:23552
    s_waitcnt lgkmcnt(6)
    v_mfma_f32_32x32x16_bf16 v[72:87], v[12:15], a[136:139], v[72:87]
    v_mfma_f32_32x32x16_bf16 v[88:103], v[12:15], a[140:143], v[88:103]
    ds_read_b128 v[8:11], v2 offset:24576
    s_waitcnt lgkmcnt(6)
    v_mfma_f32_32x32x16_bf16 v[72:87], v[16:19], a[144:147], v[72:87]
    v_mfma_f32_32x32x16_bf16 v[88:103], v[16:19], a[148:151], v[88:103]
    ds_read_b128 v[12:15], v2 offset:25600
    s_waitcnt lgkmcnt(6)
    v_mfma_f32_32x32x16_bf16 v[72:87], v[20:23], a[152:155], v[72:87]
    v_mfma_f32_32x32x16_bf16 v[88:103], v[20:23], a[156:159], v[88:103]
    ds_read_b128 v[16:19], v2 offset:26624
    s_waitcnt lgkmcnt(6)
    v_mfma_f32_32x32x16_bf16 v[72:87], v[24:27], a[160:163], v[72:87]
    v_mfma_f32_32x32x16_bf16 v[88:103], v[24:27], a[164:167], v[88:103]
    ds_read_b128 v[20:23], v2 offset:27648
    s_waitcnt lgkmcnt(6)
    v_mfma_f32_32x32x16_bf16 v[72:87], v[28:31], a[168:171], v[72:87]
    v_mfma_f32_32x32x16_bf16 v[88:103], v[28:31], a[172:175], v[88:103]
    ds_read_b128 v[24:27], v2 offset:28672
    s_waitcnt lgkmcnt(6)
    v_mfma_f32_32x32x16_bf16 v[72:87], v[32:35], a[176:179], v[72:87]
    v_mfma_f32_32x32x16_bf16 v[88:103], v[32:35], a[180:183], v[88:103]
    ds_read_b128 v[28:31], v2 offset:29696
    s_waitcnt lgkmcnt(6)
    v_mfma_f32_32x32x16_bf16 v[72:87], v[36:39], a[184:187], v[72:87]
    v_mfma_f32_32x32x16_bf16 v[88:103], v[36:39], a[188:191], v[88:103]
    ds_read_b128 v[32:35], v2 offset:30720
    s_waitcnt lgkmcnt(6)
    v_mfma_f32_32x32x16_bf16 v[72:87], v[8:11], a[192:195], v[72:87]
    v_mfma_f32_32x32x16_bf16 v[88:103], v[8:11], a[196:199], v[88:103]
    ds_read_b128 v[36:39], v2 offset:31744
    s_waitcnt lgkmcnt(6)
    v_mfma_f32_32x32x16_bf16 v[72:87], v[12:15], a[200:203], v[72:87]
    v_mfma_f32_32x32x16_bf16 v[88:103], v[12:15], a[204:207], v[88:103]
    ds_read_b128 v[8:11], v2 offset:32768
    s_waitcnt lgkmcnt(6)
    v_mfma_f32_32x32x16_bf16 v[72:87], v[16:19], a[208:211], v[72:87]
    v_mfma_f32_32x32x16_bf16 v[88:103], v[16:19], a[212:215], v[88:103]
    ds_read_b128 v[12:15], v2 offset:33792
    s_waitcnt lgkmcnt(6)
    v_mfma_f32_32x32x16_bf16 v[72:87], v[20:23], a[216:219], v[72:87]
    v_mfma_f32_32x32x16_bf16 v[88:103], v[20:23], a[220:223], v[88:103]
    ds_read_b128 v[16:19], v2 offset:34816
    s_waitcnt lgkmcnt(6)
    v_mfma_f32_32x32x16_bf16 v[72:87], v[24:27], a[224:227], v[72:87]
    v_mfma_f32_32x32x16_bf16 v[88:103], v[24:27], a[228:231], v[88:103]
    s_add_u32 s23, s14, 2
    s_cmp_lg_u32 s13, 0
    s_cbranch_scc1 layerb1_kernel_gu_lw6
    s_min_u32 s28, s23, 63
    s_cmp_gt_u32 s56, s28
    s_cbranch_scc1 layerb1_kernel_gu_lw6
layerb1_kernel_gu_lp6:
    buffer_load_dwordx4 v[124:127], v1, s[8:11], s57 offen sc1
    s_waitcnt vmcnt(0)
    v_min_u32 v124, v124, v125
    v_min_u32 v126, v126, v127
    v_min_u32 v124, v124, v126
    v_cmp_eq_u32 vcc, 0, v124
    s_nop 1
    s_ff1_i32_b64 s56, vcc
    s_min_u32 s56, s56, 64
    s_sub_u32 s58, s58, 1
    s_cbranch_scc1 layerb1_kernel_bail
    s_cmp_gt_u32 s56, s28
    s_cbranch_scc0 layerb1_kernel_gu_lp6
layerb1_kernel_gu_lw6:
    s_waitcnt vmcnt(0)
    s_barrier
    s_add_u32 s21, s16, 40960
    s_cmp_eq_u32 s21, 122880
    s_cselect_b32 s21, 0, s21
    s_add_u32 s23, s14, 2
    s_min_u32 s24, s23, 63
    s_mul_i32 s24, s24, 40960
    s_add_u32 s24, s24, s19
    s_mul_i32 s25, s13, 10240
    s_add_u32 s25, s25, s22
    s_add_u32 s22, s22, 40960
    s_cmp_eq_u32 s22, 122880
    s_cselect_b32 s22, 0, s22
    ds_read_b128 v[20:23], v2 offset:35840
    s_waitcnt lgkmcnt(6)
    v_mfma_f32_32x32x16_bf16 v[72:87], v[28:31], a[232:235], v[72:87]
    s_mov_b32 m0, s25
    s_nop 0
    buffer_load_dwordx4 v1, s[8:11], s24 offen offset:0 sc1 lds
    v_mfma_f32_32x32x16_bf16 v[88:103], v[28:31], a[236:239], v[88:103]
    ds_read_b128 v[24:27], v2 offset:36864
    s_waitcnt lgkmcnt(6)
    v_mfma_f32_32x32x16_bf16 v[72:87], v[32:35], a[240:243], v[72:87]
    buffer_load_dwordx4 v1, s[8:11], s24 offen offset:1024 sc1 lds
    v_mfma_f32_32x32x16_bf16 v[88:103], v[32:35], a[244:247], v[88:103]
    ds_read_b128 v[28:31], v2 offset:37888
    s_waitcnt lgkmcnt(6)
    v_mfma_f32_32x32x16_bf16 v[72:87], v[36:39], a[248:251], v[72:87]
    buffer_load_dwordx4 v1, s[8:11], s24 offen offset:2048 sc1 lds
    v_mfma_f32_32x32x16_bf16 v[88:103], v[36:39], a[252:255], v[88:103]
    ds_read_b128 v[32:35], v2 offset:38912
    s_waitcnt lgkmcnt(6)
    v_mfma_f32_32x32x16_bf16 v[72:87], v[8:11], v[192:195], v[72:87]
    buffer_load_dwordx4 v1, s[8:11], s24 offen offset:3072 sc1 lds
    v_mfma_f32_32x32x16_bf16 v[88:103], v[8:11], v[196:199], v[88:103]
    ds_read_b128 v[36:39], v2 offset:39936
    s_waitcnt lgkmcnt(6)
    v_mfma_f32_32x32x16_bf16 v[72:87], v[12:15], v[200:203], v[72:87]
    s_add_u32 s24, s24, 4096
    s_add_u32 s25, s25, 4096
    s_mov_b32 m0, s25
    s_nop 0
    buffer_load_dwordx4 v1, s[8:11], s24 offen offset:0 sc1 lds
    v_mfma_f32_32x32x16_bf16 v[88:103], v[12:15], v[204:207], v[88:103]
    v_add_u32 v6, s21, v1
    ds_read_b128 v[8:11], v6 offset:0
    s_waitcnt lgkmcnt(6)
    v_mfma_f32_32x32x16_bf16 v[72:87], v[16:19], v[208:211], v[72:87]
    buffer_load_dwordx4 v1, s[8:11], s24 offen offset:1024 sc1 lds
    v_mfma_f32_32x32x16_bf16 v[88:103], v[16:19], v[212:215], v[88:103]
    ds_read_b128 v[12:15], v6 offset:1024
    s_waitcnt lgkmcnt(6)
    v_mfma_f32_32x32x16_bf16 v[72:87], v[20:23], v[216:219], v[72:87]
    buffer_load_dwordx4 v1, s[8:11], s24 offen offset:2048 sc1 lds
    v_mfma_f32_32x32x16_bf16 v[88:103], v[20:23], v[220:223], v[88:103]
    ds_read_b128 v[16:19], v6 offset:2048
    s_waitcnt lgkmcnt(6)
    v_mfma_f32_32x32x16_bf16 v[72:87], v[24:27], v[224:227], v[72:87]
    buffer_load_dwordx4 v1, s[8:11], s24 offen offset:3072 sc1 lds
    v_mfma_f32_32x32x16_bf16 v[88:103], v[24:27], v[228:231], v[88:103]
    ds_read_b128 v[20:23], v6 offset:3072
    s_waitcnt lgkmcnt(6)
    v_mfma_f32_32x32x16_bf16 v[72:87], v[28:31], v[232:235], v[72:87]
    s_add_u32 s24, s24, 4096
    s_add_u32 s25, s25, 4096
    s_mov_b32 m0, s25
    s_nop 0
    buffer_load_dwordx4 v1, s[8:11], s24 offen offset:0 sc1 lds
    v_mfma_f32_32x32x16_bf16 v[88:103], v[28:31], v[236:239], v[88:103]
    ds_read_b128 v[24:27], v6 offset:4096
    s_waitcnt lgkmcnt(6)
    v_mfma_f32_32x32x16_bf16 v[72:87], v[32:35], v[240:243], v[72:87]
    buffer_load_dwordx4 v1, s[8:11], s24 offen offset:1024 sc1 lds
    v_mfma_f32_32x32x16_bf16 v[88:103], v[32:35], v[244:247], v[88:103]
    ds_read_b128 v[28:31], v6 offset:5120
    s_waitcnt lgkmcnt(6)
    v_mfma_f32_32x32x16_bf16 v[72:87], v[36:39], v[248:251], v[72:87]
    v_mfma_f32_32x32x16_bf16 v[88:103], v[36:39], v[252:255], v[88:103]
    v_mov_b32 v2, v6
    s_mov_b32 s16, s21
    s_add_u32 s14, s14, 1
layerb1_kernel_gu_loop:
    ds_read_b128 v[32:35], v2 offset:6144
    s_waitcnt lgkmcnt(6)
    v_mfma_f32_32x32x16_bf16 v[40:55], v[8:11], a[0:3], 0
    v_mfma_f32_32x32x16_bf16 v[56:71], v[8:11], a[4:7], 0
    ds_read_b128 v[36:39], v2 offset:7168
    s_waitcnt lgkmcnt(6)
    v_mfma_f32_32x32x16_bf16 v[40:55], v[12:15], a[8:11], v[40:55]
    v_mfma_f32_32x32x16_bf16 v[56:71], v[12:15], a[12:15], v[56:71]
    ds_read_b128 v[8:11], v2 offset:8192
    s_waitcnt lgkmcnt(6)
    v_mfma_f32_32x32x16_bf16 v[40:55], v[16:19], a[16:19], v[40:55]
    v_cvt_pk_bf16_f32 v104, v72, v73
    v_mfma_f32_32x32x16_bf16 v[56:71], v[16:19], a[20:23], v[56:71]
    v_cvt_pk_bf16_f32 v105, v74, v75
    ds_read_b128 v[12:15], v2 offset:9216
    s_waitcnt lgkmcnt(6)
    v_mfma_f32_32x32x16_bf16 v[40:55], v[20:23], a[24:27], v[40:55]
    v_cvt_pk_bf16_f32 v106, v76, v77
    v_mfma_f32_32x32x16_bf16 v[56:71], v[20:23], a[28:31], v[56:71]
    v_cvt_pk_bf16_f32 v107, v78, v79
    ds_read_b128 v[16:19], v2 offset:10240
    s_waitcnt lgkmcnt(6)
    v_mfma_f32_32x32x16_bf16 v[40:55], v[24:27], a[32:35], v[40:55]
    s_nop 1
    v_mfma_f32_32x32x16_bf16 v[56:71], v[24:27], a[36:39], v[56:71]
    v_permlane32_swap_b32 v104, v106
    ds_read_b128 v[20:23], v2 offset:11264
    s_waitcnt lgkmcnt(6)
    v_mfma_f32_32x32x16_bf16 v[40:55], v[28:31], a[40:43], v[40:55]
    v_permlane32_swap_b32 v105, v107
    v_mfma_f32_32x32x16_bf16 v[56:71], v[28:31], a[44:47], v[56:71]
    buffer_store_dwordx4 v[104:107], v3, s[8:11], s17 offen offset:0 sc1
    ds_read_b128 v[24:27], v2 offset:12288
    s_waitcnt lgkmcnt(6)
    v_mfma_f32_32x32x16_bf16 v[40:55], v[32:35], a[48:51], v[40:55]
    v_cvt_pk_bf16_f32 v108, v80, v81
    v_mfma_f32_32x32x16_bf16 v[56:71], v[32:35], a[52:55], v[56:71]
    v_cvt_pk_bf16_f32 v109, v82, v83
    ds_read_b128 v[28:31], v2 offset:13312
    s_waitcnt lgkmcnt(6)
    v_mfma_f32_32x32x16_bf16 v[40:55], v[36:39], a[56:59], v[40:55]
    v_cvt_pk_bf16_f32 v110, v84, v85
    v_mfma_f32_32x32x16_bf16 v[56:71], v[36:39], a[60:63], v[56:71]
    v_cvt_pk_bf16_f32 v111, v86, v87
    ds_read_b128 v[32:35], v2 offset:14336
    s_waitcnt lgkmcnt(6)
    v_mfma_f32_32x32x16_bf16 v[40:55], v[8:11], a[64:67], v[40:55]
    s_nop 1
    v_mfma_f32_32x32x16_bf16 v[56:71], v[8:11], a[68:71], v[56:71]
    v_permlane32_swap_b32 v108, v110
    ds_read_b128 v[36:39], v2 offset:15360
    s_waitcnt lgkmcnt(6)
    v_mfma_f32_32x32x16_bf16 v[40:55], v[12:15], a[72:75], v[40:55]
    v_permlane32_swap_b32 v109, v111
    v_mfma_f32_32x32x16_bf16 v[56:71], v[12:15], a[76:79], v[56:71]
    buffer_store_dwordx4 v[108:111], v3, s[8:11], s17 offen offset:256 sc1
    ds_read_b128 v[8:11], v2 offset:16384
    s_waitcnt lgkmcnt(6)
    v_mfma_f32_32x32x16_bf16 v[40:55], v[16:19], a[80:83], v[40:55]
    v_cvt_pk_bf16_f32 v112, v88, v89
    v_mfma_f32_32x32x16_bf16 v[56:71], v[16:19], a[84:87], v[56:71]
    v_cvt_pk_bf16_f32 v113, v90, v91
    ds_read_b128 v[12:15], v2 offset:17408
    s_waitcnt lgkmcnt(6)
    v_mfma_f32_32x32x16_bf16 v[40:55], v[20:23], a[88:91], v[40:55]
    v_cvt_pk_bf16_f32 v114, v92, v93
    v_mfma_f32_32x32x16_bf16 v[56:71], v[20:23], a[92:95], v[56:71]
    v_cvt_pk_bf16_f32 v115, v94, v95
    ds_read_b128 v[16:19], v2 offset:18432
    s_waitcnt lgkmcnt(6)
    v_mfma_f32_32x32x16_bf16 v[40:55], v[24:27], a[96:99], v[40:55]
    s_nop 1
    v_mfma_f32_32x32x16_bf16 v[56:71], v[24:27], a[100:103], v[56:71]
    v_permlane32_swap_b32 v112, v114
    ds_read_b128 v[20:23], v2 offset:19456
    s_waitcnt lgkmcnt(6)
    v_mfma_f32_32x32x16_bf16 v[40:55], v[28:31], a[104:107], v[40:55]
    v_permlane32_swap_b32 v113, v115
    v_mfma_f32_32x32x16_bf16 v[56:71], v[28:31], a[108:111], v[56:71]
    buffer_store_dwordx4 v[112:115], v3, s[8:11], s17 offen offset:2560 sc1
    ds_read_b128 v[24:27], v2 offset:20480
    s_waitcnt lgkmcnt(6)
    v_mfma_f32_32x32x16_bf16 v[40:55], v[32:35], a[112:115], v[40:55]
    v_cvt_pk_bf16_f32 v116, v96, v97
    v_mfma_f32_32x32x16_bf16 v[56:71], v[32:35], a[116:119], v[56:71]
    v_cvt_pk_bf16_f32 v117, v98, v99
    ds_read_b128 v[28:31], v2 offset:21504
    s_waitcnt lgkmcnt(6)
    v_mfma_f32_32x32x16_bf16 v[40:55], v[36:39], a[120:123], v[40:55]
    v_cvt_pk_bf16_f32 v118, v100, v101
    v_mfma_f32_32x32x16_bf16 v[56:71], v[36:39], a[124:127], v[56:71]
    v_cvt_pk_bf16_f32 v119, v102, v103
    ds_read_b128 v[32:35], v2 offset:22528
    s_waitcnt lgkmcnt(6)
    v_mfma_f32_32x32x16_bf16 v[40:55], v[8:11], a[128:131], v[40:55]
    s_nop 1
    v_mfma_f32_32x32x16_bf16 v[56:71], v[8:11], a[132:135], v[56:71]
    v_permlane32_swap_b32 v116, v118
    ds_read_b128 v[36:39], v2 offset:23552
    s_waitcnt lgkmcnt(6)
    v_mfma_f32_32x32x16_bf16 v[40:55], v[12:15], a[136:139], v[40:55]
    v_permlane32_swap_b32 v117, v119
    v_mfma_f32_32x32x16_bf16 v[56:71], v[12:15], a[140:143], v[56:71]
    buffer_store_dwordx4 v[116:119], v3, s[8:11], s17 offen offset:2816 sc1
    ds_read_b128 v[8:11], v2 offset:24576
    s_waitcnt lgkmcnt(6)
    v_mfma_f32_32x32x16_bf16 v[40:55], v[16:19], a[144:147], v[40:55]
    s_add_u32 s17, s17, s20
    v_mfma_f32_32x32x16_bf16 v[56:71], v[16:19], a[148:151], v[56:71]
    s_add_u32 s18, s18, s20
    ds_read_b128 v[12:15], v2 offset:25600
    s_waitcnt lgkmcnt(6)
    v_mfma_f32_32x32x16_bf16 v[40:55], v[20:23], a[152:155], v[40:55]
    v_mfma_f32_32x32x16_bf16 v[56:71], v[20:23], a[156:159], v[56:71]
    ds_read_b128 v[16:19], v2 offset:26624
    s_waitcnt lgkmcnt(6)
    v_mfma_f32_32x32x16_bf16 v[40:55], v[24:27], a[160:163], v[40:55]
    v_mfma_f32_32x32x16_bf16 v[56:71], v[24:27], a[164:167], v[56:71]
    ds_read_b128 v[20:23], v2 offset:27648
    s_waitcnt lgkmcnt(6)
    v_mfma_f32_32x32x16_bf16 v[40:55], v[28:31], a[168:171], v[40:55]
    v_mfma_f32_32x32x16_bf16 v[56:71], v[28:31], a[172:175], v[56:71]
    ds_read_b128 v[24:27], v2 offset:28672
    s_waitcnt lgkmcnt(6)
    v_mfma_f32_32x32x16_bf16 v[40:55], v[32:35], a[176:179], v[40:55]
    v_mfma_f32_32x32x16_bf16 v[56:71], v[32:35], a[180:183], v[56:71]
    ds_read_b128 v[28:31], v2 offset:29696
    s_waitcnt lgkmcnt(6)
    v_mfma_f32_32x32x16_bf16 v[40:55], v[36:39], a[184:187], v[40:55]
    v_mfma_f32_32x32x16_bf16 v[56:71], v[36:39], a[188:191], v[56:71]
    ds_read_b128 v[32:35], v2 offset:30720
    s_waitcnt lgkmcnt(6)
    v_mfma_f32_32x32x16_bf16 v[40:55], v[8:11], a[192:195], v[40:55]
    v_mfma_f32_32x32x16_bf16 v[56:71], v[8:11], a[196:199], v[56:71]
    ds_read_b128 v[36:39], v2 offset:31744
    s_waitcnt lgkmcnt(6)
    v_mfma_f32_32x32x16_bf16 v[40:55], v[12:15], a[200:203], v[40:55]
    v_mfma_f32_32x32x16_bf16 v[56:71], v[12:15], a[204:207], v[56:71]
    ds_read_b128 v[8:11], v2 offset:32768
    s_waitcnt lgkmcnt(6)
    v_mfma_f32_32x32x16_bf16 v[40:55], v[16:19], a[208:211], v[40:55]
    v_mfma_f32_32x32x16_bf16 v[56:71], v[16:19], a[212:215], v[56:71]
    ds_read_b128 v[12:15], v2 offset:33792
    s_waitcnt lgkmcnt(6)
    v_mfma_f32_32x32x16_bf16 v[40:55], v[20:23], a[216:219], v[40:55]
    v_mfma_f32_32x32x16_bf16 v[56:71], v[20:23], a[220:223], v[56:71]
    ds_read_b128 v[16:19], v2 offset:34816
    s_waitcnt lgkmcnt(6)
    v_mfma_f32_32x32x16_bf16 v[40:55], v[24:27], a[224:227], v[40:55]
    v_mfma_f32_32x32x16_bf16 v[56:71], v[24:27], a[228:231], v[56:71]
    s_add_u32 s23, s14, 2
    s_cmp_gt_u32 s14, 12
    s_cbranch_scc1 layerb1_kernel_gu_fa7
    s_waitcnt vmcnt(0)
    s_barrier
    s_cmp_lg_u32 s13, 0
    s_cbranch_scc1 layerb1_kernel_gu_fl8
    s_mov_b64 exec, 1
    s_lshl_b32 s26, s12, 7
    v_mov_b32 v7, s26
    v_mov_b32 v120, s14
    buffer_store_dword v120, v7, s[8:11], s48 offen sc1
    s_mov_b64 exec, -1
layerb1_kernel_gu_fl8:
    s_cmp_lg_u32 s13, 0
    s_cbranch_scc1 layerb1_kernel_gu_lw9
    s_min_u32 s28, s23, 63
    s_cmp_gt_u32 s56, s28
    s_cbranch_scc1 layerb1_kernel_gu_lw9
layerb1_kernel_gu_lp9:
    buffer_load_dwordx4 v[124:127], v1, s[8:11], s57 offen sc1
    s_waitcnt vmcnt(0)
    v_min_u32 v124, v124, v125
    v_min_u32 v126, v126, v127
    v_min_u32 v124, v124, v126
    v_cmp_eq_u32 vcc, 0, v124
    s_nop 1
    s_ff1_i32_b64 s56, vcc
    s_min_u32 s56, s56, 64
    s_sub_u32 s58, s58, 1
    s_cbranch_scc1 layerb1_kernel_bail
    s_cmp_gt_u32 s56, s28
    s_cbranch_scc0 layerb1_kernel_gu_lp9
layerb1_kernel_gu_lw9:
    s_barrier
    s_branch layerb1_kernel_gu_fb7
layerb1_kernel_gu_fa7:
    s_cmp_lg_u32 s13, 0
    s_cbranch_scc1 layerb1_kernel_gu_lw10
    s_min_u32 s28, s23, 63
    s_cmp_gt_u32 s56, s28
    s_cbranch_scc1 layerb1_kernel_gu_lw10
layerb1_kernel_gu_lp10:
    buffer_load_dwordx4 v[124:127], v1, s[8:11], s57 offen sc1
    s_waitcnt vmcnt(0)
    v_min_u32 v124, v124, v125
    v_min_u32 v126, v126, v127
    v_min_u32 v124, v124, v126
    v_cmp_eq_u32 vcc, 0, v124
    s_nop 1
    s_ff1_i32_b64 s56, vcc
    s_min_u32 s56, s56, 64
    s_sub_u32 s58, s58, 1
    s_cbranch_scc1 layerb1_kernel_bail
    s_cmp_gt_u32 s56, s28
    s_cbranch_scc0 layerb1_kernel_gu_lp10
layerb1_kernel_gu_lw10:
    s_waitcnt vmcnt(4)
    s_sub_u32 s27, s14, 1
    s_barrier
    s_cmp_lg_u32 s13, 0
    s_cbranch_scc1 layerb1_kernel_gu_fl11
    s_mov_b64 exec, 1
    s_lshl_b32 s26, s12, 7
    v_mov_b32 v7, s26
    v_mov_b32 v120, s27
    buffer_store_dword v120, v7, s[8:11], s48 offen sc1
    s_mov_b64 exec, -1
layerb1_kernel_gu_fl11:
layerb1_kernel_gu_fb7:
    s_add_u32 s21, s16, 40960
    s_cmp_eq_u32 s21, 122880
    s_cselect_b32 s21, 0, s21
    s_add_u32 s23, s14, 2
    s_min_u32 s24, s23, 63
    s_mul_i32 s24, s24, 40960
    s_add_u32 s24, s24, s19
    s_mul_i32 s25, s13, 10240
    s_add_u32 s25, s25, s22
    s_add_u32 s22, s22, 40960
    s_cmp_eq_u32 s22, 122880
    s_cselect_b32 s22, 0, s22
    ds_read_b128 v[20:23], v2 offset:35840
    s_waitcnt lgkmcnt(6)
    v_mfma_f32_32x32x16_bf16 v[40:55], v[28:31], a[232:235], v[40:55]
    s_mov_b32 m0, s25
    s_nop 0
    buffer_load_dwordx4 v1, s[8:11], s24 offen offset:0 sc1 lds
    v_mfma_f32_32x32x16_bf16 v[56:71], v[28:31], a[236:239], v[56:71]
    ds_read_b128 v[24:27], v2 offset:36864
    s_waitcnt lgkmcnt(6)
    v_mfma_f32_32x32x16_bf16 v[40:55], v[32:35], a[240:243], v[40:55]
    buffer_load_dwordx4 v1, s[8:11], s24 offen offset:1024 sc1 lds
    v_mfma_f32_32x32x16_bf16 v[56:71], v[32:35], a[244:247], v[56:71]
    ds_read_b128 v[28:31], v2 offset:37888
    s_waitcnt lgkmcnt(6)
    v_mfma_f32_32x32x16_bf16 v[40:55], v[36:39], a[248:251], v[40:55]
    buffer_load_dwordx4 v1, s[8:11], s24 offen offset:2048 sc1 lds
    v_mfma_f32_32x32x16_bf16 v[56:71], v[36:39], a[252:255], v[56:71]
    ds_read_b128 v[32:35], v2 offset:38912
    s_waitcnt lgkmcnt(6)
    v_mfma_f32_32x32x16_bf16 v[40:55], v[8:11], v[192:195], v[40:55]
    buffer_load_dwordx4 v1, s[8:11], s24 offen offset:3072 sc1 lds
    v_mfma_f32_32x32x16_bf16 v[56:71], v[8:11], v[196:199], v[56:71]
    ds_read_b128 v[36:39], v2 offset:39936
    s_waitcnt lgkmcnt(6)
    v_mfma_f32_32x32x16_bf16 v[40:55], v[12:15], v[200:203], v[40:55]
    s_add_u32 s24, s24, 4096
    s_add_u32 s25, s25, 4096
    s_mov_b32 m0, s25
    s_nop 0
    buffer_load_dwordx4 v1, s[8:11], s24 offen offset:0 sc1 lds
    v_mfma_f32_32x32x16_bf16 v[56:71], v[12:15], v[204:207], v[56:71]
    v_add_u32 v6, s21, v1
    ds_read_b128 v[8:11], v6 offset:0
    s_waitcnt lgkmcnt(6)
    v_mfma_f32_32x32x16_bf16 v[40:55], v[16:19], v[208:211], v[40:55]
    buffer_load_dwordx4 v1, s[8:11], s24 offen offset:1024 sc1 lds
    v_mfma_f32_32x32x16_bf16 v[56:71], v[16:19], v[212:215], v[56:71]
    ds_read_b128 v[12:15], v6 offset:1024
    s_waitcnt lgkmcnt(6)
    v_mfma_f32_32x32x16_bf16 v[40:55], v[20:23], v[216:219], v[40:55]
    buffer_load_dwordx4 v1, s[8:11], s24 offen offset:2048 sc1 lds
    v_mfma_f32_32x32x16_bf16 v[56:71], v[20:23], v[220:223], v[56:71]
    ds_read_b128 v[16:19], v6 offset:2048
    s_waitcnt lgkmcnt(6)
    v_mfma_f32_32x32x16_bf16 v[40:55], v[24:27], v[224:227], v[40:55]
    buffer_load_dwordx4 v1, s[8:11], s24 offen offset:3072 sc1 lds
    v_mfma_f32_32x32x16_bf16 v[56:71], v[24:27], v[228:231], v[56:71]
    ds_read_b128 v[20:23], v6 offset:3072
    s_waitcnt lgkmcnt(6)
    v_mfma_f32_32x32x16_bf16 v[40:55], v[28:31], v[232:235], v[40:55]
    s_add_u32 s24, s24, 4096
    s_add_u32 s25, s25, 4096
    s_mov_b32 m0, s25
    s_nop 0
    buffer_load_dwordx4 v1, s[8:11], s24 offen offset:0 sc1 lds
    v_mfma_f32_32x32x16_bf16 v[56:71], v[28:31], v[236:239], v[56:71]
    ds_read_b128 v[24:27], v6 offset:4096
    s_waitcnt lgkmcnt(6)
    v_mfma_f32_32x32x16_bf16 v[40:55], v[32:35], v[240:243], v[40:55]
    buffer_load_dwordx4 v1, s[8:11], s24 offen offset:1024 sc1 lds
    v_mfma_f32_32x32x16_bf16 v[56:71], v[32:35], v[244:247], v[56:71]
    ds_read_b128 v[28:31], v6 offset:5120
    s_waitcnt lgkmcnt(6)
    v_mfma_f32_32x32x16_bf16 v[40:55], v[36:39], v[248:251], v[40:55]
    v_mfma_f32_32x32x16_bf16 v[56:71], v[36:39], v[252:255], v[56:71]
    v_mov_b32 v2, v6
    s_mov_b32 s16, s21
    s_add_u32 s14, s14, 1
    s_cmp_ge_u32 s14, s15
    s_cbranch_scc1 layerb1_kernel_gu_fin0
    ds_read_b128 v[32:35], v2 offset:6144
    s_waitcnt lgkmcnt(6)
    v_mfma_f32_32x32x16_bf16 v[72:87], v[8:11], a[0:3], 0
    v_mfma_f32_32x32x16_bf16 v[88:103], v[8:11], a[4:7], 0
    ds_read_b128 v[36:39], v2 offset:7168
    s_waitcnt lgkmcnt(6)
    v_mfma_f32_32x32x16_bf16 v[72:87], v[12:15], a[8:11], v[72:87]
    v_mfma_f32_32x32x16_bf16 v[88:103], v[12:15], a[12:15], v[88:103]
    ds_read_b128 v[8:11], v2 offset:8192
    s_waitcnt lgkmcnt(6)
    v_mfma_f32_32x32x16_bf16 v[72:87], v[16:19], a[16:19], v[72:87]
    v_cvt_pk_bf16_f32 v104, v40, v41
    v_mfma_f32_32x32x16_bf16 v[88:103], v[16:19], a[20:23], v[88:103]
    v_cvt_pk_bf16_f32 v105, v42, v43
    ds_read_b128 v[12:15], v2 offset:9216
    s_waitcnt lgkmcnt(6)
    v_mfma_f32_32x32x16_bf16 v[72:87], v[20:23], a[24:27], v[72:87]
    v_cvt_pk_bf16_f32 v106, v44, v45
    v_mfma_f32_32x32x16_bf16 v[88:103], v[20:23], a[28:31], v[88:103]
    v_cvt_pk_bf16_f32 v107, v46, v47
    ds_read_b128 v[16:19], v2 offset:10240
    s_waitcnt lgkmcnt(6)
    v_mfma_f32_32x32x16_bf16 v[72:87], v[24:27], a[32:35], v[72:87]
    s_nop 1
    v_mfma_f32_32x32x16_bf16 v[88:103], v[24:27], a[36:39], v[88:103]
    v_permlane32_swap_b32 v104, v106
    ds_read_b128 v[20:23], v2 offset:11264
    s_waitcnt lgkmcnt(6)
    v_mfma_f32_32x32x16_bf16 v[72:87], v[28:31], a[40:43], v[72:87]
    v_permlane32_swap_b32 v105, v107
    v_mfma_f32_32x32x16_bf16 v[88:103], v[28:31], a[44:47], v[88:103]
    buffer_store_dwordx4 v[104:107], v3, s[8:11], s17 offen offset:0 sc1
    ds_read_b128 v[24:27], v2 offset:12288
    s_waitcnt lgkmcnt(6)
    v_mfma_f32_32x32x16_bf16 v[72:87], v[32:35], a[48:51], v[72:87]
    v_cvt_pk_bf16_f32 v108, v48, v49
    v_mfma_f32_32x32x16_bf16 v[88:103], v[32:35], a[52:55], v[88:103]
    v_cvt_pk_bf16_f32 v109, v50, v51
    ds_read_b128 v[28:31], v2 offset:13312
    s_waitcnt lgkmcnt(6)
    v_mfma_f32_32x32x16_bf16 v[72:87], v[36:39], a[56:59], v[72:87]
    v_cvt_pk_bf16_f32 v110, v52, v53
    v_mfma_f32_32x32x16_bf16 v[88:103], v[36:39], a[60:63], v[88:103]
    v_cvt_pk_bf16_f32 v111, v54, v55
    ds_read_b128 v[32:35], v2 offset:14336
    s_waitcnt lgkmcnt(6)
    v_mfma_f32_32x32x16_bf16 v[72:87], v[8:11], a[64:67], v[72:87]
    s_nop 1
    v_mfma_f32_32x32x16_bf16 v[88:103], v[8:11], a[68:71], v[88:103]
    v_permlane32_swap_b32 v108, v110
    ds_read_b128 v[36:39], v2 offset:15360
    s_waitcnt lgkmcnt(6)
    v_mfma_f32_32x32x16_bf16 v[72:87], v[12:15], a[72:75], v[72:87]
    v_permlane32_swap_b32 v109, v111
    v_mfma_f32_32x32x16_bf16 v[88:103], v[12:15], a[76:79], v[88:103]
    buffer_store_dwordx4 v[108:111], v3, s[8:11], s17 offen offset:256 sc1
    ds_read_b128 v[8:11], v2 offset:16384
    s_waitcnt lgkmcnt(6)
    v_mfma_f32_32x32x16_bf16 v[72:87], v[16:19], a[80:83], v[72:87]
    v_cvt_pk_bf16_f32 v112, v56, v57
    v_mfma_f32_32x32x16_bf16 v[88:103], v[16:19], a[84:87], v[88:103]
    v_cvt_pk_bf16_f32 v113, v58, v59
    ds_read_b128 v[12:15], v2 offset:17408
    s_waitcnt lgkmcnt(6)
    v_mfma_f32_32x32x16_bf16 v[72:87], v[20:23], a[88:91], v[72:87]
    v_cvt_pk_bf16_f32 v114, v60, v61
    v_mfma_f32_32x32x16_bf16 v[88:103], v[20:23], a[92:95], v[88:103]
    v_cvt_pk_bf16_f32 v115, v62, v63
    ds_read_b128 v[16:19], v2 offset:18432
    s_waitcnt lgkmcnt(6)
    v_mfma_f32_32x32x16_bf16 v[72:87], v[24:27], a[96:99], v[72:87]
    s_nop 1
    v_mfma_f32_32x32x16_bf16 v[88:103], v[24:27], a[100:103], v[88:103]
    v_permlane32_swap_b32 v112, v114
    ds_read_b128 v[20:23], v2 offset:19456
    s_waitcnt lgkmcnt(6)
    v_mfma_f32_32x32x16_bf16 v[72:87], v[28:31], a[104:107], v[72:87]
    v_permlane32_swap_b32 v113, v115
    v_mfma_f32_32x32x16_bf16 v[88:103], v[28:31], a[108:111], v[88:103]
    buffer_store_dwordx4 v[112:115], v3, s[8:11], s17 offen offset:2560 sc1
    ds_read_b128 v[24:27], v2 offset:20480
    s_waitcnt lgkmcnt(6)
    v_mfma_f32_32x32x16_bf16 v[72:87], v[32:35], a[112:115], v[72:87]
    v_cvt_pk_bf16_f32 v116, v64, v65
    v_mfma_f32_32x32x16_bf16 v[88:103], v[32:35], a[116:119], v[88:103]
    v_cvt_pk_bf16_f32 v117, v66, v67
    ds_read_b128 v[28:31], v2 offset:21504
    s_waitcnt lgkmcnt(6)
    v_mfma_f32_32x32x16_bf16 v[72:87], v[36:39], a[120:123], v[72:87]
    v_cvt_pk_bf16_f32 v118, v68, v69
    v_mfma_f32_32x32x16_bf16 v[88:103], v[36:39], a[124:127], v[88:103]
    v_cvt_pk_bf16_f32 v119, v70, v71
    ds_read_b128 v[32:35], v2 offset:22528
    s_waitcnt lgkmcnt(6)
    v_mfma_f32_32x32x16_bf16 v[72:87], v[8:11], a[128:131], v[72:87]
    s_nop 1
    v_mfma_f32_32x32x16_bf16 v[88:103], v[8:11], a[132:135], v[88:103]
    v_permlane32_swap_b32 v116, v118
    ds_read_b128 v[36:39], v2 offset:23552
    s_waitcnt lgkmcnt(6)
    v_mfma_f32_32x32x16_bf16 v[72:87], v[12:15], a[136:139], v[72:87]
    v_permlane32_swap_b32 v117, v119
    v_mfma_f32_32x32x16_bf16 v[88:103], v[12:15], a[140:143], v[88:103]
    buffer_store_dwordx4 v[116:119], v3, s[8:11], s17 offen offset:2816 sc1
    ds_read_b128 v[8:11], v2 offset:24576
    s_waitcnt lgkmcnt(6)
    v_mfma_f32_32x32x16_bf16 v[72:87], v[16:19], a[144:147], v[72:87]
    s_add_u32 s17, s17, s20
    v_mfma_f32_32x32x16_bf16 v[88:103], v[16:19], a[148:151], v[88:103]
    s_add_u32 s18, s18, s20
    ds_read_b128 v[12:15], v2 offset:25600
    s_waitcnt lgkmcnt(6)
    v_mfma_f32_32x32x16_bf16 v[72:87], v[20:23], a[152:155], v[72:87]
    v_mfma_f32_32x32x16_bf16 v[88:103], v[20:23], a[156:159], v[88:103]
    ds_read_b128 v[16:19], v2 offset:26624
    s_waitcnt lgkmcnt(6)
    v_mfma_f32_32x32x16_bf16 v[72:87], v[24:27], a[160:163], v[72:87]
    v_mfma_f32_32x32x16_bf16 v[88:103], v[24:27], a[164:167], v[88:103]
    ds_read_b128 v[20:23], v2 offset:27648
    s_waitcnt lgkmcnt(6)
    v_mfma_f32_32x32x16_bf16 v[72:87], v[28:31], a[168:171], v[72:87]
    v_mfma_f32_32x32x16_bf16 v[88:103], v[28:31], a[172:175], v[88:103]
    ds_read_b128 v[24:27], v2 offset:28672
    s_waitcnt lgkmcnt(6)
    v_mfma_f32_32x32x16_bf16 v[72:87], v[32:35], a[176:179], v[72:87]
    v_mfma_f32_32x32x16_bf16 v[88:103], v[32:35], a[180:183], v[88:103]
    ds_read_b128 v[28:31], v2 offset:29696
    s_waitcnt lgkmcnt(6)
    v_mfma_f32_32x32x16_bf16 v[72:87], v[36:39], a[184:187], v[72:87]
    v_mfma_f32_32x32x16_bf16 v[88:103], v[36:39], a[188:191], v[88:103]
    ds_read_b128 v[32:35], v2 offset:30720
    s_waitcnt lgkmcnt(6)
    v_mfma_f32_32x32x16_bf16 v[72:87], v[8:11], a[192:195], v[72:87]
    v_mfma_f32_32x32x16_bf16 v[88:103], v[8:11], a[196:199], v[88:103]
    ds_read_b128 v[36:39], v2 offset:31744
    s_waitcnt lgkmcnt(6)
    v_mfma_f32_32x32x16_bf16 v[72:87], v[12:15], a[200:203], v[72:87]
    v_mfma_f32_32x32x16_bf16 v[88:103], v[12:15], a[204:207], v[88:103]
    ds_read_b128 v[8:11], v2 offset:32768
    s_waitcnt lgkmcnt(6)
    v_mfma_f32_32x32x16_bf16 v[72:87], v[16:19], a[208:211], v[72:87]
    v_mfma_f32_32x32x16_bf16 v[88:103], v[16:19], a[212:215], v[88:103]
    ds_read_b128 v[12:15], v2 offset:33792
    s_waitcnt lgkmcnt(6)
    v_mfma_f32_32x32x16_bf16 v[72:87], v[20:23], a[216:219], v[72:87]
    v_mfma_f32_32x32x16_bf16 v[88:103], v[20:23], a[220:223], v[88:103]
    ds_read_b128 v[16:19], v2 offset:34816
    s_waitcnt lgkmcnt(6)
    v_mfma_f32_32x32x16_bf16 v[72:87], v[24:27], a[224:227], v[72:87]
    v_mfma_f32_32x32x16_bf16 v[88:103], v[24:27], a[228:231], v[88:103]
    s_add_u32 s23, s14, 2
    s_cmp_gt_u32 s14, 12
    s_cbranch_scc1 layerb1_kernel_gu_fa12
    s_waitcnt vmcnt(0)
    s_barrier
    s_cmp_lg_u32 s13, 0
    s_cbranch_scc1 layerb1_kernel_gu_fl13
    s_mov_b64 exec, 1
    s_lshl_b32 s26, s12, 7
    v_mov_b32 v7, s26
    v_mov_b32 v120, s14
    buffer_store_dword v120, v7, s[8:11], s48 offen sc1
    s_mov_b64 exec, -1
layerb1_kernel_gu_fl13:
    s_cmp_lg_u32 s13, 0
    s_cbranch_scc1 layerb1_kernel_gu_lw14
    s_min_u32 s28, s23, 63
    s_cmp_gt_u32 s56, s28
    s_cbranch_scc1 layerb1_kernel_gu_lw14
layerb1_kernel_gu_lp14:
    buffer_load_dwordx4 v[124:127], v1, s[8:11], s57 offen sc1
    s_waitcnt vmcnt(0)
    v_min_u32 v124, v124, v125
    v_min_u32 v126, v126, v127
    v_min_u32 v124, v124, v126
    v_cmp_eq_u32 vcc, 0, v124
    s_nop 1
    s_ff1_i32_b64 s56, vcc
    s_min_u32 s56, s56, 64
    s_sub_u32 s58, s58, 1
    s_cbranch_scc1 layerb1_kernel_bail
    s_cmp_gt_u32 s56, s28
    s_cbranch_scc0 layerb1_kernel_gu_lp14
layerb1_kernel_gu_lw14:
    s_barrier
    s_branch layerb1_kernel_gu_fb12
layerb1_kernel_gu_fa12:
    s_cmp_lg_u32 s13, 0
    s_cbranch_scc1 layerb1_kernel_gu_lw15
    s_min_u32 s28, s23, 63
    s_cmp_gt_u32 s56, s28
    s_cbranch_scc1 layerb1_kernel_gu_lw15
layerb1_kernel_gu_lp15:
    buffer_load_dwordx4 v[124:127], v1, s[8:11], s57 offen sc1
    s_waitcnt vmcnt(0)
    v_min_u32 v124, v124, v125
    v_min_u32 v126, v126, v127
    v_min_u32 v124, v124, v126
    v_cmp_eq_u32 vcc, 0, v124
    s_nop 1
    s_ff1_i32_b64 s56, vcc
    s_min_u32 s56, s56, 64
    s_sub_u32 s58, s58, 1
    s_cbranch_scc1 layerb1_kernel_bail
    s_cmp_gt_u32 s56, s28
    s_cbranch_scc0 layerb1_kernel_gu_lp15
layerb1_kernel_gu_lw15:
    s_waitcnt vmcnt(4)
    s_sub_u32 s27, s14, 1
    s_barrier
    s_cmp_lg_u32 s13, 0
    s_cbranch_scc1 layerb1_kernel_gu_fl16
    s_mov_b64 exec, 1
    s_lshl_b32 s26, s12, 7
    v_mov_b32 v7, s26
    v_mov_b32 v120, s27
    buffer_store_dword v120, v7, s[8:11], s48 offen sc1
    s_mov_b64 exec, -1
layerb1_kernel_gu_fl16:
layerb1_kernel_gu_fb12:
    s_add_u32 s21, s16, 40960
    s_cmp_eq_u32 s21, 122880
    s_cselect_b32 s21, 0, s21
    s_add_u32 s23, s14, 2
    s_min_u32 s24, s23, 63
    s_mul_i32 s24, s24, 40960
    s_add_u32 s24, s24, s19
    s_mul_i32 s25, s13, 10240
    s_add_u32 s25, s25, s22
    s_add_u32 s22, s22, 40960
    s_cmp_eq_u32 s22, 122880
    s_cselect_b32 s22, 0, s22
    ds_read_b128 v[20:23], v2 offset:35840
    s_waitcnt lgkmcnt(6)
    v_mfma_f32_32x32x16_bf16 v[72:87], v[28:31], a[232:235], v[72:87]
    s_mov_b32 m0, s25
    s_nop 0
    buffer_load_dwordx4 v1, s[8:11], s24 offen offset:0 sc1 lds
    v_mfma_f32_32x32x16_bf16 v[88:103], v[28:31], a[236:239], v[88:103]
    ds_read_b128 v[24:27], v2 offset:36864
    s_waitcnt lgkmcnt(6)
    v_mfma_f32_32x32x16_bf16 v[72:87], v[32:35], a[240:243], v[72:87]
    buffer_load_dwordx4 v1, s[8:11], s24 offen offset:1024 sc1 lds
    v_mfma_f32_32x32x16_bf16 v[88:103], v[32:35], a[244:247], v[88:103]
    ds_read_b128 v[28:31], v2 offset:37888
    s_waitcnt lgkmcnt(6)
    v_mfma_f32_32x32x16_bf16 v[72:87], v[36:39], a[248:251], v[72:87]
    buffer_load_dwordx4 v1, s[8:11], s24 offen offset:2048 sc1 lds
    v_mfma_f32_32x32x16_bf16 v[88:103], v[36:39], a[252:255], v[88:103]
    ds_read_b128 v[32:35], v2 offset:38912
    s_waitcnt lgkmcnt(6)
    v_mfma_f32_32x32x16_bf16 v[72:87], v[8:11], v[192:195], v[72:87]
    buffer_load_dwordx4 v1, s[8:11], s24 offen offset:3072 sc1 lds
    v_mfma_f32_32x32x16_bf16 v[88:103], v[8:11], v[196:199], v[88:103]
    ds_read_b128 v[36:39], v2 offset:39936
    s_waitcnt lgkmcnt(6)
    v_mfma_f32_32x32x16_bf16 v[72:87], v[12:15], v[200:203], v[72:87]
    s_add_u32 s24, s24, 4096
    s_add_u32 s25, s25, 4096
    s_mov_b32 m0, s25
    s_nop 0
    buffer_load_dwordx4 v1, s[8:11], s24 offen offset:0 sc1 lds
    v_mfma_f32_32x32x16_bf16 v[88:103], v[12:15], v[204:207], v[88:103]
    v_add_u32 v6, s21, v1
    ds_read_b128 v[8:11], v6 offset:0
    s_waitcnt lgkmcnt(6)
    v_mfma_f32_32x32x16_bf16 v[72:87], v[16:19], v[208:211], v[72:87]
    buffer_load_dwordx4 v1, s[8:11], s24 offen offset:1024 sc1 lds
    v_mfma_f32_32x32x16_bf16 v[88:103], v[16:19], v[212:215], v[88:103]
    ds_read_b128 v[12:15], v6 offset:1024
    s_waitcnt lgkmcnt(6)
    v_mfma_f32_32x32x16_bf16 v[72:87], v[20:23], v[216:219], v[72:87]
    buffer_load_dwordx4 v1, s[8:11], s24 offen offset:2048 sc1 lds
    v_mfma_f32_32x32x16_bf16 v[88:103], v[20:23], v[220:223], v[88:103]
    ds_read_b128 v[16:19], v6 offset:2048
    s_waitcnt lgkmcnt(6)
    v_mfma_f32_32x32x16_bf16 v[72:87], v[24:27], v[224:227], v[72:87]
    buffer_load_dwordx4 v1, s[8:11], s24 offen offset:3072 sc1 lds
    v_mfma_f32_32x32x16_bf16 v[88:103], v[24:27], v[228:231], v[88:103]
    ds_read_b128 v[20:23], v6 offset:3072
    s_waitcnt lgkmcnt(6)
    v_mfma_f32_32x32x16_bf16 v[72:87], v[28:31], v[232:235], v[72:87]
    s_add_u32 s24, s24, 4096
    s_add_u32 s25, s25, 4096
    s_mov_b32 m0, s25
    s_nop 0
    buffer_load_dwordx4 v1, s[8:11], s24 offen offset:0 sc1 lds
    v_mfma_f32_32x32x16_bf16 v[88:103], v[28:31], v[236:239], v[88:103]
    ds_read_b128 v[24:27], v6 offset:4096
    s_waitcnt lgkmcnt(6)
    v_mfma_f32_32x32x16_bf16 v[72:87], v[32:35], v[240:243], v[72:87]
    buffer_load_dwordx4 v1, s[8:11], s24 offen offset:1024 sc1 lds
    v_mfma_f32_32x32x16_bf16 v[88:103], v[32:35], v[244:247], v[88:103]
    ds_read_b128 v[28:31], v6 offset:5120
    s_waitcnt lgkmcnt(6)
    v_mfma_f32_32x32x16_bf16 v[72:87], v[36:39], v[248:251], v[72:87]
    v_mfma_f32_32x32x16_bf16 v[88:103], v[36:39], v[252:255], v[88:103]
    v_mov_b32 v2, v6
    s_mov_b32 s16, s21
    s_add_u32 s14, s14, 1
    s_cmp_lt_u32 s14, s15
    s_cbranch_scc1 layerb1_kernel_gu_loop
    s_branch layerb1_kernel_gu_fin1
layerb1_kernel_gu_fin0:
    s_nop 7
    s_nop 7
    v_cvt_pk_bf16_f32 v104, v40, v41
    v_cvt_pk_bf16_f32 v105, v42, v43
    v_cvt_pk_bf16_f32 v106, v44, v45
    v_cvt_pk_bf16_f32 v107, v46, v47
    s_nop 1
    v_permlane32_swap_b32 v104, v106
    v_permlane32_swap_b32 v105, v107
    buffer_store_dwordx4 v[104:107], v3, s[8:11], s17 offen offset:0 sc1
    v_cvt_pk_bf16_f32 v108, v48, v49
    v_cvt_pk_bf16_f32 v109, v50, v51
    v_cvt_pk_bf16_f32 v110, v52, v53
    v_cvt_pk_bf16_f32 v111, v54, v55
    s_nop 1
    v_permlane32_swap_b32 v108, v110
    v_permlane32_swap_b32 v109, v111
    buffer_store_dwordx4 v[108:111], v3, s[8:11], s17 offen offset:256 sc1
    v_cvt_pk_bf16_f32 v112, v56, v57
    v_cvt_pk_bf16_f32 v113, v58, v59
    v_cvt_pk_bf16_f32 v114, v60, v61
    v_cvt_pk_bf16_f32 v115, v62, v63
    s_nop 1
    v_permlane32_swap_b32 v112, v114
    v_permlane32_swap_b32 v113, v115
    buffer_store_dwordx4 v[112:115], v3, s[8:11], s17 offen offset:2560 sc1
    v_cvt_pk_bf16_f32 v116, v64, v65
    v_cvt_pk_bf16_f32 v117, v66, v67
    v_cvt_pk_bf16_f32 v118, v68, v69
    v_cvt_pk_bf16_f32 v119, v70, v71
    s_nop 1
    v_permlane32_swap_b32 v116, v118
    v_permlane32_swap_b32 v117, v119
    buffer_store_dwordx4 v[116:119], v3, s[8:11], s17 offen offset:2816 sc1
    s_add_u32 s17, s17, s20
    s_add_u32 s18, s18, s20
    s_branch layerb1_kernel_gu_done
layerb1_kernel_gu_fin1:
    s_nop 7
    s_nop 7
    v_cvt_pk_bf16_f32 v104, v72, v73
    v_cvt_pk_bf16_f32 v105, v74, v75
    v_cvt_pk_bf16_f32 v106, v76, v77
    v_cvt_pk_bf16_f32 v107, v78, v79
    s_nop 1
    v_permlane32_swap_b32 v104, v106
    v_permlane32_swap_b32 v105, v107
    buffer_store_dwordx4 v[104:107], v3, s[8:11], s17 offen offset:0 sc1
    v_cvt_pk_bf16_f32 v108, v80, v81
    v_cvt_pk_bf16_f32 v109, v82, v83
    v_cvt_pk_bf16_f32 v110, v84, v85
    v_cvt_pk_bf16_f32 v111, v86, v87
    s_nop 1
    v_permlane32_swap_b32 v108, v110
    v_permlane32_swap_b32 v109, v111
    buffer_store_dwordx4 v[108:111], v3, s[8:11], s17 offen offset:256 sc1
    v_cvt_pk_bf16_f32 v112, v88, v89
    v_cvt_pk_bf16_f32 v113, v90, v91
    v_cvt_pk_bf16_f32 v114, v92, v93
    v_cvt_pk_bf16_f32 v115, v94, v95
    s_nop 1
    v_permlane32_swap_b32 v112, v114
    v_permlane32_swap_b32 v113, v115
    buffer_store_dwordx4 v[112:115], v3, s[8:11], s17 offen offset:2560 sc1
    v_cvt_pk_bf16_f32 v116, v96, v97
    v_cvt_pk_bf16_f32 v117, v98, v99
    v_cvt_pk_bf16_f32 v118, v100, v101
    v_cvt_pk_bf16_f32 v119, v102, v103
    s_nop 1
    v_permlane32_swap_b32 v116, v118
    v_permlane32_swap_b32 v117, v119
    buffer_store_dwordx4 v[116:119], v3, s[8:11], s17 offen offset:2816 sc1
    s_add_u32 s17, s17, s20
    s_add_u32 s18, s18, s20
layerb1_kernel_gu_done:
    s_waitcnt vmcnt(0) lgkmcnt(0)
    s_barrier
    s_cmp_lg_u32 s13, 0
    s_cbranch_scc1 layerb1_kernel_gu_fl17
    s_mov_b64 exec, 1
    s_lshl_b32 s26, s12, 7
    v_mov_b32 v7, s26
    v_mov_b32 v120, s14
    buffer_store_dword v120, v7, s[8:11], s48 offen sc1
    s_mov_b64 exec, -1
layerb1_kernel_gu_fl17:
    s_branch layerb1_kernel_g_done
layerb1_kernel_g_qk:
    s_sub_u32 s26, s12, 80
    s_cmp_ge_u32 s26, 24
    s_cselect_b32 s27, 1, 0
    s_cselect_b32 s28, 24, 0
    s_sub_u32 s26, s26, s28
    s_lshl_b32 s26, s26, 3
    s_lshl_b32 s28, s13, 1
    s_add_u32 s26, s26, s28
    s_add_u32 s28, s26, 0
    s_mul_i32 s29, s28, 171
    s_lshr_b32 s29, s29, 10
    s_mul_i32 s30, s29, 6
    s_sub_u32 s30, s28, s30
    s_mul_i32 s31, s29, 12288
    s_lshl_b32 s32, s30, 11
    s_add_u32 s31, s31, s32
    s_mul_i32 s32, s14, 393216
    s_add_u32 s31, s31, s32
    s_mul_i32 s32, s27, 25165824
    s_add_u32 s31, s31, s32
    s_add_u32 s17, s31, 53477376
    s_lshl_b32 s30, s30, 5
    v_add_u32 v10, s30, v8
    v_and_b32 v11, 0xc1, v10
    v_and_b32 v12, 8, v10
    v_lshl_or_b32 v11, v12, 2, v11
    v_and_b32 v12, 32, v10
    v_lshrrev_b32 v12, 1, v12
    v_or_b32 v11, v11, v12
    v_and_b32 v12, 2, v10
    v_lshl_or_b32 v11, v12, 2, v11
    v_and_b32 v12, 16, v10
    v_lshrrev_b32 v12, 2, v12
    v_or_b32 v11, v11, v12
    v_and_b32 v12, 4, v10
    v_lshrrev_b32 v12, 1, v12
    v_or_b32 v11, v11, v12
    s_cmp_eq_u32 s27, 1
    s_cselect_b64 vcc, -1, 0
    s_nop 1
    v_cndmask_b32 v10, v10, v11, vcc
    v_lshrrev_b32 v12, 4, v10
    v_and_b32 v13, 3, v12
    v_mul_u32_u24 v13, 6, v13
    v_lshrrev_b32 v12, 2, v12
    v_add_u32 v12, v12, v13
    v_mul_u32_u24 v12, 20480, v12
    v_and_b32 v13, 15, v10
    v_lshl_add_u32 v11, v13, 4, v12
    v_lshl_add_u32 v4, v9, 8, v11
    s_xor_b32 s30, s27, 1
    s_mul_i32 s30, s30, 61440
    s_mul_i32 s31, s29, 491520
    s_add_u32 s30, s30, s31
    s_add_u32 s34, s30, 11534336
    s_add_u32 s28, s26, 1
    s_mul_i32 s29, s28, 171
    s_lshr_b32 s29, s29, 10
    s_mul_i32 s30, s29, 6
    s_sub_u32 s30, s28, s30
    s_mul_i32 s31, s29, 12288
    s_lshl_b32 s32, s30, 11
    s_add_u32 s31, s31, s32
    s_mul_i32 s32, s14, 393216
    s_add_u32 s31, s31, s32
    s_mul_i32 s32, s27, 25165824
    s_add_u32 s31, s31, s32
    s_add_u32 s18, s31, 53477376
    s_lshl_b32 s30, s30, 5
    v_add_u32 v10, s30, v8
    v_and_b32 v11, 0xc1, v10
    v_and_b32 v12, 8, v10
    v_lshl_or_b32 v11, v12, 2, v11
    v_and_b32 v12, 32, v10
    v_lshrrev_b32 v12, 1, v12
    v_or_b32 v11, v11, v12
    v_and_b32 v12, 2, v10
    v_lshl_or_b32 v11, v12, 2, v11
    v_and_b32 v12, 16, v10
    v_lshrrev_b32 v12, 2, v12
    v_or_b32 v11, v11, v12
    v_and_b32 v12, 4, v10
    v_lshrrev_b32 v12, 1, v12
    v_or_b32 v11, v11, v12
    s_cmp_eq_u32 s27, 1
    s_cselect_b64 vcc, -1, 0
    s_nop 1
    v_cndmask_b32 v10, v10, v11, vcc
    v_lshrrev_b32 v12, 4, v10
    v_and_b32 v13, 3, v12
    v_mul_u32_u24 v13, 6, v13
    v_lshrrev_b32 v12, 2, v12
    v_add_u32 v12, v12, v13
    v_mul_u32_u24 v12, 20480, v12
    v_and_b32 v13, 15, v10
    v_lshl_add_u32 v11, v13, 4, v12
    v_lshl_add_u32 v5, v9, 8, v11
    s_xor_b32 s30, s27, 1
    s_mul_i32 s30, s30, 61440
    s_mul_i32 s31, s29, 491520
    s_add_u32 s30, s30, s31
    s_add_u32 s35, s30, 11534336
    s_add_u32 s34, s34, 4096
    s_add_u32 s35, s35, 4096
    s_add_u32 s34, s34, 4096
    s_add_u32 s35, s35, 4096
    s_add_u32 s34, s34, 4096
    s_add_u32 s35, s35, 4096
    s_add_u32 s34, s34, 4096
    s_add_u32 s35, s35, 4096
    buffer_load_dwordx4 v[192:195], v4, s[8:11], s34 offen offset:0
    buffer_load_dwordx4 v[196:199], v5, s[8:11], s35 offen offset:0
    buffer_load_dwordx4 v[200:203], v4, s[8:11], s34 offen offset:512
    buffer_load_dwordx4 v[204:207], v5, s[8:11], s35 offen offset:512
    buffer_load_dwordx4 v[208:211], v4, s[8:11], s34 offen offset:1024
    buffer_load_dwordx4 v[212:215], v5, s[8:11], s35 offen offset:1024
    buffer_load_dwordx4 v[216:219], v4, s[8:11], s34 offen offset:1536
    buffer_load_dwordx4 v[220:223], v5, s[8:11], s35 offen offset:1536
    buffer_load_dwordx4 v[224:227], v4, s[8:11], s34 offen offset:2048
    buffer_load_dwordx4 v[228:231], v5, s[8:11], s35 offen offset:2048
    buffer_load_dwordx4 v[232:235], v4, s[8:11], s34 offen offset:2560
    buffer_load_dwordx4 v[236:239], v5, s[8:11], s35 offen offset:2560
    buffer_load_dwordx4 v[240:243], v4, s[8:11], s34 offen offset:3072
    buffer_load_dwordx4 v[244:247], v5, s[8:11], s35 offen offset:3072
    buffer_load_dwordx4 v[248:251], v4, s[8:11], s34 offen offset:3584
    buffer_load_dwordx4 v[252:255], v5, s[8:11], s35 offen offset:3584
    v_mov_b32 v3, v1
    s_mov_b32 s20, 393216
    s_mul_i32 s19, s13, 10240
    s_add_u32 s19, s19, 220200960
    s_mov_b32 s22, 0
    s_mov_b32 s56, 0
    s_mov_b32 s58, 400000
    s_add_u32 s57, s48, 45056
    s_cmp_lg_u32 s13, 0
    s_cbranch_scc1 layerb1_kernel_gk_lw1
    s_min_u32 s28, s14, 63
    s_cmp_gt_u32 s56, s28
    s_cbranch_scc1 layerb1_kernel_gk_lw1
layerb1_kernel_gk_lp1:
    buffer_load_dwordx4 v[124:127], v1, s[8:11], s57 offen sc1
    s_waitcnt vmcnt(0)
    v_min_u32 v124, v124, v125
    v_min_u32 v126, v126, v127
    v_min_u32 v124, v124, v126
    v_cmp_eq_u32 vcc, 0, v124
    s_nop 1
    s_ff1_i32_b64 s56, vcc
    s_min_u32 s56, s56, 64
    s_sub_u32 s58, s58, 1
    s_cbranch_scc1 layerb1_kernel_bail
    s_cmp_gt_u32 s56, s28
    s_cbranch_scc0 layerb1_kernel_gk_lp1
layerb1_kernel_gk_lw1:
    s_barrier
    s_min_u32 s24, s14, 63
    s_mul_i32 s24, s24, 40960
    s_add_u32 s24, s24, s19
    s_mul_i32 s25, s13, 10240
    s_add_u32 s25, s25, s22
    s_mov_b32 m0, s25
    s_nop 0
    buffer_load_dwordx4 v1, s[8:11], s24 offen offset:0 sc1 lds
    buffer_load_dwordx4 v1, s[8:11], s24 offen offset:1024 sc1 lds
    buffer_load_dwordx4 v1, s[8:11], s24 offen offset:2048 sc1 lds
    buffer_load_dwordx4 v1, s[8:11], s24 offen offset:3072 sc1 lds
    s_add_u32 s24, s24, 4096
    s_add_u32 s25, s25, 4096
    s_mov_b32 m0, s25
    s_nop 0
    buffer_load_dwordx4 v1, s[8:11], s24 offen offset:0 sc1 lds
    buffer_load_dwordx4 v1, s[8:11], s24 offen offset:1024 sc1 lds
    buffer_load_dwordx4 v1, s[8:11], s24 offen offset:2048 sc1 lds
    buffer_load_dwordx4 v1, s[8:11], s24 offen offset:3072 sc1 lds
    s_add_u32 s24, s24, 4096
    s_add_u32 s25, s25, 4096
    s_mov_b32 m0, s25
    s_nop 0
    buffer_load_dwordx4 v1, s[8:11], s24 offen offset:0 sc1 lds
    buffer_load_dwordx4 v1, s[8:11], s24 offen offset:1024 sc1 lds
    s_mov_b32 s22, 40960
    s_mov_b32 s16, 0
    s_waitcnt vmcnt(0)
    s_barrier
    v_mov_b32 v2, v1
    ds_read_b128 v[8:11], v2 offset:0
    ds_read_b128 v[12:15], v2 offset:1024
    ds_read_b128 v[16:19], v2 offset:2048
    ds_read_b128 v[20:23], v2 offset:3072
    ds_read_b128 v[24:27], v2 offset:4096
    ds_read_b128 v[28:31], v2 offset:5120
    s_mov_b32 s55, 0
    v_mov_b32 v121, 122880
    ds_read_b128 v[32:35], v2 offset:6144
    s_waitcnt lgkmcnt(6)
    v_mfma_f32_32x32x16_bf16 v[40:55], a[0:3], v[8:11], 0
    v_mfma_f32_32x32x16_bf16 v[56:71], a[4:7], v[8:11], 0
    ds_read_b128 v[36:39], v2 offset:7168
    s_waitcnt lgkmcnt(6)
    v_mfma_f32_32x32x16_bf16 v[40:55], a[8:11], v[12:15], v[40:55]
    v_mfma_f32_32x32x16_bf16 v[56:71], a[12:15], v[12:15], v[56:71]
    ds_read_b128 v[8:11], v2 offset:8192
    s_waitcnt lgkmcnt(6)
    v_mfma_f32_32x32x16_bf16 v[40:55], a[16:19], v[16:19], v[40:55]
    v_mfma_f32_32x32x16_bf16 v[56:71], a[20:23], v[16:19], v[56:71]
    ds_read_b128 v[12:15], v2 offset:9216
    s_waitcnt lgkmcnt(6)
    v_mfma_f32_32x32x16_bf16 v[40:55], a[24:27], v[20:23], v[40:55]
    v_mfma_f32_32x32x16_bf16 v[56:71], a[28:31], v[20:23], v[56:71]
    ds_read_b128 v[16:19], v2 offset:10240
    s_waitcnt lgkmcnt(6)
    v_mfma_f32_32x32x16_bf16 v[40:55], a[32:35], v[24:27], v[40:55]
    v_mfma_f32_32x32x16_bf16 v[56:71], a[36:39], v[24:27], v[56:71]
    ds_read_b128 v[20:23], v2 offset:11264
    s_waitcnt lgkmcnt(6)
    v_mfma_f32_32x32x16_bf16 v[40:55], a[40:43], v[28:31], v[40:55]
    v_mfma_f32_32x32x16_bf16 v[56:71], a[44:47], v[28:31], v[56:71]
    ds_read_b128 v[24:27], v2 offset:12288
    s_waitcnt lgkmcnt(6)
    v_mfma_f32_32x32x16_bf16 v[40:55], a[48:51], v[32:35], v[40:55]
    v_mfma_f32_32x32x16_bf16 v[56:71], a[52:55], v[32:35], v[56:71]
    ds_read_b128 v[28:31], v2 offset:13312
    s_waitcnt lgkmcnt(6)
    v_mfma_f32_32x32x16_bf16 v[40:55], a[56:59], v[36:39], v[40:55]
    v_mfma_f32_32x32x16_bf16 v[56:71], a[60:63], v[36:39], v[56:71]
    ds_read_b128 v[32:35], v2 offset:14336
    s_waitcnt lgkmcnt(6)
    v_mfma_f32_32x32x16_bf16 v[40:55], a[64:67], v[8:11], v[40:55]
    v_mfma_f32_32x32x16_bf16 v[56:71], a[68:71], v[8:11], v[56:71]
    ds_read_b128 v[36:39], v2 offset:15360
    s_waitcnt lgkmcnt(6)
    v_mfma_f32_32x32x16_bf16 v[40:55], a[72:75], v[12:15], v[40:55]
    v_mfma_f32_32x32x16_bf16 v[56:71], a[76:79], v[12:15], v[56:71]
    ds_read_b128 v[8:11], v2 offset:16384
    s_waitcnt lgkmcnt(6)
    v_mfma_f32_32x32x16_bf16 v[40:55], a[80:83], v[16:19], v[40:55]
    v_mfma_f32_32x32x16_bf16 v[56:71], a[84:87], v[16:19], v[56:71]
    ds_read_b128 v[12:15], v2 offset:17408
    s_waitcnt lgkmcnt(6)
    v_mfma_f32_32x32x16_bf16 v[40:55], a[88:91], v[20:23], v[40:55]
    v_mfma_f32_32x32x16_bf16 v[56:71], a[92:95], v[20:23], v[56:71]
    ds_read_b128 v[16:19], v2 offset:18432
    s_waitcnt lgkmcnt(6)
    v_mfma_f32_32x32x16_bf16 v[40:55], a[96:99], v[24:27], v[40:55]
    v_mfma_f32_32x32x16_bf16 v[56:71], a[100:103], v[24:27], v[56:71]
    ds_read_b128 v[20:23], v2 offset:19456
    s_waitcnt lgkmcnt(6)
    v_mfma_f32_32x32x16_bf16 v[40:55], a[104:107], v[28:31], v[40:55]
    v_mfma_f32_32x32x16_bf16 v[56:71], a[108:111], v[28:31], v[56:71]
    ds_read_b128 v[24:27], v2 offset:20480
    s_waitcnt lgkmcnt(6)
    v_mfma_f32_32x32x16_bf16 v[40:55], a[112:115], v[32:35], v[40:55]
    v_mfma_f32_32x32x16_bf16 v[56:71], a[116:119], v[32:35], v[56:71]
    ds_read_b128 v[28:31], v2 offset:21504
    s_waitcnt lgkmcnt(6)
    v_mfma_f32_32x32x16_bf16 v[40:55], a[120:123], v[36:39], v[40:55]
    v_mfma_f32_32x32x16_bf16 v[56:71], a[124:127], v[36:39], v[56:71]
    ds_read_b128 v[32:35], v2 offset:22528
    s_waitcnt lgkmcnt(6)
    v_mfma_f32_32x32x16_bf16 v[40:55], a[128:131], v[8:11], v[40:55]
    v_mfma_f32_32x32x16_bf16 v[56:71], a[132:135], v[8:11], v[56:71]
    ds_read_b128 v[36:39], v2 offset:23552
    s_waitcnt lgkmcnt(6)
    v_mfma_f32_32x32x16_bf16 v[40:55], a[136:139], v[12:15], v[40:55]
    v_mfma_f32_32x32x16_bf16 v[56:71], a[140:143], v[12:15], v[56:71]
    ds_read_b128 v[8:11], v2 offset:24576
    s_waitcnt lgkmcnt(6)
    v_mfma_f32_32x32x16_bf16 v[40:55], a[144:147], v[16:19], v[40:55]
    v_mfma_f32_32x32x16_bf16 v[56:71], a[148:151], v[16:19], v[56:71]
    ds_read_b128 v[12:15], v2 offset:25600
    s_waitcnt lgkmcnt(6)
    v_mfma_f32_32x32x16_bf16 v[40:55], a[152:155], v[20:23], v[40:55]
    v_mfma_f32_32x32x16_bf16 v[56:71], a[156:159], v[20:23], v[56:71]
    ds_read_b128 v[16:19], v2 offset:26624
    s_waitcnt lgkmcnt(6)
    v_mfma_f32_32x32x16_bf16 v[40:55], a[160:163], v[24:27], v[40:55]
    v_mfma_f32_32x32x16_bf16 v[56:71], a[164:167], v[24:27], v[56:71]
    ds_read_b128 v[20:23], v2 offset:27648
    s_waitcnt lgkmcnt(6)
    v_mfma_f32_32x32x16_bf16 v[40:55], a[168:171], v[28:31], v[40:55]
    v_mfma_f32_32x32x16_bf16 v[56:71], a[172:175], v[28:31], v[56:71]
    ds_read_b128 v[24:27], v2 offset:28672
    s_waitcnt lgkmcnt(6)
    v_mfma_f32_32x32x16_bf16 v[40:55], a[176:179], v[32:35], v[40:55]
    v_mfma_f32_32x32x16_bf16 v[56:71], a[180:183], v[32:35], v[56:71]
    ds_read_b128 v[28:31], v2 offset:29696
    s_waitcnt lgkmcnt(6)
    buffer_load_dwordx4 v[124:127], v1, s[8:11], s57 offen sc1
    v_mfma_f32_32x32x16_bf16 v[40:55], a[184:187], v[36:39], v[40:55]
    v_mfma_f32_32x32x16_bf16 v[56:71], a[188:191], v[36:39], v[56:71]
    ds_read_b128 v[32:35], v2 offset:30720
    s_waitcnt lgkmcnt(6)
    v_mfma_f32_32x32x16_bf16 v[40:55], a[192:195], v[8:11], v[40:55]
    v_mfma_f32_32x32x16_bf16 v[56:71], a[196:199], v[8:11], v[56:71]
    ds_read_b128 v[36:39], v2 offset:31744
    s_waitcnt lgkmcnt(6)
    v_mfma_f32_32x32x16_bf16 v[40:55], a[200:203], v[12:15], v[40:55]
    v_mfma_f32_32x32x16_bf16 v[56:71], a[204:207], v[12:15], v[56:71]
    ds_read_b128 v[8:11], v2 offset:32768
    s_waitcnt lgkmcnt(6)
    v_mfma_f32_32x32x16_bf16 v[40:55], a[208:211], v[16:19], v[40:55]
    v_mfma_f32_32x32x16_bf16 v[56:71], a[212:215], v[16:19], v[56:71]
    ds_read_b128 v[12:15], v2 offset:33792
    s_waitcnt lgkmcnt(6)
    v_mfma_f32_32x32x16_bf16 v[40:55], a[216:219], v[20:23], v[40:55]
    v_mfma_f32_32x32x16_bf16 v[56:71], a[220:223], v[20:23], v[56:71]
    ds_read_b128 v[16:19], v2 offset:34816
    s_waitcnt lgkmcnt(6)
    v_mfma_f32_32x32x16_bf16 v[40:55], a[224:227], v[24:27], v[40:55]
    v_mfma_f32_32x32x16_bf16 v[56:71], a[228:231], v[24:27], v[56:71]
    ds_read_b128 v[20:23], v2 offset:35840
    s_waitcnt lgkmcnt(6)
    v_mfma_f32_32x32x16_bf16 v[40:55], a[232:235], v[28:31], v[40:55]
    v_mfma_f32_32x32x16_bf16 v[56:71], a[236:239], v[28:31], v[56:71]
    ds_read_b128 v[24:27], v2 offset:36864
    s_waitcnt lgkmcnt(6)
    v_mfma_f32_32x32x16_bf16 v[40:55], a[240:243], v[32:35], v[40:55]
    v_mfma_f32_32x32x16_bf16 v[56:71], a[244:247], v[32:35], v[56:71]
    ds_read_b128 v[28:31], v2 offset:37888
    s_waitcnt lgkmcnt(6)
    v_mfma_f32_32x32x16_bf16 v[40:55], a[248:251], v[36:39], v[40:55]
    v_mfma_f32_32x32x16_bf16 v[56:71], a[252:255], v[36:39], v[56:71]
    ds_read_b128 v[32:35], v2 offset:38912
    s_waitcnt lgkmcnt(6)
    v_mfma_f32_32x32x16_bf16 v[40:55], v[192:195], v[8:11], v[40:55]
    v_mfma_f32_32x32x16_bf16 v[56:71], v[196:199], v[8:11], v[56:71]
    ds_read_b128 v[36:39], v2 offset:39936
    s_waitcnt lgkmcnt(6)
    v_mfma_f32_32x32x16_bf16 v[40:55], v[200:203], v[12:15], v[40:55]
    v_mfma_f32_32x32x16_bf16 v[56:71], v[204:207], v[12:15], v[56:71]
    s_waitcnt lgkmcnt(5)
    s_waitcnt vmcnt(0)
    v_min_u32 v124, v124, v125
    v_min_u32 v126, v126, v127
    v_min_u32 v124, v124, v126
    v_cmp_eq_u32 vcc, 0, v124
    s_add_u32 s23, s14, 1
    s_nop 0
    s_ff1_i32_b64 s56, vcc
    s_min_u32 s56, s56, 64
    s_cmp_gt_u32 s56, s23
    s_cselect_b32 s59, 1, 0
    s_min_u32 s24, s23, 63
    s_mul_i32 s24, s24, 40960
    s_add_u32 s24, s24, s19
    s_mul_i32 s25, s13, 10240
    s_add_u32 s25, s25, s22
    v_mfma_f32_32x32x16_bf16 v[40:55], v[208:211], v[16:19], v[40:55]
    v_mfma_f32_32x32x16_bf16 v[56:71], v[212:215], v[16:19], v[56:71]
    s_mov_b32 m0, s25
    s_nop 0
    buffer_load_dwordx4 v1, s[8:11], s24 offen offset:0 sc1 lds
    s_waitcnt lgkmcnt(4)
    v_mfma_f32_32x32x16_bf16 v[40:55], v[216:219], v[20:23], v[40:55]
    buffer_load_dwordx4 v1, s[8:11], s24 offen offset:1024 sc1 lds
    v_mfma_f32_32x32x16_bf16 v[56:71], v[220:223], v[20:23], v[56:71]
    buffer_load_dwordx4 v1, s[8:11], s24 offen offset:2048 sc1 lds
    s_waitcnt lgkmcnt(3)
    v_mfma_f32_32x32x16_bf16 v[40:55], v[224:227], v[24:27], v[40:55]
    buffer_load_dwordx4 v1, s[8:11], s24 offen offset:3072 sc1 lds
    v_mfma_f32_32x32x16_bf16 v[56:71], v[228:231], v[24:27], v[56:71]
    s_add_u32 s24, s24, 4096
    s_add_u32 s25, s25, 4096
    s_mov_b32 m0, s25
    s_nop 0
    buffer_load_dwordx4 v1, s[8:11], s24 offen offset:0 sc1 lds
    s_waitcnt lgkmcnt(2)
    v_mfma_f32_32x32x16_bf16 v[40:55], v[232:235], v[28:31], v[40:55]
    buffer_load_dwordx4 v1, s[8:11], s24 offen offset:1024 sc1 lds
    v_mfma_f32_32x32x16_bf16 v[56:71], v[236:239], v[28:31], v[56:71]
    buffer_load_dwordx4 v1, s[8:11], s24 offen offset:2048 sc1 lds
    s_waitcnt lgkmcnt(1)
    v_mfma_f32_32x32x16_bf16 v[40:55], v[240:243], v[32:35], v[40:55]
    buffer_load_dwordx4 v1, s[8:11], s24 offen offset:3072 sc1 lds
    v_mfma_f32_32x32x16_bf16 v[56:71], v[244:247], v[32:35], v[56:71]
    s_add_u32 s24, s24, 4096
    s_add_u32 s25, s25, 4096
    s_mov_b32 m0, s25
    s_nop 0
    buffer_load_dwordx4 v1, s[8:11], s24 offen offset:0 sc1 lds
    s_waitcnt lgkmcnt(0)
    v_mfma_f32_32x32x16_bf16 v[40:55], v[248:251], v[36:39], v[40:55]
    buffer_load_dwordx4 v1, s[8:11], s24 offen offset:1024 sc1 lds
    v_mfma_f32_32x32x16_bf16 v[56:71], v[252:255], v[36:39], v[56:71]
    s_add_u32 s14, s14, 1
    s_nop 7
    s_nop 7
    v_cvt_pk_bf16_f32 v104, v40, v41
    v_cvt_pk_bf16_f32 v105, v42, v43
    v_cvt_pk_bf16_f32 v106, v44, v45
    v_cvt_pk_bf16_f32 v107, v46, v47
    s_nop 1
    v_permlane32_swap_b32 v104, v106
    v_permlane32_swap_b32 v105, v107
    buffer_store_dwordx4 v[104:107], v3, s[8:11], s17 offen offset:0 sc1
    v_cvt_pk_bf16_f32 v108, v48, v49
    v_cvt_pk_bf16_f32 v109, v50, v51
    v_cvt_pk_bf16_f32 v110, v52, v53
    v_cvt_pk_bf16_f32 v111, v54, v55
    s_nop 1
    v_permlane32_swap_b32 v108, v110
    v_permlane32_swap_b32 v109, v111
    buffer_store_dwordx4 v[108:111], v3, s[8:11], s17 offen offset:1024 sc1
    v_cvt_pk_bf16_f32 v112, v56, v57
    v_cvt_pk_bf16_f32 v113, v58, v59
    v_cvt_pk_bf16_f32 v114, v60, v61
    v_cvt_pk_bf16_f32 v115, v62, v63
    s_nop 1
    v_permlane32_swap_b32 v112, v114
    v_permlane32_swap_b32 v113, v115
    buffer_store_dwordx4 v[112:115], v3, s[8:11], s18 offen offset:0 sc1
    v_cvt_pk_bf16_f32 v116, v64, v65
    v_cvt_pk_bf16_f32 v117, v66, v67
    v_cvt_pk_bf16_f32 v118, v68, v69
    v_cvt_pk_bf16_f32 v119, v70, v71
    s_nop 1
    v_permlane32_swap_b32 v116, v118
    v_permlane32_swap_b32 v117, v119
    buffer_store_dwordx4 v[116:119], v3, s[8:11], s18 offen offset:1024 sc1
    s_add_u32 s17, s17, s20
    s_add_u32 s18, s18, s20
    s_branch layerb1_kernel_gk_epnow
    s_waitcnt vmcnt(4)
    v_min_u32 v124, v124, v125
    v_min_u32 v126, v126, v127
    v_min_u32 v124, v124, v126
    v_cmp_eq_u32 vcc, 0, v124
    s_mov_b32 s59, 0
    s_nop 0
    s_ff1_i32_b64 s56, vcc
    s_min_u32 s56, s56, 64
    s_cmp_gt_u32 s56, s14
    s_cbranch_scc0 layerb1_kernel_gk_epnow
    s_min_u32 s24, s14, 63
    s_mul_i32 s24, s24, 40960
    s_add_u32 s24, s24, s19
    s_mul_i32 s25, s13, 10240
    s_add_u32 s25, s25, s22
    s_mov_b32 m0, s25
    s_nop 0
    buffer_load_dwordx4 v1, s[8:11], s24 offen offset:0 sc1 lds
    buffer_load_dwordx4 v1, s[8:11], s24 offen offset:1024 sc1 lds
    buffer_load_dwordx4 v1, s[8:11], s24 offen offset:2048 sc1 lds
    buffer_load_dwordx4 v1, s[8:11], s24 offen offset:3072 sc1 lds
    s_add_u32 s24, s24, 4096
    s_add_u32 s25, s25, 4096
    s_mov_b32 m0, s25
    s_nop 0
    buffer_load_dwordx4 v1, s[8:11], s24 offen offset:0 sc1 lds
    buffer_load_dwordx4 v1, s[8:11], s24 offen offset:1024 sc1 lds
    buffer_load_dwordx4 v1, s[8:11], s24 offen offset:2048 sc1 lds
    buffer_load_dwordx4 v1, s[8:11], s24 offen offset:3072 sc1 lds
    s_add_u32 s24, s24, 4096
    s_add_u32 s25, s25, 4096
    s_mov_b32 m0, s25
    s_nop 0
    buffer_load_dwordx4 v1, s[8:11], s24 offen offset:0 sc1 lds
    buffer_load_dwordx4 v1, s[8:11], s24 offen offset:1024 sc1 lds
    s_waitcnt vmcnt(10)
    s_barrier
    s_cmp_lg_u32 s13, 0
    s_cbranch_scc1 layerb1_kernel_gk_fl2
    s_mov_b64 exec, 1
    s_lshl_b32 s26, s12, 7
    v_mov_b32 v7, s26
    v_mov_b32 v120, s14
    buffer_store_dword v120, v7, s[8:11], s48 offen sc1
    s_mov_b64 exec, -1
layerb1_kernel_gk_fl2:
    s_cmp_eq_u32 s13, 0
    s_cbranch_scc1 layerb1_kernel_gk_epx1
    s_waitcnt vmcnt(0)
layerb1_kernel_gk_epx1:
    s_waitcnt vmcnt(1)
    s_branch layerb1_kernel_gk_ephave
layerb1_kernel_gk_ep:
    ds_read_b128 v[32:35], v2 offset:6144
    s_waitcnt lgkmcnt(6)
    v_mfma_f32_32x32x16_bf16 v[40:55], a[0:3], v[8:11], 0
    v_mfma_f32_32x32x16_bf16 v[56:71], a[4:7], v[8:11], 0
    ds_read_b128 v[36:39], v2 offset:7168
    s_waitcnt lgkmcnt(6)
    v_mfma_f32_32x32x16_bf16 v[40:55], a[8:11], v[12:15], v[40:55]
    v_mfma_f32_32x32x16_bf16 v[56:71], a[12:15], v[12:15], v[56:71]
    ds_read_b128 v[8:11], v2 offset:8192
    s_waitcnt lgkmcnt(6)
    v_mfma_f32_32x32x16_bf16 v[40:55], a[16:19], v[16:19], v[40:55]
    v_mfma_f32_32x32x16_bf16 v[56:71], a[20:23], v[16:19], v[56:71]
    ds_read_b128 v[12:15], v2 offset:9216
    s_waitcnt lgkmcnt(6)
    v_mfma_f32_32x32x16_bf16 v[40:55], a[24:27], v[20:23], v[40:55]
    v_mfma_f32_32x32x16_bf16 v[56:71], a[28:31], v[20:23], v[56:71]
    ds_read_b128 v[16:19], v2 offset:10240
    s_waitcnt lgkmcnt(6)
    v_mfma_f32_32x32x16_bf16 v[40:55], a[32:35], v[24:27], v[40:55]
    v_mfma_f32_32x32x16_bf16 v[56:71], a[36:39], v[24:27], v[56:71]
    ds_read_b128 v[20:23], v2 offset:11264
    s_waitcnt lgkmcnt(6)
    v_mfma_f32_32x32x16_bf16 v[40:55], a[40:43], v[28:31], v[40:55]
    v_mfma_f32_32x32x16_bf16 v[56:71], a[44:47], v[28:31], v[56:71]
    ds_read_b128 v[24:27], v2 offset:12288
    s_waitcnt lgkmcnt(6)
    s_cmp_lg_u32 s13, 1
    s_cbranch_scc1 layerb1_kernel_gk_eplTrue
    buffer_load_dwordx4 v[124:127], v1, s[8:11], s57 offen sc1
layerb1_kernel_gk_eplTrue:
    v_mfma_f32_32x32x16_bf16 v[40:55], a[48:51], v[32:35], v[40:55]
    v_mfma_f32_32x32x16_bf16 v[56:71], a[52:55], v[32:35], v[56:71]
    ds_read_b128 v[28:31], v2 offset:13312
    s_waitcnt lgkmcnt(6)
    v_mfma_f32_32x32x16_bf16 v[40:55], a[56:59], v[36:39], v[40:55]
    v_mfma_f32_32x32x16_bf16 v[56:71], a[60:63], v[36:39], v[56:71]
    ds_read_b128 v[32:35], v2 offset:14336
    s_waitcnt lgkmcnt(6)
    v_mfma_f32_32x32x16_bf16 v[40:55], a[64:67], v[8:11], v[40:55]
    v_mfma_f32_32x32x16_bf16 v[56:71], a[68:71], v[8:11], v[56:71]
    ds_read_b128 v[36:39], v2 offset:15360
    s_waitcnt lgkmcnt(6)
    v_mfma_f32_32x32x16_bf16 v[40:55], a[72:75], v[12:15], v[40:55]
    v_mfma_f32_32x32x16_bf16 v[56:71], a[76:79], v[12:15], v[56:71]
    ds_read_b128 v[8:11], v2 offset:16384
    s_waitcnt lgkmcnt(6)
    v_mfma_f32_32x32x16_bf16 v[40:55], a[80:83], v[16:19], v[40:55]
    v_mfma_f32_32x32x16_bf16 v[56:71], a[84:87], v[16:19], v[56:71]
    ds_read_b128 v[12:15], v2 offset:17408
    s_waitcnt lgkmcnt(6)
    v_mfma_f32_32x32x16_bf16 v[40:55], a[88:91], v[20:23], v[40:55]
    v_mfma_f32_32x32x16_bf16 v[56:71], a[92:95], v[20:23], v[56:71]
    ds_read_b128 v[16:19], v2 offset:18432
    s_waitcnt lgkmcnt(6)
    v_mfma_f32_32x32x16_bf16 v[40:55], a[96:99], v[24:27], v[40:55]
    v_mfma_f32_32x32x16_bf16 v[56:71], a[100:103], v[24:27], v[56:71]
    ds_read_b128 v[20:23], v2 offset:19456
    s_waitcnt lgkmcnt(6)
    v_mfma_f32_32x32x16_bf16 v[40:55], a[104:107], v[28:31], v[40:55]
    v_mfma_f32_32x32x16_bf16 v[56:71], a[108:111], v[28:31], v[56:71]
    ds_read_b128 v[24:27], v2 offset:20480
    s_waitcnt lgkmcnt(6)
    s_cmp_eq_u32 s55, 0
    s_cbranch_scc1 layerb1_kernel_gk_epq
    s_cmp_lg_u32 s13, 1
    s_cbranch_scc1 layerb1_kernel_gk_epq0
    s_waitcnt vmcnt(1)
    s_branch layerb1_kernel_gk_epq1
layerb1_kernel_gk_epq0:
    s_waitcnt vmcnt(0)
layerb1_kernel_gk_epq1:
    s_barrier
    s_cmp_lg_u32 s13, 0
    s_cbranch_scc1 layerb1_kernel_gk_fl3
    s_mov_b64 exec, 1
    s_lshl_b32 s26, s12, 7
    v_mov_b32 v7, s26
    v_mov_b32 v120, s14
    buffer_store_dword v120, v7, s[8:11], s48 offen sc1
    s_mov_b64 exec, -1
layerb1_kernel_gk_fl3:
    s_mov_b32 s55, 0
layerb1_kernel_gk_epq:
    v_mfma_f32_32x32x16_bf16 v[40:55], a[112:115], v[32:35], v[40:55]
    v_mfma_f32_32x32x16_bf16 v[56:71], a[116:119], v[32:35], v[56:71]
    ds_read_b128 v[28:31], v2 offset:21504
    s_waitcnt lgkmcnt(6)
    v_mfma_f32_32x32x16_bf16 v[40:55], a[120:123], v[36:39], v[40:55]
    v_mfma_f32_32x32x16_bf16 v[56:71], a[124:127], v[36:39], v[56:71]
    ds_read_b128 v[32:35], v2 offset:22528
    s_waitcnt lgkmcnt(6)
    v_mfma_f32_32x32x16_bf16 v[40:55], a[128:131], v[8:11], v[40:55]
    v_mfma_f32_32x32x16_bf16 v[56:71], a[132:135], v[8:11], v[56:71]
    ds_read_b128 v[36:39], v2 offset:23552
    s_waitcnt lgkmcnt(6)
    v_mfma_f32_32x32x16_bf16 v[40:55], a[136:139], v[12:15], v[40:55]
    v_mfma_f32_32x32x16_bf16 v[56:71], a[140:143], v[12:15], v[56:71]
    ds_read_b128 v[8:11], v2 offset:24576
    s_waitcnt lgkmcnt(6)
    s_cmp_lg_u32 s13, 1
    s_cbranch_scc1 layerb1_kernel_gk_epwTrue
    s_waitcnt vmcnt(0)
    v_min_u32 v124, v124, v125
    v_min_u32 v126, v126, v127
    v_min_u32 v124, v124, v126
    v_cmp_eq_u32 vcc, 0, v124
    s_nop 1
    s_ff1_i32_b64 s56, vcc
    s_min_u32 s56, s56, 64
    v_mov_b32 v122, s56
    ds_write_b32 v121, v122
    s_waitcnt lgkmcnt(0)
layerb1_kernel_gk_epwTrue:
    s_barrier
    ds_read_b32 v122, v121
    s_add_u32 s23, s14, 1
    s_min_u32 s24, s23, 63
    s_mul_i32 s24, s24, 40960
    s_add_u32 s24, s24, s19
    s_mul_i32 s25, s13, 10240
    s_add_u32 s25, s25, s22
    v_mfma_f32_32x32x16_bf16 v[40:55], a[144:147], v[16:19], v[40:55]
    v_mfma_f32_32x32x16_bf16 v[56:71], a[148:151], v[16:19], v[56:71]
    s_mov_b32 m0, s25
    s_nop 0
    buffer_load_dwordx4 v1, s[8:11], s24 offen offset:0 sc1 lds
    ds_read_b128 v[12:15], v2 offset:25600
    s_waitcnt lgkmcnt(6)
    v_mfma_f32_32x32x16_bf16 v[40:55], a[152:155], v[20:23], v[40:55]
    buffer_load_dwordx4 v1, s[8:11], s24 offen offset:1024 sc1 lds
    v_mfma_f32_32x32x16_bf16 v[56:71], a[156:159], v[20:23], v[56:71]
    buffer_load_dwordx4 v1, s[8:11], s24 offen offset:2048 sc1 lds
    ds_read_b128 v[16:19], v2 offset:26624
    s_waitcnt lgkmcnt(6)
    v_mfma_f32_32x32x16_bf16 v[40:55], a[160:163], v[24:27], v[40:55]
    buffer_load_dwordx4 v1, s[8:11], s24 offen offset:3072 sc1 lds
    v_mfma_f32_32x32x16_bf16 v[56:71], a[164:167], v[24:27], v[56:71]
    s_add_u32 s24, s24, 4096
    s_add_u32 s25, s25, 4096
    s_mov_b32 m0, s25
    s_nop 0
    buffer_load_dwordx4 v1, s[8:11], s24 offen offset:0 sc1 lds
    ds_read_b128 v[20:23], v2 offset:27648
    s_waitcnt lgkmcnt(6)
    v_mfma_f32_32x32x16_bf16 v[40:55], a[168:171], v[28:31], v[40:55]
    buffer_load_dwordx4 v1, s[8:11], s24 offen offset:1024 sc1 lds
    v_mfma_f32_32x32x16_bf16 v[56:71], a[172:175], v[28:31], v[56:71]
    buffer_load_dwordx4 v1, s[8:11], s24 offen offset:2048 sc1 lds
    ds_read_b128 v[24:27], v2 offset:28672
    s_waitcnt lgkmcnt(6)
    v_mfma_f32_32x32x16_bf16 v[40:55], a[176:179], v[32:35], v[40:55]
    buffer_load_dwordx4 v1, s[8:11], s24 offen offset:3072 sc1 lds
    v_mfma_f32_32x32x16_bf16 v[56:71], a[180:183], v[32:35], v[56:71]
    s_add_u32 s24, s24, 4096
    s_add_u32 s25, s25, 4096
    s_mov_b32 m0, s25
    s_nop 0
    buffer_load_dwordx4 v1, s[8:11], s24 offen offset:0 sc1 lds
    ds_read_b128 v[28:31], v2 offset:29696
    s_waitcnt lgkmcnt(6)
    v_mfma_f32_32x32x16_bf16 v[40:55], a[184:187], v[36:39], v[40:55]
    buffer_load_dwordx4 v1, s[8:11], s24 offen offset:1024 sc1 lds
    v_mfma_f32_32x32x16_bf16 v[56:71], a[188:191], v[36:39], v[56:71]
    ds_read_b128 v[32:35], v2 offset:30720
    s_waitcnt lgkmcnt(6)
    v_mfma_f32_32x32x16_bf16 v[40:55], a[192:195], v[8:11], v[40:55]
    v_mfma_f32_32x32x16_bf16 v[56:71], a[196:199], v[8:11], v[56:71]
    ds_read_b128 v[36:39], v2 offset:31744
    s_waitcnt lgkmcnt(6)
    v_mfma_f32_32x32x16_bf16 v[40:55], a[200:203], v[12:15], v[40:55]
    v_mfma_f32_32x32x16_bf16 v[56:71], a[204:207], v[12:15], v[56:71]
    ds_read_b128 v[8:11], v2 offset:32768
    s_waitcnt lgkmcnt(6)
    v_mfma_f32_32x32x16_bf16 v[40:55], a[208:211], v[16:19], v[40:55]
    v_mfma_f32_32x32x16_bf16 v[56:71], a[212:215], v[16:19], v[56:71]
    ds_read_b128 v[12:15], v2 offset:33792
    s_waitcnt lgkmcnt(6)
    v_mfma_f32_32x32x16_bf16 v[40:55], a[216:219], v[20:23], v[40:55]
    v_mfma_f32_32x32x16_bf16 v[56:71], a[220:223], v[20:23], v[56:71]
    ds_read_b128 v[16:19], v2 offset:34816
    s_waitcnt lgkmcnt(6)
    v_mfma_f32_32x32x16_bf16 v[40:55], a[224:227], v[24:27], v[40:55]
    v_mfma_f32_32x32x16_bf16 v[56:71], a[228:231], v[24:27], v[56:71]
    ds_read_b128 v[20:23], v2 offset:35840
    s_waitcnt lgkmcnt(6)
    v_mfma_f32_32x32x16_bf16 v[40:55], a[232:235], v[28:31], v[40:55]
    v_mfma_f32_32x32x16_bf16 v[56:71], a[236:239], v[28:31], v[56:71]
    ds_read_b128 v[24:27], v2 offset:36864
    s_waitcnt lgkmcnt(6)
    v_mfma_f32_32x32x16_bf16 v[40:55], a[240:243], v[32:35], v[40:55]
    v_mfma_f32_32x32x16_bf16 v[56:71], a[244:247], v[32:35], v[56:71]
    ds_read_b128 v[28:31], v2 offset:37888
    s_waitcnt lgkmcnt(6)
    v_mfma_f32_32x32x16_bf16 v[40:55], a[248:251], v[36:39], v[40:55]
    v_mfma_f32_32x32x16_bf16 v[56:71], a[252:255], v[36:39], v[56:71]
    ds_read_b128 v[32:35], v2 offset:38912
    s_waitcnt lgkmcnt(6)
    v_mfma_f32_32x32x16_bf16 v[40:55], v[192:195], v[8:11], v[40:55]
    v_mfma_f32_32x32x16_bf16 v[56:71], v[196:199], v[8:11], v[56:71]
    ds_read_b128 v[36:39], v2 offset:39936
    s_waitcnt lgkmcnt(6)
    v_mfma_f32_32x32x16_bf16 v[40:55], v[200:203], v[12:15], v[40:55]
    v_mfma_f32_32x32x16_bf16 v[56:71], v[204:207], v[12:15], v[56:71]
    s_waitcnt lgkmcnt(5)
    v_mfma_f32_32x32x16_bf16 v[40:55], v[208:211], v[16:19], v[40:55]
    v_mfma_f32_32x32x16_bf16 v[56:71], v[212:215], v[16:19], v[56:71]
    s_waitcnt lgkmcnt(4)
    v_mfma_f32_32x32x16_bf16 v[40:55], v[216:219], v[20:23], v[40:55]
    v_mfma_f32_32x32x16_bf16 v[56:71], v[220:223], v[20:23], v[56:71]
    s_waitcnt lgkmcnt(3)
    v_mfma_f32_32x32x16_bf16 v[40:55], v[224:227], v[24:27], v[40:55]
    v_mfma_f32_32x32x16_bf16 v[56:71], v[228:231], v[24:27], v[56:71]
    s_waitcnt lgkmcnt(2)
    v_mfma_f32_32x32x16_bf16 v[40:55], v[232:235], v[28:31], v[40:55]
    v_mfma_f32_32x32x16_bf16 v[56:71], v[236:239], v[28:31], v[56:71]
    s_waitcnt lgkmcnt(1)
    v_mfma_f32_32x32x16_bf16 v[40:55], v[240:243], v[32:35], v[40:55]
    v_mfma_f32_32x32x16_bf16 v[56:71], v[244:247], v[32:35], v[56:71]
    s_waitcnt lgkmcnt(0)
    v_mfma_f32_32x32x16_bf16 v[40:55], v[248:251], v[36:39], v[40:55]
    v_mfma_f32_32x32x16_bf16 v[56:71], v[252:255], v[36:39], v[56:71]
    s_add_u32 s14, s14, 1
    v_readfirstlane_b32 s56, v122
    s_mov_b32 s59, 0
    s_nop 0
    s_cmp_gt_u32 s56, s14
    s_cselect_b32 s59, 1, 0
    s_nop 7
    s_nop 7
    v_cvt_pk_bf16_f32 v104, v40, v41
    v_cvt_pk_bf16_f32 v105, v42, v43
    v_cvt_pk_bf16_f32 v106, v44, v45
    v_cvt_pk_bf16_f32 v107, v46, v47
    s_nop 1
    v_permlane32_swap_b32 v104, v106
    v_permlane32_swap_b32 v105, v107
    buffer_store_dwordx4 v[104:107], v3, s[8:11], s17 offen offset:0 sc1
    v_cvt_pk_bf16_f32 v108, v48, v49
    v_cvt_pk_bf16_f32 v109, v50, v51
    v_cvt_pk_bf16_f32 v110, v52, v53
    v_cvt_pk_bf16_f32 v111, v54, v55
    s_nop 1
    v_permlane32_swap_b32 v108, v110
    v_permlane32_swap_b32 v109, v111
    buffer_store_dwordx4 v[108:111], v3, s[8:11], s17 offen offset:1024 sc1
    v_cvt_pk_bf16_f32 v112, v56, v57
    v_cvt_pk_bf16_f32 v113, v58, v59
    v_cvt_pk_bf16_f32 v114, v60, v61
    v_cvt_pk_bf16_f32 v115, v62, v63
    s_nop 1
    v_permlane32_swap_b32 v112, v114
    v_permlane32_swap_b32 v113, v115
    buffer_store_dwordx4 v[112:115], v3, s[8:11], s18 offen offset:0 sc1
    v_cvt_pk_bf16_f32 v116, v64, v65
    v_cvt_pk_bf16_f32 v117, v66, v67
    v_cvt_pk_bf16_f32 v118, v68, v69
    v_cvt_pk_bf16_f32 v119, v70, v71
    s_nop 1
    v_permlane32_swap_b32 v116, v118
    v_permlane32_swap_b32 v117, v119
    buffer_store_dwordx4 v[116:119], v3, s[8:11], s18 offen offset:1024 sc1
    s_add_u32 s17, s17, s20
    s_add_u32 s18, s18, s20
    s_cmp_le_u32 s14, 0
    s_cbranch_scc1 layerb1_kernel_gk_epnow
    s_cmp_ge_u32 s14, 6
    s_cbranch_scc1 layerb1_kernel_gk_epnow
    s_cmp_eq_u32 s59, 0
    s_cbranch_scc1 layerb1_kernel_gk_epnow
    s_waitcnt vmcnt(4)
    s_mov_b32 s55, 1
    s_branch layerb1_kernel_gk_ephave
layerb1_kernel_gk_epnow:
    s_waitcnt vmcnt(0)
    s_barrier
    s_cmp_lg_u32 s13, 0
    s_cbranch_scc1 layerb1_kernel_gk_fl4
    s_mov_b64 exec, 1
    s_lshl_b32 s26, s12, 7
    v_mov_b32 v7, s26
    v_mov_b32 v120, s14
    buffer_store_dword v120, v7, s[8:11], s48 offen sc1
    s_mov_b64 exec, -1
layerb1_kernel_gk_fl4:
    s_mov_b32 s55, 0
    s_cmp_eq_u32 s59, 1
    s_cbranch_scc1 layerb1_kernel_gk_ephave
layerb1_kernel_gk_eppoll:
    buffer_load_dwordx4 v[124:127], v1, s[8:11], s57 offen sc1
    s_waitcnt vmcnt(0)
    v_min_u32 v124, v124, v125
    v_min_u32 v126, v126, v127
    v_min_u32 v124, v124, v126
    v_cmp_eq_u32 vcc, 0, v124
    s_nop 1
    s_ff1_i32_b64 s56, vcc
    s_min_u32 s56, s56, 64
    s_cmp_gt_u32 s56, s14
    s_cbranch_scc1 layerb1_kernel_gk_epok
    s_sub_u32 s58, s58, 1
    s_cbranch_scc1 layerb1_kernel_bail
    s_branch layerb1_kernel_gk_eppoll
layerb1_kernel_gk_epok:
    s_min_u32 s24, s14, 63
    s_mul_i32 s24, s24, 40960
    s_add_u32 s24, s24, s19
    s_mul_i32 s25, s13, 10240
    s_add_u32 s25, s25, s22
    s_mov_b32 m0, s25
    s_nop 0
    buffer_load_dwordx4 v1, s[8:11], s24 offen offset:0 sc1 lds
    buffer_load_dwordx4 v1, s[8:11], s24 offen offset:1024 sc1 lds
    buffer_load_dwordx4 v1, s[8:11], s24 offen offset:2048 sc1 lds
    buffer_load_dwordx4 v1, s[8:11], s24 offen offset:3072 sc1 lds
    s_add_u32 s24, s24, 4096
    s_add_u32 s25, s25, 4096
    s_mov_b32 m0, s25
    s_nop 0
    buffer_load_dwordx4 v1, s[8:11], s24 offen offset:0 sc1 lds
    buffer_load_dwordx4 v1, s[8:11], s24 offen offset:1024 sc1 lds
    buffer_load_dwordx4 v1, s[8:11], s24 offen offset:2048 sc1 lds
    buffer_load_dwordx4 v1, s[8:11], s24 offen offset:3072 sc1 lds
    s_add_u32 s24, s24, 4096
    s_add_u32 s25, s25, 4096
    s_mov_b32 m0, s25
    s_nop 0
    buffer_load_dwordx4 v1, s[8:11], s24 offen offset:0 sc1 lds
    buffer_load_dwordx4 v1, s[8:11], s24 offen offset:1024 sc1 lds
    s_waitcnt vmcnt(0)
layerb1_kernel_gk_ephave:
    s_mov_b32 s16, s22
    s_add_u32 s22, s22, 40960
    s_cmp_eq_u32 s22, 122880
    s_cselect_b32 s22, 0, s22
    v_add_u32 v2, s16, v1
    s_barrier
    ds_read_b128 v[8:11], v2 offset:0
    ds_read_b128 v[12:15], v2 offset:1024
    ds_read_b128 v[16:19], v2 offset:2048
    ds_read_b128 v[20:23], v2 offset:3072
    ds_read_b128 v[24:27], v2 offset:4096
    ds_read_b128 v[28:31], v2 offset:5120
    s_cmp_lt_u32 s14, 6
    s_cbranch_scc1 layerb1_kernel_gk_ep
    ds_read_b128 v[32:35], v2 offset:6144
    s_waitcnt lgkmcnt(6)
    v_mfma_f32_32x32x16_bf16 v[72:87], a[0:3], v[8:11], 0
    v_mfma_f32_32x32x16_bf16 v[88:103], a[4:7], v[8:11], 0
    ds_read_b128 v[36:39], v2 offset:7168
    s_waitcnt lgkmcnt(6)
    v_mfma_f32_32x32x16_bf16 v[72:87], a[8:11], v[12:15], v[72:87]
    v_mfma_f32_32x32x16_bf16 v[88:103], a[12:15], v[12:15], v[88:103]
    ds_read_b128 v[8:11], v2 offset:8192
    s_waitcnt lgkmcnt(6)
    v_mfma_f32_32x32x16_bf16 v[72:87], a[16:19], v[16:19], v[72:87]
    v_mfma_f32_32x32x16_bf16 v[88:103], a[20:23], v[16:19], v[88:103]
    s_add_u32 s23, s14, 1
    s_cmp_lg_u32 s13, 0
    s_cbranch_scc1 layerb1_kernel_gk_lw5
    s_min_u32 s28, s23, 63
    s_cmp_gt_u32 s56, s28
    s_cbranch_scc1 layerb1_kernel_gk_lw5
layerb1_kernel_gk_lp5:
    buffer_load_dwordx4 v[124:127], v1, s[8:11], s57 offen sc1
    s_waitcnt vmcnt(0)
    v_min_u32 v124, v124, v125
    v_min_u32 v126, v126, v127
    v_min_u32 v124, v124, v126
    v_cmp_eq_u32 vcc, 0, v124
    s_nop 1
    s_ff1_i32_b64 s56, vcc
    s_min_u32 s56, s56, 64
    s_sub_u32 s58, s58, 1
    s_cbranch_scc1 layerb1_kernel_bail
    s_cmp_gt_u32 s56, s28
    s_cbranch_scc0 layerb1_kernel_gk_lp5
layerb1_kernel_gk_lw5:
    s_barrier
    s_min_u32 s24, s23, 63
    s_mul_i32 s24, s24, 40960
    s_add_u32 s24, s24, s19
    s_mul_i32 s25, s13, 10240
    s_add_u32 s25, s25, s22
    s_add_u32 s22, s22, 40960
    s_cmp_eq_u32 s22, 122880
    s_cselect_b32 s22, 0, s22
    ds_read_b128 v[12:15], v2 offset:9216
    s_waitcnt lgkmcnt(6)
    v_mfma_f32_32x32x16_bf16 v[72:87], a[24:27], v[20:23], v[72:87]
    s_mov_b32 m0, s25
    s_nop 0
    buffer_load_dwordx4 v1, s[8:11], s24 offen offset:0 sc1 lds
    v_mfma_f32_32x32x16_bf16 v[88:103], a[28:31], v[20:23], v[88:103]
    ds_read_b128 v[16:19], v2 offset:10240
    s_waitcnt lgkmcnt(6)
    v_mfma_f32_32x32x16_bf16 v[72:87], a[32:35], v[24:27], v[72:87]
    buffer_load_dwordx4 v1, s[8:11], s24 offen offset:1024 sc1 lds
    v_mfma_f32_32x32x16_bf16 v[88:103], a[36:39], v[24:27], v[88:103]
    ds_read_b128 v[20:23], v2 offset:11264
    s_waitcnt lgkmcnt(6)
    v_mfma_f32_32x32x16_bf16 v[72:87], a[40:43], v[28:31], v[72:87]
    buffer_load_dwordx4 v1, s[8:11], s24 offen offset:2048 sc1 lds
    v_mfma_f32_32x32x16_bf16 v[88:103], a[44:47], v[28:31], v[88:103]
    ds_read_b128 v[24:27], v2 offset:12288
    s_waitcnt lgkmcnt(6)
    v_mfma_f32_32x32x16_bf16 v[72:87], a[48:51], v[32:35], v[72:87]
    buffer_load_dwordx4 v1, s[8:11], s24 offen offset:3072 sc1 lds
    v_mfma_f32_32x32x16_bf16 v[88:103], a[52:55], v[32:35], v[88:103]
    ds_read_b128 v[28:31], v2 offset:13312
    s_waitcnt lgkmcnt(6)
    v_mfma_f32_32x32x16_bf16 v[72:87], a[56:59], v[36:39], v[72:87]
    s_add_u32 s24, s24, 4096
    s_add_u32 s25, s25, 4096
    s_mov_b32 m0, s25
    s_nop 0
    buffer_load_dwordx4 v1, s[8:11], s24 offen offset:0 sc1 lds
    v_mfma_f32_32x32x16_bf16 v[88:103], a[60:63], v[36:39], v[88:103]
    ds_read_b128 v[32:35], v2 offset:14336
    s_waitcnt lgkmcnt(6)
    v_mfma_f32_32x32x16_bf16 v[72:87], a[64:67], v[8:11], v[72:87]
    buffer_load_dwordx4 v1, s[8:11], s24 offen offset:1024 sc1 lds
    v_mfma_f32_32x32x16_bf16 v[88:103], a[68:71], v[8:11], v[88:103]
    ds_read_b128 v[36:39], v2 offset:15360
    s_waitcnt lgkmcnt(6)
    v_mfma_f32_32x32x16_bf16 v[72:87], a[72:75], v[12:15], v[72:87]
    buffer_load_dwordx4 v1, s[8:11], s24 offen offset:2048 sc1 lds
    v_mfma_f32_32x32x16_bf16 v[88:103], a[76:79], v[12:15], v[88:103]
    ds_read_b128 v[8:11], v2 offset:16384
    s_waitcnt lgkmcnt(6)
    v_mfma_f32_32x32x16_bf16 v[72:87], a[80:83], v[16:19], v[72:87]
    buffer_load_dwordx4 v1, s[8:11], s24 offen offset:3072 sc1 lds
    v_mfma_f32_32x32x16_bf16 v[88:103], a[84:87], v[16:19], v[88:103]
    ds_read_b128 v[12:15], v2 offset:17408
    s_waitcnt lgkmcnt(6)
    v_mfma_f32_32x32x16_bf16 v[72:87], a[88:91], v[20:23], v[72:87]
    s_add_u32 s24, s24, 4096
    s_add_u32 s25, s25, 4096
    s_mov_b32 m0, s25
    s_nop 0
    buffer_load_dwordx4 v1, s[8:11], s24 offen offset:0 sc1 lds
    v_mfma_f32_32x32x16_bf16 v[88:103], a[92:95], v[20:23], v[88:103]
    ds_read_b128 v[16:19], v2 offset:18432
    s_waitcnt lgkmcnt(6)
    v_mfma_f32_32x32x16_bf16 v[72:87], a[96:99], v[24:27], v[72:87]
    buffer_load_dwordx4 v1, s[8:11], s24 offen offset:1024 sc1 lds
    v_mfma_f32_32x32x16_bf16 v[88:103], a[100:103], v[24:27], v[88:103]
    ds_read_b128 v[20:23], v2 offset:19456
    s_waitcnt lgkmcnt(6)
    v_mfma_f32_32x32x16_bf16 v[72:87], a[104:107], v[28:31], v[72:87]
    v_mfma_f32_32x32x16_bf16 v[88:103], a[108:111], v[28:31], v[88:103]
    ds_read_b128 v[24:27], v2 offset:20480
    s_waitcnt lgkmcnt(6)
    v_mfma_f32_32x32x16_bf16 v[72:87], a[112:115], v[32:35], v[72:87]
    v_mfma_f32_32x32x16_bf16 v[88:103], a[116:119], v[32:35], v[88:103]
    ds_read_b128 v[28:31], v2 offset:21504
    s_waitcnt lgkmcnt(6)
    v_mfma_f32_32x32x16_bf16 v[72:87], a[120:123], v[36:39], v[72:87]
    v_mfma_f32_32x32x16_bf16 v[88:103], a[124:127], v[36:39], v[88:103]
    ds_read_b128 v[32:35], v2 offset:22528
    s_waitcnt lgkmcnt(6)
    v_mfma_f32_32x32x16_bf16 v[72:87], a[128:131], v[8:11], v[72:87]
    v_mfma_f32_32x32x16_bf16 v[88:103], a[132:135], v[8:11], v[88:103]
    ds_read_b128 v[36:39], v2 offset:23552
    s_waitcnt lgkmcnt(6)
    v_mfma_f32_32x32x16_bf16 v[72:87], a[136:139], v[12:15], v[72:87]
    v_mfma_f32_32x32x16_bf16 v[88:103], a[140:143], v[12:15], v[88:103]
    ds_read_b128 v[8:11], v2 offset:24576
    s_waitcnt lgkmcnt(6)
    v_mfma_f32_32x32x16_bf16 v[72:87], a[144:147], v[16:19], v[72:87]
    v_mfma_f32_32x32x16_bf16 v[88:103], a[148:151], v[16:19], v[88:103]
    ds_read_b128 v[12:15], v2 offset:25600
    s_waitcnt lgkmcnt(6)
    v_mfma_f32_32x32x16_bf16 v[72:87], a[152:155], v[20:23], v[72:87]
    v_mfma_f32_32x32x16_bf16 v[88:103], a[156:159], v[20:23], v[88:103]
    ds_read_b128 v[16:19], v2 offset:26624
    s_waitcnt lgkmcnt(6)
    v_mfma_f32_32x32x16_bf16 v[72:87], a[160:163], v[24:27], v[72:87]
    v_mfma_f32_32x32x16_bf16 v[88:103], a[164:167], v[24:27], v[88:103]
    ds_read_b128 v[20:23], v2 offset:27648
    s_waitcnt lgkmcnt(6)
    v_mfma_f32_32x32x16_bf16 v[72:87], a[168:171], v[28:31], v[72:87]
    v_mfma_f32_32x32x16_bf16 v[88:103], a[172:175], v[28:31], v[88:103]
    ds_read_b128 v[24:27], v2 offset:28672
    s_waitcnt lgkmcnt(6)
    v_mfma_f32_32x32x16_bf16 v[72:87], a[176:179], v[32:35], v[72:87]
    v_mfma_f32_32x32x16_bf16 v[88:103], a[180:183], v[32:35], v[88:103]
    ds_read_b128 v[28:31], v2 offset:29696
    s_waitcnt lgkmcnt(6)
    v_mfma_f32_32x32x16_bf16 v[72:87], a[184:187], v[36:39], v[72:87]
    v_mfma_f32_32x32x16_bf16 v[88:103], a[188:191], v[36:39], v[88:103]
    ds_read_b128 v[32:35], v2 offset:30720
    s_waitcnt lgkmcnt(6)
    v_mfma_f32_32x32x16_bf16 v[72:87], a[192:195], v[8:11], v[72:87]
    v_mfma_f32_32x32x16_bf16 v[88:103], a[196:199], v[8:11], v[88:103]
    ds_read_b128 v[36:39], v2 offset:31744
    s_waitcnt lgkmcnt(6)
    v_mfma_f32_32x32x16_bf16 v[72:87], a[200:203], v[12:15], v[72:87]
    v_mfma_f32_32x32x16_bf16 v[88:103], a[204:207], v[12:15], v[88:103]
    ds_read_b128 v[8:11], v2 offset:32768
    s_waitcnt lgkmcnt(6)
    v_mfma_f32_32x32x16_bf16 v[72:87], a[208:211], v[16:19], v[72:87]
    v_mfma_f32_32x32x16_bf16 v[88:103], a[212:215], v[16:19], v[88:103]
    ds_read_b128 v[12:15], v2 offset:33792
    s_waitcnt lgkmcnt(6)
    v_mfma_f32_32x32x16_bf16 v[72:87], a[216:219], v[20:23], v[72:87]
    v_mfma_f32_32x32x16_bf16 v[88:103], a[220:223], v[20:23], v[88:103]
    ds_read_b128 v[16:19], v2 offset:34816
    s_waitcnt lgkmcnt(6)
    v_mfma_f32_32x32x16_bf16 v[72:87], a[224:227], v[24:27], v[72:87]
    v_mfma_f32_32x32x16_bf16 v[88:103], a[228:231], v[24:27], v[88:103]
    s_add_u32 s23, s14, 2
    s_cmp_lg_u32 s13, 0
    s_cbranch_scc1 layerb1_kernel_gk_lw6
    s_min_u32 s28, s23, 63
    s_cmp_gt_u32 s56, s28
    s_cbranch_scc1 layerb1_kernel_gk_lw6
layerb1_kernel_gk_lp6:
    buffer_load_dwordx4 v[124:127], v1, s[8:11], s57 offen sc1
    s_waitcnt vmcnt(0)
    v_min_u32 v124, v124, v125
    v_min_u32 v126, v126, v127
    v_min_u32 v124, v124, v126
    v_cmp_eq_u32 vcc, 0, v124
    s_nop 1
    s_ff1_i32_b64 s56, vcc
    s_min_u32 s56, s56, 64
    s_sub_u32 s58, s58, 1
    s_cbranch_scc1 layerb1_kernel_bail
    s_cmp_gt_u32 s56, s28
    s_cbranch_scc0 layerb1_kernel_gk_lp6
layerb1_kernel_gk_lw6:
    s_waitcnt vmcnt(0)
    s_barrier
    s_add_u32 s21, s16, 40960
    s_cmp_eq_u32 s21, 122880
    s_cselect_b32 s21, 0, s21
    s_add_u32 s23, s14, 2
    s_min_u32 s24, s23, 63
    s_mul_i32 s24, s24, 40960
    s_add_u32 s24, s24, s19
    s_mul_i32 s25, s13, 10240
    s_add_u32 s25, s25, s22
    s_add_u32 s22, s22, 40960
    s_cmp_eq_u32 s22, 122880
    s_cselect_b32 s22, 0, s22
    ds_read_b128 v[20:23], v2 offset:35840
    s_waitcnt lgkmcnt(6)
    v_mfma_f32_32x32x16_bf16 v[72:87], a[232:235], v[28:31], v[72:87]
    s_mov_b32 m0, s25
    s_nop 0
    buffer_load_dwordx4 v1, s[8:11], s24 offen offset:0 sc1 lds
    v_mfma_f32_32x32x16_bf16 v[88:103], a[236:239], v[28:31], v[88:103]
    ds_read_b128 v[24:27], v2 offset:36864
    s_waitcnt lgkmcnt(6)
    v_mfma_f32_32x32x16_bf16 v[72:87], a[240:243], v[32:35], v[72:87]
    buffer_load_dwordx4 v1, s[8:11], s24 offen offset:1024 sc1 lds
    v_mfma_f32_32x32x16_bf16 v[88:103], a[244:247], v[32:35], v[88:103]
    ds_read_b128 v[28:31], v2 offset:37888
    s_waitcnt lgkmcnt(6)
    v_mfma_f32_32x32x16_bf16 v[72:87], a[248:251], v[36:39], v[72:87]
    buffer_load_dwordx4 v1, s[8:11], s24 offen offset:2048 sc1 lds
    v_mfma_f32_32x32x16_bf16 v[88:103], a[252:255], v[36:39], v[88:103]
    ds_read_b128 v[32:35], v2 offset:38912
    s_waitcnt lgkmcnt(6)
    v_mfma_f32_32x32x16_bf16 v[72:87], v[192:195], v[8:11], v[72:87]
    buffer_load_dwordx4 v1, s[8:11], s24 offen offset:3072 sc1 lds
    v_mfma_f32_32x32x16_bf16 v[88:103], v[196:199], v[8:11], v[88:103]
    ds_read_b128 v[36:39], v2 offset:39936
    s_waitcnt lgkmcnt(6)
    v_mfma_f32_32x32x16_bf16 v[72:87], v[200:203], v[12:15], v[72:87]
    s_add_u32 s24, s24, 4096
    s_add_u32 s25, s25, 4096
    s_mov_b32 m0, s25
    s_nop 0
    buffer_load_dwordx4 v1, s[8:11], s24 offen offset:0 sc1 lds
    v_mfma_f32_32x32x16_bf16 v[88:103], v[204:207], v[12:15], v[88:103]
    v_add_u32 v6, s21, v1
    ds_read_b128 v[8:11], v6 offset:0
    s_waitcnt lgkmcnt(6)
    v_mfma_f32_32x32x16_bf16 v[72:87], v[208:211], v[16:19], v[72:87]
    buffer_load_dwordx4 v1, s[8:11], s24 offen offset:1024 sc1 lds
    v_mfma_f32_32x32x16_bf16 v[88:103], v[212:215], v[16:19], v[88:103]
    ds_read_b128 v[12:15], v6 offset:1024
    s_waitcnt lgkmcnt(6)
    v_mfma_f32_32x32x16_bf16 v[72:87], v[216:219], v[20:23], v[72:87]
    buffer_load_dwordx4 v1, s[8:11], s24 offen offset:2048 sc1 lds
    v_mfma_f32_32x32x16_bf16 v[88:103], v[220:223], v[20:23], v[88:103]
    ds_read_b128 v[16:19], v6 offset:2048
    s_waitcnt lgkmcnt(6)
    v_mfma_f32_32x32x16_bf16 v[72:87], v[224:227], v[24:27], v[72:87]
    buffer_load_dwordx4 v1, s[8:11], s24 offen offset:3072 sc1 lds
    v_mfma_f32_32x32x16_bf16 v[88:103], v[228:231], v[24:27], v[88:103]
    ds_read_b128 v[20:23], v6 offset:3072
    s_waitcnt lgkmcnt(6)
    v_mfma_f32_32x32x16_bf16 v[72:87], v[232:235], v[28:31], v[72:87]
    s_add_u32 s24, s24, 4096
    s_add_u32 s25, s25, 4096
    s_mov_b32 m0, s25
    s_nop 0
    buffer_load_dwordx4 v1, s[8:11], s24 offen offset:0 sc1 lds
    v_mfma_f32_32x32x16_bf16 v[88:103], v[236:239], v[28:31], v[88:103]
    ds_read_b128 v[24:27], v6 offset:4096
    s_waitcnt lgkmcnt(6)
    v_mfma_f32_32x32x16_bf16 v[72:87], v[240:243], v[32:35], v[72:87]
    buffer_load_dwordx4 v1, s[8:11], s24 offen offset:1024 sc1 lds
    v_mfma_f32_32x32x16_bf16 v[88:103], v[244:247], v[32:35], v[88:103]
    ds_read_b128 v[28:31], v6 offset:5120
    s_waitcnt lgkmcnt(6)
    v_mfma_f32_32x32x16_bf16 v[72:87], v[248:251], v[36:39], v[72:87]
    v_mfma_f32_32x32x16_bf16 v[88:103], v[252:255], v[36:39], v[88:103]
    v_mov_b32 v2, v6
    s_mov_b32 s16, s21
    s_add_u32 s14, s14, 1
layerb1_kernel_gk_loop:
    ds_read_b128 v[32:35], v2 offset:6144
    s_waitcnt lgkmcnt(6)
    v_mfma_f32_32x32x16_bf16 v[40:55], a[0:3], v[8:11], 0
    v_mfma_f32_32x32x16_bf16 v[56:71], a[4:7], v[8:11], 0
    ds_read_b128 v[36:39], v2 offset:7168
    s_waitcnt lgkmcnt(6)
    v_mfma_f32_32x32x16_bf16 v[40:55], a[8:11], v[12:15], v[40:55]
    v_mfma_f32_32x32x16_bf16 v[56:71], a[12:15], v[12:15], v[56:71]
    ds_read_b128 v[8:11], v2 offset:8192
    s_waitcnt lgkmcnt(6)
    v_mfma_f32_32x32x16_bf16 v[40:55], a[16:19], v[16:19], v[40:55]
    v_cvt_pk_bf16_f32 v104, v72, v73
    v_mfma_f32_32x32x16_bf16 v[56:71], a[20:23], v[16:19], v[56:71]
    v_cvt_pk_bf16_f32 v105, v74, v75
    ds_read_b128 v[12:15], v2 offset:9216
    s_waitcnt lgkmcnt(6)
    v_mfma_f32_32x32x16_bf16 v[40:55], a[24:27], v[20:23], v[40:55]
    v_cvt_pk_bf16_f32 v106, v76, v77
    v_mfma_f32_32x32x16_bf16 v[56:71], a[28:31], v[20:23], v[56:71]
    v_cvt_pk_bf16_f32 v107, v78, v79
    ds_read_b128 v[16:19], v2 offset:10240
    s_waitcnt lgkmcnt(6)
    v_mfma_f32_32x32x16_bf16 v[40:55], a[32:35], v[24:27], v[40:55]
    s_nop 1
    v_mfma_f32_32x32x16_bf16 v[56:71], a[36:39], v[24:27], v[56:71]
    v_permlane32_swap_b32 v104, v106
    ds_read_b128 v[20:23], v2 offset:11264
    s_waitcnt lgkmcnt(6)
    v_mfma_f32_32x32x16_bf16 v[40:55], a[40:43], v[28:31], v[40:55]
    v_permlane32_swap_b32 v105, v107
    v_mfma_f32_32x32x16_bf16 v[56:71], a[44:47], v[28:31], v[56:71]
    buffer_store_dwordx4 v[104:107], v3, s[8:11], s17 offen offset:0 sc1
    ds_read_b128 v[24:27], v2 offset:12288
    s_waitcnt lgkmcnt(6)
    v_mfma_f32_32x32x16_bf16 v[40:55], a[48:51], v[32:35], v[40:55]
    v_cvt_pk_bf16_f32 v108, v80, v81
    v_mfma_f32_32x32x16_bf16 v[56:71], a[52:55], v[32:35], v[56:71]
    v_cvt_pk_bf16_f32 v109, v82, v83
    ds_read_b128 v[28:31], v2 offset:13312
    s_waitcnt lgkmcnt(6)
    v_mfma_f32_32x32x16_bf16 v[40:55], a[56:59], v[36:39], v[40:55]
    v_cvt_pk_bf16_f32 v110, v84, v85
    v_mfma_f32_32x32x16_bf16 v[56:71], a[60:63], v[36:39], v[56:71]
    v_cvt_pk_bf16_f32 v111, v86, v87
    ds_read_b128 v[32:35], v2 offset:14336
    s_waitcnt lgkmcnt(6)
    v_mfma_f32_32x32x16_bf16 v[40:55], a[64:67], v[8:11], v[40:55]
    s_nop 1
    v_mfma_f32_32x32x16_bf16 v[56:71], a[68:71], v[8:11], v[56:71]
    v_permlane32_swap_b32 v108, v110
    ds_read_b128 v[36:39], v2 offset:15360
    s_waitcnt lgkmcnt(6)
    v_mfma_f32_32x32x16_bf16 v[40:55], a[72:75], v[12:15], v[40:55]
    v_permlane32_swap_b32 v109, v111
    v_mfma_f32_32x32x16_bf16 v[56:71], a[76:79], v[12:15], v[56:71]
    buffer_store_dwordx4 v[108:111], v3, s[8:11], s17 offen offset:1024 sc1
    ds_read_b128 v[8:11], v2 offset:16384
    s_waitcnt lgkmcnt(6)
    v_mfma_f32_32x32x16_bf16 v[40:55], a[80:83], v[16:19], v[40:55]
    v_cvt_pk_bf16_f32 v112, v88, v89
    v_mfma_f32_32x32x16_bf16 v[56:71], a[84:87], v[16:19], v[56:71]
    v_cvt_pk_bf16_f32 v113, v90, v91
    ds_read_b128 v[12:15], v2 offset:17408
    s_waitcnt lgkmcnt(6)
    v_mfma_f32_32x32x16_bf16 v[40:55], a[88:91], v[20:23], v[40:55]
    v_cvt_pk_bf16_f32 v114, v92, v93
    v_mfma_f32_32x32x16_bf16 v[56:71], a[92:95], v[20:23], v[56:71]
    v_cvt_pk_bf16_f32 v115, v94, v95
    ds_read_b128 v[16:19], v2 offset:18432
    s_waitcnt lgkmcnt(6)
    v_mfma_f32_32x32x16_bf16 v[40:55], a[96:99], v[24:27], v[40:55]
    s_nop 1
    v_mfma_f32_32x32x16_bf16 v[56:71], a[100:103], v[24:27], v[56:71]
    v_permlane32_swap_b32 v112, v114
    ds_read_b128 v[20:23], v2 offset:19456
    s_waitcnt lgkmcnt(6)
    v_mfma_f32_32x32x16_bf16 v[40:55], a[104:107], v[28:31], v[40:55]
    v_permlane32_swap_b32 v113, v115
    v_mfma_f32_32x32x16_bf16 v[56:71], a[108:111], v[28:31], v[56:71]
    buffer_store_dwordx4 v[112:115], v3, s[8:11], s18 offen offset:0 sc1
    ds_read_b128 v[24:27], v2 offset:20480
    s_waitcnt lgkmcnt(6)
    v_mfma_f32_32x32x16_bf16 v[40:55], a[112:115], v[32:35], v[40:55]
    v_cvt_pk_bf16_f32 v116, v96, v97
    v_mfma_f32_32x32x16_bf16 v[56:71], a[116:119], v[32:35], v[56:71]
    v_cvt_pk_bf16_f32 v117, v98, v99
    ds_read_b128 v[28:31], v2 offset:21504
    s_waitcnt lgkmcnt(6)
    v_mfma_f32_32x32x16_bf16 v[40:55], a[120:123], v[36:39], v[40:55]
    v_cvt_pk_bf16_f32 v118, v100, v101
    v_mfma_f32_32x32x16_bf16 v[56:71], a[124:127], v[36:39], v[56:71]
    v_cvt_pk_bf16_f32 v119, v102, v103
    ds_read_b128 v[32:35], v2 offset:22528
    s_waitcnt lgkmcnt(6)
    v_mfma_f32_32x32x16_bf16 v[40:55], a[128:131], v[8:11], v[40:55]
    s_nop 1
    v_mfma_f32_32x32x16_bf16 v[56:71], a[132:135], v[8:11], v[56:71]
    v_permlane32_swap_b32 v116, v118
    ds_read_b128 v[36:39], v2 offset:23552
    s_waitcnt lgkmcnt(6)
    v_mfma_f32_32x32x16_bf16 v[40:55], a[136:139], v[12:15], v[40:55]
    v_permlane32_swap_b32 v117, v119
    v_mfma_f32_32x32x16_bf16 v[56:71], a[140:143], v[12:15], v[56:71]
    buffer_store_dwordx4 v[116:119], v3, s[8:11], s18 offen offset:1024 sc1
    ds_read_b128 v[8:11], v2 offset:24576
    s_waitcnt lgkmcnt(6)
    v_mfma_f32_32x32x16_bf16 v[40:55], a[144:147], v[16:19], v[40:55]
    s_add_u32 s17, s17, s20
    v_mfma_f32_32x32x16_bf16 v[56:71], a[148:151], v[16:19], v[56:71]
    s_add_u32 s18, s18, s20
    ds_read_b128 v[12:15], v2 offset:25600
    s_waitcnt lgkmcnt(6)
    v_mfma_f32_32x32x16_bf16 v[40:55], a[152:155], v[20:23], v[40:55]
    v_mfma_f32_32x32x16_bf16 v[56:71], a[156:159], v[20:23], v[56:71]
    ds_read_b128 v[16:19], v2 offset:26624
    s_waitcnt lgkmcnt(6)
    v_mfma_f32_32x32x16_bf16 v[40:55], a[160:163], v[24:27], v[40:55]
    v_mfma_f32_32x32x16_bf16 v[56:71], a[164:167], v[24:27], v[56:71]
    ds_read_b128 v[20:23], v2 offset:27648
    s_waitcnt lgkmcnt(6)
    v_mfma_f32_32x32x16_bf16 v[40:55], a[168:171], v[28:31], v[40:55]
    v_mfma_f32_32x32x16_bf16 v[56:71], a[172:175], v[28:31], v[56:71]
    ds_read_b128 v[24:27], v2 offset:28672
    s_waitcnt lgkmcnt(6)
    v_mfma_f32_32x32x16_bf16 v[40:55], a[176:179], v[32:35], v[40:55]
    v_mfma_f32_32x32x16_bf16 v[56:71], a[180:183], v[32:35], v[56:71]
    ds_read_b128 v[28:31], v2 offset:29696
    s_waitcnt lgkmcnt(6)
    v_mfma_f32_32x32x16_bf16 v[40:55], a[184:187], v[36:39], v[40:55]
    v_mfma_f32_32x32x16_bf16 v[56:71], a[188:191], v[36:39], v[56:71]
    ds_read_b128 v[32:35], v2 offset:30720
    s_waitcnt lgkmcnt(6)
    v_mfma_f32_32x32x16_bf16 v[40:55], a[192:195], v[8:11], v[40:55]
    v_mfma_f32_32x32x16_bf16 v[56:71], a[196:199], v[8:11], v[56:71]
    ds_read_b128 v[36:39], v2 offset:31744
    s_waitcnt lgkmcnt(6)
    v_mfma_f32_32x32x16_bf16 v[40:55], a[200:203], v[12:15], v[40:55]
    v_mfma_f32_32x32x16_bf16 v[56:71], a[204:207], v[12:15], v[56:71]
    ds_read_b128 v[8:11], v2 offset:32768
    s_waitcnt lgkmcnt(6)
    v_mfma_f32_32x32x16_bf16 v[40:55], a[208:211], v[16:19], v[40:55]
    v_mfma_f32_32x32x16_bf16 v[56:71], a[212:215], v[16:19], v[56:71]
    ds_read_b128 v[12:15], v2 offset:33792
    s_waitcnt lgkmcnt(6)
    v_mfma_f32_32x32x16_bf16 v[40:55], a[216:219], v[20:23], v[40:55]
    v_mfma_f32_32x32x16_bf16 v[56:71], a[220:223], v[20:23], v[56:71]
    ds_read_b128 v[16:19], v2 offset:34816
    s_waitcnt lgkmcnt(6)
    v_mfma_f32_32x32x16_bf16 v[40:55], a[224:227], v[24:27], v[40:55]
    v_mfma_f32_32x32x16_bf16 v[56:71], a[228:231], v[24:27], v[56:71]
    s_add_u32 s23, s14, 2
    s_cmp_gt_u32 s14, 12
    s_cbranch_scc1 layerb1_kernel_gk_fa7
    s_waitcnt vmcnt(0)
    s_barrier
    s_cmp_lg_u32 s13, 0
    s_cbranch_scc1 layerb1_kernel_gk_fl8
    s_mov_b64 exec, 1
    s_lshl_b32 s26, s12, 7
    v_mov_b32 v7, s26
    v_mov_b32 v120, s14
    buffer_store_dword v120, v7, s[8:11], s48 offen sc1
    s_mov_b64 exec, -1
layerb1_kernel_gk_fl8:
    s_cmp_lg_u32 s13, 0
    s_cbranch_scc1 layerb1_kernel_gk_lw9
    s_min_u32 s28, s23, 63
    s_cmp_gt_u32 s56, s28
    s_cbranch_scc1 layerb1_kernel_gk_lw9
layerb1_kernel_gk_lp9:
    buffer_load_dwordx4 v[124:127], v1, s[8:11], s57 offen sc1
    s_waitcnt vmcnt(0)
    v_min_u32 v124, v124, v125
    v_min_u32 v126, v126, v127
    v_min_u32 v124, v124, v126
    v_cmp_eq_u32 vcc, 0, v124
    s_nop 1
    s_ff1_i32_b64 s56, vcc
    s_min_u32 s56, s56, 64
    s_sub_u32 s58, s58, 1
    s_cbranch_scc1 layerb1_kernel_bail
    s_cmp_gt_u32 s56, s28
    s_cbranch_scc0 layerb1_kernel_gk_lp9
layerb1_kernel_gk_lw9:
    s_barrier
    s_branch layerb1_kernel_gk_fb7
layerb1_kernel_gk_fa7:
    s_cmp_lg_u32 s13, 0
    s_cbranch_scc1 layerb1_kernel_gk_lw10
    s_min_u32 s28, s23, 63
    s_cmp_gt_u32 s56, s28
    s_cbranch_scc1 layerb1_kernel_gk_lw10
layerb1_kernel_gk_lp10:
    buffer_load_dwordx4 v[124:127], v1, s[8:11], s57 offen sc1
    s_waitcnt vmcnt(0)
    v_min_u32 v124, v124, v125
    v_min_u32 v126, v126, v127
    v_min_u32 v124, v124, v126
    v_cmp_eq_u32 vcc, 0, v124
    s_nop 1
    s_ff1_i32_b64 s56, vcc
    s_min_u32 s56, s56, 64
    s_sub_u32 s58, s58, 1
    s_cbranch_scc1 layerb1_kernel_bail
    s_cmp_gt_u32 s56, s28
    s_cbranch_scc0 layerb1_kernel_gk_lp10
layerb1_kernel_gk_lw10:
    s_waitcnt vmcnt(4)
    s_sub_u32 s27, s14, 1
    s_barrier
    s_cmp_lg_u32 s13, 0
    s_cbranch_scc1 layerb1_kernel_gk_fl11
    s_mov_b64 exec, 1
    s_lshl_b32 s26, s12, 7
    v_mov_b32 v7, s26
    v_mov_b32 v120, s27
    buffer_store_dword v120, v7, s[8:11], s48 offen sc1
    s_mov_b64 exec, -1
layerb1_kernel_gk_fl11:
layerb1_kernel_gk_fb7:
    s_add_u32 s21, s16, 40960
    s_cmp_eq_u32 s21, 122880
    s_cselect_b32 s21, 0, s21
    s_add_u32 s23, s14, 2
    s_min_u32 s24, s23, 63
    s_mul_i32 s24, s24, 40960
    s_add_u32 s24, s24, s19
    s_mul_i32 s25, s13, 10240
    s_add_u32 s25, s25, s22
    s_add_u32 s22, s22, 40960
    s_cmp_eq_u32 s22, 122880
    s_cselect_b32 s22, 0, s22
    ds_read_b128 v[20:23], v2 offset:35840
    s_waitcnt lgkmcnt(6)
    v_mfma_f32_32x32x16_bf16 v[40:55], a[232:235], v[28:31], v[40:55]
    s_mov_b32 m0, s25
    s_nop 0
    buffer_load_dwordx4 v1, s[8:11], s24 offen offset:0 sc1 lds
    v_mfma_f32_32x32x16_bf16 v[56:71], a[236:239], v[28:31], v[56:71]
    ds_read_b128 v[24:27], v2 offset:36864
    s_waitcnt lgkmcnt(6)
    v_mfma_f32_32x32x16_bf16 v[40:55], a[240:243], v[32:35], v[40:55]
    buffer_load_dwordx4 v1, s[8:11], s24 offen offset:1024 sc1 lds
    v_mfma_f32_32x32x16_bf16 v[56:71], a[244:247], v[32:35], v[56:71]
    ds_read_b128 v[28:31], v2 offset:37888
    s_waitcnt lgkmcnt(6)
    v_mfma_f32_32x32x16_bf16 v[40:55], a[248:251], v[36:39], v[40:55]
    buffer_load_dwordx4 v1, s[8:11], s24 offen offset:2048 sc1 lds
    v_mfma_f32_32x32x16_bf16 v[56:71], a[252:255], v[36:39], v[56:71]
    ds_read_b128 v[32:35], v2 offset:38912
    s_waitcnt lgkmcnt(6)
    v_mfma_f32_32x32x16_bf16 v[40:55], v[192:195], v[8:11], v[40:55]
    buffer_load_dwordx4 v1, s[8:11], s24 offen offset:3072 sc1 lds
    v_mfma_f32_32x32x16_bf16 v[56:71], v[196:199], v[8:11], v[56:71]
    ds_read_b128 v[36:39], v2 offset:39936
    s_waitcnt lgkmcnt(6)
    v_mfma_f32_32x32x16_bf16 v[40:55], v[200:203], v[12:15], v[40:55]
    s_add_u32 s24, s24, 4096
    s_add_u32 s25, s25, 4096
    s_mov_b32 m0, s25
    s_nop 0
    buffer_load_dwordx4 v1, s[8:11], s24 offen offset:0 sc1 lds
    v_mfma_f32_32x32x16_bf16 v[56:71], v[204:207], v[12:15], v[56:71]
    v_add_u32 v6, s21, v1
    ds_read_b128 v[8:11], v6 offset:0
    s_waitcnt lgkmcnt(6)
    v_mfma_f32_32x32x16_bf16 v[40:55], v[208:211], v[16:19], v[40:55]
    buffer_load_dwordx4 v1, s[8:11], s24 offen offset:1024 sc1 lds
    v_mfma_f32_32x32x16_bf16 v[56:71], v[212:215], v[16:19], v[56:71]
    ds_read_b128 v[12:15], v6 offset:1024
    s_waitcnt lgkmcnt(6)
    v_mfma_f32_32x32x16_bf16 v[40:55], v[216:219], v[20:23], v[40:55]
    buffer_load_dwordx4 v1, s[8:11], s24 offen offset:2048 sc1 lds
    v_mfma_f32_32x32x16_bf16 v[56:71], v[220:223], v[20:23], v[56:71]
    ds_read_b128 v[16:19], v6 offset:2048
    s_waitcnt lgkmcnt(6)
    v_mfma_f32_32x32x16_bf16 v[40:55], v[224:227], v[24:27], v[40:55]
    buffer_load_dwordx4 v1, s[8:11], s24 offen offset:3072 sc1 lds
    v_mfma_f32_32x32x16_bf16 v[56:71], v[228:231], v[24:27], v[56:71]
    ds_read_b128 v[20:23], v6 offset:3072
    s_waitcnt lgkmcnt(6)
    v_mfma_f32_32x32x16_bf16 v[40:55], v[232:235], v[28:31], v[40:55]
    s_add_u32 s24, s24, 4096
    s_add_u32 s25, s25, 4096
    s_mov_b32 m0, s25
    s_nop 0
    buffer_load_dwordx4 v1, s[8:11], s24 offen offset:0 sc1 lds
    v_mfma_f32_32x32x16_bf16 v[56:71], v[236:239], v[28:31], v[56:71]
    ds_read_b128 v[24:27], v6 offset:4096
    s_waitcnt lgkmcnt(6)
    v_mfma_f32_32x32x16_bf16 v[40:55], v[240:243], v[32:35], v[40:55]
    buffer_load_dwordx4 v1, s[8:11], s24 offen offset:1024 sc1 lds
    v_mfma_f32_32x32x16_bf16 v[56:71], v[244:247], v[32:35], v[56:71]
    ds_read_b128 v[28:31], v6 offset:5120
    s_waitcnt lgkmcnt(6)
    v_mfma_f32_32x32x16_bf16 v[40:55], v[248:251], v[36:39], v[40:55]
    v_mfma_f32_32x32x16_bf16 v[56:71], v[252:255], v[36:39], v[56:71]
    v_mov_b32 v2, v6
    s_mov_b32 s16, s21
    s_add_u32 s14, s14, 1
    s_cmp_ge_u32 s14, s15
    s_cbranch_scc1 layerb1_kernel_gk_fin0
    ds_read_b128 v[32:35], v2 offset:6144
    s_waitcnt lgkmcnt(6)
    v_mfma_f32_32x32x16_bf16 v[72:87], a[0:3], v[8:11], 0
    v_mfma_f32_32x32x16_bf16 v[88:103], a[4:7], v[8:11], 0
    ds_read_b128 v[36:39], v2 offset:7168
    s_waitcnt lgkmcnt(6)
    v_mfma_f32_32x32x16_bf16 v[72:87], a[8:11], v[12:15], v[72:87]
    v_mfma_f32_32x32x16_bf16 v[88:103], a[12:15], v[12:15], v[88:103]
    ds_read_b128 v[8:11], v2 offset:8192
    s_waitcnt lgkmcnt(6)
    v_mfma_f32_32x32x16_bf16 v[72:87], a[16:19], v[16:19], v[72:87]
    v_cvt_pk_bf16_f32 v104, v40, v41
    v_mfma_f32_32x32x16_bf16 v[88:103], a[20:23], v[16:19], v[88:103]
    v_cvt_pk_bf16_f32 v105, v42, v43
    ds_read_b128 v[12:15], v2 offset:9216
    s_waitcnt lgkmcnt(6)
    v_mfma_f32_32x32x16_bf16 v[72:87], a[24:27], v[20:23], v[72:87]
    v_cvt_pk_bf16_f32 v106, v44, v45
    v_mfma_f32_32x32x16_bf16 v[88:103], a[28:31], v[20:23], v[88:103]
    v_cvt_pk_bf16_f32 v107, v46, v47
    ds_read_b128 v[16:19], v2 offset:10240
    s_waitcnt lgkmcnt(6)
    v_mfma_f32_32x32x16_bf16 v[72:87], a[32:35], v[24:27], v[72:87]
    s_nop 1
    v_mfma_f32_32x32x16_bf16 v[88:103], a[36:39], v[24:27], v[88:103]
    v_permlane32_swap_b32 v104, v106
    ds_read_b128 v[20:23], v2 offset:11264
    s_waitcnt lgkmcnt(6)
    v_mfma_f32_32x32x16_bf16 v[72:87], a[40:43], v[28:31], v[72:87]
    v_permlane32_swap_b32 v105, v107
    v_mfma_f32_32x32x16_bf16 v[88:103], a[44:47], v[28:31], v[88:103]
    buffer_store_dwordx4 v[104:107], v3, s[8:11], s17 offen offset:0 sc1
    ds_read_b128 v[24:27], v2 offset:12288
    s_waitcnt lgkmcnt(6)
    v_mfma_f32_32x32x16_bf16 v[72:87], a[48:51], v[32:35], v[72:87]
    v_cvt_pk_bf16_f32 v108, v48, v49
    v_mfma_f32_32x32x16_bf16 v[88:103], a[52:55], v[32:35], v[88:103]
    v_cvt_pk_bf16_f32 v109, v50, v51
    ds_read_b128 v[28:31], v2 offset:13312
    s_waitcnt lgkmcnt(6)
    v_mfma_f32_32x32x16_bf16 v[72:87], a[56:59], v[36:39], v[72:87]
    v_cvt_pk_bf16_f32 v110, v52, v53
    v_mfma_f32_32x32x16_bf16 v[88:103], a[60:63], v[36:39], v[88:103]
    v_cvt_pk_bf16_f32 v111, v54, v55
    ds_read_b128 v[32:35], v2 offset:14336
    s_waitcnt lgkmcnt(6)
    v_mfma_f32_32x32x16_bf16 v[72:87], a[64:67], v[8:11], v[72:87]
    s_nop 1
    v_mfma_f32_32x32x16_bf16 v[88:103], a[68:71], v[8:11], v[88:103]
    v_permlane32_swap_b32 v108, v110
    ds_read_b128 v[36:39], v2 offset:15360
    s_waitcnt lgkmcnt(6)
    v_mfma_f32_32x32x16_bf16 v[72:87], a[72:75], v[12:15], v[72:87]
    v_permlane32_swap_b32 v109, v111
    v_mfma_f32_32x32x16_bf16 v[88:103], a[76:79], v[12:15], v[88:103]
    buffer_store_dwordx4 v[108:111], v3, s[8:11], s17 offen offset:1024 sc1
    ds_read_b128 v[8:11], v2 offset:16384
    s_waitcnt lgkmcnt(6)
    v_mfma_f32_32x32x16_bf16 v[72:87], a[80:83], v[16:19], v[72:87]
    v_cvt_pk_bf16_f32 v112, v56, v57
    v_mfma_f32_32x32x16_bf16 v[88:103], a[84:87], v[16:19], v[88:103]
    v_cvt_pk_bf16_f32 v113, v58, v59
    ds_read_b128 v[12:15], v2 offset:17408
    s_waitcnt lgkmcnt(6)
    v_mfma_f32_32x32x16_bf16 v[72:87], a[88:91], v[20:23], v[72:87]
    v_cvt_pk_bf16_f32 v114, v60, v61
    v_mfma_f32_32x32x16_bf16 v[88:103], a[92:95], v[20:23], v[88:103]
    v_cvt_pk_bf16_f32 v115, v62, v63
    ds_read_b128 v[16:19], v2 offset:18432
    s_waitcnt lgkmcnt(6)
    v_mfma_f32_32x32x16_bf16 v[72:87], a[96:99], v[24:27], v[72:87]
    s_nop 1
    v_mfma_f32_32x32x16_bf16 v[88:103], a[100:103], v[24:27], v[88:103]
    v_permlane32_swap_b32 v112, v114
    ds_read_b128 v[20:23], v2 offset:19456
    s_waitcnt lgkmcnt(6)
    v_mfma_f32_32x32x16_bf16 v[72:87], a[104:107], v[28:31], v[72:87]
    v_permlane32_swap_b32 v113, v115
    v_mfma_f32_32x32x16_bf16 v[88:103], a[108:111], v[28:31], v[88:103]
    buffer_store_dwordx4 v[112:115], v3, s[8:11], s18 offen offset:0 sc1
    ds_read_b128 v[24:27], v2 offset:20480
    s_waitcnt lgkmcnt(6)
    v_mfma_f32_32x32x16_bf16 v[72:87], a[112:115], v[32:35], v[72:87]
    v_cvt_pk_bf16_f32 v116, v64, v65
    v_mfma_f32_32x32x16_bf16 v[88:103], a[116:119], v[32:35], v[88:103]
    v_cvt_pk_bf16_f32 v117, v66, v67
    ds_read_b128 v[28:31], v2 offset:21504
    s_waitcnt lgkmcnt(6)
    v_mfma_f32_32x32x16_bf16 v[72:87], a[120:123], v[36:39], v[72:87]
    v_cvt_pk_bf16_f32 v118, v68, v69
    v_mfma_f32_32x32x16_bf16 v[88:103], a[124:127], v[36:39], v[88:103]
    v_cvt_pk_bf16_f32 v119, v70, v71
    ds_read_b128 v[32:35], v2 offset:22528
    s_waitcnt lgkmcnt(6)
    v_mfma_f32_32x32x16_bf16 v[72:87], a[128:131], v[8:11], v[72:87]
    s_nop 1
    v_mfma_f32_32x32x16_bf16 v[88:103], a[132:135], v[8:11], v[88:103]
    v_permlane32_swap_b32 v116, v118
    ds_read_b128 v[36:39], v2 offset:23552
    s_waitcnt lgkmcnt(6)
    v_mfma_f32_32x32x16_bf16 v[72:87], a[136:139], v[12:15], v[72:87]
    v_permlane32_swap_b32 v117, v119
    v_mfma_f32_32x32x16_bf16 v[88:103], a[140:143], v[12:15], v[88:103]
    buffer_store_dwordx4 v[116:119], v3, s[8:11], s18 offen offset:1024 sc1
    ds_read_b128 v[8:11], v2 offset:24576
    s_waitcnt lgkmcnt(6)
    v_mfma_f32_32x32x16_bf16 v[72:87], a[144:147], v[16:19], v[72:87]
    s_add_u32 s17, s17, s20
    v_mfma_f32_32x32x16_bf16 v[88:103], a[148:151], v[16:19], v[88:103]
    s_add_u32 s18, s18, s20
    ds_read_b128 v[12:15], v2 offset:25600
    s_waitcnt lgkmcnt(6)
    v_mfma_f32_32x32x16_bf16 v[72:87], a[152:155], v[20:23], v[72:87]
    v_mfma_f32_32x32x16_bf16 v[88:103], a[156:159], v[20:23], v[88:103]
    ds_read_b128 v[16:19], v2 offset:26624
    s_waitcnt lgkmcnt(6)
    v_mfma_f32_32x32x16_bf16 v[72:87], a[160:163], v[24:27], v[72:87]
    v_mfma_f32_32x32x16_bf16 v[88:103], a[164:167], v[24:27], v[88:103]
    ds_read_b128 v[20:23], v2 offset:27648
    s_waitcnt lgkmcnt(6)
    v_mfma_f32_32x32x16_bf16 v[72:87], a[168:171], v[28:31], v[72:87]
    v_mfma_f32_32x32x16_bf16 v[88:103], a[172:175], v[28:31], v[88:103]
    ds_read_b128 v[24:27], v2 offset:28672
    s_waitcnt lgkmcnt(6)
    v_mfma_f32_32x32x16_bf16 v[72:87], a[176:179], v[32:35], v[72:87]
    v_mfma_f32_32x32x16_bf16 v[88:103], a[180:183], v[32:35], v[88:103]
    ds_read_b128 v[28:31], v2 offset:29696
    s_waitcnt lgkmcnt(6)
    v_mfma_f32_32x32x16_bf16 v[72:87], a[184:187], v[36:39], v[72:87]
    v_mfma_f32_32x32x16_bf16 v[88:103], a[188:191], v[36:39], v[88:103]
    ds_read_b128 v[32:35], v2 offset:30720
    s_waitcnt lgkmcnt(6)
    v_mfma_f32_32x32x16_bf16 v[72:87], a[192:195], v[8:11], v[72:87]
    v_mfma_f32_32x32x16_bf16 v[88:103], a[196:199], v[8:11], v[88:103]
    ds_read_b128 v[36:39], v2 offset:31744
    s_waitcnt lgkmcnt(6)
    v_mfma_f32_32x32x16_bf16 v[72:87], a[200:203], v[12:15], v[72:87]
    v_mfma_f32_32x32x16_bf16 v[88:103], a[204:207], v[12:15], v[88:103]
    ds_read_b128 v[8:11], v2 offset:32768
    s_waitcnt lgkmcnt(6)
    v_mfma_f32_32x32x16_bf16 v[72:87], a[208:211], v[16:19], v[72:87]
    v_mfma_f32_32x32x16_bf16 v[88:103], a[212:215], v[16:19], v[88:103]
    ds_read_b128 v[12:15], v2 offset:33792
    s_waitcnt lgkmcnt(6)
    v_mfma_f32_32x32x16_bf16 v[72:87], a[216:219], v[20:23], v[72:87]
    v_mfma_f32_32x32x16_bf16 v[88:103], a[220:223], v[20:23], v[88:103]
    ds_read_b128 v[16:19], v2 offset:34816
    s_waitcnt lgkmcnt(6)
    v_mfma_f32_32x32x16_bf16 v[72:87], a[224:227], v[24:27], v[72:87]
    v_mfma_f32_32x32x16_bf16 v[88:103], a[228:231], v[24:27], v[88:103]
    s_add_u32 s23, s14, 2
    s_cmp_gt_u32 s14, 12
    s_cbranch_scc1 layerb1_kernel_gk_fa12
    s_waitcnt vmcnt(0)
    s_barrier
    s_cmp_lg_u32 s13, 0
    s_cbranch_scc1 layerb1_kernel_gk_fl13
    s_mov_b64 exec, 1
    s_lshl_b32 s26, s12, 7
    v_mov_b32 v7, s26
    v_mov_b32 v120, s14
    buffer_store_dword v120, v7, s[8:11], s48 offen sc1
    s_mov_b64 exec, -1
layerb1_kernel_gk_fl13:
    s_cmp_lg_u32 s13, 0
    s_cbranch_scc1 layerb1_kernel_gk_lw14
    s_min_u32 s28, s23, 63
    s_cmp_gt_u32 s56, s28
    s_cbranch_scc1 layerb1_kernel_gk_lw14
layerb1_kernel_gk_lp14:
    buffer_load_dwordx4 v[124:127], v1, s[8:11], s57 offen sc1
    s_waitcnt vmcnt(0)
    v_min_u32 v124, v124, v125
    v_min_u32 v126, v126, v127
    v_min_u32 v124, v124, v126
    v_cmp_eq_u32 vcc, 0, v124
    s_nop 1
    s_ff1_i32_b64 s56, vcc
    s_min_u32 s56, s56, 64
    s_sub_u32 s58, s58, 1
    s_cbranch_scc1 layerb1_kernel_bail
    s_cmp_gt_u32 s56, s28
    s_cbranch_scc0 layerb1_kernel_gk_lp14
layerb1_kernel_gk_lw14:
    s_barrier
    s_branch layerb1_kernel_gk_fb12
layerb1_kernel_gk_fa12:
    s_cmp_lg_u32 s13, 0
    s_cbranch_scc1 layerb1_kernel_gk_lw15
    s_min_u32 s28, s23, 63
    s_cmp_gt_u32 s56, s28
    s_cbranch_scc1 layerb1_kernel_gk_lw15
layerb1_kernel_gk_lp15:
    buffer_load_dwordx4 v[124:127], v1, s[8:11], s57 offen sc1
    s_waitcnt vmcnt(0)
    v_min_u32 v124, v124, v125
    v_min_u32 v126, v126, v127
    v_min_u32 v124, v124, v126
    v_cmp_eq_u32 vcc, 0, v124
    s_nop 1
    s_ff1_i32_b64 s56, vcc
    s_min_u32 s56, s56, 64
    s_sub_u32 s58, s58, 1
    s_cbranch_scc1 layerb1_kernel_bail
    s_cmp_gt_u32 s56, s28
    s_cbranch_scc0 layerb1_kernel_gk_lp15
layerb1_kernel_gk_lw15:
    s_waitcnt vmcnt(4)
    s_sub_u32 s27, s14, 1
    s_barrier
    s_cmp_lg_u32 s13, 0
    s_cbranch_scc1 layerb1_kernel_gk_fl16
    s_mov_b64 exec, 1
    s_lshl_b32 s26, s12, 7
    v_mov_b32 v7, s26
    v_mov_b32 v120, s27
    buffer_store_dword v120, v7, s[8:11], s48 offen sc1
    s_mov_b64 exec, -1
layerb1_kernel_gk_fl16:
layerb1_kernel_gk_fb12:
    s_add_u32 s21, s16, 40960
    s_cmp_eq_u32 s21, 122880
    s_cselect_b32 s21, 0, s21
    s_add_u32 s23, s14, 2
    s_min_u32 s24, s23, 63
    s_mul_i32 s24, s24, 40960
    s_add_u32 s24, s24, s19
    s_mul_i32 s25, s13, 10240
    s_add_u32 s25, s25, s22
    s_add_u32 s22, s22, 40960
    s_cmp_eq_u32 s22, 122880
    s_cselect_b32 s22, 0, s22
    ds_read_b128 v[20:23], v2 offset:35840
    s_waitcnt lgkmcnt(6)
    v_mfma_f32_32x32x16_bf16 v[72:87], a[232:235], v[28:31], v[72:87]
    s_mov_b32 m0, s25
    s_nop 0
    buffer_load_dwordx4 v1, s[8:11], s24 offen offset:0 sc1 lds
    v_mfma_f32_32x32x16_bf16 v[88:103], a[236:239], v[28:31], v[88:103]
    ds_read_b128 v[24:27], v2 offset:36864
    s_waitcnt lgkmcnt(6)
    v_mfma_f32_32x32x16_bf16 v[72:87], a[240:243], v[32:35], v[72:87]
    buffer_load_dwordx4 v1, s[8:11], s24 offen offset:1024 sc1 lds
    v_mfma_f32_32x32x16_bf16 v[88:103], a[244:247], v[32:35], v[88:103]
    ds_read_b128 v[28:31], v2 offset:37888
    s_waitcnt lgkmcnt(6)
    v_mfma_f32_32x32x16_bf16 v[72:87], a[248:251], v[36:39], v[72:87]
    buffer_load_dwordx4 v1, s[8:11], s24 offen offset:2048 sc1 lds
    v_mfma_f32_32x32x16_bf16 v[88:103], a[252:255], v[36:39], v[88:103]
    ds_read_b128 v[32:35], v2 offset:38912
    s_waitcnt lgkmcnt(6)
    v_mfma_f32_32x32x16_bf16 v[72:87], v[192:195], v[8:11], v[72:87]
    buffer_load_dwordx4 v1, s[8:11], s24 offen offset:3072 sc1 lds
    v_mfma_f32_32x32x16_bf16 v[88:103], v[196:199], v[8:11], v[88:103]
    ds_read_b128 v[36:39], v2 offset:39936
    s_waitcnt lgkmcnt(6)
    v_mfma_f32_32x32x16_bf16 v[72:87], v[200:203], v[12:15], v[72:87]
    s_add_u32 s24, s24, 4096
    s_add_u32 s25, s25, 4096
    s_mov_b32 m0, s25
    s_nop 0
    buffer_load_dwordx4 v1, s[8:11], s24 offen offset:0 sc1 lds
    v_mfma_f32_32x32x16_bf16 v[88:103], v[204:207], v[12:15], v[88:103]
    v_add_u32 v6, s21, v1
    ds_read_b128 v[8:11], v6 offset:0
    s_waitcnt lgkmcnt(6)
    v_mfma_f32_32x32x16_bf16 v[72:87], v[208:211], v[16:19], v[72:87]
    buffer_load_dwordx4 v1, s[8:11], s24 offen offset:1024 sc1 lds
    v_mfma_f32_32x32x16_bf16 v[88:103], v[212:215], v[16:19], v[88:103]
    ds_read_b128 v[12:15], v6 offset:1024
    s_waitcnt lgkmcnt(6)
    v_mfma_f32_32x32x16_bf16 v[72:87], v[216:219], v[20:23], v[72:87]
    buffer_load_dwordx4 v1, s[8:11], s24 offen offset:2048 sc1 lds
    v_mfma_f32_32x32x16_bf16 v[88:103], v[220:223], v[20:23], v[88:103]
    ds_read_b128 v[16:19], v6 offset:2048
    s_waitcnt lgkmcnt(6)
    v_mfma_f32_32x32x16_bf16 v[72:87], v[224:227], v[24:27], v[72:87]
    buffer_load_dwordx4 v1, s[8:11], s24 offen offset:3072 sc1 lds
    v_mfma_f32_32x32x16_bf16 v[88:103], v[228:231], v[24:27], v[88:103]
    ds_read_b128 v[20:23], v6 offset:3072
    s_waitcnt lgkmcnt(6)
    v_mfma_f32_32x32x16_bf16 v[72:87], v[232:235], v[28:31], v[72:87]
    s_add_u32 s24, s24, 4096
    s_add_u32 s25, s25, 4096
    s_mov_b32 m0, s25
    s_nop 0
    buffer_load_dwordx4 v1, s[8:11], s24 offen offset:0 sc1 lds
    v_mfma_f32_32x32x16_bf16 v[88:103], v[236:239], v[28:31], v[88:103]
    ds_read_b128 v[24:27], v6 offset:4096
    s_waitcnt lgkmcnt(6)
    v_mfma_f32_32x32x16_bf16 v[72:87], v[240:243], v[32:35], v[72:87]
    buffer_load_dwordx4 v1, s[8:11], s24 offen offset:1024 sc1 lds
    v_mfma_f32_32x32x16_bf16 v[88:103], v[244:247], v[32:35], v[88:103]
    ds_read_b128 v[28:31], v6 offset:5120
    s_waitcnt lgkmcnt(6)
    v_mfma_f32_32x32x16_bf16 v[72:87], v[248:251], v[36:39], v[72:87]
    v_mfma_f32_32x32x16_bf16 v[88:103], v[252:255], v[36:39], v[88:103]
    v_mov_b32 v2, v6
    s_mov_b32 s16, s21
    s_add_u32 s14, s14, 1
    s_cmp_lt_u32 s14, s15
    s_cbranch_scc1 layerb1_kernel_gk_loop
    s_branch layerb1_kernel_gk_fin1
layerb1_kernel_gk_fin0:
    s_nop 7
    s_nop 7
    v_cvt_pk_bf16_f32 v104, v40, v41
    v_cvt_pk_bf16_f32 v105, v42, v43
    v_cvt_pk_bf16_f32 v106, v44, v45
    v_cvt_pk_bf16_f32 v107, v46, v47
    s_nop 1
    v_permlane32_swap_b32 v104, v106
    v_permlane32_swap_b32 v105, v107
    buffer_store_dwordx4 v[104:107], v3, s[8:11], s17 offen offset:0 sc1
    v_cvt_pk_bf16_f32 v108, v48, v49
    v_cvt_pk_bf16_f32 v109, v50, v51
    v_cvt_pk_bf16_f32 v110, v52, v53
    v_cvt_pk_bf16_f32 v111, v54, v55
    s_nop 1
    v_permlane32_swap_b32 v108, v110
    v_permlane32_swap_b32 v109, v111
    buffer_store_dwordx4 v[108:111], v3, s[8:11], s17 offen offset:1024 sc1
    v_cvt_pk_bf16_f32 v112, v56, v57
    v_cvt_pk_bf16_f32 v113, v58, v59
    v_cvt_pk_bf16_f32 v114, v60, v61
    v_cvt_pk_bf16_f32 v115, v62, v63
    s_nop 1
    v_permlane32_swap_b32 v112, v114
    v_permlane32_swap_b32 v113, v115
    buffer_store_dwordx4 v[112:115], v3, s[8:11], s18 offen offset:0 sc1
    v_cvt_pk_bf16_f32 v116, v64, v65
    v_cvt_pk_bf16_f32 v117, v66, v67
    v_cvt_pk_bf16_f32 v118, v68, v69
    v_cvt_pk_bf16_f32 v119, v70, v71
    s_nop 1
    v_permlane32_swap_b32 v116, v118
    v_permlane32_swap_b32 v117, v119
    buffer_store_dwordx4 v[116:119], v3, s[8:11], s18 offen offset:1024 sc1
    s_add_u32 s17, s17, s20
    s_add_u32 s18, s18, s20
    s_branch layerb1_kernel_gk_done
layerb1_kernel_gk_fin1:
    s_nop 7
    s_nop 7
    v_cvt_pk_bf16_f32 v104, v72, v73
    v_cvt_pk_bf16_f32 v105, v74, v75
    v_cvt_pk_bf16_f32 v106, v76, v77
    v_cvt_pk_bf16_f32 v107, v78, v79
    s_nop 1
    v_permlane32_swap_b32 v104, v106
    v_permlane32_swap_b32 v105, v107
    buffer_store_dwordx4 v[104:107], v3, s[8:11], s17 offen offset:0 sc1
    v_cvt_pk_bf16_f32 v108, v80, v81
    v_cvt_pk_bf16_f32 v109, v82, v83
    v_cvt_pk_bf16_f32 v110, v84, v85
    v_cvt_pk_bf16_f32 v111, v86, v87
    s_nop 1
    v_permlane32_swap_b32 v108, v110
    v_permlane32_swap_b32 v109, v111
    buffer_store_dwordx4 v[108:111], v3, s[8:11], s17 offen offset:1024 sc1
    v_cvt_pk_bf16_f32 v112, v88, v89
    v_cvt_pk_bf16_f32 v113, v90, v91
    v_cvt_pk_bf16_f32 v114, v92, v93
    v_cvt_pk_bf16_f32 v115, v94, v95
    s_nop 1
    v_permlane32_swap_b32 v112, v114
    v_permlane32_swap_b32 v113, v115
    buffer_store_dwordx4 v[112:115], v3, s[8:11], s18 offen offset:0 sc1
    v_cvt_pk_bf16_f32 v116, v96, v97
    v_cvt_pk_bf16_f32 v117, v98, v99
    v_cvt_pk_bf16_f32 v118, v100, v101
    v_cvt_pk_bf16_f32 v119, v102, v103
    s_nop 1
    v_permlane32_swap_b32 v116, v118
    v_permlane32_swap_b32 v117, v119
    buffer_store_dwordx4 v[116:119], v3, s[8:11], s18 offen offset:1024 sc1
    s_add_u32 s17, s17, s20
    s_add_u32 s18, s18, s20
layerb1_kernel_gk_done:
    s_waitcnt vmcnt(0) lgkmcnt(0)
    s_barrier
    s_cmp_lg_u32 s13, 0
    s_cbranch_scc1 layerb1_kernel_gk_fl17
    s_mov_b64 exec, 1
    s_lshl_b32 s26, s12, 7
    v_mov_b32 v7, s26
    v_mov_b32 v120, s14
    buffer_store_dword v120, v7, s[8:11], s48 offen sc1
    s_mov_b64 exec, -1
layerb1_kernel_gk_fl17:
layerb1_kernel_g_done:
    s_branch layerb1_kernel_w3
layerb1_kernel_spare:
    s_sub_u32 s22, s20, 1
    s_mul_i32 s22, s22, 5
    s_add_u32 s22, s22, s21
    s_sub_u32 s22, s22, 27
    s_cmp_ge_u32 s21, 27
    s_cselect_b32 s22, s22, 15
    s_cmp_lt_u32 s22, 5
    s_cbranch_scc1 layerb1_kernel_sp_ab
    s_cmp_lt_u32 s22, 9
    s_cbranch_scc1 layerb1_kernel_sp_ln
    s_cmp_eq_u32 s22, 10
    s_cbranch_scc0 layerb1_kernel_sp_n10
    s_cmp_lg_u32 s13, 0
    s_cbranch_scc1 layerb1_kernel_cal1x
    s_add_u32 s24, s17, 2086912
    s_getreg_b32 s25, hwreg(HW_REG_XCC_ID)
    s_bfe_u32 s25, s25, 0x10002
    s_mov_b64 exec, 1
    v_mov_b32 v1, 0
    v_mov_b32 v2, 0
    s_mov_b32 s30, -1
    s_mov_b32 s31, -1
    s_mov_b32 s26, 8
    s_waitcnt vmcnt(0)
layerb1_kernel_cal1:
    s_and_b32 s27, s26, 15
    s_lshl_b32 s27, s27, 7
    s_add_u32 s27, s27, s24
    s_memtime s[28:29]
    s_waitcnt lgkmcnt(0)
    buffer_atomic_add v2, v1, s[8:11], s27 offen sc0 sc1
    s_waitcnt vmcnt(0)
    s_memtime s[32:33]
    v_mov_b32 v2, 0
    s_waitcnt lgkmcnt(0)
    s_sub_u32 s28, s32, s28
    s_min_u32 s30, s30, s28
    s_and_b32 s27, s26, 15
    s_lshl_b32 s27, s27, 7
    s_add_u32 s27, s27, s24
    s_add_u32 s27, s27, 8192
    s_memtime s[28:29]
    s_waitcnt lgkmcnt(0)
    buffer_atomic_add v2, v1, s[8:11], s27 offen sc0 sc1
    s_waitcnt vmcnt(0)
    s_memtime s[32:33]
    v_mov_b32 v2, 0
    s_waitcnt lgkmcnt(0)
    s_sub_u32 s28, s32, s28
    s_min_u32 s31, s31, s28
    s_sub_u32 s26, s26, 1
    s_cmp_lg_u32 s26, 0
    s_cbranch_scc1 layerb1_kernel_cal1
    s_cmp_lt_u32 s31, s30
    s_cselect_b32 s27, 1, 0
    s_xor_b32 s27, s27, s25
    s_lshl_b32 s27, s27, 13
    s_or_b32 s27, s27, 1
    v_mov_b32 v3, s27
    s_add_u32 s27, s48, 51204
    buffer_store_dword v3, v1, s[8:11], s27 offen sc1
    s_lshl_b32 s28, s30, 16
    s_or_b32 s28, s28, s31
    v_mov_b32 v3, s28
    buffer_store_dword v3, v1, s[8:11], s27 offen offset:8 sc1
    s_mov_b64 exec, -1
    s_waitcnt vmcnt(0)
layerb1_kernel_cal1x:
    s_barrier
    s_branch layerb1_kernel_w3
layerb1_kernel_sp_n10:
    s_cmp_eq_u32 s22, 9
    s_cbranch_scc0 layerb1_kernel_w3
    s_cmp_lg_u32 s13, 0
    s_cbranch_scc1 layerb1_kernel_cal0x
    s_add_u32 s24, s16, 2086912
    s_getreg_b32 s25, hwreg(HW_REG_XCC_ID)
    s_bfe_u32 s25, s25, 0x10002
    s_mov_b64 exec, 1
    v_mov_b32 v1, 0
    v_mov_b32 v2, 0
    s_mov_b32 s30, -1
    s_mov_b32 s31, -1
    s_mov_b32 s26, 8
    s_waitcnt vmcnt(0)
layerb1_kernel_cal0:
    s_and_b32 s27, s26, 15
    s_lshl_b32 s27, s27, 7
    s_add_u32 s27, s27, s24
    s_memtime s[28:29]
    s_waitcnt lgkmcnt(0)
    buffer_atomic_add v2, v1, s[8:11], s27 offen sc0 sc1
    s_waitcnt vmcnt(0)
    s_memtime s[32:33]
    v_mov_b32 v2, 0
    s_waitcnt lgkmcnt(0)
    s_sub_u32 s28, s32, s28
    s_min_u32 s30, s30, s28
    s_and_b32 s27, s26, 15
    s_lshl_b32 s27, s27, 7
    s_add_u32 s27, s27, s24
    s_add_u32 s27, s27, 8192
    s_memtime s[28:29]
    s_waitcnt lgkmcnt(0)
    buffer_atomic_add v2, v1, s[8:11], s27 offen sc0 sc1
    s_waitcnt vmcnt(0)
    s_memtime s[32:33]
    v_mov_b32 v2, 0
    s_waitcnt lgkmcnt(0)
    s_sub_u32 s28, s32, s28
    s_min_u32 s31, s31, s28
    s_sub_u32 s26, s26, 1
    s_cmp_lg_u32 s26, 0
    s_cbranch_scc1 layerb1_kernel_cal0
    s_cmp_lt_u32 s31, s30
    s_cselect_b32 s27, 1, 0
    s_xor_b32 s27, s27, s25
    s_lshl_b32 s27, s27, 13
    s_or_b32 s27, s27, 1
    v_mov_b32 v3, s27
    s_add_u32 s27, s48, 51200
    buffer_store_dword v3, v1, s[8:11], s27 offen sc1
    s_lshl_b32 s28, s30, 16
    s_or_b32 s28, s28, s31
    v_mov_b32 v3, s28
    buffer_store_dword v3, v1, s[8:11], s27 offen offset:8 sc1
    s_mov_b64 exec, -1
    s_waitcnt vmcnt(0)
layerb1_kernel_cal0x:
    s_barrier
    s_add_u32 s20, s48, 51200
    s_mov_b64 exec, 3
    v_lshlrev_b32 v16, 2, v0
layerb1_kernel_m0_par:
    buffer_load_dword v17, v16, s[8:11], s20 offen sc1
    s_waitcnt vmcnt(0)
    v_cmp_eq_u32 vcc, 0, v17
    s_sub_u32 s15, s15, 1
    s_cbranch_scc1 layerb1_kernel_bail
    s_cbranch_vccnz layerb1_kernel_m0_par
    s_mov_b64 exec, -1
    v_readlane_b32 s20, v17, 0
    v_readlane_b32 s21, v17, 1
    s_nop 0
    s_and_b32 s20, s20, 8192
    s_and_b32 s21, s21, 8192
    s_add_u32 s16, s16, s20
    s_add_u32 s17, s17, s21
    s_load_dwordx2 s[24:25], s[0:1], 32
    s_lshl_b32 s26, s13, 6
    v_add_u32 v1, s26, v0
    s_waitcnt lgkmcnt(0)
    s_mov_b32 s28, s24
    s_mov_b32 s29, s25
    s_mov_b32 s30, 10240
    s_mov_b32 s31, 0x00020000
    v_add_u32 v2, 0, v1
    v_and_b32 v3, 7, v2
    v_mul_u32_u24 v3, 1280, v3
    v_lshrrev_b32 v4, 3, v2
    v_lshl_add_u32 v3, v4, 4, v3
    v_lshlrev_b32 v5, 4, v2
    v_add_u32 v5, 20480, v5
    v_lshrrev_b32 v6, 13, v5
    v_lshlrev_b32 v6, 14, v6
    v_and_b32 v5, 8191, v5
    v_add_u32 v5, v5, v6
    v_cmp_gt_u32 vcc, 640, v2
    s_and_saveexec_b64 s[32:33], vcc
    s_cbranch_execz layerb1_kernel_m0s0
    buffer_load_dwordx4 v[8:11], v3, s[28:31], 0 offen
    s_waitcnt vmcnt(0)
    buffer_store_dwordx4 v[8:11], v5, s[8:11], s16 offen sc1
layerb1_kernel_m0s0:
    s_mov_b64 exec, s[32:33]
    v_add_u32 v2, 256, v1
    v_and_b32 v3, 7, v2
    v_mul_u32_u24 v3, 1280, v3
    v_lshrrev_b32 v4, 3, v2
    v_lshl_add_u32 v3, v4, 4, v3
    v_lshlrev_b32 v5, 4, v2
    v_add_u32 v5, 20480, v5
    v_lshrrev_b32 v6, 13, v5
    v_lshlrev_b32 v6, 14, v6
    v_and_b32 v5, 8191, v5
    v_add_u32 v5, v5, v6
    v_cmp_gt_u32 vcc, 640, v2
    s_and_saveexec_b64 s[32:33], vcc
    s_cbranch_execz layerb1_kernel_m0s1
    buffer_load_dwordx4 v[8:11], v3, s[28:31], 0 offen
    s_waitcnt vmcnt(0)
    buffer_store_dwordx4 v[8:11], v5, s[8:11], s16 offen sc1
layerb1_kernel_m0s1:
    s_mov_b64 exec, s[32:33]
    v_add_u32 v2, 512, v1
    v_and_b32 v3, 7, v2
    v_mul_u32_u24 v3, 1280, v3
    v_lshrrev_b32 v4, 3, v2
    v_lshl_add_u32 v3, v4, 4, v3
    v_lshlrev_b32 v5, 4, v2
    v_add_u32 v5, 20480, v5
    v_lshrrev_b32 v6, 13, v5
    v_lshlrev_b32 v6, 14, v6
    v_and_b32 v5, 8191, v5
    v_add_u32 v5, v5, v6
    v_cmp_gt_u32 vcc, 640, v2
    s_and_saveexec_b64 s[32:33], vcc
    s_cbranch_execz layerb1_kernel_m0s2
    buffer_load_dwordx4 v[8:11], v3, s[28:31], 0 offen
    s_waitcnt vmcnt(0)
    buffer_store_dwordx4 v[8:11], v5, s[8:11], s16 offen sc1
layerb1_kernel_m0s2:
    s_mov_b64 exec, s[32:33]
    s_waitcnt vmcnt(0)
    s_branch layerb1_kernel_w3
layerb1_kernel_sp_ab:
    s_mov_b32 s12, s22
    s_mov_b32 s14, 0
    s_mov_b32 s15, 64
    s_load_dwordx2 s[52:53], s[0:1], 0
    v_lshlrev_b32 v1, 4, v0
    s_lshl_b32 s21, s12, 2
    s_add_u32 s21, s21, s13
    s_add_u32 s24, s4, 247463936
    s_addc_u32 s25, s5, 0
    s_waitcnt lgkmcnt(0)
    s_cmp_eq_u32 s49, 0
    s_cselect_b32 s52, s52, s24
    s_cselect_b32 s53, s53, s25
    s_mov_b32 s54, 2621440
    s_mov_b32 s55, 0x00020000
    v_and_b32 v6, 31, v0
    v_lshrrev_b32 v7, 5, v0
    v_mul_u32_u24 v6, 1280, v6
    v_lshl_add_u32 v3, v7, 4, v6
    s_mul_i32 s19, s14, 40960
    s_lshl_b32 s24, s21, 6
    s_add_u32 s19, s19, s24
    s_lshl_b32 s20, s14, 7
    s_lshl_b32 s24, s21, 2
    s_add_u32 s20, s20, s24
    s_add_u32 s20, s20, 36864
    v_mov_b32 v5, 1
    v_mov_b32 v4, 0
    s_mul_i32 s18, s13, 10240
    s_add_u32 s18, s18, 229638144
    s_mov_b32 s17, 0
    buffer_load_dwordx4 v[96:99], v3, s[52:55], s19 offen offset:0
    buffer_load_dwordx4 v[100:103], v3, s[52:55], s19 offen offset:32
    s_mul_i32 s24, s21, 40960
    s_add_u32 s24, s24, 246415360
    s_add_u32 s24, s24, 4096
    s_add_u32 s24, s24, 4096
    s_add_u32 s24, s24, 4096
    s_add_u32 s24, s24, 4096
    s_add_u32 s24, s24, 4096
    s_add_u32 s24, s24, 4096
    s_add_u32 s24, s24, 4096
    s_add_u32 s24, s24, 4096
    s_add_u32 s24, s24, 4096
    s_mov_b32 s22, 0
    s_mov_b32 s30, 400000
    s_add_u32 s29, s48, 49152
    v_lshlrev_b32 v112, 3, v0
    s_cmp_lg_u32 s13, 0
    s_cbranch_scc1 layerb1_kernel_ab_ow1
    s_min_u32 s28, s14, 63
    s_cmp_gt_u32 s22, s28
    s_cbranch_scc1 layerb1_kernel_ab_ow1
layerb1_kernel_ab_op1:
    buffer_load_dwordx4 v[116:119], v1, s[8:11], s29 offen sc1
    s_waitcnt vmcnt(0)
    v_min_u32 v116, v116, v117
    v_min_u32 v118, v118, v119
    v_min_u32 v114, v116, v118
    v_cmp_eq_u32 vcc, 0, v114
    s_nop 1
    s_ff1_i32_b64 s22, vcc
    s_min_u32 s22, s22, 64
    s_and_b32 s22, s22, 0x7c
    s_sub_u32 s30, s30, 1
    s_cbranch_scc1 layerb1_kernel_bail
    s_cmp_gt_u32 s22, s28
    s_cbranch_scc0 layerb1_kernel_ab_op1
layerb1_kernel_ab_ow1:
    s_barrier
    s_min_u32 s24, s14, 63
    s_mul_i32 s24, s24, 40960
    s_add_u32 s24, s24, s18
    s_mul_i32 s25, s13, 10240
    s_add_u32 s25, s25, s17
    s_mov_b32 m0, s25
    s_nop 0
    buffer_load_dwordx4 v1, s[8:11], s24 offen offset:0 sc1 lds
    buffer_load_dwordx4 v1, s[8:11], s24 offen offset:1024 sc1 lds
    buffer_load_dwordx4 v1, s[8:11], s24 offen offset:2048 sc1 lds
    buffer_load_dwordx4 v1, s[8:11], s24 offen offset:3072 sc1 lds
    s_add_u32 s24, s24, 4096
    s_add_u32 s25, s25, 4096
    s_mov_b32 m0, s25
    s_nop 0
    buffer_load_dwordx4 v1, s[8:11], s24 offen offset:0 sc1 lds
    buffer_load_dwordx4 v1, s[8:11], s24 offen offset:1024 sc1 lds
    buffer_load_dwordx4 v1, s[8:11], s24 offen offset:2048 sc1 lds
    buffer_load_dwordx4 v1, s[8:11], s24 offen offset:3072 sc1 lds
    s_add_u32 s24, s24, 4096
    s_add_u32 s25, s25, 4096
    s_mov_b32 m0, s25
    s_nop 0
    buffer_load_dwordx4 v1, s[8:11], s24 offen offset:0 sc1 lds
    buffer_load_dwordx4 v1, s[8:11], s24 offen offset:1024 sc1 lds
    s_mov_b32 s17, 40960
    s_add_u32 s23, s14, 1
    s_cmp_lg_u32 s13, 0
    s_cbranch_scc1 layerb1_kernel_ab_ow2
    s_min_u32 s28, s23, 63
    s_cmp_gt_u32 s22, s28
    s_cbranch_scc1 layerb1_kernel_ab_ow2
layerb1_kernel_ab_op2:
    buffer_load_dwordx4 v[116:119], v1, s[8:11], s29 offen sc1
    s_waitcnt vmcnt(0)
    v_min_u32 v116, v116, v117
    v_min_u32 v118, v118, v119
    v_min_u32 v114, v116, v118
    v_cmp_eq_u32 vcc, 0, v114
    s_nop 1
    s_ff1_i32_b64 s22, vcc
    s_min_u32 s22, s22, 64
    s_and_b32 s22, s22, 0x7c
    s_sub_u32 s30, s30, 1
    s_cbranch_scc1 layerb1_kernel_bail
    s_cmp_gt_u32 s22, s28
    s_cbranch_scc0 layerb1_kernel_ab_op2
layerb1_kernel_ab_ow2:
    s_barrier
    s_min_u32 s24, s23, 63
    s_mul_i32 s24, s24, 40960
    s_add_u32 s24, s24, s18
    s_mul_i32 s25, s13, 10240
    s_add_u32 s25, s25, s17
    s_mov_b32 m0, s25
    s_nop 0
    buffer_load_dwordx4 v1, s[8:11], s24 offen offset:0 sc1 lds
    buffer_load_dwordx4 v1, s[8:11], s24 offen offset:1024 sc1 lds
    buffer_load_dwordx4 v1, s[8:11], s24 offen offset:2048 sc1 lds
    buffer_load_dwordx4 v1, s[8:11], s24 offen offset:3072 sc1 lds
    s_add_u32 s24, s24, 4096
    s_add_u32 s25, s25, 4096
    s_mov_b32 m0, s25
    s_nop 0
    buffer_load_dwordx4 v1, s[8:11], s24 offen offset:0 sc1 lds
    buffer_load_dwordx4 v1, s[8:11], s24 offen offset:1024 sc1 lds
    buffer_load_dwordx4 v1, s[8:11], s24 offen offset:2048 sc1 lds
    buffer_load_dwordx4 v1, s[8:11], s24 offen offset:3072 sc1 lds
    s_add_u32 s24, s24, 4096
    s_add_u32 s25, s25, 4096
    s_mov_b32 m0, s25
    s_nop 0
    buffer_load_dwordx4 v1, s[8:11], s24 offen offset:0 sc1 lds
    buffer_load_dwordx4 v1, s[8:11], s24 offen offset:1024 sc1 lds
    s_mov_b32 s17, 81920
    s_mov_b32 s16, 0
    s_waitcnt vmcnt(10)
    s_add_u32 s23, s14, 2
    s_cmp_lg_u32 s13, 0
    s_cbranch_scc1 layerb1_kernel_ab_ow3
    s_min_u32 s28, s23, 63
    s_cmp_gt_u32 s22, s28
    s_cbranch_scc1 layerb1_kernel_ab_ow3
layerb1_kernel_ab_op3:
    buffer_load_dwordx4 v[116:119], v1, s[8:11], s29 offen sc1
    s_waitcnt vmcnt(0)
    v_min_u32 v116, v116, v117
    v_min_u32 v118, v118, v119
    v_min_u32 v114, v116, v118
    v_cmp_eq_u32 vcc, 0, v114
    s_nop 1
    s_ff1_i32_b64 s22, vcc
    s_min_u32 s22, s22, 64
    s_and_b32 s22, s22, 0x7c
    s_sub_u32 s30, s30, 1
    s_cbranch_scc1 layerb1_kernel_bail
    s_cmp_gt_u32 s22, s28
    s_cbranch_scc0 layerb1_kernel_ab_op3
layerb1_kernel_ab_ow3:
    s_barrier
    v_add_u32 v2, s16, v1
    ds_read_b128 v[16:19], v2 offset:0
    ds_read_b128 v[20:23], v2 offset:1024
    ds_read_b128 v[24:27], v2 offset:2048
    ds_read_b128 v[28:31], v2 offset:3072
    ds_read_b128 v[32:35], v2 offset:4096
    ds_read_b128 v[36:39], v2 offset:5120
    s_add_u32 s27, s19, 40960
    s_cmp_ge_u32 s14, 63
    s_cselect_b32 s27, s19, s27
    buffer_load_dwordx4 v[104:107], v3, s[52:55], s27 offen offset:0
    buffer_load_dwordx4 v[108:111], v3, s[52:55], s27 offen offset:32
    s_add_u32 s23, s14, 2
    s_min_u32 s24, s23, 63
    s_mul_i32 s24, s24, 40960
    s_add_u32 s24, s24, s18
    s_mul_i32 s25, s13, 10240
    s_add_u32 s25, s25, s17
    s_add_u32 s17, s17, 40960
    s_cmp_eq_u32 s17, 122880
    s_cselect_b32 s17, 0, s17
    ds_read_b128 v[40:43], v2 offset:6144
    s_waitcnt lgkmcnt(6)
    v_mfma_f32_32x32x16_bf16 v[48:63], a[0:3], v[16:19], 0
    ds_read_b128 v[44:47], v2 offset:7168
    s_waitcnt lgkmcnt(6)
    v_mfma_f32_32x32x16_bf16 v[64:79], a[4:7], v[20:23], 0
    s_mov_b32 m0, s25
    s_nop 0
    buffer_load_dwordx4 v1, s[8:11], s24 offen offset:0 sc1 lds
    ds_read_b128 v[16:19], v2 offset:8192
    s_waitcnt lgkmcnt(6)
    v_mfma_f32_32x32x16_bf16 v[48:63], a[8:11], v[24:27], v[48:63]
    ds_read_b128 v[20:23], v2 offset:9216
    s_waitcnt lgkmcnt(6)
    v_mfma_f32_32x32x16_bf16 v[64:79], a[12:15], v[28:31], v[64:79]
    ds_read_b128 v[24:27], v2 offset:10240
    s_waitcnt lgkmcnt(6)
    v_mfma_f32_32x32x16_bf16 v[48:63], a[16:19], v[32:35], v[48:63]
    buffer_load_dwordx4 v1, s[8:11], s24 offen offset:1024 sc1 lds
    ds_read_b128 v[28:31], v2 offset:11264
    s_waitcnt lgkmcnt(6)
    v_mfma_f32_32x32x16_bf16 v[64:79], a[20:23], v[36:39], v[64:79]
    ds_read_b128 v[32:35], v2 offset:12288
    s_waitcnt lgkmcnt(6)
    v_mfma_f32_32x32x16_bf16 v[48:63], a[24:27], v[40:43], v[48:63]
    ds_read_b128 v[36:39], v2 offset:13312
    s_waitcnt lgkmcnt(6)
    v_mfma_f32_32x32x16_bf16 v[64:79], a[28:31], v[44:47], v[64:79]
    buffer_load_dwordx4 v1, s[8:11], s24 offen offset:2048 sc1 lds
    ds_read_b128 v[40:43], v2 offset:14336
    s_waitcnt lgkmcnt(6)
    v_mfma_f32_32x32x16_bf16 v[48:63], a[32:35], v[16:19], v[48:63]
    ds_read_b128 v[44:47], v2 offset:15360
    s_waitcnt lgkmcnt(6)
    v_mfma_f32_32x32x16_bf16 v[64:79], a[36:39], v[20:23], v[64:79]
    ds_read_b128 v[16:19], v2 offset:16384
    s_waitcnt lgkmcnt(6)
    v_mfma_f32_32x32x16_bf16 v[48:63], a[40:43], v[24:27], v[48:63]
    buffer_load_dwordx4 v1, s[8:11], s24 offen offset:3072 sc1 lds
    ds_read_b128 v[20:23], v2 offset:17408
    s_waitcnt lgkmcnt(6)
    v_mfma_f32_32x32x16_bf16 v[64:79], a[44:47], v[28:31], v[64:79]
    ds_read_b128 v[24:27], v2 offset:18432
    s_waitcnt lgkmcnt(6)
    v_mfma_f32_32x32x16_bf16 v[48:63], a[48:51], v[32:35], v[48:63]
    ds_read_b128 v[28:31], v2 offset:19456
    s_waitcnt lgkmcnt(6)
    v_mfma_f32_32x32x16_bf16 v[64:79], a[52:55], v[36:39], v[64:79]
    s_add_u32 s24, s24, 4096
    s_add_u32 s25, s25, 4096
    s_mov_b32 m0, s25
    s_nop 0
    buffer_load_dwordx4 v1, s[8:11], s24 offen offset:0 sc1 lds
    ds_read_b128 v[32:35], v2 offset:20480
    s_waitcnt lgkmcnt(6)
    v_mfma_f32_32x32x16_bf16 v[48:63], a[56:59], v[40:43], v[48:63]
    ds_read_b128 v[36:39], v2 offset:21504
    s_waitcnt lgkmcnt(6)
    v_mfma_f32_32x32x16_bf16 v[64:79], a[60:63], v[44:47], v[64:79]
    ds_read_b128 v[40:43], v2 offset:22528
    s_waitcnt lgkmcnt(6)
    v_mfma_f32_32x32x16_bf16 v[48:63], a[64:67], v[16:19], v[48:63]
    buffer_load_dwordx4 v1, s[8:11], s24 offen offset:1024 sc1 lds
    ds_read_b128 v[44:47], v2 offset:23552
    s_waitcnt lgkmcnt(6)
    v_mfma_f32_32x32x16_bf16 v[64:79], a[68:71], v[20:23], v[64:79]
    ds_read_b128 v[16:19], v2 offset:24576
    s_waitcnt lgkmcnt(6)
    v_mfma_f32_32x32x16_bf16 v[48:63], a[72:75], v[24:27], v[48:63]
    ds_read_b128 v[20:23], v2 offset:25600
    s_waitcnt lgkmcnt(6)
    v_mfma_f32_32x32x16_bf16 v[64:79], a[76:79], v[28:31], v[64:79]
    buffer_load_dwordx4 v1, s[8:11], s24 offen offset:2048 sc1 lds
    ds_read_b128 v[24:27], v2 offset:26624
    s_waitcnt lgkmcnt(6)
    v_mfma_f32_32x32x16_bf16 v[48:63], a[80:83], v[32:35], v[48:63]
    ds_read_b128 v[28:31], v2 offset:27648
    s_waitcnt lgkmcnt(6)
    v_mfma_f32_32x32x16_bf16 v[64:79], a[84:87], v[36:39], v[64:79]
    ds_read_b128 v[32:35], v2 offset:28672
    s_waitcnt lgkmcnt(6)
    v_mfma_f32_32x32x16_bf16 v[48:63], a[88:91], v[40:43], v[48:63]
    buffer_load_dwordx4 v1, s[8:11], s24 offen offset:3072 sc1 lds
    ds_read_b128 v[36:39], v2 offset:29696
    s_waitcnt lgkmcnt(6)
    v_mfma_f32_32x32x16_bf16 v[64:79], a[92:95], v[44:47], v[64:79]
    ds_read_b128 v[40:43], v2 offset:30720
    s_waitcnt lgkmcnt(6)
    v_mfma_f32_32x32x16_bf16 v[48:63], a[96:99], v[16:19], v[48:63]
    ds_read_b128 v[44:47], v2 offset:31744
    s_waitcnt lgkmcnt(6)
    v_mfma_f32_32x32x16_bf16 v[64:79], a[100:103], v[20:23], v[64:79]
    s_add_u32 s24, s24, 4096
    s_add_u32 s25, s25, 4096
    s_mov_b32 m0, s25
    s_nop 0
    buffer_load_dwordx4 v1, s[8:11], s24 offen offset:0 sc1 lds
    ds_read_b128 v[16:19], v2 offset:32768
    s_waitcnt lgkmcnt(6)
    v_mfma_f32_32x32x16_bf16 v[48:63], a[104:107], v[24:27], v[48:63]
    ds_read_b128 v[20:23], v2 offset:33792
    s_waitcnt lgkmcnt(6)
    v_mfma_f32_32x32x16_bf16 v[64:79], a[108:111], v[28:31], v[64:79]
    ds_read_b128 v[24:27], v2 offset:34816
    s_waitcnt lgkmcnt(6)
    v_mfma_f32_32x32x16_bf16 v[48:63], a[112:115], v[32:35], v[48:63]
    buffer_load_dwordx4 v1, s[8:11], s24 offen offset:1024 sc1 lds
    ds_read_b128 v[28:31], v2 offset:35840
    s_waitcnt lgkmcnt(6)
    v_mfma_f32_32x32x16_bf16 v[64:79], a[116:119], v[36:39], v[64:79]
    ds_read_b128 v[32:35], v2 offset:36864
    s_waitcnt lgkmcnt(6)
    v_mfma_f32_32x32x16_bf16 v[48:63], a[120:123], v[40:43], v[48:63]
    ds_read_b128 v[36:39], v2 offset:37888
    s_waitcnt lgkmcnt(6)
    v_mfma_f32_32x32x16_bf16 v[64:79], a[124:127], v[44:47], v[64:79]
    ds_read_b128 v[40:43], v2 offset:38912
    s_waitcnt lgkmcnt(6)
    v_mfma_f32_32x32x16_bf16 v[48:63], a[128:131], v[16:19], v[48:63]
    ds_read_b128 v[44:47], v2 offset:39936
    s_waitcnt lgkmcnt(6)
    v_mfma_f32_32x32x16_bf16 v[64:79], a[132:135], v[20:23], v[64:79]
    s_waitcnt lgkmcnt(5)
    v_mfma_f32_32x32x16_bf16 v[48:63], a[136:139], v[24:27], v[48:63]
    s_waitcnt lgkmcnt(4)
    v_mfma_f32_32x32x16_bf16 v[64:79], a[140:143], v[28:31], v[64:79]
    s_waitcnt lgkmcnt(3)
    v_mfma_f32_32x32x16_bf16 v[48:63], a[144:147], v[32:35], v[48:63]
    s_waitcnt lgkmcnt(2)
    v_mfma_f32_32x32x16_bf16 v[64:79], a[148:151], v[36:39], v[64:79]
    s_waitcnt lgkmcnt(1)
    v_mfma_f32_32x32x16_bf16 v[48:63], a[152:155], v[40:43], v[48:63]
    s_waitcnt lgkmcnt(0)
    v_mfma_f32_32x32x16_bf16 v[64:79], a[156:159], v[44:47], v[64:79]
    s_waitcnt vmcnt(12)
    s_nop 7
    s_nop 3
    v_add_f32 v48, v48, v64
    v_add_f32 v49, v49, v65
    v_add_f32 v50, v50, v66
    v_add_f32 v51, v51, v67
    v_add_f32 v52, v52, v68
    v_add_f32 v53, v53, v69
    v_add_f32 v54, v54, v70
    v_add_f32 v55, v55, v71
    v_add_f32 v56, v56, v72
    v_add_f32 v57, v57, v73
    v_add_f32 v58, v58, v74
    v_add_f32 v59, v59, v75
    v_add_f32 v60, v60, v76
    v_add_f32 v61, v61, v77
    v_add_f32 v62, v62, v78
    v_add_f32 v63, v63, v79
    s_add_u32 s26, s19, 226492416
    v_cvt_pk_bf16_f32 v80, v48, v49
    v_cvt_pk_bf16_f32 v81, v50, v51
    v_cvt_pk_bf16_f32 v82, v52, v53
    v_cvt_pk_bf16_f32 v83, v54, v55
    s_nop 1
    v_permlane32_swap_b32 v80, v82
    v_permlane32_swap_b32 v81, v83
    s_nop 1
    v_lshlrev_b32 v88, 16, v80
    v_and_b32 v89, 0xffff0000, v80
    v_lshlrev_b32 v90, 16, v96
    v_and_b32 v91, 0xffff0000, v96
    v_add_f32 v88, v88, v90
    v_add_f32 v89, v89, v91
    v_cvt_pk_bf16_f32 v80, v88, v89
    v_lshlrev_b32 v92, 16, v81
    v_and_b32 v93, 0xffff0000, v81
    v_lshlrev_b32 v94, 16, v97
    v_and_b32 v95, 0xffff0000, v97
    v_add_f32 v92, v92, v94
    v_add_f32 v93, v93, v95
    v_cvt_pk_bf16_f32 v81, v92, v93
    v_lshlrev_b32 v88, 16, v82
    v_and_b32 v89, 0xffff0000, v82
    v_lshlrev_b32 v90, 16, v98
    v_and_b32 v91, 0xffff0000, v98
    v_add_f32 v88, v88, v90
    v_add_f32 v89, v89, v91
    v_cvt_pk_bf16_f32 v82, v88, v89
    v_lshlrev_b32 v92, 16, v83
    v_and_b32 v93, 0xffff0000, v83
    v_lshlrev_b32 v94, 16, v99
    v_and_b32 v95, 0xffff0000, v99
    v_add_f32 v92, v92, v94
    v_add_f32 v93, v93, v95
    v_cvt_pk_bf16_f32 v83, v92, v93
    buffer_store_dwordx4 v[80:83], v3, s[8:11], s26 offen offset:0 sc1
    v_cvt_pk_bf16_f32 v84, v56, v57
    v_cvt_pk_bf16_f32 v85, v58, v59
    v_cvt_pk_bf16_f32 v86, v60, v61
    v_cvt_pk_bf16_f32 v87, v62, v63
    s_nop 1
    v_permlane32_swap_b32 v84, v86
    v_permlane32_swap_b32 v85, v87
    s_nop 1
    v_lshlrev_b32 v88, 16, v84
    v_and_b32 v89, 0xffff0000, v84
    v_lshlrev_b32 v90, 16, v100
    v_and_b32 v91, 0xffff0000, v100
    v_add_f32 v88, v88, v90
    v_add_f32 v89, v89, v91
    v_cvt_pk_bf16_f32 v84, v88, v89
    v_lshlrev_b32 v92, 16, v85
    v_and_b32 v93, 0xffff0000, v85
    v_lshlrev_b32 v94, 16, v101
    v_and_b32 v95, 0xffff0000, v101
    v_add_f32 v92, v92, v94
    v_add_f32 v93, v93, v95
    v_cvt_pk_bf16_f32 v85, v92, v93
    v_lshlrev_b32 v88, 16, v86
    v_and_b32 v89, 0xffff0000, v86
    v_lshlrev_b32 v90, 16, v102
    v_and_b32 v91, 0xffff0000, v102
    v_add_f32 v88, v88, v90
    v_add_f32 v89, v89, v91
    v_cvt_pk_bf16_f32 v86, v88, v89
    v_lshlrev_b32 v92, 16, v87
    v_and_b32 v93, 0xffff0000, v87
    v_lshlrev_b32 v94, 16, v103
    v_and_b32 v95, 0xffff0000, v103
    v_add_f32 v92, v92, v94
    v_add_f32 v93, v93, v95
    v_cvt_pk_bf16_f32 v87, v92, v93
    buffer_store_dwordx4 v[84:87], v3, s[8:11], s26 offen offset:32 sc1
    s_waitcnt vmcnt(0)
    s_mov_b64 exec, 1
    s_add_u32 s26, s48, s20
    buffer_store_dword v5, v4, s[8:11], s26 offen sc1
    s_mov_b64 exec, -1
    s_add_u32 s20, s20, 128
    s_add_u32 s19, s19, 40960
    s_add_u32 s16, s16, 40960
    s_cmp_eq_u32 s16, 122880
    s_cselect_b32 s16, 0, s16
    s_add_u32 s14, s14, 1
    s_cmp_ge_u32 s14, s15
    s_cbranch_scc1 layerb1_kernel_ab_fin
    s_add_u32 s23, s14, 2
    s_cmp_lg_u32 s13, 0
    s_cbranch_scc1 layerb1_kernel_ab_ow4
    s_min_u32 s28, s23, 63
    s_cmp_gt_u32 s22, s28
    s_cbranch_scc1 layerb1_kernel_ab_ow4
layerb1_kernel_ab_op4:
    buffer_load_dwordx4 v[116:119], v1, s[8:11], s29 offen sc1
    s_waitcnt vmcnt(0)
    v_min_u32 v116, v116, v117
    v_min_u32 v118, v118, v119
    v_min_u32 v114, v116, v118
    v_cmp_eq_u32 vcc, 0, v114
    s_nop 1
    s_ff1_i32_b64 s22, vcc
    s_min_u32 s22, s22, 64
    s_and_b32 s22, s22, 0x7c
    s_sub_u32 s30, s30, 1
    s_cbranch_scc1 layerb1_kernel_bail
    s_cmp_gt_u32 s22, s28
    s_cbranch_scc0 layerb1_kernel_ab_op4
layerb1_kernel_ab_ow4:
    s_barrier
    v_add_u32 v2, s16, v1
    ds_read_b128 v[16:19], v2 offset:0
    ds_read_b128 v[20:23], v2 offset:1024
    ds_read_b128 v[24:27], v2 offset:2048
    ds_read_b128 v[28:31], v2 offset:3072
    ds_read_b128 v[32:35], v2 offset:4096
    ds_read_b128 v[36:39], v2 offset:5120
    s_add_u32 s27, s19, 40960
    s_cmp_ge_u32 s14, 63
    s_cselect_b32 s27, s19, s27
    buffer_load_dwordx4 v[96:99], v3, s[52:55], s27 offen offset:0
    buffer_load_dwordx4 v[100:103], v3, s[52:55], s27 offen offset:32
    s_add_u32 s23, s14, 2
    s_min_u32 s24, s23, 63
    s_mul_i32 s24, s24, 40960
    s_add_u32 s24, s24, s18
    s_mul_i32 s25, s13, 10240
    s_add_u32 s25, s25, s17
    s_add_u32 s17, s17, 40960
    s_cmp_eq_u32 s17, 122880
    s_cselect_b32 s17, 0, s17
    ds_read_b128 v[40:43], v2 offset:6144
    s_waitcnt lgkmcnt(6)
    v_mfma_f32_32x32x16_bf16 v[48:63], a[0:3], v[16:19], 0
    ds_read_b128 v[44:47], v2 offset:7168
    s_waitcnt lgkmcnt(6)
    v_mfma_f32_32x32x16_bf16 v[64:79], a[4:7], v[20:23], 0
    s_mov_b32 m0, s25
    s_nop 0
    buffer_load_dwordx4 v1, s[8:11], s24 offen offset:0 sc1 lds
    ds_read_b128 v[16:19], v2 offset:8192
    s_waitcnt lgkmcnt(6)
    v_mfma_f32_32x32x16_bf16 v[48:63], a[8:11], v[24:27], v[48:63]
    ds_read_b128 v[20:23], v2 offset:9216
    s_waitcnt lgkmcnt(6)
    v_mfma_f32_32x32x16_bf16 v[64:79], a[12:15], v[28:31], v[64:79]
    ds_read_b128 v[24:27], v2 offset:10240
    s_waitcnt lgkmcnt(6)
    v_mfma_f32_32x32x16_bf16 v[48:63], a[16:19], v[32:35], v[48:63]
    buffer_load_dwordx4 v1, s[8:11], s24 offen offset:1024 sc1 lds
    ds_read_b128 v[28:31], v2 offset:11264
    s_waitcnt lgkmcnt(6)
    v_mfma_f32_32x32x16_bf16 v[64:79], a[20:23], v[36:39], v[64:79]
    ds_read_b128 v[32:35], v2 offset:12288
    s_waitcnt lgkmcnt(6)
    v_mfma_f32_32x32x16_bf16 v[48:63], a[24:27], v[40:43], v[48:63]
    ds_read_b128 v[36:39], v2 offset:13312
    s_waitcnt lgkmcnt(6)
    v_mfma_f32_32x32x16_bf16 v[64:79], a[28:31], v[44:47], v[64:79]
    buffer_load_dwordx4 v1, s[8:11], s24 offen offset:2048 sc1 lds
    ds_read_b128 v[40:43], v2 offset:14336
    s_waitcnt lgkmcnt(6)
    v_mfma_f32_32x32x16_bf16 v[48:63], a[32:35], v[16:19], v[48:63]
    ds_read_b128 v[44:47], v2 offset:15360
    s_waitcnt lgkmcnt(6)
    v_mfma_f32_32x32x16_bf16 v[64:79], a[36:39], v[20:23], v[64:79]
    ds_read_b128 v[16:19], v2 offset:16384
    s_waitcnt lgkmcnt(6)
    v_mfma_f32_32x32x16_bf16 v[48:63], a[40:43], v[24:27], v[48:63]
    buffer_load_dwordx4 v1, s[8:11], s24 offen offset:3072 sc1 lds
    ds_read_b128 v[20:23], v2 offset:17408
    s_waitcnt lgkmcnt(6)
    v_mfma_f32_32x32x16_bf16 v[64:79], a[44:47], v[28:31], v[64:79]
    ds_read_b128 v[24:27], v2 offset:18432
    s_waitcnt lgkmcnt(6)
    v_mfma_f32_32x32x16_bf16 v[48:63], a[48:51], v[32:35], v[48:63]
    ds_read_b128 v[28:31], v2 offset:19456
    s_waitcnt lgkmcnt(6)
    v_mfma_f32_32x32x16_bf16 v[64:79], a[52:55], v[36:39], v[64:79]
    s_add_u32 s24, s24, 4096
    s_add_u32 s25, s25, 4096
    s_mov_b32 m0, s25
    s_nop 0
    buffer_load_dwordx4 v1, s[8:11], s24 offen offset:0 sc1 lds
    ds_read_b128 v[32:35], v2 offset:20480
    s_waitcnt lgkmcnt(6)
    v_mfma_f32_32x32x16_bf16 v[48:63], a[56:59], v[40:43], v[48:63]
    ds_read_b128 v[36:39], v2 offset:21504
    s_waitcnt lgkmcnt(6)
    v_mfma_f32_32x32x16_bf16 v[64:79], a[60:63], v[44:47], v[64:79]
    ds_read_b128 v[40:43], v2 offset:22528
    s_waitcnt lgkmcnt(6)
    v_mfma_f32_32x32x16_bf16 v[48:63], a[64:67], v[16:19], v[48:63]
    buffer_load_dwordx4 v1, s[8:11], s24 offen offset:1024 sc1 lds
    ds_read_b128 v[44:47], v2 offset:23552
    s_waitcnt lgkmcnt(6)
    v_mfma_f32_32x32x16_bf16 v[64:79], a[68:71], v[20:23], v[64:79]
    ds_read_b128 v[16:19], v2 offset:24576
    s_waitcnt lgkmcnt(6)
    v_mfma_f32_32x32x16_bf16 v[48:63], a[72:75], v[24:27], v[48:63]
    ds_read_b128 v[20:23], v2 offset:25600
    s_waitcnt lgkmcnt(6)
    v_mfma_f32_32x32x16_bf16 v[64:79], a[76:79], v[28:31], v[64:79]
    buffer_load_dwordx4 v1, s[8:11], s24 offen offset:2048 sc1 lds
    ds_read_b128 v[24:27], v2 offset:26624
    s_waitcnt lgkmcnt(6)
    v_mfma_f32_32x32x16_bf16 v[48:63], a[80:83], v[32:35], v[48:63]
    ds_read_b128 v[28:31], v2 offset:27648
    s_waitcnt lgkmcnt(6)
    v_mfma_f32_32x32x16_bf16 v[64:79], a[84:87], v[36:39], v[64:79]
    ds_read_b128 v[32:35], v2 offset:28672
    s_waitcnt lgkmcnt(6)
    v_mfma_f32_32x32x16_bf16 v[48:63], a[88:91], v[40:43], v[48:63]
    buffer_load_dwordx4 v1, s[8:11], s24 offen offset:3072 sc1 lds
    ds_read_b128 v[36:39], v2 offset:29696
    s_waitcnt lgkmcnt(6)
    v_mfma_f32_32x32x16_bf16 v[64:79], a[92:95], v[44:47], v[64:79]
    ds_read_b128 v[40:43], v2 offset:30720
    s_waitcnt lgkmcnt(6)
    v_mfma_f32_32x32x16_bf16 v[48:63], a[96:99], v[16:19], v[48:63]
    ds_read_b128 v[44:47], v2 offset:31744
    s_waitcnt lgkmcnt(6)
    v_mfma_f32_32x32x16_bf16 v[64:79], a[100:103], v[20:23], v[64:79]
    s_add_u32 s24, s24, 4096
    s_add_u32 s25, s25, 4096
    s_mov_b32 m0, s25
    s_nop 0
    buffer_load_dwordx4 v1, s[8:11], s24 offen offset:0 sc1 lds
    ds_read_b128 v[16:19], v2 offset:32768
    s_waitcnt lgkmcnt(6)
    v_mfma_f32_32x32x16_bf16 v[48:63], a[104:107], v[24:27], v[48:63]
    ds_read_b128 v[20:23], v2 offset:33792
    s_waitcnt lgkmcnt(6)
    v_mfma_f32_32x32x16_bf16 v[64:79], a[108:111], v[28:31], v[64:79]
    ds_read_b128 v[24:27], v2 offset:34816
    s_waitcnt lgkmcnt(6)
    v_mfma_f32_32x32x16_bf16 v[48:63], a[112:115], v[32:35], v[48:63]
    buffer_load_dwordx4 v1, s[8:11], s24 offen offset:1024 sc1 lds
    ds_read_b128 v[28:31], v2 offset:35840
    s_waitcnt lgkmcnt(6)
    v_mfma_f32_32x32x16_bf16 v[64:79], a[116:119], v[36:39], v[64:79]
    ds_read_b128 v[32:35], v2 offset:36864
    s_waitcnt lgkmcnt(6)
    v_mfma_f32_32x32x16_bf16 v[48:63], a[120:123], v[40:43], v[48:63]
    ds_read_b128 v[36:39], v2 offset:37888
    s_waitcnt lgkmcnt(6)
    v_mfma_f32_32x32x16_bf16 v[64:79], a[124:127], v[44:47], v[64:79]
    ds_read_b128 v[40:43], v2 offset:38912
    s_waitcnt lgkmcnt(6)
    v_mfma_f32_32x32x16_bf16 v[48:63], a[128:131], v[16:19], v[48:63]
    ds_read_b128 v[44:47], v2 offset:39936
    s_waitcnt lgkmcnt(6)
    v_mfma_f32_32x32x16_bf16 v[64:79], a[132:135], v[20:23], v[64:79]
    s_waitcnt lgkmcnt(5)
    v_mfma_f32_32x32x16_bf16 v[48:63], a[136:139], v[24:27], v[48:63]
    s_waitcnt lgkmcnt(4)
    v_mfma_f32_32x32x16_bf16 v[64:79], a[140:143], v[28:31], v[64:79]
    s_waitcnt lgkmcnt(3)
    v_mfma_f32_32x32x16_bf16 v[48:63], a[144:147], v[32:35], v[48:63]
    s_waitcnt lgkmcnt(2)
    v_mfma_f32_32x32x16_bf16 v[64:79], a[148:151], v[36:39], v[64:79]
    s_waitcnt lgkmcnt(1)
    v_mfma_f32_32x32x16_bf16 v[48:63], a[152:155], v[40:43], v[48:63]
    s_waitcnt lgkmcnt(0)
    v_mfma_f32_32x32x16_bf16 v[64:79], a[156:159], v[44:47], v[64:79]
    s_waitcnt vmcnt(12)
    s_nop 7
    s_nop 3
    v_add_f32 v48, v48, v64
    v_add_f32 v49, v49, v65
    v_add_f32 v50, v50, v66
    v_add_f32 v51, v51, v67
    v_add_f32 v52, v52, v68
    v_add_f32 v53, v53, v69
    v_add_f32 v54, v54, v70
    v_add_f32 v55, v55, v71
    v_add_f32 v56, v56, v72
    v_add_f32 v57, v57, v73
    v_add_f32 v58, v58, v74
    v_add_f32 v59, v59, v75
    v_add_f32 v60, v60, v76
    v_add_f32 v61, v61, v77
    v_add_f32 v62, v62, v78
    v_add_f32 v63, v63, v79
    s_add_u32 s26, s19, 226492416
    v_cvt_pk_bf16_f32 v80, v48, v49
    v_cvt_pk_bf16_f32 v81, v50, v51
    v_cvt_pk_bf16_f32 v82, v52, v53
    v_cvt_pk_bf16_f32 v83, v54, v55
    s_nop 1
    v_permlane32_swap_b32 v80, v82
    v_permlane32_swap_b32 v81, v83
    s_nop 1
    v_lshlrev_b32 v88, 16, v80
    v_and_b32 v89, 0xffff0000, v80
    v_lshlrev_b32 v90, 16, v104
    v_and_b32 v91, 0xffff0000, v104
    v_add_f32 v88, v88, v90
    v_add_f32 v89, v89, v91
    v_cvt_pk_bf16_f32 v80, v88, v89
    v_lshlrev_b32 v92, 16, v81
    v_and_b32 v93, 0xffff0000, v81
    v_lshlrev_b32 v94, 16, v105
    v_and_b32 v95, 0xffff0000, v105
    v_add_f32 v92, v92, v94
    v_add_f32 v93, v93, v95
    v_cvt_pk_bf16_f32 v81, v92, v93
    v_lshlrev_b32 v88, 16, v82
    v_and_b32 v89, 0xffff0000, v82
    v_lshlrev_b32 v90, 16, v106
    v_and_b32 v91, 0xffff0000, v106
    v_add_f32 v88, v88, v90
    v_add_f32 v89, v89, v91
    v_cvt_pk_bf16_f32 v82, v88, v89
    v_lshlrev_b32 v92, 16, v83
    v_and_b32 v93, 0xffff0000, v83
    v_lshlrev_b32 v94, 16, v107
    v_and_b32 v95, 0xffff0000, v107
    v_add_f32 v92, v92, v94
    v_add_f32 v93, v93, v95
    v_cvt_pk_bf16_f32 v83, v92, v93
    buffer_store_dwordx4 v[80:83], v3, s[8:11], s26 offen offset:0 sc1
    v_cvt_pk_bf16_f32 v84, v56, v57
    v_cvt_pk_bf16_f32 v85, v58, v59
    v_cvt_pk_bf16_f32 v86, v60, v61
    v_cvt_pk_bf16_f32 v87, v62, v63
    s_nop 1
    v_permlane32_swap_b32 v84, v86
    v_permlane32_swap_b32 v85, v87
    s_nop 1
    v_lshlrev_b32 v88, 16, v84
    v_and_b32 v89, 0xffff0000, v84
    v_lshlrev_b32 v90, 16, v108
    v_and_b32 v91, 0xffff0000, v108
    v_add_f32 v88, v88, v90
    v_add_f32 v89, v89, v91
    v_cvt_pk_bf16_f32 v84, v88, v89
    v_lshlrev_b32 v92, 16, v85
    v_and_b32 v93, 0xffff0000, v85
    v_lshlrev_b32 v94, 16, v109
    v_and_b32 v95, 0xffff0000, v109
    v_add_f32 v92, v92, v94
    v_add_f32 v93, v93, v95
    v_cvt_pk_bf16_f32 v85, v92, v93
    v_lshlrev_b32 v88, 16, v86
    v_and_b32 v89, 0xffff0000, v86
    v_lshlrev_b32 v90, 16, v110
    v_and_b32 v91, 0xffff0000, v110
    v_add_f32 v88, v88, v90
    v_add_f32 v89, v89, v91
    v_cvt_pk_bf16_f32 v86, v88, v89
    v_lshlrev_b32 v92, 16, v87
    v_and_b32 v93, 0xffff0000, v87
    v_lshlrev_b32 v94, 16, v111
    v_and_b32 v95, 0xffff0000, v111
    v_add_f32 v92, v92, v94
    v_add_f32 v93, v93, v95
    v_cvt_pk_bf16_f32 v87, v92, v93
    buffer_store_dwordx4 v[84:87], v3, s[8:11], s26 offen offset:32 sc1
    s_waitcnt vmcnt(0)
    s_mov_b64 exec, 1
    s_add_u32 s26, s48, s20
    buffer_store_dword v5, v4, s[8:11], s26 offen sc1
    s_mov_b64 exec, -1
    s_add_u32 s20, s20, 128
    s_add_u32 s19, s19, 40960
    s_add_u32 s16, s16, 40960
    s_cmp_eq_u32 s16, 122880
    s_cselect_b32 s16, 0, s16
    s_add_u32 s14, s14, 1
    s_cmp_ge_u32 s14, s15
    s_cbranch_scc1 layerb1_kernel_ab_fin
    s_add_u32 s23, s14, 2
    s_cmp_lg_u32 s13, 0
    s_cbranch_scc1 layerb1_kernel_ab_ow5
    s_min_u32 s28, s23, 63
    s_cmp_gt_u32 s22, s28
    s_cbranch_scc1 layerb1_kernel_ab_ow5
layerb1_kernel_ab_op5:
    buffer_load_dwordx4 v[116:119], v1, s[8:11], s29 offen sc1
    s_waitcnt vmcnt(0)
    v_min_u32 v116, v116, v117
    v_min_u32 v118, v118, v119
    v_min_u32 v114, v116, v118
    v_cmp_eq_u32 vcc, 0, v114
    s_nop 1
    s_ff1_i32_b64 s22, vcc
    s_min_u32 s22, s22, 64
    s_and_b32 s22, s22, 0x7c
    s_sub_u32 s30, s30, 1
    s_cbranch_scc1 layerb1_kernel_bail
    s_cmp_gt_u32 s22, s28
    s_cbranch_scc0 layerb1_kernel_ab_op5
layerb1_kernel_ab_ow5:
    s_barrier
    v_add_u32 v2, s16, v1
    ds_read_b128 v[16:19], v2 offset:0
    ds_read_b128 v[20:23], v2 offset:1024
    ds_read_b128 v[24:27], v2 offset:2048
    ds_read_b128 v[28:31], v2 offset:3072
    ds_read_b128 v[32:35], v2 offset:4096
    ds_read_b128 v[36:39], v2 offset:5120
    s_add_u32 s27, s19, 40960
    s_cmp_ge_u32 s14, 63
    s_cselect_b32 s27, s19, s27
    buffer_load_dwordx4 v[104:107], v3, s[52:55], s27 offen offset:0
    buffer_load_dwordx4 v[108:111], v3, s[52:55], s27 offen offset:32
    s_add_u32 s23, s14, 2
    s_min_u32 s24, s23, 63
    s_mul_i32 s24, s24, 40960
    s_add_u32 s24, s24, s18
    s_mul_i32 s25, s13, 10240
    s_add_u32 s25, s25, s17
    s_add_u32 s17, s17, 40960
    s_cmp_eq_u32 s17, 122880
    s_cselect_b32 s17, 0, s17
    ds_read_b128 v[40:43], v2 offset:6144
    s_waitcnt lgkmcnt(6)
    v_mfma_f32_32x32x16_bf16 v[48:63], a[0:3], v[16:19], 0
    ds_read_b128 v[44:47], v2 offset:7168
    s_waitcnt lgkmcnt(6)
    v_mfma_f32_32x32x16_bf16 v[64:79], a[4:7], v[20:23], 0
    s_mov_b32 m0, s25
    s_nop 0
    buffer_load_dwordx4 v1, s[8:11], s24 offen offset:0 sc1 lds
    ds_read_b128 v[16:19], v2 offset:8192
    s_waitcnt lgkmcnt(6)
    v_mfma_f32_32x32x16_bf16 v[48:63], a[8:11], v[24:27], v[48:63]
    ds_read_b128 v[20:23], v2 offset:9216
    s_waitcnt lgkmcnt(6)
    v_mfma_f32_32x32x16_bf16 v[64:79], a[12:15], v[28:31], v[64:79]
    ds_read_b128 v[24:27], v2 offset:10240
    s_waitcnt lgkmcnt(6)
    v_mfma_f32_32x32x16_bf16 v[48:63], a[16:19], v[32:35], v[48:63]
    buffer_load_dwordx4 v1, s[8:11], s24 offen offset:1024 sc1 lds
    ds_read_b128 v[28:31], v2 offset:11264
    s_waitcnt lgkmcnt(6)
    v_mfma_f32_32x32x16_bf16 v[64:79], a[20:23], v[36:39], v[64:79]
    ds_read_b128 v[32:35], v2 offset:12288
    s_waitcnt lgkmcnt(6)
    v_mfma_f32_32x32x16_bf16 v[48:63], a[24:27], v[40:43], v[48:63]
    ds_read_b128 v[36:39], v2 offset:13312
    s_waitcnt lgkmcnt(6)
    v_mfma_f32_32x32x16_bf16 v[64:79], a[28:31], v[44:47], v[64:79]
    buffer_load_dwordx4 v1, s[8:11], s24 offen offset:2048 sc1 lds
    ds_read_b128 v[40:43], v2 offset:14336
    s_waitcnt lgkmcnt(6)
    v_mfma_f32_32x32x16_bf16 v[48:63], a[32:35], v[16:19], v[48:63]
    ds_read_b128 v[44:47], v2 offset:15360
    s_waitcnt lgkmcnt(6)
    v_mfma_f32_32x32x16_bf16 v[64:79], a[36:39], v[20:23], v[64:79]
    ds_read_b128 v[16:19], v2 offset:16384
    s_waitcnt lgkmcnt(6)
    v_mfma_f32_32x32x16_bf16 v[48:63], a[40:43], v[24:27], v[48:63]
    buffer_load_dwordx4 v1, s[8:11], s24 offen offset:3072 sc1 lds
    ds_read_b128 v[20:23], v2 offset:17408
    s_waitcnt lgkmcnt(6)
    v_mfma_f32_32x32x16_bf16 v[64:79], a[44:47], v[28:31], v[64:79]
    ds_read_b128 v[24:27], v2 offset:18432
    s_waitcnt lgkmcnt(6)
    v_mfma_f32_32x32x16_bf16 v[48:63], a[48:51], v[32:35], v[48:63]
    ds_read_b128 v[28:31], v2 offset:19456
    s_waitcnt lgkmcnt(6)
    v_mfma_f32_32x32x16_bf16 v[64:79], a[52:55], v[36:39], v[64:79]
    s_add_u32 s24, s24, 4096
    s_add_u32 s25, s25, 4096
    s_mov_b32 m0, s25
    s_nop 0
    buffer_load_dwordx4 v1, s[8:11], s24 offen offset:0 sc1 lds
    ds_read_b128 v[32:35], v2 offset:20480
    s_waitcnt lgkmcnt(6)
    v_mfma_f32_32x32x16_bf16 v[48:63], a[56:59], v[40:43], v[48:63]
    ds_read_b128 v[36:39], v2 offset:21504
    s_waitcnt lgkmcnt(6)
    v_mfma_f32_32x32x16_bf16 v[64:79], a[60:63], v[44:47], v[64:79]
    ds_read_b128 v[40:43], v2 offset:22528
    s_waitcnt lgkmcnt(6)
    v_mfma_f32_32x32x16_bf16 v[48:63], a[64:67], v[16:19], v[48:63]
    buffer_load_dwordx4 v1, s[8:11], s24 offen offset:1024 sc1 lds
    ds_read_b128 v[44:47], v2 offset:23552
    s_waitcnt lgkmcnt(6)
    v_mfma_f32_32x32x16_bf16 v[64:79], a[68:71], v[20:23], v[64:79]
    ds_read_b128 v[16:19], v2 offset:24576
    s_waitcnt lgkmcnt(6)
    v_mfma_f32_32x32x16_bf16 v[48:63], a[72:75], v[24:27], v[48:63]
    ds_read_b128 v[20:23], v2 offset:25600
    s_waitcnt lgkmcnt(6)
    v_mfma_f32_32x32x16_bf16 v[64:79], a[76:79], v[28:31], v[64:79]
    buffer_load_dwordx4 v1, s[8:11], s24 offen offset:2048 sc1 lds
    ds_read_b128 v[24:27], v2 offset:26624
    s_waitcnt lgkmcnt(6)
    v_mfma_f32_32x32x16_bf16 v[48:63], a[80:83], v[32:35], v[48:63]
    ds_read_b128 v[28:31], v2 offset:27648
    s_waitcnt lgkmcnt(6)
    v_mfma_f32_32x32x16_bf16 v[64:79], a[84:87], v[36:39], v[64:79]
    ds_read_b128 v[32:35], v2 offset:28672
    s_waitcnt lgkmcnt(6)
    v_mfma_f32_32x32x16_bf16 v[48:63], a[88:91], v[40:43], v[48:63]
    buffer_load_dwordx4 v1, s[8:11], s24 offen offset:3072 sc1 lds
    ds_read_b128 v[36:39], v2 offset:29696
    s_waitcnt lgkmcnt(6)
    v_mfma_f32_32x32x16_bf16 v[64:79], a[92:95], v[44:47], v[64:79]
    ds_read_b128 v[40:43], v2 offset:30720
    s_waitcnt lgkmcnt(6)
    v_mfma_f32_32x32x16_bf16 v[48:63], a[96:99], v[16:19], v[48:63]
    ds_read_b128 v[44:47], v2 offset:31744
    s_waitcnt lgkmcnt(6)
    v_mfma_f32_32x32x16_bf16 v[64:79], a[100:103], v[20:23], v[64:79]
    s_add_u32 s24, s24, 4096
    s_add_u32 s25, s25, 4096
    s_mov_b32 m0, s25
    s_nop 0
    buffer_load_dwordx4 v1, s[8:11], s24 offen offset:0 sc1 lds
    ds_read_b128 v[16:19], v2 offset:32768
    s_waitcnt lgkmcnt(6)
    v_mfma_f32_32x32x16_bf16 v[48:63], a[104:107], v[24:27], v[48:63]
    ds_read_b128 v[20:23], v2 offset:33792
    s_waitcnt lgkmcnt(6)
    v_mfma_f32_32x32x16_bf16 v[64:79], a[108:111], v[28:31], v[64:79]
    ds_read_b128 v[24:27], v2 offset:34816
    s_waitcnt lgkmcnt(6)
    v_mfma_f32_32x32x16_bf16 v[48:63], a[112:115], v[32:35], v[48:63]
    buffer_load_dwordx4 v1, s[8:11], s24 offen offset:1024 sc1 lds
    ds_read_b128 v[28:31], v2 offset:35840
    s_waitcnt lgkmcnt(6)
    v_mfma_f32_32x32x16_bf16 v[64:79], a[116:119], v[36:39], v[64:79]
    ds_read_b128 v[32:35], v2 offset:36864
    s_waitcnt lgkmcnt(6)
    v_mfma_f32_32x32x16_bf16 v[48:63], a[120:123], v[40:43], v[48:63]
    ds_read_b128 v[36:39], v2 offset:37888
    s_waitcnt lgkmcnt(6)
    v_mfma_f32_32x32x16_bf16 v[64:79], a[124:127], v[44:47], v[64:79]
    ds_read_b128 v[40:43], v2 offset:38912
    s_waitcnt lgkmcnt(6)
    v_mfma_f32_32x32x16_bf16 v[48:63], a[128:131], v[16:19], v[48:63]
    ds_read_b128 v[44:47], v2 offset:39936
    s_waitcnt lgkmcnt(6)
    v_mfma_f32_32x32x16_bf16 v[64:79], a[132:135], v[20:23], v[64:79]
    s_waitcnt lgkmcnt(5)
    v_mfma_f32_32x32x16_bf16 v[48:63], a[136:139], v[24:27], v[48:63]
    s_waitcnt lgkmcnt(4)
    v_mfma_f32_32x32x16_bf16 v[64:79], a[140:143], v[28:31], v[64:79]
    s_waitcnt lgkmcnt(3)
    v_mfma_f32_32x32x16_bf16 v[48:63], a[144:147], v[32:35], v[48:63]
    s_waitcnt lgkmcnt(2)
    v_mfma_f32_32x32x16_bf16 v[64:79], a[148:151], v[36:39], v[64:79]
    s_waitcnt lgkmcnt(1)
    v_mfma_f32_32x32x16_bf16 v[48:63], a[152:155], v[40:43], v[48:63]
    s_waitcnt lgkmcnt(0)
    v_mfma_f32_32x32x16_bf16 v[64:79], a[156:159], v[44:47], v[64:79]
    s_waitcnt vmcnt(12)
    s_nop 7
    s_nop 3
    v_add_f32 v48, v48, v64
    v_add_f32 v49, v49, v65
    v_add_f32 v50, v50, v66
    v_add_f32 v51, v51, v67
    v_add_f32 v52, v52, v68
    v_add_f32 v53, v53, v69
    v_add_f32 v54, v54, v70
    v_add_f32 v55, v55, v71
    v_add_f32 v56, v56, v72
    v_add_f32 v57, v57, v73
    v_add_f32 v58, v58, v74
    v_add_f32 v59, v59, v75
    v_add_f32 v60, v60, v76
    v_add_f32 v61, v61, v77
    v_add_f32 v62, v62, v78
    v_add_f32 v63, v63, v79
    s_add_u32 s26, s19, 226492416
    v_cvt_pk_bf16_f32 v80, v48, v49
    v_cvt_pk_bf16_f32 v81, v50, v51
    v_cvt_pk_bf16_f32 v82, v52, v53
    v_cvt_pk_bf16_f32 v83, v54, v55
    s_nop 1
    v_permlane32_swap_b32 v80, v82
    v_permlane32_swap_b32 v81, v83
    s_nop 1
    v_lshlrev_b32 v88, 16, v80
    v_and_b32 v89, 0xffff0000, v80
    v_lshlrev_b32 v90, 16, v96
    v_and_b32 v91, 0xffff0000, v96
    v_add_f32 v88, v88, v90
    v_add_f32 v89, v89, v91
    v_cvt_pk_bf16_f32 v80, v88, v89
    v_lshlrev_b32 v92, 16, v81
    v_and_b32 v93, 0xffff0000, v81
    v_lshlrev_b32 v94, 16, v97
    v_and_b32 v95, 0xffff0000, v97
    v_add_f32 v92, v92, v94
    v_add_f32 v93, v93, v95
    v_cvt_pk_bf16_f32 v81, v92, v93
    v_lshlrev_b32 v88, 16, v82
    v_and_b32 v89, 0xffff0000, v82
    v_lshlrev_b32 v90, 16, v98
    v_and_b32 v91, 0xffff0000, v98
    v_add_f32 v88, v88, v90
    v_add_f32 v89, v89, v91
    v_cvt_pk_bf16_f32 v82, v88, v89
    v_lshlrev_b32 v92, 16, v83
    v_and_b32 v93, 0xffff0000, v83
    v_lshlrev_b32 v94, 16, v99
    v_and_b32 v95, 0xffff0000, v99
    v_add_f32 v92, v92, v94
    v_add_f32 v93, v93, v95
    v_cvt_pk_bf16_f32 v83, v92, v93
    buffer_store_dwordx4 v[80:83], v3, s[8:11], s26 offen offset:0 sc1
    v_cvt_pk_bf16_f32 v84, v56, v57
    v_cvt_pk_bf16_f32 v85, v58, v59
    v_cvt_pk_bf16_f32 v86, v60, v61
    v_cvt_pk_bf16_f32 v87, v62, v63
    s_nop 1
    v_permlane32_swap_b32 v84, v86
    v_permlane32_swap_b32 v85, v87
    s_nop 1
    v_lshlrev_b32 v88, 16, v84
    v_and_b32 v89, 0xffff0000, v84
    v_lshlrev_b32 v90, 16, v100
    v_and_b32 v91, 0xffff0000, v100
    v_add_f32 v88, v88, v90
    v_add_f32 v89, v89, v91
    v_cvt_pk_bf16_f32 v84, v88, v89
    v_lshlrev_b32 v92, 16, v85
    v_and_b32 v93, 0xffff0000, v85
    v_lshlrev_b32 v94, 16, v101
    v_and_b32 v95, 0xffff0000, v101
    v_add_f32 v92, v92, v94
    v_add_f32 v93, v93, v95
    v_cvt_pk_bf16_f32 v85, v92, v93
    v_lshlrev_b32 v88, 16, v86
    v_and_b32 v89, 0xffff0000, v86
    v_lshlrev_b32 v90, 16, v102
    v_and_b32 v91, 0xffff0000, v102
    v_add_f32 v88, v88, v90
    v_add_f32 v89, v89, v91
    v_cvt_pk_bf16_f32 v86, v88, v89
    v_lshlrev_b32 v92, 16, v87
    v_and_b32 v93, 0xffff0000, v87
    v_lshlrev_b32 v94, 16, v103
    v_and_b32 v95, 0xffff0000, v103
    v_add_f32 v92, v92, v94
    v_add_f32 v93, v93, v95
    v_cvt_pk_bf16_f32 v87, v92, v93
    buffer_store_dwordx4 v[84:87], v3, s[8:11], s26 offen offset:32 sc1
    s_waitcnt vmcnt(0)
    s_mov_b64 exec, 1
    s_add_u32 s26, s48, s20
    buffer_store_dword v5, v4, s[8:11], s26 offen sc1
    s_mov_b64 exec, -1
    s_add_u32 s20, s20, 128
    s_add_u32 s19, s19, 40960
    s_add_u32 s16, s16, 40960
    s_cmp_eq_u32 s16, 122880
    s_cselect_b32 s16, 0, s16
    s_add_u32 s14, s14, 1
    s_cmp_ge_u32 s14, s15
    s_cbranch_scc1 layerb1_kernel_ab_fin
    s_add_u32 s23, s14, 2
    s_cmp_lg_u32 s13, 0
    s_cbranch_scc1 layerb1_kernel_ab_ow6
    s_min_u32 s28, s23, 63
    s_cmp_gt_u32 s22, s28
    s_cbranch_scc1 layerb1_kernel_ab_ow6
layerb1_kernel_ab_op6:
    buffer_load_dwordx4 v[116:119], v1, s[8:11], s29 offen sc1
    s_waitcnt vmcnt(0)
    v_min_u32 v116, v116, v117
    v_min_u32 v118, v118, v119
    v_min_u32 v114, v116, v118
    v_cmp_eq_u32 vcc, 0, v114
    s_nop 1
    s_ff1_i32_b64 s22, vcc
    s_min_u32 s22, s22, 64
    s_and_b32 s22, s22, 0x7c
    s_sub_u32 s30, s30, 1
    s_cbranch_scc1 layerb1_kernel_bail
    s_cmp_gt_u32 s22, s28
    s_cbranch_scc0 layerb1_kernel_ab_op6
layerb1_kernel_ab_ow6:
    s_barrier
    v_add_u32 v2, s16, v1
    ds_read_b128 v[16:19], v2 offset:0
    ds_read_b128 v[20:23], v2 offset:1024
    ds_read_b128 v[24:27], v2 offset:2048
    ds_read_b128 v[28:31], v2 offset:3072
    ds_read_b128 v[32:35], v2 offset:4096
    ds_read_b128 v[36:39], v2 offset:5120
    s_add_u32 s27, s19, 40960
    s_cmp_ge_u32 s14, 63
    s_cselect_b32 s27, s19, s27
    buffer_load_dwordx4 v[96:99], v3, s[52:55], s27 offen offset:0
    buffer_load_dwordx4 v[100:103], v3, s[52:55], s27 offen offset:32
    s_add_u32 s23, s14, 2
    s_min_u32 s24, s23, 63
    s_mul_i32 s24, s24, 40960
    s_add_u32 s24, s24, s18
    s_mul_i32 s25, s13, 10240
    s_add_u32 s25, s25, s17
    s_add_u32 s17, s17, 40960
    s_cmp_eq_u32 s17, 122880
    s_cselect_b32 s17, 0, s17
    ds_read_b128 v[40:43], v2 offset:6144
    s_waitcnt lgkmcnt(6)
    v_mfma_f32_32x32x16_bf16 v[48:63], a[0:3], v[16:19], 0
    ds_read_b128 v[44:47], v2 offset:7168
    s_waitcnt lgkmcnt(6)
    v_mfma_f32_32x32x16_bf16 v[64:79], a[4:7], v[20:23], 0
    s_mov_b32 m0, s25
    s_nop 0
    buffer_load_dwordx4 v1, s[8:11], s24 offen offset:0 sc1 lds
    ds_read_b128 v[16:19], v2 offset:8192
    s_waitcnt lgkmcnt(6)
    v_mfma_f32_32x32x16_bf16 v[48:63], a[8:11], v[24:27], v[48:63]
    ds_read_b128 v[20:23], v2 offset:9216
    s_waitcnt lgkmcnt(6)
    v_mfma_f32_32x32x16_bf16 v[64:79], a[12:15], v[28:31], v[64:79]
    ds_read_b128 v[24:27], v2 offset:10240
    s_waitcnt lgkmcnt(6)
    v_mfma_f32_32x32x16_bf16 v[48:63], a[16:19], v[32:35], v[48:63]
    buffer_load_dwordx4 v1, s[8:11], s24 offen offset:1024 sc1 lds
    ds_read_b128 v[28:31], v2 offset:11264
    s_waitcnt lgkmcnt(6)
    v_mfma_f32_32x32x16_bf16 v[64:79], a[20:23], v[36:39], v[64:79]
    ds_read_b128 v[32:35], v2 offset:12288
    s_waitcnt lgkmcnt(6)
    v_mfma_f32_32x32x16_bf16 v[48:63], a[24:27], v[40:43], v[48:63]
    ds_read_b128 v[36:39], v2 offset:13312
    s_waitcnt lgkmcnt(6)
    v_mfma_f32_32x32x16_bf16 v[64:79], a[28:31], v[44:47], v[64:79]
    buffer_load_dwordx4 v1, s[8:11], s24 offen offset:2048 sc1 lds
    ds_read_b128 v[40:43], v2 offset:14336
    s_waitcnt lgkmcnt(6)
    v_mfma_f32_32x32x16_bf16 v[48:63], a[32:35], v[16:19], v[48:63]
    ds_read_b128 v[44:47], v2 offset:15360
    s_waitcnt lgkmcnt(6)
    v_mfma_f32_32x32x16_bf16 v[64:79], a[36:39], v[20:23], v[64:79]
    ds_read_b128 v[16:19], v2 offset:16384
    s_waitcnt lgkmcnt(6)
    v_mfma_f32_32x32x16_bf16 v[48:63], a[40:43], v[24:27], v[48:63]
    buffer_load_dwordx4 v1, s[8:11], s24 offen offset:3072 sc1 lds
    ds_read_b128 v[20:23], v2 offset:17408
    s_waitcnt lgkmcnt(6)
    v_mfma_f32_32x32x16_bf16 v[64:79], a[44:47], v[28:31], v[64:79]
    ds_read_b128 v[24:27], v2 offset:18432
    s_waitcnt lgkmcnt(6)
    v_mfma_f32_32x32x16_bf16 v[48:63], a[48:51], v[32:35], v[48:63]
    ds_read_b128 v[28:31], v2 offset:19456
    s_waitcnt lgkmcnt(6)
    v_mfma_f32_32x32x16_bf16 v[64:79], a[52:55], v[36:39], v[64:79]
    s_add_u32 s24, s24, 4096
    s_add_u32 s25, s25, 4096
    s_mov_b32 m0, s25
    s_nop 0
    buffer_load_dwordx4 v1, s[8:11], s24 offen offset:0 sc1 lds
    ds_read_b128 v[32:35], v2 offset:20480
    s_waitcnt lgkmcnt(6)
    v_mfma_f32_32x32x16_bf16 v[48:63], a[56:59], v[40:43], v[48:63]
    ds_read_b128 v[36:39], v2 offset:21504
    s_waitcnt lgkmcnt(6)
    v_mfma_f32_32x32x16_bf16 v[64:79], a[60:63], v[44:47], v[64:79]
    ds_read_b128 v[40:43], v2 offset:22528
    s_waitcnt lgkmcnt(6)
    v_mfma_f32_32x32x16_bf16 v[48:63], a[64:67], v[16:19], v[48:63]
    buffer_load_dwordx4 v1, s[8:11], s24 offen offset:1024 sc1 lds
    ds_read_b128 v[44:47], v2 offset:23552
    s_waitcnt lgkmcnt(6)
    v_mfma_f32_32x32x16_bf16 v[64:79], a[68:71], v[20:23], v[64:79]
    ds_read_b128 v[16:19], v2 offset:24576
    s_waitcnt lgkmcnt(6)
    v_mfma_f32_32x32x16_bf16 v[48:63], a[72:75], v[24:27], v[48:63]
    ds_read_b128 v[20:23], v2 offset:25600
    s_waitcnt lgkmcnt(6)
    v_mfma_f32_32x32x16_bf16 v[64:79], a[76:79], v[28:31], v[64:79]
    buffer_load_dwordx4 v1, s[8:11], s24 offen offset:2048 sc1 lds
    ds_read_b128 v[24:27], v2 offset:26624
    s_waitcnt lgkmcnt(6)
    v_mfma_f32_32x32x16_bf16 v[48:63], a[80:83], v[32:35], v[48:63]
    ds_read_b128 v[28:31], v2 offset:27648
    s_waitcnt lgkmcnt(6)
    v_mfma_f32_32x32x16_bf16 v[64:79], a[84:87], v[36:39], v[64:79]
    ds_read_b128 v[32:35], v2 offset:28672
    s_waitcnt lgkmcnt(6)
    v_mfma_f32_32x32x16_bf16 v[48:63], a[88:91], v[40:43], v[48:63]
    buffer_load_dwordx4 v1, s[8:11], s24 offen offset:3072 sc1 lds
    ds_read_b128 v[36:39], v2 offset:29696
    s_waitcnt lgkmcnt(6)
    v_mfma_f32_32x32x16_bf16 v[64:79], a[92:95], v[44:47], v[64:79]
    ds_read_b128 v[40:43], v2 offset:30720
    s_waitcnt lgkmcnt(6)
    v_mfma_f32_32x32x16_bf16 v[48:63], a[96:99], v[16:19], v[48:63]
    ds_read_b128 v[44:47], v2 offset:31744
    s_waitcnt lgkmcnt(6)
    v_mfma_f32_32x32x16_bf16 v[64:79], a[100:103], v[20:23], v[64:79]
    s_add_u32 s24, s24, 4096
    s_add_u32 s25, s25, 4096
    s_mov_b32 m0, s25
    s_nop 0
    buffer_load_dwordx4 v1, s[8:11], s24 offen offset:0 sc1 lds
    ds_read_b128 v[16:19], v2 offset:32768
    s_waitcnt lgkmcnt(6)
    v_mfma_f32_32x32x16_bf16 v[48:63], a[104:107], v[24:27], v[48:63]
    ds_read_b128 v[20:23], v2 offset:33792
    s_waitcnt lgkmcnt(6)
    v_mfma_f32_32x32x16_bf16 v[64:79], a[108:111], v[28:31], v[64:79]
    ds_read_b128 v[24:27], v2 offset:34816
    s_waitcnt lgkmcnt(6)
    v_mfma_f32_32x32x16_bf16 v[48:63], a[112:115], v[32:35], v[48:63]
    buffer_load_dwordx4 v1, s[8:11], s24 offen offset:1024 sc1 lds
    ds_read_b128 v[28:31], v2 offset:35840
    s_waitcnt lgkmcnt(6)
    v_mfma_f32_32x32x16_bf16 v[64:79], a[116:119], v[36:39], v[64:79]
    ds_read_b128 v[32:35], v2 offset:36864
    s_waitcnt lgkmcnt(6)
    v_mfma_f32_32x32x16_bf16 v[48:63], a[120:123], v[40:43], v[48:63]
    ds_read_b128 v[36:39], v2 offset:37888
    s_waitcnt lgkmcnt(6)
    v_mfma_f32_32x32x16_bf16 v[64:79], a[124:127], v[44:47], v[64:79]
    ds_read_b128 v[40:43], v2 offset:38912
    s_waitcnt lgkmcnt(6)
    v_mfma_f32_32x32x16_bf16 v[48:63], a[128:131], v[16:19], v[48:63]
    ds_read_b128 v[44:47], v2 offset:39936
    s_waitcnt lgkmcnt(6)
    v_mfma_f32_32x32x16_bf16 v[64:79], a[132:135], v[20:23], v[64:79]
    s_waitcnt lgkmcnt(5)
    v_mfma_f32_32x32x16_bf16 v[48:63], a[136:139], v[24:27], v[48:63]
    s_waitcnt lgkmcnt(4)
    v_mfma_f32_32x32x16_bf16 v[64:79], a[140:143], v[28:31], v[64:79]
    s_waitcnt lgkmcnt(3)
    v_mfma_f32_32x32x16_bf16 v[48:63], a[144:147], v[32:35], v[48:63]
    s_waitcnt lgkmcnt(2)
    v_mfma_f32_32x32x16_bf16 v[64:79], a[148:151], v[36:39], v[64:79]
    s_waitcnt lgkmcnt(1)
    v_mfma_f32_32x32x16_bf16 v[48:63], a[152:155], v[40:43], v[48:63]
    s_waitcnt lgkmcnt(0)
    v_mfma_f32_32x32x16_bf16 v[64:79], a[156:159], v[44:47], v[64:79]
    s_waitcnt vmcnt(12)
    s_nop 7
    s_nop 3
    v_add_f32 v48, v48, v64
    v_add_f32 v49, v49, v65
    v_add_f32 v50, v50, v66
    v_add_f32 v51, v51, v67
    v_add_f32 v52, v52, v68
    v_add_f32 v53, v53, v69
    v_add_f32 v54, v54, v70
    v_add_f32 v55, v55, v71
    v_add_f32 v56, v56, v72
    v_add_f32 v57, v57, v73
    v_add_f32 v58, v58, v74
    v_add_f32 v59, v59, v75
    v_add_f32 v60, v60, v76
    v_add_f32 v61, v61, v77
    v_add_f32 v62, v62, v78
    v_add_f32 v63, v63, v79
    s_add_u32 s26, s19, 226492416
    v_cvt_pk_bf16_f32 v80, v48, v49
    v_cvt_pk_bf16_f32 v81, v50, v51
    v_cvt_pk_bf16_f32 v82, v52, v53
    v_cvt_pk_bf16_f32 v83, v54, v55
    s_nop 1
    v_permlane32_swap_b32 v80, v82
    v_permlane32_swap_b32 v81, v83
    s_nop 1
    v_lshlrev_b32 v88, 16, v80
    v_and_b32 v89, 0xffff0000, v80
    v_lshlrev_b32 v90, 16, v104
    v_and_b32 v91, 0xffff0000, v104
    v_add_f32 v88, v88, v90
    v_add_f32 v89, v89, v91
    v_cvt_pk_bf16_f32 v80, v88, v89
    v_lshlrev_b32 v92, 16, v81
    v_and_b32 v93, 0xffff0000, v81
    v_lshlrev_b32 v94, 16, v105
    v_and_b32 v95, 0xffff0000, v105
    v_add_f32 v92, v92, v94
    v_add_f32 v93, v93, v95
    v_cvt_pk_bf16_f32 v81, v92, v93
    v_lshlrev_b32 v88, 16, v82
    v_and_b32 v89, 0xffff0000, v82
    v_lshlrev_b32 v90, 16, v106
    v_and_b32 v91, 0xffff0000, v106
    v_add_f32 v88, v88, v90
    v_add_f32 v89, v89, v91
    v_cvt_pk_bf16_f32 v82, v88, v89
    v_lshlrev_b32 v92, 16, v83
    v_and_b32 v93, 0xffff0000, v83
    v_lshlrev_b32 v94, 16, v107
    v_and_b32 v95, 0xffff0000, v107
    v_add_f32 v92, v92, v94
    v_add_f32 v93, v93, v95
    v_cvt_pk_bf16_f32 v83, v92, v93
    buffer_store_dwordx4 v[80:83], v3, s[8:11], s26 offen offset:0 sc1
    v_cvt_pk_bf16_f32 v84, v56, v57
    v_cvt_pk_bf16_f32 v85, v58, v59
    v_cvt_pk_bf16_f32 v86, v60, v61
    v_cvt_pk_bf16_f32 v87, v62, v63
    s_nop 1
    v_permlane32_swap_b32 v84, v86
    v_permlane32_swap_b32 v85, v87
    s_nop 1
    v_lshlrev_b32 v88, 16, v84
    v_and_b32 v89, 0xffff0000, v84
    v_lshlrev_b32 v90, 16, v108
    v_and_b32 v91, 0xffff0000, v108
    v_add_f32 v88, v88, v90
    v_add_f32 v89, v89, v91
    v_cvt_pk_bf16_f32 v84, v88, v89
    v_lshlrev_b32 v92, 16, v85
    v_and_b32 v93, 0xffff0000, v85
    v_lshlrev_b32 v94, 16, v109
    v_and_b32 v95, 0xffff0000, v109
    v_add_f32 v92, v92, v94
    v_add_f32 v93, v93, v95
    v_cvt_pk_bf16_f32 v85, v92, v93
    v_lshlrev_b32 v88, 16, v86
    v_and_b32 v89, 0xffff0000, v86
    v_lshlrev_b32 v90, 16, v110
    v_and_b32 v91, 0xffff0000, v110
    v_add_f32 v88, v88, v90
    v_add_f32 v89, v89, v91
    v_cvt_pk_bf16_f32 v86, v88, v89
    v_lshlrev_b32 v92, 16, v87
    v_and_b32 v93, 0xffff0000, v87
    v_lshlrev_b32 v94, 16, v111
    v_and_b32 v95, 0xffff0000, v111
    v_add_f32 v92, v92, v94
    v_add_f32 v93, v93, v95
    v_cvt_pk_bf16_f32 v87, v92, v93
    buffer_store_dwordx4 v[84:87], v3, s[8:11], s26 offen offset:32 sc1
    s_waitcnt vmcnt(0)
    s_mov_b64 exec, 1
    s_add_u32 s26, s48, s20
    buffer_store_dword v5, v4, s[8:11], s26 offen sc1
    s_mov_b64 exec, -1
    s_add_u32 s20, s20, 128
    s_add_u32 s19, s19, 40960
    s_add_u32 s16, s16, 40960
    s_cmp_eq_u32 s16, 122880
    s_cselect_b32 s16, 0, s16
    s_add_u32 s14, s14, 1
    s_cmp_ge_u32 s14, s15
    s_cbranch_scc1 layerb1_kernel_ab_fin
    s_add_u32 s23, s14, 2
    s_cmp_lg_u32 s13, 0
    s_cbranch_scc1 layerb1_kernel_ab_ow7
    s_min_u32 s28, s23, 63
    s_cmp_gt_u32 s22, s28
    s_cbranch_scc1 layerb1_kernel_ab_ow7
layerb1_kernel_ab_op7:
    buffer_load_dwordx4 v[116:119], v1, s[8:11], s29 offen sc1
    s_waitcnt vmcnt(0)
    v_min_u32 v116, v116, v117
    v_min_u32 v118, v118, v119
    v_min_u32 v114, v116, v118
    v_cmp_eq_u32 vcc, 0, v114
    s_nop 1
    s_ff1_i32_b64 s22, vcc
    s_min_u32 s22, s22, 64
    s_and_b32 s22, s22, 0x7c
    s_sub_u32 s30, s30, 1
    s_cbranch_scc1 layerb1_kernel_bail
    s_cmp_gt_u32 s22, s28
    s_cbranch_scc0 layerb1_kernel_ab_op7
layerb1_kernel_ab_ow7:
    s_barrier
    v_add_u32 v2, s16, v1
    ds_read_b128 v[16:19], v2 offset:0
    ds_read_b128 v[20:23], v2 offset:1024
    ds_read_b128 v[24:27], v2 offset:2048
    ds_read_b128 v[28:31], v2 offset:3072
    ds_read_b128 v[32:35], v2 offset:4096
    ds_read_b128 v[36:39], v2 offset:5120
    s_add_u32 s27, s19, 40960
    s_cmp_ge_u32 s14, 63
    s_cselect_b32 s27, s19, s27
    buffer_load_dwordx4 v[104:107], v3, s[52:55], s27 offen offset:0
    buffer_load_dwordx4 v[108:111], v3, s[52:55], s27 offen offset:32
    s_add_u32 s23, s14, 2
    s_min_u32 s24, s23, 63
    s_mul_i32 s24, s24, 40960
    s_add_u32 s24, s24, s18
    s_mul_i32 s25, s13, 10240
    s_add_u32 s25, s25, s17
    s_add_u32 s17, s17, 40960
    s_cmp_eq_u32 s17, 122880
    s_cselect_b32 s17, 0, s17
    ds_read_b128 v[40:43], v2 offset:6144
    s_waitcnt lgkmcnt(6)
    v_mfma_f32_32x32x16_bf16 v[48:63], a[0:3], v[16:19], 0
    ds_read_b128 v[44:47], v2 offset:7168
    s_waitcnt lgkmcnt(6)
    v_mfma_f32_32x32x16_bf16 v[64:79], a[4:7], v[20:23], 0
    s_mov_b32 m0, s25
    s_nop 0
    buffer_load_dwordx4 v1, s[8:11], s24 offen offset:0 sc1 lds
    ds_read_b128 v[16:19], v2 offset:8192
    s_waitcnt lgkmcnt(6)
    v_mfma_f32_32x32x16_bf16 v[48:63], a[8:11], v[24:27], v[48:63]
    ds_read_b128 v[20:23], v2 offset:9216
    s_waitcnt lgkmcnt(6)
    v_mfma_f32_32x32x16_bf16 v[64:79], a[12:15], v[28:31], v[64:79]
    ds_read_b128 v[24:27], v2 offset:10240
    s_waitcnt lgkmcnt(6)
    v_mfma_f32_32x32x16_bf16 v[48:63], a[16:19], v[32:35], v[48:63]
    buffer_load_dwordx4 v1, s[8:11], s24 offen offset:1024 sc1 lds
    ds_read_b128 v[28:31], v2 offset:11264
    s_waitcnt lgkmcnt(6)
    v_mfma_f32_32x32x16_bf16 v[64:79], a[20:23], v[36:39], v[64:79]
    ds_read_b128 v[32:35], v2 offset:12288
    s_waitcnt lgkmcnt(6)
    v_mfma_f32_32x32x16_bf16 v[48:63], a[24:27], v[40:43], v[48:63]
    ds_read_b128 v[36:39], v2 offset:13312
    s_waitcnt lgkmcnt(6)
    v_mfma_f32_32x32x16_bf16 v[64:79], a[28:31], v[44:47], v[64:79]
    buffer_load_dwordx4 v1, s[8:11], s24 offen offset:2048 sc1 lds
    ds_read_b128 v[40:43], v2 offset:14336
    s_waitcnt lgkmcnt(6)
    v_mfma_f32_32x32x16_bf16 v[48:63], a[32:35], v[16:19], v[48:63]
    ds_read_b128 v[44:47], v2 offset:15360
    s_waitcnt lgkmcnt(6)
    v_mfma_f32_32x32x16_bf16 v[64:79], a[36:39], v[20:23], v[64:79]
    ds_read_b128 v[16:19], v2 offset:16384
    s_waitcnt lgkmcnt(6)
    v_mfma_f32_32x32x16_bf16 v[48:63], a[40:43], v[24:27], v[48:63]
    buffer_load_dwordx4 v1, s[8:11], s24 offen offset:3072 sc1 lds
    ds_read_b128 v[20:23], v2 offset:17408
    s_waitcnt lgkmcnt(6)
    v_mfma_f32_32x32x16_bf16 v[64:79], a[44:47], v[28:31], v[64:79]
    ds_read_b128 v[24:27], v2 offset:18432
    s_waitcnt lgkmcnt(6)
    v_mfma_f32_32x32x16_bf16 v[48:63], a[48:51], v[32:35], v[48:63]
    ds_read_b128 v[28:31], v2 offset:19456
    s_waitcnt lgkmcnt(6)
    v_mfma_f32_32x32x16_bf16 v[64:79], a[52:55], v[36:39], v[64:79]
    s_add_u32 s24, s24, 4096
    s_add_u32 s25, s25, 4096
    s_mov_b32 m0, s25
    s_nop 0
    buffer_load_dwordx4 v1, s[8:11], s24 offen offset:0 sc1 lds
    ds_read_b128 v[32:35], v2 offset:20480
    s_waitcnt lgkmcnt(6)
    v_mfma_f32_32x32x16_bf16 v[48:63], a[56:59], v[40:43], v[48:63]
    ds_read_b128 v[36:39], v2 offset:21504
    s_waitcnt lgkmcnt(6)
    v_mfma_f32_32x32x16_bf16 v[64:79], a[60:63], v[44:47], v[64:79]
    ds_read_b128 v[40:43], v2 offset:22528
    s_waitcnt lgkmcnt(6)
    v_mfma_f32_32x32x16_bf16 v[48:63], a[64:67], v[16:19], v[48:63]
    buffer_load_dwordx4 v1, s[8:11], s24 offen offset:1024 sc1 lds
    ds_read_b128 v[44:47], v2 offset:23552
    s_waitcnt lgkmcnt(6)
    v_mfma_f32_32x32x16_bf16 v[64:79], a[68:71], v[20:23], v[64:79]
    ds_read_b128 v[16:19], v2 offset:24576
    s_waitcnt lgkmcnt(6)
    v_mfma_f32_32x32x16_bf16 v[48:63], a[72:75], v[24:27], v[48:63]
    ds_read_b128 v[20:23], v2 offset:25600
    s_waitcnt lgkmcnt(6)
    v_mfma_f32_32x32x16_bf16 v[64:79], a[76:79], v[28:31], v[64:79]
    buffer_load_dwordx4 v1, s[8:11], s24 offen offset:2048 sc1 lds
    ds_read_b128 v[24:27], v2 offset:26624
    s_waitcnt lgkmcnt(6)
    v_mfma_f32_32x32x16_bf16 v[48:63], a[80:83], v[32:35], v[48:63]
    ds_read_b128 v[28:31], v2 offset:27648
    s_waitcnt lgkmcnt(6)
    v_mfma_f32_32x32x16_bf16 v[64:79], a[84:87], v[36:39], v[64:79]
    ds_read_b128 v[32:35], v2 offset:28672
    s_waitcnt lgkmcnt(6)
    v_mfma_f32_32x32x16_bf16 v[48:63], a[88:91], v[40:43], v[48:63]
    buffer_load_dwordx4 v1, s[8:11], s24 offen offset:3072 sc1 lds
    ds_read_b128 v[36:39], v2 offset:29696
    s_waitcnt lgkmcnt(6)
    v_mfma_f32_32x32x16_bf16 v[64:79], a[92:95], v[44:47], v[64:79]
    ds_read_b128 v[40:43], v2 offset:30720
    s_waitcnt lgkmcnt(6)
    v_mfma_f32_32x32x16_bf16 v[48:63], a[96:99], v[16:19], v[48:63]
    ds_read_b128 v[44:47], v2 offset:31744
    s_waitcnt lgkmcnt(6)
    v_mfma_f32_32x32x16_bf16 v[64:79], a[100:103], v[20:23], v[64:79]
    s_add_u32 s24, s24, 4096
    s_add_u32 s25, s25, 4096
    s_mov_b32 m0, s25
    s_nop 0
    buffer_load_dwordx4 v1, s[8:11], s24 offen offset:0 sc1 lds
    ds_read_b128 v[16:19], v2 offset:32768
    s_waitcnt lgkmcnt(6)
    v_mfma_f32_32x32x16_bf16 v[48:63], a[104:107], v[24:27], v[48:63]
    ds_read_b128 v[20:23], v2 offset:33792
    s_waitcnt lgkmcnt(6)
    v_mfma_f32_32x32x16_bf16 v[64:79], a[108:111], v[28:31], v[64:79]
    ds_read_b128 v[24:27], v2 offset:34816
    s_waitcnt lgkmcnt(6)
    v_mfma_f32_32x32x16_bf16 v[48:63], a[112:115], v[32:35], v[48:63]
    buffer_load_dwordx4 v1, s[8:11], s24 offen offset:1024 sc1 lds
    ds_read_b128 v[28:31], v2 offset:35840
    s_waitcnt lgkmcnt(6)
    v_mfma_f32_32x32x16_bf16 v[64:79], a[116:119], v[36:39], v[64:79]
    ds_read_b128 v[32:35], v2 offset:36864
    s_waitcnt lgkmcnt(6)
    v_mfma_f32_32x32x16_bf16 v[48:63], a[120:123], v[40:43], v[48:63]
    ds_read_b128 v[36:39], v2 offset:37888
    s_waitcnt lgkmcnt(6)
    v_mfma_f32_32x32x16_bf16 v[64:79], a[124:127], v[44:47], v[64:79]
    ds_read_b128 v[40:43], v2 offset:38912
    s_waitcnt lgkmcnt(6)
    v_mfma_f32_32x32x16_bf16 v[48:63], a[128:131], v[16:19], v[48:63]
    ds_read_b128 v[44:47], v2 offset:39936
    s_waitcnt lgkmcnt(6)
    v_mfma_f32_32x32x16_bf16 v[64:79], a[132:135], v[20:23], v[64:79]
    s_waitcnt lgkmcnt(5)
    v_mfma_f32_32x32x16_bf16 v[48:63], a[136:139], v[24:27], v[48:63]
    s_waitcnt lgkmcnt(4)
    v_mfma_f32_32x32x16_bf16 v[64:79], a[140:143], v[28:31], v[64:79]
    s_waitcnt lgkmcnt(3)
    v_mfma_f32_32x32x16_bf16 v[48:63], a[144:147], v[32:35], v[48:63]
    s_waitcnt lgkmcnt(2)
    v_mfma_f32_32x32x16_bf16 v[64:79], a[148:151], v[36:39], v[64:79]
    s_waitcnt lgkmcnt(1)
    v_mfma_f32_32x32x16_bf16 v[48:63], a[152:155], v[40:43], v[48:63]
    s_waitcnt lgkmcnt(0)
    v_mfma_f32_32x32x16_bf16 v[64:79], a[156:159], v[44:47], v[64:79]
    s_waitcnt vmcnt(12)
    s_nop 7
    s_nop 3
    v_add_f32 v48, v48, v64
    v_add_f32 v49, v49, v65
    v_add_f32 v50, v50, v66
    v_add_f32 v51, v51, v67
    v_add_f32 v52, v52, v68
    v_add_f32 v53, v53, v69
    v_add_f32 v54, v54, v70
    v_add_f32 v55, v55, v71
    v_add_f32 v56, v56, v72
    v_add_f32 v57, v57, v73
    v_add_f32 v58, v58, v74
    v_add_f32 v59, v59, v75
    v_add_f32 v60, v60, v76
    v_add_f32 v61, v61, v77
    v_add_f32 v62, v62, v78
    v_add_f32 v63, v63, v79
    s_add_u32 s26, s19, 226492416
    v_cvt_pk_bf16_f32 v80, v48, v49
    v_cvt_pk_bf16_f32 v81, v50, v51
    v_cvt_pk_bf16_f32 v82, v52, v53
    v_cvt_pk_bf16_f32 v83, v54, v55
    s_nop 1
    v_permlane32_swap_b32 v80, v82
    v_permlane32_swap_b32 v81, v83
    s_nop 1
    v_lshlrev_b32 v88, 16, v80
    v_and_b32 v89, 0xffff0000, v80
    v_lshlrev_b32 v90, 16, v96
    v_and_b32 v91, 0xffff0000, v96
    v_add_f32 v88, v88, v90
    v_add_f32 v89, v89, v91
    v_cvt_pk_bf16_f32 v80, v88, v89
    v_lshlrev_b32 v92, 16, v81
    v_and_b32 v93, 0xffff0000, v81
    v_lshlrev_b32 v94, 16, v97
    v_and_b32 v95, 0xffff0000, v97
    v_add_f32 v92, v92, v94
    v_add_f32 v93, v93, v95
    v_cvt_pk_bf16_f32 v81, v92, v93
    v_lshlrev_b32 v88, 16, v82
    v_and_b32 v89, 0xffff0000, v82
    v_lshlrev_b32 v90, 16, v98
    v_and_b32 v91, 0xffff0000, v98
    v_add_f32 v88, v88, v90
    v_add_f32 v89, v89, v91
    v_cvt_pk_bf16_f32 v82, v88, v89
    v_lshlrev_b32 v92, 16, v83
    v_and_b32 v93, 0xffff0000, v83
    v_lshlrev_b32 v94, 16, v99
    v_and_b32 v95, 0xffff0000, v99
    v_add_f32 v92, v92, v94
    v_add_f32 v93, v93, v95
    v_cvt_pk_bf16_f32 v83, v92, v93
    buffer_store_dwordx4 v[80:83], v3, s[8:11], s26 offen offset:0 sc1
    v_cvt_pk_bf16_f32 v84, v56, v57
    v_cvt_pk_bf16_f32 v85, v58, v59
    v_cvt_pk_bf16_f32 v86, v60, v61
    v_cvt_pk_bf16_f32 v87, v62, v63
    s_nop 1
    v_permlane32_swap_b32 v84, v86
    v_permlane32_swap_b32 v85, v87
    s_nop 1
    v_lshlrev_b32 v88, 16, v84
    v_and_b32 v89, 0xffff0000, v84
    v_lshlrev_b32 v90, 16, v100
    v_and_b32 v91, 0xffff0000, v100
    v_add_f32 v88, v88, v90
    v_add_f32 v89, v89, v91
    v_cvt_pk_bf16_f32 v84, v88, v89
    v_lshlrev_b32 v92, 16, v85
    v_and_b32 v93, 0xffff0000, v85
    v_lshlrev_b32 v94, 16, v101
    v_and_b32 v95, 0xffff0000, v101
    v_add_f32 v92, v92, v94
    v_add_f32 v93, v93, v95
    v_cvt_pk_bf16_f32 v85, v92, v93
    v_lshlrev_b32 v88, 16, v86
    v_and_b32 v89, 0xffff0000, v86
    v_lshlrev_b32 v90, 16, v102
    v_and_b32 v91, 0xffff0000, v102
    v_add_f32 v88, v88, v90
    v_add_f32 v89, v89, v91
    v_cvt_pk_bf16_f32 v86, v88, v89
    v_lshlrev_b32 v92, 16, v87
    v_and_b32 v93, 0xffff0000, v87
    v_lshlrev_b32 v94, 16, v103
    v_and_b32 v95, 0xffff0000, v103
    v_add_f32 v92, v92, v94
    v_add_f32 v93, v93, v95
    v_cvt_pk_bf16_f32 v87, v92, v93
    buffer_store_dwordx4 v[84:87], v3, s[8:11], s26 offen offset:32 sc1
    s_waitcnt vmcnt(0)
    s_mov_b64 exec, 1
    s_add_u32 s26, s48, s20
    buffer_store_dword v5, v4, s[8:11], s26 offen sc1
    s_mov_b64 exec, -1
    s_add_u32 s20, s20, 128
    s_add_u32 s19, s19, 40960
    s_add_u32 s16, s16, 40960
    s_cmp_eq_u32 s16, 122880
    s_cselect_b32 s16, 0, s16
    s_add_u32 s14, s14, 1
    s_cmp_ge_u32 s14, s15
    s_cbranch_scc1 layerb1_kernel_ab_fin
    s_add_u32 s23, s14, 2
    s_cmp_lg_u32 s13, 0
    s_cbranch_scc1 layerb1_kernel_ab_ow8
    s_min_u32 s28, s23, 63
    s_cmp_gt_u32 s22, s28
    s_cbranch_scc1 layerb1_kernel_ab_ow8
layerb1_kernel_ab_op8:
    buffer_load_dwordx4 v[116:119], v1, s[8:11], s29 offen sc1
    s_waitcnt vmcnt(0)
    v_min_u32 v116, v116, v117
    v_min_u32 v118, v118, v119
    v_min_u32 v114, v116, v118
    v_cmp_eq_u32 vcc, 0, v114
    s_nop 1
    s_ff1_i32_b64 s22, vcc
    s_min_u32 s22, s22, 64
    s_and_b32 s22, s22, 0x7c
    s_sub_u32 s30, s30, 1
    s_cbranch_scc1 layerb1_kernel_bail
    s_cmp_gt_u32 s22, s28
    s_cbranch_scc0 layerb1_kernel_ab_op8
layerb1_kernel_ab_ow8:
    s_barrier
    v_add_u32 v2, s16, v1
    ds_read_b128 v[16:19], v2 offset:0
    ds_read_b128 v[20:23], v2 offset:1024
    ds_read_b128 v[24:27], v2 offset:2048
    ds_read_b128 v[28:31], v2 offset:3072
    ds_read_b128 v[32:35], v2 offset:4096
    ds_read_b128 v[36:39], v2 offset:5120
    s_add_u32 s27, s19, 40960
    s_cmp_ge_u32 s14, 63
    s_cselect_b32 s27, s19, s27
    buffer_load_dwordx4 v[96:99], v3, s[52:55], s27 offen offset:0
    buffer_load_dwordx4 v[100:103], v3, s[52:55], s27 offen offset:32
    s_add_u32 s23, s14, 2
    s_min_u32 s24, s23, 63
    s_mul_i32 s24, s24, 40960
    s_add_u32 s24, s24, s18
    s_mul_i32 s25, s13, 10240
    s_add_u32 s25, s25, s17
    s_add_u32 s17, s17, 40960
    s_cmp_eq_u32 s17, 122880
    s_cselect_b32 s17, 0, s17
    ds_read_b128 v[40:43], v2 offset:6144
    s_waitcnt lgkmcnt(6)
    v_mfma_f32_32x32x16_bf16 v[48:63], a[0:3], v[16:19], 0
    ds_read_b128 v[44:47], v2 offset:7168
    s_waitcnt lgkmcnt(6)
    v_mfma_f32_32x32x16_bf16 v[64:79], a[4:7], v[20:23], 0
    s_mov_b32 m0, s25
    s_nop 0
    buffer_load_dwordx4 v1, s[8:11], s24 offen offset:0 sc1 lds
    ds_read_b128 v[16:19], v2 offset:8192
    s_waitcnt lgkmcnt(6)
    v_mfma_f32_32x32x16_bf16 v[48:63], a[8:11], v[24:27], v[48:63]
    ds_read_b128 v[20:23], v2 offset:9216
    s_waitcnt lgkmcnt(6)
    v_mfma_f32_32x32x16_bf16 v[64:79], a[12:15], v[28:31], v[64:79]
    ds_read_b128 v[24:27], v2 offset:10240
    s_waitcnt lgkmcnt(6)
    v_mfma_f32_32x32x16_bf16 v[48:63], a[16:19], v[32:35], v[48:63]
    buffer_load_dwordx4 v1, s[8:11], s24 offen offset:1024 sc1 lds
    ds_read_b128 v[28:31], v2 offset:11264
    s_waitcnt lgkmcnt(6)
    v_mfma_f32_32x32x16_bf16 v[64:79], a[20:23], v[36:39], v[64:79]
    ds_read_b128 v[32:35], v2 offset:12288
    s_waitcnt lgkmcnt(6)
    v_mfma_f32_32x32x16_bf16 v[48:63], a[24:27], v[40:43], v[48:63]
    ds_read_b128 v[36:39], v2 offset:13312
    s_waitcnt lgkmcnt(6)
    v_mfma_f32_32x32x16_bf16 v[64:79], a[28:31], v[44:47], v[64:79]
    buffer_load_dwordx4 v1, s[8:11], s24 offen offset:2048 sc1 lds
    ds_read_b128 v[40:43], v2 offset:14336
    s_waitcnt lgkmcnt(6)
    v_mfma_f32_32x32x16_bf16 v[48:63], a[32:35], v[16:19], v[48:63]
    ds_read_b128 v[44:47], v2 offset:15360
    s_waitcnt lgkmcnt(6)
    v_mfma_f32_32x32x16_bf16 v[64:79], a[36:39], v[20:23], v[64:79]
    ds_read_b128 v[16:19], v2 offset:16384
    s_waitcnt lgkmcnt(6)
    v_mfma_f32_32x32x16_bf16 v[48:63], a[40:43], v[24:27], v[48:63]
    buffer_load_dwordx4 v1, s[8:11], s24 offen offset:3072 sc1 lds
    ds_read_b128 v[20:23], v2 offset:17408
    s_waitcnt lgkmcnt(6)
    v_mfma_f32_32x32x16_bf16 v[64:79], a[44:47], v[28:31], v[64:79]
    ds_read_b128 v[24:27], v2 offset:18432
    s_waitcnt lgkmcnt(6)
    v_mfma_f32_32x32x16_bf16 v[48:63], a[48:51], v[32:35], v[48:63]
    ds_read_b128 v[28:31], v2 offset:19456
    s_waitcnt lgkmcnt(6)
    v_mfma_f32_32x32x16_bf16 v[64:79], a[52:55], v[36:39], v[64:79]
    s_add_u32 s24, s24, 4096
    s_add_u32 s25, s25, 4096
    s_mov_b32 m0, s25
    s_nop 0
    buffer_load_dwordx4 v1, s[8:11], s24 offen offset:0 sc1 lds
    ds_read_b128 v[32:35], v2 offset:20480
    s_waitcnt lgkmcnt(6)
    v_mfma_f32_32x32x16_bf16 v[48:63], a[56:59], v[40:43], v[48:63]
    ds_read_b128 v[36:39], v2 offset:21504
    s_waitcnt lgkmcnt(6)
    v_mfma_f32_32x32x16_bf16 v[64:79], a[60:63], v[44:47], v[64:79]
    ds_read_b128 v[40:43], v2 offset:22528
    s_waitcnt lgkmcnt(6)
    v_mfma_f32_32x32x16_bf16 v[48:63], a[64:67], v[16:19], v[48:63]
    buffer_load_dwordx4 v1, s[8:11], s24 offen offset:1024 sc1 lds
    ds_read_b128 v[44:47], v2 offset:23552
    s_waitcnt lgkmcnt(6)
    v_mfma_f32_32x32x16_bf16 v[64:79], a[68:71], v[20:23], v[64:79]
    ds_read_b128 v[16:19], v2 offset:24576
    s_waitcnt lgkmcnt(6)
    v_mfma_f32_32x32x16_bf16 v[48:63], a[72:75], v[24:27], v[48:63]
    ds_read_b128 v[20:23], v2 offset:25600
    s_waitcnt lgkmcnt(6)
    v_mfma_f32_32x32x16_bf16 v[64:79], a[76:79], v[28:31], v[64:79]
    buffer_load_dwordx4 v1, s[8:11], s24 offen offset:2048 sc1 lds
    ds_read_b128 v[24:27], v2 offset:26624
    s_waitcnt lgkmcnt(6)
    v_mfma_f32_32x32x16_bf16 v[48:63], a[80:83], v[32:35], v[48:63]
    ds_read_b128 v[28:31], v2 offset:27648
    s_waitcnt lgkmcnt(6)
    v_mfma_f32_32x32x16_bf16 v[64:79], a[84:87], v[36:39], v[64:79]
    ds_read_b128 v[32:35], v2 offset:28672
    s_waitcnt lgkmcnt(6)
    v_mfma_f32_32x32x16_bf16 v[48:63], a[88:91], v[40:43], v[48:63]
    buffer_load_dwordx4 v1, s[8:11], s24 offen offset:3072 sc1 lds
    ds_read_b128 v[36:39], v2 offset:29696
    s_waitcnt lgkmcnt(6)
    v_mfma_f32_32x32x16_bf16 v[64:79], a[92:95], v[44:47], v[64:79]
    ds_read_b128 v[40:43], v2 offset:30720
    s_waitcnt lgkmcnt(6)
    v_mfma_f32_32x32x16_bf16 v[48:63], a[96:99], v[16:19], v[48:63]
    ds_read_b128 v[44:47], v2 offset:31744
    s_waitcnt lgkmcnt(6)
    v_mfma_f32_32x32x16_bf16 v[64:79], a[100:103], v[20:23], v[64:79]
    s_add_u32 s24, s24, 4096
    s_add_u32 s25, s25, 4096
    s_mov_b32 m0, s25
    s_nop 0
    buffer_load_dwordx4 v1, s[8:11], s24 offen offset:0 sc1 lds
    ds_read_b128 v[16:19], v2 offset:32768
    s_waitcnt lgkmcnt(6)
    v_mfma_f32_32x32x16_bf16 v[48:63], a[104:107], v[24:27], v[48:63]
    ds_read_b128 v[20:23], v2 offset:33792
    s_waitcnt lgkmcnt(6)
    v_mfma_f32_32x32x16_bf16 v[64:79], a[108:111], v[28:31], v[64:79]
    ds_read_b128 v[24:27], v2 offset:34816
    s_waitcnt lgkmcnt(6)
    v_mfma_f32_32x32x16_bf16 v[48:63], a[112:115], v[32:35], v[48:63]
    buffer_load_dwordx4 v1, s[8:11], s24 offen offset:1024 sc1 lds
    ds_read_b128 v[28:31], v2 offset:35840
    s_waitcnt lgkmcnt(6)
    v_mfma_f32_32x32x16_bf16 v[64:79], a[116:119], v[36:39], v[64:79]
    ds_read_b128 v[32:35], v2 offset:36864
    s_waitcnt lgkmcnt(6)
    v_mfma_f32_32x32x16_bf16 v[48:63], a[120:123], v[40:43], v[48:63]
    ds_read_b128 v[36:39], v2 offset:37888
    s_waitcnt lgkmcnt(6)
    v_mfma_f32_32x32x16_bf16 v[64:79], a[124:127], v[44:47], v[64:79]
    ds_read_b128 v[40:43], v2 offset:38912
    s_waitcnt lgkmcnt(6)
    v_mfma_f32_32x32x16_bf16 v[48:63], a[128:131], v[16:19], v[48:63]
    ds_read_b128 v[44:47], v2 offset:39936
    s_waitcnt lgkmcnt(6)
    v_mfma_f32_32x32x16_bf16 v[64:79], a[132:135], v[20:23], v[64:79]
    s_waitcnt lgkmcnt(5)
    v_mfma_f32_32x32x16_bf16 v[48:63], a[136:139], v[24:27], v[48:63]
    s_waitcnt lgkmcnt(4)
    v_mfma_f32_32x32x16_bf16 v[64:79], a[140:143], v[28:31], v[64:79]
    s_waitcnt lgkmcnt(3)
    v_mfma_f32_32x32x16_bf16 v[48:63], a[144:147], v[32:35], v[48:63]
    s_waitcnt lgkmcnt(2)
    v_mfma_f32_32x32x16_bf16 v[64:79], a[148:151], v[36:39], v[64:79]
    s_waitcnt lgkmcnt(1)
    v_mfma_f32_32x32x16_bf16 v[48:63], a[152:155], v[40:43], v[48:63]
    s_waitcnt lgkmcnt(0)
    v_mfma_f32_32x32x16_bf16 v[64:79], a[156:159], v[44:47], v[64:79]
    s_waitcnt vmcnt(12)
    s_nop 7
    s_nop 3
    v_add_f32 v48, v48, v64
    v_add_f32 v49, v49, v65
    v_add_f32 v50, v50, v66
    v_add_f32 v51, v51, v67
    v_add_f32 v52, v52, v68
    v_add_f32 v53, v53, v69
    v_add_f32 v54, v54, v70
    v_add_f32 v55, v55, v71
    v_add_f32 v56, v56, v72
    v_add_f32 v57, v57, v73
    v_add_f32 v58, v58, v74
    v_add_f32 v59, v59, v75
    v_add_f32 v60, v60, v76
    v_add_f32 v61, v61, v77
    v_add_f32 v62, v62, v78
    v_add_f32 v63, v63, v79
    s_add_u32 s26, s19, 226492416
    v_cvt_pk_bf16_f32 v80, v48, v49
    v_cvt_pk_bf16_f32 v81, v50, v51
    v_cvt_pk_bf16_f32 v82, v52, v53
    v_cvt_pk_bf16_f32 v83, v54, v55
    s_nop 1
    v_permlane32_swap_b32 v80, v82
    v_permlane32_swap_b32 v81, v83
    s_nop 1
    v_lshlrev_b32 v88, 16, v80
    v_and_b32 v89, 0xffff0000, v80
    v_lshlrev_b32 v90, 16, v104
    v_and_b32 v91, 0xffff0000, v104
    v_add_f32 v88, v88, v90
    v_add_f32 v89, v89, v91
    v_cvt_pk_bf16_f32 v80, v88, v89
    v_lshlrev_b32 v92, 16, v81
    v_and_b32 v93, 0xffff0000, v81
    v_lshlrev_b32 v94, 16, v105
    v_and_b32 v95, 0xffff0000, v105
    v_add_f32 v92, v92, v94
    v_add_f32 v93, v93, v95
    v_cvt_pk_bf16_f32 v81, v92, v93
    v_lshlrev_b32 v88, 16, v82
    v_and_b32 v89, 0xffff0000, v82
    v_lshlrev_b32 v90, 16, v106
    v_and_b32 v91, 0xffff0000, v106
    v_add_f32 v88, v88, v90
    v_add_f32 v89, v89, v91
    v_cvt_pk_bf16_f32 v82, v88, v89
    v_lshlrev_b32 v92, 16, v83
    v_and_b32 v93, 0xffff0000, v83
    v_lshlrev_b32 v94, 16, v107
    v_and_b32 v95, 0xffff0000, v107
    v_add_f32 v92, v92, v94
    v_add_f32 v93, v93, v95
    v_cvt_pk_bf16_f32 v83, v92, v93
    buffer_store_dwordx4 v[80:83], v3, s[8:11], s26 offen offset:0 sc1
    v_cvt_pk_bf16_f32 v84, v56, v57
    v_cvt_pk_bf16_f32 v85, v58, v59
    v_cvt_pk_bf16_f32 v86, v60, v61
    v_cvt_pk_bf16_f32 v87, v62, v63
    s_nop 1
    v_permlane32_swap_b32 v84, v86
    v_permlane32_swap_b32 v85, v87
    s_nop 1
    v_lshlrev_b32 v88, 16, v84
    v_and_b32 v89, 0xffff0000, v84
    v_lshlrev_b32 v90, 16, v108
    v_and_b32 v91, 0xffff0000, v108
    v_add_f32 v88, v88, v90
    v_add_f32 v89, v89, v91
    v_cvt_pk_bf16_f32 v84, v88, v89
    v_lshlrev_b32 v92, 16, v85
    v_and_b32 v93, 0xffff0000, v85
    v_lshlrev_b32 v94, 16, v109
    v_and_b32 v95, 0xffff0000, v109
    v_add_f32 v92, v92, v94
    v_add_f32 v93, v93, v95
    v_cvt_pk_bf16_f32 v85, v92, v93
    v_lshlrev_b32 v88, 16, v86
    v_and_b32 v89, 0xffff0000, v86
    v_lshlrev_b32 v90, 16, v110
    v_and_b32 v91, 0xffff0000, v110
    v_add_f32 v88, v88, v90
    v_add_f32 v89, v89, v91
    v_cvt_pk_bf16_f32 v86, v88, v89
    v_lshlrev_b32 v92, 16, v87
    v_and_b32 v93, 0xffff0000, v87
    v_lshlrev_b32 v94, 16, v111
    v_and_b32 v95, 0xffff0000, v111
    v_add_f32 v92, v92, v94
    v_add_f32 v93, v93, v95
    v_cvt_pk_bf16_f32 v87, v92, v93
    buffer_store_dwordx4 v[84:87], v3, s[8:11], s26 offen offset:32 sc1
    s_waitcnt vmcnt(0)
    s_mov_b64 exec, 1
    s_add_u32 s26, s48, s20
    buffer_store_dword v5, v4, s[8:11], s26 offen sc1
    s_mov_b64 exec, -1
    s_add_u32 s20, s20, 128
    s_add_u32 s19, s19, 40960
    s_add_u32 s16, s16, 40960
    s_cmp_eq_u32 s16, 122880
    s_cselect_b32 s16, 0, s16
    s_add_u32 s14, s14, 1
    s_cmp_ge_u32 s14, s15
    s_cbranch_scc1 layerb1_kernel_ab_fin
    s_sub_u32 s20, s20, 128
layerb1_kernel_ab_loop:
    s_add_u32 s23, s14, 2
    s_cmp_lg_u32 s13, 0
    s_cbranch_scc1 layerb1_kernel_ab_ow9
    s_min_u32 s28, s23, 63
    s_cmp_gt_u32 s22, s28
    s_cbranch_scc1 layerb1_kernel_ab_ow9
layerb1_kernel_ab_op9:
    buffer_load_dwordx4 v[116:119], v1, s[8:11], s29 offen sc1
    s_waitcnt vmcnt(0)
    v_min_u32 v116, v116, v117
    v_min_u32 v118, v118, v119
    v_min_u32 v114, v116, v118
    v_cmp_eq_u32 vcc, 0, v114
    s_nop 1
    s_ff1_i32_b64 s22, vcc
    s_min_u32 s22, s22, 64
    s_and_b32 s22, s22, 0x7c
    s_sub_u32 s30, s30, 1
    s_cbranch_scc1 layerb1_kernel_bail
    s_cmp_gt_u32 s22, s28
    s_cbranch_scc0 layerb1_kernel_ab_op9
layerb1_kernel_ab_ow9:
    s_barrier
    v_add_u32 v2, s16, v1
    ds_read_b128 v[16:19], v2 offset:0
    ds_read_b128 v[20:23], v2 offset:1024
    ds_read_b128 v[24:27], v2 offset:2048
    ds_read_b128 v[28:31], v2 offset:3072
    ds_read_b128 v[32:35], v2 offset:4096
    ds_read_b128 v[36:39], v2 offset:5120
    s_add_u32 s27, s19, 40960
    s_cmp_ge_u32 s14, 63
    s_cselect_b32 s27, s19, s27
    buffer_load_dwordx4 v[104:107], v3, s[52:55], s27 offen offset:0
    buffer_load_dwordx4 v[108:111], v3, s[52:55], s27 offen offset:32
    s_add_u32 s23, s14, 2
    s_min_u32 s24, s23, 63
    s_mul_i32 s24, s24, 40960
    s_add_u32 s24, s24, s18
    s_mul_i32 s25, s13, 10240
    s_add_u32 s25, s25, s17
    s_add_u32 s17, s17, 40960
    s_cmp_eq_u32 s17, 122880
    s_cselect_b32 s17, 0, s17
    ds_read_b128 v[40:43], v2 offset:6144
    s_waitcnt lgkmcnt(6)
    v_mfma_f32_32x32x16_bf16 v[48:63], a[0:3], v[16:19], 0
    ds_read_b128 v[44:47], v2 offset:7168
    s_waitcnt lgkmcnt(6)
    v_mfma_f32_32x32x16_bf16 v[64:79], a[4:7], v[20:23], 0
    s_mov_b32 m0, s25
    s_nop 0
    buffer_load_dwordx4 v1, s[8:11], s24 offen offset:0 sc1 lds
    ds_read_b128 v[16:19], v2 offset:8192
    s_waitcnt lgkmcnt(6)
    v_mfma_f32_32x32x16_bf16 v[48:63], a[8:11], v[24:27], v[48:63]
    ds_read_b128 v[20:23], v2 offset:9216
    s_waitcnt lgkmcnt(6)
    v_mfma_f32_32x32x16_bf16 v[64:79], a[12:15], v[28:31], v[64:79]
    ds_read_b128 v[24:27], v2 offset:10240
    s_waitcnt lgkmcnt(6)
    v_mfma_f32_32x32x16_bf16 v[48:63], a[16:19], v[32:35], v[48:63]
    buffer_load_dwordx4 v1, s[8:11], s24 offen offset:1024 sc1 lds
    ds_read_b128 v[28:31], v2 offset:11264
    s_waitcnt lgkmcnt(6)
    v_mfma_f32_32x32x16_bf16 v[64:79], a[20:23], v[36:39], v[64:79]
    ds_read_b128 v[32:35], v2 offset:12288
    s_waitcnt lgkmcnt(6)
    v_mfma_f32_32x32x16_bf16 v[48:63], a[24:27], v[40:43], v[48:63]
    ds_read_b128 v[36:39], v2 offset:13312
    s_waitcnt lgkmcnt(6)
    v_mfma_f32_32x32x16_bf16 v[64:79], a[28:31], v[44:47], v[64:79]
    buffer_load_dwordx4 v1, s[8:11], s24 offen offset:2048 sc1 lds
    ds_read_b128 v[40:43], v2 offset:14336
    s_waitcnt lgkmcnt(6)
    v_mfma_f32_32x32x16_bf16 v[48:63], a[32:35], v[16:19], v[48:63]
    ds_read_b128 v[44:47], v2 offset:15360
    s_waitcnt lgkmcnt(6)
    v_mfma_f32_32x32x16_bf16 v[64:79], a[36:39], v[20:23], v[64:79]
    ds_read_b128 v[16:19], v2 offset:16384
    s_waitcnt lgkmcnt(6)
    v_mfma_f32_32x32x16_bf16 v[48:63], a[40:43], v[24:27], v[48:63]
    buffer_load_dwordx4 v1, s[8:11], s24 offen offset:3072 sc1 lds
    ds_read_b128 v[20:23], v2 offset:17408
    s_waitcnt lgkmcnt(6)
    v_mfma_f32_32x32x16_bf16 v[64:79], a[44:47], v[28:31], v[64:79]
    ds_read_b128 v[24:27], v2 offset:18432
    s_waitcnt lgkmcnt(6)
    v_mfma_f32_32x32x16_bf16 v[48:63], a[48:51], v[32:35], v[48:63]
    ds_read_b128 v[28:31], v2 offset:19456
    s_waitcnt lgkmcnt(6)
    v_mfma_f32_32x32x16_bf16 v[64:79], a[52:55], v[36:39], v[64:79]
    s_add_u32 s24, s24, 4096
    s_add_u32 s25, s25, 4096
    s_mov_b32 m0, s25
    s_nop 0
    buffer_load_dwordx4 v1, s[8:11], s24 offen offset:0 sc1 lds
    ds_read_b128 v[32:35], v2 offset:20480
    s_waitcnt lgkmcnt(6)
    v_mfma_f32_32x32x16_bf16 v[48:63], a[56:59], v[40:43], v[48:63]
    ds_read_b128 v[36:39], v2 offset:21504
    s_waitcnt lgkmcnt(6)
    v_mfma_f32_32x32x16_bf16 v[64:79], a[60:63], v[44:47], v[64:79]
    ds_read_b128 v[40:43], v2 offset:22528
    s_waitcnt lgkmcnt(6)
    v_mfma_f32_32x32x16_bf16 v[48:63], a[64:67], v[16:19], v[48:63]
    buffer_load_dwordx4 v1, s[8:11], s24 offen offset:1024 sc1 lds
    ds_read_b128 v[44:47], v2 offset:23552
    s_waitcnt lgkmcnt(6)
    v_mfma_f32_32x32x16_bf16 v[64:79], a[68:71], v[20:23], v[64:79]
    ds_read_b128 v[16:19], v2 offset:24576
    s_waitcnt lgkmcnt(6)
    v_mfma_f32_32x32x16_bf16 v[48:63], a[72:75], v[24:27], v[48:63]
    ds_read_b128 v[20:23], v2 offset:25600
    s_waitcnt lgkmcnt(6)
    v_mfma_f32_32x32x16_bf16 v[64:79], a[76:79], v[28:31], v[64:79]
    buffer_load_dwordx4 v1, s[8:11], s24 offen offset:2048 sc1 lds
    ds_read_b128 v[24:27], v2 offset:26624
    s_waitcnt lgkmcnt(6)
    v_mfma_f32_32x32x16_bf16 v[48:63], a[80:83], v[32:35], v[48:63]
    ds_read_b128 v[28:31], v2 offset:27648
    s_waitcnt lgkmcnt(6)
    v_mfma_f32_32x32x16_bf16 v[64:79], a[84:87], v[36:39], v[64:79]
    ds_read_b128 v[32:35], v2 offset:28672
    s_waitcnt lgkmcnt(6)
    v_mfma_f32_32x32x16_bf16 v[48:63], a[88:91], v[40:43], v[48:63]
    buffer_load_dwordx4 v1, s[8:11], s24 offen offset:3072 sc1 lds
    ds_read_b128 v[36:39], v2 offset:29696
    s_waitcnt lgkmcnt(6)
    v_mfma_f32_32x32x16_bf16 v[64:79], a[92:95], v[44:47], v[64:79]
    ds_read_b128 v[40:43], v2 offset:30720
    s_waitcnt lgkmcnt(6)
    v_mfma_f32_32x32x16_bf16 v[48:63], a[96:99], v[16:19], v[48:63]
    ds_read_b128 v[44:47], v2 offset:31744
    s_waitcnt lgkmcnt(6)
    v_mfma_f32_32x32x16_bf16 v[64:79], a[100:103], v[20:23], v[64:79]
    s_add_u32 s24, s24, 4096
    s_add_u32 s25, s25, 4096
    s_mov_b32 m0, s25
    s_nop 0
    buffer_load_dwordx4 v1, s[8:11], s24 offen offset:0 sc1 lds
    ds_read_b128 v[16:19], v2 offset:32768
    s_waitcnt lgkmcnt(6)
    v_mfma_f32_32x32x16_bf16 v[48:63], a[104:107], v[24:27], v[48:63]
    ds_read_b128 v[20:23], v2 offset:33792
    s_waitcnt lgkmcnt(6)
    v_mfma_f32_32x32x16_bf16 v[64:79], a[108:111], v[28:31], v[64:79]
    ds_read_b128 v[24:27], v2 offset:34816
    s_waitcnt lgkmcnt(6)
    v_mfma_f32_32x32x16_bf16 v[48:63], a[112:115], v[32:35], v[48:63]
    buffer_load_dwordx4 v1, s[8:11], s24 offen offset:1024 sc1 lds
    ds_read_b128 v[28:31], v2 offset:35840
    s_waitcnt lgkmcnt(6)
    v_mfma_f32_32x32x16_bf16 v[64:79], a[116:119], v[36:39], v[64:79]
    ds_read_b128 v[32:35], v2 offset:36864
    s_waitcnt lgkmcnt(6)
    v_mfma_f32_32x32x16_bf16 v[48:63], a[120:123], v[40:43], v[48:63]
    ds_read_b128 v[36:39], v2 offset:37888
    s_waitcnt lgkmcnt(6)
    v_mfma_f32_32x32x16_bf16 v[64:79], a[124:127], v[44:47], v[64:79]
    ds_read_b128 v[40:43], v2 offset:38912
    s_waitcnt lgkmcnt(6)
    v_mfma_f32_32x32x16_bf16 v[48:63], a[128:131], v[16:19], v[48:63]
    ds_read_b128 v[44:47], v2 offset:39936
    s_waitcnt lgkmcnt(6)
    v_mfma_f32_32x32x16_bf16 v[64:79], a[132:135], v[20:23], v[64:79]
    s_waitcnt lgkmcnt(5)
    v_mfma_f32_32x32x16_bf16 v[48:63], a[136:139], v[24:27], v[48:63]
    s_waitcnt lgkmcnt(4)
    v_mfma_f32_32x32x16_bf16 v[64:79], a[140:143], v[28:31], v[64:79]
    s_waitcnt lgkmcnt(3)
    v_mfma_f32_32x32x16_bf16 v[48:63], a[144:147], v[32:35], v[48:63]
    s_waitcnt lgkmcnt(2)
    v_mfma_f32_32x32x16_bf16 v[64:79], a[148:151], v[36:39], v[64:79]
    s_waitcnt lgkmcnt(1)
    v_mfma_f32_32x32x16_bf16 v[48:63], a[152:155], v[40:43], v[48:63]
    s_waitcnt lgkmcnt(0)
    v_mfma_f32_32x32x16_bf16 v[64:79], a[156:159], v[44:47], v[64:79]
    s_waitcnt vmcnt(15)
    s_nop 7
    s_nop 3
    v_add_f32 v48, v48, v64
    v_add_f32 v49, v49, v65
    v_add_f32 v50, v50, v66
    v_add_f32 v51, v51, v67
    v_add_f32 v52, v52, v68
    v_add_f32 v53, v53, v69
    v_add_f32 v54, v54, v70
    v_add_f32 v55, v55, v71
    v_add_f32 v56, v56, v72
    v_add_f32 v57, v57, v73
    v_add_f32 v58, v58, v74
    v_add_f32 v59, v59, v75
    v_add_f32 v60, v60, v76
    v_add_f32 v61, v61, v77
    v_add_f32 v62, v62, v78
    v_add_f32 v63, v63, v79
    s_add_u32 s26, s19, 226492416
    v_cvt_pk_bf16_f32 v80, v48, v49
    v_cvt_pk_bf16_f32 v81, v50, v51
    v_cvt_pk_bf16_f32 v82, v52, v53
    v_cvt_pk_bf16_f32 v83, v54, v55
    s_nop 1
    v_permlane32_swap_b32 v80, v82
    v_permlane32_swap_b32 v81, v83
    s_nop 1
    v_lshlrev_b32 v88, 16, v80
    v_and_b32 v89, 0xffff0000, v80
    v_lshlrev_b32 v90, 16, v96
    v_and_b32 v91, 0xffff0000, v96
    v_add_f32 v88, v88, v90
    v_add_f32 v89, v89, v91
    v_cvt_pk_bf16_f32 v80, v88, v89
    v_lshlrev_b32 v92, 16, v81
    v_and_b32 v93, 0xffff0000, v81
    v_lshlrev_b32 v94, 16, v97
    v_and_b32 v95, 0xffff0000, v97
    v_add_f32 v92, v92, v94
    v_add_f32 v93, v93, v95
    v_cvt_pk_bf16_f32 v81, v92, v93
    v_lshlrev_b32 v88, 16, v82
    v_and_b32 v89, 0xffff0000, v82
    v_lshlrev_b32 v90, 16, v98
    v_and_b32 v91, 0xffff0000, v98
    v_add_f32 v88, v88, v90
    v_add_f32 v89, v89, v91
    v_cvt_pk_bf16_f32 v82, v88, v89
    v_lshlrev_b32 v92, 16, v83
    v_and_b32 v93, 0xffff0000, v83
    v_lshlrev_b32 v94, 16, v99
    v_and_b32 v95, 0xffff0000, v99
    v_add_f32 v92, v92, v94
    v_add_f32 v93, v93, v95
    v_cvt_pk_bf16_f32 v83, v92, v93
    buffer_store_dwordx4 v[80:83], v3, s[8:11], s26 offen offset:0 sc1
    v_cvt_pk_bf16_f32 v84, v56, v57
    v_cvt_pk_bf16_f32 v85, v58, v59
    v_cvt_pk_bf16_f32 v86, v60, v61
    v_cvt_pk_bf16_f32 v87, v62, v63
    s_nop 1
    v_permlane32_swap_b32 v84, v86
    v_permlane32_swap_b32 v85, v87
    s_nop 1
    v_lshlrev_b32 v88, 16, v84
    v_and_b32 v89, 0xffff0000, v84
    v_lshlrev_b32 v90, 16, v100
    v_and_b32 v91, 0xffff0000, v100
    v_add_f32 v88, v88, v90
    v_add_f32 v89, v89, v91
    v_cvt_pk_bf16_f32 v84, v88, v89
    v_lshlrev_b32 v92, 16, v85
    v_and_b32 v93, 0xffff0000, v85
    v_lshlrev_b32 v94, 16, v101
    v_and_b32 v95, 0xffff0000, v101
    v_add_f32 v92, v92, v94
    v_add_f32 v93, v93, v95
    v_cvt_pk_bf16_f32 v85, v92, v93
    v_lshlrev_b32 v88, 16, v86
    v_and_b32 v89, 0xffff0000, v86
    v_lshlrev_b32 v90, 16, v102
    v_and_b32 v91, 0xffff0000, v102
    v_add_f32 v88, v88, v90
    v_add_f32 v89, v89, v91
    v_cvt_pk_bf16_f32 v86, v88, v89
    v_lshlrev_b32 v92, 16, v87
    v_and_b32 v93, 0xffff0000, v87
    v_lshlrev_b32 v94, 16, v103
    v_and_b32 v95, 0xffff0000, v103
    v_add_f32 v92, v92, v94
    v_add_f32 v93, v93, v95
    v_cvt_pk_bf16_f32 v87, v92, v93
    buffer_store_dwordx4 v[84:87], v3, s[8:11], s26 offen offset:32 sc1
    s_waitcnt vmcnt(15)
    s_mov_b64 exec, 1
    s_add_u32 s26, s48, s20
    buffer_store_dword v5, v4, s[8:11], s26 offen sc1
    s_mov_b64 exec, -1
    s_add_u32 s20, s20, 128
    s_add_u32 s19, s19, 40960
    s_add_u32 s16, s16, 40960
    s_cmp_eq_u32 s16, 122880
    s_cselect_b32 s16, 0, s16
    s_add_u32 s14, s14, 1
    s_cmp_ge_u32 s14, s15
    s_cbranch_scc1 layerb1_kernel_ab_fin
    s_add_u32 s23, s14, 2
    s_cmp_lg_u32 s13, 0
    s_cbranch_scc1 layerb1_kernel_ab_ow10
    s_min_u32 s28, s23, 63
    s_cmp_gt_u32 s22, s28
    s_cbranch_scc1 layerb1_kernel_ab_ow10
layerb1_kernel_ab_op10:
    buffer_load_dwordx4 v[116:119], v1, s[8:11], s29 offen sc1
    s_waitcnt vmcnt(0)
    v_min_u32 v116, v116, v117
    v_min_u32 v118, v118, v119
    v_min_u32 v114, v116, v118
    v_cmp_eq_u32 vcc, 0, v114
    s_nop 1
    s_ff1_i32_b64 s22, vcc
    s_min_u32 s22, s22, 64
    s_and_b32 s22, s22, 0x7c
    s_sub_u32 s30, s30, 1
    s_cbranch_scc1 layerb1_kernel_bail
    s_cmp_gt_u32 s22, s28
    s_cbranch_scc0 layerb1_kernel_ab_op10
layerb1_kernel_ab_ow10:
    s_barrier
    v_add_u32 v2, s16, v1
    ds_read_b128 v[16:19], v2 offset:0
    ds_read_b128 v[20:23], v2 offset:1024
    ds_read_b128 v[24:27], v2 offset:2048
    ds_read_b128 v[28:31], v2 offset:3072
    ds_read_b128 v[32:35], v2 offset:4096
    ds_read_b128 v[36:39], v2 offset:5120
    s_add_u32 s27, s19, 40960
    s_cmp_ge_u32 s14, 63
    s_cselect_b32 s27, s19, s27
    buffer_load_dwordx4 v[96:99], v3, s[52:55], s27 offen offset:0
    buffer_load_dwordx4 v[100:103], v3, s[52:55], s27 offen offset:32
    s_add_u32 s23, s14, 2
    s_min_u32 s24, s23, 63
    s_mul_i32 s24, s24, 40960
    s_add_u32 s24, s24, s18
    s_mul_i32 s25, s13, 10240
    s_add_u32 s25, s25, s17
    s_add_u32 s17, s17, 40960
    s_cmp_eq_u32 s17, 122880
    s_cselect_b32 s17, 0, s17
    ds_read_b128 v[40:43], v2 offset:6144
    s_waitcnt lgkmcnt(6)
    v_mfma_f32_32x32x16_bf16 v[48:63], a[0:3], v[16:19], 0
    ds_read_b128 v[44:47], v2 offset:7168
    s_waitcnt lgkmcnt(6)
    v_mfma_f32_32x32x16_bf16 v[64:79], a[4:7], v[20:23], 0
    s_mov_b32 m0, s25
    s_nop 0
    buffer_load_dwordx4 v1, s[8:11], s24 offen offset:0 sc1 lds
    ds_read_b128 v[16:19], v2 offset:8192
    s_waitcnt lgkmcnt(6)
    v_mfma_f32_32x32x16_bf16 v[48:63], a[8:11], v[24:27], v[48:63]
    ds_read_b128 v[20:23], v2 offset:9216
    s_waitcnt lgkmcnt(6)
    v_mfma_f32_32x32x16_bf16 v[64:79], a[12:15], v[28:31], v[64:79]
    ds_read_b128 v[24:27], v2 offset:10240
    s_waitcnt lgkmcnt(6)
    v_mfma_f32_32x32x16_bf16 v[48:63], a[16:19], v[32:35], v[48:63]
    buffer_load_dwordx4 v1, s[8:11], s24 offen offset:1024 sc1 lds
    ds_read_b128 v[28:31], v2 offset:11264
    s_waitcnt lgkmcnt(6)
    v_mfma_f32_32x32x16_bf16 v[64:79], a[20:23], v[36:39], v[64:79]
    ds_read_b128 v[32:35], v2 offset:12288
    s_waitcnt lgkmcnt(6)
    v_mfma_f32_32x32x16_bf16 v[48:63], a[24:27], v[40:43], v[48:63]
    ds_read_b128 v[36:39], v2 offset:13312
    s_waitcnt lgkmcnt(6)
    v_mfma_f32_32x32x16_bf16 v[64:79], a[28:31], v[44:47], v[64:79]
    buffer_load_dwordx4 v1, s[8:11], s24 offen offset:2048 sc1 lds
    ds_read_b128 v[40:43], v2 offset:14336
    s_waitcnt lgkmcnt(6)
    v_mfma_f32_32x32x16_bf16 v[48:63], a[32:35], v[16:19], v[48:63]
    ds_read_b128 v[44:47], v2 offset:15360
    s_waitcnt lgkmcnt(6)
    v_mfma_f32_32x32x16_bf16 v[64:79], a[36:39], v[20:23], v[64:79]
    ds_read_b128 v[16:19], v2 offset:16384
    s_waitcnt lgkmcnt(6)
    v_mfma_f32_32x32x16_bf16 v[48:63], a[40:43], v[24:27], v[48:63]
    buffer_load_dwordx4 v1, s[8:11], s24 offen offset:3072 sc1 lds
    ds_read_b128 v[20:23], v2 offset:17408
    s_waitcnt lgkmcnt(6)
    v_mfma_f32_32x32x16_bf16 v[64:79], a[44:47], v[28:31], v[64:79]
    ds_read_b128 v[24:27], v2 offset:18432
    s_waitcnt lgkmcnt(6)
    v_mfma_f32_32x32x16_bf16 v[48:63], a[48:51], v[32:35], v[48:63]
    ds_read_b128 v[28:31], v2 offset:19456
    s_waitcnt lgkmcnt(6)
    v_mfma_f32_32x32x16_bf16 v[64:79], a[52:55], v[36:39], v[64:79]
    s_add_u32 s24, s24, 4096
    s_add_u32 s25, s25, 4096
    s_mov_b32 m0, s25
    s_nop 0
    buffer_load_dwordx4 v1, s[8:11], s24 offen offset:0 sc1 lds
    ds_read_b128 v[32:35], v2 offset:20480
    s_waitcnt lgkmcnt(6)
    v_mfma_f32_32x32x16_bf16 v[48:63], a[56:59], v[40:43], v[48:63]
    ds_read_b128 v[36:39], v2 offset:21504
    s_waitcnt lgkmcnt(6)
    v_mfma_f32_32x32x16_bf16 v[64:79], a[60:63], v[44:47], v[64:79]
    ds_read_b128 v[40:43], v2 offset:22528
    s_waitcnt lgkmcnt(6)
    v_mfma_f32_32x32x16_bf16 v[48:63], a[64:67], v[16:19], v[48:63]
    buffer_load_dwordx4 v1, s[8:11], s24 offen offset:1024 sc1 lds
    ds_read_b128 v[44:47], v2 offset:23552
    s_waitcnt lgkmcnt(6)
    v_mfma_f32_32x32x16_bf16 v[64:79], a[68:71], v[20:23], v[64:79]
    ds_read_b128 v[16:19], v2 offset:24576
    s_waitcnt lgkmcnt(6)
    v_mfma_f32_32x32x16_bf16 v[48:63], a[72:75], v[24:27], v[48:63]
    ds_read_b128 v[20:23], v2 offset:25600
    s_waitcnt lgkmcnt(6)
    v_mfma_f32_32x32x16_bf16 v[64:79], a[76:79], v[28:31], v[64:79]
    buffer_load_dwordx4 v1, s[8:11], s24 offen offset:2048 sc1 lds
    ds_read_b128 v[24:27], v2 offset:26624
    s_waitcnt lgkmcnt(6)
    v_mfma_f32_32x32x16_bf16 v[48:63], a[80:83], v[32:35], v[48:63]
    ds_read_b128 v[28:31], v2 offset:27648
    s_waitcnt lgkmcnt(6)
    v_mfma_f32_32x32x16_bf16 v[64:79], a[84:87], v[36:39], v[64:79]
    ds_read_b128 v[32:35], v2 offset:28672
    s_waitcnt lgkmcnt(6)
    v_mfma_f32_32x32x16_bf16 v[48:63], a[88:91], v[40:43], v[48:63]
    buffer_load_dwordx4 v1, s[8:11], s24 offen offset:3072 sc1 lds
    ds_read_b128 v[36:39], v2 offset:29696
    s_waitcnt lgkmcnt(6)
    v_mfma_f32_32x32x16_bf16 v[64:79], a[92:95], v[44:47], v[64:79]
    ds_read_b128 v[40:43], v2 offset:30720
    s_waitcnt lgkmcnt(6)
    v_mfma_f32_32x32x16_bf16 v[48:63], a[96:99], v[16:19], v[48:63]
    ds_read_b128 v[44:47], v2 offset:31744
    s_waitcnt lgkmcnt(6)
    v_mfma_f32_32x32x16_bf16 v[64:79], a[100:103], v[20:23], v[64:79]
    s_add_u32 s24, s24, 4096
    s_add_u32 s25, s25, 4096
    s_mov_b32 m0, s25
    s_nop 0
    buffer_load_dwordx4 v1, s[8:11], s24 offen offset:0 sc1 lds
    ds_read_b128 v[16:19], v2 offset:32768
    s_waitcnt lgkmcnt(6)
    v_mfma_f32_32x32x16_bf16 v[48:63], a[104:107], v[24:27], v[48:63]
    ds_read_b128 v[20:23], v2 offset:33792
    s_waitcnt lgkmcnt(6)
    v_mfma_f32_32x32x16_bf16 v[64:79], a[108:111], v[28:31], v[64:79]
    ds_read_b128 v[24:27], v2 offset:34816
    s_waitcnt lgkmcnt(6)
    v_mfma_f32_32x32x16_bf16 v[48:63], a[112:115], v[32:35], v[48:63]
    buffer_load_dwordx4 v1, s[8:11], s24 offen offset:1024 sc1 lds
    ds_read_b128 v[28:31], v2 offset:35840
    s_waitcnt lgkmcnt(6)
    v_mfma_f32_32x32x16_bf16 v[64:79], a[116:119], v[36:39], v[64:79]
    ds_read_b128 v[32:35], v2 offset:36864
    s_waitcnt lgkmcnt(6)
    v_mfma_f32_32x32x16_bf16 v[48:63], a[120:123], v[40:43], v[48:63]
    ds_read_b128 v[36:39], v2 offset:37888
    s_waitcnt lgkmcnt(6)
    v_mfma_f32_32x32x16_bf16 v[64:79], a[124:127], v[44:47], v[64:79]
    ds_read_b128 v[40:43], v2 offset:38912
    s_waitcnt lgkmcnt(6)
    v_mfma_f32_32x32x16_bf16 v[48:63], a[128:131], v[16:19], v[48:63]
    ds_read_b128 v[44:47], v2 offset:39936
    s_waitcnt lgkmcnt(6)
    v_mfma_f32_32x32x16_bf16 v[64:79], a[132:135], v[20:23], v[64:79]
    s_waitcnt lgkmcnt(5)
    v_mfma_f32_32x32x16_bf16 v[48:63], a[136:139], v[24:27], v[48:63]
    s_waitcnt lgkmcnt(4)
    v_mfma_f32_32x32x16_bf16 v[64:79], a[140:143], v[28:31], v[64:79]
    s_waitcnt lgkmcnt(3)
    v_mfma_f32_32x32x16_bf16 v[48:63], a[144:147], v[32:35], v[48:63]
    s_waitcnt lgkmcnt(2)
    v_mfma_f32_32x32x16_bf16 v[64:79], a[148:151], v[36:39], v[64:79]
    s_waitcnt lgkmcnt(1)
    v_mfma_f32_32x32x16_bf16 v[48:63], a[152:155], v[40:43], v[48:63]
    s_waitcnt lgkmcnt(0)
    v_mfma_f32_32x32x16_bf16 v[64:79], a[156:159], v[44:47], v[64:79]
    s_waitcnt vmcnt(15)
    s_nop 7
    s_nop 3
    v_add_f32 v48, v48, v64
    v_add_f32 v49, v49, v65
    v_add_f32 v50, v50, v66
    v_add_f32 v51, v51, v67
    v_add_f32 v52, v52, v68
    v_add_f32 v53, v53, v69
    v_add_f32 v54, v54, v70
    v_add_f32 v55, v55, v71
    v_add_f32 v56, v56, v72
    v_add_f32 v57, v57, v73
    v_add_f32 v58, v58, v74
    v_add_f32 v59, v59, v75
    v_add_f32 v60, v60, v76
    v_add_f32 v61, v61, v77
    v_add_f32 v62, v62, v78
    v_add_f32 v63, v63, v79
    s_add_u32 s26, s19, 226492416
    v_cvt_pk_bf16_f32 v80, v48, v49
    v_cvt_pk_bf16_f32 v81, v50, v51
    v_cvt_pk_bf16_f32 v82, v52, v53
    v_cvt_pk_bf16_f32 v83, v54, v55
    s_nop 1
    v_permlane32_swap_b32 v80, v82
    v_permlane32_swap_b32 v81, v83
    s_nop 1
    v_lshlrev_b32 v88, 16, v80
    v_and_b32 v89, 0xffff0000, v80
    v_lshlrev_b32 v90, 16, v104
    v_and_b32 v91, 0xffff0000, v104
    v_add_f32 v88, v88, v90
    v_add_f32 v89, v89, v91
    v_cvt_pk_bf16_f32 v80, v88, v89
    v_lshlrev_b32 v92, 16, v81
    v_and_b32 v93, 0xffff0000, v81
    v_lshlrev_b32 v94, 16, v105
    v_and_b32 v95, 0xffff0000, v105
    v_add_f32 v92, v92, v94
    v_add_f32 v93, v93, v95
    v_cvt_pk_bf16_f32 v81, v92, v93
    v_lshlrev_b32 v88, 16, v82
    v_and_b32 v89, 0xffff0000, v82
    v_lshlrev_b32 v90, 16, v106
    v_and_b32 v91, 0xffff0000, v106
    v_add_f32 v88, v88, v90
    v_add_f32 v89, v89, v91
    v_cvt_pk_bf16_f32 v82, v88, v89
    v_lshlrev_b32 v92, 16, v83
    v_and_b32 v93, 0xffff0000, v83
    v_lshlrev_b32 v94, 16, v107
    v_and_b32 v95, 0xffff0000, v107
    v_add_f32 v92, v92, v94
    v_add_f32 v93, v93, v95
    v_cvt_pk_bf16_f32 v83, v92, v93
    buffer_store_dwordx4 v[80:83], v3, s[8:11], s26 offen offset:0 sc1
    v_cvt_pk_bf16_f32 v84, v56, v57
    v_cvt_pk_bf16_f32 v85, v58, v59
    v_cvt_pk_bf16_f32 v86, v60, v61
    v_cvt_pk_bf16_f32 v87, v62, v63
    s_nop 1
    v_permlane32_swap_b32 v84, v86
    v_permlane32_swap_b32 v85, v87
    s_nop 1
    v_lshlrev_b32 v88, 16, v84
    v_and_b32 v89, 0xffff0000, v84
    v_lshlrev_b32 v90, 16, v108
    v_and_b32 v91, 0xffff0000, v108
    v_add_f32 v88, v88, v90
    v_add_f32 v89, v89, v91
    v_cvt_pk_bf16_f32 v84, v88, v89
    v_lshlrev_b32 v92, 16, v85
    v_and_b32 v93, 0xffff0000, v85
    v_lshlrev_b32 v94, 16, v109
    v_and_b32 v95, 0xffff0000, v109
    v_add_f32 v92, v92, v94
    v_add_f32 v93, v93, v95
    v_cvt_pk_bf16_f32 v85, v92, v93
    v_lshlrev_b32 v88, 16, v86
    v_and_b32 v89, 0xffff0000, v86
    v_lshlrev_b32 v90, 16, v110
    v_and_b32 v91, 0xffff0000, v110
    v_add_f32 v88, v88, v90
    v_add_f32 v89, v89, v91
    v_cvt_pk_bf16_f32 v86, v88, v89
    v_lshlrev_b32 v92, 16, v87
    v_and_b32 v93, 0xffff0000, v87
    v_lshlrev_b32 v94, 16, v111
    v_and_b32 v95, 0xffff0000, v111
    v_add_f32 v92, v92, v94
    v_add_f32 v93, v93, v95
    v_cvt_pk_bf16_f32 v87, v92, v93
    buffer_store_dwordx4 v[84:87], v3, s[8:11], s26 offen offset:32 sc1
    s_waitcnt vmcnt(15)
    s_mov_b64 exec, 1
    s_add_u32 s26, s48, s20
    buffer_store_dword v5, v4, s[8:11], s26 offen sc1
    s_mov_b64 exec, -1
    s_add_u32 s20, s20, 128
    s_add_u32 s19, s19, 40960
    s_add_u32 s16, s16, 40960
    s_cmp_eq_u32 s16, 122880
    s_cselect_b32 s16, 0, s16
    s_add_u32 s14, s14, 1
    s_cmp_lt_u32 s14, s15
    s_cbranch_scc1 layerb1_kernel_ab_loop
layerb1_kernel_ab_fin:
    s_waitcnt vmcnt(0) lgkmcnt(0)
    s_mov_b64 exec, 1
    s_add_u32 s26, s48, s20
    buffer_store_dword v5, v4, s[8:11], s26 offen sc1
    s_mov_b64 exec, -1
    s_add_u32 s20, s20, 128
    s_barrier
    s_branch layerb1_kernel_w3
layerb1_kernel_sp_ln:
    s_sub_u32 s12, s22, 5
    s_mov_b32 s14, s12
    s_mov_b32 s16, 0x3f803f80
    v_lshrrev_b32 v6, 3, v0
    v_and_b32 v7, 7, v0
    v_mul_u32_u24 v1, 1280, v6
    v_lshl_add_u32 v1, v7, 5, v1
    v_lshlrev_b32 v2, 10, v7
    v_lshl_add_u32 v2, v6, 4, v2
    v_lshlrev_b32 v3, 2, v0
    v_mov_b32 v4, 1
layerb1_kernel_ln_seg:
    s_lshl_b32 s17, s14, 7
    s_add_u32 s17, s17, s48
    s_add_u32 s17, s17, 36864
    s_mov_b64 exec, 0xfffff
layerb1_kernel_ln_poll:
    buffer_load_dword v5, v3, s[8:11], s17 offen sc1
    s_waitcnt vmcnt(0)
    v_cmp_eq_u32 vcc, 0, v5
    s_sub_u32 s15, s15, 1
    s_cbranch_scc1 layerb1_kernel_bail
    s_cbranch_vccnz layerb1_kernel_ln_poll
    s_mov_b64 exec, -1
    s_lshl_b32 s18, s14, 5
    s_lshl_b32 s19, s13, 3
    s_add_u32 s18, s18, s19
    s_mul_i32 s18, s18, 1280
    s_add_u32 s18, s18, 226492416
    buffer_load_dwordx4 v[16:19], v1, s[8:11], s18 offen offset:0 sc1
    buffer_load_dwordx4 v[20:23], v1, s[8:11], s18 offen offset:16 sc1
    buffer_load_dwordx4 v[24:27], v1, s[8:11], s18 offen offset:256 sc1
    buffer_load_dwordx4 v[28:31], v1, s[8:11], s18 offen offset:272 sc1
    buffer_load_dwordx4 v[32:35], v1, s[8:11], s18 offen offset:512 sc1
    buffer_load_dwordx4 v[36:39], v1, s[8:11], s18 offen offset:528 sc1
    buffer_load_dwordx4 v[40:43], v1, s[8:11], s18 offen offset:768 sc1
    buffer_load_dwordx4 v[44:47], v1, s[8:11], s18 offen offset:784 sc1
    buffer_load_dwordx4 v[48:51], v1, s[8:11], s18 offen offset:1024 sc1
    buffer_load_dwordx4 v[52:55], v1, s[8:11], s18 offen offset:1040 sc1
    v_mov_b32 v8, 0
    v_mov_b32 v9, 0
    v_mov_b32 v10, 0
    v_mov_b32 v11, 0
    s_waitcnt vmcnt(9)
    v_dot2c_f32_bf16 v8, s16, v16
    v_dot2c_f32_bf16 v10, v16, v16
    v_dot2c_f32_bf16 v9, s16, v17
    v_dot2c_f32_bf16 v11, v17, v17
    v_dot2c_f32_bf16 v8, s16, v18
    v_dot2c_f32_bf16 v10, v18, v18
    v_dot2c_f32_bf16 v9, s16, v19
    v_dot2c_f32_bf16 v11, v19, v19
    s_waitcnt vmcnt(8)
    v_dot2c_f32_bf16 v8, s16, v20
    v_dot2c_f32_bf16 v10, v20, v20
    v_dot2c_f32_bf16 v9, s16, v21
    v_dot2c_f32_bf16 v11, v21, v21
    v_dot2c_f32_bf16 v8, s16, v22
    v_dot2c_f32_bf16 v10, v22, v22
    v_dot2c_f32_bf16 v9, s16, v23
    v_dot2c_f32_bf16 v11, v23, v23
    s_waitcnt vmcnt(7)
    v_dot2c_f32_bf16 v8, s16, v24
    v_dot2c_f32_bf16 v10, v24, v24
    v_dot2c_f32_bf16 v9, s16, v25
    v_dot2c_f32_bf16 v11, v25, v25
    v_dot2c_f32_bf16 v8, s16, v26
    v_dot2c_f32_bf16 v10, v26, v26
    v_dot2c_f32_bf16 v9, s16, v27
    v_dot2c_f32_bf16 v11, v27, v27
    s_waitcnt vmcnt(6)
    v_dot2c_f32_bf16 v8, s16, v28
    v_dot2c_f32_bf16 v10, v28, v28
    v_dot2c_f32_bf16 v9, s16, v29
    v_dot2c_f32_bf16 v11, v29, v29
    v_dot2c_f32_bf16 v8, s16, v30
    v_dot2c_f32_bf16 v10, v30, v30
    v_dot2c_f32_bf16 v9, s16, v31
    v_dot2c_f32_bf16 v11, v31, v31
    s_waitcnt vmcnt(5)
    v_dot2c_f32_bf16 v8, s16, v32
    v_dot2c_f32_bf16 v10, v32, v32
    v_dot2c_f32_bf16 v9, s16, v33
    v_dot2c_f32_bf16 v11, v33, v33
    v_dot2c_f32_bf16 v8, s16, v34
    v_dot2c_f32_bf16 v10, v34, v34
    v_dot2c_f32_bf16 v9, s16, v35
    v_dot2c_f32_bf16 v11, v35, v35
    s_waitcnt vmcnt(4)
    v_dot2c_f32_bf16 v8, s16, v36
    v_dot2c_f32_bf16 v10, v36, v36
    v_dot2c_f32_bf16 v9, s16, v37
    v_dot2c_f32_bf16 v11, v37, v37
    v_dot2c_f32_bf16 v8, s16, v38
    v_dot2c_f32_bf16 v10, v38, v38
    v_dot2c_f32_bf16 v9, s16, v39
    v_dot2c_f32_bf16 v11, v39, v39
    s_waitcnt vmcnt(3)
    v_dot2c_f32_bf16 v8, s16, v40
    v_dot2c_f32_bf16 v10, v40, v40
    v_dot2c_f32_bf16 v9, s16, v41
    v_dot2c_f32_bf16 v11, v41, v41
    v_dot2c_f32_bf16 v8, s16, v42
    v_dot2c_f32_bf16 v10, v42, v42
    v_dot2c_f32_bf16 v9, s16, v43
    v_dot2c_f32_bf16 v11, v43, v43
    s_waitcnt vmcnt(2)
    v_dot2c_f32_bf16 v8, s16, v44
    v_dot2c_f32_bf16 v10, v44, v44
    v_dot2c_f32_bf16 v9, s16, v45
    v_dot2c_f32_bf16 v11, v45, v45
    v_dot2c_f32_bf16 v8, s16, v46
    v_dot2c_f32_bf16 v10, v46, v46
    v_dot2c_f32_bf16 v9, s16, v47
    v_dot2c_f32_bf16 v11, v47, v47
    s_waitcnt vmcnt(1)
    v_dot2c_f32_bf16 v8, s16, v48
    v_dot2c_f32_bf16 v10, v48, v48
    v_dot2c_f32_bf16 v9, s16, v49
    v_dot2c_f32_bf16 v11, v49, v49
    v_dot2c_f32_bf16 v8, s16, v50
    v_dot2c_f32_bf16 v10, v50, v50
    v_dot2c_f32_bf16 v9, s16, v51
    v_dot2c_f32_bf16 v11, v51, v51
    s_waitcnt vmcnt(0)
    v_dot2c_f32_bf16 v8, s16, v52
    v_dot2c_f32_bf16 v10, v52, v52
    v_dot2c_f32_bf16 v9, s16, v53
    v_dot2c_f32_bf16 v11, v53, v53
    v_dot2c_f32_bf16 v8, s16, v54
    v_dot2c_f32_bf16 v10, v54, v54
    v_dot2c_f32_bf16 v9, s16, v55
    v_dot2c_f32_bf16 v11, v55, v55
    s_nop 3
    v_add_f32 v8, v8, v9
    v_add_f32 v10, v10, v11
    s_nop 1
    v_add_f32_dpp v8, v8, v8 quad_perm:[1,0,3,2] row_mask:0xf bank_mask:0xf
    v_add_f32_dpp v10, v10, v10 quad_perm:[1,0,3,2] row_mask:0xf bank_mask:0xf
    s_nop 1
    v_add_f32_dpp v8, v8, v8 quad_perm:[2,3,0,1] row_mask:0xf bank_mask:0xf
    v_add_f32_dpp v10, v10, v10 quad_perm:[2,3,0,1] row_mask:0xf bank_mask:0xf
    s_nop 1
    v_add_f32_dpp v8, v8, v8 row_half_mirror row_mask:0xf bank_mask:0xf
    v_add_f32_dpp v10, v10, v10 row_half_mirror row_mask:0xf bank_mask:0xf
    v_mul_f32 v8, 0x3acccccd, v8
    v_mul_f32 v9, v8, v8
    v_mul_f32 v10, 0x3acccccd, v10
    v_sub_f32 v10, v10, v9
    v_max_f32 v10, 0, v10
    v_add_f32 v10, 0x3727c5ac, v10
    v_rsq_f32 v10, v10
    s_nop 0
    v_mul_f32 v8, v8, v10
    v_sub_f32 v8, 0, v8
    s_mul_i32 s18, s14, 40960
    s_lshl_b32 s19, s13, 7
    s_add_u32 s18, s18, s19
    s_add_u32 s18, s18, 220200960
    v_lshlrev_b32 v64, 16, v16
    v_and_b32 v65, 0xffff0000, v16
    v_fma_f32 v64, v64, v10, v8
    v_fma_f32 v65, v65, v10, v8
    v_cvt_pk_bf16_f32 v72, v64, v65
    v_lshlrev_b32 v66, 16, v17
    v_and_b32 v67, 0xffff0000, v17
    v_fma_f32 v66, v66, v10, v8
    v_fma_f32 v67, v67, v10, v8
    v_cvt_pk_bf16_f32 v74, v66, v67
    v_lshlrev_b32 v68, 16, v18
    v_and_b32 v69, 0xffff0000, v18
    v_fma_f32 v68, v68, v10, v8
    v_fma_f32 v69, v69, v10, v8
    v_cvt_pk_bf16_f32 v76, v68, v69
    v_lshlrev_b32 v70, 16, v19
    v_and_b32 v71, 0xffff0000, v19
    v_fma_f32 v70, v70, v10, v8
    v_fma_f32 v71, v71, v10, v8
    v_cvt_pk_bf16_f32 v78, v70, v71
    v_lshlrev_b32 v64, 16, v20
    v_and_b32 v65, 0xffff0000, v20
    v_fma_f32 v64, v64, v10, v8
    v_fma_f32 v65, v65, v10, v8
    v_cvt_pk_bf16_f32 v73, v64, v65
    v_lshlrev_b32 v66, 16, v21
    v_and_b32 v67, 0xffff0000, v21
    v_fma_f32 v66, v66, v10, v8
    v_fma_f32 v67, v67, v10, v8
    v_cvt_pk_bf16_f32 v75, v66, v67
    v_lshlrev_b32 v68, 16, v22
    v_and_b32 v69, 0xffff0000, v22
    v_fma_f32 v68, v68, v10, v8
    v_fma_f32 v69, v69, v10, v8
    v_cvt_pk_bf16_f32 v77, v68, v69
    v_lshlrev_b32 v70, 16, v23
    v_and_b32 v71, 0xffff0000, v23
    v_fma_f32 v70, v70, v10, v8
    v_fma_f32 v71, v71, v10, v8
    v_cvt_pk_bf16_f32 v79, v70, v71
    buffer_store_dwordx4 v[72:75], v2, s[8:11], s18 offen offset:0 sc1
    buffer_store_dwordx4 v[76:79], v2, s[8:11], s18 offen offset:512 sc1
    s_add_u32 s18, s18, 8192
    v_lshlrev_b32 v64, 16, v24
    v_and_b32 v65, 0xffff0000, v24
    v_fma_f32 v64, v64, v10, v8
    v_fma_f32 v65, v65, v10, v8
    v_cvt_pk_bf16_f32 v80, v64, v65
    v_lshlrev_b32 v66, 16, v25
    v_and_b32 v67, 0xffff0000, v25
    v_fma_f32 v66, v66, v10, v8
    v_fma_f32 v67, v67, v10, v8
    v_cvt_pk_bf16_f32 v82, v66, v67
    v_lshlrev_b32 v68, 16, v26
    v_and_b32 v69, 0xffff0000, v26
    v_fma_f32 v68, v68, v10, v8
    v_fma_f32 v69, v69, v10, v8
    v_cvt_pk_bf16_f32 v84, v68, v69
    v_lshlrev_b32 v70, 16, v27
    v_and_b32 v71, 0xffff0000, v27
    v_fma_f32 v70, v70, v10, v8
    v_fma_f32 v71, v71, v10, v8
    v_cvt_pk_bf16_f32 v86, v70, v71
    v_lshlrev_b32 v64, 16, v28
    v_and_b32 v65, 0xffff0000, v28
    v_fma_f32 v64, v64, v10, v8
    v_fma_f32 v65, v65, v10, v8
    v_cvt_pk_bf16_f32 v81, v64, v65
    v_lshlrev_b32 v66, 16, v29
    v_and_b32 v67, 0xffff0000, v29
    v_fma_f32 v66, v66, v10, v8
    v_fma_f32 v67, v67, v10, v8
    v_cvt_pk_bf16_f32 v83, v66, v67
    v_lshlrev_b32 v68, 16, v30
    v_and_b32 v69, 0xffff0000, v30
    v_fma_f32 v68, v68, v10, v8
    v_fma_f32 v69, v69, v10, v8
    v_cvt_pk_bf16_f32 v85, v68, v69
    v_lshlrev_b32 v70, 16, v31
    v_and_b32 v71, 0xffff0000, v31
    v_fma_f32 v70, v70, v10, v8
    v_fma_f32 v71, v71, v10, v8
    v_cvt_pk_bf16_f32 v87, v70, v71
    buffer_store_dwordx4 v[80:83], v2, s[8:11], s18 offen offset:0 sc1
    buffer_store_dwordx4 v[84:87], v2, s[8:11], s18 offen offset:512 sc1
    s_add_u32 s18, s18, 8192
    v_lshlrev_b32 v64, 16, v32
    v_and_b32 v65, 0xffff0000, v32
    v_fma_f32 v64, v64, v10, v8
    v_fma_f32 v65, v65, v10, v8
    v_cvt_pk_bf16_f32 v72, v64, v65
    v_lshlrev_b32 v66, 16, v33
    v_and_b32 v67, 0xffff0000, v33
    v_fma_f32 v66, v66, v10, v8
    v_fma_f32 v67, v67, v10, v8
    v_cvt_pk_bf16_f32 v74, v66, v67
    v_lshlrev_b32 v68, 16, v34
    v_and_b32 v69, 0xffff0000, v34
    v_fma_f32 v68, v68, v10, v8
    v_fma_f32 v69, v69, v10, v8
    v_cvt_pk_bf16_f32 v76, v68, v69
    v_lshlrev_b32 v70, 16, v35
    v_and_b32 v71, 0xffff0000, v35
    v_fma_f32 v70, v70, v10, v8
    v_fma_f32 v71, v71, v10, v8
    v_cvt_pk_bf16_f32 v78, v70, v71
    v_lshlrev_b32 v64, 16, v36
    v_and_b32 v65, 0xffff0000, v36
    v_fma_f32 v64, v64, v10, v8
    v_fma_f32 v65, v65, v10, v8
    v_cvt_pk_bf16_f32 v73, v64, v65
    v_lshlrev_b32 v66, 16, v37
    v_and_b32 v67, 0xffff0000, v37
    v_fma_f32 v66, v66, v10, v8
    v_fma_f32 v67, v67, v10, v8
    v_cvt_pk_bf16_f32 v75, v66, v67
    v_lshlrev_b32 v68, 16, v38
    v_and_b32 v69, 0xffff0000, v38
    v_fma_f32 v68, v68, v10, v8
    v_fma_f32 v69, v69, v10, v8
    v_cvt_pk_bf16_f32 v77, v68, v69
    v_lshlrev_b32 v70, 16, v39
    v_and_b32 v71, 0xffff0000, v39
    v_fma_f32 v70, v70, v10, v8
    v_fma_f32 v71, v71, v10, v8
    v_cvt_pk_bf16_f32 v79, v70, v71
    buffer_store_dwordx4 v[72:75], v2, s[8:11], s18 offen offset:0 sc1
    buffer_store_dwordx4 v[76:79], v2, s[8:11], s18 offen offset:512 sc1
    s_add_u32 s18, s18, 8192
    v_lshlrev_b32 v64, 16, v40
    v_and_b32 v65, 0xffff0000, v40
    v_fma_f32 v64, v64, v10, v8
    v_fma_f32 v65, v65, v10, v8
    v_cvt_pk_bf16_f32 v80, v64, v65
    v_lshlrev_b32 v66, 16, v41
    v_and_b32 v67, 0xffff0000, v41
    v_fma_f32 v66, v66, v10, v8
    v_fma_f32 v67, v67, v10, v8
    v_cvt_pk_bf16_f32 v82, v66, v67
    v_lshlrev_b32 v68, 16, v42
    v_and_b32 v69, 0xffff0000, v42
    v_fma_f32 v68, v68, v10, v8
    v_fma_f32 v69, v69, v10, v8
    v_cvt_pk_bf16_f32 v84, v68, v69
    v_lshlrev_b32 v70, 16, v43
    v_and_b32 v71, 0xffff0000, v43
    v_fma_f32 v70, v70, v10, v8
    v_fma_f32 v71, v71, v10, v8
    v_cvt_pk_bf16_f32 v86, v70, v71
    v_lshlrev_b32 v64, 16, v44
    v_and_b32 v65, 0xffff0000, v44
    v_fma_f32 v64, v64, v10, v8
    v_fma_f32 v65, v65, v10, v8
    v_cvt_pk_bf16_f32 v81, v64, v65
    v_lshlrev_b32 v66, 16, v45
    v_and_b32 v67, 0xffff0000, v45
    v_fma_f32 v66, v66, v10, v8
    v_fma_f32 v67, v67, v10, v8
    v_cvt_pk_bf16_f32 v83, v66, v67
    v_lshlrev_b32 v68, 16, v46
    v_and_b32 v69, 0xffff0000, v46
    v_fma_f32 v68, v68, v10, v8
    v_fma_f32 v69, v69, v10, v8
    v_cvt_pk_bf16_f32 v85, v68, v69
    v_lshlrev_b32 v70, 16, v47
    v_and_b32 v71, 0xffff0000, v47
    v_fma_f32 v70, v70, v10, v8
    v_fma_f32 v71, v71, v10, v8
    v_cvt_pk_bf16_f32 v87, v70, v71
    buffer_store_dwordx4 v[80:83], v2, s[8:11], s18 offen offset:0 sc1
    buffer_store_dwordx4 v[84:87], v2, s[8:11], s18 offen offset:512 sc1
    s_add_u32 s18, s18, 8192
    v_lshlrev_b32 v64, 16, v48
    v_and_b32 v65, 0xffff0000, v48
    v_fma_f32 v64, v64, v10, v8
    v_fma_f32 v65, v65, v10, v8
    v_cvt_pk_bf16_f32 v72, v64, v65
    v_lshlrev_b32 v66, 16, v49
    v_and_b32 v67, 0xffff0000, v49
    v_fma_f32 v66, v66, v10, v8
    v_fma_f32 v67, v67, v10, v8
    v_cvt_pk_bf16_f32 v74, v66, v67
    v_lshlrev_b32 v68, 16, v50
    v_and_b32 v69, 0xffff0000, v50
    v_fma_f32 v68, v68, v10, v8
    v_fma_f32 v69, v69, v10, v8
    v_cvt_pk_bf16_f32 v76, v68, v69
    v_lshlrev_b32 v70, 16, v51
    v_and_b32 v71, 0xffff0000, v51
    v_fma_f32 v70, v70, v10, v8
    v_fma_f32 v71, v71, v10, v8
    v_cvt_pk_bf16_f32 v78, v70, v71
    v_lshlrev_b32 v64, 16, v52
    v_and_b32 v65, 0xffff0000, v52
    v_fma_f32 v64, v64, v10, v8
    v_fma_f32 v65, v65, v10, v8
    v_cvt_pk_bf16_f32 v73, v64, v65
    v_lshlrev_b32 v66, 16, v53
    v_and_b32 v67, 0xffff0000, v53
    v_fma_f32 v66, v66, v10, v8
    v_fma_f32 v67, v67, v10, v8
    v_cvt_pk_bf16_f32 v75, v66, v67
    v_lshlrev_b32 v68, 16, v54
    v_and_b32 v69, 0xffff0000, v54
    v_fma_f32 v68, v68, v10, v8
    v_fma_f32 v69, v69, v10, v8
    v_cvt_pk_bf16_f32 v77, v68, v69
    v_lshlrev_b32 v70, 16, v55
    v_and_b32 v71, 0xffff0000, v55
    v_fma_f32 v70, v70, v10, v8
    v_fma_f32 v71, v71, v10, v8
    v_cvt_pk_bf16_f32 v79, v70, v71
    buffer_store_dwordx4 v[72:75], v2, s[8:11], s18 offen offset:0 sc1
    buffer_store_dwordx4 v[76:79], v2, s[8:11], s18 offen offset:512 sc1
    s_waitcnt vmcnt(0)
    s_lshl_b32 s17, s14, 4
    s_lshl_b32 s19, s13, 2
    s_add_u32 s17, s17, s19
    s_add_u32 s17, s17, s48
    s_add_u32 s17, s17, 45056
    v_mov_b32 v5, 0
    s_mov_b64 exec, 1
    buffer_store_dword v4, v5, s[8:11], s17 offen sc1
    s_mov_b64 exec, -1
    s_add_u32 s14, s14, 4
    s_cmp_lt_u32 s14, 64
    s_cbranch_scc1 layerb1_kernel_ln_seg
    s_waitcnt vmcnt(0)
    s_barrier
layerb1_kernel_w3:
    s_mov_b32 s15, 400000
    s_mov_b32 s43, 32768
layerb1_kernel_j_next:
    s_xor_b32 s43, s43, 4
    s_cmp_lg_u32 s13, 0
    s_cbranch_scc1 layerb1_kernel_j_rel
    s_mov_b64 exec, 1
    v_mov_b32 v2, 31744
    v_mov_b32 v3, 1
    buffer_atomic_add v3, v2, s[8:11], s48 offen sc0 sc1
    s_waitcnt vmcnt(0)
    s_mov_b64 exec, -1
    s_nop 0
    v_readfirstlane_b32 s38, v3
    s_cmp_ge_u32 s38, 1152
    s_cbranch_scc1 layerb1_kernel_j_pub
    s_mul_i32 s39, s38, 58255
    s_lshr_b32 s40, s39, 20
    s_mul_i32 s39, s40, 18
    s_sub_u32 s41, s38, s39
    s_add_u32 s42, s40, 1
    v_mov_b32 v4, s42
    v_lshlrev_b32 v2, 7, v0
    s_cmp_ge_u32 s41, 8
    s_cbranch_scc1 layerb1_kernel_j_dep_b
    s_lshl_b32 s24, s41, 9
    s_add_u32 s24, s24, 16384
    v_add_u32 v2, s24, v2
    s_mul_i32 s25, s41, 384
    s_add_u32 s26, s25, 10240
    v_writelane_b32 v2, s26, 4
    s_add_u32 s26, s25, 10368
    v_writelane_b32 v2, s26, 5
    s_add_u32 s26, s25, 10496
    v_writelane_b32 v2, s26, 6
    s_add_u32 s26, s25, 13312
    v_writelane_b32 v2, s26, 7
    s_add_u32 s26, s25, 13440
    v_writelane_b32 v2, s26, 8
    s_add_u32 s26, s25, 13568
    v_writelane_b32 v2, s26, 9
    s_mov_b64 exec, 0x3ff
    s_mov_b32 s44, 0xf
    s_branch layerb1_kernel_j_poll
layerb1_kernel_j_dep_b:
    s_sub_u32 s24, s41, 8
    s_lshl_b32 s24, s24, 10
    v_add_u32 v2, s24, v2
    v_cmp_gt_u32 vcc, 8, v0
    v_mov_b32 v5, 20480
    v_mov_b32 v6, -1024
    v_cndmask_b32 v5, v6, v5, vcc
    v_add_u32 v2, v5, v2
    s_lshl_b32 s25, s40, 7
    s_add_u32 s25, s25, 53184
    v_lshl_add_u32 v5, v0, 2, s25
    v_cmp_le_u32 vcc, 16, v0
    s_nop 1
    v_cndmask_b32 v2, v2, v5, vcc
    v_cndmask_b32 v4, v4, 1, vcc
    s_mov_b32 exec_lo, -1
    s_mov_b32 exec_hi, 0xffff
    s_mov_b32 s44, 0xffff00ff
layerb1_kernel_j_poll:
    buffer_load_dword v3, v2, s[8:11], s48 offen sc1
    s_waitcnt vmcnt(0)
    v_cmp_gt_u32 vcc, v4, v3
    s_sub_u32 s15, s15, 1
    s_cbranch_scc1 layerb1_kernel_j_giveup
    s_andn2_b32 s24, vcc_lo, s44
    s_cbranch_scc1 layerb1_kernel_j_poll
    s_mov_b64 exec, -1
    s_and_b32 s24, vcc_lo, s44
    s_or_b32 s25, s24, vcc_hi
    s_cselect_b32 s25, 0xf, 0
    s_cmp_ge_u32 s41, 8
    s_cselect_b32 s24, s25, s24
    s_lshl_b32 s24, s24, 11
    s_or_b32 s38, s38, s24
layerb1_kernel_j_pub:
    v_mov_b32 v2, s43
    v_mov_b32 v3, s38
    ds_write_b32 v2, v3
    s_waitcnt lgkmcnt(0)
layerb1_kernel_j_rel:
    s_barrier
    v_mov_b32 v2, s43
    ds_read_b32 v3, v2
    s_waitcnt lgkmcnt(0)
    v_readfirstlane_b32 s38, v3
    s_cmp_eq_u32 s38, -1
    s_cbranch_scc1 layerb1_kernel_j_done
    s_lshr_b32 s44, s38, 11
    s_and_b32 s38, s38, 0x7ff
    s_cmp_ge_u32 s38, 1152
    s_cbranch_scc1 layerb1_kernel_j_done
    s_lshr_b32 s44, s44, s13
    s_and_b32 s44, s44, 1
    s_mul_i32 s39, s38, 58255
    s_lshr_b32 s40, s39, 20
    s_mul_i32 s39, s40, 18
    s_sub_u32 s41, s38, s39
    s_add_u32 s42, s40, 1
    s_cmp_ge_u32 s41, 8
    s_cbranch_scc1 layerb1_kernel_j_b
    s_lshl_b32 s41, s41, 2
    s_add_u32 s41, s41, s13
    v_lshlrev_b32 v1, 4, v0
    v_and_b32 v2, 31, v0
    v_lshrrev_b32 v3, 5, v0
    s_lshl_b32 s24, s40, 5
    s_add_u32 s24, s24, s41
    s_mul_i32 s25, s24, 12288
    s_add_u32 s26, s25, 78643200
    s_add_u32 s27, s25, 53477376
    s_mul_i32 s28, s24, 3072
    s_add_u32 s28, s28, 208666624
    v_and_b32 v4, 7, v0
    v_lshlrev_b32 v4, 4, v4
    v_lshl_add_u32 v4, v3, 7, v4
    buffer_load_dwordx4 v[16:19], v1, s[8:11], s26 offen offset:0 sc1
    buffer_load_dwordx4 v[64:67], v1, s[8:11], s27 offen offset:0 sc1
    buffer_load_dwordx4 v[20:23], v1, s[8:11], s26 offen offset:1024 sc1
    buffer_load_dwordx4 v[68:71], v1, s[8:11], s27 offen offset:1024 sc1
    buffer_load_dwordx4 v[24:27], v1, s[8:11], s26 offen offset:2048 sc1
    buffer_load_dwordx4 v[72:75], v1, s[8:11], s27 offen offset:2048 sc1
    buffer_load_dwordx4 v[28:31], v1, s[8:11], s26 offen offset:3072 sc1
    buffer_load_dwordx4 v[76:79], v1, s[8:11], s27 offen offset:3072 sc1
    s_add_u32 s26, s26, 4096
    s_add_u32 s27, s27, 4096
    buffer_load_dwordx4 v[32:35], v1, s[8:11], s26 offen offset:0 sc1
    buffer_load_dwordx4 v[80:83], v1, s[8:11], s27 offen offset:0 sc1
    buffer_load_dwordx4 v[36:39], v1, s[8:11], s26 offen offset:1024 sc1
    buffer_load_dwordx4 v[84:87], v1, s[8:11], s27 offen offset:1024 sc1
    buffer_load_dwordx4 v[40:43], v1, s[8:11], s26 offen offset:2048 sc1
    buffer_load_dwordx4 v[88:91], v1, s[8:11], s27 offen offset:2048 sc1
    buffer_load_dwordx4 v[44:47], v1, s[8:11], s26 offen offset:3072 sc1
    buffer_load_dwordx4 v[92:95], v1, s[8:11], s27 offen offset:3072 sc1
    s_add_u32 s26, s26, 4096
    s_add_u32 s27, s27, 4096
    buffer_load_dwordx4 v[48:51], v1, s[8:11], s26 offen offset:0 sc1
    buffer_load_dwordx4 v[96:99], v1, s[8:11], s27 offen offset:0 sc1
    buffer_load_dwordx4 v[52:55], v1, s[8:11], s26 offen offset:1024 sc1
    buffer_load_dwordx4 v[100:103], v1, s[8:11], s27 offen offset:1024 sc1
    buffer_load_dwordx4 v[56:59], v1, s[8:11], s26 offen offset:2048 sc1
    buffer_load_dwordx4 v[104:107], v1, s[8:11], s27 offen offset:2048 sc1
    buffer_load_dwordx4 v[60:63], v1, s[8:11], s26 offen offset:3072 sc1
    buffer_load_dwordx4 v[108:111], v1, s[8:11], s27 offen offset:3072 sc1
    s_cmp_eq_u32 s44, 1
    s_cbranch_scc1 layerb1_kernel_w3a_nf
    buffer_load_dwordx4 v[112:115], v4, s[8:11], s28 offen offset:0 sc1
    buffer_load_dwordx4 v[116:119], v4, s[8:11], s28 offen offset:256 sc1
    buffer_load_dwordx4 v[120:123], v4, s[8:11], s28 offen offset:512 sc1
    buffer_load_dwordx4 v[124:127], v4, s[8:11], s28 offen offset:768 sc1
    buffer_load_dwordx4 v[128:131], v4, s[8:11], s28 offen offset:1024 sc1
    buffer_load_dwordx4 v[132:135], v4, s[8:11], s28 offen offset:1280 sc1
    buffer_load_dwordx4 v[136:139], v4, s[8:11], s28 offen offset:1536 sc1
    buffer_load_dwordx4 v[140:143], v4, s[8:11], s28 offen offset:1792 sc1
    buffer_load_dwordx4 v[144:147], v4, s[8:11], s28 offen offset:2048 sc1
    buffer_load_dwordx4 v[148:151], v4, s[8:11], s28 offen offset:2304 sc1
    buffer_load_dwordx4 v[152:155], v4, s[8:11], s28 offen offset:2560 sc1
    buffer_load_dwordx4 v[156:159], v4, s[8:11], s28 offen offset:2816 sc1
layerb1_kernel_w3a_nf:
    v_lshlrev_b32 v5, 2, v3
    v_sub_u32 v5, v2, v5
    v_mov_b32 v6, 0xf149f2ca
    v_cmp_gt_i32 vcc, 0, v5
    s_nop 1
    v_cndmask_b32 v192, 0, v6, vcc
    v_cmp_gt_i32 vcc, 1, v5
    s_nop 1
    v_cndmask_b32 v193, 0, v6, vcc
    v_cmp_gt_i32 vcc, 2, v5
    s_nop 1
    v_cndmask_b32 v194, 0, v6, vcc
    v_cmp_gt_i32 vcc, 3, v5
    s_nop 1
    v_cndmask_b32 v195, 0, v6, vcc
    v_cmp_gt_i32 vcc, 8, v5
    s_nop 1
    v_cndmask_b32 v196, 0, v6, vcc
    v_cmp_gt_i32 vcc, 9, v5
    s_nop 1
    v_cndmask_b32 v197, 0, v6, vcc
    v_cmp_gt_i32 vcc, 10, v5
    s_nop 1
    v_cndmask_b32 v198, 0, v6, vcc
    v_cmp_gt_i32 vcc, 11, v5
    s_nop 1
    v_cndmask_b32 v199, 0, v6, vcc
    v_cmp_gt_i32 vcc, 16, v5
    s_nop 1
    v_cndmask_b32 v200, 0, v6, vcc
    v_cmp_gt_i32 vcc, 17, v5
    s_nop 1
    v_cndmask_b32 v201, 0, v6, vcc
    v_cmp_gt_i32 vcc, 18, v5
    s_nop 1
    v_cndmask_b32 v202, 0, v6, vcc
    v_cmp_gt_i32 vcc, 19, v5
    s_nop 1
    v_cndmask_b32 v203, 0, v6, vcc
    v_cmp_gt_i32 vcc, 24, v5
    s_nop 1
    v_cndmask_b32 v204, 0, v6, vcc
    v_cmp_gt_i32 vcc, 25, v5
    s_nop 1
    v_cndmask_b32 v205, 0, v6, vcc
    v_cmp_gt_i32 vcc, 26, v5
    s_nop 1
    v_cndmask_b32 v206, 0, v6, vcc
    v_cmp_gt_i32 vcc, 27, v5
    s_nop 1
    v_cndmask_b32 v207, 0, v6, vcc
    s_waitcnt vmcnt(22)
    v_mfma_f32_32x32x16_bf16 v[160:175], v[64:67], v[16:19], 0
    s_waitcnt vmcnt(20)
    v_mfma_f32_32x32x16_bf16 v[160:175], v[68:71], v[20:23], v[160:175]
    s_waitcnt vmcnt(18)
    v_mfma_f32_32x32x16_bf16 v[160:175], v[72:75], v[24:27], v[160:175]
    s_waitcnt vmcnt(16)
    v_mfma_f32_32x32x16_bf16 v[160:175], v[76:79], v[28:31], v[160:175]
    s_waitcnt vmcnt(14)
    v_mfma_f32_32x32x16_bf16 v[160:175], v[80:83], v[32:35], v[160:175]
    s_waitcnt vmcnt(12)
    v_mfma_f32_32x32x16_bf16 v[160:175], v[84:87], v[36:39], v[160:175]
    s_waitcnt vmcnt(10)
    v_mfma_f32_32x32x16_bf16 v[160:175], v[88:91], v[40:43], v[160:175]
    s_waitcnt vmcnt(8)
    v_mfma_f32_32x32x16_bf16 v[160:175], v[92:95], v[44:47], v[160:175]
    s_waitcnt vmcnt(6)
    v_mfma_f32_32x32x16_bf16 v[160:175], v[96:99], v[48:51], v[160:175]
    s_waitcnt vmcnt(4)
    v_mfma_f32_32x32x16_bf16 v[160:175], v[100:103], v[52:55], v[160:175]
    s_waitcnt vmcnt(2)
    v_mfma_f32_32x32x16_bf16 v[160:175], v[104:107], v[56:59], v[160:175]
    s_waitcnt vmcnt(0)
    v_mfma_f32_32x32x16_bf16 v[160:175], v[108:111], v[60:63], v[160:175]
    s_cmp_eq_u32 s44, 0
    s_cbranch_scc1 layerb1_kernel_w3a_f
    s_lshl_b32 s31, s41, 7
    s_add_u32 s31, s31, 16384
    v_mov_b32 v212, s31
    v_mov_b32 v215, s42
    v_mov_b32 v214, -1
    s_mov_b32 exec_lo, 0x1
    s_mov_b32 exec_hi, 0x0
layerb1_kernel_j_la:
    buffer_load_dword v213, v212, s[8:11], s48 offen sc1
    s_waitcnt vmcnt(0)
    v_and_b32 v213, v213, v214
    v_cmp_gt_u32 vcc, v215, v213
    s_sub_u32 s15, s15, 1
    s_cbranch_scc1 layerb1_kernel_bail
    s_cbranch_vccnz layerb1_kernel_j_la
    s_mov_b64 exec, -1
    buffer_load_dwordx4 v[112:115], v4, s[8:11], s28 offen offset:0 sc1
    buffer_load_dwordx4 v[116:119], v4, s[8:11], s28 offen offset:256 sc1
    buffer_load_dwordx4 v[120:123], v4, s[8:11], s28 offen offset:512 sc1
    buffer_load_dwordx4 v[124:127], v4, s[8:11], s28 offen offset:768 sc1
    buffer_load_dwordx4 v[128:131], v4, s[8:11], s28 offen offset:1024 sc1
    buffer_load_dwordx4 v[132:135], v4, s[8:11], s28 offen offset:1280 sc1
    buffer_load_dwordx4 v[136:139], v4, s[8:11], s28 offen offset:1536 sc1
    buffer_load_dwordx4 v[140:143], v4, s[8:11], s28 offen offset:1792 sc1
    buffer_load_dwordx4 v[144:147], v4, s[8:11], s28 offen offset:2048 sc1
    buffer_load_dwordx4 v[148:151], v4, s[8:11], s28 offen offset:2304 sc1
    buffer_load_dwordx4 v[152:155], v4, s[8:11], s28 offen offset:2560 sc1
    buffer_load_dwordx4 v[156:159], v4, s[8:11], s28 offen offset:2816 sc1
layerb1_kernel_w3a_f:
    s_waitcnt vmcnt(11)
    v_mfma_f32_32x32x16_bf16 v[176:191], v[112:115], v[16:19], 0
    s_waitcnt vmcnt(10)
    v_mfma_f32_32x32x16_bf16 v[176:191], v[116:119], v[20:23], v[176:191]
    s_waitcnt vmcnt(9)
    v_mfma_f32_32x32x16_bf16 v[176:191], v[120:123], v[24:27], v[176:191]
    s_waitcnt vmcnt(8)
    v_mfma_f32_32x32x16_bf16 v[176:191], v[124:127], v[28:31], v[176:191]
    s_waitcnt vmcnt(7)
    v_mfma_f32_32x32x16_bf16 v[176:191], v[128:131], v[32:35], v[176:191]
    s_waitcnt vmcnt(6)
    v_mfma_f32_32x32x16_bf16 v[176:191], v[132:135], v[36:39], v[176:191]
    s_waitcnt vmcnt(5)
    v_mfma_f32_32x32x16_bf16 v[176:191], v[136:139], v[40:43], v[176:191]
    s_waitcnt vmcnt(4)
    v_mfma_f32_32x32x16_bf16 v[176:191], v[140:143], v[44:47], v[176:191]
    s_waitcnt vmcnt(3)
    v_mfma_f32_32x32x16_bf16 v[176:191], v[144:147], v[48:51], v[176:191]
    s_waitcnt vmcnt(2)
    v_mfma_f32_32x32x16_bf16 v[176:191], v[148:151], v[52:55], v[176:191]
    s_waitcnt vmcnt(1)
    v_mfma_f32_32x32x16_bf16 v[176:191], v[152:155], v[56:59], v[176:191]
    s_waitcnt vmcnt(0)
    v_mfma_f32_32x32x16_bf16 v[176:191], v[156:159], v[60:63], v[176:191]
    s_nop 7
    s_nop 7
    v_mov_b32 v7, 0x3dd53b95
    v_fma_f32 v160, v160, v7, v192
    v_fma_f32 v161, v161, v7, v193
    v_fma_f32 v162, v162, v7, v194
    v_fma_f32 v163, v163, v7, v195
    v_fma_f32 v164, v164, v7, v196
    v_fma_f32 v165, v165, v7, v197
    v_fma_f32 v166, v166, v7, v198
    v_fma_f32 v167, v167, v7, v199
    v_fma_f32 v168, v168, v7, v200
    v_fma_f32 v169, v169, v7, v201
    v_fma_f32 v170, v170, v7, v202
    v_fma_f32 v171, v171, v7, v203
    v_fma_f32 v172, v172, v7, v204
    v_fma_f32 v173, v173, v7, v205
    v_fma_f32 v174, v174, v7, v206
    v_fma_f32 v175, v175, v7, v207
    v_mul_f32 v176, v176, v7
    v_mul_f32 v177, v177, v7
    v_mul_f32 v178, v178, v7
    v_mul_f32 v179, v179, v7
    v_max3_f32 v208, v160, v161, v162
    v_max3_f32 v208, v208, v163, v164
    v_max3_f32 v208, v208, v165, v166
    v_max3_f32 v208, v208, v167, v168
    v_max3_f32 v208, v208, v169, v170
    v_max3_f32 v208, v208, v171, v172
    v_max3_f32 v208, v208, v173, v174
    v_max3_f32 v208, v208, v175, v176
    v_max3_f32 v208, v208, v177, v178
    v_max_f32 v208, v208, v179
    v_mov_b32 v209, v208
    s_nop 1
    v_permlane32_swap_b32 v208, v209
    v_max_f32 v208, v208, v209
    v_sub_f32 v160, v160, v208
    v_sub_f32 v161, v161, v208
    v_sub_f32 v162, v162, v208
    v_sub_f32 v163, v163, v208
    v_sub_f32 v164, v164, v208
    v_sub_f32 v165, v165, v208
    v_sub_f32 v166, v166, v208
    v_sub_f32 v167, v167, v208
    v_sub_f32 v168, v168, v208
    v_sub_f32 v169, v169, v208
    v_sub_f32 v170, v170, v208
    v_sub_f32 v171, v171, v208
    v_sub_f32 v172, v172, v208
    v_sub_f32 v173, v173, v208
    v_sub_f32 v174, v174, v208
    v_sub_f32 v175, v175, v208
    v_sub_f32 v176, v176, v208
    v_sub_f32 v177, v177, v208
    v_sub_f32 v178, v178, v208
    v_sub_f32 v179, v179, v208
    v_exp_f32 v160, v160
    v_exp_f32 v161, v161
    v_exp_f32 v162, v162
    v_exp_f32 v163, v163
    v_exp_f32 v164, v164
    v_exp_f32 v165, v165
    v_exp_f32 v166, v166
    v_exp_f32 v167, v167
    v_exp_f32 v168, v168
    v_exp_f32 v169, v169
    v_exp_f32 v170, v170
    v_exp_f32 v171, v171
    v_exp_f32 v172, v172
    v_exp_f32 v173, v173
    v_exp_f32 v174, v174
    v_exp_f32 v175, v175
    v_exp_f32 v176, v176
    v_exp_f32 v177, v177
    v_exp_f32 v178, v178
    v_exp_f32 v179, v179
    s_nop 0
    v_add_f32 v210, v160, v161
    v_add_f32 v210, v210, v162
    v_add_f32 v210, v210, v163
    v_add_f32 v210, v210, v164
    v_add_f32 v210, v210, v165
    v_add_f32 v210, v210, v166
    v_add_f32 v210, v210, v167
    v_add_f32 v210, v210, v168
    v_add_f32 v210, v210, v169
    v_add_f32 v210, v210, v170
    v_add_f32 v210, v210, v171
    v_add_f32 v210, v210, v172
    v_add_f32 v210, v210, v173
    v_add_f32 v210, v210, v174
    v_add_f32 v210, v210, v175
    v_add_f32 v210, v210, v176
    v_add_f32 v210, v210, v177
    v_add_f32 v210, v210, v178
    v_add_f32 v210, v210, v179
    v_mov_b32 v209, v210
    s_nop 1
    v_permlane32_swap_b32 v210, v209
    v_add_f32 v210, v210, v209
    v_rcp_f32 v210, v210
    s_nop 0
    v_mul_f32 v160, v160, v210
    v_mul_f32 v161, v161, v210
    v_mul_f32 v162, v162, v210
    v_mul_f32 v163, v163, v210
    v_mul_f32 v164, v164, v210
    v_mul_f32 v165, v165, v210
    v_mul_f32 v166, v166, v210
    v_mul_f32 v167, v167, v210
    v_mul_f32 v168, v168, v210
    v_mul_f32 v169, v169, v210
    v_mul_f32 v170, v170, v210
    v_mul_f32 v171, v171, v210
    v_mul_f32 v172, v172, v210
    v_mul_f32 v173, v173, v210
    v_mul_f32 v174, v174, v210
    v_mul_f32 v175, v175, v210
    v_mul_f32 v176, v176, v210
    v_mul_f32 v177, v177, v210
    v_mul_f32 v178, v178, v210
    v_mul_f32 v179, v179, v210
    s_mul_i32 s25, s40, 81920
    s_mul_i32 s26, s41, 2560
    s_add_u32 s25, s25, s26
    s_add_u32 s25, s25, 214958080
    v_cvt_pk_bf16_f32 v16, v160, v161
    v_cvt_pk_bf16_f32 v17, v162, v163
    v_cvt_pk_bf16_f32 v18, v164, v165
    v_cvt_pk_bf16_f32 v19, v166, v167
    s_nop 1
    v_permlane32_swap_b32 v16, v18
    v_permlane32_swap_b32 v17, v19
    buffer_store_dwordx4 v[16:19], v1, s[8:11], s25 offen offset:512 sc1
    v_cvt_pk_bf16_f32 v20, v168, v169
    v_cvt_pk_bf16_f32 v21, v170, v171
    v_cvt_pk_bf16_f32 v22, v172, v173
    v_cvt_pk_bf16_f32 v23, v174, v175
    s_nop 1
    v_permlane32_swap_b32 v20, v22
    v_permlane32_swap_b32 v21, v23
    buffer_store_dwordx4 v[20:23], v1, s[8:11], s25 offen offset:1536 sc1
    v_cvt_pk_bf16_f32 v24, v176, v177
    v_cvt_pk_bf16_f32 v25, v178, v179
    v_lshlrev_b32 v4, 4, v2
    v_lshl_add_u32 v4, v3, 3, v4
    buffer_store_dwordx2 v[24:25], v4, s[8:11], s25 offen sc1
    s_waitcnt vmcnt(0)
    s_mov_b64 exec, 1
    s_lshl_b32 s24, s40, 7
    s_lshl_b32 s25, s41, 2
    s_add_u32 s24, s24, s25
    s_add_u32 s24, s24, 53248
    v_mov_b32 v2, s24
    v_mov_b32 v3, 1
    buffer_store_dword v3, v2, s[8:11], s48 offen sc1
    s_mov_b64 exec, -1
    s_branch layerb1_kernel_j_next
layerb1_kernel_j_b:
    s_sub_u32 s41, s41, 8
    v_lshlrev_b32 v1, 4, v0
    v_and_b32 v2, 31, v0
    v_lshrrev_b32 v3, 5, v0
    v_lshrrev_b32 v4, 3, v2
    v_mul_u32_u24 v4, 20480, v4
    v_and_b32 v5, 7, v2
    v_lshl_add_u32 v4, v5, 4, v4
    v_lshl_add_u32 v4, v3, 7, v4
    s_mul_i32 s24, s40, 1638400
    s_mul_i32 s25, s41, 163840
    s_add_u32 s24, s24, s25
    s_mul_i32 s25, s13, 5120
    s_add_u32 s24, s24, s25
    s_add_u32 s24, s24, 103809024
    s_add_u32 s28, s24, 81920
    s_mul_i32 s25, s40, 81920
    s_mul_i32 s26, s13, 20480
    s_add_u32 s25, s25, s26
    s_add_u32 s25, s25, 214958080
    v_mul_u32_u24 v6, 1280, v2
    v_lshl_add_u32 v6, v3, 4, v6
    s_mul_i32 s26, s40, 40960
    s_lshl_b32 s27, s41, 7
    s_add_u32 s26, s26, s27
    s_lshl_b32 s27, s13, 5
    s_add_u32 s26, s26, s27
    s_add_u32 s27, s26, 226492416
    buffer_load_dwordx4 v[8:11], v6, s[8:11], s27 offen sc1
    s_add_u32 s29, s24, 4096
    s_add_u32 s30, s28, 4096
    s_mov_b32 exec_lo, 0
    s_mov_b32 exec_hi, -1
    buffer_load_dwordx4 a[0:3], v4, s[8:11], s24 offen offset:0 sc1
    buffer_load_dwordx4 a[80:83], v4, s[8:11], s28 offen offset:0 sc1
    s_mov_b64 exec, -1
    buffer_load_dwordx4 a[4:7], v4, s[8:11], s24 offen offset:256 sc1
    buffer_load_dwordx4 a[84:87], v4, s[8:11], s28 offen offset:256 sc1
    s_mov_b32 exec_lo, -1
    s_mov_b32 exec_hi, 0
    buffer_load_dwordx4 a[8:11], v4, s[8:11], s24 offen offset:512 sc1
    buffer_load_dwordx4 a[88:91], v4, s[8:11], s28 offen offset:512 sc1
    s_mov_b64 exec, -1
    buffer_load_dwordx4 a[12:15], v4, s[8:11], s24 offen offset:768 sc1
    buffer_load_dwordx4 a[92:95], v4, s[8:11], s28 offen offset:768 sc1
    buffer_load_dwordx4 a[16:19], v4, s[8:11], s24 offen offset:1024 sc1
    buffer_load_dwordx4 a[96:99], v4, s[8:11], s28 offen offset:1024 sc1
    s_mov_b32 exec_lo, 0
    s_mov_b32 exec_hi, -1
    buffer_load_dwordx4 a[20:23], v4, s[8:11], s24 offen offset:1280 sc1
    buffer_load_dwordx4 a[100:103], v4, s[8:11], s28 offen offset:1280 sc1
    s_mov_b64 exec, -1
    buffer_load_dwordx4 a[24:27], v4, s[8:11], s24 offen offset:1536 sc1
    buffer_load_dwordx4 a[104:107], v4, s[8:11], s28 offen offset:1536 sc1
    s_mov_b32 exec_lo, -1
    s_mov_b32 exec_hi, 0
    buffer_load_dwordx4 a[28:31], v4, s[8:11], s24 offen offset:1792 sc1
    buffer_load_dwordx4 a[108:111], v4, s[8:11], s28 offen offset:1792 sc1
    s_mov_b64 exec, -1
    buffer_load_dwordx4 a[32:35], v4, s[8:11], s24 offen offset:2048 sc1
    buffer_load_dwordx4 a[112:115], v4, s[8:11], s28 offen offset:2048 sc1
    buffer_load_dwordx4 a[36:39], v4, s[8:11], s24 offen offset:2304 sc1
    buffer_load_dwordx4 a[116:119], v4, s[8:11], s28 offen offset:2304 sc1
    s_mov_b32 exec_lo, 0
    s_mov_b32 exec_hi, -1
    buffer_load_dwordx4 a[40:43], v4, s[8:11], s24 offen offset:2560 sc1
    buffer_load_dwordx4 a[120:123], v4, s[8:11], s28 offen offset:2560 sc1
    s_mov_b64 exec, -1
    buffer_load_dwordx4 a[44:47], v4, s[8:11], s24 offen offset:2816 sc1
    buffer_load_dwordx4 a[124:127], v4, s[8:11], s28 offen offset:2816 sc1
    s_mov_b32 exec_lo, -1
    s_mov_b32 exec_hi, 0
    buffer_load_dwordx4 a[48:51], v4, s[8:11], s24 offen offset:3072 sc1
    buffer_load_dwordx4 a[128:131], v4, s[8:11], s28 offen offset:3072 sc1
    s_mov_b64 exec, -1
    buffer_load_dwordx4 a[52:55], v4, s[8:11], s24 offen offset:3328 sc1
    buffer_load_dwordx4 a[132:135], v4, s[8:11], s28 offen offset:3328 sc1
    buffer_load_dwordx4 a[56:59], v4, s[8:11], s24 offen offset:3584 sc1
    buffer_load_dwordx4 a[136:139], v4, s[8:11], s28 offen offset:3584 sc1
    s_mov_b32 exec_lo, 0
    s_mov_b32 exec_hi, -1
    buffer_load_dwordx4 a[60:63], v4, s[8:11], s24 offen offset:3840 sc1
    buffer_load_dwordx4 a[140:143], v4, s[8:11], s28 offen offset:3840 sc1
    s_mov_b64 exec, -1
    buffer_load_dwordx4 a[64:67], v4, s[8:11], s29 offen offset:0 sc1
    buffer_load_dwordx4 a[144:147], v4, s[8:11], s30 offen offset:0 sc1
    s_mov_b32 exec_lo, -1
    s_mov_b32 exec_hi, 0
    buffer_load_dwordx4 a[68:71], v4, s[8:11], s29 offen offset:256 sc1
    buffer_load_dwordx4 a[148:151], v4, s[8:11], s30 offen offset:256 sc1
    s_mov_b64 exec, -1
    buffer_load_dwordx4 a[72:75], v4, s[8:11], s29 offen offset:512 sc1
    buffer_load_dwordx4 a[152:155], v4, s[8:11], s30 offen offset:512 sc1
    buffer_load_dwordx4 a[76:79], v4, s[8:11], s29 offen offset:768 sc1
    buffer_load_dwordx4 a[156:159], v4, s[8:11], s30 offen offset:768 sc1
    s_cmp_eq_u32 s44, 0
    s_cbranch_scc1 layerb1_kernel_j_bf
    s_cmp_lg_u32 s13, 0
    s_cbranch_scc1 layerb1_kernel_j_bw
    s_lshl_b32 s31, s41, 10
    s_add_u32 s31, s31, 20480
    v_lshlrev_b32 v212, 7, v0
    v_add_u32 v212, s31, v212
    v_mov_b32 v215, s42
    v_mov_b32 v214, -1
    s_lshl_b32 s31, s40, 7
    s_add_u32 s31, s31, 53216
    v_lshl_add_u32 v213, v0, 2, s31
    v_cmp_le_u32 vcc, 8, v0
    s_nop 1
    v_cndmask_b32 v212, v212, v213, vcc
    v_cndmask_b32 v215, v215, 1, vcc
    s_mov_b32 exec_lo, 0xffffffff
    s_mov_b32 exec_hi, 0xff
layerb1_kernel_j_lb:
    buffer_load_dword v213, v212, s[8:11], s48 offen sc1
    s_waitcnt vmcnt(0)
    v_and_b32 v213, v213, v214
    v_cmp_gt_u32 vcc, v215, v213
    s_sub_u32 s15, s15, 1
    s_cbranch_scc1 layerb1_kernel_bail
    s_cbranch_vccnz layerb1_kernel_j_lb
    s_mov_b64 exec, -1
layerb1_kernel_j_bw:
    s_barrier
layerb1_kernel_j_bf:
    buffer_load_dwordx4 a[160:163], v1, s[8:11], s25 offen offset:0 sc1
    s_mov_b32 exec_lo, -1
    s_mov_b32 exec_hi, 0
    buffer_load_dwordx4 a[0:3], v4, s[8:11], s24 offen offset:0 sc1
    buffer_load_dwordx4 a[80:83], v4, s[8:11], s28 offen offset:0 sc1
    s_mov_b64 exec, -1
    buffer_load_dwordx4 a[164:167], v1, s[8:11], s25 offen offset:1024 sc1
    buffer_load_dwordx4 a[168:171], v1, s[8:11], s25 offen offset:2048 sc1
    s_mov_b32 exec_lo, 0
    s_mov_b32 exec_hi, -1
    buffer_load_dwordx4 a[8:11], v4, s[8:11], s24 offen offset:512 sc1
    buffer_load_dwordx4 a[88:91], v4, s[8:11], s28 offen offset:512 sc1
    s_mov_b64 exec, -1
    buffer_load_dwordx4 a[172:175], v1, s[8:11], s25 offen offset:3072 sc1
    s_add_u32 s25, s25, 4096
    buffer_load_dwordx4 a[176:179], v1, s[8:11], s25 offen offset:0 sc1
    buffer_load_dwordx4 a[180:183], v1, s[8:11], s25 offen offset:1024 sc1
    s_mov_b32 exec_lo, -1
    s_mov_b32 exec_hi, 0
    buffer_load_dwordx4 a[20:23], v4, s[8:11], s24 offen offset:1280 sc1
    buffer_load_dwordx4 a[100:103], v4, s[8:11], s28 offen offset:1280 sc1
    s_mov_b64 exec, -1
    buffer_load_dwordx4 a[184:187], v1, s[8:11], s25 offen offset:2048 sc1
    buffer_load_dwordx4 a[188:191], v1, s[8:11], s25 offen offset:3072 sc1
    s_mov_b32 exec_lo, 0
    s_mov_b32 exec_hi, -1
    buffer_load_dwordx4 a[28:31], v4, s[8:11], s24 offen offset:1792 sc1
    buffer_load_dwordx4 a[108:111], v4, s[8:11], s28 offen offset:1792 sc1
    s_mov_b64 exec, -1
    s_add_u32 s25, s25, 4096
    buffer_load_dwordx4 a[192:195], v1, s[8:11], s25 offen offset:0 sc1
    buffer_load_dwordx4 a[196:199], v1, s[8:11], s25 offen offset:1024 sc1
    buffer_load_dwordx4 a[200:203], v1, s[8:11], s25 offen offset:2048 sc1
    s_mov_b32 exec_lo, -1
    s_mov_b32 exec_hi, 0
    buffer_load_dwordx4 a[40:43], v4, s[8:11], s24 offen offset:2560 sc1
    buffer_load_dwordx4 a[120:123], v4, s[8:11], s28 offen offset:2560 sc1
    s_mov_b64 exec, -1
    buffer_load_dwordx4 a[204:207], v1, s[8:11], s25 offen offset:3072 sc1
    s_add_u32 s25, s25, 4096
    buffer_load_dwordx4 a[208:211], v1, s[8:11], s25 offen offset:0 sc1
    s_mov_b32 exec_lo, 0
    s_mov_b32 exec_hi, -1
    buffer_load_dwordx4 a[48:51], v4, s[8:11], s24 offen offset:3072 sc1
    buffer_load_dwordx4 a[128:131], v4, s[8:11], s28 offen offset:3072 sc1
    s_mov_b64 exec, -1
    buffer_load_dwordx4 a[212:215], v1, s[8:11], s25 offen offset:1024 sc1
    buffer_load_dwordx4 a[216:219], v1, s[8:11], s25 offen offset:2048 sc1
    buffer_load_dwordx4 a[220:223], v1, s[8:11], s25 offen offset:3072 sc1
    s_mov_b32 exec_lo, -1
    s_mov_b32 exec_hi, 0
    buffer_load_dwordx4 a[60:63], v4, s[8:11], s24 offen offset:3840 sc1
    buffer_load_dwordx4 a[140:143], v4, s[8:11], s28 offen offset:3840 sc1
    s_mov_b64 exec, -1
    s_add_u32 s25, s25, 4096
    buffer_load_dwordx4 a[224:227], v1, s[8:11], s25 offen offset:0 sc1
    buffer_load_dwordx4 a[228:231], v1, s[8:11], s25 offen offset:1024 sc1
    s_mov_b32 exec_lo, 0
    s_mov_b32 exec_hi, -1
    buffer_load_dwordx4 a[68:71], v4, s[8:11], s29 offen offset:256 sc1
    buffer_load_dwordx4 a[148:151], v4, s[8:11], s30 offen offset:256 sc1
    s_mov_b64 exec, -1
    buffer_load_dwordx4 a[232:235], v1, s[8:11], s25 offen offset:2048 sc1
    buffer_load_dwordx4 a[236:239], v1, s[8:11], s25 offen offset:3072 sc1
    s_nop 3
    s_waitcnt vmcnt(33)
    v_mfma_f32_32x32x16_bf16 v[16:31], a[0:3], a[160:163], 0
    v_mfma_f32_32x32x16_bf16 v[32:47], a[80:83], a[160:163], 0
    s_waitcnt vmcnt(32)
    v_mfma_f32_32x32x16_bf16 v[16:31], a[4:7], a[164:167], v[16:31]
    v_mfma_f32_32x32x16_bf16 v[32:47], a[84:87], a[164:167], v[32:47]
    s_waitcnt vmcnt(29)
    v_mfma_f32_32x32x16_bf16 v[16:31], a[8:11], a[168:171], v[16:31]
    v_mfma_f32_32x32x16_bf16 v[32:47], a[88:91], a[168:171], v[32:47]
    s_waitcnt vmcnt(28)
    v_mfma_f32_32x32x16_bf16 v[16:31], a[12:15], a[172:175], v[16:31]
    v_mfma_f32_32x32x16_bf16 v[32:47], a[92:95], a[172:175], v[32:47]
    s_waitcnt vmcnt(27)
    v_mfma_f32_32x32x16_bf16 v[16:31], a[16:19], a[176:179], v[16:31]
    v_mfma_f32_32x32x16_bf16 v[32:47], a[96:99], a[176:179], v[32:47]
    s_waitcnt vmcnt(24)
    v_mfma_f32_32x32x16_bf16 v[16:31], a[20:23], a[180:183], v[16:31]
    v_mfma_f32_32x32x16_bf16 v[32:47], a[100:103], a[180:183], v[32:47]
    s_waitcnt vmcnt(23)
    v_mfma_f32_32x32x16_bf16 v[16:31], a[24:27], a[184:187], v[16:31]
    v_mfma_f32_32x32x16_bf16 v[32:47], a[104:107], a[184:187], v[32:47]
    s_waitcnt vmcnt(20)
    v_mfma_f32_32x32x16_bf16 v[16:31], a[28:31], a[188:191], v[16:31]
    v_mfma_f32_32x32x16_bf16 v[32:47], a[108:111], a[188:191], v[32:47]
    s_waitcnt vmcnt(19)
    v_mfma_f32_32x32x16_bf16 v[16:31], a[32:35], a[192:195], v[16:31]
    v_mfma_f32_32x32x16_bf16 v[32:47], a[112:115], a[192:195], v[32:47]
    s_waitcnt vmcnt(18)
    v_mfma_f32_32x32x16_bf16 v[16:31], a[36:39], a[196:199], v[16:31]
    v_mfma_f32_32x32x16_bf16 v[32:47], a[116:119], a[196:199], v[32:47]
    s_waitcnt vmcnt(15)
    v_mfma_f32_32x32x16_bf16 v[16:31], a[40:43], a[200:203], v[16:31]
    v_mfma_f32_32x32x16_bf16 v[32:47], a[120:123], a[200:203], v[32:47]
    s_waitcnt vmcnt(14)
    v_mfma_f32_32x32x16_bf16 v[16:31], a[44:47], a[204:207], v[16:31]
    v_mfma_f32_32x32x16_bf16 v[32:47], a[124:127], a[204:207], v[32:47]
    s_waitcnt vmcnt(11)
    v_mfma_f32_32x32x16_bf16 v[16:31], a[48:51], a[208:211], v[16:31]
    v_mfma_f32_32x32x16_bf16 v[32:47], a[128:131], a[208:211], v[32:47]
    s_waitcnt vmcnt(10)
    v_mfma_f32_32x32x16_bf16 v[16:31], a[52:55], a[212:215], v[16:31]
    v_mfma_f32_32x32x16_bf16 v[32:47], a[132:135], a[212:215], v[32:47]
    s_waitcnt vmcnt(9)
    v_mfma_f32_32x32x16_bf16 v[16:31], a[56:59], a[216:219], v[16:31]
    v_mfma_f32_32x32x16_bf16 v[32:47], a[136:139], a[216:219], v[32:47]
    s_waitcnt vmcnt(6)
    v_mfma_f32_32x32x16_bf16 v[16:31], a[60:63], a[220:223], v[16:31]
    v_mfma_f32_32x32x16_bf16 v[32:47], a[140:143], a[220:223], v[32:47]
    s_waitcnt vmcnt(5)
    v_mfma_f32_32x32x16_bf16 v[16:31], a[64:67], a[224:227], v[16:31]
    v_mfma_f32_32x32x16_bf16 v[32:47], a[144:147], a[224:227], v[32:47]
    s_waitcnt vmcnt(2)
    v_mfma_f32_32x32x16_bf16 v[16:31], a[68:71], a[228:231], v[16:31]
    v_mfma_f32_32x32x16_bf16 v[32:47], a[148:151], a[228:231], v[32:47]
    s_waitcnt vmcnt(1)
    v_mfma_f32_32x32x16_bf16 v[16:31], a[72:75], a[232:235], v[16:31]
    v_mfma_f32_32x32x16_bf16 v[32:47], a[152:155], a[232:235], v[32:47]
    s_waitcnt vmcnt(0)
    v_mfma_f32_32x32x16_bf16 v[16:31], a[76:79], a[236:239], v[16:31]
    v_mfma_f32_32x32x16_bf16 v[32:47], a[156:159], a[236:239], v[32:47]
    s_lshl_b32 s27, s13, 11
    v_add_u32 v7, s27, v1
    s_nop 7
    s_nop 7
    ds_write_b128 v7, v[16:19] offset:0
    ds_write_b128 v7, v[20:23] offset:1024
    ds_write_b128 v7, v[24:27] offset:8192
    ds_write_b128 v7, v[28:31] offset:9216
    ds_write_b128 v7, v[32:35] offset:16384
    ds_write_b128 v7, v[36:39] offset:17408
    ds_write_b128 v7, v[40:43] offset:24576
    ds_write_b128 v7, v[44:47] offset:25600
    s_waitcnt lgkmcnt(0)
    s_barrier
    s_lshl_b32 s27, s13, 13
    v_add_u32 v7, s27, v1
    ds_read_b128 v[48:51], v7 offset:0
    ds_read_b128 v[52:55], v7 offset:1024
    ds_read_b128 v[56:59], v7 offset:2048
    ds_read_b128 v[60:63], v7 offset:3072
    ds_read_b128 v[64:67], v7 offset:4096
    ds_read_b128 v[68:71], v7 offset:5120
    ds_read_b128 v[72:75], v7 offset:6144
    ds_read_b128 v[76:79], v7 offset:7168
    s_waitcnt lgkmcnt(4)
    v_add_f32 v48, v48, v56
    v_add_f32 v49, v49, v57
    v_add_f32 v50, v50, v58
    v_add_f32 v51, v51, v59
    v_add_f32 v52, v52, v60
    v_add_f32 v53, v53, v61
    v_add_f32 v54, v54, v62
    v_add_f32 v55, v55, v63
    s_waitcnt lgkmcnt(0)
    v_add_f32 v64, v64, v72
    v_add_f32 v65, v65, v73
    v_add_f32 v66, v66, v74
    v_add_f32 v67, v67, v75
    v_add_f32 v68, v68, v76
    v_add_f32 v69, v69, v77
    v_add_f32 v70, v70, v78
    v_add_f32 v71, v71, v79
    v_add_f32 v48, v48, v64
    v_add_f32 v49, v49, v65
    v_add_f32 v50, v50, v66
    v_add_f32 v51, v51, v67
    v_add_f32 v52, v52, v68
    v_add_f32 v53, v53, v69
    v_add_f32 v54, v54, v70
    v_add_f32 v55, v55, v71
    v_cvt_pk_bf16_f32 v16, v48, v49
    v_cvt_pk_bf16_f32 v17, v50, v51
    v_cvt_pk_bf16_f32 v18, v52, v53
    v_cvt_pk_bf16_f32 v19, v54, v55
    s_nop 1
    v_permlane32_swap_b32 v16, v18
    v_permlane32_swap_b32 v17, v19
    s_nop 1
    v_lshlrev_b32 v48, 16, v16
    v_and_b32 v49, 0xffff0000, v16
    v_lshlrev_b32 v50, 16, v8
    v_and_b32 v51, 0xffff0000, v8
    v_add_f32 v48, v48, v50
    v_add_f32 v49, v49, v51
    v_cvt_pk_bf16_f32 v16, v48, v49
    v_lshlrev_b32 v48, 16, v17
    v_and_b32 v49, 0xffff0000, v17
    v_lshlrev_b32 v50, 16, v9
    v_and_b32 v51, 0xffff0000, v9
    v_add_f32 v48, v48, v50
    v_add_f32 v49, v49, v51
    v_cvt_pk_bf16_f32 v17, v48, v49
    v_lshlrev_b32 v48, 16, v18
    v_and_b32 v49, 0xffff0000, v18
    v_lshlrev_b32 v50, 16, v10
    v_and_b32 v51, 0xffff0000, v10
    v_add_f32 v48, v48, v50
    v_add_f32 v49, v49, v51
    v_cvt_pk_bf16_f32 v18, v48, v49
    v_lshlrev_b32 v48, 16, v19
    v_and_b32 v49, 0xffff0000, v19
    v_lshlrev_b32 v50, 16, v11
    v_and_b32 v51, 0xffff0000, v11
    v_add_f32 v48, v48, v50
    v_add_f32 v49, v49, v51
    v_cvt_pk_bf16_f32 v19, v48, v49
    buffer_store_dwordx4 v[16:19], v6, s[84:87], s26 offen
    s_branch layerb1_kernel_j_next
layerb1_kernel_j_giveup:
    s_mov_b64 exec, -1
    v_mov_b32 v2, s43
    v_mov_b32 v3, -1
    ds_write_b32 v2, v3
    s_waitcnt lgkmcnt(0)
    s_barrier
    s_branch layerb1_kernel_bail
layerb1_kernel_j_done:
    s_branch layerb1_kernel_end
layerb1_kernel_bail:
    s_mov_b64 exec, 1
    s_load_dwordx2 s[6:7], s[0:1], 88
    s_waitcnt lgkmcnt(0)
    s_mov_b32 s24, s6
    s_mov_b32 s25, s7
    s_mov_b32 s26, 256
    s_mov_b32 s27, 0x00020000
    v_mov_b32 v1, 0xdead
    v_mov_b32 v2, s14
    v_mov_b32 v3, 0
    buffer_store_dword v1, v3, s[24:27], 0 offen
    buffer_store_dword v2, v3, s[24:27], 0 offen offset:4
layerb1_kernel_end:
layerb1_kernel_end0:
    s_endpgm
.section .rodata,"a"
.p2align 6
.amdhsa_kernel layerb1_kernel
  .amdhsa_next_free_vgpr 512
  .amdhsa_next_free_sgpr 100
  .amdhsa_accum_offset 256
  .amdhsa_group_segment_fixed_size 0
  .amdhsa_kernarg_size 104
  .amdhsa_user_sgpr_count 2
  .amdhsa_user_sgpr_kernarg_segment_ptr 1
  .amdhsa_system_sgpr_workgroup_id_x 1
.end_amdhsa_kernel
```
